```python
import torch

def _softmax(x, axis=-1):
    return torch.softmax(x, dim=axis)
def _gelu(x):
    return torch.nn.functional.gelu(x, approximate="tanh")
def _silu(x):
    return torch.nn.functional.silu(x)
def _sigmoid(x):
    return torch.sigmoid(x)
def _layernorm(x, axis=-1, eps=1e-5):
    m = x.mean(dim=axis, keepdim=True)
    v = x.var(dim=axis, keepdim=True, unbiased=False)
    return (x - m) / torch.sqrt(v + eps)
def _scatter_add(tgt, idx, src, axis=0):
    return tgt.clone().index_add_(axis, idx, src)
def _segment_sum(src, seg, n):
    out = torch.zeros((n,) + src.shape[1:], dtype=src.dtype)
    return out.index_add_(0, seg, src)
def _pad(x, pw):
    flat = tuple(v for pair in reversed(pw) for v in pair)
    return torch.nn.functional.pad(x, flat)

kernel_name = 'interleave_layers__sliding_local_dilated__dense_activation_gelu__prompt'

def setup_inputs():

    _w = (lambda a: (lambda t: t.to(torch.bfloat16) if t.is_floating_point() else t)(torch.as_tensor(a)))
    def _A_setup():
        B, S, D = 1, 2048, 1024
        return {
            "x": _w((lambda *s: torch.randn(*s, dtype=torch.bfloat16) * 0.05)(B, S, D)),
            "wqkv": _w((lambda *s: torch.randn(*s, dtype=torch.bfloat16) * 0.05)(D, 3 * D)),
            "wo": _w((lambda *s: torch.randn(*s, dtype=torch.bfloat16) * 0.05)(D, D)),
        }
    _A_in = _A_setup()

    def _B_setup():
        B, S, D, F = 1, 2048, 1024, 3584
        return {
            "x": _w((lambda *s: torch.randn(*s, dtype=torch.bfloat16) * 0.05)(B, S, D)),
            "w1": _w((lambda *s: torch.randn(*s, dtype=torch.bfloat16) * 1.6)(D, F) * (D ** -0.5)),
            "b1": _w((lambda *s: torch.randn(*s, dtype=torch.bfloat16) * 1.6)(F) * 0.01),
            "w2": _w((lambda *s: torch.randn(*s, dtype=torch.bfloat16) * 1.6)(F, D) * (F ** -0.5)),
            "b2": _w((lambda *s: torch.randn(*s, dtype=torch.bfloat16) * 1.6)(D) * 0.01),
        }
    _B_in = _B_setup()

    return {
        "A_x": _A_in["x"],
        "A_wqkv": _A_in["wqkv"],
        "A_wo": _A_in["wo"],
        "B_x": _B_in["x"],
        "B_w1": _B_in["w1"],
        "B_b1": _B_in["b1"],
        "B_w2": _B_in["w2"],
        "B_b2": _B_in["b2"],
    }

def reference(A_x, A_wqkv, A_wo, B_x, B_w1, B_b1, B_w2, B_b2):
    def _A_ref(x, wqkv, wo):
        B, S, D = x.shape
        H = 32; Dh = D // H
        W, dil = 8, 2
        qkv = (lambda x, *d: x.permute(*d))((x @ wqkv).reshape(B, S, 3, H, Dh), 2, 0, 3, 1, 4)
        q, k, v = qkv[0], qkv[1], qkv[2]
        scale = Dh ** -0.5
        pos = torch.arange(S)
        off = torch.arange(W) * dil
        idx = pos[:, None] - off[None, :]
        mask = idx >= 0
        idx_c = torch.where(mask, idx, 0).reshape(-1)
        kg = k[:, :, idx_c, :].reshape(B, H, S, W, Dh)
        vg = v[:, :, idx_c, :].reshape(B, H, S, W, Dh)
        logits = torch.einsum("bhsd,bhswd->bhsw", q, kg) * scale
        logits = torch.where(mask[None, None, :, :], logits, -1e9)
        attn = _softmax(logits, axis=-1)
        o = torch.einsum("bhsw,bhswd->bhsd", attn, vg)
        return (lambda x, *d: x.permute(*d))(o, 0, 2, 1, 3).reshape(B, S, D) @ wo

    def _B_ref(x, w1, b1, w2, b2):
        h = torch.einsum("bsd,df->bsf", x, w1) + b1
        h = _gelu(h)
        return torch.einsum("bsf,fd->bsd", h, w2) + b2

    x = A_x
    x = x + _A_ref(_layernorm(x, axis=-1), A_wqkv, A_wo)
    x = x + _B_ref(_layernorm(x, axis=-1), B_w1, B_b1, B_w2, B_b2)
    x = x + _A_ref(_layernorm(x, axis=-1), A_wqkv, A_wo)
    x = x + _B_ref(_layernorm(x, axis=-1), B_w1, B_b1, B_w2, B_b2)
    return x
```

```asm
; @launch kernel=attnl0_kernel grid=(256,1,1) block=(512,1,1) lds=130304
; @launch kernel=wol0_kernel grid=(256,1,1) block=(512,1,1) lds=147456
; @launch kernel=w1l0_kernel grid=(256,1,1) block=(512,1,1) lds=150784
; @launch kernel=w2l0_kernel grid=(256,1,1) block=(512,1,1) lds=147456
; @launch kernel=attnl1_kernel grid=(256,1,1) block=(512,1,1) lds=130304
; @launch kernel=wol1_kernel grid=(256,1,1) block=(512,1,1) lds=147456
; @launch kernel=w1l1_kernel grid=(256,1,1) block=(512,1,1) lds=150784
; @launch kernel=w2l1_kernel grid=(256,1,1) block=(512,1,1) lds=147456
.amdgcn_target "amdgcn-amd-amdhsa--gfx950"
L_attn_c0:
.text
.globl attnl0_kernel
.p2align 8
.type attnl0_kernel,@function
attnl0_kernel:
  s_load_dwordx16 s[16:31], s[0:1], 0
  s_load_dwordx2 s[32:33], s[0:1], 64
  s_load_dwordx2 s[34:35], s[0:1], 80
  s_load_dwordx2 s[12:13], s[0:1], 0
  s_mov_b32 s96, 0
L_attn_body:
  s_cmp_ge_u32 s2, 256
  s_cbranch_scc1 L_attn_end
  v_lshrrev_b32 v2, 6, v0
  v_and_b32 v1, 63, v0
  v_readfirstlane_b32 s70, v2
  s_and_b32 s3, s2, 7
  s_lshr_b32 s99, s2, 3
  s_and_b32 s5, s3, 1
  s_lshl_b32 s5, s5, 3
  s_and_b32 s6, s99, 7
  s_add_u32 s68, s5, s6
  s_lshr_b32 s5, s3, 1
  s_lshl_b32 s5, s5, 2
  s_lshr_b32 s6, s99, 3
  s_add_u32 s69, s5, s6
  s_cmp_ge_u32 s70, 4
  s_cbranch_scc1 L_attn_loader
  s_and_b32 s71, s70, 1
  s_lshr_b32 s72, s70, 1
  v_and_b32 v3, 31, v1
  v_lshlrev_b32 v3, 2, v3
  v_add_u32 v3, 40960, v3
  v_mov_b32 v236, 0x3f803f80
  v_mov_b32 v237, 0x3f803f80
  v_mov_b32 v238, 0x3f803f80
  v_mov_b32 v239, 0x3f803f80
  ds_write_b32 v3, v236
  ds_write_b32 v3, v236 offset:43008
  v_add_u32 v3, 86016, v3
  ds_write_b32 v3, v236
  v_and_b32 v3, 15, v1
  v_lshrrev_b32 v2, 4, v1
  v_lshrrev_b32 v33, 1, v3
  s_lshl_b32 s8, s71, 13
  v_xor_b32 v4, v2, v33
  v_lshlrev_b32 v4, 4, v4
  v_lshl_add_u32 v4, v3, 7, v4
  v_add_u32 v8, 40960, v4
  v_add_u32 v4, s8, v4
  v_add_u32 v5, 4, v2
  v_xor_b32 v5, v5, v33
  v_lshlrev_b32 v5, 4, v5
  v_lshl_add_u32 v5, v3, 7, v5
  v_add_u32 v9, 40960, v5
  v_add_u32 v5, s8, v5
  v_bfe_u32 v34, v1, 2, 2
  v_lshl_add_u32 v34, v2, 3, v34
  v_lshlrev_b32 v34, 7, v34
  v_and_b32 v33, 3, v1
  v_lshl_add_u32 v34, v33, 3, v34
  v_bfe_u32 v33, v1, 3, 2
  v_lshl_add_u32 v34, v33, 5, v34
  v_and_b32 v35, 1, v2
  v_xor_b32 v35, s71, v35
  s_lshl_b32 s8, s70, 5
  v_xor_b32 v34, s8, v34
  v_add_u32 v6, 16384, v34
  v_xor_b32 v7, 32, v6
  s_lshl_b32 s8, s68, 7
  s_lshl_b32 s9, s71, 6
  s_add_u32 s8, s8, s9
  v_add_u32 v33, s8, v3
  s_lshl_b32 s10, s69, 7
  s_lshl_b32 s11, s72, 6
  s_add_u32 s10, s10, s11
  v_lshl_add_u32 v33, v33, 11, s10
  v_lshl_add_u32 v33, v35, 5, v33
  v_lshrrev_b32 v34, 1, v2
  v_lshl_add_u32 v31, v34, 4, v33
  s_mul_i32 s10, s72, 12288
  s_add_u32 s10, s10, 1024
  s_lshl_b32 s11, s71, 10
  s_add_u32 s4, s10, s11
  s_sub_u32 s5, s10, s11
  s_mul_i32 s6, s71, 6144
  v_lshl_add_u32 v16, v1, 4, s4
  v_add_u32 v17, s6, v16
  v_lshl_add_u32 v18, v1, 4, s5
  v_add_u32 v18, s6, v18
  v_lshl_add_u32 v19, v2, 8, s4
  v_lshl_add_u32 v20, v2, 8, s5
  v_lshl_add_u32 v21, v3, 4, s4
  v_lshl_add_u32 v22, v3, 4, s5
  s_lshl_b32 s10, s71, 8
  s_add_u32 s10, s10, 129024
  v_lshl_add_u32 v23, v3, 2, s10
  v_lshl_add_u32 v24, v2, 4, s10
  v_and_b32 v33, 1, v3
  v_cmp_eq_u32 s[48:49], 1, v33
  v_lshl_add_u32 v34, v2, 2, v33
  v_add_u32 v35, 2, v34
  v_cmp_gt_u32 s[50:51], v34, v3
  v_cmp_gt_u32 s[52:53], v35, v3
  v_mov_b32 v36, 0xffff
  v_mov_b32 v37, 0xffff0000
  v_cndmask_b32 v36, v36, v37, s[48:49]
  s_add_u32 s10, s10, 704
  v_lshl_add_u32 v34, v34, 2, s10
  v_lshl_add_u32 v35, v35, 2, s10
  v_subrev_u32 v38, 64, v34
  v_subrev_u32 v39, 64, v35
  v_cndmask_b32 v25, v34, v38, s[50:51]
  v_cndmask_b32 v26, v35, v39, s[52:53]
  v_cndmask_b32 v27, 0, v36, s[50:51]
  v_cndmask_b32 v29, 0, v36, s[52:53]
  v_xor_b32 v28, v27, v36
  v_xor_b32 v30, v29, v36
  s_cmp_eq_u32 s8, 0
  s_cselect_b64 s[54:55], s[50:51], 0
  s_cselect_b64 s[14:15], s[52:53], 0
  v_mov_b32 v128, 0
  v_mov_b32 v129, 0
  v_mov_b32 v130, 0
  v_mov_b32 v131, 0
  v_mov_b32 v132, 0
  v_mov_b32 v133, 0
  v_mov_b32 v134, 0
  v_mov_b32 v135, 0
  v_mov_b32 v136, 0
  v_mov_b32 v137, 0
  v_mov_b32 v138, 0
  v_mov_b32 v139, 0
  v_mov_b32 v140, 0
  v_mov_b32 v141, 0
  v_mov_b32 v142, 0
  v_mov_b32 v143, 0
  v_mov_b32 v144, 0
  v_mov_b32 v145, 0
  v_mov_b32 v146, 0
  v_mov_b32 v147, 0
  v_mov_b32 v148, 0
  v_mov_b32 v149, 0
  v_mov_b32 v150, 0
  v_mov_b32 v151, 0
  v_mov_b32 v152, 0
  v_mov_b32 v153, 0
  v_mov_b32 v154, 0
  v_mov_b32 v155, 0
  v_mov_b32 v156, 0
  v_mov_b32 v157, 0
  v_mov_b32 v158, 0
  v_mov_b32 v159, 0
  v_mov_b32 v160, 0
  v_mov_b32 v161, 0
  v_mov_b32 v162, 0
  v_mov_b32 v163, 0
  v_mov_b32 v164, 0
  v_mov_b32 v165, 0
  v_mov_b32 v166, 0
  v_mov_b32 v167, 0
  v_mov_b32 v168, 0
  v_mov_b32 v169, 0
  v_mov_b32 v170, 0
  v_mov_b32 v171, 0
  v_mov_b32 v172, 0
  v_mov_b32 v173, 0
  v_mov_b32 v174, 0
  v_mov_b32 v175, 0
  v_mov_b32 v176, 0
  v_mov_b32 v177, 0
  v_mov_b32 v178, 0
  v_mov_b32 v179, 0
  v_mov_b32 v180, 0
  v_mov_b32 v181, 0
  v_mov_b32 v182, 0
  v_mov_b32 v183, 0
  v_mov_b32 v184, 0
  v_mov_b32 v185, 0
  v_mov_b32 v186, 0
  v_mov_b32 v187, 0
  v_mov_b32 v188, 0
  v_mov_b32 v189, 0
  v_mov_b32 v190, 0
  v_mov_b32 v191, 0
  v_mov_b32 v192, 0
  v_mov_b32 v193, 0
  v_mov_b32 v194, 0
  v_mov_b32 v195, 0
  v_mov_b32 v196, 0
  v_mov_b32 v197, 0
  v_mov_b32 v198, 0
  v_mov_b32 v199, 0
  v_mov_b32 v200, 0
  v_mov_b32 v201, 0
  v_mov_b32 v202, 0
  v_mov_b32 v203, 0
  v_mov_b32 v204, 0
  v_mov_b32 v205, 0
  v_mov_b32 v206, 0
  v_mov_b32 v207, 0
  v_mov_b32 v208, 0
  v_mov_b32 v209, 0
  v_mov_b32 v210, 0
  v_mov_b32 v211, 0
  v_mov_b32 v212, 0
  v_mov_b32 v213, 0
  v_mov_b32 v214, 0
  v_mov_b32 v215, 0
  v_mov_b32 v216, 0
  v_mov_b32 v217, 0
  v_mov_b32 v218, 0
  v_mov_b32 v219, 0
  v_mov_b32 v220, 0
  v_mov_b32 v221, 0
  v_mov_b32 v222, 0
  v_mov_b32 v223, 0
  v_mov_b32 v224, 0
  v_mov_b32 v225, 0
  v_mov_b32 v226, 0
  v_mov_b32 v227, 0
  v_mov_b32 v228, 0
  v_mov_b32 v229, 0
  v_mov_b32 v230, 0
  v_mov_b32 v231, 0
  v_mov_b32 v232, 0
  v_mov_b32 v233, 0
  v_mov_b32 v234, 0
  v_mov_b32 v235, 0
  s_waitcnt lgkmcnt(0)
  s_mov_b32 s44, s34
  s_and_b32 s45, s35, 0xffff
  s_mov_b32 s46, 4194304
  s_mov_b32 s47, 0x00020000
  s_mov_b32 s75, 0
  v_add_u32 v10, s75, v4
  v_add_u32 v11, s75, v5
  v_add_u32 v12, s75, v6
  v_add_u32 v13, s75, v7
  v_add_u32 v14, s75, v8
  v_add_u32 v15, s75, v9
  s_add_u32 s75, s75, 43008
  s_cmp_eq_u32 s75, 129024
  s_cselect_b32 s75, 0, s75
  s_mov_b32 s79, 16
  s_barrier
  ds_read_b128 v[32:35], v10 offset:0
  ds_read_b128 v[36:39], v10 offset:2048
  ds_read_b128 v[40:43], v10 offset:4096
  ds_read_b128 v[44:47], v10 offset:6144
  ds_read_b128 v[48:51], v14
  ds_read_b64_tr_b16 v[52:53], v12 offset:0
  ds_read_b64_tr_b16 v[54:55], v12 offset:512
  ds_read_b64_tr_b16 v[56:57], v13 offset:0
  ds_read_b64_tr_b16 v[58:59], v13 offset:512
  ds_read_b64_tr_b16 v[60:61], v12 offset:8192
  ds_read_b64_tr_b16 v[62:63], v12 offset:8704
  ds_read_b64_tr_b16 v[64:65], v13 offset:8192
  ds_read_b64_tr_b16 v[66:67], v13 offset:8704
  ds_read_b64_tr_b16 v[68:69], v12 offset:16384
  ds_read_b64_tr_b16 v[70:71], v12 offset:16896
  ds_read_b64_tr_b16 v[72:73], v13 offset:16384
  ds_read_b64_tr_b16 v[74:75], v13 offset:16896
  s_waitcnt lgkmcnt(0)
.p2align 3
L_attn_loop:
  v_mfma_f32_16x16x32_bf16 v[128:131], v[52:55], v[32:35], v[128:131]
  ds_read_b128 v[76:79], v11 offset:0
  v_mfma_f32_16x16x32_bf16 v[132:135], v[52:55], v[36:39], v[132:135]
  ds_read_b128 v[80:83], v11 offset:2048
  v_mfma_f32_16x16x32_bf16 v[136:139], v[52:55], v[40:43], v[136:139]
  ds_read_b128 v[84:87], v11 offset:4096
  v_mfma_f32_16x16x32_bf16 v[140:143], v[52:55], v[44:47], v[140:143]
  ds_read_b128 v[88:91], v11 offset:6144
  v_mfma_f32_16x16x32_bf16 v[224:227], v[52:55], v[48:51], v[224:227]
  ds_read_b128 v[92:95], v15
  v_mfma_f32_16x16x32_bf16 v[144:147], v[56:59], v[32:35], v[144:147]
  ds_read_b64_tr_b16 v[96:97], v12 offset:4096
  v_mfma_f32_16x16x32_bf16 v[148:151], v[56:59], v[36:39], v[148:151]
  ds_read_b64_tr_b16 v[98:99], v12 offset:4608
  v_mfma_f32_16x16x32_bf16 v[152:155], v[56:59], v[40:43], v[152:155]
  ds_read_b64_tr_b16 v[100:101], v13 offset:4096
  v_mfma_f32_16x16x32_bf16 v[156:159], v[56:59], v[44:47], v[156:159]
  ds_read_b64_tr_b16 v[102:103], v13 offset:4608
  v_mfma_f32_16x16x32_bf16 v[160:163], v[60:63], v[32:35], v[160:163]
  ds_read_b64_tr_b16 v[104:105], v12 offset:12288
  v_mfma_f32_16x16x32_bf16 v[164:167], v[60:63], v[36:39], v[164:167]
  ds_read_b64_tr_b16 v[106:107], v12 offset:12800
  v_mfma_f32_16x16x32_bf16 v[168:171], v[60:63], v[40:43], v[168:171]
  ds_read_b64_tr_b16 v[108:109], v13 offset:12288
  v_mfma_f32_16x16x32_bf16 v[172:175], v[60:63], v[44:47], v[172:175]
  ds_read_b64_tr_b16 v[110:111], v13 offset:12800
  v_mfma_f32_16x16x32_bf16 v[228:231], v[60:63], v[48:51], v[228:231]
  ds_read_b64_tr_b16 v[112:113], v12 offset:20480
  v_mfma_f32_16x16x32_bf16 v[176:179], v[64:67], v[32:35], v[176:179]
  ds_read_b64_tr_b16 v[114:115], v12 offset:20992
  v_mfma_f32_16x16x32_bf16 v[180:183], v[64:67], v[36:39], v[180:183]
  ds_read_b64_tr_b16 v[116:117], v13 offset:20480
  v_mfma_f32_16x16x32_bf16 v[184:187], v[64:67], v[40:43], v[184:187]
  ds_read_b64_tr_b16 v[118:119], v13 offset:20992
  v_mfma_f32_16x16x32_bf16 v[188:191], v[64:67], v[44:47], v[188:191]
  v_add_u32 v10, s75, v4
  v_mfma_f32_16x16x32_bf16 v[192:195], v[32:35], v[68:71], v[192:195]
  v_add_u32 v11, s75, v5
  v_mfma_f32_16x16x32_bf16 v[196:199], v[36:39], v[68:71], v[196:199]
  v_add_u32 v12, s75, v6
  v_mfma_f32_16x16x32_bf16 v[200:203], v[40:43], v[68:71], v[200:203]
  v_add_u32 v13, s75, v7
  v_mfma_f32_16x16x32_bf16 v[204:207], v[44:47], v[68:71], v[204:207]
  v_add_u32 v14, s75, v8
  v_mfma_f32_16x16x32_bf16 v[232:235], v[48:51], v[68:71], v[232:235]
  v_add_u32 v15, s75, v9
  v_mfma_f32_16x16x32_bf16 v[208:211], v[32:35], v[72:75], v[208:211]
  s_add_u32 s75, s75, 43008
  v_mfma_f32_16x16x32_bf16 v[212:215], v[36:39], v[72:75], v[212:215]
  s_cmp_eq_u32 s75, 129024
  v_mfma_f32_16x16x32_bf16 v[216:219], v[40:43], v[72:75], v[216:219]
  s_cselect_b32 s75, 0, s75
  v_mfma_f32_16x16x32_bf16 v[220:223], v[44:47], v[72:75], v[220:223]
  s_waitcnt lgkmcnt(0)
  s_barrier
  v_mfma_f32_16x16x32_bf16 v[128:131], v[96:99], v[76:79], v[128:131]
  ds_read_b128 v[32:35], v10 offset:0
  v_mfma_f32_16x16x32_bf16 v[132:135], v[96:99], v[80:83], v[132:135]
  ds_read_b128 v[36:39], v10 offset:2048
  v_mfma_f32_16x16x32_bf16 v[136:139], v[96:99], v[84:87], v[136:139]
  ds_read_b128 v[40:43], v10 offset:4096
  v_mfma_f32_16x16x32_bf16 v[140:143], v[96:99], v[88:91], v[140:143]
  ds_read_b128 v[44:47], v10 offset:6144
  v_mfma_f32_16x16x32_bf16 v[224:227], v[96:99], v[92:95], v[224:227]
  ds_read_b128 v[48:51], v14
  v_mfma_f32_16x16x32_bf16 v[144:147], v[100:103], v[76:79], v[144:147]
  ds_read_b64_tr_b16 v[52:53], v12 offset:0
  v_mfma_f32_16x16x32_bf16 v[148:151], v[100:103], v[80:83], v[148:151]
  ds_read_b64_tr_b16 v[54:55], v12 offset:512
  v_mfma_f32_16x16x32_bf16 v[152:155], v[100:103], v[84:87], v[152:155]
  ds_read_b64_tr_b16 v[56:57], v13 offset:0
  v_mfma_f32_16x16x32_bf16 v[156:159], v[100:103], v[88:91], v[156:159]
  ds_read_b64_tr_b16 v[58:59], v13 offset:512
  v_mfma_f32_16x16x32_bf16 v[160:163], v[104:107], v[76:79], v[160:163]
  ds_read_b64_tr_b16 v[60:61], v12 offset:8192
  v_mfma_f32_16x16x32_bf16 v[164:167], v[104:107], v[80:83], v[164:167]
  ds_read_b64_tr_b16 v[62:63], v12 offset:8704
  v_mfma_f32_16x16x32_bf16 v[168:171], v[104:107], v[84:87], v[168:171]
  ds_read_b64_tr_b16 v[64:65], v13 offset:8192
  v_mfma_f32_16x16x32_bf16 v[172:175], v[104:107], v[88:91], v[172:175]
  ds_read_b64_tr_b16 v[66:67], v13 offset:8704
  v_mfma_f32_16x16x32_bf16 v[228:231], v[104:107], v[92:95], v[228:231]
  ds_read_b64_tr_b16 v[68:69], v12 offset:16384
  v_mfma_f32_16x16x32_bf16 v[176:179], v[108:111], v[76:79], v[176:179]
  ds_read_b64_tr_b16 v[70:71], v12 offset:16896
  v_mfma_f32_16x16x32_bf16 v[180:183], v[108:111], v[80:83], v[180:183]
  ds_read_b64_tr_b16 v[72:73], v13 offset:16384
  v_mfma_f32_16x16x32_bf16 v[184:187], v[108:111], v[84:87], v[184:187]
  ds_read_b64_tr_b16 v[74:75], v13 offset:16896
  v_mfma_f32_16x16x32_bf16 v[188:191], v[108:111], v[88:91], v[188:191]
  s_sub_u32 s79, s79, 1
  v_mfma_f32_16x16x32_bf16 v[192:195], v[76:79], v[112:115], v[192:195]
  s_cmp_lg_u32 s79, 0
  v_mfma_f32_16x16x32_bf16 v[196:199], v[80:83], v[112:115], v[196:199]
  v_mfma_f32_16x16x32_bf16 v[200:203], v[84:87], v[112:115], v[200:203]
  v_mfma_f32_16x16x32_bf16 v[204:207], v[88:91], v[112:115], v[204:207]
  v_mfma_f32_16x16x32_bf16 v[232:235], v[92:95], v[112:115], v[232:235]
  v_mfma_f32_16x16x32_bf16 v[208:211], v[76:79], v[116:119], v[208:211]
  v_mfma_f32_16x16x32_bf16 v[212:215], v[80:83], v[116:119], v[212:215]
  v_mfma_f32_16x16x32_bf16 v[216:219], v[84:87], v[116:119], v[216:219]
  v_mfma_f32_16x16x32_bf16 v[220:223], v[88:91], v[116:119], v[220:223]
  s_waitcnt lgkmcnt(0)
  s_cbranch_scc1 L_attn_loop
  ds_read2_b32 v[66:67], v23 offset0:0 offset1:160
  ds_read2_b32 v[68:69], v23 offset0:16 offset1:176
  ds_read2_b32 v[70:71], v23 offset0:32 offset1:192
  ds_read2_b32 v[72:73], v23 offset0:48 offset1:208
  ds_read2_b32 v[74:75], v23 offset0:64 offset1:224
  ds_read2_b32 v[76:77], v25 offset0:0 offset1:16
  ds_read2_b32 v[80:81], v26 offset0:0 offset1:16
  ds_read2_b32 v[78:79], v25 offset0:32 offset1:48
  ds_read2_b32 v[82:83], v26 offset0:32 offset1:48
  ds_write_b128 v16, v[224:227] offset:0
  ds_write_b128 v16, v[228:231] offset:2048
  ds_write_b128 v16, v[232:235] offset:4096
  s_cmp_eq_u32 s71, 1
  s_cbranch_scc1 L_attn_nop3
  ds_write_b128 v16, v[172:175] offset:8192
  ds_write_b128 v16, v[188:191] offset:9216
  ds_write_b128 v16, v[204:207] offset:10240
  ds_write_b128 v16, v[220:223] offset:11264
L_attn_nop3:
  ds_read_b128 v[84:87], v24 offset:0
  ds_read_b128 v[104:107], v24 offset:640
  ds_read_b128 v[88:91], v24 offset:64
  ds_read_b128 v[108:111], v24 offset:704
  ds_read_b128 v[92:95], v24 offset:128
  ds_read_b128 v[112:115], v24 offset:768
  ds_read_b128 v[96:99], v24 offset:192
  ds_read_b128 v[116:119], v24 offset:832
  ds_read_b128 v[100:103], v24 offset:256
  ds_read_b128 v[120:123], v24 offset:896
  s_waitcnt lgkmcnt(10)
  s_barrier
  ds_read_b128 v[48:51], v19 offset:0
  ds_read_b128 v[52:55], v20 offset:1024
  ds_read_b128 v[56:59], v19 offset:2048
  ds_read_b128 v[60:63], v20 offset:3072
  ds_read_b32 v64, v21 offset:4096
  ds_read_b32 v65, v22 offset:5120
  ds_read_b128 v[32:35], v17 offset:2048
  ds_read_b128 v[36:39], v18 offset:3072
  ds_read_b128 v[40:43], v17 offset:4096
  ds_read_b128 v[44:47], v18 offset:5120
  v_mul_f32 v69, 0x3e8293ee, v69
  v_mul_f32 v71, 0x3e8293ee, v71
  v_mul_f32 v73, 0x3e8293ee, v73
  v_mul_f32 v75, 0x3e8293ee, v75
  v_mul_f32 v76, v76, v69
  v_mul_f32 v80, v80, v69
  v_mul_f32 v77, v77, v71
  v_mul_f32 v81, v81, v71
  v_mul_f32 v78, v78, v73
  v_mul_f32 v82, v82, v73
  v_mul_f32 v79, v79, v75
  v_mul_f32 v83, v83, v75
  s_waitcnt lgkmcnt(6)
  v_pk_fma_f32 v[128:129], v[48:49], v[68:69], v[128:129] op_sel:[0,0,0] op_sel_hi:[1,0,1] neg_lo:[0,1,0] neg_hi:[0,1,0]
  v_pk_fma_f32 v[130:131], v[50:51], v[68:69], v[130:131] op_sel:[0,0,0] op_sel_hi:[1,0,1] neg_lo:[0,1,0] neg_hi:[0,1,0]
  v_pk_fma_f32 v[144:145], v[52:53], v[68:69], v[144:145] op_sel:[0,0,0] op_sel_hi:[1,0,1] neg_lo:[0,1,0] neg_hi:[0,1,0]
  v_pk_fma_f32 v[146:147], v[54:55], v[68:69], v[146:147] op_sel:[0,0,0] op_sel_hi:[1,0,1] neg_lo:[0,1,0] neg_hi:[0,1,0]
  v_cvt_pk_bf16_f32 v128, v128, v129
  v_cvt_pk_bf16_f32 v129, v130, v131
  v_cvt_pk_bf16_f32 v130, v144, v145
  v_cvt_pk_bf16_f32 v131, v146, v147
  v_pk_fma_f32 v[160:161], v[56:57], v[68:69], v[160:161] op_sel:[0,0,0] op_sel_hi:[1,0,1] neg_lo:[0,1,0] neg_hi:[0,1,0]
  v_pk_fma_f32 v[162:163], v[58:59], v[68:69], v[162:163] op_sel:[0,0,0] op_sel_hi:[1,0,1] neg_lo:[0,1,0] neg_hi:[0,1,0]
  v_pk_fma_f32 v[176:177], v[60:61], v[68:69], v[176:177] op_sel:[0,0,0] op_sel_hi:[1,0,1] neg_lo:[0,1,0] neg_hi:[0,1,0]
  v_pk_fma_f32 v[178:179], v[62:63], v[68:69], v[178:179] op_sel:[0,0,0] op_sel_hi:[1,0,1] neg_lo:[0,1,0] neg_hi:[0,1,0]
  v_cvt_pk_bf16_f32 v160, v160, v161
  v_cvt_pk_bf16_f32 v161, v162, v163
  v_cvt_pk_bf16_f32 v162, v176, v177
  v_cvt_pk_bf16_f32 v163, v178, v179
  v_pk_fma_f32 v[132:133], v[48:49], v[70:71], v[132:133] op_sel:[0,0,0] op_sel_hi:[1,0,1] neg_lo:[0,1,0] neg_hi:[0,1,0]
  v_pk_fma_f32 v[134:135], v[50:51], v[70:71], v[134:135] op_sel:[0,0,0] op_sel_hi:[1,0,1] neg_lo:[0,1,0] neg_hi:[0,1,0]
  v_pk_fma_f32 v[148:149], v[52:53], v[70:71], v[148:149] op_sel:[0,0,0] op_sel_hi:[1,0,1] neg_lo:[0,1,0] neg_hi:[0,1,0]
  v_pk_fma_f32 v[150:151], v[54:55], v[70:71], v[150:151] op_sel:[0,0,0] op_sel_hi:[1,0,1] neg_lo:[0,1,0] neg_hi:[0,1,0]
  v_cvt_pk_bf16_f32 v132, v132, v133
  v_cvt_pk_bf16_f32 v133, v134, v135
  v_cvt_pk_bf16_f32 v134, v148, v149
  v_cvt_pk_bf16_f32 v135, v150, v151
  v_pk_fma_f32 v[164:165], v[56:57], v[70:71], v[164:165] op_sel:[0,0,0] op_sel_hi:[1,0,1] neg_lo:[0,1,0] neg_hi:[0,1,0]
  v_pk_fma_f32 v[166:167], v[58:59], v[70:71], v[166:167] op_sel:[0,0,0] op_sel_hi:[1,0,1] neg_lo:[0,1,0] neg_hi:[0,1,0]
  v_pk_fma_f32 v[180:181], v[60:61], v[70:71], v[180:181] op_sel:[0,0,0] op_sel_hi:[1,0,1] neg_lo:[0,1,0] neg_hi:[0,1,0]
  v_pk_fma_f32 v[182:183], v[62:63], v[70:71], v[182:183] op_sel:[0,0,0] op_sel_hi:[1,0,1] neg_lo:[0,1,0] neg_hi:[0,1,0]
  v_cvt_pk_bf16_f32 v164, v164, v165
  v_cvt_pk_bf16_f32 v165, v166, v167
  v_cvt_pk_bf16_f32 v166, v180, v181
  v_cvt_pk_bf16_f32 v167, v182, v183
  v_mfma_f32_16x16x32_bf16 v[144:147], v[160:163], v[128:131], 0
  v_pk_fma_f32 v[136:137], v[48:49], v[72:73], v[136:137] op_sel:[0,0,0] op_sel_hi:[1,0,1] neg_lo:[0,1,0] neg_hi:[0,1,0]
  v_pk_fma_f32 v[138:139], v[50:51], v[72:73], v[138:139] op_sel:[0,0,0] op_sel_hi:[1,0,1] neg_lo:[0,1,0] neg_hi:[0,1,0]
  v_pk_fma_f32 v[152:153], v[52:53], v[72:73], v[152:153] op_sel:[0,0,0] op_sel_hi:[1,0,1] neg_lo:[0,1,0] neg_hi:[0,1,0]
  v_pk_fma_f32 v[154:155], v[54:55], v[72:73], v[154:155] op_sel:[0,0,0] op_sel_hi:[1,0,1] neg_lo:[0,1,0] neg_hi:[0,1,0]
  v_cvt_pk_bf16_f32 v136, v136, v137
  v_cvt_pk_bf16_f32 v137, v138, v139
  v_cvt_pk_bf16_f32 v138, v152, v153
  v_cvt_pk_bf16_f32 v139, v154, v155
  v_pk_fma_f32 v[168:169], v[56:57], v[72:73], v[168:169] op_sel:[0,0,0] op_sel_hi:[1,0,1] neg_lo:[0,1,0] neg_hi:[0,1,0]
  v_pk_fma_f32 v[170:171], v[58:59], v[72:73], v[170:171] op_sel:[0,0,0] op_sel_hi:[1,0,1] neg_lo:[0,1,0] neg_hi:[0,1,0]
  v_pk_fma_f32 v[184:185], v[60:61], v[72:73], v[184:185] op_sel:[0,0,0] op_sel_hi:[1,0,1] neg_lo:[0,1,0] neg_hi:[0,1,0]
  v_pk_fma_f32 v[186:187], v[62:63], v[72:73], v[186:187] op_sel:[0,0,0] op_sel_hi:[1,0,1] neg_lo:[0,1,0] neg_hi:[0,1,0]
  v_cvt_pk_bf16_f32 v168, v168, v169
  v_cvt_pk_bf16_f32 v169, v170, v171
  v_cvt_pk_bf16_f32 v170, v184, v185
  v_cvt_pk_bf16_f32 v171, v186, v187
  v_mfma_f32_16x16x32_bf16 v[148:151], v[164:167], v[132:135], 0
  v_mfma_f32_16x16x32_bf16 v[180:183], v[160:163], v[132:135], 0
  v_pk_fma_f32 v[140:141], v[48:49], v[74:75], v[140:141] op_sel:[0,0,0] op_sel_hi:[1,0,1] neg_lo:[0,1,0] neg_hi:[0,1,0]
  v_pk_fma_f32 v[142:143], v[50:51], v[74:75], v[142:143] op_sel:[0,0,0] op_sel_hi:[1,0,1] neg_lo:[0,1,0] neg_hi:[0,1,0]
  v_pk_fma_f32 v[156:157], v[52:53], v[74:75], v[156:157] op_sel:[0,0,0] op_sel_hi:[1,0,1] neg_lo:[0,1,0] neg_hi:[0,1,0]
  v_pk_fma_f32 v[158:159], v[54:55], v[74:75], v[158:159] op_sel:[0,0,0] op_sel_hi:[1,0,1] neg_lo:[0,1,0] neg_hi:[0,1,0]
  v_cvt_pk_bf16_f32 v140, v140, v141
  v_cvt_pk_bf16_f32 v141, v142, v143
  v_cvt_pk_bf16_f32 v142, v156, v157
  v_cvt_pk_bf16_f32 v143, v158, v159
  v_pk_fma_f32 v[172:173], v[56:57], v[74:75], v[172:173] op_sel:[0,0,0] op_sel_hi:[1,0,1] neg_lo:[0,1,0] neg_hi:[0,1,0]
  v_pk_fma_f32 v[174:175], v[58:59], v[74:75], v[174:175] op_sel:[0,0,0] op_sel_hi:[1,0,1] neg_lo:[0,1,0] neg_hi:[0,1,0]
  v_pk_fma_f32 v[188:189], v[60:61], v[74:75], v[188:189] op_sel:[0,0,0] op_sel_hi:[1,0,1] neg_lo:[0,1,0] neg_hi:[0,1,0]
  v_pk_fma_f32 v[190:191], v[62:63], v[74:75], v[190:191] op_sel:[0,0,0] op_sel_hi:[1,0,1] neg_lo:[0,1,0] neg_hi:[0,1,0]
  v_cvt_pk_bf16_f32 v172, v172, v173
  v_cvt_pk_bf16_f32 v173, v174, v175
  v_cvt_pk_bf16_f32 v174, v188, v189
  v_cvt_pk_bf16_f32 v175, v190, v191
  s_waitcnt lgkmcnt(0)
  v_pk_fma_f32 v[32:33], v[56:57], v[66:67], v[32:33] op_sel:[0,0,0] op_sel_hi:[1,0,1] neg_lo:[0,1,0] neg_hi:[0,1,0]
  v_pk_fma_f32 v[34:35], v[58:59], v[66:67], v[34:35] op_sel:[0,0,0] op_sel_hi:[1,0,1] neg_lo:[0,1,0] neg_hi:[0,1,0]
  v_pk_fma_f32 v[36:37], v[60:61], v[66:67], v[36:37] op_sel:[0,0,0] op_sel_hi:[1,0,1] neg_lo:[0,1,0] neg_hi:[0,1,0]
  v_pk_fma_f32 v[38:39], v[62:63], v[66:67], v[38:39] op_sel:[0,0,0] op_sel_hi:[1,0,1] neg_lo:[0,1,0] neg_hi:[0,1,0]
  v_cvt_pk_bf16_f32 v32, v32, v33
  v_cvt_pk_bf16_f32 v33, v34, v35
  v_cvt_pk_bf16_f32 v34, v36, v37
  v_cvt_pk_bf16_f32 v35, v38, v39
  v_mfma_f32_16x16x32_bf16 v[152:155], v[168:171], v[136:139], 0
  v_mfma_f32_16x16x32_bf16 v[184:187], v[164:167], v[136:139], 0
  v_mfma_f32_16x16x32_bf16 v[156:159], v[172:175], v[140:143], 0
  v_mfma_f32_16x16x32_bf16 v[188:191], v[168:171], v[140:143], 0
  v_mfma_f32_16x16x32_bf16 v[176:179], v[32:35], v[128:131], 0
  v_pk_fma_f32 v[40:41], v[84:85], v[64:65], v[40:41] op_sel:[0,0,0] op_sel_hi:[1,0,1] neg_lo:[1,0,0] neg_hi:[1,0,0]
  v_pk_fma_f32 v[42:43], v[86:87], v[64:65], v[42:43] op_sel:[0,0,0] op_sel_hi:[1,0,1] neg_lo:[1,0,0] neg_hi:[1,0,0]
  v_pk_mul_f32 v[40:41], v[40:41], v[104:105]
  v_pk_mul_f32 v[42:43], v[42:43], v[106:107]
  v_cvt_pk_bf16_f32 v240, v40, v41
  v_cvt_pk_bf16_f32 v241, v42, v43
  v_pk_fma_f32 v[192:193], v[88:89], v[64:65], v[192:193] op_sel:[0,0,0] op_sel_hi:[1,0,1] neg_lo:[1,0,0] neg_hi:[1,0,0]
  v_pk_fma_f32 v[194:195], v[90:91], v[64:65], v[194:195] op_sel:[0,0,0] op_sel_hi:[1,0,1] neg_lo:[1,0,0] neg_hi:[1,0,0]
  v_pk_mul_f32 v[192:193], v[192:193], v[108:109]
  v_pk_mul_f32 v[194:195], v[194:195], v[110:111]
  v_cvt_pk_bf16_f32 v242, v192, v193
  v_cvt_pk_bf16_f32 v243, v194, v195
  v_pk_fma_f32 v[196:197], v[92:93], v[64:65], v[196:197] op_sel:[0,0,0] op_sel_hi:[1,0,1] neg_lo:[1,0,0] neg_hi:[1,0,0]
  v_pk_fma_f32 v[198:199], v[94:95], v[64:65], v[198:199] op_sel:[0,0,0] op_sel_hi:[1,0,1] neg_lo:[1,0,0] neg_hi:[1,0,0]
  v_pk_mul_f32 v[196:197], v[196:197], v[112:113]
  v_pk_mul_f32 v[198:199], v[198:199], v[114:115]
  v_cvt_pk_bf16_f32 v244, v196, v197
  v_cvt_pk_bf16_f32 v245, v198, v199
  v_pk_fma_f32 v[200:201], v[96:97], v[64:65], v[200:201] op_sel:[0,0,0] op_sel_hi:[1,0,1] neg_lo:[1,0,0] neg_hi:[1,0,0]
  v_pk_fma_f32 v[202:203], v[98:99], v[64:65], v[202:203] op_sel:[0,0,0] op_sel_hi:[1,0,1] neg_lo:[1,0,0] neg_hi:[1,0,0]
  v_pk_mul_f32 v[200:201], v[200:201], v[116:117]
  v_pk_mul_f32 v[202:203], v[202:203], v[118:119]
  v_cvt_pk_bf16_f32 v246, v200, v201
  v_cvt_pk_bf16_f32 v247, v202, v203
  v_pk_fma_f32 v[204:205], v[100:101], v[64:65], v[204:205] op_sel:[0,0,0] op_sel_hi:[1,0,1] neg_lo:[1,0,0] neg_hi:[1,0,0]
  v_pk_fma_f32 v[206:207], v[102:103], v[64:65], v[206:207] op_sel:[0,0,0] op_sel_hi:[1,0,1] neg_lo:[1,0,0] neg_hi:[1,0,0]
  v_pk_mul_f32 v[204:205], v[204:205], v[120:121]
  v_pk_mul_f32 v[206:207], v[206:207], v[122:123]
  v_cvt_pk_bf16_f32 v248, v204, v205
  v_cvt_pk_bf16_f32 v249, v206, v207
  v_pk_fma_f32 v[44:45], v[84:85], v[64:65], v[44:45] op_sel:[0,1,0] op_sel_hi:[1,1,1] neg_lo:[1,0,0] neg_hi:[1,0,0]
  v_pk_fma_f32 v[46:47], v[86:87], v[64:65], v[46:47] op_sel:[0,1,0] op_sel_hi:[1,1,1] neg_lo:[1,0,0] neg_hi:[1,0,0]
  v_pk_mul_f32 v[44:45], v[44:45], v[104:105]
  v_pk_mul_f32 v[46:47], v[46:47], v[106:107]
  v_cvt_pk_bf16_f32 v224, v44, v45
  v_cvt_pk_bf16_f32 v225, v46, v47
  v_pk_fma_f32 v[208:209], v[88:89], v[64:65], v[208:209] op_sel:[0,1,0] op_sel_hi:[1,1,1] neg_lo:[1,0,0] neg_hi:[1,0,0]
  v_pk_fma_f32 v[210:211], v[90:91], v[64:65], v[210:211] op_sel:[0,1,0] op_sel_hi:[1,1,1] neg_lo:[1,0,0] neg_hi:[1,0,0]
  v_pk_mul_f32 v[208:209], v[208:209], v[108:109]
  v_pk_mul_f32 v[210:211], v[210:211], v[110:111]
  v_cvt_pk_bf16_f32 v226, v208, v209
  v_cvt_pk_bf16_f32 v227, v210, v211
  v_pk_fma_f32 v[212:213], v[92:93], v[64:65], v[212:213] op_sel:[0,1,0] op_sel_hi:[1,1,1] neg_lo:[1,0,0] neg_hi:[1,0,0]
  v_pk_fma_f32 v[214:215], v[94:95], v[64:65], v[214:215] op_sel:[0,1,0] op_sel_hi:[1,1,1] neg_lo:[1,0,0] neg_hi:[1,0,0]
  v_pk_mul_f32 v[212:213], v[212:213], v[112:113]
  v_pk_mul_f32 v[214:215], v[214:215], v[114:115]
  v_cvt_pk_bf16_f32 v228, v212, v213
  v_cvt_pk_bf16_f32 v229, v214, v215
  v_pk_fma_f32 v[216:217], v[96:97], v[64:65], v[216:217] op_sel:[0,1,0] op_sel_hi:[1,1,1] neg_lo:[1,0,0] neg_hi:[1,0,0]
  v_pk_fma_f32 v[218:219], v[98:99], v[64:65], v[218:219] op_sel:[0,1,0] op_sel_hi:[1,1,1] neg_lo:[1,0,0] neg_hi:[1,0,0]
  v_pk_mul_f32 v[216:217], v[216:217], v[116:117]
  v_pk_mul_f32 v[218:219], v[218:219], v[118:119]
  v_cvt_pk_bf16_f32 v230, v216, v217
  v_cvt_pk_bf16_f32 v231, v218, v219
  v_pk_fma_f32 v[220:221], v[100:101], v[64:65], v[220:221] op_sel:[0,1,0] op_sel_hi:[1,1,1] neg_lo:[1,0,0] neg_hi:[1,0,0]
  v_pk_fma_f32 v[222:223], v[102:103], v[64:65], v[222:223] op_sel:[0,1,0] op_sel_hi:[1,1,1] neg_lo:[1,0,0] neg_hi:[1,0,0]
  v_pk_mul_f32 v[220:221], v[220:221], v[120:121]
  v_pk_mul_f32 v[222:223], v[222:223], v[122:123]
  v_cvt_pk_bf16_f32 v232, v220, v221
  v_cvt_pk_bf16_f32 v233, v222, v223
  v_cndmask_b32 v148, v148, v149, s[48:49]
  v_cndmask_b32 v180, v180, v181, s[48:49]
  v_cndmask_b32 v150, v150, v151, s[48:49]
  v_cndmask_b32 v182, v182, v183, s[48:49]
  v_cndmask_b32 v36, v148, v180, s[50:51]
  v_cndmask_b32 v37, v150, v182, s[52:53]
  v_mul_f32 v36, v36, v77
  v_mul_f32 v37, v37, v81
  v_cndmask_b32 v152, v152, v153, s[48:49]
  v_cndmask_b32 v184, v184, v185, s[48:49]
  v_cndmask_b32 v154, v154, v155, s[48:49]
  v_cndmask_b32 v186, v186, v187, s[48:49]
  v_cndmask_b32 v40, v152, v184, s[50:51]
  v_cndmask_b32 v41, v154, v186, s[52:53]
  v_mul_f32 v40, v40, v78
  v_mul_f32 v41, v41, v82
  v_cndmask_b32 v156, v156, v157, s[48:49]
  v_cndmask_b32 v188, v188, v189, s[48:49]
  v_cndmask_b32 v158, v158, v159, s[48:49]
  v_cndmask_b32 v190, v190, v191, s[48:49]
  v_cndmask_b32 v44, v156, v188, s[50:51]
  v_cndmask_b32 v45, v158, v190, s[52:53]
  v_mul_f32 v44, v44, v79
  v_mul_f32 v45, v45, v83
  v_cndmask_b32 v144, v144, v145, s[48:49]
  v_cndmask_b32 v176, v176, v177, s[48:49]
  v_cndmask_b32 v146, v146, v147, s[48:49]
  v_cndmask_b32 v178, v178, v179, s[48:49]
  v_cndmask_b32 v32, v144, v176, s[50:51]
  v_cndmask_b32 v33, v146, v178, s[52:53]
  v_mul_f32 v32, v32, v76
  v_mul_f32 v33, v33, v80
  v_mov_b32 v48, 0xceabfb8f
  v_cndmask_b32 v32, v32, v48, s[54:55]
  v_cndmask_b32 v33, v33, v48, s[14:15]
  v_max_f32 v34, v32, v33
  v_max_f32 v38, v36, v37
  v_max_f32 v42, v40, v41
  v_max_f32 v46, v44, v45
  v_mov_b32 v35, v34
  v_mov_b32 v39, v38
  v_mov_b32 v43, v42
  v_mov_b32 v47, v46
  v_permlane32_swap_b32 v34, v35
  v_permlane32_swap_b32 v38, v39
  v_permlane32_swap_b32 v42, v43
  v_permlane32_swap_b32 v46, v47
  v_max_f32 v34, v34, v35
  v_max_f32 v38, v38, v39
  v_max_f32 v42, v42, v43
  v_max_f32 v46, v46, v47
  v_mov_b32 v35, v34
  v_mov_b32 v39, v38
  v_mov_b32 v43, v42
  v_mov_b32 v47, v46
  v_permlane16_swap_b32 v34, v35
  v_permlane16_swap_b32 v38, v39
  v_permlane16_swap_b32 v42, v43
  v_permlane16_swap_b32 v46, v47
  v_max_f32 v34, v34, v35
  v_max_f32 v38, v38, v39
  v_max_f32 v42, v42, v43
  v_max_f32 v46, v46, v47
  v_sub_f32 v32, v32, v34
  v_sub_f32 v33, v33, v34
  v_sub_f32 v36, v36, v38
  v_sub_f32 v37, v37, v38
  v_sub_f32 v40, v40, v42
  v_sub_f32 v41, v41, v42
  v_sub_f32 v44, v44, v46
  v_sub_f32 v45, v45, v46
  v_exp_f32 v32, v32
  v_exp_f32 v33, v33
  v_exp_f32 v36, v36
  v_exp_f32 v37, v37
  v_exp_f32 v40, v40
  v_exp_f32 v41, v41
  v_exp_f32 v44, v44
  v_exp_f32 v45, v45
  v_cvt_pk_bf16_f32 v32, v32, v32
  v_cvt_pk_bf16_f32 v33, v33, v33
  v_and_b32 v128, v32, v27
  v_and_b32 v129, v33, v29
  v_and_b32 v130, v32, v28
  v_and_b32 v131, v33, v30
  v_cvt_pk_bf16_f32 v36, v36, v36
  v_cvt_pk_bf16_f32 v37, v37, v37
  v_and_b32 v132, v36, v27
  v_and_b32 v133, v37, v29
  v_and_b32 v134, v36, v28
  v_and_b32 v135, v37, v30
  v_mfma_f32_16x16x32_bf16 v[144:147], v[236:239], v[128:131], 0
  v_mfma_f32_16x16x32_bf16 v[192:195], v[240:243], v[128:131], 0
  v_mfma_f32_16x16x32_bf16 v[208:211], v[224:227], v[128:131], 0
  v_cvt_pk_bf16_f32 v40, v40, v40
  v_cvt_pk_bf16_f32 v41, v41, v41
  v_and_b32 v136, v40, v27
  v_and_b32 v137, v41, v29
  v_and_b32 v138, v40, v28
  v_and_b32 v139, v41, v30
  v_mfma_f32_16x16x32_bf16 v[148:151], v[236:239], v[132:135], 0
  v_mfma_f32_16x16x32_bf16 v[196:199], v[242:245], v[132:135], 0
  v_mfma_f32_16x16x32_bf16 v[212:215], v[226:229], v[132:135], 0
  v_cvt_pk_bf16_f32 v44, v44, v44
  v_cvt_pk_bf16_f32 v45, v45, v45
  v_and_b32 v140, v44, v27
  v_and_b32 v141, v45, v29
  v_and_b32 v142, v44, v28
  v_and_b32 v143, v45, v30
  v_mfma_f32_16x16x32_bf16 v[152:155], v[236:239], v[136:139], 0
  v_mfma_f32_16x16x32_bf16 v[200:203], v[244:247], v[136:139], 0
  v_mfma_f32_16x16x32_bf16 v[216:219], v[228:231], v[136:139], 0
  v_mfma_f32_16x16x32_bf16 v[156:159], v[236:239], v[140:143], 0
  v_mfma_f32_16x16x32_bf16 v[204:207], v[246:249], v[140:143], 0
  v_mfma_f32_16x16x32_bf16 v[220:223], v[230:233], v[140:143], 0
  v_rcp_f32 v144, v144
  s_mov_b32 s3, 0
  v_pk_mul_f32 v[192:193], v[192:193], v[144:145] op_sel_hi:[1,0]
  v_pk_mul_f32 v[194:195], v[194:195], v[144:145] op_sel_hi:[1,0]
  v_pk_mul_f32 v[208:209], v[208:209], v[144:145] op_sel_hi:[1,0]
  v_pk_mul_f32 v[210:211], v[210:211], v[144:145] op_sel_hi:[1,0]
  v_cvt_pk_bf16_f32 v48, v192, v193
  v_cvt_pk_bf16_f32 v49, v194, v195
  v_cvt_pk_bf16_f32 v50, v208, v209
  v_cvt_pk_bf16_f32 v51, v210, v211
  s_nop 1
  v_permlane16_swap_b32 v48, v50
  v_permlane16_swap_b32 v49, v51
  buffer_store_dwordx4 v[48:51], v31, s[44:47], s3 offen
  v_rcp_f32 v148, v148
  s_mov_b32 s3, 32768
  v_pk_mul_f32 v[196:197], v[196:197], v[148:149] op_sel_hi:[1,0]
  v_pk_mul_f32 v[198:199], v[198:199], v[148:149] op_sel_hi:[1,0]
  v_pk_mul_f32 v[212:213], v[212:213], v[148:149] op_sel_hi:[1,0]
  v_pk_mul_f32 v[214:215], v[214:215], v[148:149] op_sel_hi:[1,0]
  v_cvt_pk_bf16_f32 v52, v196, v197
  v_cvt_pk_bf16_f32 v53, v198, v199
  v_cvt_pk_bf16_f32 v54, v212, v213
  v_cvt_pk_bf16_f32 v55, v214, v215
  s_nop 1
  v_permlane16_swap_b32 v52, v54
  v_permlane16_swap_b32 v53, v55
  buffer_store_dwordx4 v[52:55], v31, s[44:47], s3 offen
  v_rcp_f32 v152, v152
  s_mov_b32 s3, 65536
  v_pk_mul_f32 v[200:201], v[200:201], v[152:153] op_sel_hi:[1,0]
  v_pk_mul_f32 v[202:203], v[202:203], v[152:153] op_sel_hi:[1,0]
  v_pk_mul_f32 v[216:217], v[216:217], v[152:153] op_sel_hi:[1,0]
  v_pk_mul_f32 v[218:219], v[218:219], v[152:153] op_sel_hi:[1,0]
  v_cvt_pk_bf16_f32 v56, v200, v201
  v_cvt_pk_bf16_f32 v57, v202, v203
  v_cvt_pk_bf16_f32 v58, v216, v217
  v_cvt_pk_bf16_f32 v59, v218, v219
  s_nop 1
  v_permlane16_swap_b32 v56, v58
  v_permlane16_swap_b32 v57, v59
  buffer_store_dwordx4 v[56:59], v31, s[44:47], s3 offen
  v_rcp_f32 v156, v156
  s_mov_b32 s3, 98304
  v_pk_mul_f32 v[204:205], v[204:205], v[156:157] op_sel_hi:[1,0]
  v_pk_mul_f32 v[206:207], v[206:207], v[156:157] op_sel_hi:[1,0]
  v_pk_mul_f32 v[220:221], v[220:221], v[156:157] op_sel_hi:[1,0]
  v_pk_mul_f32 v[222:223], v[222:223], v[156:157] op_sel_hi:[1,0]
  v_cvt_pk_bf16_f32 v60, v204, v205
  v_cvt_pk_bf16_f32 v61, v206, v207
  v_cvt_pk_bf16_f32 v62, v220, v221
  v_cvt_pk_bf16_f32 v63, v222, v223
  s_nop 1
  v_permlane16_swap_b32 v60, v62
  v_permlane16_swap_b32 v61, v63
  buffer_store_dwordx4 v[60:63], v31, s[44:47], s3 offen
  s_endpgm
L_attn_loader:
  s_add_u32 s8, s70, s69
  s_and_b32 s8, s8, 3
  s_add_u32 s9, s70, s68
  s_and_b32 s9, s9, 3
  s_lshl_b32 s76, s8, 12
  s_lshl_b32 s77, s9, 11
  s_add_u32 s77, s77, 16384
  v_lshrrev_b32 v3, 3, v1
  s_lshl_b32 s10, s8, 5
  s_lshl_b32 s11, s68, 7
  s_add_u32 s10, s10, s11
  v_add_u32 v3, s10, v3
  v_mul_u32_u24 v3, 2048, v3
  v_lshrrev_b32 v2, 4, v1
  v_and_b32 v10, 7, v1
  v_xor_b32 v4, v2, v10
  v_lshl_add_u32 v4, v4, 4, v3
  v_add_u32 v3, 16384, v3
  v_add_u32 v5, 4, v2
  v_xor_b32 v5, v5, v10
  v_lshl_add_u32 v5, v5, 4, v3
  v_add_u32 v3, 16384, v3
  v_xor_b32 v6, v2, v10
  v_lshl_add_u32 v6, v6, 4, v3
  v_add_u32 v3, 16384, v3
  v_add_u32 v7, 4, v2
  v_xor_b32 v7, v7, v10
  v_lshl_add_u32 v7, v7, 4, v3
  v_lshrrev_b32 v3, 3, v1
  s_lshl_b32 s10, s9, 4
  v_add_u32 v3, s10, v3
  v_mul_u32_u24 v3, 6144, v3
  v_lshrrev_b32 v2, 3, v1
  v_and_b32 v2, 2, v2
  v_xor_b32 v2, v2, v10
  s_mul_i32 s10, s69, 128
  v_add_u32 v3, s10, v3
  v_lshl_add_u32 v8, v2, 4, v3
  v_xor_b32 v2, 4, v2
  v_add_u32 v3, 49152, v3
  v_lshl_add_u32 v9, v2, 4, v3
  s_and_b32 s10, s70, 3
  s_lshl_b32 s78, s10, 9
  s_add_u32 s78, s78, 40960
  s_lshl_b32 s14, s10, 2
  s_add_u32 s14, s14, s11
  s_sub_u32 s14, s14, 16
  v_lshrrev_b32 v3, 3, v1
  v_add_u32 v3, s14, v3
  v_max_i32 v3, 0, v3
  v_mul_u32_u24 v3, 2048, v3
  s_lshl_b32 s14, s10, 1
  v_lshrrev_b32 v2, 4, v1
  v_add_u32 v2, s14, v2
  v_and_b32 v2, 7, v2
  v_xor_b32 v2, v2, v10
  v_lshl_add_u32 v28, v2, 4, v3
  s_cmp_eq_u32 s10, 0
  s_cselect_b32 s14, 0xffffff00, -1
  s_mov_b32 s15, 0
  s_mov_b32 s75, 0
  s_add_u32 s100, s68, s69
  s_mov_b32 s101, -1
  s_add_u32 s101, s101, 1
  s_xor_b32 s73, s101, s100
  s_and_b32 s73, s73, 3
  s_cselect_b32 s73, 15, 3
  s_add_u32 s73, s73, s101
  s_and_b32 s73, s73, 15
  s_mul_i32 s74, s73, 393216
  s_lshl_b32 s73, s73, 7
  s_waitcnt lgkmcnt(0)
  s_mov_b32 s36, s12
  s_and_b32 s37, s13, 0xffff
  s_mov_b32 s38, 4194304
  s_mov_b32 s39, 0x00020000
  s_mov_b32 s40, s18
  s_and_b32 s41, s19, 0xffff
  s_mov_b32 s42, 6291456
  s_mov_b32 s43, 0x00020000
  s_cmp_eq_u32 s96, 0
  s_cbranch_scc1 L_attn_ld0
  s_add_u32 s56, s34, 24117248
  s_addc_u32 s57, s35, 0
  s_and_b32 s57, s57, 0xffff
  s_mov_b32 s58, 262144
  s_mov_b32 s59, 0x00020000
  s_add_u32 s3, s75, s76
  s_add_u32 m0, s3, 0
  s_nop 0
  buffer_load_dwordx4 v4, s[36:39], s73 offen lds
  s_add_u32 m0, s3, 1024
  s_nop 0
  buffer_load_dwordx4 v5, s[36:39], s73 offen lds
  s_add_u32 m0, s3, 2048
  s_nop 0
  buffer_load_dwordx4 v6, s[36:39], s73 offen lds
  s_add_u32 m0, s3, 3072
  s_nop 0
  buffer_load_dwordx4 v7, s[36:39], s73 offen lds
  s_add_u32 m0, s75, s78
  s_mov_b64 exec, s[14:15]
  buffer_load_dwordx4 v28, s[36:39], s73 offen lds
  s_mov_b64 exec, -1
  s_add_u32 s3, s75, s77
  s_add_u32 m0, s3, 0
  s_add_u32 s4, s74, 0
  buffer_load_dwordx4 v8, s[40:43], s4 offen lds
  s_add_u32 m0, s3, 1024
  s_nop 0
  buffer_load_dwordx4 v9, s[40:43], s4 offen lds
  s_add_u32 m0, s3, 8192
  s_add_u32 s4, s74, 2048
  buffer_load_dwordx4 v8, s[40:43], s4 offen lds
  s_add_u32 m0, s3, 9216
  s_nop 0
  buffer_load_dwordx4 v9, s[40:43], s4 offen lds
  s_add_u32 m0, s3, 16384
  s_add_u32 s4, s74, 4096
  buffer_load_dwordx4 v8, s[40:43], s4 offen lds
  s_add_u32 m0, s3, 17408
  s_nop 0
  buffer_load_dwordx4 v9, s[40:43], s4 offen lds
  s_add_u32 s101, s101, 1
  s_xor_b32 s73, s101, s100
  s_and_b32 s73, s73, 3
  s_cselect_b32 s73, 15, 3
  s_add_u32 s73, s73, s101
  s_and_b32 s73, s73, 15
  s_mul_i32 s74, s73, 393216
  s_lshl_b32 s73, s73, 7
  s_add_u32 s75, s75, 43008
  s_cmp_eq_u32 s75, 129024
  s_cselect_b32 s75, 0, s75
  s_add_u32 s3, s75, s76
  s_add_u32 m0, s3, 0
  s_nop 0
  buffer_load_dwordx4 v4, s[36:39], s73 offen lds
  s_add_u32 m0, s3, 1024
  s_nop 0
  buffer_load_dwordx4 v5, s[36:39], s73 offen lds
  s_add_u32 m0, s3, 2048
  s_nop 0
  buffer_load_dwordx4 v6, s[36:39], s73 offen lds
  s_add_u32 m0, s3, 3072
  s_nop 0
  buffer_load_dwordx4 v7, s[36:39], s73 offen lds
  s_add_u32 m0, s75, s78
  s_mov_b64 exec, s[14:15]
  buffer_load_dwordx4 v28, s[36:39], s73 offen lds
  s_mov_b64 exec, -1
  s_add_u32 s3, s75, s77
  s_add_u32 m0, s3, 0
  s_add_u32 s4, s74, 0
  buffer_load_dwordx4 v8, s[40:43], s4 offen lds
  s_add_u32 m0, s3, 1024
  s_nop 0
  buffer_load_dwordx4 v9, s[40:43], s4 offen lds
  s_add_u32 m0, s3, 8192
  s_add_u32 s4, s74, 2048
  buffer_load_dwordx4 v8, s[40:43], s4 offen lds
  s_add_u32 m0, s3, 9216
  s_nop 0
  buffer_load_dwordx4 v9, s[40:43], s4 offen lds
  s_add_u32 m0, s3, 16384
  s_add_u32 s4, s74, 4096
  buffer_load_dwordx4 v8, s[40:43], s4 offen lds
  s_add_u32 m0, s3, 17408
  s_nop 0
  buffer_load_dwordx4 v9, s[40:43], s4 offen lds
  s_add_u32 s101, s101, 1
  s_xor_b32 s73, s101, s100
  s_and_b32 s73, s73, 3
  s_cselect_b32 s73, 15, 3
  s_add_u32 s73, s73, s101
  s_and_b32 s73, s73, 15
  s_mul_i32 s74, s73, 393216
  s_lshl_b32 s73, s73, 7
  s_add_u32 s75, s75, 43008
  s_cmp_eq_u32 s75, 129024
  s_cselect_b32 s75, 0, s75
  s_waitcnt vmcnt(11)
  s_barrier
  s_mov_b32 s79, 13
L_attn1_ld:
  s_add_u32 s3, s75, s76
  s_add_u32 m0, s3, 0
  s_nop 0
  buffer_load_dwordx4 v4, s[36:39], s73 offen lds
  s_add_u32 m0, s3, 1024
  s_nop 0
  buffer_load_dwordx4 v5, s[36:39], s73 offen lds
  s_add_u32 m0, s3, 2048
  s_nop 0
  buffer_load_dwordx4 v6, s[36:39], s73 offen lds
  s_add_u32 m0, s3, 3072
  s_nop 0
  buffer_load_dwordx4 v7, s[36:39], s73 offen lds
  s_add_u32 m0, s75, s78
  s_mov_b64 exec, s[14:15]
  buffer_load_dwordx4 v28, s[36:39], s73 offen lds
  s_mov_b64 exec, -1
  s_add_u32 s3, s75, s77
  s_add_u32 m0, s3, 0
  s_add_u32 s4, s74, 0
  buffer_load_dwordx4 v8, s[40:43], s4 offen lds
  s_add_u32 m0, s3, 1024
  s_nop 0
  buffer_load_dwordx4 v9, s[40:43], s4 offen lds
  s_add_u32 m0, s3, 8192
  s_add_u32 s4, s74, 2048
  buffer_load_dwordx4 v8, s[40:43], s4 offen lds
  s_add_u32 m0, s3, 9216
  s_nop 0
  buffer_load_dwordx4 v9, s[40:43], s4 offen lds
  s_add_u32 m0, s3, 16384
  s_add_u32 s4, s74, 4096
  buffer_load_dwordx4 v8, s[40:43], s4 offen lds
  s_add_u32 m0, s3, 17408
  s_nop 0
  buffer_load_dwordx4 v9, s[40:43], s4 offen lds
  s_add_u32 s101, s101, 1
  s_xor_b32 s73, s101, s100
  s_and_b32 s73, s73, 3
  s_cselect_b32 s73, 15, 3
  s_add_u32 s73, s73, s101
  s_and_b32 s73, s73, 15
  s_mul_i32 s74, s73, 393216
  s_lshl_b32 s73, s73, 7
  s_add_u32 s75, s75, 43008
  s_cmp_eq_u32 s75, 129024
  s_cselect_b32 s75, 0, s75
  s_waitcnt vmcnt(11)
  s_barrier
  s_sub_u32 s79, s79, 1
  s_cmp_lg_u32 s79, 0
  s_cbranch_scc1 L_attn1_ld
  s_add_u32 s3, s75, s76
  s_add_u32 m0, s3, 0
  s_nop 0
  buffer_load_dwordx4 v4, s[36:39], s73 offen lds
  s_add_u32 m0, s3, 1024
  s_nop 0
  buffer_load_dwordx4 v5, s[36:39], s73 offen lds
  s_add_u32 m0, s3, 2048
  s_nop 0
  buffer_load_dwordx4 v6, s[36:39], s73 offen lds
  s_add_u32 m0, s3, 3072
  s_nop 0
  buffer_load_dwordx4 v7, s[36:39], s73 offen lds
  s_add_u32 m0, s75, s78
  s_mov_b64 exec, s[14:15]
  buffer_load_dwordx4 v28, s[36:39], s73 offen lds
  s_mov_b64 exec, -1
  s_add_u32 s3, s75, s77
  s_add_u32 m0, s3, 0
  s_add_u32 s4, s74, 0
  buffer_load_dwordx4 v8, s[40:43], s4 offen lds
  s_add_u32 m0, s3, 1024
  s_nop 0
  buffer_load_dwordx4 v9, s[40:43], s4 offen lds
  s_add_u32 m0, s3, 8192
  s_add_u32 s4, s74, 2048
  buffer_load_dwordx4 v8, s[40:43], s4 offen lds
  s_add_u32 m0, s3, 9216
  s_nop 0
  buffer_load_dwordx4 v9, s[40:43], s4 offen lds
  s_add_u32 m0, s3, 16384
  s_add_u32 s4, s74, 4096
  buffer_load_dwordx4 v8, s[40:43], s4 offen lds
  s_add_u32 m0, s3, 17408
  s_nop 0
  buffer_load_dwordx4 v9, s[40:43], s4 offen lds
  s_add_u32 s101, s101, 1
  s_xor_b32 s73, s101, s100
  s_and_b32 s73, s73, 3
  s_cselect_b32 s73, 15, 3
  s_add_u32 s73, s73, s101
  s_and_b32 s73, s73, 15
  s_mul_i32 s74, s73, 393216
  s_lshl_b32 s73, s73, 7
  s_add_u32 s75, s75, 43008
  s_cmp_eq_u32 s75, 129024
  s_cselect_b32 s75, 0, s75
  s_and_b32 s3, s70, 3
  s_lshl_b32 s4, s68, 7
  s_lshl_b32 s5, s3, 6
  s_add_u32 s5, s5, s4
  v_add_u32 v2, s5, v1
  s_sub_u32 s4, s4, 16
  v_and_b32 v3, 15, v1
  v_add_u32 v3, s4, v3
  v_max_i32 v3, 0, v3
  s_cmp_ge_u32 s3, 2
  s_cselect_b64 vcc, -1, 0
  v_cndmask_b32 v2, v2, v3, vcc
  v_lshlrev_b32 v2, 3, v2
  s_mov_b32 s3, 0
  buffer_load_dwordx2 v[32:33], v2, s[56:59], s3 offen
  s_add_u32 s3, s3, 16384
  buffer_load_dwordx2 v[34:35], v2, s[56:59], s3 offen
  s_add_u32 s3, s3, 16384
  buffer_load_dwordx2 v[36:37], v2, s[56:59], s3 offen
  s_add_u32 s3, s3, 16384
  buffer_load_dwordx2 v[38:39], v2, s[56:59], s3 offen
  s_add_u32 s3, s3, 16384
  buffer_load_dwordx2 v[40:41], v2, s[56:59], s3 offen
  s_add_u32 s3, s3, 16384
  buffer_load_dwordx2 v[42:43], v2, s[56:59], s3 offen
  s_add_u32 s3, s3, 16384
  buffer_load_dwordx2 v[44:45], v2, s[56:59], s3 offen
  s_add_u32 s3, s3, 16384
  buffer_load_dwordx2 v[46:47], v2, s[56:59], s3 offen
  s_add_u32 s3, s3, 16384
  buffer_load_dwordx2 v[48:49], v2, s[56:59], s3 offen
  s_add_u32 s3, s3, 16384
  buffer_load_dwordx2 v[50:51], v2, s[56:59], s3 offen
  s_add_u32 s3, s3, 16384
  buffer_load_dwordx2 v[52:53], v2, s[56:59], s3 offen
  s_add_u32 s3, s3, 16384
  buffer_load_dwordx2 v[54:55], v2, s[56:59], s3 offen
  s_add_u32 s3, s3, 16384
  buffer_load_dwordx2 v[56:57], v2, s[56:59], s3 offen
  s_add_u32 s3, s3, 16384
  buffer_load_dwordx2 v[58:59], v2, s[56:59], s3 offen
  s_add_u32 s3, s3, 16384
  buffer_load_dwordx2 v[60:61], v2, s[56:59], s3 offen
  s_add_u32 s3, s3, 16384
  buffer_load_dwordx2 v[62:63], v2, s[56:59], s3 offen
  s_mov_b32 s60, s20
  s_and_b32 s61, s21, 0xffff
  s_mov_b32 s62, 2097152
  s_mov_b32 s63, 0x00020000
  s_and_b32 s3, s70, 3
  s_mul_i32 s3, s3, 8
  s_mul_i32 s4, s99, 32
  s_add_u32 s3, s3, s4
  v_lshrrev_b32 v2, 3, v1
  v_add_u32 v2, s3, v2
  v_mul_u32_u24 v2, 2048, v2
  v_and_b32 v3, 7, v1
  v_lshl_add_u32 v2, v3, 7, v2
  s_and_b32 s3, s2, 7
  s_lshr_b32 s3, s3, 2
  s_mul_i32 s3, s3, 1024
  buffer_load_dword v96, v2, s[60:63], s3 offen
  s_waitcnt vmcnt(28)
  s_barrier
  s_waitcnt vmcnt(17)
  s_barrier
  s_waitcnt vmcnt(1)
  v_add_f32 v32, v32, v34
  v_add_f32 v33, v33, v35
  v_add_f32 v48, v48, v50
  v_add_f32 v49, v49, v51
  v_add_f32 v32, v32, v36
  v_add_f32 v33, v33, v37
  v_add_f32 v48, v48, v52
  v_add_f32 v49, v49, v53
  v_add_f32 v32, v32, v38
  v_add_f32 v33, v33, v39
  v_add_f32 v48, v48, v54
  v_add_f32 v49, v49, v55
  v_add_f32 v32, v32, v40
  v_add_f32 v33, v33, v41
  v_add_f32 v48, v48, v56
  v_add_f32 v49, v49, v57
  v_add_f32 v32, v32, v42
  v_add_f32 v33, v33, v43
  v_add_f32 v48, v48, v58
  v_add_f32 v49, v49, v59
  v_add_f32 v32, v32, v44
  v_add_f32 v33, v33, v45
  v_add_f32 v48, v48, v60
  v_add_f32 v49, v49, v61
  v_add_f32 v32, v32, v46
  v_add_f32 v33, v33, v47
  v_add_f32 v48, v48, v62
  v_add_f32 v49, v49, v63
  v_add_f32 v32, v32, v48
  v_add_f32 v33, v33, v49
  v_mul_f32 v32, 0x3a800000, v32
  v_mul_f32 v33, 0x3a800000, v33
  v_fma_f32 v33, -v32, v32, v33
  v_max_f32 v33, 0, v33
  v_add_f32 v33, 0x3727c5ac, v33
  v_rsq_f32 v33, v33
  s_nop 0
  s_and_b32 s3, s70, 3
  s_lshl_b32 s5, s3, 6
  s_add_u32 s5, s5, 16
  v_add_u32 v2, s5, v1
  v_and_b32 v3, 15, v1
  s_cmp_ge_u32 s3, 2
  s_cselect_b64 vcc, -1, 0
  v_cndmask_b32 v2, v2, v3, vcc
  v_lshlrev_b32 v2, 2, v2
  v_add_u32 v2, 129024, v2
  ds_write2_b32 v2, v32, v33 offset0:0 offset1:160
  s_waitcnt lgkmcnt(0)
  s_barrier
  s_barrier
  s_waitcnt vmcnt(0)
  s_endpgm
L_attn_ld0:
  v_lshl_add_u32 v12, v1, 4, s76
  v_and_b32 v13, 31, v1
  v_lshl_add_u32 v13, v13, 4, s78
  v_mov_b32 v16, 0
  v_mov_b32 v17, 0
  v_mov_b32 v18, 0
  v_mov_b32 v19, 0
  v_mov_b32 v20, 0
  v_mov_b32 v21, 0
  v_mov_b32 v22, 0
  v_mov_b32 v23, 0
  v_mov_b32 v24, 0
  v_mov_b32 v25, 0
  s_mov_b32 s98, 0
  s_mov_b32 s7, 0xffff0000
  s_mov_b32 s6, 0x3f803f80
  s_add_u32 s3, s75, s76
  s_add_u32 m0, s3, 0
  s_nop 0
  buffer_load_dwordx4 v4, s[36:39], s73 offen lds
  s_add_u32 m0, s3, 1024
  s_nop 0
  buffer_load_dwordx4 v5, s[36:39], s73 offen lds
  s_add_u32 m0, s3, 2048
  s_nop 0
  buffer_load_dwordx4 v6, s[36:39], s73 offen lds
  s_add_u32 m0, s3, 3072
  s_nop 0
  buffer_load_dwordx4 v7, s[36:39], s73 offen lds
  s_add_u32 m0, s75, s78
  s_mov_b64 exec, s[14:15]
  buffer_load_dwordx4 v28, s[36:39], s73 offen lds
  s_mov_b64 exec, -1
  s_add_u32 s3, s75, s77
  s_add_u32 m0, s3, 0
  s_add_u32 s4, s74, 0
  buffer_load_dwordx4 v8, s[40:43], s4 offen lds
  s_add_u32 m0, s3, 1024
  s_nop 0
  buffer_load_dwordx4 v9, s[40:43], s4 offen lds
  s_add_u32 m0, s3, 8192
  s_add_u32 s4, s74, 2048
  buffer_load_dwordx4 v8, s[40:43], s4 offen lds
  s_add_u32 m0, s3, 9216
  s_nop 0
  buffer_load_dwordx4 v9, s[40:43], s4 offen lds
  s_add_u32 m0, s3, 16384
  s_add_u32 s4, s74, 4096
  buffer_load_dwordx4 v8, s[40:43], s4 offen lds
  s_add_u32 m0, s3, 17408
  s_nop 0
  buffer_load_dwordx4 v9, s[40:43], s4 offen lds
  s_add_u32 s101, s101, 1
  s_xor_b32 s73, s101, s100
  s_and_b32 s73, s73, 3
  s_cselect_b32 s73, 15, 3
  s_add_u32 s73, s73, s101
  s_and_b32 s73, s73, 15
  s_mul_i32 s74, s73, 393216
  s_lshl_b32 s73, s73, 7
  s_add_u32 s75, s75, 43008
  s_cmp_eq_u32 s75, 129024
  s_cselect_b32 s75, 0, s75
  s_add_u32 s3, s75, s76
  s_add_u32 m0, s3, 0
  s_nop 0
  buffer_load_dwordx4 v4, s[36:39], s73 offen lds
  s_add_u32 m0, s3, 1024
  s_nop 0
  buffer_load_dwordx4 v5, s[36:39], s73 offen lds
  s_add_u32 m0, s3, 2048
  s_nop 0
  buffer_load_dwordx4 v6, s[36:39], s73 offen lds
  s_add_u32 m0, s3, 3072
  s_nop 0
  buffer_load_dwordx4 v7, s[36:39], s73 offen lds
  s_add_u32 m0, s75, s78
  s_mov_b64 exec, s[14:15]
  buffer_load_dwordx4 v28, s[36:39], s73 offen lds
  s_mov_b64 exec, -1
  s_add_u32 s3, s75, s77
  s_add_u32 m0, s3, 0
  s_add_u32 s4, s74, 0
  buffer_load_dwordx4 v8, s[40:43], s4 offen lds
  s_add_u32 m0, s3, 1024
  s_nop 0
  buffer_load_dwordx4 v9, s[40:43], s4 offen lds
  s_add_u32 m0, s3, 8192
  s_add_u32 s4, s74, 2048
  buffer_load_dwordx4 v8, s[40:43], s4 offen lds
  s_add_u32 m0, s3, 9216
  s_nop 0
  buffer_load_dwordx4 v9, s[40:43], s4 offen lds
  s_add_u32 m0, s3, 16384
  s_add_u32 s4, s74, 4096
  buffer_load_dwordx4 v8, s[40:43], s4 offen lds
  s_add_u32 m0, s3, 17408
  s_nop 0
  buffer_load_dwordx4 v9, s[40:43], s4 offen lds
  s_add_u32 s101, s101, 1
  s_xor_b32 s73, s101, s100
  s_and_b32 s73, s73, 3
  s_cselect_b32 s73, 15, 3
  s_add_u32 s73, s73, s101
  s_and_b32 s73, s73, 15
  s_mul_i32 s74, s73, 393216
  s_lshl_b32 s73, s73, 7
  s_add_u32 s75, s75, 43008
  s_cmp_eq_u32 s75, 129024
  s_cselect_b32 s75, 0, s75
  s_waitcnt vmcnt(11) lgkmcnt(0)
  s_barrier
  s_mov_b32 s79, 13
L_attn0_ld:
  s_add_u32 s3, s75, s76
  s_add_u32 m0, s3, 0
  s_nop 0
  buffer_load_dwordx4 v4, s[36:39], s73 offen lds
  s_add_u32 m0, s3, 1024
  s_nop 0
  buffer_load_dwordx4 v5, s[36:39], s73 offen lds
  s_add_u32 m0, s3, 2048
  s_nop 0
  buffer_load_dwordx4 v6, s[36:39], s73 offen lds
  s_add_u32 m0, s3, 3072
  s_nop 0
  buffer_load_dwordx4 v7, s[36:39], s73 offen lds
  s_add_u32 m0, s75, s78
  s_mov_b64 exec, s[14:15]
  buffer_load_dwordx4 v28, s[36:39], s73 offen lds
  s_mov_b64 exec, -1
  s_add_u32 s3, s75, s77
  s_add_u32 m0, s3, 0
  s_add_u32 s4, s74, 0
  buffer_load_dwordx4 v8, s[40:43], s4 offen lds
  s_add_u32 m0, s3, 1024
  s_nop 0
  buffer_load_dwordx4 v9, s[40:43], s4 offen lds
  s_add_u32 m0, s3, 8192
  s_add_u32 s4, s74, 2048
  buffer_load_dwordx4 v8, s[40:43], s4 offen lds
  s_add_u32 m0, s3, 9216
  s_nop 0
  buffer_load_dwordx4 v9, s[40:43], s4 offen lds
  s_add_u32 m0, s3, 16384
  s_add_u32 s4, s74, 4096
  buffer_load_dwordx4 v8, s[40:43], s4 offen lds
  s_add_u32 m0, s3, 17408
  s_nop 0
  buffer_load_dwordx4 v9, s[40:43], s4 offen lds
  s_add_u32 s101, s101, 1
  s_xor_b32 s73, s101, s100
  s_and_b32 s73, s73, 3
  s_cselect_b32 s73, 15, 3
  s_add_u32 s73, s73, s101
  s_and_b32 s73, s73, 15
  s_mul_i32 s74, s73, 393216
  s_lshl_b32 s73, s73, 7
  s_add_u32 s75, s75, 43008
  s_cmp_eq_u32 s75, 129024
  s_cselect_b32 s75, 0, s75
  v_add_u32 v14, s98, v12
  v_add_u32 v15, s98, v13
  ds_read_b128 v[32:35], v14 offset:0
  ds_read_b128 v[36:39], v14 offset:1024
  ds_read_b128 v[40:43], v14 offset:2048
  ds_read_b128 v[44:47], v14 offset:3072
  ds_read_b128 v[48:51], v15
  s_add_u32 s98, s98, 43008
  s_cmp_eq_u32 s98, 129024
  s_cselect_b32 s98, 0, s98
  s_waitcnt lgkmcnt(4)
  v_lshlrev_b32 v52, 16, v32
  v_and_b32 v53, s7, v32
  v_add_f32 v16, v16, v52
  v_fmac_f32 v17, v52, v52
  v_add_f32 v16, v16, v53
  v_fmac_f32 v17, v53, v53
  v_lshlrev_b32 v52, 16, v33
  v_and_b32 v53, s7, v33
  v_add_f32 v16, v16, v52
  v_fmac_f32 v17, v52, v52
  v_add_f32 v16, v16, v53
  v_fmac_f32 v17, v53, v53
  v_lshlrev_b32 v52, 16, v34
  v_and_b32 v53, s7, v34
  v_add_f32 v16, v16, v52
  v_fmac_f32 v17, v52, v52
  v_add_f32 v16, v16, v53
  v_fmac_f32 v17, v53, v53
  v_lshlrev_b32 v52, 16, v35
  v_and_b32 v53, s7, v35
  v_add_f32 v16, v16, v52
  v_fmac_f32 v17, v52, v52
  v_add_f32 v16, v16, v53
  v_fmac_f32 v17, v53, v53
  s_waitcnt lgkmcnt(3)
  v_lshlrev_b32 v52, 16, v36
  v_and_b32 v53, s7, v36
  v_add_f32 v18, v18, v52
  v_fmac_f32 v19, v52, v52
  v_add_f32 v18, v18, v53
  v_fmac_f32 v19, v53, v53
  v_lshlrev_b32 v52, 16, v37
  v_and_b32 v53, s7, v37
  v_add_f32 v18, v18, v52
  v_fmac_f32 v19, v52, v52
  v_add_f32 v18, v18, v53
  v_fmac_f32 v19, v53, v53
  v_lshlrev_b32 v52, 16, v38
  v_and_b32 v53, s7, v38
  v_add_f32 v18, v18, v52
  v_fmac_f32 v19, v52, v52
  v_add_f32 v18, v18, v53
  v_fmac_f32 v19, v53, v53
  v_lshlrev_b32 v52, 16, v39
  v_and_b32 v53, s7, v39
  v_add_f32 v18, v18, v52
  v_fmac_f32 v19, v52, v52
  v_add_f32 v18, v18, v53
  v_fmac_f32 v19, v53, v53
  s_waitcnt lgkmcnt(2)
  v_lshlrev_b32 v52, 16, v40
  v_and_b32 v53, s7, v40
  v_add_f32 v20, v20, v52
  v_fmac_f32 v21, v52, v52
  v_add_f32 v20, v20, v53
  v_fmac_f32 v21, v53, v53
  v_lshlrev_b32 v52, 16, v41
  v_and_b32 v53, s7, v41
  v_add_f32 v20, v20, v52
  v_fmac_f32 v21, v52, v52
  v_add_f32 v20, v20, v53
  v_fmac_f32 v21, v53, v53
  v_lshlrev_b32 v52, 16, v42
  v_and_b32 v53, s7, v42
  v_add_f32 v20, v20, v52
  v_fmac_f32 v21, v52, v52
  v_add_f32 v20, v20, v53
  v_fmac_f32 v21, v53, v53
  v_lshlrev_b32 v52, 16, v43
  v_and_b32 v53, s7, v43
  v_add_f32 v20, v20, v52
  v_fmac_f32 v21, v52, v52
  v_add_f32 v20, v20, v53
  v_fmac_f32 v21, v53, v53
  s_waitcnt lgkmcnt(1)
  v_lshlrev_b32 v52, 16, v44
  v_and_b32 v53, s7, v44
  v_add_f32 v22, v22, v52
  v_fmac_f32 v23, v52, v52
  v_add_f32 v22, v22, v53
  v_fmac_f32 v23, v53, v53
  v_lshlrev_b32 v52, 16, v45
  v_and_b32 v53, s7, v45
  v_add_f32 v22, v22, v52
  v_fmac_f32 v23, v52, v52
  v_add_f32 v22, v22, v53
  v_fmac_f32 v23, v53, v53
  v_lshlrev_b32 v52, 16, v46
  v_and_b32 v53, s7, v46
  v_add_f32 v22, v22, v52
  v_fmac_f32 v23, v52, v52
  v_add_f32 v22, v22, v53
  v_fmac_f32 v23, v53, v53
  v_lshlrev_b32 v52, 16, v47
  v_and_b32 v53, s7, v47
  v_add_f32 v22, v22, v52
  v_fmac_f32 v23, v52, v52
  v_add_f32 v22, v22, v53
  v_fmac_f32 v23, v53, v53
  s_waitcnt lgkmcnt(0)
  v_lshlrev_b32 v52, 16, v48
  v_and_b32 v53, s7, v48
  v_add_f32 v24, v24, v52
  v_fmac_f32 v25, v52, v52
  v_add_f32 v24, v24, v53
  v_fmac_f32 v25, v53, v53
  v_lshlrev_b32 v52, 16, v49
  v_and_b32 v53, s7, v49
  v_add_f32 v24, v24, v52
  v_fmac_f32 v25, v52, v52
  v_add_f32 v24, v24, v53
  v_fmac_f32 v25, v53, v53
  v_lshlrev_b32 v52, 16, v50
  v_and_b32 v53, s7, v50
  v_add_f32 v24, v24, v52
  v_fmac_f32 v25, v52, v52
  v_add_f32 v24, v24, v53
  v_fmac_f32 v25, v53, v53
  v_lshlrev_b32 v52, 16, v51
  v_and_b32 v53, s7, v51
  v_add_f32 v24, v24, v52
  v_fmac_f32 v25, v52, v52
  v_add_f32 v24, v24, v53
  v_fmac_f32 v25, v53, v53
  s_waitcnt vmcnt(11) lgkmcnt(0)
  s_barrier
  s_sub_u32 s79, s79, 1
  s_cmp_lg_u32 s79, 0
  s_cbranch_scc1 L_attn0_ld
  s_add_u32 s3, s75, s76
  s_add_u32 m0, s3, 0
  s_nop 0
  buffer_load_dwordx4 v4, s[36:39], s73 offen lds
  s_add_u32 m0, s3, 1024
  s_nop 0
  buffer_load_dwordx4 v5, s[36:39], s73 offen lds
  s_add_u32 m0, s3, 2048
  s_nop 0
  buffer_load_dwordx4 v6, s[36:39], s73 offen lds
  s_add_u32 m0, s3, 3072
  s_nop 0
  buffer_load_dwordx4 v7, s[36:39], s73 offen lds
  s_add_u32 m0, s75, s78
  s_mov_b64 exec, s[14:15]
  buffer_load_dwordx4 v28, s[36:39], s73 offen lds
  s_mov_b64 exec, -1
  s_add_u32 s3, s75, s77
  s_add_u32 m0, s3, 0
  s_add_u32 s4, s74, 0
  buffer_load_dwordx4 v8, s[40:43], s4 offen lds
  s_add_u32 m0, s3, 1024
  s_nop 0
  buffer_load_dwordx4 v9, s[40:43], s4 offen lds
  s_add_u32 m0, s3, 8192
  s_add_u32 s4, s74, 2048
  buffer_load_dwordx4 v8, s[40:43], s4 offen lds
  s_add_u32 m0, s3, 9216
  s_nop 0
  buffer_load_dwordx4 v9, s[40:43], s4 offen lds
  s_add_u32 m0, s3, 16384
  s_add_u32 s4, s74, 4096
  buffer_load_dwordx4 v8, s[40:43], s4 offen lds
  s_add_u32 m0, s3, 17408
  s_nop 0
  buffer_load_dwordx4 v9, s[40:43], s4 offen lds
  s_add_u32 s101, s101, 1
  s_xor_b32 s73, s101, s100
  s_and_b32 s73, s73, 3
  s_cselect_b32 s73, 15, 3
  s_add_u32 s73, s73, s101
  s_and_b32 s73, s73, 15
  s_mul_i32 s74, s73, 393216
  s_lshl_b32 s73, s73, 7
  s_add_u32 s75, s75, 43008
  s_cmp_eq_u32 s75, 129024
  s_cselect_b32 s75, 0, s75
  s_mov_b32 s64, s24
  s_and_b32 s65, s25, 0xffff
  s_mov_b32 s66, 7340032
  s_mov_b32 s67, 0x00020000
  s_min_u32 s3, s2, 223
  s_mul_i32 s4, s3, 4682
  s_lshr_b32 s4, s4, 16
  s_mul_i32 s5, s4, 14
  s_sub_u32 s3, s3, s5
  s_lshl_b32 s3, s3, 2
  s_and_b32 s5, s70, 3
  s_add_u32 s3, s3, s5
  s_mul_i32 s5, s4, 458752
  s_lshl_b32 s8, s3, 7
  s_add_u32 s5, s5, s8
  s_lshl_b32 s9, s4, 14
  s_lshl_b32 s8, s3, 8
  s_add_u32 s9, s9, s8
  v_lshrrev_b32 v2, 3, v1
  v_mul_u32_u24 v2, 7168, v2
  v_and_b32 v3, 7, v1
  v_lshl_add_u32 v2, v3, 4, v2
  buffer_load_dwordx4 v[64:67], v2, s[64:67], s5 offen
  s_add_u32 s5, s5, 57344
  buffer_load_dwordx4 v[68:71], v2, s[64:67], s5 offen
  s_add_u32 s5, s5, 57344
  buffer_load_dwordx4 v[72:75], v2, s[64:67], s5 offen
  s_add_u32 s5, s5, 57344
  buffer_load_dwordx4 v[76:79], v2, s[64:67], s5 offen
  s_add_u32 s5, s5, 57344
  buffer_load_dwordx4 v[80:83], v2, s[64:67], s5 offen
  s_add_u32 s5, s5, 57344
  buffer_load_dwordx4 v[84:87], v2, s[64:67], s5 offen
  s_add_u32 s5, s5, 57344
  buffer_load_dwordx4 v[88:91], v2, s[64:67], s5 offen
  s_add_u32 s5, s5, 57344
  buffer_load_dwordx4 v[92:95], v2, s[64:67], s5 offen
  s_mov_b32 s60, s20
  s_and_b32 s61, s21, 0xffff
  s_mov_b32 s62, 2097152
  s_mov_b32 s63, 0x00020000
  s_and_b32 s3, s70, 3
  s_mul_i32 s3, s3, 8
  s_mul_i32 s4, s99, 32
  s_add_u32 s3, s3, s4
  v_lshrrev_b32 v2, 3, v1
  v_add_u32 v2, s3, v2
  v_mul_u32_u24 v2, 2048, v2
  v_and_b32 v3, 7, v1
  v_lshl_add_u32 v2, v3, 7, v2
  s_and_b32 s3, s2, 7
  s_lshr_b32 s3, s3, 2
  s_mul_i32 s3, s3, 1024
  buffer_load_dword v96, v2, s[60:63], s3 offen
  s_getpc_b64 s[4:5]
L_pfc2:
  s_add_u32 s4, s4, L_wo_c0-L_pfc2
  s_addc_u32 s5, s5, 0
  s_and_b32 s3, s70, 3
  s_lshl_b32 s3, s3, 13
  v_lshl_add_u32 v2, v1, 7, s3
  v_min_u32 v2, L_wo_c1-L_wo_c0-4, v2
  global_load_dword v104, v2, s[4:5]
  v_add_u32 v14, s98, v12
  v_add_u32 v15, s98, v13
  ds_read_b128 v[32:35], v14 offset:0
  ds_read_b128 v[36:39], v14 offset:1024
  ds_read_b128 v[40:43], v14 offset:2048
  ds_read_b128 v[44:47], v14 offset:3072
  ds_read_b128 v[48:51], v15
  s_add_u32 s98, s98, 43008
  s_cmp_eq_u32 s98, 129024
  s_cselect_b32 s98, 0, s98
  s_waitcnt lgkmcnt(4)
  v_lshlrev_b32 v52, 16, v32
  v_and_b32 v53, s7, v32
  v_add_f32 v16, v16, v52
  v_fmac_f32 v17, v52, v52
  v_add_f32 v16, v16, v53
  v_fmac_f32 v17, v53, v53
  v_lshlrev_b32 v52, 16, v33
  v_and_b32 v53, s7, v33
  v_add_f32 v16, v16, v52
  v_fmac_f32 v17, v52, v52
  v_add_f32 v16, v16, v53
  v_fmac_f32 v17, v53, v53
  v_lshlrev_b32 v52, 16, v34
  v_and_b32 v53, s7, v34
  v_add_f32 v16, v16, v52
  v_fmac_f32 v17, v52, v52
  v_add_f32 v16, v16, v53
  v_fmac_f32 v17, v53, v53
  v_lshlrev_b32 v52, 16, v35
  v_and_b32 v53, s7, v35
  v_add_f32 v16, v16, v52
  v_fmac_f32 v17, v52, v52
  v_add_f32 v16, v16, v53
  v_fmac_f32 v17, v53, v53
  s_waitcnt lgkmcnt(3)
  v_lshlrev_b32 v52, 16, v36
  v_and_b32 v53, s7, v36
  v_add_f32 v18, v18, v52
  v_fmac_f32 v19, v52, v52
  v_add_f32 v18, v18, v53
  v_fmac_f32 v19, v53, v53
  v_lshlrev_b32 v52, 16, v37
  v_and_b32 v53, s7, v37
  v_add_f32 v18, v18, v52
  v_fmac_f32 v19, v52, v52
  v_add_f32 v18, v18, v53
  v_fmac_f32 v19, v53, v53
  v_lshlrev_b32 v52, 16, v38
  v_and_b32 v53, s7, v38
  v_add_f32 v18, v18, v52
  v_fmac_f32 v19, v52, v52
  v_add_f32 v18, v18, v53
  v_fmac_f32 v19, v53, v53
  v_lshlrev_b32 v52, 16, v39
  v_and_b32 v53, s7, v39
  v_add_f32 v18, v18, v52
  v_fmac_f32 v19, v52, v52
  v_add_f32 v18, v18, v53
  v_fmac_f32 v19, v53, v53
  s_waitcnt lgkmcnt(2)
  v_lshlrev_b32 v52, 16, v40
  v_and_b32 v53, s7, v40
  v_add_f32 v20, v20, v52
  v_fmac_f32 v21, v52, v52
  v_add_f32 v20, v20, v53
  v_fmac_f32 v21, v53, v53
  v_lshlrev_b32 v52, 16, v41
  v_and_b32 v53, s7, v41
  v_add_f32 v20, v20, v52
  v_fmac_f32 v21, v52, v52
  v_add_f32 v20, v20, v53
  v_fmac_f32 v21, v53, v53
  v_lshlrev_b32 v52, 16, v42
  v_and_b32 v53, s7, v42
  v_add_f32 v20, v20, v52
  v_fmac_f32 v21, v52, v52
  v_add_f32 v20, v20, v53
  v_fmac_f32 v21, v53, v53
  v_lshlrev_b32 v52, 16, v43
  v_and_b32 v53, s7, v43
  v_add_f32 v20, v20, v52
  v_fmac_f32 v21, v52, v52
  v_add_f32 v20, v20, v53
  v_fmac_f32 v21, v53, v53
  s_waitcnt lgkmcnt(1)
  v_lshlrev_b32 v52, 16, v44
  v_and_b32 v53, s7, v44
  v_add_f32 v22, v22, v52
  v_fmac_f32 v23, v52, v52
  v_add_f32 v22, v22, v53
  v_fmac_f32 v23, v53, v53
  v_lshlrev_b32 v52, 16, v45
  v_and_b32 v53, s7, v45
  v_add_f32 v22, v22, v52
  v_fmac_f32 v23, v52, v52
  v_add_f32 v22, v22, v53
  v_fmac_f32 v23, v53, v53
  v_lshlrev_b32 v52, 16, v46
  v_and_b32 v53, s7, v46
  v_add_f32 v22, v22, v52
  v_fmac_f32 v23, v52, v52
  v_add_f32 v22, v22, v53
  v_fmac_f32 v23, v53, v53
  v_lshlrev_b32 v52, 16, v47
  v_and_b32 v53, s7, v47
  v_add_f32 v22, v22, v52
  v_fmac_f32 v23, v52, v52
  v_add_f32 v22, v22, v53
  v_fmac_f32 v23, v53, v53
  s_waitcnt lgkmcnt(0)
  v_lshlrev_b32 v52, 16, v48
  v_and_b32 v53, s7, v48
  v_add_f32 v24, v24, v52
  v_fmac_f32 v25, v52, v52
  v_add_f32 v24, v24, v53
  v_fmac_f32 v25, v53, v53
  v_lshlrev_b32 v52, 16, v49
  v_and_b32 v53, s7, v49
  v_add_f32 v24, v24, v52
  v_fmac_f32 v25, v52, v52
  v_add_f32 v24, v24, v53
  v_fmac_f32 v25, v53, v53
  v_lshlrev_b32 v52, 16, v50
  v_and_b32 v53, s7, v50
  v_add_f32 v24, v24, v52
  v_fmac_f32 v25, v52, v52
  v_add_f32 v24, v24, v53
  v_fmac_f32 v25, v53, v53
  v_lshlrev_b32 v52, 16, v51
  v_and_b32 v53, s7, v51
  v_add_f32 v24, v24, v52
  v_fmac_f32 v25, v52, v52
  v_add_f32 v24, v24, v53
  v_fmac_f32 v25, v53, v53
  s_waitcnt vmcnt(21) lgkmcnt(0)
  s_barrier
  v_add_u32 v14, s98, v12
  v_add_u32 v15, s98, v13
  ds_read_b128 v[32:35], v14 offset:0
  ds_read_b128 v[36:39], v14 offset:1024
  ds_read_b128 v[40:43], v14 offset:2048
  ds_read_b128 v[44:47], v14 offset:3072
  ds_read_b128 v[48:51], v15
  s_add_u32 s98, s98, 43008
  s_cmp_eq_u32 s98, 129024
  s_cselect_b32 s98, 0, s98
  s_waitcnt lgkmcnt(4)
  v_lshlrev_b32 v52, 16, v32
  v_and_b32 v53, s7, v32
  v_add_f32 v16, v16, v52
  v_fmac_f32 v17, v52, v52
  v_add_f32 v16, v16, v53
  v_fmac_f32 v17, v53, v53
  v_lshlrev_b32 v52, 16, v33
  v_and_b32 v53, s7, v33
  v_add_f32 v16, v16, v52
  v_fmac_f32 v17, v52, v52
  v_add_f32 v16, v16, v53
  v_fmac_f32 v17, v53, v53
  v_lshlrev_b32 v52, 16, v34
  v_and_b32 v53, s7, v34
  v_add_f32 v16, v16, v52
  v_fmac_f32 v17, v52, v52
  v_add_f32 v16, v16, v53
  v_fmac_f32 v17, v53, v53
  v_lshlrev_b32 v52, 16, v35
  v_and_b32 v53, s7, v35
  v_add_f32 v16, v16, v52
  v_fmac_f32 v17, v52, v52
  v_add_f32 v16, v16, v53
  v_fmac_f32 v17, v53, v53
  s_waitcnt lgkmcnt(3)
  v_lshlrev_b32 v52, 16, v36
  v_and_b32 v53, s7, v36
  v_add_f32 v18, v18, v52
  v_fmac_f32 v19, v52, v52
  v_add_f32 v18, v18, v53
  v_fmac_f32 v19, v53, v53
  v_lshlrev_b32 v52, 16, v37
  v_and_b32 v53, s7, v37
  v_add_f32 v18, v18, v52
  v_fmac_f32 v19, v52, v52
  v_add_f32 v18, v18, v53
  v_fmac_f32 v19, v53, v53
  v_lshlrev_b32 v52, 16, v38
  v_and_b32 v53, s7, v38
  v_add_f32 v18, v18, v52
  v_fmac_f32 v19, v52, v52
  v_add_f32 v18, v18, v53
  v_fmac_f32 v19, v53, v53
  v_lshlrev_b32 v52, 16, v39
  v_and_b32 v53, s7, v39
  v_add_f32 v18, v18, v52
  v_fmac_f32 v19, v52, v52
  v_add_f32 v18, v18, v53
  v_fmac_f32 v19, v53, v53
  s_waitcnt lgkmcnt(2)
  v_lshlrev_b32 v52, 16, v40
  v_and_b32 v53, s7, v40
  v_add_f32 v20, v20, v52
  v_fmac_f32 v21, v52, v52
  v_add_f32 v20, v20, v53
  v_fmac_f32 v21, v53, v53
  v_lshlrev_b32 v52, 16, v41
  v_and_b32 v53, s7, v41
  v_add_f32 v20, v20, v52
  v_fmac_f32 v21, v52, v52
  v_add_f32 v20, v20, v53
  v_fmac_f32 v21, v53, v53
  v_lshlrev_b32 v52, 16, v42
  v_and_b32 v53, s7, v42
  v_add_f32 v20, v20, v52
  v_fmac_f32 v21, v52, v52
  v_add_f32 v20, v20, v53
  v_fmac_f32 v21, v53, v53
  v_lshlrev_b32 v52, 16, v43
  v_and_b32 v53, s7, v43
  v_add_f32 v20, v20, v52
  v_fmac_f32 v21, v52, v52
  v_add_f32 v20, v20, v53
  v_fmac_f32 v21, v53, v53
  s_waitcnt lgkmcnt(1)
  v_lshlrev_b32 v52, 16, v44
  v_and_b32 v53, s7, v44
  v_add_f32 v22, v22, v52
  v_fmac_f32 v23, v52, v52
  v_add_f32 v22, v22, v53
  v_fmac_f32 v23, v53, v53
  v_lshlrev_b32 v52, 16, v45
  v_and_b32 v53, s7, v45
  v_add_f32 v22, v22, v52
  v_fmac_f32 v23, v52, v52
  v_add_f32 v22, v22, v53
  v_fmac_f32 v23, v53, v53
  v_lshlrev_b32 v52, 16, v46
  v_and_b32 v53, s7, v46
  v_add_f32 v22, v22, v52
  v_fmac_f32 v23, v52, v52
  v_add_f32 v22, v22, v53
  v_fmac_f32 v23, v53, v53
  v_lshlrev_b32 v52, 16, v47
  v_and_b32 v53, s7, v47
  v_add_f32 v22, v22, v52
  v_fmac_f32 v23, v52, v52
  v_add_f32 v22, v22, v53
  v_fmac_f32 v23, v53, v53
  s_waitcnt lgkmcnt(0)
  v_lshlrev_b32 v52, 16, v48
  v_and_b32 v53, s7, v48
  v_add_f32 v24, v24, v52
  v_fmac_f32 v25, v52, v52
  v_add_f32 v24, v24, v53
  v_fmac_f32 v25, v53, v53
  v_lshlrev_b32 v52, 16, v49
  v_and_b32 v53, s7, v49
  v_add_f32 v24, v24, v52
  v_fmac_f32 v25, v52, v52
  v_add_f32 v24, v24, v53
  v_fmac_f32 v25, v53, v53
  v_lshlrev_b32 v52, 16, v50
  v_and_b32 v53, s7, v50
  v_add_f32 v24, v24, v52
  v_fmac_f32 v25, v52, v52
  v_add_f32 v24, v24, v53
  v_fmac_f32 v25, v53, v53
  v_lshlrev_b32 v52, 16, v51
  v_and_b32 v53, s7, v51
  v_add_f32 v24, v24, v52
  v_fmac_f32 v25, v52, v52
  v_add_f32 v24, v24, v53
  v_fmac_f32 v25, v53, v53
  s_waitcnt vmcnt(10) lgkmcnt(0)
  s_barrier
  v_add_u32 v14, s98, v12
  v_add_u32 v15, s98, v13
  ds_read_b128 v[32:35], v14 offset:0
  ds_read_b128 v[36:39], v14 offset:1024
  ds_read_b128 v[40:43], v14 offset:2048
  ds_read_b128 v[44:47], v14 offset:3072
  ds_read_b128 v[48:51], v15
  s_add_u32 s98, s98, 43008
  s_cmp_eq_u32 s98, 129024
  s_cselect_b32 s98, 0, s98
  s_waitcnt lgkmcnt(4)
  v_lshlrev_b32 v52, 16, v32
  v_and_b32 v53, s7, v32
  v_add_f32 v16, v16, v52
  v_fmac_f32 v17, v52, v52
  v_add_f32 v16, v16, v53
  v_fmac_f32 v17, v53, v53
  v_lshlrev_b32 v52, 16, v33
  v_and_b32 v53, s7, v33
  v_add_f32 v16, v16, v52
  v_fmac_f32 v17, v52, v52
  v_add_f32 v16, v16, v53
  v_fmac_f32 v17, v53, v53
  v_lshlrev_b32 v52, 16, v34
  v_and_b32 v53, s7, v34
  v_add_f32 v16, v16, v52
  v_fmac_f32 v17, v52, v52
  v_add_f32 v16, v16, v53
  v_fmac_f32 v17, v53, v53
  v_lshlrev_b32 v52, 16, v35
  v_and_b32 v53, s7, v35
  v_add_f32 v16, v16, v52
  v_fmac_f32 v17, v52, v52
  v_add_f32 v16, v16, v53
  v_fmac_f32 v17, v53, v53
  s_waitcnt lgkmcnt(3)
  v_lshlrev_b32 v52, 16, v36
  v_and_b32 v53, s7, v36
  v_add_f32 v18, v18, v52
  v_fmac_f32 v19, v52, v52
  v_add_f32 v18, v18, v53
  v_fmac_f32 v19, v53, v53
  v_lshlrev_b32 v52, 16, v37
  v_and_b32 v53, s7, v37
  v_add_f32 v18, v18, v52
  v_fmac_f32 v19, v52, v52
  v_add_f32 v18, v18, v53
  v_fmac_f32 v19, v53, v53
  v_lshlrev_b32 v52, 16, v38
  v_and_b32 v53, s7, v38
  v_add_f32 v18, v18, v52
  v_fmac_f32 v19, v52, v52
  v_add_f32 v18, v18, v53
  v_fmac_f32 v19, v53, v53
  v_lshlrev_b32 v52, 16, v39
  v_and_b32 v53, s7, v39
  v_add_f32 v18, v18, v52
  v_fmac_f32 v19, v52, v52
  v_add_f32 v18, v18, v53
  v_fmac_f32 v19, v53, v53
  s_waitcnt lgkmcnt(2)
  v_lshlrev_b32 v52, 16, v40
  v_and_b32 v53, s7, v40
  v_add_f32 v20, v20, v52
  v_fmac_f32 v21, v52, v52
  v_add_f32 v20, v20, v53
  v_fmac_f32 v21, v53, v53
  v_lshlrev_b32 v52, 16, v41
  v_and_b32 v53, s7, v41
  v_add_f32 v20, v20, v52
  v_fmac_f32 v21, v52, v52
  v_add_f32 v20, v20, v53
  v_fmac_f32 v21, v53, v53
  v_lshlrev_b32 v52, 16, v42
  v_and_b32 v53, s7, v42
  v_add_f32 v20, v20, v52
  v_fmac_f32 v21, v52, v52
  v_add_f32 v20, v20, v53
  v_fmac_f32 v21, v53, v53
  v_lshlrev_b32 v52, 16, v43
  v_and_b32 v53, s7, v43
  v_add_f32 v20, v20, v52
  v_fmac_f32 v21, v52, v52
  v_add_f32 v20, v20, v53
  v_fmac_f32 v21, v53, v53
  s_waitcnt lgkmcnt(1)
  v_lshlrev_b32 v52, 16, v44
  v_and_b32 v53, s7, v44
  v_add_f32 v22, v22, v52
  v_fmac_f32 v23, v52, v52
  v_add_f32 v22, v22, v53
  v_fmac_f32 v23, v53, v53
  v_lshlrev_b32 v52, 16, v45
  v_and_b32 v53, s7, v45
  v_add_f32 v22, v22, v52
  v_fmac_f32 v23, v52, v52
  v_add_f32 v22, v22, v53
  v_fmac_f32 v23, v53, v53
  v_lshlrev_b32 v52, 16, v46
  v_and_b32 v53, s7, v46
  v_add_f32 v22, v22, v52
  v_fmac_f32 v23, v52, v52
  v_add_f32 v22, v22, v53
  v_fmac_f32 v23, v53, v53
  v_lshlrev_b32 v52, 16, v47
  v_and_b32 v53, s7, v47
  v_add_f32 v22, v22, v52
  v_fmac_f32 v23, v52, v52
  v_add_f32 v22, v22, v53
  v_fmac_f32 v23, v53, v53
  s_waitcnt lgkmcnt(0)
  v_lshlrev_b32 v52, 16, v48
  v_and_b32 v53, s7, v48
  v_add_f32 v24, v24, v52
  v_fmac_f32 v25, v52, v52
  v_add_f32 v24, v24, v53
  v_fmac_f32 v25, v53, v53
  v_lshlrev_b32 v52, 16, v49
  v_and_b32 v53, s7, v49
  v_add_f32 v24, v24, v52
  v_fmac_f32 v25, v52, v52
  v_add_f32 v24, v24, v53
  v_fmac_f32 v25, v53, v53
  v_lshlrev_b32 v52, 16, v50
  v_and_b32 v53, s7, v50
  v_add_f32 v24, v24, v52
  v_fmac_f32 v25, v52, v52
  v_add_f32 v24, v24, v53
  v_fmac_f32 v25, v53, v53
  v_lshlrev_b32 v52, 16, v51
  v_and_b32 v53, s7, v51
  v_add_f32 v24, v24, v52
  v_fmac_f32 v25, v52, v52
  v_add_f32 v24, v24, v53
  v_fmac_f32 v25, v53, v53
  s_nop 2
  v_add_f32_dpp v16, v16, v16 quad_perm:[1,0,3,2] row_mask:0xf bank_mask:0xf
  v_add_f32_dpp v17, v17, v17 quad_perm:[1,0,3,2] row_mask:0xf bank_mask:0xf
  v_add_f32_dpp v18, v18, v18 quad_perm:[1,0,3,2] row_mask:0xf bank_mask:0xf
  v_add_f32_dpp v19, v19, v19 quad_perm:[1,0,3,2] row_mask:0xf bank_mask:0xf
  v_add_f32_dpp v20, v20, v20 quad_perm:[1,0,3,2] row_mask:0xf bank_mask:0xf
  v_add_f32_dpp v21, v21, v21 quad_perm:[1,0,3,2] row_mask:0xf bank_mask:0xf
  v_add_f32_dpp v22, v22, v22 quad_perm:[1,0,3,2] row_mask:0xf bank_mask:0xf
  v_add_f32_dpp v23, v23, v23 quad_perm:[1,0,3,2] row_mask:0xf bank_mask:0xf
  v_add_f32_dpp v24, v24, v24 quad_perm:[1,0,3,2] row_mask:0xf bank_mask:0xf
  v_add_f32_dpp v25, v25, v25 quad_perm:[1,0,3,2] row_mask:0xf bank_mask:0xf
  v_add_f32_dpp v16, v16, v16 quad_perm:[2,3,0,1] row_mask:0xf bank_mask:0xf
  v_add_f32_dpp v17, v17, v17 quad_perm:[2,3,0,1] row_mask:0xf bank_mask:0xf
  v_add_f32_dpp v18, v18, v18 quad_perm:[2,3,0,1] row_mask:0xf bank_mask:0xf
  v_add_f32_dpp v19, v19, v19 quad_perm:[2,3,0,1] row_mask:0xf bank_mask:0xf
  v_add_f32_dpp v20, v20, v20 quad_perm:[2,3,0,1] row_mask:0xf bank_mask:0xf
  v_add_f32_dpp v21, v21, v21 quad_perm:[2,3,0,1] row_mask:0xf bank_mask:0xf
  v_add_f32_dpp v22, v22, v22 quad_perm:[2,3,0,1] row_mask:0xf bank_mask:0xf
  v_add_f32_dpp v23, v23, v23 quad_perm:[2,3,0,1] row_mask:0xf bank_mask:0xf
  v_add_f32_dpp v24, v24, v24 quad_perm:[2,3,0,1] row_mask:0xf bank_mask:0xf
  v_add_f32_dpp v25, v25, v25 quad_perm:[2,3,0,1] row_mask:0xf bank_mask:0xf
  v_add_f32_dpp v16, v16, v16 row_half_mirror row_mask:0xf bank_mask:0xf
  v_add_f32_dpp v17, v17, v17 row_half_mirror row_mask:0xf bank_mask:0xf
  v_add_f32_dpp v18, v18, v18 row_half_mirror row_mask:0xf bank_mask:0xf
  v_add_f32_dpp v19, v19, v19 row_half_mirror row_mask:0xf bank_mask:0xf
  v_add_f32_dpp v20, v20, v20 row_half_mirror row_mask:0xf bank_mask:0xf
  v_add_f32_dpp v21, v21, v21 row_half_mirror row_mask:0xf bank_mask:0xf
  v_add_f32_dpp v22, v22, v22 row_half_mirror row_mask:0xf bank_mask:0xf
  v_add_f32_dpp v23, v23, v23 row_half_mirror row_mask:0xf bank_mask:0xf
  v_add_f32_dpp v24, v24, v24 row_half_mirror row_mask:0xf bank_mask:0xf
  v_add_f32_dpp v25, v25, v25 row_half_mirror row_mask:0xf bank_mask:0xf
  v_mul_f32 v16, 0x3a800000, v16
  v_mul_f32 v17, 0x3a800000, v17
  v_fma_f32 v17, -v16, v16, v17
  v_max_f32 v17, 0, v17
  v_add_f32 v17, 0x3727c5ac, v17
  v_rsq_f32 v17, v17
  s_nop 0
  v_mul_f32 v18, 0x3a800000, v18
  v_mul_f32 v19, 0x3a800000, v19
  v_fma_f32 v19, -v18, v18, v19
  v_max_f32 v19, 0, v19
  v_add_f32 v19, 0x3727c5ac, v19
  v_rsq_f32 v19, v19
  s_nop 0
  v_mul_f32 v20, 0x3a800000, v20
  v_mul_f32 v21, 0x3a800000, v21
  v_fma_f32 v21, -v20, v20, v21
  v_max_f32 v21, 0, v21
  v_add_f32 v21, 0x3727c5ac, v21
  v_rsq_f32 v21, v21
  s_nop 0
  v_mul_f32 v22, 0x3a800000, v22
  v_mul_f32 v23, 0x3a800000, v23
  v_fma_f32 v23, -v22, v22, v23
  v_max_f32 v23, 0, v23
  v_add_f32 v23, 0x3727c5ac, v23
  v_rsq_f32 v23, v23
  s_nop 0
  v_mul_f32 v24, 0x3a800000, v24
  v_mul_f32 v25, 0x3a800000, v25
  v_fma_f32 v25, -v24, v24, v25
  v_max_f32 v25, 0, v25
  v_add_f32 v25, 0x3727c5ac, v25
  v_rsq_f32 v25, v25
  s_nop 0
  v_lshrrev_b32 v2, 3, v1
  s_lshr_b32 s3, s76, 5
  s_add_u32 s3, s3, 129088
  v_lshl_add_u32 v3, v2, 2, s3
  ds_write2_b32 v3, v16, v17 offset0:0 offset1:160
  ds_write2_b32 v3, v18, v19 offset0:8 offset1:168
  ds_write2_b32 v3, v20, v21 offset0:16 offset1:176
  ds_write2_b32 v3, v22, v23 offset0:24 offset1:184
  v_and_b32 v2, 3, v2
  s_and_b32 s3, s70, 3
  s_lshl_b32 s3, s3, 4
  s_add_u32 s3, s3, 129024
  v_lshl_add_u32 v3, v2, 2, s3
  ds_write2_b32 v3, v24, v25 offset0:0 offset1:160
  s_waitcnt lgkmcnt(0)
  s_barrier
  s_barrier
  s_waitcnt vmcnt(0)
  s_mov_b32 s7, 0xffff0000
  v_lshlrev_b32 v32, 16, v64
  v_and_b32 v33, s7, v64
  v_lshlrev_b32 v34, 16, v65
  v_and_b32 v35, s7, v65
  v_lshlrev_b32 v36, 16, v66
  v_and_b32 v37, s7, v66
  v_lshlrev_b32 v38, 16, v67
  v_and_b32 v39, s7, v67
  v_lshlrev_b32 v40, 16, v68
  v_and_b32 v41, s7, v68
  v_pk_add_f32 v[32:33], v[32:33], v[40:41]
  v_lshlrev_b32 v40, 16, v69
  v_and_b32 v41, s7, v69
  v_pk_add_f32 v[34:35], v[34:35], v[40:41]
  v_lshlrev_b32 v40, 16, v70
  v_and_b32 v41, s7, v70
  v_pk_add_f32 v[36:37], v[36:37], v[40:41]
  v_lshlrev_b32 v40, 16, v71
  v_and_b32 v41, s7, v71
  v_pk_add_f32 v[38:39], v[38:39], v[40:41]
  v_lshlrev_b32 v40, 16, v72
  v_and_b32 v41, s7, v72
  v_pk_add_f32 v[32:33], v[32:33], v[40:41]
  v_lshlrev_b32 v40, 16, v73
  v_and_b32 v41, s7, v73
  v_pk_add_f32 v[34:35], v[34:35], v[40:41]
  v_lshlrev_b32 v40, 16, v74
  v_and_b32 v41, s7, v74
  v_pk_add_f32 v[36:37], v[36:37], v[40:41]
  v_lshlrev_b32 v40, 16, v75
  v_and_b32 v41, s7, v75
  v_pk_add_f32 v[38:39], v[38:39], v[40:41]
  v_lshlrev_b32 v40, 16, v76
  v_and_b32 v41, s7, v76
  v_pk_add_f32 v[32:33], v[32:33], v[40:41]
  v_lshlrev_b32 v40, 16, v77
  v_and_b32 v41, s7, v77
  v_pk_add_f32 v[34:35], v[34:35], v[40:41]
  v_lshlrev_b32 v40, 16, v78
  v_and_b32 v41, s7, v78
  v_pk_add_f32 v[36:37], v[36:37], v[40:41]
  v_lshlrev_b32 v40, 16, v79
  v_and_b32 v41, s7, v79
  v_pk_add_f32 v[38:39], v[38:39], v[40:41]
  v_lshlrev_b32 v40, 16, v80
  v_and_b32 v41, s7, v80
  v_pk_add_f32 v[32:33], v[32:33], v[40:41]
  v_lshlrev_b32 v40, 16, v81
  v_and_b32 v41, s7, v81
  v_pk_add_f32 v[34:35], v[34:35], v[40:41]
  v_lshlrev_b32 v40, 16, v82
  v_and_b32 v41, s7, v82
  v_pk_add_f32 v[36:37], v[36:37], v[40:41]
  v_lshlrev_b32 v40, 16, v83
  v_and_b32 v41, s7, v83
  v_pk_add_f32 v[38:39], v[38:39], v[40:41]
  v_lshlrev_b32 v40, 16, v84
  v_and_b32 v41, s7, v84
  v_pk_add_f32 v[32:33], v[32:33], v[40:41]
  v_lshlrev_b32 v40, 16, v85
  v_and_b32 v41, s7, v85
  v_pk_add_f32 v[34:35], v[34:35], v[40:41]
  v_lshlrev_b32 v40, 16, v86
  v_and_b32 v41, s7, v86
  v_pk_add_f32 v[36:37], v[36:37], v[40:41]
  v_lshlrev_b32 v40, 16, v87
  v_and_b32 v41, s7, v87
  v_pk_add_f32 v[38:39], v[38:39], v[40:41]
  v_lshlrev_b32 v40, 16, v88
  v_and_b32 v41, s7, v88
  v_pk_add_f32 v[32:33], v[32:33], v[40:41]
  v_lshlrev_b32 v40, 16, v89
  v_and_b32 v41, s7, v89
  v_pk_add_f32 v[34:35], v[34:35], v[40:41]
  v_lshlrev_b32 v40, 16, v90
  v_and_b32 v41, s7, v90
  v_pk_add_f32 v[36:37], v[36:37], v[40:41]
  v_lshlrev_b32 v40, 16, v91
  v_and_b32 v41, s7, v91
  v_pk_add_f32 v[38:39], v[38:39], v[40:41]
  v_lshlrev_b32 v40, 16, v92
  v_and_b32 v41, s7, v92
  v_pk_add_f32 v[32:33], v[32:33], v[40:41]
  v_lshlrev_b32 v40, 16, v93
  v_and_b32 v41, s7, v93
  v_pk_add_f32 v[34:35], v[34:35], v[40:41]
  v_lshlrev_b32 v40, 16, v94
  v_and_b32 v41, s7, v94
  v_pk_add_f32 v[36:37], v[36:37], v[40:41]
  v_lshlrev_b32 v40, 16, v95
  v_and_b32 v41, s7, v95
  v_pk_add_f32 v[38:39], v[38:39], v[40:41]
  s_add_u32 s64, s34, 24641536
  s_addc_u32 s65, s35, 0
  s_and_b32 s65, s65, 0xffff
  s_mov_b32 s66, 262144
  s_mov_b32 s67, 0x00020000
  v_permlane32_swap_b32 v32, v36
  v_permlane32_swap_b32 v33, v37
  v_permlane32_swap_b32 v34, v38
  v_permlane32_swap_b32 v35, v39
  v_add_f32 v32, v32, v36
  v_add_f32 v33, v33, v37
  v_add_f32 v34, v34, v38
  v_add_f32 v35, v35, v39
  v_and_b32 v2, 7, v1
  v_lshlrev_b32 v2, 5, v2
  v_permlane16_swap_b32 v32, v34
  v_permlane16_swap_b32 v33, v35
  v_add_f32 v32, v32, v34
  v_add_f32 v33, v33, v35
  v_lshrrev_b32 v3, 4, v1
  v_lshl_add_u32 v2, v3, 3, v2
  v_add_f32_dpp v32, v32, v32 row_ror:8 row_mask:0xf bank_mask:0xf
  v_add_f32_dpp v33, v33, v33 row_ror:8 row_mask:0xf bank_mask:0xf
  buffer_store_dwordx2 v[32:33], v2, s[64:67], s9 offen
L_attn_end:
  s_endpgm
.section .rodata,"a"
.p2align 6
.amdhsa_kernel attnl0_kernel
  .amdhsa_next_free_vgpr 256
  .amdhsa_next_free_sgpr 102
  .amdhsa_accum_offset 256
  .amdhsa_group_segment_fixed_size 0
  .amdhsa_kernarg_size 88
  .amdhsa_user_sgpr_count 2
  .amdhsa_user_sgpr_kernarg_segment_ptr 1
  .amdhsa_system_sgpr_workgroup_id_x 1
  .amdhsa_float_denorm_mode_32 3
  .amdhsa_float_denorm_mode_16_64 3
.end_amdhsa_kernel
.text
.text
.globl attnl1_kernel
.p2align 8
.type attnl1_kernel,@function
attnl1_kernel:
  s_load_dwordx16 s[16:31], s[0:1], 0
  s_load_dwordx2 s[32:33], s[0:1], 64
  s_load_dwordx2 s[34:35], s[0:1], 80
  s_load_dwordx2 s[12:13], s[0:1], 64
  s_mov_b32 s96, 1
  s_branch L_attn_body
L_attn_c1:
.section .rodata,"a"
.p2align 6
.amdhsa_kernel attnl1_kernel
  .amdhsa_next_free_vgpr 256
  .amdhsa_next_free_sgpr 102
  .amdhsa_accum_offset 256
  .amdhsa_group_segment_fixed_size 0
  .amdhsa_kernarg_size 88
  .amdhsa_user_sgpr_count 2
  .amdhsa_user_sgpr_kernarg_segment_ptr 1
  .amdhsa_system_sgpr_workgroup_id_x 1
  .amdhsa_float_denorm_mode_32 3
  .amdhsa_float_denorm_mode_16_64 3
.end_amdhsa_kernel
.text
L_wo_c0:
.text
.globl wol0_kernel
.p2align 8
.type wol0_kernel,@function
wol0_kernel:
  s_load_dwordx16 s[16:31], s[0:1], 0
  s_load_dwordx2 s[32:33], s[0:1], 64
  s_load_dwordx2 s[34:35], s[0:1], 80
  s_load_dwordx2 s[12:13], s[0:1], 0
  s_mov_b32 s96, 0
L_wo_body:
  s_cmp_ge_u32 s2, 256
  s_cbranch_scc1 L_wo_end
  v_lshrrev_b32 v2, 6, v0
  v_and_b32 v1, 63, v0
  v_readfirstlane_b32 s70, v2
  s_and_b32 s3, s2, 7
  s_lshr_b32 s99, s2, 3
  s_and_b32 s5, s3, 3
  s_lshl_b32 s5, s5, 2
  s_and_b32 s6, s99, 3
  s_add_u32 s68, s5, s6
  s_lshr_b32 s5, s3, 2
  s_lshl_b32 s5, s5, 3
  s_lshr_b32 s6, s99, 2
  s_add_u32 s69, s5, s6
  s_cmp_ge_u32 s70, 4
  s_cbranch_scc1 L_wo_loader
  v_and_b32 v3, 15, v1
  v_lshrrev_b32 v2, 4, v1
  s_lshl_b32 s8, s68, 7
  s_lshl_b32 s9, s70, 5
  s_add_u32 s8, s8, s9
  v_add_u32 v13, s8, v3
  s_lshl_b32 s10, s69, 7
  v_lshl_add_u32 v14, v2, 3, s10
  v_lshl_add_u32 v15, v13, 11, v14
  v_and_b32 v16, 1, v2
  v_lshlrev_b32 v16, 5, v16
  v_lshrrev_b32 v17, 1, v2
  v_lshl_add_u32 v16, v17, 4, v16
  v_add_u32 v16, s10, v16
  v_lshl_add_u32 v12, v13, 11, v16
  v_lshl_add_u32 v18, v17, 4, v13
  v_lshlrev_b32 v18, 3, v18
  v_and_b32 v16, 1, v2
  v_lshl_add_u32 v18, v16, 2, v18
  s_lshl_b32 s10, s69, 14
  v_add_u32 v18, s10, v18
  v_lshrrev_b32 v17, 1, v3
  s_lshl_b32 s8, s70, 12
  v_xor_b32 v4, v2, v17
  v_lshlrev_b32 v4, 4, v4
  v_lshl_add_u32 v4, v3, 7, v4
  v_add_u32 v4, s8, v4
  v_add_u32 v5, 4, v2
  v_xor_b32 v5, v5, v17
  v_lshlrev_b32 v5, 4, v5
  v_lshl_add_u32 v5, v3, 7, v5
  v_add_u32 v5, s8, v5
  v_bfe_u32 v6, v1, 2, 2
  v_lshl_add_u32 v6, v2, 3, v6
  v_lshlrev_b32 v6, 7, v6
  v_and_b32 v17, 3, v1
  v_lshl_add_u32 v6, v17, 3, v6
  v_bfe_u32 v17, v1, 3, 2
  v_lshl_add_u32 v6, v17, 5, v6
  v_add_u32 v6, 16384, v6
  v_xor_b32 v7, 32, v6
  v_xor_b32 v8, 64, v6
  v_xor_b32 v9, 96, v6
  s_waitcnt lgkmcnt(0)
  s_mov_b32 s48, s12
  s_and_b32 s49, s13, 0xffff
  s_mov_b32 s50, 4194304
  s_mov_b32 s51, 0x00020000
  s_add_u32 s44, s34, 4194304
  s_addc_u32 s45, s35, 0
  s_and_b32 s45, s45, 0xffff
  s_mov_b32 s46, 4194304
  s_mov_b32 s47, 0x00020000
  s_add_u32 s56, s34, 24117248
  s_addc_u32 s57, s35, 0
  s_and_b32 s57, s57, 0xffff
  s_mov_b32 s58, 262144
  s_mov_b32 s59, 0x00020000
  s_mov_b32 s3, 32768
  buffer_load_dwordx2 v[160:161], v15, s[48:51], 0 offen offset:0
  buffer_load_dwordx2 v[164:165], v15, s[48:51], 0 offen offset:32
  buffer_load_dwordx2 v[168:169], v15, s[48:51], 0 offen offset:64
  buffer_load_dwordx2 v[172:173], v15, s[48:51], 0 offen offset:96
  buffer_load_dwordx2 v[162:163], v15, s[48:51], s3 offen offset:0
  buffer_load_dwordx2 v[166:167], v15, s[48:51], s3 offen offset:32
  buffer_load_dwordx2 v[170:171], v15, s[48:51], s3 offen offset:64
  buffer_load_dwordx2 v[174:175], v15, s[48:51], s3 offen offset:96
  s_mov_b32 s11, 0xffff0000
  s_mov_b32 s75, 0
  s_waitcnt vmcnt(0)
  v_lshlrev_b32 v128, 16, v160
  v_and_b32 v129, s11, v160
  v_lshlrev_b32 v130, 16, v161
  v_and_b32 v131, s11, v161
  v_lshlrev_b32 v132, 16, v162
  v_and_b32 v133, s11, v162
  v_lshlrev_b32 v134, 16, v163
  v_and_b32 v135, s11, v163
  v_lshlrev_b32 v136, 16, v164
  v_and_b32 v137, s11, v164
  v_lshlrev_b32 v138, 16, v165
  v_and_b32 v139, s11, v165
  v_lshlrev_b32 v140, 16, v166
  v_and_b32 v141, s11, v166
  v_lshlrev_b32 v142, 16, v167
  v_and_b32 v143, s11, v167
  v_lshlrev_b32 v144, 16, v168
  v_and_b32 v145, s11, v168
  v_lshlrev_b32 v146, 16, v169
  v_and_b32 v147, s11, v169
  v_lshlrev_b32 v148, 16, v170
  v_and_b32 v149, s11, v170
  v_lshlrev_b32 v150, 16, v171
  v_and_b32 v151, s11, v171
  v_lshlrev_b32 v152, 16, v172
  v_and_b32 v153, s11, v172
  v_lshlrev_b32 v154, 16, v173
  v_and_b32 v155, s11, v173
  v_lshlrev_b32 v156, 16, v174
  v_and_b32 v157, s11, v174
  v_lshlrev_b32 v158, 16, v175
  v_and_b32 v159, s11, v175
  v_add_u32 v24, s75, v4
  v_add_u32 v25, s75, v5
  v_add_u32 v26, s75, v6
  v_add_u32 v27, s75, v7
  v_add_u32 v28, s75, v8
  v_add_u32 v29, s75, v9
  s_add_u32 s75, s75, 24576
  s_cmp_eq_u32 s75, 147456
  s_cselect_b32 s75, 0, s75
  s_barrier
  ds_read_b128 v[32:35], v24 offset:0
  ds_read_b128 v[36:39], v24 offset:2048
  ds_read_b64_tr_b16 v[48:49], v26 offset:0
  ds_read_b64_tr_b16 v[50:51], v26 offset:512
  ds_read_b64_tr_b16 v[52:53], v27 offset:0
  ds_read_b64_tr_b16 v[54:55], v27 offset:512
  ds_read_b64_tr_b16 v[56:57], v28 offset:0
  ds_read_b64_tr_b16 v[58:59], v28 offset:512
  ds_read_b64_tr_b16 v[60:61], v29 offset:0
  ds_read_b64_tr_b16 v[62:63], v29 offset:512
  ds_read_b128 v[40:43], v25 offset:0
  ds_read_b128 v[44:47], v25 offset:2048
  ds_read_b64_tr_b16 v[64:65], v26 offset:4096
  ds_read_b64_tr_b16 v[66:67], v26 offset:4608
  ds_read_b64_tr_b16 v[68:69], v27 offset:4096
  ds_read_b64_tr_b16 v[70:71], v27 offset:4608
  ds_read_b64_tr_b16 v[72:73], v28 offset:4096
  ds_read_b64_tr_b16 v[74:75], v28 offset:4608
  ds_read_b64_tr_b16 v[76:77], v29 offset:4096
  ds_read_b64_tr_b16 v[78:79], v29 offset:4608
  s_mov_b32 s79, 8
  v_add_u32 v24, s75, v4
  v_add_u32 v25, s75, v5
  v_add_u32 v26, s75, v6
  v_add_u32 v27, s75, v7
  v_add_u32 v28, s75, v8
  v_add_u32 v29, s75, v9
  s_add_u32 s75, s75, 24576
  s_cmp_eq_u32 s75, 147456
  s_cselect_b32 s75, 0, s75
  s_waitcnt lgkmcnt(0)
.p2align 3
L_wo_loop:
  s_barrier
  v_mfma_f32_16x16x32_bf16 v[128:131], v[48:51], v[32:35], v[128:131]
  ds_read_b128 v[80:83], v24 offset:0
  ds_read_b128 v[84:87], v24 offset:2048
  v_mfma_f32_16x16x32_bf16 v[132:135], v[48:51], v[36:39], v[132:135]
  ds_read_b64_tr_b16 v[96:97], v26 offset:0
  ds_read_b64_tr_b16 v[98:99], v26 offset:512
  v_mfma_f32_16x16x32_bf16 v[136:139], v[52:55], v[32:35], v[136:139]
  ds_read_b64_tr_b16 v[100:101], v27 offset:0
  ds_read_b64_tr_b16 v[102:103], v27 offset:512
  v_mfma_f32_16x16x32_bf16 v[140:143], v[52:55], v[36:39], v[140:143]
  ds_read_b64_tr_b16 v[104:105], v28 offset:0
  ds_read_b64_tr_b16 v[106:107], v28 offset:512
  v_mfma_f32_16x16x32_bf16 v[144:147], v[56:59], v[32:35], v[144:147]
  ds_read_b64_tr_b16 v[108:109], v29 offset:0
  ds_read_b64_tr_b16 v[110:111], v29 offset:512
  v_mfma_f32_16x16x32_bf16 v[148:151], v[56:59], v[36:39], v[148:151]
  ds_read_b128 v[88:91], v25 offset:0
  ds_read_b128 v[92:95], v25 offset:2048
  v_mfma_f32_16x16x32_bf16 v[152:155], v[60:63], v[32:35], v[152:155]
  ds_read_b64_tr_b16 v[112:113], v26 offset:4096
  ds_read_b64_tr_b16 v[114:115], v26 offset:4608
  v_mfma_f32_16x16x32_bf16 v[156:159], v[60:63], v[36:39], v[156:159]
  ds_read_b64_tr_b16 v[116:117], v27 offset:4096
  ds_read_b64_tr_b16 v[118:119], v27 offset:4608
  v_mfma_f32_16x16x32_bf16 v[128:131], v[64:67], v[40:43], v[128:131]
  ds_read_b64_tr_b16 v[120:121], v28 offset:4096
  ds_read_b64_tr_b16 v[122:123], v28 offset:4608
  v_mfma_f32_16x16x32_bf16 v[132:135], v[64:67], v[44:47], v[132:135]
  ds_read_b64_tr_b16 v[124:125], v29 offset:4096
  ds_read_b64_tr_b16 v[126:127], v29 offset:4608
  v_mfma_f32_16x16x32_bf16 v[136:139], v[68:71], v[40:43], v[136:139]
  v_add_u32 v24, s75, v4
  v_add_u32 v25, s75, v5
  v_mfma_f32_16x16x32_bf16 v[140:143], v[68:71], v[44:47], v[140:143]
  v_add_u32 v26, s75, v6
  v_add_u32 v27, s75, v7
  v_mfma_f32_16x16x32_bf16 v[144:147], v[72:75], v[40:43], v[144:147]
  v_add_u32 v28, s75, v8
  v_add_u32 v29, s75, v9
  v_mfma_f32_16x16x32_bf16 v[148:151], v[72:75], v[44:47], v[148:151]
  s_add_u32 s75, s75, 24576
  s_cmp_eq_u32 s75, 147456
  v_mfma_f32_16x16x32_bf16 v[152:155], v[76:79], v[40:43], v[152:155]
  s_cselect_b32 s75, 0, s75
  v_mfma_f32_16x16x32_bf16 v[156:159], v[76:79], v[44:47], v[156:159]
  s_waitcnt lgkmcnt(0)
  s_barrier
  v_mfma_f32_16x16x32_bf16 v[128:131], v[96:99], v[80:83], v[128:131]
  ds_read_b128 v[32:35], v24 offset:0
  ds_read_b128 v[36:39], v24 offset:2048
  v_mfma_f32_16x16x32_bf16 v[132:135], v[96:99], v[84:87], v[132:135]
  ds_read_b64_tr_b16 v[48:49], v26 offset:0
  ds_read_b64_tr_b16 v[50:51], v26 offset:512
  v_mfma_f32_16x16x32_bf16 v[136:139], v[100:103], v[80:83], v[136:139]
  ds_read_b64_tr_b16 v[52:53], v27 offset:0
  ds_read_b64_tr_b16 v[54:55], v27 offset:512
  v_mfma_f32_16x16x32_bf16 v[140:143], v[100:103], v[84:87], v[140:143]
  ds_read_b64_tr_b16 v[56:57], v28 offset:0
  ds_read_b64_tr_b16 v[58:59], v28 offset:512
  v_mfma_f32_16x16x32_bf16 v[144:147], v[104:107], v[80:83], v[144:147]
  ds_read_b64_tr_b16 v[60:61], v29 offset:0
  ds_read_b64_tr_b16 v[62:63], v29 offset:512
  v_mfma_f32_16x16x32_bf16 v[148:151], v[104:107], v[84:87], v[148:151]
  ds_read_b128 v[40:43], v25 offset:0
  ds_read_b128 v[44:47], v25 offset:2048
  v_mfma_f32_16x16x32_bf16 v[152:155], v[108:111], v[80:83], v[152:155]
  ds_read_b64_tr_b16 v[64:65], v26 offset:4096
  ds_read_b64_tr_b16 v[66:67], v26 offset:4608
  v_mfma_f32_16x16x32_bf16 v[156:159], v[108:111], v[84:87], v[156:159]
  ds_read_b64_tr_b16 v[68:69], v27 offset:4096
  ds_read_b64_tr_b16 v[70:71], v27 offset:4608
  v_mfma_f32_16x16x32_bf16 v[128:131], v[112:115], v[88:91], v[128:131]
  ds_read_b64_tr_b16 v[72:73], v28 offset:4096
  ds_read_b64_tr_b16 v[74:75], v28 offset:4608
  v_mfma_f32_16x16x32_bf16 v[132:135], v[112:115], v[92:95], v[132:135]
  ds_read_b64_tr_b16 v[76:77], v29 offset:4096
  ds_read_b64_tr_b16 v[78:79], v29 offset:4608
  v_mfma_f32_16x16x32_bf16 v[136:139], v[116:119], v[88:91], v[136:139]
  v_add_u32 v24, s75, v4
  v_add_u32 v25, s75, v5
  v_mfma_f32_16x16x32_bf16 v[140:143], v[116:119], v[92:95], v[140:143]
  v_add_u32 v26, s75, v6
  v_add_u32 v27, s75, v7
  v_mfma_f32_16x16x32_bf16 v[144:147], v[120:123], v[88:91], v[144:147]
  v_add_u32 v28, s75, v8
  v_add_u32 v29, s75, v9
  v_mfma_f32_16x16x32_bf16 v[148:151], v[120:123], v[92:95], v[148:151]
  s_add_u32 s75, s75, 24576
  s_cmp_eq_u32 s75, 147456
  v_mfma_f32_16x16x32_bf16 v[152:155], v[124:127], v[88:91], v[152:155]
  s_cselect_b32 s75, 0, s75
  v_mfma_f32_16x16x32_bf16 v[156:159], v[124:127], v[92:95], v[156:159]
  s_sub_u32 s79, s79, 1
  s_cmp_lg_u32 s79, 0
  s_waitcnt lgkmcnt(0)
  s_cbranch_scc1 L_wo_loop
  s_mov_b32 s11, 0x3f803f80
  v_mov_b32 v20, 0
  v_mov_b32 v21, 0
  v_mov_b32 v22, 0
  v_mov_b32 v23, 0
  s_mov_b32 s3, 32768
  s_nop 4
  v_cvt_pk_bf16_f32 v32, v128, v129
  v_cvt_pk_bf16_f32 v33, v130, v131
  v_cvt_pk_bf16_f32 v34, v136, v137
  v_cvt_pk_bf16_f32 v35, v138, v139
  s_nop 1
  v_permlane16_swap_b32 v32, v34
  v_permlane16_swap_b32 v33, v35
  buffer_store_dwordx4 v[32:35], v12, s[44:47], 0 offen offset:0
  v_cvt_pk_bf16_f32 v36, v144, v145
  v_cvt_pk_bf16_f32 v37, v146, v147
  v_cvt_pk_bf16_f32 v38, v152, v153
  v_cvt_pk_bf16_f32 v39, v154, v155
  s_nop 1
  v_permlane16_swap_b32 v36, v38
  v_permlane16_swap_b32 v37, v39
  buffer_store_dwordx4 v[36:39], v12, s[44:47], 0 offen offset:64
  v_cvt_pk_bf16_f32 v40, v132, v133
  v_cvt_pk_bf16_f32 v41, v134, v135
  v_cvt_pk_bf16_f32 v42, v140, v141
  v_cvt_pk_bf16_f32 v43, v142, v143
  s_nop 1
  v_permlane16_swap_b32 v40, v42
  v_permlane16_swap_b32 v41, v43
  buffer_store_dwordx4 v[40:43], v12, s[44:47], s3 offen offset:0
  v_cvt_pk_bf16_f32 v44, v148, v149
  v_cvt_pk_bf16_f32 v45, v150, v151
  v_cvt_pk_bf16_f32 v46, v156, v157
  v_cvt_pk_bf16_f32 v47, v158, v159
  s_nop 1
  v_permlane16_swap_b32 v44, v46
  v_permlane16_swap_b32 v45, v47
  buffer_store_dwordx4 v[44:47], v12, s[44:47], s3 offen offset:64
  v_dot2_f32_bf16 v20, v32, s11, v20
  v_dot2_f32_bf16 v22, v32, v32, v22
  v_dot2_f32_bf16 v20, v33, s11, v20
  v_dot2_f32_bf16 v22, v33, v33, v22
  v_dot2_f32_bf16 v20, v34, s11, v20
  v_dot2_f32_bf16 v22, v34, v34, v22
  v_dot2_f32_bf16 v20, v35, s11, v20
  v_dot2_f32_bf16 v22, v35, v35, v22
  v_dot2_f32_bf16 v20, v36, s11, v20
  v_dot2_f32_bf16 v22, v36, v36, v22
  v_dot2_f32_bf16 v20, v37, s11, v20
  v_dot2_f32_bf16 v22, v37, v37, v22
  v_dot2_f32_bf16 v20, v38, s11, v20
  v_dot2_f32_bf16 v22, v38, v38, v22
  v_dot2_f32_bf16 v20, v39, s11, v20
  v_dot2_f32_bf16 v22, v39, v39, v22
  v_dot2_f32_bf16 v21, v40, s11, v21
  v_dot2_f32_bf16 v23, v40, v40, v23
  v_dot2_f32_bf16 v21, v41, s11, v21
  v_dot2_f32_bf16 v23, v41, v41, v23
  v_dot2_f32_bf16 v21, v42, s11, v21
  v_dot2_f32_bf16 v23, v42, v42, v23
  v_dot2_f32_bf16 v21, v43, s11, v21
  v_dot2_f32_bf16 v23, v43, v43, v23
  v_dot2_f32_bf16 v21, v44, s11, v21
  v_dot2_f32_bf16 v23, v44, v44, v23
  v_dot2_f32_bf16 v21, v45, s11, v21
  v_dot2_f32_bf16 v23, v45, v45, v23
  v_dot2_f32_bf16 v21, v46, s11, v21
  v_dot2_f32_bf16 v23, v46, v46, v23
  v_dot2_f32_bf16 v21, v47, s11, v21
  v_dot2_f32_bf16 v23, v47, v47, v23
  s_nop 2
  v_permlane32_swap_b32 v20, v21
  v_permlane32_swap_b32 v22, v23
  v_add_f32 v20, v20, v21
  v_add_f32 v22, v22, v23
  s_nop 1
  v_permlane16_swap_b32 v20, v22
  v_add_f32 v20, v20, v22
  buffer_store_dword v20, v18, s[56:59], 0 offen
  s_endpgm
L_wo_loader:
  s_add_u32 s8, s70, s69
  s_and_b32 s8, s8, 3
  s_add_u32 s9, s70, s68
  s_and_b32 s9, s9, 3
  s_lshl_b32 s76, s8, 12
  s_lshl_b32 s77, s9, 11
  s_add_u32 s77, s77, 16384
  v_lshrrev_b32 v3, 3, v1
  s_lshl_b32 s10, s8, 5
  s_lshl_b32 s11, s68, 7
  s_add_u32 s10, s10, s11
  v_add_u32 v3, s10, v3
  v_mul_u32_u24 v3, 2048, v3
  v_lshrrev_b32 v2, 4, v1
  v_and_b32 v10, 7, v1
  v_xor_b32 v4, v2, v10
  v_lshl_add_u32 v4, v4, 4, v3
  v_add_u32 v3, 16384, v3
  v_add_u32 v5, 4, v2
  v_xor_b32 v5, v5, v10
  v_lshl_add_u32 v5, v5, 4, v3
  v_add_u32 v3, 16384, v3
  v_xor_b32 v6, v2, v10
  v_lshl_add_u32 v6, v6, 4, v3
  v_add_u32 v3, 16384, v3
  v_add_u32 v7, 4, v2
  v_xor_b32 v7, v7, v10
  v_lshl_add_u32 v7, v7, 4, v3
  v_lshrrev_b32 v3, 3, v1
  s_lshl_b32 s10, s9, 4
  v_add_u32 v3, s10, v3
  v_mul_u32_u24 v3, 2048, v3
  v_lshrrev_b32 v2, 3, v1
  v_and_b32 v2, 2, v2
  v_xor_b32 v2, v2, v10
  s_mul_i32 s10, s69, 128
  v_add_u32 v3, s10, v3
  v_lshl_add_u32 v8, v2, 4, v3
  v_xor_b32 v2, 4, v2
  v_add_u32 v3, 16384, v3
  v_lshl_add_u32 v9, v2, 4, v3
  s_mov_b32 s75, 0
  s_add_u32 s100, s68, s69
  s_mov_b32 s101, -1
  s_add_u32 s101, s101, 1
  s_lshr_b32 s73, s101, 1
  s_xor_b32 s73, s73, s100
  s_and_b32 s73, s73, 3
  s_cselect_b32 s73, 14, 6
  s_add_u32 s73, s73, s101
  s_and_b32 s73, s73, 15
  s_mul_i32 s74, s73, 131072
  s_lshl_b32 s73, s73, 7
  s_waitcnt lgkmcnt(0)
  s_mov_b32 s36, s34
  s_and_b32 s37, s35, 0xffff
  s_mov_b32 s38, 4194304
  s_mov_b32 s39, 0x00020000
  s_mov_b32 s40, s20
  s_and_b32 s41, s21, 0xffff
  s_mov_b32 s42, 2097152
  s_mov_b32 s43, 0x00020000
  s_add_u32 s3, s75, s76
  s_add_u32 m0, s3, 0
  s_nop 0
  buffer_load_dwordx4 v4, s[36:39], s73 offen lds
  s_add_u32 m0, s3, 1024
  s_nop 0
  buffer_load_dwordx4 v5, s[36:39], s73 offen lds
  s_add_u32 m0, s3, 2048
  s_nop 0
  buffer_load_dwordx4 v6, s[36:39], s73 offen lds
  s_add_u32 m0, s3, 3072
  s_nop 0
  buffer_load_dwordx4 v7, s[36:39], s73 offen lds
  s_add_u32 s3, s75, s77
  s_add_u32 m0, s3, 0
  s_add_u32 s4, s74, 0
  buffer_load_dwordx4 v8, s[40:43], s4 offen lds
  s_add_u32 m0, s3, 1024
  s_nop 0
  buffer_load_dwordx4 v9, s[40:43], s4 offen lds
  s_add_u32 s101, s101, 1
  s_lshr_b32 s73, s101, 1
  s_xor_b32 s73, s73, s100
  s_and_b32 s73, s73, 3
  s_cselect_b32 s73, 14, 6
  s_add_u32 s73, s73, s101
  s_and_b32 s73, s73, 15
  s_mul_i32 s74, s73, 131072
  s_lshl_b32 s73, s73, 7
  s_add_u32 s75, s75, 24576
  s_cmp_eq_u32 s75, 147456
  s_cselect_b32 s75, 0, s75
  s_add_u32 s3, s75, s76
  s_add_u32 m0, s3, 0
  s_nop 0
  buffer_load_dwordx4 v4, s[36:39], s73 offen lds
  s_add_u32 m0, s3, 1024
  s_nop 0
  buffer_load_dwordx4 v5, s[36:39], s73 offen lds
  s_add_u32 m0, s3, 2048
  s_nop 0
  buffer_load_dwordx4 v6, s[36:39], s73 offen lds
  s_add_u32 m0, s3, 3072
  s_nop 0
  buffer_load_dwordx4 v7, s[36:39], s73 offen lds
  s_add_u32 s3, s75, s77
  s_add_u32 m0, s3, 0
  s_add_u32 s4, s74, 0
  buffer_load_dwordx4 v8, s[40:43], s4 offen lds
  s_add_u32 m0, s3, 1024
  s_nop 0
  buffer_load_dwordx4 v9, s[40:43], s4 offen lds
  s_add_u32 s101, s101, 1
  s_lshr_b32 s73, s101, 1
  s_xor_b32 s73, s73, s100
  s_and_b32 s73, s73, 3
  s_cselect_b32 s73, 14, 6
  s_add_u32 s73, s73, s101
  s_and_b32 s73, s73, 15
  s_mul_i32 s74, s73, 131072
  s_lshl_b32 s73, s73, 7
  s_add_u32 s75, s75, 24576
  s_cmp_eq_u32 s75, 147456
  s_cselect_b32 s75, 0, s75
  s_waitcnt vmcnt(6)
  s_barrier
  s_add_u32 s3, s75, s76
  s_add_u32 m0, s3, 0
  s_nop 0
  buffer_load_dwordx4 v4, s[36:39], s73 offen lds
  s_add_u32 m0, s3, 1024
  s_nop 0
  buffer_load_dwordx4 v5, s[36:39], s73 offen lds
  s_add_u32 m0, s3, 2048
  s_nop 0
  buffer_load_dwordx4 v6, s[36:39], s73 offen lds
  s_add_u32 m0, s3, 3072
  s_nop 0
  buffer_load_dwordx4 v7, s[36:39], s73 offen lds
  s_add_u32 s3, s75, s77
  s_add_u32 m0, s3, 0
  s_add_u32 s4, s74, 0
  buffer_load_dwordx4 v8, s[40:43], s4 offen lds
  s_add_u32 m0, s3, 1024
  s_nop 0
  buffer_load_dwordx4 v9, s[40:43], s4 offen lds
  s_add_u32 s101, s101, 1
  s_lshr_b32 s73, s101, 1
  s_xor_b32 s73, s73, s100
  s_and_b32 s73, s73, 3
  s_cselect_b32 s73, 14, 6
  s_add_u32 s73, s73, s101
  s_and_b32 s73, s73, 15
  s_mul_i32 s74, s73, 131072
  s_lshl_b32 s73, s73, 7
  s_add_u32 s75, s75, 24576
  s_cmp_eq_u32 s75, 147456
  s_cselect_b32 s75, 0, s75
  s_add_u32 s3, s75, s76
  s_add_u32 m0, s3, 0
  s_nop 0
  buffer_load_dwordx4 v4, s[36:39], s73 offen lds
  s_add_u32 m0, s3, 1024
  s_nop 0
  buffer_load_dwordx4 v5, s[36:39], s73 offen lds
  s_add_u32 m0, s3, 2048
  s_nop 0
  buffer_load_dwordx4 v6, s[36:39], s73 offen lds
  s_add_u32 m0, s3, 3072
  s_nop 0
  buffer_load_dwordx4 v7, s[36:39], s73 offen lds
  s_add_u32 s3, s75, s77
  s_add_u32 m0, s3, 0
  s_add_u32 s4, s74, 0
  buffer_load_dwordx4 v8, s[40:43], s4 offen lds
  s_add_u32 m0, s3, 1024
  s_nop 0
  buffer_load_dwordx4 v9, s[40:43], s4 offen lds
  s_add_u32 s101, s101, 1
  s_lshr_b32 s73, s101, 1
  s_xor_b32 s73, s73, s100
  s_and_b32 s73, s73, 3
  s_cselect_b32 s73, 14, 6
  s_add_u32 s73, s73, s101
  s_and_b32 s73, s73, 15
  s_mul_i32 s74, s73, 131072
  s_lshl_b32 s73, s73, 7
  s_add_u32 s75, s75, 24576
  s_cmp_eq_u32 s75, 147456
  s_cselect_b32 s75, 0, s75
  s_add_u32 s3, s75, s76
  s_add_u32 m0, s3, 0
  s_nop 0
  buffer_load_dwordx4 v4, s[36:39], s73 offen lds
  s_add_u32 m0, s3, 1024
  s_nop 0
  buffer_load_dwordx4 v5, s[36:39], s73 offen lds
  s_add_u32 m0, s3, 2048
  s_nop 0
  buffer_load_dwordx4 v6, s[36:39], s73 offen lds
  s_add_u32 m0, s3, 3072
  s_nop 0
  buffer_load_dwordx4 v7, s[36:39], s73 offen lds
  s_add_u32 s3, s75, s77
  s_add_u32 m0, s3, 0
  s_add_u32 s4, s74, 0
  buffer_load_dwordx4 v8, s[40:43], s4 offen lds
  s_add_u32 m0, s3, 1024
  s_nop 0
  buffer_load_dwordx4 v9, s[40:43], s4 offen lds
  s_add_u32 s101, s101, 1
  s_lshr_b32 s73, s101, 1
  s_xor_b32 s73, s73, s100
  s_and_b32 s73, s73, 3
  s_cselect_b32 s73, 14, 6
  s_add_u32 s73, s73, s101
  s_and_b32 s73, s73, 15
  s_mul_i32 s74, s73, 131072
  s_lshl_b32 s73, s73, 7
  s_add_u32 s75, s75, 24576
  s_cmp_eq_u32 s75, 147456
  s_cselect_b32 s75, 0, s75
  s_mov_b32 s79, 10
L_wol_ld:
  s_add_u32 s3, s75, s76
  s_add_u32 m0, s3, 0
  s_nop 0
  buffer_load_dwordx4 v4, s[36:39], s73 offen lds
  s_add_u32 m0, s3, 1024
  s_nop 0
  buffer_load_dwordx4 v5, s[36:39], s73 offen lds
  s_add_u32 m0, s3, 2048
  s_nop 0
  buffer_load_dwordx4 v6, s[36:39], s73 offen lds
  s_add_u32 m0, s3, 3072
  s_nop 0
  buffer_load_dwordx4 v7, s[36:39], s73 offen lds
  s_add_u32 s3, s75, s77
  s_add_u32 m0, s3, 0
  s_add_u32 s4, s74, 0
  buffer_load_dwordx4 v8, s[40:43], s4 offen lds
  s_add_u32 m0, s3, 1024
  s_nop 0
  buffer_load_dwordx4 v9, s[40:43], s4 offen lds
  s_add_u32 s101, s101, 1
  s_lshr_b32 s73, s101, 1
  s_xor_b32 s73, s73, s100
  s_and_b32 s73, s73, 3
  s_cselect_b32 s73, 14, 6
  s_add_u32 s73, s73, s101
  s_and_b32 s73, s73, 15
  s_mul_i32 s74, s73, 131072
  s_lshl_b32 s73, s73, 7
  s_add_u32 s75, s75, 24576
  s_cmp_eq_u32 s75, 147456
  s_cselect_b32 s75, 0, s75
  s_waitcnt vmcnt(24)
  s_barrier
  s_sub_u32 s79, s79, 1
  s_cmp_lg_u32 s79, 0
  s_cbranch_scc1 L_wol_ld
  s_add_u32 s3, s75, s76
  s_add_u32 m0, s3, 0
  s_nop 0
  buffer_load_dwordx4 v4, s[36:39], s73 offen lds
  s_add_u32 m0, s3, 1024
  s_nop 0
  buffer_load_dwordx4 v5, s[36:39], s73 offen lds
  s_add_u32 m0, s3, 2048
  s_nop 0
  buffer_load_dwordx4 v6, s[36:39], s73 offen lds
  s_add_u32 m0, s3, 3072
  s_nop 0
  buffer_load_dwordx4 v7, s[36:39], s73 offen lds
  s_add_u32 s3, s75, s77
  s_add_u32 m0, s3, 0
  s_add_u32 s4, s74, 0
  buffer_load_dwordx4 v8, s[40:43], s4 offen lds
  s_add_u32 m0, s3, 1024
  s_nop 0
  buffer_load_dwordx4 v9, s[40:43], s4 offen lds
  s_add_u32 s101, s101, 1
  s_lshr_b32 s73, s101, 1
  s_xor_b32 s73, s73, s100
  s_and_b32 s73, s73, 3
  s_cselect_b32 s73, 14, 6
  s_add_u32 s73, s73, s101
  s_and_b32 s73, s73, 15
  s_mul_i32 s74, s73, 131072
  s_lshl_b32 s73, s73, 7
  s_add_u32 s75, s75, 24576
  s_cmp_eq_u32 s75, 147456
  s_cselect_b32 s75, 0, s75
  s_mov_b32 s60, s24
  s_and_b32 s61, s25, 0xffff
  s_mov_b32 s62, 7340032
  s_mov_b32 s63, 0x00020000
  s_and_b32 s3, s70, 3
  s_mul_i32 s3, s3, 8
  s_mul_i32 s4, s99, 32
  s_add_u32 s3, s3, s4
  v_lshrrev_b32 v2, 4, v1
  v_add_u32 v2, s3, v2
  v_mul_u32_u24 v2, 7168, v2
  v_and_b32 v3, 15, v1
  v_min_u32 v3, 13, v3
  v_lshl_add_u32 v2, v3, 7, v2
  s_and_b32 s3, s2, 7
  s_lshr_b32 s3, s3, 1
  s_mul_i32 s3, s3, 1792
  buffer_load_dword v96, v2, s[60:63], s3 offen
  s_add_u32 s3, s3, 28672
  buffer_load_dword v97, v2, s[60:63], s3 offen
  s_getpc_b64 s[4:5]
L_pfc4:
  s_add_u32 s4, s4, L_w1_c0-L_pfc4
  s_addc_u32 s5, s5, 0
  s_and_b32 s3, s70, 3
  s_lshl_b32 s3, s3, 13
  v_lshl_add_u32 v2, v1, 7, s3
  v_min_u32 v2, L_w1_c1-L_w1_c0-4, v2
  global_load_dword v104, v2, s[4:5]
  s_waitcnt vmcnt(27)
  s_barrier
  s_waitcnt vmcnt(21)
  s_barrier
  s_waitcnt vmcnt(15)
  s_barrier
  s_waitcnt vmcnt(9)
  s_barrier
  s_waitcnt vmcnt(3)
  s_barrier
  s_barrier
L_wo_side:
  s_waitcnt vmcnt(0)
L_wo_end:
  s_endpgm
.section .rodata,"a"
.p2align 6
.amdhsa_kernel wol0_kernel
  .amdhsa_next_free_vgpr 256
  .amdhsa_next_free_sgpr 102
  .amdhsa_accum_offset 256
  .amdhsa_group_segment_fixed_size 0
  .amdhsa_kernarg_size 88
  .amdhsa_user_sgpr_count 2
  .amdhsa_user_sgpr_kernarg_segment_ptr 1
  .amdhsa_system_sgpr_workgroup_id_x 1
  .amdhsa_float_denorm_mode_32 3
  .amdhsa_float_denorm_mode_16_64 3
.end_amdhsa_kernel
.text
.text
.globl wol1_kernel
.p2align 8
.type wol1_kernel,@function
wol1_kernel:
  s_load_dwordx16 s[16:31], s[0:1], 0
  s_load_dwordx2 s[32:33], s[0:1], 64
  s_load_dwordx2 s[34:35], s[0:1], 80
  s_load_dwordx2 s[12:13], s[0:1], 64
  s_mov_b32 s96, 1
  s_branch L_wo_body
L_wo_c1:
.section .rodata,"a"
.p2align 6
.amdhsa_kernel wol1_kernel
  .amdhsa_next_free_vgpr 256
  .amdhsa_next_free_sgpr 102
  .amdhsa_accum_offset 256
  .amdhsa_group_segment_fixed_size 0
  .amdhsa_kernarg_size 88
  .amdhsa_user_sgpr_count 2
  .amdhsa_user_sgpr_kernarg_segment_ptr 1
  .amdhsa_system_sgpr_workgroup_id_x 1
  .amdhsa_float_denorm_mode_32 3
  .amdhsa_float_denorm_mode_16_64 3
.end_amdhsa_kernel
.text
L_w1_c0:
.text
.globl w1l0_kernel
.p2align 8
.type w1l0_kernel,@function
w1l0_kernel:
  s_load_dwordx16 s[16:31], s[0:1], 0
  s_load_dwordx2 s[32:33], s[0:1], 64
  s_load_dwordx2 s[34:35], s[0:1], 80
  s_load_dwordx2 s[12:13], s[0:1], 0
  s_mov_b32 s96, 0
L_w1_body:
  s_cmp_ge_u32 s2, 256
  s_cbranch_scc1 L_w1_end
  v_lshrrev_b32 v2, 6, v0
  v_and_b32 v1, 63, v0
  v_readfirstlane_b32 s70, v2
  s_and_b32 s3, s2, 7
  s_lshr_b32 s99, s2, 3
  s_and_b32 s5, s3, 1
  s_lshl_b32 s5, s5, 3
  s_and_b32 s6, s99, 7
  s_add_u32 s68, s5, s6
  s_lshr_b32 s5, s3, 1
  s_lshl_b32 s5, s5, 2
  s_lshr_b32 s6, s99, 3
  s_add_u32 s69, s5, s6
  s_cmp_ge_u32 s70, 4
  s_cbranch_scc1 L_w1_loader
  s_and_b32 s71, s70, 1
  s_lshr_b32 s72, s70, 1
  v_and_b32 v3, 15, v1
  v_lshrrev_b32 v2, 4, v1
  v_lshrrev_b32 v17, 1, v3
  s_lshl_b32 s8, s71, 13
  v_xor_b32 v4, v2, v17
  v_lshlrev_b32 v4, 4, v4
  v_lshl_add_u32 v4, v3, 7, v4
  v_add_u32 v4, s8, v4
  v_add_u32 v5, 4, v2
  v_xor_b32 v5, v5, v17
  v_lshlrev_b32 v5, 4, v5
  v_lshl_add_u32 v5, v3, 7, v5
  v_add_u32 v5, s8, v5
  v_bfe_u32 v13, v1, 2, 2
  v_lshl_add_u32 v13, v2, 3, v13
  v_lshlrev_b32 v13, 7, v13
  v_and_b32 v17, 3, v1
  v_lshl_add_u32 v13, v17, 3, v13
  v_bfe_u32 v17, v1, 3, 2
  v_lshl_add_u32 v13, v17, 5, v13
  s_and_b32 s8, s69, 1
  s_lshl_b32 s8, s8, 1
  s_mul_i32 s9, s72, 7
  s_add_u32 s8, s8, s9
  s_add_u32 s9, s8, 0
  s_and_b32 s10, s9, 3
  s_lshl_b32 s10, s10, 5
  s_lshr_b32 s9, s9, 2
  s_lshl_b32 s9, s9, 13
  s_add_u32 s9, s9, 16384
  v_xor_b32 v6, s10, v13
  v_add_u32 v6, s9, v6
  s_add_u32 s9, s8, 1
  s_and_b32 s10, s9, 3
  s_lshl_b32 s10, s10, 5
  s_lshr_b32 s9, s9, 2
  s_lshl_b32 s9, s9, 13
  s_add_u32 s9, s9, 16384
  v_xor_b32 v7, s10, v13
  v_add_u32 v7, s9, v7
  s_add_u32 s9, s8, 2
  s_and_b32 s10, s9, 3
  s_lshl_b32 s10, s10, 5
  s_lshr_b32 s9, s9, 2
  s_lshl_b32 s9, s9, 13
  s_add_u32 s9, s9, 16384
  v_xor_b32 v8, s10, v13
  v_add_u32 v8, s9, v8
  s_add_u32 s9, s8, 3
  s_and_b32 s10, s9, 3
  s_lshl_b32 s10, s10, 5
  s_lshr_b32 s9, s9, 2
  s_lshl_b32 s9, s9, 13
  s_add_u32 s9, s9, 16384
  v_xor_b32 v9, s10, v13
  v_add_u32 v9, s9, v9
  s_lshl_b32 s8, s68, 7
  s_lshl_b32 s9, s71, 6
  s_add_u32 s8, s8, s9
  v_add_u32 v13, s8, v3
  s_mul_i32 s10, s69, 448
  s_mul_i32 s9, s72, 224
  s_add_u32 s10, s10, s9
  v_and_b32 v16, 1, v2
  v_lshrrev_b32 v17, 1, v2
  v_mul_u32_u24 v14, 7168, v13
  v_lshl_add_u32 v14, v17, 4, v14
  v_add_u32 v14, s10, v14
  v_lshl_add_u32 v12, v16, 5, v14
  v_mul_u32_u24 v16, 114688, v16
  v_add_u32 v13, v16, v14
  s_lshl_b32 s9, s71, 8
  s_add_u32 s9, s9, 147520
  v_lshl_add_u32 v14, v3, 2, s9
  s_mul_i32 s9, s72, 448
  s_add_u32 s9, s9, 148736
  v_lshl_add_u32 v15, v2, 4, s9
  v_mov_b32 v128, 0
  v_mov_b32 v129, 0
  v_mov_b32 v130, 0
  v_mov_b32 v131, 0
  v_mov_b32 v132, 0
  v_mov_b32 v133, 0
  v_mov_b32 v134, 0
  v_mov_b32 v135, 0
  v_mov_b32 v136, 0
  v_mov_b32 v137, 0
  v_mov_b32 v138, 0
  v_mov_b32 v139, 0
  v_mov_b32 v140, 0
  v_mov_b32 v141, 0
  v_mov_b32 v142, 0
  v_mov_b32 v143, 0
  v_mov_b32 v144, 0
  v_mov_b32 v145, 0
  v_mov_b32 v146, 0
  v_mov_b32 v147, 0
  v_mov_b32 v148, 0
  v_mov_b32 v149, 0
  v_mov_b32 v150, 0
  v_mov_b32 v151, 0
  v_mov_b32 v152, 0
  v_mov_b32 v153, 0
  v_mov_b32 v154, 0
  v_mov_b32 v155, 0
  v_mov_b32 v156, 0
  v_mov_b32 v157, 0
  v_mov_b32 v158, 0
  v_mov_b32 v159, 0
  v_mov_b32 v160, 0
  v_mov_b32 v161, 0
  v_mov_b32 v162, 0
  v_mov_b32 v163, 0
  v_mov_b32 v164, 0
  v_mov_b32 v165, 0
  v_mov_b32 v166, 0
  v_mov_b32 v167, 0
  v_mov_b32 v168, 0
  v_mov_b32 v169, 0
  v_mov_b32 v170, 0
  v_mov_b32 v171, 0
  v_mov_b32 v172, 0
  v_mov_b32 v173, 0
  v_mov_b32 v174, 0
  v_mov_b32 v175, 0
  v_mov_b32 v176, 0
  v_mov_b32 v177, 0
  v_mov_b32 v178, 0
  v_mov_b32 v179, 0
  v_mov_b32 v180, 0
  v_mov_b32 v181, 0
  v_mov_b32 v182, 0
  v_mov_b32 v183, 0
  v_mov_b32 v184, 0
  v_mov_b32 v185, 0
  v_mov_b32 v186, 0
  v_mov_b32 v187, 0
  v_mov_b32 v188, 0
  v_mov_b32 v189, 0
  v_mov_b32 v190, 0
  v_mov_b32 v191, 0
  v_mov_b32 v192, 0
  v_mov_b32 v193, 0
  v_mov_b32 v194, 0
  v_mov_b32 v195, 0
  v_mov_b32 v196, 0
  v_mov_b32 v197, 0
  v_mov_b32 v198, 0
  v_mov_b32 v199, 0
  v_mov_b32 v200, 0
  v_mov_b32 v201, 0
  v_mov_b32 v202, 0
  v_mov_b32 v203, 0
  v_mov_b32 v204, 0
  v_mov_b32 v205, 0
  v_mov_b32 v206, 0
  v_mov_b32 v207, 0
  v_mov_b32 v208, 0
  v_mov_b32 v209, 0
  v_mov_b32 v210, 0
  v_mov_b32 v211, 0
  v_mov_b32 v212, 0
  v_mov_b32 v213, 0
  v_mov_b32 v214, 0
  v_mov_b32 v215, 0
  v_mov_b32 v216, 0
  v_mov_b32 v217, 0
  v_mov_b32 v218, 0
  v_mov_b32 v219, 0
  v_mov_b32 v220, 0
  v_mov_b32 v221, 0
  v_mov_b32 v222, 0
  v_mov_b32 v223, 0
  v_mov_b32 v224, 0
  v_mov_b32 v225, 0
  v_mov_b32 v226, 0
  v_mov_b32 v227, 0
  v_mov_b32 v228, 0
  v_mov_b32 v229, 0
  v_mov_b32 v230, 0
  v_mov_b32 v231, 0
  v_mov_b32 v232, 0
  v_mov_b32 v233, 0
  v_mov_b32 v234, 0
  v_mov_b32 v235, 0
  v_mov_b32 v236, 0
  v_mov_b32 v237, 0
  v_mov_b32 v238, 0
  v_mov_b32 v239, 0
  s_waitcnt lgkmcnt(0)
  s_add_u32 s44, s34, 8388608
  s_addc_u32 s45, s35, 0
  s_and_b32 s45, s45, 0xffff
  s_mov_b32 s46, 14680064
  s_mov_b32 s47, 0x00020000
  s_mov_b32 s75, 0
  v_add_u32 v20, s75, v4
  v_add_u32 v21, s75, v5
  v_add_u32 v22, s75, v6
  v_add_u32 v23, s75, v7
  v_add_u32 v24, s75, v8
  v_add_u32 v25, s75, v9
  s_add_u32 s75, s75, 49152
  s_cmp_eq_u32 s75, 147456
  s_cselect_b32 s75, 0, s75
  s_mov_b32 s79, 16
  s_barrier
  ds_read_b128 v[32:35], v20 offset:0
  ds_read_b128 v[36:39], v20 offset:2048
  ds_read_b128 v[40:43], v20 offset:4096
  ds_read_b128 v[44:47], v20 offset:6144
  ds_read_b64_tr_b16 v[48:49], v22 offset:0
  ds_read_b64_tr_b16 v[50:51], v22 offset:512
  ds_read_b64_tr_b16 v[52:53], v23 offset:0
  ds_read_b64_tr_b16 v[54:55], v23 offset:512
  ds_read_b64_tr_b16 v[56:57], v24 offset:0
  ds_read_b64_tr_b16 v[58:59], v24 offset:512
  ds_read_b64_tr_b16 v[60:61], v25 offset:0
  ds_read_b64_tr_b16 v[62:63], v25 offset:512
  ds_read_b64_tr_b16 v[64:65], v22 offset:8192
  ds_read_b64_tr_b16 v[66:67], v22 offset:8704
  ds_read_b64_tr_b16 v[68:69], v23 offset:8192
  ds_read_b64_tr_b16 v[70:71], v23 offset:8704
  ds_read_b64_tr_b16 v[72:73], v24 offset:8192
  ds_read_b64_tr_b16 v[74:75], v24 offset:8704
  s_waitcnt lgkmcnt(0)
.p2align 3
L_w1_loop:
  v_mfma_f32_16x16x32_bf16 v[128:131], v[48:51], v[32:35], v[128:131]
  ds_read_b128 v[80:83], v21 offset:0
  v_mfma_f32_16x16x32_bf16 v[132:135], v[48:51], v[36:39], v[132:135]
  ds_read_b128 v[84:87], v21 offset:2048
  v_mfma_f32_16x16x32_bf16 v[136:139], v[48:51], v[40:43], v[136:139]
  ds_read_b128 v[88:91], v21 offset:4096
  v_mfma_f32_16x16x32_bf16 v[140:143], v[48:51], v[44:47], v[140:143]
  ds_read_b128 v[92:95], v21 offset:6144
  v_mfma_f32_16x16x32_bf16 v[144:147], v[52:55], v[32:35], v[144:147]
  ds_read_b64_tr_b16 v[96:97], v22 offset:4096
  v_mfma_f32_16x16x32_bf16 v[148:151], v[52:55], v[36:39], v[148:151]
  ds_read_b64_tr_b16 v[98:99], v22 offset:4608
  v_mfma_f32_16x16x32_bf16 v[152:155], v[52:55], v[40:43], v[152:155]
  ds_read_b64_tr_b16 v[100:101], v23 offset:4096
  v_mfma_f32_16x16x32_bf16 v[156:159], v[52:55], v[44:47], v[156:159]
  ds_read_b64_tr_b16 v[102:103], v23 offset:4608
  v_mfma_f32_16x16x32_bf16 v[160:163], v[56:59], v[32:35], v[160:163]
  ds_read_b64_tr_b16 v[104:105], v24 offset:4096
  v_mfma_f32_16x16x32_bf16 v[164:167], v[56:59], v[36:39], v[164:167]
  ds_read_b64_tr_b16 v[106:107], v24 offset:4608
  v_mfma_f32_16x16x32_bf16 v[168:171], v[56:59], v[40:43], v[168:171]
  ds_read_b64_tr_b16 v[108:109], v25 offset:4096
  v_mfma_f32_16x16x32_bf16 v[172:175], v[56:59], v[44:47], v[172:175]
  ds_read_b64_tr_b16 v[110:111], v25 offset:4608
  v_mfma_f32_16x16x32_bf16 v[176:179], v[60:63], v[32:35], v[176:179]
  ds_read_b64_tr_b16 v[112:113], v22 offset:12288
  v_mfma_f32_16x16x32_bf16 v[180:183], v[60:63], v[36:39], v[180:183]
  ds_read_b64_tr_b16 v[114:115], v22 offset:12800
  v_mfma_f32_16x16x32_bf16 v[184:187], v[60:63], v[40:43], v[184:187]
  ds_read_b64_tr_b16 v[116:117], v23 offset:12288
  v_mfma_f32_16x16x32_bf16 v[188:191], v[60:63], v[44:47], v[188:191]
  ds_read_b64_tr_b16 v[118:119], v23 offset:12800
  v_mfma_f32_16x16x32_bf16 v[192:195], v[64:67], v[32:35], v[192:195]
  ds_read_b64_tr_b16 v[120:121], v24 offset:12288
  v_mfma_f32_16x16x32_bf16 v[196:199], v[64:67], v[36:39], v[196:199]
  ds_read_b64_tr_b16 v[122:123], v24 offset:12800
  v_mfma_f32_16x16x32_bf16 v[200:203], v[64:67], v[40:43], v[200:203]
  v_add_u32 v20, s75, v4
  v_mfma_f32_16x16x32_bf16 v[204:207], v[64:67], v[44:47], v[204:207]
  v_add_u32 v21, s75, v5
  v_mfma_f32_16x16x32_bf16 v[208:211], v[68:71], v[32:35], v[208:211]
  v_add_u32 v22, s75, v6
  v_mfma_f32_16x16x32_bf16 v[212:215], v[68:71], v[36:39], v[212:215]
  v_add_u32 v23, s75, v7
  v_mfma_f32_16x16x32_bf16 v[216:219], v[68:71], v[40:43], v[216:219]
  v_add_u32 v24, s75, v8
  v_mfma_f32_16x16x32_bf16 v[220:223], v[68:71], v[44:47], v[220:223]
  v_add_u32 v25, s75, v9
  v_mfma_f32_16x16x32_bf16 v[224:227], v[72:75], v[32:35], v[224:227]
  s_add_u32 s75, s75, 49152
  v_mfma_f32_16x16x32_bf16 v[228:231], v[72:75], v[36:39], v[228:231]
  s_cmp_eq_u32 s75, 147456
  v_mfma_f32_16x16x32_bf16 v[232:235], v[72:75], v[40:43], v[232:235]
  s_cselect_b32 s75, 0, s75
  v_mfma_f32_16x16x32_bf16 v[236:239], v[72:75], v[44:47], v[236:239]
  s_waitcnt lgkmcnt(0)
  s_barrier
  v_mfma_f32_16x16x32_bf16 v[128:131], v[96:99], v[80:83], v[128:131]
  ds_read_b128 v[32:35], v20 offset:0
  v_mfma_f32_16x16x32_bf16 v[132:135], v[96:99], v[84:87], v[132:135]
  ds_read_b128 v[36:39], v20 offset:2048
  v_mfma_f32_16x16x32_bf16 v[136:139], v[96:99], v[88:91], v[136:139]
  ds_read_b128 v[40:43], v20 offset:4096
  v_mfma_f32_16x16x32_bf16 v[140:143], v[96:99], v[92:95], v[140:143]
  ds_read_b128 v[44:47], v20 offset:6144
  v_mfma_f32_16x16x32_bf16 v[144:147], v[100:103], v[80:83], v[144:147]
  ds_read_b64_tr_b16 v[48:49], v22 offset:0
  v_mfma_f32_16x16x32_bf16 v[148:151], v[100:103], v[84:87], v[148:151]
  ds_read_b64_tr_b16 v[50:51], v22 offset:512
  v_mfma_f32_16x16x32_bf16 v[152:155], v[100:103], v[88:91], v[152:155]
  ds_read_b64_tr_b16 v[52:53], v23 offset:0
  v_mfma_f32_16x16x32_bf16 v[156:159], v[100:103], v[92:95], v[156:159]
  ds_read_b64_tr_b16 v[54:55], v23 offset:512
  v_mfma_f32_16x16x32_bf16 v[160:163], v[104:107], v[80:83], v[160:163]
  ds_read_b64_tr_b16 v[56:57], v24 offset:0
  v_mfma_f32_16x16x32_bf16 v[164:167], v[104:107], v[84:87], v[164:167]
  ds_read_b64_tr_b16 v[58:59], v24 offset:512
  v_mfma_f32_16x16x32_bf16 v[168:171], v[104:107], v[88:91], v[168:171]
  ds_read_b64_tr_b16 v[60:61], v25 offset:0
  v_mfma_f32_16x16x32_bf16 v[172:175], v[104:107], v[92:95], v[172:175]
  ds_read_b64_tr_b16 v[62:63], v25 offset:512
  v_mfma_f32_16x16x32_bf16 v[176:179], v[108:111], v[80:83], v[176:179]
  ds_read_b64_tr_b16 v[64:65], v22 offset:8192
  v_mfma_f32_16x16x32_bf16 v[180:183], v[108:111], v[84:87], v[180:183]
  ds_read_b64_tr_b16 v[66:67], v22 offset:8704
  v_mfma_f32_16x16x32_bf16 v[184:187], v[108:111], v[88:91], v[184:187]
  ds_read_b64_tr_b16 v[68:69], v23 offset:8192
  v_mfma_f32_16x16x32_bf16 v[188:191], v[108:111], v[92:95], v[188:191]
  ds_read_b64_tr_b16 v[70:71], v23 offset:8704
  v_mfma_f32_16x16x32_bf16 v[192:195], v[112:115], v[80:83], v[192:195]
  ds_read_b64_tr_b16 v[72:73], v24 offset:8192
  v_mfma_f32_16x16x32_bf16 v[196:199], v[112:115], v[84:87], v[196:199]
  ds_read_b64_tr_b16 v[74:75], v24 offset:8704
  v_mfma_f32_16x16x32_bf16 v[200:203], v[112:115], v[88:91], v[200:203]
  s_sub_u32 s79, s79, 1
  v_mfma_f32_16x16x32_bf16 v[204:207], v[112:115], v[92:95], v[204:207]
  s_cmp_lg_u32 s79, 0
  v_mfma_f32_16x16x32_bf16 v[208:211], v[116:119], v[80:83], v[208:211]
  v_mfma_f32_16x16x32_bf16 v[212:215], v[116:119], v[84:87], v[212:215]
  v_mfma_f32_16x16x32_bf16 v[216:219], v[116:119], v[88:91], v[216:219]
  v_mfma_f32_16x16x32_bf16 v[220:223], v[116:119], v[92:95], v[220:223]
  v_mfma_f32_16x16x32_bf16 v[224:227], v[120:123], v[80:83], v[224:227]
  v_mfma_f32_16x16x32_bf16 v[228:231], v[120:123], v[84:87], v[228:231]
  v_mfma_f32_16x16x32_bf16 v[232:235], v[120:123], v[88:91], v[232:235]
  v_mfma_f32_16x16x32_bf16 v[236:239], v[120:123], v[92:95], v[236:239]
  s_waitcnt lgkmcnt(0)
  s_cbranch_scc1 L_w1_loop
  ds_read2_b32 v[88:89], v14 offset0:0 offset1:160
  ds_read2_b32 v[90:91], v14 offset0:16 offset1:176
  ds_read2_b32 v[92:93], v14 offset0:32 offset1:192
  ds_read2_b32 v[94:95], v14 offset0:48 offset1:208
  ds_read_b128 v[32:35], v15 offset:0
  ds_read_b128 v[60:63], v15 offset:1024
  ds_read_b128 v[36:39], v15 offset:64
  ds_read_b128 v[64:67], v15 offset:1088
  ds_read_b128 v[40:43], v15 offset:128
  ds_read_b128 v[68:71], v15 offset:1152
  ds_read_b128 v[44:47], v15 offset:192
  ds_read_b128 v[72:75], v15 offset:1216
  ds_read_b128 v[48:51], v15 offset:256
  ds_read_b128 v[76:79], v15 offset:1280
  ds_read_b128 v[52:55], v15 offset:320
  ds_read_b128 v[80:83], v15 offset:1344
  ds_read_b128 v[56:59], v15 offset:384
  ds_read_b128 v[84:87], v15 offset:1408
  v_mov_b32 v96, 0xc0135761
  v_mov_b32 v97, 0xbdd2d3e8
  v_mov_b32 v98, 1.0
  s_waitcnt lgkmcnt(0)
  v_mul_f32 v88, v88, v89
  v_mul_f32 v90, v90, v91
  v_mul_f32 v92, v92, v93
  v_mul_f32 v94, v94, v95
  v_pk_fma_f32 v[100:101], v[32:33], v[88:89], v[60:61] op_sel:[0,0,0] op_sel_hi:[1,0,1] neg_lo:[0,1,0] neg_hi:[0,1,0]
  v_pk_fma_f32 v[102:103], v[34:35], v[88:89], v[62:63] op_sel:[0,0,0] op_sel_hi:[1,0,1] neg_lo:[0,1,0] neg_hi:[0,1,0]
  v_pk_fma_f32 v[128:129], v[128:129], v[88:89], v[100:101] op_sel:[0,1,0] op_sel_hi:[1,1,1]
  v_pk_fma_f32 v[130:131], v[130:131], v[88:89], v[102:103] op_sel:[0,1,0] op_sel_hi:[1,1,1]
  v_pk_mul_f32 v[100:101], v[128:129], v[128:129]
  v_pk_mul_f32 v[102:103], v[130:131], v[130:131]
  v_pk_fma_f32 v[100:101], v[100:101], v[96:97], v[96:97] op_sel:[0,1,0] op_sel_hi:[1,1,0]
  v_pk_fma_f32 v[102:103], v[102:103], v[96:97], v[96:97] op_sel:[0,1,0] op_sel_hi:[1,1,0]
  v_pk_mul_f32 v[100:101], v[100:101], v[128:129]
  v_pk_mul_f32 v[102:103], v[102:103], v[130:131]
  v_exp_f32 v100, v100
  v_exp_f32 v101, v101
  v_exp_f32 v102, v102
  v_exp_f32 v103, v103
  v_pk_add_f32 v[100:101], v[100:101], v[98:99] op_sel_hi:[1,0]
  v_pk_add_f32 v[102:103], v[102:103], v[98:99] op_sel_hi:[1,0]
  v_rcp_f32 v100, v100
  v_rcp_f32 v101, v101
  v_rcp_f32 v102, v102
  v_rcp_f32 v103, v103
  v_pk_mul_f32 v[128:129], v[128:129], v[100:101]
  v_pk_mul_f32 v[130:131], v[130:131], v[102:103]
  v_cvt_pk_bf16_f32 v108, v128, v129
  v_cvt_pk_bf16_f32 v109, v130, v131
  v_pk_fma_f32 v[104:105], v[36:37], v[88:89], v[64:65] op_sel:[0,0,0] op_sel_hi:[1,0,1] neg_lo:[0,1,0] neg_hi:[0,1,0]
  v_pk_fma_f32 v[106:107], v[38:39], v[88:89], v[66:67] op_sel:[0,0,0] op_sel_hi:[1,0,1] neg_lo:[0,1,0] neg_hi:[0,1,0]
  v_pk_fma_f32 v[144:145], v[144:145], v[88:89], v[104:105] op_sel:[0,1,0] op_sel_hi:[1,1,1]
  v_pk_fma_f32 v[146:147], v[146:147], v[88:89], v[106:107] op_sel:[0,1,0] op_sel_hi:[1,1,1]
  v_pk_mul_f32 v[104:105], v[144:145], v[144:145]
  v_pk_mul_f32 v[106:107], v[146:147], v[146:147]
  v_pk_fma_f32 v[104:105], v[104:105], v[96:97], v[96:97] op_sel:[0,1,0] op_sel_hi:[1,1,0]
  v_pk_fma_f32 v[106:107], v[106:107], v[96:97], v[96:97] op_sel:[0,1,0] op_sel_hi:[1,1,0]
  v_pk_mul_f32 v[104:105], v[104:105], v[144:145]
  v_pk_mul_f32 v[106:107], v[106:107], v[146:147]
  v_exp_f32 v104, v104
  v_exp_f32 v105, v105
  v_exp_f32 v106, v106
  v_exp_f32 v107, v107
  v_pk_add_f32 v[104:105], v[104:105], v[98:99] op_sel_hi:[1,0]
  v_pk_add_f32 v[106:107], v[106:107], v[98:99] op_sel_hi:[1,0]
  v_rcp_f32 v104, v104
  v_rcp_f32 v105, v105
  v_rcp_f32 v106, v106
  v_rcp_f32 v107, v107
  v_pk_mul_f32 v[144:145], v[144:145], v[104:105]
  v_pk_mul_f32 v[146:147], v[146:147], v[106:107]
  v_cvt_pk_bf16_f32 v110, v144, v145
  v_cvt_pk_bf16_f32 v111, v146, v147
  s_mov_b32 s3, 0
  s_nop 0
  v_permlane16_swap_b32 v108, v110
  v_permlane16_swap_b32 v109, v111
  buffer_store_dwordx4 v[108:111], v12, s[44:47], s3 offen
  v_pk_fma_f32 v[100:101], v[40:41], v[88:89], v[68:69] op_sel:[0,0,0] op_sel_hi:[1,0,1] neg_lo:[0,1,0] neg_hi:[0,1,0]
  v_pk_fma_f32 v[102:103], v[42:43], v[88:89], v[70:71] op_sel:[0,0,0] op_sel_hi:[1,0,1] neg_lo:[0,1,0] neg_hi:[0,1,0]
  v_pk_fma_f32 v[160:161], v[160:161], v[88:89], v[100:101] op_sel:[0,1,0] op_sel_hi:[1,1,1]
  v_pk_fma_f32 v[162:163], v[162:163], v[88:89], v[102:103] op_sel:[0,1,0] op_sel_hi:[1,1,1]
  v_pk_mul_f32 v[100:101], v[160:161], v[160:161]
  v_pk_mul_f32 v[102:103], v[162:163], v[162:163]
  v_pk_fma_f32 v[100:101], v[100:101], v[96:97], v[96:97] op_sel:[0,1,0] op_sel_hi:[1,1,0]
  v_pk_fma_f32 v[102:103], v[102:103], v[96:97], v[96:97] op_sel:[0,1,0] op_sel_hi:[1,1,0]
  v_pk_mul_f32 v[100:101], v[100:101], v[160:161]
  v_pk_mul_f32 v[102:103], v[102:103], v[162:163]
  v_exp_f32 v100, v100
  v_exp_f32 v101, v101
  v_exp_f32 v102, v102
  v_exp_f32 v103, v103
  v_pk_add_f32 v[100:101], v[100:101], v[98:99] op_sel_hi:[1,0]
  v_pk_add_f32 v[102:103], v[102:103], v[98:99] op_sel_hi:[1,0]
  v_rcp_f32 v100, v100
  v_rcp_f32 v101, v101
  v_rcp_f32 v102, v102
  v_rcp_f32 v103, v103
  v_pk_mul_f32 v[160:161], v[160:161], v[100:101]
  v_pk_mul_f32 v[162:163], v[162:163], v[102:103]
  v_cvt_pk_bf16_f32 v112, v160, v161
  v_cvt_pk_bf16_f32 v113, v162, v163
  v_pk_fma_f32 v[104:105], v[44:45], v[88:89], v[72:73] op_sel:[0,0,0] op_sel_hi:[1,0,1] neg_lo:[0,1,0] neg_hi:[0,1,0]
  v_pk_fma_f32 v[106:107], v[46:47], v[88:89], v[74:75] op_sel:[0,0,0] op_sel_hi:[1,0,1] neg_lo:[0,1,0] neg_hi:[0,1,0]
  v_pk_fma_f32 v[176:177], v[176:177], v[88:89], v[104:105] op_sel:[0,1,0] op_sel_hi:[1,1,1]
  v_pk_fma_f32 v[178:179], v[178:179], v[88:89], v[106:107] op_sel:[0,1,0] op_sel_hi:[1,1,1]
  v_pk_mul_f32 v[104:105], v[176:177], v[176:177]
  v_pk_mul_f32 v[106:107], v[178:179], v[178:179]
  v_pk_fma_f32 v[104:105], v[104:105], v[96:97], v[96:97] op_sel:[0,1,0] op_sel_hi:[1,1,0]
  v_pk_fma_f32 v[106:107], v[106:107], v[96:97], v[96:97] op_sel:[0,1,0] op_sel_hi:[1,1,0]
  v_pk_mul_f32 v[104:105], v[104:105], v[176:177]
  v_pk_mul_f32 v[106:107], v[106:107], v[178:179]
  v_exp_f32 v104, v104
  v_exp_f32 v105, v105
  v_exp_f32 v106, v106
  v_exp_f32 v107, v107
  v_pk_add_f32 v[104:105], v[104:105], v[98:99] op_sel_hi:[1,0]
  v_pk_add_f32 v[106:107], v[106:107], v[98:99] op_sel_hi:[1,0]
  v_rcp_f32 v104, v104
  v_rcp_f32 v105, v105
  v_rcp_f32 v106, v106
  v_rcp_f32 v107, v107
  v_pk_mul_f32 v[176:177], v[176:177], v[104:105]
  v_pk_mul_f32 v[178:179], v[178:179], v[106:107]
  v_cvt_pk_bf16_f32 v114, v176, v177
  v_cvt_pk_bf16_f32 v115, v178, v179
  s_mov_b32 s3, 64
  s_nop 0
  v_permlane16_swap_b32 v112, v114
  v_permlane16_swap_b32 v113, v115
  buffer_store_dwordx4 v[112:115], v12, s[44:47], s3 offen
  v_pk_fma_f32 v[100:101], v[48:49], v[88:89], v[76:77] op_sel:[0,0,0] op_sel_hi:[1,0,1] neg_lo:[0,1,0] neg_hi:[0,1,0]
  v_pk_fma_f32 v[102:103], v[50:51], v[88:89], v[78:79] op_sel:[0,0,0] op_sel_hi:[1,0,1] neg_lo:[0,1,0] neg_hi:[0,1,0]
  v_pk_fma_f32 v[192:193], v[192:193], v[88:89], v[100:101] op_sel:[0,1,0] op_sel_hi:[1,1,1]
  v_pk_fma_f32 v[194:195], v[194:195], v[88:89], v[102:103] op_sel:[0,1,0] op_sel_hi:[1,1,1]
  v_pk_mul_f32 v[100:101], v[192:193], v[192:193]
  v_pk_mul_f32 v[102:103], v[194:195], v[194:195]
  v_pk_fma_f32 v[100:101], v[100:101], v[96:97], v[96:97] op_sel:[0,1,0] op_sel_hi:[1,1,0]
  v_pk_fma_f32 v[102:103], v[102:103], v[96:97], v[96:97] op_sel:[0,1,0] op_sel_hi:[1,1,0]
  v_pk_mul_f32 v[100:101], v[100:101], v[192:193]
  v_pk_mul_f32 v[102:103], v[102:103], v[194:195]
  v_exp_f32 v100, v100
  v_exp_f32 v101, v101
  v_exp_f32 v102, v102
  v_exp_f32 v103, v103
  v_pk_add_f32 v[100:101], v[100:101], v[98:99] op_sel_hi:[1,0]
  v_pk_add_f32 v[102:103], v[102:103], v[98:99] op_sel_hi:[1,0]
  v_rcp_f32 v100, v100
  v_rcp_f32 v101, v101
  v_rcp_f32 v102, v102
  v_rcp_f32 v103, v103
  v_pk_mul_f32 v[192:193], v[192:193], v[100:101]
  v_pk_mul_f32 v[194:195], v[194:195], v[102:103]
  v_cvt_pk_bf16_f32 v116, v192, v193
  v_cvt_pk_bf16_f32 v117, v194, v195
  v_pk_fma_f32 v[104:105], v[52:53], v[88:89], v[80:81] op_sel:[0,0,0] op_sel_hi:[1,0,1] neg_lo:[0,1,0] neg_hi:[0,1,0]
  v_pk_fma_f32 v[106:107], v[54:55], v[88:89], v[82:83] op_sel:[0,0,0] op_sel_hi:[1,0,1] neg_lo:[0,1,0] neg_hi:[0,1,0]
  v_pk_fma_f32 v[208:209], v[208:209], v[88:89], v[104:105] op_sel:[0,1,0] op_sel_hi:[1,1,1]
  v_pk_fma_f32 v[210:211], v[210:211], v[88:89], v[106:107] op_sel:[0,1,0] op_sel_hi:[1,1,1]
  v_pk_mul_f32 v[104:105], v[208:209], v[208:209]
  v_pk_mul_f32 v[106:107], v[210:211], v[210:211]
  v_pk_fma_f32 v[104:105], v[104:105], v[96:97], v[96:97] op_sel:[0,1,0] op_sel_hi:[1,1,0]
  v_pk_fma_f32 v[106:107], v[106:107], v[96:97], v[96:97] op_sel:[0,1,0] op_sel_hi:[1,1,0]
  v_pk_mul_f32 v[104:105], v[104:105], v[208:209]
  v_pk_mul_f32 v[106:107], v[106:107], v[210:211]
  v_exp_f32 v104, v104
  v_exp_f32 v105, v105
  v_exp_f32 v106, v106
  v_exp_f32 v107, v107
  v_pk_add_f32 v[104:105], v[104:105], v[98:99] op_sel_hi:[1,0]
  v_pk_add_f32 v[106:107], v[106:107], v[98:99] op_sel_hi:[1,0]
  v_rcp_f32 v104, v104
  v_rcp_f32 v105, v105
  v_rcp_f32 v106, v106
  v_rcp_f32 v107, v107
  v_pk_mul_f32 v[208:209], v[208:209], v[104:105]
  v_pk_mul_f32 v[210:211], v[210:211], v[106:107]
  v_cvt_pk_bf16_f32 v118, v208, v209
  v_cvt_pk_bf16_f32 v119, v210, v211
  s_mov_b32 s3, 128
  s_nop 0
  v_permlane16_swap_b32 v116, v118
  v_permlane16_swap_b32 v117, v119
  buffer_store_dwordx4 v[116:119], v12, s[44:47], s3 offen
  v_pk_fma_f32 v[100:101], v[32:33], v[90:91], v[60:61] op_sel:[0,0,0] op_sel_hi:[1,0,1] neg_lo:[0,1,0] neg_hi:[0,1,0]
  v_pk_fma_f32 v[102:103], v[34:35], v[90:91], v[62:63] op_sel:[0,0,0] op_sel_hi:[1,0,1] neg_lo:[0,1,0] neg_hi:[0,1,0]
  v_pk_fma_f32 v[132:133], v[132:133], v[90:91], v[100:101] op_sel:[0,1,0] op_sel_hi:[1,1,1]
  v_pk_fma_f32 v[134:135], v[134:135], v[90:91], v[102:103] op_sel:[0,1,0] op_sel_hi:[1,1,1]
  v_pk_mul_f32 v[100:101], v[132:133], v[132:133]
  v_pk_mul_f32 v[102:103], v[134:135], v[134:135]
  v_pk_fma_f32 v[100:101], v[100:101], v[96:97], v[96:97] op_sel:[0,1,0] op_sel_hi:[1,1,0]
  v_pk_fma_f32 v[102:103], v[102:103], v[96:97], v[96:97] op_sel:[0,1,0] op_sel_hi:[1,1,0]
  v_pk_mul_f32 v[100:101], v[100:101], v[132:133]
  v_pk_mul_f32 v[102:103], v[102:103], v[134:135]
  v_exp_f32 v100, v100
  v_exp_f32 v101, v101
  v_exp_f32 v102, v102
  v_exp_f32 v103, v103
  v_pk_add_f32 v[100:101], v[100:101], v[98:99] op_sel_hi:[1,0]
  v_pk_add_f32 v[102:103], v[102:103], v[98:99] op_sel_hi:[1,0]
  v_rcp_f32 v100, v100
  v_rcp_f32 v101, v101
  v_rcp_f32 v102, v102
  v_rcp_f32 v103, v103
  v_pk_mul_f32 v[132:133], v[132:133], v[100:101]
  v_pk_mul_f32 v[134:135], v[134:135], v[102:103]
  v_cvt_pk_bf16_f32 v120, v132, v133
  v_cvt_pk_bf16_f32 v121, v134, v135
  v_pk_fma_f32 v[104:105], v[36:37], v[90:91], v[64:65] op_sel:[0,0,0] op_sel_hi:[1,0,1] neg_lo:[0,1,0] neg_hi:[0,1,0]
  v_pk_fma_f32 v[106:107], v[38:39], v[90:91], v[66:67] op_sel:[0,0,0] op_sel_hi:[1,0,1] neg_lo:[0,1,0] neg_hi:[0,1,0]
  v_pk_fma_f32 v[148:149], v[148:149], v[90:91], v[104:105] op_sel:[0,1,0] op_sel_hi:[1,1,1]
  v_pk_fma_f32 v[150:151], v[150:151], v[90:91], v[106:107] op_sel:[0,1,0] op_sel_hi:[1,1,1]
  v_pk_mul_f32 v[104:105], v[148:149], v[148:149]
  v_pk_mul_f32 v[106:107], v[150:151], v[150:151]
  v_pk_fma_f32 v[104:105], v[104:105], v[96:97], v[96:97] op_sel:[0,1,0] op_sel_hi:[1,1,0]
  v_pk_fma_f32 v[106:107], v[106:107], v[96:97], v[96:97] op_sel:[0,1,0] op_sel_hi:[1,1,0]
  v_pk_mul_f32 v[104:105], v[104:105], v[148:149]
  v_pk_mul_f32 v[106:107], v[106:107], v[150:151]
  v_exp_f32 v104, v104
  v_exp_f32 v105, v105
  v_exp_f32 v106, v106
  v_exp_f32 v107, v107
  v_pk_add_f32 v[104:105], v[104:105], v[98:99] op_sel_hi:[1,0]
  v_pk_add_f32 v[106:107], v[106:107], v[98:99] op_sel_hi:[1,0]
  v_rcp_f32 v104, v104
  v_rcp_f32 v105, v105
  v_rcp_f32 v106, v106
  v_rcp_f32 v107, v107
  v_pk_mul_f32 v[148:149], v[148:149], v[104:105]
  v_pk_mul_f32 v[150:151], v[150:151], v[106:107]
  v_cvt_pk_bf16_f32 v122, v148, v149
  v_cvt_pk_bf16_f32 v123, v150, v151
  s_mov_b32 s3, 114688
  s_nop 0
  v_permlane16_swap_b32 v120, v122
  v_permlane16_swap_b32 v121, v123
  buffer_store_dwordx4 v[120:123], v12, s[44:47], s3 offen
  v_pk_fma_f32 v[100:101], v[40:41], v[90:91], v[68:69] op_sel:[0,0,0] op_sel_hi:[1,0,1] neg_lo:[0,1,0] neg_hi:[0,1,0]
  v_pk_fma_f32 v[102:103], v[42:43], v[90:91], v[70:71] op_sel:[0,0,0] op_sel_hi:[1,0,1] neg_lo:[0,1,0] neg_hi:[0,1,0]
  v_pk_fma_f32 v[164:165], v[164:165], v[90:91], v[100:101] op_sel:[0,1,0] op_sel_hi:[1,1,1]
  v_pk_fma_f32 v[166:167], v[166:167], v[90:91], v[102:103] op_sel:[0,1,0] op_sel_hi:[1,1,1]
  v_pk_mul_f32 v[100:101], v[164:165], v[164:165]
  v_pk_mul_f32 v[102:103], v[166:167], v[166:167]
  v_pk_fma_f32 v[100:101], v[100:101], v[96:97], v[96:97] op_sel:[0,1,0] op_sel_hi:[1,1,0]
  v_pk_fma_f32 v[102:103], v[102:103], v[96:97], v[96:97] op_sel:[0,1,0] op_sel_hi:[1,1,0]
  v_pk_mul_f32 v[100:101], v[100:101], v[164:165]
  v_pk_mul_f32 v[102:103], v[102:103], v[166:167]
  v_exp_f32 v100, v100
  v_exp_f32 v101, v101
  v_exp_f32 v102, v102
  v_exp_f32 v103, v103
  v_pk_add_f32 v[100:101], v[100:101], v[98:99] op_sel_hi:[1,0]
  v_pk_add_f32 v[102:103], v[102:103], v[98:99] op_sel_hi:[1,0]
  v_rcp_f32 v100, v100
  v_rcp_f32 v101, v101
  v_rcp_f32 v102, v102
  v_rcp_f32 v103, v103
  v_pk_mul_f32 v[164:165], v[164:165], v[100:101]
  v_pk_mul_f32 v[166:167], v[166:167], v[102:103]
  v_cvt_pk_bf16_f32 v108, v164, v165
  v_cvt_pk_bf16_f32 v109, v166, v167
  v_pk_fma_f32 v[104:105], v[44:45], v[90:91], v[72:73] op_sel:[0,0,0] op_sel_hi:[1,0,1] neg_lo:[0,1,0] neg_hi:[0,1,0]
  v_pk_fma_f32 v[106:107], v[46:47], v[90:91], v[74:75] op_sel:[0,0,0] op_sel_hi:[1,0,1] neg_lo:[0,1,0] neg_hi:[0,1,0]
  v_pk_fma_f32 v[180:181], v[180:181], v[90:91], v[104:105] op_sel:[0,1,0] op_sel_hi:[1,1,1]
  v_pk_fma_f32 v[182:183], v[182:183], v[90:91], v[106:107] op_sel:[0,1,0] op_sel_hi:[1,1,1]
  v_pk_mul_f32 v[104:105], v[180:181], v[180:181]
  v_pk_mul_f32 v[106:107], v[182:183], v[182:183]
  v_pk_fma_f32 v[104:105], v[104:105], v[96:97], v[96:97] op_sel:[0,1,0] op_sel_hi:[1,1,0]
  v_pk_fma_f32 v[106:107], v[106:107], v[96:97], v[96:97] op_sel:[0,1,0] op_sel_hi:[1,1,0]
  v_pk_mul_f32 v[104:105], v[104:105], v[180:181]
  v_pk_mul_f32 v[106:107], v[106:107], v[182:183]
  v_exp_f32 v104, v104
  v_exp_f32 v105, v105
  v_exp_f32 v106, v106
  v_exp_f32 v107, v107
  v_pk_add_f32 v[104:105], v[104:105], v[98:99] op_sel_hi:[1,0]
  v_pk_add_f32 v[106:107], v[106:107], v[98:99] op_sel_hi:[1,0]
  v_rcp_f32 v104, v104
  v_rcp_f32 v105, v105
  v_rcp_f32 v106, v106
  v_rcp_f32 v107, v107
  v_pk_mul_f32 v[180:181], v[180:181], v[104:105]
  v_pk_mul_f32 v[182:183], v[182:183], v[106:107]
  v_cvt_pk_bf16_f32 v110, v180, v181
  v_cvt_pk_bf16_f32 v111, v182, v183
  s_mov_b32 s3, 114752
  s_nop 0
  v_permlane16_swap_b32 v108, v110
  v_permlane16_swap_b32 v109, v111
  buffer_store_dwordx4 v[108:111], v12, s[44:47], s3 offen
  v_pk_fma_f32 v[100:101], v[48:49], v[90:91], v[76:77] op_sel:[0,0,0] op_sel_hi:[1,0,1] neg_lo:[0,1,0] neg_hi:[0,1,0]
  v_pk_fma_f32 v[102:103], v[50:51], v[90:91], v[78:79] op_sel:[0,0,0] op_sel_hi:[1,0,1] neg_lo:[0,1,0] neg_hi:[0,1,0]
  v_pk_fma_f32 v[196:197], v[196:197], v[90:91], v[100:101] op_sel:[0,1,0] op_sel_hi:[1,1,1]
  v_pk_fma_f32 v[198:199], v[198:199], v[90:91], v[102:103] op_sel:[0,1,0] op_sel_hi:[1,1,1]
  v_pk_mul_f32 v[100:101], v[196:197], v[196:197]
  v_pk_mul_f32 v[102:103], v[198:199], v[198:199]
  v_pk_fma_f32 v[100:101], v[100:101], v[96:97], v[96:97] op_sel:[0,1,0] op_sel_hi:[1,1,0]
  v_pk_fma_f32 v[102:103], v[102:103], v[96:97], v[96:97] op_sel:[0,1,0] op_sel_hi:[1,1,0]
  v_pk_mul_f32 v[100:101], v[100:101], v[196:197]
  v_pk_mul_f32 v[102:103], v[102:103], v[198:199]
  v_exp_f32 v100, v100
  v_exp_f32 v101, v101
  v_exp_f32 v102, v102
  v_exp_f32 v103, v103
  v_pk_add_f32 v[100:101], v[100:101], v[98:99] op_sel_hi:[1,0]
  v_pk_add_f32 v[102:103], v[102:103], v[98:99] op_sel_hi:[1,0]
  v_rcp_f32 v100, v100
  v_rcp_f32 v101, v101
  v_rcp_f32 v102, v102
  v_rcp_f32 v103, v103
  v_pk_mul_f32 v[196:197], v[196:197], v[100:101]
  v_pk_mul_f32 v[198:199], v[198:199], v[102:103]
  v_cvt_pk_bf16_f32 v112, v196, v197
  v_cvt_pk_bf16_f32 v113, v198, v199
  v_pk_fma_f32 v[104:105], v[52:53], v[90:91], v[80:81] op_sel:[0,0,0] op_sel_hi:[1,0,1] neg_lo:[0,1,0] neg_hi:[0,1,0]
  v_pk_fma_f32 v[106:107], v[54:55], v[90:91], v[82:83] op_sel:[0,0,0] op_sel_hi:[1,0,1] neg_lo:[0,1,0] neg_hi:[0,1,0]
  v_pk_fma_f32 v[212:213], v[212:213], v[90:91], v[104:105] op_sel:[0,1,0] op_sel_hi:[1,1,1]
  v_pk_fma_f32 v[214:215], v[214:215], v[90:91], v[106:107] op_sel:[0,1,0] op_sel_hi:[1,1,1]
  v_pk_mul_f32 v[104:105], v[212:213], v[212:213]
  v_pk_mul_f32 v[106:107], v[214:215], v[214:215]
  v_pk_fma_f32 v[104:105], v[104:105], v[96:97], v[96:97] op_sel:[0,1,0] op_sel_hi:[1,1,0]
  v_pk_fma_f32 v[106:107], v[106:107], v[96:97], v[96:97] op_sel:[0,1,0] op_sel_hi:[1,1,0]
  v_pk_mul_f32 v[104:105], v[104:105], v[212:213]
  v_pk_mul_f32 v[106:107], v[106:107], v[214:215]
  v_exp_f32 v104, v104
  v_exp_f32 v105, v105
  v_exp_f32 v106, v106
  v_exp_f32 v107, v107
  v_pk_add_f32 v[104:105], v[104:105], v[98:99] op_sel_hi:[1,0]
  v_pk_add_f32 v[106:107], v[106:107], v[98:99] op_sel_hi:[1,0]
  v_rcp_f32 v104, v104
  v_rcp_f32 v105, v105
  v_rcp_f32 v106, v106
  v_rcp_f32 v107, v107
  v_pk_mul_f32 v[212:213], v[212:213], v[104:105]
  v_pk_mul_f32 v[214:215], v[214:215], v[106:107]
  v_cvt_pk_bf16_f32 v114, v212, v213
  v_cvt_pk_bf16_f32 v115, v214, v215
  s_mov_b32 s3, 114816
  s_nop 0
  v_permlane16_swap_b32 v112, v114
  v_permlane16_swap_b32 v113, v115
  buffer_store_dwordx4 v[112:115], v12, s[44:47], s3 offen
  v_pk_fma_f32 v[100:101], v[56:57], v[88:89], v[84:85] op_sel:[0,0,0] op_sel_hi:[1,0,1] neg_lo:[0,1,0] neg_hi:[0,1,0]
  v_pk_fma_f32 v[102:103], v[58:59], v[88:89], v[86:87] op_sel:[0,0,0] op_sel_hi:[1,0,1] neg_lo:[0,1,0] neg_hi:[0,1,0]
  v_pk_fma_f32 v[224:225], v[224:225], v[88:89], v[100:101] op_sel:[0,1,0] op_sel_hi:[1,1,1]
  v_pk_fma_f32 v[226:227], v[226:227], v[88:89], v[102:103] op_sel:[0,1,0] op_sel_hi:[1,1,1]
  v_pk_mul_f32 v[100:101], v[224:225], v[224:225]
  v_pk_mul_f32 v[102:103], v[226:227], v[226:227]
  v_pk_fma_f32 v[100:101], v[100:101], v[96:97], v[96:97] op_sel:[0,1,0] op_sel_hi:[1,1,0]
  v_pk_fma_f32 v[102:103], v[102:103], v[96:97], v[96:97] op_sel:[0,1,0] op_sel_hi:[1,1,0]
  v_pk_mul_f32 v[100:101], v[100:101], v[224:225]
  v_pk_mul_f32 v[102:103], v[102:103], v[226:227]
  v_exp_f32 v100, v100
  v_exp_f32 v101, v101
  v_exp_f32 v102, v102
  v_exp_f32 v103, v103
  v_pk_add_f32 v[100:101], v[100:101], v[98:99] op_sel_hi:[1,0]
  v_pk_add_f32 v[102:103], v[102:103], v[98:99] op_sel_hi:[1,0]
  v_rcp_f32 v100, v100
  v_rcp_f32 v101, v101
  v_rcp_f32 v102, v102
  v_rcp_f32 v103, v103
  v_pk_mul_f32 v[224:225], v[224:225], v[100:101]
  v_pk_mul_f32 v[226:227], v[226:227], v[102:103]
  v_cvt_pk_bf16_f32 v116, v224, v225
  v_cvt_pk_bf16_f32 v117, v226, v227
  v_pk_fma_f32 v[100:101], v[56:57], v[90:91], v[84:85] op_sel:[0,0,0] op_sel_hi:[1,0,1] neg_lo:[0,1,0] neg_hi:[0,1,0]
  v_pk_fma_f32 v[102:103], v[58:59], v[90:91], v[86:87] op_sel:[0,0,0] op_sel_hi:[1,0,1] neg_lo:[0,1,0] neg_hi:[0,1,0]
  v_pk_fma_f32 v[228:229], v[228:229], v[90:91], v[100:101] op_sel:[0,1,0] op_sel_hi:[1,1,1]
  v_pk_fma_f32 v[230:231], v[230:231], v[90:91], v[102:103] op_sel:[0,1,0] op_sel_hi:[1,1,1]
  v_pk_mul_f32 v[100:101], v[228:229], v[228:229]
  v_pk_mul_f32 v[102:103], v[230:231], v[230:231]
  v_pk_fma_f32 v[100:101], v[100:101], v[96:97], v[96:97] op_sel:[0,1,0] op_sel_hi:[1,1,0]
  v_pk_fma_f32 v[102:103], v[102:103], v[96:97], v[96:97] op_sel:[0,1,0] op_sel_hi:[1,1,0]
  v_pk_mul_f32 v[100:101], v[100:101], v[228:229]
  v_pk_mul_f32 v[102:103], v[102:103], v[230:231]
  v_exp_f32 v100, v100
  v_exp_f32 v101, v101
  v_exp_f32 v102, v102
  v_exp_f32 v103, v103
  v_pk_add_f32 v[100:101], v[100:101], v[98:99] op_sel_hi:[1,0]
  v_pk_add_f32 v[102:103], v[102:103], v[98:99] op_sel_hi:[1,0]
  v_rcp_f32 v100, v100
  v_rcp_f32 v101, v101
  v_rcp_f32 v102, v102
  v_rcp_f32 v103, v103
  v_pk_mul_f32 v[228:229], v[228:229], v[100:101]
  v_pk_mul_f32 v[230:231], v[230:231], v[102:103]
  v_cvt_pk_bf16_f32 v118, v228, v229
  v_cvt_pk_bf16_f32 v119, v230, v231
  s_mov_b32 s3, 192
  s_nop 0
  v_permlane16_swap_b32 v116, v118
  v_permlane16_swap_b32 v117, v119
  buffer_store_dwordx4 v[116:119], v13, s[44:47], s3 offen
  v_pk_fma_f32 v[100:101], v[32:33], v[92:93], v[60:61] op_sel:[0,0,0] op_sel_hi:[1,0,1] neg_lo:[0,1,0] neg_hi:[0,1,0]
  v_pk_fma_f32 v[102:103], v[34:35], v[92:93], v[62:63] op_sel:[0,0,0] op_sel_hi:[1,0,1] neg_lo:[0,1,0] neg_hi:[0,1,0]
  v_pk_fma_f32 v[136:137], v[136:137], v[92:93], v[100:101] op_sel:[0,1,0] op_sel_hi:[1,1,1]
  v_pk_fma_f32 v[138:139], v[138:139], v[92:93], v[102:103] op_sel:[0,1,0] op_sel_hi:[1,1,1]
  v_pk_mul_f32 v[100:101], v[136:137], v[136:137]
  v_pk_mul_f32 v[102:103], v[138:139], v[138:139]
  v_pk_fma_f32 v[100:101], v[100:101], v[96:97], v[96:97] op_sel:[0,1,0] op_sel_hi:[1,1,0]
  v_pk_fma_f32 v[102:103], v[102:103], v[96:97], v[96:97] op_sel:[0,1,0] op_sel_hi:[1,1,0]
  v_pk_mul_f32 v[100:101], v[100:101], v[136:137]
  v_pk_mul_f32 v[102:103], v[102:103], v[138:139]
  v_exp_f32 v100, v100
  v_exp_f32 v101, v101
  v_exp_f32 v102, v102
  v_exp_f32 v103, v103
  v_pk_add_f32 v[100:101], v[100:101], v[98:99] op_sel_hi:[1,0]
  v_pk_add_f32 v[102:103], v[102:103], v[98:99] op_sel_hi:[1,0]
  v_rcp_f32 v100, v100
  v_rcp_f32 v101, v101
  v_rcp_f32 v102, v102
  v_rcp_f32 v103, v103
  v_pk_mul_f32 v[136:137], v[136:137], v[100:101]
  v_pk_mul_f32 v[138:139], v[138:139], v[102:103]
  v_cvt_pk_bf16_f32 v120, v136, v137
  v_cvt_pk_bf16_f32 v121, v138, v139
  v_pk_fma_f32 v[104:105], v[36:37], v[92:93], v[64:65] op_sel:[0,0,0] op_sel_hi:[1,0,1] neg_lo:[0,1,0] neg_hi:[0,1,0]
  v_pk_fma_f32 v[106:107], v[38:39], v[92:93], v[66:67] op_sel:[0,0,0] op_sel_hi:[1,0,1] neg_lo:[0,1,0] neg_hi:[0,1,0]
  v_pk_fma_f32 v[152:153], v[152:153], v[92:93], v[104:105] op_sel:[0,1,0] op_sel_hi:[1,1,1]
  v_pk_fma_f32 v[154:155], v[154:155], v[92:93], v[106:107] op_sel:[0,1,0] op_sel_hi:[1,1,1]
  v_pk_mul_f32 v[104:105], v[152:153], v[152:153]
  v_pk_mul_f32 v[106:107], v[154:155], v[154:155]
  v_pk_fma_f32 v[104:105], v[104:105], v[96:97], v[96:97] op_sel:[0,1,0] op_sel_hi:[1,1,0]
  v_pk_fma_f32 v[106:107], v[106:107], v[96:97], v[96:97] op_sel:[0,1,0] op_sel_hi:[1,1,0]
  v_pk_mul_f32 v[104:105], v[104:105], v[152:153]
  v_pk_mul_f32 v[106:107], v[106:107], v[154:155]
  v_exp_f32 v104, v104
  v_exp_f32 v105, v105
  v_exp_f32 v106, v106
  v_exp_f32 v107, v107
  v_pk_add_f32 v[104:105], v[104:105], v[98:99] op_sel_hi:[1,0]
  v_pk_add_f32 v[106:107], v[106:107], v[98:99] op_sel_hi:[1,0]
  v_rcp_f32 v104, v104
  v_rcp_f32 v105, v105
  v_rcp_f32 v106, v106
  v_rcp_f32 v107, v107
  v_pk_mul_f32 v[152:153], v[152:153], v[104:105]
  v_pk_mul_f32 v[154:155], v[154:155], v[106:107]
  v_cvt_pk_bf16_f32 v122, v152, v153
  v_cvt_pk_bf16_f32 v123, v154, v155
  s_mov_b32 s3, 229376
  s_nop 0
  v_permlane16_swap_b32 v120, v122
  v_permlane16_swap_b32 v121, v123
  buffer_store_dwordx4 v[120:123], v12, s[44:47], s3 offen
  v_pk_fma_f32 v[100:101], v[40:41], v[92:93], v[68:69] op_sel:[0,0,0] op_sel_hi:[1,0,1] neg_lo:[0,1,0] neg_hi:[0,1,0]
  v_pk_fma_f32 v[102:103], v[42:43], v[92:93], v[70:71] op_sel:[0,0,0] op_sel_hi:[1,0,1] neg_lo:[0,1,0] neg_hi:[0,1,0]
  v_pk_fma_f32 v[168:169], v[168:169], v[92:93], v[100:101] op_sel:[0,1,0] op_sel_hi:[1,1,1]
  v_pk_fma_f32 v[170:171], v[170:171], v[92:93], v[102:103] op_sel:[0,1,0] op_sel_hi:[1,1,1]
  v_pk_mul_f32 v[100:101], v[168:169], v[168:169]
  v_pk_mul_f32 v[102:103], v[170:171], v[170:171]
  v_pk_fma_f32 v[100:101], v[100:101], v[96:97], v[96:97] op_sel:[0,1,0] op_sel_hi:[1,1,0]
  v_pk_fma_f32 v[102:103], v[102:103], v[96:97], v[96:97] op_sel:[0,1,0] op_sel_hi:[1,1,0]
  v_pk_mul_f32 v[100:101], v[100:101], v[168:169]
  v_pk_mul_f32 v[102:103], v[102:103], v[170:171]
  v_exp_f32 v100, v100
  v_exp_f32 v101, v101
  v_exp_f32 v102, v102
  v_exp_f32 v103, v103
  v_pk_add_f32 v[100:101], v[100:101], v[98:99] op_sel_hi:[1,0]
  v_pk_add_f32 v[102:103], v[102:103], v[98:99] op_sel_hi:[1,0]
  v_rcp_f32 v100, v100
  v_rcp_f32 v101, v101
  v_rcp_f32 v102, v102
  v_rcp_f32 v103, v103
  v_pk_mul_f32 v[168:169], v[168:169], v[100:101]
  v_pk_mul_f32 v[170:171], v[170:171], v[102:103]
  v_cvt_pk_bf16_f32 v108, v168, v169
  v_cvt_pk_bf16_f32 v109, v170, v171
  v_pk_fma_f32 v[104:105], v[44:45], v[92:93], v[72:73] op_sel:[0,0,0] op_sel_hi:[1,0,1] neg_lo:[0,1,0] neg_hi:[0,1,0]
  v_pk_fma_f32 v[106:107], v[46:47], v[92:93], v[74:75] op_sel:[0,0,0] op_sel_hi:[1,0,1] neg_lo:[0,1,0] neg_hi:[0,1,0]
  v_pk_fma_f32 v[184:185], v[184:185], v[92:93], v[104:105] op_sel:[0,1,0] op_sel_hi:[1,1,1]
  v_pk_fma_f32 v[186:187], v[186:187], v[92:93], v[106:107] op_sel:[0,1,0] op_sel_hi:[1,1,1]
  v_pk_mul_f32 v[104:105], v[184:185], v[184:185]
  v_pk_mul_f32 v[106:107], v[186:187], v[186:187]
  v_pk_fma_f32 v[104:105], v[104:105], v[96:97], v[96:97] op_sel:[0,1,0] op_sel_hi:[1,1,0]
  v_pk_fma_f32 v[106:107], v[106:107], v[96:97], v[96:97] op_sel:[0,1,0] op_sel_hi:[1,1,0]
  v_pk_mul_f32 v[104:105], v[104:105], v[184:185]
  v_pk_mul_f32 v[106:107], v[106:107], v[186:187]
  v_exp_f32 v104, v104
  v_exp_f32 v105, v105
  v_exp_f32 v106, v106
  v_exp_f32 v107, v107
  v_pk_add_f32 v[104:105], v[104:105], v[98:99] op_sel_hi:[1,0]
  v_pk_add_f32 v[106:107], v[106:107], v[98:99] op_sel_hi:[1,0]
  v_rcp_f32 v104, v104
  v_rcp_f32 v105, v105
  v_rcp_f32 v106, v106
  v_rcp_f32 v107, v107
  v_pk_mul_f32 v[184:185], v[184:185], v[104:105]
  v_pk_mul_f32 v[186:187], v[186:187], v[106:107]
  v_cvt_pk_bf16_f32 v110, v184, v185
  v_cvt_pk_bf16_f32 v111, v186, v187
  s_mov_b32 s3, 229440
  s_nop 0
  v_permlane16_swap_b32 v108, v110
  v_permlane16_swap_b32 v109, v111
  buffer_store_dwordx4 v[108:111], v12, s[44:47], s3 offen
  v_pk_fma_f32 v[100:101], v[48:49], v[92:93], v[76:77] op_sel:[0,0,0] op_sel_hi:[1,0,1] neg_lo:[0,1,0] neg_hi:[0,1,0]
  v_pk_fma_f32 v[102:103], v[50:51], v[92:93], v[78:79] op_sel:[0,0,0] op_sel_hi:[1,0,1] neg_lo:[0,1,0] neg_hi:[0,1,0]
  v_pk_fma_f32 v[200:201], v[200:201], v[92:93], v[100:101] op_sel:[0,1,0] op_sel_hi:[1,1,1]
  v_pk_fma_f32 v[202:203], v[202:203], v[92:93], v[102:103] op_sel:[0,1,0] op_sel_hi:[1,1,1]
  v_pk_mul_f32 v[100:101], v[200:201], v[200:201]
  v_pk_mul_f32 v[102:103], v[202:203], v[202:203]
  v_pk_fma_f32 v[100:101], v[100:101], v[96:97], v[96:97] op_sel:[0,1,0] op_sel_hi:[1,1,0]
  v_pk_fma_f32 v[102:103], v[102:103], v[96:97], v[96:97] op_sel:[0,1,0] op_sel_hi:[1,1,0]
  v_pk_mul_f32 v[100:101], v[100:101], v[200:201]
  v_pk_mul_f32 v[102:103], v[102:103], v[202:203]
  v_exp_f32 v100, v100
  v_exp_f32 v101, v101
  v_exp_f32 v102, v102
  v_exp_f32 v103, v103
  v_pk_add_f32 v[100:101], v[100:101], v[98:99] op_sel_hi:[1,0]
  v_pk_add_f32 v[102:103], v[102:103], v[98:99] op_sel_hi:[1,0]
  v_rcp_f32 v100, v100
  v_rcp_f32 v101, v101
  v_rcp_f32 v102, v102
  v_rcp_f32 v103, v103
  v_pk_mul_f32 v[200:201], v[200:201], v[100:101]
  v_pk_mul_f32 v[202:203], v[202:203], v[102:103]
  v_cvt_pk_bf16_f32 v112, v200, v201
  v_cvt_pk_bf16_f32 v113, v202, v203
  v_pk_fma_f32 v[104:105], v[52:53], v[92:93], v[80:81] op_sel:[0,0,0] op_sel_hi:[1,0,1] neg_lo:[0,1,0] neg_hi:[0,1,0]
  v_pk_fma_f32 v[106:107], v[54:55], v[92:93], v[82:83] op_sel:[0,0,0] op_sel_hi:[1,0,1] neg_lo:[0,1,0] neg_hi:[0,1,0]
  v_pk_fma_f32 v[216:217], v[216:217], v[92:93], v[104:105] op_sel:[0,1,0] op_sel_hi:[1,1,1]
  v_pk_fma_f32 v[218:219], v[218:219], v[92:93], v[106:107] op_sel:[0,1,0] op_sel_hi:[1,1,1]
  v_pk_mul_f32 v[104:105], v[216:217], v[216:217]
  v_pk_mul_f32 v[106:107], v[218:219], v[218:219]
  v_pk_fma_f32 v[104:105], v[104:105], v[96:97], v[96:97] op_sel:[0,1,0] op_sel_hi:[1,1,0]
  v_pk_fma_f32 v[106:107], v[106:107], v[96:97], v[96:97] op_sel:[0,1,0] op_sel_hi:[1,1,0]
  v_pk_mul_f32 v[104:105], v[104:105], v[216:217]
  v_pk_mul_f32 v[106:107], v[106:107], v[218:219]
  v_exp_f32 v104, v104
  v_exp_f32 v105, v105
  v_exp_f32 v106, v106
  v_exp_f32 v107, v107
  v_pk_add_f32 v[104:105], v[104:105], v[98:99] op_sel_hi:[1,0]
  v_pk_add_f32 v[106:107], v[106:107], v[98:99] op_sel_hi:[1,0]
  v_rcp_f32 v104, v104
  v_rcp_f32 v105, v105
  v_rcp_f32 v106, v106
  v_rcp_f32 v107, v107
  v_pk_mul_f32 v[216:217], v[216:217], v[104:105]
  v_pk_mul_f32 v[218:219], v[218:219], v[106:107]
  v_cvt_pk_bf16_f32 v114, v216, v217
  v_cvt_pk_bf16_f32 v115, v218, v219
  s_mov_b32 s3, 229504
  s_nop 0
  v_permlane16_swap_b32 v112, v114
  v_permlane16_swap_b32 v113, v115
  buffer_store_dwordx4 v[112:115], v12, s[44:47], s3 offen
  v_pk_fma_f32 v[100:101], v[32:33], v[94:95], v[60:61] op_sel:[0,0,0] op_sel_hi:[1,0,1] neg_lo:[0,1,0] neg_hi:[0,1,0]
  v_pk_fma_f32 v[102:103], v[34:35], v[94:95], v[62:63] op_sel:[0,0,0] op_sel_hi:[1,0,1] neg_lo:[0,1,0] neg_hi:[0,1,0]
  v_pk_fma_f32 v[140:141], v[140:141], v[94:95], v[100:101] op_sel:[0,1,0] op_sel_hi:[1,1,1]
  v_pk_fma_f32 v[142:143], v[142:143], v[94:95], v[102:103] op_sel:[0,1,0] op_sel_hi:[1,1,1]
  v_pk_mul_f32 v[100:101], v[140:141], v[140:141]
  v_pk_mul_f32 v[102:103], v[142:143], v[142:143]
  v_pk_fma_f32 v[100:101], v[100:101], v[96:97], v[96:97] op_sel:[0,1,0] op_sel_hi:[1,1,0]
  v_pk_fma_f32 v[102:103], v[102:103], v[96:97], v[96:97] op_sel:[0,1,0] op_sel_hi:[1,1,0]
  v_pk_mul_f32 v[100:101], v[100:101], v[140:141]
  v_pk_mul_f32 v[102:103], v[102:103], v[142:143]
  v_exp_f32 v100, v100
  v_exp_f32 v101, v101
  v_exp_f32 v102, v102
  v_exp_f32 v103, v103
  v_pk_add_f32 v[100:101], v[100:101], v[98:99] op_sel_hi:[1,0]
  v_pk_add_f32 v[102:103], v[102:103], v[98:99] op_sel_hi:[1,0]
  v_rcp_f32 v100, v100
  v_rcp_f32 v101, v101
  v_rcp_f32 v102, v102
  v_rcp_f32 v103, v103
  v_pk_mul_f32 v[140:141], v[140:141], v[100:101]
  v_pk_mul_f32 v[142:143], v[142:143], v[102:103]
  v_cvt_pk_bf16_f32 v116, v140, v141
  v_cvt_pk_bf16_f32 v117, v142, v143
  v_pk_fma_f32 v[104:105], v[36:37], v[94:95], v[64:65] op_sel:[0,0,0] op_sel_hi:[1,0,1] neg_lo:[0,1,0] neg_hi:[0,1,0]
  v_pk_fma_f32 v[106:107], v[38:39], v[94:95], v[66:67] op_sel:[0,0,0] op_sel_hi:[1,0,1] neg_lo:[0,1,0] neg_hi:[0,1,0]
  v_pk_fma_f32 v[156:157], v[156:157], v[94:95], v[104:105] op_sel:[0,1,0] op_sel_hi:[1,1,1]
  v_pk_fma_f32 v[158:159], v[158:159], v[94:95], v[106:107] op_sel:[0,1,0] op_sel_hi:[1,1,1]
  v_pk_mul_f32 v[104:105], v[156:157], v[156:157]
  v_pk_mul_f32 v[106:107], v[158:159], v[158:159]
  v_pk_fma_f32 v[104:105], v[104:105], v[96:97], v[96:97] op_sel:[0,1,0] op_sel_hi:[1,1,0]
  v_pk_fma_f32 v[106:107], v[106:107], v[96:97], v[96:97] op_sel:[0,1,0] op_sel_hi:[1,1,0]
  v_pk_mul_f32 v[104:105], v[104:105], v[156:157]
  v_pk_mul_f32 v[106:107], v[106:107], v[158:159]
  v_exp_f32 v104, v104
  v_exp_f32 v105, v105
  v_exp_f32 v106, v106
  v_exp_f32 v107, v107
  v_pk_add_f32 v[104:105], v[104:105], v[98:99] op_sel_hi:[1,0]
  v_pk_add_f32 v[106:107], v[106:107], v[98:99] op_sel_hi:[1,0]
  v_rcp_f32 v104, v104
  v_rcp_f32 v105, v105
  v_rcp_f32 v106, v106
  v_rcp_f32 v107, v107
  v_pk_mul_f32 v[156:157], v[156:157], v[104:105]
  v_pk_mul_f32 v[158:159], v[158:159], v[106:107]
  v_cvt_pk_bf16_f32 v118, v156, v157
  v_cvt_pk_bf16_f32 v119, v158, v159
  s_mov_b32 s3, 344064
  s_nop 0
  v_permlane16_swap_b32 v116, v118
  v_permlane16_swap_b32 v117, v119
  buffer_store_dwordx4 v[116:119], v12, s[44:47], s3 offen
  v_pk_fma_f32 v[100:101], v[40:41], v[94:95], v[68:69] op_sel:[0,0,0] op_sel_hi:[1,0,1] neg_lo:[0,1,0] neg_hi:[0,1,0]
  v_pk_fma_f32 v[102:103], v[42:43], v[94:95], v[70:71] op_sel:[0,0,0] op_sel_hi:[1,0,1] neg_lo:[0,1,0] neg_hi:[0,1,0]
  v_pk_fma_f32 v[172:173], v[172:173], v[94:95], v[100:101] op_sel:[0,1,0] op_sel_hi:[1,1,1]
  v_pk_fma_f32 v[174:175], v[174:175], v[94:95], v[102:103] op_sel:[0,1,0] op_sel_hi:[1,1,1]
  v_pk_mul_f32 v[100:101], v[172:173], v[172:173]
  v_pk_mul_f32 v[102:103], v[174:175], v[174:175]
  v_pk_fma_f32 v[100:101], v[100:101], v[96:97], v[96:97] op_sel:[0,1,0] op_sel_hi:[1,1,0]
  v_pk_fma_f32 v[102:103], v[102:103], v[96:97], v[96:97] op_sel:[0,1,0] op_sel_hi:[1,1,0]
  v_pk_mul_f32 v[100:101], v[100:101], v[172:173]
  v_pk_mul_f32 v[102:103], v[102:103], v[174:175]
  v_exp_f32 v100, v100
  v_exp_f32 v101, v101
  v_exp_f32 v102, v102
  v_exp_f32 v103, v103
  v_pk_add_f32 v[100:101], v[100:101], v[98:99] op_sel_hi:[1,0]
  v_pk_add_f32 v[102:103], v[102:103], v[98:99] op_sel_hi:[1,0]
  v_rcp_f32 v100, v100
  v_rcp_f32 v101, v101
  v_rcp_f32 v102, v102
  v_rcp_f32 v103, v103
  v_pk_mul_f32 v[172:173], v[172:173], v[100:101]
  v_pk_mul_f32 v[174:175], v[174:175], v[102:103]
  v_cvt_pk_bf16_f32 v120, v172, v173
  v_cvt_pk_bf16_f32 v121, v174, v175
  v_pk_fma_f32 v[104:105], v[44:45], v[94:95], v[72:73] op_sel:[0,0,0] op_sel_hi:[1,0,1] neg_lo:[0,1,0] neg_hi:[0,1,0]
  v_pk_fma_f32 v[106:107], v[46:47], v[94:95], v[74:75] op_sel:[0,0,0] op_sel_hi:[1,0,1] neg_lo:[0,1,0] neg_hi:[0,1,0]
  v_pk_fma_f32 v[188:189], v[188:189], v[94:95], v[104:105] op_sel:[0,1,0] op_sel_hi:[1,1,1]
  v_pk_fma_f32 v[190:191], v[190:191], v[94:95], v[106:107] op_sel:[0,1,0] op_sel_hi:[1,1,1]
  v_pk_mul_f32 v[104:105], v[188:189], v[188:189]
  v_pk_mul_f32 v[106:107], v[190:191], v[190:191]
  v_pk_fma_f32 v[104:105], v[104:105], v[96:97], v[96:97] op_sel:[0,1,0] op_sel_hi:[1,1,0]
  v_pk_fma_f32 v[106:107], v[106:107], v[96:97], v[96:97] op_sel:[0,1,0] op_sel_hi:[1,1,0]
  v_pk_mul_f32 v[104:105], v[104:105], v[188:189]
  v_pk_mul_f32 v[106:107], v[106:107], v[190:191]
  v_exp_f32 v104, v104
  v_exp_f32 v105, v105
  v_exp_f32 v106, v106
  v_exp_f32 v107, v107
  v_pk_add_f32 v[104:105], v[104:105], v[98:99] op_sel_hi:[1,0]
  v_pk_add_f32 v[106:107], v[106:107], v[98:99] op_sel_hi:[1,0]
  v_rcp_f32 v104, v104
  v_rcp_f32 v105, v105
  v_rcp_f32 v106, v106
  v_rcp_f32 v107, v107
  v_pk_mul_f32 v[188:189], v[188:189], v[104:105]
  v_pk_mul_f32 v[190:191], v[190:191], v[106:107]
  v_cvt_pk_bf16_f32 v122, v188, v189
  v_cvt_pk_bf16_f32 v123, v190, v191
  s_mov_b32 s3, 344128
  s_nop 0
  v_permlane16_swap_b32 v120, v122
  v_permlane16_swap_b32 v121, v123
  buffer_store_dwordx4 v[120:123], v12, s[44:47], s3 offen
  v_pk_fma_f32 v[100:101], v[48:49], v[94:95], v[76:77] op_sel:[0,0,0] op_sel_hi:[1,0,1] neg_lo:[0,1,0] neg_hi:[0,1,0]
  v_pk_fma_f32 v[102:103], v[50:51], v[94:95], v[78:79] op_sel:[0,0,0] op_sel_hi:[1,0,1] neg_lo:[0,1,0] neg_hi:[0,1,0]
  v_pk_fma_f32 v[204:205], v[204:205], v[94:95], v[100:101] op_sel:[0,1,0] op_sel_hi:[1,1,1]
  v_pk_fma_f32 v[206:207], v[206:207], v[94:95], v[102:103] op_sel:[0,1,0] op_sel_hi:[1,1,1]
  v_pk_mul_f32 v[100:101], v[204:205], v[204:205]
  v_pk_mul_f32 v[102:103], v[206:207], v[206:207]
  v_pk_fma_f32 v[100:101], v[100:101], v[96:97], v[96:97] op_sel:[0,1,0] op_sel_hi:[1,1,0]
  v_pk_fma_f32 v[102:103], v[102:103], v[96:97], v[96:97] op_sel:[0,1,0] op_sel_hi:[1,1,0]
  v_pk_mul_f32 v[100:101], v[100:101], v[204:205]
  v_pk_mul_f32 v[102:103], v[102:103], v[206:207]
  v_exp_f32 v100, v100
  v_exp_f32 v101, v101
  v_exp_f32 v102, v102
  v_exp_f32 v103, v103
  v_pk_add_f32 v[100:101], v[100:101], v[98:99] op_sel_hi:[1,0]
  v_pk_add_f32 v[102:103], v[102:103], v[98:99] op_sel_hi:[1,0]
  v_rcp_f32 v100, v100
  v_rcp_f32 v101, v101
  v_rcp_f32 v102, v102
  v_rcp_f32 v103, v103
  v_pk_mul_f32 v[204:205], v[204:205], v[100:101]
  v_pk_mul_f32 v[206:207], v[206:207], v[102:103]
  v_cvt_pk_bf16_f32 v108, v204, v205
  v_cvt_pk_bf16_f32 v109, v206, v207
  v_pk_fma_f32 v[104:105], v[52:53], v[94:95], v[80:81] op_sel:[0,0,0] op_sel_hi:[1,0,1] neg_lo:[0,1,0] neg_hi:[0,1,0]
  v_pk_fma_f32 v[106:107], v[54:55], v[94:95], v[82:83] op_sel:[0,0,0] op_sel_hi:[1,0,1] neg_lo:[0,1,0] neg_hi:[0,1,0]
  v_pk_fma_f32 v[220:221], v[220:221], v[94:95], v[104:105] op_sel:[0,1,0] op_sel_hi:[1,1,1]
  v_pk_fma_f32 v[222:223], v[222:223], v[94:95], v[106:107] op_sel:[0,1,0] op_sel_hi:[1,1,1]
  v_pk_mul_f32 v[104:105], v[220:221], v[220:221]
  v_pk_mul_f32 v[106:107], v[222:223], v[222:223]
  v_pk_fma_f32 v[104:105], v[104:105], v[96:97], v[96:97] op_sel:[0,1,0] op_sel_hi:[1,1,0]
  v_pk_fma_f32 v[106:107], v[106:107], v[96:97], v[96:97] op_sel:[0,1,0] op_sel_hi:[1,1,0]
  v_pk_mul_f32 v[104:105], v[104:105], v[220:221]
  v_pk_mul_f32 v[106:107], v[106:107], v[222:223]
  v_exp_f32 v104, v104
  v_exp_f32 v105, v105
  v_exp_f32 v106, v106
  v_exp_f32 v107, v107
  v_pk_add_f32 v[104:105], v[104:105], v[98:99] op_sel_hi:[1,0]
  v_pk_add_f32 v[106:107], v[106:107], v[98:99] op_sel_hi:[1,0]
  v_rcp_f32 v104, v104
  v_rcp_f32 v105, v105
  v_rcp_f32 v106, v106
  v_rcp_f32 v107, v107
  v_pk_mul_f32 v[220:221], v[220:221], v[104:105]
  v_pk_mul_f32 v[222:223], v[222:223], v[106:107]
  v_cvt_pk_bf16_f32 v110, v220, v221
  v_cvt_pk_bf16_f32 v111, v222, v223
  s_mov_b32 s3, 344192
  s_nop 0
  v_permlane16_swap_b32 v108, v110
  v_permlane16_swap_b32 v109, v111
  buffer_store_dwordx4 v[108:111], v12, s[44:47], s3 offen
  v_pk_fma_f32 v[100:101], v[56:57], v[92:93], v[84:85] op_sel:[0,0,0] op_sel_hi:[1,0,1] neg_lo:[0,1,0] neg_hi:[0,1,0]
  v_pk_fma_f32 v[102:103], v[58:59], v[92:93], v[86:87] op_sel:[0,0,0] op_sel_hi:[1,0,1] neg_lo:[0,1,0] neg_hi:[0,1,0]
  v_pk_fma_f32 v[232:233], v[232:233], v[92:93], v[100:101] op_sel:[0,1,0] op_sel_hi:[1,1,1]
  v_pk_fma_f32 v[234:235], v[234:235], v[92:93], v[102:103] op_sel:[0,1,0] op_sel_hi:[1,1,1]
  v_pk_mul_f32 v[100:101], v[232:233], v[232:233]
  v_pk_mul_f32 v[102:103], v[234:235], v[234:235]
  v_pk_fma_f32 v[100:101], v[100:101], v[96:97], v[96:97] op_sel:[0,1,0] op_sel_hi:[1,1,0]
  v_pk_fma_f32 v[102:103], v[102:103], v[96:97], v[96:97] op_sel:[0,1,0] op_sel_hi:[1,1,0]
  v_pk_mul_f32 v[100:101], v[100:101], v[232:233]
  v_pk_mul_f32 v[102:103], v[102:103], v[234:235]
  v_exp_f32 v100, v100
  v_exp_f32 v101, v101
  v_exp_f32 v102, v102
  v_exp_f32 v103, v103
  v_pk_add_f32 v[100:101], v[100:101], v[98:99] op_sel_hi:[1,0]
  v_pk_add_f32 v[102:103], v[102:103], v[98:99] op_sel_hi:[1,0]
  v_rcp_f32 v100, v100
  v_rcp_f32 v101, v101
  v_rcp_f32 v102, v102
  v_rcp_f32 v103, v103
  v_pk_mul_f32 v[232:233], v[232:233], v[100:101]
  v_pk_mul_f32 v[234:235], v[234:235], v[102:103]
  v_cvt_pk_bf16_f32 v112, v232, v233
  v_cvt_pk_bf16_f32 v113, v234, v235
  v_pk_fma_f32 v[100:101], v[56:57], v[94:95], v[84:85] op_sel:[0,0,0] op_sel_hi:[1,0,1] neg_lo:[0,1,0] neg_hi:[0,1,0]
  v_pk_fma_f32 v[102:103], v[58:59], v[94:95], v[86:87] op_sel:[0,0,0] op_sel_hi:[1,0,1] neg_lo:[0,1,0] neg_hi:[0,1,0]
  v_pk_fma_f32 v[236:237], v[236:237], v[94:95], v[100:101] op_sel:[0,1,0] op_sel_hi:[1,1,1]
  v_pk_fma_f32 v[238:239], v[238:239], v[94:95], v[102:103] op_sel:[0,1,0] op_sel_hi:[1,1,1]
  v_pk_mul_f32 v[100:101], v[236:237], v[236:237]
  v_pk_mul_f32 v[102:103], v[238:239], v[238:239]
  v_pk_fma_f32 v[100:101], v[100:101], v[96:97], v[96:97] op_sel:[0,1,0] op_sel_hi:[1,1,0]
  v_pk_fma_f32 v[102:103], v[102:103], v[96:97], v[96:97] op_sel:[0,1,0] op_sel_hi:[1,1,0]
  v_pk_mul_f32 v[100:101], v[100:101], v[236:237]
  v_pk_mul_f32 v[102:103], v[102:103], v[238:239]
  v_exp_f32 v100, v100
  v_exp_f32 v101, v101
  v_exp_f32 v102, v102
  v_exp_f32 v103, v103
  v_pk_add_f32 v[100:101], v[100:101], v[98:99] op_sel_hi:[1,0]
  v_pk_add_f32 v[102:103], v[102:103], v[98:99] op_sel_hi:[1,0]
  v_rcp_f32 v100, v100
  v_rcp_f32 v101, v101
  v_rcp_f32 v102, v102
  v_rcp_f32 v103, v103
  v_pk_mul_f32 v[236:237], v[236:237], v[100:101]
  v_pk_mul_f32 v[238:239], v[238:239], v[102:103]
  v_cvt_pk_bf16_f32 v114, v236, v237
  v_cvt_pk_bf16_f32 v115, v238, v239
  s_mov_b32 s3, 229568
  s_nop 0
  v_permlane16_swap_b32 v112, v114
  v_permlane16_swap_b32 v113, v115
  buffer_store_dwordx4 v[112:115], v13, s[44:47], s3 offen
  s_endpgm
L_w1_loader:
  s_add_u32 s8, s70, s69
  s_and_b32 s8, s8, 3
  s_add_u32 s9, s70, s68
  s_and_b32 s9, s9, 3
  s_lshl_b32 s76, s8, 12
  s_lshl_b32 s77, s9, 11
  s_add_u32 s77, s77, 16384
  v_lshrrev_b32 v3, 3, v1
  s_lshl_b32 s10, s8, 5
  s_lshl_b32 s11, s68, 7
  s_add_u32 s10, s10, s11
  v_add_u32 v3, s10, v3
  v_mul_u32_u24 v3, 2048, v3
  v_lshrrev_b32 v2, 4, v1
  v_and_b32 v10, 7, v1
  v_xor_b32 v4, v2, v10
  v_lshl_add_u32 v4, v4, 4, v3
  v_add_u32 v3, 16384, v3
  v_add_u32 v5, 4, v2
  v_xor_b32 v5, v5, v10
  v_lshl_add_u32 v5, v5, 4, v3
  v_add_u32 v3, 16384, v3
  v_xor_b32 v6, v2, v10
  v_lshl_add_u32 v6, v6, 4, v3
  v_add_u32 v3, 16384, v3
  v_add_u32 v7, 4, v2
  v_xor_b32 v7, v7, v10
  v_lshl_add_u32 v7, v7, 4, v3
  v_lshrrev_b32 v3, 3, v1
  s_lshl_b32 s10, s9, 4
  v_add_u32 v3, s10, v3
  v_mul_u32_u24 v3, 7168, v3
  v_lshrrev_b32 v2, 3, v1
  v_and_b32 v2, 2, v2
  v_xor_b32 v2, v2, v10
  s_mul_i32 s10, s69, 448
  s_andn2_b32 s10, s10, 127
  v_add_u32 v3, s10, v3
  v_lshl_add_u32 v8, v2, 4, v3
  v_xor_b32 v2, 4, v2
  v_add_u32 v3, 57344, v3
  v_lshl_add_u32 v9, v2, 4, v3
  s_mov_b32 s75, 0
  s_add_u32 s100, s68, s69
  s_mov_b32 s101, -1
  s_add_u32 s101, s101, 1
  s_xor_b32 s73, s101, s100
  s_and_b32 s73, s73, 3
  s_cselect_b32 s73, 15, 3
  s_add_u32 s73, s73, s101
  s_and_b32 s73, s73, 15
  s_mul_i32 s74, s73, 458752
  s_lshl_b32 s73, s73, 7
  s_waitcnt lgkmcnt(0)
  s_add_u32 s36, s34, 4194304
  s_addc_u32 s37, s35, 0
  s_and_b32 s37, s37, 0xffff
  s_mov_b32 s38, 4194304
  s_mov_b32 s39, 0x00020000
  s_mov_b32 s40, s24
  s_and_b32 s41, s25, 0xffff
  s_mov_b32 s42, 7340032
  s_mov_b32 s43, 0x00020000
  s_add_u32 s56, s34, 24117248
  s_addc_u32 s57, s35, 0
  s_and_b32 s57, s57, 0xffff
  s_mov_b32 s58, 262144
  s_mov_b32 s59, 0x00020000
  s_add_u32 s64, s34, 24641536
  s_addc_u32 s65, s35, 0
  s_and_b32 s65, s65, 0xffff
  s_mov_b32 s66, 262144
  s_mov_b32 s67, 0x00020000
  s_mov_b32 s52, s26
  s_and_b32 s53, s27, 0xffff
  s_mov_b32 s54, 7168
  s_mov_b32 s55, 0x00020000
  s_add_u32 s3, s75, s76
  s_add_u32 m0, s3, 0
  s_nop 0
  buffer_load_dwordx4 v4, s[36:39], s73 offen lds
  s_add_u32 m0, s3, 1024
  s_nop 0
  buffer_load_dwordx4 v5, s[36:39], s73 offen lds
  s_add_u32 m0, s3, 2048
  s_nop 0
  buffer_load_dwordx4 v6, s[36:39], s73 offen lds
  s_add_u32 m0, s3, 3072
  s_nop 0
  buffer_load_dwordx4 v7, s[36:39], s73 offen lds
  s_add_u32 s3, s75, s77
  s_add_u32 m0, s3, 0
  s_add_u32 s4, s74, 0
  buffer_load_dwordx4 v8, s[40:43], s4 offen lds
  s_add_u32 m0, s3, 1024
  s_nop 0
  buffer_load_dwordx4 v9, s[40:43], s4 offen lds
  s_add_u32 m0, s3, 8192
  s_add_u32 s4, s74, 128
  buffer_load_dwordx4 v8, s[40:43], s4 offen lds
  s_add_u32 m0, s3, 9216
  s_nop 0
  buffer_load_dwordx4 v9, s[40:43], s4 offen lds
  s_add_u32 m0, s3, 16384
  s_add_u32 s4, s74, 256
  buffer_load_dwordx4 v8, s[40:43], s4 offen lds
  s_add_u32 m0, s3, 17408
  s_nop 0
  buffer_load_dwordx4 v9, s[40:43], s4 offen lds
  s_add_u32 m0, s3, 24576
  s_add_u32 s4, s74, 384
  buffer_load_dwordx4 v8, s[40:43], s4 offen lds
  s_add_u32 m0, s3, 25600
  s_nop 0
  buffer_load_dwordx4 v9, s[40:43], s4 offen lds
  s_add_u32 s101, s101, 1
  s_xor_b32 s73, s101, s100
  s_and_b32 s73, s73, 3
  s_cselect_b32 s73, 15, 3
  s_add_u32 s73, s73, s101
  s_and_b32 s73, s73, 15
  s_mul_i32 s74, s73, 458752
  s_lshl_b32 s73, s73, 7
  s_add_u32 s75, s75, 49152
  s_cmp_eq_u32 s75, 147456
  s_cselect_b32 s75, 0, s75
  s_add_u32 s3, s75, s76
  s_add_u32 m0, s3, 0
  s_nop 0
  buffer_load_dwordx4 v4, s[36:39], s73 offen lds
  s_add_u32 m0, s3, 1024
  s_nop 0
  buffer_load_dwordx4 v5, s[36:39], s73 offen lds
  s_add_u32 m0, s3, 2048
  s_nop 0
  buffer_load_dwordx4 v6, s[36:39], s73 offen lds
  s_add_u32 m0, s3, 3072
  s_nop 0
  buffer_load_dwordx4 v7, s[36:39], s73 offen lds
  s_add_u32 s3, s75, s77
  s_add_u32 m0, s3, 0
  s_add_u32 s4, s74, 0
  buffer_load_dwordx4 v8, s[40:43], s4 offen lds
  s_add_u32 m0, s3, 1024
  s_nop 0
  buffer_load_dwordx4 v9, s[40:43], s4 offen lds
  s_add_u32 m0, s3, 8192
  s_add_u32 s4, s74, 128
  buffer_load_dwordx4 v8, s[40:43], s4 offen lds
  s_add_u32 m0, s3, 9216
  s_nop 0
  buffer_load_dwordx4 v9, s[40:43], s4 offen lds
  s_add_u32 m0, s3, 16384
  s_add_u32 s4, s74, 256
  buffer_load_dwordx4 v8, s[40:43], s4 offen lds
  s_add_u32 m0, s3, 17408
  s_nop 0
  buffer_load_dwordx4 v9, s[40:43], s4 offen lds
  s_add_u32 m0, s3, 24576
  s_add_u32 s4, s74, 384
  buffer_load_dwordx4 v8, s[40:43], s4 offen lds
  s_add_u32 m0, s3, 25600
  s_nop 0
  buffer_load_dwordx4 v9, s[40:43], s4 offen lds
  s_add_u32 s101, s101, 1
  s_xor_b32 s73, s101, s100
  s_and_b32 s73, s73, 3
  s_cselect_b32 s73, 15, 3
  s_add_u32 s73, s73, s101
  s_and_b32 s73, s73, 15
  s_mul_i32 s74, s73, 458752
  s_lshl_b32 s73, s73, 7
  s_add_u32 s75, s75, 49152
  s_cmp_eq_u32 s75, 147456
  s_cselect_b32 s75, 0, s75
  s_waitcnt vmcnt(12)
  s_barrier
  s_mov_b32 s79, 13
L_w1_ld:
  s_add_u32 s3, s75, s76
  s_add_u32 m0, s3, 0
  s_nop 0
  buffer_load_dwordx4 v4, s[36:39], s73 offen lds
  s_add_u32 m0, s3, 1024
  s_nop 0
  buffer_load_dwordx4 v5, s[36:39], s73 offen lds
  s_add_u32 m0, s3, 2048
  s_nop 0
  buffer_load_dwordx4 v6, s[36:39], s73 offen lds
  s_add_u32 m0, s3, 3072
  s_nop 0
  buffer_load_dwordx4 v7, s[36:39], s73 offen lds
  s_add_u32 s3, s75, s77
  s_add_u32 m0, s3, 0
  s_add_u32 s4, s74, 0
  buffer_load_dwordx4 v8, s[40:43], s4 offen lds
  s_add_u32 m0, s3, 1024
  s_nop 0
  buffer_load_dwordx4 v9, s[40:43], s4 offen lds
  s_add_u32 m0, s3, 8192
  s_add_u32 s4, s74, 128
  buffer_load_dwordx4 v8, s[40:43], s4 offen lds
  s_add_u32 m0, s3, 9216
  s_nop 0
  buffer_load_dwordx4 v9, s[40:43], s4 offen lds
  s_add_u32 m0, s3, 16384
  s_add_u32 s4, s74, 256
  buffer_load_dwordx4 v8, s[40:43], s4 offen lds
  s_add_u32 m0, s3, 17408
  s_nop 0
  buffer_load_dwordx4 v9, s[40:43], s4 offen lds
  s_add_u32 m0, s3, 24576
  s_add_u32 s4, s74, 384
  buffer_load_dwordx4 v8, s[40:43], s4 offen lds
  s_add_u32 m0, s3, 25600
  s_nop 0
  buffer_load_dwordx4 v9, s[40:43], s4 offen lds
  s_add_u32 s101, s101, 1
  s_xor_b32 s73, s101, s100
  s_and_b32 s73, s73, 3
  s_cselect_b32 s73, 15, 3
  s_add_u32 s73, s73, s101
  s_and_b32 s73, s73, 15
  s_mul_i32 s74, s73, 458752
  s_lshl_b32 s73, s73, 7
  s_add_u32 s75, s75, 49152
  s_cmp_eq_u32 s75, 147456
  s_cselect_b32 s75, 0, s75
  s_waitcnt vmcnt(12)
  s_barrier
  s_sub_u32 s79, s79, 1
  s_cmp_lg_u32 s79, 0
  s_cbranch_scc1 L_w1_ld
  s_add_u32 s3, s75, s76
  s_add_u32 m0, s3, 0
  s_nop 0
  buffer_load_dwordx4 v4, s[36:39], s73 offen lds
  s_add_u32 m0, s3, 1024
  s_nop 0
  buffer_load_dwordx4 v5, s[36:39], s73 offen lds
  s_add_u32 m0, s3, 2048
  s_nop 0
  buffer_load_dwordx4 v6, s[36:39], s73 offen lds
  s_add_u32 m0, s3, 3072
  s_nop 0
  buffer_load_dwordx4 v7, s[36:39], s73 offen lds
  s_add_u32 s3, s75, s77
  s_add_u32 m0, s3, 0
  s_add_u32 s4, s74, 0
  buffer_load_dwordx4 v8, s[40:43], s4 offen lds
  s_add_u32 m0, s3, 1024
  s_nop 0
  buffer_load_dwordx4 v9, s[40:43], s4 offen lds
  s_add_u32 m0, s3, 8192
  s_add_u32 s4, s74, 128
  buffer_load_dwordx4 v8, s[40:43], s4 offen lds
  s_add_u32 m0, s3, 9216
  s_nop 0
  buffer_load_dwordx4 v9, s[40:43], s4 offen lds
  s_add_u32 m0, s3, 16384
  s_add_u32 s4, s74, 256
  buffer_load_dwordx4 v8, s[40:43], s4 offen lds
  s_add_u32 m0, s3, 17408
  s_nop 0
  buffer_load_dwordx4 v9, s[40:43], s4 offen lds
  s_add_u32 m0, s3, 24576
  s_add_u32 s4, s74, 384
  buffer_load_dwordx4 v8, s[40:43], s4 offen lds
  s_add_u32 m0, s3, 25600
  s_nop 0
  buffer_load_dwordx4 v9, s[40:43], s4 offen lds
  s_add_u32 s101, s101, 1
  s_xor_b32 s73, s101, s100
  s_and_b32 s73, s73, 3
  s_cselect_b32 s73, 15, 3
  s_add_u32 s73, s73, s101
  s_and_b32 s73, s73, 15
  s_mul_i32 s74, s73, 458752
  s_lshl_b32 s73, s73, 7
  s_add_u32 s75, s75, 49152
  s_cmp_eq_u32 s75, 147456
  s_cselect_b32 s75, 0, s75
  s_and_b32 s3, s70, 3
  s_lshl_b32 s4, s68, 7
  s_lshl_b32 s5, s3, 6
  s_add_u32 s5, s5, s4
  v_add_u32 v2, s5, v1
  s_sub_u32 s4, s4, 16
  v_and_b32 v3, 15, v1
  v_add_u32 v3, s4, v3
  v_max_i32 v3, 0, v3
  s_cmp_ge_u32 s3, 2
  s_cselect_b64 vcc, -1, 0
  v_cndmask_b32 v2, v2, v3, vcc
  v_lshlrev_b32 v2, 3, v2
  s_mov_b32 s3, 0
  buffer_load_dwordx2 v[32:33], v2, s[56:59], s3 offen
  s_add_u32 s3, s3, 16384
  buffer_load_dwordx2 v[34:35], v2, s[56:59], s3 offen
  s_add_u32 s3, s3, 16384
  buffer_load_dwordx2 v[36:37], v2, s[56:59], s3 offen
  s_add_u32 s3, s3, 16384
  buffer_load_dwordx2 v[38:39], v2, s[56:59], s3 offen
  s_add_u32 s3, s3, 16384
  buffer_load_dwordx2 v[40:41], v2, s[56:59], s3 offen
  s_add_u32 s3, s3, 16384
  buffer_load_dwordx2 v[42:43], v2, s[56:59], s3 offen
  s_add_u32 s3, s3, 16384
  buffer_load_dwordx2 v[44:45], v2, s[56:59], s3 offen
  s_add_u32 s3, s3, 16384
  buffer_load_dwordx2 v[46:47], v2, s[56:59], s3 offen
  s_add_u32 s3, s3, 16384
  buffer_load_dwordx2 v[48:49], v2, s[56:59], s3 offen
  s_add_u32 s3, s3, 16384
  buffer_load_dwordx2 v[50:51], v2, s[56:59], s3 offen
  s_add_u32 s3, s3, 16384
  buffer_load_dwordx2 v[52:53], v2, s[56:59], s3 offen
  s_add_u32 s3, s3, 16384
  buffer_load_dwordx2 v[54:55], v2, s[56:59], s3 offen
  s_add_u32 s3, s3, 16384
  buffer_load_dwordx2 v[56:57], v2, s[56:59], s3 offen
  s_add_u32 s3, s3, 16384
  buffer_load_dwordx2 v[58:59], v2, s[56:59], s3 offen
  s_add_u32 s3, s3, 16384
  buffer_load_dwordx2 v[60:61], v2, s[56:59], s3 offen
  s_add_u32 s3, s3, 16384
  buffer_load_dwordx2 v[62:63], v2, s[56:59], s3 offen
  s_mul_i32 s4, s69, 224
  s_sub_u32 s4, s4, 256
  v_add_u32 v3, s4, v0
  v_lshlrev_b32 v2, 2, v3
  v_lshlrev_b32 v3, 1, v3
  s_mov_b32 s3, 0
  buffer_load_dword v64, v2, s[64:67], s3 offen
  s_add_u32 s3, s3, 16384
  buffer_load_dword v65, v2, s[64:67], s3 offen
  s_add_u32 s3, s3, 16384
  buffer_load_dword v66, v2, s[64:67], s3 offen
  s_add_u32 s3, s3, 16384
  buffer_load_dword v67, v2, s[64:67], s3 offen
  s_add_u32 s3, s3, 16384
  buffer_load_dword v68, v2, s[64:67], s3 offen
  s_add_u32 s3, s3, 16384
  buffer_load_dword v69, v2, s[64:67], s3 offen
  s_add_u32 s3, s3, 16384
  buffer_load_dword v70, v2, s[64:67], s3 offen
  s_add_u32 s3, s3, 16384
  buffer_load_dword v71, v2, s[64:67], s3 offen
  s_add_u32 s3, s3, 16384
  buffer_load_dword v72, v2, s[64:67], s3 offen
  s_add_u32 s3, s3, 16384
  buffer_load_dword v73, v2, s[64:67], s3 offen
  s_add_u32 s3, s3, 16384
  buffer_load_dword v74, v2, s[64:67], s3 offen
  s_add_u32 s3, s3, 16384
  buffer_load_dword v75, v2, s[64:67], s3 offen
  s_add_u32 s3, s3, 16384
  buffer_load_dword v76, v2, s[64:67], s3 offen
  s_add_u32 s3, s3, 16384
  buffer_load_dword v77, v2, s[64:67], s3 offen
  s_add_u32 s3, s3, 16384
  buffer_load_dword v78, v2, s[64:67], s3 offen
  s_add_u32 s3, s3, 16384
  buffer_load_dword v79, v2, s[64:67], s3 offen
  buffer_load_ushort v80, v3, s[52:55], 0 offen
  s_mov_b32 s60, s28
  s_and_b32 s61, s29, 0xffff
  s_mov_b32 s62, 7340032
  s_mov_b32 s63, 0x00020000
  s_and_b32 s3, s70, 3
  s_mul_i32 s3, s3, 16
  s_mul_i32 s4, s99, 64
  s_add_u32 s3, s3, s4
  v_lshrrev_b32 v2, 3, v1
  v_add_u32 v2, s3, v2
  v_mul_u32_u24 v2, 2048, v2
  v_and_b32 v3, 7, v1
  v_lshl_add_u32 v2, v3, 7, v2
  s_and_b32 s3, s2, 7
  s_lshr_b32 s3, s3, 2
  s_mul_i32 s3, s3, 1024
  buffer_load_dword v96, v2, s[60:63], s3 offen
  s_add_u32 s3, s3, 16384
  buffer_load_dword v97, v2, s[60:63], s3 offen
  s_getpc_b64 s[4:5]
L_pfc6:
  s_add_u32 s4, s4, L_w2_c0-L_pfc6
  s_addc_u32 s5, s5, 0
  s_and_b32 s3, s70, 3
  s_lshl_b32 s3, s3, 13
  v_lshl_add_u32 v2, v1, 7, s3
  v_min_u32 v2, L_w2_c1-L_w2_c0-4, v2
  global_load_dword v104, v2, s[4:5]
  s_waitcnt vmcnt(48)
  s_barrier
  s_waitcnt vmcnt(36)
  s_barrier
  s_waitcnt vmcnt(3)
  v_add_f32 v32, v32, v34
  v_add_f32 v33, v33, v35
  v_add_f32 v48, v48, v50
  v_add_f32 v49, v49, v51
  v_add_f32 v32, v32, v36
  v_add_f32 v33, v33, v37
  v_add_f32 v48, v48, v52
  v_add_f32 v49, v49, v53
  v_add_f32 v32, v32, v38
  v_add_f32 v33, v33, v39
  v_add_f32 v48, v48, v54
  v_add_f32 v49, v49, v55
  v_add_f32 v32, v32, v40
  v_add_f32 v33, v33, v41
  v_add_f32 v48, v48, v56
  v_add_f32 v49, v49, v57
  v_add_f32 v32, v32, v42
  v_add_f32 v33, v33, v43
  v_add_f32 v48, v48, v58
  v_add_f32 v49, v49, v59
  v_add_f32 v32, v32, v44
  v_add_f32 v33, v33, v45
  v_add_f32 v48, v48, v60
  v_add_f32 v49, v49, v61
  v_add_f32 v32, v32, v46
  v_add_f32 v33, v33, v47
  v_add_f32 v48, v48, v62
  v_add_f32 v49, v49, v63
  v_add_f32 v32, v32, v48
  v_add_f32 v33, v33, v49
  v_mul_f32 v32, 0x3a800000, v32
  v_mul_f32 v33, 0x3a800000, v33
  v_fma_f32 v33, -v32, v32, v33
  v_max_f32 v33, 0, v33
  v_add_f32 v33, 0x3727c5ac, v33
  v_rsq_f32 v33, v33
  s_nop 0
  s_and_b32 s3, s70, 3
  s_lshl_b32 s5, s3, 6
  s_add_u32 s5, s5, 16
  v_add_u32 v2, s5, v1
  v_and_b32 v3, 15, v1
  s_cmp_ge_u32 s3, 2
  s_cselect_b64 vcc, -1, 0
  v_cndmask_b32 v2, v2, v3, vcc
  v_lshlrev_b32 v2, 2, v2
  v_add_u32 v2, 147456, v2
  ds_write2_b32 v2, v32, v33 offset0:0 offset1:160
  v_add_f32 v64, v64, v72
  v_add_f32 v65, v65, v73
  v_add_f32 v66, v66, v74
  v_add_f32 v67, v67, v75
  v_add_f32 v68, v68, v76
  v_add_f32 v69, v69, v77
  v_add_f32 v70, v70, v78
  v_add_f32 v71, v71, v79
  v_add_f32 v64, v64, v68
  v_add_f32 v65, v65, v69
  v_add_f32 v66, v66, v70
  v_add_f32 v67, v67, v71
  v_add_f32 v64, v64, v65
  v_add_f32 v66, v66, v67
  v_add_f32 v64, v64, v66
  v_lshlrev_b32 v80, 16, v80
  v_lshlrev_b32 v2, 2, v0
  v_add_u32 v2, 147712, v2
  ds_write_b32 v2, v64
  ds_write_b32 v2, v80 offset:1024
  s_waitcnt lgkmcnt(0)
  s_barrier
  s_waitcnt vmcnt(0)
L_w1_end:
  s_endpgm
.section .rodata,"a"
.p2align 6
.amdhsa_kernel w1l0_kernel
  .amdhsa_next_free_vgpr 256
  .amdhsa_next_free_sgpr 102
  .amdhsa_accum_offset 256
  .amdhsa_group_segment_fixed_size 0
  .amdhsa_kernarg_size 88
  .amdhsa_user_sgpr_count 2
  .amdhsa_user_sgpr_kernarg_segment_ptr 1
  .amdhsa_system_sgpr_workgroup_id_x 1
  .amdhsa_float_denorm_mode_32 3
  .amdhsa_float_denorm_mode_16_64 3
.end_amdhsa_kernel
.text
.text
.globl w1l1_kernel
.p2align 8
.type w1l1_kernel,@function
w1l1_kernel:
  s_load_dwordx16 s[16:31], s[0:1], 0
  s_load_dwordx2 s[32:33], s[0:1], 64
  s_load_dwordx2 s[34:35], s[0:1], 80
  s_load_dwordx2 s[12:13], s[0:1], 64
  s_mov_b32 s96, 1
  s_branch L_w1_body
L_w1_c1:
.section .rodata,"a"
.p2align 6
.amdhsa_kernel w1l1_kernel
  .amdhsa_next_free_vgpr 256
  .amdhsa_next_free_sgpr 102
  .amdhsa_accum_offset 256
  .amdhsa_group_segment_fixed_size 0
  .amdhsa_kernarg_size 88
  .amdhsa_user_sgpr_count 2
  .amdhsa_user_sgpr_kernarg_segment_ptr 1
  .amdhsa_system_sgpr_workgroup_id_x 1
  .amdhsa_float_denorm_mode_32 3
  .amdhsa_float_denorm_mode_16_64 3
.end_amdhsa_kernel
.text
L_w2_c0:
.text
.globl w2l0_kernel
.p2align 8
.type w2l0_kernel,@function
w2l0_kernel:
  s_load_dwordx16 s[16:31], s[0:1], 0
  s_load_dwordx2 s[32:33], s[0:1], 64
  s_load_dwordx2 s[34:35], s[0:1], 80
  s_load_dwordx2 s[12:13], s[0:1], 0
  s_mov_b32 s96, 0
L_w2_body:
  s_cmp_ge_u32 s2, 256
  s_cbranch_scc1 L_w2_end
  v_lshrrev_b32 v2, 6, v0
  v_and_b32 v1, 63, v0
  v_readfirstlane_b32 s70, v2
  s_and_b32 s3, s2, 7
  s_lshr_b32 s99, s2, 3
  s_and_b32 s5, s3, 3
  s_lshl_b32 s5, s5, 2
  s_and_b32 s6, s99, 3
  s_add_u32 s68, s5, s6
  s_lshr_b32 s5, s3, 2
  s_lshl_b32 s5, s5, 3
  s_lshr_b32 s6, s99, 2
  s_add_u32 s69, s5, s6
  s_cmp_ge_u32 s70, 4
  s_cbranch_scc1 L_w2_loader
  v_and_b32 v3, 15, v1
  v_lshrrev_b32 v2, 4, v1
  s_lshl_b32 s8, s68, 7
  s_lshl_b32 s9, s70, 5
  s_add_u32 s8, s8, s9
  v_add_u32 v13, s8, v3
  s_lshl_b32 s10, s69, 7
  v_lshl_add_u32 v14, v2, 3, s10
  v_lshl_add_u32 v15, v13, 11, v14
  v_and_b32 v16, 1, v2
  v_lshlrev_b32 v16, 5, v16
  v_lshrrev_b32 v17, 1, v2
  v_lshl_add_u32 v16, v17, 4, v16
  v_add_u32 v16, s10, v16
  v_lshl_add_u32 v12, v13, 11, v16
  v_lshl_add_u32 v18, v17, 4, v13
  v_lshlrev_b32 v18, 3, v18
  v_and_b32 v16, 1, v2
  v_lshl_add_u32 v18, v16, 2, v18
  s_lshl_b32 s10, s69, 14
  v_add_u32 v18, s10, v18
  v_lshrrev_b32 v17, 1, v3
  s_lshl_b32 s8, s70, 12
  v_xor_b32 v4, v2, v17
  v_lshlrev_b32 v4, 4, v4
  v_lshl_add_u32 v4, v3, 7, v4
  v_add_u32 v4, s8, v4
  v_add_u32 v5, 4, v2
  v_xor_b32 v5, v5, v17
  v_lshlrev_b32 v5, 4, v5
  v_lshl_add_u32 v5, v3, 7, v5
  v_add_u32 v5, s8, v5
  v_bfe_u32 v6, v1, 2, 2
  v_lshl_add_u32 v6, v2, 3, v6
  v_lshlrev_b32 v6, 7, v6
  v_and_b32 v17, 3, v1
  v_lshl_add_u32 v6, v17, 3, v6
  v_bfe_u32 v17, v1, 3, 2
  v_lshl_add_u32 v6, v17, 5, v6
  v_add_u32 v6, 16384, v6
  v_xor_b32 v7, 32, v6
  v_xor_b32 v8, 64, v6
  v_xor_b32 v9, 96, v6
  s_waitcnt lgkmcnt(0)
  s_add_u32 s48, s34, 4194304
  s_addc_u32 s49, s35, 0
  s_and_b32 s49, s49, 0xffff
  s_mov_b32 s50, 4194304
  s_mov_b32 s51, 0x00020000
  s_mov_b32 s44, s32
  s_and_b32 s45, s33, 0xffff
  s_mov_b32 s46, 4194304
  s_mov_b32 s47, 0x00020000
  s_mov_b32 s52, s30
  s_and_b32 s53, s31, 0xffff
  s_mov_b32 s54, 2048
  s_mov_b32 s55, 0x00020000
  s_add_u32 s56, s34, 24117248
  s_addc_u32 s57, s35, 0
  s_and_b32 s57, s57, 0xffff
  s_mov_b32 s58, 262144
  s_mov_b32 s59, 0x00020000
  s_mov_b32 s3, 32768
  buffer_load_dwordx2 v[160:161], v15, s[48:51], 0 offen offset:0
  buffer_load_dwordx2 v[164:165], v15, s[48:51], 0 offen offset:32
  buffer_load_dwordx2 v[168:169], v15, s[48:51], 0 offen offset:64
  buffer_load_dwordx2 v[172:173], v15, s[48:51], 0 offen offset:96
  buffer_load_dwordx2 v[162:163], v15, s[48:51], s3 offen offset:0
  buffer_load_dwordx2 v[166:167], v15, s[48:51], s3 offen offset:32
  buffer_load_dwordx2 v[170:171], v15, s[48:51], s3 offen offset:64
  buffer_load_dwordx2 v[174:175], v15, s[48:51], s3 offen offset:96
  buffer_load_dwordx2 v[176:177], v14, s[52:55], 0 offen offset:0
  buffer_load_dwordx2 v[178:179], v14, s[52:55], 0 offen offset:32
  buffer_load_dwordx2 v[180:181], v14, s[52:55], 0 offen offset:64
  buffer_load_dwordx2 v[182:183], v14, s[52:55], 0 offen offset:96
  s_mov_b32 s11, 0xffff0000
  s_mov_b32 s75, 0
  s_waitcnt vmcnt(0)
  v_lshlrev_b32 v184, 16, v176
  v_and_b32 v185, s11, v176
  v_lshlrev_b32 v186, 16, v177
  v_and_b32 v187, s11, v177
  v_lshlrev_b32 v188, 16, v178
  v_and_b32 v189, s11, v178
  v_lshlrev_b32 v190, 16, v179
  v_and_b32 v191, s11, v179
  v_lshlrev_b32 v192, 16, v180
  v_and_b32 v193, s11, v180
  v_lshlrev_b32 v194, 16, v181
  v_and_b32 v195, s11, v181
  v_lshlrev_b32 v196, 16, v182
  v_and_b32 v197, s11, v182
  v_lshlrev_b32 v198, 16, v183
  v_and_b32 v199, s11, v183
  v_lshlrev_b32 v128, 16, v160
  v_and_b32 v129, s11, v160
  v_pk_add_f32 v[128:129], v[128:129], v[184:185]
  v_lshlrev_b32 v130, 16, v161
  v_and_b32 v131, s11, v161
  v_pk_add_f32 v[130:131], v[130:131], v[186:187]
  v_lshlrev_b32 v132, 16, v162
  v_and_b32 v133, s11, v162
  v_pk_add_f32 v[132:133], v[132:133], v[184:185]
  v_lshlrev_b32 v134, 16, v163
  v_and_b32 v135, s11, v163
  v_pk_add_f32 v[134:135], v[134:135], v[186:187]
  v_lshlrev_b32 v136, 16, v164
  v_and_b32 v137, s11, v164
  v_pk_add_f32 v[136:137], v[136:137], v[188:189]
  v_lshlrev_b32 v138, 16, v165
  v_and_b32 v139, s11, v165
  v_pk_add_f32 v[138:139], v[138:139], v[190:191]
  v_lshlrev_b32 v140, 16, v166
  v_and_b32 v141, s11, v166
  v_pk_add_f32 v[140:141], v[140:141], v[188:189]
  v_lshlrev_b32 v142, 16, v167
  v_and_b32 v143, s11, v167
  v_pk_add_f32 v[142:143], v[142:143], v[190:191]
  v_lshlrev_b32 v144, 16, v168
  v_and_b32 v145, s11, v168
  v_pk_add_f32 v[144:145], v[144:145], v[192:193]
  v_lshlrev_b32 v146, 16, v169
  v_and_b32 v147, s11, v169
  v_pk_add_f32 v[146:147], v[146:147], v[194:195]
  v_lshlrev_b32 v148, 16, v170
  v_and_b32 v149, s11, v170
  v_pk_add_f32 v[148:149], v[148:149], v[192:193]
  v_lshlrev_b32 v150, 16, v171
  v_and_b32 v151, s11, v171
  v_pk_add_f32 v[150:151], v[150:151], v[194:195]
  v_lshlrev_b32 v152, 16, v172
  v_and_b32 v153, s11, v172
  v_pk_add_f32 v[152:153], v[152:153], v[196:197]
  v_lshlrev_b32 v154, 16, v173
  v_and_b32 v155, s11, v173
  v_pk_add_f32 v[154:155], v[154:155], v[198:199]
  v_lshlrev_b32 v156, 16, v174
  v_and_b32 v157, s11, v174
  v_pk_add_f32 v[156:157], v[156:157], v[196:197]
  v_lshlrev_b32 v158, 16, v175
  v_and_b32 v159, s11, v175
  v_pk_add_f32 v[158:159], v[158:159], v[198:199]
  v_add_u32 v24, s75, v4
  v_add_u32 v25, s75, v5
  v_add_u32 v26, s75, v6
  v_add_u32 v27, s75, v7
  v_add_u32 v28, s75, v8
  v_add_u32 v29, s75, v9
  s_add_u32 s75, s75, 24576
  s_cmp_eq_u32 s75, 147456
  s_cselect_b32 s75, 0, s75
  s_barrier
  ds_read_b128 v[32:35], v24 offset:0
  ds_read_b128 v[36:39], v24 offset:2048
  ds_read_b64_tr_b16 v[48:49], v26 offset:0
  ds_read_b64_tr_b16 v[50:51], v26 offset:512
  ds_read_b64_tr_b16 v[52:53], v27 offset:0
  ds_read_b64_tr_b16 v[54:55], v27 offset:512
  ds_read_b64_tr_b16 v[56:57], v28 offset:0
  ds_read_b64_tr_b16 v[58:59], v28 offset:512
  ds_read_b64_tr_b16 v[60:61], v29 offset:0
  ds_read_b64_tr_b16 v[62:63], v29 offset:512
  ds_read_b128 v[40:43], v25 offset:0
  ds_read_b128 v[44:47], v25 offset:2048
  ds_read_b64_tr_b16 v[64:65], v26 offset:4096
  ds_read_b64_tr_b16 v[66:67], v26 offset:4608
  ds_read_b64_tr_b16 v[68:69], v27 offset:4096
  ds_read_b64_tr_b16 v[70:71], v27 offset:4608
  ds_read_b64_tr_b16 v[72:73], v28 offset:4096
  ds_read_b64_tr_b16 v[74:75], v28 offset:4608
  ds_read_b64_tr_b16 v[76:77], v29 offset:4096
  ds_read_b64_tr_b16 v[78:79], v29 offset:4608
  s_mov_b32 s79, 28
  v_add_u32 v24, s75, v4
  v_add_u32 v25, s75, v5
  v_add_u32 v26, s75, v6
  v_add_u32 v27, s75, v7
  v_add_u32 v28, s75, v8
  v_add_u32 v29, s75, v9
  s_add_u32 s75, s75, 24576
  s_cmp_eq_u32 s75, 147456
  s_cselect_b32 s75, 0, s75
  s_waitcnt lgkmcnt(0)
.p2align 3
L_w2_loop:
  s_barrier
  v_mfma_f32_16x16x32_bf16 v[128:131], v[48:51], v[32:35], v[128:131]
  ds_read_b128 v[80:83], v24 offset:0
  ds_read_b128 v[84:87], v24 offset:2048
  v_mfma_f32_16x16x32_bf16 v[132:135], v[48:51], v[36:39], v[132:135]
  ds_read_b64_tr_b16 v[96:97], v26 offset:0
  ds_read_b64_tr_b16 v[98:99], v26 offset:512
  v_mfma_f32_16x16x32_bf16 v[136:139], v[52:55], v[32:35], v[136:139]
  ds_read_b64_tr_b16 v[100:101], v27 offset:0
  ds_read_b64_tr_b16 v[102:103], v27 offset:512
  v_mfma_f32_16x16x32_bf16 v[140:143], v[52:55], v[36:39], v[140:143]
  ds_read_b64_tr_b16 v[104:105], v28 offset:0
  ds_read_b64_tr_b16 v[106:107], v28 offset:512
  v_mfma_f32_16x16x32_bf16 v[144:147], v[56:59], v[32:35], v[144:147]
  ds_read_b64_tr_b16 v[108:109], v29 offset:0
  ds_read_b64_tr_b16 v[110:111], v29 offset:512
  v_mfma_f32_16x16x32_bf16 v[148:151], v[56:59], v[36:39], v[148:151]
  ds_read_b128 v[88:91], v25 offset:0
  ds_read_b128 v[92:95], v25 offset:2048
  v_mfma_f32_16x16x32_bf16 v[152:155], v[60:63], v[32:35], v[152:155]
  ds_read_b64_tr_b16 v[112:113], v26 offset:4096
  ds_read_b64_tr_b16 v[114:115], v26 offset:4608
  v_mfma_f32_16x16x32_bf16 v[156:159], v[60:63], v[36:39], v[156:159]
  ds_read_b64_tr_b16 v[116:117], v27 offset:4096
  ds_read_b64_tr_b16 v[118:119], v27 offset:4608
  v_mfma_f32_16x16x32_bf16 v[128:131], v[64:67], v[40:43], v[128:131]
  ds_read_b64_tr_b16 v[120:121], v28 offset:4096
  ds_read_b64_tr_b16 v[122:123], v28 offset:4608
  v_mfma_f32_16x16x32_bf16 v[132:135], v[64:67], v[44:47], v[132:135]
  ds_read_b64_tr_b16 v[124:125], v29 offset:4096
  ds_read_b64_tr_b16 v[126:127], v29 offset:4608
  v_mfma_f32_16x16x32_bf16 v[136:139], v[68:71], v[40:43], v[136:139]
  v_add_u32 v24, s75, v4
  v_add_u32 v25, s75, v5
  v_mfma_f32_16x16x32_bf16 v[140:143], v[68:71], v[44:47], v[140:143]
  v_add_u32 v26, s75, v6
  v_add_u32 v27, s75, v7
  v_mfma_f32_16x16x32_bf16 v[144:147], v[72:75], v[40:43], v[144:147]
  v_add_u32 v28, s75, v8
  v_add_u32 v29, s75, v9
  v_mfma_f32_16x16x32_bf16 v[148:151], v[72:75], v[44:47], v[148:151]
  s_add_u32 s75, s75, 24576
  s_cmp_eq_u32 s75, 147456
  v_mfma_f32_16x16x32_bf16 v[152:155], v[76:79], v[40:43], v[152:155]
  s_cselect_b32 s75, 0, s75
  v_mfma_f32_16x16x32_bf16 v[156:159], v[76:79], v[44:47], v[156:159]
  s_waitcnt lgkmcnt(0)
  s_barrier
  v_mfma_f32_16x16x32_bf16 v[128:131], v[96:99], v[80:83], v[128:131]
  ds_read_b128 v[32:35], v24 offset:0
  ds_read_b128 v[36:39], v24 offset:2048
  v_mfma_f32_16x16x32_bf16 v[132:135], v[96:99], v[84:87], v[132:135]
  ds_read_b64_tr_b16 v[48:49], v26 offset:0
  ds_read_b64_tr_b16 v[50:51], v26 offset:512
  v_mfma_f32_16x16x32_bf16 v[136:139], v[100:103], v[80:83], v[136:139]
  ds_read_b64_tr_b16 v[52:53], v27 offset:0
  ds_read_b64_tr_b16 v[54:55], v27 offset:512
  v_mfma_f32_16x16x32_bf16 v[140:143], v[100:103], v[84:87], v[140:143]
  ds_read_b64_tr_b16 v[56:57], v28 offset:0
  ds_read_b64_tr_b16 v[58:59], v28 offset:512
  v_mfma_f32_16x16x32_bf16 v[144:147], v[104:107], v[80:83], v[144:147]
  ds_read_b64_tr_b16 v[60:61], v29 offset:0
  ds_read_b64_tr_b16 v[62:63], v29 offset:512
  v_mfma_f32_16x16x32_bf16 v[148:151], v[104:107], v[84:87], v[148:151]
  ds_read_b128 v[40:43], v25 offset:0
  ds_read_b128 v[44:47], v25 offset:2048
  v_mfma_f32_16x16x32_bf16 v[152:155], v[108:111], v[80:83], v[152:155]
  ds_read_b64_tr_b16 v[64:65], v26 offset:4096
  ds_read_b64_tr_b16 v[66:67], v26 offset:4608
  v_mfma_f32_16x16x32_bf16 v[156:159], v[108:111], v[84:87], v[156:159]
  ds_read_b64_tr_b16 v[68:69], v27 offset:4096
  ds_read_b64_tr_b16 v[70:71], v27 offset:4608
  v_mfma_f32_16x16x32_bf16 v[128:131], v[112:115], v[88:91], v[128:131]
  ds_read_b64_tr_b16 v[72:73], v28 offset:4096
  ds_read_b64_tr_b16 v[74:75], v28 offset:4608
  v_mfma_f32_16x16x32_bf16 v[132:135], v[112:115], v[92:95], v[132:135]
  ds_read_b64_tr_b16 v[76:77], v29 offset:4096
  ds_read_b64_tr_b16 v[78:79], v29 offset:4608
  v_mfma_f32_16x16x32_bf16 v[136:139], v[116:119], v[88:91], v[136:139]
  v_add_u32 v24, s75, v4
  v_add_u32 v25, s75, v5
  v_mfma_f32_16x16x32_bf16 v[140:143], v[116:119], v[92:95], v[140:143]
  v_add_u32 v26, s75, v6
  v_add_u32 v27, s75, v7
  v_mfma_f32_16x16x32_bf16 v[144:147], v[120:123], v[88:91], v[144:147]
  v_add_u32 v28, s75, v8
  v_add_u32 v29, s75, v9
  v_mfma_f32_16x16x32_bf16 v[148:151], v[120:123], v[92:95], v[148:151]
  s_add_u32 s75, s75, 24576
  s_cmp_eq_u32 s75, 147456
  v_mfma_f32_16x16x32_bf16 v[152:155], v[124:127], v[88:91], v[152:155]
  s_cselect_b32 s75, 0, s75
  v_mfma_f32_16x16x32_bf16 v[156:159], v[124:127], v[92:95], v[156:159]
  s_sub_u32 s79, s79, 1
  s_cmp_lg_u32 s79, 0
  s_waitcnt lgkmcnt(0)
  s_cbranch_scc1 L_w2_loop
  s_mov_b32 s11, 0x3f803f80
  v_mov_b32 v20, 0
  v_mov_b32 v21, 0
  v_mov_b32 v22, 0
  v_mov_b32 v23, 0
  s_mov_b32 s3, 32768
  s_nop 4
  v_cvt_pk_bf16_f32 v32, v128, v129
  v_cvt_pk_bf16_f32 v33, v130, v131
  v_cvt_pk_bf16_f32 v34, v136, v137
  v_cvt_pk_bf16_f32 v35, v138, v139
  s_nop 1
  v_permlane16_swap_b32 v32, v34
  v_permlane16_swap_b32 v33, v35
  buffer_store_dwordx4 v[32:35], v12, s[44:47], 0 offen offset:0
  v_cvt_pk_bf16_f32 v36, v144, v145
  v_cvt_pk_bf16_f32 v37, v146, v147
  v_cvt_pk_bf16_f32 v38, v152, v153
  v_cvt_pk_bf16_f32 v39, v154, v155
  s_nop 1
  v_permlane16_swap_b32 v36, v38
  v_permlane16_swap_b32 v37, v39
  buffer_store_dwordx4 v[36:39], v12, s[44:47], 0 offen offset:64
  v_cvt_pk_bf16_f32 v40, v132, v133
  v_cvt_pk_bf16_f32 v41, v134, v135
  v_cvt_pk_bf16_f32 v42, v140, v141
  v_cvt_pk_bf16_f32 v43, v142, v143
  s_nop 1
  v_permlane16_swap_b32 v40, v42
  v_permlane16_swap_b32 v41, v43
  buffer_store_dwordx4 v[40:43], v12, s[44:47], s3 offen offset:0
  v_cvt_pk_bf16_f32 v44, v148, v149
  v_cvt_pk_bf16_f32 v45, v150, v151
  v_cvt_pk_bf16_f32 v46, v156, v157
  v_cvt_pk_bf16_f32 v47, v158, v159
  s_nop 1
  v_permlane16_swap_b32 v44, v46
  v_permlane16_swap_b32 v45, v47
  buffer_store_dwordx4 v[44:47], v12, s[44:47], s3 offen offset:64
  v_dot2_f32_bf16 v20, v32, s11, v20
  v_dot2_f32_bf16 v22, v32, v32, v22
  v_dot2_f32_bf16 v20, v33, s11, v20
  v_dot2_f32_bf16 v22, v33, v33, v22
  v_dot2_f32_bf16 v20, v34, s11, v20
  v_dot2_f32_bf16 v22, v34, v34, v22
  v_dot2_f32_bf16 v20, v35, s11, v20
  v_dot2_f32_bf16 v22, v35, v35, v22
  v_dot2_f32_bf16 v20, v36, s11, v20
  v_dot2_f32_bf16 v22, v36, v36, v22
  v_dot2_f32_bf16 v20, v37, s11, v20
  v_dot2_f32_bf16 v22, v37, v37, v22
  v_dot2_f32_bf16 v20, v38, s11, v20
  v_dot2_f32_bf16 v22, v38, v38, v22
  v_dot2_f32_bf16 v20, v39, s11, v20
  v_dot2_f32_bf16 v22, v39, v39, v22
  v_dot2_f32_bf16 v21, v40, s11, v21
  v_dot2_f32_bf16 v23, v40, v40, v23
  v_dot2_f32_bf16 v21, v41, s11, v21
  v_dot2_f32_bf16 v23, v41, v41, v23
  v_dot2_f32_bf16 v21, v42, s11, v21
  v_dot2_f32_bf16 v23, v42, v42, v23
  v_dot2_f32_bf16 v21, v43, s11, v21
  v_dot2_f32_bf16 v23, v43, v43, v23
  v_dot2_f32_bf16 v21, v44, s11, v21
  v_dot2_f32_bf16 v23, v44, v44, v23
  v_dot2_f32_bf16 v21, v45, s11, v21
  v_dot2_f32_bf16 v23, v45, v45, v23
  v_dot2_f32_bf16 v21, v46, s11, v21
  v_dot2_f32_bf16 v23, v46, v46, v23
  v_dot2_f32_bf16 v21, v47, s11, v21
  v_dot2_f32_bf16 v23, v47, v47, v23
  s_nop 2
  v_permlane32_swap_b32 v20, v21
  v_permlane32_swap_b32 v22, v23
  v_add_f32 v20, v20, v21
  v_add_f32 v22, v22, v23
  s_nop 1
  v_permlane16_swap_b32 v20, v22
  v_add_f32 v20, v20, v22
  buffer_store_dword v20, v18, s[56:59], 0 offen
  s_endpgm
L_w2_loader:
  s_add_u32 s8, s70, s69
  s_and_b32 s8, s8, 3
  s_add_u32 s9, s70, s68
  s_and_b32 s9, s9, 3
  s_lshl_b32 s76, s8, 12
  s_lshl_b32 s77, s9, 11
  s_add_u32 s77, s77, 16384
  v_lshrrev_b32 v3, 3, v1
  s_lshl_b32 s10, s8, 5
  s_lshl_b32 s11, s68, 7
  s_add_u32 s10, s10, s11
  v_add_u32 v3, s10, v3
  v_mul_u32_u24 v3, 7168, v3
  v_lshrrev_b32 v2, 4, v1
  v_and_b32 v10, 7, v1
  v_xor_b32 v4, v2, v10
  v_lshl_add_u32 v4, v4, 4, v3
  v_add_u32 v3, 57344, v3
  v_add_u32 v5, 4, v2
  v_xor_b32 v5, v5, v10
  v_lshl_add_u32 v5, v5, 4, v3
  v_add_u32 v3, 57344, v3
  v_xor_b32 v6, v2, v10
  v_lshl_add_u32 v6, v6, 4, v3
  v_add_u32 v3, 57344, v3
  v_add_u32 v7, 4, v2
  v_xor_b32 v7, v7, v10
  v_lshl_add_u32 v7, v7, 4, v3
  v_lshrrev_b32 v3, 3, v1
  s_lshl_b32 s10, s9, 4
  v_add_u32 v3, s10, v3
  v_mul_u32_u24 v3, 2048, v3
  v_lshrrev_b32 v2, 3, v1
  v_and_b32 v2, 2, v2
  v_xor_b32 v2, v2, v10
  s_mul_i32 s10, s69, 128
  v_add_u32 v3, s10, v3
  v_lshl_add_u32 v8, v2, 4, v3
  v_xor_b32 v2, 4, v2
  v_add_u32 v3, 16384, v3
  v_lshl_add_u32 v9, v2, 4, v3
  s_mov_b32 s75, 0
  s_add_u32 s100, s68, s69
  s_mov_b32 s101, -1
  s_add_u32 s101, s101, 1
  s_lshr_b32 s73, s101, 1
  s_xor_b32 s73, s73, s100
  s_and_b32 s73, s73, 3
  s_cselect_b32 s73, 54, 6
  s_add_u32 s73, s73, s101
  s_sub_u32 s74, s73, 56
  s_cselect_b32 s73, s73, s74
  s_mul_i32 s74, s73, 131072
  s_lshl_b32 s73, s73, 7
  s_waitcnt lgkmcnt(0)
  s_add_u32 s36, s34, 8388608
  s_addc_u32 s37, s35, 0
  s_and_b32 s37, s37, 0xffff
  s_mov_b32 s38, 14680064
  s_mov_b32 s39, 0x00020000
  s_mov_b32 s40, s28
  s_and_b32 s41, s29, 0xffff
  s_mov_b32 s42, 7340032
  s_mov_b32 s43, 0x00020000
  s_add_u32 s3, s75, s76
  s_add_u32 m0, s3, 0
  s_nop 0
  buffer_load_dwordx4 v4, s[36:39], s73 offen lds
  s_add_u32 m0, s3, 1024
  s_nop 0
  buffer_load_dwordx4 v5, s[36:39], s73 offen lds
  s_add_u32 m0, s3, 2048
  s_nop 0
  buffer_load_dwordx4 v6, s[36:39], s73 offen lds
  s_add_u32 m0, s3, 3072
  s_nop 0
  buffer_load_dwordx4 v7, s[36:39], s73 offen lds
  s_add_u32 s3, s75, s77
  s_add_u32 m0, s3, 0
  s_add_u32 s4, s74, 0
  buffer_load_dwordx4 v8, s[40:43], s4 offen lds
  s_add_u32 m0, s3, 1024
  s_nop 0
  buffer_load_dwordx4 v9, s[40:43], s4 offen lds
  s_add_u32 s101, s101, 1
  s_lshr_b32 s73, s101, 1
  s_xor_b32 s73, s73, s100
  s_and_b32 s73, s73, 3
  s_cselect_b32 s73, 54, 6
  s_add_u32 s73, s73, s101
  s_sub_u32 s74, s73, 56
  s_cselect_b32 s73, s73, s74
  s_mul_i32 s74, s73, 131072
  s_lshl_b32 s73, s73, 7
  s_add_u32 s75, s75, 24576
  s_cmp_eq_u32 s75, 147456
  s_cselect_b32 s75, 0, s75
  s_add_u32 s3, s75, s76
  s_add_u32 m0, s3, 0
  s_nop 0
  buffer_load_dwordx4 v4, s[36:39], s73 offen lds
  s_add_u32 m0, s3, 1024
  s_nop 0
  buffer_load_dwordx4 v5, s[36:39], s73 offen lds
  s_add_u32 m0, s3, 2048
  s_nop 0
  buffer_load_dwordx4 v6, s[36:39], s73 offen lds
  s_add_u32 m0, s3, 3072
  s_nop 0
  buffer_load_dwordx4 v7, s[36:39], s73 offen lds
  s_add_u32 s3, s75, s77
  s_add_u32 m0, s3, 0
  s_add_u32 s4, s74, 0
  buffer_load_dwordx4 v8, s[40:43], s4 offen lds
  s_add_u32 m0, s3, 1024
  s_nop 0
  buffer_load_dwordx4 v9, s[40:43], s4 offen lds
  s_add_u32 s101, s101, 1
  s_lshr_b32 s73, s101, 1
  s_xor_b32 s73, s73, s100
  s_and_b32 s73, s73, 3
  s_cselect_b32 s73, 54, 6
  s_add_u32 s73, s73, s101
  s_sub_u32 s74, s73, 56
  s_cselect_b32 s73, s73, s74
  s_mul_i32 s74, s73, 131072
  s_lshl_b32 s73, s73, 7
  s_add_u32 s75, s75, 24576
  s_cmp_eq_u32 s75, 147456
  s_cselect_b32 s75, 0, s75
  s_waitcnt vmcnt(6)
  s_barrier
  s_add_u32 s3, s75, s76
  s_add_u32 m0, s3, 0
  s_nop 0
  buffer_load_dwordx4 v4, s[36:39], s73 offen lds
  s_add_u32 m0, s3, 1024
  s_nop 0
  buffer_load_dwordx4 v5, s[36:39], s73 offen lds
  s_add_u32 m0, s3, 2048
  s_nop 0
  buffer_load_dwordx4 v6, s[36:39], s73 offen lds
  s_add_u32 m0, s3, 3072
  s_nop 0
  buffer_load_dwordx4 v7, s[36:39], s73 offen lds
  s_add_u32 s3, s75, s77
  s_add_u32 m0, s3, 0
  s_add_u32 s4, s74, 0
  buffer_load_dwordx4 v8, s[40:43], s4 offen lds
  s_add_u32 m0, s3, 1024
  s_nop 0
  buffer_load_dwordx4 v9, s[40:43], s4 offen lds
  s_add_u32 s101, s101, 1
  s_lshr_b32 s73, s101, 1
  s_xor_b32 s73, s73, s100
  s_and_b32 s73, s73, 3
  s_cselect_b32 s73, 54, 6
  s_add_u32 s73, s73, s101
  s_sub_u32 s74, s73, 56
  s_cselect_b32 s73, s73, s74
  s_mul_i32 s74, s73, 131072
  s_lshl_b32 s73, s73, 7
  s_add_u32 s75, s75, 24576
  s_cmp_eq_u32 s75, 147456
  s_cselect_b32 s75, 0, s75
  s_add_u32 s3, s75, s76
  s_add_u32 m0, s3, 0
  s_nop 0
  buffer_load_dwordx4 v4, s[36:39], s73 offen lds
  s_add_u32 m0, s3, 1024
  s_nop 0
  buffer_load_dwordx4 v5, s[36:39], s73 offen lds
  s_add_u32 m0, s3, 2048
  s_nop 0
  buffer_load_dwordx4 v6, s[36:39], s73 offen lds
  s_add_u32 m0, s3, 3072
  s_nop 0
  buffer_load_dwordx4 v7, s[36:39], s73 offen lds
  s_add_u32 s3, s75, s77
  s_add_u32 m0, s3, 0
  s_add_u32 s4, s74, 0
  buffer_load_dwordx4 v8, s[40:43], s4 offen lds
  s_add_u32 m0, s3, 1024
  s_nop 0
  buffer_load_dwordx4 v9, s[40:43], s4 offen lds
  s_add_u32 s101, s101, 1
  s_lshr_b32 s73, s101, 1
  s_xor_b32 s73, s73, s100
  s_and_b32 s73, s73, 3
  s_cselect_b32 s73, 54, 6
  s_add_u32 s73, s73, s101
  s_sub_u32 s74, s73, 56
  s_cselect_b32 s73, s73, s74
  s_mul_i32 s74, s73, 131072
  s_lshl_b32 s73, s73, 7
  s_add_u32 s75, s75, 24576
  s_cmp_eq_u32 s75, 147456
  s_cselect_b32 s75, 0, s75
  s_add_u32 s3, s75, s76
  s_add_u32 m0, s3, 0
  s_nop 0
  buffer_load_dwordx4 v4, s[36:39], s73 offen lds
  s_add_u32 m0, s3, 1024
  s_nop 0
  buffer_load_dwordx4 v5, s[36:39], s73 offen lds
  s_add_u32 m0, s3, 2048
  s_nop 0
  buffer_load_dwordx4 v6, s[36:39], s73 offen lds
  s_add_u32 m0, s3, 3072
  s_nop 0
  buffer_load_dwordx4 v7, s[36:39], s73 offen lds
  s_add_u32 s3, s75, s77
  s_add_u32 m0, s3, 0
  s_add_u32 s4, s74, 0
  buffer_load_dwordx4 v8, s[40:43], s4 offen lds
  s_add_u32 m0, s3, 1024
  s_nop 0
  buffer_load_dwordx4 v9, s[40:43], s4 offen lds
  s_add_u32 s101, s101, 1
  s_lshr_b32 s73, s101, 1
  s_xor_b32 s73, s73, s100
  s_and_b32 s73, s73, 3
  s_cselect_b32 s73, 54, 6
  s_add_u32 s73, s73, s101
  s_sub_u32 s74, s73, 56
  s_cselect_b32 s73, s73, s74
  s_mul_i32 s74, s73, 131072
  s_lshl_b32 s73, s73, 7
  s_add_u32 s75, s75, 24576
  s_cmp_eq_u32 s75, 147456
  s_cselect_b32 s75, 0, s75
  s_mov_b32 s79, 50
L_w2l_ld:
  s_add_u32 s3, s75, s76
  s_add_u32 m0, s3, 0
  s_nop 0
  buffer_load_dwordx4 v4, s[36:39], s73 offen lds
  s_add_u32 m0, s3, 1024
  s_nop 0
  buffer_load_dwordx4 v5, s[36:39], s73 offen lds
  s_add_u32 m0, s3, 2048
  s_nop 0
  buffer_load_dwordx4 v6, s[36:39], s73 offen lds
  s_add_u32 m0, s3, 3072
  s_nop 0
  buffer_load_dwordx4 v7, s[36:39], s73 offen lds
  s_add_u32 s3, s75, s77
  s_add_u32 m0, s3, 0
  s_add_u32 s4, s74, 0
  buffer_load_dwordx4 v8, s[40:43], s4 offen lds
  s_add_u32 m0, s3, 1024
  s_nop 0
  buffer_load_dwordx4 v9, s[40:43], s4 offen lds
  s_add_u32 s101, s101, 1
  s_lshr_b32 s73, s101, 1
  s_xor_b32 s73, s73, s100
  s_and_b32 s73, s73, 3
  s_cselect_b32 s73, 54, 6
  s_add_u32 s73, s73, s101
  s_sub_u32 s74, s73, 56
  s_cselect_b32 s73, s73, s74
  s_mul_i32 s74, s73, 131072
  s_lshl_b32 s73, s73, 7
  s_add_u32 s75, s75, 24576
  s_cmp_eq_u32 s75, 147456
  s_cselect_b32 s75, 0, s75
  s_waitcnt vmcnt(24)
  s_barrier
  s_sub_u32 s79, s79, 1
  s_cmp_lg_u32 s79, 0
  s_cbranch_scc1 L_w2l_ld
  s_add_u32 s3, s75, s76
  s_add_u32 m0, s3, 0
  s_nop 0
  buffer_load_dwordx4 v4, s[36:39], s73 offen lds
  s_add_u32 m0, s3, 1024
  s_nop 0
  buffer_load_dwordx4 v5, s[36:39], s73 offen lds
  s_add_u32 m0, s3, 2048
  s_nop 0
  buffer_load_dwordx4 v6, s[36:39], s73 offen lds
  s_add_u32 m0, s3, 3072
  s_nop 0
  buffer_load_dwordx4 v7, s[36:39], s73 offen lds
  s_add_u32 s3, s75, s77
  s_add_u32 m0, s3, 0
  s_add_u32 s4, s74, 0
  buffer_load_dwordx4 v8, s[40:43], s4 offen lds
  s_add_u32 m0, s3, 1024
  s_nop 0
  buffer_load_dwordx4 v9, s[40:43], s4 offen lds
  s_add_u32 s101, s101, 1
  s_lshr_b32 s73, s101, 1
  s_xor_b32 s73, s73, s100
  s_and_b32 s73, s73, 3
  s_cselect_b32 s73, 54, 6
  s_add_u32 s73, s73, s101
  s_sub_u32 s74, s73, 56
  s_cselect_b32 s73, s73, s74
  s_mul_i32 s74, s73, 131072
  s_lshl_b32 s73, s73, 7
  s_add_u32 s75, s75, 24576
  s_cmp_eq_u32 s75, 147456
  s_cselect_b32 s75, 0, s75
  s_mov_b32 s60, s18
  s_and_b32 s61, s19, 0xffff
  s_mov_b32 s62, 6291456
  s_mov_b32 s63, 0x00020000
  s_and_b32 s3, s70, 3
  s_mul_i32 s3, s3, 8
  s_mul_i32 s4, s99, 32
  s_add_u32 s3, s3, s4
  v_lshrrev_b32 v2, 4, v1
  v_add_u32 v2, s3, v2
  v_mul_u32_u24 v2, 6144, v2
  v_and_b32 v3, 15, v1
  v_min_u32 v3, 11, v3
  v_lshrrev_b32 v12, 2, v3
  v_lshl_add_u32 v2, v12, 11, v2
  v_and_b32 v3, 3, v3
  v_lshl_add_u32 v2, v3, 7, v2
  s_and_b32 s3, s2, 7
  s_lshr_b32 s3, s3, 1
  s_mul_i32 s3, s3, 512
  buffer_load_dword v96, v2, s[60:63], s3 offen
  s_add_u32 s3, s3, 24576
  buffer_load_dword v97, v2, s[60:63], s3 offen
  s_getpc_b64 s[4:5]
L_pfc8:
  s_sub_u32 s4, s4, L_pfc8-L_attn_c0
  s_subb_u32 s5, s5, 0
  s_and_b32 s3, s70, 3
  s_lshl_b32 s3, s3, 13
  v_lshl_add_u32 v2, v1, 7, s3
  v_min_u32 v2, L_attn_c1-L_attn_c0-4, v2
  global_load_dword v104, v2, s[4:5]
  s_waitcnt vmcnt(27)
  s_barrier
  s_waitcnt vmcnt(21)
  s_barrier
  s_waitcnt vmcnt(15)
  s_barrier
  s_waitcnt vmcnt(9)
  s_barrier
  s_waitcnt vmcnt(3)
  s_barrier
  s_barrier
L_w2_side:
  s_waitcnt vmcnt(0)
L_w2_end:
  s_endpgm
.section .rodata,"a"
.p2align 6
.amdhsa_kernel w2l0_kernel
  .amdhsa_next_free_vgpr 256
  .amdhsa_next_free_sgpr 102
  .amdhsa_accum_offset 256
  .amdhsa_group_segment_fixed_size 0
  .amdhsa_kernarg_size 88
  .amdhsa_user_sgpr_count 2
  .amdhsa_user_sgpr_kernarg_segment_ptr 1
  .amdhsa_system_sgpr_workgroup_id_x 1
  .amdhsa_float_denorm_mode_32 3
  .amdhsa_float_denorm_mode_16_64 3
.end_amdhsa_kernel
.text
.text
.globl w2l1_kernel
.p2align 8
.type w2l1_kernel,@function
w2l1_kernel:
  s_load_dwordx16 s[16:31], s[0:1], 0
  s_load_dwordx2 s[32:33], s[0:1], 64
  s_load_dwordx2 s[34:35], s[0:1], 80
  s_load_dwordx2 s[12:13], s[0:1], 64
  s_mov_b32 s96, 1
  s_branch L_w2_body
L_w2_c1:
.section .rodata,"a"
.p2align 6
.amdhsa_kernel w2l1_kernel
  .amdhsa_next_free_vgpr 256
  .amdhsa_next_free_sgpr 102
  .amdhsa_accum_offset 256
  .amdhsa_group_segment_fixed_size 0
  .amdhsa_kernarg_size 88
  .amdhsa_user_sgpr_count 2
  .amdhsa_user_sgpr_kernarg_segment_ptr 1
  .amdhsa_system_sgpr_workgroup_id_x 1
  .amdhsa_float_denorm_mode_32 3
  .amdhsa_float_denorm_mode_16_64 3
.end_amdhsa_kernel
.text
```

```asm
; @launch kernel=attnl0_kernel grid=(256,1,1) block=(512,1,1) lds=130304
; @launch kernel=wol0_kernel grid=(256,1,1) block=(512,1,1) lds=163840
; @launch kernel=w1l0_kernel grid=(256,1,1) block=(512,1,1) lds=150784
; @launch kernel=w2l0_kernel grid=(256,1,1) block=(512,1,1) lds=163840
; @launch kernel=attnl1_kernel grid=(256,1,1) block=(512,1,1) lds=130304
; @launch kernel=wol1_kernel grid=(256,1,1) block=(512,1,1) lds=163840
; @launch kernel=w1l1_kernel grid=(256,1,1) block=(512,1,1) lds=150784
; @launch kernel=w2l1_kernel grid=(256,1,1) block=(512,1,1) lds=163840
.amdgcn_target "amdgcn-amd-amdhsa--gfx950"
L_attn_c0:
.text
.globl attnl0_kernel
.p2align 8
.type attnl0_kernel,@function
attnl0_kernel:
  s_load_dwordx16 s[16:31], s[0:1], 0
  s_load_dwordx2 s[32:33], s[0:1], 64
  s_load_dwordx2 s[34:35], s[0:1], 80
  s_load_dwordx2 s[12:13], s[0:1], 0
  s_mov_b32 s96, 0
L_attn_body:
  s_cmp_ge_u32 s2, 256
  s_cbranch_scc1 L_attn_end
  v_lshrrev_b32 v2, 6, v0
  v_and_b32 v1, 63, v0
  v_readfirstlane_b32 s70, v2
  s_and_b32 s3, s2, 7
  s_lshr_b32 s99, s2, 3
  s_and_b32 s5, s3, 1
  s_lshl_b32 s5, s5, 3
  s_and_b32 s6, s99, 7
  s_add_u32 s68, s5, s6
  s_lshr_b32 s5, s3, 1
  s_lshl_b32 s5, s5, 2
  s_lshr_b32 s6, s99, 3
  s_add_u32 s69, s5, s6
  s_cmp_ge_u32 s70, 4
  s_cbranch_scc1 L_attn_loader
  s_and_b32 s71, s70, 1
  s_lshr_b32 s72, s70, 1
  v_and_b32 v3, 31, v1
  v_lshlrev_b32 v3, 2, v3
  v_add_u32 v3, 40960, v3
  v_mov_b32 v236, 0x3f803f80
  v_mov_b32 v237, 0x3f803f80
  v_mov_b32 v238, 0x3f803f80
  v_mov_b32 v239, 0x3f803f80
  ds_write_b32 v3, v236
  ds_write_b32 v3, v236 offset:43008
  v_add_u32 v3, 86016, v3
  ds_write_b32 v3, v236
  v_and_b32 v3, 15, v1
  v_lshrrev_b32 v2, 4, v1
  v_lshrrev_b32 v33, 1, v3
  s_lshl_b32 s8, s71, 13
  v_xor_b32 v4, v2, v33
  v_lshlrev_b32 v4, 4, v4
  v_lshl_add_u32 v4, v3, 7, v4
  v_add_u32 v8, 40960, v4
  v_add_u32 v4, s8, v4
  v_add_u32 v5, 4, v2
  v_xor_b32 v5, v5, v33
  v_lshlrev_b32 v5, 4, v5
  v_lshl_add_u32 v5, v3, 7, v5
  v_add_u32 v9, 40960, v5
  v_add_u32 v5, s8, v5
  v_bfe_u32 v34, v1, 2, 2
  v_lshl_add_u32 v34, v2, 3, v34
  v_lshlrev_b32 v34, 7, v34
  v_and_b32 v33, 3, v1
  v_lshl_add_u32 v34, v33, 3, v34
  v_bfe_u32 v33, v1, 3, 2
  v_lshl_add_u32 v34, v33, 5, v34
  v_and_b32 v35, 1, v2
  v_xor_b32 v35, s71, v35
  s_lshl_b32 s8, s70, 5
  v_xor_b32 v34, s8, v34
  v_add_u32 v6, 16384, v34
  v_xor_b32 v7, 32, v6
  s_lshl_b32 s8, s68, 7
  s_lshl_b32 s9, s71, 6
  s_add_u32 s8, s8, s9
  s_add_u32 s10, s8, s69
  s_lshl_b32 s10, s10, 11
  s_lshl_b32 s11, s72, 10
  s_add_u32 s10, s10, s11
  v_lshl_add_u32 v33, v3, 4, s10
  v_lshl_add_u32 v33, v35, 9, v33
  v_lshrrev_b32 v34, 1, v2
  v_lshl_add_u32 v31, v34, 8, v33
  s_mul_i32 s10, s72, 12288
  s_add_u32 s10, s10, 1024
  s_lshl_b32 s11, s71, 10
  s_add_u32 s4, s10, s11
  s_sub_u32 s5, s10, s11
  s_mul_i32 s6, s71, 6144
  v_lshl_add_u32 v16, v1, 4, s4
  v_add_u32 v17, s6, v16
  v_lshl_add_u32 v18, v1, 4, s5
  v_add_u32 v18, s6, v18
  v_lshl_add_u32 v19, v2, 8, s4
  v_lshl_add_u32 v20, v2, 8, s5
  v_lshl_add_u32 v21, v3, 4, s4
  v_lshl_add_u32 v22, v3, 4, s5
  s_lshl_b32 s10, s71, 8
  s_add_u32 s10, s10, 129024
  v_lshl_add_u32 v23, v3, 2, s10
  v_lshl_add_u32 v24, v2, 4, s10
  v_and_b32 v33, 1, v3
  v_cmp_eq_u32 s[48:49], 1, v33
  v_lshl_add_u32 v34, v2, 2, v33
  v_add_u32 v35, 2, v34
  v_cmp_gt_u32 s[50:51], v34, v3
  v_cmp_gt_u32 s[52:53], v35, v3
  v_mov_b32 v36, 0xffff
  v_mov_b32 v37, 0xffff0000
  v_cndmask_b32 v36, v36, v37, s[48:49]
  s_add_u32 s10, s10, 704
  v_lshl_add_u32 v34, v34, 2, s10
  v_lshl_add_u32 v35, v35, 2, s10
  v_subrev_u32 v38, 64, v34
  v_subrev_u32 v39, 64, v35
  v_cndmask_b32 v25, v34, v38, s[50:51]
  v_cndmask_b32 v26, v35, v39, s[52:53]
  v_cndmask_b32 v27, 0, v36, s[50:51]
  v_cndmask_b32 v29, 0, v36, s[52:53]
  v_xor_b32 v28, v27, v36
  v_xor_b32 v30, v29, v36
  s_cmp_eq_u32 s8, 0
  s_cselect_b64 s[54:55], s[50:51], 0
  s_cselect_b64 s[14:15], s[52:53], 0
  v_mov_b32 v120, 0
  v_mov_b32 v121, 0
  v_mov_b32 v122, 0
  v_mov_b32 v123, 0
  v_mov_b32 v124, 0
  v_mov_b32 v125, 0
  v_mov_b32 v126, 0
  v_mov_b32 v127, 0
  v_mov_b32 v128, 0
  v_mov_b32 v129, 0
  v_mov_b32 v130, 0
  v_mov_b32 v131, 0
  v_mov_b32 v132, 0
  v_mov_b32 v133, 0
  v_mov_b32 v134, 0
  v_mov_b32 v135, 0
  v_mov_b32 v136, 0
  v_mov_b32 v137, 0
  v_mov_b32 v138, 0
  v_mov_b32 v139, 0
  v_mov_b32 v140, 0
  v_mov_b32 v141, 0
  v_mov_b32 v142, 0
  v_mov_b32 v143, 0
  v_mov_b32 v144, 0
  v_mov_b32 v145, 0
  v_mov_b32 v146, 0
  v_mov_b32 v147, 0
  v_mov_b32 v148, 0
  v_mov_b32 v149, 0
  v_mov_b32 v150, 0
  v_mov_b32 v151, 0
  v_mov_b32 v152, 0
  v_mov_b32 v153, 0
  v_mov_b32 v154, 0
  v_mov_b32 v155, 0
  v_mov_b32 v156, 0
  v_mov_b32 v157, 0
  v_mov_b32 v158, 0
  v_mov_b32 v159, 0
  v_mov_b32 v160, 0
  v_mov_b32 v161, 0
  v_mov_b32 v162, 0
  v_mov_b32 v163, 0
  v_mov_b32 v164, 0
  v_mov_b32 v165, 0
  v_mov_b32 v166, 0
  v_mov_b32 v167, 0
  v_mov_b32 v168, 0
  v_mov_b32 v169, 0
  v_mov_b32 v170, 0
  v_mov_b32 v171, 0
  v_mov_b32 v172, 0
  v_mov_b32 v173, 0
  v_mov_b32 v174, 0
  v_mov_b32 v175, 0
  v_mov_b32 v176, 0
  v_mov_b32 v177, 0
  v_mov_b32 v178, 0
  v_mov_b32 v179, 0
  v_mov_b32 v180, 0
  v_mov_b32 v181, 0
  v_mov_b32 v182, 0
  v_mov_b32 v183, 0
  v_mov_b32 v184, 0
  v_mov_b32 v185, 0
  v_mov_b32 v186, 0
  v_mov_b32 v187, 0
  v_mov_b32 v188, 0
  v_mov_b32 v189, 0
  v_mov_b32 v190, 0
  v_mov_b32 v191, 0
  v_mov_b32 v192, 0
  v_mov_b32 v193, 0
  v_mov_b32 v194, 0
  v_mov_b32 v195, 0
  v_mov_b32 v196, 0
  v_mov_b32 v197, 0
  v_mov_b32 v198, 0
  v_mov_b32 v199, 0
  v_mov_b32 v200, 0
  v_mov_b32 v201, 0
  v_mov_b32 v202, 0
  v_mov_b32 v203, 0
  v_mov_b32 v204, 0
  v_mov_b32 v205, 0
  v_mov_b32 v206, 0
  v_mov_b32 v207, 0
  v_mov_b32 v208, 0
  v_mov_b32 v209, 0
  v_mov_b32 v210, 0
  v_mov_b32 v211, 0
  v_mov_b32 v212, 0
  v_mov_b32 v213, 0
  v_mov_b32 v214, 0
  v_mov_b32 v215, 0
  v_mov_b32 v216, 0
  v_mov_b32 v217, 0
  v_mov_b32 v218, 0
  v_mov_b32 v219, 0
  v_mov_b32 v220, 0
  v_mov_b32 v221, 0
  v_mov_b32 v222, 0
  v_mov_b32 v223, 0
  v_mov_b32 v224, 0
  v_mov_b32 v225, 0
  v_mov_b32 v226, 0
  v_mov_b32 v227, 0
  v_mov_b32 v228, 0
  v_mov_b32 v229, 0
  v_mov_b32 v230, 0
  v_mov_b32 v231, 0
  v_mov_b32 v232, 0
  v_mov_b32 v233, 0
  v_mov_b32 v234, 0
  v_mov_b32 v235, 0
  v_mov_b32 v240, 0
  v_mov_b32 v241, 0
  v_mov_b32 v242, 0
  v_mov_b32 v243, 0
  v_mov_b32 v244, 0
  v_mov_b32 v245, 0
  v_mov_b32 v246, 0
  v_mov_b32 v247, 0
  v_mov_b32 v248, 0
  v_mov_b32 v249, 0
  v_mov_b32 v250, 0
  v_mov_b32 v251, 0
  v_mov_b32 v252, 0
  v_mov_b32 v253, 0
  v_mov_b32 v254, 0
  v_mov_b32 v255, 0
  s_waitcnt lgkmcnt(0)
  s_mov_b32 s44, s34
  s_and_b32 s45, s35, 0xffff
  s_mov_b32 s46, 4194304
  s_mov_b32 s47, 0x00020000
  s_mov_b32 s75, 0
  v_add_u32_e64 v10, s75, v4
  v_add_u32_e64 v11, s75, v5
  v_add_u32_e64 v12, s75, v6
  v_add_u32_e64 v13, s75, v7
  v_add_u32_e64 v14, s75, v8
  v_add_u32_e64 v15, s75, v9
  s_add_u32 s75, s75, 43008
  s_cmp_eq_u32 s75, 129024
  s_cselect_b32 s75, 0, s75
  s_mov_b32 s79, 16
  s_barrier
  ds_read_b128 v[32:35], v10 offset:0
  ds_read_b128 v[36:39], v10 offset:2048
  ds_read_b128 v[40:43], v10 offset:4096
  ds_read_b128 v[44:47], v10 offset:6144
  ds_read_b128 v[48:51], v14
  ds_read_b64_tr_b16 v[52:53], v12 offset:0
  ds_read_b64_tr_b16 v[54:55], v12 offset:512
  ds_read_b64_tr_b16 v[56:57], v13 offset:0
  ds_read_b64_tr_b16 v[58:59], v13 offset:512
  ds_read_b64_tr_b16 v[60:61], v12 offset:8192
  ds_read_b64_tr_b16 v[62:63], v12 offset:8704
  ds_read_b64_tr_b16 v[64:65], v13 offset:8192
  ds_read_b64_tr_b16 v[66:67], v13 offset:8704
  ds_read_b64_tr_b16 v[68:69], v12 offset:16384
  ds_read_b64_tr_b16 v[70:71], v12 offset:16896
  ds_read_b64_tr_b16 v[72:73], v13 offset:16384
  ds_read_b64_tr_b16 v[74:75], v13 offset:16896
  s_waitcnt lgkmcnt(0)
  s_cmp_lg_u32 s96, 0
  s_cbranch_scc1 L_attn_loop
  s_cmp_lg_u32 s72, 0
  s_cbranch_scc1 L_attn_loopb
.p2align 3
L_attn_loopa:
  v_mfma_f32_16x16x32_bf16 v[240:243], v[236:239], v[32:35], v[240:243]
  ds_read_b128 v[76:79], v11 offset:0
  v_mfma_f32_16x16x32_bf16 v[244:247], v[32:35], v[32:35], v[244:247]
  ds_read_b128 v[80:83], v11 offset:2048
  v_mfma_f32_16x16x32_bf16 v[248:251], v[236:239], v[36:39], v[248:251]
  ds_read_b128 v[84:87], v11 offset:4096
  v_mfma_f32_16x16x32_bf16 v[252:255], v[36:39], v[36:39], v[252:255]
  ds_read_b128 v[88:91], v11 offset:6144
  v_mfma_f32_16x16x32_bf16 v[120:123], v[236:239], v[48:51], v[120:123]
  ds_read_b128 v[92:95], v15
  v_mfma_f32_16x16x32_bf16 v[124:127], v[48:51], v[48:51], v[124:127]
  ds_read_b64_tr_b16 v[96:97], v12 offset:4096
  v_mfma_f32_16x16x32_bf16 v[128:131], v[52:55], v[32:35], v[128:131]
  ds_read_b64_tr_b16 v[98:99], v12 offset:4608
  v_mfma_f32_16x16x32_bf16 v[132:135], v[52:55], v[36:39], v[132:135]
  ds_read_b64_tr_b16 v[100:101], v13 offset:4096
  v_mfma_f32_16x16x32_bf16 v[136:139], v[52:55], v[40:43], v[136:139]
  ds_read_b64_tr_b16 v[102:103], v13 offset:4608
  v_mfma_f32_16x16x32_bf16 v[140:143], v[52:55], v[44:47], v[140:143]
  ds_read_b64_tr_b16 v[104:105], v12 offset:12288
  v_mfma_f32_16x16x32_bf16 v[224:227], v[52:55], v[48:51], v[224:227]
  ds_read_b64_tr_b16 v[106:107], v12 offset:12800
  v_mfma_f32_16x16x32_bf16 v[144:147], v[56:59], v[32:35], v[144:147]
  ds_read_b64_tr_b16 v[108:109], v13 offset:12288
  v_mfma_f32_16x16x32_bf16 v[148:151], v[56:59], v[36:39], v[148:151]
  ds_read_b64_tr_b16 v[110:111], v13 offset:12800
  v_mfma_f32_16x16x32_bf16 v[152:155], v[56:59], v[40:43], v[152:155]
  ds_read_b64_tr_b16 v[112:113], v12 offset:20480
  v_mfma_f32_16x16x32_bf16 v[156:159], v[56:59], v[44:47], v[156:159]
  ds_read_b64_tr_b16 v[114:115], v12 offset:20992
  v_mfma_f32_16x16x32_bf16 v[160:163], v[60:63], v[32:35], v[160:163]
  ds_read_b64_tr_b16 v[116:117], v13 offset:20480
  v_mfma_f32_16x16x32_bf16 v[164:167], v[60:63], v[36:39], v[164:167]
  ds_read_b64_tr_b16 v[118:119], v13 offset:20992
  v_mfma_f32_16x16x32_bf16 v[168:171], v[60:63], v[40:43], v[168:171]
  v_add_u32_e64 v10, s75, v4
  v_mfma_f32_16x16x32_bf16 v[172:175], v[60:63], v[44:47], v[172:175]
  v_add_u32_e64 v11, s75, v5
  v_mfma_f32_16x16x32_bf16 v[228:231], v[60:63], v[48:51], v[228:231]
  v_add_u32_e64 v12, s75, v6
  v_mfma_f32_16x16x32_bf16 v[176:179], v[64:67], v[32:35], v[176:179]
  v_add_u32_e64 v13, s75, v7
  v_mfma_f32_16x16x32_bf16 v[180:183], v[64:67], v[36:39], v[180:183]
  v_add_u32_e64 v14, s75, v8
  v_mfma_f32_16x16x32_bf16 v[184:187], v[64:67], v[40:43], v[184:187]
  v_add_u32_e64 v15, s75, v9
  v_mfma_f32_16x16x32_bf16 v[188:191], v[64:67], v[44:47], v[188:191]
  s_add_u32 s75, s75, 43008
  v_mfma_f32_16x16x32_bf16 v[192:195], v[32:35], v[68:71], v[192:195]
  s_cmp_eq_u32 s75, 129024
  v_mfma_f32_16x16x32_bf16 v[196:199], v[36:39], v[68:71], v[196:199]
  s_cselect_b32 s75, 0, s75
  s_sub_u32 s79, s79, 1
  v_mfma_f32_16x16x32_bf16 v[200:203], v[40:43], v[68:71], v[200:203]
  v_mfma_f32_16x16x32_bf16 v[204:207], v[44:47], v[68:71], v[204:207]
  v_mfma_f32_16x16x32_bf16 v[232:235], v[48:51], v[68:71], v[232:235]
  v_mfma_f32_16x16x32_bf16 v[208:211], v[32:35], v[72:75], v[208:211]
  v_mfma_f32_16x16x32_bf16 v[212:215], v[36:39], v[72:75], v[212:215]
  v_mfma_f32_16x16x32_bf16 v[216:219], v[40:43], v[72:75], v[216:219]
  v_mfma_f32_16x16x32_bf16 v[220:223], v[44:47], v[72:75], v[220:223]
  s_waitcnt lgkmcnt(0)
  s_barrier
  v_mfma_f32_16x16x32_bf16 v[240:243], v[236:239], v[76:79], v[240:243]
  ds_read_b128 v[32:35], v10 offset:0
  v_mfma_f32_16x16x32_bf16 v[244:247], v[76:79], v[76:79], v[244:247]
  ds_read_b128 v[36:39], v10 offset:2048
  v_mfma_f32_16x16x32_bf16 v[248:251], v[236:239], v[80:83], v[248:251]
  ds_read_b128 v[40:43], v10 offset:4096
  v_mfma_f32_16x16x32_bf16 v[252:255], v[80:83], v[80:83], v[252:255]
  ds_read_b128 v[44:47], v10 offset:6144
  v_mfma_f32_16x16x32_bf16 v[120:123], v[236:239], v[92:95], v[120:123]
  ds_read_b128 v[48:51], v14
  v_mfma_f32_16x16x32_bf16 v[124:127], v[92:95], v[92:95], v[124:127]
  ds_read_b64_tr_b16 v[52:53], v12 offset:0
  v_mfma_f32_16x16x32_bf16 v[128:131], v[96:99], v[76:79], v[128:131]
  ds_read_b64_tr_b16 v[54:55], v12 offset:512
  v_mfma_f32_16x16x32_bf16 v[132:135], v[96:99], v[80:83], v[132:135]
  ds_read_b64_tr_b16 v[56:57], v13 offset:0
  v_mfma_f32_16x16x32_bf16 v[136:139], v[96:99], v[84:87], v[136:139]
  ds_read_b64_tr_b16 v[58:59], v13 offset:512
  v_mfma_f32_16x16x32_bf16 v[140:143], v[96:99], v[88:91], v[140:143]
  ds_read_b64_tr_b16 v[60:61], v12 offset:8192
  v_mfma_f32_16x16x32_bf16 v[224:227], v[96:99], v[92:95], v[224:227]
  ds_read_b64_tr_b16 v[62:63], v12 offset:8704
  v_mfma_f32_16x16x32_bf16 v[144:147], v[100:103], v[76:79], v[144:147]
  ds_read_b64_tr_b16 v[64:65], v13 offset:8192
  v_mfma_f32_16x16x32_bf16 v[148:151], v[100:103], v[80:83], v[148:151]
  ds_read_b64_tr_b16 v[66:67], v13 offset:8704
  v_mfma_f32_16x16x32_bf16 v[152:155], v[100:103], v[84:87], v[152:155]
  ds_read_b64_tr_b16 v[68:69], v12 offset:16384
  v_mfma_f32_16x16x32_bf16 v[156:159], v[100:103], v[88:91], v[156:159]
  ds_read_b64_tr_b16 v[70:71], v12 offset:16896
  v_mfma_f32_16x16x32_bf16 v[160:163], v[104:107], v[76:79], v[160:163]
  ds_read_b64_tr_b16 v[72:73], v13 offset:16384
  v_mfma_f32_16x16x32_bf16 v[164:167], v[104:107], v[80:83], v[164:167]
  ds_read_b64_tr_b16 v[74:75], v13 offset:16896
  v_mfma_f32_16x16x32_bf16 v[168:171], v[104:107], v[84:87], v[168:171]
  s_cmp_lg_u32 s79, 0
  s_nop 0
  v_mfma_f32_16x16x32_bf16 v[172:175], v[104:107], v[88:91], v[172:175]
  v_mfma_f32_16x16x32_bf16 v[228:231], v[104:107], v[92:95], v[228:231]
  v_mfma_f32_16x16x32_bf16 v[176:179], v[108:111], v[76:79], v[176:179]
  v_mfma_f32_16x16x32_bf16 v[180:183], v[108:111], v[80:83], v[180:183]
  v_mfma_f32_16x16x32_bf16 v[184:187], v[108:111], v[84:87], v[184:187]
  v_mfma_f32_16x16x32_bf16 v[188:191], v[108:111], v[88:91], v[188:191]
  v_mfma_f32_16x16x32_bf16 v[192:195], v[76:79], v[112:115], v[192:195]
  v_mfma_f32_16x16x32_bf16 v[196:199], v[80:83], v[112:115], v[196:199]
  v_mfma_f32_16x16x32_bf16 v[200:203], v[84:87], v[112:115], v[200:203]
  v_mfma_f32_16x16x32_bf16 v[204:207], v[88:91], v[112:115], v[204:207]
  v_mfma_f32_16x16x32_bf16 v[232:235], v[92:95], v[112:115], v[232:235]
  v_mfma_f32_16x16x32_bf16 v[208:211], v[76:79], v[116:119], v[208:211]
  v_mfma_f32_16x16x32_bf16 v[212:215], v[80:83], v[116:119], v[212:215]
  v_mfma_f32_16x16x32_bf16 v[216:219], v[84:87], v[116:119], v[216:219]
  v_mfma_f32_16x16x32_bf16 v[220:223], v[88:91], v[116:119], v[220:223]
  s_waitcnt lgkmcnt(0)
  s_cbranch_scc1 L_attn_loopa
  s_branch L_attn_post
.p2align 3
L_attn_loopb:
  v_mfma_f32_16x16x32_bf16 v[240:243], v[236:239], v[40:43], v[240:243]
  ds_read_b128 v[76:79], v11 offset:0
  v_mfma_f32_16x16x32_bf16 v[244:247], v[40:43], v[40:43], v[244:247]
  ds_read_b128 v[80:83], v11 offset:2048
  v_mfma_f32_16x16x32_bf16 v[248:251], v[236:239], v[44:47], v[248:251]
  ds_read_b128 v[84:87], v11 offset:4096
  v_mfma_f32_16x16x32_bf16 v[252:255], v[44:47], v[44:47], v[252:255]
  ds_read_b128 v[88:91], v11 offset:6144
  v_mfma_f32_16x16x32_bf16 v[128:131], v[52:55], v[32:35], v[128:131]
  ds_read_b128 v[92:95], v15
  v_mfma_f32_16x16x32_bf16 v[132:135], v[52:55], v[36:39], v[132:135]
  ds_read_b64_tr_b16 v[96:97], v12 offset:4096
  v_mfma_f32_16x16x32_bf16 v[136:139], v[52:55], v[40:43], v[136:139]
  ds_read_b64_tr_b16 v[98:99], v12 offset:4608
  v_mfma_f32_16x16x32_bf16 v[140:143], v[52:55], v[44:47], v[140:143]
  ds_read_b64_tr_b16 v[100:101], v13 offset:4096
  v_mfma_f32_16x16x32_bf16 v[224:227], v[52:55], v[48:51], v[224:227]
  ds_read_b64_tr_b16 v[102:103], v13 offset:4608
  v_mfma_f32_16x16x32_bf16 v[144:147], v[56:59], v[32:35], v[144:147]
  ds_read_b64_tr_b16 v[104:105], v12 offset:12288
  v_mfma_f32_16x16x32_bf16 v[148:151], v[56:59], v[36:39], v[148:151]
  ds_read_b64_tr_b16 v[106:107], v12 offset:12800
  v_mfma_f32_16x16x32_bf16 v[152:155], v[56:59], v[40:43], v[152:155]
  ds_read_b64_tr_b16 v[108:109], v13 offset:12288
  v_mfma_f32_16x16x32_bf16 v[156:159], v[56:59], v[44:47], v[156:159]
  ds_read_b64_tr_b16 v[110:111], v13 offset:12800
  v_mfma_f32_16x16x32_bf16 v[160:163], v[60:63], v[32:35], v[160:163]
  ds_read_b64_tr_b16 v[112:113], v12 offset:20480
  v_mfma_f32_16x16x32_bf16 v[164:167], v[60:63], v[36:39], v[164:167]
  ds_read_b64_tr_b16 v[114:115], v12 offset:20992
  v_mfma_f32_16x16x32_bf16 v[168:171], v[60:63], v[40:43], v[168:171]
  ds_read_b64_tr_b16 v[116:117], v13 offset:20480
  v_mfma_f32_16x16x32_bf16 v[172:175], v[60:63], v[44:47], v[172:175]
  ds_read_b64_tr_b16 v[118:119], v13 offset:20992
  v_mfma_f32_16x16x32_bf16 v[228:231], v[60:63], v[48:51], v[228:231]
  v_add_u32_e64 v10, s75, v4
  v_mfma_f32_16x16x32_bf16 v[176:179], v[64:67], v[32:35], v[176:179]
  v_add_u32_e64 v11, s75, v5
  v_mfma_f32_16x16x32_bf16 v[180:183], v[64:67], v[36:39], v[180:183]
  v_add_u32_e64 v12, s75, v6
  v_mfma_f32_16x16x32_bf16 v[184:187], v[64:67], v[40:43], v[184:187]
  v_add_u32_e64 v13, s75, v7
  v_mfma_f32_16x16x32_bf16 v[188:191], v[64:67], v[44:47], v[188:191]
  v_add_u32_e64 v14, s75, v8
  v_mfma_f32_16x16x32_bf16 v[192:195], v[32:35], v[68:71], v[192:195]
  v_add_u32_e64 v15, s75, v9
  v_mfma_f32_16x16x32_bf16 v[196:199], v[36:39], v[68:71], v[196:199]
  s_add_u32 s75, s75, 43008
  v_mfma_f32_16x16x32_bf16 v[200:203], v[40:43], v[68:71], v[200:203]
  s_cmp_eq_u32 s75, 129024
  v_mfma_f32_16x16x32_bf16 v[204:207], v[44:47], v[68:71], v[204:207]
  s_cselect_b32 s75, 0, s75
  s_sub_u32 s79, s79, 1
  v_mfma_f32_16x16x32_bf16 v[232:235], v[48:51], v[68:71], v[232:235]
  v_mfma_f32_16x16x32_bf16 v[208:211], v[32:35], v[72:75], v[208:211]
  v_mfma_f32_16x16x32_bf16 v[212:215], v[36:39], v[72:75], v[212:215]
  v_mfma_f32_16x16x32_bf16 v[216:219], v[40:43], v[72:75], v[216:219]
  v_mfma_f32_16x16x32_bf16 v[220:223], v[44:47], v[72:75], v[220:223]
  s_waitcnt lgkmcnt(0)
  s_barrier
  v_mfma_f32_16x16x32_bf16 v[240:243], v[236:239], v[84:87], v[240:243]
  ds_read_b128 v[32:35], v10 offset:0
  v_mfma_f32_16x16x32_bf16 v[244:247], v[84:87], v[84:87], v[244:247]
  ds_read_b128 v[36:39], v10 offset:2048
  v_mfma_f32_16x16x32_bf16 v[248:251], v[236:239], v[88:91], v[248:251]
  ds_read_b128 v[40:43], v10 offset:4096
  v_mfma_f32_16x16x32_bf16 v[252:255], v[88:91], v[88:91], v[252:255]
  ds_read_b128 v[44:47], v10 offset:6144
  v_mfma_f32_16x16x32_bf16 v[128:131], v[96:99], v[76:79], v[128:131]
  ds_read_b128 v[48:51], v14
  v_mfma_f32_16x16x32_bf16 v[132:135], v[96:99], v[80:83], v[132:135]
  ds_read_b64_tr_b16 v[52:53], v12 offset:0
  v_mfma_f32_16x16x32_bf16 v[136:139], v[96:99], v[84:87], v[136:139]
  ds_read_b64_tr_b16 v[54:55], v12 offset:512
  v_mfma_f32_16x16x32_bf16 v[140:143], v[96:99], v[88:91], v[140:143]
  ds_read_b64_tr_b16 v[56:57], v13 offset:0
  v_mfma_f32_16x16x32_bf16 v[224:227], v[96:99], v[92:95], v[224:227]
  ds_read_b64_tr_b16 v[58:59], v13 offset:512
  v_mfma_f32_16x16x32_bf16 v[144:147], v[100:103], v[76:79], v[144:147]
  ds_read_b64_tr_b16 v[60:61], v12 offset:8192
  v_mfma_f32_16x16x32_bf16 v[148:151], v[100:103], v[80:83], v[148:151]
  ds_read_b64_tr_b16 v[62:63], v12 offset:8704
  v_mfma_f32_16x16x32_bf16 v[152:155], v[100:103], v[84:87], v[152:155]
  ds_read_b64_tr_b16 v[64:65], v13 offset:8192
  v_mfma_f32_16x16x32_bf16 v[156:159], v[100:103], v[88:91], v[156:159]
  ds_read_b64_tr_b16 v[66:67], v13 offset:8704
  v_mfma_f32_16x16x32_bf16 v[160:163], v[104:107], v[76:79], v[160:163]
  ds_read_b64_tr_b16 v[68:69], v12 offset:16384
  v_mfma_f32_16x16x32_bf16 v[164:167], v[104:107], v[80:83], v[164:167]
  ds_read_b64_tr_b16 v[70:71], v12 offset:16896
  v_mfma_f32_16x16x32_bf16 v[168:171], v[104:107], v[84:87], v[168:171]
  ds_read_b64_tr_b16 v[72:73], v13 offset:16384
  v_mfma_f32_16x16x32_bf16 v[172:175], v[104:107], v[88:91], v[172:175]
  ds_read_b64_tr_b16 v[74:75], v13 offset:16896
  v_mfma_f32_16x16x32_bf16 v[228:231], v[104:107], v[92:95], v[228:231]
  s_cmp_lg_u32 s79, 0
  s_nop 0
  v_mfma_f32_16x16x32_bf16 v[176:179], v[108:111], v[76:79], v[176:179]
  v_mfma_f32_16x16x32_bf16 v[180:183], v[108:111], v[80:83], v[180:183]
  v_mfma_f32_16x16x32_bf16 v[184:187], v[108:111], v[84:87], v[184:187]
  v_mfma_f32_16x16x32_bf16 v[188:191], v[108:111], v[88:91], v[188:191]
  v_mfma_f32_16x16x32_bf16 v[192:195], v[76:79], v[112:115], v[192:195]
  v_mfma_f32_16x16x32_bf16 v[196:199], v[80:83], v[112:115], v[196:199]
  v_mfma_f32_16x16x32_bf16 v[200:203], v[84:87], v[112:115], v[200:203]
  v_mfma_f32_16x16x32_bf16 v[204:207], v[88:91], v[112:115], v[204:207]
  v_mfma_f32_16x16x32_bf16 v[232:235], v[92:95], v[112:115], v[232:235]
  v_mfma_f32_16x16x32_bf16 v[208:211], v[76:79], v[116:119], v[208:211]
  v_mfma_f32_16x16x32_bf16 v[212:215], v[80:83], v[116:119], v[212:215]
  v_mfma_f32_16x16x32_bf16 v[216:219], v[84:87], v[116:119], v[216:219]
  v_mfma_f32_16x16x32_bf16 v[220:223], v[88:91], v[116:119], v[220:223]
  s_waitcnt lgkmcnt(0)
  s_cbranch_scc1 L_attn_loopb
L_attn_post:
  v_and_b32 v32, 3, v1
  v_cmp_eq_u32 s[4:5], 1, v32
  v_cmp_eq_u32 s[6:7], 2, v32
  v_cmp_eq_u32 s[8:9], 3, v32
  v_bfe_u32 v33, v1, 2, 2
  v_lshrrev_b32 v34, 4, v1
  v_cmp_eq_u32 s[10:11], v33, v34
  s_lshl_b32 s3, s72, 7
  v_add_u32 v35, s3, v23
  v_and_b32 v36, 15, v1
  s_cmp_eq_u32 s70, 0
  s_cselect_b32 s3, 0, 576
  s_add_u32 s3, s3, 129024
  v_lshl_add_u32 v36, v36, 2, s3
  v_cndmask_b32 v241, v244, v245, s[4:5]
  v_cndmask_b32 v249, v252, v253, s[4:5]
  v_cndmask_b32 v121, v124, v125, s[4:5]
  v_cndmask_b32 v241, v241, v246, s[6:7]
  v_cndmask_b32 v249, v249, v254, s[6:7]
  v_cndmask_b32 v121, v121, v126, s[6:7]
  v_cndmask_b32 v241, v241, v247, s[8:9]
  v_cndmask_b32 v249, v249, v255, s[8:9]
  v_cndmask_b32 v121, v121, v127, s[8:9]
  v_mul_f32 v240, 0x3a800000, v240
  v_mul_f32 v241, 0x3a800000, v241
  v_fma_f32 v241, -v240, v240, v241
  v_max_f32 v241, 0, v241
  v_add_f32 v241, 0x3727c5ac, v241
  v_rsq_f32 v241, v241
  s_nop 0
  v_mul_f32 v248, 0x3a800000, v248
  v_mul_f32 v249, 0x3a800000, v249
  v_fma_f32 v249, -v248, v248, v249
  v_max_f32 v249, 0, v249
  v_add_f32 v249, 0x3727c5ac, v249
  v_rsq_f32 v249, v249
  s_nop 0
  v_mul_f32 v120, 0x3a800000, v120
  v_mul_f32 v121, 0x3a800000, v121
  v_fma_f32 v121, -v120, v120, v121
  v_max_f32 v121, 0, v121
  v_add_f32 v121, 0x3727c5ac, v121
  v_rsq_f32 v121, v121
  s_nop 0
  s_mov_b64 exec, s[10:11]
  ds_write2_b32 v35, v240, v241 offset0:16 offset1:176
  ds_write2_b32 v35, v248, v249 offset0:32 offset1:192
  ds_write2_b32 v36, v120, v121 offset0:0 offset1:160
  s_mov_b64 exec, -1
  s_waitcnt lgkmcnt(0)
  s_barrier
  s_branch L_attn_exit
.p2align 3
L_attn_loop:
  v_mfma_f32_16x16x32_bf16 v[128:131], v[52:55], v[32:35], v[128:131]
  ds_read_b128 v[76:79], v11 offset:0
  v_mfma_f32_16x16x32_bf16 v[132:135], v[52:55], v[36:39], v[132:135]
  ds_read_b128 v[80:83], v11 offset:2048
  v_mfma_f32_16x16x32_bf16 v[136:139], v[52:55], v[40:43], v[136:139]
  ds_read_b128 v[84:87], v11 offset:4096
  v_mfma_f32_16x16x32_bf16 v[140:143], v[52:55], v[44:47], v[140:143]
  ds_read_b128 v[88:91], v11 offset:6144
  v_mfma_f32_16x16x32_bf16 v[224:227], v[52:55], v[48:51], v[224:227]
  ds_read_b128 v[92:95], v15
  v_mfma_f32_16x16x32_bf16 v[144:147], v[56:59], v[32:35], v[144:147]
  ds_read_b64_tr_b16 v[96:97], v12 offset:4096
  v_mfma_f32_16x16x32_bf16 v[148:151], v[56:59], v[36:39], v[148:151]
  ds_read_b64_tr_b16 v[98:99], v12 offset:4608
  v_mfma_f32_16x16x32_bf16 v[152:155], v[56:59], v[40:43], v[152:155]
  ds_read_b64_tr_b16 v[100:101], v13 offset:4096
  v_mfma_f32_16x16x32_bf16 v[156:159], v[56:59], v[44:47], v[156:159]
  ds_read_b64_tr_b16 v[102:103], v13 offset:4608
  v_mfma_f32_16x16x32_bf16 v[160:163], v[60:63], v[32:35], v[160:163]
  ds_read_b64_tr_b16 v[104:105], v12 offset:12288
  v_mfma_f32_16x16x32_bf16 v[164:167], v[60:63], v[36:39], v[164:167]
  ds_read_b64_tr_b16 v[106:107], v12 offset:12800
  v_mfma_f32_16x16x32_bf16 v[168:171], v[60:63], v[40:43], v[168:171]
  ds_read_b64_tr_b16 v[108:109], v13 offset:12288
  v_mfma_f32_16x16x32_bf16 v[172:175], v[60:63], v[44:47], v[172:175]
  ds_read_b64_tr_b16 v[110:111], v13 offset:12800
  v_mfma_f32_16x16x32_bf16 v[228:231], v[60:63], v[48:51], v[228:231]
  ds_read_b64_tr_b16 v[112:113], v12 offset:20480
  v_mfma_f32_16x16x32_bf16 v[176:179], v[64:67], v[32:35], v[176:179]
  ds_read_b64_tr_b16 v[114:115], v12 offset:20992
  v_mfma_f32_16x16x32_bf16 v[180:183], v[64:67], v[36:39], v[180:183]
  ds_read_b64_tr_b16 v[116:117], v13 offset:20480
  v_mfma_f32_16x16x32_bf16 v[184:187], v[64:67], v[40:43], v[184:187]
  ds_read_b64_tr_b16 v[118:119], v13 offset:20992
  v_mfma_f32_16x16x32_bf16 v[188:191], v[64:67], v[44:47], v[188:191]
  v_add_u32_e64 v10, s75, v4
  v_mfma_f32_16x16x32_bf16 v[192:195], v[32:35], v[68:71], v[192:195]
  v_add_u32_e64 v11, s75, v5
  v_mfma_f32_16x16x32_bf16 v[196:199], v[36:39], v[68:71], v[196:199]
  v_add_u32_e64 v12, s75, v6
  v_mfma_f32_16x16x32_bf16 v[200:203], v[40:43], v[68:71], v[200:203]
  v_add_u32_e64 v13, s75, v7
  v_mfma_f32_16x16x32_bf16 v[204:207], v[44:47], v[68:71], v[204:207]
  v_add_u32_e64 v14, s75, v8
  v_mfma_f32_16x16x32_bf16 v[232:235], v[48:51], v[68:71], v[232:235]
  v_add_u32_e64 v15, s75, v9
  v_mfma_f32_16x16x32_bf16 v[208:211], v[32:35], v[72:75], v[208:211]
  s_add_u32 s75, s75, 43008
  v_mfma_f32_16x16x32_bf16 v[212:215], v[36:39], v[72:75], v[212:215]
  s_cmp_eq_u32 s75, 129024
  v_mfma_f32_16x16x32_bf16 v[216:219], v[40:43], v[72:75], v[216:219]
  s_cselect_b32 s75, 0, s75
  s_sub_u32 s79, s79, 1
  v_mfma_f32_16x16x32_bf16 v[220:223], v[44:47], v[72:75], v[220:223]
  s_waitcnt lgkmcnt(0)
  s_barrier
  v_mfma_f32_16x16x32_bf16 v[128:131], v[96:99], v[76:79], v[128:131]
  ds_read_b128 v[32:35], v10 offset:0
  v_mfma_f32_16x16x32_bf16 v[132:135], v[96:99], v[80:83], v[132:135]
  ds_read_b128 v[36:39], v10 offset:2048
  v_mfma_f32_16x16x32_bf16 v[136:139], v[96:99], v[84:87], v[136:139]
  ds_read_b128 v[40:43], v10 offset:4096
  v_mfma_f32_16x16x32_bf16 v[140:143], v[96:99], v[88:91], v[140:143]
  ds_read_b128 v[44:47], v10 offset:6144
  v_mfma_f32_16x16x32_bf16 v[224:227], v[96:99], v[92:95], v[224:227]
  ds_read_b128 v[48:51], v14
  v_mfma_f32_16x16x32_bf16 v[144:147], v[100:103], v[76:79], v[144:147]
  ds_read_b64_tr_b16 v[52:53], v12 offset:0
  v_mfma_f32_16x16x32_bf16 v[148:151], v[100:103], v[80:83], v[148:151]
  ds_read_b64_tr_b16 v[54:55], v12 offset:512
  v_mfma_f32_16x16x32_bf16 v[152:155], v[100:103], v[84:87], v[152:155]
  ds_read_b64_tr_b16 v[56:57], v13 offset:0
  v_mfma_f32_16x16x32_bf16 v[156:159], v[100:103], v[88:91], v[156:159]
  ds_read_b64_tr_b16 v[58:59], v13 offset:512
  v_mfma_f32_16x16x32_bf16 v[160:163], v[104:107], v[76:79], v[160:163]
  ds_read_b64_tr_b16 v[60:61], v12 offset:8192
  v_mfma_f32_16x16x32_bf16 v[164:167], v[104:107], v[80:83], v[164:167]
  ds_read_b64_tr_b16 v[62:63], v12 offset:8704
  v_mfma_f32_16x16x32_bf16 v[168:171], v[104:107], v[84:87], v[168:171]
  ds_read_b64_tr_b16 v[64:65], v13 offset:8192
  v_mfma_f32_16x16x32_bf16 v[172:175], v[104:107], v[88:91], v[172:175]
  ds_read_b64_tr_b16 v[66:67], v13 offset:8704
  v_mfma_f32_16x16x32_bf16 v[228:231], v[104:107], v[92:95], v[228:231]
  ds_read_b64_tr_b16 v[68:69], v12 offset:16384
  v_mfma_f32_16x16x32_bf16 v[176:179], v[108:111], v[76:79], v[176:179]
  ds_read_b64_tr_b16 v[70:71], v12 offset:16896
  v_mfma_f32_16x16x32_bf16 v[180:183], v[108:111], v[80:83], v[180:183]
  ds_read_b64_tr_b16 v[72:73], v13 offset:16384
  v_mfma_f32_16x16x32_bf16 v[184:187], v[108:111], v[84:87], v[184:187]
  ds_read_b64_tr_b16 v[74:75], v13 offset:16896
  v_mfma_f32_16x16x32_bf16 v[188:191], v[108:111], v[88:91], v[188:191]
  s_cmp_lg_u32 s79, 0
  s_nop 0
  v_mfma_f32_16x16x32_bf16 v[192:195], v[76:79], v[112:115], v[192:195]
  v_mfma_f32_16x16x32_bf16 v[196:199], v[80:83], v[112:115], v[196:199]
  v_mfma_f32_16x16x32_bf16 v[200:203], v[84:87], v[112:115], v[200:203]
  v_mfma_f32_16x16x32_bf16 v[204:207], v[88:91], v[112:115], v[204:207]
  v_mfma_f32_16x16x32_bf16 v[232:235], v[92:95], v[112:115], v[232:235]
  v_mfma_f32_16x16x32_bf16 v[208:211], v[76:79], v[116:119], v[208:211]
  v_mfma_f32_16x16x32_bf16 v[212:215], v[80:83], v[116:119], v[212:215]
  v_mfma_f32_16x16x32_bf16 v[216:219], v[84:87], v[116:119], v[216:219]
  v_mfma_f32_16x16x32_bf16 v[220:223], v[88:91], v[116:119], v[220:223]
  s_waitcnt lgkmcnt(0)
  s_cbranch_scc1 L_attn_loop
L_attn_exit:
  ds_read2_b32 v[66:67], v23 offset0:0 offset1:160
  ds_read2_b32 v[68:69], v23 offset0:16 offset1:176
  ds_read2_b32 v[70:71], v23 offset0:32 offset1:192
  ds_read2_b32 v[72:73], v23 offset0:48 offset1:208
  ds_read2_b32 v[74:75], v23 offset0:64 offset1:224
  ds_read2_b32 v[76:77], v25 offset0:0 offset1:16
  ds_read2_b32 v[80:81], v26 offset0:0 offset1:16
  ds_read2_b32 v[78:79], v25 offset0:32 offset1:48
  ds_read2_b32 v[82:83], v26 offset0:32 offset1:48
  ds_write_b128 v16, v[224:227] offset:0
  ds_write_b128 v16, v[228:231] offset:2048
  ds_write_b128 v16, v[232:235] offset:4096
  s_cmp_eq_u32 s71, 1
  s_cbranch_scc1 L_attn_nop3
  ds_write_b128 v16, v[172:175] offset:8192
  ds_write_b128 v16, v[188:191] offset:9216
  ds_write_b128 v16, v[204:207] offset:10240
  ds_write_b128 v16, v[220:223] offset:11264
L_attn_nop3:
  ds_read_b128 v[84:87], v24 offset:0
  ds_read_b128 v[104:107], v24 offset:640
  ds_read_b128 v[88:91], v24 offset:64
  ds_read_b128 v[108:111], v24 offset:704
  ds_read_b128 v[92:95], v24 offset:128
  ds_read_b128 v[112:115], v24 offset:768
  ds_read_b128 v[96:99], v24 offset:192
  ds_read_b128 v[116:119], v24 offset:832
  ds_read_b128 v[100:103], v24 offset:256
  ds_read_b128 v[120:123], v24 offset:896
  s_waitcnt lgkmcnt(10)
  s_barrier
  ds_read_b128 v[48:51], v19 offset:0
  ds_read_b128 v[52:55], v20 offset:1024
  ds_read_b128 v[56:59], v19 offset:2048
  ds_read_b128 v[60:63], v20 offset:3072
  ds_read_b32 v64, v21 offset:4096
  ds_read_b32 v65, v22 offset:5120
  ds_read_b128 v[32:35], v17 offset:2048
  ds_read_b128 v[36:39], v18 offset:3072
  ds_read_b128 v[40:43], v17 offset:4096
  ds_read_b128 v[44:47], v18 offset:5120
  v_mul_f32 v69, 0x3e8293ee, v69
  v_mul_f32 v71, 0x3e8293ee, v71
  v_mul_f32 v73, 0x3e8293ee, v73
  v_mul_f32 v75, 0x3e8293ee, v75
  v_mul_f32 v76, v76, v69
  v_mul_f32 v80, v80, v69
  v_mul_f32 v77, v77, v71
  v_mul_f32 v81, v81, v71
  v_mul_f32 v78, v78, v73
  v_mul_f32 v82, v82, v73
  v_mul_f32 v79, v79, v75
  v_mul_f32 v83, v83, v75
  s_waitcnt lgkmcnt(6)
  v_pk_fma_f32 v[128:129], v[48:49], v[68:69], v[128:129] op_sel:[0,0,0] op_sel_hi:[1,0,1] neg_lo:[0,1,0] neg_hi:[0,1,0]
  v_pk_fma_f32 v[130:131], v[50:51], v[68:69], v[130:131] op_sel:[0,0,0] op_sel_hi:[1,0,1] neg_lo:[0,1,0] neg_hi:[0,1,0]
  v_pk_fma_f32 v[144:145], v[52:53], v[68:69], v[144:145] op_sel:[0,0,0] op_sel_hi:[1,0,1] neg_lo:[0,1,0] neg_hi:[0,1,0]
  v_pk_fma_f32 v[146:147], v[54:55], v[68:69], v[146:147] op_sel:[0,0,0] op_sel_hi:[1,0,1] neg_lo:[0,1,0] neg_hi:[0,1,0]
  v_cvt_pk_bf16_f32 v128, v128, v129
  v_cvt_pk_bf16_f32 v129, v130, v131
  v_cvt_pk_bf16_f32 v130, v144, v145
  v_cvt_pk_bf16_f32 v131, v146, v147
  v_pk_fma_f32 v[160:161], v[56:57], v[68:69], v[160:161] op_sel:[0,0,0] op_sel_hi:[1,0,1] neg_lo:[0,1,0] neg_hi:[0,1,0]
  v_pk_fma_f32 v[162:163], v[58:59], v[68:69], v[162:163] op_sel:[0,0,0] op_sel_hi:[1,0,1] neg_lo:[0,1,0] neg_hi:[0,1,0]
  v_pk_fma_f32 v[176:177], v[60:61], v[68:69], v[176:177] op_sel:[0,0,0] op_sel_hi:[1,0,1] neg_lo:[0,1,0] neg_hi:[0,1,0]
  v_pk_fma_f32 v[178:179], v[62:63], v[68:69], v[178:179] op_sel:[0,0,0] op_sel_hi:[1,0,1] neg_lo:[0,1,0] neg_hi:[0,1,0]
  v_cvt_pk_bf16_f32 v160, v160, v161
  v_cvt_pk_bf16_f32 v161, v162, v163
  v_cvt_pk_bf16_f32 v162, v176, v177
  v_cvt_pk_bf16_f32 v163, v178, v179
  v_pk_fma_f32 v[132:133], v[48:49], v[70:71], v[132:133] op_sel:[0,0,0] op_sel_hi:[1,0,1] neg_lo:[0,1,0] neg_hi:[0,1,0]
  v_pk_fma_f32 v[134:135], v[50:51], v[70:71], v[134:135] op_sel:[0,0,0] op_sel_hi:[1,0,1] neg_lo:[0,1,0] neg_hi:[0,1,0]
  v_pk_fma_f32 v[148:149], v[52:53], v[70:71], v[148:149] op_sel:[0,0,0] op_sel_hi:[1,0,1] neg_lo:[0,1,0] neg_hi:[0,1,0]
  v_pk_fma_f32 v[150:151], v[54:55], v[70:71], v[150:151] op_sel:[0,0,0] op_sel_hi:[1,0,1] neg_lo:[0,1,0] neg_hi:[0,1,0]
  v_cvt_pk_bf16_f32 v132, v132, v133
  v_cvt_pk_bf16_f32 v133, v134, v135
  v_cvt_pk_bf16_f32 v134, v148, v149
  v_cvt_pk_bf16_f32 v135, v150, v151
  v_pk_fma_f32 v[164:165], v[56:57], v[70:71], v[164:165] op_sel:[0,0,0] op_sel_hi:[1,0,1] neg_lo:[0,1,0] neg_hi:[0,1,0]
  v_pk_fma_f32 v[166:167], v[58:59], v[70:71], v[166:167] op_sel:[0,0,0] op_sel_hi:[1,0,1] neg_lo:[0,1,0] neg_hi:[0,1,0]
  v_pk_fma_f32 v[180:181], v[60:61], v[70:71], v[180:181] op_sel:[0,0,0] op_sel_hi:[1,0,1] neg_lo:[0,1,0] neg_hi:[0,1,0]
  v_pk_fma_f32 v[182:183], v[62:63], v[70:71], v[182:183] op_sel:[0,0,0] op_sel_hi:[1,0,1] neg_lo:[0,1,0] neg_hi:[0,1,0]
  v_cvt_pk_bf16_f32 v164, v164, v165
  v_cvt_pk_bf16_f32 v165, v166, v167
  v_cvt_pk_bf16_f32 v166, v180, v181
  v_cvt_pk_bf16_f32 v167, v182, v183
  v_mfma_f32_16x16x32_bf16 v[144:147], v[160:163], v[128:131], 0
  v_pk_fma_f32 v[136:137], v[48:49], v[72:73], v[136:137] op_sel:[0,0,0] op_sel_hi:[1,0,1] neg_lo:[0,1,0] neg_hi:[0,1,0]
  v_pk_fma_f32 v[138:139], v[50:51], v[72:73], v[138:139] op_sel:[0,0,0] op_sel_hi:[1,0,1] neg_lo:[0,1,0] neg_hi:[0,1,0]
  v_pk_fma_f32 v[152:153], v[52:53], v[72:73], v[152:153] op_sel:[0,0,0] op_sel_hi:[1,0,1] neg_lo:[0,1,0] neg_hi:[0,1,0]
  v_pk_fma_f32 v[154:155], v[54:55], v[72:73], v[154:155] op_sel:[0,0,0] op_sel_hi:[1,0,1] neg_lo:[0,1,0] neg_hi:[0,1,0]
  v_cvt_pk_bf16_f32 v136, v136, v137
  v_cvt_pk_bf16_f32 v137, v138, v139
  v_cvt_pk_bf16_f32 v138, v152, v153
  v_cvt_pk_bf16_f32 v139, v154, v155
  v_pk_fma_f32 v[168:169], v[56:57], v[72:73], v[168:169] op_sel:[0,0,0] op_sel_hi:[1,0,1] neg_lo:[0,1,0] neg_hi:[0,1,0]
  v_pk_fma_f32 v[170:171], v[58:59], v[72:73], v[170:171] op_sel:[0,0,0] op_sel_hi:[1,0,1] neg_lo:[0,1,0] neg_hi:[0,1,0]
  v_pk_fma_f32 v[184:185], v[60:61], v[72:73], v[184:185] op_sel:[0,0,0] op_sel_hi:[1,0,1] neg_lo:[0,1,0] neg_hi:[0,1,0]
  v_pk_fma_f32 v[186:187], v[62:63], v[72:73], v[186:187] op_sel:[0,0,0] op_sel_hi:[1,0,1] neg_lo:[0,1,0] neg_hi:[0,1,0]
  v_cvt_pk_bf16_f32 v168, v168, v169
  v_cvt_pk_bf16_f32 v169, v170, v171
  v_cvt_pk_bf16_f32 v170, v184, v185
  v_cvt_pk_bf16_f32 v171, v186, v187
  v_mfma_f32_16x16x32_bf16 v[148:151], v[164:167], v[132:135], 0
  v_mfma_f32_16x16x32_bf16 v[180:183], v[160:163], v[132:135], 0
  v_pk_fma_f32 v[140:141], v[48:49], v[74:75], v[140:141] op_sel:[0,0,0] op_sel_hi:[1,0,1] neg_lo:[0,1,0] neg_hi:[0,1,0]
  v_pk_fma_f32 v[142:143], v[50:51], v[74:75], v[142:143] op_sel:[0,0,0] op_sel_hi:[1,0,1] neg_lo:[0,1,0] neg_hi:[0,1,0]
  v_pk_fma_f32 v[156:157], v[52:53], v[74:75], v[156:157] op_sel:[0,0,0] op_sel_hi:[1,0,1] neg_lo:[0,1,0] neg_hi:[0,1,0]
  v_pk_fma_f32 v[158:159], v[54:55], v[74:75], v[158:159] op_sel:[0,0,0] op_sel_hi:[1,0,1] neg_lo:[0,1,0] neg_hi:[0,1,0]
  v_cvt_pk_bf16_f32 v140, v140, v141
  v_cvt_pk_bf16_f32 v141, v142, v143
  v_cvt_pk_bf16_f32 v142, v156, v157
  v_cvt_pk_bf16_f32 v143, v158, v159
  v_pk_fma_f32 v[172:173], v[56:57], v[74:75], v[172:173] op_sel:[0,0,0] op_sel_hi:[1,0,1] neg_lo:[0,1,0] neg_hi:[0,1,0]
  v_pk_fma_f32 v[174:175], v[58:59], v[74:75], v[174:175] op_sel:[0,0,0] op_sel_hi:[1,0,1] neg_lo:[0,1,0] neg_hi:[0,1,0]
  v_pk_fma_f32 v[188:189], v[60:61], v[74:75], v[188:189] op_sel:[0,0,0] op_sel_hi:[1,0,1] neg_lo:[0,1,0] neg_hi:[0,1,0]
  v_pk_fma_f32 v[190:191], v[62:63], v[74:75], v[190:191] op_sel:[0,0,0] op_sel_hi:[1,0,1] neg_lo:[0,1,0] neg_hi:[0,1,0]
  v_cvt_pk_bf16_f32 v172, v172, v173
  v_cvt_pk_bf16_f32 v173, v174, v175
  v_cvt_pk_bf16_f32 v174, v188, v189
  v_cvt_pk_bf16_f32 v175, v190, v191
  s_waitcnt lgkmcnt(0)
  v_pk_fma_f32 v[32:33], v[56:57], v[66:67], v[32:33] op_sel:[0,0,0] op_sel_hi:[1,0,1] neg_lo:[0,1,0] neg_hi:[0,1,0]
  v_pk_fma_f32 v[34:35], v[58:59], v[66:67], v[34:35] op_sel:[0,0,0] op_sel_hi:[1,0,1] neg_lo:[0,1,0] neg_hi:[0,1,0]
  v_pk_fma_f32 v[36:37], v[60:61], v[66:67], v[36:37] op_sel:[0,0,0] op_sel_hi:[1,0,1] neg_lo:[0,1,0] neg_hi:[0,1,0]
  v_pk_fma_f32 v[38:39], v[62:63], v[66:67], v[38:39] op_sel:[0,0,0] op_sel_hi:[1,0,1] neg_lo:[0,1,0] neg_hi:[0,1,0]
  v_cvt_pk_bf16_f32 v32, v32, v33
  v_cvt_pk_bf16_f32 v33, v34, v35
  v_cvt_pk_bf16_f32 v34, v36, v37
  v_cvt_pk_bf16_f32 v35, v38, v39
  v_mfma_f32_16x16x32_bf16 v[152:155], v[168:171], v[136:139], 0
  v_mfma_f32_16x16x32_bf16 v[184:187], v[164:167], v[136:139], 0
  v_mfma_f32_16x16x32_bf16 v[156:159], v[172:175], v[140:143], 0
  v_mfma_f32_16x16x32_bf16 v[188:191], v[168:171], v[140:143], 0
  v_mfma_f32_16x16x32_bf16 v[176:179], v[32:35], v[128:131], 0
  v_pk_fma_f32 v[40:41], v[84:85], v[64:65], v[40:41] op_sel:[0,0,0] op_sel_hi:[1,0,1] neg_lo:[1,0,0] neg_hi:[1,0,0]
  v_pk_fma_f32 v[42:43], v[86:87], v[64:65], v[42:43] op_sel:[0,0,0] op_sel_hi:[1,0,1] neg_lo:[1,0,0] neg_hi:[1,0,0]
  v_pk_mul_f32 v[40:41], v[40:41], v[104:105]
  v_pk_mul_f32 v[42:43], v[42:43], v[106:107]
  v_cvt_pk_bf16_f32 v240, v40, v41
  v_cvt_pk_bf16_f32 v241, v42, v43
  v_pk_fma_f32 v[192:193], v[88:89], v[64:65], v[192:193] op_sel:[0,0,0] op_sel_hi:[1,0,1] neg_lo:[1,0,0] neg_hi:[1,0,0]
  v_pk_fma_f32 v[194:195], v[90:91], v[64:65], v[194:195] op_sel:[0,0,0] op_sel_hi:[1,0,1] neg_lo:[1,0,0] neg_hi:[1,0,0]
  v_pk_mul_f32 v[192:193], v[192:193], v[108:109]
  v_pk_mul_f32 v[194:195], v[194:195], v[110:111]
  v_cvt_pk_bf16_f32 v242, v192, v193
  v_cvt_pk_bf16_f32 v243, v194, v195
  v_pk_fma_f32 v[196:197], v[92:93], v[64:65], v[196:197] op_sel:[0,0,0] op_sel_hi:[1,0,1] neg_lo:[1,0,0] neg_hi:[1,0,0]
  v_pk_fma_f32 v[198:199], v[94:95], v[64:65], v[198:199] op_sel:[0,0,0] op_sel_hi:[1,0,1] neg_lo:[1,0,0] neg_hi:[1,0,0]
  v_pk_mul_f32 v[196:197], v[196:197], v[112:113]
  v_pk_mul_f32 v[198:199], v[198:199], v[114:115]
  v_cvt_pk_bf16_f32 v244, v196, v197
  v_cvt_pk_bf16_f32 v245, v198, v199
  v_pk_fma_f32 v[200:201], v[96:97], v[64:65], v[200:201] op_sel:[0,0,0] op_sel_hi:[1,0,1] neg_lo:[1,0,0] neg_hi:[1,0,0]
  v_pk_fma_f32 v[202:203], v[98:99], v[64:65], v[202:203] op_sel:[0,0,0] op_sel_hi:[1,0,1] neg_lo:[1,0,0] neg_hi:[1,0,0]
  v_pk_mul_f32 v[200:201], v[200:201], v[116:117]
  v_pk_mul_f32 v[202:203], v[202:203], v[118:119]
  v_cvt_pk_bf16_f32 v246, v200, v201
  v_cvt_pk_bf16_f32 v247, v202, v203
  v_pk_fma_f32 v[204:205], v[100:101], v[64:65], v[204:205] op_sel:[0,0,0] op_sel_hi:[1,0,1] neg_lo:[1,0,0] neg_hi:[1,0,0]
  v_pk_fma_f32 v[206:207], v[102:103], v[64:65], v[206:207] op_sel:[0,0,0] op_sel_hi:[1,0,1] neg_lo:[1,0,0] neg_hi:[1,0,0]
  v_pk_mul_f32 v[204:205], v[204:205], v[120:121]
  v_pk_mul_f32 v[206:207], v[206:207], v[122:123]
  v_cvt_pk_bf16_f32 v248, v204, v205
  v_cvt_pk_bf16_f32 v249, v206, v207
  v_pk_fma_f32 v[44:45], v[84:85], v[64:65], v[44:45] op_sel:[0,1,0] op_sel_hi:[1,1,1] neg_lo:[1,0,0] neg_hi:[1,0,0]
  v_pk_fma_f32 v[46:47], v[86:87], v[64:65], v[46:47] op_sel:[0,1,0] op_sel_hi:[1,1,1] neg_lo:[1,0,0] neg_hi:[1,0,0]
  v_pk_mul_f32 v[44:45], v[44:45], v[104:105]
  v_pk_mul_f32 v[46:47], v[46:47], v[106:107]
  v_cvt_pk_bf16_f32 v224, v44, v45
  v_cvt_pk_bf16_f32 v225, v46, v47
  v_pk_fma_f32 v[208:209], v[88:89], v[64:65], v[208:209] op_sel:[0,1,0] op_sel_hi:[1,1,1] neg_lo:[1,0,0] neg_hi:[1,0,0]
  v_pk_fma_f32 v[210:211], v[90:91], v[64:65], v[210:211] op_sel:[0,1,0] op_sel_hi:[1,1,1] neg_lo:[1,0,0] neg_hi:[1,0,0]
  v_pk_mul_f32 v[208:209], v[208:209], v[108:109]
  v_pk_mul_f32 v[210:211], v[210:211], v[110:111]
  v_cvt_pk_bf16_f32 v226, v208, v209
  v_cvt_pk_bf16_f32 v227, v210, v211
  v_pk_fma_f32 v[212:213], v[92:93], v[64:65], v[212:213] op_sel:[0,1,0] op_sel_hi:[1,1,1] neg_lo:[1,0,0] neg_hi:[1,0,0]
  v_pk_fma_f32 v[214:215], v[94:95], v[64:65], v[214:215] op_sel:[0,1,0] op_sel_hi:[1,1,1] neg_lo:[1,0,0] neg_hi:[1,0,0]
  v_pk_mul_f32 v[212:213], v[212:213], v[112:113]
  v_pk_mul_f32 v[214:215], v[214:215], v[114:115]
  v_cvt_pk_bf16_f32 v228, v212, v213
  v_cvt_pk_bf16_f32 v229, v214, v215
  v_pk_fma_f32 v[216:217], v[96:97], v[64:65], v[216:217] op_sel:[0,1,0] op_sel_hi:[1,1,1] neg_lo:[1,0,0] neg_hi:[1,0,0]
  v_pk_fma_f32 v[218:219], v[98:99], v[64:65], v[218:219] op_sel:[0,1,0] op_sel_hi:[1,1,1] neg_lo:[1,0,0] neg_hi:[1,0,0]
  v_pk_mul_f32 v[216:217], v[216:217], v[116:117]
  v_pk_mul_f32 v[218:219], v[218:219], v[118:119]
  v_cvt_pk_bf16_f32 v230, v216, v217
  v_cvt_pk_bf16_f32 v231, v218, v219
  v_pk_fma_f32 v[220:221], v[100:101], v[64:65], v[220:221] op_sel:[0,1,0] op_sel_hi:[1,1,1] neg_lo:[1,0,0] neg_hi:[1,0,0]
  v_pk_fma_f32 v[222:223], v[102:103], v[64:65], v[222:223] op_sel:[0,1,0] op_sel_hi:[1,1,1] neg_lo:[1,0,0] neg_hi:[1,0,0]
  v_pk_mul_f32 v[220:221], v[220:221], v[120:121]
  v_pk_mul_f32 v[222:223], v[222:223], v[122:123]
  v_cvt_pk_bf16_f32 v232, v220, v221
  v_cvt_pk_bf16_f32 v233, v222, v223
  v_cndmask_b32 v148, v148, v149, s[48:49]
  v_cndmask_b32 v180, v180, v181, s[48:49]
  v_cndmask_b32 v150, v150, v151, s[48:49]
  v_cndmask_b32 v182, v182, v183, s[48:49]
  v_cndmask_b32 v36, v148, v180, s[50:51]
  v_cndmask_b32 v37, v150, v182, s[52:53]
  v_mul_f32 v36, v36, v77
  v_mul_f32 v37, v37, v81
  v_cndmask_b32 v152, v152, v153, s[48:49]
  v_cndmask_b32 v184, v184, v185, s[48:49]
  v_cndmask_b32 v154, v154, v155, s[48:49]
  v_cndmask_b32 v186, v186, v187, s[48:49]
  v_cndmask_b32 v40, v152, v184, s[50:51]
  v_cndmask_b32 v41, v154, v186, s[52:53]
  v_mul_f32 v40, v40, v78
  v_mul_f32 v41, v41, v82
  v_cndmask_b32 v156, v156, v157, s[48:49]
  v_cndmask_b32 v188, v188, v189, s[48:49]
  v_cndmask_b32 v158, v158, v159, s[48:49]
  v_cndmask_b32 v190, v190, v191, s[48:49]
  v_cndmask_b32 v44, v156, v188, s[50:51]
  v_cndmask_b32 v45, v158, v190, s[52:53]
  v_mul_f32 v44, v44, v79
  v_mul_f32 v45, v45, v83
  v_cndmask_b32 v144, v144, v145, s[48:49]
  v_cndmask_b32 v176, v176, v177, s[48:49]
  v_cndmask_b32 v146, v146, v147, s[48:49]
  v_cndmask_b32 v178, v178, v179, s[48:49]
  v_cndmask_b32 v32, v144, v176, s[50:51]
  v_cndmask_b32 v33, v146, v178, s[52:53]
  v_mul_f32 v32, v32, v76
  v_mul_f32 v33, v33, v80
  v_mov_b32 v48, 0xceabfb8f
  v_cndmask_b32 v32, v32, v48, s[54:55]
  v_cndmask_b32 v33, v33, v48, s[14:15]
  v_max_f32 v34, v32, v33
  v_max_f32 v38, v36, v37
  v_max_f32 v42, v40, v41
  v_max_f32 v46, v44, v45
  v_mov_b32 v35, v34
  v_mov_b32 v39, v38
  v_mov_b32 v43, v42
  v_mov_b32 v47, v46
  v_permlane32_swap_b32 v34, v35
  v_permlane32_swap_b32 v38, v39
  v_permlane32_swap_b32 v42, v43
  v_permlane32_swap_b32 v46, v47
  v_max_f32 v34, v34, v35
  v_max_f32 v38, v38, v39
  v_max_f32 v42, v42, v43
  v_max_f32 v46, v46, v47
  v_mov_b32 v35, v34
  v_mov_b32 v39, v38
  v_mov_b32 v43, v42
  v_mov_b32 v47, v46
  v_permlane16_swap_b32 v34, v35
  v_permlane16_swap_b32 v38, v39
  v_permlane16_swap_b32 v42, v43
  v_permlane16_swap_b32 v46, v47
  v_max_f32 v34, v34, v35
  v_max_f32 v38, v38, v39
  v_max_f32 v42, v42, v43
  v_max_f32 v46, v46, v47
  v_sub_f32 v32, v32, v34
  v_sub_f32 v33, v33, v34
  v_sub_f32 v36, v36, v38
  v_sub_f32 v37, v37, v38
  v_sub_f32 v40, v40, v42
  v_sub_f32 v41, v41, v42
  v_sub_f32 v44, v44, v46
  v_sub_f32 v45, v45, v46
  v_exp_f32 v32, v32
  v_exp_f32 v33, v33
  v_exp_f32 v36, v36
  v_exp_f32 v37, v37
  v_exp_f32 v40, v40
  v_exp_f32 v41, v41
  v_exp_f32 v44, v44
  v_exp_f32 v45, v45
  v_cvt_pk_bf16_f32 v32, v32, v32
  v_cvt_pk_bf16_f32 v33, v33, v33
  v_and_b32 v128, v32, v27
  v_and_b32 v129, v33, v29
  v_and_b32 v130, v32, v28
  v_and_b32 v131, v33, v30
  v_cvt_pk_bf16_f32 v36, v36, v36
  v_cvt_pk_bf16_f32 v37, v37, v37
  v_and_b32 v132, v36, v27
  v_and_b32 v133, v37, v29
  v_and_b32 v134, v36, v28
  v_and_b32 v135, v37, v30
  v_mfma_f32_16x16x32_bf16 v[144:147], v[236:239], v[128:131], 0
  v_mfma_f32_16x16x32_bf16 v[192:195], v[240:243], v[128:131], 0
  v_mfma_f32_16x16x32_bf16 v[208:211], v[224:227], v[128:131], 0
  v_cvt_pk_bf16_f32 v40, v40, v40
  v_cvt_pk_bf16_f32 v41, v41, v41
  v_and_b32 v136, v40, v27
  v_and_b32 v137, v41, v29
  v_and_b32 v138, v40, v28
  v_and_b32 v139, v41, v30
  v_mfma_f32_16x16x32_bf16 v[148:151], v[236:239], v[132:135], 0
  v_mfma_f32_16x16x32_bf16 v[196:199], v[242:245], v[132:135], 0
  v_mfma_f32_16x16x32_bf16 v[212:215], v[226:229], v[132:135], 0
  v_cvt_pk_bf16_f32 v44, v44, v44
  v_cvt_pk_bf16_f32 v45, v45, v45
  v_and_b32 v140, v44, v27
  v_and_b32 v141, v45, v29
  v_and_b32 v142, v44, v28
  v_and_b32 v143, v45, v30
  v_mfma_f32_16x16x32_bf16 v[152:155], v[236:239], v[136:139], 0
  v_mfma_f32_16x16x32_bf16 v[200:203], v[244:247], v[136:139], 0
  v_mfma_f32_16x16x32_bf16 v[216:219], v[228:231], v[136:139], 0
  v_mfma_f32_16x16x32_bf16 v[156:159], v[236:239], v[140:143], 0
  v_mfma_f32_16x16x32_bf16 v[204:207], v[246:249], v[140:143], 0
  v_mfma_f32_16x16x32_bf16 v[220:223], v[230:233], v[140:143], 0
  v_rcp_f32 v144, v144
  s_mov_b32 s3, 0
  v_pk_mul_f32 v[192:193], v[192:193], v[144:145] op_sel_hi:[1,0]
  v_pk_mul_f32 v[194:195], v[194:195], v[144:145] op_sel_hi:[1,0]
  v_pk_mul_f32 v[208:209], v[208:209], v[144:145] op_sel_hi:[1,0]
  v_pk_mul_f32 v[210:211], v[210:211], v[144:145] op_sel_hi:[1,0]
  v_cvt_pk_bf16_f32 v48, v192, v193
  v_cvt_pk_bf16_f32 v49, v194, v195
  v_cvt_pk_bf16_f32 v50, v208, v209
  v_cvt_pk_bf16_f32 v51, v210, v211
  s_nop 1
  v_permlane16_swap_b32 v48, v50
  v_permlane16_swap_b32 v49, v51
  buffer_store_dwordx4 v[48:51], v31, s[44:47], s3 offen sc1
  v_rcp_f32 v148, v148
  s_mov_b32 s3, 32768
  v_pk_mul_f32 v[196:197], v[196:197], v[148:149] op_sel_hi:[1,0]
  v_pk_mul_f32 v[198:199], v[198:199], v[148:149] op_sel_hi:[1,0]
  v_pk_mul_f32 v[212:213], v[212:213], v[148:149] op_sel_hi:[1,0]
  v_pk_mul_f32 v[214:215], v[214:215], v[148:149] op_sel_hi:[1,0]
  v_cvt_pk_bf16_f32 v52, v196, v197
  v_cvt_pk_bf16_f32 v53, v198, v199
  v_cvt_pk_bf16_f32 v54, v212, v213
  v_cvt_pk_bf16_f32 v55, v214, v215
  s_nop 1
  v_permlane16_swap_b32 v52, v54
  v_permlane16_swap_b32 v53, v55
  buffer_store_dwordx4 v[52:55], v31, s[44:47], s3 offen sc1
  v_rcp_f32 v152, v152
  s_mov_b32 s3, 65536
  v_pk_mul_f32 v[200:201], v[200:201], v[152:153] op_sel_hi:[1,0]
  v_pk_mul_f32 v[202:203], v[202:203], v[152:153] op_sel_hi:[1,0]
  v_pk_mul_f32 v[216:217], v[216:217], v[152:153] op_sel_hi:[1,0]
  v_pk_mul_f32 v[218:219], v[218:219], v[152:153] op_sel_hi:[1,0]
  v_cvt_pk_bf16_f32 v56, v200, v201
  v_cvt_pk_bf16_f32 v57, v202, v203
  v_cvt_pk_bf16_f32 v58, v216, v217
  v_cvt_pk_bf16_f32 v59, v218, v219
  s_nop 1
  v_permlane16_swap_b32 v56, v58
  v_permlane16_swap_b32 v57, v59
  buffer_store_dwordx4 v[56:59], v31, s[44:47], s3 offen sc1
  v_rcp_f32 v156, v156
  s_mov_b32 s3, 98304
  v_pk_mul_f32 v[204:205], v[204:205], v[156:157] op_sel_hi:[1,0]
  v_pk_mul_f32 v[206:207], v[206:207], v[156:157] op_sel_hi:[1,0]
  v_pk_mul_f32 v[220:221], v[220:221], v[156:157] op_sel_hi:[1,0]
  v_pk_mul_f32 v[222:223], v[222:223], v[156:157] op_sel_hi:[1,0]
  v_cvt_pk_bf16_f32 v60, v204, v205
  v_cvt_pk_bf16_f32 v61, v206, v207
  v_cvt_pk_bf16_f32 v62, v220, v221
  v_cvt_pk_bf16_f32 v63, v222, v223
  s_nop 1
  v_permlane16_swap_b32 v60, v62
  v_permlane16_swap_b32 v61, v63
  buffer_store_dwordx4 v[60:63], v31, s[44:47], s3 offen sc1
  s_endpgm
L_attn_loader:
  s_add_u32 s8, s70, s69
  s_and_b32 s8, s8, 3
  s_add_u32 s9, s70, s68
  s_and_b32 s9, s9, 3
  s_lshl_b32 s76, s8, 12
  s_lshl_b32 s77, s9, 11
  s_add_u32 s77, s77, 16384
  s_lshl_b32 s11, s68, 7
  v_and_b32 v10, 7, v1
  v_lshrrev_b32 v3, 3, v1
  s_lshr_b32 s10, s76, 7
  s_lshl_b32 s3, s68, 7
  s_add_u32 s10, s10, s3
  v_add_u32 v3, s10, v3
  v_mul_u32_u24 v3, 2048, v3
  v_lshrrev_b32 v2, 4, v1
  v_xor_b32 v4, v2, v10
  v_lshl_add_u32 v4, v4, 4, v3
  v_add_u32 v3, 16384, v3
  v_add_u32 v5, 4, v2
  v_xor_b32 v5, v5, v10
  v_lshl_add_u32 v5, v5, 4, v3
  v_add_u32 v3, 16384, v3
  v_xor_b32 v6, v2, v10
  v_lshl_add_u32 v6, v6, 4, v3
  v_add_u32 v3, 16384, v3
  v_add_u32 v7, 4, v2
  v_xor_b32 v7, v7, v10
  v_lshl_add_u32 v7, v7, 4, v3
  v_lshrrev_b32 v3, 3, v1
  s_lshl_b32 s10, s9, 4
  v_add_u32 v3, s10, v3
  v_mul_u32_u24 v3, 6144, v3
  v_lshrrev_b32 v2, 3, v1
  v_and_b32 v2, 2, v2
  v_xor_b32 v2, v2, v10
  s_mul_i32 s10, s69, 128
  v_add_u32 v3, s10, v3
  v_lshl_add_u32 v8, v2, 4, v3
  v_xor_b32 v2, 4, v2
  v_add_u32 v3, 49152, v3
  v_lshl_add_u32 v9, v2, 4, v3
  s_and_b32 s10, s70, 3
  s_lshl_b32 s78, s10, 9
  s_add_u32 s78, s78, 40960
  s_lshl_b32 s14, s10, 2
  s_add_u32 s14, s14, s11
  s_sub_u32 s14, s14, 16
  v_lshrrev_b32 v3, 3, v1
  v_add_u32 v3, s14, v3
  v_max_i32 v3, 0, v3
  v_mul_u32_u24 v3, 2048, v3
  s_lshl_b32 s14, s10, 1
  v_lshrrev_b32 v2, 4, v1
  v_add_u32 v2, s14, v2
  v_and_b32 v2, 7, v2
  v_xor_b32 v2, v2, v10
  v_lshl_add_u32 v28, v2, 4, v3
  s_cmp_eq_u32 s10, 0
  s_cselect_b32 s14, 0xffffff00, -1
  s_mov_b32 s15, 0
  s_mov_b32 s75, 0
  s_add_u32 s100, s68, s69
  s_mov_b32 s101, -1
  s_add_u32 s101, s101, 1
  s_sub_u32 s73, s101, s100
  s_lshl_b32 s73, s73, 3
  s_lshr_b32 s73, 0xf0f02, s73
  s_and_b32 s73, s73, 255
  s_add_u32 s73, s73, s101
  s_and_b32 s73, s73, 15
  s_mul_i32 s74, s73, 393216
  s_lshl_b32 s73, s73, 7
  s_waitcnt lgkmcnt(0)
  s_mov_b32 s36, s12
  s_and_b32 s37, s13, 0xffff
  s_mov_b32 s38, 4194304
  s_mov_b32 s39, 0x00020000
  s_mov_b32 s40, s18
  s_and_b32 s41, s19, 0xffff
  s_mov_b32 s42, 6291456
  s_mov_b32 s43, 0x00020000
  s_cmp_eq_u32 s96, 0
  s_cbranch_scc1 L_attn_ld0
  s_add_u32 s56, s34, 24117248
  s_addc_u32 s57, s35, 0
  s_and_b32 s57, s57, 0xffff
  s_mov_b32 s58, 262144
  s_mov_b32 s59, 0x00020000
  s_add_u32 s3, s75, s76
  s_add_u32 m0, s3, 0
  s_nop 0
  buffer_load_dwordx4 v4, s[36:39], s73 offen lds
  s_add_u32 m0, s3, 1024
  s_nop 0
  buffer_load_dwordx4 v5, s[36:39], s73 offen lds
  s_add_u32 m0, s3, 2048
  s_nop 0
  buffer_load_dwordx4 v6, s[36:39], s73 offen lds
  s_add_u32 m0, s3, 3072
  s_nop 0
  buffer_load_dwordx4 v7, s[36:39], s73 offen lds
  s_add_u32 m0, s75, s78
  s_mov_b64 exec, s[14:15]
  buffer_load_dwordx4 v28, s[36:39], s73 offen lds
  s_mov_b64 exec, -1
  s_add_u32 s3, s75, s77
  s_add_u32 m0, s3, 0
  s_add_u32 s4, s74, 0
  buffer_load_dwordx4 v8, s[40:43], s4 offen lds
  s_add_u32 m0, s3, 1024
  s_nop 0
  buffer_load_dwordx4 v9, s[40:43], s4 offen lds
  s_add_u32 m0, s3, 8192
  s_add_u32 s4, s74, 2048
  buffer_load_dwordx4 v8, s[40:43], s4 offen lds
  s_add_u32 m0, s3, 9216
  s_nop 0
  buffer_load_dwordx4 v9, s[40:43], s4 offen lds
  s_add_u32 m0, s3, 16384
  s_add_u32 s4, s74, 4096
  buffer_load_dwordx4 v8, s[40:43], s4 offen lds
  s_add_u32 m0, s3, 17408
  s_nop 0
  buffer_load_dwordx4 v9, s[40:43], s4 offen lds
  s_add_u32 s101, s101, 1
  s_sub_u32 s73, s101, s100
  s_lshl_b32 s73, s73, 3
  s_lshr_b32 s73, 0xf0f02, s73
  s_and_b32 s73, s73, 255
  s_add_u32 s73, s73, s101
  s_and_b32 s73, s73, 15
  s_mul_i32 s74, s73, 393216
  s_lshl_b32 s73, s73, 7
  s_add_u32 s75, s75, 43008
  s_cmp_eq_u32 s75, 129024
  s_cselect_b32 s75, 0, s75
  s_add_u32 s3, s75, s76
  s_add_u32 m0, s3, 0
  s_nop 0
  buffer_load_dwordx4 v4, s[36:39], s73 offen lds
  s_add_u32 m0, s3, 1024
  s_nop 0
  buffer_load_dwordx4 v5, s[36:39], s73 offen lds
  s_add_u32 m0, s3, 2048
  s_nop 0
  buffer_load_dwordx4 v6, s[36:39], s73 offen lds
  s_add_u32 m0, s3, 3072
  s_nop 0
  buffer_load_dwordx4 v7, s[36:39], s73 offen lds
  s_add_u32 m0, s75, s78
  s_mov_b64 exec, s[14:15]
  buffer_load_dwordx4 v28, s[36:39], s73 offen lds
  s_mov_b64 exec, -1
  s_add_u32 s3, s75, s77
  s_add_u32 m0, s3, 0
  s_add_u32 s4, s74, 0
  buffer_load_dwordx4 v8, s[40:43], s4 offen lds
  s_add_u32 m0, s3, 1024
  s_nop 0
  buffer_load_dwordx4 v9, s[40:43], s4 offen lds
  s_add_u32 m0, s3, 8192
  s_add_u32 s4, s74, 2048
  buffer_load_dwordx4 v8, s[40:43], s4 offen lds
  s_add_u32 m0, s3, 9216
  s_nop 0
  buffer_load_dwordx4 v9, s[40:43], s4 offen lds
  s_add_u32 m0, s3, 16384
  s_add_u32 s4, s74, 4096
  buffer_load_dwordx4 v8, s[40:43], s4 offen lds
  s_add_u32 m0, s3, 17408
  s_nop 0
  buffer_load_dwordx4 v9, s[40:43], s4 offen lds
  s_add_u32 s101, s101, 1
  s_sub_u32 s73, s101, s100
  s_lshl_b32 s73, s73, 3
  s_lshr_b32 s73, 0xf0f02, s73
  s_and_b32 s73, s73, 255
  s_add_u32 s73, s73, s101
  s_and_b32 s73, s73, 15
  s_mul_i32 s74, s73, 393216
  s_lshl_b32 s73, s73, 7
  s_add_u32 s75, s75, 43008
  s_cmp_eq_u32 s75, 129024
  s_cselect_b32 s75, 0, s75
  s_waitcnt vmcnt(11)
  s_barrier
  s_mov_b32 s79, 13
L_attn1_ld:
  s_add_u32 s3, s75, s76
  s_add_u32 m0, s3, 0
  s_nop 0
  buffer_load_dwordx4 v4, s[36:39], s73 offen lds
  s_add_u32 m0, s3, 1024
  s_nop 0
  buffer_load_dwordx4 v5, s[36:39], s73 offen lds
  s_add_u32 m0, s3, 2048
  s_nop 0
  buffer_load_dwordx4 v6, s[36:39], s73 offen lds
  s_add_u32 m0, s3, 3072
  s_nop 0
  buffer_load_dwordx4 v7, s[36:39], s73 offen lds
  s_add_u32 m0, s75, s78
  s_mov_b64 exec, s[14:15]
  buffer_load_dwordx4 v28, s[36:39], s73 offen lds
  s_mov_b64 exec, -1
  s_add_u32 s3, s75, s77
  s_add_u32 m0, s3, 0
  s_add_u32 s4, s74, 0
  buffer_load_dwordx4 v8, s[40:43], s4 offen lds
  s_add_u32 m0, s3, 1024
  s_nop 0
  buffer_load_dwordx4 v9, s[40:43], s4 offen lds
  s_add_u32 m0, s3, 8192
  s_add_u32 s4, s74, 2048
  buffer_load_dwordx4 v8, s[40:43], s4 offen lds
  s_add_u32 m0, s3, 9216
  s_nop 0
  buffer_load_dwordx4 v9, s[40:43], s4 offen lds
  s_add_u32 m0, s3, 16384
  s_add_u32 s4, s74, 4096
  buffer_load_dwordx4 v8, s[40:43], s4 offen lds
  s_add_u32 m0, s3, 17408
  s_nop 0
  buffer_load_dwordx4 v9, s[40:43], s4 offen lds
  s_add_u32 s101, s101, 1
  s_sub_u32 s73, s101, s100
  s_lshl_b32 s73, s73, 3
  s_lshr_b32 s73, 0xf0f02, s73
  s_and_b32 s73, s73, 255
  s_add_u32 s73, s73, s101
  s_and_b32 s73, s73, 15
  s_mul_i32 s74, s73, 393216
  s_lshl_b32 s73, s73, 7
  s_add_u32 s75, s75, 43008
  s_cmp_eq_u32 s75, 129024
  s_cselect_b32 s75, 0, s75
  s_waitcnt vmcnt(11)
  s_barrier
  s_sub_u32 s79, s79, 1
  s_cmp_lg_u32 s79, 0
  s_cbranch_scc1 L_attn1_ld
  s_add_u32 s3, s75, s76
  s_add_u32 m0, s3, 0
  s_nop 0
  buffer_load_dwordx4 v4, s[36:39], s73 offen lds
  s_add_u32 m0, s3, 1024
  s_nop 0
  buffer_load_dwordx4 v5, s[36:39], s73 offen lds
  s_add_u32 m0, s3, 2048
  s_nop 0
  buffer_load_dwordx4 v6, s[36:39], s73 offen lds
  s_add_u32 m0, s3, 3072
  s_nop 0
  buffer_load_dwordx4 v7, s[36:39], s73 offen lds
  s_add_u32 m0, s75, s78
  s_mov_b64 exec, s[14:15]
  buffer_load_dwordx4 v28, s[36:39], s73 offen lds
  s_mov_b64 exec, -1
  s_add_u32 s3, s75, s77
  s_add_u32 m0, s3, 0
  s_add_u32 s4, s74, 0
  buffer_load_dwordx4 v8, s[40:43], s4 offen lds
  s_add_u32 m0, s3, 1024
  s_nop 0
  buffer_load_dwordx4 v9, s[40:43], s4 offen lds
  s_add_u32 m0, s3, 8192
  s_add_u32 s4, s74, 2048
  buffer_load_dwordx4 v8, s[40:43], s4 offen lds
  s_add_u32 m0, s3, 9216
  s_nop 0
  buffer_load_dwordx4 v9, s[40:43], s4 offen lds
  s_add_u32 m0, s3, 16384
  s_add_u32 s4, s74, 4096
  buffer_load_dwordx4 v8, s[40:43], s4 offen lds
  s_add_u32 m0, s3, 17408
  s_nop 0
  buffer_load_dwordx4 v9, s[40:43], s4 offen lds
  s_add_u32 s101, s101, 1
  s_sub_u32 s73, s101, s100
  s_lshl_b32 s73, s73, 3
  s_lshr_b32 s73, 0xf0f02, s73
  s_and_b32 s73, s73, 255
  s_add_u32 s73, s73, s101
  s_and_b32 s73, s73, 15
  s_mul_i32 s74, s73, 393216
  s_lshl_b32 s73, s73, 7
  s_add_u32 s75, s75, 43008
  s_cmp_eq_u32 s75, 129024
  s_cselect_b32 s75, 0, s75
  s_and_b32 s3, s70, 3
  s_lshl_b32 s4, s68, 7
  s_lshl_b32 s5, s3, 6
  s_add_u32 s5, s5, s4
  v_add_u32 v2, s5, v1
  s_sub_u32 s4, s4, 16
  v_and_b32 v3, 15, v1
  v_add_u32 v3, s4, v3
  v_max_i32 v3, 0, v3
  s_cmp_ge_u32 s3, 2
  s_cselect_b64 vcc, -1, 0
  v_cndmask_b32 v2, v2, v3, vcc
  v_lshlrev_b32 v2, 3, v2
  s_mov_b32 s3, 0
  buffer_load_dwordx2 v[32:33], v2, s[56:59], s3 offen
  s_add_u32 s3, s3, 16384
  buffer_load_dwordx2 v[34:35], v2, s[56:59], s3 offen
  s_add_u32 s3, s3, 16384
  buffer_load_dwordx2 v[36:37], v2, s[56:59], s3 offen
  s_add_u32 s3, s3, 16384
  buffer_load_dwordx2 v[38:39], v2, s[56:59], s3 offen
  s_add_u32 s3, s3, 16384
  buffer_load_dwordx2 v[40:41], v2, s[56:59], s3 offen
  s_add_u32 s3, s3, 16384
  buffer_load_dwordx2 v[42:43], v2, s[56:59], s3 offen
  s_add_u32 s3, s3, 16384
  buffer_load_dwordx2 v[44:45], v2, s[56:59], s3 offen
  s_add_u32 s3, s3, 16384
  buffer_load_dwordx2 v[46:47], v2, s[56:59], s3 offen
  s_add_u32 s3, s3, 16384
  buffer_load_dwordx2 v[48:49], v2, s[56:59], s3 offen
  s_add_u32 s3, s3, 16384
  buffer_load_dwordx2 v[50:51], v2, s[56:59], s3 offen
  s_add_u32 s3, s3, 16384
  buffer_load_dwordx2 v[52:53], v2, s[56:59], s3 offen
  s_add_u32 s3, s3, 16384
  buffer_load_dwordx2 v[54:55], v2, s[56:59], s3 offen
  s_add_u32 s3, s3, 16384
  buffer_load_dwordx2 v[56:57], v2, s[56:59], s3 offen
  s_add_u32 s3, s3, 16384
  buffer_load_dwordx2 v[58:59], v2, s[56:59], s3 offen
  s_add_u32 s3, s3, 16384
  buffer_load_dwordx2 v[60:61], v2, s[56:59], s3 offen
  s_add_u32 s3, s3, 16384
  buffer_load_dwordx2 v[62:63], v2, s[56:59], s3 offen
  s_mov_b32 s60, s20
  s_and_b32 s61, s21, 0xffff
  s_mov_b32 s62, 2097152
  s_mov_b32 s63, 0x00020000
  s_and_b32 s3, s70, 3
  s_mul_i32 s3, s3, 8
  s_mul_i32 s4, s99, 32
  s_add_u32 s3, s3, s4
  v_lshrrev_b32 v2, 3, v1
  v_add_u32 v2, s3, v2
  v_mul_u32_u24 v2, 2048, v2
  v_and_b32 v3, 7, v1
  v_lshl_add_u32 v2, v3, 7, v2
  s_and_b32 s3, s2, 7
  s_lshr_b32 s3, s3, 2
  s_mul_i32 s3, s3, 1024
  buffer_load_dword v96, v2, s[60:63], s3 offen
  s_waitcnt vmcnt(28)
  s_barrier
  s_waitcnt vmcnt(17)
  s_barrier
  s_waitcnt vmcnt(1)
  v_add_f32 v32, v32, v34
  v_add_f32 v33, v33, v35
  v_add_f32 v48, v48, v50
  v_add_f32 v49, v49, v51
  v_add_f32 v32, v32, v36
  v_add_f32 v33, v33, v37
  v_add_f32 v48, v48, v52
  v_add_f32 v49, v49, v53
  v_add_f32 v32, v32, v38
  v_add_f32 v33, v33, v39
  v_add_f32 v48, v48, v54
  v_add_f32 v49, v49, v55
  v_add_f32 v32, v32, v40
  v_add_f32 v33, v33, v41
  v_add_f32 v48, v48, v56
  v_add_f32 v49, v49, v57
  v_add_f32 v32, v32, v42
  v_add_f32 v33, v33, v43
  v_add_f32 v48, v48, v58
  v_add_f32 v49, v49, v59
  v_add_f32 v32, v32, v44
  v_add_f32 v33, v33, v45
  v_add_f32 v48, v48, v60
  v_add_f32 v49, v49, v61
  v_add_f32 v32, v32, v46
  v_add_f32 v33, v33, v47
  v_add_f32 v48, v48, v62
  v_add_f32 v49, v49, v63
  v_add_f32 v32, v32, v48
  v_add_f32 v33, v33, v49
  v_mul_f32 v32, 0x3a800000, v32
  v_mul_f32 v33, 0x3a800000, v33
  v_fma_f32 v33, -v32, v32, v33
  v_max_f32 v33, 0, v33
  v_add_f32 v33, 0x3727c5ac, v33
  v_rsq_f32 v33, v33
  s_nop 0
  s_and_b32 s3, s70, 3
  s_lshl_b32 s5, s3, 6
  s_add_u32 s5, s5, 16
  v_add_u32 v2, s5, v1
  v_and_b32 v3, 15, v1
  s_cmp_ge_u32 s3, 2
  s_cselect_b64 vcc, -1, 0
  v_cndmask_b32 v2, v2, v3, vcc
  v_lshlrev_b32 v2, 2, v2
  v_add_u32 v2, 129024, v2
  ds_write2_b32 v2, v32, v33 offset0:0 offset1:160
  s_waitcnt lgkmcnt(0)
  s_barrier
  s_barrier
  s_waitcnt vmcnt(0)
  s_endpgm
L_attn_ld0:
  s_add_u32 s3, s75, s76
  s_add_u32 m0, s3, 0
  s_nop 0
  buffer_load_dwordx4 v4, s[36:39], s73 offen lds
  s_add_u32 m0, s3, 1024
  s_nop 0
  buffer_load_dwordx4 v5, s[36:39], s73 offen lds
  s_add_u32 m0, s3, 2048
  s_nop 0
  buffer_load_dwordx4 v6, s[36:39], s73 offen lds
  s_add_u32 m0, s3, 3072
  s_nop 0
  buffer_load_dwordx4 v7, s[36:39], s73 offen lds
  s_add_u32 m0, s75, s78
  s_mov_b64 exec, s[14:15]
  buffer_load_dwordx4 v28, s[36:39], s73 offen lds
  s_mov_b64 exec, -1
  s_add_u32 s3, s75, s77
  s_add_u32 m0, s3, 0
  s_add_u32 s4, s74, 0
  buffer_load_dwordx4 v8, s[40:43], s4 offen lds
  s_add_u32 m0, s3, 1024
  s_nop 0
  buffer_load_dwordx4 v9, s[40:43], s4 offen lds
  s_add_u32 m0, s3, 8192
  s_add_u32 s4, s74, 2048
  buffer_load_dwordx4 v8, s[40:43], s4 offen lds
  s_add_u32 m0, s3, 9216
  s_nop 0
  buffer_load_dwordx4 v9, s[40:43], s4 offen lds
  s_add_u32 m0, s3, 16384
  s_add_u32 s4, s74, 4096
  buffer_load_dwordx4 v8, s[40:43], s4 offen lds
  s_add_u32 m0, s3, 17408
  s_nop 0
  buffer_load_dwordx4 v9, s[40:43], s4 offen lds
  s_add_u32 s101, s101, 1
  s_sub_u32 s73, s101, s100
  s_lshl_b32 s73, s73, 3
  s_lshr_b32 s73, 0xf0f02, s73
  s_and_b32 s73, s73, 255
  s_add_u32 s73, s73, s101
  s_and_b32 s73, s73, 15
  s_mul_i32 s74, s73, 393216
  s_lshl_b32 s73, s73, 7
  s_add_u32 s75, s75, 43008
  s_cmp_eq_u32 s75, 129024
  s_cselect_b32 s75, 0, s75
  s_add_u32 s3, s75, s76
  s_add_u32 m0, s3, 0
  s_nop 0
  buffer_load_dwordx4 v4, s[36:39], s73 offen lds
  s_add_u32 m0, s3, 1024
  s_nop 0
  buffer_load_dwordx4 v5, s[36:39], s73 offen lds
  s_add_u32 m0, s3, 2048
  s_nop 0
  buffer_load_dwordx4 v6, s[36:39], s73 offen lds
  s_add_u32 m0, s3, 3072
  s_nop 0
  buffer_load_dwordx4 v7, s[36:39], s73 offen lds
  s_add_u32 m0, s75, s78
  s_mov_b64 exec, s[14:15]
  buffer_load_dwordx4 v28, s[36:39], s73 offen lds
  s_mov_b64 exec, -1
  s_add_u32 s3, s75, s77
  s_add_u32 m0, s3, 0
  s_add_u32 s4, s74, 0
  buffer_load_dwordx4 v8, s[40:43], s4 offen lds
  s_add_u32 m0, s3, 1024
  s_nop 0
  buffer_load_dwordx4 v9, s[40:43], s4 offen lds
  s_add_u32 m0, s3, 8192
  s_add_u32 s4, s74, 2048
  buffer_load_dwordx4 v8, s[40:43], s4 offen lds
  s_add_u32 m0, s3, 9216
  s_nop 0
  buffer_load_dwordx4 v9, s[40:43], s4 offen lds
  s_add_u32 m0, s3, 16384
  s_add_u32 s4, s74, 4096
  buffer_load_dwordx4 v8, s[40:43], s4 offen lds
  s_add_u32 m0, s3, 17408
  s_nop 0
  buffer_load_dwordx4 v9, s[40:43], s4 offen lds
  s_add_u32 s101, s101, 1
  s_sub_u32 s73, s101, s100
  s_lshl_b32 s73, s73, 3
  s_lshr_b32 s73, 0xf0f02, s73
  s_and_b32 s73, s73, 255
  s_add_u32 s73, s73, s101
  s_and_b32 s73, s73, 15
  s_mul_i32 s74, s73, 393216
  s_lshl_b32 s73, s73, 7
  s_add_u32 s75, s75, 43008
  s_cmp_eq_u32 s75, 129024
  s_cselect_b32 s75, 0, s75
  s_waitcnt vmcnt(11)
  s_barrier
  s_mov_b32 s79, 13
L_attn0_ld:
  s_add_u32 s3, s75, s76
  s_add_u32 m0, s3, 0
  s_nop 0
  buffer_load_dwordx4 v4, s[36:39], s73 offen lds
  s_add_u32 m0, s3, 1024
  s_nop 0
  buffer_load_dwordx4 v5, s[36:39], s73 offen lds
  s_add_u32 m0, s3, 2048
  s_nop 0
  buffer_load_dwordx4 v6, s[36:39], s73 offen lds
  s_add_u32 m0, s3, 3072
  s_nop 0
  buffer_load_dwordx4 v7, s[36:39], s73 offen lds
  s_add_u32 m0, s75, s78
  s_mov_b64 exec, s[14:15]
  buffer_load_dwordx4 v28, s[36:39], s73 offen lds
  s_mov_b64 exec, -1
  s_add_u32 s3, s75, s77
  s_add_u32 m0, s3, 0
  s_add_u32 s4, s74, 0
  buffer_load_dwordx4 v8, s[40:43], s4 offen lds
  s_add_u32 m0, s3, 1024
  s_nop 0
  buffer_load_dwordx4 v9, s[40:43], s4 offen lds
  s_add_u32 m0, s3, 8192
  s_add_u32 s4, s74, 2048
  buffer_load_dwordx4 v8, s[40:43], s4 offen lds
  s_add_u32 m0, s3, 9216
  s_nop 0
  buffer_load_dwordx4 v9, s[40:43], s4 offen lds
  s_add_u32 m0, s3, 16384
  s_add_u32 s4, s74, 4096
  buffer_load_dwordx4 v8, s[40:43], s4 offen lds
  s_add_u32 m0, s3, 17408
  s_nop 0
  buffer_load_dwordx4 v9, s[40:43], s4 offen lds
  s_add_u32 s101, s101, 1
  s_sub_u32 s73, s101, s100
  s_lshl_b32 s73, s73, 3
  s_lshr_b32 s73, 0xf0f02, s73
  s_and_b32 s73, s73, 255
  s_add_u32 s73, s73, s101
  s_and_b32 s73, s73, 15
  s_mul_i32 s74, s73, 393216
  s_lshl_b32 s73, s73, 7
  s_add_u32 s75, s75, 43008
  s_cmp_eq_u32 s75, 129024
  s_cselect_b32 s75, 0, s75
  s_waitcnt vmcnt(11)
  s_barrier
  s_sub_u32 s79, s79, 1
  s_cmp_lg_u32 s79, 0
  s_cbranch_scc1 L_attn0_ld
  s_add_u32 s3, s75, s76
  s_add_u32 m0, s3, 0
  s_nop 0
  buffer_load_dwordx4 v4, s[36:39], s73 offen lds
  s_add_u32 m0, s3, 1024
  s_nop 0
  buffer_load_dwordx4 v5, s[36:39], s73 offen lds
  s_add_u32 m0, s3, 2048
  s_nop 0
  buffer_load_dwordx4 v6, s[36:39], s73 offen lds
  s_add_u32 m0, s3, 3072
  s_nop 0
  buffer_load_dwordx4 v7, s[36:39], s73 offen lds
  s_add_u32 m0, s75, s78
  s_mov_b64 exec, s[14:15]
  buffer_load_dwordx4 v28, s[36:39], s73 offen lds
  s_mov_b64 exec, -1
  s_add_u32 s3, s75, s77
  s_add_u32 m0, s3, 0
  s_add_u32 s4, s74, 0
  buffer_load_dwordx4 v8, s[40:43], s4 offen lds
  s_add_u32 m0, s3, 1024
  s_nop 0
  buffer_load_dwordx4 v9, s[40:43], s4 offen lds
  s_add_u32 m0, s3, 8192
  s_add_u32 s4, s74, 2048
  buffer_load_dwordx4 v8, s[40:43], s4 offen lds
  s_add_u32 m0, s3, 9216
  s_nop 0
  buffer_load_dwordx4 v9, s[40:43], s4 offen lds
  s_add_u32 m0, s3, 16384
  s_add_u32 s4, s74, 4096
  buffer_load_dwordx4 v8, s[40:43], s4 offen lds
  s_add_u32 m0, s3, 17408
  s_nop 0
  buffer_load_dwordx4 v9, s[40:43], s4 offen lds
  s_add_u32 s101, s101, 1
  s_sub_u32 s73, s101, s100
  s_lshl_b32 s73, s73, 3
  s_lshr_b32 s73, 0xf0f02, s73
  s_and_b32 s73, s73, 255
  s_add_u32 s73, s73, s101
  s_and_b32 s73, s73, 15
  s_mul_i32 s74, s73, 393216
  s_lshl_b32 s73, s73, 7
  s_add_u32 s75, s75, 43008
  s_cmp_eq_u32 s75, 129024
  s_cselect_b32 s75, 0, s75
  s_mov_b32 s64, s24
  s_and_b32 s65, s25, 0xffff
  s_mov_b32 s66, 7340032
  s_mov_b32 s67, 0x00020000
  s_min_u32 s3, s2, 223
  s_mul_i32 s4, s3, 4682
  s_lshr_b32 s4, s4, 16
  s_mul_i32 s5, s4, 14
  s_sub_u32 s3, s3, s5
  s_lshl_b32 s3, s3, 2
  s_and_b32 s5, s70, 3
  s_add_u32 s3, s3, s5
  s_mul_i32 s5, s4, 458752
  s_lshl_b32 s8, s3, 7
  s_add_u32 s5, s5, s8
  s_lshl_b32 s9, s4, 14
  s_lshl_b32 s8, s3, 8
  s_add_u32 s9, s9, s8
  v_lshrrev_b32 v2, 3, v1
  v_mul_u32_u24 v2, 7168, v2
  v_and_b32 v3, 7, v1
  v_lshl_add_u32 v2, v3, 4, v2
  buffer_load_dwordx4 v[64:67], v2, s[64:67], s5 offen
  s_add_u32 s5, s5, 57344
  buffer_load_dwordx4 v[68:71], v2, s[64:67], s5 offen
  s_add_u32 s5, s5, 57344
  buffer_load_dwordx4 v[72:75], v2, s[64:67], s5 offen
  s_add_u32 s5, s5, 57344
  buffer_load_dwordx4 v[76:79], v2, s[64:67], s5 offen
  s_add_u32 s5, s5, 57344
  buffer_load_dwordx4 v[80:83], v2, s[64:67], s5 offen
  s_add_u32 s5, s5, 57344
  buffer_load_dwordx4 v[84:87], v2, s[64:67], s5 offen
  s_add_u32 s5, s5, 57344
  buffer_load_dwordx4 v[88:91], v2, s[64:67], s5 offen
  s_add_u32 s5, s5, 57344
  buffer_load_dwordx4 v[92:95], v2, s[64:67], s5 offen
  s_mov_b32 s60, s20
  s_and_b32 s61, s21, 0xffff
  s_mov_b32 s62, 2097152
  s_mov_b32 s63, 0x00020000
  s_and_b32 s3, s70, 3
  s_mul_i32 s3, s3, 8
  s_mul_i32 s4, s99, 32
  s_add_u32 s3, s3, s4
  v_lshrrev_b32 v2, 3, v1
  v_add_u32 v2, s3, v2
  v_mul_u32_u24 v2, 2048, v2
  v_and_b32 v3, 7, v1
  v_lshl_add_u32 v2, v3, 7, v2
  s_and_b32 s3, s2, 7
  s_lshr_b32 s3, s3, 2
  s_mul_i32 s3, s3, 1024
  buffer_load_dword v96, v2, s[60:63], s3 offen
  s_waitcnt vmcnt(20)
  s_barrier
  s_waitcnt vmcnt(9)
  s_barrier
  s_barrier
  s_barrier
  s_barrier
  s_waitcnt vmcnt(0)
  s_mov_b32 s7, 0xffff0000
  v_lshlrev_b32 v32, 16, v64
  v_and_b32 v33, s7, v64
  v_lshlrev_b32 v34, 16, v65
  v_and_b32 v35, s7, v65
  v_lshlrev_b32 v36, 16, v66
  v_and_b32 v37, s7, v66
  v_lshlrev_b32 v38, 16, v67
  v_and_b32 v39, s7, v67
  v_lshlrev_b32 v40, 16, v68
  v_and_b32 v41, s7, v68
  v_pk_add_f32 v[32:33], v[32:33], v[40:41]
  v_lshlrev_b32 v40, 16, v69
  v_and_b32 v41, s7, v69
  v_pk_add_f32 v[34:35], v[34:35], v[40:41]
  v_lshlrev_b32 v40, 16, v70
  v_and_b32 v41, s7, v70
  v_pk_add_f32 v[36:37], v[36:37], v[40:41]
  v_lshlrev_b32 v40, 16, v71
  v_and_b32 v41, s7, v71
  v_pk_add_f32 v[38:39], v[38:39], v[40:41]
  v_lshlrev_b32 v40, 16, v72
  v_and_b32 v41, s7, v72
  v_pk_add_f32 v[32:33], v[32:33], v[40:41]
  v_lshlrev_b32 v40, 16, v73
  v_and_b32 v41, s7, v73
  v_pk_add_f32 v[34:35], v[34:35], v[40:41]
  v_lshlrev_b32 v40, 16, v74
  v_and_b32 v41, s7, v74
  v_pk_add_f32 v[36:37], v[36:37], v[40:41]
  v_lshlrev_b32 v40, 16, v75
  v_and_b32 v41, s7, v75
  v_pk_add_f32 v[38:39], v[38:39], v[40:41]
  v_lshlrev_b32 v40, 16, v76
  v_and_b32 v41, s7, v76
  v_pk_add_f32 v[32:33], v[32:33], v[40:41]
  v_lshlrev_b32 v40, 16, v77
  v_and_b32 v41, s7, v77
  v_pk_add_f32 v[34:35], v[34:35], v[40:41]
  v_lshlrev_b32 v40, 16, v78
  v_and_b32 v41, s7, v78
  v_pk_add_f32 v[36:37], v[36:37], v[40:41]
  v_lshlrev_b32 v40, 16, v79
  v_and_b32 v41, s7, v79
  v_pk_add_f32 v[38:39], v[38:39], v[40:41]
  v_lshlrev_b32 v40, 16, v80
  v_and_b32 v41, s7, v80
  v_pk_add_f32 v[32:33], v[32:33], v[40:41]
  v_lshlrev_b32 v40, 16, v81
  v_and_b32 v41, s7, v81
  v_pk_add_f32 v[34:35], v[34:35], v[40:41]
  v_lshlrev_b32 v40, 16, v82
  v_and_b32 v41, s7, v82
  v_pk_add_f32 v[36:37], v[36:37], v[40:41]
  v_lshlrev_b32 v40, 16, v83
  v_and_b32 v41, s7, v83
  v_pk_add_f32 v[38:39], v[38:39], v[40:41]
  v_lshlrev_b32 v40, 16, v84
  v_and_b32 v41, s7, v84
  v_pk_add_f32 v[32:33], v[32:33], v[40:41]
  v_lshlrev_b32 v40, 16, v85
  v_and_b32 v41, s7, v85
  v_pk_add_f32 v[34:35], v[34:35], v[40:41]
  v_lshlrev_b32 v40, 16, v86
  v_and_b32 v41, s7, v86
  v_pk_add_f32 v[36:37], v[36:37], v[40:41]
  v_lshlrev_b32 v40, 16, v87
  v_and_b32 v41, s7, v87
  v_pk_add_f32 v[38:39], v[38:39], v[40:41]
  v_lshlrev_b32 v40, 16, v88
  v_and_b32 v41, s7, v88
  v_pk_add_f32 v[32:33], v[32:33], v[40:41]
  v_lshlrev_b32 v40, 16, v89
  v_and_b32 v41, s7, v89
  v_pk_add_f32 v[34:35], v[34:35], v[40:41]
  v_lshlrev_b32 v40, 16, v90
  v_and_b32 v41, s7, v90
  v_pk_add_f32 v[36:37], v[36:37], v[40:41]
  v_lshlrev_b32 v40, 16, v91
  v_and_b32 v41, s7, v91
  v_pk_add_f32 v[38:39], v[38:39], v[40:41]
  v_lshlrev_b32 v40, 16, v92
  v_and_b32 v41, s7, v92
  v_pk_add_f32 v[32:33], v[32:33], v[40:41]
  v_lshlrev_b32 v40, 16, v93
  v_and_b32 v41, s7, v93
  v_pk_add_f32 v[34:35], v[34:35], v[40:41]
  v_lshlrev_b32 v40, 16, v94
  v_and_b32 v41, s7, v94
  v_pk_add_f32 v[36:37], v[36:37], v[40:41]
  v_lshlrev_b32 v40, 16, v95
  v_and_b32 v41, s7, v95
  v_pk_add_f32 v[38:39], v[38:39], v[40:41]
  s_add_u32 s64, s34, 24641536
  s_addc_u32 s65, s35, 0
  s_and_b32 s65, s65, 0xffff
  s_mov_b32 s66, 262144
  s_mov_b32 s67, 0x00020000
  v_permlane32_swap_b32 v32, v36
  v_permlane32_swap_b32 v33, v37
  v_permlane32_swap_b32 v34, v38
  v_permlane32_swap_b32 v35, v39
  v_add_f32 v32, v32, v36
  v_add_f32 v33, v33, v37
  v_add_f32 v34, v34, v38
  v_add_f32 v35, v35, v39
  v_and_b32 v2, 7, v1
  v_lshlrev_b32 v2, 5, v2
  v_permlane16_swap_b32 v32, v34
  v_permlane16_swap_b32 v33, v35
  v_add_f32 v32, v32, v34
  v_add_f32 v33, v33, v35
  v_lshrrev_b32 v3, 4, v1
  v_lshl_add_u32 v2, v3, 3, v2
  v_add_f32_dpp v32, v32, v32 row_ror:8 row_mask:0xf bank_mask:0xf
  v_add_f32_dpp v33, v33, v33 row_ror:8 row_mask:0xf bank_mask:0xf
  buffer_store_dwordx2 v[32:33], v2, s[64:67], s9 offen
L_attn_end:
  s_endpgm
.section .rodata,"a"
.p2align 6
.amdhsa_kernel attnl0_kernel
  .amdhsa_next_free_vgpr 256
  .amdhsa_next_free_sgpr 102
  .amdhsa_accum_offset 256
  .amdhsa_group_segment_fixed_size 0
  .amdhsa_kernarg_size 88
  .amdhsa_user_sgpr_count 2
  .amdhsa_user_sgpr_kernarg_segment_ptr 1
  .amdhsa_system_sgpr_workgroup_id_x 1
  .amdhsa_float_denorm_mode_32 3
  .amdhsa_float_denorm_mode_16_64 3
.end_amdhsa_kernel
.text
.text
.globl attnl1_kernel
.p2align 8
.type attnl1_kernel,@function
attnl1_kernel:
  s_load_dwordx16 s[16:31], s[0:1], 0
  s_load_dwordx2 s[32:33], s[0:1], 64
  s_load_dwordx2 s[34:35], s[0:1], 80
  s_load_dwordx2 s[12:13], s[0:1], 64
  s_mov_b32 s96, 1
  s_branch L_attn_body
L_attn_c1:
.section .rodata,"a"
.p2align 6
.amdhsa_kernel attnl1_kernel
  .amdhsa_next_free_vgpr 256
  .amdhsa_next_free_sgpr 102
  .amdhsa_accum_offset 256
  .amdhsa_group_segment_fixed_size 0
  .amdhsa_kernarg_size 88
  .amdhsa_user_sgpr_count 2
  .amdhsa_user_sgpr_kernarg_segment_ptr 1
  .amdhsa_system_sgpr_workgroup_id_x 1
  .amdhsa_float_denorm_mode_32 3
  .amdhsa_float_denorm_mode_16_64 3
.end_amdhsa_kernel
.text
L_wo_c0:
.text
.globl wol0_kernel
.p2align 8
.type wol0_kernel,@function
wol0_kernel:
  s_load_dwordx16 s[16:31], s[0:1], 0
  s_load_dwordx2 s[32:33], s[0:1], 64
  s_load_dwordx2 s[34:35], s[0:1], 80
  s_load_dwordx2 s[12:13], s[0:1], 0
  s_mov_b32 s96, 0
L_wo_body:
  s_cmp_ge_u32 s2, 256
  s_cbranch_scc1 L_wo_end
  v_lshrrev_b32 v2, 6, v0
  v_and_b32 v1, 63, v0
  v_readfirstlane_b32 s70, v2
  s_and_b32 s3, s2, 7
  s_lshr_b32 s99, s2, 3
  s_and_b32 s5, s3, 3
  s_lshl_b32 s5, s5, 2
  s_and_b32 s6, s99, 3
  s_add_u32 s68, s5, s6
  s_lshr_b32 s5, s3, 2
  s_lshl_b32 s5, s5, 3
  s_lshr_b32 s6, s99, 2
  s_add_u32 s69, s5, s6
  s_cmp_ge_u32 s70, 4
  s_cbranch_scc1 L_wo_loader
  v_and_b32 v3, 15, v1
  v_lshrrev_b32 v2, 4, v1
  s_lshl_b32 s8, s68, 7
  s_lshl_b32 s9, s70, 5
  s_add_u32 s8, s8, s9
  v_add_u32 v13, s8, v3
  s_lshl_b32 s10, s69, 7
  v_lshl_add_u32 v14, v2, 3, s10
  v_and_b32 v16, 1, v2
  v_lshrrev_b32 v17, 1, v2
  v_lshl_add_u32 v16, v16, 1, v17
  v_lshlrev_b32 v16, 8, v16
  v_lshl_add_u32 v16, v3, 4, v16
  s_add_u32 s9, s8, s69
  s_lshl_b32 s9, s9, 11
  v_add_u32 v12, s9, v16
  v_lshl_add_u32 v18, v17, 4, v13
  v_lshlrev_b32 v18, 3, v18
  v_and_b32 v16, 1, v2
  v_lshl_add_u32 v18, v16, 2, v18
  s_lshl_b32 s10, s69, 14
  v_add_u32 v18, s10, v18
  s_lshl_b32 s8, s70, 12
  v_lshl_add_u32 v5, v1, 4, s8
  v_bfe_u32 v6, v1, 2, 2
  v_lshl_add_u32 v6, v2, 3, v6
  v_lshlrev_b32 v6, 7, v6
  v_and_b32 v17, 3, v1
  v_lshl_add_u32 v6, v17, 3, v6
  v_bfe_u32 v17, v1, 3, 2
  v_lshl_add_u32 v6, v17, 5, v6
  v_add_u32 v6, 16384, v6
  v_xor_b32 v7, 32, v6
  v_xor_b32 v8, 64, v6
  v_xor_b32 v9, 96, v6
  v_lshrrev_b32 v15, 1, v2
  v_lshrrev_b32 v17, 1, v3
  v_xor_b32 v15, v15, v17
  v_lshlrev_b32 v15, 4, v15
  v_lshl_add_u32 v15, v3, 7, v15
  v_lshl_add_u32 v15, v16, 3, v15
  s_add_u32 s8, s8, 147456
  v_add_u32 v15, s8, v15
  s_mov_b32 s11, 0xffff0000
  s_mov_b32 s75, 0
  v_mov_b32 v128, 0
  v_mov_b32 v129, 0
  v_mov_b32 v130, 0
  v_mov_b32 v131, 0
  v_mov_b32 v132, 0
  v_mov_b32 v133, 0
  v_mov_b32 v134, 0
  v_mov_b32 v135, 0
  v_mov_b32 v136, 0
  v_mov_b32 v137, 0
  v_mov_b32 v138, 0
  v_mov_b32 v139, 0
  v_mov_b32 v140, 0
  v_mov_b32 v141, 0
  v_mov_b32 v142, 0
  v_mov_b32 v143, 0
  v_mov_b32 v144, 0
  v_mov_b32 v145, 0
  v_mov_b32 v146, 0
  v_mov_b32 v147, 0
  v_mov_b32 v148, 0
  v_mov_b32 v149, 0
  v_mov_b32 v150, 0
  v_mov_b32 v151, 0
  v_mov_b32 v152, 0
  v_mov_b32 v153, 0
  v_mov_b32 v154, 0
  v_mov_b32 v155, 0
  v_mov_b32 v156, 0
  v_mov_b32 v157, 0
  v_mov_b32 v158, 0
  v_mov_b32 v159, 0
  s_waitcnt lgkmcnt(0)
  s_add_u32 s44, s34, 4194304
  s_addc_u32 s45, s35, 0
  s_and_b32 s45, s45, 0xffff
  s_mov_b32 s46, 4194304
  s_mov_b32 s47, 0x00020000
  s_add_u32 s56, s34, 24117248
  s_addc_u32 s57, s35, 0
  s_and_b32 s57, s57, 0xffff
  s_mov_b32 s58, 262144
  s_mov_b32 s59, 0x00020000
  v_add_u32_e64 v25, s75, v5
  v_add_u32_e64 v26, s75, v6
  v_add_u32_e64 v27, s75, v7
  v_add_u32_e64 v28, s75, v8
  v_add_u32_e64 v29, s75, v9
  s_add_u32 s75, s75, 24576
  s_cmp_eq_u32 s75, 147456
  s_cselect_b32 s75, 0, s75
  s_barrier
  ds_read_b128 v[32:35], v25 offset:0
  ds_read_b128 v[36:39], v25 offset:2048
  ds_read_b64_tr_b16 v[48:49], v26 offset:0
  ds_read_b64_tr_b16 v[50:51], v26 offset:512
  ds_read_b64_tr_b16 v[52:53], v27 offset:0
  ds_read_b64_tr_b16 v[54:55], v27 offset:512
  ds_read_b64_tr_b16 v[56:57], v28 offset:0
  ds_read_b64_tr_b16 v[58:59], v28 offset:512
  ds_read_b64_tr_b16 v[60:61], v29 offset:0
  ds_read_b64_tr_b16 v[62:63], v29 offset:512
  ds_read_b128 v[40:43], v25 offset:1024
  ds_read_b128 v[44:47], v25 offset:3072
  ds_read_b64_tr_b16 v[64:65], v26 offset:4096
  ds_read_b64_tr_b16 v[66:67], v26 offset:4608
  ds_read_b64_tr_b16 v[68:69], v27 offset:4096
  ds_read_b64_tr_b16 v[70:71], v27 offset:4608
  ds_read_b64_tr_b16 v[72:73], v28 offset:4096
  ds_read_b64_tr_b16 v[74:75], v28 offset:4608
  ds_read_b64_tr_b16 v[76:77], v29 offset:4096
  ds_read_b64_tr_b16 v[78:79], v29 offset:4608
  s_mov_b32 s79, 8
  v_add_u32_e64 v25, s75, v5
  v_add_u32_e64 v26, s75, v6
  v_add_u32_e64 v27, s75, v7
  v_add_u32_e64 v28, s75, v8
  v_add_u32_e64 v29, s75, v9
  s_add_u32 s75, s75, 24576
  s_cmp_eq_u32 s75, 147456
  s_cselect_b32 s75, 0, s75
  s_waitcnt lgkmcnt(0)
.p2align 3
L_wo_loop:
  s_barrier
  s_sub_u32 s79, s79, 1
  v_mfma_f32_16x16x32_bf16 v[128:131], v[48:51], v[32:35], v[128:131]
  ds_read_b128 v[80:83], v25 offset:0
  ds_read_b128 v[84:87], v25 offset:2048
  v_mfma_f32_16x16x32_bf16 v[132:135], v[48:51], v[36:39], v[132:135]
  ds_read_b64_tr_b16 v[96:97], v26 offset:0
  ds_read_b64_tr_b16 v[98:99], v26 offset:512
  v_mfma_f32_16x16x32_bf16 v[136:139], v[52:55], v[32:35], v[136:139]
  ds_read_b64_tr_b16 v[100:101], v27 offset:0
  ds_read_b64_tr_b16 v[102:103], v27 offset:512
  v_mfma_f32_16x16x32_bf16 v[140:143], v[52:55], v[36:39], v[140:143]
  ds_read_b64_tr_b16 v[104:105], v28 offset:0
  ds_read_b64_tr_b16 v[106:107], v28 offset:512
  v_mfma_f32_16x16x32_bf16 v[144:147], v[56:59], v[32:35], v[144:147]
  ds_read_b64_tr_b16 v[108:109], v29 offset:0
  ds_read_b64_tr_b16 v[110:111], v29 offset:512
  v_mfma_f32_16x16x32_bf16 v[148:151], v[56:59], v[36:39], v[148:151]
  ds_read_b128 v[88:91], v25 offset:1024
  ds_read_b128 v[92:95], v25 offset:3072
  v_mfma_f32_16x16x32_bf16 v[152:155], v[60:63], v[32:35], v[152:155]
  ds_read_b64_tr_b16 v[112:113], v26 offset:4096
  ds_read_b64_tr_b16 v[114:115], v26 offset:4608
  v_mfma_f32_16x16x32_bf16 v[156:159], v[60:63], v[36:39], v[156:159]
  ds_read_b64_tr_b16 v[116:117], v27 offset:4096
  ds_read_b64_tr_b16 v[118:119], v27 offset:4608
  v_mfma_f32_16x16x32_bf16 v[128:131], v[64:67], v[40:43], v[128:131]
  ds_read_b64_tr_b16 v[120:121], v28 offset:4096
  ds_read_b64_tr_b16 v[122:123], v28 offset:4608
  v_mfma_f32_16x16x32_bf16 v[132:135], v[64:67], v[44:47], v[132:135]
  ds_read_b64_tr_b16 v[124:125], v29 offset:4096
  ds_read_b64_tr_b16 v[126:127], v29 offset:4608
  v_mfma_f32_16x16x32_bf16 v[136:139], v[68:71], v[40:43], v[136:139]
  v_add_u32_e64 v25, s75, v5
  v_add_u32_e64 v26, s75, v6
  v_mfma_f32_16x16x32_bf16 v[140:143], v[68:71], v[44:47], v[140:143]
  v_add_u32_e64 v27, s75, v7
  v_add_u32_e64 v28, s75, v8
  v_mfma_f32_16x16x32_bf16 v[144:147], v[72:75], v[40:43], v[144:147]
  v_add_u32_e64 v29, s75, v9
  s_add_u32 s75, s75, 24576
  v_mfma_f32_16x16x32_bf16 v[148:151], v[72:75], v[44:47], v[148:151]
  s_cmp_eq_u32 s75, 147456
  s_cselect_b32 s75, 0, s75
  s_nop 0
  v_mfma_f32_16x16x32_bf16 v[152:155], v[76:79], v[40:43], v[152:155]
  v_mfma_f32_16x16x32_bf16 v[156:159], v[76:79], v[44:47], v[156:159]
  s_waitcnt lgkmcnt(0)
  s_barrier
  v_mfma_f32_16x16x32_bf16 v[128:131], v[96:99], v[80:83], v[128:131]
  ds_read_b128 v[32:35], v25 offset:0
  ds_read_b128 v[36:39], v25 offset:2048
  v_mfma_f32_16x16x32_bf16 v[132:135], v[96:99], v[84:87], v[132:135]
  ds_read_b64_tr_b16 v[48:49], v26 offset:0
  ds_read_b64_tr_b16 v[50:51], v26 offset:512
  v_mfma_f32_16x16x32_bf16 v[136:139], v[100:103], v[80:83], v[136:139]
  ds_read_b64_tr_b16 v[52:53], v27 offset:0
  ds_read_b64_tr_b16 v[54:55], v27 offset:512
  v_mfma_f32_16x16x32_bf16 v[140:143], v[100:103], v[84:87], v[140:143]
  ds_read_b64_tr_b16 v[56:57], v28 offset:0
  ds_read_b64_tr_b16 v[58:59], v28 offset:512
  v_mfma_f32_16x16x32_bf16 v[144:147], v[104:107], v[80:83], v[144:147]
  ds_read_b64_tr_b16 v[60:61], v29 offset:0
  ds_read_b64_tr_b16 v[62:63], v29 offset:512
  v_mfma_f32_16x16x32_bf16 v[148:151], v[104:107], v[84:87], v[148:151]
  ds_read_b128 v[40:43], v25 offset:1024
  ds_read_b128 v[44:47], v25 offset:3072
  v_mfma_f32_16x16x32_bf16 v[152:155], v[108:111], v[80:83], v[152:155]
  ds_read_b64_tr_b16 v[64:65], v26 offset:4096
  ds_read_b64_tr_b16 v[66:67], v26 offset:4608
  v_mfma_f32_16x16x32_bf16 v[156:159], v[108:111], v[84:87], v[156:159]
  ds_read_b64_tr_b16 v[68:69], v27 offset:4096
  ds_read_b64_tr_b16 v[70:71], v27 offset:4608
  v_mfma_f32_16x16x32_bf16 v[128:131], v[112:115], v[88:91], v[128:131]
  ds_read_b64_tr_b16 v[72:73], v28 offset:4096
  ds_read_b64_tr_b16 v[74:75], v28 offset:4608
  v_mfma_f32_16x16x32_bf16 v[132:135], v[112:115], v[92:95], v[132:135]
  ds_read_b64_tr_b16 v[76:77], v29 offset:4096
  ds_read_b64_tr_b16 v[78:79], v29 offset:4608
  v_mfma_f32_16x16x32_bf16 v[136:139], v[116:119], v[88:91], v[136:139]
  v_add_u32_e64 v25, s75, v5
  v_add_u32_e64 v26, s75, v6
  v_mfma_f32_16x16x32_bf16 v[140:143], v[116:119], v[92:95], v[140:143]
  v_add_u32_e64 v27, s75, v7
  v_add_u32_e64 v28, s75, v8
  v_mfma_f32_16x16x32_bf16 v[144:147], v[120:123], v[88:91], v[144:147]
  v_add_u32_e64 v29, s75, v9
  s_add_u32 s75, s75, 24576
  v_mfma_f32_16x16x32_bf16 v[148:151], v[120:123], v[92:95], v[148:151]
  s_cmp_eq_u32 s75, 147456
  s_cselect_b32 s75, 0, s75
  s_cmp_lg_u32 s79, 0
  v_mfma_f32_16x16x32_bf16 v[152:155], v[124:127], v[88:91], v[152:155]
  v_mfma_f32_16x16x32_bf16 v[156:159], v[124:127], v[92:95], v[156:159]
  s_waitcnt lgkmcnt(0)
  s_cbranch_scc1 L_wo_loop
  v_xor_b32 v26, 32, v15
  v_xor_b32 v27, 64, v15
  v_xor_b32 v28, 96, v15
  ds_read_b64 v[160:161], v15 offset:0
  ds_read_b64 v[164:165], v26 offset:0
  ds_read_b64 v[168:169], v27 offset:0
  ds_read_b64 v[172:173], v28 offset:0
  ds_read_b64 v[162:163], v15 offset:2048
  ds_read_b64 v[166:167], v26 offset:2048
  ds_read_b64 v[170:171], v27 offset:2048
  ds_read_b64 v[174:175], v28 offset:2048
  v_mov_b32 v20, 0
  v_mov_b32 v21, 0
  v_mov_b32 v22, 0
  v_mov_b32 v23, 0
  s_mov_b32 s3, 32768
  s_mov_b32 s10, 0x3f803f80
  s_waitcnt lgkmcnt(7)
  v_lshlrev_b32 v184, 16, v160
  v_and_b32 v185, s11, v160
  v_lshlrev_b32 v186, 16, v161
  v_and_b32 v187, s11, v161
  v_pk_add_f32 v[128:129], v[128:129], v[184:185]
  v_pk_add_f32 v[130:131], v[130:131], v[186:187]
  v_cvt_pk_bf16_f32 v32, v128, v129
  v_cvt_pk_bf16_f32 v33, v130, v131
  s_waitcnt lgkmcnt(6)
  v_lshlrev_b32 v184, 16, v164
  v_and_b32 v185, s11, v164
  v_lshlrev_b32 v186, 16, v165
  v_and_b32 v187, s11, v165
  v_pk_add_f32 v[136:137], v[136:137], v[184:185]
  v_pk_add_f32 v[138:139], v[138:139], v[186:187]
  v_cvt_pk_bf16_f32 v34, v136, v137
  v_cvt_pk_bf16_f32 v35, v138, v139
  s_nop 1
  v_permlane16_swap_b32 v32, v34
  v_permlane16_swap_b32 v33, v35
  buffer_store_dwordx4 v[32:35], v12, s[44:47], 0 offen offset:0 sc1
  s_waitcnt lgkmcnt(5)
  v_lshlrev_b32 v184, 16, v168
  v_and_b32 v185, s11, v168
  v_lshlrev_b32 v186, 16, v169
  v_and_b32 v187, s11, v169
  v_pk_add_f32 v[144:145], v[144:145], v[184:185]
  v_pk_add_f32 v[146:147], v[146:147], v[186:187]
  v_cvt_pk_bf16_f32 v36, v144, v145
  v_cvt_pk_bf16_f32 v37, v146, v147
  s_waitcnt lgkmcnt(4)
  v_lshlrev_b32 v184, 16, v172
  v_and_b32 v185, s11, v172
  v_lshlrev_b32 v186, 16, v173
  v_and_b32 v187, s11, v173
  v_pk_add_f32 v[152:153], v[152:153], v[184:185]
  v_pk_add_f32 v[154:155], v[154:155], v[186:187]
  v_cvt_pk_bf16_f32 v38, v152, v153
  v_cvt_pk_bf16_f32 v39, v154, v155
  s_nop 1
  v_permlane16_swap_b32 v36, v38
  v_permlane16_swap_b32 v37, v39
  buffer_store_dwordx4 v[36:39], v12, s[44:47], 0 offen offset:1024 sc1
  s_waitcnt lgkmcnt(3)
  v_lshlrev_b32 v184, 16, v162
  v_and_b32 v185, s11, v162
  v_lshlrev_b32 v186, 16, v163
  v_and_b32 v187, s11, v163
  v_pk_add_f32 v[132:133], v[132:133], v[184:185]
  v_pk_add_f32 v[134:135], v[134:135], v[186:187]
  v_cvt_pk_bf16_f32 v40, v132, v133
  v_cvt_pk_bf16_f32 v41, v134, v135
  s_waitcnt lgkmcnt(2)
  v_lshlrev_b32 v184, 16, v166
  v_and_b32 v185, s11, v166
  v_lshlrev_b32 v186, 16, v167
  v_and_b32 v187, s11, v167
  v_pk_add_f32 v[140:141], v[140:141], v[184:185]
  v_pk_add_f32 v[142:143], v[142:143], v[186:187]
  v_cvt_pk_bf16_f32 v42, v140, v141
  v_cvt_pk_bf16_f32 v43, v142, v143
  s_nop 1
  v_permlane16_swap_b32 v40, v42
  v_permlane16_swap_b32 v41, v43
  buffer_store_dwordx4 v[40:43], v12, s[44:47], s3 offen offset:0 sc1
  s_waitcnt lgkmcnt(1)
  v_lshlrev_b32 v184, 16, v170
  v_and_b32 v185, s11, v170
  v_lshlrev_b32 v186, 16, v171
  v_and_b32 v187, s11, v171
  v_pk_add_f32 v[148:149], v[148:149], v[184:185]
  v_pk_add_f32 v[150:151], v[150:151], v[186:187]
  v_cvt_pk_bf16_f32 v44, v148, v149
  v_cvt_pk_bf16_f32 v45, v150, v151
  s_waitcnt lgkmcnt(0)
  v_lshlrev_b32 v184, 16, v174
  v_and_b32 v185, s11, v174
  v_lshlrev_b32 v186, 16, v175
  v_and_b32 v187, s11, v175
  v_pk_add_f32 v[156:157], v[156:157], v[184:185]
  v_pk_add_f32 v[158:159], v[158:159], v[186:187]
  v_cvt_pk_bf16_f32 v46, v156, v157
  v_cvt_pk_bf16_f32 v47, v158, v159
  s_nop 1
  v_permlane16_swap_b32 v44, v46
  v_permlane16_swap_b32 v45, v47
  buffer_store_dwordx4 v[44:47], v12, s[44:47], s3 offen offset:1024 sc1
  v_dot2_f32_bf16 v20, v32, s10, v20
  v_dot2_f32_bf16 v22, v32, v32, v22
  v_dot2_f32_bf16 v20, v33, s10, v20
  v_dot2_f32_bf16 v22, v33, v33, v22
  v_dot2_f32_bf16 v20, v34, s10, v20
  v_dot2_f32_bf16 v22, v34, v34, v22
  v_dot2_f32_bf16 v20, v35, s10, v20
  v_dot2_f32_bf16 v22, v35, v35, v22
  v_dot2_f32_bf16 v20, v36, s10, v20
  v_dot2_f32_bf16 v22, v36, v36, v22
  v_dot2_f32_bf16 v20, v37, s10, v20
  v_dot2_f32_bf16 v22, v37, v37, v22
  v_dot2_f32_bf16 v20, v38, s10, v20
  v_dot2_f32_bf16 v22, v38, v38, v22
  v_dot2_f32_bf16 v20, v39, s10, v20
  v_dot2_f32_bf16 v22, v39, v39, v22
  v_dot2_f32_bf16 v21, v40, s10, v21
  v_dot2_f32_bf16 v23, v40, v40, v23
  v_dot2_f32_bf16 v21, v41, s10, v21
  v_dot2_f32_bf16 v23, v41, v41, v23
  v_dot2_f32_bf16 v21, v42, s10, v21
  v_dot2_f32_bf16 v23, v42, v42, v23
  v_dot2_f32_bf16 v21, v43, s10, v21
  v_dot2_f32_bf16 v23, v43, v43, v23
  v_dot2_f32_bf16 v21, v44, s10, v21
  v_dot2_f32_bf16 v23, v44, v44, v23
  v_dot2_f32_bf16 v21, v45, s10, v21
  v_dot2_f32_bf16 v23, v45, v45, v23
  v_dot2_f32_bf16 v21, v46, s10, v21
  v_dot2_f32_bf16 v23, v46, v46, v23
  v_dot2_f32_bf16 v21, v47, s10, v21
  v_dot2_f32_bf16 v23, v47, v47, v23
  s_nop 2
  v_permlane32_swap_b32 v20, v21
  v_permlane32_swap_b32 v22, v23
  v_add_f32 v20, v20, v21
  v_add_f32 v22, v22, v23
  s_nop 1
  v_permlane16_swap_b32 v20, v22
  v_add_f32 v20, v20, v22
  buffer_store_dword v20, v18, s[56:59], 0 offen sc1
  s_endpgm
L_wo_loader:
  s_add_u32 s8, s70, s69
  s_and_b32 s8, s8, 3
  s_add_u32 s9, s70, s68
  s_and_b32 s9, s9, 3
  s_lshl_b32 s76, s8, 12
  s_lshl_b32 s77, s9, 11
  s_add_u32 s77, s77, 16384
  s_lshl_b32 s11, s68, 7
  v_and_b32 v10, 7, v1
  s_lshr_b32 s10, s76, 11
  s_lshl_b32 s3, s68, 3
  s_add_u32 s10, s10, s3
  s_mul_i32 s10, s10, 32768
  v_lshl_add_u32 v4, v1, 4, s10
  v_add_u32 v5, 32768, v4
  v_lshrrev_b32 v3, 3, v1
  s_lshl_b32 s10, s9, 4
  v_add_u32 v3, s10, v3
  v_mul_u32_u24 v3, 2048, v3
  v_lshrrev_b32 v2, 3, v1
  v_and_b32 v2, 2, v2
  v_xor_b32 v2, v2, v10
  s_mul_i32 s10, s69, 128
  v_add_u32 v3, s10, v3
  v_lshl_add_u32 v8, v2, 4, v3
  v_xor_b32 v2, 4, v2
  v_add_u32 v3, 16384, v3
  v_lshl_add_u32 v9, v2, 4, v3
  s_mov_b32 s75, 0
  s_add_u32 s100, s68, s69
  s_mov_b32 s101, -1
  s_add_u32 s101, s101, 1
  s_sub_u32 s73, s101, s100
  s_lshl_b32 s73, s73, 3
  s_lshr_b32 s73, 0xf0f02, s73
  s_and_b32 s73, s73, 255
  s_add_u32 s73, s73, s101
  s_and_b32 s73, s73, 15
  s_mul_i32 s74, s73, 131072
  s_lshl_b32 s73, s73, 11
  s_waitcnt lgkmcnt(0)
  s_mov_b32 s36, s34
  s_and_b32 s37, s35, 0xffff
  s_mov_b32 s38, 4194304
  s_mov_b32 s39, 0x00020000
  s_mov_b32 s40, s20
  s_and_b32 s41, s21, 0xffff
  s_mov_b32 s42, 2097152
  s_mov_b32 s43, 0x00020000
  s_add_u32 s3, s75, s76
  s_add_u32 m0, s3, 0
  s_nop 0
  buffer_load_dwordx4 v4, s[36:39], s73 offen offset:0 lds
  buffer_load_dwordx4 v4, s[36:39], s73 offen offset:1024 lds
  s_add_u32 m0, s3, 2048
  s_nop 0
  buffer_load_dwordx4 v5, s[36:39], s73 offen offset:0 lds
  buffer_load_dwordx4 v5, s[36:39], s73 offen offset:1024 lds
  s_add_u32 s3, s75, s77
  s_add_u32 m0, s3, 0
  s_add_u32 s4, s74, 0
  buffer_load_dwordx4 v8, s[40:43], s4 offen lds
  s_add_u32 m0, s3, 1024
  s_nop 0
  buffer_load_dwordx4 v9, s[40:43], s4 offen lds
  s_add_u32 s101, s101, 1
  s_sub_u32 s73, s101, s100
  s_lshl_b32 s73, s73, 3
  s_lshr_b32 s73, 0xf0f02, s73
  s_and_b32 s73, s73, 255
  s_add_u32 s73, s73, s101
  s_and_b32 s73, s73, 15
  s_mul_i32 s74, s73, 131072
  s_lshl_b32 s73, s73, 11
  s_add_u32 s75, s75, 24576
  s_cmp_eq_u32 s75, 147456
  s_cselect_b32 s75, 0, s75
  s_add_u32 s3, s75, s76
  s_add_u32 m0, s3, 0
  s_nop 0
  buffer_load_dwordx4 v4, s[36:39], s73 offen offset:0 lds
  buffer_load_dwordx4 v4, s[36:39], s73 offen offset:1024 lds
  s_add_u32 m0, s3, 2048
  s_nop 0
  buffer_load_dwordx4 v5, s[36:39], s73 offen offset:0 lds
  buffer_load_dwordx4 v5, s[36:39], s73 offen offset:1024 lds
  s_add_u32 s3, s75, s77
  s_add_u32 m0, s3, 0
  s_add_u32 s4, s74, 0
  buffer_load_dwordx4 v8, s[40:43], s4 offen lds
  s_add_u32 m0, s3, 1024
  s_nop 0
  buffer_load_dwordx4 v9, s[40:43], s4 offen lds
  s_add_u32 s101, s101, 1
  s_sub_u32 s73, s101, s100
  s_lshl_b32 s73, s73, 3
  s_lshr_b32 s73, 0xf0f02, s73
  s_and_b32 s73, s73, 255
  s_add_u32 s73, s73, s101
  s_and_b32 s73, s73, 15
  s_mul_i32 s74, s73, 131072
  s_lshl_b32 s73, s73, 11
  s_add_u32 s75, s75, 24576
  s_cmp_eq_u32 s75, 147456
  s_cselect_b32 s75, 0, s75
  s_waitcnt vmcnt(6)
  s_barrier
  s_add_u32 s3, s75, s76
  s_add_u32 m0, s3, 0
  s_nop 0
  buffer_load_dwordx4 v4, s[36:39], s73 offen offset:0 lds
  buffer_load_dwordx4 v4, s[36:39], s73 offen offset:1024 lds
  s_add_u32 m0, s3, 2048
  s_nop 0
  buffer_load_dwordx4 v5, s[36:39], s73 offen offset:0 lds
  buffer_load_dwordx4 v5, s[36:39], s73 offen offset:1024 lds
  s_add_u32 s3, s75, s77
  s_add_u32 m0, s3, 0
  s_add_u32 s4, s74, 0
  buffer_load_dwordx4 v8, s[40:43], s4 offen lds
  s_add_u32 m0, s3, 1024
  s_nop 0
  buffer_load_dwordx4 v9, s[40:43], s4 offen lds
  s_add_u32 s101, s101, 1
  s_sub_u32 s73, s101, s100
  s_lshl_b32 s73, s73, 3
  s_lshr_b32 s73, 0xf0f02, s73
  s_and_b32 s73, s73, 255
  s_add_u32 s73, s73, s101
  s_and_b32 s73, s73, 15
  s_mul_i32 s74, s73, 131072
  s_lshl_b32 s73, s73, 11
  s_add_u32 s75, s75, 24576
  s_cmp_eq_u32 s75, 147456
  s_cselect_b32 s75, 0, s75
  s_add_u32 s3, s75, s76
  s_add_u32 m0, s3, 0
  s_nop 0
  buffer_load_dwordx4 v4, s[36:39], s73 offen offset:0 lds
  buffer_load_dwordx4 v4, s[36:39], s73 offen offset:1024 lds
  s_add_u32 m0, s3, 2048
  s_nop 0
  buffer_load_dwordx4 v5, s[36:39], s73 offen offset:0 lds
  buffer_load_dwordx4 v5, s[36:39], s73 offen offset:1024 lds
  s_add_u32 s3, s75, s77
  s_add_u32 m0, s3, 0
  s_add_u32 s4, s74, 0
  buffer_load_dwordx4 v8, s[40:43], s4 offen lds
  s_add_u32 m0, s3, 1024
  s_nop 0
  buffer_load_dwordx4 v9, s[40:43], s4 offen lds
  s_add_u32 s101, s101, 1
  s_sub_u32 s73, s101, s100
  s_lshl_b32 s73, s73, 3
  s_lshr_b32 s73, 0xf0f02, s73
  s_and_b32 s73, s73, 255
  s_add_u32 s73, s73, s101
  s_and_b32 s73, s73, 15
  s_mul_i32 s74, s73, 131072
  s_lshl_b32 s73, s73, 11
  s_add_u32 s75, s75, 24576
  s_cmp_eq_u32 s75, 147456
  s_cselect_b32 s75, 0, s75
  s_add_u32 s3, s75, s76
  s_add_u32 m0, s3, 0
  s_nop 0
  buffer_load_dwordx4 v4, s[36:39], s73 offen offset:0 lds
  buffer_load_dwordx4 v4, s[36:39], s73 offen offset:1024 lds
  s_add_u32 m0, s3, 2048
  s_nop 0
  buffer_load_dwordx4 v5, s[36:39], s73 offen offset:0 lds
  buffer_load_dwordx4 v5, s[36:39], s73 offen offset:1024 lds
  s_add_u32 s3, s75, s77
  s_add_u32 m0, s3, 0
  s_add_u32 s4, s74, 0
  buffer_load_dwordx4 v8, s[40:43], s4 offen lds
  s_add_u32 m0, s3, 1024
  s_nop 0
  buffer_load_dwordx4 v9, s[40:43], s4 offen lds
  s_add_u32 s101, s101, 1
  s_sub_u32 s73, s101, s100
  s_lshl_b32 s73, s73, 3
  s_lshr_b32 s73, 0xf0f02, s73
  s_and_b32 s73, s73, 255
  s_add_u32 s73, s73, s101
  s_and_b32 s73, s73, 15
  s_mul_i32 s74, s73, 131072
  s_lshl_b32 s73, s73, 11
  s_add_u32 s75, s75, 24576
  s_cmp_eq_u32 s75, 147456
  s_cselect_b32 s75, 0, s75
  s_mov_b32 s79, 10
L_wol_ld:
  s_add_u32 s3, s75, s76
  s_add_u32 m0, s3, 0
  s_nop 0
  buffer_load_dwordx4 v4, s[36:39], s73 offen offset:0 lds
  buffer_load_dwordx4 v4, s[36:39], s73 offen offset:1024 lds
  s_add_u32 m0, s3, 2048
  s_nop 0
  buffer_load_dwordx4 v5, s[36:39], s73 offen offset:0 lds
  buffer_load_dwordx4 v5, s[36:39], s73 offen offset:1024 lds
  s_add_u32 s3, s75, s77
  s_add_u32 m0, s3, 0
  s_add_u32 s4, s74, 0
  buffer_load_dwordx4 v8, s[40:43], s4 offen lds
  s_add_u32 m0, s3, 1024
  s_nop 0
  buffer_load_dwordx4 v9, s[40:43], s4 offen lds
  s_add_u32 s101, s101, 1
  s_sub_u32 s73, s101, s100
  s_lshl_b32 s73, s73, 3
  s_lshr_b32 s73, 0xf0f02, s73
  s_and_b32 s73, s73, 255
  s_add_u32 s73, s73, s101
  s_and_b32 s73, s73, 15
  s_mul_i32 s74, s73, 131072
  s_lshl_b32 s73, s73, 11
  s_add_u32 s75, s75, 24576
  s_cmp_eq_u32 s75, 147456
  s_cselect_b32 s75, 0, s75
  s_waitcnt vmcnt(24)
  s_barrier
  s_sub_u32 s79, s79, 1
  s_cmp_lg_u32 s79, 0
  s_cbranch_scc1 L_wol_ld
  s_add_u32 s3, s75, s76
  s_add_u32 m0, s3, 0
  s_nop 0
  buffer_load_dwordx4 v4, s[36:39], s73 offen offset:0 lds
  buffer_load_dwordx4 v4, s[36:39], s73 offen offset:1024 lds
  s_add_u32 m0, s3, 2048
  s_nop 0
  buffer_load_dwordx4 v5, s[36:39], s73 offen offset:0 lds
  buffer_load_dwordx4 v5, s[36:39], s73 offen offset:1024 lds
  s_add_u32 s3, s75, s77
  s_add_u32 m0, s3, 0
  s_add_u32 s4, s74, 0
  buffer_load_dwordx4 v8, s[40:43], s4 offen lds
  s_add_u32 m0, s3, 1024
  s_nop 0
  buffer_load_dwordx4 v9, s[40:43], s4 offen lds
  s_add_u32 s101, s101, 1
  s_sub_u32 s73, s101, s100
  s_lshl_b32 s73, s73, 3
  s_lshr_b32 s73, 0xf0f02, s73
  s_and_b32 s73, s73, 255
  s_add_u32 s73, s73, s101
  s_and_b32 s73, s73, 15
  s_mul_i32 s74, s73, 131072
  s_lshl_b32 s73, s73, 11
  s_add_u32 s75, s75, 24576
  s_cmp_eq_u32 s75, 147456
  s_cselect_b32 s75, 0, s75
  s_mov_b32 s48, s12
  s_and_b32 s49, s13, 0xffff
  s_mov_b32 s50, 4194304
  s_mov_b32 s51, 0x00020000
  v_lshrrev_b32 v3, 3, v1
  s_lshr_b32 s10, s76, 7
  s_lshl_b32 s3, s68, 7
  s_add_u32 s10, s10, s3
  v_add_u32 v3, s10, v3
  v_mul_u32_u24 v3, 2048, v3
  v_lshrrev_b32 v2, 4, v1
  v_xor_b32 v4, v2, v10
  v_lshl_add_u32 v4, v4, 4, v3
  v_add_u32 v3, 16384, v3
  v_add_u32 v5, 4, v2
  v_xor_b32 v5, v5, v10
  v_lshl_add_u32 v5, v5, 4, v3
  v_add_u32 v3, 16384, v3
  v_xor_b32 v6, v2, v10
  v_lshl_add_u32 v6, v6, 4, v3
  v_add_u32 v3, 16384, v3
  v_add_u32 v7, 4, v2
  v_xor_b32 v7, v7, v10
  v_lshl_add_u32 v7, v7, 4, v3
  s_lshl_b32 s4, s69, 7
  s_add_u32 m0, s76, 147456
  s_nop 0
  buffer_load_dwordx4 v4, s[48:51], s4 offen lds
  s_add_u32 m0, s76, 148480
  s_nop 0
  buffer_load_dwordx4 v5, s[48:51], s4 offen lds
  s_add_u32 m0, s76, 149504
  s_nop 0
  buffer_load_dwordx4 v6, s[48:51], s4 offen lds
  s_add_u32 m0, s76, 150528
  s_nop 0
  buffer_load_dwordx4 v7, s[48:51], s4 offen lds
  s_waitcnt vmcnt(28)
  s_barrier
  s_waitcnt vmcnt(22)
  s_barrier
  s_waitcnt vmcnt(16)
  s_barrier
  s_waitcnt vmcnt(10)
  s_barrier
  s_waitcnt vmcnt(4)
  s_barrier
  s_waitcnt vmcnt(0)
  s_barrier
L_wo_side:
  s_waitcnt vmcnt(0)
L_wo_end:
  s_endpgm
.section .rodata,"a"
.p2align 6
.amdhsa_kernel wol0_kernel
  .amdhsa_next_free_vgpr 256
  .amdhsa_next_free_sgpr 102
  .amdhsa_accum_offset 256
  .amdhsa_group_segment_fixed_size 0
  .amdhsa_kernarg_size 88
  .amdhsa_user_sgpr_count 2
  .amdhsa_user_sgpr_kernarg_segment_ptr 1
  .amdhsa_system_sgpr_workgroup_id_x 1
  .amdhsa_float_denorm_mode_32 3
  .amdhsa_float_denorm_mode_16_64 3
.end_amdhsa_kernel
.text
.text
.globl wol1_kernel
.p2align 8
.type wol1_kernel,@function
wol1_kernel:
  s_load_dwordx16 s[16:31], s[0:1], 0
  s_load_dwordx2 s[32:33], s[0:1], 64
  s_load_dwordx2 s[34:35], s[0:1], 80
  s_load_dwordx2 s[12:13], s[0:1], 64
  s_mov_b32 s96, 1
  s_branch L_wo_body
L_wo_c1:
.section .rodata,"a"
.p2align 6
.amdhsa_kernel wol1_kernel
  .amdhsa_next_free_vgpr 256
  .amdhsa_next_free_sgpr 102
  .amdhsa_accum_offset 256
  .amdhsa_group_segment_fixed_size 0
  .amdhsa_kernarg_size 88
  .amdhsa_user_sgpr_count 2
  .amdhsa_user_sgpr_kernarg_segment_ptr 1
  .amdhsa_system_sgpr_workgroup_id_x 1
  .amdhsa_float_denorm_mode_32 3
  .amdhsa_float_denorm_mode_16_64 3
.end_amdhsa_kernel
.text
L_w1_c0:
.text
.globl w1l0_kernel
.p2align 8
.type w1l0_kernel,@function
w1l0_kernel:
  s_load_dwordx16 s[16:31], s[0:1], 0
  s_load_dwordx2 s[32:33], s[0:1], 64
  s_load_dwordx2 s[34:35], s[0:1], 80
  s_load_dwordx2 s[12:13], s[0:1], 0
  s_mov_b32 s96, 0
L_w1_body:
  s_cmp_ge_u32 s2, 256
  s_cbranch_scc1 L_w1_end
  v_lshrrev_b32 v2, 6, v0
  v_and_b32 v1, 63, v0
  v_readfirstlane_b32 s70, v2
  s_and_b32 s3, s2, 7
  s_lshr_b32 s99, s2, 3
  s_and_b32 s5, s3, 1
  s_lshl_b32 s5, s5, 3
  s_and_b32 s6, s99, 7
  s_add_u32 s68, s5, s6
  s_lshr_b32 s5, s3, 1
  s_lshl_b32 s5, s5, 2
  s_lshr_b32 s6, s99, 3
  s_add_u32 s69, s5, s6
  s_cmp_ge_u32 s70, 4
  s_cbranch_scc1 L_w1_loader
  s_and_b32 s71, s70, 1
  s_lshr_b32 s72, s70, 1
  v_and_b32 v3, 15, v1
  v_lshrrev_b32 v2, 4, v1
  s_lshl_b32 s8, s71, 13
  v_lshl_add_u32 v4, v1, 4, s8
  v_bfe_u32 v13, v1, 2, 2
  v_lshl_add_u32 v13, v2, 3, v13
  v_lshlrev_b32 v13, 7, v13
  v_and_b32 v17, 3, v1
  v_lshl_add_u32 v13, v17, 3, v13
  v_bfe_u32 v17, v1, 3, 2
  v_lshl_add_u32 v13, v17, 5, v13
  s_and_b32 s8, s69, 1
  s_lshl_b32 s8, s8, 1
  s_lshl_b32 s9, s72, 3
  s_add_u32 s11, s8, s72
  s_add_u32 s8, s8, s9
  s_add_u32 s9, s8, 0
  s_and_b32 s10, s9, 3
  s_lshl_b32 s10, s10, 5
  s_lshr_b32 s9, s9, 2
  s_lshl_b32 s9, s9, 13
  s_add_u32 s9, s9, 16384
  v_xor_b32 v5, s10, v13
  v_add_u32 v5, s9, v5
  s_add_u32 s9, s8, 1
  s_and_b32 s10, s9, 3
  s_lshl_b32 s10, s10, 5
  s_lshr_b32 s9, s9, 2
  s_lshl_b32 s9, s9, 13
  s_add_u32 s9, s9, 16384
  v_xor_b32 v6, s10, v13
  v_add_u32 v6, s9, v6
  s_add_u32 s9, s8, 2
  s_and_b32 s10, s9, 3
  s_lshl_b32 s10, s10, 5
  s_lshr_b32 s9, s9, 2
  s_lshl_b32 s9, s9, 13
  s_add_u32 s9, s9, 16384
  v_xor_b32 v7, s10, v13
  v_add_u32 v7, s9, v7
  s_add_u32 s9, s8, 3
  s_and_b32 s10, s9, 3
  s_lshl_b32 s10, s10, 5
  s_lshr_b32 s9, s9, 2
  s_lshl_b32 s9, s9, 13
  s_add_u32 s9, s9, 16384
  v_xor_b32 v8, s10, v13
  v_add_u32 v8, s9, v8
  s_add_u32 s9, s11, 6
  s_and_b32 s10, s9, 3
  s_lshl_b32 s10, s10, 5
  s_lshr_b32 s9, s9, 2
  s_lshl_b32 s9, s9, 13
  s_add_u32 s9, s9, 16384
  v_xor_b32 v9, s10, v13
  v_add_u32 v9, s9, v9
  s_lshl_b32 s8, s68, 7
  s_lshl_b32 s9, s71, 6
  s_add_u32 s8, s8, s9
  s_add_u32 s8, s8, s69
  s_mul_i32 s8, s8, 7168
  v_and_b32 v16, 1, v2
  v_lshrrev_b32 v17, 1, v2
  v_lshlrev_b32 v14, 8, v17
  v_lshl_add_u32 v14, v3, 4, v14
  v_add_u32 v14, s8, v14
  s_lshl_b32 s9, s72, 12
  v_lshl_add_u32 v12, v16, 9, v14
  v_add_u32 v12, s9, v12
  v_mul_u32_u24 v16, 114688, v16
  s_lshl_b32 s9, s72, 9
  v_add3_u32 v13, v16, v14, s9
  s_lshl_b32 s9, s71, 8
  s_add_u32 s9, s9, 147520
  v_lshl_add_u32 v14, v3, 2, s9
  s_lshl_b32 s9, s72, 9
  s_add_u32 s9, s9, 148736
  v_lshl_add_u32 v15, v2, 4, s9
  s_lshl_b32 s9, s72, 6
  s_add_u32 s9, s9, 148736
  v_lshl_add_u32 v16, v2, 4, s9
  v_mov_b32 v128, 0
  v_mov_b32 v129, 0
  v_mov_b32 v130, 0
  v_mov_b32 v131, 0
  v_mov_b32 v132, 0
  v_mov_b32 v133, 0
  v_mov_b32 v134, 0
  v_mov_b32 v135, 0
  v_mov_b32 v136, 0
  v_mov_b32 v137, 0
  v_mov_b32 v138, 0
  v_mov_b32 v139, 0
  v_mov_b32 v140, 0
  v_mov_b32 v141, 0
  v_mov_b32 v142, 0
  v_mov_b32 v143, 0
  v_mov_b32 v144, 0
  v_mov_b32 v145, 0
  v_mov_b32 v146, 0
  v_mov_b32 v147, 0
  v_mov_b32 v148, 0
  v_mov_b32 v149, 0
  v_mov_b32 v150, 0
  v_mov_b32 v151, 0
  v_mov_b32 v152, 0
  v_mov_b32 v153, 0
  v_mov_b32 v154, 0
  v_mov_b32 v155, 0
  v_mov_b32 v156, 0
  v_mov_b32 v157, 0
  v_mov_b32 v158, 0
  v_mov_b32 v159, 0
  v_mov_b32 v160, 0
  v_mov_b32 v161, 0
  v_mov_b32 v162, 0
  v_mov_b32 v163, 0
  v_mov_b32 v164, 0
  v_mov_b32 v165, 0
  v_mov_b32 v166, 0
  v_mov_b32 v167, 0
  v_mov_b32 v168, 0
  v_mov_b32 v169, 0
  v_mov_b32 v170, 0
  v_mov_b32 v171, 0
  v_mov_b32 v172, 0
  v_mov_b32 v173, 0
  v_mov_b32 v174, 0
  v_mov_b32 v175, 0
  v_mov_b32 v176, 0
  v_mov_b32 v177, 0
  v_mov_b32 v178, 0
  v_mov_b32 v179, 0
  v_mov_b32 v180, 0
  v_mov_b32 v181, 0
  v_mov_b32 v182, 0
  v_mov_b32 v183, 0
  v_mov_b32 v184, 0
  v_mov_b32 v185, 0
  v_mov_b32 v186, 0
  v_mov_b32 v187, 0
  v_mov_b32 v188, 0
  v_mov_b32 v189, 0
  v_mov_b32 v190, 0
  v_mov_b32 v191, 0
  v_mov_b32 v192, 0
  v_mov_b32 v193, 0
  v_mov_b32 v194, 0
  v_mov_b32 v195, 0
  v_mov_b32 v196, 0
  v_mov_b32 v197, 0
  v_mov_b32 v198, 0
  v_mov_b32 v199, 0
  v_mov_b32 v200, 0
  v_mov_b32 v201, 0
  v_mov_b32 v202, 0
  v_mov_b32 v203, 0
  v_mov_b32 v204, 0
  v_mov_b32 v205, 0
  v_mov_b32 v206, 0
  v_mov_b32 v207, 0
  v_mov_b32 v208, 0
  v_mov_b32 v209, 0
  v_mov_b32 v210, 0
  v_mov_b32 v211, 0
  v_mov_b32 v212, 0
  v_mov_b32 v213, 0
  v_mov_b32 v214, 0
  v_mov_b32 v215, 0
  v_mov_b32 v216, 0
  v_mov_b32 v217, 0
  v_mov_b32 v218, 0
  v_mov_b32 v219, 0
  v_mov_b32 v220, 0
  v_mov_b32 v221, 0
  v_mov_b32 v222, 0
  v_mov_b32 v223, 0
  v_mov_b32 v224, 0
  v_mov_b32 v225, 0
  v_mov_b32 v226, 0
  v_mov_b32 v227, 0
  v_mov_b32 v228, 0
  v_mov_b32 v229, 0
  v_mov_b32 v230, 0
  v_mov_b32 v231, 0
  v_mov_b32 v232, 0
  v_mov_b32 v233, 0
  v_mov_b32 v234, 0
  v_mov_b32 v235, 0
  v_mov_b32 v236, 0
  v_mov_b32 v237, 0
  v_mov_b32 v238, 0
  v_mov_b32 v239, 0
  s_waitcnt lgkmcnt(0)
  s_add_u32 s44, s34, 8388608
  s_addc_u32 s45, s35, 0
  s_and_b32 s45, s45, 0xffff
  s_mov_b32 s46, 14680064
  s_mov_b32 s47, 0x00020000
  s_mov_b32 s75, 0
  v_add_u32_e64 v20, s75, v4
  v_add_u32_e64 v21, s75, v5
  v_add_u32_e64 v22, s75, v6
  v_add_u32_e64 v23, s75, v7
  v_add_u32_e64 v24, s75, v8
  v_add_u32_e64 v25, s75, v9
  s_add_u32 s75, s75, 49152
  s_cmp_eq_u32 s75, 147456
  s_cselect_b32 s75, 0, s75
  s_mov_b32 s79, 16
  s_barrier
  ds_read_b128 v[32:35], v20 offset:0
  ds_read_b128 v[36:39], v20 offset:2048
  ds_read_b128 v[40:43], v20 offset:4096
  ds_read_b128 v[44:47], v20 offset:6144
  ds_read_b64_tr_b16 v[48:49], v21 offset:0
  ds_read_b64_tr_b16 v[50:51], v21 offset:512
  ds_read_b64_tr_b16 v[52:53], v22 offset:0
  ds_read_b64_tr_b16 v[54:55], v22 offset:512
  ds_read_b64_tr_b16 v[56:57], v23 offset:0
  ds_read_b64_tr_b16 v[58:59], v23 offset:512
  ds_read_b64_tr_b16 v[60:61], v24 offset:0
  ds_read_b64_tr_b16 v[62:63], v24 offset:512
  ds_read_b64_tr_b16 v[64:65], v21 offset:8192
  ds_read_b64_tr_b16 v[66:67], v21 offset:8704
  ds_read_b64_tr_b16 v[68:69], v22 offset:8192
  ds_read_b64_tr_b16 v[70:71], v22 offset:8704
  ds_read_b64_tr_b16 v[72:73], v25 offset:0
  ds_read_b64_tr_b16 v[74:75], v25 offset:512
  s_waitcnt lgkmcnt(0)
.p2align 3
L_w1_loop:
  v_mfma_f32_16x16x32_bf16 v[128:131], v[48:51], v[32:35], v[128:131]
  ds_read_b128 v[80:83], v20 offset:1024
  v_mfma_f32_16x16x32_bf16 v[132:135], v[48:51], v[36:39], v[132:135]
  ds_read_b128 v[84:87], v20 offset:3072
  v_mfma_f32_16x16x32_bf16 v[136:139], v[48:51], v[40:43], v[136:139]
  ds_read_b128 v[88:91], v20 offset:5120
  v_mfma_f32_16x16x32_bf16 v[140:143], v[48:51], v[44:47], v[140:143]
  ds_read_b128 v[92:95], v20 offset:7168
  v_mfma_f32_16x16x32_bf16 v[144:147], v[52:55], v[32:35], v[144:147]
  ds_read_b64_tr_b16 v[96:97], v21 offset:4096
  v_mfma_f32_16x16x32_bf16 v[148:151], v[52:55], v[36:39], v[148:151]
  ds_read_b64_tr_b16 v[98:99], v21 offset:4608
  v_mfma_f32_16x16x32_bf16 v[152:155], v[52:55], v[40:43], v[152:155]
  ds_read_b64_tr_b16 v[100:101], v22 offset:4096
  v_mfma_f32_16x16x32_bf16 v[156:159], v[52:55], v[44:47], v[156:159]
  ds_read_b64_tr_b16 v[102:103], v22 offset:4608
  v_mfma_f32_16x16x32_bf16 v[160:163], v[56:59], v[32:35], v[160:163]
  ds_read_b64_tr_b16 v[104:105], v23 offset:4096
  v_mfma_f32_16x16x32_bf16 v[164:167], v[56:59], v[36:39], v[164:167]
  ds_read_b64_tr_b16 v[106:107], v23 offset:4608
  v_mfma_f32_16x16x32_bf16 v[168:171], v[56:59], v[40:43], v[168:171]
  ds_read_b64_tr_b16 v[108:109], v24 offset:4096
  v_mfma_f32_16x16x32_bf16 v[172:175], v[56:59], v[44:47], v[172:175]
  ds_read_b64_tr_b16 v[110:111], v24 offset:4608
  v_mfma_f32_16x16x32_bf16 v[176:179], v[60:63], v[32:35], v[176:179]
  ds_read_b64_tr_b16 v[112:113], v21 offset:12288
  v_mfma_f32_16x16x32_bf16 v[180:183], v[60:63], v[36:39], v[180:183]
  ds_read_b64_tr_b16 v[114:115], v21 offset:12800
  v_mfma_f32_16x16x32_bf16 v[184:187], v[60:63], v[40:43], v[184:187]
  ds_read_b64_tr_b16 v[116:117], v22 offset:12288
  v_mfma_f32_16x16x32_bf16 v[188:191], v[60:63], v[44:47], v[188:191]
  ds_read_b64_tr_b16 v[118:119], v22 offset:12800
  v_mfma_f32_16x16x32_bf16 v[192:195], v[64:67], v[32:35], v[192:195]
  ds_read_b64_tr_b16 v[120:121], v25 offset:4096
  v_mfma_f32_16x16x32_bf16 v[196:199], v[64:67], v[36:39], v[196:199]
  ds_read_b64_tr_b16 v[122:123], v25 offset:4608
  v_mfma_f32_16x16x32_bf16 v[200:203], v[64:67], v[40:43], v[200:203]
  v_add_u32_e64 v20, s75, v4
  v_mfma_f32_16x16x32_bf16 v[204:207], v[64:67], v[44:47], v[204:207]
  v_add_u32_e64 v21, s75, v5
  v_mfma_f32_16x16x32_bf16 v[208:211], v[68:71], v[32:35], v[208:211]
  v_add_u32_e64 v22, s75, v6
  v_mfma_f32_16x16x32_bf16 v[212:215], v[68:71], v[36:39], v[212:215]
  v_add_u32_e64 v23, s75, v7
  v_mfma_f32_16x16x32_bf16 v[216:219], v[68:71], v[40:43], v[216:219]
  v_add_u32_e64 v24, s75, v8
  v_mfma_f32_16x16x32_bf16 v[220:223], v[68:71], v[44:47], v[220:223]
  v_add_u32_e64 v25, s75, v9
  v_mfma_f32_16x16x32_bf16 v[224:227], v[72:75], v[32:35], v[224:227]
  s_add_u32 s75, s75, 49152
  v_mfma_f32_16x16x32_bf16 v[228:231], v[72:75], v[36:39], v[228:231]
  s_cmp_eq_u32 s75, 147456
  v_mfma_f32_16x16x32_bf16 v[232:235], v[72:75], v[40:43], v[232:235]
  s_cselect_b32 s75, 0, s75
  s_sub_u32 s79, s79, 1
  v_mfma_f32_16x16x32_bf16 v[236:239], v[72:75], v[44:47], v[236:239]
  s_waitcnt lgkmcnt(0)
  s_barrier
  v_mfma_f32_16x16x32_bf16 v[128:131], v[96:99], v[80:83], v[128:131]
  ds_read_b128 v[32:35], v20 offset:0
  v_mfma_f32_16x16x32_bf16 v[132:135], v[96:99], v[84:87], v[132:135]
  ds_read_b128 v[36:39], v20 offset:2048
  v_mfma_f32_16x16x32_bf16 v[136:139], v[96:99], v[88:91], v[136:139]
  ds_read_b128 v[40:43], v20 offset:4096
  v_mfma_f32_16x16x32_bf16 v[140:143], v[96:99], v[92:95], v[140:143]
  ds_read_b128 v[44:47], v20 offset:6144
  v_mfma_f32_16x16x32_bf16 v[144:147], v[100:103], v[80:83], v[144:147]
  ds_read_b64_tr_b16 v[48:49], v21 offset:0
  v_mfma_f32_16x16x32_bf16 v[148:151], v[100:103], v[84:87], v[148:151]
  ds_read_b64_tr_b16 v[50:51], v21 offset:512
  v_mfma_f32_16x16x32_bf16 v[152:155], v[100:103], v[88:91], v[152:155]
  ds_read_b64_tr_b16 v[52:53], v22 offset:0
  v_mfma_f32_16x16x32_bf16 v[156:159], v[100:103], v[92:95], v[156:159]
  ds_read_b64_tr_b16 v[54:55], v22 offset:512
  v_mfma_f32_16x16x32_bf16 v[160:163], v[104:107], v[80:83], v[160:163]
  ds_read_b64_tr_b16 v[56:57], v23 offset:0
  v_mfma_f32_16x16x32_bf16 v[164:167], v[104:107], v[84:87], v[164:167]
  ds_read_b64_tr_b16 v[58:59], v23 offset:512
  v_mfma_f32_16x16x32_bf16 v[168:171], v[104:107], v[88:91], v[168:171]
  ds_read_b64_tr_b16 v[60:61], v24 offset:0
  v_mfma_f32_16x16x32_bf16 v[172:175], v[104:107], v[92:95], v[172:175]
  ds_read_b64_tr_b16 v[62:63], v24 offset:512
  v_mfma_f32_16x16x32_bf16 v[176:179], v[108:111], v[80:83], v[176:179]
  ds_read_b64_tr_b16 v[64:65], v21 offset:8192
  v_mfma_f32_16x16x32_bf16 v[180:183], v[108:111], v[84:87], v[180:183]
  ds_read_b64_tr_b16 v[66:67], v21 offset:8704
  v_mfma_f32_16x16x32_bf16 v[184:187], v[108:111], v[88:91], v[184:187]
  ds_read_b64_tr_b16 v[68:69], v22 offset:8192
  v_mfma_f32_16x16x32_bf16 v[188:191], v[108:111], v[92:95], v[188:191]
  ds_read_b64_tr_b16 v[70:71], v22 offset:8704
  v_mfma_f32_16x16x32_bf16 v[192:195], v[112:115], v[80:83], v[192:195]
  ds_read_b64_tr_b16 v[72:73], v25 offset:0
  v_mfma_f32_16x16x32_bf16 v[196:199], v[112:115], v[84:87], v[196:199]
  ds_read_b64_tr_b16 v[74:75], v25 offset:512
  v_mfma_f32_16x16x32_bf16 v[200:203], v[112:115], v[88:91], v[200:203]
  s_cmp_lg_u32 s79, 0
  s_nop 0
  v_mfma_f32_16x16x32_bf16 v[204:207], v[112:115], v[92:95], v[204:207]
  v_mfma_f32_16x16x32_bf16 v[208:211], v[116:119], v[80:83], v[208:211]
  v_mfma_f32_16x16x32_bf16 v[212:215], v[116:119], v[84:87], v[212:215]
  v_mfma_f32_16x16x32_bf16 v[216:219], v[116:119], v[88:91], v[216:219]
  v_mfma_f32_16x16x32_bf16 v[220:223], v[116:119], v[92:95], v[220:223]
  v_mfma_f32_16x16x32_bf16 v[224:227], v[120:123], v[80:83], v[224:227]
  v_mfma_f32_16x16x32_bf16 v[228:231], v[120:123], v[84:87], v[228:231]
  v_mfma_f32_16x16x32_bf16 v[232:235], v[120:123], v[88:91], v[232:235]
  v_mfma_f32_16x16x32_bf16 v[236:239], v[120:123], v[92:95], v[236:239]
  s_waitcnt lgkmcnt(0)
  s_cbranch_scc1 L_w1_loop
L_w1_exit:
  ds_read2_b32 v[88:89], v14 offset0:0 offset1:160
  ds_read2_b32 v[90:91], v14 offset0:16 offset1:176
  ds_read2_b32 v[92:93], v14 offset0:32 offset1:192
  ds_read2_b32 v[94:95], v14 offset0:48 offset1:208
  ds_read_b128 v[32:35], v15 offset:0
  ds_read_b128 v[60:63], v15 offset:1024
  ds_read_b128 v[36:39], v15 offset:64
  ds_read_b128 v[64:67], v15 offset:1088
  ds_read_b128 v[40:43], v15 offset:128
  ds_read_b128 v[68:71], v15 offset:1152
  ds_read_b128 v[44:47], v15 offset:192
  ds_read_b128 v[72:75], v15 offset:1216
  ds_read_b128 v[48:51], v15 offset:256
  ds_read_b128 v[76:79], v15 offset:1280
  ds_read_b128 v[52:55], v15 offset:320
  ds_read_b128 v[80:83], v15 offset:1344
  ds_read_b128 v[56:59], v16 offset:384
  ds_read_b128 v[84:87], v16 offset:1408
  v_mov_b32 v96, 0xc0135761
  v_mov_b32 v97, 0xbdd2d3e8
  v_mov_b32 v98, 1.0
  s_waitcnt lgkmcnt(0)
  v_mul_f32 v88, v88, v89
  v_mul_f32 v90, v90, v91
  v_mul_f32 v92, v92, v93
  v_mul_f32 v94, v94, v95
  v_pk_fma_f32 v[100:101], v[32:33], v[88:89], v[60:61] op_sel:[0,0,0] op_sel_hi:[1,0,1] neg_lo:[0,1,0] neg_hi:[0,1,0]
  v_pk_fma_f32 v[102:103], v[34:35], v[88:89], v[62:63] op_sel:[0,0,0] op_sel_hi:[1,0,1] neg_lo:[0,1,0] neg_hi:[0,1,0]
  v_pk_fma_f32 v[128:129], v[128:129], v[88:89], v[100:101] op_sel:[0,1,0] op_sel_hi:[1,1,1]
  v_pk_fma_f32 v[130:131], v[130:131], v[88:89], v[102:103] op_sel:[0,1,0] op_sel_hi:[1,1,1]
  v_pk_mul_f32 v[100:101], v[128:129], v[128:129]
  v_pk_mul_f32 v[102:103], v[130:131], v[130:131]
  v_pk_fma_f32 v[100:101], v[100:101], v[96:97], v[96:97] op_sel:[0,1,0] op_sel_hi:[1,1,0]
  v_pk_fma_f32 v[102:103], v[102:103], v[96:97], v[96:97] op_sel:[0,1,0] op_sel_hi:[1,1,0]
  v_pk_mul_f32 v[100:101], v[100:101], v[128:129]
  v_pk_mul_f32 v[102:103], v[102:103], v[130:131]
  v_exp_f32 v100, v100
  v_exp_f32 v101, v101
  v_exp_f32 v102, v102
  v_exp_f32 v103, v103
  v_pk_add_f32 v[100:101], v[100:101], v[98:99] op_sel_hi:[1,0]
  v_pk_add_f32 v[102:103], v[102:103], v[98:99] op_sel_hi:[1,0]
  v_rcp_f32 v100, v100
  v_rcp_f32 v101, v101
  v_rcp_f32 v102, v102
  v_rcp_f32 v103, v103
  v_pk_mul_f32 v[128:129], v[128:129], v[100:101]
  v_pk_mul_f32 v[130:131], v[130:131], v[102:103]
  v_cvt_pk_bf16_f32 v108, v128, v129
  v_cvt_pk_bf16_f32 v109, v130, v131
  v_pk_fma_f32 v[104:105], v[36:37], v[88:89], v[64:65] op_sel:[0,0,0] op_sel_hi:[1,0,1] neg_lo:[0,1,0] neg_hi:[0,1,0]
  v_pk_fma_f32 v[106:107], v[38:39], v[88:89], v[66:67] op_sel:[0,0,0] op_sel_hi:[1,0,1] neg_lo:[0,1,0] neg_hi:[0,1,0]
  v_pk_fma_f32 v[144:145], v[144:145], v[88:89], v[104:105] op_sel:[0,1,0] op_sel_hi:[1,1,1]
  v_pk_fma_f32 v[146:147], v[146:147], v[88:89], v[106:107] op_sel:[0,1,0] op_sel_hi:[1,1,1]
  v_pk_mul_f32 v[104:105], v[144:145], v[144:145]
  v_pk_mul_f32 v[106:107], v[146:147], v[146:147]
  v_pk_fma_f32 v[104:105], v[104:105], v[96:97], v[96:97] op_sel:[0,1,0] op_sel_hi:[1,1,0]
  v_pk_fma_f32 v[106:107], v[106:107], v[96:97], v[96:97] op_sel:[0,1,0] op_sel_hi:[1,1,0]
  v_pk_mul_f32 v[104:105], v[104:105], v[144:145]
  v_pk_mul_f32 v[106:107], v[106:107], v[146:147]
  v_exp_f32 v104, v104
  v_exp_f32 v105, v105
  v_exp_f32 v106, v106
  v_exp_f32 v107, v107
  v_pk_add_f32 v[104:105], v[104:105], v[98:99] op_sel_hi:[1,0]
  v_pk_add_f32 v[106:107], v[106:107], v[98:99] op_sel_hi:[1,0]
  v_rcp_f32 v104, v104
  v_rcp_f32 v105, v105
  v_rcp_f32 v106, v106
  v_rcp_f32 v107, v107
  v_pk_mul_f32 v[144:145], v[144:145], v[104:105]
  v_pk_mul_f32 v[146:147], v[146:147], v[106:107]
  v_cvt_pk_bf16_f32 v110, v144, v145
  v_cvt_pk_bf16_f32 v111, v146, v147
  s_mov_b32 s3, 0
  s_nop 0
  v_permlane16_swap_b32 v108, v110
  v_permlane16_swap_b32 v109, v111
  buffer_store_dwordx4 v[108:111], v12, s[44:47], s3 offen sc1
  v_pk_fma_f32 v[100:101], v[40:41], v[88:89], v[68:69] op_sel:[0,0,0] op_sel_hi:[1,0,1] neg_lo:[0,1,0] neg_hi:[0,1,0]
  v_pk_fma_f32 v[102:103], v[42:43], v[88:89], v[70:71] op_sel:[0,0,0] op_sel_hi:[1,0,1] neg_lo:[0,1,0] neg_hi:[0,1,0]
  v_pk_fma_f32 v[160:161], v[160:161], v[88:89], v[100:101] op_sel:[0,1,0] op_sel_hi:[1,1,1]
  v_pk_fma_f32 v[162:163], v[162:163], v[88:89], v[102:103] op_sel:[0,1,0] op_sel_hi:[1,1,1]
  v_pk_mul_f32 v[100:101], v[160:161], v[160:161]
  v_pk_mul_f32 v[102:103], v[162:163], v[162:163]
  v_pk_fma_f32 v[100:101], v[100:101], v[96:97], v[96:97] op_sel:[0,1,0] op_sel_hi:[1,1,0]
  v_pk_fma_f32 v[102:103], v[102:103], v[96:97], v[96:97] op_sel:[0,1,0] op_sel_hi:[1,1,0]
  v_pk_mul_f32 v[100:101], v[100:101], v[160:161]
  v_pk_mul_f32 v[102:103], v[102:103], v[162:163]
  v_exp_f32 v100, v100
  v_exp_f32 v101, v101
  v_exp_f32 v102, v102
  v_exp_f32 v103, v103
  v_pk_add_f32 v[100:101], v[100:101], v[98:99] op_sel_hi:[1,0]
  v_pk_add_f32 v[102:103], v[102:103], v[98:99] op_sel_hi:[1,0]
  v_rcp_f32 v100, v100
  v_rcp_f32 v101, v101
  v_rcp_f32 v102, v102
  v_rcp_f32 v103, v103
  v_pk_mul_f32 v[160:161], v[160:161], v[100:101]
  v_pk_mul_f32 v[162:163], v[162:163], v[102:103]
  v_cvt_pk_bf16_f32 v112, v160, v161
  v_cvt_pk_bf16_f32 v113, v162, v163
  v_pk_fma_f32 v[104:105], v[44:45], v[88:89], v[72:73] op_sel:[0,0,0] op_sel_hi:[1,0,1] neg_lo:[0,1,0] neg_hi:[0,1,0]
  v_pk_fma_f32 v[106:107], v[46:47], v[88:89], v[74:75] op_sel:[0,0,0] op_sel_hi:[1,0,1] neg_lo:[0,1,0] neg_hi:[0,1,0]
  v_pk_fma_f32 v[176:177], v[176:177], v[88:89], v[104:105] op_sel:[0,1,0] op_sel_hi:[1,1,1]
  v_pk_fma_f32 v[178:179], v[178:179], v[88:89], v[106:107] op_sel:[0,1,0] op_sel_hi:[1,1,1]
  v_pk_mul_f32 v[104:105], v[176:177], v[176:177]
  v_pk_mul_f32 v[106:107], v[178:179], v[178:179]
  v_pk_fma_f32 v[104:105], v[104:105], v[96:97], v[96:97] op_sel:[0,1,0] op_sel_hi:[1,1,0]
  v_pk_fma_f32 v[106:107], v[106:107], v[96:97], v[96:97] op_sel:[0,1,0] op_sel_hi:[1,1,0]
  v_pk_mul_f32 v[104:105], v[104:105], v[176:177]
  v_pk_mul_f32 v[106:107], v[106:107], v[178:179]
  v_exp_f32 v104, v104
  v_exp_f32 v105, v105
  v_exp_f32 v106, v106
  v_exp_f32 v107, v107
  v_pk_add_f32 v[104:105], v[104:105], v[98:99] op_sel_hi:[1,0]
  v_pk_add_f32 v[106:107], v[106:107], v[98:99] op_sel_hi:[1,0]
  v_rcp_f32 v104, v104
  v_rcp_f32 v105, v105
  v_rcp_f32 v106, v106
  v_rcp_f32 v107, v107
  v_pk_mul_f32 v[176:177], v[176:177], v[104:105]
  v_pk_mul_f32 v[178:179], v[178:179], v[106:107]
  v_cvt_pk_bf16_f32 v114, v176, v177
  v_cvt_pk_bf16_f32 v115, v178, v179
  s_mov_b32 s3, 1024
  s_nop 0
  v_permlane16_swap_b32 v112, v114
  v_permlane16_swap_b32 v113, v115
  buffer_store_dwordx4 v[112:115], v12, s[44:47], s3 offen sc1
  v_pk_fma_f32 v[100:101], v[48:49], v[88:89], v[76:77] op_sel:[0,0,0] op_sel_hi:[1,0,1] neg_lo:[0,1,0] neg_hi:[0,1,0]
  v_pk_fma_f32 v[102:103], v[50:51], v[88:89], v[78:79] op_sel:[0,0,0] op_sel_hi:[1,0,1] neg_lo:[0,1,0] neg_hi:[0,1,0]
  v_pk_fma_f32 v[192:193], v[192:193], v[88:89], v[100:101] op_sel:[0,1,0] op_sel_hi:[1,1,1]
  v_pk_fma_f32 v[194:195], v[194:195], v[88:89], v[102:103] op_sel:[0,1,0] op_sel_hi:[1,1,1]
  v_pk_mul_f32 v[100:101], v[192:193], v[192:193]
  v_pk_mul_f32 v[102:103], v[194:195], v[194:195]
  v_pk_fma_f32 v[100:101], v[100:101], v[96:97], v[96:97] op_sel:[0,1,0] op_sel_hi:[1,1,0]
  v_pk_fma_f32 v[102:103], v[102:103], v[96:97], v[96:97] op_sel:[0,1,0] op_sel_hi:[1,1,0]
  v_pk_mul_f32 v[100:101], v[100:101], v[192:193]
  v_pk_mul_f32 v[102:103], v[102:103], v[194:195]
  v_exp_f32 v100, v100
  v_exp_f32 v101, v101
  v_exp_f32 v102, v102
  v_exp_f32 v103, v103
  v_pk_add_f32 v[100:101], v[100:101], v[98:99] op_sel_hi:[1,0]
  v_pk_add_f32 v[102:103], v[102:103], v[98:99] op_sel_hi:[1,0]
  v_rcp_f32 v100, v100
  v_rcp_f32 v101, v101
  v_rcp_f32 v102, v102
  v_rcp_f32 v103, v103
  v_pk_mul_f32 v[192:193], v[192:193], v[100:101]
  v_pk_mul_f32 v[194:195], v[194:195], v[102:103]
  v_cvt_pk_bf16_f32 v116, v192, v193
  v_cvt_pk_bf16_f32 v117, v194, v195
  v_pk_fma_f32 v[104:105], v[52:53], v[88:89], v[80:81] op_sel:[0,0,0] op_sel_hi:[1,0,1] neg_lo:[0,1,0] neg_hi:[0,1,0]
  v_pk_fma_f32 v[106:107], v[54:55], v[88:89], v[82:83] op_sel:[0,0,0] op_sel_hi:[1,0,1] neg_lo:[0,1,0] neg_hi:[0,1,0]
  v_pk_fma_f32 v[208:209], v[208:209], v[88:89], v[104:105] op_sel:[0,1,0] op_sel_hi:[1,1,1]
  v_pk_fma_f32 v[210:211], v[210:211], v[88:89], v[106:107] op_sel:[0,1,0] op_sel_hi:[1,1,1]
  v_pk_mul_f32 v[104:105], v[208:209], v[208:209]
  v_pk_mul_f32 v[106:107], v[210:211], v[210:211]
  v_pk_fma_f32 v[104:105], v[104:105], v[96:97], v[96:97] op_sel:[0,1,0] op_sel_hi:[1,1,0]
  v_pk_fma_f32 v[106:107], v[106:107], v[96:97], v[96:97] op_sel:[0,1,0] op_sel_hi:[1,1,0]
  v_pk_mul_f32 v[104:105], v[104:105], v[208:209]
  v_pk_mul_f32 v[106:107], v[106:107], v[210:211]
  v_exp_f32 v104, v104
  v_exp_f32 v105, v105
  v_exp_f32 v106, v106
  v_exp_f32 v107, v107
  v_pk_add_f32 v[104:105], v[104:105], v[98:99] op_sel_hi:[1,0]
  v_pk_add_f32 v[106:107], v[106:107], v[98:99] op_sel_hi:[1,0]
  v_rcp_f32 v104, v104
  v_rcp_f32 v105, v105
  v_rcp_f32 v106, v106
  v_rcp_f32 v107, v107
  v_pk_mul_f32 v[208:209], v[208:209], v[104:105]
  v_pk_mul_f32 v[210:211], v[210:211], v[106:107]
  v_cvt_pk_bf16_f32 v118, v208, v209
  v_cvt_pk_bf16_f32 v119, v210, v211
  s_mov_b32 s3, 2048
  s_nop 0
  v_permlane16_swap_b32 v116, v118
  v_permlane16_swap_b32 v117, v119
  buffer_store_dwordx4 v[116:119], v12, s[44:47], s3 offen sc1
  v_pk_fma_f32 v[100:101], v[32:33], v[90:91], v[60:61] op_sel:[0,0,0] op_sel_hi:[1,0,1] neg_lo:[0,1,0] neg_hi:[0,1,0]
  v_pk_fma_f32 v[102:103], v[34:35], v[90:91], v[62:63] op_sel:[0,0,0] op_sel_hi:[1,0,1] neg_lo:[0,1,0] neg_hi:[0,1,0]
  v_pk_fma_f32 v[132:133], v[132:133], v[90:91], v[100:101] op_sel:[0,1,0] op_sel_hi:[1,1,1]
  v_pk_fma_f32 v[134:135], v[134:135], v[90:91], v[102:103] op_sel:[0,1,0] op_sel_hi:[1,1,1]
  v_pk_mul_f32 v[100:101], v[132:133], v[132:133]
  v_pk_mul_f32 v[102:103], v[134:135], v[134:135]
  v_pk_fma_f32 v[100:101], v[100:101], v[96:97], v[96:97] op_sel:[0,1,0] op_sel_hi:[1,1,0]
  v_pk_fma_f32 v[102:103], v[102:103], v[96:97], v[96:97] op_sel:[0,1,0] op_sel_hi:[1,1,0]
  v_pk_mul_f32 v[100:101], v[100:101], v[132:133]
  v_pk_mul_f32 v[102:103], v[102:103], v[134:135]
  v_exp_f32 v100, v100
  v_exp_f32 v101, v101
  v_exp_f32 v102, v102
  v_exp_f32 v103, v103
  v_pk_add_f32 v[100:101], v[100:101], v[98:99] op_sel_hi:[1,0]
  v_pk_add_f32 v[102:103], v[102:103], v[98:99] op_sel_hi:[1,0]
  v_rcp_f32 v100, v100
  v_rcp_f32 v101, v101
  v_rcp_f32 v102, v102
  v_rcp_f32 v103, v103
  v_pk_mul_f32 v[132:133], v[132:133], v[100:101]
  v_pk_mul_f32 v[134:135], v[134:135], v[102:103]
  v_cvt_pk_bf16_f32 v120, v132, v133
  v_cvt_pk_bf16_f32 v121, v134, v135
  v_pk_fma_f32 v[104:105], v[36:37], v[90:91], v[64:65] op_sel:[0,0,0] op_sel_hi:[1,0,1] neg_lo:[0,1,0] neg_hi:[0,1,0]
  v_pk_fma_f32 v[106:107], v[38:39], v[90:91], v[66:67] op_sel:[0,0,0] op_sel_hi:[1,0,1] neg_lo:[0,1,0] neg_hi:[0,1,0]
  v_pk_fma_f32 v[148:149], v[148:149], v[90:91], v[104:105] op_sel:[0,1,0] op_sel_hi:[1,1,1]
  v_pk_fma_f32 v[150:151], v[150:151], v[90:91], v[106:107] op_sel:[0,1,0] op_sel_hi:[1,1,1]
  v_pk_mul_f32 v[104:105], v[148:149], v[148:149]
  v_pk_mul_f32 v[106:107], v[150:151], v[150:151]
  v_pk_fma_f32 v[104:105], v[104:105], v[96:97], v[96:97] op_sel:[0,1,0] op_sel_hi:[1,1,0]
  v_pk_fma_f32 v[106:107], v[106:107], v[96:97], v[96:97] op_sel:[0,1,0] op_sel_hi:[1,1,0]
  v_pk_mul_f32 v[104:105], v[104:105], v[148:149]
  v_pk_mul_f32 v[106:107], v[106:107], v[150:151]
  v_exp_f32 v104, v104
  v_exp_f32 v105, v105
  v_exp_f32 v106, v106
  v_exp_f32 v107, v107
  v_pk_add_f32 v[104:105], v[104:105], v[98:99] op_sel_hi:[1,0]
  v_pk_add_f32 v[106:107], v[106:107], v[98:99] op_sel_hi:[1,0]
  v_rcp_f32 v104, v104
  v_rcp_f32 v105, v105
  v_rcp_f32 v106, v106
  v_rcp_f32 v107, v107
  v_pk_mul_f32 v[148:149], v[148:149], v[104:105]
  v_pk_mul_f32 v[150:151], v[150:151], v[106:107]
  v_cvt_pk_bf16_f32 v122, v148, v149
  v_cvt_pk_bf16_f32 v123, v150, v151
  s_mov_b32 s3, 114688
  s_nop 0
  v_permlane16_swap_b32 v120, v122
  v_permlane16_swap_b32 v121, v123
  buffer_store_dwordx4 v[120:123], v12, s[44:47], s3 offen sc1
  v_pk_fma_f32 v[100:101], v[40:41], v[90:91], v[68:69] op_sel:[0,0,0] op_sel_hi:[1,0,1] neg_lo:[0,1,0] neg_hi:[0,1,0]
  v_pk_fma_f32 v[102:103], v[42:43], v[90:91], v[70:71] op_sel:[0,0,0] op_sel_hi:[1,0,1] neg_lo:[0,1,0] neg_hi:[0,1,0]
  v_pk_fma_f32 v[164:165], v[164:165], v[90:91], v[100:101] op_sel:[0,1,0] op_sel_hi:[1,1,1]
  v_pk_fma_f32 v[166:167], v[166:167], v[90:91], v[102:103] op_sel:[0,1,0] op_sel_hi:[1,1,1]
  v_pk_mul_f32 v[100:101], v[164:165], v[164:165]
  v_pk_mul_f32 v[102:103], v[166:167], v[166:167]
  v_pk_fma_f32 v[100:101], v[100:101], v[96:97], v[96:97] op_sel:[0,1,0] op_sel_hi:[1,1,0]
  v_pk_fma_f32 v[102:103], v[102:103], v[96:97], v[96:97] op_sel:[0,1,0] op_sel_hi:[1,1,0]
  v_pk_mul_f32 v[100:101], v[100:101], v[164:165]
  v_pk_mul_f32 v[102:103], v[102:103], v[166:167]
  v_exp_f32 v100, v100
  v_exp_f32 v101, v101
  v_exp_f32 v102, v102
  v_exp_f32 v103, v103
  v_pk_add_f32 v[100:101], v[100:101], v[98:99] op_sel_hi:[1,0]
  v_pk_add_f32 v[102:103], v[102:103], v[98:99] op_sel_hi:[1,0]
  v_rcp_f32 v100, v100
  v_rcp_f32 v101, v101
  v_rcp_f32 v102, v102
  v_rcp_f32 v103, v103
  v_pk_mul_f32 v[164:165], v[164:165], v[100:101]
  v_pk_mul_f32 v[166:167], v[166:167], v[102:103]
  v_cvt_pk_bf16_f32 v108, v164, v165
  v_cvt_pk_bf16_f32 v109, v166, v167
  v_pk_fma_f32 v[104:105], v[44:45], v[90:91], v[72:73] op_sel:[0,0,0] op_sel_hi:[1,0,1] neg_lo:[0,1,0] neg_hi:[0,1,0]
  v_pk_fma_f32 v[106:107], v[46:47], v[90:91], v[74:75] op_sel:[0,0,0] op_sel_hi:[1,0,1] neg_lo:[0,1,0] neg_hi:[0,1,0]
  v_pk_fma_f32 v[180:181], v[180:181], v[90:91], v[104:105] op_sel:[0,1,0] op_sel_hi:[1,1,1]
  v_pk_fma_f32 v[182:183], v[182:183], v[90:91], v[106:107] op_sel:[0,1,0] op_sel_hi:[1,1,1]
  v_pk_mul_f32 v[104:105], v[180:181], v[180:181]
  v_pk_mul_f32 v[106:107], v[182:183], v[182:183]
  v_pk_fma_f32 v[104:105], v[104:105], v[96:97], v[96:97] op_sel:[0,1,0] op_sel_hi:[1,1,0]
  v_pk_fma_f32 v[106:107], v[106:107], v[96:97], v[96:97] op_sel:[0,1,0] op_sel_hi:[1,1,0]
  v_pk_mul_f32 v[104:105], v[104:105], v[180:181]
  v_pk_mul_f32 v[106:107], v[106:107], v[182:183]
  v_exp_f32 v104, v104
  v_exp_f32 v105, v105
  v_exp_f32 v106, v106
  v_exp_f32 v107, v107
  v_pk_add_f32 v[104:105], v[104:105], v[98:99] op_sel_hi:[1,0]
  v_pk_add_f32 v[106:107], v[106:107], v[98:99] op_sel_hi:[1,0]
  v_rcp_f32 v104, v104
  v_rcp_f32 v105, v105
  v_rcp_f32 v106, v106
  v_rcp_f32 v107, v107
  v_pk_mul_f32 v[180:181], v[180:181], v[104:105]
  v_pk_mul_f32 v[182:183], v[182:183], v[106:107]
  v_cvt_pk_bf16_f32 v110, v180, v181
  v_cvt_pk_bf16_f32 v111, v182, v183
  s_mov_b32 s3, 115712
  s_nop 0
  v_permlane16_swap_b32 v108, v110
  v_permlane16_swap_b32 v109, v111
  buffer_store_dwordx4 v[108:111], v12, s[44:47], s3 offen sc1
  v_pk_fma_f32 v[100:101], v[48:49], v[90:91], v[76:77] op_sel:[0,0,0] op_sel_hi:[1,0,1] neg_lo:[0,1,0] neg_hi:[0,1,0]
  v_pk_fma_f32 v[102:103], v[50:51], v[90:91], v[78:79] op_sel:[0,0,0] op_sel_hi:[1,0,1] neg_lo:[0,1,0] neg_hi:[0,1,0]
  v_pk_fma_f32 v[196:197], v[196:197], v[90:91], v[100:101] op_sel:[0,1,0] op_sel_hi:[1,1,1]
  v_pk_fma_f32 v[198:199], v[198:199], v[90:91], v[102:103] op_sel:[0,1,0] op_sel_hi:[1,1,1]
  v_pk_mul_f32 v[100:101], v[196:197], v[196:197]
  v_pk_mul_f32 v[102:103], v[198:199], v[198:199]
  v_pk_fma_f32 v[100:101], v[100:101], v[96:97], v[96:97] op_sel:[0,1,0] op_sel_hi:[1,1,0]
  v_pk_fma_f32 v[102:103], v[102:103], v[96:97], v[96:97] op_sel:[0,1,0] op_sel_hi:[1,1,0]
  v_pk_mul_f32 v[100:101], v[100:101], v[196:197]
  v_pk_mul_f32 v[102:103], v[102:103], v[198:199]
  v_exp_f32 v100, v100
  v_exp_f32 v101, v101
  v_exp_f32 v102, v102
  v_exp_f32 v103, v103
  v_pk_add_f32 v[100:101], v[100:101], v[98:99] op_sel_hi:[1,0]
  v_pk_add_f32 v[102:103], v[102:103], v[98:99] op_sel_hi:[1,0]
  v_rcp_f32 v100, v100
  v_rcp_f32 v101, v101
  v_rcp_f32 v102, v102
  v_rcp_f32 v103, v103
  v_pk_mul_f32 v[196:197], v[196:197], v[100:101]
  v_pk_mul_f32 v[198:199], v[198:199], v[102:103]
  v_cvt_pk_bf16_f32 v112, v196, v197
  v_cvt_pk_bf16_f32 v113, v198, v199
  v_pk_fma_f32 v[104:105], v[52:53], v[90:91], v[80:81] op_sel:[0,0,0] op_sel_hi:[1,0,1] neg_lo:[0,1,0] neg_hi:[0,1,0]
  v_pk_fma_f32 v[106:107], v[54:55], v[90:91], v[82:83] op_sel:[0,0,0] op_sel_hi:[1,0,1] neg_lo:[0,1,0] neg_hi:[0,1,0]
  v_pk_fma_f32 v[212:213], v[212:213], v[90:91], v[104:105] op_sel:[0,1,0] op_sel_hi:[1,1,1]
  v_pk_fma_f32 v[214:215], v[214:215], v[90:91], v[106:107] op_sel:[0,1,0] op_sel_hi:[1,1,1]
  v_pk_mul_f32 v[104:105], v[212:213], v[212:213]
  v_pk_mul_f32 v[106:107], v[214:215], v[214:215]
  v_pk_fma_f32 v[104:105], v[104:105], v[96:97], v[96:97] op_sel:[0,1,0] op_sel_hi:[1,1,0]
  v_pk_fma_f32 v[106:107], v[106:107], v[96:97], v[96:97] op_sel:[0,1,0] op_sel_hi:[1,1,0]
  v_pk_mul_f32 v[104:105], v[104:105], v[212:213]
  v_pk_mul_f32 v[106:107], v[106:107], v[214:215]
  v_exp_f32 v104, v104
  v_exp_f32 v105, v105
  v_exp_f32 v106, v106
  v_exp_f32 v107, v107
  v_pk_add_f32 v[104:105], v[104:105], v[98:99] op_sel_hi:[1,0]
  v_pk_add_f32 v[106:107], v[106:107], v[98:99] op_sel_hi:[1,0]
  v_rcp_f32 v104, v104
  v_rcp_f32 v105, v105
  v_rcp_f32 v106, v106
  v_rcp_f32 v107, v107
  v_pk_mul_f32 v[212:213], v[212:213], v[104:105]
  v_pk_mul_f32 v[214:215], v[214:215], v[106:107]
  v_cvt_pk_bf16_f32 v114, v212, v213
  v_cvt_pk_bf16_f32 v115, v214, v215
  s_mov_b32 s3, 116736
  s_nop 0
  v_permlane16_swap_b32 v112, v114
  v_permlane16_swap_b32 v113, v115
  buffer_store_dwordx4 v[112:115], v12, s[44:47], s3 offen sc1
  v_pk_fma_f32 v[100:101], v[56:57], v[88:89], v[84:85] op_sel:[0,0,0] op_sel_hi:[1,0,1] neg_lo:[0,1,0] neg_hi:[0,1,0]
  v_pk_fma_f32 v[102:103], v[58:59], v[88:89], v[86:87] op_sel:[0,0,0] op_sel_hi:[1,0,1] neg_lo:[0,1,0] neg_hi:[0,1,0]
  v_pk_fma_f32 v[224:225], v[224:225], v[88:89], v[100:101] op_sel:[0,1,0] op_sel_hi:[1,1,1]
  v_pk_fma_f32 v[226:227], v[226:227], v[88:89], v[102:103] op_sel:[0,1,0] op_sel_hi:[1,1,1]
  v_pk_mul_f32 v[100:101], v[224:225], v[224:225]
  v_pk_mul_f32 v[102:103], v[226:227], v[226:227]
  v_pk_fma_f32 v[100:101], v[100:101], v[96:97], v[96:97] op_sel:[0,1,0] op_sel_hi:[1,1,0]
  v_pk_fma_f32 v[102:103], v[102:103], v[96:97], v[96:97] op_sel:[0,1,0] op_sel_hi:[1,1,0]
  v_pk_mul_f32 v[100:101], v[100:101], v[224:225]
  v_pk_mul_f32 v[102:103], v[102:103], v[226:227]
  v_exp_f32 v100, v100
  v_exp_f32 v101, v101
  v_exp_f32 v102, v102
  v_exp_f32 v103, v103
  v_pk_add_f32 v[100:101], v[100:101], v[98:99] op_sel_hi:[1,0]
  v_pk_add_f32 v[102:103], v[102:103], v[98:99] op_sel_hi:[1,0]
  v_rcp_f32 v100, v100
  v_rcp_f32 v101, v101
  v_rcp_f32 v102, v102
  v_rcp_f32 v103, v103
  v_pk_mul_f32 v[224:225], v[224:225], v[100:101]
  v_pk_mul_f32 v[226:227], v[226:227], v[102:103]
  v_cvt_pk_bf16_f32 v116, v224, v225
  v_cvt_pk_bf16_f32 v117, v226, v227
  v_pk_fma_f32 v[100:101], v[56:57], v[90:91], v[84:85] op_sel:[0,0,0] op_sel_hi:[1,0,1] neg_lo:[0,1,0] neg_hi:[0,1,0]
  v_pk_fma_f32 v[102:103], v[58:59], v[90:91], v[86:87] op_sel:[0,0,0] op_sel_hi:[1,0,1] neg_lo:[0,1,0] neg_hi:[0,1,0]
  v_pk_fma_f32 v[228:229], v[228:229], v[90:91], v[100:101] op_sel:[0,1,0] op_sel_hi:[1,1,1]
  v_pk_fma_f32 v[230:231], v[230:231], v[90:91], v[102:103] op_sel:[0,1,0] op_sel_hi:[1,1,1]
  v_pk_mul_f32 v[100:101], v[228:229], v[228:229]
  v_pk_mul_f32 v[102:103], v[230:231], v[230:231]
  v_pk_fma_f32 v[100:101], v[100:101], v[96:97], v[96:97] op_sel:[0,1,0] op_sel_hi:[1,1,0]
  v_pk_fma_f32 v[102:103], v[102:103], v[96:97], v[96:97] op_sel:[0,1,0] op_sel_hi:[1,1,0]
  v_pk_mul_f32 v[100:101], v[100:101], v[228:229]
  v_pk_mul_f32 v[102:103], v[102:103], v[230:231]
  v_exp_f32 v100, v100
  v_exp_f32 v101, v101
  v_exp_f32 v102, v102
  v_exp_f32 v103, v103
  v_pk_add_f32 v[100:101], v[100:101], v[98:99] op_sel_hi:[1,0]
  v_pk_add_f32 v[102:103], v[102:103], v[98:99] op_sel_hi:[1,0]
  v_rcp_f32 v100, v100
  v_rcp_f32 v101, v101
  v_rcp_f32 v102, v102
  v_rcp_f32 v103, v103
  v_pk_mul_f32 v[228:229], v[228:229], v[100:101]
  v_pk_mul_f32 v[230:231], v[230:231], v[102:103]
  v_cvt_pk_bf16_f32 v118, v228, v229
  v_cvt_pk_bf16_f32 v119, v230, v231
  s_mov_b32 s3, 3072
  s_nop 0
  v_permlane16_swap_b32 v116, v118
  v_permlane16_swap_b32 v117, v119
  buffer_store_dwordx4 v[116:119], v13, s[44:47], s3 offen sc1
  v_pk_fma_f32 v[100:101], v[32:33], v[92:93], v[60:61] op_sel:[0,0,0] op_sel_hi:[1,0,1] neg_lo:[0,1,0] neg_hi:[0,1,0]
  v_pk_fma_f32 v[102:103], v[34:35], v[92:93], v[62:63] op_sel:[0,0,0] op_sel_hi:[1,0,1] neg_lo:[0,1,0] neg_hi:[0,1,0]
  v_pk_fma_f32 v[136:137], v[136:137], v[92:93], v[100:101] op_sel:[0,1,0] op_sel_hi:[1,1,1]
  v_pk_fma_f32 v[138:139], v[138:139], v[92:93], v[102:103] op_sel:[0,1,0] op_sel_hi:[1,1,1]
  v_pk_mul_f32 v[100:101], v[136:137], v[136:137]
  v_pk_mul_f32 v[102:103], v[138:139], v[138:139]
  v_pk_fma_f32 v[100:101], v[100:101], v[96:97], v[96:97] op_sel:[0,1,0] op_sel_hi:[1,1,0]
  v_pk_fma_f32 v[102:103], v[102:103], v[96:97], v[96:97] op_sel:[0,1,0] op_sel_hi:[1,1,0]
  v_pk_mul_f32 v[100:101], v[100:101], v[136:137]
  v_pk_mul_f32 v[102:103], v[102:103], v[138:139]
  v_exp_f32 v100, v100
  v_exp_f32 v101, v101
  v_exp_f32 v102, v102
  v_exp_f32 v103, v103
  v_pk_add_f32 v[100:101], v[100:101], v[98:99] op_sel_hi:[1,0]
  v_pk_add_f32 v[102:103], v[102:103], v[98:99] op_sel_hi:[1,0]
  v_rcp_f32 v100, v100
  v_rcp_f32 v101, v101
  v_rcp_f32 v102, v102
  v_rcp_f32 v103, v103
  v_pk_mul_f32 v[136:137], v[136:137], v[100:101]
  v_pk_mul_f32 v[138:139], v[138:139], v[102:103]
  v_cvt_pk_bf16_f32 v120, v136, v137
  v_cvt_pk_bf16_f32 v121, v138, v139
  v_pk_fma_f32 v[104:105], v[36:37], v[92:93], v[64:65] op_sel:[0,0,0] op_sel_hi:[1,0,1] neg_lo:[0,1,0] neg_hi:[0,1,0]
  v_pk_fma_f32 v[106:107], v[38:39], v[92:93], v[66:67] op_sel:[0,0,0] op_sel_hi:[1,0,1] neg_lo:[0,1,0] neg_hi:[0,1,0]
  v_pk_fma_f32 v[152:153], v[152:153], v[92:93], v[104:105] op_sel:[0,1,0] op_sel_hi:[1,1,1]
  v_pk_fma_f32 v[154:155], v[154:155], v[92:93], v[106:107] op_sel:[0,1,0] op_sel_hi:[1,1,1]
  v_pk_mul_f32 v[104:105], v[152:153], v[152:153]
  v_pk_mul_f32 v[106:107], v[154:155], v[154:155]
  v_pk_fma_f32 v[104:105], v[104:105], v[96:97], v[96:97] op_sel:[0,1,0] op_sel_hi:[1,1,0]
  v_pk_fma_f32 v[106:107], v[106:107], v[96:97], v[96:97] op_sel:[0,1,0] op_sel_hi:[1,1,0]
  v_pk_mul_f32 v[104:105], v[104:105], v[152:153]
  v_pk_mul_f32 v[106:107], v[106:107], v[154:155]
  v_exp_f32 v104, v104
  v_exp_f32 v105, v105
  v_exp_f32 v106, v106
  v_exp_f32 v107, v107
  v_pk_add_f32 v[104:105], v[104:105], v[98:99] op_sel_hi:[1,0]
  v_pk_add_f32 v[106:107], v[106:107], v[98:99] op_sel_hi:[1,0]
  v_rcp_f32 v104, v104
  v_rcp_f32 v105, v105
  v_rcp_f32 v106, v106
  v_rcp_f32 v107, v107
  v_pk_mul_f32 v[152:153], v[152:153], v[104:105]
  v_pk_mul_f32 v[154:155], v[154:155], v[106:107]
  v_cvt_pk_bf16_f32 v122, v152, v153
  v_cvt_pk_bf16_f32 v123, v154, v155
  s_mov_b32 s3, 229376
  s_nop 0
  v_permlane16_swap_b32 v120, v122
  v_permlane16_swap_b32 v121, v123
  buffer_store_dwordx4 v[120:123], v12, s[44:47], s3 offen sc1
  v_pk_fma_f32 v[100:101], v[40:41], v[92:93], v[68:69] op_sel:[0,0,0] op_sel_hi:[1,0,1] neg_lo:[0,1,0] neg_hi:[0,1,0]
  v_pk_fma_f32 v[102:103], v[42:43], v[92:93], v[70:71] op_sel:[0,0,0] op_sel_hi:[1,0,1] neg_lo:[0,1,0] neg_hi:[0,1,0]
  v_pk_fma_f32 v[168:169], v[168:169], v[92:93], v[100:101] op_sel:[0,1,0] op_sel_hi:[1,1,1]
  v_pk_fma_f32 v[170:171], v[170:171], v[92:93], v[102:103] op_sel:[0,1,0] op_sel_hi:[1,1,1]
  v_pk_mul_f32 v[100:101], v[168:169], v[168:169]
  v_pk_mul_f32 v[102:103], v[170:171], v[170:171]
  v_pk_fma_f32 v[100:101], v[100:101], v[96:97], v[96:97] op_sel:[0,1,0] op_sel_hi:[1,1,0]
  v_pk_fma_f32 v[102:103], v[102:103], v[96:97], v[96:97] op_sel:[0,1,0] op_sel_hi:[1,1,0]
  v_pk_mul_f32 v[100:101], v[100:101], v[168:169]
  v_pk_mul_f32 v[102:103], v[102:103], v[170:171]
  v_exp_f32 v100, v100
  v_exp_f32 v101, v101
  v_exp_f32 v102, v102
  v_exp_f32 v103, v103
  v_pk_add_f32 v[100:101], v[100:101], v[98:99] op_sel_hi:[1,0]
  v_pk_add_f32 v[102:103], v[102:103], v[98:99] op_sel_hi:[1,0]
  v_rcp_f32 v100, v100
  v_rcp_f32 v101, v101
  v_rcp_f32 v102, v102
  v_rcp_f32 v103, v103
  v_pk_mul_f32 v[168:169], v[168:169], v[100:101]
  v_pk_mul_f32 v[170:171], v[170:171], v[102:103]
  v_cvt_pk_bf16_f32 v108, v168, v169
  v_cvt_pk_bf16_f32 v109, v170, v171
  v_pk_fma_f32 v[104:105], v[44:45], v[92:93], v[72:73] op_sel:[0,0,0] op_sel_hi:[1,0,1] neg_lo:[0,1,0] neg_hi:[0,1,0]
  v_pk_fma_f32 v[106:107], v[46:47], v[92:93], v[74:75] op_sel:[0,0,0] op_sel_hi:[1,0,1] neg_lo:[0,1,0] neg_hi:[0,1,0]
  v_pk_fma_f32 v[184:185], v[184:185], v[92:93], v[104:105] op_sel:[0,1,0] op_sel_hi:[1,1,1]
  v_pk_fma_f32 v[186:187], v[186:187], v[92:93], v[106:107] op_sel:[0,1,0] op_sel_hi:[1,1,1]
  v_pk_mul_f32 v[104:105], v[184:185], v[184:185]
  v_pk_mul_f32 v[106:107], v[186:187], v[186:187]
  v_pk_fma_f32 v[104:105], v[104:105], v[96:97], v[96:97] op_sel:[0,1,0] op_sel_hi:[1,1,0]
  v_pk_fma_f32 v[106:107], v[106:107], v[96:97], v[96:97] op_sel:[0,1,0] op_sel_hi:[1,1,0]
  v_pk_mul_f32 v[104:105], v[104:105], v[184:185]
  v_pk_mul_f32 v[106:107], v[106:107], v[186:187]
  v_exp_f32 v104, v104
  v_exp_f32 v105, v105
  v_exp_f32 v106, v106
  v_exp_f32 v107, v107
  v_pk_add_f32 v[104:105], v[104:105], v[98:99] op_sel_hi:[1,0]
  v_pk_add_f32 v[106:107], v[106:107], v[98:99] op_sel_hi:[1,0]
  v_rcp_f32 v104, v104
  v_rcp_f32 v105, v105
  v_rcp_f32 v106, v106
  v_rcp_f32 v107, v107
  v_pk_mul_f32 v[184:185], v[184:185], v[104:105]
  v_pk_mul_f32 v[186:187], v[186:187], v[106:107]
  v_cvt_pk_bf16_f32 v110, v184, v185
  v_cvt_pk_bf16_f32 v111, v186, v187
  s_mov_b32 s3, 230400
  s_nop 0
  v_permlane16_swap_b32 v108, v110
  v_permlane16_swap_b32 v109, v111
  buffer_store_dwordx4 v[108:111], v12, s[44:47], s3 offen sc1
  v_pk_fma_f32 v[100:101], v[48:49], v[92:93], v[76:77] op_sel:[0,0,0] op_sel_hi:[1,0,1] neg_lo:[0,1,0] neg_hi:[0,1,0]
  v_pk_fma_f32 v[102:103], v[50:51], v[92:93], v[78:79] op_sel:[0,0,0] op_sel_hi:[1,0,1] neg_lo:[0,1,0] neg_hi:[0,1,0]
  v_pk_fma_f32 v[200:201], v[200:201], v[92:93], v[100:101] op_sel:[0,1,0] op_sel_hi:[1,1,1]
  v_pk_fma_f32 v[202:203], v[202:203], v[92:93], v[102:103] op_sel:[0,1,0] op_sel_hi:[1,1,1]
  v_pk_mul_f32 v[100:101], v[200:201], v[200:201]
  v_pk_mul_f32 v[102:103], v[202:203], v[202:203]
  v_pk_fma_f32 v[100:101], v[100:101], v[96:97], v[96:97] op_sel:[0,1,0] op_sel_hi:[1,1,0]
  v_pk_fma_f32 v[102:103], v[102:103], v[96:97], v[96:97] op_sel:[0,1,0] op_sel_hi:[1,1,0]
  v_pk_mul_f32 v[100:101], v[100:101], v[200:201]
  v_pk_mul_f32 v[102:103], v[102:103], v[202:203]
  v_exp_f32 v100, v100
  v_exp_f32 v101, v101
  v_exp_f32 v102, v102
  v_exp_f32 v103, v103
  v_pk_add_f32 v[100:101], v[100:101], v[98:99] op_sel_hi:[1,0]
  v_pk_add_f32 v[102:103], v[102:103], v[98:99] op_sel_hi:[1,0]
  v_rcp_f32 v100, v100
  v_rcp_f32 v101, v101
  v_rcp_f32 v102, v102
  v_rcp_f32 v103, v103
  v_pk_mul_f32 v[200:201], v[200:201], v[100:101]
  v_pk_mul_f32 v[202:203], v[202:203], v[102:103]
  v_cvt_pk_bf16_f32 v112, v200, v201
  v_cvt_pk_bf16_f32 v113, v202, v203
  v_pk_fma_f32 v[104:105], v[52:53], v[92:93], v[80:81] op_sel:[0,0,0] op_sel_hi:[1,0,1] neg_lo:[0,1,0] neg_hi:[0,1,0]
  v_pk_fma_f32 v[106:107], v[54:55], v[92:93], v[82:83] op_sel:[0,0,0] op_sel_hi:[1,0,1] neg_lo:[0,1,0] neg_hi:[0,1,0]
  v_pk_fma_f32 v[216:217], v[216:217], v[92:93], v[104:105] op_sel:[0,1,0] op_sel_hi:[1,1,1]
  v_pk_fma_f32 v[218:219], v[218:219], v[92:93], v[106:107] op_sel:[0,1,0] op_sel_hi:[1,1,1]
  v_pk_mul_f32 v[104:105], v[216:217], v[216:217]
  v_pk_mul_f32 v[106:107], v[218:219], v[218:219]
  v_pk_fma_f32 v[104:105], v[104:105], v[96:97], v[96:97] op_sel:[0,1,0] op_sel_hi:[1,1,0]
  v_pk_fma_f32 v[106:107], v[106:107], v[96:97], v[96:97] op_sel:[0,1,0] op_sel_hi:[1,1,0]
  v_pk_mul_f32 v[104:105], v[104:105], v[216:217]
  v_pk_mul_f32 v[106:107], v[106:107], v[218:219]
  v_exp_f32 v104, v104
  v_exp_f32 v105, v105
  v_exp_f32 v106, v106
  v_exp_f32 v107, v107
  v_pk_add_f32 v[104:105], v[104:105], v[98:99] op_sel_hi:[1,0]
  v_pk_add_f32 v[106:107], v[106:107], v[98:99] op_sel_hi:[1,0]
  v_rcp_f32 v104, v104
  v_rcp_f32 v105, v105
  v_rcp_f32 v106, v106
  v_rcp_f32 v107, v107
  v_pk_mul_f32 v[216:217], v[216:217], v[104:105]
  v_pk_mul_f32 v[218:219], v[218:219], v[106:107]
  v_cvt_pk_bf16_f32 v114, v216, v217
  v_cvt_pk_bf16_f32 v115, v218, v219
  s_mov_b32 s3, 231424
  s_nop 0
  v_permlane16_swap_b32 v112, v114
  v_permlane16_swap_b32 v113, v115
  buffer_store_dwordx4 v[112:115], v12, s[44:47], s3 offen sc1
  v_pk_fma_f32 v[100:101], v[32:33], v[94:95], v[60:61] op_sel:[0,0,0] op_sel_hi:[1,0,1] neg_lo:[0,1,0] neg_hi:[0,1,0]
  v_pk_fma_f32 v[102:103], v[34:35], v[94:95], v[62:63] op_sel:[0,0,0] op_sel_hi:[1,0,1] neg_lo:[0,1,0] neg_hi:[0,1,0]
  v_pk_fma_f32 v[140:141], v[140:141], v[94:95], v[100:101] op_sel:[0,1,0] op_sel_hi:[1,1,1]
  v_pk_fma_f32 v[142:143], v[142:143], v[94:95], v[102:103] op_sel:[0,1,0] op_sel_hi:[1,1,1]
  v_pk_mul_f32 v[100:101], v[140:141], v[140:141]
  v_pk_mul_f32 v[102:103], v[142:143], v[142:143]
  v_pk_fma_f32 v[100:101], v[100:101], v[96:97], v[96:97] op_sel:[0,1,0] op_sel_hi:[1,1,0]
  v_pk_fma_f32 v[102:103], v[102:103], v[96:97], v[96:97] op_sel:[0,1,0] op_sel_hi:[1,1,0]
  v_pk_mul_f32 v[100:101], v[100:101], v[140:141]
  v_pk_mul_f32 v[102:103], v[102:103], v[142:143]
  v_exp_f32 v100, v100
  v_exp_f32 v101, v101
  v_exp_f32 v102, v102
  v_exp_f32 v103, v103
  v_pk_add_f32 v[100:101], v[100:101], v[98:99] op_sel_hi:[1,0]
  v_pk_add_f32 v[102:103], v[102:103], v[98:99] op_sel_hi:[1,0]
  v_rcp_f32 v100, v100
  v_rcp_f32 v101, v101
  v_rcp_f32 v102, v102
  v_rcp_f32 v103, v103
  v_pk_mul_f32 v[140:141], v[140:141], v[100:101]
  v_pk_mul_f32 v[142:143], v[142:143], v[102:103]
  v_cvt_pk_bf16_f32 v116, v140, v141
  v_cvt_pk_bf16_f32 v117, v142, v143
  v_pk_fma_f32 v[104:105], v[36:37], v[94:95], v[64:65] op_sel:[0,0,0] op_sel_hi:[1,0,1] neg_lo:[0,1,0] neg_hi:[0,1,0]
  v_pk_fma_f32 v[106:107], v[38:39], v[94:95], v[66:67] op_sel:[0,0,0] op_sel_hi:[1,0,1] neg_lo:[0,1,0] neg_hi:[0,1,0]
  v_pk_fma_f32 v[156:157], v[156:157], v[94:95], v[104:105] op_sel:[0,1,0] op_sel_hi:[1,1,1]
  v_pk_fma_f32 v[158:159], v[158:159], v[94:95], v[106:107] op_sel:[0,1,0] op_sel_hi:[1,1,1]
  v_pk_mul_f32 v[104:105], v[156:157], v[156:157]
  v_pk_mul_f32 v[106:107], v[158:159], v[158:159]
  v_pk_fma_f32 v[104:105], v[104:105], v[96:97], v[96:97] op_sel:[0,1,0] op_sel_hi:[1,1,0]
  v_pk_fma_f32 v[106:107], v[106:107], v[96:97], v[96:97] op_sel:[0,1,0] op_sel_hi:[1,1,0]
  v_pk_mul_f32 v[104:105], v[104:105], v[156:157]
  v_pk_mul_f32 v[106:107], v[106:107], v[158:159]
  v_exp_f32 v104, v104
  v_exp_f32 v105, v105
  v_exp_f32 v106, v106
  v_exp_f32 v107, v107
  v_pk_add_f32 v[104:105], v[104:105], v[98:99] op_sel_hi:[1,0]
  v_pk_add_f32 v[106:107], v[106:107], v[98:99] op_sel_hi:[1,0]
  v_rcp_f32 v104, v104
  v_rcp_f32 v105, v105
  v_rcp_f32 v106, v106
  v_rcp_f32 v107, v107
  v_pk_mul_f32 v[156:157], v[156:157], v[104:105]
  v_pk_mul_f32 v[158:159], v[158:159], v[106:107]
  v_cvt_pk_bf16_f32 v118, v156, v157
  v_cvt_pk_bf16_f32 v119, v158, v159
  s_mov_b32 s3, 344064
  s_nop 0
  v_permlane16_swap_b32 v116, v118
  v_permlane16_swap_b32 v117, v119
  buffer_store_dwordx4 v[116:119], v12, s[44:47], s3 offen sc1
  v_pk_fma_f32 v[100:101], v[40:41], v[94:95], v[68:69] op_sel:[0,0,0] op_sel_hi:[1,0,1] neg_lo:[0,1,0] neg_hi:[0,1,0]
  v_pk_fma_f32 v[102:103], v[42:43], v[94:95], v[70:71] op_sel:[0,0,0] op_sel_hi:[1,0,1] neg_lo:[0,1,0] neg_hi:[0,1,0]
  v_pk_fma_f32 v[172:173], v[172:173], v[94:95], v[100:101] op_sel:[0,1,0] op_sel_hi:[1,1,1]
  v_pk_fma_f32 v[174:175], v[174:175], v[94:95], v[102:103] op_sel:[0,1,0] op_sel_hi:[1,1,1]
  v_pk_mul_f32 v[100:101], v[172:173], v[172:173]
  v_pk_mul_f32 v[102:103], v[174:175], v[174:175]
  v_pk_fma_f32 v[100:101], v[100:101], v[96:97], v[96:97] op_sel:[0,1,0] op_sel_hi:[1,1,0]
  v_pk_fma_f32 v[102:103], v[102:103], v[96:97], v[96:97] op_sel:[0,1,0] op_sel_hi:[1,1,0]
  v_pk_mul_f32 v[100:101], v[100:101], v[172:173]
  v_pk_mul_f32 v[102:103], v[102:103], v[174:175]
  v_exp_f32 v100, v100
  v_exp_f32 v101, v101
  v_exp_f32 v102, v102
  v_exp_f32 v103, v103
  v_pk_add_f32 v[100:101], v[100:101], v[98:99] op_sel_hi:[1,0]
  v_pk_add_f32 v[102:103], v[102:103], v[98:99] op_sel_hi:[1,0]
  v_rcp_f32 v100, v100
  v_rcp_f32 v101, v101
  v_rcp_f32 v102, v102
  v_rcp_f32 v103, v103
  v_pk_mul_f32 v[172:173], v[172:173], v[100:101]
  v_pk_mul_f32 v[174:175], v[174:175], v[102:103]
  v_cvt_pk_bf16_f32 v120, v172, v173
  v_cvt_pk_bf16_f32 v121, v174, v175
  v_pk_fma_f32 v[104:105], v[44:45], v[94:95], v[72:73] op_sel:[0,0,0] op_sel_hi:[1,0,1] neg_lo:[0,1,0] neg_hi:[0,1,0]
  v_pk_fma_f32 v[106:107], v[46:47], v[94:95], v[74:75] op_sel:[0,0,0] op_sel_hi:[1,0,1] neg_lo:[0,1,0] neg_hi:[0,1,0]
  v_pk_fma_f32 v[188:189], v[188:189], v[94:95], v[104:105] op_sel:[0,1,0] op_sel_hi:[1,1,1]
  v_pk_fma_f32 v[190:191], v[190:191], v[94:95], v[106:107] op_sel:[0,1,0] op_sel_hi:[1,1,1]
  v_pk_mul_f32 v[104:105], v[188:189], v[188:189]
  v_pk_mul_f32 v[106:107], v[190:191], v[190:191]
  v_pk_fma_f32 v[104:105], v[104:105], v[96:97], v[96:97] op_sel:[0,1,0] op_sel_hi:[1,1,0]
  v_pk_fma_f32 v[106:107], v[106:107], v[96:97], v[96:97] op_sel:[0,1,0] op_sel_hi:[1,1,0]
  v_pk_mul_f32 v[104:105], v[104:105], v[188:189]
  v_pk_mul_f32 v[106:107], v[106:107], v[190:191]
  v_exp_f32 v104, v104
  v_exp_f32 v105, v105
  v_exp_f32 v106, v106
  v_exp_f32 v107, v107
  v_pk_add_f32 v[104:105], v[104:105], v[98:99] op_sel_hi:[1,0]
  v_pk_add_f32 v[106:107], v[106:107], v[98:99] op_sel_hi:[1,0]
  v_rcp_f32 v104, v104
  v_rcp_f32 v105, v105
  v_rcp_f32 v106, v106
  v_rcp_f32 v107, v107
  v_pk_mul_f32 v[188:189], v[188:189], v[104:105]
  v_pk_mul_f32 v[190:191], v[190:191], v[106:107]
  v_cvt_pk_bf16_f32 v122, v188, v189
  v_cvt_pk_bf16_f32 v123, v190, v191
  s_mov_b32 s3, 345088
  s_nop 0
  v_permlane16_swap_b32 v120, v122
  v_permlane16_swap_b32 v121, v123
  buffer_store_dwordx4 v[120:123], v12, s[44:47], s3 offen sc1
  v_pk_fma_f32 v[100:101], v[48:49], v[94:95], v[76:77] op_sel:[0,0,0] op_sel_hi:[1,0,1] neg_lo:[0,1,0] neg_hi:[0,1,0]
  v_pk_fma_f32 v[102:103], v[50:51], v[94:95], v[78:79] op_sel:[0,0,0] op_sel_hi:[1,0,1] neg_lo:[0,1,0] neg_hi:[0,1,0]
  v_pk_fma_f32 v[204:205], v[204:205], v[94:95], v[100:101] op_sel:[0,1,0] op_sel_hi:[1,1,1]
  v_pk_fma_f32 v[206:207], v[206:207], v[94:95], v[102:103] op_sel:[0,1,0] op_sel_hi:[1,1,1]
  v_pk_mul_f32 v[100:101], v[204:205], v[204:205]
  v_pk_mul_f32 v[102:103], v[206:207], v[206:207]
  v_pk_fma_f32 v[100:101], v[100:101], v[96:97], v[96:97] op_sel:[0,1,0] op_sel_hi:[1,1,0]
  v_pk_fma_f32 v[102:103], v[102:103], v[96:97], v[96:97] op_sel:[0,1,0] op_sel_hi:[1,1,0]
  v_pk_mul_f32 v[100:101], v[100:101], v[204:205]
  v_pk_mul_f32 v[102:103], v[102:103], v[206:207]
  v_exp_f32 v100, v100
  v_exp_f32 v101, v101
  v_exp_f32 v102, v102
  v_exp_f32 v103, v103
  v_pk_add_f32 v[100:101], v[100:101], v[98:99] op_sel_hi:[1,0]
  v_pk_add_f32 v[102:103], v[102:103], v[98:99] op_sel_hi:[1,0]
  v_rcp_f32 v100, v100
  v_rcp_f32 v101, v101
  v_rcp_f32 v102, v102
  v_rcp_f32 v103, v103
  v_pk_mul_f32 v[204:205], v[204:205], v[100:101]
  v_pk_mul_f32 v[206:207], v[206:207], v[102:103]
  v_cvt_pk_bf16_f32 v108, v204, v205
  v_cvt_pk_bf16_f32 v109, v206, v207
  v_pk_fma_f32 v[104:105], v[52:53], v[94:95], v[80:81] op_sel:[0,0,0] op_sel_hi:[1,0,1] neg_lo:[0,1,0] neg_hi:[0,1,0]
  v_pk_fma_f32 v[106:107], v[54:55], v[94:95], v[82:83] op_sel:[0,0,0] op_sel_hi:[1,0,1] neg_lo:[0,1,0] neg_hi:[0,1,0]
  v_pk_fma_f32 v[220:221], v[220:221], v[94:95], v[104:105] op_sel:[0,1,0] op_sel_hi:[1,1,1]
  v_pk_fma_f32 v[222:223], v[222:223], v[94:95], v[106:107] op_sel:[0,1,0] op_sel_hi:[1,1,1]
  v_pk_mul_f32 v[104:105], v[220:221], v[220:221]
  v_pk_mul_f32 v[106:107], v[222:223], v[222:223]
  v_pk_fma_f32 v[104:105], v[104:105], v[96:97], v[96:97] op_sel:[0,1,0] op_sel_hi:[1,1,0]
  v_pk_fma_f32 v[106:107], v[106:107], v[96:97], v[96:97] op_sel:[0,1,0] op_sel_hi:[1,1,0]
  v_pk_mul_f32 v[104:105], v[104:105], v[220:221]
  v_pk_mul_f32 v[106:107], v[106:107], v[222:223]
  v_exp_f32 v104, v104
  v_exp_f32 v105, v105
  v_exp_f32 v106, v106
  v_exp_f32 v107, v107
  v_pk_add_f32 v[104:105], v[104:105], v[98:99] op_sel_hi:[1,0]
  v_pk_add_f32 v[106:107], v[106:107], v[98:99] op_sel_hi:[1,0]
  v_rcp_f32 v104, v104
  v_rcp_f32 v105, v105
  v_rcp_f32 v106, v106
  v_rcp_f32 v107, v107
  v_pk_mul_f32 v[220:221], v[220:221], v[104:105]
  v_pk_mul_f32 v[222:223], v[222:223], v[106:107]
  v_cvt_pk_bf16_f32 v110, v220, v221
  v_cvt_pk_bf16_f32 v111, v222, v223
  s_mov_b32 s3, 346112
  s_nop 0
  v_permlane16_swap_b32 v108, v110
  v_permlane16_swap_b32 v109, v111
  buffer_store_dwordx4 v[108:111], v12, s[44:47], s3 offen sc1
  v_pk_fma_f32 v[100:101], v[56:57], v[92:93], v[84:85] op_sel:[0,0,0] op_sel_hi:[1,0,1] neg_lo:[0,1,0] neg_hi:[0,1,0]
  v_pk_fma_f32 v[102:103], v[58:59], v[92:93], v[86:87] op_sel:[0,0,0] op_sel_hi:[1,0,1] neg_lo:[0,1,0] neg_hi:[0,1,0]
  v_pk_fma_f32 v[232:233], v[232:233], v[92:93], v[100:101] op_sel:[0,1,0] op_sel_hi:[1,1,1]
  v_pk_fma_f32 v[234:235], v[234:235], v[92:93], v[102:103] op_sel:[0,1,0] op_sel_hi:[1,1,1]
  v_pk_mul_f32 v[100:101], v[232:233], v[232:233]
  v_pk_mul_f32 v[102:103], v[234:235], v[234:235]
  v_pk_fma_f32 v[100:101], v[100:101], v[96:97], v[96:97] op_sel:[0,1,0] op_sel_hi:[1,1,0]
  v_pk_fma_f32 v[102:103], v[102:103], v[96:97], v[96:97] op_sel:[0,1,0] op_sel_hi:[1,1,0]
  v_pk_mul_f32 v[100:101], v[100:101], v[232:233]
  v_pk_mul_f32 v[102:103], v[102:103], v[234:235]
  v_exp_f32 v100, v100
  v_exp_f32 v101, v101
  v_exp_f32 v102, v102
  v_exp_f32 v103, v103
  v_pk_add_f32 v[100:101], v[100:101], v[98:99] op_sel_hi:[1,0]
  v_pk_add_f32 v[102:103], v[102:103], v[98:99] op_sel_hi:[1,0]
  v_rcp_f32 v100, v100
  v_rcp_f32 v101, v101
  v_rcp_f32 v102, v102
  v_rcp_f32 v103, v103
  v_pk_mul_f32 v[232:233], v[232:233], v[100:101]
  v_pk_mul_f32 v[234:235], v[234:235], v[102:103]
  v_cvt_pk_bf16_f32 v112, v232, v233
  v_cvt_pk_bf16_f32 v113, v234, v235
  v_pk_fma_f32 v[100:101], v[56:57], v[94:95], v[84:85] op_sel:[0,0,0] op_sel_hi:[1,0,1] neg_lo:[0,1,0] neg_hi:[0,1,0]
  v_pk_fma_f32 v[102:103], v[58:59], v[94:95], v[86:87] op_sel:[0,0,0] op_sel_hi:[1,0,1] neg_lo:[0,1,0] neg_hi:[0,1,0]
  v_pk_fma_f32 v[236:237], v[236:237], v[94:95], v[100:101] op_sel:[0,1,0] op_sel_hi:[1,1,1]
  v_pk_fma_f32 v[238:239], v[238:239], v[94:95], v[102:103] op_sel:[0,1,0] op_sel_hi:[1,1,1]
  v_pk_mul_f32 v[100:101], v[236:237], v[236:237]
  v_pk_mul_f32 v[102:103], v[238:239], v[238:239]
  v_pk_fma_f32 v[100:101], v[100:101], v[96:97], v[96:97] op_sel:[0,1,0] op_sel_hi:[1,1,0]
  v_pk_fma_f32 v[102:103], v[102:103], v[96:97], v[96:97] op_sel:[0,1,0] op_sel_hi:[1,1,0]
  v_pk_mul_f32 v[100:101], v[100:101], v[236:237]
  v_pk_mul_f32 v[102:103], v[102:103], v[238:239]
  v_exp_f32 v100, v100
  v_exp_f32 v101, v101
  v_exp_f32 v102, v102
  v_exp_f32 v103, v103
  v_pk_add_f32 v[100:101], v[100:101], v[98:99] op_sel_hi:[1,0]
  v_pk_add_f32 v[102:103], v[102:103], v[98:99] op_sel_hi:[1,0]
  v_rcp_f32 v100, v100
  v_rcp_f32 v101, v101
  v_rcp_f32 v102, v102
  v_rcp_f32 v103, v103
  v_pk_mul_f32 v[236:237], v[236:237], v[100:101]
  v_pk_mul_f32 v[238:239], v[238:239], v[102:103]
  v_cvt_pk_bf16_f32 v114, v236, v237
  v_cvt_pk_bf16_f32 v115, v238, v239
  s_mov_b32 s3, 232448
  s_nop 0
  v_permlane16_swap_b32 v112, v114
  v_permlane16_swap_b32 v113, v115
  buffer_store_dwordx4 v[112:115], v13, s[44:47], s3 offen sc1
  s_endpgm
L_w1_loader:
  s_add_u32 s8, s70, s69
  s_and_b32 s8, s8, 3
  s_add_u32 s9, s70, s68
  s_and_b32 s9, s9, 3
  s_lshl_b32 s76, s8, 12
  s_lshl_b32 s77, s9, 11
  s_add_u32 s77, s77, 16384
  s_lshl_b32 s11, s68, 7
  v_and_b32 v10, 7, v1
  s_lshr_b32 s10, s76, 11
  s_lshl_b32 s3, s68, 3
  s_add_u32 s10, s10, s3
  s_mul_i32 s10, s10, 32768
  v_lshl_add_u32 v4, v1, 4, s10
  v_add_u32 v5, 32768, v4
  v_lshrrev_b32 v3, 3, v1
  s_lshl_b32 s10, s9, 4
  v_add_u32 v3, s10, v3
  v_mul_u32_u24 v3, 7168, v3
  v_lshrrev_b32 v2, 3, v1
  v_and_b32 v2, 2, v2
  v_xor_b32 v2, v2, v10
  s_mul_i32 s10, s69, 448
  s_andn2_b32 s10, s10, 127
  v_add_u32 v3, s10, v3
  v_lshl_add_u32 v8, v2, 4, v3
  v_xor_b32 v2, 4, v2
  v_add_u32 v3, 57344, v3
  v_lshl_add_u32 v9, v2, 4, v3
  s_mov_b32 s75, 0
  s_add_u32 s100, s68, s69
  s_mov_b32 s101, -1
  s_add_u32 s101, s101, 1
  s_sub_u32 s73, s101, s100
  s_lshl_b32 s73, s73, 3
  s_lshr_b32 s73, 0xf0f02, s73
  s_and_b32 s73, s73, 255
  s_add_u32 s73, s73, s101
  s_and_b32 s73, s73, 15
  s_mul_i32 s74, s73, 458752
  s_lshl_b32 s73, s73, 11
  s_waitcnt lgkmcnt(0)
  s_add_u32 s36, s34, 4194304
  s_addc_u32 s37, s35, 0
  s_and_b32 s37, s37, 0xffff
  s_mov_b32 s38, 4194304
  s_mov_b32 s39, 0x00020000
  s_mov_b32 s40, s24
  s_and_b32 s41, s25, 0xffff
  s_mov_b32 s42, 7340032
  s_mov_b32 s43, 0x00020000
  s_add_u32 s56, s34, 24117248
  s_addc_u32 s57, s35, 0
  s_and_b32 s57, s57, 0xffff
  s_mov_b32 s58, 262144
  s_mov_b32 s59, 0x00020000
  s_add_u32 s64, s34, 24641536
  s_addc_u32 s65, s35, 0
  s_and_b32 s65, s65, 0xffff
  s_mov_b32 s66, 262144
  s_mov_b32 s67, 0x00020000
  s_mov_b32 s52, s26
  s_and_b32 s53, s27, 0xffff
  s_mov_b32 s54, 7168
  s_mov_b32 s55, 0x00020000
  s_add_u32 s3, s75, s76
  s_add_u32 m0, s3, 0
  s_nop 0
  buffer_load_dwordx4 v4, s[36:39], s73 offen offset:0 lds
  buffer_load_dwordx4 v4, s[36:39], s73 offen offset:1024 lds
  s_add_u32 m0, s3, 2048
  s_nop 0
  buffer_load_dwordx4 v5, s[36:39], s73 offen offset:0 lds
  buffer_load_dwordx4 v5, s[36:39], s73 offen offset:1024 lds
  s_add_u32 s3, s75, s77
  s_add_u32 m0, s3, 0
  s_add_u32 s4, s74, 0
  buffer_load_dwordx4 v8, s[40:43], s4 offen lds
  s_add_u32 m0, s3, 1024
  s_nop 0
  buffer_load_dwordx4 v9, s[40:43], s4 offen lds
  s_add_u32 m0, s3, 8192
  s_add_u32 s4, s74, 128
  buffer_load_dwordx4 v8, s[40:43], s4 offen lds
  s_add_u32 m0, s3, 9216
  s_nop 0
  buffer_load_dwordx4 v9, s[40:43], s4 offen lds
  s_add_u32 m0, s3, 16384
  s_add_u32 s4, s74, 256
  buffer_load_dwordx4 v8, s[40:43], s4 offen lds
  s_add_u32 m0, s3, 17408
  s_nop 0
  buffer_load_dwordx4 v9, s[40:43], s4 offen lds
  s_add_u32 m0, s3, 24576
  s_add_u32 s4, s74, 384
  buffer_load_dwordx4 v8, s[40:43], s4 offen lds
  s_add_u32 m0, s3, 25600
  s_nop 0
  buffer_load_dwordx4 v9, s[40:43], s4 offen lds
  s_add_u32 s101, s101, 1
  s_sub_u32 s73, s101, s100
  s_lshl_b32 s73, s73, 3
  s_lshr_b32 s73, 0xf0f02, s73
  s_and_b32 s73, s73, 255
  s_add_u32 s73, s73, s101
  s_and_b32 s73, s73, 15
  s_mul_i32 s74, s73, 458752
  s_lshl_b32 s73, s73, 11
  s_add_u32 s75, s75, 49152
  s_cmp_eq_u32 s75, 147456
  s_cselect_b32 s75, 0, s75
  s_add_u32 s3, s75, s76
  s_add_u32 m0, s3, 0
  s_nop 0
  buffer_load_dwordx4 v4, s[36:39], s73 offen offset:0 lds
  buffer_load_dwordx4 v4, s[36:39], s73 offen offset:1024 lds
  s_add_u32 m0, s3, 2048
  s_nop 0
  buffer_load_dwordx4 v5, s[36:39], s73 offen offset:0 lds
  buffer_load_dwordx4 v5, s[36:39], s73 offen offset:1024 lds
  s_add_u32 s3, s75, s77
  s_add_u32 m0, s3, 0
  s_add_u32 s4, s74, 0
  buffer_load_dwordx4 v8, s[40:43], s4 offen lds
  s_add_u32 m0, s3, 1024
  s_nop 0
  buffer_load_dwordx4 v9, s[40:43], s4 offen lds
  s_add_u32 m0, s3, 8192
  s_add_u32 s4, s74, 128
  buffer_load_dwordx4 v8, s[40:43], s4 offen lds
  s_add_u32 m0, s3, 9216
  s_nop 0
  buffer_load_dwordx4 v9, s[40:43], s4 offen lds
  s_add_u32 m0, s3, 16384
  s_add_u32 s4, s74, 256
  buffer_load_dwordx4 v8, s[40:43], s4 offen lds
  s_add_u32 m0, s3, 17408
  s_nop 0
  buffer_load_dwordx4 v9, s[40:43], s4 offen lds
  s_add_u32 m0, s3, 24576
  s_add_u32 s4, s74, 384
  buffer_load_dwordx4 v8, s[40:43], s4 offen lds
  s_add_u32 m0, s3, 25600
  s_nop 0
  buffer_load_dwordx4 v9, s[40:43], s4 offen lds
  s_add_u32 s101, s101, 1
  s_sub_u32 s73, s101, s100
  s_lshl_b32 s73, s73, 3
  s_lshr_b32 s73, 0xf0f02, s73
  s_and_b32 s73, s73, 255
  s_add_u32 s73, s73, s101
  s_and_b32 s73, s73, 15
  s_mul_i32 s74, s73, 458752
  s_lshl_b32 s73, s73, 11
  s_add_u32 s75, s75, 49152
  s_cmp_eq_u32 s75, 147456
  s_cselect_b32 s75, 0, s75
  s_waitcnt vmcnt(12)
  s_barrier
  s_mov_b32 s79, 13
L_w1_ld:
  s_add_u32 s3, s75, s76
  s_add_u32 m0, s3, 0
  s_nop 0
  buffer_load_dwordx4 v4, s[36:39], s73 offen offset:0 lds
  buffer_load_dwordx4 v4, s[36:39], s73 offen offset:1024 lds
  s_add_u32 m0, s3, 2048
  s_nop 0
  buffer_load_dwordx4 v5, s[36:39], s73 offen offset:0 lds
  buffer_load_dwordx4 v5, s[36:39], s73 offen offset:1024 lds
  s_add_u32 s3, s75, s77
  s_add_u32 m0, s3, 0
  s_add_u32 s4, s74, 0
  buffer_load_dwordx4 v8, s[40:43], s4 offen lds
  s_add_u32 m0, s3, 1024
  s_nop 0
  buffer_load_dwordx4 v9, s[40:43], s4 offen lds
  s_add_u32 m0, s3, 8192
  s_add_u32 s4, s74, 128
  buffer_load_dwordx4 v8, s[40:43], s4 offen lds
  s_add_u32 m0, s3, 9216
  s_nop 0
  buffer_load_dwordx4 v9, s[40:43], s4 offen lds
  s_add_u32 m0, s3, 16384
  s_add_u32 s4, s74, 256
  buffer_load_dwordx4 v8, s[40:43], s4 offen lds
  s_add_u32 m0, s3, 17408
  s_nop 0
  buffer_load_dwordx4 v9, s[40:43], s4 offen lds
  s_add_u32 m0, s3, 24576
  s_add_u32 s4, s74, 384
  buffer_load_dwordx4 v8, s[40:43], s4 offen lds
  s_add_u32 m0, s3, 25600
  s_nop 0
  buffer_load_dwordx4 v9, s[40:43], s4 offen lds
  s_add_u32 s101, s101, 1
  s_sub_u32 s73, s101, s100
  s_lshl_b32 s73, s73, 3
  s_lshr_b32 s73, 0xf0f02, s73
  s_and_b32 s73, s73, 255
  s_add_u32 s73, s73, s101
  s_and_b32 s73, s73, 15
  s_mul_i32 s74, s73, 458752
  s_lshl_b32 s73, s73, 11
  s_add_u32 s75, s75, 49152
  s_cmp_eq_u32 s75, 147456
  s_cselect_b32 s75, 0, s75
  s_waitcnt vmcnt(12)
  s_barrier
  s_sub_u32 s79, s79, 1
  s_cmp_lg_u32 s79, 0
  s_cbranch_scc1 L_w1_ld
  s_add_u32 s3, s75, s76
  s_add_u32 m0, s3, 0
  s_nop 0
  buffer_load_dwordx4 v4, s[36:39], s73 offen offset:0 lds
  buffer_load_dwordx4 v4, s[36:39], s73 offen offset:1024 lds
  s_add_u32 m0, s3, 2048
  s_nop 0
  buffer_load_dwordx4 v5, s[36:39], s73 offen offset:0 lds
  buffer_load_dwordx4 v5, s[36:39], s73 offen offset:1024 lds
  s_add_u32 s3, s75, s77
  s_add_u32 m0, s3, 0
  s_add_u32 s4, s74, 0
  buffer_load_dwordx4 v8, s[40:43], s4 offen lds
  s_add_u32 m0, s3, 1024
  s_nop 0
  buffer_load_dwordx4 v9, s[40:43], s4 offen lds
  s_add_u32 m0, s3, 8192
  s_add_u32 s4, s74, 128
  buffer_load_dwordx4 v8, s[40:43], s4 offen lds
  s_add_u32 m0, s3, 9216
  s_nop 0
  buffer_load_dwordx4 v9, s[40:43], s4 offen lds
  s_add_u32 m0, s3, 16384
  s_add_u32 s4, s74, 256
  buffer_load_dwordx4 v8, s[40:43], s4 offen lds
  s_add_u32 m0, s3, 17408
  s_nop 0
  buffer_load_dwordx4 v9, s[40:43], s4 offen lds
  s_add_u32 m0, s3, 24576
  s_add_u32 s4, s74, 384
  buffer_load_dwordx4 v8, s[40:43], s4 offen lds
  s_add_u32 m0, s3, 25600
  s_nop 0
  buffer_load_dwordx4 v9, s[40:43], s4 offen lds
  s_add_u32 s101, s101, 1
  s_sub_u32 s73, s101, s100
  s_lshl_b32 s73, s73, 3
  s_lshr_b32 s73, 0xf0f02, s73
  s_and_b32 s73, s73, 255
  s_add_u32 s73, s73, s101
  s_and_b32 s73, s73, 15
  s_mul_i32 s74, s73, 458752
  s_lshl_b32 s73, s73, 11
  s_add_u32 s75, s75, 49152
  s_cmp_eq_u32 s75, 147456
  s_cselect_b32 s75, 0, s75
  s_and_b32 s3, s70, 3
  s_lshl_b32 s4, s68, 7
  s_lshl_b32 s5, s3, 6
  s_add_u32 s5, s5, s4
  v_add_u32 v2, s5, v1
  s_sub_u32 s4, s4, 16
  v_and_b32 v3, 15, v1
  v_add_u32 v3, s4, v3
  v_max_i32 v3, 0, v3
  s_cmp_ge_u32 s3, 2
  s_cselect_b64 vcc, -1, 0
  v_cndmask_b32 v2, v2, v3, vcc
  v_lshlrev_b32 v2, 3, v2
  s_mov_b32 s3, 0
  buffer_load_dwordx2 v[32:33], v2, s[56:59], s3 offen
  s_add_u32 s3, s3, 16384
  buffer_load_dwordx2 v[34:35], v2, s[56:59], s3 offen
  s_add_u32 s3, s3, 16384
  buffer_load_dwordx2 v[36:37], v2, s[56:59], s3 offen
  s_add_u32 s3, s3, 16384
  buffer_load_dwordx2 v[38:39], v2, s[56:59], s3 offen
  s_add_u32 s3, s3, 16384
  buffer_load_dwordx2 v[40:41], v2, s[56:59], s3 offen
  s_add_u32 s3, s3, 16384
  buffer_load_dwordx2 v[42:43], v2, s[56:59], s3 offen
  s_add_u32 s3, s3, 16384
  buffer_load_dwordx2 v[44:45], v2, s[56:59], s3 offen
  s_add_u32 s3, s3, 16384
  buffer_load_dwordx2 v[46:47], v2, s[56:59], s3 offen
  s_add_u32 s3, s3, 16384
  buffer_load_dwordx2 v[48:49], v2, s[56:59], s3 offen
  s_add_u32 s3, s3, 16384
  buffer_load_dwordx2 v[50:51], v2, s[56:59], s3 offen
  s_add_u32 s3, s3, 16384
  buffer_load_dwordx2 v[52:53], v2, s[56:59], s3 offen
  s_add_u32 s3, s3, 16384
  buffer_load_dwordx2 v[54:55], v2, s[56:59], s3 offen
  s_add_u32 s3, s3, 16384
  buffer_load_dwordx2 v[56:57], v2, s[56:59], s3 offen
  s_add_u32 s3, s3, 16384
  buffer_load_dwordx2 v[58:59], v2, s[56:59], s3 offen
  s_add_u32 s3, s3, 16384
  buffer_load_dwordx2 v[60:61], v2, s[56:59], s3 offen
  s_add_u32 s3, s3, 16384
  buffer_load_dwordx2 v[62:63], v2, s[56:59], s3 offen
  s_mul_i32 s4, s69, 224
  s_sub_u32 s4, s4, 256
  v_add_u32 v3, s4, v0
  v_lshlrev_b32 v2, 2, v3
  v_lshlrev_b32 v3, 1, v3
  s_mov_b32 s3, 0
  buffer_load_dword v64, v2, s[64:67], s3 offen
  s_add_u32 s3, s3, 16384
  buffer_load_dword v65, v2, s[64:67], s3 offen
  s_add_u32 s3, s3, 16384
  buffer_load_dword v66, v2, s[64:67], s3 offen
  s_add_u32 s3, s3, 16384
  buffer_load_dword v67, v2, s[64:67], s3 offen
  s_add_u32 s3, s3, 16384
  buffer_load_dword v68, v2, s[64:67], s3 offen
  s_add_u32 s3, s3, 16384
  buffer_load_dword v69, v2, s[64:67], s3 offen
  s_add_u32 s3, s3, 16384
  buffer_load_dword v70, v2, s[64:67], s3 offen
  s_add_u32 s3, s3, 16384
  buffer_load_dword v71, v2, s[64:67], s3 offen
  s_add_u32 s3, s3, 16384
  buffer_load_dword v72, v2, s[64:67], s3 offen
  s_add_u32 s3, s3, 16384
  buffer_load_dword v73, v2, s[64:67], s3 offen
  s_add_u32 s3, s3, 16384
  buffer_load_dword v74, v2, s[64:67], s3 offen
  s_add_u32 s3, s3, 16384
  buffer_load_dword v75, v2, s[64:67], s3 offen
  s_add_u32 s3, s3, 16384
  buffer_load_dword v76, v2, s[64:67], s3 offen
  s_add_u32 s3, s3, 16384
  buffer_load_dword v77, v2, s[64:67], s3 offen
  s_add_u32 s3, s3, 16384
  buffer_load_dword v78, v2, s[64:67], s3 offen
  s_add_u32 s3, s3, 16384
  buffer_load_dword v79, v2, s[64:67], s3 offen
  buffer_load_ushort v80, v3, s[52:55], 0 offen
  s_mov_b32 s60, s28
  s_and_b32 s61, s29, 0xffff
  s_mov_b32 s62, 7340032
  s_mov_b32 s63, 0x00020000
  s_and_b32 s3, s70, 3
  s_lshl_b32 s4, s2, 2
  s_add_u32 s3, s3, s4
  s_mul_i32 s3, s3, 7168
  v_min_u32 v2, 55, v1
  v_lshlrev_b32 v2, 7, v2
  s_sub_u32 s4, s96, 1
  v_and_b32 v2, s4, v2
  buffer_load_dword v96, v2, s[60:63], s3 offen
  s_waitcnt vmcnt(46)
  s_barrier
  s_waitcnt vmcnt(34)
  s_barrier
  s_waitcnt vmcnt(1)
  v_add_f32 v32, v32, v34
  v_add_f32 v33, v33, v35
  v_add_f32 v48, v48, v50
  v_add_f32 v49, v49, v51
  v_add_f32 v32, v32, v36
  v_add_f32 v33, v33, v37
  v_add_f32 v48, v48, v52
  v_add_f32 v49, v49, v53
  v_add_f32 v32, v32, v38
  v_add_f32 v33, v33, v39
  v_add_f32 v48, v48, v54
  v_add_f32 v49, v49, v55
  v_add_f32 v32, v32, v40
  v_add_f32 v33, v33, v41
  v_add_f32 v48, v48, v56
  v_add_f32 v49, v49, v57
  v_add_f32 v32, v32, v42
  v_add_f32 v33, v33, v43
  v_add_f32 v48, v48, v58
  v_add_f32 v49, v49, v59
  v_add_f32 v32, v32, v44
  v_add_f32 v33, v33, v45
  v_add_f32 v48, v48, v60
  v_add_f32 v49, v49, v61
  v_add_f32 v32, v32, v46
  v_add_f32 v33, v33, v47
  v_add_f32 v48, v48, v62
  v_add_f32 v49, v49, v63
  v_add_f32 v32, v32, v48
  v_add_f32 v33, v33, v49
  v_mul_f32 v32, 0x3a800000, v32
  v_mul_f32 v33, 0x3a800000, v33
  v_fma_f32 v33, -v32, v32, v33
  v_max_f32 v33, 0, v33
  v_add_f32 v33, 0x3727c5ac, v33
  v_rsq_f32 v33, v33
  s_nop 0
  s_and_b32 s3, s70, 3
  s_lshl_b32 s5, s3, 6
  s_add_u32 s5, s5, 16
  v_add_u32 v2, s5, v1
  v_and_b32 v3, 15, v1
  s_cmp_ge_u32 s3, 2
  s_cselect_b64 vcc, -1, 0
  v_cndmask_b32 v2, v2, v3, vcc
  v_lshlrev_b32 v2, 2, v2
  v_add_u32 v2, 147456, v2
  ds_write2_b32 v2, v32, v33 offset0:0 offset1:160
  v_add_f32 v64, v64, v72
  v_add_f32 v65, v65, v73
  v_add_f32 v66, v66, v74
  v_add_f32 v67, v67, v75
  v_add_f32 v68, v68, v76
  v_add_f32 v69, v69, v77
  v_add_f32 v70, v70, v78
  v_add_f32 v71, v71, v79
  v_add_f32 v64, v64, v68
  v_add_f32 v65, v65, v69
  v_add_f32 v66, v66, v70
  v_add_f32 v67, v67, v71
  v_add_f32 v64, v64, v65
  v_add_f32 v66, v66, v67
  v_add_f32 v64, v64, v66
  v_lshlrev_b32 v80, 16, v80
  v_lshlrev_b32 v2, 2, v0
  v_add_u32 v2, 147712, v2
  ds_write_b32 v2, v64
  ds_write_b32 v2, v80 offset:1024
  s_waitcnt lgkmcnt(0)
  s_barrier
  s_waitcnt vmcnt(0)
L_w1_end:
  s_endpgm
.section .rodata,"a"
.p2align 6
.amdhsa_kernel w1l0_kernel
  .amdhsa_next_free_vgpr 256
  .amdhsa_next_free_sgpr 102
  .amdhsa_accum_offset 256
  .amdhsa_group_segment_fixed_size 0
  .amdhsa_kernarg_size 88
  .amdhsa_user_sgpr_count 2
  .amdhsa_user_sgpr_kernarg_segment_ptr 1
  .amdhsa_system_sgpr_workgroup_id_x 1
  .amdhsa_float_denorm_mode_32 3
  .amdhsa_float_denorm_mode_16_64 3
.end_amdhsa_kernel
.text
.text
.globl w1l1_kernel
.p2align 8
.type w1l1_kernel,@function
w1l1_kernel:
  s_load_dwordx16 s[16:31], s[0:1], 0
  s_load_dwordx2 s[32:33], s[0:1], 64
  s_load_dwordx2 s[34:35], s[0:1], 80
  s_load_dwordx2 s[12:13], s[0:1], 64
  s_mov_b32 s96, 1
  s_branch L_w1_body
L_w1_c1:
.section .rodata,"a"
.p2align 6
.amdhsa_kernel w1l1_kernel
  .amdhsa_next_free_vgpr 256
  .amdhsa_next_free_sgpr 102
  .amdhsa_accum_offset 256
  .amdhsa_group_segment_fixed_size 0
  .amdhsa_kernarg_size 88
  .amdhsa_user_sgpr_count 2
  .amdhsa_user_sgpr_kernarg_segment_ptr 1
  .amdhsa_system_sgpr_workgroup_id_x 1
  .amdhsa_float_denorm_mode_32 3
  .amdhsa_float_denorm_mode_16_64 3
.end_amdhsa_kernel
.text
L_w2_c0:
.text
.globl w2l0_kernel
.p2align 8
.type w2l0_kernel,@function
w2l0_kernel:
  s_load_dwordx16 s[16:31], s[0:1], 0
  s_load_dwordx2 s[32:33], s[0:1], 64
  s_load_dwordx2 s[34:35], s[0:1], 80
  s_load_dwordx2 s[12:13], s[0:1], 0
  s_mov_b32 s96, 0
L_w2_body:
  s_cmp_ge_u32 s2, 256
  s_cbranch_scc1 L_w2_end
  v_lshrrev_b32 v2, 6, v0
  v_and_b32 v1, 63, v0
  v_readfirstlane_b32 s70, v2
  s_and_b32 s3, s2, 7
  s_lshr_b32 s99, s2, 3
  s_and_b32 s5, s3, 3
  s_lshl_b32 s5, s5, 2
  s_and_b32 s6, s99, 3
  s_add_u32 s68, s5, s6
  s_lshr_b32 s5, s3, 2
  s_lshl_b32 s5, s5, 3
  s_lshr_b32 s6, s99, 2
  s_add_u32 s69, s5, s6
  s_cmp_ge_u32 s70, 4
  s_cbranch_scc1 L_w2_loader
  v_and_b32 v3, 15, v1
  v_lshrrev_b32 v2, 4, v1
  s_lshl_b32 s8, s68, 7
  s_lshl_b32 s9, s70, 5
  s_add_u32 s8, s8, s9
  v_add_u32 v13, s8, v3
  s_lshl_b32 s10, s69, 7
  v_lshl_add_u32 v14, v2, 3, s10
  v_and_b32 v16, 1, v2
  v_lshrrev_b32 v17, 1, v2
  v_lshlrev_b32 v16, 5, v16
  v_lshl_add_u32 v16, v17, 4, v16
  v_add_u32 v16, s10, v16
  v_lshl_add_u32 v12, v13, 11, v16
  v_lshl_add_u32 v18, v17, 4, v13
  v_lshlrev_b32 v18, 3, v18
  v_and_b32 v16, 1, v2
  v_lshl_add_u32 v18, v16, 2, v18
  s_lshl_b32 s10, s69, 14
  v_add_u32 v18, s10, v18
  s_lshl_b32 s8, s70, 12
  v_lshl_add_u32 v5, v1, 4, s8
  v_bfe_u32 v6, v1, 2, 2
  v_lshl_add_u32 v6, v2, 3, v6
  v_lshlrev_b32 v6, 7, v6
  v_and_b32 v17, 3, v1
  v_lshl_add_u32 v6, v17, 3, v6
  v_bfe_u32 v17, v1, 3, 2
  v_lshl_add_u32 v6, v17, 5, v6
  v_add_u32 v6, 16384, v6
  v_xor_b32 v7, 32, v6
  v_xor_b32 v8, 64, v6
  v_xor_b32 v9, 96, v6
  v_lshrrev_b32 v15, 1, v2
  v_lshlrev_b32 v15, 8, v15
  v_lshl_add_u32 v15, v3, 4, v15
  v_lshl_add_u32 v15, v16, 3, v15
  s_add_u32 s8, s8, 147456
  v_add_u32 v15, s8, v15
  s_mov_b32 s11, 0xffff0000
  s_mov_b32 s75, 0
  s_waitcnt lgkmcnt(0)
  s_mov_b32 s52, s30
  s_and_b32 s53, s31, 0xffff
  s_mov_b32 s54, 2048
  s_mov_b32 s55, 0x00020000
  buffer_load_dwordx2 v[176:177], v14, s[52:55], 0 offen offset:0
  buffer_load_dwordx2 v[178:179], v14, s[52:55], 0 offen offset:32
  buffer_load_dwordx2 v[180:181], v14, s[52:55], 0 offen offset:64
  buffer_load_dwordx2 v[182:183], v14, s[52:55], 0 offen offset:96
  s_mov_b32 s44, s32
  s_and_b32 s45, s33, 0xffff
  s_mov_b32 s46, 4194304
  s_mov_b32 s47, 0x00020000
  s_add_u32 s56, s34, 24117248
  s_addc_u32 s57, s35, 0
  s_and_b32 s57, s57, 0xffff
  s_mov_b32 s58, 262144
  s_mov_b32 s59, 0x00020000
  s_waitcnt vmcnt(0)
  v_lshlrev_b32 v128, 16, v176
  v_and_b32 v129, s11, v176
  v_lshlrev_b32 v130, 16, v177
  v_and_b32 v131, s11, v177
  v_lshlrev_b32 v132, 16, v176
  v_and_b32 v133, s11, v176
  v_lshlrev_b32 v134, 16, v177
  v_and_b32 v135, s11, v177
  v_lshlrev_b32 v136, 16, v178
  v_and_b32 v137, s11, v178
  v_lshlrev_b32 v138, 16, v179
  v_and_b32 v139, s11, v179
  v_lshlrev_b32 v140, 16, v178
  v_and_b32 v141, s11, v178
  v_lshlrev_b32 v142, 16, v179
  v_and_b32 v143, s11, v179
  v_lshlrev_b32 v144, 16, v180
  v_and_b32 v145, s11, v180
  v_lshlrev_b32 v146, 16, v181
  v_and_b32 v147, s11, v181
  v_lshlrev_b32 v148, 16, v180
  v_and_b32 v149, s11, v180
  v_lshlrev_b32 v150, 16, v181
  v_and_b32 v151, s11, v181
  v_lshlrev_b32 v152, 16, v182
  v_and_b32 v153, s11, v182
  v_lshlrev_b32 v154, 16, v183
  v_and_b32 v155, s11, v183
  v_lshlrev_b32 v156, 16, v182
  v_and_b32 v157, s11, v182
  v_lshlrev_b32 v158, 16, v183
  v_and_b32 v159, s11, v183
  v_add_u32_e64 v25, s75, v5
  v_add_u32_e64 v26, s75, v6
  v_add_u32_e64 v27, s75, v7
  v_add_u32_e64 v28, s75, v8
  v_add_u32_e64 v29, s75, v9
  s_add_u32 s75, s75, 24576
  s_cmp_eq_u32 s75, 147456
  s_cselect_b32 s75, 0, s75
  s_barrier
  ds_read_b128 v[32:35], v25 offset:0
  ds_read_b128 v[36:39], v25 offset:2048
  ds_read_b64_tr_b16 v[48:49], v26 offset:0
  ds_read_b64_tr_b16 v[50:51], v26 offset:512
  ds_read_b64_tr_b16 v[52:53], v27 offset:0
  ds_read_b64_tr_b16 v[54:55], v27 offset:512
  ds_read_b64_tr_b16 v[56:57], v28 offset:0
  ds_read_b64_tr_b16 v[58:59], v28 offset:512
  ds_read_b64_tr_b16 v[60:61], v29 offset:0
  ds_read_b64_tr_b16 v[62:63], v29 offset:512
  ds_read_b128 v[40:43], v25 offset:1024
  ds_read_b128 v[44:47], v25 offset:3072
  ds_read_b64_tr_b16 v[64:65], v26 offset:4096
  ds_read_b64_tr_b16 v[66:67], v26 offset:4608
  ds_read_b64_tr_b16 v[68:69], v27 offset:4096
  ds_read_b64_tr_b16 v[70:71], v27 offset:4608
  ds_read_b64_tr_b16 v[72:73], v28 offset:4096
  ds_read_b64_tr_b16 v[74:75], v28 offset:4608
  ds_read_b64_tr_b16 v[76:77], v29 offset:4096
  ds_read_b64_tr_b16 v[78:79], v29 offset:4608
  s_mov_b32 s79, 28
  v_add_u32_e64 v25, s75, v5
  v_add_u32_e64 v26, s75, v6
  v_add_u32_e64 v27, s75, v7
  v_add_u32_e64 v28, s75, v8
  v_add_u32_e64 v29, s75, v9
  s_add_u32 s75, s75, 24576
  s_cmp_eq_u32 s75, 147456
  s_cselect_b32 s75, 0, s75
  s_waitcnt lgkmcnt(0)
.p2align 3
L_w2_loop:
  s_barrier
  s_sub_u32 s79, s79, 1
  v_mfma_f32_16x16x32_bf16 v[128:131], v[48:51], v[32:35], v[128:131]
  ds_read_b128 v[80:83], v25 offset:0
  ds_read_b128 v[84:87], v25 offset:2048
  v_mfma_f32_16x16x32_bf16 v[132:135], v[48:51], v[36:39], v[132:135]
  ds_read_b64_tr_b16 v[96:97], v26 offset:0
  ds_read_b64_tr_b16 v[98:99], v26 offset:512
  v_mfma_f32_16x16x32_bf16 v[136:139], v[52:55], v[32:35], v[136:139]
  ds_read_b64_tr_b16 v[100:101], v27 offset:0
  ds_read_b64_tr_b16 v[102:103], v27 offset:512
  v_mfma_f32_16x16x32_bf16 v[140:143], v[52:55], v[36:39], v[140:143]
  ds_read_b64_tr_b16 v[104:105], v28 offset:0
  ds_read_b64_tr_b16 v[106:107], v28 offset:512
  v_mfma_f32_16x16x32_bf16 v[144:147], v[56:59], v[32:35], v[144:147]
  ds_read_b64_tr_b16 v[108:109], v29 offset:0
  ds_read_b64_tr_b16 v[110:111], v29 offset:512
  v_mfma_f32_16x16x32_bf16 v[148:151], v[56:59], v[36:39], v[148:151]
  ds_read_b128 v[88:91], v25 offset:1024
  ds_read_b128 v[92:95], v25 offset:3072
  v_mfma_f32_16x16x32_bf16 v[152:155], v[60:63], v[32:35], v[152:155]
  ds_read_b64_tr_b16 v[112:113], v26 offset:4096
  ds_read_b64_tr_b16 v[114:115], v26 offset:4608
  v_mfma_f32_16x16x32_bf16 v[156:159], v[60:63], v[36:39], v[156:159]
  ds_read_b64_tr_b16 v[116:117], v27 offset:4096
  ds_read_b64_tr_b16 v[118:119], v27 offset:4608
  v_mfma_f32_16x16x32_bf16 v[128:131], v[64:67], v[40:43], v[128:131]
  ds_read_b64_tr_b16 v[120:121], v28 offset:4096
  ds_read_b64_tr_b16 v[122:123], v28 offset:4608
  v_mfma_f32_16x16x32_bf16 v[132:135], v[64:67], v[44:47], v[132:135]
  ds_read_b64_tr_b16 v[124:125], v29 offset:4096
  ds_read_b64_tr_b16 v[126:127], v29 offset:4608
  v_mfma_f32_16x16x32_bf16 v[136:139], v[68:71], v[40:43], v[136:139]
  v_add_u32_e64 v25, s75, v5
  v_add_u32_e64 v26, s75, v6
  v_mfma_f32_16x16x32_bf16 v[140:143], v[68:71], v[44:47], v[140:143]
  v_add_u32_e64 v27, s75, v7
  v_add_u32_e64 v28, s75, v8
  v_mfma_f32_16x16x32_bf16 v[144:147], v[72:75], v[40:43], v[144:147]
  v_add_u32_e64 v29, s75, v9
  s_add_u32 s75, s75, 24576
  v_mfma_f32_16x16x32_bf16 v[148:151], v[72:75], v[44:47], v[148:151]
  s_cmp_eq_u32 s75, 147456
  s_cselect_b32 s75, 0, s75
  s_nop 0
  v_mfma_f32_16x16x32_bf16 v[152:155], v[76:79], v[40:43], v[152:155]
  v_mfma_f32_16x16x32_bf16 v[156:159], v[76:79], v[44:47], v[156:159]
  s_waitcnt lgkmcnt(0)
  s_barrier
  v_mfma_f32_16x16x32_bf16 v[128:131], v[96:99], v[80:83], v[128:131]
  ds_read_b128 v[32:35], v25 offset:0
  ds_read_b128 v[36:39], v25 offset:2048
  v_mfma_f32_16x16x32_bf16 v[132:135], v[96:99], v[84:87], v[132:135]
  ds_read_b64_tr_b16 v[48:49], v26 offset:0
  ds_read_b64_tr_b16 v[50:51], v26 offset:512
  v_mfma_f32_16x16x32_bf16 v[136:139], v[100:103], v[80:83], v[136:139]
  ds_read_b64_tr_b16 v[52:53], v27 offset:0
  ds_read_b64_tr_b16 v[54:55], v27 offset:512
  v_mfma_f32_16x16x32_bf16 v[140:143], v[100:103], v[84:87], v[140:143]
  ds_read_b64_tr_b16 v[56:57], v28 offset:0
  ds_read_b64_tr_b16 v[58:59], v28 offset:512
  v_mfma_f32_16x16x32_bf16 v[144:147], v[104:107], v[80:83], v[144:147]
  ds_read_b64_tr_b16 v[60:61], v29 offset:0
  ds_read_b64_tr_b16 v[62:63], v29 offset:512
  v_mfma_f32_16x16x32_bf16 v[148:151], v[104:107], v[84:87], v[148:151]
  ds_read_b128 v[40:43], v25 offset:1024
  ds_read_b128 v[44:47], v25 offset:3072
  v_mfma_f32_16x16x32_bf16 v[152:155], v[108:111], v[80:83], v[152:155]
  ds_read_b64_tr_b16 v[64:65], v26 offset:4096
  ds_read_b64_tr_b16 v[66:67], v26 offset:4608
  v_mfma_f32_16x16x32_bf16 v[156:159], v[108:111], v[84:87], v[156:159]
  ds_read_b64_tr_b16 v[68:69], v27 offset:4096
  ds_read_b64_tr_b16 v[70:71], v27 offset:4608
  v_mfma_f32_16x16x32_bf16 v[128:131], v[112:115], v[88:91], v[128:131]
  ds_read_b64_tr_b16 v[72:73], v28 offset:4096
  ds_read_b64_tr_b16 v[74:75], v28 offset:4608
  v_mfma_f32_16x16x32_bf16 v[132:135], v[112:115], v[92:95], v[132:135]
  ds_read_b64_tr_b16 v[76:77], v29 offset:4096
  ds_read_b64_tr_b16 v[78:79], v29 offset:4608
  v_mfma_f32_16x16x32_bf16 v[136:139], v[116:119], v[88:91], v[136:139]
  v_add_u32_e64 v25, s75, v5
  v_add_u32_e64 v26, s75, v6
  v_mfma_f32_16x16x32_bf16 v[140:143], v[116:119], v[92:95], v[140:143]
  v_add_u32_e64 v27, s75, v7
  v_add_u32_e64 v28, s75, v8
  v_mfma_f32_16x16x32_bf16 v[144:147], v[120:123], v[88:91], v[144:147]
  v_add_u32_e64 v29, s75, v9
  s_add_u32 s75, s75, 24576
  v_mfma_f32_16x16x32_bf16 v[148:151], v[120:123], v[92:95], v[148:151]
  s_cmp_eq_u32 s75, 147456
  s_cselect_b32 s75, 0, s75
  s_cmp_lg_u32 s79, 0
  v_mfma_f32_16x16x32_bf16 v[152:155], v[124:127], v[88:91], v[152:155]
  v_mfma_f32_16x16x32_bf16 v[156:159], v[124:127], v[92:95], v[156:159]
  s_waitcnt lgkmcnt(0)
  s_cbranch_scc1 L_w2_loop
  ds_read_b64 v[160:161], v15 offset:0
  ds_read_b64 v[164:165], v15 offset:512
  ds_read_b64 v[168:169], v15 offset:1024
  ds_read_b64 v[172:173], v15 offset:1536
  ds_read_b64 v[162:163], v15 offset:2048
  ds_read_b64 v[166:167], v15 offset:2560
  ds_read_b64 v[170:171], v15 offset:3072
  ds_read_b64 v[174:175], v15 offset:3584
  v_mov_b32 v20, 0
  v_mov_b32 v21, 0
  v_mov_b32 v22, 0
  v_mov_b32 v23, 0
  s_mov_b32 s3, 32768
  s_mov_b32 s10, 0x3f803f80
  s_waitcnt lgkmcnt(7)
  v_lshlrev_b32 v184, 16, v160
  v_and_b32 v185, s11, v160
  v_lshlrev_b32 v186, 16, v161
  v_and_b32 v187, s11, v161
  v_pk_add_f32 v[128:129], v[128:129], v[184:185]
  v_pk_add_f32 v[130:131], v[130:131], v[186:187]
  v_cvt_pk_bf16_f32 v32, v128, v129
  v_cvt_pk_bf16_f32 v33, v130, v131
  s_waitcnt lgkmcnt(6)
  v_lshlrev_b32 v184, 16, v164
  v_and_b32 v185, s11, v164
  v_lshlrev_b32 v186, 16, v165
  v_and_b32 v187, s11, v165
  v_pk_add_f32 v[136:137], v[136:137], v[184:185]
  v_pk_add_f32 v[138:139], v[138:139], v[186:187]
  v_cvt_pk_bf16_f32 v34, v136, v137
  v_cvt_pk_bf16_f32 v35, v138, v139
  s_nop 1
  v_permlane16_swap_b32 v32, v34
  v_permlane16_swap_b32 v33, v35
  buffer_store_dwordx4 v[32:35], v12, s[44:47], 0 offen offset:0 sc1
  s_waitcnt lgkmcnt(5)
  v_lshlrev_b32 v184, 16, v168
  v_and_b32 v185, s11, v168
  v_lshlrev_b32 v186, 16, v169
  v_and_b32 v187, s11, v169
  v_pk_add_f32 v[144:145], v[144:145], v[184:185]
  v_pk_add_f32 v[146:147], v[146:147], v[186:187]
  v_cvt_pk_bf16_f32 v36, v144, v145
  v_cvt_pk_bf16_f32 v37, v146, v147
  s_waitcnt lgkmcnt(4)
  v_lshlrev_b32 v184, 16, v172
  v_and_b32 v185, s11, v172
  v_lshlrev_b32 v186, 16, v173
  v_and_b32 v187, s11, v173
  v_pk_add_f32 v[152:153], v[152:153], v[184:185]
  v_pk_add_f32 v[154:155], v[154:155], v[186:187]
  v_cvt_pk_bf16_f32 v38, v152, v153
  v_cvt_pk_bf16_f32 v39, v154, v155
  s_nop 1
  v_permlane16_swap_b32 v36, v38
  v_permlane16_swap_b32 v37, v39
  buffer_store_dwordx4 v[36:39], v12, s[44:47], 0 offen offset:64 sc1
  s_waitcnt lgkmcnt(3)
  v_lshlrev_b32 v184, 16, v162
  v_and_b32 v185, s11, v162
  v_lshlrev_b32 v186, 16, v163
  v_and_b32 v187, s11, v163
  v_pk_add_f32 v[132:133], v[132:133], v[184:185]
  v_pk_add_f32 v[134:135], v[134:135], v[186:187]
  v_cvt_pk_bf16_f32 v40, v132, v133
  v_cvt_pk_bf16_f32 v41, v134, v135
  s_waitcnt lgkmcnt(2)
  v_lshlrev_b32 v184, 16, v166
  v_and_b32 v185, s11, v166
  v_lshlrev_b32 v186, 16, v167
  v_and_b32 v187, s11, v167
  v_pk_add_f32 v[140:141], v[140:141], v[184:185]
  v_pk_add_f32 v[142:143], v[142:143], v[186:187]
  v_cvt_pk_bf16_f32 v42, v140, v141
  v_cvt_pk_bf16_f32 v43, v142, v143
  s_nop 1
  v_permlane16_swap_b32 v40, v42
  v_permlane16_swap_b32 v41, v43
  buffer_store_dwordx4 v[40:43], v12, s[44:47], s3 offen offset:0 sc1
  s_waitcnt lgkmcnt(1)
  v_lshlrev_b32 v184, 16, v170
  v_and_b32 v185, s11, v170
  v_lshlrev_b32 v186, 16, v171
  v_and_b32 v187, s11, v171
  v_pk_add_f32 v[148:149], v[148:149], v[184:185]
  v_pk_add_f32 v[150:151], v[150:151], v[186:187]
  v_cvt_pk_bf16_f32 v44, v148, v149
  v_cvt_pk_bf16_f32 v45, v150, v151
  s_waitcnt lgkmcnt(0)
  v_lshlrev_b32 v184, 16, v174
  v_and_b32 v185, s11, v174
  v_lshlrev_b32 v186, 16, v175
  v_and_b32 v187, s11, v175
  v_pk_add_f32 v[156:157], v[156:157], v[184:185]
  v_pk_add_f32 v[158:159], v[158:159], v[186:187]
  v_cvt_pk_bf16_f32 v46, v156, v157
  v_cvt_pk_bf16_f32 v47, v158, v159
  s_nop 1
  v_permlane16_swap_b32 v44, v46
  v_permlane16_swap_b32 v45, v47
  buffer_store_dwordx4 v[44:47], v12, s[44:47], s3 offen offset:64 sc1
  v_dot2_f32_bf16 v20, v32, s10, v20
  v_dot2_f32_bf16 v22, v32, v32, v22
  v_dot2_f32_bf16 v20, v33, s10, v20
  v_dot2_f32_bf16 v22, v33, v33, v22
  v_dot2_f32_bf16 v20, v34, s10, v20
  v_dot2_f32_bf16 v22, v34, v34, v22
  v_dot2_f32_bf16 v20, v35, s10, v20
  v_dot2_f32_bf16 v22, v35, v35, v22
  v_dot2_f32_bf16 v20, v36, s10, v20
  v_dot2_f32_bf16 v22, v36, v36, v22
  v_dot2_f32_bf16 v20, v37, s10, v20
  v_dot2_f32_bf16 v22, v37, v37, v22
  v_dot2_f32_bf16 v20, v38, s10, v20
  v_dot2_f32_bf16 v22, v38, v38, v22
  v_dot2_f32_bf16 v20, v39, s10, v20
  v_dot2_f32_bf16 v22, v39, v39, v22
  v_dot2_f32_bf16 v21, v40, s10, v21
  v_dot2_f32_bf16 v23, v40, v40, v23
  v_dot2_f32_bf16 v21, v41, s10, v21
  v_dot2_f32_bf16 v23, v41, v41, v23
  v_dot2_f32_bf16 v21, v42, s10, v21
  v_dot2_f32_bf16 v23, v42, v42, v23
  v_dot2_f32_bf16 v21, v43, s10, v21
  v_dot2_f32_bf16 v23, v43, v43, v23
  v_dot2_f32_bf16 v21, v44, s10, v21
  v_dot2_f32_bf16 v23, v44, v44, v23
  v_dot2_f32_bf16 v21, v45, s10, v21
  v_dot2_f32_bf16 v23, v45, v45, v23
  v_dot2_f32_bf16 v21, v46, s10, v21
  v_dot2_f32_bf16 v23, v46, v46, v23
  v_dot2_f32_bf16 v21, v47, s10, v21
  v_dot2_f32_bf16 v23, v47, v47, v23
  s_nop 2
  v_permlane32_swap_b32 v20, v21
  v_permlane32_swap_b32 v22, v23
  v_add_f32 v20, v20, v21
  v_add_f32 v22, v22, v23
  s_nop 1
  v_permlane16_swap_b32 v20, v22
  v_add_f32 v20, v20, v22
  buffer_store_dword v20, v18, s[56:59], 0 offen sc1
  s_endpgm
L_w2_loader:
  s_add_u32 s8, s70, s69
  s_and_b32 s8, s8, 3
  s_add_u32 s9, s70, s68
  s_and_b32 s9, s9, 3
  s_lshl_b32 s76, s8, 12
  s_lshl_b32 s77, s9, 11
  s_add_u32 s77, s77, 16384
  s_lshl_b32 s11, s68, 7
  v_and_b32 v10, 7, v1
  s_lshr_b32 s10, s76, 11
  s_lshl_b32 s3, s68, 3
  s_add_u32 s10, s10, s3
  s_mul_i32 s10, s10, 114688
  v_lshl_add_u32 v4, v1, 4, s10
  v_add_u32 v5, 114688, v4
  v_lshrrev_b32 v3, 3, v1
  s_lshl_b32 s10, s9, 4
  v_add_u32 v3, s10, v3
  v_mul_u32_u24 v3, 2048, v3
  v_lshrrev_b32 v2, 3, v1
  v_and_b32 v2, 2, v2
  v_xor_b32 v2, v2, v10
  s_mul_i32 s10, s69, 128
  v_add_u32 v3, s10, v3
  v_lshl_add_u32 v8, v2, 4, v3
  v_xor_b32 v2, 4, v2
  v_add_u32 v3, 16384, v3
  v_lshl_add_u32 v9, v2, 4, v3
  s_mov_b32 s75, 0
  s_add_u32 s100, s68, s69
  s_mov_b32 s101, -1
  s_add_u32 s101, s101, 1
  s_sub_u32 s73, s101, s100
  s_lshl_b32 s73, s73, 3
  s_lshr_b32 s73, 0x373702, s73
  s_and_b32 s73, s73, 255
  s_add_u32 s73, s73, s101
  s_sub_u32 s74, s73, 56
  s_cselect_b32 s73, s73, s74
  s_mul_i32 s74, s73, 131072
  s_lshl_b32 s73, s73, 11
  s_waitcnt lgkmcnt(0)
  s_add_u32 s36, s34, 8388608
  s_addc_u32 s37, s35, 0
  s_and_b32 s37, s37, 0xffff
  s_mov_b32 s38, 14680064
  s_mov_b32 s39, 0x00020000
  s_mov_b32 s40, s28
  s_and_b32 s41, s29, 0xffff
  s_mov_b32 s42, 7340032
  s_mov_b32 s43, 0x00020000
  s_add_u32 s3, s75, s76
  s_add_u32 m0, s3, 0
  s_nop 0
  buffer_load_dwordx4 v4, s[36:39], s73 offen offset:0 lds
  buffer_load_dwordx4 v4, s[36:39], s73 offen offset:1024 lds
  s_add_u32 m0, s3, 2048
  s_nop 0
  buffer_load_dwordx4 v5, s[36:39], s73 offen offset:0 lds
  buffer_load_dwordx4 v5, s[36:39], s73 offen offset:1024 lds
  s_add_u32 s3, s75, s77
  s_add_u32 m0, s3, 0
  s_add_u32 s4, s74, 0
  buffer_load_dwordx4 v8, s[40:43], s4 offen lds
  s_add_u32 m0, s3, 1024
  s_nop 0
  buffer_load_dwordx4 v9, s[40:43], s4 offen lds
  s_add_u32 s101, s101, 1
  s_sub_u32 s73, s101, s100
  s_lshl_b32 s73, s73, 3
  s_lshr_b32 s73, 0x373702, s73
  s_and_b32 s73, s73, 255
  s_add_u32 s73, s73, s101
  s_sub_u32 s74, s73, 56
  s_cselect_b32 s73, s73, s74
  s_mul_i32 s74, s73, 131072
  s_lshl_b32 s73, s73, 11
  s_add_u32 s75, s75, 24576
  s_cmp_eq_u32 s75, 147456
  s_cselect_b32 s75, 0, s75
  s_add_u32 s3, s75, s76
  s_add_u32 m0, s3, 0
  s_nop 0
  buffer_load_dwordx4 v4, s[36:39], s73 offen offset:0 lds
  buffer_load_dwordx4 v4, s[36:39], s73 offen offset:1024 lds
  s_add_u32 m0, s3, 2048
  s_nop 0
  buffer_load_dwordx4 v5, s[36:39], s73 offen offset:0 lds
  buffer_load_dwordx4 v5, s[36:39], s73 offen offset:1024 lds
  s_add_u32 s3, s75, s77
  s_add_u32 m0, s3, 0
  s_add_u32 s4, s74, 0
  buffer_load_dwordx4 v8, s[40:43], s4 offen lds
  s_add_u32 m0, s3, 1024
  s_nop 0
  buffer_load_dwordx4 v9, s[40:43], s4 offen lds
  s_add_u32 s101, s101, 1
  s_sub_u32 s73, s101, s100
  s_lshl_b32 s73, s73, 3
  s_lshr_b32 s73, 0x373702, s73
  s_and_b32 s73, s73, 255
  s_add_u32 s73, s73, s101
  s_sub_u32 s74, s73, 56
  s_cselect_b32 s73, s73, s74
  s_mul_i32 s74, s73, 131072
  s_lshl_b32 s73, s73, 11
  s_add_u32 s75, s75, 24576
  s_cmp_eq_u32 s75, 147456
  s_cselect_b32 s75, 0, s75
  s_waitcnt vmcnt(6)
  s_barrier
  s_add_u32 s3, s75, s76
  s_add_u32 m0, s3, 0
  s_nop 0
  buffer_load_dwordx4 v4, s[36:39], s73 offen offset:0 lds
  buffer_load_dwordx4 v4, s[36:39], s73 offen offset:1024 lds
  s_add_u32 m0, s3, 2048
  s_nop 0
  buffer_load_dwordx4 v5, s[36:39], s73 offen offset:0 lds
  buffer_load_dwordx4 v5, s[36:39], s73 offen offset:1024 lds
  s_add_u32 s3, s75, s77
  s_add_u32 m0, s3, 0
  s_add_u32 s4, s74, 0
  buffer_load_dwordx4 v8, s[40:43], s4 offen lds
  s_add_u32 m0, s3, 1024
  s_nop 0
  buffer_load_dwordx4 v9, s[40:43], s4 offen lds
  s_add_u32 s101, s101, 1
  s_sub_u32 s73, s101, s100
  s_lshl_b32 s73, s73, 3
  s_lshr_b32 s73, 0x373702, s73
  s_and_b32 s73, s73, 255
  s_add_u32 s73, s73, s101
  s_sub_u32 s74, s73, 56
  s_cselect_b32 s73, s73, s74
  s_mul_i32 s74, s73, 131072
  s_lshl_b32 s73, s73, 11
  s_add_u32 s75, s75, 24576
  s_cmp_eq_u32 s75, 147456
  s_cselect_b32 s75, 0, s75
  s_add_u32 s3, s75, s76
  s_add_u32 m0, s3, 0
  s_nop 0
  buffer_load_dwordx4 v4, s[36:39], s73 offen offset:0 lds
  buffer_load_dwordx4 v4, s[36:39], s73 offen offset:1024 lds
  s_add_u32 m0, s3, 2048
  s_nop 0
  buffer_load_dwordx4 v5, s[36:39], s73 offen offset:0 lds
  buffer_load_dwordx4 v5, s[36:39], s73 offen offset:1024 lds
  s_add_u32 s3, s75, s77
  s_add_u32 m0, s3, 0
  s_add_u32 s4, s74, 0
  buffer_load_dwordx4 v8, s[40:43], s4 offen lds
  s_add_u32 m0, s3, 1024
  s_nop 0
  buffer_load_dwordx4 v9, s[40:43], s4 offen lds
  s_add_u32 s101, s101, 1
  s_sub_u32 s73, s101, s100
  s_lshl_b32 s73, s73, 3
  s_lshr_b32 s73, 0x373702, s73
  s_and_b32 s73, s73, 255
  s_add_u32 s73, s73, s101
  s_sub_u32 s74, s73, 56
  s_cselect_b32 s73, s73, s74
  s_mul_i32 s74, s73, 131072
  s_lshl_b32 s73, s73, 11
  s_add_u32 s75, s75, 24576
  s_cmp_eq_u32 s75, 147456
  s_cselect_b32 s75, 0, s75
  s_add_u32 s3, s75, s76
  s_add_u32 m0, s3, 0
  s_nop 0
  buffer_load_dwordx4 v4, s[36:39], s73 offen offset:0 lds
  buffer_load_dwordx4 v4, s[36:39], s73 offen offset:1024 lds
  s_add_u32 m0, s3, 2048
  s_nop 0
  buffer_load_dwordx4 v5, s[36:39], s73 offen offset:0 lds
  buffer_load_dwordx4 v5, s[36:39], s73 offen offset:1024 lds
  s_add_u32 s3, s75, s77
  s_add_u32 m0, s3, 0
  s_add_u32 s4, s74, 0
  buffer_load_dwordx4 v8, s[40:43], s4 offen lds
  s_add_u32 m0, s3, 1024
  s_nop 0
  buffer_load_dwordx4 v9, s[40:43], s4 offen lds
  s_add_u32 s101, s101, 1
  s_sub_u32 s73, s101, s100
  s_lshl_b32 s73, s73, 3
  s_lshr_b32 s73, 0x373702, s73
  s_and_b32 s73, s73, 255
  s_add_u32 s73, s73, s101
  s_sub_u32 s74, s73, 56
  s_cselect_b32 s73, s73, s74
  s_mul_i32 s74, s73, 131072
  s_lshl_b32 s73, s73, 11
  s_add_u32 s75, s75, 24576
  s_cmp_eq_u32 s75, 147456
  s_cselect_b32 s75, 0, s75
  s_mov_b32 s79, 50
L_w2l_ld:
  s_add_u32 s3, s75, s76
  s_add_u32 m0, s3, 0
  s_nop 0
  buffer_load_dwordx4 v4, s[36:39], s73 offen offset:0 lds
  buffer_load_dwordx4 v4, s[36:39], s73 offen offset:1024 lds
  s_add_u32 m0, s3, 2048
  s_nop 0
  buffer_load_dwordx4 v5, s[36:39], s73 offen offset:0 lds
  buffer_load_dwordx4 v5, s[36:39], s73 offen offset:1024 lds
  s_add_u32 s3, s75, s77
  s_add_u32 m0, s3, 0
  s_add_u32 s4, s74, 0
  buffer_load_dwordx4 v8, s[40:43], s4 offen lds
  s_add_u32 m0, s3, 1024
  s_nop 0
  buffer_load_dwordx4 v9, s[40:43], s4 offen lds
  s_add_u32 s101, s101, 1
  s_sub_u32 s73, s101, s100
  s_lshl_b32 s73, s73, 3
  s_lshr_b32 s73, 0x373702, s73
  s_and_b32 s73, s73, 255
  s_add_u32 s73, s73, s101
  s_sub_u32 s74, s73, 56
  s_cselect_b32 s73, s73, s74
  s_mul_i32 s74, s73, 131072
  s_lshl_b32 s73, s73, 11
  s_add_u32 s75, s75, 24576
  s_cmp_eq_u32 s75, 147456
  s_cselect_b32 s75, 0, s75
  s_waitcnt vmcnt(24)
  s_barrier
  s_sub_u32 s79, s79, 1
  s_cmp_lg_u32 s79, 0
  s_cbranch_scc1 L_w2l_ld
  s_add_u32 s3, s75, s76
  s_add_u32 m0, s3, 0
  s_nop 0
  buffer_load_dwordx4 v4, s[36:39], s73 offen offset:0 lds
  buffer_load_dwordx4 v4, s[36:39], s73 offen offset:1024 lds
  s_add_u32 m0, s3, 2048
  s_nop 0
  buffer_load_dwordx4 v5, s[36:39], s73 offen offset:0 lds
  buffer_load_dwordx4 v5, s[36:39], s73 offen offset:1024 lds
  s_add_u32 s3, s75, s77
  s_add_u32 m0, s3, 0
  s_add_u32 s4, s74, 0
  buffer_load_dwordx4 v8, s[40:43], s4 offen lds
  s_add_u32 m0, s3, 1024
  s_nop 0
  buffer_load_dwordx4 v9, s[40:43], s4 offen lds
  s_add_u32 s101, s101, 1
  s_sub_u32 s73, s101, s100
  s_lshl_b32 s73, s73, 3
  s_lshr_b32 s73, 0x373702, s73
  s_and_b32 s73, s73, 255
  s_add_u32 s73, s73, s101
  s_sub_u32 s74, s73, 56
  s_cselect_b32 s73, s73, s74
  s_mul_i32 s74, s73, 131072
  s_lshl_b32 s73, s73, 11
  s_add_u32 s75, s75, 24576
  s_cmp_eq_u32 s75, 147456
  s_cselect_b32 s75, 0, s75
  s_add_u32 s48, s34, 4194304
  s_addc_u32 s49, s35, 0
  s_and_b32 s49, s49, 0xffff
  s_mov_b32 s50, 4194304
  s_mov_b32 s51, 0x00020000
  s_lshr_b32 s10, s76, 11
  s_lshl_b32 s3, s68, 3
  s_add_u32 s10, s10, s3
  s_mul_i32 s10, s10, 32768
  v_lshl_add_u32 v4, v1, 4, s10
  v_add_u32 v5, 32768, v4
  s_lshl_b32 s4, s69, 11
  s_add_u32 m0, s76, 147456
  s_nop 0
  buffer_load_dwordx4 v4, s[48:51], s4 offen offset:0 lds
  buffer_load_dwordx4 v4, s[48:51], s4 offen offset:1024 lds
  s_add_u32 m0, s76, 149504
  s_nop 0
  buffer_load_dwordx4 v5, s[48:51], s4 offen offset:0 lds
  buffer_load_dwordx4 v5, s[48:51], s4 offen offset:1024 lds
  s_waitcnt vmcnt(28)
  s_barrier
  s_waitcnt vmcnt(22)
  s_barrier
  s_waitcnt vmcnt(16)
  s_barrier
  s_waitcnt vmcnt(10)
  s_barrier
  s_waitcnt vmcnt(4)
  s_barrier
  s_waitcnt vmcnt(0)
  s_barrier
L_w2_side:
L_w2_end:
  s_endpgm
.section .rodata,"a"
.p2align 6
.amdhsa_kernel w2l0_kernel
  .amdhsa_next_free_vgpr 256
  .amdhsa_next_free_sgpr 102
  .amdhsa_accum_offset 256
  .amdhsa_group_segment_fixed_size 0
  .amdhsa_kernarg_size 88
  .amdhsa_user_sgpr_count 2
  .amdhsa_user_sgpr_kernarg_segment_ptr 1
  .amdhsa_system_sgpr_workgroup_id_x 1
  .amdhsa_float_denorm_mode_32 3
  .amdhsa_float_denorm_mode_16_64 3
.end_amdhsa_kernel
.text
.text
.globl w2l1_kernel
.p2align 8
.type w2l1_kernel,@function
w2l1_kernel:
  s_load_dwordx16 s[16:31], s[0:1], 0
  s_load_dwordx2 s[32:33], s[0:1], 64
  s_load_dwordx2 s[34:35], s[0:1], 80
  s_load_dwordx2 s[12:13], s[0:1], 64
  s_mov_b32 s96, 1
  s_branch L_w2_body
L_w2_c1:
.section .rodata,"a"
.p2align 6
.amdhsa_kernel w2l1_kernel
  .amdhsa_next_free_vgpr 256
  .amdhsa_next_free_sgpr 102
  .amdhsa_accum_offset 256
  .amdhsa_group_segment_fixed_size 0
  .amdhsa_kernarg_size 88
  .amdhsa_user_sgpr_count 2
  .amdhsa_user_sgpr_kernarg_segment_ptr 1
  .amdhsa_system_sgpr_workgroup_id_x 1
  .amdhsa_float_denorm_mode_32 3
  .amdhsa_float_denorm_mode_16_64 3
.end_amdhsa_kernel
.text
```

```asm
; @launch kernel=attnl0_kernel grid=(256,1,1) block=(512,1,1) lds=130304
; @launch kernel=wol0_kernel grid=(256,1,1) block=(512,1,1) lds=163840
; @launch kernel=w1l0_kernel grid=(256,1,1) block=(512,1,1) lds=150784
; @launch kernel=w2l0_kernel grid=(256,1,1) block=(512,1,1) lds=163840
; @launch kernel=attnl1_kernel grid=(256,1,1) block=(512,1,1) lds=130304
; @launch kernel=wol1_kernel grid=(256,1,1) block=(512,1,1) lds=163840
; @launch kernel=w1l1_kernel grid=(256,1,1) block=(512,1,1) lds=150784
; @launch kernel=w2l1_kernel grid=(256,1,1) block=(512,1,1) lds=163840
.amdgcn_target "amdgcn-amd-amdhsa--gfx950"
L_attn_c0:
.text
.globl attnl0_kernel
.p2align 8
.type attnl0_kernel,@function
attnl0_kernel:
  s_load_dwordx16 s[16:31], s[0:1], 0
  s_load_dwordx2 s[32:33], s[0:1], 64
  s_load_dwordx2 s[34:35], s[0:1], 80
  s_load_dwordx2 s[12:13], s[0:1], 0
  s_mov_b32 s96, 0
L_attn_body:
  s_cmp_ge_u32 s2, 256
  s_cbranch_scc1 L_attn_end
  v_lshrrev_b32 v2, 6, v0
  v_and_b32 v1, 63, v0
  v_readfirstlane_b32 s70, v2
  s_and_b32 s3, s2, 7
  s_lshr_b32 s99, s2, 3
  s_and_b32 s5, s3, 1
  s_lshl_b32 s5, s5, 3
  s_and_b32 s6, s99, 7
  s_add_u32 s68, s5, s6
  s_lshr_b32 s5, s3, 1
  s_lshl_b32 s5, s5, 2
  s_lshr_b32 s6, s99, 3
  s_add_u32 s69, s5, s6
  s_cmp_lt_u32 s70, 4
  s_cbranch_scc1 L_attn_compute
L_attn_loader:
  s_add_u32 s8, s70, s69
  s_and_b32 s8, s8, 3
  s_add_u32 s9, s70, s68
  s_and_b32 s9, s9, 3
  s_lshl_b32 s76, s8, 12
  s_lshl_b32 s77, s9, 11
  s_add_u32 s77, s77, 16384
  s_lshl_b32 s11, s68, 7
  v_and_b32 v10, 7, v1
  v_lshrrev_b32 v3, 3, v1
  s_lshr_b32 s10, s76, 7
  s_lshl_b32 s3, s68, 7
  s_add_u32 s10, s10, s3
  v_add_u32 v3, s10, v3
  v_mul_u32_u24 v3, 2048, v3
  v_lshrrev_b32 v2, 4, v1
  v_xor_b32 v4, v2, v10
  v_lshl_add_u32 v4, v4, 4, v3
  v_add_u32 v3, 16384, v3
  v_add_u32 v5, 4, v2
  v_xor_b32 v5, v5, v10
  v_lshl_add_u32 v5, v5, 4, v3
  v_add_u32 v3, 16384, v3
  v_xor_b32 v6, v2, v10
  v_lshl_add_u32 v6, v6, 4, v3
  v_add_u32 v3, 16384, v3
  v_add_u32 v7, 4, v2
  v_xor_b32 v7, v7, v10
  v_lshl_add_u32 v7, v7, 4, v3
  v_lshrrev_b32 v3, 3, v1
  s_lshl_b32 s10, s9, 4
  v_add_u32 v3, s10, v3
  v_mul_u32_u24 v3, 6144, v3
  v_lshrrev_b32 v2, 3, v1
  v_and_b32 v2, 2, v2
  v_xor_b32 v2, v2, v10
  s_mul_i32 s10, s69, 128
  v_add_u32 v3, s10, v3
  v_lshl_add_u32 v8, v2, 4, v3
  v_xor_b32 v2, 4, v2
  v_add_u32 v3, 49152, v3
  v_lshl_add_u32 v9, v2, 4, v3
  s_and_b32 s10, s70, 3
  s_lshl_b32 s78, s10, 9
  s_add_u32 s78, s78, 40960
  s_lshl_b32 s14, s10, 2
  s_add_u32 s14, s14, s11
  s_sub_u32 s14, s14, 16
  v_lshrrev_b32 v3, 3, v1
  v_add_u32 v3, s14, v3
  v_max_i32 v3, 0, v3
  v_mul_u32_u24 v3, 2048, v3
  s_lshl_b32 s14, s10, 1
  v_lshrrev_b32 v2, 4, v1
  v_add_u32 v2, s14, v2
  v_and_b32 v2, 7, v2
  v_xor_b32 v2, v2, v10
  v_lshl_add_u32 v28, v2, 4, v3
  s_cmp_eq_u32 s10, 0
  s_cselect_b32 s14, 0xffffff00, -1
  s_mov_b32 s15, 0
  s_mov_b32 s75, 0
  s_add_u32 s100, s68, s69
  s_mov_b32 s101, -1
  s_add_u32 s101, s101, 1
  s_sub_u32 s73, s101, s100
  s_lshl_b32 s73, s73, 3
  s_lshr_b32 s73, 0xf0f02, s73
  s_and_b32 s73, s73, 255
  s_add_u32 s73, s73, s101
  s_and_b32 s73, s73, 15
  s_mul_i32 s74, s73, 393216
  s_lshl_b32 s73, s73, 7
  s_waitcnt lgkmcnt(0)
  s_mov_b32 s36, s12
  s_and_b32 s37, s13, 0xffff
  s_mov_b32 s38, 4194304
  s_mov_b32 s39, 0x00020000
  s_mov_b32 s40, s18
  s_and_b32 s41, s19, 0xffff
  s_mov_b32 s42, 6291456
  s_mov_b32 s43, 0x00020000
  s_cmp_lg_u32 s96, 0
  s_cbranch_scc1 L_attn_ld1
  s_add_u32 s3, s75, s76
  s_add_u32 m0, s3, 0
  s_nop 0
  buffer_load_dwordx4 v4, s[36:39], s73 offen lds
  s_add_u32 m0, s3, 1024
  s_nop 0
  buffer_load_dwordx4 v5, s[36:39], s73 offen lds
  s_add_u32 m0, s3, 2048
  s_nop 0
  buffer_load_dwordx4 v6, s[36:39], s73 offen lds
  s_add_u32 m0, s3, 3072
  s_nop 0
  buffer_load_dwordx4 v7, s[36:39], s73 offen lds
  s_add_u32 m0, s75, s78
  s_mov_b64 exec, s[14:15]
  buffer_load_dwordx4 v28, s[36:39], s73 offen lds
  s_mov_b64 exec, -1
  s_add_u32 s3, s75, s77
  s_add_u32 m0, s3, 0
  s_add_u32 s4, s74, 0
  buffer_load_dwordx4 v8, s[40:43], s4 offen lds
  s_add_u32 m0, s3, 1024
  s_nop 0
  buffer_load_dwordx4 v9, s[40:43], s4 offen lds
  s_add_u32 m0, s3, 8192
  s_add_u32 s4, s74, 2048
  buffer_load_dwordx4 v8, s[40:43], s4 offen lds
  s_add_u32 m0, s3, 9216
  s_nop 0
  buffer_load_dwordx4 v9, s[40:43], s4 offen lds
  s_add_u32 m0, s3, 16384
  s_add_u32 s4, s74, 4096
  buffer_load_dwordx4 v8, s[40:43], s4 offen lds
  s_add_u32 m0, s3, 17408
  s_nop 0
  buffer_load_dwordx4 v9, s[40:43], s4 offen lds
  s_add_u32 s101, s101, 1
  s_sub_u32 s73, s101, s100
  s_lshl_b32 s73, s73, 3
  s_lshr_b32 s73, 0xf0f02, s73
  s_and_b32 s73, s73, 255
  s_add_u32 s73, s73, s101
  s_and_b32 s73, s73, 15
  s_mul_i32 s74, s73, 393216
  s_lshl_b32 s73, s73, 7
  s_add_u32 s75, s75, 43008
  s_cmp_eq_u32 s75, 129024
  s_cselect_b32 s75, 0, s75
  s_add_u32 s3, s75, s76
  s_add_u32 m0, s3, 0
  s_nop 0
  buffer_load_dwordx4 v4, s[36:39], s73 offen lds
  s_add_u32 m0, s3, 1024
  s_nop 0
  buffer_load_dwordx4 v5, s[36:39], s73 offen lds
  s_add_u32 m0, s3, 2048
  s_nop 0
  buffer_load_dwordx4 v6, s[36:39], s73 offen lds
  s_add_u32 m0, s3, 3072
  s_nop 0
  buffer_load_dwordx4 v7, s[36:39], s73 offen lds
  s_add_u32 m0, s75, s78
  s_mov_b64 exec, s[14:15]
  buffer_load_dwordx4 v28, s[36:39], s73 offen lds
  s_mov_b64 exec, -1
  s_add_u32 s3, s75, s77
  s_add_u32 m0, s3, 0
  s_add_u32 s4, s74, 0
  buffer_load_dwordx4 v8, s[40:43], s4 offen lds
  s_add_u32 m0, s3, 1024
  s_nop 0
  buffer_load_dwordx4 v9, s[40:43], s4 offen lds
  s_add_u32 m0, s3, 8192
  s_add_u32 s4, s74, 2048
  buffer_load_dwordx4 v8, s[40:43], s4 offen lds
  s_add_u32 m0, s3, 9216
  s_nop 0
  buffer_load_dwordx4 v9, s[40:43], s4 offen lds
  s_add_u32 m0, s3, 16384
  s_add_u32 s4, s74, 4096
  buffer_load_dwordx4 v8, s[40:43], s4 offen lds
  s_add_u32 m0, s3, 17408
  s_nop 0
  buffer_load_dwordx4 v9, s[40:43], s4 offen lds
  s_add_u32 s101, s101, 1
  s_sub_u32 s73, s101, s100
  s_lshl_b32 s73, s73, 3
  s_lshr_b32 s73, 0xf0f02, s73
  s_and_b32 s73, s73, 255
  s_add_u32 s73, s73, s101
  s_and_b32 s73, s73, 15
  s_mul_i32 s74, s73, 393216
  s_lshl_b32 s73, s73, 7
  s_add_u32 s75, s75, 43008
  s_cmp_eq_u32 s75, 129024
  s_cselect_b32 s75, 0, s75
  s_waitcnt vmcnt(11)
  s_barrier
  s_mov_b32 s79, 13
L_attn0_ld:
  s_add_u32 s3, s75, s76
  s_add_u32 m0, s3, 0
  s_nop 0
  buffer_load_dwordx4 v4, s[36:39], s73 offen lds
  s_add_u32 m0, s3, 1024
  s_nop 0
  buffer_load_dwordx4 v5, s[36:39], s73 offen lds
  s_add_u32 m0, s3, 2048
  s_nop 0
  buffer_load_dwordx4 v6, s[36:39], s73 offen lds
  s_add_u32 m0, s3, 3072
  s_nop 0
  buffer_load_dwordx4 v7, s[36:39], s73 offen lds
  s_add_u32 m0, s75, s78
  s_mov_b64 exec, s[14:15]
  buffer_load_dwordx4 v28, s[36:39], s73 offen lds
  s_mov_b64 exec, -1
  s_add_u32 s3, s75, s77
  s_add_u32 m0, s3, 0
  s_add_u32 s4, s74, 0
  buffer_load_dwordx4 v8, s[40:43], s4 offen lds
  s_add_u32 m0, s3, 1024
  s_nop 0
  buffer_load_dwordx4 v9, s[40:43], s4 offen lds
  s_add_u32 m0, s3, 8192
  s_add_u32 s4, s74, 2048
  buffer_load_dwordx4 v8, s[40:43], s4 offen lds
  s_add_u32 m0, s3, 9216
  s_nop 0
  buffer_load_dwordx4 v9, s[40:43], s4 offen lds
  s_add_u32 m0, s3, 16384
  s_add_u32 s4, s74, 4096
  buffer_load_dwordx4 v8, s[40:43], s4 offen lds
  s_add_u32 m0, s3, 17408
  s_nop 0
  buffer_load_dwordx4 v9, s[40:43], s4 offen lds
  s_add_u32 s101, s101, 1
  s_sub_u32 s73, s101, s100
  s_lshl_b32 s73, s73, 3
  s_lshr_b32 s73, 0xf0f02, s73
  s_and_b32 s73, s73, 255
  s_add_u32 s73, s73, s101
  s_and_b32 s73, s73, 15
  s_mul_i32 s74, s73, 393216
  s_lshl_b32 s73, s73, 7
  s_add_u32 s75, s75, 43008
  s_cmp_eq_u32 s75, 129024
  s_cselect_b32 s75, 0, s75
  s_waitcnt vmcnt(11)
  s_barrier
  s_sub_u32 s79, s79, 1
  s_cmp_lg_u32 s79, 0
  s_cbranch_scc1 L_attn0_ld
  s_add_u32 s3, s75, s76
  s_add_u32 m0, s3, 0
  s_nop 0
  buffer_load_dwordx4 v4, s[36:39], s73 offen lds
  s_add_u32 m0, s3, 1024
  s_nop 0
  buffer_load_dwordx4 v5, s[36:39], s73 offen lds
  s_add_u32 m0, s3, 2048
  s_nop 0
  buffer_load_dwordx4 v6, s[36:39], s73 offen lds
  s_add_u32 m0, s3, 3072
  s_nop 0
  buffer_load_dwordx4 v7, s[36:39], s73 offen lds
  s_add_u32 m0, s75, s78
  s_mov_b64 exec, s[14:15]
  buffer_load_dwordx4 v28, s[36:39], s73 offen lds
  s_mov_b64 exec, -1
  s_add_u32 s3, s75, s77
  s_add_u32 m0, s3, 0
  s_add_u32 s4, s74, 0
  buffer_load_dwordx4 v8, s[40:43], s4 offen lds
  s_add_u32 m0, s3, 1024
  s_nop 0
  buffer_load_dwordx4 v9, s[40:43], s4 offen lds
  s_add_u32 m0, s3, 8192
  s_add_u32 s4, s74, 2048
  buffer_load_dwordx4 v8, s[40:43], s4 offen lds
  s_add_u32 m0, s3, 9216
  s_nop 0
  buffer_load_dwordx4 v9, s[40:43], s4 offen lds
  s_add_u32 m0, s3, 16384
  s_add_u32 s4, s74, 4096
  buffer_load_dwordx4 v8, s[40:43], s4 offen lds
  s_add_u32 m0, s3, 17408
  s_nop 0
  buffer_load_dwordx4 v9, s[40:43], s4 offen lds
  s_add_u32 s101, s101, 1
  s_sub_u32 s73, s101, s100
  s_lshl_b32 s73, s73, 3
  s_lshr_b32 s73, 0xf0f02, s73
  s_and_b32 s73, s73, 255
  s_add_u32 s73, s73, s101
  s_and_b32 s73, s73, 15
  s_mul_i32 s74, s73, 393216
  s_lshl_b32 s73, s73, 7
  s_add_u32 s75, s75, 43008
  s_cmp_eq_u32 s75, 129024
  s_cselect_b32 s75, 0, s75
  s_mov_b32 s64, s24
  s_and_b32 s65, s25, 0xffff
  s_mov_b32 s66, 7340032
  s_mov_b32 s67, 0x00020000
  s_min_u32 s3, s2, 223
  s_mul_i32 s4, s3, 4682
  s_lshr_b32 s4, s4, 16
  s_mul_i32 s5, s4, 14
  s_sub_u32 s3, s3, s5
  s_lshl_b32 s3, s3, 2
  s_and_b32 s5, s70, 3
  s_add_u32 s3, s3, s5
  s_mul_i32 s5, s4, 458752
  s_lshl_b32 s8, s3, 7
  s_add_u32 s5, s5, s8
  s_lshl_b32 s9, s4, 14
  s_lshl_b32 s8, s3, 8
  s_add_u32 s9, s9, s8
  v_lshrrev_b32 v2, 3, v1
  v_mul_u32_u24 v2, 7168, v2
  v_and_b32 v3, 7, v1
  v_lshl_add_u32 v2, v3, 4, v2
  buffer_load_dwordx4 v[64:67], v2, s[64:67], s5 offen
  s_add_u32 s5, s5, 57344
  buffer_load_dwordx4 v[68:71], v2, s[64:67], s5 offen
  s_add_u32 s5, s5, 57344
  buffer_load_dwordx4 v[72:75], v2, s[64:67], s5 offen
  s_add_u32 s5, s5, 57344
  buffer_load_dwordx4 v[76:79], v2, s[64:67], s5 offen
  s_add_u32 s5, s5, 57344
  buffer_load_dwordx4 v[80:83], v2, s[64:67], s5 offen
  s_add_u32 s5, s5, 57344
  buffer_load_dwordx4 v[84:87], v2, s[64:67], s5 offen
  s_add_u32 s5, s5, 57344
  buffer_load_dwordx4 v[88:91], v2, s[64:67], s5 offen
  s_add_u32 s5, s5, 57344
  buffer_load_dwordx4 v[92:95], v2, s[64:67], s5 offen
  s_mov_b32 s60, s20
  s_and_b32 s61, s21, 0xffff
  s_mov_b32 s62, 2097152
  s_mov_b32 s63, 0x00020000
  s_and_b32 s3, s70, 3
  s_mul_i32 s3, s3, 8
  s_mul_i32 s4, s99, 32
  s_add_u32 s3, s3, s4
  v_lshrrev_b32 v2, 3, v1
  v_add_u32 v2, s3, v2
  v_mul_u32_u24 v2, 2048, v2
  v_and_b32 v3, 7, v1
  v_lshl_add_u32 v2, v3, 7, v2
  s_and_b32 s3, s2, 7
  s_lshr_b32 s3, s3, 2
  s_mul_i32 s3, s3, 1024
  buffer_load_dword v96, v2, s[60:63], s3 offen
  s_waitcnt vmcnt(20)
  s_barrier
  s_waitcnt vmcnt(9)
  s_barrier
  s_barrier
  s_barrier
  s_barrier
  s_waitcnt vmcnt(0)
  s_mov_b32 s7, 0xffff0000
  v_lshlrev_b32 v32, 16, v64
  v_and_b32 v33, s7, v64
  v_lshlrev_b32 v34, 16, v65
  v_and_b32 v35, s7, v65
  v_lshlrev_b32 v36, 16, v66
  v_and_b32 v37, s7, v66
  v_lshlrev_b32 v38, 16, v67
  v_and_b32 v39, s7, v67
  v_lshlrev_b32 v40, 16, v68
  v_and_b32 v41, s7, v68
  v_pk_add_f32 v[32:33], v[32:33], v[40:41]
  v_lshlrev_b32 v40, 16, v69
  v_and_b32 v41, s7, v69
  v_pk_add_f32 v[34:35], v[34:35], v[40:41]
  v_lshlrev_b32 v40, 16, v70
  v_and_b32 v41, s7, v70
  v_pk_add_f32 v[36:37], v[36:37], v[40:41]
  v_lshlrev_b32 v40, 16, v71
  v_and_b32 v41, s7, v71
  v_pk_add_f32 v[38:39], v[38:39], v[40:41]
  v_lshlrev_b32 v40, 16, v72
  v_and_b32 v41, s7, v72
  v_pk_add_f32 v[32:33], v[32:33], v[40:41]
  v_lshlrev_b32 v40, 16, v73
  v_and_b32 v41, s7, v73
  v_pk_add_f32 v[34:35], v[34:35], v[40:41]
  v_lshlrev_b32 v40, 16, v74
  v_and_b32 v41, s7, v74
  v_pk_add_f32 v[36:37], v[36:37], v[40:41]
  v_lshlrev_b32 v40, 16, v75
  v_and_b32 v41, s7, v75
  v_pk_add_f32 v[38:39], v[38:39], v[40:41]
  v_lshlrev_b32 v40, 16, v76
  v_and_b32 v41, s7, v76
  v_pk_add_f32 v[32:33], v[32:33], v[40:41]
  v_lshlrev_b32 v40, 16, v77
  v_and_b32 v41, s7, v77
  v_pk_add_f32 v[34:35], v[34:35], v[40:41]
  v_lshlrev_b32 v40, 16, v78
  v_and_b32 v41, s7, v78
  v_pk_add_f32 v[36:37], v[36:37], v[40:41]
  v_lshlrev_b32 v40, 16, v79
  v_and_b32 v41, s7, v79
  v_pk_add_f32 v[38:39], v[38:39], v[40:41]
  v_lshlrev_b32 v40, 16, v80
  v_and_b32 v41, s7, v80
  v_pk_add_f32 v[32:33], v[32:33], v[40:41]
  v_lshlrev_b32 v40, 16, v81
  v_and_b32 v41, s7, v81
  v_pk_add_f32 v[34:35], v[34:35], v[40:41]
  v_lshlrev_b32 v40, 16, v82
  v_and_b32 v41, s7, v82
  v_pk_add_f32 v[36:37], v[36:37], v[40:41]
  v_lshlrev_b32 v40, 16, v83
  v_and_b32 v41, s7, v83
  v_pk_add_f32 v[38:39], v[38:39], v[40:41]
  v_lshlrev_b32 v40, 16, v84
  v_and_b32 v41, s7, v84
  v_pk_add_f32 v[32:33], v[32:33], v[40:41]
  v_lshlrev_b32 v40, 16, v85
  v_and_b32 v41, s7, v85
  v_pk_add_f32 v[34:35], v[34:35], v[40:41]
  v_lshlrev_b32 v40, 16, v86
  v_and_b32 v41, s7, v86
  v_pk_add_f32 v[36:37], v[36:37], v[40:41]
  v_lshlrev_b32 v40, 16, v87
  v_and_b32 v41, s7, v87
  v_pk_add_f32 v[38:39], v[38:39], v[40:41]
  v_lshlrev_b32 v40, 16, v88
  v_and_b32 v41, s7, v88
  v_pk_add_f32 v[32:33], v[32:33], v[40:41]
  v_lshlrev_b32 v40, 16, v89
  v_and_b32 v41, s7, v89
  v_pk_add_f32 v[34:35], v[34:35], v[40:41]
  v_lshlrev_b32 v40, 16, v90
  v_and_b32 v41, s7, v90
  v_pk_add_f32 v[36:37], v[36:37], v[40:41]
  v_lshlrev_b32 v40, 16, v91
  v_and_b32 v41, s7, v91
  v_pk_add_f32 v[38:39], v[38:39], v[40:41]
  v_lshlrev_b32 v40, 16, v92
  v_and_b32 v41, s7, v92
  v_pk_add_f32 v[32:33], v[32:33], v[40:41]
  v_lshlrev_b32 v40, 16, v93
  v_and_b32 v41, s7, v93
  v_pk_add_f32 v[34:35], v[34:35], v[40:41]
  v_lshlrev_b32 v40, 16, v94
  v_and_b32 v41, s7, v94
  v_pk_add_f32 v[36:37], v[36:37], v[40:41]
  v_lshlrev_b32 v40, 16, v95
  v_and_b32 v41, s7, v95
  v_pk_add_f32 v[38:39], v[38:39], v[40:41]
  s_add_u32 s64, s34, 24641536
  s_addc_u32 s65, s35, 0
  s_and_b32 s65, s65, 0xffff
  s_mov_b32 s66, 262144
  s_mov_b32 s67, 0x00020000
  v_permlane32_swap_b32 v32, v36
  v_permlane32_swap_b32 v33, v37
  v_permlane32_swap_b32 v34, v38
  v_permlane32_swap_b32 v35, v39
  v_add_f32 v32, v32, v36
  v_add_f32 v33, v33, v37
  v_add_f32 v34, v34, v38
  v_add_f32 v35, v35, v39
  v_and_b32 v2, 7, v1
  v_lshlrev_b32 v2, 5, v2
  v_permlane16_swap_b32 v32, v34
  v_permlane16_swap_b32 v33, v35
  v_add_f32 v32, v32, v34
  v_add_f32 v33, v33, v35
  v_lshrrev_b32 v3, 4, v1
  v_lshl_add_u32 v2, v3, 3, v2
  v_add_f32_dpp v32, v32, v32 row_ror:8 row_mask:0xf bank_mask:0xf
  v_add_f32_dpp v33, v33, v33 row_ror:8 row_mask:0xf bank_mask:0xf
  buffer_store_dwordx2 v[32:33], v2, s[64:67], s9 offen
  s_endpgm
L_attn_ld1:
  s_add_u32 s56, s34, 24117248
  s_addc_u32 s57, s35, 0
  s_and_b32 s57, s57, 0xffff
  s_mov_b32 s58, 262144
  s_mov_b32 s59, 0x00020000
  s_add_u32 s3, s75, s76
  s_add_u32 m0, s3, 0
  s_nop 0
  buffer_load_dwordx4 v4, s[36:39], s73 offen lds
  s_add_u32 m0, s3, 1024
  s_nop 0
  buffer_load_dwordx4 v5, s[36:39], s73 offen lds
  s_add_u32 m0, s3, 2048
  s_nop 0
  buffer_load_dwordx4 v6, s[36:39], s73 offen lds
  s_add_u32 m0, s3, 3072
  s_nop 0
  buffer_load_dwordx4 v7, s[36:39], s73 offen lds
  s_add_u32 m0, s75, s78
  s_mov_b64 exec, s[14:15]
  buffer_load_dwordx4 v28, s[36:39], s73 offen lds
  s_mov_b64 exec, -1
  s_add_u32 s3, s75, s77
  s_add_u32 m0, s3, 0
  s_add_u32 s4, s74, 0
  buffer_load_dwordx4 v8, s[40:43], s4 offen lds
  s_add_u32 m0, s3, 1024
  s_nop 0
  buffer_load_dwordx4 v9, s[40:43], s4 offen lds
  s_add_u32 m0, s3, 8192
  s_add_u32 s4, s74, 2048
  buffer_load_dwordx4 v8, s[40:43], s4 offen lds
  s_add_u32 m0, s3, 9216
  s_nop 0
  buffer_load_dwordx4 v9, s[40:43], s4 offen lds
  s_add_u32 m0, s3, 16384
  s_add_u32 s4, s74, 4096
  buffer_load_dwordx4 v8, s[40:43], s4 offen lds
  s_add_u32 m0, s3, 17408
  s_nop 0
  buffer_load_dwordx4 v9, s[40:43], s4 offen lds
  s_add_u32 s101, s101, 1
  s_sub_u32 s73, s101, s100
  s_lshl_b32 s73, s73, 3
  s_lshr_b32 s73, 0xf0f02, s73
  s_and_b32 s73, s73, 255
  s_add_u32 s73, s73, s101
  s_and_b32 s73, s73, 15
  s_mul_i32 s74, s73, 393216
  s_lshl_b32 s73, s73, 7
  s_add_u32 s75, s75, 43008
  s_cmp_eq_u32 s75, 129024
  s_cselect_b32 s75, 0, s75
  s_add_u32 s3, s75, s76
  s_add_u32 m0, s3, 0
  s_nop 0
  buffer_load_dwordx4 v4, s[36:39], s73 offen lds
  s_add_u32 m0, s3, 1024
  s_nop 0
  buffer_load_dwordx4 v5, s[36:39], s73 offen lds
  s_add_u32 m0, s3, 2048
  s_nop 0
  buffer_load_dwordx4 v6, s[36:39], s73 offen lds
  s_add_u32 m0, s3, 3072
  s_nop 0
  buffer_load_dwordx4 v7, s[36:39], s73 offen lds
  s_add_u32 m0, s75, s78
  s_mov_b64 exec, s[14:15]
  buffer_load_dwordx4 v28, s[36:39], s73 offen lds
  s_mov_b64 exec, -1
  s_add_u32 s3, s75, s77
  s_add_u32 m0, s3, 0
  s_add_u32 s4, s74, 0
  buffer_load_dwordx4 v8, s[40:43], s4 offen lds
  s_add_u32 m0, s3, 1024
  s_nop 0
  buffer_load_dwordx4 v9, s[40:43], s4 offen lds
  s_add_u32 m0, s3, 8192
  s_add_u32 s4, s74, 2048
  buffer_load_dwordx4 v8, s[40:43], s4 offen lds
  s_add_u32 m0, s3, 9216
  s_nop 0
  buffer_load_dwordx4 v9, s[40:43], s4 offen lds
  s_add_u32 m0, s3, 16384
  s_add_u32 s4, s74, 4096
  buffer_load_dwordx4 v8, s[40:43], s4 offen lds
  s_add_u32 m0, s3, 17408
  s_nop 0
  buffer_load_dwordx4 v9, s[40:43], s4 offen lds
  s_add_u32 s101, s101, 1
  s_sub_u32 s73, s101, s100
  s_lshl_b32 s73, s73, 3
  s_lshr_b32 s73, 0xf0f02, s73
  s_and_b32 s73, s73, 255
  s_add_u32 s73, s73, s101
  s_and_b32 s73, s73, 15
  s_mul_i32 s74, s73, 393216
  s_lshl_b32 s73, s73, 7
  s_add_u32 s75, s75, 43008
  s_cmp_eq_u32 s75, 129024
  s_cselect_b32 s75, 0, s75
  s_waitcnt vmcnt(11)
  s_barrier
  s_mov_b32 s79, 13
L_attn1_ld:
  s_add_u32 s3, s75, s76
  s_add_u32 m0, s3, 0
  s_nop 0
  buffer_load_dwordx4 v4, s[36:39], s73 offen lds
  s_add_u32 m0, s3, 1024
  s_nop 0
  buffer_load_dwordx4 v5, s[36:39], s73 offen lds
  s_add_u32 m0, s3, 2048
  s_nop 0
  buffer_load_dwordx4 v6, s[36:39], s73 offen lds
  s_add_u32 m0, s3, 3072
  s_nop 0
  buffer_load_dwordx4 v7, s[36:39], s73 offen lds
  s_add_u32 m0, s75, s78
  s_mov_b64 exec, s[14:15]
  buffer_load_dwordx4 v28, s[36:39], s73 offen lds
  s_mov_b64 exec, -1
  s_add_u32 s3, s75, s77
  s_add_u32 m0, s3, 0
  s_add_u32 s4, s74, 0
  buffer_load_dwordx4 v8, s[40:43], s4 offen lds
  s_add_u32 m0, s3, 1024
  s_nop 0
  buffer_load_dwordx4 v9, s[40:43], s4 offen lds
  s_add_u32 m0, s3, 8192
  s_add_u32 s4, s74, 2048
  buffer_load_dwordx4 v8, s[40:43], s4 offen lds
  s_add_u32 m0, s3, 9216
  s_nop 0
  buffer_load_dwordx4 v9, s[40:43], s4 offen lds
  s_add_u32 m0, s3, 16384
  s_add_u32 s4, s74, 4096
  buffer_load_dwordx4 v8, s[40:43], s4 offen lds
  s_add_u32 m0, s3, 17408
  s_nop 0
  buffer_load_dwordx4 v9, s[40:43], s4 offen lds
  s_add_u32 s101, s101, 1
  s_sub_u32 s73, s101, s100
  s_lshl_b32 s73, s73, 3
  s_lshr_b32 s73, 0xf0f02, s73
  s_and_b32 s73, s73, 255
  s_add_u32 s73, s73, s101
  s_and_b32 s73, s73, 15
  s_mul_i32 s74, s73, 393216
  s_lshl_b32 s73, s73, 7
  s_add_u32 s75, s75, 43008
  s_cmp_eq_u32 s75, 129024
  s_cselect_b32 s75, 0, s75
  s_waitcnt vmcnt(11)
  s_barrier
  s_sub_u32 s79, s79, 1
  s_cmp_lg_u32 s79, 0
  s_cbranch_scc1 L_attn1_ld
  s_add_u32 s3, s75, s76
  s_add_u32 m0, s3, 0
  s_nop 0
  buffer_load_dwordx4 v4, s[36:39], s73 offen lds
  s_add_u32 m0, s3, 1024
  s_nop 0
  buffer_load_dwordx4 v5, s[36:39], s73 offen lds
  s_add_u32 m0, s3, 2048
  s_nop 0
  buffer_load_dwordx4 v6, s[36:39], s73 offen lds
  s_add_u32 m0, s3, 3072
  s_nop 0
  buffer_load_dwordx4 v7, s[36:39], s73 offen lds
  s_add_u32 m0, s75, s78
  s_mov_b64 exec, s[14:15]
  buffer_load_dwordx4 v28, s[36:39], s73 offen lds
  s_mov_b64 exec, -1
  s_add_u32 s3, s75, s77
  s_add_u32 m0, s3, 0
  s_add_u32 s4, s74, 0
  buffer_load_dwordx4 v8, s[40:43], s4 offen lds
  s_add_u32 m0, s3, 1024
  s_nop 0
  buffer_load_dwordx4 v9, s[40:43], s4 offen lds
  s_add_u32 m0, s3, 8192
  s_add_u32 s4, s74, 2048
  buffer_load_dwordx4 v8, s[40:43], s4 offen lds
  s_add_u32 m0, s3, 9216
  s_nop 0
  buffer_load_dwordx4 v9, s[40:43], s4 offen lds
  s_add_u32 m0, s3, 16384
  s_add_u32 s4, s74, 4096
  buffer_load_dwordx4 v8, s[40:43], s4 offen lds
  s_add_u32 m0, s3, 17408
  s_nop 0
  buffer_load_dwordx4 v9, s[40:43], s4 offen lds
  s_add_u32 s101, s101, 1
  s_sub_u32 s73, s101, s100
  s_lshl_b32 s73, s73, 3
  s_lshr_b32 s73, 0xf0f02, s73
  s_and_b32 s73, s73, 255
  s_add_u32 s73, s73, s101
  s_and_b32 s73, s73, 15
  s_mul_i32 s74, s73, 393216
  s_lshl_b32 s73, s73, 7
  s_add_u32 s75, s75, 43008
  s_cmp_eq_u32 s75, 129024
  s_cselect_b32 s75, 0, s75
  s_and_b32 s3, s70, 3
  s_lshl_b32 s4, s68, 7
  s_lshl_b32 s5, s3, 6
  s_add_u32 s5, s5, s4
  v_add_u32 v2, s5, v1
  s_sub_u32 s4, s4, 16
  v_and_b32 v3, 15, v1
  v_add_u32 v3, s4, v3
  v_max_i32 v3, 0, v3
  s_cmp_ge_u32 s3, 2
  s_cselect_b64 vcc, -1, 0
  v_cndmask_b32 v2, v2, v3, vcc
  v_lshlrev_b32 v2, 3, v2
  s_mov_b32 s3, 0
  buffer_load_dwordx2 v[32:33], v2, s[56:59], s3 offen
  s_add_u32 s3, s3, 16384
  buffer_load_dwordx2 v[34:35], v2, s[56:59], s3 offen
  s_add_u32 s3, s3, 16384
  buffer_load_dwordx2 v[36:37], v2, s[56:59], s3 offen
  s_add_u32 s3, s3, 16384
  buffer_load_dwordx2 v[38:39], v2, s[56:59], s3 offen
  s_add_u32 s3, s3, 16384
  buffer_load_dwordx2 v[40:41], v2, s[56:59], s3 offen
  s_add_u32 s3, s3, 16384
  buffer_load_dwordx2 v[42:43], v2, s[56:59], s3 offen
  s_add_u32 s3, s3, 16384
  buffer_load_dwordx2 v[44:45], v2, s[56:59], s3 offen
  s_add_u32 s3, s3, 16384
  buffer_load_dwordx2 v[46:47], v2, s[56:59], s3 offen
  s_add_u32 s3, s3, 16384
  buffer_load_dwordx2 v[48:49], v2, s[56:59], s3 offen
  s_add_u32 s3, s3, 16384
  buffer_load_dwordx2 v[50:51], v2, s[56:59], s3 offen
  s_add_u32 s3, s3, 16384
  buffer_load_dwordx2 v[52:53], v2, s[56:59], s3 offen
  s_add_u32 s3, s3, 16384
  buffer_load_dwordx2 v[54:55], v2, s[56:59], s3 offen
  s_add_u32 s3, s3, 16384
  buffer_load_dwordx2 v[56:57], v2, s[56:59], s3 offen
  s_add_u32 s3, s3, 16384
  buffer_load_dwordx2 v[58:59], v2, s[56:59], s3 offen
  s_add_u32 s3, s3, 16384
  buffer_load_dwordx2 v[60:61], v2, s[56:59], s3 offen
  s_add_u32 s3, s3, 16384
  buffer_load_dwordx2 v[62:63], v2, s[56:59], s3 offen
  s_mov_b32 s60, s20
  s_and_b32 s61, s21, 0xffff
  s_mov_b32 s62, 2097152
  s_mov_b32 s63, 0x00020000
  s_and_b32 s3, s70, 3
  s_mul_i32 s3, s3, 8
  s_mul_i32 s4, s99, 32
  s_add_u32 s3, s3, s4
  v_lshrrev_b32 v2, 3, v1
  v_add_u32 v2, s3, v2
  v_mul_u32_u24 v2, 2048, v2
  v_and_b32 v3, 7, v1
  v_lshl_add_u32 v2, v3, 7, v2
  s_and_b32 s3, s2, 7
  s_lshr_b32 s3, s3, 2
  s_mul_i32 s3, s3, 1024
  buffer_load_dword v96, v2, s[60:63], s3 offen
  s_waitcnt vmcnt(28)
  s_barrier
  s_waitcnt vmcnt(17)
  s_barrier
  s_waitcnt vmcnt(1)
  v_add_f32 v32, v32, v34
  v_add_f32 v33, v33, v35
  v_add_f32 v48, v48, v50
  v_add_f32 v49, v49, v51
  v_add_f32 v32, v32, v36
  v_add_f32 v33, v33, v37
  v_add_f32 v48, v48, v52
  v_add_f32 v49, v49, v53
  v_add_f32 v32, v32, v38
  v_add_f32 v33, v33, v39
  v_add_f32 v48, v48, v54
  v_add_f32 v49, v49, v55
  v_add_f32 v32, v32, v40
  v_add_f32 v33, v33, v41
  v_add_f32 v48, v48, v56
  v_add_f32 v49, v49, v57
  v_add_f32 v32, v32, v42
  v_add_f32 v33, v33, v43
  v_add_f32 v48, v48, v58
  v_add_f32 v49, v49, v59
  v_add_f32 v32, v32, v44
  v_add_f32 v33, v33, v45
  v_add_f32 v48, v48, v60
  v_add_f32 v49, v49, v61
  v_add_f32 v32, v32, v46
  v_add_f32 v33, v33, v47
  v_add_f32 v48, v48, v62
  v_add_f32 v49, v49, v63
  v_add_f32 v32, v32, v48
  v_add_f32 v33, v33, v49
  v_mul_f32 v32, 0x3a800000, v32
  v_mul_f32 v33, 0x3a800000, v33
  v_fma_f32 v33, -v32, v32, v33
  v_max_f32 v33, 0, v33
  v_add_f32 v33, 0x3727c5ac, v33
  v_rsq_f32 v33, v33
  s_nop 0
  s_and_b32 s3, s70, 3
  s_lshl_b32 s5, s3, 6
  s_add_u32 s5, s5, 16
  v_add_u32 v2, s5, v1
  v_and_b32 v3, 15, v1
  s_cmp_ge_u32 s3, 2
  s_cselect_b64 vcc, -1, 0
  v_cndmask_b32 v2, v2, v3, vcc
  v_lshlrev_b32 v2, 2, v2
  v_add_u32 v2, 129024, v2
  ds_write2_b32 v2, v32, v33 offset0:0 offset1:160
  s_waitcnt lgkmcnt(0)
  s_barrier
  s_barrier
  s_waitcnt vmcnt(0)
L_attn_end:
  s_endpgm
L_attn_compute:
  s_getpc_b64 s[4:5]
L_pfc1:
  s_lshl_b32 s3, s99, 2
  s_add_u32 s3, s3, s70
  s_mul_i32 s3, s3, 256
  s_min_u32 s3, s3, L_w2_c1-L_attn_c0-256
  s_add_i32 s3, s3, L_attn_c0-L_pfc1
  s_ashr_i32 s6, s3, 31
  s_add_u32 s4, s4, s3
  s_addc_u32 s5, s5, s6
  s_load_dword s36, s[4:5], 0
  s_load_dword s37, s[4:5], 64
  s_load_dword s38, s[4:5], 128
  s_load_dword s39, s[4:5], 192
  s_and_b32 s71, s70, 1
  s_lshr_b32 s72, s70, 1
  v_and_b32 v3, 31, v1
  v_lshlrev_b32 v3, 2, v3
  v_add_u32 v3, 40960, v3
  v_mov_b32 v236, 0x3f803f80
  v_mov_b32 v237, 0x3f803f80
  v_mov_b32 v238, 0x3f803f80
  v_mov_b32 v239, 0x3f803f80
  ds_write_b32 v3, v236
  ds_write_b32 v3, v236 offset:43008
  v_add_u32 v3, 86016, v3
  ds_write_b32 v3, v236
  v_and_b32 v3, 15, v1
  v_lshrrev_b32 v2, 4, v1
  v_lshrrev_b32 v33, 1, v3
  s_lshl_b32 s8, s71, 13
  v_xor_b32 v4, v2, v33
  v_lshlrev_b32 v4, 4, v4
  v_lshl_add_u32 v4, v3, 7, v4
  v_add_u32 v8, 40960, v4
  v_add_u32 v4, s8, v4
  v_add_u32 v5, 4, v2
  v_xor_b32 v5, v5, v33
  v_lshlrev_b32 v5, 4, v5
  v_lshl_add_u32 v5, v3, 7, v5
  v_add_u32 v9, 40960, v5
  v_add_u32 v5, s8, v5
  v_bfe_u32 v34, v1, 2, 2
  v_lshl_add_u32 v34, v2, 3, v34
  v_lshlrev_b32 v34, 7, v34
  v_and_b32 v33, 3, v1
  v_lshl_add_u32 v34, v33, 3, v34
  v_bfe_u32 v33, v1, 3, 2
  v_lshl_add_u32 v34, v33, 5, v34
  v_and_b32 v35, 1, v2
  v_xor_b32 v35, s71, v35
  s_lshl_b32 s8, s70, 5
  v_xor_b32 v34, s8, v34
  v_add_u32 v6, 16384, v34
  v_xor_b32 v7, 32, v6
  s_lshl_b32 s8, s68, 7
  s_lshl_b32 s9, s71, 6
  s_add_u32 s8, s8, s9
  s_add_u32 s10, s8, s69
  s_lshl_b32 s10, s10, 11
  s_lshl_b32 s11, s72, 10
  s_add_u32 s10, s10, s11
  v_lshl_add_u32 v33, v3, 4, s10
  v_lshl_add_u32 v33, v35, 9, v33
  v_lshrrev_b32 v34, 1, v2
  v_lshl_add_u32 v31, v34, 8, v33
  s_mul_i32 s10, s72, 12288
  s_add_u32 s10, s10, 1024
  s_lshl_b32 s11, s71, 10
  s_add_u32 s4, s10, s11
  s_sub_u32 s5, s10, s11
  s_mul_i32 s6, s71, 6144
  v_lshl_add_u32 v16, v1, 4, s4
  v_add_u32 v17, s6, v16
  v_lshl_add_u32 v18, v1, 4, s5
  v_add_u32 v18, s6, v18
  v_lshl_add_u32 v19, v2, 8, s4
  v_lshl_add_u32 v20, v2, 8, s5
  v_lshl_add_u32 v21, v3, 4, s4
  v_lshl_add_u32 v22, v3, 4, s5
  s_lshl_b32 s10, s71, 8
  s_add_u32 s10, s10, 129024
  v_lshl_add_u32 v23, v3, 2, s10
  v_lshl_add_u32 v24, v2, 4, s10
  v_and_b32 v33, 1, v3
  v_cmp_eq_u32 s[48:49], 1, v33
  v_lshl_add_u32 v34, v2, 2, v33
  v_add_u32 v35, 2, v34
  v_cmp_gt_u32 s[50:51], v34, v3
  v_cmp_gt_u32 s[52:53], v35, v3
  v_mov_b32 v36, 0xffff
  v_mov_b32 v37, 0xffff0000
  v_cndmask_b32 v36, v36, v37, s[48:49]
  s_add_u32 s10, s10, 704
  v_lshl_add_u32 v34, v34, 2, s10
  v_lshl_add_u32 v35, v35, 2, s10
  v_subrev_u32 v38, 64, v34
  v_subrev_u32 v39, 64, v35
  v_cndmask_b32 v25, v34, v38, s[50:51]
  v_cndmask_b32 v26, v35, v39, s[52:53]
  v_cndmask_b32 v27, 0, v36, s[50:51]
  v_cndmask_b32 v29, 0, v36, s[52:53]
  v_xor_b32 v28, v27, v36
  v_xor_b32 v30, v29, v36
  s_cmp_eq_u32 s8, 0
  s_cselect_b64 s[54:55], s[50:51], 0
  s_cselect_b64 s[14:15], s[52:53], 0
  v_mov_b32 v120, 0
  v_mov_b32 v121, 0
  v_mov_b32 v122, 0
  v_mov_b32 v123, 0
  v_mov_b32 v124, 0
  v_mov_b32 v125, 0
  v_mov_b32 v126, 0
  v_mov_b32 v127, 0
  v_mov_b32 v128, 0
  v_mov_b32 v129, 0
  v_mov_b32 v130, 0
  v_mov_b32 v131, 0
  v_mov_b32 v132, 0
  v_mov_b32 v133, 0
  v_mov_b32 v134, 0
  v_mov_b32 v135, 0
  v_mov_b32 v136, 0
  v_mov_b32 v137, 0
  v_mov_b32 v138, 0
  v_mov_b32 v139, 0
  v_mov_b32 v140, 0
  v_mov_b32 v141, 0
  v_mov_b32 v142, 0
  v_mov_b32 v143, 0
  v_mov_b32 v144, 0
  v_mov_b32 v145, 0
  v_mov_b32 v146, 0
  v_mov_b32 v147, 0
  v_mov_b32 v148, 0
  v_mov_b32 v149, 0
  v_mov_b32 v150, 0
  v_mov_b32 v151, 0
  v_mov_b32 v152, 0
  v_mov_b32 v153, 0
  v_mov_b32 v154, 0
  v_mov_b32 v155, 0
  v_mov_b32 v156, 0
  v_mov_b32 v157, 0
  v_mov_b32 v158, 0
  v_mov_b32 v159, 0
  v_mov_b32 v160, 0
  v_mov_b32 v161, 0
  v_mov_b32 v162, 0
  v_mov_b32 v163, 0
  v_mov_b32 v164, 0
  v_mov_b32 v165, 0
  v_mov_b32 v166, 0
  v_mov_b32 v167, 0
  v_mov_b32 v168, 0
  v_mov_b32 v169, 0
  v_mov_b32 v170, 0
  v_mov_b32 v171, 0
  v_mov_b32 v172, 0
  v_mov_b32 v173, 0
  v_mov_b32 v174, 0
  v_mov_b32 v175, 0
  v_mov_b32 v176, 0
  v_mov_b32 v177, 0
  v_mov_b32 v178, 0
  v_mov_b32 v179, 0
  v_mov_b32 v180, 0
  v_mov_b32 v181, 0
  v_mov_b32 v182, 0
  v_mov_b32 v183, 0
  v_mov_b32 v184, 0
  v_mov_b32 v185, 0
  v_mov_b32 v186, 0
  v_mov_b32 v187, 0
  v_mov_b32 v188, 0
  v_mov_b32 v189, 0
  v_mov_b32 v190, 0
  v_mov_b32 v191, 0
  v_mov_b32 v192, 0
  v_mov_b32 v193, 0
  v_mov_b32 v194, 0
  v_mov_b32 v195, 0
  v_mov_b32 v196, 0
  v_mov_b32 v197, 0
  v_mov_b32 v198, 0
  v_mov_b32 v199, 0
  v_mov_b32 v200, 0
  v_mov_b32 v201, 0
  v_mov_b32 v202, 0
  v_mov_b32 v203, 0
  v_mov_b32 v204, 0
  v_mov_b32 v205, 0
  v_mov_b32 v206, 0
  v_mov_b32 v207, 0
  v_mov_b32 v208, 0
  v_mov_b32 v209, 0
  v_mov_b32 v210, 0
  v_mov_b32 v211, 0
  v_mov_b32 v212, 0
  v_mov_b32 v213, 0
  v_mov_b32 v214, 0
  v_mov_b32 v215, 0
  v_mov_b32 v216, 0
  v_mov_b32 v217, 0
  v_mov_b32 v218, 0
  v_mov_b32 v219, 0
  v_mov_b32 v220, 0
  v_mov_b32 v221, 0
  v_mov_b32 v222, 0
  v_mov_b32 v223, 0
  v_mov_b32 v224, 0
  v_mov_b32 v225, 0
  v_mov_b32 v226, 0
  v_mov_b32 v227, 0
  v_mov_b32 v228, 0
  v_mov_b32 v229, 0
  v_mov_b32 v230, 0
  v_mov_b32 v231, 0
  v_mov_b32 v232, 0
  v_mov_b32 v233, 0
  v_mov_b32 v234, 0
  v_mov_b32 v235, 0
  v_mov_b32 v240, 0
  v_mov_b32 v241, 0
  v_mov_b32 v242, 0
  v_mov_b32 v243, 0
  v_mov_b32 v244, 0
  v_mov_b32 v245, 0
  v_mov_b32 v246, 0
  v_mov_b32 v247, 0
  v_mov_b32 v248, 0
  v_mov_b32 v249, 0
  v_mov_b32 v250, 0
  v_mov_b32 v251, 0
  v_mov_b32 v252, 0
  v_mov_b32 v253, 0
  v_mov_b32 v254, 0
  v_mov_b32 v255, 0
  s_waitcnt lgkmcnt(0)
  s_mov_b32 s44, s34
  s_and_b32 s45, s35, 0xffff
  s_mov_b32 s46, 4194304
  s_mov_b32 s47, 0x00020000
  s_mov_b32 s75, 0
  v_add_u32_e64 v10, s75, v4
  v_add_u32_e64 v11, s75, v5
  v_add_u32_e64 v12, s75, v6
  v_add_u32_e64 v13, s75, v7
  v_add_u32_e64 v14, s75, v8
  v_add_u32_e64 v15, s75, v9
  s_add_u32 s75, s75, 43008
  s_cmp_eq_u32 s75, 129024
  s_cselect_b32 s75, 0, s75
  s_mov_b32 s79, 16
  s_barrier
  ds_read_b128 v[32:35], v10 offset:0
  ds_read_b128 v[36:39], v10 offset:2048
  ds_read_b128 v[40:43], v10 offset:4096
  ds_read_b128 v[44:47], v10 offset:6144
  ds_read_b128 v[48:51], v14
  ds_read_b64_tr_b16 v[52:53], v12 offset:0
  ds_read_b64_tr_b16 v[54:55], v12 offset:512
  ds_read_b64_tr_b16 v[56:57], v13 offset:0
  ds_read_b64_tr_b16 v[58:59], v13 offset:512
  ds_read_b64_tr_b16 v[60:61], v12 offset:8192
  ds_read_b64_tr_b16 v[62:63], v12 offset:8704
  ds_read_b64_tr_b16 v[64:65], v13 offset:8192
  ds_read_b64_tr_b16 v[66:67], v13 offset:8704
  ds_read_b64_tr_b16 v[68:69], v12 offset:16384
  ds_read_b64_tr_b16 v[70:71], v12 offset:16896
  ds_read_b64_tr_b16 v[72:73], v13 offset:16384
  ds_read_b64_tr_b16 v[74:75], v13 offset:16896
  s_waitcnt lgkmcnt(0)
  s_cmp_lg_u32 s96, 0
  s_cbranch_scc1 L_attn_loop
  s_cmp_lg_u32 s72, 0
  s_cbranch_scc1 L_attn_loopb
.p2align 3
L_attn_loopa:
  v_mfma_f32_16x16x32_bf16 v[240:243], v[236:239], v[32:35], v[240:243]
  ds_read_b128 v[76:79], v11 offset:0
  v_mfma_f32_16x16x32_bf16 v[244:247], v[32:35], v[32:35], v[244:247]
  ds_read_b128 v[80:83], v11 offset:2048
  v_mfma_f32_16x16x32_bf16 v[248:251], v[236:239], v[36:39], v[248:251]
  ds_read_b128 v[84:87], v11 offset:4096
  v_mfma_f32_16x16x32_bf16 v[252:255], v[36:39], v[36:39], v[252:255]
  ds_read_b128 v[88:91], v11 offset:6144
  v_mfma_f32_16x16x32_bf16 v[120:123], v[236:239], v[48:51], v[120:123]
  ds_read_b128 v[92:95], v15
  v_mfma_f32_16x16x32_bf16 v[124:127], v[48:51], v[48:51], v[124:127]
  ds_read_b64_tr_b16 v[96:97], v12 offset:4096
  v_mfma_f32_16x16x32_bf16 v[128:131], v[52:55], v[32:35], v[128:131]
  ds_read_b64_tr_b16 v[98:99], v12 offset:4608
  v_mfma_f32_16x16x32_bf16 v[132:135], v[52:55], v[36:39], v[132:135]
  ds_read_b64_tr_b16 v[100:101], v13 offset:4096
  v_mfma_f32_16x16x32_bf16 v[136:139], v[52:55], v[40:43], v[136:139]
  ds_read_b64_tr_b16 v[102:103], v13 offset:4608
  v_mfma_f32_16x16x32_bf16 v[140:143], v[52:55], v[44:47], v[140:143]
  ds_read_b64_tr_b16 v[104:105], v12 offset:12288
  v_mfma_f32_16x16x32_bf16 v[224:227], v[52:55], v[48:51], v[224:227]
  ds_read_b64_tr_b16 v[106:107], v12 offset:12800
  v_mfma_f32_16x16x32_bf16 v[144:147], v[56:59], v[32:35], v[144:147]
  ds_read_b64_tr_b16 v[108:109], v13 offset:12288
  v_mfma_f32_16x16x32_bf16 v[148:151], v[56:59], v[36:39], v[148:151]
  ds_read_b64_tr_b16 v[110:111], v13 offset:12800
  v_mfma_f32_16x16x32_bf16 v[152:155], v[56:59], v[40:43], v[152:155]
  ds_read_b64_tr_b16 v[112:113], v12 offset:20480
  v_mfma_f32_16x16x32_bf16 v[156:159], v[56:59], v[44:47], v[156:159]
  ds_read_b64_tr_b16 v[114:115], v12 offset:20992
  v_mfma_f32_16x16x32_bf16 v[160:163], v[60:63], v[32:35], v[160:163]
  ds_read_b64_tr_b16 v[116:117], v13 offset:20480
  v_mfma_f32_16x16x32_bf16 v[164:167], v[60:63], v[36:39], v[164:167]
  ds_read_b64_tr_b16 v[118:119], v13 offset:20992
  v_mfma_f32_16x16x32_bf16 v[168:171], v[60:63], v[40:43], v[168:171]
  v_add_u32_e64 v10, s75, v4
  v_mfma_f32_16x16x32_bf16 v[172:175], v[60:63], v[44:47], v[172:175]
  v_add_u32_e64 v11, s75, v5
  v_mfma_f32_16x16x32_bf16 v[228:231], v[60:63], v[48:51], v[228:231]
  v_add_u32_e64 v12, s75, v6
  v_mfma_f32_16x16x32_bf16 v[176:179], v[64:67], v[32:35], v[176:179]
  v_add_u32_e64 v13, s75, v7
  v_mfma_f32_16x16x32_bf16 v[180:183], v[64:67], v[36:39], v[180:183]
  v_add_u32_e64 v14, s75, v8
  v_mfma_f32_16x16x32_bf16 v[184:187], v[64:67], v[40:43], v[184:187]
  v_add_u32_e64 v15, s75, v9
  v_mfma_f32_16x16x32_bf16 v[188:191], v[64:67], v[44:47], v[188:191]
  s_add_u32 s75, s75, 43008
  v_mfma_f32_16x16x32_bf16 v[192:195], v[32:35], v[68:71], v[192:195]
  s_cmp_eq_u32 s75, 129024
  v_mfma_f32_16x16x32_bf16 v[196:199], v[36:39], v[68:71], v[196:199]
  s_cselect_b32 s75, 0, s75
  s_sub_u32 s79, s79, 1
  v_mfma_f32_16x16x32_bf16 v[200:203], v[40:43], v[68:71], v[200:203]
  v_mfma_f32_16x16x32_bf16 v[204:207], v[44:47], v[68:71], v[204:207]
  v_mfma_f32_16x16x32_bf16 v[232:235], v[48:51], v[68:71], v[232:235]
  v_mfma_f32_16x16x32_bf16 v[208:211], v[32:35], v[72:75], v[208:211]
  v_mfma_f32_16x16x32_bf16 v[212:215], v[36:39], v[72:75], v[212:215]
  v_mfma_f32_16x16x32_bf16 v[216:219], v[40:43], v[72:75], v[216:219]
  v_mfma_f32_16x16x32_bf16 v[220:223], v[44:47], v[72:75], v[220:223]
  s_waitcnt lgkmcnt(0)
  s_barrier
  v_mfma_f32_16x16x32_bf16 v[240:243], v[236:239], v[76:79], v[240:243]
  ds_read_b128 v[32:35], v10 offset:0
  v_mfma_f32_16x16x32_bf16 v[244:247], v[76:79], v[76:79], v[244:247]
  ds_read_b128 v[36:39], v10 offset:2048
  v_mfma_f32_16x16x32_bf16 v[248:251], v[236:239], v[80:83], v[248:251]
  ds_read_b128 v[40:43], v10 offset:4096
  v_mfma_f32_16x16x32_bf16 v[252:255], v[80:83], v[80:83], v[252:255]
  ds_read_b128 v[44:47], v10 offset:6144
  v_mfma_f32_16x16x32_bf16 v[120:123], v[236:239], v[92:95], v[120:123]
  ds_read_b128 v[48:51], v14
  v_mfma_f32_16x16x32_bf16 v[124:127], v[92:95], v[92:95], v[124:127]
  ds_read_b64_tr_b16 v[52:53], v12 offset:0
  v_mfma_f32_16x16x32_bf16 v[128:131], v[96:99], v[76:79], v[128:131]
  ds_read_b64_tr_b16 v[54:55], v12 offset:512
  v_mfma_f32_16x16x32_bf16 v[132:135], v[96:99], v[80:83], v[132:135]
  ds_read_b64_tr_b16 v[56:57], v13 offset:0
  v_mfma_f32_16x16x32_bf16 v[136:139], v[96:99], v[84:87], v[136:139]
  ds_read_b64_tr_b16 v[58:59], v13 offset:512
  v_mfma_f32_16x16x32_bf16 v[140:143], v[96:99], v[88:91], v[140:143]
  ds_read_b64_tr_b16 v[60:61], v12 offset:8192
  v_mfma_f32_16x16x32_bf16 v[224:227], v[96:99], v[92:95], v[224:227]
  ds_read_b64_tr_b16 v[62:63], v12 offset:8704
  v_mfma_f32_16x16x32_bf16 v[144:147], v[100:103], v[76:79], v[144:147]
  ds_read_b64_tr_b16 v[64:65], v13 offset:8192
  v_mfma_f32_16x16x32_bf16 v[148:151], v[100:103], v[80:83], v[148:151]
  ds_read_b64_tr_b16 v[66:67], v13 offset:8704
  v_mfma_f32_16x16x32_bf16 v[152:155], v[100:103], v[84:87], v[152:155]
  ds_read_b64_tr_b16 v[68:69], v12 offset:16384
  v_mfma_f32_16x16x32_bf16 v[156:159], v[100:103], v[88:91], v[156:159]
  ds_read_b64_tr_b16 v[70:71], v12 offset:16896
  v_mfma_f32_16x16x32_bf16 v[160:163], v[104:107], v[76:79], v[160:163]
  ds_read_b64_tr_b16 v[72:73], v13 offset:16384
  v_mfma_f32_16x16x32_bf16 v[164:167], v[104:107], v[80:83], v[164:167]
  ds_read_b64_tr_b16 v[74:75], v13 offset:16896
  v_mfma_f32_16x16x32_bf16 v[168:171], v[104:107], v[84:87], v[168:171]
  s_cmp_lg_u32 s79, 0
  s_nop 0
  v_mfma_f32_16x16x32_bf16 v[172:175], v[104:107], v[88:91], v[172:175]
  v_mfma_f32_16x16x32_bf16 v[228:231], v[104:107], v[92:95], v[228:231]
  v_mfma_f32_16x16x32_bf16 v[176:179], v[108:111], v[76:79], v[176:179]
  v_mfma_f32_16x16x32_bf16 v[180:183], v[108:111], v[80:83], v[180:183]
  v_mfma_f32_16x16x32_bf16 v[184:187], v[108:111], v[84:87], v[184:187]
  v_mfma_f32_16x16x32_bf16 v[188:191], v[108:111], v[88:91], v[188:191]
  v_mfma_f32_16x16x32_bf16 v[192:195], v[76:79], v[112:115], v[192:195]
  v_mfma_f32_16x16x32_bf16 v[196:199], v[80:83], v[112:115], v[196:199]
  v_mfma_f32_16x16x32_bf16 v[200:203], v[84:87], v[112:115], v[200:203]
  v_mfma_f32_16x16x32_bf16 v[204:207], v[88:91], v[112:115], v[204:207]
  v_mfma_f32_16x16x32_bf16 v[232:235], v[92:95], v[112:115], v[232:235]
  v_mfma_f32_16x16x32_bf16 v[208:211], v[76:79], v[116:119], v[208:211]
  v_mfma_f32_16x16x32_bf16 v[212:215], v[80:83], v[116:119], v[212:215]
  v_mfma_f32_16x16x32_bf16 v[216:219], v[84:87], v[116:119], v[216:219]
  v_mfma_f32_16x16x32_bf16 v[220:223], v[88:91], v[116:119], v[220:223]
  s_waitcnt lgkmcnt(0)
  s_cbranch_scc1 L_attn_loopa
  s_branch L_attn_post
.p2align 3
L_attn_loopb:
  v_mfma_f32_16x16x32_bf16 v[240:243], v[236:239], v[40:43], v[240:243]
  ds_read_b128 v[76:79], v11 offset:0
  v_mfma_f32_16x16x32_bf16 v[244:247], v[40:43], v[40:43], v[244:247]
  ds_read_b128 v[80:83], v11 offset:2048
  v_mfma_f32_16x16x32_bf16 v[248:251], v[236:239], v[44:47], v[248:251]
  ds_read_b128 v[84:87], v11 offset:4096
  v_mfma_f32_16x16x32_bf16 v[252:255], v[44:47], v[44:47], v[252:255]
  ds_read_b128 v[88:91], v11 offset:6144
  v_mfma_f32_16x16x32_bf16 v[128:131], v[52:55], v[32:35], v[128:131]
  ds_read_b128 v[92:95], v15
  v_mfma_f32_16x16x32_bf16 v[132:135], v[52:55], v[36:39], v[132:135]
  ds_read_b64_tr_b16 v[96:97], v12 offset:4096
  v_mfma_f32_16x16x32_bf16 v[136:139], v[52:55], v[40:43], v[136:139]
  ds_read_b64_tr_b16 v[98:99], v12 offset:4608
  v_mfma_f32_16x16x32_bf16 v[140:143], v[52:55], v[44:47], v[140:143]
  ds_read_b64_tr_b16 v[100:101], v13 offset:4096
  v_mfma_f32_16x16x32_bf16 v[224:227], v[52:55], v[48:51], v[224:227]
  ds_read_b64_tr_b16 v[102:103], v13 offset:4608
  v_mfma_f32_16x16x32_bf16 v[144:147], v[56:59], v[32:35], v[144:147]
  ds_read_b64_tr_b16 v[104:105], v12 offset:12288
  v_mfma_f32_16x16x32_bf16 v[148:151], v[56:59], v[36:39], v[148:151]
  ds_read_b64_tr_b16 v[106:107], v12 offset:12800
  v_mfma_f32_16x16x32_bf16 v[152:155], v[56:59], v[40:43], v[152:155]
  ds_read_b64_tr_b16 v[108:109], v13 offset:12288
  v_mfma_f32_16x16x32_bf16 v[156:159], v[56:59], v[44:47], v[156:159]
  ds_read_b64_tr_b16 v[110:111], v13 offset:12800
  v_mfma_f32_16x16x32_bf16 v[160:163], v[60:63], v[32:35], v[160:163]
  ds_read_b64_tr_b16 v[112:113], v12 offset:20480
  v_mfma_f32_16x16x32_bf16 v[164:167], v[60:63], v[36:39], v[164:167]
  ds_read_b64_tr_b16 v[114:115], v12 offset:20992
  v_mfma_f32_16x16x32_bf16 v[168:171], v[60:63], v[40:43], v[168:171]
  ds_read_b64_tr_b16 v[116:117], v13 offset:20480
  v_mfma_f32_16x16x32_bf16 v[172:175], v[60:63], v[44:47], v[172:175]
  ds_read_b64_tr_b16 v[118:119], v13 offset:20992
  v_mfma_f32_16x16x32_bf16 v[228:231], v[60:63], v[48:51], v[228:231]
  v_add_u32_e64 v10, s75, v4
  v_mfma_f32_16x16x32_bf16 v[176:179], v[64:67], v[32:35], v[176:179]
  v_add_u32_e64 v11, s75, v5
  v_mfma_f32_16x16x32_bf16 v[180:183], v[64:67], v[36:39], v[180:183]
  v_add_u32_e64 v12, s75, v6
  v_mfma_f32_16x16x32_bf16 v[184:187], v[64:67], v[40:43], v[184:187]
  v_add_u32_e64 v13, s75, v7
  v_mfma_f32_16x16x32_bf16 v[188:191], v[64:67], v[44:47], v[188:191]
  v_add_u32_e64 v14, s75, v8
  v_mfma_f32_16x16x32_bf16 v[192:195], v[32:35], v[68:71], v[192:195]
  v_add_u32_e64 v15, s75, v9
  v_mfma_f32_16x16x32_bf16 v[196:199], v[36:39], v[68:71], v[196:199]
  s_add_u32 s75, s75, 43008
  v_mfma_f32_16x16x32_bf16 v[200:203], v[40:43], v[68:71], v[200:203]
  s_cmp_eq_u32 s75, 129024
  v_mfma_f32_16x16x32_bf16 v[204:207], v[44:47], v[68:71], v[204:207]
  s_cselect_b32 s75, 0, s75
  s_sub_u32 s79, s79, 1
  v_mfma_f32_16x16x32_bf16 v[232:235], v[48:51], v[68:71], v[232:235]
  v_mfma_f32_16x16x32_bf16 v[208:211], v[32:35], v[72:75], v[208:211]
  v_mfma_f32_16x16x32_bf16 v[212:215], v[36:39], v[72:75], v[212:215]
  v_mfma_f32_16x16x32_bf16 v[216:219], v[40:43], v[72:75], v[216:219]
  v_mfma_f32_16x16x32_bf16 v[220:223], v[44:47], v[72:75], v[220:223]
  s_waitcnt lgkmcnt(0)
  s_barrier
  v_mfma_f32_16x16x32_bf16 v[240:243], v[236:239], v[84:87], v[240:243]
  ds_read_b128 v[32:35], v10 offset:0
  v_mfma_f32_16x16x32_bf16 v[244:247], v[84:87], v[84:87], v[244:247]
  ds_read_b128 v[36:39], v10 offset:2048
  v_mfma_f32_16x16x32_bf16 v[248:251], v[236:239], v[88:91], v[248:251]
  ds_read_b128 v[40:43], v10 offset:4096
  v_mfma_f32_16x16x32_bf16 v[252:255], v[88:91], v[88:91], v[252:255]
  ds_read_b128 v[44:47], v10 offset:6144
  v_mfma_f32_16x16x32_bf16 v[128:131], v[96:99], v[76:79], v[128:131]
  ds_read_b128 v[48:51], v14
  v_mfma_f32_16x16x32_bf16 v[132:135], v[96:99], v[80:83], v[132:135]
  ds_read_b64_tr_b16 v[52:53], v12 offset:0
  v_mfma_f32_16x16x32_bf16 v[136:139], v[96:99], v[84:87], v[136:139]
  ds_read_b64_tr_b16 v[54:55], v12 offset:512
  v_mfma_f32_16x16x32_bf16 v[140:143], v[96:99], v[88:91], v[140:143]
  ds_read_b64_tr_b16 v[56:57], v13 offset:0
  v_mfma_f32_16x16x32_bf16 v[224:227], v[96:99], v[92:95], v[224:227]
  ds_read_b64_tr_b16 v[58:59], v13 offset:512
  v_mfma_f32_16x16x32_bf16 v[144:147], v[100:103], v[76:79], v[144:147]
  ds_read_b64_tr_b16 v[60:61], v12 offset:8192
  v_mfma_f32_16x16x32_bf16 v[148:151], v[100:103], v[80:83], v[148:151]
  ds_read_b64_tr_b16 v[62:63], v12 offset:8704
  v_mfma_f32_16x16x32_bf16 v[152:155], v[100:103], v[84:87], v[152:155]
  ds_read_b64_tr_b16 v[64:65], v13 offset:8192
  v_mfma_f32_16x16x32_bf16 v[156:159], v[100:103], v[88:91], v[156:159]
  ds_read_b64_tr_b16 v[66:67], v13 offset:8704
  v_mfma_f32_16x16x32_bf16 v[160:163], v[104:107], v[76:79], v[160:163]
  ds_read_b64_tr_b16 v[68:69], v12 offset:16384
  v_mfma_f32_16x16x32_bf16 v[164:167], v[104:107], v[80:83], v[164:167]
  ds_read_b64_tr_b16 v[70:71], v12 offset:16896
  v_mfma_f32_16x16x32_bf16 v[168:171], v[104:107], v[84:87], v[168:171]
  ds_read_b64_tr_b16 v[72:73], v13 offset:16384
  v_mfma_f32_16x16x32_bf16 v[172:175], v[104:107], v[88:91], v[172:175]
  ds_read_b64_tr_b16 v[74:75], v13 offset:16896
  v_mfma_f32_16x16x32_bf16 v[228:231], v[104:107], v[92:95], v[228:231]
  s_cmp_lg_u32 s79, 0
  s_nop 0
  v_mfma_f32_16x16x32_bf16 v[176:179], v[108:111], v[76:79], v[176:179]
  v_mfma_f32_16x16x32_bf16 v[180:183], v[108:111], v[80:83], v[180:183]
  v_mfma_f32_16x16x32_bf16 v[184:187], v[108:111], v[84:87], v[184:187]
  v_mfma_f32_16x16x32_bf16 v[188:191], v[108:111], v[88:91], v[188:191]
  v_mfma_f32_16x16x32_bf16 v[192:195], v[76:79], v[112:115], v[192:195]
  v_mfma_f32_16x16x32_bf16 v[196:199], v[80:83], v[112:115], v[196:199]
  v_mfma_f32_16x16x32_bf16 v[200:203], v[84:87], v[112:115], v[200:203]
  v_mfma_f32_16x16x32_bf16 v[204:207], v[88:91], v[112:115], v[204:207]
  v_mfma_f32_16x16x32_bf16 v[232:235], v[92:95], v[112:115], v[232:235]
  v_mfma_f32_16x16x32_bf16 v[208:211], v[76:79], v[116:119], v[208:211]
  v_mfma_f32_16x16x32_bf16 v[212:215], v[80:83], v[116:119], v[212:215]
  v_mfma_f32_16x16x32_bf16 v[216:219], v[84:87], v[116:119], v[216:219]
  v_mfma_f32_16x16x32_bf16 v[220:223], v[88:91], v[116:119], v[220:223]
  s_waitcnt lgkmcnt(0)
  s_cbranch_scc1 L_attn_loopb
L_attn_post:
  v_and_b32 v32, 3, v1
  v_cmp_eq_u32 s[4:5], 1, v32
  v_cmp_eq_u32 s[6:7], 2, v32
  v_cmp_eq_u32 s[8:9], 3, v32
  v_bfe_u32 v33, v1, 2, 2
  v_lshrrev_b32 v34, 4, v1
  v_cmp_eq_u32 s[10:11], v33, v34
  s_lshl_b32 s3, s72, 7
  v_add_u32 v35, s3, v23
  v_and_b32 v36, 15, v1
  s_cmp_eq_u32 s70, 0
  s_cselect_b32 s3, 0, 576
  s_add_u32 s3, s3, 129024
  v_lshl_add_u32 v36, v36, 2, s3
  v_cndmask_b32 v241, v244, v245, s[4:5]
  v_cndmask_b32 v249, v252, v253, s[4:5]
  v_cndmask_b32 v121, v124, v125, s[4:5]
  v_cndmask_b32 v241, v241, v246, s[6:7]
  v_cndmask_b32 v249, v249, v254, s[6:7]
  v_cndmask_b32 v121, v121, v126, s[6:7]
  v_cndmask_b32 v241, v241, v247, s[8:9]
  v_cndmask_b32 v249, v249, v255, s[8:9]
  v_cndmask_b32 v121, v121, v127, s[8:9]
  v_mul_f32 v240, 0x3a800000, v240
  v_mul_f32 v241, 0x3a800000, v241
  v_fma_f32 v241, -v240, v240, v241
  v_max_f32 v241, 0, v241
  v_add_f32 v241, 0x3727c5ac, v241
  v_rsq_f32 v241, v241
  s_nop 0
  v_mul_f32 v248, 0x3a800000, v248
  v_mul_f32 v249, 0x3a800000, v249
  v_fma_f32 v249, -v248, v248, v249
  v_max_f32 v249, 0, v249
  v_add_f32 v249, 0x3727c5ac, v249
  v_rsq_f32 v249, v249
  s_nop 0
  v_mul_f32 v120, 0x3a800000, v120
  v_mul_f32 v121, 0x3a800000, v121
  v_fma_f32 v121, -v120, v120, v121
  v_max_f32 v121, 0, v121
  v_add_f32 v121, 0x3727c5ac, v121
  v_rsq_f32 v121, v121
  s_nop 0
  s_mov_b64 exec, s[10:11]
  ds_write2_b32 v35, v240, v241 offset0:16 offset1:176
  ds_write2_b32 v35, v248, v249 offset0:32 offset1:192
  ds_write2_b32 v36, v120, v121 offset0:0 offset1:160
  s_mov_b64 exec, -1
  s_waitcnt lgkmcnt(0)
  s_barrier
  s_branch L_attn_exit
.p2align 3
L_attn_loop:
  v_mfma_f32_16x16x32_bf16 v[128:131], v[52:55], v[32:35], v[128:131]
  ds_read_b128 v[76:79], v11 offset:0
  v_mfma_f32_16x16x32_bf16 v[132:135], v[52:55], v[36:39], v[132:135]
  ds_read_b128 v[80:83], v11 offset:2048
  v_mfma_f32_16x16x32_bf16 v[136:139], v[52:55], v[40:43], v[136:139]
  ds_read_b128 v[84:87], v11 offset:4096
  v_mfma_f32_16x16x32_bf16 v[140:143], v[52:55], v[44:47], v[140:143]
  ds_read_b128 v[88:91], v11 offset:6144
  v_mfma_f32_16x16x32_bf16 v[224:227], v[52:55], v[48:51], v[224:227]
  ds_read_b128 v[92:95], v15
  v_mfma_f32_16x16x32_bf16 v[144:147], v[56:59], v[32:35], v[144:147]
  ds_read_b64_tr_b16 v[96:97], v12 offset:4096
  v_mfma_f32_16x16x32_bf16 v[148:151], v[56:59], v[36:39], v[148:151]
  ds_read_b64_tr_b16 v[98:99], v12 offset:4608
  v_mfma_f32_16x16x32_bf16 v[152:155], v[56:59], v[40:43], v[152:155]
  ds_read_b64_tr_b16 v[100:101], v13 offset:4096
  v_mfma_f32_16x16x32_bf16 v[156:159], v[56:59], v[44:47], v[156:159]
  ds_read_b64_tr_b16 v[102:103], v13 offset:4608
  v_mfma_f32_16x16x32_bf16 v[160:163], v[60:63], v[32:35], v[160:163]
  ds_read_b64_tr_b16 v[104:105], v12 offset:12288
  v_mfma_f32_16x16x32_bf16 v[164:167], v[60:63], v[36:39], v[164:167]
  ds_read_b64_tr_b16 v[106:107], v12 offset:12800
  v_mfma_f32_16x16x32_bf16 v[168:171], v[60:63], v[40:43], v[168:171]
  ds_read_b64_tr_b16 v[108:109], v13 offset:12288
  v_mfma_f32_16x16x32_bf16 v[172:175], v[60:63], v[44:47], v[172:175]
  ds_read_b64_tr_b16 v[110:111], v13 offset:12800
  v_mfma_f32_16x16x32_bf16 v[228:231], v[60:63], v[48:51], v[228:231]
  ds_read_b64_tr_b16 v[112:113], v12 offset:20480
  v_mfma_f32_16x16x32_bf16 v[176:179], v[64:67], v[32:35], v[176:179]
  ds_read_b64_tr_b16 v[114:115], v12 offset:20992
  v_mfma_f32_16x16x32_bf16 v[180:183], v[64:67], v[36:39], v[180:183]
  ds_read_b64_tr_b16 v[116:117], v13 offset:20480
  v_mfma_f32_16x16x32_bf16 v[184:187], v[64:67], v[40:43], v[184:187]
  ds_read_b64_tr_b16 v[118:119], v13 offset:20992
  v_mfma_f32_16x16x32_bf16 v[188:191], v[64:67], v[44:47], v[188:191]
  v_add_u32_e64 v10, s75, v4
  v_mfma_f32_16x16x32_bf16 v[192:195], v[32:35], v[68:71], v[192:195]
  v_add_u32_e64 v11, s75, v5
  v_mfma_f32_16x16x32_bf16 v[196:199], v[36:39], v[68:71], v[196:199]
  v_add_u32_e64 v12, s75, v6
  v_mfma_f32_16x16x32_bf16 v[200:203], v[40:43], v[68:71], v[200:203]
  v_add_u32_e64 v13, s75, v7
  v_mfma_f32_16x16x32_bf16 v[204:207], v[44:47], v[68:71], v[204:207]
  v_add_u32_e64 v14, s75, v8
  v_mfma_f32_16x16x32_bf16 v[232:235], v[48:51], v[68:71], v[232:235]
  v_add_u32_e64 v15, s75, v9
  v_mfma_f32_16x16x32_bf16 v[208:211], v[32:35], v[72:75], v[208:211]
  s_add_u32 s75, s75, 43008
  v_mfma_f32_16x16x32_bf16 v[212:215], v[36:39], v[72:75], v[212:215]
  s_cmp_eq_u32 s75, 129024
  v_mfma_f32_16x16x32_bf16 v[216:219], v[40:43], v[72:75], v[216:219]
  s_cselect_b32 s75, 0, s75
  s_sub_u32 s79, s79, 1
  v_mfma_f32_16x16x32_bf16 v[220:223], v[44:47], v[72:75], v[220:223]
  s_waitcnt lgkmcnt(0)
  s_barrier
  v_mfma_f32_16x16x32_bf16 v[128:131], v[96:99], v[76:79], v[128:131]
  ds_read_b128 v[32:35], v10 offset:0
  v_mfma_f32_16x16x32_bf16 v[132:135], v[96:99], v[80:83], v[132:135]
  ds_read_b128 v[36:39], v10 offset:2048
  v_mfma_f32_16x16x32_bf16 v[136:139], v[96:99], v[84:87], v[136:139]
  ds_read_b128 v[40:43], v10 offset:4096
  v_mfma_f32_16x16x32_bf16 v[140:143], v[96:99], v[88:91], v[140:143]
  ds_read_b128 v[44:47], v10 offset:6144
  v_mfma_f32_16x16x32_bf16 v[224:227], v[96:99], v[92:95], v[224:227]
  ds_read_b128 v[48:51], v14
  v_mfma_f32_16x16x32_bf16 v[144:147], v[100:103], v[76:79], v[144:147]
  ds_read_b64_tr_b16 v[52:53], v12 offset:0
  v_mfma_f32_16x16x32_bf16 v[148:151], v[100:103], v[80:83], v[148:151]
  ds_read_b64_tr_b16 v[54:55], v12 offset:512
  v_mfma_f32_16x16x32_bf16 v[152:155], v[100:103], v[84:87], v[152:155]
  ds_read_b64_tr_b16 v[56:57], v13 offset:0
  v_mfma_f32_16x16x32_bf16 v[156:159], v[100:103], v[88:91], v[156:159]
  ds_read_b64_tr_b16 v[58:59], v13 offset:512
  v_mfma_f32_16x16x32_bf16 v[160:163], v[104:107], v[76:79], v[160:163]
  ds_read_b64_tr_b16 v[60:61], v12 offset:8192
  v_mfma_f32_16x16x32_bf16 v[164:167], v[104:107], v[80:83], v[164:167]
  ds_read_b64_tr_b16 v[62:63], v12 offset:8704
  v_mfma_f32_16x16x32_bf16 v[168:171], v[104:107], v[84:87], v[168:171]
  ds_read_b64_tr_b16 v[64:65], v13 offset:8192
  v_mfma_f32_16x16x32_bf16 v[172:175], v[104:107], v[88:91], v[172:175]
  ds_read_b64_tr_b16 v[66:67], v13 offset:8704
  v_mfma_f32_16x16x32_bf16 v[228:231], v[104:107], v[92:95], v[228:231]
  ds_read_b64_tr_b16 v[68:69], v12 offset:16384
  v_mfma_f32_16x16x32_bf16 v[176:179], v[108:111], v[76:79], v[176:179]
  ds_read_b64_tr_b16 v[70:71], v12 offset:16896
  v_mfma_f32_16x16x32_bf16 v[180:183], v[108:111], v[80:83], v[180:183]
  ds_read_b64_tr_b16 v[72:73], v13 offset:16384
  v_mfma_f32_16x16x32_bf16 v[184:187], v[108:111], v[84:87], v[184:187]
  ds_read_b64_tr_b16 v[74:75], v13 offset:16896
  v_mfma_f32_16x16x32_bf16 v[188:191], v[108:111], v[88:91], v[188:191]
  s_cmp_lg_u32 s79, 0
  s_nop 0
  v_mfma_f32_16x16x32_bf16 v[192:195], v[76:79], v[112:115], v[192:195]
  v_mfma_f32_16x16x32_bf16 v[196:199], v[80:83], v[112:115], v[196:199]
  v_mfma_f32_16x16x32_bf16 v[200:203], v[84:87], v[112:115], v[200:203]
  v_mfma_f32_16x16x32_bf16 v[204:207], v[88:91], v[112:115], v[204:207]
  v_mfma_f32_16x16x32_bf16 v[232:235], v[92:95], v[112:115], v[232:235]
  v_mfma_f32_16x16x32_bf16 v[208:211], v[76:79], v[116:119], v[208:211]
  v_mfma_f32_16x16x32_bf16 v[212:215], v[80:83], v[116:119], v[212:215]
  v_mfma_f32_16x16x32_bf16 v[216:219], v[84:87], v[116:119], v[216:219]
  v_mfma_f32_16x16x32_bf16 v[220:223], v[88:91], v[116:119], v[220:223]
  s_waitcnt lgkmcnt(0)
  s_cbranch_scc1 L_attn_loop
L_attn_exit:
  ds_read2_b32 v[66:67], v23 offset0:0 offset1:160
  ds_read2_b32 v[68:69], v23 offset0:16 offset1:176
  ds_read2_b32 v[70:71], v23 offset0:32 offset1:192
  ds_read2_b32 v[72:73], v23 offset0:48 offset1:208
  ds_read2_b32 v[74:75], v23 offset0:64 offset1:224
  ds_read2_b32 v[76:77], v25 offset0:0 offset1:16
  ds_read2_b32 v[80:81], v26 offset0:0 offset1:16
  ds_read2_b32 v[78:79], v25 offset0:32 offset1:48
  ds_read2_b32 v[82:83], v26 offset0:32 offset1:48
  ds_write_b128 v16, v[224:227] offset:0
  ds_write_b128 v16, v[228:231] offset:2048
  ds_write_b128 v16, v[232:235] offset:4096
  s_cmp_eq_u32 s71, 1
  s_cbranch_scc1 L_attn_nop3
  ds_write_b128 v16, v[172:175] offset:8192
  ds_write_b128 v16, v[188:191] offset:9216
  ds_write_b128 v16, v[204:207] offset:10240
  ds_write_b128 v16, v[220:223] offset:11264
L_attn_nop3:
  ds_read_b128 v[84:87], v24 offset:0
  ds_read_b128 v[104:107], v24 offset:640
  ds_read_b128 v[88:91], v24 offset:64
  ds_read_b128 v[108:111], v24 offset:704
  ds_read_b128 v[92:95], v24 offset:128
  ds_read_b128 v[112:115], v24 offset:768
  ds_read_b128 v[96:99], v24 offset:192
  ds_read_b128 v[116:119], v24 offset:832
  ds_read_b128 v[100:103], v24 offset:256
  ds_read_b128 v[120:123], v24 offset:896
  s_waitcnt lgkmcnt(10)
  s_barrier
  ds_read_b128 v[48:51], v19 offset:0
  ds_read_b128 v[52:55], v20 offset:1024
  ds_read_b128 v[56:59], v19 offset:2048
  ds_read_b128 v[60:63], v20 offset:3072
  ds_read_b32 v64, v21 offset:4096
  ds_read_b32 v65, v22 offset:5120
  ds_read_b128 v[32:35], v17 offset:2048
  ds_read_b128 v[36:39], v18 offset:3072
  ds_read_b128 v[40:43], v17 offset:4096
  ds_read_b128 v[44:47], v18 offset:5120
  v_mul_f32 v69, 0x3e8293ee, v69
  v_mul_f32 v71, 0x3e8293ee, v71
  v_mul_f32 v73, 0x3e8293ee, v73
  v_mul_f32 v75, 0x3e8293ee, v75
  v_mul_f32 v76, v76, v69
  v_mul_f32 v80, v80, v69
  v_mul_f32 v77, v77, v71
  v_mul_f32 v81, v81, v71
  v_mul_f32 v78, v78, v73
  v_mul_f32 v82, v82, v73
  v_mul_f32 v79, v79, v75
  v_mul_f32 v83, v83, v75
  s_waitcnt lgkmcnt(6)
  v_pk_fma_f32 v[128:129], v[48:49], v[68:69], v[128:129] op_sel:[0,0,0] op_sel_hi:[1,0,1] neg_lo:[0,1,0] neg_hi:[0,1,0]
  v_pk_fma_f32 v[130:131], v[50:51], v[68:69], v[130:131] op_sel:[0,0,0] op_sel_hi:[1,0,1] neg_lo:[0,1,0] neg_hi:[0,1,0]
  v_pk_fma_f32 v[144:145], v[52:53], v[68:69], v[144:145] op_sel:[0,0,0] op_sel_hi:[1,0,1] neg_lo:[0,1,0] neg_hi:[0,1,0]
  v_pk_fma_f32 v[146:147], v[54:55], v[68:69], v[146:147] op_sel:[0,0,0] op_sel_hi:[1,0,1] neg_lo:[0,1,0] neg_hi:[0,1,0]
  v_cvt_pk_bf16_f32 v128, v128, v129
  v_cvt_pk_bf16_f32 v129, v130, v131
  v_cvt_pk_bf16_f32 v130, v144, v145
  v_cvt_pk_bf16_f32 v131, v146, v147
  v_pk_fma_f32 v[160:161], v[56:57], v[68:69], v[160:161] op_sel:[0,0,0] op_sel_hi:[1,0,1] neg_lo:[0,1,0] neg_hi:[0,1,0]
  v_pk_fma_f32 v[162:163], v[58:59], v[68:69], v[162:163] op_sel:[0,0,0] op_sel_hi:[1,0,1] neg_lo:[0,1,0] neg_hi:[0,1,0]
  v_pk_fma_f32 v[176:177], v[60:61], v[68:69], v[176:177] op_sel:[0,0,0] op_sel_hi:[1,0,1] neg_lo:[0,1,0] neg_hi:[0,1,0]
  v_pk_fma_f32 v[178:179], v[62:63], v[68:69], v[178:179] op_sel:[0,0,0] op_sel_hi:[1,0,1] neg_lo:[0,1,0] neg_hi:[0,1,0]
  v_cvt_pk_bf16_f32 v160, v160, v161
  v_cvt_pk_bf16_f32 v161, v162, v163
  v_cvt_pk_bf16_f32 v162, v176, v177
  v_cvt_pk_bf16_f32 v163, v178, v179
  v_pk_fma_f32 v[132:133], v[48:49], v[70:71], v[132:133] op_sel:[0,0,0] op_sel_hi:[1,0,1] neg_lo:[0,1,0] neg_hi:[0,1,0]
  v_pk_fma_f32 v[134:135], v[50:51], v[70:71], v[134:135] op_sel:[0,0,0] op_sel_hi:[1,0,1] neg_lo:[0,1,0] neg_hi:[0,1,0]
  v_pk_fma_f32 v[148:149], v[52:53], v[70:71], v[148:149] op_sel:[0,0,0] op_sel_hi:[1,0,1] neg_lo:[0,1,0] neg_hi:[0,1,0]
  v_pk_fma_f32 v[150:151], v[54:55], v[70:71], v[150:151] op_sel:[0,0,0] op_sel_hi:[1,0,1] neg_lo:[0,1,0] neg_hi:[0,1,0]
  v_cvt_pk_bf16_f32 v132, v132, v133
  v_cvt_pk_bf16_f32 v133, v134, v135
  v_cvt_pk_bf16_f32 v134, v148, v149
  v_cvt_pk_bf16_f32 v135, v150, v151
  v_pk_fma_f32 v[164:165], v[56:57], v[70:71], v[164:165] op_sel:[0,0,0] op_sel_hi:[1,0,1] neg_lo:[0,1,0] neg_hi:[0,1,0]
  v_pk_fma_f32 v[166:167], v[58:59], v[70:71], v[166:167] op_sel:[0,0,0] op_sel_hi:[1,0,1] neg_lo:[0,1,0] neg_hi:[0,1,0]
  v_pk_fma_f32 v[180:181], v[60:61], v[70:71], v[180:181] op_sel:[0,0,0] op_sel_hi:[1,0,1] neg_lo:[0,1,0] neg_hi:[0,1,0]
  v_pk_fma_f32 v[182:183], v[62:63], v[70:71], v[182:183] op_sel:[0,0,0] op_sel_hi:[1,0,1] neg_lo:[0,1,0] neg_hi:[0,1,0]
  v_cvt_pk_bf16_f32 v164, v164, v165
  v_cvt_pk_bf16_f32 v165, v166, v167
  v_cvt_pk_bf16_f32 v166, v180, v181
  v_cvt_pk_bf16_f32 v167, v182, v183
  v_mfma_f32_16x16x32_bf16 v[144:147], v[160:163], v[128:131], 0
  v_pk_fma_f32 v[136:137], v[48:49], v[72:73], v[136:137] op_sel:[0,0,0] op_sel_hi:[1,0,1] neg_lo:[0,1,0] neg_hi:[0,1,0]
  v_pk_fma_f32 v[138:139], v[50:51], v[72:73], v[138:139] op_sel:[0,0,0] op_sel_hi:[1,0,1] neg_lo:[0,1,0] neg_hi:[0,1,0]
  v_pk_fma_f32 v[152:153], v[52:53], v[72:73], v[152:153] op_sel:[0,0,0] op_sel_hi:[1,0,1] neg_lo:[0,1,0] neg_hi:[0,1,0]
  v_pk_fma_f32 v[154:155], v[54:55], v[72:73], v[154:155] op_sel:[0,0,0] op_sel_hi:[1,0,1] neg_lo:[0,1,0] neg_hi:[0,1,0]
  v_cvt_pk_bf16_f32 v136, v136, v137
  v_cvt_pk_bf16_f32 v137, v138, v139
  v_cvt_pk_bf16_f32 v138, v152, v153
  v_cvt_pk_bf16_f32 v139, v154, v155
  v_pk_fma_f32 v[168:169], v[56:57], v[72:73], v[168:169] op_sel:[0,0,0] op_sel_hi:[1,0,1] neg_lo:[0,1,0] neg_hi:[0,1,0]
  v_pk_fma_f32 v[170:171], v[58:59], v[72:73], v[170:171] op_sel:[0,0,0] op_sel_hi:[1,0,1] neg_lo:[0,1,0] neg_hi:[0,1,0]
  v_pk_fma_f32 v[184:185], v[60:61], v[72:73], v[184:185] op_sel:[0,0,0] op_sel_hi:[1,0,1] neg_lo:[0,1,0] neg_hi:[0,1,0]
  v_pk_fma_f32 v[186:187], v[62:63], v[72:73], v[186:187] op_sel:[0,0,0] op_sel_hi:[1,0,1] neg_lo:[0,1,0] neg_hi:[0,1,0]
  v_cvt_pk_bf16_f32 v168, v168, v169
  v_cvt_pk_bf16_f32 v169, v170, v171
  v_cvt_pk_bf16_f32 v170, v184, v185
  v_cvt_pk_bf16_f32 v171, v186, v187
  v_mfma_f32_16x16x32_bf16 v[148:151], v[164:167], v[132:135], 0
  v_mfma_f32_16x16x32_bf16 v[180:183], v[160:163], v[132:135], 0
  v_pk_fma_f32 v[140:141], v[48:49], v[74:75], v[140:141] op_sel:[0,0,0] op_sel_hi:[1,0,1] neg_lo:[0,1,0] neg_hi:[0,1,0]
  v_pk_fma_f32 v[142:143], v[50:51], v[74:75], v[142:143] op_sel:[0,0,0] op_sel_hi:[1,0,1] neg_lo:[0,1,0] neg_hi:[0,1,0]
  v_pk_fma_f32 v[156:157], v[52:53], v[74:75], v[156:157] op_sel:[0,0,0] op_sel_hi:[1,0,1] neg_lo:[0,1,0] neg_hi:[0,1,0]
  v_pk_fma_f32 v[158:159], v[54:55], v[74:75], v[158:159] op_sel:[0,0,0] op_sel_hi:[1,0,1] neg_lo:[0,1,0] neg_hi:[0,1,0]
  v_cvt_pk_bf16_f32 v140, v140, v141
  v_cvt_pk_bf16_f32 v141, v142, v143
  v_cvt_pk_bf16_f32 v142, v156, v157
  v_cvt_pk_bf16_f32 v143, v158, v159
  v_pk_fma_f32 v[172:173], v[56:57], v[74:75], v[172:173] op_sel:[0,0,0] op_sel_hi:[1,0,1] neg_lo:[0,1,0] neg_hi:[0,1,0]
  v_pk_fma_f32 v[174:175], v[58:59], v[74:75], v[174:175] op_sel:[0,0,0] op_sel_hi:[1,0,1] neg_lo:[0,1,0] neg_hi:[0,1,0]
  v_pk_fma_f32 v[188:189], v[60:61], v[74:75], v[188:189] op_sel:[0,0,0] op_sel_hi:[1,0,1] neg_lo:[0,1,0] neg_hi:[0,1,0]
  v_pk_fma_f32 v[190:191], v[62:63], v[74:75], v[190:191] op_sel:[0,0,0] op_sel_hi:[1,0,1] neg_lo:[0,1,0] neg_hi:[0,1,0]
  v_cvt_pk_bf16_f32 v172, v172, v173
  v_cvt_pk_bf16_f32 v173, v174, v175
  v_cvt_pk_bf16_f32 v174, v188, v189
  v_cvt_pk_bf16_f32 v175, v190, v191
  s_waitcnt lgkmcnt(0)
  v_pk_fma_f32 v[32:33], v[56:57], v[66:67], v[32:33] op_sel:[0,0,0] op_sel_hi:[1,0,1] neg_lo:[0,1,0] neg_hi:[0,1,0]
  v_pk_fma_f32 v[34:35], v[58:59], v[66:67], v[34:35] op_sel:[0,0,0] op_sel_hi:[1,0,1] neg_lo:[0,1,0] neg_hi:[0,1,0]
  v_pk_fma_f32 v[36:37], v[60:61], v[66:67], v[36:37] op_sel:[0,0,0] op_sel_hi:[1,0,1] neg_lo:[0,1,0] neg_hi:[0,1,0]
  v_pk_fma_f32 v[38:39], v[62:63], v[66:67], v[38:39] op_sel:[0,0,0] op_sel_hi:[1,0,1] neg_lo:[0,1,0] neg_hi:[0,1,0]
  v_cvt_pk_bf16_f32 v32, v32, v33
  v_cvt_pk_bf16_f32 v33, v34, v35
  v_cvt_pk_bf16_f32 v34, v36, v37
  v_cvt_pk_bf16_f32 v35, v38, v39
  v_mfma_f32_16x16x32_bf16 v[152:155], v[168:171], v[136:139], 0
  v_mfma_f32_16x16x32_bf16 v[184:187], v[164:167], v[136:139], 0
  v_mfma_f32_16x16x32_bf16 v[156:159], v[172:175], v[140:143], 0
  v_mfma_f32_16x16x32_bf16 v[188:191], v[168:171], v[140:143], 0
  v_mfma_f32_16x16x32_bf16 v[176:179], v[32:35], v[128:131], 0
  v_pk_fma_f32 v[40:41], v[84:85], v[64:65], v[40:41] op_sel:[0,0,0] op_sel_hi:[1,0,1] neg_lo:[1,0,0] neg_hi:[1,0,0]
  v_pk_fma_f32 v[42:43], v[86:87], v[64:65], v[42:43] op_sel:[0,0,0] op_sel_hi:[1,0,1] neg_lo:[1,0,0] neg_hi:[1,0,0]
  v_pk_mul_f32 v[40:41], v[40:41], v[104:105]
  v_pk_mul_f32 v[42:43], v[42:43], v[106:107]
  v_cvt_pk_bf16_f32 v240, v40, v41
  v_cvt_pk_bf16_f32 v241, v42, v43
  v_pk_fma_f32 v[192:193], v[88:89], v[64:65], v[192:193] op_sel:[0,0,0] op_sel_hi:[1,0,1] neg_lo:[1,0,0] neg_hi:[1,0,0]
  v_pk_fma_f32 v[194:195], v[90:91], v[64:65], v[194:195] op_sel:[0,0,0] op_sel_hi:[1,0,1] neg_lo:[1,0,0] neg_hi:[1,0,0]
  v_pk_mul_f32 v[192:193], v[192:193], v[108:109]
  v_pk_mul_f32 v[194:195], v[194:195], v[110:111]
  v_cvt_pk_bf16_f32 v242, v192, v193
  v_cvt_pk_bf16_f32 v243, v194, v195
  v_pk_fma_f32 v[196:197], v[92:93], v[64:65], v[196:197] op_sel:[0,0,0] op_sel_hi:[1,0,1] neg_lo:[1,0,0] neg_hi:[1,0,0]
  v_pk_fma_f32 v[198:199], v[94:95], v[64:65], v[198:199] op_sel:[0,0,0] op_sel_hi:[1,0,1] neg_lo:[1,0,0] neg_hi:[1,0,0]
  v_pk_mul_f32 v[196:197], v[196:197], v[112:113]
  v_pk_mul_f32 v[198:199], v[198:199], v[114:115]
  v_cvt_pk_bf16_f32 v244, v196, v197
  v_cvt_pk_bf16_f32 v245, v198, v199
  v_pk_fma_f32 v[200:201], v[96:97], v[64:65], v[200:201] op_sel:[0,0,0] op_sel_hi:[1,0,1] neg_lo:[1,0,0] neg_hi:[1,0,0]
  v_pk_fma_f32 v[202:203], v[98:99], v[64:65], v[202:203] op_sel:[0,0,0] op_sel_hi:[1,0,1] neg_lo:[1,0,0] neg_hi:[1,0,0]
  v_pk_mul_f32 v[200:201], v[200:201], v[116:117]
  v_pk_mul_f32 v[202:203], v[202:203], v[118:119]
  v_cvt_pk_bf16_f32 v246, v200, v201
  v_cvt_pk_bf16_f32 v247, v202, v203
  v_pk_fma_f32 v[204:205], v[100:101], v[64:65], v[204:205] op_sel:[0,0,0] op_sel_hi:[1,0,1] neg_lo:[1,0,0] neg_hi:[1,0,0]
  v_pk_fma_f32 v[206:207], v[102:103], v[64:65], v[206:207] op_sel:[0,0,0] op_sel_hi:[1,0,1] neg_lo:[1,0,0] neg_hi:[1,0,0]
  v_pk_mul_f32 v[204:205], v[204:205], v[120:121]
  v_pk_mul_f32 v[206:207], v[206:207], v[122:123]
  v_cvt_pk_bf16_f32 v248, v204, v205
  v_cvt_pk_bf16_f32 v249, v206, v207
  v_pk_fma_f32 v[44:45], v[84:85], v[64:65], v[44:45] op_sel:[0,1,0] op_sel_hi:[1,1,1] neg_lo:[1,0,0] neg_hi:[1,0,0]
  v_pk_fma_f32 v[46:47], v[86:87], v[64:65], v[46:47] op_sel:[0,1,0] op_sel_hi:[1,1,1] neg_lo:[1,0,0] neg_hi:[1,0,0]
  v_pk_mul_f32 v[44:45], v[44:45], v[104:105]
  v_pk_mul_f32 v[46:47], v[46:47], v[106:107]
  v_cvt_pk_bf16_f32 v224, v44, v45
  v_cvt_pk_bf16_f32 v225, v46, v47
  v_pk_fma_f32 v[208:209], v[88:89], v[64:65], v[208:209] op_sel:[0,1,0] op_sel_hi:[1,1,1] neg_lo:[1,0,0] neg_hi:[1,0,0]
  v_pk_fma_f32 v[210:211], v[90:91], v[64:65], v[210:211] op_sel:[0,1,0] op_sel_hi:[1,1,1] neg_lo:[1,0,0] neg_hi:[1,0,0]
  v_pk_mul_f32 v[208:209], v[208:209], v[108:109]
  v_pk_mul_f32 v[210:211], v[210:211], v[110:111]
  v_cvt_pk_bf16_f32 v226, v208, v209
  v_cvt_pk_bf16_f32 v227, v210, v211
  v_pk_fma_f32 v[212:213], v[92:93], v[64:65], v[212:213] op_sel:[0,1,0] op_sel_hi:[1,1,1] neg_lo:[1,0,0] neg_hi:[1,0,0]
  v_pk_fma_f32 v[214:215], v[94:95], v[64:65], v[214:215] op_sel:[0,1,0] op_sel_hi:[1,1,1] neg_lo:[1,0,0] neg_hi:[1,0,0]
  v_pk_mul_f32 v[212:213], v[212:213], v[112:113]
  v_pk_mul_f32 v[214:215], v[214:215], v[114:115]
  v_cvt_pk_bf16_f32 v228, v212, v213
  v_cvt_pk_bf16_f32 v229, v214, v215
  v_pk_fma_f32 v[216:217], v[96:97], v[64:65], v[216:217] op_sel:[0,1,0] op_sel_hi:[1,1,1] neg_lo:[1,0,0] neg_hi:[1,0,0]
  v_pk_fma_f32 v[218:219], v[98:99], v[64:65], v[218:219] op_sel:[0,1,0] op_sel_hi:[1,1,1] neg_lo:[1,0,0] neg_hi:[1,0,0]
  v_pk_mul_f32 v[216:217], v[216:217], v[116:117]
  v_pk_mul_f32 v[218:219], v[218:219], v[118:119]
  v_cvt_pk_bf16_f32 v230, v216, v217
  v_cvt_pk_bf16_f32 v231, v218, v219
  v_pk_fma_f32 v[220:221], v[100:101], v[64:65], v[220:221] op_sel:[0,1,0] op_sel_hi:[1,1,1] neg_lo:[1,0,0] neg_hi:[1,0,0]
  v_pk_fma_f32 v[222:223], v[102:103], v[64:65], v[222:223] op_sel:[0,1,0] op_sel_hi:[1,1,1] neg_lo:[1,0,0] neg_hi:[1,0,0]
  v_pk_mul_f32 v[220:221], v[220:221], v[120:121]
  v_pk_mul_f32 v[222:223], v[222:223], v[122:123]
  v_cvt_pk_bf16_f32 v232, v220, v221
  v_cvt_pk_bf16_f32 v233, v222, v223
  v_cndmask_b32 v148, v148, v149, s[48:49]
  v_cndmask_b32 v180, v180, v181, s[48:49]
  v_cndmask_b32 v150, v150, v151, s[48:49]
  v_cndmask_b32 v182, v182, v183, s[48:49]
  v_cndmask_b32 v36, v148, v180, s[50:51]
  v_cndmask_b32 v37, v150, v182, s[52:53]
  v_mul_f32 v36, v36, v77
  v_mul_f32 v37, v37, v81
  v_cndmask_b32 v152, v152, v153, s[48:49]
  v_cndmask_b32 v184, v184, v185, s[48:49]
  v_cndmask_b32 v154, v154, v155, s[48:49]
  v_cndmask_b32 v186, v186, v187, s[48:49]
  v_cndmask_b32 v40, v152, v184, s[50:51]
  v_cndmask_b32 v41, v154, v186, s[52:53]
  v_mul_f32 v40, v40, v78
  v_mul_f32 v41, v41, v82
  v_cndmask_b32 v156, v156, v157, s[48:49]
  v_cndmask_b32 v188, v188, v189, s[48:49]
  v_cndmask_b32 v158, v158, v159, s[48:49]
  v_cndmask_b32 v190, v190, v191, s[48:49]
  v_cndmask_b32 v44, v156, v188, s[50:51]
  v_cndmask_b32 v45, v158, v190, s[52:53]
  v_mul_f32 v44, v44, v79
  v_mul_f32 v45, v45, v83
  v_cndmask_b32 v144, v144, v145, s[48:49]
  v_cndmask_b32 v176, v176, v177, s[48:49]
  v_cndmask_b32 v146, v146, v147, s[48:49]
  v_cndmask_b32 v178, v178, v179, s[48:49]
  v_cndmask_b32 v32, v144, v176, s[50:51]
  v_cndmask_b32 v33, v146, v178, s[52:53]
  v_mul_f32 v32, v32, v76
  v_mul_f32 v33, v33, v80
  v_mov_b32 v48, 0xceabfb8f
  v_cndmask_b32 v32, v32, v48, s[54:55]
  v_cndmask_b32 v33, v33, v48, s[14:15]
  v_max_f32 v34, v32, v33
  v_max_f32 v38, v36, v37
  v_max_f32 v42, v40, v41
  v_max_f32 v46, v44, v45
  v_mov_b32 v35, v34
  v_mov_b32 v39, v38
  v_mov_b32 v43, v42
  v_mov_b32 v47, v46
  v_permlane32_swap_b32 v34, v35
  v_permlane32_swap_b32 v38, v39
  v_permlane32_swap_b32 v42, v43
  v_permlane32_swap_b32 v46, v47
  v_max_f32 v34, v34, v35
  v_max_f32 v38, v38, v39
  v_max_f32 v42, v42, v43
  v_max_f32 v46, v46, v47
  v_mov_b32 v35, v34
  v_mov_b32 v39, v38
  v_mov_b32 v43, v42
  v_mov_b32 v47, v46
  v_permlane16_swap_b32 v34, v35
  v_permlane16_swap_b32 v38, v39
  v_permlane16_swap_b32 v42, v43
  v_permlane16_swap_b32 v46, v47
  v_max_f32 v34, v34, v35
  v_max_f32 v38, v38, v39
  v_max_f32 v42, v42, v43
  v_max_f32 v46, v46, v47
  v_sub_f32 v32, v32, v34
  v_sub_f32 v33, v33, v34
  v_sub_f32 v36, v36, v38
  v_sub_f32 v37, v37, v38
  v_sub_f32 v40, v40, v42
  v_sub_f32 v41, v41, v42
  v_sub_f32 v44, v44, v46
  v_sub_f32 v45, v45, v46
  v_exp_f32 v32, v32
  v_exp_f32 v33, v33
  v_exp_f32 v36, v36
  v_exp_f32 v37, v37
  v_exp_f32 v40, v40
  v_exp_f32 v41, v41
  v_exp_f32 v44, v44
  v_exp_f32 v45, v45
  v_cvt_pk_bf16_f32 v32, v32, v32
  v_cvt_pk_bf16_f32 v33, v33, v33
  v_and_b32 v128, v32, v27
  v_and_b32 v129, v33, v29
  v_and_b32 v130, v32, v28
  v_and_b32 v131, v33, v30
  v_cvt_pk_bf16_f32 v36, v36, v36
  v_cvt_pk_bf16_f32 v37, v37, v37
  v_and_b32 v132, v36, v27
  v_and_b32 v133, v37, v29
  v_and_b32 v134, v36, v28
  v_and_b32 v135, v37, v30
  v_mfma_f32_16x16x32_bf16 v[144:147], v[236:239], v[128:131], 0
  v_mfma_f32_16x16x32_bf16 v[192:195], v[240:243], v[128:131], 0
  v_mfma_f32_16x16x32_bf16 v[208:211], v[224:227], v[128:131], 0
  v_cvt_pk_bf16_f32 v40, v40, v40
  v_cvt_pk_bf16_f32 v41, v41, v41
  v_and_b32 v136, v40, v27
  v_and_b32 v137, v41, v29
  v_and_b32 v138, v40, v28
  v_and_b32 v139, v41, v30
  v_mfma_f32_16x16x32_bf16 v[148:151], v[236:239], v[132:135], 0
  v_mfma_f32_16x16x32_bf16 v[196:199], v[242:245], v[132:135], 0
  v_mfma_f32_16x16x32_bf16 v[212:215], v[226:229], v[132:135], 0
  v_cvt_pk_bf16_f32 v44, v44, v44
  v_cvt_pk_bf16_f32 v45, v45, v45
  v_and_b32 v140, v44, v27
  v_and_b32 v141, v45, v29
  v_and_b32 v142, v44, v28
  v_and_b32 v143, v45, v30
  v_mfma_f32_16x16x32_bf16 v[152:155], v[236:239], v[136:139], 0
  v_mfma_f32_16x16x32_bf16 v[200:203], v[244:247], v[136:139], 0
  v_mfma_f32_16x16x32_bf16 v[216:219], v[228:231], v[136:139], 0
  v_mfma_f32_16x16x32_bf16 v[156:159], v[236:239], v[140:143], 0
  v_mfma_f32_16x16x32_bf16 v[204:207], v[246:249], v[140:143], 0
  v_mfma_f32_16x16x32_bf16 v[220:223], v[230:233], v[140:143], 0
  v_rcp_f32 v144, v144
  s_mov_b32 s3, 0
  v_pk_mul_f32 v[192:193], v[192:193], v[144:145] op_sel_hi:[1,0]
  v_pk_mul_f32 v[194:195], v[194:195], v[144:145] op_sel_hi:[1,0]
  v_pk_mul_f32 v[208:209], v[208:209], v[144:145] op_sel_hi:[1,0]
  v_pk_mul_f32 v[210:211], v[210:211], v[144:145] op_sel_hi:[1,0]
  v_cvt_pk_bf16_f32 v48, v192, v193
  v_cvt_pk_bf16_f32 v49, v194, v195
  v_cvt_pk_bf16_f32 v50, v208, v209
  v_cvt_pk_bf16_f32 v51, v210, v211
  s_nop 1
  v_permlane16_swap_b32 v48, v50
  v_permlane16_swap_b32 v49, v51
  buffer_store_dwordx4 v[48:51], v31, s[44:47], s3 offen sc1
  v_rcp_f32 v148, v148
  s_mov_b32 s3, 32768
  v_pk_mul_f32 v[196:197], v[196:197], v[148:149] op_sel_hi:[1,0]
  v_pk_mul_f32 v[198:199], v[198:199], v[148:149] op_sel_hi:[1,0]
  v_pk_mul_f32 v[212:213], v[212:213], v[148:149] op_sel_hi:[1,0]
  v_pk_mul_f32 v[214:215], v[214:215], v[148:149] op_sel_hi:[1,0]
  v_cvt_pk_bf16_f32 v52, v196, v197
  v_cvt_pk_bf16_f32 v53, v198, v199
  v_cvt_pk_bf16_f32 v54, v212, v213
  v_cvt_pk_bf16_f32 v55, v214, v215
  s_nop 1
  v_permlane16_swap_b32 v52, v54
  v_permlane16_swap_b32 v53, v55
  buffer_store_dwordx4 v[52:55], v31, s[44:47], s3 offen sc1
  v_rcp_f32 v152, v152
  s_mov_b32 s3, 65536
  v_pk_mul_f32 v[200:201], v[200:201], v[152:153] op_sel_hi:[1,0]
  v_pk_mul_f32 v[202:203], v[202:203], v[152:153] op_sel_hi:[1,0]
  v_pk_mul_f32 v[216:217], v[216:217], v[152:153] op_sel_hi:[1,0]
  v_pk_mul_f32 v[218:219], v[218:219], v[152:153] op_sel_hi:[1,0]
  v_cvt_pk_bf16_f32 v56, v200, v201
  v_cvt_pk_bf16_f32 v57, v202, v203
  v_cvt_pk_bf16_f32 v58, v216, v217
  v_cvt_pk_bf16_f32 v59, v218, v219
  s_nop 1
  v_permlane16_swap_b32 v56, v58
  v_permlane16_swap_b32 v57, v59
  buffer_store_dwordx4 v[56:59], v31, s[44:47], s3 offen sc1
  v_rcp_f32 v156, v156
  s_mov_b32 s3, 98304
  v_pk_mul_f32 v[204:205], v[204:205], v[156:157] op_sel_hi:[1,0]
  v_pk_mul_f32 v[206:207], v[206:207], v[156:157] op_sel_hi:[1,0]
  v_pk_mul_f32 v[220:221], v[220:221], v[156:157] op_sel_hi:[1,0]
  v_pk_mul_f32 v[222:223], v[222:223], v[156:157] op_sel_hi:[1,0]
  v_cvt_pk_bf16_f32 v60, v204, v205
  v_cvt_pk_bf16_f32 v61, v206, v207
  v_cvt_pk_bf16_f32 v62, v220, v221
  v_cvt_pk_bf16_f32 v63, v222, v223
  s_nop 1
  v_permlane16_swap_b32 v60, v62
  v_permlane16_swap_b32 v61, v63
  buffer_store_dwordx4 v[60:63], v31, s[44:47], s3 offen sc1
  s_endpgm
.section .rodata,"a"
.p2align 6
.amdhsa_kernel attnl0_kernel
  .amdhsa_next_free_vgpr 256
  .amdhsa_next_free_sgpr 102
  .amdhsa_accum_offset 256
  .amdhsa_group_segment_fixed_size 0
  .amdhsa_kernarg_size 88
  .amdhsa_user_sgpr_count 2
  .amdhsa_user_sgpr_kernarg_segment_ptr 1
  .amdhsa_system_sgpr_workgroup_id_x 1
  .amdhsa_float_denorm_mode_32 3
  .amdhsa_float_denorm_mode_16_64 3
.end_amdhsa_kernel
.text
.text
.globl attnl1_kernel
.p2align 8
.type attnl1_kernel,@function
attnl1_kernel:
  s_load_dwordx16 s[16:31], s[0:1], 0
  s_load_dwordx2 s[32:33], s[0:1], 64
  s_load_dwordx2 s[34:35], s[0:1], 80
  s_load_dwordx2 s[12:13], s[0:1], 64
  s_mov_b32 s96, 1
  s_branch L_attn_body
L_attn_c1:
.section .rodata,"a"
.p2align 6
.amdhsa_kernel attnl1_kernel
  .amdhsa_next_free_vgpr 256
  .amdhsa_next_free_sgpr 102
  .amdhsa_accum_offset 256
  .amdhsa_group_segment_fixed_size 0
  .amdhsa_kernarg_size 88
  .amdhsa_user_sgpr_count 2
  .amdhsa_user_sgpr_kernarg_segment_ptr 1
  .amdhsa_system_sgpr_workgroup_id_x 1
  .amdhsa_float_denorm_mode_32 3
  .amdhsa_float_denorm_mode_16_64 3
.end_amdhsa_kernel
.text
L_wo_c0:
.text
.globl wol0_kernel
.p2align 8
.type wol0_kernel,@function
wol0_kernel:
  s_load_dwordx16 s[16:31], s[0:1], 0
  s_load_dwordx2 s[32:33], s[0:1], 64
  s_load_dwordx2 s[34:35], s[0:1], 80
  s_load_dwordx2 s[12:13], s[0:1], 0
  s_mov_b32 s96, 0
L_wo_body:
  s_cmp_ge_u32 s2, 256
  s_cbranch_scc1 L_wo_end
  v_lshrrev_b32 v2, 6, v0
  v_and_b32 v1, 63, v0
  v_readfirstlane_b32 s70, v2
  s_and_b32 s3, s2, 7
  s_lshr_b32 s99, s2, 3
  s_and_b32 s5, s3, 3
  s_lshl_b32 s5, s5, 2
  s_and_b32 s6, s99, 3
  s_add_u32 s68, s5, s6
  s_lshr_b32 s5, s3, 2
  s_lshl_b32 s5, s5, 3
  s_lshr_b32 s6, s99, 2
  s_add_u32 s69, s5, s6
  s_cmp_lt_u32 s70, 4
  s_cbranch_scc1 L_wo_compute
L_wo_loader:
  s_add_u32 s8, s70, s69
  s_and_b32 s8, s8, 3
  s_add_u32 s9, s70, s68
  s_and_b32 s9, s9, 3
  s_lshl_b32 s76, s8, 12
  s_lshl_b32 s77, s9, 11
  s_add_u32 s77, s77, 16384
  s_lshl_b32 s11, s68, 7
  v_and_b32 v10, 7, v1
  s_lshr_b32 s10, s76, 11
  s_lshl_b32 s3, s68, 3
  s_add_u32 s10, s10, s3
  s_mul_i32 s10, s10, 32768
  v_lshl_add_u32 v4, v1, 4, s10
  v_add_u32 v5, 32768, v4
  v_lshrrev_b32 v3, 3, v1
  s_lshl_b32 s10, s9, 4
  v_add_u32 v3, s10, v3
  v_mul_u32_u24 v3, 2048, v3
  v_lshrrev_b32 v2, 3, v1
  v_and_b32 v2, 2, v2
  v_xor_b32 v2, v2, v10
  s_mul_i32 s10, s69, 128
  v_add_u32 v3, s10, v3
  v_lshl_add_u32 v8, v2, 4, v3
  v_xor_b32 v2, 4, v2
  v_add_u32 v3, 16384, v3
  v_lshl_add_u32 v9, v2, 4, v3
  s_mov_b32 s75, 0
  s_add_u32 s100, s68, s69
  s_mov_b32 s101, -1
  s_add_u32 s101, s101, 1
  s_sub_u32 s73, s101, s100
  s_lshl_b32 s73, s73, 3
  s_lshr_b32 s73, 0xf0f02, s73
  s_and_b32 s73, s73, 255
  s_add_u32 s73, s73, s101
  s_and_b32 s73, s73, 15
  s_mul_i32 s74, s73, 131072
  s_lshl_b32 s73, s73, 11
  s_waitcnt lgkmcnt(0)
  s_mov_b32 s36, s34
  s_and_b32 s37, s35, 0xffff
  s_mov_b32 s38, 4194304
  s_mov_b32 s39, 0x00020000
  s_mov_b32 s40, s20
  s_and_b32 s41, s21, 0xffff
  s_mov_b32 s42, 2097152
  s_mov_b32 s43, 0x00020000
  s_add_u32 s3, s75, s76
  s_add_u32 m0, s3, 0
  s_nop 0
  buffer_load_dwordx4 v4, s[36:39], s73 offen offset:0 lds
  buffer_load_dwordx4 v4, s[36:39], s73 offen offset:1024 lds
  s_add_u32 m0, s3, 2048
  s_nop 0
  buffer_load_dwordx4 v5, s[36:39], s73 offen offset:0 lds
  buffer_load_dwordx4 v5, s[36:39], s73 offen offset:1024 lds
  s_add_u32 s3, s75, s77
  s_add_u32 m0, s3, 0
  s_add_u32 s4, s74, 0
  buffer_load_dwordx4 v8, s[40:43], s4 offen lds
  s_add_u32 m0, s3, 1024
  s_nop 0
  buffer_load_dwordx4 v9, s[40:43], s4 offen lds
  s_add_u32 s101, s101, 1
  s_sub_u32 s73, s101, s100
  s_lshl_b32 s73, s73, 3
  s_lshr_b32 s73, 0xf0f02, s73
  s_and_b32 s73, s73, 255
  s_add_u32 s73, s73, s101
  s_and_b32 s73, s73, 15
  s_mul_i32 s74, s73, 131072
  s_lshl_b32 s73, s73, 11
  s_add_u32 s75, s75, 24576
  s_cmp_eq_u32 s75, 147456
  s_cselect_b32 s75, 0, s75
  s_add_u32 s3, s75, s76
  s_add_u32 m0, s3, 0
  s_nop 0
  buffer_load_dwordx4 v4, s[36:39], s73 offen offset:0 lds
  buffer_load_dwordx4 v4, s[36:39], s73 offen offset:1024 lds
  s_add_u32 m0, s3, 2048
  s_nop 0
  buffer_load_dwordx4 v5, s[36:39], s73 offen offset:0 lds
  buffer_load_dwordx4 v5, s[36:39], s73 offen offset:1024 lds
  s_add_u32 s3, s75, s77
  s_add_u32 m0, s3, 0
  s_add_u32 s4, s74, 0
  buffer_load_dwordx4 v8, s[40:43], s4 offen lds
  s_add_u32 m0, s3, 1024
  s_nop 0
  buffer_load_dwordx4 v9, s[40:43], s4 offen lds
  s_add_u32 s101, s101, 1
  s_sub_u32 s73, s101, s100
  s_lshl_b32 s73, s73, 3
  s_lshr_b32 s73, 0xf0f02, s73
  s_and_b32 s73, s73, 255
  s_add_u32 s73, s73, s101
  s_and_b32 s73, s73, 15
  s_mul_i32 s74, s73, 131072
  s_lshl_b32 s73, s73, 11
  s_add_u32 s75, s75, 24576
  s_cmp_eq_u32 s75, 147456
  s_cselect_b32 s75, 0, s75
  s_waitcnt vmcnt(6)
  s_barrier
  s_add_u32 s3, s75, s76
  s_add_u32 m0, s3, 0
  s_nop 0
  buffer_load_dwordx4 v4, s[36:39], s73 offen offset:0 lds
  buffer_load_dwordx4 v4, s[36:39], s73 offen offset:1024 lds
  s_add_u32 m0, s3, 2048
  s_nop 0
  buffer_load_dwordx4 v5, s[36:39], s73 offen offset:0 lds
  buffer_load_dwordx4 v5, s[36:39], s73 offen offset:1024 lds
  s_add_u32 s3, s75, s77
  s_add_u32 m0, s3, 0
  s_add_u32 s4, s74, 0
  buffer_load_dwordx4 v8, s[40:43], s4 offen lds
  s_add_u32 m0, s3, 1024
  s_nop 0
  buffer_load_dwordx4 v9, s[40:43], s4 offen lds
  s_add_u32 s101, s101, 1
  s_sub_u32 s73, s101, s100
  s_lshl_b32 s73, s73, 3
  s_lshr_b32 s73, 0xf0f02, s73
  s_and_b32 s73, s73, 255
  s_add_u32 s73, s73, s101
  s_and_b32 s73, s73, 15
  s_mul_i32 s74, s73, 131072
  s_lshl_b32 s73, s73, 11
  s_add_u32 s75, s75, 24576
  s_cmp_eq_u32 s75, 147456
  s_cselect_b32 s75, 0, s75
  s_add_u32 s3, s75, s76
  s_add_u32 m0, s3, 0
  s_nop 0
  buffer_load_dwordx4 v4, s[36:39], s73 offen offset:0 lds
  buffer_load_dwordx4 v4, s[36:39], s73 offen offset:1024 lds
  s_add_u32 m0, s3, 2048
  s_nop 0
  buffer_load_dwordx4 v5, s[36:39], s73 offen offset:0 lds
  buffer_load_dwordx4 v5, s[36:39], s73 offen offset:1024 lds
  s_add_u32 s3, s75, s77
  s_add_u32 m0, s3, 0
  s_add_u32 s4, s74, 0
  buffer_load_dwordx4 v8, s[40:43], s4 offen lds
  s_add_u32 m0, s3, 1024
  s_nop 0
  buffer_load_dwordx4 v9, s[40:43], s4 offen lds
  s_add_u32 s101, s101, 1
  s_sub_u32 s73, s101, s100
  s_lshl_b32 s73, s73, 3
  s_lshr_b32 s73, 0xf0f02, s73
  s_and_b32 s73, s73, 255
  s_add_u32 s73, s73, s101
  s_and_b32 s73, s73, 15
  s_mul_i32 s74, s73, 131072
  s_lshl_b32 s73, s73, 11
  s_add_u32 s75, s75, 24576
  s_cmp_eq_u32 s75, 147456
  s_cselect_b32 s75, 0, s75
  s_add_u32 s3, s75, s76
  s_add_u32 m0, s3, 0
  s_nop 0
  buffer_load_dwordx4 v4, s[36:39], s73 offen offset:0 lds
  buffer_load_dwordx4 v4, s[36:39], s73 offen offset:1024 lds
  s_add_u32 m0, s3, 2048
  s_nop 0
  buffer_load_dwordx4 v5, s[36:39], s73 offen offset:0 lds
  buffer_load_dwordx4 v5, s[36:39], s73 offen offset:1024 lds
  s_add_u32 s3, s75, s77
  s_add_u32 m0, s3, 0
  s_add_u32 s4, s74, 0
  buffer_load_dwordx4 v8, s[40:43], s4 offen lds
  s_add_u32 m0, s3, 1024
  s_nop 0
  buffer_load_dwordx4 v9, s[40:43], s4 offen lds
  s_add_u32 s101, s101, 1
  s_sub_u32 s73, s101, s100
  s_lshl_b32 s73, s73, 3
  s_lshr_b32 s73, 0xf0f02, s73
  s_and_b32 s73, s73, 255
  s_add_u32 s73, s73, s101
  s_and_b32 s73, s73, 15
  s_mul_i32 s74, s73, 131072
  s_lshl_b32 s73, s73, 11
  s_add_u32 s75, s75, 24576
  s_cmp_eq_u32 s75, 147456
  s_cselect_b32 s75, 0, s75
  s_mov_b32 s79, 10
L_wol_ld:
  s_add_u32 s3, s75, s76
  s_add_u32 m0, s3, 0
  s_nop 0
  buffer_load_dwordx4 v4, s[36:39], s73 offen offset:0 lds
  buffer_load_dwordx4 v4, s[36:39], s73 offen offset:1024 lds
  s_add_u32 m0, s3, 2048
  s_nop 0
  buffer_load_dwordx4 v5, s[36:39], s73 offen offset:0 lds
  buffer_load_dwordx4 v5, s[36:39], s73 offen offset:1024 lds
  s_add_u32 s3, s75, s77
  s_add_u32 m0, s3, 0
  s_add_u32 s4, s74, 0
  buffer_load_dwordx4 v8, s[40:43], s4 offen lds
  s_add_u32 m0, s3, 1024
  s_nop 0
  buffer_load_dwordx4 v9, s[40:43], s4 offen lds
  s_add_u32 s101, s101, 1
  s_sub_u32 s73, s101, s100
  s_lshl_b32 s73, s73, 3
  s_lshr_b32 s73, 0xf0f02, s73
  s_and_b32 s73, s73, 255
  s_add_u32 s73, s73, s101
  s_and_b32 s73, s73, 15
  s_mul_i32 s74, s73, 131072
  s_lshl_b32 s73, s73, 11
  s_add_u32 s75, s75, 24576
  s_cmp_eq_u32 s75, 147456
  s_cselect_b32 s75, 0, s75
  s_waitcnt vmcnt(24)
  s_barrier
  s_sub_u32 s79, s79, 1
  s_cmp_lg_u32 s79, 0
  s_cbranch_scc1 L_wol_ld
  s_add_u32 s3, s75, s76
  s_add_u32 m0, s3, 0
  s_nop 0
  buffer_load_dwordx4 v4, s[36:39], s73 offen offset:0 lds
  buffer_load_dwordx4 v4, s[36:39], s73 offen offset:1024 lds
  s_add_u32 m0, s3, 2048
  s_nop 0
  buffer_load_dwordx4 v5, s[36:39], s73 offen offset:0 lds
  buffer_load_dwordx4 v5, s[36:39], s73 offen offset:1024 lds
  s_add_u32 s3, s75, s77
  s_add_u32 m0, s3, 0
  s_add_u32 s4, s74, 0
  buffer_load_dwordx4 v8, s[40:43], s4 offen lds
  s_add_u32 m0, s3, 1024
  s_nop 0
  buffer_load_dwordx4 v9, s[40:43], s4 offen lds
  s_add_u32 s101, s101, 1
  s_sub_u32 s73, s101, s100
  s_lshl_b32 s73, s73, 3
  s_lshr_b32 s73, 0xf0f02, s73
  s_and_b32 s73, s73, 255
  s_add_u32 s73, s73, s101
  s_and_b32 s73, s73, 15
  s_mul_i32 s74, s73, 131072
  s_lshl_b32 s73, s73, 11
  s_add_u32 s75, s75, 24576
  s_cmp_eq_u32 s75, 147456
  s_cselect_b32 s75, 0, s75
  s_mov_b32 s48, s12
  s_and_b32 s49, s13, 0xffff
  s_mov_b32 s50, 4194304
  s_mov_b32 s51, 0x00020000
  v_lshrrev_b32 v3, 3, v1
  s_lshr_b32 s10, s76, 7
  s_lshl_b32 s3, s68, 7
  s_add_u32 s10, s10, s3
  v_add_u32 v3, s10, v3
  v_mul_u32_u24 v3, 2048, v3
  v_lshrrev_b32 v2, 4, v1
  v_xor_b32 v4, v2, v10
  v_lshl_add_u32 v4, v4, 4, v3
  v_add_u32 v3, 16384, v3
  v_add_u32 v5, 4, v2
  v_xor_b32 v5, v5, v10
  v_lshl_add_u32 v5, v5, 4, v3
  v_add_u32 v3, 16384, v3
  v_xor_b32 v6, v2, v10
  v_lshl_add_u32 v6, v6, 4, v3
  v_add_u32 v3, 16384, v3
  v_add_u32 v7, 4, v2
  v_xor_b32 v7, v7, v10
  v_lshl_add_u32 v7, v7, 4, v3
  s_lshl_b32 s4, s69, 7
  s_add_u32 m0, s76, 147456
  s_nop 0
  buffer_load_dwordx4 v4, s[48:51], s4 offen lds
  s_add_u32 m0, s76, 148480
  s_nop 0
  buffer_load_dwordx4 v5, s[48:51], s4 offen lds
  s_add_u32 m0, s76, 149504
  s_nop 0
  buffer_load_dwordx4 v6, s[48:51], s4 offen lds
  s_add_u32 m0, s76, 150528
  s_nop 0
  buffer_load_dwordx4 v7, s[48:51], s4 offen lds
  s_waitcnt vmcnt(28)
  s_barrier
  s_waitcnt vmcnt(22)
  s_barrier
  s_waitcnt vmcnt(16)
  s_barrier
  s_waitcnt vmcnt(10)
  s_barrier
  s_waitcnt vmcnt(4)
  s_barrier
  s_waitcnt vmcnt(0)
  s_barrier
L_wo_side:
  s_waitcnt vmcnt(0)
L_wo_end:
  s_endpgm
L_wo_compute:
  v_and_b32 v3, 15, v1
  v_lshrrev_b32 v2, 4, v1
  s_lshl_b32 s8, s68, 7
  s_lshl_b32 s9, s70, 5
  s_add_u32 s8, s8, s9
  v_add_u32 v13, s8, v3
  s_lshl_b32 s10, s69, 7
  v_lshl_add_u32 v14, v2, 3, s10
  v_and_b32 v16, 1, v2
  v_lshrrev_b32 v17, 1, v2
  v_lshl_add_u32 v16, v16, 1, v17
  v_lshlrev_b32 v16, 8, v16
  v_lshl_add_u32 v16, v3, 4, v16
  s_add_u32 s9, s8, s69
  s_lshl_b32 s9, s9, 11
  v_add_u32 v12, s9, v16
  v_lshl_add_u32 v18, v17, 4, v13
  v_lshlrev_b32 v18, 3, v18
  v_and_b32 v16, 1, v2
  v_lshl_add_u32 v18, v16, 2, v18
  s_lshl_b32 s10, s69, 14
  v_add_u32 v18, s10, v18
  s_lshl_b32 s8, s70, 12
  v_lshl_add_u32 v5, v1, 4, s8
  v_bfe_u32 v6, v1, 2, 2
  v_lshl_add_u32 v6, v2, 3, v6
  v_lshlrev_b32 v6, 7, v6
  v_and_b32 v17, 3, v1
  v_lshl_add_u32 v6, v17, 3, v6
  v_bfe_u32 v17, v1, 3, 2
  v_lshl_add_u32 v6, v17, 5, v6
  v_add_u32 v6, 16384, v6
  v_xor_b32 v7, 32, v6
  v_xor_b32 v8, 64, v6
  v_xor_b32 v9, 96, v6
  v_lshrrev_b32 v15, 1, v2
  v_lshrrev_b32 v17, 1, v3
  v_xor_b32 v15, v15, v17
  v_lshlrev_b32 v15, 4, v15
  v_lshl_add_u32 v15, v3, 7, v15
  v_lshl_add_u32 v15, v16, 3, v15
  s_add_u32 s8, s8, 147456
  v_add_u32 v15, s8, v15
  s_mov_b32 s11, 0xffff0000
  s_mov_b32 s75, 0
  v_mov_b32 v128, 0
  v_mov_b32 v129, 0
  v_mov_b32 v130, 0
  v_mov_b32 v131, 0
  v_mov_b32 v132, 0
  v_mov_b32 v133, 0
  v_mov_b32 v134, 0
  v_mov_b32 v135, 0
  v_mov_b32 v136, 0
  v_mov_b32 v137, 0
  v_mov_b32 v138, 0
  v_mov_b32 v139, 0
  v_mov_b32 v140, 0
  v_mov_b32 v141, 0
  v_mov_b32 v142, 0
  v_mov_b32 v143, 0
  v_mov_b32 v144, 0
  v_mov_b32 v145, 0
  v_mov_b32 v146, 0
  v_mov_b32 v147, 0
  v_mov_b32 v148, 0
  v_mov_b32 v149, 0
  v_mov_b32 v150, 0
  v_mov_b32 v151, 0
  v_mov_b32 v152, 0
  v_mov_b32 v153, 0
  v_mov_b32 v154, 0
  v_mov_b32 v155, 0
  v_mov_b32 v156, 0
  v_mov_b32 v157, 0
  v_mov_b32 v158, 0
  v_mov_b32 v159, 0
  s_waitcnt lgkmcnt(0)
  s_add_u32 s44, s34, 4194304
  s_addc_u32 s45, s35, 0
  s_and_b32 s45, s45, 0xffff
  s_mov_b32 s46, 4194304
  s_mov_b32 s47, 0x00020000
  s_add_u32 s56, s34, 24117248
  s_addc_u32 s57, s35, 0
  s_and_b32 s57, s57, 0xffff
  s_mov_b32 s58, 262144
  s_mov_b32 s59, 0x00020000
  s_getpc_b64 s[4:5]
L_pfc2:
  s_lshl_b32 s3, s99, 2
  s_add_u32 s3, s3, s70
  s_mul_i32 s3, s3, 128
  s_min_u32 s3, s3, L_w1_c1-L_w1_c0-128
  s_add_i32 s3, s3, L_w1_c0-L_pfc2
  s_ashr_i32 s6, s3, 31
  s_add_u32 s4, s4, s3
  s_addc_u32 s5, s5, s6
  s_load_dword s36, s[4:5], 0
  s_load_dword s37, s[4:5], 64
  v_add_u32_e64 v25, s75, v5
  v_add_u32_e64 v26, s75, v6
  v_add_u32_e64 v27, s75, v7
  v_add_u32_e64 v28, s75, v8
  v_add_u32_e64 v29, s75, v9
  s_add_u32 s75, s75, 24576
  s_cmp_eq_u32 s75, 147456
  s_cselect_b32 s75, 0, s75
  s_barrier
  ds_read_b128 v[32:35], v25 offset:0
  ds_read_b128 v[36:39], v25 offset:2048
  ds_read_b64_tr_b16 v[48:49], v26 offset:0
  ds_read_b64_tr_b16 v[50:51], v26 offset:512
  ds_read_b64_tr_b16 v[52:53], v27 offset:0
  ds_read_b64_tr_b16 v[54:55], v27 offset:512
  ds_read_b64_tr_b16 v[56:57], v28 offset:0
  ds_read_b64_tr_b16 v[58:59], v28 offset:512
  ds_read_b64_tr_b16 v[60:61], v29 offset:0
  ds_read_b64_tr_b16 v[62:63], v29 offset:512
  ds_read_b128 v[40:43], v25 offset:1024
  ds_read_b128 v[44:47], v25 offset:3072
  ds_read_b64_tr_b16 v[64:65], v26 offset:4096
  ds_read_b64_tr_b16 v[66:67], v26 offset:4608
  ds_read_b64_tr_b16 v[68:69], v27 offset:4096
  ds_read_b64_tr_b16 v[70:71], v27 offset:4608
  ds_read_b64_tr_b16 v[72:73], v28 offset:4096
  ds_read_b64_tr_b16 v[74:75], v28 offset:4608
  ds_read_b64_tr_b16 v[76:77], v29 offset:4096
  ds_read_b64_tr_b16 v[78:79], v29 offset:4608
  s_mov_b32 s79, 8
  v_add_u32_e64 v25, s75, v5
  v_add_u32_e64 v26, s75, v6
  v_add_u32_e64 v27, s75, v7
  v_add_u32_e64 v28, s75, v8
  v_add_u32_e64 v29, s75, v9
  s_add_u32 s75, s75, 24576
  s_cmp_eq_u32 s75, 147456
  s_cselect_b32 s75, 0, s75
  s_waitcnt lgkmcnt(0)
.p2align 3
L_wo_loop:
  s_barrier
  s_sub_u32 s79, s79, 1
  v_mfma_f32_16x16x32_bf16 v[128:131], v[48:51], v[32:35], v[128:131]
  ds_read_b128 v[80:83], v25 offset:0
  ds_read_b128 v[84:87], v25 offset:2048
  v_mfma_f32_16x16x32_bf16 v[132:135], v[48:51], v[36:39], v[132:135]
  ds_read_b64_tr_b16 v[96:97], v26 offset:0
  ds_read_b64_tr_b16 v[98:99], v26 offset:512
  v_mfma_f32_16x16x32_bf16 v[136:139], v[52:55], v[32:35], v[136:139]
  ds_read_b64_tr_b16 v[100:101], v27 offset:0
  ds_read_b64_tr_b16 v[102:103], v27 offset:512
  v_mfma_f32_16x16x32_bf16 v[140:143], v[52:55], v[36:39], v[140:143]
  ds_read_b64_tr_b16 v[104:105], v28 offset:0
  ds_read_b64_tr_b16 v[106:107], v28 offset:512
  v_mfma_f32_16x16x32_bf16 v[144:147], v[56:59], v[32:35], v[144:147]
  ds_read_b64_tr_b16 v[108:109], v29 offset:0
  ds_read_b64_tr_b16 v[110:111], v29 offset:512
  v_mfma_f32_16x16x32_bf16 v[148:151], v[56:59], v[36:39], v[148:151]
  ds_read_b128 v[88:91], v25 offset:1024
  ds_read_b128 v[92:95], v25 offset:3072
  v_mfma_f32_16x16x32_bf16 v[152:155], v[60:63], v[32:35], v[152:155]
  ds_read_b64_tr_b16 v[112:113], v26 offset:4096
  ds_read_b64_tr_b16 v[114:115], v26 offset:4608
  v_mfma_f32_16x16x32_bf16 v[156:159], v[60:63], v[36:39], v[156:159]
  ds_read_b64_tr_b16 v[116:117], v27 offset:4096
  ds_read_b64_tr_b16 v[118:119], v27 offset:4608
  v_mfma_f32_16x16x32_bf16 v[128:131], v[64:67], v[40:43], v[128:131]
  ds_read_b64_tr_b16 v[120:121], v28 offset:4096
  ds_read_b64_tr_b16 v[122:123], v28 offset:4608
  v_mfma_f32_16x16x32_bf16 v[132:135], v[64:67], v[44:47], v[132:135]
  ds_read_b64_tr_b16 v[124:125], v29 offset:4096
  ds_read_b64_tr_b16 v[126:127], v29 offset:4608
  v_mfma_f32_16x16x32_bf16 v[136:139], v[68:71], v[40:43], v[136:139]
  v_add_u32_e64 v25, s75, v5
  v_add_u32_e64 v26, s75, v6
  v_mfma_f32_16x16x32_bf16 v[140:143], v[68:71], v[44:47], v[140:143]
  v_add_u32_e64 v27, s75, v7
  v_add_u32_e64 v28, s75, v8
  v_mfma_f32_16x16x32_bf16 v[144:147], v[72:75], v[40:43], v[144:147]
  v_add_u32_e64 v29, s75, v9
  s_add_u32 s75, s75, 24576
  v_mfma_f32_16x16x32_bf16 v[148:151], v[72:75], v[44:47], v[148:151]
  s_cmp_eq_u32 s75, 147456
  s_cselect_b32 s75, 0, s75
  s_nop 0
  v_mfma_f32_16x16x32_bf16 v[152:155], v[76:79], v[40:43], v[152:155]
  v_mfma_f32_16x16x32_bf16 v[156:159], v[76:79], v[44:47], v[156:159]
  s_waitcnt lgkmcnt(0)
  s_barrier
  v_mfma_f32_16x16x32_bf16 v[128:131], v[96:99], v[80:83], v[128:131]
  ds_read_b128 v[32:35], v25 offset:0
  ds_read_b128 v[36:39], v25 offset:2048
  v_mfma_f32_16x16x32_bf16 v[132:135], v[96:99], v[84:87], v[132:135]
  ds_read_b64_tr_b16 v[48:49], v26 offset:0
  ds_read_b64_tr_b16 v[50:51], v26 offset:512
  v_mfma_f32_16x16x32_bf16 v[136:139], v[100:103], v[80:83], v[136:139]
  ds_read_b64_tr_b16 v[52:53], v27 offset:0
  ds_read_b64_tr_b16 v[54:55], v27 offset:512
  v_mfma_f32_16x16x32_bf16 v[140:143], v[100:103], v[84:87], v[140:143]
  ds_read_b64_tr_b16 v[56:57], v28 offset:0
  ds_read_b64_tr_b16 v[58:59], v28 offset:512
  v_mfma_f32_16x16x32_bf16 v[144:147], v[104:107], v[80:83], v[144:147]
  ds_read_b64_tr_b16 v[60:61], v29 offset:0
  ds_read_b64_tr_b16 v[62:63], v29 offset:512
  v_mfma_f32_16x16x32_bf16 v[148:151], v[104:107], v[84:87], v[148:151]
  ds_read_b128 v[40:43], v25 offset:1024
  ds_read_b128 v[44:47], v25 offset:3072
  v_mfma_f32_16x16x32_bf16 v[152:155], v[108:111], v[80:83], v[152:155]
  ds_read_b64_tr_b16 v[64:65], v26 offset:4096
  ds_read_b64_tr_b16 v[66:67], v26 offset:4608
  v_mfma_f32_16x16x32_bf16 v[156:159], v[108:111], v[84:87], v[156:159]
  ds_read_b64_tr_b16 v[68:69], v27 offset:4096
  ds_read_b64_tr_b16 v[70:71], v27 offset:4608
  v_mfma_f32_16x16x32_bf16 v[128:131], v[112:115], v[88:91], v[128:131]
  ds_read_b64_tr_b16 v[72:73], v28 offset:4096
  ds_read_b64_tr_b16 v[74:75], v28 offset:4608
  v_mfma_f32_16x16x32_bf16 v[132:135], v[112:115], v[92:95], v[132:135]
  ds_read_b64_tr_b16 v[76:77], v29 offset:4096
  ds_read_b64_tr_b16 v[78:79], v29 offset:4608
  v_mfma_f32_16x16x32_bf16 v[136:139], v[116:119], v[88:91], v[136:139]
  v_add_u32_e64 v25, s75, v5
  v_add_u32_e64 v26, s75, v6
  v_mfma_f32_16x16x32_bf16 v[140:143], v[116:119], v[92:95], v[140:143]
  v_add_u32_e64 v27, s75, v7
  v_add_u32_e64 v28, s75, v8
  v_mfma_f32_16x16x32_bf16 v[144:147], v[120:123], v[88:91], v[144:147]
  v_add_u32_e64 v29, s75, v9
  s_add_u32 s75, s75, 24576
  v_mfma_f32_16x16x32_bf16 v[148:151], v[120:123], v[92:95], v[148:151]
  s_cmp_eq_u32 s75, 147456
  s_cselect_b32 s75, 0, s75
  s_cmp_lg_u32 s79, 0
  v_mfma_f32_16x16x32_bf16 v[152:155], v[124:127], v[88:91], v[152:155]
  v_mfma_f32_16x16x32_bf16 v[156:159], v[124:127], v[92:95], v[156:159]
  s_waitcnt lgkmcnt(0)
  s_cbranch_scc1 L_wo_loop
  v_xor_b32 v26, 32, v15
  v_xor_b32 v27, 64, v15
  v_xor_b32 v28, 96, v15
  ds_read_b64 v[160:161], v15 offset:0
  ds_read_b64 v[164:165], v26 offset:0
  ds_read_b64 v[168:169], v27 offset:0
  ds_read_b64 v[172:173], v28 offset:0
  ds_read_b64 v[162:163], v15 offset:2048
  ds_read_b64 v[166:167], v26 offset:2048
  ds_read_b64 v[170:171], v27 offset:2048
  ds_read_b64 v[174:175], v28 offset:2048
  v_mov_b32 v20, 0
  v_mov_b32 v21, 0
  v_mov_b32 v22, 0
  v_mov_b32 v23, 0
  s_mov_b32 s3, 32768
  s_mov_b32 s10, 0x3f803f80
  s_waitcnt lgkmcnt(7)
  v_lshlrev_b32 v184, 16, v160
  v_and_b32 v185, s11, v160
  v_lshlrev_b32 v186, 16, v161
  v_and_b32 v187, s11, v161
  v_pk_add_f32 v[128:129], v[128:129], v[184:185]
  v_pk_add_f32 v[130:131], v[130:131], v[186:187]
  v_cvt_pk_bf16_f32 v32, v128, v129
  v_cvt_pk_bf16_f32 v33, v130, v131
  s_waitcnt lgkmcnt(6)
  v_lshlrev_b32 v184, 16, v164
  v_and_b32 v185, s11, v164
  v_lshlrev_b32 v186, 16, v165
  v_and_b32 v187, s11, v165
  v_pk_add_f32 v[136:137], v[136:137], v[184:185]
  v_pk_add_f32 v[138:139], v[138:139], v[186:187]
  v_cvt_pk_bf16_f32 v34, v136, v137
  v_cvt_pk_bf16_f32 v35, v138, v139
  s_nop 1
  v_permlane16_swap_b32 v32, v34
  v_permlane16_swap_b32 v33, v35
  buffer_store_dwordx4 v[32:35], v12, s[44:47], 0 offen offset:0 sc1
  s_waitcnt lgkmcnt(5)
  v_lshlrev_b32 v184, 16, v168
  v_and_b32 v185, s11, v168
  v_lshlrev_b32 v186, 16, v169
  v_and_b32 v187, s11, v169
  v_pk_add_f32 v[144:145], v[144:145], v[184:185]
  v_pk_add_f32 v[146:147], v[146:147], v[186:187]
  v_cvt_pk_bf16_f32 v36, v144, v145
  v_cvt_pk_bf16_f32 v37, v146, v147
  s_waitcnt lgkmcnt(4)
  v_lshlrev_b32 v184, 16, v172
  v_and_b32 v185, s11, v172
  v_lshlrev_b32 v186, 16, v173
  v_and_b32 v187, s11, v173
  v_pk_add_f32 v[152:153], v[152:153], v[184:185]
  v_pk_add_f32 v[154:155], v[154:155], v[186:187]
  v_cvt_pk_bf16_f32 v38, v152, v153
  v_cvt_pk_bf16_f32 v39, v154, v155
  s_nop 1
  v_permlane16_swap_b32 v36, v38
  v_permlane16_swap_b32 v37, v39
  buffer_store_dwordx4 v[36:39], v12, s[44:47], 0 offen offset:1024 sc1
  s_waitcnt lgkmcnt(3)
  v_lshlrev_b32 v184, 16, v162
  v_and_b32 v185, s11, v162
  v_lshlrev_b32 v186, 16, v163
  v_and_b32 v187, s11, v163
  v_pk_add_f32 v[132:133], v[132:133], v[184:185]
  v_pk_add_f32 v[134:135], v[134:135], v[186:187]
  v_cvt_pk_bf16_f32 v40, v132, v133
  v_cvt_pk_bf16_f32 v41, v134, v135
  s_waitcnt lgkmcnt(2)
  v_lshlrev_b32 v184, 16, v166
  v_and_b32 v185, s11, v166
  v_lshlrev_b32 v186, 16, v167
  v_and_b32 v187, s11, v167
  v_pk_add_f32 v[140:141], v[140:141], v[184:185]
  v_pk_add_f32 v[142:143], v[142:143], v[186:187]
  v_cvt_pk_bf16_f32 v42, v140, v141
  v_cvt_pk_bf16_f32 v43, v142, v143
  s_nop 1
  v_permlane16_swap_b32 v40, v42
  v_permlane16_swap_b32 v41, v43
  buffer_store_dwordx4 v[40:43], v12, s[44:47], s3 offen offset:0 sc1
  s_waitcnt lgkmcnt(1)
  v_lshlrev_b32 v184, 16, v170
  v_and_b32 v185, s11, v170
  v_lshlrev_b32 v186, 16, v171
  v_and_b32 v187, s11, v171
  v_pk_add_f32 v[148:149], v[148:149], v[184:185]
  v_pk_add_f32 v[150:151], v[150:151], v[186:187]
  v_cvt_pk_bf16_f32 v44, v148, v149
  v_cvt_pk_bf16_f32 v45, v150, v151
  s_waitcnt lgkmcnt(0)
  v_lshlrev_b32 v184, 16, v174
  v_and_b32 v185, s11, v174
  v_lshlrev_b32 v186, 16, v175
  v_and_b32 v187, s11, v175
  v_pk_add_f32 v[156:157], v[156:157], v[184:185]
  v_pk_add_f32 v[158:159], v[158:159], v[186:187]
  v_cvt_pk_bf16_f32 v46, v156, v157
  v_cvt_pk_bf16_f32 v47, v158, v159
  s_nop 1
  v_permlane16_swap_b32 v44, v46
  v_permlane16_swap_b32 v45, v47
  buffer_store_dwordx4 v[44:47], v12, s[44:47], s3 offen offset:1024 sc1
  v_dot2_f32_bf16 v20, v32, s10, v20
  v_dot2_f32_bf16 v22, v32, v32, v22
  v_dot2_f32_bf16 v20, v33, s10, v20
  v_dot2_f32_bf16 v22, v33, v33, v22
  v_dot2_f32_bf16 v20, v34, s10, v20
  v_dot2_f32_bf16 v22, v34, v34, v22
  v_dot2_f32_bf16 v20, v35, s10, v20
  v_dot2_f32_bf16 v22, v35, v35, v22
  v_dot2_f32_bf16 v20, v36, s10, v20
  v_dot2_f32_bf16 v22, v36, v36, v22
  v_dot2_f32_bf16 v20, v37, s10, v20
  v_dot2_f32_bf16 v22, v37, v37, v22
  v_dot2_f32_bf16 v20, v38, s10, v20
  v_dot2_f32_bf16 v22, v38, v38, v22
  v_dot2_f32_bf16 v20, v39, s10, v20
  v_dot2_f32_bf16 v22, v39, v39, v22
  v_dot2_f32_bf16 v21, v40, s10, v21
  v_dot2_f32_bf16 v23, v40, v40, v23
  v_dot2_f32_bf16 v21, v41, s10, v21
  v_dot2_f32_bf16 v23, v41, v41, v23
  v_dot2_f32_bf16 v21, v42, s10, v21
  v_dot2_f32_bf16 v23, v42, v42, v23
  v_dot2_f32_bf16 v21, v43, s10, v21
  v_dot2_f32_bf16 v23, v43, v43, v23
  v_dot2_f32_bf16 v21, v44, s10, v21
  v_dot2_f32_bf16 v23, v44, v44, v23
  v_dot2_f32_bf16 v21, v45, s10, v21
  v_dot2_f32_bf16 v23, v45, v45, v23
  v_dot2_f32_bf16 v21, v46, s10, v21
  v_dot2_f32_bf16 v23, v46, v46, v23
  v_dot2_f32_bf16 v21, v47, s10, v21
  v_dot2_f32_bf16 v23, v47, v47, v23
  s_nop 2
  v_permlane32_swap_b32 v20, v21
  v_permlane32_swap_b32 v22, v23
  v_add_f32 v20, v20, v21
  v_add_f32 v22, v22, v23
  s_nop 1
  v_permlane16_swap_b32 v20, v22
  v_add_f32 v20, v20, v22
  buffer_store_dword v20, v18, s[56:59], 0 offen sc1
  s_endpgm
.section .rodata,"a"
.p2align 6
.amdhsa_kernel wol0_kernel
  .amdhsa_next_free_vgpr 256
  .amdhsa_next_free_sgpr 102
  .amdhsa_accum_offset 256
  .amdhsa_group_segment_fixed_size 0
  .amdhsa_kernarg_size 88
  .amdhsa_user_sgpr_count 2
  .amdhsa_user_sgpr_kernarg_segment_ptr 1
  .amdhsa_system_sgpr_workgroup_id_x 1
  .amdhsa_float_denorm_mode_32 3
  .amdhsa_float_denorm_mode_16_64 3
.end_amdhsa_kernel
.text
.text
.globl wol1_kernel
.p2align 8
.type wol1_kernel,@function
wol1_kernel:
  s_load_dwordx16 s[16:31], s[0:1], 0
  s_load_dwordx2 s[32:33], s[0:1], 64
  s_load_dwordx2 s[34:35], s[0:1], 80
  s_load_dwordx2 s[12:13], s[0:1], 64
  s_mov_b32 s96, 1
  s_branch L_wo_body
L_wo_c1:
.section .rodata,"a"
.p2align 6
.amdhsa_kernel wol1_kernel
  .amdhsa_next_free_vgpr 256
  .amdhsa_next_free_sgpr 102
  .amdhsa_accum_offset 256
  .amdhsa_group_segment_fixed_size 0
  .amdhsa_kernarg_size 88
  .amdhsa_user_sgpr_count 2
  .amdhsa_user_sgpr_kernarg_segment_ptr 1
  .amdhsa_system_sgpr_workgroup_id_x 1
  .amdhsa_float_denorm_mode_32 3
  .amdhsa_float_denorm_mode_16_64 3
.end_amdhsa_kernel
.text
L_w1_c0:
.text
.globl w1l0_kernel
.p2align 8
.type w1l0_kernel,@function
w1l0_kernel:
  s_load_dwordx16 s[16:31], s[0:1], 0
  s_load_dwordx2 s[32:33], s[0:1], 64
  s_load_dwordx2 s[34:35], s[0:1], 80
  s_load_dwordx2 s[12:13], s[0:1], 0
  s_mov_b32 s96, 0
L_w1_body:
  s_cmp_ge_u32 s2, 256
  s_cbranch_scc1 L_w1_end
  v_lshrrev_b32 v2, 6, v0
  v_and_b32 v1, 63, v0
  v_readfirstlane_b32 s70, v2
  s_and_b32 s3, s2, 7
  s_lshr_b32 s99, s2, 3
  s_and_b32 s5, s3, 1
  s_lshl_b32 s5, s5, 3
  s_and_b32 s6, s99, 7
  s_add_u32 s68, s5, s6
  s_lshr_b32 s5, s3, 1
  s_lshl_b32 s5, s5, 2
  s_lshr_b32 s6, s99, 3
  s_add_u32 s69, s5, s6
  s_cmp_lt_u32 s70, 4
  s_cbranch_scc1 L_w1_compute
L_w1_loader:
  s_add_u32 s8, s70, s69
  s_and_b32 s8, s8, 3
  s_add_u32 s9, s70, s68
  s_and_b32 s9, s9, 3
  s_lshl_b32 s76, s8, 12
  s_lshl_b32 s77, s9, 11
  s_add_u32 s77, s77, 16384
  s_lshl_b32 s11, s68, 7
  v_and_b32 v10, 7, v1
  s_lshr_b32 s10, s76, 11
  s_lshl_b32 s3, s68, 3
  s_add_u32 s10, s10, s3
  s_mul_i32 s10, s10, 32768
  v_lshl_add_u32 v4, v1, 4, s10
  v_add_u32 v5, 32768, v4
  v_lshrrev_b32 v3, 3, v1
  s_lshl_b32 s10, s9, 4
  v_add_u32 v3, s10, v3
  v_mul_u32_u24 v3, 7168, v3
  v_lshrrev_b32 v2, 3, v1
  v_and_b32 v2, 2, v2
  v_xor_b32 v2, v2, v10
  s_mul_i32 s10, s69, 448
  s_andn2_b32 s10, s10, 127
  v_add_u32 v3, s10, v3
  v_lshl_add_u32 v8, v2, 4, v3
  v_xor_b32 v2, 4, v2
  v_add_u32 v3, 57344, v3
  v_lshl_add_u32 v9, v2, 4, v3
  s_mov_b32 s75, 0
  s_add_u32 s100, s68, s69
  s_mov_b32 s101, -1
  s_add_u32 s101, s101, 1
  s_sub_u32 s73, s101, s100
  s_lshl_b32 s73, s73, 3
  s_lshr_b32 s73, 0xf0f02, s73
  s_and_b32 s73, s73, 255
  s_add_u32 s73, s73, s101
  s_and_b32 s73, s73, 15
  s_mul_i32 s74, s73, 458752
  s_lshl_b32 s73, s73, 11
  s_waitcnt lgkmcnt(0)
  s_add_u32 s36, s34, 4194304
  s_addc_u32 s37, s35, 0
  s_and_b32 s37, s37, 0xffff
  s_mov_b32 s38, 4194304
  s_mov_b32 s39, 0x00020000
  s_mov_b32 s40, s24
  s_and_b32 s41, s25, 0xffff
  s_mov_b32 s42, 7340032
  s_mov_b32 s43, 0x00020000
  s_add_u32 s56, s34, 24117248
  s_addc_u32 s57, s35, 0
  s_and_b32 s57, s57, 0xffff
  s_mov_b32 s58, 262144
  s_mov_b32 s59, 0x00020000
  s_add_u32 s64, s34, 24641536
  s_addc_u32 s65, s35, 0
  s_and_b32 s65, s65, 0xffff
  s_mov_b32 s66, 262144
  s_mov_b32 s67, 0x00020000
  s_mov_b32 s52, s26
  s_and_b32 s53, s27, 0xffff
  s_mov_b32 s54, 7168
  s_mov_b32 s55, 0x00020000
  s_add_u32 s3, s75, s76
  s_add_u32 m0, s3, 0
  s_nop 0
  buffer_load_dwordx4 v4, s[36:39], s73 offen offset:0 lds
  buffer_load_dwordx4 v4, s[36:39], s73 offen offset:1024 lds
  s_add_u32 m0, s3, 2048
  s_nop 0
  buffer_load_dwordx4 v5, s[36:39], s73 offen offset:0 lds
  buffer_load_dwordx4 v5, s[36:39], s73 offen offset:1024 lds
  s_add_u32 s3, s75, s77
  s_add_u32 m0, s3, 0
  s_add_u32 s4, s74, 0
  buffer_load_dwordx4 v8, s[40:43], s4 offen lds
  s_add_u32 m0, s3, 1024
  s_nop 0
  buffer_load_dwordx4 v9, s[40:43], s4 offen lds
  s_add_u32 m0, s3, 8192
  s_add_u32 s4, s74, 128
  buffer_load_dwordx4 v8, s[40:43], s4 offen lds
  s_add_u32 m0, s3, 9216
  s_nop 0
  buffer_load_dwordx4 v9, s[40:43], s4 offen lds
  s_add_u32 m0, s3, 16384
  s_add_u32 s4, s74, 256
  buffer_load_dwordx4 v8, s[40:43], s4 offen lds
  s_add_u32 m0, s3, 17408
  s_nop 0
  buffer_load_dwordx4 v9, s[40:43], s4 offen lds
  s_add_u32 m0, s3, 24576
  s_add_u32 s4, s74, 384
  buffer_load_dwordx4 v8, s[40:43], s4 offen lds
  s_add_u32 m0, s3, 25600
  s_nop 0
  buffer_load_dwordx4 v9, s[40:43], s4 offen lds
  s_add_u32 s101, s101, 1
  s_sub_u32 s73, s101, s100
  s_lshl_b32 s73, s73, 3
  s_lshr_b32 s73, 0xf0f02, s73
  s_and_b32 s73, s73, 255
  s_add_u32 s73, s73, s101
  s_and_b32 s73, s73, 15
  s_mul_i32 s74, s73, 458752
  s_lshl_b32 s73, s73, 11
  s_add_u32 s75, s75, 49152
  s_cmp_eq_u32 s75, 147456
  s_cselect_b32 s75, 0, s75
  s_add_u32 s3, s75, s76
  s_add_u32 m0, s3, 0
  s_nop 0
  buffer_load_dwordx4 v4, s[36:39], s73 offen offset:0 lds
  buffer_load_dwordx4 v4, s[36:39], s73 offen offset:1024 lds
  s_add_u32 m0, s3, 2048
  s_nop 0
  buffer_load_dwordx4 v5, s[36:39], s73 offen offset:0 lds
  buffer_load_dwordx4 v5, s[36:39], s73 offen offset:1024 lds
  s_add_u32 s3, s75, s77
  s_add_u32 m0, s3, 0
  s_add_u32 s4, s74, 0
  buffer_load_dwordx4 v8, s[40:43], s4 offen lds
  s_add_u32 m0, s3, 1024
  s_nop 0
  buffer_load_dwordx4 v9, s[40:43], s4 offen lds
  s_add_u32 m0, s3, 8192
  s_add_u32 s4, s74, 128
  buffer_load_dwordx4 v8, s[40:43], s4 offen lds
  s_add_u32 m0, s3, 9216
  s_nop 0
  buffer_load_dwordx4 v9, s[40:43], s4 offen lds
  s_add_u32 m0, s3, 16384
  s_add_u32 s4, s74, 256
  buffer_load_dwordx4 v8, s[40:43], s4 offen lds
  s_add_u32 m0, s3, 17408
  s_nop 0
  buffer_load_dwordx4 v9, s[40:43], s4 offen lds
  s_add_u32 m0, s3, 24576
  s_add_u32 s4, s74, 384
  buffer_load_dwordx4 v8, s[40:43], s4 offen lds
  s_add_u32 m0, s3, 25600
  s_nop 0
  buffer_load_dwordx4 v9, s[40:43], s4 offen lds
  s_add_u32 s101, s101, 1
  s_sub_u32 s73, s101, s100
  s_lshl_b32 s73, s73, 3
  s_lshr_b32 s73, 0xf0f02, s73
  s_and_b32 s73, s73, 255
  s_add_u32 s73, s73, s101
  s_and_b32 s73, s73, 15
  s_mul_i32 s74, s73, 458752
  s_lshl_b32 s73, s73, 11
  s_add_u32 s75, s75, 49152
  s_cmp_eq_u32 s75, 147456
  s_cselect_b32 s75, 0, s75
  s_waitcnt vmcnt(12)
  s_barrier
  s_mov_b32 s79, 13
L_w1_ld:
  s_add_u32 s3, s75, s76
  s_add_u32 m0, s3, 0
  s_nop 0
  buffer_load_dwordx4 v4, s[36:39], s73 offen offset:0 lds
  buffer_load_dwordx4 v4, s[36:39], s73 offen offset:1024 lds
  s_add_u32 m0, s3, 2048
  s_nop 0
  buffer_load_dwordx4 v5, s[36:39], s73 offen offset:0 lds
  buffer_load_dwordx4 v5, s[36:39], s73 offen offset:1024 lds
  s_add_u32 s3, s75, s77
  s_add_u32 m0, s3, 0
  s_add_u32 s4, s74, 0
  buffer_load_dwordx4 v8, s[40:43], s4 offen lds
  s_add_u32 m0, s3, 1024
  s_nop 0
  buffer_load_dwordx4 v9, s[40:43], s4 offen lds
  s_add_u32 m0, s3, 8192
  s_add_u32 s4, s74, 128
  buffer_load_dwordx4 v8, s[40:43], s4 offen lds
  s_add_u32 m0, s3, 9216
  s_nop 0
  buffer_load_dwordx4 v9, s[40:43], s4 offen lds
  s_add_u32 m0, s3, 16384
  s_add_u32 s4, s74, 256
  buffer_load_dwordx4 v8, s[40:43], s4 offen lds
  s_add_u32 m0, s3, 17408
  s_nop 0
  buffer_load_dwordx4 v9, s[40:43], s4 offen lds
  s_add_u32 m0, s3, 24576
  s_add_u32 s4, s74, 384
  buffer_load_dwordx4 v8, s[40:43], s4 offen lds
  s_add_u32 m0, s3, 25600
  s_nop 0
  buffer_load_dwordx4 v9, s[40:43], s4 offen lds
  s_add_u32 s101, s101, 1
  s_sub_u32 s73, s101, s100
  s_lshl_b32 s73, s73, 3
  s_lshr_b32 s73, 0xf0f02, s73
  s_and_b32 s73, s73, 255
  s_add_u32 s73, s73, s101
  s_and_b32 s73, s73, 15
  s_mul_i32 s74, s73, 458752
  s_lshl_b32 s73, s73, 11
  s_add_u32 s75, s75, 49152
  s_cmp_eq_u32 s75, 147456
  s_cselect_b32 s75, 0, s75
  s_waitcnt vmcnt(12)
  s_barrier
  s_sub_u32 s79, s79, 1
  s_cmp_lg_u32 s79, 0
  s_cbranch_scc1 L_w1_ld
  s_add_u32 s3, s75, s76
  s_add_u32 m0, s3, 0
  s_nop 0
  buffer_load_dwordx4 v4, s[36:39], s73 offen offset:0 lds
  buffer_load_dwordx4 v4, s[36:39], s73 offen offset:1024 lds
  s_add_u32 m0, s3, 2048
  s_nop 0
  buffer_load_dwordx4 v5, s[36:39], s73 offen offset:0 lds
  buffer_load_dwordx4 v5, s[36:39], s73 offen offset:1024 lds
  s_add_u32 s3, s75, s77
  s_add_u32 m0, s3, 0
  s_add_u32 s4, s74, 0
  buffer_load_dwordx4 v8, s[40:43], s4 offen lds
  s_add_u32 m0, s3, 1024
  s_nop 0
  buffer_load_dwordx4 v9, s[40:43], s4 offen lds
  s_add_u32 m0, s3, 8192
  s_add_u32 s4, s74, 128
  buffer_load_dwordx4 v8, s[40:43], s4 offen lds
  s_add_u32 m0, s3, 9216
  s_nop 0
  buffer_load_dwordx4 v9, s[40:43], s4 offen lds
  s_add_u32 m0, s3, 16384
  s_add_u32 s4, s74, 256
  buffer_load_dwordx4 v8, s[40:43], s4 offen lds
  s_add_u32 m0, s3, 17408
  s_nop 0
  buffer_load_dwordx4 v9, s[40:43], s4 offen lds
  s_add_u32 m0, s3, 24576
  s_add_u32 s4, s74, 384
  buffer_load_dwordx4 v8, s[40:43], s4 offen lds
  s_add_u32 m0, s3, 25600
  s_nop 0
  buffer_load_dwordx4 v9, s[40:43], s4 offen lds
  s_add_u32 s101, s101, 1
  s_sub_u32 s73, s101, s100
  s_lshl_b32 s73, s73, 3
  s_lshr_b32 s73, 0xf0f02, s73
  s_and_b32 s73, s73, 255
  s_add_u32 s73, s73, s101
  s_and_b32 s73, s73, 15
  s_mul_i32 s74, s73, 458752
  s_lshl_b32 s73, s73, 11
  s_add_u32 s75, s75, 49152
  s_cmp_eq_u32 s75, 147456
  s_cselect_b32 s75, 0, s75
  s_and_b32 s3, s70, 3
  s_lshl_b32 s4, s68, 7
  s_lshl_b32 s5, s3, 6
  s_add_u32 s5, s5, s4
  v_add_u32 v2, s5, v1
  s_sub_u32 s4, s4, 16
  v_and_b32 v3, 15, v1
  v_add_u32 v3, s4, v3
  v_max_i32 v3, 0, v3
  s_cmp_ge_u32 s3, 2
  s_cselect_b64 vcc, -1, 0
  v_cndmask_b32 v2, v2, v3, vcc
  v_lshlrev_b32 v2, 3, v2
  s_mov_b32 s3, 0
  buffer_load_dwordx2 v[32:33], v2, s[56:59], s3 offen
  s_add_u32 s3, s3, 16384
  buffer_load_dwordx2 v[34:35], v2, s[56:59], s3 offen
  s_add_u32 s3, s3, 16384
  buffer_load_dwordx2 v[36:37], v2, s[56:59], s3 offen
  s_add_u32 s3, s3, 16384
  buffer_load_dwordx2 v[38:39], v2, s[56:59], s3 offen
  s_add_u32 s3, s3, 16384
  buffer_load_dwordx2 v[40:41], v2, s[56:59], s3 offen
  s_add_u32 s3, s3, 16384
  buffer_load_dwordx2 v[42:43], v2, s[56:59], s3 offen
  s_add_u32 s3, s3, 16384
  buffer_load_dwordx2 v[44:45], v2, s[56:59], s3 offen
  s_add_u32 s3, s3, 16384
  buffer_load_dwordx2 v[46:47], v2, s[56:59], s3 offen
  s_add_u32 s3, s3, 16384
  buffer_load_dwordx2 v[48:49], v2, s[56:59], s3 offen
  s_add_u32 s3, s3, 16384
  buffer_load_dwordx2 v[50:51], v2, s[56:59], s3 offen
  s_add_u32 s3, s3, 16384
  buffer_load_dwordx2 v[52:53], v2, s[56:59], s3 offen
  s_add_u32 s3, s3, 16384
  buffer_load_dwordx2 v[54:55], v2, s[56:59], s3 offen
  s_add_u32 s3, s3, 16384
  buffer_load_dwordx2 v[56:57], v2, s[56:59], s3 offen
  s_add_u32 s3, s3, 16384
  buffer_load_dwordx2 v[58:59], v2, s[56:59], s3 offen
  s_add_u32 s3, s3, 16384
  buffer_load_dwordx2 v[60:61], v2, s[56:59], s3 offen
  s_add_u32 s3, s3, 16384
  buffer_load_dwordx2 v[62:63], v2, s[56:59], s3 offen
  s_mul_i32 s4, s69, 224
  s_sub_u32 s4, s4, 256
  v_add_u32 v3, s4, v0
  v_lshlrev_b32 v2, 2, v3
  v_lshlrev_b32 v3, 1, v3
  s_mov_b32 s3, 0
  buffer_load_dword v64, v2, s[64:67], s3 offen
  s_add_u32 s3, s3, 16384
  buffer_load_dword v65, v2, s[64:67], s3 offen
  s_add_u32 s3, s3, 16384
  buffer_load_dword v66, v2, s[64:67], s3 offen
  s_add_u32 s3, s3, 16384
  buffer_load_dword v67, v2, s[64:67], s3 offen
  s_add_u32 s3, s3, 16384
  buffer_load_dword v68, v2, s[64:67], s3 offen
  s_add_u32 s3, s3, 16384
  buffer_load_dword v69, v2, s[64:67], s3 offen
  s_add_u32 s3, s3, 16384
  buffer_load_dword v70, v2, s[64:67], s3 offen
  s_add_u32 s3, s3, 16384
  buffer_load_dword v71, v2, s[64:67], s3 offen
  s_add_u32 s3, s3, 16384
  buffer_load_dword v72, v2, s[64:67], s3 offen
  s_add_u32 s3, s3, 16384
  buffer_load_dword v73, v2, s[64:67], s3 offen
  s_add_u32 s3, s3, 16384
  buffer_load_dword v74, v2, s[64:67], s3 offen
  s_add_u32 s3, s3, 16384
  buffer_load_dword v75, v2, s[64:67], s3 offen
  s_add_u32 s3, s3, 16384
  buffer_load_dword v76, v2, s[64:67], s3 offen
  s_add_u32 s3, s3, 16384
  buffer_load_dword v77, v2, s[64:67], s3 offen
  s_add_u32 s3, s3, 16384
  buffer_load_dword v78, v2, s[64:67], s3 offen
  s_add_u32 s3, s3, 16384
  buffer_load_dword v79, v2, s[64:67], s3 offen
  buffer_load_ushort v80, v3, s[52:55], 0 offen
  s_mov_b32 s60, s28
  s_and_b32 s61, s29, 0xffff
  s_mov_b32 s62, 7340032
  s_mov_b32 s63, 0x00020000
  s_and_b32 s3, s70, 3
  s_lshl_b32 s4, s2, 2
  s_add_u32 s3, s3, s4
  s_mul_i32 s3, s3, 7168
  v_min_u32 v2, 55, v1
  v_lshlrev_b32 v2, 7, v2
  s_sub_u32 s4, s96, 1
  v_and_b32 v2, s4, v2
  buffer_load_dword v96, v2, s[60:63], s3 offen
  s_waitcnt vmcnt(46)
  s_barrier
  s_waitcnt vmcnt(34)
  s_barrier
  s_waitcnt vmcnt(1)
  v_add_f32 v32, v32, v34
  v_add_f32 v33, v33, v35
  v_add_f32 v48, v48, v50
  v_add_f32 v49, v49, v51
  v_add_f32 v32, v32, v36
  v_add_f32 v33, v33, v37
  v_add_f32 v48, v48, v52
  v_add_f32 v49, v49, v53
  v_add_f32 v32, v32, v38
  v_add_f32 v33, v33, v39
  v_add_f32 v48, v48, v54
  v_add_f32 v49, v49, v55
  v_add_f32 v32, v32, v40
  v_add_f32 v33, v33, v41
  v_add_f32 v48, v48, v56
  v_add_f32 v49, v49, v57
  v_add_f32 v32, v32, v42
  v_add_f32 v33, v33, v43
  v_add_f32 v48, v48, v58
  v_add_f32 v49, v49, v59
  v_add_f32 v32, v32, v44
  v_add_f32 v33, v33, v45
  v_add_f32 v48, v48, v60
  v_add_f32 v49, v49, v61
  v_add_f32 v32, v32, v46
  v_add_f32 v33, v33, v47
  v_add_f32 v48, v48, v62
  v_add_f32 v49, v49, v63
  v_add_f32 v32, v32, v48
  v_add_f32 v33, v33, v49
  v_mul_f32 v32, 0x3a800000, v32
  v_mul_f32 v33, 0x3a800000, v33
  v_fma_f32 v33, -v32, v32, v33
  v_max_f32 v33, 0, v33
  v_add_f32 v33, 0x3727c5ac, v33
  v_rsq_f32 v33, v33
  s_nop 0
  s_and_b32 s3, s70, 3
  s_lshl_b32 s5, s3, 6
  s_add_u32 s5, s5, 16
  v_add_u32 v2, s5, v1
  v_and_b32 v3, 15, v1
  s_cmp_ge_u32 s3, 2
  s_cselect_b64 vcc, -1, 0
  v_cndmask_b32 v2, v2, v3, vcc
  v_lshlrev_b32 v2, 2, v2
  v_add_u32 v2, 147456, v2
  ds_write2_b32 v2, v32, v33 offset0:0 offset1:160
  v_add_f32 v64, v64, v72
  v_add_f32 v65, v65, v73
  v_add_f32 v66, v66, v74
  v_add_f32 v67, v67, v75
  v_add_f32 v68, v68, v76
  v_add_f32 v69, v69, v77
  v_add_f32 v70, v70, v78
  v_add_f32 v71, v71, v79
  v_add_f32 v64, v64, v68
  v_add_f32 v65, v65, v69
  v_add_f32 v66, v66, v70
  v_add_f32 v67, v67, v71
  v_add_f32 v64, v64, v65
  v_add_f32 v66, v66, v67
  v_add_f32 v64, v64, v66
  v_lshlrev_b32 v80, 16, v80
  v_lshlrev_b32 v2, 2, v0
  v_add_u32 v2, 147712, v2
  ds_write_b32 v2, v64
  ds_write_b32 v2, v80 offset:1024
  s_waitcnt lgkmcnt(0)
  s_barrier
  s_waitcnt vmcnt(0)
L_w1_end:
  s_endpgm
L_w1_compute:
  s_and_b32 s71, s70, 1
  s_lshr_b32 s72, s70, 1
  v_and_b32 v3, 15, v1
  v_lshrrev_b32 v2, 4, v1
  s_lshl_b32 s8, s71, 13
  v_lshl_add_u32 v4, v1, 4, s8
  v_bfe_u32 v13, v1, 2, 2
  v_lshl_add_u32 v13, v2, 3, v13
  v_lshlrev_b32 v13, 7, v13
  v_and_b32 v17, 3, v1
  v_lshl_add_u32 v13, v17, 3, v13
  v_bfe_u32 v17, v1, 3, 2
  v_lshl_add_u32 v13, v17, 5, v13
  s_and_b32 s8, s69, 1
  s_lshl_b32 s8, s8, 1
  s_lshl_b32 s9, s72, 3
  s_add_u32 s11, s8, s72
  s_add_u32 s8, s8, s9
  s_add_u32 s9, s8, 0
  s_and_b32 s10, s9, 3
  s_lshl_b32 s10, s10, 5
  s_lshr_b32 s9, s9, 2
  s_lshl_b32 s9, s9, 13
  s_add_u32 s9, s9, 16384
  v_xor_b32 v5, s10, v13
  v_add_u32 v5, s9, v5
  s_add_u32 s9, s8, 1
  s_and_b32 s10, s9, 3
  s_lshl_b32 s10, s10, 5
  s_lshr_b32 s9, s9, 2
  s_lshl_b32 s9, s9, 13
  s_add_u32 s9, s9, 16384
  v_xor_b32 v6, s10, v13
  v_add_u32 v6, s9, v6
  s_add_u32 s9, s8, 2
  s_and_b32 s10, s9, 3
  s_lshl_b32 s10, s10, 5
  s_lshr_b32 s9, s9, 2
  s_lshl_b32 s9, s9, 13
  s_add_u32 s9, s9, 16384
  v_xor_b32 v7, s10, v13
  v_add_u32 v7, s9, v7
  s_add_u32 s9, s8, 3
  s_and_b32 s10, s9, 3
  s_lshl_b32 s10, s10, 5
  s_lshr_b32 s9, s9, 2
  s_lshl_b32 s9, s9, 13
  s_add_u32 s9, s9, 16384
  v_xor_b32 v8, s10, v13
  v_add_u32 v8, s9, v8
  s_add_u32 s9, s11, 6
  s_and_b32 s10, s9, 3
  s_lshl_b32 s10, s10, 5
  s_lshr_b32 s9, s9, 2
  s_lshl_b32 s9, s9, 13
  s_add_u32 s9, s9, 16384
  v_xor_b32 v9, s10, v13
  v_add_u32 v9, s9, v9
  s_lshl_b32 s8, s68, 7
  s_lshl_b32 s9, s71, 6
  s_add_u32 s8, s8, s9
  s_add_u32 s8, s8, s69
  s_mul_i32 s8, s8, 7168
  v_and_b32 v16, 1, v2
  v_lshrrev_b32 v17, 1, v2
  v_lshlrev_b32 v14, 8, v17
  v_lshl_add_u32 v14, v3, 4, v14
  v_add_u32 v14, s8, v14
  s_lshl_b32 s9, s72, 12
  v_lshl_add_u32 v12, v16, 9, v14
  v_add_u32 v12, s9, v12
  v_mul_u32_u24 v16, 114688, v16
  s_lshl_b32 s9, s72, 9
  v_add3_u32 v13, v16, v14, s9
  s_lshl_b32 s9, s71, 8
  s_add_u32 s9, s9, 147520
  v_lshl_add_u32 v14, v3, 2, s9
  s_lshl_b32 s9, s72, 9
  s_add_u32 s9, s9, 148736
  v_lshl_add_u32 v15, v2, 4, s9
  s_lshl_b32 s9, s72, 6
  s_add_u32 s9, s9, 148736
  v_lshl_add_u32 v16, v2, 4, s9
  v_mov_b32 v128, 0
  v_mov_b32 v129, 0
  v_mov_b32 v130, 0
  v_mov_b32 v131, 0
  v_mov_b32 v132, 0
  v_mov_b32 v133, 0
  v_mov_b32 v134, 0
  v_mov_b32 v135, 0
  v_mov_b32 v136, 0
  v_mov_b32 v137, 0
  v_mov_b32 v138, 0
  v_mov_b32 v139, 0
  v_mov_b32 v140, 0
  v_mov_b32 v141, 0
  v_mov_b32 v142, 0
  v_mov_b32 v143, 0
  v_mov_b32 v144, 0
  v_mov_b32 v145, 0
  v_mov_b32 v146, 0
  v_mov_b32 v147, 0
  v_mov_b32 v148, 0
  v_mov_b32 v149, 0
  v_mov_b32 v150, 0
  v_mov_b32 v151, 0
  v_mov_b32 v152, 0
  v_mov_b32 v153, 0
  v_mov_b32 v154, 0
  v_mov_b32 v155, 0
  v_mov_b32 v156, 0
  v_mov_b32 v157, 0
  v_mov_b32 v158, 0
  v_mov_b32 v159, 0
  v_mov_b32 v160, 0
  v_mov_b32 v161, 0
  v_mov_b32 v162, 0
  v_mov_b32 v163, 0
  v_mov_b32 v164, 0
  v_mov_b32 v165, 0
  v_mov_b32 v166, 0
  v_mov_b32 v167, 0
  v_mov_b32 v168, 0
  v_mov_b32 v169, 0
  v_mov_b32 v170, 0
  v_mov_b32 v171, 0
  v_mov_b32 v172, 0
  v_mov_b32 v173, 0
  v_mov_b32 v174, 0
  v_mov_b32 v175, 0
  v_mov_b32 v176, 0
  v_mov_b32 v177, 0
  v_mov_b32 v178, 0
  v_mov_b32 v179, 0
  v_mov_b32 v180, 0
  v_mov_b32 v181, 0
  v_mov_b32 v182, 0
  v_mov_b32 v183, 0
  v_mov_b32 v184, 0
  v_mov_b32 v185, 0
  v_mov_b32 v186, 0
  v_mov_b32 v187, 0
  v_mov_b32 v188, 0
  v_mov_b32 v189, 0
  v_mov_b32 v190, 0
  v_mov_b32 v191, 0
  v_mov_b32 v192, 0
  v_mov_b32 v193, 0
  v_mov_b32 v194, 0
  v_mov_b32 v195, 0
  v_mov_b32 v196, 0
  v_mov_b32 v197, 0
  v_mov_b32 v198, 0
  v_mov_b32 v199, 0
  v_mov_b32 v200, 0
  v_mov_b32 v201, 0
  v_mov_b32 v202, 0
  v_mov_b32 v203, 0
  v_mov_b32 v204, 0
  v_mov_b32 v205, 0
  v_mov_b32 v206, 0
  v_mov_b32 v207, 0
  v_mov_b32 v208, 0
  v_mov_b32 v209, 0
  v_mov_b32 v210, 0
  v_mov_b32 v211, 0
  v_mov_b32 v212, 0
  v_mov_b32 v213, 0
  v_mov_b32 v214, 0
  v_mov_b32 v215, 0
  v_mov_b32 v216, 0
  v_mov_b32 v217, 0
  v_mov_b32 v218, 0
  v_mov_b32 v219, 0
  v_mov_b32 v220, 0
  v_mov_b32 v221, 0
  v_mov_b32 v222, 0
  v_mov_b32 v223, 0
  v_mov_b32 v224, 0
  v_mov_b32 v225, 0
  v_mov_b32 v226, 0
  v_mov_b32 v227, 0
  v_mov_b32 v228, 0
  v_mov_b32 v229, 0
  v_mov_b32 v230, 0
  v_mov_b32 v231, 0
  v_mov_b32 v232, 0
  v_mov_b32 v233, 0
  v_mov_b32 v234, 0
  v_mov_b32 v235, 0
  v_mov_b32 v236, 0
  v_mov_b32 v237, 0
  v_mov_b32 v238, 0
  v_mov_b32 v239, 0
  s_waitcnt lgkmcnt(0)
  s_add_u32 s44, s34, 8388608
  s_addc_u32 s45, s35, 0
  s_and_b32 s45, s45, 0xffff
  s_mov_b32 s46, 14680064
  s_mov_b32 s47, 0x00020000
  s_getpc_b64 s[4:5]
L_pfc3:
  s_lshl_b32 s3, s99, 2
  s_add_u32 s3, s3, s70
  s_mul_i32 s3, s3, 64
  s_min_u32 s3, s3, L_w2_c1-L_w2_c0-64
  s_add_i32 s3, s3, L_w2_c0-L_pfc3
  s_ashr_i32 s6, s3, 31
  s_add_u32 s4, s4, s3
  s_addc_u32 s5, s5, s6
  s_load_dword s36, s[4:5], 0
  s_mov_b32 s75, 0
  v_add_u32_e64 v20, s75, v4
  v_add_u32_e64 v21, s75, v5
  v_add_u32_e64 v22, s75, v6
  v_add_u32_e64 v23, s75, v7
  v_add_u32_e64 v24, s75, v8
  v_add_u32_e64 v25, s75, v9
  s_add_u32 s75, s75, 49152
  s_cmp_eq_u32 s75, 147456
  s_cselect_b32 s75, 0, s75
  s_mov_b32 s79, 16
  s_barrier
  ds_read_b128 v[32:35], v20 offset:0
  ds_read_b128 v[36:39], v20 offset:2048
  ds_read_b128 v[40:43], v20 offset:4096
  ds_read_b128 v[44:47], v20 offset:6144
  ds_read_b64_tr_b16 v[48:49], v21 offset:0
  ds_read_b64_tr_b16 v[50:51], v21 offset:512
  ds_read_b64_tr_b16 v[52:53], v22 offset:0
  ds_read_b64_tr_b16 v[54:55], v22 offset:512
  ds_read_b64_tr_b16 v[56:57], v23 offset:0
  ds_read_b64_tr_b16 v[58:59], v23 offset:512
  ds_read_b64_tr_b16 v[60:61], v24 offset:0
  ds_read_b64_tr_b16 v[62:63], v24 offset:512
  ds_read_b64_tr_b16 v[64:65], v21 offset:8192
  ds_read_b64_tr_b16 v[66:67], v21 offset:8704
  ds_read_b64_tr_b16 v[68:69], v22 offset:8192
  ds_read_b64_tr_b16 v[70:71], v22 offset:8704
  ds_read_b64_tr_b16 v[72:73], v25 offset:0
  ds_read_b64_tr_b16 v[74:75], v25 offset:512
  s_waitcnt lgkmcnt(0)
.p2align 3
L_w1_loop:
  v_mfma_f32_16x16x32_bf16 v[128:131], v[48:51], v[32:35], v[128:131]
  ds_read_b128 v[80:83], v20 offset:1024
  v_mfma_f32_16x16x32_bf16 v[132:135], v[48:51], v[36:39], v[132:135]
  ds_read_b128 v[84:87], v20 offset:3072
  v_mfma_f32_16x16x32_bf16 v[136:139], v[48:51], v[40:43], v[136:139]
  ds_read_b128 v[88:91], v20 offset:5120
  v_mfma_f32_16x16x32_bf16 v[140:143], v[48:51], v[44:47], v[140:143]
  ds_read_b128 v[92:95], v20 offset:7168
  v_mfma_f32_16x16x32_bf16 v[144:147], v[52:55], v[32:35], v[144:147]
  ds_read_b64_tr_b16 v[96:97], v21 offset:4096
  v_mfma_f32_16x16x32_bf16 v[148:151], v[52:55], v[36:39], v[148:151]
  ds_read_b64_tr_b16 v[98:99], v21 offset:4608
  v_mfma_f32_16x16x32_bf16 v[152:155], v[52:55], v[40:43], v[152:155]
  ds_read_b64_tr_b16 v[100:101], v22 offset:4096
  v_mfma_f32_16x16x32_bf16 v[156:159], v[52:55], v[44:47], v[156:159]
  ds_read_b64_tr_b16 v[102:103], v22 offset:4608
  v_mfma_f32_16x16x32_bf16 v[160:163], v[56:59], v[32:35], v[160:163]
  ds_read_b64_tr_b16 v[104:105], v23 offset:4096
  v_mfma_f32_16x16x32_bf16 v[164:167], v[56:59], v[36:39], v[164:167]
  ds_read_b64_tr_b16 v[106:107], v23 offset:4608
  v_mfma_f32_16x16x32_bf16 v[168:171], v[56:59], v[40:43], v[168:171]
  ds_read_b64_tr_b16 v[108:109], v24 offset:4096
  v_mfma_f32_16x16x32_bf16 v[172:175], v[56:59], v[44:47], v[172:175]
  ds_read_b64_tr_b16 v[110:111], v24 offset:4608
  v_mfma_f32_16x16x32_bf16 v[176:179], v[60:63], v[32:35], v[176:179]
  ds_read_b64_tr_b16 v[112:113], v21 offset:12288
  v_mfma_f32_16x16x32_bf16 v[180:183], v[60:63], v[36:39], v[180:183]
  ds_read_b64_tr_b16 v[114:115], v21 offset:12800
  v_mfma_f32_16x16x32_bf16 v[184:187], v[60:63], v[40:43], v[184:187]
  ds_read_b64_tr_b16 v[116:117], v22 offset:12288
  v_mfma_f32_16x16x32_bf16 v[188:191], v[60:63], v[44:47], v[188:191]
  ds_read_b64_tr_b16 v[118:119], v22 offset:12800
  v_mfma_f32_16x16x32_bf16 v[192:195], v[64:67], v[32:35], v[192:195]
  ds_read_b64_tr_b16 v[120:121], v25 offset:4096
  v_mfma_f32_16x16x32_bf16 v[196:199], v[64:67], v[36:39], v[196:199]
  ds_read_b64_tr_b16 v[122:123], v25 offset:4608
  v_mfma_f32_16x16x32_bf16 v[200:203], v[64:67], v[40:43], v[200:203]
  v_add_u32_e64 v20, s75, v4
  v_mfma_f32_16x16x32_bf16 v[204:207], v[64:67], v[44:47], v[204:207]
  v_add_u32_e64 v21, s75, v5
  v_mfma_f32_16x16x32_bf16 v[208:211], v[68:71], v[32:35], v[208:211]
  v_add_u32_e64 v22, s75, v6
  v_mfma_f32_16x16x32_bf16 v[212:215], v[68:71], v[36:39], v[212:215]
  v_add_u32_e64 v23, s75, v7
  v_mfma_f32_16x16x32_bf16 v[216:219], v[68:71], v[40:43], v[216:219]
  v_add_u32_e64 v24, s75, v8
  v_mfma_f32_16x16x32_bf16 v[220:223], v[68:71], v[44:47], v[220:223]
  v_add_u32_e64 v25, s75, v9
  v_mfma_f32_16x16x32_bf16 v[224:227], v[72:75], v[32:35], v[224:227]
  s_add_u32 s75, s75, 49152
  v_mfma_f32_16x16x32_bf16 v[228:231], v[72:75], v[36:39], v[228:231]
  s_cmp_eq_u32 s75, 147456
  v_mfma_f32_16x16x32_bf16 v[232:235], v[72:75], v[40:43], v[232:235]
  s_cselect_b32 s75, 0, s75
  s_sub_u32 s79, s79, 1
  v_mfma_f32_16x16x32_bf16 v[236:239], v[72:75], v[44:47], v[236:239]
  s_waitcnt lgkmcnt(0)
  s_barrier
  v_mfma_f32_16x16x32_bf16 v[128:131], v[96:99], v[80:83], v[128:131]
  ds_read_b128 v[32:35], v20 offset:0
  v_mfma_f32_16x16x32_bf16 v[132:135], v[96:99], v[84:87], v[132:135]
  ds_read_b128 v[36:39], v20 offset:2048
  v_mfma_f32_16x16x32_bf16 v[136:139], v[96:99], v[88:91], v[136:139]
  ds_read_b128 v[40:43], v20 offset:4096
  v_mfma_f32_16x16x32_bf16 v[140:143], v[96:99], v[92:95], v[140:143]
  ds_read_b128 v[44:47], v20 offset:6144
  v_mfma_f32_16x16x32_bf16 v[144:147], v[100:103], v[80:83], v[144:147]
  ds_read_b64_tr_b16 v[48:49], v21 offset:0
  v_mfma_f32_16x16x32_bf16 v[148:151], v[100:103], v[84:87], v[148:151]
  ds_read_b64_tr_b16 v[50:51], v21 offset:512
  v_mfma_f32_16x16x32_bf16 v[152:155], v[100:103], v[88:91], v[152:155]
  ds_read_b64_tr_b16 v[52:53], v22 offset:0
  v_mfma_f32_16x16x32_bf16 v[156:159], v[100:103], v[92:95], v[156:159]
  ds_read_b64_tr_b16 v[54:55], v22 offset:512
  v_mfma_f32_16x16x32_bf16 v[160:163], v[104:107], v[80:83], v[160:163]
  ds_read_b64_tr_b16 v[56:57], v23 offset:0
  v_mfma_f32_16x16x32_bf16 v[164:167], v[104:107], v[84:87], v[164:167]
  ds_read_b64_tr_b16 v[58:59], v23 offset:512
  v_mfma_f32_16x16x32_bf16 v[168:171], v[104:107], v[88:91], v[168:171]
  ds_read_b64_tr_b16 v[60:61], v24 offset:0
  v_mfma_f32_16x16x32_bf16 v[172:175], v[104:107], v[92:95], v[172:175]
  ds_read_b64_tr_b16 v[62:63], v24 offset:512
  v_mfma_f32_16x16x32_bf16 v[176:179], v[108:111], v[80:83], v[176:179]
  ds_read_b64_tr_b16 v[64:65], v21 offset:8192
  v_mfma_f32_16x16x32_bf16 v[180:183], v[108:111], v[84:87], v[180:183]
  ds_read_b64_tr_b16 v[66:67], v21 offset:8704
  v_mfma_f32_16x16x32_bf16 v[184:187], v[108:111], v[88:91], v[184:187]
  ds_read_b64_tr_b16 v[68:69], v22 offset:8192
  v_mfma_f32_16x16x32_bf16 v[188:191], v[108:111], v[92:95], v[188:191]
  ds_read_b64_tr_b16 v[70:71], v22 offset:8704
  v_mfma_f32_16x16x32_bf16 v[192:195], v[112:115], v[80:83], v[192:195]
  ds_read_b64_tr_b16 v[72:73], v25 offset:0
  v_mfma_f32_16x16x32_bf16 v[196:199], v[112:115], v[84:87], v[196:199]
  ds_read_b64_tr_b16 v[74:75], v25 offset:512
  v_mfma_f32_16x16x32_bf16 v[200:203], v[112:115], v[88:91], v[200:203]
  s_cmp_lg_u32 s79, 0
  s_nop 0
  v_mfma_f32_16x16x32_bf16 v[204:207], v[112:115], v[92:95], v[204:207]
  v_mfma_f32_16x16x32_bf16 v[208:211], v[116:119], v[80:83], v[208:211]
  v_mfma_f32_16x16x32_bf16 v[212:215], v[116:119], v[84:87], v[212:215]
  v_mfma_f32_16x16x32_bf16 v[216:219], v[116:119], v[88:91], v[216:219]
  v_mfma_f32_16x16x32_bf16 v[220:223], v[116:119], v[92:95], v[220:223]
  v_mfma_f32_16x16x32_bf16 v[224:227], v[120:123], v[80:83], v[224:227]
  v_mfma_f32_16x16x32_bf16 v[228:231], v[120:123], v[84:87], v[228:231]
  v_mfma_f32_16x16x32_bf16 v[232:235], v[120:123], v[88:91], v[232:235]
  v_mfma_f32_16x16x32_bf16 v[236:239], v[120:123], v[92:95], v[236:239]
  s_waitcnt lgkmcnt(0)
  s_cbranch_scc1 L_w1_loop
L_w1_exit:
  ds_read2_b32 v[88:89], v14 offset0:0 offset1:160
  ds_read2_b32 v[90:91], v14 offset0:16 offset1:176
  ds_read2_b32 v[92:93], v14 offset0:32 offset1:192
  ds_read2_b32 v[94:95], v14 offset0:48 offset1:208
  ds_read_b128 v[32:35], v15 offset:0
  ds_read_b128 v[60:63], v15 offset:1024
  ds_read_b128 v[36:39], v15 offset:64
  ds_read_b128 v[64:67], v15 offset:1088
  ds_read_b128 v[40:43], v15 offset:128
  ds_read_b128 v[68:71], v15 offset:1152
  ds_read_b128 v[44:47], v15 offset:192
  ds_read_b128 v[72:75], v15 offset:1216
  ds_read_b128 v[48:51], v15 offset:256
  ds_read_b128 v[76:79], v15 offset:1280
  ds_read_b128 v[52:55], v15 offset:320
  ds_read_b128 v[80:83], v15 offset:1344
  ds_read_b128 v[56:59], v16 offset:384
  ds_read_b128 v[84:87], v16 offset:1408
  v_mov_b32 v96, 0xc0135761
  v_mov_b32 v97, 0xbdd2d3e8
  v_mov_b32 v98, 1.0
  s_waitcnt lgkmcnt(0)
  v_mul_f32 v88, v88, v89
  v_mul_f32 v90, v90, v91
  v_mul_f32 v92, v92, v93
  v_mul_f32 v94, v94, v95
  v_pk_fma_f32 v[100:101], v[32:33], v[88:89], v[60:61] op_sel:[0,0,0] op_sel_hi:[1,0,1] neg_lo:[0,1,0] neg_hi:[0,1,0]
  v_pk_fma_f32 v[102:103], v[34:35], v[88:89], v[62:63] op_sel:[0,0,0] op_sel_hi:[1,0,1] neg_lo:[0,1,0] neg_hi:[0,1,0]
  v_pk_fma_f32 v[128:129], v[128:129], v[88:89], v[100:101] op_sel:[0,1,0] op_sel_hi:[1,1,1]
  v_pk_fma_f32 v[130:131], v[130:131], v[88:89], v[102:103] op_sel:[0,1,0] op_sel_hi:[1,1,1]
  v_pk_mul_f32 v[100:101], v[128:129], v[128:129]
  v_pk_mul_f32 v[102:103], v[130:131], v[130:131]
  v_pk_fma_f32 v[100:101], v[100:101], v[96:97], v[96:97] op_sel:[0,1,0] op_sel_hi:[1,1,0]
  v_pk_fma_f32 v[102:103], v[102:103], v[96:97], v[96:97] op_sel:[0,1,0] op_sel_hi:[1,1,0]
  v_pk_mul_f32 v[100:101], v[100:101], v[128:129]
  v_pk_mul_f32 v[102:103], v[102:103], v[130:131]
  v_exp_f32 v100, v100
  v_exp_f32 v101, v101
  v_exp_f32 v102, v102
  v_exp_f32 v103, v103
  v_pk_add_f32 v[100:101], v[100:101], v[98:99] op_sel_hi:[1,0]
  v_pk_add_f32 v[102:103], v[102:103], v[98:99] op_sel_hi:[1,0]
  v_rcp_f32 v100, v100
  v_rcp_f32 v101, v101
  v_rcp_f32 v102, v102
  v_rcp_f32 v103, v103
  v_pk_mul_f32 v[128:129], v[128:129], v[100:101]
  v_pk_mul_f32 v[130:131], v[130:131], v[102:103]
  v_cvt_pk_bf16_f32 v108, v128, v129
  v_cvt_pk_bf16_f32 v109, v130, v131
  v_pk_fma_f32 v[104:105], v[36:37], v[88:89], v[64:65] op_sel:[0,0,0] op_sel_hi:[1,0,1] neg_lo:[0,1,0] neg_hi:[0,1,0]
  v_pk_fma_f32 v[106:107], v[38:39], v[88:89], v[66:67] op_sel:[0,0,0] op_sel_hi:[1,0,1] neg_lo:[0,1,0] neg_hi:[0,1,0]
  v_pk_fma_f32 v[144:145], v[144:145], v[88:89], v[104:105] op_sel:[0,1,0] op_sel_hi:[1,1,1]
  v_pk_fma_f32 v[146:147], v[146:147], v[88:89], v[106:107] op_sel:[0,1,0] op_sel_hi:[1,1,1]
  v_pk_mul_f32 v[104:105], v[144:145], v[144:145]
  v_pk_mul_f32 v[106:107], v[146:147], v[146:147]
  v_pk_fma_f32 v[104:105], v[104:105], v[96:97], v[96:97] op_sel:[0,1,0] op_sel_hi:[1,1,0]
  v_pk_fma_f32 v[106:107], v[106:107], v[96:97], v[96:97] op_sel:[0,1,0] op_sel_hi:[1,1,0]
  v_pk_mul_f32 v[104:105], v[104:105], v[144:145]
  v_pk_mul_f32 v[106:107], v[106:107], v[146:147]
  v_exp_f32 v104, v104
  v_exp_f32 v105, v105
  v_exp_f32 v106, v106
  v_exp_f32 v107, v107
  v_pk_add_f32 v[104:105], v[104:105], v[98:99] op_sel_hi:[1,0]
  v_pk_add_f32 v[106:107], v[106:107], v[98:99] op_sel_hi:[1,0]
  v_rcp_f32 v104, v104
  v_rcp_f32 v105, v105
  v_rcp_f32 v106, v106
  v_rcp_f32 v107, v107
  v_pk_mul_f32 v[144:145], v[144:145], v[104:105]
  v_pk_mul_f32 v[146:147], v[146:147], v[106:107]
  v_cvt_pk_bf16_f32 v110, v144, v145
  v_cvt_pk_bf16_f32 v111, v146, v147
  s_mov_b32 s3, 0
  s_nop 0
  v_permlane16_swap_b32 v108, v110
  v_permlane16_swap_b32 v109, v111
  buffer_store_dwordx4 v[108:111], v12, s[44:47], s3 offen sc1
  v_pk_fma_f32 v[100:101], v[40:41], v[88:89], v[68:69] op_sel:[0,0,0] op_sel_hi:[1,0,1] neg_lo:[0,1,0] neg_hi:[0,1,0]
  v_pk_fma_f32 v[102:103], v[42:43], v[88:89], v[70:71] op_sel:[0,0,0] op_sel_hi:[1,0,1] neg_lo:[0,1,0] neg_hi:[0,1,0]
  v_pk_fma_f32 v[160:161], v[160:161], v[88:89], v[100:101] op_sel:[0,1,0] op_sel_hi:[1,1,1]
  v_pk_fma_f32 v[162:163], v[162:163], v[88:89], v[102:103] op_sel:[0,1,0] op_sel_hi:[1,1,1]
  v_pk_mul_f32 v[100:101], v[160:161], v[160:161]
  v_pk_mul_f32 v[102:103], v[162:163], v[162:163]
  v_pk_fma_f32 v[100:101], v[100:101], v[96:97], v[96:97] op_sel:[0,1,0] op_sel_hi:[1,1,0]
  v_pk_fma_f32 v[102:103], v[102:103], v[96:97], v[96:97] op_sel:[0,1,0] op_sel_hi:[1,1,0]
  v_pk_mul_f32 v[100:101], v[100:101], v[160:161]
  v_pk_mul_f32 v[102:103], v[102:103], v[162:163]
  v_exp_f32 v100, v100
  v_exp_f32 v101, v101
  v_exp_f32 v102, v102
  v_exp_f32 v103, v103
  v_pk_add_f32 v[100:101], v[100:101], v[98:99] op_sel_hi:[1,0]
  v_pk_add_f32 v[102:103], v[102:103], v[98:99] op_sel_hi:[1,0]
  v_rcp_f32 v100, v100
  v_rcp_f32 v101, v101
  v_rcp_f32 v102, v102
  v_rcp_f32 v103, v103
  v_pk_mul_f32 v[160:161], v[160:161], v[100:101]
  v_pk_mul_f32 v[162:163], v[162:163], v[102:103]
  v_cvt_pk_bf16_f32 v112, v160, v161
  v_cvt_pk_bf16_f32 v113, v162, v163
  v_pk_fma_f32 v[104:105], v[44:45], v[88:89], v[72:73] op_sel:[0,0,0] op_sel_hi:[1,0,1] neg_lo:[0,1,0] neg_hi:[0,1,0]
  v_pk_fma_f32 v[106:107], v[46:47], v[88:89], v[74:75] op_sel:[0,0,0] op_sel_hi:[1,0,1] neg_lo:[0,1,0] neg_hi:[0,1,0]
  v_pk_fma_f32 v[176:177], v[176:177], v[88:89], v[104:105] op_sel:[0,1,0] op_sel_hi:[1,1,1]
  v_pk_fma_f32 v[178:179], v[178:179], v[88:89], v[106:107] op_sel:[0,1,0] op_sel_hi:[1,1,1]
  v_pk_mul_f32 v[104:105], v[176:177], v[176:177]
  v_pk_mul_f32 v[106:107], v[178:179], v[178:179]
  v_pk_fma_f32 v[104:105], v[104:105], v[96:97], v[96:97] op_sel:[0,1,0] op_sel_hi:[1,1,0]
  v_pk_fma_f32 v[106:107], v[106:107], v[96:97], v[96:97] op_sel:[0,1,0] op_sel_hi:[1,1,0]
  v_pk_mul_f32 v[104:105], v[104:105], v[176:177]
  v_pk_mul_f32 v[106:107], v[106:107], v[178:179]
  v_exp_f32 v104, v104
  v_exp_f32 v105, v105
  v_exp_f32 v106, v106
  v_exp_f32 v107, v107
  v_pk_add_f32 v[104:105], v[104:105], v[98:99] op_sel_hi:[1,0]
  v_pk_add_f32 v[106:107], v[106:107], v[98:99] op_sel_hi:[1,0]
  v_rcp_f32 v104, v104
  v_rcp_f32 v105, v105
  v_rcp_f32 v106, v106
  v_rcp_f32 v107, v107
  v_pk_mul_f32 v[176:177], v[176:177], v[104:105]
  v_pk_mul_f32 v[178:179], v[178:179], v[106:107]
  v_cvt_pk_bf16_f32 v114, v176, v177
  v_cvt_pk_bf16_f32 v115, v178, v179
  s_mov_b32 s3, 1024
  s_nop 0
  v_permlane16_swap_b32 v112, v114
  v_permlane16_swap_b32 v113, v115
  buffer_store_dwordx4 v[112:115], v12, s[44:47], s3 offen sc1
  v_pk_fma_f32 v[100:101], v[48:49], v[88:89], v[76:77] op_sel:[0,0,0] op_sel_hi:[1,0,1] neg_lo:[0,1,0] neg_hi:[0,1,0]
  v_pk_fma_f32 v[102:103], v[50:51], v[88:89], v[78:79] op_sel:[0,0,0] op_sel_hi:[1,0,1] neg_lo:[0,1,0] neg_hi:[0,1,0]
  v_pk_fma_f32 v[192:193], v[192:193], v[88:89], v[100:101] op_sel:[0,1,0] op_sel_hi:[1,1,1]
  v_pk_fma_f32 v[194:195], v[194:195], v[88:89], v[102:103] op_sel:[0,1,0] op_sel_hi:[1,1,1]
  v_pk_mul_f32 v[100:101], v[192:193], v[192:193]
  v_pk_mul_f32 v[102:103], v[194:195], v[194:195]
  v_pk_fma_f32 v[100:101], v[100:101], v[96:97], v[96:97] op_sel:[0,1,0] op_sel_hi:[1,1,0]
  v_pk_fma_f32 v[102:103], v[102:103], v[96:97], v[96:97] op_sel:[0,1,0] op_sel_hi:[1,1,0]
  v_pk_mul_f32 v[100:101], v[100:101], v[192:193]
  v_pk_mul_f32 v[102:103], v[102:103], v[194:195]
  v_exp_f32 v100, v100
  v_exp_f32 v101, v101
  v_exp_f32 v102, v102
  v_exp_f32 v103, v103
  v_pk_add_f32 v[100:101], v[100:101], v[98:99] op_sel_hi:[1,0]
  v_pk_add_f32 v[102:103], v[102:103], v[98:99] op_sel_hi:[1,0]
  v_rcp_f32 v100, v100
  v_rcp_f32 v101, v101
  v_rcp_f32 v102, v102
  v_rcp_f32 v103, v103
  v_pk_mul_f32 v[192:193], v[192:193], v[100:101]
  v_pk_mul_f32 v[194:195], v[194:195], v[102:103]
  v_cvt_pk_bf16_f32 v116, v192, v193
  v_cvt_pk_bf16_f32 v117, v194, v195
  v_pk_fma_f32 v[104:105], v[52:53], v[88:89], v[80:81] op_sel:[0,0,0] op_sel_hi:[1,0,1] neg_lo:[0,1,0] neg_hi:[0,1,0]
  v_pk_fma_f32 v[106:107], v[54:55], v[88:89], v[82:83] op_sel:[0,0,0] op_sel_hi:[1,0,1] neg_lo:[0,1,0] neg_hi:[0,1,0]
  v_pk_fma_f32 v[208:209], v[208:209], v[88:89], v[104:105] op_sel:[0,1,0] op_sel_hi:[1,1,1]
  v_pk_fma_f32 v[210:211], v[210:211], v[88:89], v[106:107] op_sel:[0,1,0] op_sel_hi:[1,1,1]
  v_pk_mul_f32 v[104:105], v[208:209], v[208:209]
  v_pk_mul_f32 v[106:107], v[210:211], v[210:211]
  v_pk_fma_f32 v[104:105], v[104:105], v[96:97], v[96:97] op_sel:[0,1,0] op_sel_hi:[1,1,0]
  v_pk_fma_f32 v[106:107], v[106:107], v[96:97], v[96:97] op_sel:[0,1,0] op_sel_hi:[1,1,0]
  v_pk_mul_f32 v[104:105], v[104:105], v[208:209]
  v_pk_mul_f32 v[106:107], v[106:107], v[210:211]
  v_exp_f32 v104, v104
  v_exp_f32 v105, v105
  v_exp_f32 v106, v106
  v_exp_f32 v107, v107
  v_pk_add_f32 v[104:105], v[104:105], v[98:99] op_sel_hi:[1,0]
  v_pk_add_f32 v[106:107], v[106:107], v[98:99] op_sel_hi:[1,0]
  v_rcp_f32 v104, v104
  v_rcp_f32 v105, v105
  v_rcp_f32 v106, v106
  v_rcp_f32 v107, v107
  v_pk_mul_f32 v[208:209], v[208:209], v[104:105]
  v_pk_mul_f32 v[210:211], v[210:211], v[106:107]
  v_cvt_pk_bf16_f32 v118, v208, v209
  v_cvt_pk_bf16_f32 v119, v210, v211
  s_mov_b32 s3, 2048
  s_nop 0
  v_permlane16_swap_b32 v116, v118
  v_permlane16_swap_b32 v117, v119
  buffer_store_dwordx4 v[116:119], v12, s[44:47], s3 offen sc1
  v_pk_fma_f32 v[100:101], v[32:33], v[90:91], v[60:61] op_sel:[0,0,0] op_sel_hi:[1,0,1] neg_lo:[0,1,0] neg_hi:[0,1,0]
  v_pk_fma_f32 v[102:103], v[34:35], v[90:91], v[62:63] op_sel:[0,0,0] op_sel_hi:[1,0,1] neg_lo:[0,1,0] neg_hi:[0,1,0]
  v_pk_fma_f32 v[132:133], v[132:133], v[90:91], v[100:101] op_sel:[0,1,0] op_sel_hi:[1,1,1]
  v_pk_fma_f32 v[134:135], v[134:135], v[90:91], v[102:103] op_sel:[0,1,0] op_sel_hi:[1,1,1]
  v_pk_mul_f32 v[100:101], v[132:133], v[132:133]
  v_pk_mul_f32 v[102:103], v[134:135], v[134:135]
  v_pk_fma_f32 v[100:101], v[100:101], v[96:97], v[96:97] op_sel:[0,1,0] op_sel_hi:[1,1,0]
  v_pk_fma_f32 v[102:103], v[102:103], v[96:97], v[96:97] op_sel:[0,1,0] op_sel_hi:[1,1,0]
  v_pk_mul_f32 v[100:101], v[100:101], v[132:133]
  v_pk_mul_f32 v[102:103], v[102:103], v[134:135]
  v_exp_f32 v100, v100
  v_exp_f32 v101, v101
  v_exp_f32 v102, v102
  v_exp_f32 v103, v103
  v_pk_add_f32 v[100:101], v[100:101], v[98:99] op_sel_hi:[1,0]
  v_pk_add_f32 v[102:103], v[102:103], v[98:99] op_sel_hi:[1,0]
  v_rcp_f32 v100, v100
  v_rcp_f32 v101, v101
  v_rcp_f32 v102, v102
  v_rcp_f32 v103, v103
  v_pk_mul_f32 v[132:133], v[132:133], v[100:101]
  v_pk_mul_f32 v[134:135], v[134:135], v[102:103]
  v_cvt_pk_bf16_f32 v120, v132, v133
  v_cvt_pk_bf16_f32 v121, v134, v135
  v_pk_fma_f32 v[104:105], v[36:37], v[90:91], v[64:65] op_sel:[0,0,0] op_sel_hi:[1,0,1] neg_lo:[0,1,0] neg_hi:[0,1,0]
  v_pk_fma_f32 v[106:107], v[38:39], v[90:91], v[66:67] op_sel:[0,0,0] op_sel_hi:[1,0,1] neg_lo:[0,1,0] neg_hi:[0,1,0]
  v_pk_fma_f32 v[148:149], v[148:149], v[90:91], v[104:105] op_sel:[0,1,0] op_sel_hi:[1,1,1]
  v_pk_fma_f32 v[150:151], v[150:151], v[90:91], v[106:107] op_sel:[0,1,0] op_sel_hi:[1,1,1]
  v_pk_mul_f32 v[104:105], v[148:149], v[148:149]
  v_pk_mul_f32 v[106:107], v[150:151], v[150:151]
  v_pk_fma_f32 v[104:105], v[104:105], v[96:97], v[96:97] op_sel:[0,1,0] op_sel_hi:[1,1,0]
  v_pk_fma_f32 v[106:107], v[106:107], v[96:97], v[96:97] op_sel:[0,1,0] op_sel_hi:[1,1,0]
  v_pk_mul_f32 v[104:105], v[104:105], v[148:149]
  v_pk_mul_f32 v[106:107], v[106:107], v[150:151]
  v_exp_f32 v104, v104
  v_exp_f32 v105, v105
  v_exp_f32 v106, v106
  v_exp_f32 v107, v107
  v_pk_add_f32 v[104:105], v[104:105], v[98:99] op_sel_hi:[1,0]
  v_pk_add_f32 v[106:107], v[106:107], v[98:99] op_sel_hi:[1,0]
  v_rcp_f32 v104, v104
  v_rcp_f32 v105, v105
  v_rcp_f32 v106, v106
  v_rcp_f32 v107, v107
  v_pk_mul_f32 v[148:149], v[148:149], v[104:105]
  v_pk_mul_f32 v[150:151], v[150:151], v[106:107]
  v_cvt_pk_bf16_f32 v122, v148, v149
  v_cvt_pk_bf16_f32 v123, v150, v151
  s_mov_b32 s3, 114688
  s_nop 0
  v_permlane16_swap_b32 v120, v122
  v_permlane16_swap_b32 v121, v123
  buffer_store_dwordx4 v[120:123], v12, s[44:47], s3 offen sc1
  v_pk_fma_f32 v[100:101], v[40:41], v[90:91], v[68:69] op_sel:[0,0,0] op_sel_hi:[1,0,1] neg_lo:[0,1,0] neg_hi:[0,1,0]
  v_pk_fma_f32 v[102:103], v[42:43], v[90:91], v[70:71] op_sel:[0,0,0] op_sel_hi:[1,0,1] neg_lo:[0,1,0] neg_hi:[0,1,0]
  v_pk_fma_f32 v[164:165], v[164:165], v[90:91], v[100:101] op_sel:[0,1,0] op_sel_hi:[1,1,1]
  v_pk_fma_f32 v[166:167], v[166:167], v[90:91], v[102:103] op_sel:[0,1,0] op_sel_hi:[1,1,1]
  v_pk_mul_f32 v[100:101], v[164:165], v[164:165]
  v_pk_mul_f32 v[102:103], v[166:167], v[166:167]
  v_pk_fma_f32 v[100:101], v[100:101], v[96:97], v[96:97] op_sel:[0,1,0] op_sel_hi:[1,1,0]
  v_pk_fma_f32 v[102:103], v[102:103], v[96:97], v[96:97] op_sel:[0,1,0] op_sel_hi:[1,1,0]
  v_pk_mul_f32 v[100:101], v[100:101], v[164:165]
  v_pk_mul_f32 v[102:103], v[102:103], v[166:167]
  v_exp_f32 v100, v100
  v_exp_f32 v101, v101
  v_exp_f32 v102, v102
  v_exp_f32 v103, v103
  v_pk_add_f32 v[100:101], v[100:101], v[98:99] op_sel_hi:[1,0]
  v_pk_add_f32 v[102:103], v[102:103], v[98:99] op_sel_hi:[1,0]
  v_rcp_f32 v100, v100
  v_rcp_f32 v101, v101
  v_rcp_f32 v102, v102
  v_rcp_f32 v103, v103
  v_pk_mul_f32 v[164:165], v[164:165], v[100:101]
  v_pk_mul_f32 v[166:167], v[166:167], v[102:103]
  v_cvt_pk_bf16_f32 v108, v164, v165
  v_cvt_pk_bf16_f32 v109, v166, v167
  v_pk_fma_f32 v[104:105], v[44:45], v[90:91], v[72:73] op_sel:[0,0,0] op_sel_hi:[1,0,1] neg_lo:[0,1,0] neg_hi:[0,1,0]
  v_pk_fma_f32 v[106:107], v[46:47], v[90:91], v[74:75] op_sel:[0,0,0] op_sel_hi:[1,0,1] neg_lo:[0,1,0] neg_hi:[0,1,0]
  v_pk_fma_f32 v[180:181], v[180:181], v[90:91], v[104:105] op_sel:[0,1,0] op_sel_hi:[1,1,1]
  v_pk_fma_f32 v[182:183], v[182:183], v[90:91], v[106:107] op_sel:[0,1,0] op_sel_hi:[1,1,1]
  v_pk_mul_f32 v[104:105], v[180:181], v[180:181]
  v_pk_mul_f32 v[106:107], v[182:183], v[182:183]
  v_pk_fma_f32 v[104:105], v[104:105], v[96:97], v[96:97] op_sel:[0,1,0] op_sel_hi:[1,1,0]
  v_pk_fma_f32 v[106:107], v[106:107], v[96:97], v[96:97] op_sel:[0,1,0] op_sel_hi:[1,1,0]
  v_pk_mul_f32 v[104:105], v[104:105], v[180:181]
  v_pk_mul_f32 v[106:107], v[106:107], v[182:183]
  v_exp_f32 v104, v104
  v_exp_f32 v105, v105
  v_exp_f32 v106, v106
  v_exp_f32 v107, v107
  v_pk_add_f32 v[104:105], v[104:105], v[98:99] op_sel_hi:[1,0]
  v_pk_add_f32 v[106:107], v[106:107], v[98:99] op_sel_hi:[1,0]
  v_rcp_f32 v104, v104
  v_rcp_f32 v105, v105
  v_rcp_f32 v106, v106
  v_rcp_f32 v107, v107
  v_pk_mul_f32 v[180:181], v[180:181], v[104:105]
  v_pk_mul_f32 v[182:183], v[182:183], v[106:107]
  v_cvt_pk_bf16_f32 v110, v180, v181
  v_cvt_pk_bf16_f32 v111, v182, v183
  s_mov_b32 s3, 115712
  s_nop 0
  v_permlane16_swap_b32 v108, v110
  v_permlane16_swap_b32 v109, v111
  buffer_store_dwordx4 v[108:111], v12, s[44:47], s3 offen sc1
  v_pk_fma_f32 v[100:101], v[48:49], v[90:91], v[76:77] op_sel:[0,0,0] op_sel_hi:[1,0,1] neg_lo:[0,1,0] neg_hi:[0,1,0]
  v_pk_fma_f32 v[102:103], v[50:51], v[90:91], v[78:79] op_sel:[0,0,0] op_sel_hi:[1,0,1] neg_lo:[0,1,0] neg_hi:[0,1,0]
  v_pk_fma_f32 v[196:197], v[196:197], v[90:91], v[100:101] op_sel:[0,1,0] op_sel_hi:[1,1,1]
  v_pk_fma_f32 v[198:199], v[198:199], v[90:91], v[102:103] op_sel:[0,1,0] op_sel_hi:[1,1,1]
  v_pk_mul_f32 v[100:101], v[196:197], v[196:197]
  v_pk_mul_f32 v[102:103], v[198:199], v[198:199]
  v_pk_fma_f32 v[100:101], v[100:101], v[96:97], v[96:97] op_sel:[0,1,0] op_sel_hi:[1,1,0]
  v_pk_fma_f32 v[102:103], v[102:103], v[96:97], v[96:97] op_sel:[0,1,0] op_sel_hi:[1,1,0]
  v_pk_mul_f32 v[100:101], v[100:101], v[196:197]
  v_pk_mul_f32 v[102:103], v[102:103], v[198:199]
  v_exp_f32 v100, v100
  v_exp_f32 v101, v101
  v_exp_f32 v102, v102
  v_exp_f32 v103, v103
  v_pk_add_f32 v[100:101], v[100:101], v[98:99] op_sel_hi:[1,0]
  v_pk_add_f32 v[102:103], v[102:103], v[98:99] op_sel_hi:[1,0]
  v_rcp_f32 v100, v100
  v_rcp_f32 v101, v101
  v_rcp_f32 v102, v102
  v_rcp_f32 v103, v103
  v_pk_mul_f32 v[196:197], v[196:197], v[100:101]
  v_pk_mul_f32 v[198:199], v[198:199], v[102:103]
  v_cvt_pk_bf16_f32 v112, v196, v197
  v_cvt_pk_bf16_f32 v113, v198, v199
  v_pk_fma_f32 v[104:105], v[52:53], v[90:91], v[80:81] op_sel:[0,0,0] op_sel_hi:[1,0,1] neg_lo:[0,1,0] neg_hi:[0,1,0]
  v_pk_fma_f32 v[106:107], v[54:55], v[90:91], v[82:83] op_sel:[0,0,0] op_sel_hi:[1,0,1] neg_lo:[0,1,0] neg_hi:[0,1,0]
  v_pk_fma_f32 v[212:213], v[212:213], v[90:91], v[104:105] op_sel:[0,1,0] op_sel_hi:[1,1,1]
  v_pk_fma_f32 v[214:215], v[214:215], v[90:91], v[106:107] op_sel:[0,1,0] op_sel_hi:[1,1,1]
  v_pk_mul_f32 v[104:105], v[212:213], v[212:213]
  v_pk_mul_f32 v[106:107], v[214:215], v[214:215]
  v_pk_fma_f32 v[104:105], v[104:105], v[96:97], v[96:97] op_sel:[0,1,0] op_sel_hi:[1,1,0]
  v_pk_fma_f32 v[106:107], v[106:107], v[96:97], v[96:97] op_sel:[0,1,0] op_sel_hi:[1,1,0]
  v_pk_mul_f32 v[104:105], v[104:105], v[212:213]
  v_pk_mul_f32 v[106:107], v[106:107], v[214:215]
  v_exp_f32 v104, v104
  v_exp_f32 v105, v105
  v_exp_f32 v106, v106
  v_exp_f32 v107, v107
  v_pk_add_f32 v[104:105], v[104:105], v[98:99] op_sel_hi:[1,0]
  v_pk_add_f32 v[106:107], v[106:107], v[98:99] op_sel_hi:[1,0]
  v_rcp_f32 v104, v104
  v_rcp_f32 v105, v105
  v_rcp_f32 v106, v106
  v_rcp_f32 v107, v107
  v_pk_mul_f32 v[212:213], v[212:213], v[104:105]
  v_pk_mul_f32 v[214:215], v[214:215], v[106:107]
  v_cvt_pk_bf16_f32 v114, v212, v213
  v_cvt_pk_bf16_f32 v115, v214, v215
  s_mov_b32 s3, 116736
  s_nop 0
  v_permlane16_swap_b32 v112, v114
  v_permlane16_swap_b32 v113, v115
  buffer_store_dwordx4 v[112:115], v12, s[44:47], s3 offen sc1
  v_pk_fma_f32 v[100:101], v[56:57], v[88:89], v[84:85] op_sel:[0,0,0] op_sel_hi:[1,0,1] neg_lo:[0,1,0] neg_hi:[0,1,0]
  v_pk_fma_f32 v[102:103], v[58:59], v[88:89], v[86:87] op_sel:[0,0,0] op_sel_hi:[1,0,1] neg_lo:[0,1,0] neg_hi:[0,1,0]
  v_pk_fma_f32 v[224:225], v[224:225], v[88:89], v[100:101] op_sel:[0,1,0] op_sel_hi:[1,1,1]
  v_pk_fma_f32 v[226:227], v[226:227], v[88:89], v[102:103] op_sel:[0,1,0] op_sel_hi:[1,1,1]
  v_pk_mul_f32 v[100:101], v[224:225], v[224:225]
  v_pk_mul_f32 v[102:103], v[226:227], v[226:227]
  v_pk_fma_f32 v[100:101], v[100:101], v[96:97], v[96:97] op_sel:[0,1,0] op_sel_hi:[1,1,0]
  v_pk_fma_f32 v[102:103], v[102:103], v[96:97], v[96:97] op_sel:[0,1,0] op_sel_hi:[1,1,0]
  v_pk_mul_f32 v[100:101], v[100:101], v[224:225]
  v_pk_mul_f32 v[102:103], v[102:103], v[226:227]
  v_exp_f32 v100, v100
  v_exp_f32 v101, v101
  v_exp_f32 v102, v102
  v_exp_f32 v103, v103
  v_pk_add_f32 v[100:101], v[100:101], v[98:99] op_sel_hi:[1,0]
  v_pk_add_f32 v[102:103], v[102:103], v[98:99] op_sel_hi:[1,0]
  v_rcp_f32 v100, v100
  v_rcp_f32 v101, v101
  v_rcp_f32 v102, v102
  v_rcp_f32 v103, v103
  v_pk_mul_f32 v[224:225], v[224:225], v[100:101]
  v_pk_mul_f32 v[226:227], v[226:227], v[102:103]
  v_cvt_pk_bf16_f32 v116, v224, v225
  v_cvt_pk_bf16_f32 v117, v226, v227
  v_pk_fma_f32 v[100:101], v[56:57], v[90:91], v[84:85] op_sel:[0,0,0] op_sel_hi:[1,0,1] neg_lo:[0,1,0] neg_hi:[0,1,0]
  v_pk_fma_f32 v[102:103], v[58:59], v[90:91], v[86:87] op_sel:[0,0,0] op_sel_hi:[1,0,1] neg_lo:[0,1,0] neg_hi:[0,1,0]
  v_pk_fma_f32 v[228:229], v[228:229], v[90:91], v[100:101] op_sel:[0,1,0] op_sel_hi:[1,1,1]
  v_pk_fma_f32 v[230:231], v[230:231], v[90:91], v[102:103] op_sel:[0,1,0] op_sel_hi:[1,1,1]
  v_pk_mul_f32 v[100:101], v[228:229], v[228:229]
  v_pk_mul_f32 v[102:103], v[230:231], v[230:231]
  v_pk_fma_f32 v[100:101], v[100:101], v[96:97], v[96:97] op_sel:[0,1,0] op_sel_hi:[1,1,0]
  v_pk_fma_f32 v[102:103], v[102:103], v[96:97], v[96:97] op_sel:[0,1,0] op_sel_hi:[1,1,0]
  v_pk_mul_f32 v[100:101], v[100:101], v[228:229]
  v_pk_mul_f32 v[102:103], v[102:103], v[230:231]
  v_exp_f32 v100, v100
  v_exp_f32 v101, v101
  v_exp_f32 v102, v102
  v_exp_f32 v103, v103
  v_pk_add_f32 v[100:101], v[100:101], v[98:99] op_sel_hi:[1,0]
  v_pk_add_f32 v[102:103], v[102:103], v[98:99] op_sel_hi:[1,0]
  v_rcp_f32 v100, v100
  v_rcp_f32 v101, v101
  v_rcp_f32 v102, v102
  v_rcp_f32 v103, v103
  v_pk_mul_f32 v[228:229], v[228:229], v[100:101]
  v_pk_mul_f32 v[230:231], v[230:231], v[102:103]
  v_cvt_pk_bf16_f32 v118, v228, v229
  v_cvt_pk_bf16_f32 v119, v230, v231
  s_mov_b32 s3, 3072
  s_nop 0
  v_permlane16_swap_b32 v116, v118
  v_permlane16_swap_b32 v117, v119
  buffer_store_dwordx4 v[116:119], v13, s[44:47], s3 offen sc1
  v_pk_fma_f32 v[100:101], v[32:33], v[92:93], v[60:61] op_sel:[0,0,0] op_sel_hi:[1,0,1] neg_lo:[0,1,0] neg_hi:[0,1,0]
  v_pk_fma_f32 v[102:103], v[34:35], v[92:93], v[62:63] op_sel:[0,0,0] op_sel_hi:[1,0,1] neg_lo:[0,1,0] neg_hi:[0,1,0]
  v_pk_fma_f32 v[136:137], v[136:137], v[92:93], v[100:101] op_sel:[0,1,0] op_sel_hi:[1,1,1]
  v_pk_fma_f32 v[138:139], v[138:139], v[92:93], v[102:103] op_sel:[0,1,0] op_sel_hi:[1,1,1]
  v_pk_mul_f32 v[100:101], v[136:137], v[136:137]
  v_pk_mul_f32 v[102:103], v[138:139], v[138:139]
  v_pk_fma_f32 v[100:101], v[100:101], v[96:97], v[96:97] op_sel:[0,1,0] op_sel_hi:[1,1,0]
  v_pk_fma_f32 v[102:103], v[102:103], v[96:97], v[96:97] op_sel:[0,1,0] op_sel_hi:[1,1,0]
  v_pk_mul_f32 v[100:101], v[100:101], v[136:137]
  v_pk_mul_f32 v[102:103], v[102:103], v[138:139]
  v_exp_f32 v100, v100
  v_exp_f32 v101, v101
  v_exp_f32 v102, v102
  v_exp_f32 v103, v103
  v_pk_add_f32 v[100:101], v[100:101], v[98:99] op_sel_hi:[1,0]
  v_pk_add_f32 v[102:103], v[102:103], v[98:99] op_sel_hi:[1,0]
  v_rcp_f32 v100, v100
  v_rcp_f32 v101, v101
  v_rcp_f32 v102, v102
  v_rcp_f32 v103, v103
  v_pk_mul_f32 v[136:137], v[136:137], v[100:101]
  v_pk_mul_f32 v[138:139], v[138:139], v[102:103]
  v_cvt_pk_bf16_f32 v120, v136, v137
  v_cvt_pk_bf16_f32 v121, v138, v139
  v_pk_fma_f32 v[104:105], v[36:37], v[92:93], v[64:65] op_sel:[0,0,0] op_sel_hi:[1,0,1] neg_lo:[0,1,0] neg_hi:[0,1,0]
  v_pk_fma_f32 v[106:107], v[38:39], v[92:93], v[66:67] op_sel:[0,0,0] op_sel_hi:[1,0,1] neg_lo:[0,1,0] neg_hi:[0,1,0]
  v_pk_fma_f32 v[152:153], v[152:153], v[92:93], v[104:105] op_sel:[0,1,0] op_sel_hi:[1,1,1]
  v_pk_fma_f32 v[154:155], v[154:155], v[92:93], v[106:107] op_sel:[0,1,0] op_sel_hi:[1,1,1]
  v_pk_mul_f32 v[104:105], v[152:153], v[152:153]
  v_pk_mul_f32 v[106:107], v[154:155], v[154:155]
  v_pk_fma_f32 v[104:105], v[104:105], v[96:97], v[96:97] op_sel:[0,1,0] op_sel_hi:[1,1,0]
  v_pk_fma_f32 v[106:107], v[106:107], v[96:97], v[96:97] op_sel:[0,1,0] op_sel_hi:[1,1,0]
  v_pk_mul_f32 v[104:105], v[104:105], v[152:153]
  v_pk_mul_f32 v[106:107], v[106:107], v[154:155]
  v_exp_f32 v104, v104
  v_exp_f32 v105, v105
  v_exp_f32 v106, v106
  v_exp_f32 v107, v107
  v_pk_add_f32 v[104:105], v[104:105], v[98:99] op_sel_hi:[1,0]
  v_pk_add_f32 v[106:107], v[106:107], v[98:99] op_sel_hi:[1,0]
  v_rcp_f32 v104, v104
  v_rcp_f32 v105, v105
  v_rcp_f32 v106, v106
  v_rcp_f32 v107, v107
  v_pk_mul_f32 v[152:153], v[152:153], v[104:105]
  v_pk_mul_f32 v[154:155], v[154:155], v[106:107]
  v_cvt_pk_bf16_f32 v122, v152, v153
  v_cvt_pk_bf16_f32 v123, v154, v155
  s_mov_b32 s3, 229376
  s_nop 0
  v_permlane16_swap_b32 v120, v122
  v_permlane16_swap_b32 v121, v123
  buffer_store_dwordx4 v[120:123], v12, s[44:47], s3 offen sc1
  v_pk_fma_f32 v[100:101], v[40:41], v[92:93], v[68:69] op_sel:[0,0,0] op_sel_hi:[1,0,1] neg_lo:[0,1,0] neg_hi:[0,1,0]
  v_pk_fma_f32 v[102:103], v[42:43], v[92:93], v[70:71] op_sel:[0,0,0] op_sel_hi:[1,0,1] neg_lo:[0,1,0] neg_hi:[0,1,0]
  v_pk_fma_f32 v[168:169], v[168:169], v[92:93], v[100:101] op_sel:[0,1,0] op_sel_hi:[1,1,1]
  v_pk_fma_f32 v[170:171], v[170:171], v[92:93], v[102:103] op_sel:[0,1,0] op_sel_hi:[1,1,1]
  v_pk_mul_f32 v[100:101], v[168:169], v[168:169]
  v_pk_mul_f32 v[102:103], v[170:171], v[170:171]
  v_pk_fma_f32 v[100:101], v[100:101], v[96:97], v[96:97] op_sel:[0,1,0] op_sel_hi:[1,1,0]
  v_pk_fma_f32 v[102:103], v[102:103], v[96:97], v[96:97] op_sel:[0,1,0] op_sel_hi:[1,1,0]
  v_pk_mul_f32 v[100:101], v[100:101], v[168:169]
  v_pk_mul_f32 v[102:103], v[102:103], v[170:171]
  v_exp_f32 v100, v100
  v_exp_f32 v101, v101
  v_exp_f32 v102, v102
  v_exp_f32 v103, v103
  v_pk_add_f32 v[100:101], v[100:101], v[98:99] op_sel_hi:[1,0]
  v_pk_add_f32 v[102:103], v[102:103], v[98:99] op_sel_hi:[1,0]
  v_rcp_f32 v100, v100
  v_rcp_f32 v101, v101
  v_rcp_f32 v102, v102
  v_rcp_f32 v103, v103
  v_pk_mul_f32 v[168:169], v[168:169], v[100:101]
  v_pk_mul_f32 v[170:171], v[170:171], v[102:103]
  v_cvt_pk_bf16_f32 v108, v168, v169
  v_cvt_pk_bf16_f32 v109, v170, v171
  v_pk_fma_f32 v[104:105], v[44:45], v[92:93], v[72:73] op_sel:[0,0,0] op_sel_hi:[1,0,1] neg_lo:[0,1,0] neg_hi:[0,1,0]
  v_pk_fma_f32 v[106:107], v[46:47], v[92:93], v[74:75] op_sel:[0,0,0] op_sel_hi:[1,0,1] neg_lo:[0,1,0] neg_hi:[0,1,0]
  v_pk_fma_f32 v[184:185], v[184:185], v[92:93], v[104:105] op_sel:[0,1,0] op_sel_hi:[1,1,1]
  v_pk_fma_f32 v[186:187], v[186:187], v[92:93], v[106:107] op_sel:[0,1,0] op_sel_hi:[1,1,1]
  v_pk_mul_f32 v[104:105], v[184:185], v[184:185]
  v_pk_mul_f32 v[106:107], v[186:187], v[186:187]
  v_pk_fma_f32 v[104:105], v[104:105], v[96:97], v[96:97] op_sel:[0,1,0] op_sel_hi:[1,1,0]
  v_pk_fma_f32 v[106:107], v[106:107], v[96:97], v[96:97] op_sel:[0,1,0] op_sel_hi:[1,1,0]
  v_pk_mul_f32 v[104:105], v[104:105], v[184:185]
  v_pk_mul_f32 v[106:107], v[106:107], v[186:187]
  v_exp_f32 v104, v104
  v_exp_f32 v105, v105
  v_exp_f32 v106, v106
  v_exp_f32 v107, v107
  v_pk_add_f32 v[104:105], v[104:105], v[98:99] op_sel_hi:[1,0]
  v_pk_add_f32 v[106:107], v[106:107], v[98:99] op_sel_hi:[1,0]
  v_rcp_f32 v104, v104
  v_rcp_f32 v105, v105
  v_rcp_f32 v106, v106
  v_rcp_f32 v107, v107
  v_pk_mul_f32 v[184:185], v[184:185], v[104:105]
  v_pk_mul_f32 v[186:187], v[186:187], v[106:107]
  v_cvt_pk_bf16_f32 v110, v184, v185
  v_cvt_pk_bf16_f32 v111, v186, v187
  s_mov_b32 s3, 230400
  s_nop 0
  v_permlane16_swap_b32 v108, v110
  v_permlane16_swap_b32 v109, v111
  buffer_store_dwordx4 v[108:111], v12, s[44:47], s3 offen sc1
  v_pk_fma_f32 v[100:101], v[48:49], v[92:93], v[76:77] op_sel:[0,0,0] op_sel_hi:[1,0,1] neg_lo:[0,1,0] neg_hi:[0,1,0]
  v_pk_fma_f32 v[102:103], v[50:51], v[92:93], v[78:79] op_sel:[0,0,0] op_sel_hi:[1,0,1] neg_lo:[0,1,0] neg_hi:[0,1,0]
  v_pk_fma_f32 v[200:201], v[200:201], v[92:93], v[100:101] op_sel:[0,1,0] op_sel_hi:[1,1,1]
  v_pk_fma_f32 v[202:203], v[202:203], v[92:93], v[102:103] op_sel:[0,1,0] op_sel_hi:[1,1,1]
  v_pk_mul_f32 v[100:101], v[200:201], v[200:201]
  v_pk_mul_f32 v[102:103], v[202:203], v[202:203]
  v_pk_fma_f32 v[100:101], v[100:101], v[96:97], v[96:97] op_sel:[0,1,0] op_sel_hi:[1,1,0]
  v_pk_fma_f32 v[102:103], v[102:103], v[96:97], v[96:97] op_sel:[0,1,0] op_sel_hi:[1,1,0]
  v_pk_mul_f32 v[100:101], v[100:101], v[200:201]
  v_pk_mul_f32 v[102:103], v[102:103], v[202:203]
  v_exp_f32 v100, v100
  v_exp_f32 v101, v101
  v_exp_f32 v102, v102
  v_exp_f32 v103, v103
  v_pk_add_f32 v[100:101], v[100:101], v[98:99] op_sel_hi:[1,0]
  v_pk_add_f32 v[102:103], v[102:103], v[98:99] op_sel_hi:[1,0]
  v_rcp_f32 v100, v100
  v_rcp_f32 v101, v101
  v_rcp_f32 v102, v102
  v_rcp_f32 v103, v103
  v_pk_mul_f32 v[200:201], v[200:201], v[100:101]
  v_pk_mul_f32 v[202:203], v[202:203], v[102:103]
  v_cvt_pk_bf16_f32 v112, v200, v201
  v_cvt_pk_bf16_f32 v113, v202, v203
  v_pk_fma_f32 v[104:105], v[52:53], v[92:93], v[80:81] op_sel:[0,0,0] op_sel_hi:[1,0,1] neg_lo:[0,1,0] neg_hi:[0,1,0]
  v_pk_fma_f32 v[106:107], v[54:55], v[92:93], v[82:83] op_sel:[0,0,0] op_sel_hi:[1,0,1] neg_lo:[0,1,0] neg_hi:[0,1,0]
  v_pk_fma_f32 v[216:217], v[216:217], v[92:93], v[104:105] op_sel:[0,1,0] op_sel_hi:[1,1,1]
  v_pk_fma_f32 v[218:219], v[218:219], v[92:93], v[106:107] op_sel:[0,1,0] op_sel_hi:[1,1,1]
  v_pk_mul_f32 v[104:105], v[216:217], v[216:217]
  v_pk_mul_f32 v[106:107], v[218:219], v[218:219]
  v_pk_fma_f32 v[104:105], v[104:105], v[96:97], v[96:97] op_sel:[0,1,0] op_sel_hi:[1,1,0]
  v_pk_fma_f32 v[106:107], v[106:107], v[96:97], v[96:97] op_sel:[0,1,0] op_sel_hi:[1,1,0]
  v_pk_mul_f32 v[104:105], v[104:105], v[216:217]
  v_pk_mul_f32 v[106:107], v[106:107], v[218:219]
  v_exp_f32 v104, v104
  v_exp_f32 v105, v105
  v_exp_f32 v106, v106
  v_exp_f32 v107, v107
  v_pk_add_f32 v[104:105], v[104:105], v[98:99] op_sel_hi:[1,0]
  v_pk_add_f32 v[106:107], v[106:107], v[98:99] op_sel_hi:[1,0]
  v_rcp_f32 v104, v104
  v_rcp_f32 v105, v105
  v_rcp_f32 v106, v106
  v_rcp_f32 v107, v107
  v_pk_mul_f32 v[216:217], v[216:217], v[104:105]
  v_pk_mul_f32 v[218:219], v[218:219], v[106:107]
  v_cvt_pk_bf16_f32 v114, v216, v217
  v_cvt_pk_bf16_f32 v115, v218, v219
  s_mov_b32 s3, 231424
  s_nop 0
  v_permlane16_swap_b32 v112, v114
  v_permlane16_swap_b32 v113, v115
  buffer_store_dwordx4 v[112:115], v12, s[44:47], s3 offen sc1
  v_pk_fma_f32 v[100:101], v[32:33], v[94:95], v[60:61] op_sel:[0,0,0] op_sel_hi:[1,0,1] neg_lo:[0,1,0] neg_hi:[0,1,0]
  v_pk_fma_f32 v[102:103], v[34:35], v[94:95], v[62:63] op_sel:[0,0,0] op_sel_hi:[1,0,1] neg_lo:[0,1,0] neg_hi:[0,1,0]
  v_pk_fma_f32 v[140:141], v[140:141], v[94:95], v[100:101] op_sel:[0,1,0] op_sel_hi:[1,1,1]
  v_pk_fma_f32 v[142:143], v[142:143], v[94:95], v[102:103] op_sel:[0,1,0] op_sel_hi:[1,1,1]
  v_pk_mul_f32 v[100:101], v[140:141], v[140:141]
  v_pk_mul_f32 v[102:103], v[142:143], v[142:143]
  v_pk_fma_f32 v[100:101], v[100:101], v[96:97], v[96:97] op_sel:[0,1,0] op_sel_hi:[1,1,0]
  v_pk_fma_f32 v[102:103], v[102:103], v[96:97], v[96:97] op_sel:[0,1,0] op_sel_hi:[1,1,0]
  v_pk_mul_f32 v[100:101], v[100:101], v[140:141]
  v_pk_mul_f32 v[102:103], v[102:103], v[142:143]
  v_exp_f32 v100, v100
  v_exp_f32 v101, v101
  v_exp_f32 v102, v102
  v_exp_f32 v103, v103
  v_pk_add_f32 v[100:101], v[100:101], v[98:99] op_sel_hi:[1,0]
  v_pk_add_f32 v[102:103], v[102:103], v[98:99] op_sel_hi:[1,0]
  v_rcp_f32 v100, v100
  v_rcp_f32 v101, v101
  v_rcp_f32 v102, v102
  v_rcp_f32 v103, v103
  v_pk_mul_f32 v[140:141], v[140:141], v[100:101]
  v_pk_mul_f32 v[142:143], v[142:143], v[102:103]
  v_cvt_pk_bf16_f32 v116, v140, v141
  v_cvt_pk_bf16_f32 v117, v142, v143
  v_pk_fma_f32 v[104:105], v[36:37], v[94:95], v[64:65] op_sel:[0,0,0] op_sel_hi:[1,0,1] neg_lo:[0,1,0] neg_hi:[0,1,0]
  v_pk_fma_f32 v[106:107], v[38:39], v[94:95], v[66:67] op_sel:[0,0,0] op_sel_hi:[1,0,1] neg_lo:[0,1,0] neg_hi:[0,1,0]
  v_pk_fma_f32 v[156:157], v[156:157], v[94:95], v[104:105] op_sel:[0,1,0] op_sel_hi:[1,1,1]
  v_pk_fma_f32 v[158:159], v[158:159], v[94:95], v[106:107] op_sel:[0,1,0] op_sel_hi:[1,1,1]
  v_pk_mul_f32 v[104:105], v[156:157], v[156:157]
  v_pk_mul_f32 v[106:107], v[158:159], v[158:159]
  v_pk_fma_f32 v[104:105], v[104:105], v[96:97], v[96:97] op_sel:[0,1,0] op_sel_hi:[1,1,0]
  v_pk_fma_f32 v[106:107], v[106:107], v[96:97], v[96:97] op_sel:[0,1,0] op_sel_hi:[1,1,0]
  v_pk_mul_f32 v[104:105], v[104:105], v[156:157]
  v_pk_mul_f32 v[106:107], v[106:107], v[158:159]
  v_exp_f32 v104, v104
  v_exp_f32 v105, v105
  v_exp_f32 v106, v106
  v_exp_f32 v107, v107
  v_pk_add_f32 v[104:105], v[104:105], v[98:99] op_sel_hi:[1,0]
  v_pk_add_f32 v[106:107], v[106:107], v[98:99] op_sel_hi:[1,0]
  v_rcp_f32 v104, v104
  v_rcp_f32 v105, v105
  v_rcp_f32 v106, v106
  v_rcp_f32 v107, v107
  v_pk_mul_f32 v[156:157], v[156:157], v[104:105]
  v_pk_mul_f32 v[158:159], v[158:159], v[106:107]
  v_cvt_pk_bf16_f32 v118, v156, v157
  v_cvt_pk_bf16_f32 v119, v158, v159
  s_mov_b32 s3, 344064
  s_nop 0
  v_permlane16_swap_b32 v116, v118
  v_permlane16_swap_b32 v117, v119
  buffer_store_dwordx4 v[116:119], v12, s[44:47], s3 offen sc1
  v_pk_fma_f32 v[100:101], v[40:41], v[94:95], v[68:69] op_sel:[0,0,0] op_sel_hi:[1,0,1] neg_lo:[0,1,0] neg_hi:[0,1,0]
  v_pk_fma_f32 v[102:103], v[42:43], v[94:95], v[70:71] op_sel:[0,0,0] op_sel_hi:[1,0,1] neg_lo:[0,1,0] neg_hi:[0,1,0]
  v_pk_fma_f32 v[172:173], v[172:173], v[94:95], v[100:101] op_sel:[0,1,0] op_sel_hi:[1,1,1]
  v_pk_fma_f32 v[174:175], v[174:175], v[94:95], v[102:103] op_sel:[0,1,0] op_sel_hi:[1,1,1]
  v_pk_mul_f32 v[100:101], v[172:173], v[172:173]
  v_pk_mul_f32 v[102:103], v[174:175], v[174:175]
  v_pk_fma_f32 v[100:101], v[100:101], v[96:97], v[96:97] op_sel:[0,1,0] op_sel_hi:[1,1,0]
  v_pk_fma_f32 v[102:103], v[102:103], v[96:97], v[96:97] op_sel:[0,1,0] op_sel_hi:[1,1,0]
  v_pk_mul_f32 v[100:101], v[100:101], v[172:173]
  v_pk_mul_f32 v[102:103], v[102:103], v[174:175]
  v_exp_f32 v100, v100
  v_exp_f32 v101, v101
  v_exp_f32 v102, v102
  v_exp_f32 v103, v103
  v_pk_add_f32 v[100:101], v[100:101], v[98:99] op_sel_hi:[1,0]
  v_pk_add_f32 v[102:103], v[102:103], v[98:99] op_sel_hi:[1,0]
  v_rcp_f32 v100, v100
  v_rcp_f32 v101, v101
  v_rcp_f32 v102, v102
  v_rcp_f32 v103, v103
  v_pk_mul_f32 v[172:173], v[172:173], v[100:101]
  v_pk_mul_f32 v[174:175], v[174:175], v[102:103]
  v_cvt_pk_bf16_f32 v120, v172, v173
  v_cvt_pk_bf16_f32 v121, v174, v175
  v_pk_fma_f32 v[104:105], v[44:45], v[94:95], v[72:73] op_sel:[0,0,0] op_sel_hi:[1,0,1] neg_lo:[0,1,0] neg_hi:[0,1,0]
  v_pk_fma_f32 v[106:107], v[46:47], v[94:95], v[74:75] op_sel:[0,0,0] op_sel_hi:[1,0,1] neg_lo:[0,1,0] neg_hi:[0,1,0]
  v_pk_fma_f32 v[188:189], v[188:189], v[94:95], v[104:105] op_sel:[0,1,0] op_sel_hi:[1,1,1]
  v_pk_fma_f32 v[190:191], v[190:191], v[94:95], v[106:107] op_sel:[0,1,0] op_sel_hi:[1,1,1]
  v_pk_mul_f32 v[104:105], v[188:189], v[188:189]
  v_pk_mul_f32 v[106:107], v[190:191], v[190:191]
  v_pk_fma_f32 v[104:105], v[104:105], v[96:97], v[96:97] op_sel:[0,1,0] op_sel_hi:[1,1,0]
  v_pk_fma_f32 v[106:107], v[106:107], v[96:97], v[96:97] op_sel:[0,1,0] op_sel_hi:[1,1,0]
  v_pk_mul_f32 v[104:105], v[104:105], v[188:189]
  v_pk_mul_f32 v[106:107], v[106:107], v[190:191]
  v_exp_f32 v104, v104
  v_exp_f32 v105, v105
  v_exp_f32 v106, v106
  v_exp_f32 v107, v107
  v_pk_add_f32 v[104:105], v[104:105], v[98:99] op_sel_hi:[1,0]
  v_pk_add_f32 v[106:107], v[106:107], v[98:99] op_sel_hi:[1,0]
  v_rcp_f32 v104, v104
  v_rcp_f32 v105, v105
  v_rcp_f32 v106, v106
  v_rcp_f32 v107, v107
  v_pk_mul_f32 v[188:189], v[188:189], v[104:105]
  v_pk_mul_f32 v[190:191], v[190:191], v[106:107]
  v_cvt_pk_bf16_f32 v122, v188, v189
  v_cvt_pk_bf16_f32 v123, v190, v191
  s_mov_b32 s3, 345088
  s_nop 0
  v_permlane16_swap_b32 v120, v122
  v_permlane16_swap_b32 v121, v123
  buffer_store_dwordx4 v[120:123], v12, s[44:47], s3 offen sc1
  v_pk_fma_f32 v[100:101], v[48:49], v[94:95], v[76:77] op_sel:[0,0,0] op_sel_hi:[1,0,1] neg_lo:[0,1,0] neg_hi:[0,1,0]
  v_pk_fma_f32 v[102:103], v[50:51], v[94:95], v[78:79] op_sel:[0,0,0] op_sel_hi:[1,0,1] neg_lo:[0,1,0] neg_hi:[0,1,0]
  v_pk_fma_f32 v[204:205], v[204:205], v[94:95], v[100:101] op_sel:[0,1,0] op_sel_hi:[1,1,1]
  v_pk_fma_f32 v[206:207], v[206:207], v[94:95], v[102:103] op_sel:[0,1,0] op_sel_hi:[1,1,1]
  v_pk_mul_f32 v[100:101], v[204:205], v[204:205]
  v_pk_mul_f32 v[102:103], v[206:207], v[206:207]
  v_pk_fma_f32 v[100:101], v[100:101], v[96:97], v[96:97] op_sel:[0,1,0] op_sel_hi:[1,1,0]
  v_pk_fma_f32 v[102:103], v[102:103], v[96:97], v[96:97] op_sel:[0,1,0] op_sel_hi:[1,1,0]
  v_pk_mul_f32 v[100:101], v[100:101], v[204:205]
  v_pk_mul_f32 v[102:103], v[102:103], v[206:207]
  v_exp_f32 v100, v100
  v_exp_f32 v101, v101
  v_exp_f32 v102, v102
  v_exp_f32 v103, v103
  v_pk_add_f32 v[100:101], v[100:101], v[98:99] op_sel_hi:[1,0]
  v_pk_add_f32 v[102:103], v[102:103], v[98:99] op_sel_hi:[1,0]
  v_rcp_f32 v100, v100
  v_rcp_f32 v101, v101
  v_rcp_f32 v102, v102
  v_rcp_f32 v103, v103
  v_pk_mul_f32 v[204:205], v[204:205], v[100:101]
  v_pk_mul_f32 v[206:207], v[206:207], v[102:103]
  v_cvt_pk_bf16_f32 v108, v204, v205
  v_cvt_pk_bf16_f32 v109, v206, v207
  v_pk_fma_f32 v[104:105], v[52:53], v[94:95], v[80:81] op_sel:[0,0,0] op_sel_hi:[1,0,1] neg_lo:[0,1,0] neg_hi:[0,1,0]
  v_pk_fma_f32 v[106:107], v[54:55], v[94:95], v[82:83] op_sel:[0,0,0] op_sel_hi:[1,0,1] neg_lo:[0,1,0] neg_hi:[0,1,0]
  v_pk_fma_f32 v[220:221], v[220:221], v[94:95], v[104:105] op_sel:[0,1,0] op_sel_hi:[1,1,1]
  v_pk_fma_f32 v[222:223], v[222:223], v[94:95], v[106:107] op_sel:[0,1,0] op_sel_hi:[1,1,1]
  v_pk_mul_f32 v[104:105], v[220:221], v[220:221]
  v_pk_mul_f32 v[106:107], v[222:223], v[222:223]
  v_pk_fma_f32 v[104:105], v[104:105], v[96:97], v[96:97] op_sel:[0,1,0] op_sel_hi:[1,1,0]
  v_pk_fma_f32 v[106:107], v[106:107], v[96:97], v[96:97] op_sel:[0,1,0] op_sel_hi:[1,1,0]
  v_pk_mul_f32 v[104:105], v[104:105], v[220:221]
  v_pk_mul_f32 v[106:107], v[106:107], v[222:223]
  v_exp_f32 v104, v104
  v_exp_f32 v105, v105
  v_exp_f32 v106, v106
  v_exp_f32 v107, v107
  v_pk_add_f32 v[104:105], v[104:105], v[98:99] op_sel_hi:[1,0]
  v_pk_add_f32 v[106:107], v[106:107], v[98:99] op_sel_hi:[1,0]
  v_rcp_f32 v104, v104
  v_rcp_f32 v105, v105
  v_rcp_f32 v106, v106
  v_rcp_f32 v107, v107
  v_pk_mul_f32 v[220:221], v[220:221], v[104:105]
  v_pk_mul_f32 v[222:223], v[222:223], v[106:107]
  v_cvt_pk_bf16_f32 v110, v220, v221
  v_cvt_pk_bf16_f32 v111, v222, v223
  s_mov_b32 s3, 346112
  s_nop 0
  v_permlane16_swap_b32 v108, v110
  v_permlane16_swap_b32 v109, v111
  buffer_store_dwordx4 v[108:111], v12, s[44:47], s3 offen sc1
  v_pk_fma_f32 v[100:101], v[56:57], v[92:93], v[84:85] op_sel:[0,0,0] op_sel_hi:[1,0,1] neg_lo:[0,1,0] neg_hi:[0,1,0]
  v_pk_fma_f32 v[102:103], v[58:59], v[92:93], v[86:87] op_sel:[0,0,0] op_sel_hi:[1,0,1] neg_lo:[0,1,0] neg_hi:[0,1,0]
  v_pk_fma_f32 v[232:233], v[232:233], v[92:93], v[100:101] op_sel:[0,1,0] op_sel_hi:[1,1,1]
  v_pk_fma_f32 v[234:235], v[234:235], v[92:93], v[102:103] op_sel:[0,1,0] op_sel_hi:[1,1,1]
  v_pk_mul_f32 v[100:101], v[232:233], v[232:233]
  v_pk_mul_f32 v[102:103], v[234:235], v[234:235]
  v_pk_fma_f32 v[100:101], v[100:101], v[96:97], v[96:97] op_sel:[0,1,0] op_sel_hi:[1,1,0]
  v_pk_fma_f32 v[102:103], v[102:103], v[96:97], v[96:97] op_sel:[0,1,0] op_sel_hi:[1,1,0]
  v_pk_mul_f32 v[100:101], v[100:101], v[232:233]
  v_pk_mul_f32 v[102:103], v[102:103], v[234:235]
  v_exp_f32 v100, v100
  v_exp_f32 v101, v101
  v_exp_f32 v102, v102
  v_exp_f32 v103, v103
  v_pk_add_f32 v[100:101], v[100:101], v[98:99] op_sel_hi:[1,0]
  v_pk_add_f32 v[102:103], v[102:103], v[98:99] op_sel_hi:[1,0]
  v_rcp_f32 v100, v100
  v_rcp_f32 v101, v101
  v_rcp_f32 v102, v102
  v_rcp_f32 v103, v103
  v_pk_mul_f32 v[232:233], v[232:233], v[100:101]
  v_pk_mul_f32 v[234:235], v[234:235], v[102:103]
  v_cvt_pk_bf16_f32 v112, v232, v233
  v_cvt_pk_bf16_f32 v113, v234, v235
  v_pk_fma_f32 v[100:101], v[56:57], v[94:95], v[84:85] op_sel:[0,0,0] op_sel_hi:[1,0,1] neg_lo:[0,1,0] neg_hi:[0,1,0]
  v_pk_fma_f32 v[102:103], v[58:59], v[94:95], v[86:87] op_sel:[0,0,0] op_sel_hi:[1,0,1] neg_lo:[0,1,0] neg_hi:[0,1,0]
  v_pk_fma_f32 v[236:237], v[236:237], v[94:95], v[100:101] op_sel:[0,1,0] op_sel_hi:[1,1,1]
  v_pk_fma_f32 v[238:239], v[238:239], v[94:95], v[102:103] op_sel:[0,1,0] op_sel_hi:[1,1,1]
  v_pk_mul_f32 v[100:101], v[236:237], v[236:237]
  v_pk_mul_f32 v[102:103], v[238:239], v[238:239]
  v_pk_fma_f32 v[100:101], v[100:101], v[96:97], v[96:97] op_sel:[0,1,0] op_sel_hi:[1,1,0]
  v_pk_fma_f32 v[102:103], v[102:103], v[96:97], v[96:97] op_sel:[0,1,0] op_sel_hi:[1,1,0]
  v_pk_mul_f32 v[100:101], v[100:101], v[236:237]
  v_pk_mul_f32 v[102:103], v[102:103], v[238:239]
  v_exp_f32 v100, v100
  v_exp_f32 v101, v101
  v_exp_f32 v102, v102
  v_exp_f32 v103, v103
  v_pk_add_f32 v[100:101], v[100:101], v[98:99] op_sel_hi:[1,0]
  v_pk_add_f32 v[102:103], v[102:103], v[98:99] op_sel_hi:[1,0]
  v_rcp_f32 v100, v100
  v_rcp_f32 v101, v101
  v_rcp_f32 v102, v102
  v_rcp_f32 v103, v103
  v_pk_mul_f32 v[236:237], v[236:237], v[100:101]
  v_pk_mul_f32 v[238:239], v[238:239], v[102:103]
  v_cvt_pk_bf16_f32 v114, v236, v237
  v_cvt_pk_bf16_f32 v115, v238, v239
  s_mov_b32 s3, 232448
  s_nop 0
  v_permlane16_swap_b32 v112, v114
  v_permlane16_swap_b32 v113, v115
  buffer_store_dwordx4 v[112:115], v13, s[44:47], s3 offen sc1
  s_endpgm
.section .rodata,"a"
.p2align 6
.amdhsa_kernel w1l0_kernel
  .amdhsa_next_free_vgpr 256
  .amdhsa_next_free_sgpr 102
  .amdhsa_accum_offset 256
  .amdhsa_group_segment_fixed_size 0
  .amdhsa_kernarg_size 88
  .amdhsa_user_sgpr_count 2
  .amdhsa_user_sgpr_kernarg_segment_ptr 1
  .amdhsa_system_sgpr_workgroup_id_x 1
  .amdhsa_float_denorm_mode_32 3
  .amdhsa_float_denorm_mode_16_64 3
.end_amdhsa_kernel
.text
.text
.globl w1l1_kernel
.p2align 8
.type w1l1_kernel,@function
w1l1_kernel:
  s_load_dwordx16 s[16:31], s[0:1], 0
  s_load_dwordx2 s[32:33], s[0:1], 64
  s_load_dwordx2 s[34:35], s[0:1], 80
  s_load_dwordx2 s[12:13], s[0:1], 64
  s_mov_b32 s96, 1
  s_branch L_w1_body
L_w1_c1:
.section .rodata,"a"
.p2align 6
.amdhsa_kernel w1l1_kernel
  .amdhsa_next_free_vgpr 256
  .amdhsa_next_free_sgpr 102
  .amdhsa_accum_offset 256
  .amdhsa_group_segment_fixed_size 0
  .amdhsa_kernarg_size 88
  .amdhsa_user_sgpr_count 2
  .amdhsa_user_sgpr_kernarg_segment_ptr 1
  .amdhsa_system_sgpr_workgroup_id_x 1
  .amdhsa_float_denorm_mode_32 3
  .amdhsa_float_denorm_mode_16_64 3
.end_amdhsa_kernel
.text
L_w2_c0:
.text
.globl w2l0_kernel
.p2align 8
.type w2l0_kernel,@function
w2l0_kernel:
  s_load_dwordx16 s[16:31], s[0:1], 0
  s_load_dwordx2 s[32:33], s[0:1], 64
  s_load_dwordx2 s[34:35], s[0:1], 80
  s_load_dwordx2 s[12:13], s[0:1], 0
  s_mov_b32 s96, 0
L_w2_body:
  s_cmp_ge_u32 s2, 256
  s_cbranch_scc1 L_w2_end
  v_lshrrev_b32 v2, 6, v0
  v_and_b32 v1, 63, v0
  v_readfirstlane_b32 s70, v2
  s_and_b32 s3, s2, 7
  s_lshr_b32 s99, s2, 3
  s_and_b32 s5, s3, 3
  s_lshl_b32 s5, s5, 2
  s_and_b32 s6, s99, 3
  s_add_u32 s68, s5, s6
  s_lshr_b32 s5, s3, 2
  s_lshl_b32 s5, s5, 3
  s_lshr_b32 s6, s99, 2
  s_add_u32 s69, s5, s6
  s_cmp_lt_u32 s70, 4
  s_cbranch_scc1 L_w2_compute
L_w2_loader:
  s_add_u32 s8, s70, s69
  s_and_b32 s8, s8, 3
  s_add_u32 s9, s70, s68
  s_and_b32 s9, s9, 3
  s_lshl_b32 s76, s8, 12
  s_lshl_b32 s77, s9, 11
  s_add_u32 s77, s77, 16384
  s_lshl_b32 s11, s68, 7
  v_and_b32 v10, 7, v1
  s_lshr_b32 s10, s76, 11
  s_lshl_b32 s3, s68, 3
  s_add_u32 s10, s10, s3
  s_mul_i32 s10, s10, 114688
  v_lshl_add_u32 v4, v1, 4, s10
  v_add_u32 v5, 114688, v4
  v_lshrrev_b32 v3, 3, v1
  s_lshl_b32 s10, s9, 4
  v_add_u32 v3, s10, v3
  v_mul_u32_u24 v3, 2048, v3
  v_lshrrev_b32 v2, 3, v1
  v_and_b32 v2, 2, v2
  v_xor_b32 v2, v2, v10
  s_mul_i32 s10, s69, 128
  v_add_u32 v3, s10, v3
  v_lshl_add_u32 v8, v2, 4, v3
  v_xor_b32 v2, 4, v2
  v_add_u32 v3, 16384, v3
  v_lshl_add_u32 v9, v2, 4, v3
  s_mov_b32 s75, 0
  s_add_u32 s100, s68, s69
  s_mov_b32 s101, -1
  s_add_u32 s101, s101, 1
  s_sub_u32 s73, s101, s100
  s_lshl_b32 s73, s73, 3
  s_lshr_b32 s73, 0x373702, s73
  s_and_b32 s73, s73, 255
  s_add_u32 s73, s73, s101
  s_sub_u32 s74, s73, 56
  s_cselect_b32 s73, s73, s74
  s_mul_i32 s74, s73, 131072
  s_lshl_b32 s73, s73, 11
  s_waitcnt lgkmcnt(0)
  s_add_u32 s36, s34, 8388608
  s_addc_u32 s37, s35, 0
  s_and_b32 s37, s37, 0xffff
  s_mov_b32 s38, 14680064
  s_mov_b32 s39, 0x00020000
  s_mov_b32 s40, s28
  s_and_b32 s41, s29, 0xffff
  s_mov_b32 s42, 7340032
  s_mov_b32 s43, 0x00020000
  s_add_u32 s3, s75, s76
  s_add_u32 m0, s3, 0
  s_nop 0
  buffer_load_dwordx4 v4, s[36:39], s73 offen offset:0 lds
  buffer_load_dwordx4 v4, s[36:39], s73 offen offset:1024 lds
  s_add_u32 m0, s3, 2048
  s_nop 0
  buffer_load_dwordx4 v5, s[36:39], s73 offen offset:0 lds
  buffer_load_dwordx4 v5, s[36:39], s73 offen offset:1024 lds
  s_add_u32 s3, s75, s77
  s_add_u32 m0, s3, 0
  s_add_u32 s4, s74, 0
  buffer_load_dwordx4 v8, s[40:43], s4 offen lds
  s_add_u32 m0, s3, 1024
  s_nop 0
  buffer_load_dwordx4 v9, s[40:43], s4 offen lds
  s_add_u32 s101, s101, 1
  s_sub_u32 s73, s101, s100
  s_lshl_b32 s73, s73, 3
  s_lshr_b32 s73, 0x373702, s73
  s_and_b32 s73, s73, 255
  s_add_u32 s73, s73, s101
  s_sub_u32 s74, s73, 56
  s_cselect_b32 s73, s73, s74
  s_mul_i32 s74, s73, 131072
  s_lshl_b32 s73, s73, 11
  s_add_u32 s75, s75, 24576
  s_cmp_eq_u32 s75, 147456
  s_cselect_b32 s75, 0, s75
  s_add_u32 s3, s75, s76
  s_add_u32 m0, s3, 0
  s_nop 0
  buffer_load_dwordx4 v4, s[36:39], s73 offen offset:0 lds
  buffer_load_dwordx4 v4, s[36:39], s73 offen offset:1024 lds
  s_add_u32 m0, s3, 2048
  s_nop 0
  buffer_load_dwordx4 v5, s[36:39], s73 offen offset:0 lds
  buffer_load_dwordx4 v5, s[36:39], s73 offen offset:1024 lds
  s_add_u32 s3, s75, s77
  s_add_u32 m0, s3, 0
  s_add_u32 s4, s74, 0
  buffer_load_dwordx4 v8, s[40:43], s4 offen lds
  s_add_u32 m0, s3, 1024
  s_nop 0
  buffer_load_dwordx4 v9, s[40:43], s4 offen lds
  s_add_u32 s101, s101, 1
  s_sub_u32 s73, s101, s100
  s_lshl_b32 s73, s73, 3
  s_lshr_b32 s73, 0x373702, s73
  s_and_b32 s73, s73, 255
  s_add_u32 s73, s73, s101
  s_sub_u32 s74, s73, 56
  s_cselect_b32 s73, s73, s74
  s_mul_i32 s74, s73, 131072
  s_lshl_b32 s73, s73, 11
  s_add_u32 s75, s75, 24576
  s_cmp_eq_u32 s75, 147456
  s_cselect_b32 s75, 0, s75
  s_waitcnt vmcnt(6)
  s_barrier
  s_add_u32 s3, s75, s76
  s_add_u32 m0, s3, 0
  s_nop 0
  buffer_load_dwordx4 v4, s[36:39], s73 offen offset:0 lds
  buffer_load_dwordx4 v4, s[36:39], s73 offen offset:1024 lds
  s_add_u32 m0, s3, 2048
  s_nop 0
  buffer_load_dwordx4 v5, s[36:39], s73 offen offset:0 lds
  buffer_load_dwordx4 v5, s[36:39], s73 offen offset:1024 lds
  s_add_u32 s3, s75, s77
  s_add_u32 m0, s3, 0
  s_add_u32 s4, s74, 0
  buffer_load_dwordx4 v8, s[40:43], s4 offen lds
  s_add_u32 m0, s3, 1024
  s_nop 0
  buffer_load_dwordx4 v9, s[40:43], s4 offen lds
  s_add_u32 s101, s101, 1
  s_sub_u32 s73, s101, s100
  s_lshl_b32 s73, s73, 3
  s_lshr_b32 s73, 0x373702, s73
  s_and_b32 s73, s73, 255
  s_add_u32 s73, s73, s101
  s_sub_u32 s74, s73, 56
  s_cselect_b32 s73, s73, s74
  s_mul_i32 s74, s73, 131072
  s_lshl_b32 s73, s73, 11
  s_add_u32 s75, s75, 24576
  s_cmp_eq_u32 s75, 147456
  s_cselect_b32 s75, 0, s75
  s_add_u32 s3, s75, s76
  s_add_u32 m0, s3, 0
  s_nop 0
  buffer_load_dwordx4 v4, s[36:39], s73 offen offset:0 lds
  buffer_load_dwordx4 v4, s[36:39], s73 offen offset:1024 lds
  s_add_u32 m0, s3, 2048
  s_nop 0
  buffer_load_dwordx4 v5, s[36:39], s73 offen offset:0 lds
  buffer_load_dwordx4 v5, s[36:39], s73 offen offset:1024 lds
  s_add_u32 s3, s75, s77
  s_add_u32 m0, s3, 0
  s_add_u32 s4, s74, 0
  buffer_load_dwordx4 v8, s[40:43], s4 offen lds
  s_add_u32 m0, s3, 1024
  s_nop 0
  buffer_load_dwordx4 v9, s[40:43], s4 offen lds
  s_add_u32 s101, s101, 1
  s_sub_u32 s73, s101, s100
  s_lshl_b32 s73, s73, 3
  s_lshr_b32 s73, 0x373702, s73
  s_and_b32 s73, s73, 255
  s_add_u32 s73, s73, s101
  s_sub_u32 s74, s73, 56
  s_cselect_b32 s73, s73, s74
  s_mul_i32 s74, s73, 131072
  s_lshl_b32 s73, s73, 11
  s_add_u32 s75, s75, 24576
  s_cmp_eq_u32 s75, 147456
  s_cselect_b32 s75, 0, s75
  s_add_u32 s3, s75, s76
  s_add_u32 m0, s3, 0
  s_nop 0
  buffer_load_dwordx4 v4, s[36:39], s73 offen offset:0 lds
  buffer_load_dwordx4 v4, s[36:39], s73 offen offset:1024 lds
  s_add_u32 m0, s3, 2048
  s_nop 0
  buffer_load_dwordx4 v5, s[36:39], s73 offen offset:0 lds
  buffer_load_dwordx4 v5, s[36:39], s73 offen offset:1024 lds
  s_add_u32 s3, s75, s77
  s_add_u32 m0, s3, 0
  s_add_u32 s4, s74, 0
  buffer_load_dwordx4 v8, s[40:43], s4 offen lds
  s_add_u32 m0, s3, 1024
  s_nop 0
  buffer_load_dwordx4 v9, s[40:43], s4 offen lds
  s_add_u32 s101, s101, 1
  s_sub_u32 s73, s101, s100
  s_lshl_b32 s73, s73, 3
  s_lshr_b32 s73, 0x373702, s73
  s_and_b32 s73, s73, 255
  s_add_u32 s73, s73, s101
  s_sub_u32 s74, s73, 56
  s_cselect_b32 s73, s73, s74
  s_mul_i32 s74, s73, 131072
  s_lshl_b32 s73, s73, 11
  s_add_u32 s75, s75, 24576
  s_cmp_eq_u32 s75, 147456
  s_cselect_b32 s75, 0, s75
  s_mov_b32 s79, 50
L_w2l_ld:
  s_add_u32 s3, s75, s76
  s_add_u32 m0, s3, 0
  s_nop 0
  buffer_load_dwordx4 v4, s[36:39], s73 offen offset:0 lds
  buffer_load_dwordx4 v4, s[36:39], s73 offen offset:1024 lds
  s_add_u32 m0, s3, 2048
  s_nop 0
  buffer_load_dwordx4 v5, s[36:39], s73 offen offset:0 lds
  buffer_load_dwordx4 v5, s[36:39], s73 offen offset:1024 lds
  s_add_u32 s3, s75, s77
  s_add_u32 m0, s3, 0
  s_add_u32 s4, s74, 0
  buffer_load_dwordx4 v8, s[40:43], s4 offen lds
  s_add_u32 m0, s3, 1024
  s_nop 0
  buffer_load_dwordx4 v9, s[40:43], s4 offen lds
  s_add_u32 s101, s101, 1
  s_sub_u32 s73, s101, s100
  s_lshl_b32 s73, s73, 3
  s_lshr_b32 s73, 0x373702, s73
  s_and_b32 s73, s73, 255
  s_add_u32 s73, s73, s101
  s_sub_u32 s74, s73, 56
  s_cselect_b32 s73, s73, s74
  s_mul_i32 s74, s73, 131072
  s_lshl_b32 s73, s73, 11
  s_add_u32 s75, s75, 24576
  s_cmp_eq_u32 s75, 147456
  s_cselect_b32 s75, 0, s75
  s_waitcnt vmcnt(24)
  s_barrier
  s_sub_u32 s79, s79, 1
  s_cmp_lg_u32 s79, 0
  s_cbranch_scc1 L_w2l_ld
  s_add_u32 s3, s75, s76
  s_add_u32 m0, s3, 0
  s_nop 0
  buffer_load_dwordx4 v4, s[36:39], s73 offen offset:0 lds
  buffer_load_dwordx4 v4, s[36:39], s73 offen offset:1024 lds
  s_add_u32 m0, s3, 2048
  s_nop 0
  buffer_load_dwordx4 v5, s[36:39], s73 offen offset:0 lds
  buffer_load_dwordx4 v5, s[36:39], s73 offen offset:1024 lds
  s_add_u32 s3, s75, s77
  s_add_u32 m0, s3, 0
  s_add_u32 s4, s74, 0
  buffer_load_dwordx4 v8, s[40:43], s4 offen lds
  s_add_u32 m0, s3, 1024
  s_nop 0
  buffer_load_dwordx4 v9, s[40:43], s4 offen lds
  s_add_u32 s101, s101, 1
  s_sub_u32 s73, s101, s100
  s_lshl_b32 s73, s73, 3
  s_lshr_b32 s73, 0x373702, s73
  s_and_b32 s73, s73, 255
  s_add_u32 s73, s73, s101
  s_sub_u32 s74, s73, 56
  s_cselect_b32 s73, s73, s74
  s_mul_i32 s74, s73, 131072
  s_lshl_b32 s73, s73, 11
  s_add_u32 s75, s75, 24576
  s_cmp_eq_u32 s75, 147456
  s_cselect_b32 s75, 0, s75
  s_add_u32 s48, s34, 4194304
  s_addc_u32 s49, s35, 0
  s_and_b32 s49, s49, 0xffff
  s_mov_b32 s50, 4194304
  s_mov_b32 s51, 0x00020000
  s_lshr_b32 s10, s76, 11
  s_lshl_b32 s3, s68, 3
  s_add_u32 s10, s10, s3
  s_mul_i32 s10, s10, 32768
  v_lshl_add_u32 v4, v1, 4, s10
  v_add_u32 v5, 32768, v4
  s_lshl_b32 s4, s69, 11
  s_add_u32 m0, s76, 147456
  s_nop 0
  buffer_load_dwordx4 v4, s[48:51], s4 offen offset:0 lds
  buffer_load_dwordx4 v4, s[48:51], s4 offen offset:1024 lds
  s_add_u32 m0, s76, 149504
  s_nop 0
  buffer_load_dwordx4 v5, s[48:51], s4 offen offset:0 lds
  buffer_load_dwordx4 v5, s[48:51], s4 offen offset:1024 lds
  s_waitcnt vmcnt(28)
  s_barrier
  s_waitcnt vmcnt(22)
  s_barrier
  s_waitcnt vmcnt(16)
  s_barrier
  s_waitcnt vmcnt(10)
  s_barrier
  s_waitcnt vmcnt(4)
  s_barrier
  s_waitcnt vmcnt(0)
  s_barrier
L_w2_side:
L_w2_end:
  s_endpgm
L_w2_compute:
  v_and_b32 v3, 15, v1
  v_lshrrev_b32 v2, 4, v1
  s_lshl_b32 s8, s68, 7
  s_lshl_b32 s9, s70, 5
  s_add_u32 s8, s8, s9
  v_add_u32 v13, s8, v3
  s_lshl_b32 s10, s69, 7
  v_lshl_add_u32 v14, v2, 3, s10
  v_and_b32 v16, 1, v2
  v_lshrrev_b32 v17, 1, v2
  v_lshlrev_b32 v16, 5, v16
  v_lshl_add_u32 v16, v17, 4, v16
  v_add_u32 v16, s10, v16
  v_lshl_add_u32 v12, v13, 11, v16
  v_lshl_add_u32 v18, v17, 4, v13
  v_lshlrev_b32 v18, 3, v18
  v_and_b32 v16, 1, v2
  v_lshl_add_u32 v18, v16, 2, v18
  s_lshl_b32 s10, s69, 14
  v_add_u32 v18, s10, v18
  s_lshl_b32 s8, s70, 12
  v_lshl_add_u32 v5, v1, 4, s8
  v_bfe_u32 v6, v1, 2, 2
  v_lshl_add_u32 v6, v2, 3, v6
  v_lshlrev_b32 v6, 7, v6
  v_and_b32 v17, 3, v1
  v_lshl_add_u32 v6, v17, 3, v6
  v_bfe_u32 v17, v1, 3, 2
  v_lshl_add_u32 v6, v17, 5, v6
  v_add_u32 v6, 16384, v6
  v_xor_b32 v7, 32, v6
  v_xor_b32 v8, 64, v6
  v_xor_b32 v9, 96, v6
  v_lshrrev_b32 v15, 1, v2
  v_lshlrev_b32 v15, 8, v15
  v_lshl_add_u32 v15, v3, 4, v15
  v_lshl_add_u32 v15, v16, 3, v15
  s_add_u32 s8, s8, 147456
  v_add_u32 v15, s8, v15
  s_mov_b32 s11, 0xffff0000
  s_mov_b32 s75, 0
  s_waitcnt lgkmcnt(0)
  s_mov_b32 s52, s30
  s_and_b32 s53, s31, 0xffff
  s_mov_b32 s54, 2048
  s_mov_b32 s55, 0x00020000
  buffer_load_dwordx2 v[176:177], v14, s[52:55], 0 offen offset:0
  buffer_load_dwordx2 v[178:179], v14, s[52:55], 0 offen offset:32
  buffer_load_dwordx2 v[180:181], v14, s[52:55], 0 offen offset:64
  buffer_load_dwordx2 v[182:183], v14, s[52:55], 0 offen offset:96
  s_mov_b32 s44, s32
  s_and_b32 s45, s33, 0xffff
  s_mov_b32 s46, 4194304
  s_mov_b32 s47, 0x00020000
  s_add_u32 s56, s34, 24117248
  s_addc_u32 s57, s35, 0
  s_and_b32 s57, s57, 0xffff
  s_mov_b32 s58, 262144
  s_mov_b32 s59, 0x00020000
  s_waitcnt vmcnt(0)
  v_lshlrev_b32 v128, 16, v176
  v_and_b32 v129, s11, v176
  v_lshlrev_b32 v130, 16, v177
  v_and_b32 v131, s11, v177
  v_lshlrev_b32 v132, 16, v176
  v_and_b32 v133, s11, v176
  v_lshlrev_b32 v134, 16, v177
  v_and_b32 v135, s11, v177
  v_lshlrev_b32 v136, 16, v178
  v_and_b32 v137, s11, v178
  v_lshlrev_b32 v138, 16, v179
  v_and_b32 v139, s11, v179
  v_lshlrev_b32 v140, 16, v178
  v_and_b32 v141, s11, v178
  v_lshlrev_b32 v142, 16, v179
  v_and_b32 v143, s11, v179
  v_lshlrev_b32 v144, 16, v180
  v_and_b32 v145, s11, v180
  v_lshlrev_b32 v146, 16, v181
  v_and_b32 v147, s11, v181
  v_lshlrev_b32 v148, 16, v180
  v_and_b32 v149, s11, v180
  v_lshlrev_b32 v150, 16, v181
  v_and_b32 v151, s11, v181
  v_lshlrev_b32 v152, 16, v182
  v_and_b32 v153, s11, v182
  v_lshlrev_b32 v154, 16, v183
  v_and_b32 v155, s11, v183
  v_lshlrev_b32 v156, 16, v182
  v_and_b32 v157, s11, v182
  v_lshlrev_b32 v158, 16, v183
  v_and_b32 v159, s11, v183
  v_add_u32_e64 v25, s75, v5
  v_add_u32_e64 v26, s75, v6
  v_add_u32_e64 v27, s75, v7
  v_add_u32_e64 v28, s75, v8
  v_add_u32_e64 v29, s75, v9
  s_add_u32 s75, s75, 24576
  s_cmp_eq_u32 s75, 147456
  s_cselect_b32 s75, 0, s75
  s_barrier
  ds_read_b128 v[32:35], v25 offset:0
  ds_read_b128 v[36:39], v25 offset:2048
  ds_read_b64_tr_b16 v[48:49], v26 offset:0
  ds_read_b64_tr_b16 v[50:51], v26 offset:512
  ds_read_b64_tr_b16 v[52:53], v27 offset:0
  ds_read_b64_tr_b16 v[54:55], v27 offset:512
  ds_read_b64_tr_b16 v[56:57], v28 offset:0
  ds_read_b64_tr_b16 v[58:59], v28 offset:512
  ds_read_b64_tr_b16 v[60:61], v29 offset:0
  ds_read_b64_tr_b16 v[62:63], v29 offset:512
  ds_read_b128 v[40:43], v25 offset:1024
  ds_read_b128 v[44:47], v25 offset:3072
  ds_read_b64_tr_b16 v[64:65], v26 offset:4096
  ds_read_b64_tr_b16 v[66:67], v26 offset:4608
  ds_read_b64_tr_b16 v[68:69], v27 offset:4096
  ds_read_b64_tr_b16 v[70:71], v27 offset:4608
  ds_read_b64_tr_b16 v[72:73], v28 offset:4096
  ds_read_b64_tr_b16 v[74:75], v28 offset:4608
  ds_read_b64_tr_b16 v[76:77], v29 offset:4096
  ds_read_b64_tr_b16 v[78:79], v29 offset:4608
  s_mov_b32 s79, 28
  v_add_u32_e64 v25, s75, v5
  v_add_u32_e64 v26, s75, v6
  v_add_u32_e64 v27, s75, v7
  v_add_u32_e64 v28, s75, v8
  v_add_u32_e64 v29, s75, v9
  s_add_u32 s75, s75, 24576
  s_cmp_eq_u32 s75, 147456
  s_cselect_b32 s75, 0, s75
  s_waitcnt lgkmcnt(0)
.p2align 3
L_w2_loop:
  s_barrier
  s_sub_u32 s79, s79, 1
  v_mfma_f32_16x16x32_bf16 v[128:131], v[48:51], v[32:35], v[128:131]
  ds_read_b128 v[80:83], v25 offset:0
  ds_read_b128 v[84:87], v25 offset:2048
  v_mfma_f32_16x16x32_bf16 v[132:135], v[48:51], v[36:39], v[132:135]
  ds_read_b64_tr_b16 v[96:97], v26 offset:0
  ds_read_b64_tr_b16 v[98:99], v26 offset:512
  v_mfma_f32_16x16x32_bf16 v[136:139], v[52:55], v[32:35], v[136:139]
  ds_read_b64_tr_b16 v[100:101], v27 offset:0
  ds_read_b64_tr_b16 v[102:103], v27 offset:512
  v_mfma_f32_16x16x32_bf16 v[140:143], v[52:55], v[36:39], v[140:143]
  ds_read_b64_tr_b16 v[104:105], v28 offset:0
  ds_read_b64_tr_b16 v[106:107], v28 offset:512
  v_mfma_f32_16x16x32_bf16 v[144:147], v[56:59], v[32:35], v[144:147]
  ds_read_b64_tr_b16 v[108:109], v29 offset:0
  ds_read_b64_tr_b16 v[110:111], v29 offset:512
  v_mfma_f32_16x16x32_bf16 v[148:151], v[56:59], v[36:39], v[148:151]
  ds_read_b128 v[88:91], v25 offset:1024
  ds_read_b128 v[92:95], v25 offset:3072
  v_mfma_f32_16x16x32_bf16 v[152:155], v[60:63], v[32:35], v[152:155]
  ds_read_b64_tr_b16 v[112:113], v26 offset:4096
  ds_read_b64_tr_b16 v[114:115], v26 offset:4608
  v_mfma_f32_16x16x32_bf16 v[156:159], v[60:63], v[36:39], v[156:159]
  ds_read_b64_tr_b16 v[116:117], v27 offset:4096
  ds_read_b64_tr_b16 v[118:119], v27 offset:4608
  v_mfma_f32_16x16x32_bf16 v[128:131], v[64:67], v[40:43], v[128:131]
  ds_read_b64_tr_b16 v[120:121], v28 offset:4096
  ds_read_b64_tr_b16 v[122:123], v28 offset:4608
  v_mfma_f32_16x16x32_bf16 v[132:135], v[64:67], v[44:47], v[132:135]
  ds_read_b64_tr_b16 v[124:125], v29 offset:4096
  ds_read_b64_tr_b16 v[126:127], v29 offset:4608
  v_mfma_f32_16x16x32_bf16 v[136:139], v[68:71], v[40:43], v[136:139]
  v_add_u32_e64 v25, s75, v5
  v_add_u32_e64 v26, s75, v6
  v_mfma_f32_16x16x32_bf16 v[140:143], v[68:71], v[44:47], v[140:143]
  v_add_u32_e64 v27, s75, v7
  v_add_u32_e64 v28, s75, v8
  v_mfma_f32_16x16x32_bf16 v[144:147], v[72:75], v[40:43], v[144:147]
  v_add_u32_e64 v29, s75, v9
  s_add_u32 s75, s75, 24576
  v_mfma_f32_16x16x32_bf16 v[148:151], v[72:75], v[44:47], v[148:151]
  s_cmp_eq_u32 s75, 147456
  s_cselect_b32 s75, 0, s75
  s_nop 0
  v_mfma_f32_16x16x32_bf16 v[152:155], v[76:79], v[40:43], v[152:155]
  v_mfma_f32_16x16x32_bf16 v[156:159], v[76:79], v[44:47], v[156:159]
  s_waitcnt lgkmcnt(0)
  s_barrier
  v_mfma_f32_16x16x32_bf16 v[128:131], v[96:99], v[80:83], v[128:131]
  ds_read_b128 v[32:35], v25 offset:0
  ds_read_b128 v[36:39], v25 offset:2048
  v_mfma_f32_16x16x32_bf16 v[132:135], v[96:99], v[84:87], v[132:135]
  ds_read_b64_tr_b16 v[48:49], v26 offset:0
  ds_read_b64_tr_b16 v[50:51], v26 offset:512
  v_mfma_f32_16x16x32_bf16 v[136:139], v[100:103], v[80:83], v[136:139]
  ds_read_b64_tr_b16 v[52:53], v27 offset:0
  ds_read_b64_tr_b16 v[54:55], v27 offset:512
  v_mfma_f32_16x16x32_bf16 v[140:143], v[100:103], v[84:87], v[140:143]
  ds_read_b64_tr_b16 v[56:57], v28 offset:0
  ds_read_b64_tr_b16 v[58:59], v28 offset:512
  v_mfma_f32_16x16x32_bf16 v[144:147], v[104:107], v[80:83], v[144:147]
  ds_read_b64_tr_b16 v[60:61], v29 offset:0
  ds_read_b64_tr_b16 v[62:63], v29 offset:512
  v_mfma_f32_16x16x32_bf16 v[148:151], v[104:107], v[84:87], v[148:151]
  ds_read_b128 v[40:43], v25 offset:1024
  ds_read_b128 v[44:47], v25 offset:3072
  v_mfma_f32_16x16x32_bf16 v[152:155], v[108:111], v[80:83], v[152:155]
  ds_read_b64_tr_b16 v[64:65], v26 offset:4096
  ds_read_b64_tr_b16 v[66:67], v26 offset:4608
  v_mfma_f32_16x16x32_bf16 v[156:159], v[108:111], v[84:87], v[156:159]
  ds_read_b64_tr_b16 v[68:69], v27 offset:4096
  ds_read_b64_tr_b16 v[70:71], v27 offset:4608
  v_mfma_f32_16x16x32_bf16 v[128:131], v[112:115], v[88:91], v[128:131]
  ds_read_b64_tr_b16 v[72:73], v28 offset:4096
  ds_read_b64_tr_b16 v[74:75], v28 offset:4608
  v_mfma_f32_16x16x32_bf16 v[132:135], v[112:115], v[92:95], v[132:135]
  ds_read_b64_tr_b16 v[76:77], v29 offset:4096
  ds_read_b64_tr_b16 v[78:79], v29 offset:4608
  v_mfma_f32_16x16x32_bf16 v[136:139], v[116:119], v[88:91], v[136:139]
  v_add_u32_e64 v25, s75, v5
  v_add_u32_e64 v26, s75, v6
  v_mfma_f32_16x16x32_bf16 v[140:143], v[116:119], v[92:95], v[140:143]
  v_add_u32_e64 v27, s75, v7
  v_add_u32_e64 v28, s75, v8
  v_mfma_f32_16x16x32_bf16 v[144:147], v[120:123], v[88:91], v[144:147]
  v_add_u32_e64 v29, s75, v9
  s_add_u32 s75, s75, 24576
  v_mfma_f32_16x16x32_bf16 v[148:151], v[120:123], v[92:95], v[148:151]
  s_cmp_eq_u32 s75, 147456
  s_cselect_b32 s75, 0, s75
  s_cmp_lg_u32 s79, 0
  v_mfma_f32_16x16x32_bf16 v[152:155], v[124:127], v[88:91], v[152:155]
  v_mfma_f32_16x16x32_bf16 v[156:159], v[124:127], v[92:95], v[156:159]
  s_waitcnt lgkmcnt(0)
  s_cbranch_scc1 L_w2_loop
  ds_read_b64 v[160:161], v15 offset:0
  ds_read_b64 v[164:165], v15 offset:512
  ds_read_b64 v[168:169], v15 offset:1024
  ds_read_b64 v[172:173], v15 offset:1536
  ds_read_b64 v[162:163], v15 offset:2048
  ds_read_b64 v[166:167], v15 offset:2560
  ds_read_b64 v[170:171], v15 offset:3072
  ds_read_b64 v[174:175], v15 offset:3584
  v_mov_b32 v20, 0
  v_mov_b32 v21, 0
  v_mov_b32 v22, 0
  v_mov_b32 v23, 0
  s_mov_b32 s3, 32768
  s_mov_b32 s10, 0x3f803f80
  s_waitcnt lgkmcnt(7)
  v_lshlrev_b32 v184, 16, v160
  v_and_b32 v185, s11, v160
  v_lshlrev_b32 v186, 16, v161
  v_and_b32 v187, s11, v161
  v_pk_add_f32 v[128:129], v[128:129], v[184:185]
  v_pk_add_f32 v[130:131], v[130:131], v[186:187]
  v_cvt_pk_bf16_f32 v32, v128, v129
  v_cvt_pk_bf16_f32 v33, v130, v131
  s_waitcnt lgkmcnt(6)
  v_lshlrev_b32 v184, 16, v164
  v_and_b32 v185, s11, v164
  v_lshlrev_b32 v186, 16, v165
  v_and_b32 v187, s11, v165
  v_pk_add_f32 v[136:137], v[136:137], v[184:185]
  v_pk_add_f32 v[138:139], v[138:139], v[186:187]
  v_cvt_pk_bf16_f32 v34, v136, v137
  v_cvt_pk_bf16_f32 v35, v138, v139
  s_nop 1
  v_permlane16_swap_b32 v32, v34
  v_permlane16_swap_b32 v33, v35
  buffer_store_dwordx4 v[32:35], v12, s[44:47], 0 offen offset:0 sc1
  s_waitcnt lgkmcnt(5)
  v_lshlrev_b32 v184, 16, v168
  v_and_b32 v185, s11, v168
  v_lshlrev_b32 v186, 16, v169
  v_and_b32 v187, s11, v169
  v_pk_add_f32 v[144:145], v[144:145], v[184:185]
  v_pk_add_f32 v[146:147], v[146:147], v[186:187]
  v_cvt_pk_bf16_f32 v36, v144, v145
  v_cvt_pk_bf16_f32 v37, v146, v147
  s_waitcnt lgkmcnt(4)
  v_lshlrev_b32 v184, 16, v172
  v_and_b32 v185, s11, v172
  v_lshlrev_b32 v186, 16, v173
  v_and_b32 v187, s11, v173
  v_pk_add_f32 v[152:153], v[152:153], v[184:185]
  v_pk_add_f32 v[154:155], v[154:155], v[186:187]
  v_cvt_pk_bf16_f32 v38, v152, v153
  v_cvt_pk_bf16_f32 v39, v154, v155
  s_nop 1
  v_permlane16_swap_b32 v36, v38
  v_permlane16_swap_b32 v37, v39
  buffer_store_dwordx4 v[36:39], v12, s[44:47], 0 offen offset:64 sc1
  s_waitcnt lgkmcnt(3)
  v_lshlrev_b32 v184, 16, v162
  v_and_b32 v185, s11, v162
  v_lshlrev_b32 v186, 16, v163
  v_and_b32 v187, s11, v163
  v_pk_add_f32 v[132:133], v[132:133], v[184:185]
  v_pk_add_f32 v[134:135], v[134:135], v[186:187]
  v_cvt_pk_bf16_f32 v40, v132, v133
  v_cvt_pk_bf16_f32 v41, v134, v135
  s_waitcnt lgkmcnt(2)
  v_lshlrev_b32 v184, 16, v166
  v_and_b32 v185, s11, v166
  v_lshlrev_b32 v186, 16, v167
  v_and_b32 v187, s11, v167
  v_pk_add_f32 v[140:141], v[140:141], v[184:185]
  v_pk_add_f32 v[142:143], v[142:143], v[186:187]
  v_cvt_pk_bf16_f32 v42, v140, v141
  v_cvt_pk_bf16_f32 v43, v142, v143
  s_nop 1
  v_permlane16_swap_b32 v40, v42
  v_permlane16_swap_b32 v41, v43
  buffer_store_dwordx4 v[40:43], v12, s[44:47], s3 offen offset:0 sc1
  s_waitcnt lgkmcnt(1)
  v_lshlrev_b32 v184, 16, v170
  v_and_b32 v185, s11, v170
  v_lshlrev_b32 v186, 16, v171
  v_and_b32 v187, s11, v171
  v_pk_add_f32 v[148:149], v[148:149], v[184:185]
  v_pk_add_f32 v[150:151], v[150:151], v[186:187]
  v_cvt_pk_bf16_f32 v44, v148, v149
  v_cvt_pk_bf16_f32 v45, v150, v151
  s_waitcnt lgkmcnt(0)
  v_lshlrev_b32 v184, 16, v174
  v_and_b32 v185, s11, v174
  v_lshlrev_b32 v186, 16, v175
  v_and_b32 v187, s11, v175
  v_pk_add_f32 v[156:157], v[156:157], v[184:185]
  v_pk_add_f32 v[158:159], v[158:159], v[186:187]
  v_cvt_pk_bf16_f32 v46, v156, v157
  v_cvt_pk_bf16_f32 v47, v158, v159
  s_nop 1
  v_permlane16_swap_b32 v44, v46
  v_permlane16_swap_b32 v45, v47
  buffer_store_dwordx4 v[44:47], v12, s[44:47], s3 offen offset:64 sc1
  v_dot2_f32_bf16 v20, v32, s10, v20
  v_dot2_f32_bf16 v22, v32, v32, v22
  v_dot2_f32_bf16 v20, v33, s10, v20
  v_dot2_f32_bf16 v22, v33, v33, v22
  v_dot2_f32_bf16 v20, v34, s10, v20
  v_dot2_f32_bf16 v22, v34, v34, v22
  v_dot2_f32_bf16 v20, v35, s10, v20
  v_dot2_f32_bf16 v22, v35, v35, v22
  v_dot2_f32_bf16 v20, v36, s10, v20
  v_dot2_f32_bf16 v22, v36, v36, v22
  v_dot2_f32_bf16 v20, v37, s10, v20
  v_dot2_f32_bf16 v22, v37, v37, v22
  v_dot2_f32_bf16 v20, v38, s10, v20
  v_dot2_f32_bf16 v22, v38, v38, v22
  v_dot2_f32_bf16 v20, v39, s10, v20
  v_dot2_f32_bf16 v22, v39, v39, v22
  v_dot2_f32_bf16 v21, v40, s10, v21
  v_dot2_f32_bf16 v23, v40, v40, v23
  v_dot2_f32_bf16 v21, v41, s10, v21
  v_dot2_f32_bf16 v23, v41, v41, v23
  v_dot2_f32_bf16 v21, v42, s10, v21
  v_dot2_f32_bf16 v23, v42, v42, v23
  v_dot2_f32_bf16 v21, v43, s10, v21
  v_dot2_f32_bf16 v23, v43, v43, v23
  v_dot2_f32_bf16 v21, v44, s10, v21
  v_dot2_f32_bf16 v23, v44, v44, v23
  v_dot2_f32_bf16 v21, v45, s10, v21
  v_dot2_f32_bf16 v23, v45, v45, v23
  v_dot2_f32_bf16 v21, v46, s10, v21
  v_dot2_f32_bf16 v23, v46, v46, v23
  v_dot2_f32_bf16 v21, v47, s10, v21
  v_dot2_f32_bf16 v23, v47, v47, v23
  s_nop 2
  v_permlane32_swap_b32 v20, v21
  v_permlane32_swap_b32 v22, v23
  v_add_f32 v20, v20, v21
  v_add_f32 v22, v22, v23
  s_nop 1
  v_permlane16_swap_b32 v20, v22
  v_add_f32 v20, v20, v22
  buffer_store_dword v20, v18, s[56:59], 0 offen sc1
  s_endpgm
.section .rodata,"a"
.p2align 6
.amdhsa_kernel w2l0_kernel
  .amdhsa_next_free_vgpr 256
  .amdhsa_next_free_sgpr 102
  .amdhsa_accum_offset 256
  .amdhsa_group_segment_fixed_size 0
  .amdhsa_kernarg_size 88
  .amdhsa_user_sgpr_count 2
  .amdhsa_user_sgpr_kernarg_segment_ptr 1
  .amdhsa_system_sgpr_workgroup_id_x 1
  .amdhsa_float_denorm_mode_32 3
  .amdhsa_float_denorm_mode_16_64 3
.end_amdhsa_kernel
.text
.text
.globl w2l1_kernel
.p2align 8
.type w2l1_kernel,@function
w2l1_kernel:
  s_load_dwordx16 s[16:31], s[0:1], 0
  s_load_dwordx2 s[32:33], s[0:1], 64
  s_load_dwordx2 s[34:35], s[0:1], 80
  s_load_dwordx2 s[12:13], s[0:1], 64
  s_mov_b32 s96, 1
  s_branch L_w2_body
L_w2_c1:
.section .rodata,"a"
.p2align 6
.amdhsa_kernel w2l1_kernel
  .amdhsa_next_free_vgpr 256
  .amdhsa_next_free_sgpr 102
  .amdhsa_accum_offset 256
  .amdhsa_group_segment_fixed_size 0
  .amdhsa_kernarg_size 88
  .amdhsa_user_sgpr_count 2
  .amdhsa_user_sgpr_kernarg_segment_ptr 1
  .amdhsa_system_sgpr_workgroup_id_x 1
  .amdhsa_float_denorm_mode_32 3
  .amdhsa_float_denorm_mode_16_64 3
.end_amdhsa_kernel
.text
```

```asm
; @launch kernel=attnl0_kernel grid=(256,1,1) block=(512,1,1) lds=130304
; @launch kernel=wol0_kernel grid=(256,1,1) block=(512,1,1) lds=163840
.amdgcn_target "amdgcn-amd-amdhsa--gfx950"
L_attn_c0:
.text
.globl attnl0_kernel
.p2align 8
.type attnl0_kernel,@function
attnl0_kernel:
  s_load_dwordx4 s[16:19], s[0:1], 0
  s_load_dwordx2 s[20:21], s[0:1], 16
  s_load_dwordx2 s[22:23], s[0:1], 80
  s_load_dwordx8 s[24:31], s[0:1], 32
  s_load_dwordx2 s[32:33], s[0:1], 64
  s_load_dwordx2 s[34:35], s[0:1], 80
  s_load_dwordx2 s[12:13], s[0:1], 0
  s_mov_b32 s96, 0
  s_mov_b32 s97, 0
L_attn_body:
  s_cmp_ge_u32 s2, 256
  s_cbranch_scc1 L_attn_end
  v_lshrrev_b32 v2, 6, v0
  v_and_b32 v1, 63, v0
  v_readfirstlane_b32 s70, v2
  s_and_b32 s3, s2, 7
  s_lshr_b32 s99, s2, 3
  s_and_b32 s5, s3, 1
  s_lshl_b32 s5, s5, 3
  s_and_b32 s6, s99, 7
  s_add_u32 s68, s5, s6
  s_lshr_b32 s5, s3, 1
  s_lshl_b32 s5, s5, 2
  s_lshr_b32 s6, s99, 3
  s_add_u32 s69, s5, s6
  s_cmp_lt_u32 s70, 4
  s_cbranch_scc1 L_attn_compute
L_attn_loader:
  s_add_u32 s8, s70, s69
  s_and_b32 s8, s8, 3
  s_add_u32 s9, s70, s68
  s_and_b32 s9, s9, 3
  s_lshl_b32 s76, s8, 12
  s_lshl_b32 s77, s9, 11
  s_add_u32 s77, s77, 16384
  s_lshl_b32 s11, s68, 7
  v_and_b32 v10, 7, v1
  v_lshrrev_b32 v3, 3, v1
  s_lshr_b32 s10, s76, 7
  s_lshl_b32 s3, s68, 7
  s_add_u32 s10, s10, s3
  v_add_u32 v3, s10, v3
  v_mul_u32_u24 v3, 2048, v3
  v_lshrrev_b32 v2, 4, v1
  v_xor_b32 v4, v2, v10
  v_lshl_add_u32 v4, v4, 4, v3
  v_add_u32 v3, 16384, v3
  v_add_u32 v5, 4, v2
  v_xor_b32 v5, v5, v10
  v_lshl_add_u32 v5, v5, 4, v3
  v_add_u32 v3, 16384, v3
  v_xor_b32 v6, v2, v10
  v_lshl_add_u32 v6, v6, 4, v3
  v_add_u32 v3, 16384, v3
  v_add_u32 v7, 4, v2
  v_xor_b32 v7, v7, v10
  v_lshl_add_u32 v7, v7, 4, v3
  v_lshrrev_b32 v3, 3, v1
  s_lshl_b32 s10, s9, 4
  v_add_u32 v3, s10, v3
  v_mul_u32_u24 v3, 6144, v3
  v_lshrrev_b32 v2, 3, v1
  v_and_b32 v2, 2, v2
  v_xor_b32 v2, v2, v10
  s_mul_i32 s10, s69, 128
  v_add_u32 v3, s10, v3
  v_lshl_add_u32 v8, v2, 4, v3
  v_xor_b32 v2, 4, v2
  v_add_u32 v3, 49152, v3
  v_lshl_add_u32 v9, v2, 4, v3
  s_and_b32 s10, s70, 3
  s_lshl_b32 s78, s10, 9
  s_add_u32 s78, s78, 40960
  s_lshl_b32 s14, s10, 2
  s_add_u32 s14, s14, s11
  s_sub_u32 s14, s14, 16
  v_lshrrev_b32 v3, 3, v1
  v_add_u32 v3, s14, v3
  v_max_i32 v3, 0, v3
  v_mul_u32_u24 v3, 2048, v3
  s_lshl_b32 s14, s10, 1
  v_lshrrev_b32 v2, 4, v1
  v_add_u32 v2, s14, v2
  v_and_b32 v2, 7, v2
  v_xor_b32 v2, v2, v10
  v_lshl_add_u32 v28, v2, 4, v3
  s_cmp_eq_u32 s10, 0
  s_cselect_b32 s14, 0xffffff00, -1
  s_mov_b32 s15, 0
  s_mov_b32 s75, 0
  s_add_u32 s100, s68, s69
  s_mov_b32 s101, -1
  s_add_u32 s101, s101, 1
  s_sub_u32 s73, s101, s100
  s_lshl_b32 s73, s73, 3
  s_lshr_b32 s73, 0xf0f02, s73
  s_and_b32 s73, s73, 255
  s_add_u32 s73, s73, s101
  s_and_b32 s73, s73, 15
  s_mul_i32 s74, s73, 393216
  s_lshl_b32 s73, s73, 7
  s_waitcnt lgkmcnt(0)
  s_mov_b32 s36, s12
  s_and_b32 s37, s13, 0xffff
  s_mov_b32 s38, 4194304
  s_mov_b32 s39, 0x00020000
  s_mov_b32 s40, s18
  s_and_b32 s41, s19, 0xffff
  s_mov_b32 s42, 6291456
  s_mov_b32 s43, 0x00020000
  s_cmp_lg_u32 s96, 0
  s_cbranch_scc1 L_attn_ld1
  s_mov_b32 s48, s28
  s_and_b32 s49, s29, 0xffff
  s_mov_b32 s50, 7340032
  s_mov_b32 s51, 0x00020000
  s_cmp_eq_u32 s96, 0
  s_cselect_b32 s50, s50, 0
  s_and_b32 s3, s70, 3
  s_lshl_b32 s4, s2, 2
  s_add_u32 s3, s3, s4
  s_mul_i32 s98, s3, 7168
  s_add_u32 s3, s75, s76
  s_add_u32 m0, s3, 0
  s_nop 0
  buffer_load_dwordx4 v4, s[36:39], s73 offen lds
  s_add_u32 m0, s3, 1024
  s_nop 0
  buffer_load_dwordx4 v5, s[36:39], s73 offen lds
  s_add_u32 m0, s3, 2048
  s_nop 0
  buffer_load_dwordx4 v6, s[36:39], s73 offen lds
  s_add_u32 m0, s3, 3072
  s_nop 0
  buffer_load_dwordx4 v7, s[36:39], s73 offen lds
  s_add_u32 m0, s78, s75
  s_mov_b64 exec, s[14:15]
  buffer_load_dwordx4 v28, s[36:39], s73 offen lds
  s_mov_b64 exec, -1
  s_add_u32 s3, s75, s77
  s_add_u32 m0, s3, 0
  s_add_u32 s4, s74, 0
  buffer_load_dwordx4 v8, s[40:43], s4 offen lds
  s_add_u32 m0, s3, 1024
  s_nop 0
  buffer_load_dwordx4 v9, s[40:43], s4 offen lds
  s_add_u32 m0, s3, 8192
  s_add_u32 s4, s74, 2048
  buffer_load_dwordx4 v8, s[40:43], s4 offen lds
  s_add_u32 m0, s3, 9216
  s_nop 0
  buffer_load_dwordx4 v9, s[40:43], s4 offen lds
  s_add_u32 m0, s3, 16384
  s_add_u32 s4, s74, 4096
  buffer_load_dwordx4 v8, s[40:43], s4 offen lds
  s_add_u32 m0, s3, 17408
  s_nop 0
  buffer_load_dwordx4 v9, s[40:43], s4 offen lds
  s_add_u32 s101, s101, 1
  s_sub_u32 s73, s101, s100
  s_lshl_b32 s73, s73, 3
  s_lshr_b32 s73, 0xf0f02, s73
  s_and_b32 s73, s73, 255
  s_add_u32 s73, s73, s101
  s_and_b32 s73, s73, 15
  s_mul_i32 s74, s73, 393216
  s_lshl_b32 s73, s73, 7
  s_add_u32 s75, s75, 43008
  s_cmp_eq_u32 s75, 129024
  s_cselect_b32 s75, 0, s75
  s_add_u32 s3, s75, s76
  s_add_u32 m0, s3, 0
  s_nop 0
  buffer_load_dwordx4 v4, s[36:39], s73 offen lds
  s_add_u32 m0, s3, 1024
  s_nop 0
  buffer_load_dwordx4 v5, s[36:39], s73 offen lds
  s_add_u32 m0, s3, 2048
  s_nop 0
  buffer_load_dwordx4 v6, s[36:39], s73 offen lds
  s_add_u32 m0, s3, 3072
  s_nop 0
  buffer_load_dwordx4 v7, s[36:39], s73 offen lds
  s_add_u32 m0, s78, s75
  s_mov_b64 exec, s[14:15]
  buffer_load_dwordx4 v28, s[36:39], s73 offen lds
  s_mov_b64 exec, -1
  s_add_u32 s3, s75, s77
  s_add_u32 m0, s3, 0
  s_add_u32 s4, s74, 0
  buffer_load_dwordx4 v8, s[40:43], s4 offen lds
  s_add_u32 m0, s3, 1024
  s_nop 0
  buffer_load_dwordx4 v9, s[40:43], s4 offen lds
  s_add_u32 m0, s3, 8192
  s_add_u32 s4, s74, 2048
  buffer_load_dwordx4 v8, s[40:43], s4 offen lds
  s_add_u32 m0, s3, 9216
  s_nop 0
  buffer_load_dwordx4 v9, s[40:43], s4 offen lds
  s_add_u32 m0, s3, 16384
  s_add_u32 s4, s74, 4096
  buffer_load_dwordx4 v8, s[40:43], s4 offen lds
  s_add_u32 m0, s3, 17408
  s_nop 0
  buffer_load_dwordx4 v9, s[40:43], s4 offen lds
  s_add_u32 s101, s101, 1
  s_sub_u32 s73, s101, s100
  s_lshl_b32 s73, s73, 3
  s_lshr_b32 s73, 0xf0f02, s73
  s_and_b32 s73, s73, 255
  s_add_u32 s73, s73, s101
  s_and_b32 s73, s73, 15
  s_mul_i32 s74, s73, 393216
  s_lshl_b32 s73, s73, 7
  s_add_u32 s75, s75, 43008
  s_cmp_eq_u32 s75, 129024
  s_cselect_b32 s75, 0, s75
  s_waitcnt vmcnt(11)
  s_barrier
  s_mov_b32 s79, 13
L_attn0_ld1:
  s_add_u32 s3, s75, s76
  s_add_u32 m0, s3, 0
  s_nop 0
  buffer_load_dwordx4 v4, s[36:39], s73 offen lds
  s_add_u32 m0, s3, 1024
  s_nop 0
  buffer_load_dwordx4 v5, s[36:39], s73 offen lds
  s_add_u32 m0, s3, 2048
  s_nop 0
  buffer_load_dwordx4 v6, s[36:39], s73 offen lds
  s_add_u32 m0, s3, 3072
  s_nop 0
  buffer_load_dwordx4 v7, s[36:39], s73 offen lds
  s_add_u32 m0, s78, s75
  s_mov_b64 exec, s[14:15]
  buffer_load_dwordx4 v28, s[36:39], s73 offen lds
  s_mov_b64 exec, -1
  s_add_u32 s3, s75, s77
  s_add_u32 m0, s3, 0
  s_add_u32 s4, s74, 0
  buffer_load_dwordx4 v8, s[40:43], s4 offen lds
  s_add_u32 m0, s3, 1024
  s_nop 0
  buffer_load_dwordx4 v9, s[40:43], s4 offen lds
  s_add_u32 m0, s3, 8192
  s_add_u32 s4, s74, 2048
  buffer_load_dwordx4 v8, s[40:43], s4 offen lds
  s_add_u32 m0, s3, 9216
  s_nop 0
  buffer_load_dwordx4 v9, s[40:43], s4 offen lds
  s_add_u32 m0, s3, 16384
  s_add_u32 s4, s74, 4096
  buffer_load_dwordx4 v8, s[40:43], s4 offen lds
  s_add_u32 m0, s3, 17408
  s_nop 0
  buffer_load_dwordx4 v9, s[40:43], s4 offen lds
  s_add_u32 s101, s101, 1
  s_sub_u32 s73, s101, s100
  s_lshl_b32 s73, s73, 3
  s_lshr_b32 s73, 0xf0f02, s73
  s_and_b32 s73, s73, 255
  s_add_u32 s73, s73, s101
  s_and_b32 s73, s73, 15
  s_mul_i32 s74, s73, 393216
  s_lshl_b32 s73, s73, 7
  s_add_u32 s75, s75, 43008
  s_cmp_eq_u32 s75, 129024
  s_cselect_b32 s75, 0, s75
  s_buffer_load_dword s84, s[48:51], s98 offset:0
  s_buffer_load_dword s84, s[48:51], s98 offset:64
  s_buffer_load_dword s84, s[48:51], s98 offset:128
  s_buffer_load_dword s84, s[48:51], s98 offset:192
  s_add_u32 s98, s98, 256
  s_waitcnt vmcnt(11)
  s_barrier
  s_sub_u32 s79, s79, 1
  s_cmp_lg_u32 s79, 0
  s_cbranch_scc1 L_attn0_ld1
  s_add_u32 s3, s75, s76
  s_add_u32 m0, s3, 0
  s_nop 0
  buffer_load_dwordx4 v4, s[36:39], s73 offen lds
  s_add_u32 m0, s3, 1024
  s_nop 0
  buffer_load_dwordx4 v5, s[36:39], s73 offen lds
  s_add_u32 m0, s3, 2048
  s_nop 0
  buffer_load_dwordx4 v6, s[36:39], s73 offen lds
  s_add_u32 m0, s3, 3072
  s_nop 0
  buffer_load_dwordx4 v7, s[36:39], s73 offen lds
  s_add_u32 m0, s78, s75
  s_mov_b64 exec, s[14:15]
  buffer_load_dwordx4 v28, s[36:39], s73 offen lds
  s_mov_b64 exec, -1
  s_add_u32 s3, s75, s77
  s_add_u32 m0, s3, 0
  s_add_u32 s4, s74, 0
  buffer_load_dwordx4 v8, s[40:43], s4 offen lds
  s_add_u32 m0, s3, 1024
  s_nop 0
  buffer_load_dwordx4 v9, s[40:43], s4 offen lds
  s_add_u32 m0, s3, 8192
  s_add_u32 s4, s74, 2048
  buffer_load_dwordx4 v8, s[40:43], s4 offen lds
  s_add_u32 m0, s3, 9216
  s_nop 0
  buffer_load_dwordx4 v9, s[40:43], s4 offen lds
  s_add_u32 m0, s3, 16384
  s_add_u32 s4, s74, 4096
  buffer_load_dwordx4 v8, s[40:43], s4 offen lds
  s_add_u32 m0, s3, 17408
  s_nop 0
  buffer_load_dwordx4 v9, s[40:43], s4 offen lds
  s_add_u32 s101, s101, 1
  s_sub_u32 s73, s101, s100
  s_lshl_b32 s73, s73, 3
  s_lshr_b32 s73, 0xf0f02, s73
  s_and_b32 s73, s73, 255
  s_add_u32 s73, s73, s101
  s_and_b32 s73, s73, 15
  s_mul_i32 s74, s73, 393216
  s_lshl_b32 s73, s73, 7
  s_add_u32 s75, s75, 43008
  s_cmp_eq_u32 s75, 129024
  s_cselect_b32 s75, 0, s75
  s_buffer_load_dword s84, s[48:51], s98 offset:0
  s_buffer_load_dword s84, s[48:51], s98 offset:64
  s_buffer_load_dword s84, s[48:51], s98 offset:128
  s_buffer_load_dword s84, s[48:51], s98 offset:192
  s_add_u32 s98, s98, 256
  s_mov_b32 s64, s24
  s_and_b32 s65, s25, 0xffff
  s_mov_b32 s66, 7340032
  s_mov_b32 s67, 0x00020000
  s_min_u32 s3, s2, 223
  s_mul_i32 s4, s3, 4682
  s_lshr_b32 s4, s4, 16
  s_mul_i32 s5, s4, 14
  s_sub_u32 s3, s3, s5
  s_lshl_b32 s3, s3, 2
  s_and_b32 s5, s70, 3
  s_add_u32 s3, s3, s5
  s_mul_i32 s5, s4, 458752
  s_lshl_b32 s8, s3, 7
  s_add_u32 s5, s5, s8
  s_lshl_b32 s9, s4, 14
  s_lshl_b32 s8, s3, 8
  s_add_u32 s9, s9, s8
  v_lshrrev_b32 v2, 3, v1
  v_mul_u32_u24 v2, 7168, v2
  v_and_b32 v3, 7, v1
  v_lshl_add_u32 v2, v3, 4, v2
  buffer_load_dwordx4 v[64:67], v2, s[64:67], s5 offen
  s_add_u32 s5, s5, 57344
  buffer_load_dwordx4 v[68:71], v2, s[64:67], s5 offen
  s_add_u32 s5, s5, 57344
  buffer_load_dwordx4 v[72:75], v2, s[64:67], s5 offen
  s_add_u32 s5, s5, 57344
  buffer_load_dwordx4 v[76:79], v2, s[64:67], s5 offen
  s_add_u32 s5, s5, 57344
  buffer_load_dwordx4 v[80:83], v2, s[64:67], s5 offen
  s_add_u32 s5, s5, 57344
  buffer_load_dwordx4 v[84:87], v2, s[64:67], s5 offen
  s_add_u32 s5, s5, 57344
  buffer_load_dwordx4 v[88:91], v2, s[64:67], s5 offen
  s_add_u32 s5, s5, 57344
  buffer_load_dwordx4 v[92:95], v2, s[64:67], s5 offen
  s_add_u32 s52, s22, 24903680
  s_addc_u32 s53, s23, 0
  s_and_b32 s53, s53, 0xffff
  s_mov_b32 s54, 262144
  s_mov_b32 s55, 0x00020000
  s_lshl_b32 s3, s2, 10
  v_lshlrev_b32 v2, 2, v0
  v_and_b32 v2, 1023, v2
  v_mov_b32 v3, 0
  buffer_store_dword v3, v2, s[52:55], s3 offen sc1
  s_mov_b32 s60, s20
  s_and_b32 s61, s21, 0xffff
  s_mov_b32 s62, 2097152
  s_mov_b32 s63, 0x00020000
  s_and_b32 s3, s70, 3
  s_mul_i32 s3, s3, 8
  s_mul_i32 s4, s99, 32
  s_add_u32 s3, s3, s4
  v_lshrrev_b32 v2, 3, v1
  v_add_u32 v2, s3, v2
  v_mul_u32_u24 v2, 2048, v2
  v_and_b32 v3, 7, v1
  v_lshl_add_u32 v2, v3, 7, v2
  s_and_b32 s3, s2, 7
  s_lshr_b32 s3, s3, 2
  s_mul_i32 s3, s3, 1024
  buffer_load_dword v96, v2, s[60:63], s3 offen
  s_waitcnt vmcnt(21)
  s_barrier
  s_waitcnt vmcnt(10)
  s_barrier
  s_barrier
  s_barrier
  s_barrier
  s_waitcnt vmcnt(0)
  s_mov_b32 s7, 0xffff0000
  v_lshlrev_b32 v32, 16, v64
  v_and_b32 v33, s7, v64
  v_lshlrev_b32 v34, 16, v65
  v_and_b32 v35, s7, v65
  v_lshlrev_b32 v36, 16, v66
  v_and_b32 v37, s7, v66
  v_lshlrev_b32 v38, 16, v67
  v_and_b32 v39, s7, v67
  v_lshlrev_b32 v40, 16, v68
  v_and_b32 v41, s7, v68
  v_pk_add_f32 v[32:33], v[32:33], v[40:41]
  v_lshlrev_b32 v40, 16, v69
  v_and_b32 v41, s7, v69
  v_pk_add_f32 v[34:35], v[34:35], v[40:41]
  v_lshlrev_b32 v40, 16, v70
  v_and_b32 v41, s7, v70
  v_pk_add_f32 v[36:37], v[36:37], v[40:41]
  v_lshlrev_b32 v40, 16, v71
  v_and_b32 v41, s7, v71
  v_pk_add_f32 v[38:39], v[38:39], v[40:41]
  v_lshlrev_b32 v40, 16, v72
  v_and_b32 v41, s7, v72
  v_pk_add_f32 v[32:33], v[32:33], v[40:41]
  v_lshlrev_b32 v40, 16, v73
  v_and_b32 v41, s7, v73
  v_pk_add_f32 v[34:35], v[34:35], v[40:41]
  v_lshlrev_b32 v40, 16, v74
  v_and_b32 v41, s7, v74
  v_pk_add_f32 v[36:37], v[36:37], v[40:41]
  v_lshlrev_b32 v40, 16, v75
  v_and_b32 v41, s7, v75
  v_pk_add_f32 v[38:39], v[38:39], v[40:41]
  v_lshlrev_b32 v40, 16, v76
  v_and_b32 v41, s7, v76
  v_pk_add_f32 v[32:33], v[32:33], v[40:41]
  v_lshlrev_b32 v40, 16, v77
  v_and_b32 v41, s7, v77
  v_pk_add_f32 v[34:35], v[34:35], v[40:41]
  v_lshlrev_b32 v40, 16, v78
  v_and_b32 v41, s7, v78
  v_pk_add_f32 v[36:37], v[36:37], v[40:41]
  v_lshlrev_b32 v40, 16, v79
  v_and_b32 v41, s7, v79
  v_pk_add_f32 v[38:39], v[38:39], v[40:41]
  v_lshlrev_b32 v40, 16, v80
  v_and_b32 v41, s7, v80
  v_pk_add_f32 v[32:33], v[32:33], v[40:41]
  v_lshlrev_b32 v40, 16, v81
  v_and_b32 v41, s7, v81
  v_pk_add_f32 v[34:35], v[34:35], v[40:41]
  v_lshlrev_b32 v40, 16, v82
  v_and_b32 v41, s7, v82
  v_pk_add_f32 v[36:37], v[36:37], v[40:41]
  v_lshlrev_b32 v40, 16, v83
  v_and_b32 v41, s7, v83
  v_pk_add_f32 v[38:39], v[38:39], v[40:41]
  v_lshlrev_b32 v40, 16, v84
  v_and_b32 v41, s7, v84
  v_pk_add_f32 v[32:33], v[32:33], v[40:41]
  v_lshlrev_b32 v40, 16, v85
  v_and_b32 v41, s7, v85
  v_pk_add_f32 v[34:35], v[34:35], v[40:41]
  v_lshlrev_b32 v40, 16, v86
  v_and_b32 v41, s7, v86
  v_pk_add_f32 v[36:37], v[36:37], v[40:41]
  v_lshlrev_b32 v40, 16, v87
  v_and_b32 v41, s7, v87
  v_pk_add_f32 v[38:39], v[38:39], v[40:41]
  v_lshlrev_b32 v40, 16, v88
  v_and_b32 v41, s7, v88
  v_pk_add_f32 v[32:33], v[32:33], v[40:41]
  v_lshlrev_b32 v40, 16, v89
  v_and_b32 v41, s7, v89
  v_pk_add_f32 v[34:35], v[34:35], v[40:41]
  v_lshlrev_b32 v40, 16, v90
  v_and_b32 v41, s7, v90
  v_pk_add_f32 v[36:37], v[36:37], v[40:41]
  v_lshlrev_b32 v40, 16, v91
  v_and_b32 v41, s7, v91
  v_pk_add_f32 v[38:39], v[38:39], v[40:41]
  v_lshlrev_b32 v40, 16, v92
  v_and_b32 v41, s7, v92
  v_pk_add_f32 v[32:33], v[32:33], v[40:41]
  v_lshlrev_b32 v40, 16, v93
  v_and_b32 v41, s7, v93
  v_pk_add_f32 v[34:35], v[34:35], v[40:41]
  v_lshlrev_b32 v40, 16, v94
  v_and_b32 v41, s7, v94
  v_pk_add_f32 v[36:37], v[36:37], v[40:41]
  v_lshlrev_b32 v40, 16, v95
  v_and_b32 v41, s7, v95
  v_pk_add_f32 v[38:39], v[38:39], v[40:41]
  s_add_u32 s64, s22, 24641536
  s_addc_u32 s65, s23, 0
  s_and_b32 s65, s65, 0xffff
  s_mov_b32 s66, 262144
  s_mov_b32 s67, 0x00020000
  v_permlane32_swap_b32 v32, v36
  v_permlane32_swap_b32 v33, v37
  v_permlane32_swap_b32 v34, v38
  v_permlane32_swap_b32 v35, v39
  v_add_f32 v32, v32, v36
  v_add_f32 v33, v33, v37
  v_add_f32 v34, v34, v38
  v_add_f32 v35, v35, v39
  v_and_b32 v2, 7, v1
  v_lshlrev_b32 v2, 5, v2
  v_permlane16_swap_b32 v32, v34
  v_permlane16_swap_b32 v33, v35
  v_add_f32 v32, v32, v34
  v_add_f32 v33, v33, v35
  v_lshrrev_b32 v3, 4, v1
  v_lshl_add_u32 v2, v3, 3, v2
  v_add_f32_dpp v32, v32, v32 row_ror:8 row_mask:0xf bank_mask:0xf
  v_add_f32_dpp v33, v33, v33 row_ror:8 row_mask:0xf bank_mask:0xf
  buffer_store_dwordx2 v[32:33], v2, s[64:67], s9 offen
  s_endpgm
L_attn_ld1:
  s_add_u32 s56, s22, 24379392
  s_addc_u32 s57, s23, 0
  s_and_b32 s57, s57, 0xffff
  s_mov_b32 s58, 262144
  s_mov_b32 s59, 0x00020000
  s_mov_b32 s88, s73
  s_add_u32 m0, s77, 0
  s_add_u32 s4, s74, 0
  buffer_load_dwordx4 v8, s[40:43], s4 offen lds
  s_add_u32 m0, s77, 1024
  s_nop 0
  buffer_load_dwordx4 v9, s[40:43], s4 offen lds
  s_add_u32 m0, s77, 8192
  s_add_u32 s4, s74, 2048
  buffer_load_dwordx4 v8, s[40:43], s4 offen lds
  s_add_u32 m0, s77, 9216
  s_nop 0
  buffer_load_dwordx4 v9, s[40:43], s4 offen lds
  s_add_u32 m0, s77, 16384
  s_add_u32 s4, s74, 4096
  buffer_load_dwordx4 v8, s[40:43], s4 offen lds
  s_add_u32 m0, s77, 17408
  s_nop 0
  buffer_load_dwordx4 v9, s[40:43], s4 offen lds
  s_add_u32 s101, s101, 1
  s_sub_u32 s73, s101, s100
  s_lshl_b32 s73, s73, 3
  s_lshr_b32 s73, 0xf0f02, s73
  s_and_b32 s73, s73, 255
  s_add_u32 s73, s73, s101
  s_and_b32 s73, s73, 15
  s_mul_i32 s74, s73, 393216
  s_lshl_b32 s73, s73, 7
  s_mov_b32 s89, s73
  s_add_u32 m0, s77, 43008
  s_add_u32 s4, s74, 0
  buffer_load_dwordx4 v8, s[40:43], s4 offen lds
  s_add_u32 m0, s77, 44032
  s_nop 0
  buffer_load_dwordx4 v9, s[40:43], s4 offen lds
  s_add_u32 m0, s77, 51200
  s_add_u32 s4, s74, 2048
  buffer_load_dwordx4 v8, s[40:43], s4 offen lds
  s_add_u32 m0, s77, 52224
  s_nop 0
  buffer_load_dwordx4 v9, s[40:43], s4 offen lds
  s_add_u32 m0, s77, 59392
  s_add_u32 s4, s74, 4096
  buffer_load_dwordx4 v8, s[40:43], s4 offen lds
  s_add_u32 m0, s77, 60416
  s_nop 0
  buffer_load_dwordx4 v9, s[40:43], s4 offen lds
  s_add_u32 s101, s101, 1
  s_sub_u32 s73, s101, s100
  s_lshl_b32 s73, s73, 3
  s_lshr_b32 s73, 0xf0f02, s73
  s_and_b32 s73, s73, 255
  s_add_u32 s73, s73, s101
  s_and_b32 s73, s73, 15
  s_mul_i32 s74, s73, 393216
  s_lshl_b32 s73, s73, 7
  s_mov_b32 s75, 86016
  s_add_u32 s44, s22, 24903680
  s_addc_u32 s45, s23, 0
  s_and_b32 s45, s45, 0xffff
  s_mov_b32 s46, 32768
  s_mov_b32 s47, 0x00020000
  s_lshl_b32 s3, s97, 12
  s_lshl_b32 s4, s68, 8
  s_add_u32 s3, s3, s4
  s_sub_u32 s3, s3, 4096
  v_and_b32 v2, 15, v1
  v_lshlrev_b32 v2, 2, v2
  s_min_u32 s4, s4, 256
  s_sub_u32 s3, s3, s4
  v_lshlrev_b32 v3, 4, v1
  v_and_b32 v3, s4, v3
  v_add_u32 v2, v2, v3
  v_mov_b32 v3, 1
  s_mov_b32 s79, 0x100000
  s_cmp_lg_u32 s70, 4
  s_barrier
  s_cbranch_scc1 L_attn_dep
  s_mov_b64 exec, 1
  buffer_store_dword v3, off, s[44:47], s87 sc1
  s_mov_b64 exec, -1
L_attn_poll:
  buffer_load_dword v3, v2, s[44:47], s3 offen sc1
  s_sub_u32 s79, s79, 1
  s_cbranch_scc1 L_attn_dep
  s_waitcnt vmcnt(0)
  v_cmp_ne_u32 vcc, 1, v3
  s_cbranch_vccnz L_attn_poll
L_attn_dep:
  s_barrier
  s_add_u32 m0, s76, 0
  s_nop 0
  buffer_load_dwordx4 v4, s[36:39], s88 offen lds
  s_add_u32 m0, s76, 1024
  s_nop 0
  buffer_load_dwordx4 v5, s[36:39], s88 offen lds
  s_add_u32 m0, s76, 2048
  s_nop 0
  buffer_load_dwordx4 v6, s[36:39], s88 offen lds
  s_add_u32 m0, s76, 3072
  s_nop 0
  buffer_load_dwordx4 v7, s[36:39], s88 offen lds
  s_add_u32 m0, s78, 0
  s_mov_b64 exec, s[14:15]
  buffer_load_dwordx4 v28, s[36:39], s88 offen lds
  s_mov_b64 exec, -1
  s_add_u32 m0, s76, 43008
  s_nop 0
  buffer_load_dwordx4 v4, s[36:39], s89 offen lds
  s_add_u32 m0, s76, 44032
  s_nop 0
  buffer_load_dwordx4 v5, s[36:39], s89 offen lds
  s_add_u32 m0, s76, 45056
  s_nop 0
  buffer_load_dwordx4 v6, s[36:39], s89 offen lds
  s_add_u32 m0, s76, 46080
  s_nop 0
  buffer_load_dwordx4 v7, s[36:39], s89 offen lds
  s_add_u32 m0, s78, 43008
  s_mov_b64 exec, s[14:15]
  buffer_load_dwordx4 v28, s[36:39], s89 offen lds
  s_mov_b64 exec, -1
  s_waitcnt vmcnt(5)
  s_barrier
  s_mov_b32 s79, 13
L_attn1_ld1:
  s_add_u32 s3, s75, s76
  s_add_u32 m0, s3, 0
  s_nop 0
  buffer_load_dwordx4 v4, s[36:39], s73 offen lds
  s_add_u32 m0, s3, 1024
  s_nop 0
  buffer_load_dwordx4 v5, s[36:39], s73 offen lds
  s_add_u32 m0, s3, 2048
  s_nop 0
  buffer_load_dwordx4 v6, s[36:39], s73 offen lds
  s_add_u32 m0, s3, 3072
  s_nop 0
  buffer_load_dwordx4 v7, s[36:39], s73 offen lds
  s_add_u32 m0, s78, s75
  s_mov_b64 exec, s[14:15]
  buffer_load_dwordx4 v28, s[36:39], s73 offen lds
  s_mov_b64 exec, -1
  s_add_u32 s3, s75, s77
  s_add_u32 m0, s3, 0
  s_add_u32 s4, s74, 0
  buffer_load_dwordx4 v8, s[40:43], s4 offen lds
  s_add_u32 m0, s3, 1024
  s_nop 0
  buffer_load_dwordx4 v9, s[40:43], s4 offen lds
  s_add_u32 m0, s3, 8192
  s_add_u32 s4, s74, 2048
  buffer_load_dwordx4 v8, s[40:43], s4 offen lds
  s_add_u32 m0, s3, 9216
  s_nop 0
  buffer_load_dwordx4 v9, s[40:43], s4 offen lds
  s_add_u32 m0, s3, 16384
  s_add_u32 s4, s74, 4096
  buffer_load_dwordx4 v8, s[40:43], s4 offen lds
  s_add_u32 m0, s3, 17408
  s_nop 0
  buffer_load_dwordx4 v9, s[40:43], s4 offen lds
  s_add_u32 s101, s101, 1
  s_sub_u32 s73, s101, s100
  s_lshl_b32 s73, s73, 3
  s_lshr_b32 s73, 0xf0f02, s73
  s_and_b32 s73, s73, 255
  s_add_u32 s73, s73, s101
  s_and_b32 s73, s73, 15
  s_mul_i32 s74, s73, 393216
  s_lshl_b32 s73, s73, 7
  s_add_u32 s75, s75, 43008
  s_cmp_eq_u32 s75, 129024
  s_cselect_b32 s75, 0, s75
  s_waitcnt vmcnt(11)
  s_barrier
  s_sub_u32 s79, s79, 1
  s_cmp_lg_u32 s79, 0
  s_cbranch_scc1 L_attn1_ld1
  s_add_u32 s3, s75, s76
  s_add_u32 m0, s3, 0
  s_nop 0
  buffer_load_dwordx4 v4, s[36:39], s73 offen lds
  s_add_u32 m0, s3, 1024
  s_nop 0
  buffer_load_dwordx4 v5, s[36:39], s73 offen lds
  s_add_u32 m0, s3, 2048
  s_nop 0
  buffer_load_dwordx4 v6, s[36:39], s73 offen lds
  s_add_u32 m0, s3, 3072
  s_nop 0
  buffer_load_dwordx4 v7, s[36:39], s73 offen lds
  s_add_u32 m0, s78, s75
  s_mov_b64 exec, s[14:15]
  buffer_load_dwordx4 v28, s[36:39], s73 offen lds
  s_mov_b64 exec, -1
  s_add_u32 s3, s75, s77
  s_add_u32 m0, s3, 0
  s_add_u32 s4, s74, 0
  buffer_load_dwordx4 v8, s[40:43], s4 offen lds
  s_add_u32 m0, s3, 1024
  s_nop 0
  buffer_load_dwordx4 v9, s[40:43], s4 offen lds
  s_add_u32 m0, s3, 8192
  s_add_u32 s4, s74, 2048
  buffer_load_dwordx4 v8, s[40:43], s4 offen lds
  s_add_u32 m0, s3, 9216
  s_nop 0
  buffer_load_dwordx4 v9, s[40:43], s4 offen lds
  s_add_u32 m0, s3, 16384
  s_add_u32 s4, s74, 4096
  buffer_load_dwordx4 v8, s[40:43], s4 offen lds
  s_add_u32 m0, s3, 17408
  s_nop 0
  buffer_load_dwordx4 v9, s[40:43], s4 offen lds
  s_add_u32 s101, s101, 1
  s_sub_u32 s73, s101, s100
  s_lshl_b32 s73, s73, 3
  s_lshr_b32 s73, 0xf0f02, s73
  s_and_b32 s73, s73, 255
  s_add_u32 s73, s73, s101
  s_and_b32 s73, s73, 15
  s_mul_i32 s74, s73, 393216
  s_lshl_b32 s73, s73, 7
  s_add_u32 s75, s75, 43008
  s_cmp_eq_u32 s75, 129024
  s_cselect_b32 s75, 0, s75
  s_and_b32 s3, s70, 3
  s_lshl_b32 s4, s68, 7
  s_lshl_b32 s5, s3, 6
  s_add_u32 s5, s5, s4
  v_add_u32 v2, s5, v1
  s_sub_u32 s4, s4, 16
  v_and_b32 v3, 15, v1
  v_add_u32 v3, s4, v3
  v_max_i32 v3, 0, v3
  s_cmp_ge_u32 s3, 2
  s_cselect_b64 vcc, -1, 0
  v_cndmask_b32 v2, v2, v3, vcc
  v_lshlrev_b32 v2, 3, v2
  s_mov_b32 s3, 0
  buffer_load_dwordx2 v[32:33], v2, s[56:59], s3 offen
  s_add_u32 s3, s3, 16384
  buffer_load_dwordx2 v[34:35], v2, s[56:59], s3 offen
  s_add_u32 s3, s3, 16384
  buffer_load_dwordx2 v[36:37], v2, s[56:59], s3 offen
  s_add_u32 s3, s3, 16384
  buffer_load_dwordx2 v[38:39], v2, s[56:59], s3 offen
  s_add_u32 s3, s3, 16384
  buffer_load_dwordx2 v[40:41], v2, s[56:59], s3 offen
  s_add_u32 s3, s3, 16384
  buffer_load_dwordx2 v[42:43], v2, s[56:59], s3 offen
  s_add_u32 s3, s3, 16384
  buffer_load_dwordx2 v[44:45], v2, s[56:59], s3 offen
  s_add_u32 s3, s3, 16384
  buffer_load_dwordx2 v[46:47], v2, s[56:59], s3 offen
  s_add_u32 s3, s3, 16384
  buffer_load_dwordx2 v[48:49], v2, s[56:59], s3 offen
  s_add_u32 s3, s3, 16384
  buffer_load_dwordx2 v[50:51], v2, s[56:59], s3 offen
  s_add_u32 s3, s3, 16384
  buffer_load_dwordx2 v[52:53], v2, s[56:59], s3 offen
  s_add_u32 s3, s3, 16384
  buffer_load_dwordx2 v[54:55], v2, s[56:59], s3 offen
  s_add_u32 s3, s3, 16384
  buffer_load_dwordx2 v[56:57], v2, s[56:59], s3 offen
  s_add_u32 s3, s3, 16384
  buffer_load_dwordx2 v[58:59], v2, s[56:59], s3 offen
  s_add_u32 s3, s3, 16384
  buffer_load_dwordx2 v[60:61], v2, s[56:59], s3 offen
  s_add_u32 s3, s3, 16384
  buffer_load_dwordx2 v[62:63], v2, s[56:59], s3 offen
  s_mov_b32 s60, s20
  s_and_b32 s61, s21, 0xffff
  s_mov_b32 s62, 2097152
  s_mov_b32 s63, 0x00020000
  s_and_b32 s3, s70, 3
  s_mul_i32 s3, s3, 8
  s_mul_i32 s4, s99, 32
  s_add_u32 s3, s3, s4
  v_lshrrev_b32 v2, 3, v1
  v_add_u32 v2, s3, v2
  v_mul_u32_u24 v2, 2048, v2
  v_and_b32 v3, 7, v1
  v_lshl_add_u32 v2, v3, 7, v2
  s_and_b32 s3, s2, 7
  s_lshr_b32 s3, s3, 2
  s_mul_i32 s3, s3, 1024
  buffer_load_dword v96, v2, s[60:63], s3 offen
  s_waitcnt vmcnt(28)
  s_barrier
  s_waitcnt vmcnt(17)
  s_barrier
  s_waitcnt vmcnt(1)
  v_add_f32 v32, v32, v34
  v_add_f32 v33, v33, v35
  v_add_f32 v48, v48, v50
  v_add_f32 v49, v49, v51
  v_add_f32 v32, v32, v36
  v_add_f32 v33, v33, v37
  v_add_f32 v48, v48, v52
  v_add_f32 v49, v49, v53
  v_add_f32 v32, v32, v38
  v_add_f32 v33, v33, v39
  v_add_f32 v48, v48, v54
  v_add_f32 v49, v49, v55
  v_add_f32 v32, v32, v40
  v_add_f32 v33, v33, v41
  v_add_f32 v48, v48, v56
  v_add_f32 v49, v49, v57
  v_add_f32 v32, v32, v42
  v_add_f32 v33, v33, v43
  v_add_f32 v48, v48, v58
  v_add_f32 v49, v49, v59
  v_add_f32 v32, v32, v44
  v_add_f32 v33, v33, v45
  v_add_f32 v48, v48, v60
  v_add_f32 v49, v49, v61
  v_add_f32 v32, v32, v46
  v_add_f32 v33, v33, v47
  v_add_f32 v48, v48, v62
  v_add_f32 v49, v49, v63
  v_add_f32 v32, v32, v48
  v_add_f32 v33, v33, v49
  v_mul_f32 v32, 0x3a800000, v32
  v_mul_f32 v33, 0x3a800000, v33
  v_fma_f32 v33, -v32, v32, v33
  v_max_f32 v33, 0, v33
  v_add_f32 v33, 0x3727c5ac, v33
  v_rsq_f32 v33, v33
  s_nop 0
  s_and_b32 s3, s70, 3
  s_lshl_b32 s5, s3, 6
  s_add_u32 s5, s5, 16
  v_add_u32 v2, s5, v1
  v_and_b32 v3, 15, v1
  s_cmp_ge_u32 s3, 2
  s_cselect_b64 vcc, -1, 0
  v_cndmask_b32 v2, v2, v3, vcc
  v_lshlrev_b32 v2, 2, v2
  v_add_u32 v2, 129024, v2
  ds_write2_b32 v2, v32, v33 offset0:0 offset1:160
  s_waitcnt lgkmcnt(0)
  s_barrier
  s_barrier
  s_waitcnt vmcnt(0)
  s_lshl_b32 s87, s97, 12
  s_lshl_b32 s4, s68, 8
  s_add_u32 s87, s87, s4
  s_lshl_b32 s4, s69, 2
  s_add_u32 s87, s87, s4
  s_add_u32 s97, s97, 1
  s_branch L_wo_body
L_attn_end:
  s_endpgm
L_attn_compute:
  s_cmp_lg_u32 s96, 0
  s_cbranch_scc1 L_pfc1_skip
  s_getpc_b64 s[4:5]
L_pfc1:
  s_lshl_b32 s3, s99, 2
  s_add_u32 s3, s3, s70
  s_mul_i32 s3, s3, 256
  s_min_u32 s3, s3, L_w2_c1-L_attn_c0-256
  s_add_i32 s3, s3, L_attn_c0-L_pfc1
  s_ashr_i32 s6, s3, 31
  s_add_u32 s4, s4, s3
  s_addc_u32 s5, s5, s6
  s_load_dword s36, s[4:5], 0
  s_load_dword s37, s[4:5], 64
  s_load_dword s38, s[4:5], 128
  s_load_dword s39, s[4:5], 192
L_pfc1_skip:
  s_and_b32 s71, s70, 1
  s_lshr_b32 s72, s70, 1
  v_and_b32 v3, 31, v1
  v_lshlrev_b32 v3, 2, v3
  v_add_u32 v3, 40960, v3
  v_mov_b32 v236, 0x3f803f80
  v_mov_b32 v237, 0x3f803f80
  v_mov_b32 v238, 0x3f803f80
  v_mov_b32 v239, 0x3f803f80
  ds_write_b32 v3, v236
  ds_write_b32 v3, v236 offset:43008
  v_add_u32 v3, 86016, v3
  ds_write_b32 v3, v236
  v_and_b32 v3, 15, v1
  v_lshrrev_b32 v2, 4, v1
  v_lshrrev_b32 v33, 1, v3
  s_lshl_b32 s8, s71, 13
  v_xor_b32 v4, v2, v33
  v_lshlrev_b32 v4, 4, v4
  v_lshl_add_u32 v4, v3, 7, v4
  v_add_u32 v8, 40960, v4
  v_add_u32 v4, s8, v4
  v_add_u32 v5, 4, v2
  v_xor_b32 v5, v5, v33
  v_lshlrev_b32 v5, 4, v5
  v_lshl_add_u32 v5, v3, 7, v5
  v_add_u32 v9, 40960, v5
  v_add_u32 v5, s8, v5
  v_bfe_u32 v34, v1, 2, 2
  v_lshl_add_u32 v34, v2, 3, v34
  v_lshlrev_b32 v34, 7, v34
  v_and_b32 v33, 3, v1
  v_lshl_add_u32 v34, v33, 3, v34
  v_bfe_u32 v33, v1, 3, 2
  v_lshl_add_u32 v34, v33, 5, v34
  v_and_b32 v35, 1, v2
  v_xor_b32 v35, s71, v35
  s_lshl_b32 s8, s70, 5
  v_xor_b32 v34, s8, v34
  v_add_u32 v6, 16384, v34
  v_xor_b32 v7, 32, v6
  s_lshl_b32 s8, s68, 7
  s_lshl_b32 s9, s71, 6
  s_add_u32 s8, s8, s9
  s_add_u32 s10, s8, s69
  s_lshl_b32 s10, s10, 11
  s_lshl_b32 s11, s72, 10
  s_add_u32 s10, s10, s11
  v_lshl_add_u32 v33, v3, 4, s10
  v_lshl_add_u32 v33, v35, 9, v33
  v_lshrrev_b32 v34, 1, v2
  v_lshl_add_u32 v31, v34, 8, v33
  s_mul_i32 s10, s72, 24576
  s_add_u32 s10, s10, 1024
  s_lshl_b32 s11, s71, 10
  s_add_u32 s4, s10, s11
  s_sub_u32 s5, s10, s11
  s_mul_i32 s6, s71, 6144
  v_lshl_add_u32 v16, v1, 4, s4
  v_add_u32 v17, s6, v16
  v_lshl_add_u32 v18, v1, 4, s5
  v_add_u32 v18, s6, v18
  v_lshl_add_u32 v19, v2, 8, s4
  v_lshl_add_u32 v20, v2, 8, s5
  v_lshl_add_u32 v21, v3, 4, s4
  v_lshl_add_u32 v22, v3, 4, s5
  s_lshl_b32 s10, s71, 8
  s_add_u32 s10, s10, 129024
  v_lshl_add_u32 v23, v3, 2, s10
  v_lshl_add_u32 v24, v2, 4, s10
  v_and_b32 v33, 1, v3
  v_cmp_eq_u32 s[48:49], 1, v33
  v_lshl_add_u32 v34, v2, 2, v33
  v_add_u32 v35, 2, v34
  v_cmp_gt_u32 s[50:51], v34, v3
  v_cmp_gt_u32 s[52:53], v35, v3
  v_mov_b32 v36, 0xffff
  v_mov_b32 v37, 0xffff0000
  v_cndmask_b32 v36, v36, v37, s[48:49]
  s_add_u32 s10, s10, 704
  v_lshl_add_u32 v34, v34, 2, s10
  v_lshl_add_u32 v35, v35, 2, s10
  v_subrev_u32 v38, 64, v34
  v_subrev_u32 v39, 64, v35
  v_cndmask_b32 v25, v34, v38, s[50:51]
  v_cndmask_b32 v26, v35, v39, s[52:53]
  v_cndmask_b32 v27, 0, v36, s[50:51]
  v_cndmask_b32 v29, 0, v36, s[52:53]
  v_xor_b32 v28, v27, v36
  v_xor_b32 v30, v29, v36
  s_cmp_eq_u32 s8, 0
  s_cselect_b64 s[54:55], s[50:51], 0
  s_cselect_b64 s[14:15], s[52:53], 0
  v_mov_b32 v120, 0
  v_mov_b32 v121, 0
  v_mov_b32 v122, 0
  v_mov_b32 v123, 0
  v_mov_b32 v124, 0
  v_mov_b32 v125, 0
  v_mov_b32 v126, 0
  v_mov_b32 v127, 0
  v_mov_b32 v128, 0
  v_mov_b32 v129, 0
  v_mov_b32 v130, 0
  v_mov_b32 v131, 0
  v_mov_b32 v132, 0
  v_mov_b32 v133, 0
  v_mov_b32 v134, 0
  v_mov_b32 v135, 0
  v_mov_b32 v136, 0
  v_mov_b32 v137, 0
  v_mov_b32 v138, 0
  v_mov_b32 v139, 0
  v_mov_b32 v140, 0
  v_mov_b32 v141, 0
  v_mov_b32 v142, 0
  v_mov_b32 v143, 0
  v_mov_b32 v144, 0
  v_mov_b32 v145, 0
  v_mov_b32 v146, 0
  v_mov_b32 v147, 0
  v_mov_b32 v148, 0
  v_mov_b32 v149, 0
  v_mov_b32 v150, 0
  v_mov_b32 v151, 0
  v_mov_b32 v152, 0
  v_mov_b32 v153, 0
  v_mov_b32 v154, 0
  v_mov_b32 v155, 0
  v_mov_b32 v156, 0
  v_mov_b32 v157, 0
  v_mov_b32 v158, 0
  v_mov_b32 v159, 0
  v_mov_b32 v160, 0
  v_mov_b32 v161, 0
  v_mov_b32 v162, 0
  v_mov_b32 v163, 0
  v_mov_b32 v164, 0
  v_mov_b32 v165, 0
  v_mov_b32 v166, 0
  v_mov_b32 v167, 0
  v_mov_b32 v168, 0
  v_mov_b32 v169, 0
  v_mov_b32 v170, 0
  v_mov_b32 v171, 0
  v_mov_b32 v172, 0
  v_mov_b32 v173, 0
  v_mov_b32 v174, 0
  v_mov_b32 v175, 0
  v_mov_b32 v176, 0
  v_mov_b32 v177, 0
  v_mov_b32 v178, 0
  v_mov_b32 v179, 0
  v_mov_b32 v180, 0
  v_mov_b32 v181, 0
  v_mov_b32 v182, 0
  v_mov_b32 v183, 0
  v_mov_b32 v184, 0
  v_mov_b32 v185, 0
  v_mov_b32 v186, 0
  v_mov_b32 v187, 0
  v_mov_b32 v188, 0
  v_mov_b32 v189, 0
  v_mov_b32 v190, 0
  v_mov_b32 v191, 0
  v_mov_b32 v192, 0
  v_mov_b32 v193, 0
  v_mov_b32 v194, 0
  v_mov_b32 v195, 0
  v_mov_b32 v196, 0
  v_mov_b32 v197, 0
  v_mov_b32 v198, 0
  v_mov_b32 v199, 0
  v_mov_b32 v200, 0
  v_mov_b32 v201, 0
  v_mov_b32 v202, 0
  v_mov_b32 v203, 0
  v_mov_b32 v204, 0
  v_mov_b32 v205, 0
  v_mov_b32 v206, 0
  v_mov_b32 v207, 0
  v_mov_b32 v208, 0
  v_mov_b32 v209, 0
  v_mov_b32 v210, 0
  v_mov_b32 v211, 0
  v_mov_b32 v212, 0
  v_mov_b32 v213, 0
  v_mov_b32 v214, 0
  v_mov_b32 v215, 0
  v_mov_b32 v216, 0
  v_mov_b32 v217, 0
  v_mov_b32 v218, 0
  v_mov_b32 v219, 0
  v_mov_b32 v220, 0
  v_mov_b32 v221, 0
  v_mov_b32 v222, 0
  v_mov_b32 v223, 0
  v_mov_b32 v224, 0
  v_mov_b32 v225, 0
  v_mov_b32 v226, 0
  v_mov_b32 v227, 0
  v_mov_b32 v228, 0
  v_mov_b32 v229, 0
  v_mov_b32 v230, 0
  v_mov_b32 v231, 0
  v_mov_b32 v232, 0
  v_mov_b32 v233, 0
  v_mov_b32 v234, 0
  v_mov_b32 v235, 0
  v_mov_b32 v240, 0
  v_mov_b32 v241, 0
  v_mov_b32 v242, 0
  v_mov_b32 v243, 0
  v_mov_b32 v244, 0
  v_mov_b32 v245, 0
  v_mov_b32 v246, 0
  v_mov_b32 v247, 0
  v_mov_b32 v248, 0
  v_mov_b32 v249, 0
  v_mov_b32 v250, 0
  v_mov_b32 v251, 0
  v_mov_b32 v252, 0
  v_mov_b32 v253, 0
  v_mov_b32 v254, 0
  v_mov_b32 v255, 0
  s_waitcnt lgkmcnt(0)
  s_mov_b32 s44, s34
  s_and_b32 s45, s35, 0xffff
  s_mov_b32 s46, 4194304
  s_mov_b32 s47, 0x00020000
  s_mov_b32 s75, 0
  v_add_u32_e64 v10, s75, v4
  v_add_u32_e64 v11, s75, v5
  v_add_u32_e64 v12, s75, v6
  v_add_u32_e64 v13, s75, v7
  v_add_u32_e64 v14, s75, v8
  v_add_u32_e64 v15, s75, v9
  s_add_u32 s75, s75, 43008
  s_cmp_eq_u32 s75, 129024
  s_cselect_b32 s75, 0, s75
  s_mov_b32 s79, 16
  s_cmp_eq_u32 s96, 0
  s_cbranch_scc1 L_attn_nog
  s_barrier
L_attn_nog:
  s_barrier
  ds_read_b128 v[32:35], v10 offset:0
  ds_read_b128 v[36:39], v10 offset:2048
  ds_read_b128 v[40:43], v10 offset:4096
  ds_read_b128 v[44:47], v10 offset:6144
  ds_read_b128 v[48:51], v14
  ds_read_b64_tr_b16 v[52:53], v12 offset:0
  ds_read_b64_tr_b16 v[54:55], v12 offset:512
  ds_read_b64_tr_b16 v[56:57], v13 offset:0
  ds_read_b64_tr_b16 v[58:59], v13 offset:512
  ds_read_b64_tr_b16 v[60:61], v12 offset:8192
  ds_read_b64_tr_b16 v[62:63], v12 offset:8704
  ds_read_b64_tr_b16 v[64:65], v13 offset:8192
  ds_read_b64_tr_b16 v[66:67], v13 offset:8704
  ds_read_b64_tr_b16 v[68:69], v12 offset:16384
  ds_read_b64_tr_b16 v[70:71], v12 offset:16896
  ds_read_b64_tr_b16 v[72:73], v13 offset:16384
  ds_read_b64_tr_b16 v[74:75], v13 offset:16896
  s_waitcnt lgkmcnt(0)
  s_cmp_lg_u32 s96, 0
  s_cbranch_scc1 L_attn_loop
  s_cmp_lg_u32 s72, 0
  s_cbranch_scc1 L_attn_loopb
.p2align 3
L_attn_loopa:
  v_mfma_f32_16x16x32_bf16 v[240:243], v[236:239], v[32:35], v[240:243]
  ds_read_b128 v[76:79], v11 offset:0
  v_mfma_f32_16x16x32_bf16 v[244:247], v[32:35], v[32:35], v[244:247]
  ds_read_b128 v[80:83], v11 offset:2048
  v_mfma_f32_16x16x32_bf16 v[248:251], v[236:239], v[36:39], v[248:251]
  ds_read_b128 v[84:87], v11 offset:4096
  v_mfma_f32_16x16x32_bf16 v[252:255], v[36:39], v[36:39], v[252:255]
  ds_read_b128 v[88:91], v11 offset:6144
  v_mfma_f32_16x16x32_bf16 v[120:123], v[236:239], v[48:51], v[120:123]
  ds_read_b128 v[92:95], v15
  v_mfma_f32_16x16x32_bf16 v[124:127], v[48:51], v[48:51], v[124:127]
  ds_read_b64_tr_b16 v[96:97], v12 offset:4096
  v_mfma_f32_16x16x32_bf16 v[128:131], v[52:55], v[32:35], v[128:131]
  ds_read_b64_tr_b16 v[98:99], v12 offset:4608
  v_mfma_f32_16x16x32_bf16 v[132:135], v[52:55], v[36:39], v[132:135]
  ds_read_b64_tr_b16 v[100:101], v13 offset:4096
  v_mfma_f32_16x16x32_bf16 v[136:139], v[52:55], v[40:43], v[136:139]
  ds_read_b64_tr_b16 v[102:103], v13 offset:4608
  v_mfma_f32_16x16x32_bf16 v[140:143], v[52:55], v[44:47], v[140:143]
  ds_read_b64_tr_b16 v[104:105], v12 offset:12288
  v_mfma_f32_16x16x32_bf16 v[224:227], v[52:55], v[48:51], v[224:227]
  ds_read_b64_tr_b16 v[106:107], v12 offset:12800
  v_mfma_f32_16x16x32_bf16 v[144:147], v[56:59], v[32:35], v[144:147]
  ds_read_b64_tr_b16 v[108:109], v13 offset:12288
  v_mfma_f32_16x16x32_bf16 v[148:151], v[56:59], v[36:39], v[148:151]
  ds_read_b64_tr_b16 v[110:111], v13 offset:12800
  v_mfma_f32_16x16x32_bf16 v[152:155], v[56:59], v[40:43], v[152:155]
  ds_read_b64_tr_b16 v[112:113], v12 offset:20480
  v_mfma_f32_16x16x32_bf16 v[156:159], v[56:59], v[44:47], v[156:159]
  ds_read_b64_tr_b16 v[114:115], v12 offset:20992
  v_mfma_f32_16x16x32_bf16 v[160:163], v[60:63], v[32:35], v[160:163]
  ds_read_b64_tr_b16 v[116:117], v13 offset:20480
  v_mfma_f32_16x16x32_bf16 v[164:167], v[60:63], v[36:39], v[164:167]
  ds_read_b64_tr_b16 v[118:119], v13 offset:20992
  v_mfma_f32_16x16x32_bf16 v[168:171], v[60:63], v[40:43], v[168:171]
  v_add_u32_e64 v10, s75, v4
  v_mfma_f32_16x16x32_bf16 v[172:175], v[60:63], v[44:47], v[172:175]
  v_add_u32_e64 v11, s75, v5
  v_mfma_f32_16x16x32_bf16 v[228:231], v[60:63], v[48:51], v[228:231]
  v_add_u32_e64 v12, s75, v6
  v_mfma_f32_16x16x32_bf16 v[176:179], v[64:67], v[32:35], v[176:179]
  v_add_u32_e64 v13, s75, v7
  v_mfma_f32_16x16x32_bf16 v[180:183], v[64:67], v[36:39], v[180:183]
  v_add_u32_e64 v14, s75, v8
  v_mfma_f32_16x16x32_bf16 v[184:187], v[64:67], v[40:43], v[184:187]
  v_add_u32_e64 v15, s75, v9
  v_mfma_f32_16x16x32_bf16 v[188:191], v[64:67], v[44:47], v[188:191]
  s_add_u32 s75, s75, 43008
  v_mfma_f32_16x16x32_bf16 v[192:195], v[32:35], v[68:71], v[192:195]
  s_cmp_eq_u32 s75, 129024
  v_mfma_f32_16x16x32_bf16 v[196:199], v[36:39], v[68:71], v[196:199]
  s_cselect_b32 s75, 0, s75
  s_sub_u32 s79, s79, 1
  v_mfma_f32_16x16x32_bf16 v[200:203], v[40:43], v[68:71], v[200:203]
  v_mfma_f32_16x16x32_bf16 v[204:207], v[44:47], v[68:71], v[204:207]
  v_mfma_f32_16x16x32_bf16 v[232:235], v[48:51], v[68:71], v[232:235]
  v_mfma_f32_16x16x32_bf16 v[208:211], v[32:35], v[72:75], v[208:211]
  v_mfma_f32_16x16x32_bf16 v[212:215], v[36:39], v[72:75], v[212:215]
  v_mfma_f32_16x16x32_bf16 v[216:219], v[40:43], v[72:75], v[216:219]
  v_mfma_f32_16x16x32_bf16 v[220:223], v[44:47], v[72:75], v[220:223]
  s_waitcnt lgkmcnt(0)
  s_barrier
  v_mfma_f32_16x16x32_bf16 v[240:243], v[236:239], v[76:79], v[240:243]
  ds_read_b128 v[32:35], v10 offset:0
  v_mfma_f32_16x16x32_bf16 v[244:247], v[76:79], v[76:79], v[244:247]
  ds_read_b128 v[36:39], v10 offset:2048
  v_mfma_f32_16x16x32_bf16 v[248:251], v[236:239], v[80:83], v[248:251]
  ds_read_b128 v[40:43], v10 offset:4096
  v_mfma_f32_16x16x32_bf16 v[252:255], v[80:83], v[80:83], v[252:255]
  ds_read_b128 v[44:47], v10 offset:6144
  v_mfma_f32_16x16x32_bf16 v[120:123], v[236:239], v[92:95], v[120:123]
  ds_read_b128 v[48:51], v14
  v_mfma_f32_16x16x32_bf16 v[124:127], v[92:95], v[92:95], v[124:127]
  ds_read_b64_tr_b16 v[52:53], v12 offset:0
  v_mfma_f32_16x16x32_bf16 v[128:131], v[96:99], v[76:79], v[128:131]
  ds_read_b64_tr_b16 v[54:55], v12 offset:512
  v_mfma_f32_16x16x32_bf16 v[132:135], v[96:99], v[80:83], v[132:135]
  ds_read_b64_tr_b16 v[56:57], v13 offset:0
  v_mfma_f32_16x16x32_bf16 v[136:139], v[96:99], v[84:87], v[136:139]
  ds_read_b64_tr_b16 v[58:59], v13 offset:512
  v_mfma_f32_16x16x32_bf16 v[140:143], v[96:99], v[88:91], v[140:143]
  ds_read_b64_tr_b16 v[60:61], v12 offset:8192
  v_mfma_f32_16x16x32_bf16 v[224:227], v[96:99], v[92:95], v[224:227]
  ds_read_b64_tr_b16 v[62:63], v12 offset:8704
  v_mfma_f32_16x16x32_bf16 v[144:147], v[100:103], v[76:79], v[144:147]
  ds_read_b64_tr_b16 v[64:65], v13 offset:8192
  v_mfma_f32_16x16x32_bf16 v[148:151], v[100:103], v[80:83], v[148:151]
  ds_read_b64_tr_b16 v[66:67], v13 offset:8704
  v_mfma_f32_16x16x32_bf16 v[152:155], v[100:103], v[84:87], v[152:155]
  ds_read_b64_tr_b16 v[68:69], v12 offset:16384
  v_mfma_f32_16x16x32_bf16 v[156:159], v[100:103], v[88:91], v[156:159]
  ds_read_b64_tr_b16 v[70:71], v12 offset:16896
  v_mfma_f32_16x16x32_bf16 v[160:163], v[104:107], v[76:79], v[160:163]
  ds_read_b64_tr_b16 v[72:73], v13 offset:16384
  v_mfma_f32_16x16x32_bf16 v[164:167], v[104:107], v[80:83], v[164:167]
  ds_read_b64_tr_b16 v[74:75], v13 offset:16896
  v_mfma_f32_16x16x32_bf16 v[168:171], v[104:107], v[84:87], v[168:171]
  s_cmp_lg_u32 s79, 0
  s_nop 0
  v_mfma_f32_16x16x32_bf16 v[172:175], v[104:107], v[88:91], v[172:175]
  v_mfma_f32_16x16x32_bf16 v[228:231], v[104:107], v[92:95], v[228:231]
  v_mfma_f32_16x16x32_bf16 v[176:179], v[108:111], v[76:79], v[176:179]
  v_mfma_f32_16x16x32_bf16 v[180:183], v[108:111], v[80:83], v[180:183]
  v_mfma_f32_16x16x32_bf16 v[184:187], v[108:111], v[84:87], v[184:187]
  v_mfma_f32_16x16x32_bf16 v[188:191], v[108:111], v[88:91], v[188:191]
  v_mfma_f32_16x16x32_bf16 v[192:195], v[76:79], v[112:115], v[192:195]
  v_mfma_f32_16x16x32_bf16 v[196:199], v[80:83], v[112:115], v[196:199]
  v_mfma_f32_16x16x32_bf16 v[200:203], v[84:87], v[112:115], v[200:203]
  v_mfma_f32_16x16x32_bf16 v[204:207], v[88:91], v[112:115], v[204:207]
  v_mfma_f32_16x16x32_bf16 v[232:235], v[92:95], v[112:115], v[232:235]
  v_mfma_f32_16x16x32_bf16 v[208:211], v[76:79], v[116:119], v[208:211]
  v_mfma_f32_16x16x32_bf16 v[212:215], v[80:83], v[116:119], v[212:215]
  v_mfma_f32_16x16x32_bf16 v[216:219], v[84:87], v[116:119], v[216:219]
  v_mfma_f32_16x16x32_bf16 v[220:223], v[88:91], v[116:119], v[220:223]
  s_waitcnt lgkmcnt(0)
  s_cbranch_scc1 L_attn_loopa
  s_branch L_attn_post
.p2align 3
L_attn_loopb:
  v_mfma_f32_16x16x32_bf16 v[240:243], v[236:239], v[40:43], v[240:243]
  ds_read_b128 v[76:79], v11 offset:0
  v_mfma_f32_16x16x32_bf16 v[244:247], v[40:43], v[40:43], v[244:247]
  ds_read_b128 v[80:83], v11 offset:2048
  v_mfma_f32_16x16x32_bf16 v[248:251], v[236:239], v[44:47], v[248:251]
  ds_read_b128 v[84:87], v11 offset:4096
  v_mfma_f32_16x16x32_bf16 v[252:255], v[44:47], v[44:47], v[252:255]
  ds_read_b128 v[88:91], v11 offset:6144
  v_mfma_f32_16x16x32_bf16 v[128:131], v[52:55], v[32:35], v[128:131]
  ds_read_b128 v[92:95], v15
  v_mfma_f32_16x16x32_bf16 v[132:135], v[52:55], v[36:39], v[132:135]
  ds_read_b64_tr_b16 v[96:97], v12 offset:4096
  v_mfma_f32_16x16x32_bf16 v[136:139], v[52:55], v[40:43], v[136:139]
  ds_read_b64_tr_b16 v[98:99], v12 offset:4608
  v_mfma_f32_16x16x32_bf16 v[140:143], v[52:55], v[44:47], v[140:143]
  ds_read_b64_tr_b16 v[100:101], v13 offset:4096
  v_mfma_f32_16x16x32_bf16 v[224:227], v[52:55], v[48:51], v[224:227]
  ds_read_b64_tr_b16 v[102:103], v13 offset:4608
  v_mfma_f32_16x16x32_bf16 v[144:147], v[56:59], v[32:35], v[144:147]
  ds_read_b64_tr_b16 v[104:105], v12 offset:12288
  v_mfma_f32_16x16x32_bf16 v[148:151], v[56:59], v[36:39], v[148:151]
  ds_read_b64_tr_b16 v[106:107], v12 offset:12800
  v_mfma_f32_16x16x32_bf16 v[152:155], v[56:59], v[40:43], v[152:155]
  ds_read_b64_tr_b16 v[108:109], v13 offset:12288
  v_mfma_f32_16x16x32_bf16 v[156:159], v[56:59], v[44:47], v[156:159]
  ds_read_b64_tr_b16 v[110:111], v13 offset:12800
  v_mfma_f32_16x16x32_bf16 v[160:163], v[60:63], v[32:35], v[160:163]
  ds_read_b64_tr_b16 v[112:113], v12 offset:20480
  v_mfma_f32_16x16x32_bf16 v[164:167], v[60:63], v[36:39], v[164:167]
  ds_read_b64_tr_b16 v[114:115], v12 offset:20992
  v_mfma_f32_16x16x32_bf16 v[168:171], v[60:63], v[40:43], v[168:171]
  ds_read_b64_tr_b16 v[116:117], v13 offset:20480
  v_mfma_f32_16x16x32_bf16 v[172:175], v[60:63], v[44:47], v[172:175]
  ds_read_b64_tr_b16 v[118:119], v13 offset:20992
  v_mfma_f32_16x16x32_bf16 v[228:231], v[60:63], v[48:51], v[228:231]
  v_add_u32_e64 v10, s75, v4
  v_mfma_f32_16x16x32_bf16 v[176:179], v[64:67], v[32:35], v[176:179]
  v_add_u32_e64 v11, s75, v5
  v_mfma_f32_16x16x32_bf16 v[180:183], v[64:67], v[36:39], v[180:183]
  v_add_u32_e64 v12, s75, v6
  v_mfma_f32_16x16x32_bf16 v[184:187], v[64:67], v[40:43], v[184:187]
  v_add_u32_e64 v13, s75, v7
  v_mfma_f32_16x16x32_bf16 v[188:191], v[64:67], v[44:47], v[188:191]
  v_add_u32_e64 v14, s75, v8
  v_mfma_f32_16x16x32_bf16 v[192:195], v[32:35], v[68:71], v[192:195]
  v_add_u32_e64 v15, s75, v9
  v_mfma_f32_16x16x32_bf16 v[196:199], v[36:39], v[68:71], v[196:199]
  s_add_u32 s75, s75, 43008
  v_mfma_f32_16x16x32_bf16 v[200:203], v[40:43], v[68:71], v[200:203]
  s_cmp_eq_u32 s75, 129024
  v_mfma_f32_16x16x32_bf16 v[204:207], v[44:47], v[68:71], v[204:207]
  s_cselect_b32 s75, 0, s75
  s_sub_u32 s79, s79, 1
  v_mfma_f32_16x16x32_bf16 v[232:235], v[48:51], v[68:71], v[232:235]
  v_mfma_f32_16x16x32_bf16 v[208:211], v[32:35], v[72:75], v[208:211]
  v_mfma_f32_16x16x32_bf16 v[212:215], v[36:39], v[72:75], v[212:215]
  v_mfma_f32_16x16x32_bf16 v[216:219], v[40:43], v[72:75], v[216:219]
  v_mfma_f32_16x16x32_bf16 v[220:223], v[44:47], v[72:75], v[220:223]
  s_waitcnt lgkmcnt(0)
  s_barrier
  v_mfma_f32_16x16x32_bf16 v[240:243], v[236:239], v[84:87], v[240:243]
  ds_read_b128 v[32:35], v10 offset:0
  v_mfma_f32_16x16x32_bf16 v[244:247], v[84:87], v[84:87], v[244:247]
  ds_read_b128 v[36:39], v10 offset:2048
  v_mfma_f32_16x16x32_bf16 v[248:251], v[236:239], v[88:91], v[248:251]
  ds_read_b128 v[40:43], v10 offset:4096
  v_mfma_f32_16x16x32_bf16 v[252:255], v[88:91], v[88:91], v[252:255]
  ds_read_b128 v[44:47], v10 offset:6144
  v_mfma_f32_16x16x32_bf16 v[128:131], v[96:99], v[76:79], v[128:131]
  ds_read_b128 v[48:51], v14
  v_mfma_f32_16x16x32_bf16 v[132:135], v[96:99], v[80:83], v[132:135]
  ds_read_b64_tr_b16 v[52:53], v12 offset:0
  v_mfma_f32_16x16x32_bf16 v[136:139], v[96:99], v[84:87], v[136:139]
  ds_read_b64_tr_b16 v[54:55], v12 offset:512
  v_mfma_f32_16x16x32_bf16 v[140:143], v[96:99], v[88:91], v[140:143]
  ds_read_b64_tr_b16 v[56:57], v13 offset:0
  v_mfma_f32_16x16x32_bf16 v[224:227], v[96:99], v[92:95], v[224:227]
  ds_read_b64_tr_b16 v[58:59], v13 offset:512
  v_mfma_f32_16x16x32_bf16 v[144:147], v[100:103], v[76:79], v[144:147]
  ds_read_b64_tr_b16 v[60:61], v12 offset:8192
  v_mfma_f32_16x16x32_bf16 v[148:151], v[100:103], v[80:83], v[148:151]
  ds_read_b64_tr_b16 v[62:63], v12 offset:8704
  v_mfma_f32_16x16x32_bf16 v[152:155], v[100:103], v[84:87], v[152:155]
  ds_read_b64_tr_b16 v[64:65], v13 offset:8192
  v_mfma_f32_16x16x32_bf16 v[156:159], v[100:103], v[88:91], v[156:159]
  ds_read_b64_tr_b16 v[66:67], v13 offset:8704
  v_mfma_f32_16x16x32_bf16 v[160:163], v[104:107], v[76:79], v[160:163]
  ds_read_b64_tr_b16 v[68:69], v12 offset:16384
  v_mfma_f32_16x16x32_bf16 v[164:167], v[104:107], v[80:83], v[164:167]
  ds_read_b64_tr_b16 v[70:71], v12 offset:16896
  v_mfma_f32_16x16x32_bf16 v[168:171], v[104:107], v[84:87], v[168:171]
  ds_read_b64_tr_b16 v[72:73], v13 offset:16384
  v_mfma_f32_16x16x32_bf16 v[172:175], v[104:107], v[88:91], v[172:175]
  ds_read_b64_tr_b16 v[74:75], v13 offset:16896
  v_mfma_f32_16x16x32_bf16 v[228:231], v[104:107], v[92:95], v[228:231]
  s_cmp_lg_u32 s79, 0
  s_nop 0
  v_mfma_f32_16x16x32_bf16 v[176:179], v[108:111], v[76:79], v[176:179]
  v_mfma_f32_16x16x32_bf16 v[180:183], v[108:111], v[80:83], v[180:183]
  v_mfma_f32_16x16x32_bf16 v[184:187], v[108:111], v[84:87], v[184:187]
  v_mfma_f32_16x16x32_bf16 v[188:191], v[108:111], v[88:91], v[188:191]
  v_mfma_f32_16x16x32_bf16 v[192:195], v[76:79], v[112:115], v[192:195]
  v_mfma_f32_16x16x32_bf16 v[196:199], v[80:83], v[112:115], v[196:199]
  v_mfma_f32_16x16x32_bf16 v[200:203], v[84:87], v[112:115], v[200:203]
  v_mfma_f32_16x16x32_bf16 v[204:207], v[88:91], v[112:115], v[204:207]
  v_mfma_f32_16x16x32_bf16 v[232:235], v[92:95], v[112:115], v[232:235]
  v_mfma_f32_16x16x32_bf16 v[208:211], v[76:79], v[116:119], v[208:211]
  v_mfma_f32_16x16x32_bf16 v[212:215], v[80:83], v[116:119], v[212:215]
  v_mfma_f32_16x16x32_bf16 v[216:219], v[84:87], v[116:119], v[216:219]
  v_mfma_f32_16x16x32_bf16 v[220:223], v[88:91], v[116:119], v[220:223]
  s_waitcnt lgkmcnt(0)
  s_cbranch_scc1 L_attn_loopb
L_attn_post:
  v_and_b32 v32, 3, v1
  v_cmp_eq_u32 s[4:5], 1, v32
  v_cmp_eq_u32 s[6:7], 2, v32
  v_cmp_eq_u32 s[8:9], 3, v32
  v_bfe_u32 v33, v1, 2, 2
  v_lshrrev_b32 v34, 4, v1
  v_cmp_eq_u32 s[10:11], v33, v34
  s_lshl_b32 s3, s72, 7
  v_add_u32 v35, s3, v23
  v_and_b32 v36, 15, v1
  s_cmp_eq_u32 s70, 0
  s_cselect_b32 s3, 0, 576
  s_add_u32 s3, s3, 129024
  v_lshl_add_u32 v36, v36, 2, s3
  v_cndmask_b32 v241, v244, v245, s[4:5]
  v_cndmask_b32 v249, v252, v253, s[4:5]
  v_cndmask_b32 v121, v124, v125, s[4:5]
  v_cndmask_b32 v241, v241, v246, s[6:7]
  v_cndmask_b32 v249, v249, v254, s[6:7]
  v_cndmask_b32 v121, v121, v126, s[6:7]
  v_cndmask_b32 v241, v241, v247, s[8:9]
  v_cndmask_b32 v249, v249, v255, s[8:9]
  v_cndmask_b32 v121, v121, v127, s[8:9]
  v_mul_f32 v240, 0x3a800000, v240
  v_mul_f32 v241, 0x3a800000, v241
  v_fma_f32 v241, -v240, v240, v241
  v_max_f32 v241, 0, v241
  v_add_f32 v241, 0x3727c5ac, v241
  v_rsq_f32 v241, v241
  s_nop 0
  v_mul_f32 v248, 0x3a800000, v248
  v_mul_f32 v249, 0x3a800000, v249
  v_fma_f32 v249, -v248, v248, v249
  v_max_f32 v249, 0, v249
  v_add_f32 v249, 0x3727c5ac, v249
  v_rsq_f32 v249, v249
  s_nop 0
  v_mul_f32 v120, 0x3a800000, v120
  v_mul_f32 v121, 0x3a800000, v121
  v_fma_f32 v121, -v120, v120, v121
  v_max_f32 v121, 0, v121
  v_add_f32 v121, 0x3727c5ac, v121
  v_rsq_f32 v121, v121
  s_nop 0
  s_mov_b64 exec, s[10:11]
  ds_write2_b32 v35, v240, v241 offset0:16 offset1:176
  ds_write2_b32 v35, v248, v249 offset0:32 offset1:192
  ds_write2_b32 v36, v120, v121 offset0:0 offset1:160
  s_mov_b64 exec, -1
  s_waitcnt lgkmcnt(0)
  s_barrier
  s_branch L_attn_exit
.p2align 3
L_attn_loop:
  v_mfma_f32_16x16x32_bf16 v[128:131], v[52:55], v[32:35], v[128:131]
  ds_read_b128 v[76:79], v11 offset:0
  v_mfma_f32_16x16x32_bf16 v[132:135], v[52:55], v[36:39], v[132:135]
  ds_read_b128 v[80:83], v11 offset:2048
  v_mfma_f32_16x16x32_bf16 v[136:139], v[52:55], v[40:43], v[136:139]
  ds_read_b128 v[84:87], v11 offset:4096
  v_mfma_f32_16x16x32_bf16 v[140:143], v[52:55], v[44:47], v[140:143]
  ds_read_b128 v[88:91], v11 offset:6144
  v_mfma_f32_16x16x32_bf16 v[224:227], v[52:55], v[48:51], v[224:227]
  ds_read_b128 v[92:95], v15
  v_mfma_f32_16x16x32_bf16 v[144:147], v[56:59], v[32:35], v[144:147]
  ds_read_b64_tr_b16 v[96:97], v12 offset:4096
  v_mfma_f32_16x16x32_bf16 v[148:151], v[56:59], v[36:39], v[148:151]
  ds_read_b64_tr_b16 v[98:99], v12 offset:4608
  v_mfma_f32_16x16x32_bf16 v[152:155], v[56:59], v[40:43], v[152:155]
  ds_read_b64_tr_b16 v[100:101], v13 offset:4096
  v_mfma_f32_16x16x32_bf16 v[156:159], v[56:59], v[44:47], v[156:159]
  ds_read_b64_tr_b16 v[102:103], v13 offset:4608
  v_mfma_f32_16x16x32_bf16 v[160:163], v[60:63], v[32:35], v[160:163]
  ds_read_b64_tr_b16 v[104:105], v12 offset:12288
  v_mfma_f32_16x16x32_bf16 v[164:167], v[60:63], v[36:39], v[164:167]
  ds_read_b64_tr_b16 v[106:107], v12 offset:12800
  v_mfma_f32_16x16x32_bf16 v[168:171], v[60:63], v[40:43], v[168:171]
  ds_read_b64_tr_b16 v[108:109], v13 offset:12288
  v_mfma_f32_16x16x32_bf16 v[172:175], v[60:63], v[44:47], v[172:175]
  ds_read_b64_tr_b16 v[110:111], v13 offset:12800
  v_mfma_f32_16x16x32_bf16 v[228:231], v[60:63], v[48:51], v[228:231]
  ds_read_b64_tr_b16 v[112:113], v12 offset:20480
  v_mfma_f32_16x16x32_bf16 v[176:179], v[64:67], v[32:35], v[176:179]
  ds_read_b64_tr_b16 v[114:115], v12 offset:20992
  v_mfma_f32_16x16x32_bf16 v[180:183], v[64:67], v[36:39], v[180:183]
  ds_read_b64_tr_b16 v[116:117], v13 offset:20480
  v_mfma_f32_16x16x32_bf16 v[184:187], v[64:67], v[40:43], v[184:187]
  ds_read_b64_tr_b16 v[118:119], v13 offset:20992
  v_mfma_f32_16x16x32_bf16 v[188:191], v[64:67], v[44:47], v[188:191]
  v_add_u32_e64 v10, s75, v4
  v_mfma_f32_16x16x32_bf16 v[192:195], v[32:35], v[68:71], v[192:195]
  v_add_u32_e64 v11, s75, v5
  v_mfma_f32_16x16x32_bf16 v[196:199], v[36:39], v[68:71], v[196:199]
  v_add_u32_e64 v12, s75, v6
  v_mfma_f32_16x16x32_bf16 v[200:203], v[40:43], v[68:71], v[200:203]
  v_add_u32_e64 v13, s75, v7
  v_mfma_f32_16x16x32_bf16 v[204:207], v[44:47], v[68:71], v[204:207]
  v_add_u32_e64 v14, s75, v8
  v_mfma_f32_16x16x32_bf16 v[232:235], v[48:51], v[68:71], v[232:235]
  v_add_u32_e64 v15, s75, v9
  v_mfma_f32_16x16x32_bf16 v[208:211], v[32:35], v[72:75], v[208:211]
  s_add_u32 s75, s75, 43008
  v_mfma_f32_16x16x32_bf16 v[212:215], v[36:39], v[72:75], v[212:215]
  s_cmp_eq_u32 s75, 129024
  v_mfma_f32_16x16x32_bf16 v[216:219], v[40:43], v[72:75], v[216:219]
  s_cselect_b32 s75, 0, s75
  s_sub_u32 s79, s79, 1
  v_mfma_f32_16x16x32_bf16 v[220:223], v[44:47], v[72:75], v[220:223]
  s_waitcnt lgkmcnt(0)
  s_barrier
  v_mfma_f32_16x16x32_bf16 v[128:131], v[96:99], v[76:79], v[128:131]
  ds_read_b128 v[32:35], v10 offset:0
  v_mfma_f32_16x16x32_bf16 v[132:135], v[96:99], v[80:83], v[132:135]
  ds_read_b128 v[36:39], v10 offset:2048
  v_mfma_f32_16x16x32_bf16 v[136:139], v[96:99], v[84:87], v[136:139]
  ds_read_b128 v[40:43], v10 offset:4096
  v_mfma_f32_16x16x32_bf16 v[140:143], v[96:99], v[88:91], v[140:143]
  ds_read_b128 v[44:47], v10 offset:6144
  v_mfma_f32_16x16x32_bf16 v[224:227], v[96:99], v[92:95], v[224:227]
  ds_read_b128 v[48:51], v14
  v_mfma_f32_16x16x32_bf16 v[144:147], v[100:103], v[76:79], v[144:147]
  ds_read_b64_tr_b16 v[52:53], v12 offset:0
  v_mfma_f32_16x16x32_bf16 v[148:151], v[100:103], v[80:83], v[148:151]
  ds_read_b64_tr_b16 v[54:55], v12 offset:512
  v_mfma_f32_16x16x32_bf16 v[152:155], v[100:103], v[84:87], v[152:155]
  ds_read_b64_tr_b16 v[56:57], v13 offset:0
  v_mfma_f32_16x16x32_bf16 v[156:159], v[100:103], v[88:91], v[156:159]
  ds_read_b64_tr_b16 v[58:59], v13 offset:512
  v_mfma_f32_16x16x32_bf16 v[160:163], v[104:107], v[76:79], v[160:163]
  ds_read_b64_tr_b16 v[60:61], v12 offset:8192
  v_mfma_f32_16x16x32_bf16 v[164:167], v[104:107], v[80:83], v[164:167]
  ds_read_b64_tr_b16 v[62:63], v12 offset:8704
  v_mfma_f32_16x16x32_bf16 v[168:171], v[104:107], v[84:87], v[168:171]
  ds_read_b64_tr_b16 v[64:65], v13 offset:8192
  v_mfma_f32_16x16x32_bf16 v[172:175], v[104:107], v[88:91], v[172:175]
  ds_read_b64_tr_b16 v[66:67], v13 offset:8704
  v_mfma_f32_16x16x32_bf16 v[228:231], v[104:107], v[92:95], v[228:231]
  ds_read_b64_tr_b16 v[68:69], v12 offset:16384
  v_mfma_f32_16x16x32_bf16 v[176:179], v[108:111], v[76:79], v[176:179]
  ds_read_b64_tr_b16 v[70:71], v12 offset:16896
  v_mfma_f32_16x16x32_bf16 v[180:183], v[108:111], v[80:83], v[180:183]
  ds_read_b64_tr_b16 v[72:73], v13 offset:16384
  v_mfma_f32_16x16x32_bf16 v[184:187], v[108:111], v[84:87], v[184:187]
  ds_read_b64_tr_b16 v[74:75], v13 offset:16896
  v_mfma_f32_16x16x32_bf16 v[188:191], v[108:111], v[88:91], v[188:191]
  s_cmp_lg_u32 s79, 0
  s_nop 0
  v_mfma_f32_16x16x32_bf16 v[192:195], v[76:79], v[112:115], v[192:195]
  v_mfma_f32_16x16x32_bf16 v[196:199], v[80:83], v[112:115], v[196:199]
  v_mfma_f32_16x16x32_bf16 v[200:203], v[84:87], v[112:115], v[200:203]
  v_mfma_f32_16x16x32_bf16 v[204:207], v[88:91], v[112:115], v[204:207]
  v_mfma_f32_16x16x32_bf16 v[232:235], v[92:95], v[112:115], v[232:235]
  v_mfma_f32_16x16x32_bf16 v[208:211], v[76:79], v[116:119], v[208:211]
  v_mfma_f32_16x16x32_bf16 v[212:215], v[80:83], v[116:119], v[212:215]
  v_mfma_f32_16x16x32_bf16 v[216:219], v[84:87], v[116:119], v[216:219]
  v_mfma_f32_16x16x32_bf16 v[220:223], v[88:91], v[116:119], v[220:223]
  s_waitcnt lgkmcnt(0)
  s_cbranch_scc1 L_attn_loop
L_attn_exit:
  ds_read2_b32 v[66:67], v23 offset0:0 offset1:160
  ds_read2_b32 v[68:69], v23 offset0:16 offset1:176
  ds_read2_b32 v[70:71], v23 offset0:32 offset1:192
  ds_read2_b32 v[72:73], v23 offset0:48 offset1:208
  ds_read2_b32 v[74:75], v23 offset0:64 offset1:224
  ds_read2_b32 v[76:77], v25 offset0:0 offset1:16
  ds_read2_b32 v[80:81], v26 offset0:0 offset1:16
  ds_read2_b32 v[78:79], v25 offset0:32 offset1:48
  ds_read2_b32 v[82:83], v26 offset0:32 offset1:48
  ds_write_b128 v16, v[224:227] offset:0
  ds_write_b128 v16, v[228:231] offset:2048
  ds_write_b128 v16, v[232:235] offset:4096
  s_cmp_eq_u32 s71, 1
  s_cbranch_scc1 L_attn_nop3
  ds_write_b128 v16, v[172:175] offset:8192
  ds_write_b128 v16, v[188:191] offset:9216
  ds_write_b128 v16, v[204:207] offset:10240
  ds_write_b128 v16, v[220:223] offset:11264
L_attn_nop3:
  ds_read_b128 v[84:87], v24 offset:0
  ds_read_b128 v[104:107], v24 offset:640
  ds_read_b128 v[88:91], v24 offset:64
  ds_read_b128 v[108:111], v24 offset:704
  ds_read_b128 v[92:95], v24 offset:128
  ds_read_b128 v[112:115], v24 offset:768
  ds_read_b128 v[96:99], v24 offset:192
  ds_read_b128 v[116:119], v24 offset:832
  ds_read_b128 v[100:103], v24 offset:256
  ds_read_b128 v[120:123], v24 offset:896
  s_waitcnt lgkmcnt(10)
  s_barrier
  ds_read_b128 v[48:51], v19 offset:0
  ds_read_b128 v[52:55], v20 offset:1024
  ds_read_b128 v[56:59], v19 offset:2048
  ds_read_b128 v[60:63], v20 offset:3072
  ds_read_b32 v64, v21 offset:4096
  ds_read_b32 v65, v22 offset:5120
  ds_read_b128 v[32:35], v17 offset:2048
  ds_read_b128 v[36:39], v18 offset:3072
  ds_read_b128 v[40:43], v17 offset:4096
  ds_read_b128 v[44:47], v18 offset:5120
  v_mul_f32 v69, 0x3e8293ee, v69
  v_mul_f32 v71, 0x3e8293ee, v71
  v_mul_f32 v73, 0x3e8293ee, v73
  v_mul_f32 v75, 0x3e8293ee, v75
  v_mul_f32 v76, v76, v69
  v_mul_f32 v80, v80, v69
  v_mul_f32 v77, v77, v71
  v_mul_f32 v81, v81, v71
  v_mul_f32 v78, v78, v73
  v_mul_f32 v82, v82, v73
  v_mul_f32 v79, v79, v75
  v_mul_f32 v83, v83, v75
  s_waitcnt lgkmcnt(6)
  v_pk_fma_f32 v[128:129], v[48:49], v[68:69], v[128:129] op_sel:[0,0,0] op_sel_hi:[1,0,1] neg_lo:[0,1,0] neg_hi:[0,1,0]
  v_pk_fma_f32 v[130:131], v[50:51], v[68:69], v[130:131] op_sel:[0,0,0] op_sel_hi:[1,0,1] neg_lo:[0,1,0] neg_hi:[0,1,0]
  v_pk_fma_f32 v[144:145], v[52:53], v[68:69], v[144:145] op_sel:[0,0,0] op_sel_hi:[1,0,1] neg_lo:[0,1,0] neg_hi:[0,1,0]
  v_pk_fma_f32 v[146:147], v[54:55], v[68:69], v[146:147] op_sel:[0,0,0] op_sel_hi:[1,0,1] neg_lo:[0,1,0] neg_hi:[0,1,0]
  v_cvt_pk_bf16_f32 v128, v128, v129
  v_cvt_pk_bf16_f32 v129, v130, v131
  v_cvt_pk_bf16_f32 v130, v144, v145
  v_cvt_pk_bf16_f32 v131, v146, v147
  v_pk_fma_f32 v[160:161], v[56:57], v[68:69], v[160:161] op_sel:[0,0,0] op_sel_hi:[1,0,1] neg_lo:[0,1,0] neg_hi:[0,1,0]
  v_pk_fma_f32 v[162:163], v[58:59], v[68:69], v[162:163] op_sel:[0,0,0] op_sel_hi:[1,0,1] neg_lo:[0,1,0] neg_hi:[0,1,0]
  v_pk_fma_f32 v[176:177], v[60:61], v[68:69], v[176:177] op_sel:[0,0,0] op_sel_hi:[1,0,1] neg_lo:[0,1,0] neg_hi:[0,1,0]
  v_pk_fma_f32 v[178:179], v[62:63], v[68:69], v[178:179] op_sel:[0,0,0] op_sel_hi:[1,0,1] neg_lo:[0,1,0] neg_hi:[0,1,0]
  v_cvt_pk_bf16_f32 v160, v160, v161
  v_cvt_pk_bf16_f32 v161, v162, v163
  v_cvt_pk_bf16_f32 v162, v176, v177
  v_cvt_pk_bf16_f32 v163, v178, v179
  v_pk_fma_f32 v[132:133], v[48:49], v[70:71], v[132:133] op_sel:[0,0,0] op_sel_hi:[1,0,1] neg_lo:[0,1,0] neg_hi:[0,1,0]
  v_pk_fma_f32 v[134:135], v[50:51], v[70:71], v[134:135] op_sel:[0,0,0] op_sel_hi:[1,0,1] neg_lo:[0,1,0] neg_hi:[0,1,0]
  v_pk_fma_f32 v[148:149], v[52:53], v[70:71], v[148:149] op_sel:[0,0,0] op_sel_hi:[1,0,1] neg_lo:[0,1,0] neg_hi:[0,1,0]
  v_pk_fma_f32 v[150:151], v[54:55], v[70:71], v[150:151] op_sel:[0,0,0] op_sel_hi:[1,0,1] neg_lo:[0,1,0] neg_hi:[0,1,0]
  v_cvt_pk_bf16_f32 v132, v132, v133
  v_cvt_pk_bf16_f32 v133, v134, v135
  v_cvt_pk_bf16_f32 v134, v148, v149
  v_cvt_pk_bf16_f32 v135, v150, v151
  v_pk_fma_f32 v[164:165], v[56:57], v[70:71], v[164:165] op_sel:[0,0,0] op_sel_hi:[1,0,1] neg_lo:[0,1,0] neg_hi:[0,1,0]
  v_pk_fma_f32 v[166:167], v[58:59], v[70:71], v[166:167] op_sel:[0,0,0] op_sel_hi:[1,0,1] neg_lo:[0,1,0] neg_hi:[0,1,0]
  v_pk_fma_f32 v[180:181], v[60:61], v[70:71], v[180:181] op_sel:[0,0,0] op_sel_hi:[1,0,1] neg_lo:[0,1,0] neg_hi:[0,1,0]
  v_pk_fma_f32 v[182:183], v[62:63], v[70:71], v[182:183] op_sel:[0,0,0] op_sel_hi:[1,0,1] neg_lo:[0,1,0] neg_hi:[0,1,0]
  v_cvt_pk_bf16_f32 v164, v164, v165
  v_cvt_pk_bf16_f32 v165, v166, v167
  v_cvt_pk_bf16_f32 v166, v180, v181
  v_cvt_pk_bf16_f32 v167, v182, v183
  v_mfma_f32_16x16x32_bf16 v[144:147], v[160:163], v[128:131], 0
  v_pk_fma_f32 v[136:137], v[48:49], v[72:73], v[136:137] op_sel:[0,0,0] op_sel_hi:[1,0,1] neg_lo:[0,1,0] neg_hi:[0,1,0]
  v_pk_fma_f32 v[138:139], v[50:51], v[72:73], v[138:139] op_sel:[0,0,0] op_sel_hi:[1,0,1] neg_lo:[0,1,0] neg_hi:[0,1,0]
  v_pk_fma_f32 v[152:153], v[52:53], v[72:73], v[152:153] op_sel:[0,0,0] op_sel_hi:[1,0,1] neg_lo:[0,1,0] neg_hi:[0,1,0]
  v_pk_fma_f32 v[154:155], v[54:55], v[72:73], v[154:155] op_sel:[0,0,0] op_sel_hi:[1,0,1] neg_lo:[0,1,0] neg_hi:[0,1,0]
  v_cvt_pk_bf16_f32 v136, v136, v137
  v_cvt_pk_bf16_f32 v137, v138, v139
  v_cvt_pk_bf16_f32 v138, v152, v153
  v_cvt_pk_bf16_f32 v139, v154, v155
  v_pk_fma_f32 v[168:169], v[56:57], v[72:73], v[168:169] op_sel:[0,0,0] op_sel_hi:[1,0,1] neg_lo:[0,1,0] neg_hi:[0,1,0]
  v_pk_fma_f32 v[170:171], v[58:59], v[72:73], v[170:171] op_sel:[0,0,0] op_sel_hi:[1,0,1] neg_lo:[0,1,0] neg_hi:[0,1,0]
  v_pk_fma_f32 v[184:185], v[60:61], v[72:73], v[184:185] op_sel:[0,0,0] op_sel_hi:[1,0,1] neg_lo:[0,1,0] neg_hi:[0,1,0]
  v_pk_fma_f32 v[186:187], v[62:63], v[72:73], v[186:187] op_sel:[0,0,0] op_sel_hi:[1,0,1] neg_lo:[0,1,0] neg_hi:[0,1,0]
  v_cvt_pk_bf16_f32 v168, v168, v169
  v_cvt_pk_bf16_f32 v169, v170, v171
  v_cvt_pk_bf16_f32 v170, v184, v185
  v_cvt_pk_bf16_f32 v171, v186, v187
  v_mfma_f32_16x16x32_bf16 v[148:151], v[164:167], v[132:135], 0
  v_mfma_f32_16x16x32_bf16 v[180:183], v[160:163], v[132:135], 0
  v_pk_fma_f32 v[140:141], v[48:49], v[74:75], v[140:141] op_sel:[0,0,0] op_sel_hi:[1,0,1] neg_lo:[0,1,0] neg_hi:[0,1,0]
  v_pk_fma_f32 v[142:143], v[50:51], v[74:75], v[142:143] op_sel:[0,0,0] op_sel_hi:[1,0,1] neg_lo:[0,1,0] neg_hi:[0,1,0]
  v_pk_fma_f32 v[156:157], v[52:53], v[74:75], v[156:157] op_sel:[0,0,0] op_sel_hi:[1,0,1] neg_lo:[0,1,0] neg_hi:[0,1,0]
  v_pk_fma_f32 v[158:159], v[54:55], v[74:75], v[158:159] op_sel:[0,0,0] op_sel_hi:[1,0,1] neg_lo:[0,1,0] neg_hi:[0,1,0]
  v_cvt_pk_bf16_f32 v140, v140, v141
  v_cvt_pk_bf16_f32 v141, v142, v143
  v_cvt_pk_bf16_f32 v142, v156, v157
  v_cvt_pk_bf16_f32 v143, v158, v159
  v_pk_fma_f32 v[172:173], v[56:57], v[74:75], v[172:173] op_sel:[0,0,0] op_sel_hi:[1,0,1] neg_lo:[0,1,0] neg_hi:[0,1,0]
  v_pk_fma_f32 v[174:175], v[58:59], v[74:75], v[174:175] op_sel:[0,0,0] op_sel_hi:[1,0,1] neg_lo:[0,1,0] neg_hi:[0,1,0]
  v_pk_fma_f32 v[188:189], v[60:61], v[74:75], v[188:189] op_sel:[0,0,0] op_sel_hi:[1,0,1] neg_lo:[0,1,0] neg_hi:[0,1,0]
  v_pk_fma_f32 v[190:191], v[62:63], v[74:75], v[190:191] op_sel:[0,0,0] op_sel_hi:[1,0,1] neg_lo:[0,1,0] neg_hi:[0,1,0]
  v_cvt_pk_bf16_f32 v172, v172, v173
  v_cvt_pk_bf16_f32 v173, v174, v175
  v_cvt_pk_bf16_f32 v174, v188, v189
  v_cvt_pk_bf16_f32 v175, v190, v191
  s_waitcnt lgkmcnt(0)
  v_pk_fma_f32 v[32:33], v[56:57], v[66:67], v[32:33] op_sel:[0,0,0] op_sel_hi:[1,0,1] neg_lo:[0,1,0] neg_hi:[0,1,0]
  v_pk_fma_f32 v[34:35], v[58:59], v[66:67], v[34:35] op_sel:[0,0,0] op_sel_hi:[1,0,1] neg_lo:[0,1,0] neg_hi:[0,1,0]
  v_pk_fma_f32 v[36:37], v[60:61], v[66:67], v[36:37] op_sel:[0,0,0] op_sel_hi:[1,0,1] neg_lo:[0,1,0] neg_hi:[0,1,0]
  v_pk_fma_f32 v[38:39], v[62:63], v[66:67], v[38:39] op_sel:[0,0,0] op_sel_hi:[1,0,1] neg_lo:[0,1,0] neg_hi:[0,1,0]
  v_cvt_pk_bf16_f32 v32, v32, v33
  v_cvt_pk_bf16_f32 v33, v34, v35
  v_cvt_pk_bf16_f32 v34, v36, v37
  v_cvt_pk_bf16_f32 v35, v38, v39
  v_mfma_f32_16x16x32_bf16 v[152:155], v[168:171], v[136:139], 0
  v_mfma_f32_16x16x32_bf16 v[184:187], v[164:167], v[136:139], 0
  v_mfma_f32_16x16x32_bf16 v[156:159], v[172:175], v[140:143], 0
  v_mfma_f32_16x16x32_bf16 v[188:191], v[168:171], v[140:143], 0
  v_mfma_f32_16x16x32_bf16 v[176:179], v[32:35], v[128:131], 0
  v_pk_fma_f32 v[40:41], v[84:85], v[64:65], v[40:41] op_sel:[0,0,0] op_sel_hi:[1,0,1] neg_lo:[1,0,0] neg_hi:[1,0,0]
  v_pk_fma_f32 v[42:43], v[86:87], v[64:65], v[42:43] op_sel:[0,0,0] op_sel_hi:[1,0,1] neg_lo:[1,0,0] neg_hi:[1,0,0]
  v_pk_mul_f32 v[40:41], v[40:41], v[104:105]
  v_pk_mul_f32 v[42:43], v[42:43], v[106:107]
  v_cvt_pk_bf16_f32 v240, v40, v41
  v_cvt_pk_bf16_f32 v241, v42, v43
  v_pk_fma_f32 v[192:193], v[88:89], v[64:65], v[192:193] op_sel:[0,0,0] op_sel_hi:[1,0,1] neg_lo:[1,0,0] neg_hi:[1,0,0]
  v_pk_fma_f32 v[194:195], v[90:91], v[64:65], v[194:195] op_sel:[0,0,0] op_sel_hi:[1,0,1] neg_lo:[1,0,0] neg_hi:[1,0,0]
  v_pk_mul_f32 v[192:193], v[192:193], v[108:109]
  v_pk_mul_f32 v[194:195], v[194:195], v[110:111]
  v_cvt_pk_bf16_f32 v242, v192, v193
  v_cvt_pk_bf16_f32 v243, v194, v195
  v_pk_fma_f32 v[196:197], v[92:93], v[64:65], v[196:197] op_sel:[0,0,0] op_sel_hi:[1,0,1] neg_lo:[1,0,0] neg_hi:[1,0,0]
  v_pk_fma_f32 v[198:199], v[94:95], v[64:65], v[198:199] op_sel:[0,0,0] op_sel_hi:[1,0,1] neg_lo:[1,0,0] neg_hi:[1,0,0]
  v_pk_mul_f32 v[196:197], v[196:197], v[112:113]
  v_pk_mul_f32 v[198:199], v[198:199], v[114:115]
  v_cvt_pk_bf16_f32 v244, v196, v197
  v_cvt_pk_bf16_f32 v245, v198, v199
  v_pk_fma_f32 v[200:201], v[96:97], v[64:65], v[200:201] op_sel:[0,0,0] op_sel_hi:[1,0,1] neg_lo:[1,0,0] neg_hi:[1,0,0]
  v_pk_fma_f32 v[202:203], v[98:99], v[64:65], v[202:203] op_sel:[0,0,0] op_sel_hi:[1,0,1] neg_lo:[1,0,0] neg_hi:[1,0,0]
  v_pk_mul_f32 v[200:201], v[200:201], v[116:117]
  v_pk_mul_f32 v[202:203], v[202:203], v[118:119]
  v_cvt_pk_bf16_f32 v246, v200, v201
  v_cvt_pk_bf16_f32 v247, v202, v203
  v_pk_fma_f32 v[204:205], v[100:101], v[64:65], v[204:205] op_sel:[0,0,0] op_sel_hi:[1,0,1] neg_lo:[1,0,0] neg_hi:[1,0,0]
  v_pk_fma_f32 v[206:207], v[102:103], v[64:65], v[206:207] op_sel:[0,0,0] op_sel_hi:[1,0,1] neg_lo:[1,0,0] neg_hi:[1,0,0]
  v_pk_mul_f32 v[204:205], v[204:205], v[120:121]
  v_pk_mul_f32 v[206:207], v[206:207], v[122:123]
  v_cvt_pk_bf16_f32 v248, v204, v205
  v_cvt_pk_bf16_f32 v249, v206, v207
  v_pk_fma_f32 v[44:45], v[84:85], v[64:65], v[44:45] op_sel:[0,1,0] op_sel_hi:[1,1,1] neg_lo:[1,0,0] neg_hi:[1,0,0]
  v_pk_fma_f32 v[46:47], v[86:87], v[64:65], v[46:47] op_sel:[0,1,0] op_sel_hi:[1,1,1] neg_lo:[1,0,0] neg_hi:[1,0,0]
  v_pk_mul_f32 v[44:45], v[44:45], v[104:105]
  v_pk_mul_f32 v[46:47], v[46:47], v[106:107]
  v_cvt_pk_bf16_f32 v224, v44, v45
  v_cvt_pk_bf16_f32 v225, v46, v47
  v_pk_fma_f32 v[208:209], v[88:89], v[64:65], v[208:209] op_sel:[0,1,0] op_sel_hi:[1,1,1] neg_lo:[1,0,0] neg_hi:[1,0,0]
  v_pk_fma_f32 v[210:211], v[90:91], v[64:65], v[210:211] op_sel:[0,1,0] op_sel_hi:[1,1,1] neg_lo:[1,0,0] neg_hi:[1,0,0]
  v_pk_mul_f32 v[208:209], v[208:209], v[108:109]
  v_pk_mul_f32 v[210:211], v[210:211], v[110:111]
  v_cvt_pk_bf16_f32 v226, v208, v209
  v_cvt_pk_bf16_f32 v227, v210, v211
  v_pk_fma_f32 v[212:213], v[92:93], v[64:65], v[212:213] op_sel:[0,1,0] op_sel_hi:[1,1,1] neg_lo:[1,0,0] neg_hi:[1,0,0]
  v_pk_fma_f32 v[214:215], v[94:95], v[64:65], v[214:215] op_sel:[0,1,0] op_sel_hi:[1,1,1] neg_lo:[1,0,0] neg_hi:[1,0,0]
  v_pk_mul_f32 v[212:213], v[212:213], v[112:113]
  v_pk_mul_f32 v[214:215], v[214:215], v[114:115]
  v_cvt_pk_bf16_f32 v228, v212, v213
  v_cvt_pk_bf16_f32 v229, v214, v215
  v_pk_fma_f32 v[216:217], v[96:97], v[64:65], v[216:217] op_sel:[0,1,0] op_sel_hi:[1,1,1] neg_lo:[1,0,0] neg_hi:[1,0,0]
  v_pk_fma_f32 v[218:219], v[98:99], v[64:65], v[218:219] op_sel:[0,1,0] op_sel_hi:[1,1,1] neg_lo:[1,0,0] neg_hi:[1,0,0]
  v_pk_mul_f32 v[216:217], v[216:217], v[116:117]
  v_pk_mul_f32 v[218:219], v[218:219], v[118:119]
  v_cvt_pk_bf16_f32 v230, v216, v217
  v_cvt_pk_bf16_f32 v231, v218, v219
  v_pk_fma_f32 v[220:221], v[100:101], v[64:65], v[220:221] op_sel:[0,1,0] op_sel_hi:[1,1,1] neg_lo:[1,0,0] neg_hi:[1,0,0]
  v_pk_fma_f32 v[222:223], v[102:103], v[64:65], v[222:223] op_sel:[0,1,0] op_sel_hi:[1,1,1] neg_lo:[1,0,0] neg_hi:[1,0,0]
  v_pk_mul_f32 v[220:221], v[220:221], v[120:121]
  v_pk_mul_f32 v[222:223], v[222:223], v[122:123]
  v_cvt_pk_bf16_f32 v232, v220, v221
  v_cvt_pk_bf16_f32 v233, v222, v223
  v_cndmask_b32 v148, v148, v149, s[48:49]
  v_cndmask_b32 v180, v180, v181, s[48:49]
  v_cndmask_b32 v150, v150, v151, s[48:49]
  v_cndmask_b32 v182, v182, v183, s[48:49]
  v_cndmask_b32 v36, v148, v180, s[50:51]
  v_cndmask_b32 v37, v150, v182, s[52:53]
  v_mul_f32 v36, v36, v77
  v_mul_f32 v37, v37, v81
  v_cndmask_b32 v152, v152, v153, s[48:49]
  v_cndmask_b32 v184, v184, v185, s[48:49]
  v_cndmask_b32 v154, v154, v155, s[48:49]
  v_cndmask_b32 v186, v186, v187, s[48:49]
  v_cndmask_b32 v40, v152, v184, s[50:51]
  v_cndmask_b32 v41, v154, v186, s[52:53]
  v_mul_f32 v40, v40, v78
  v_mul_f32 v41, v41, v82
  v_cndmask_b32 v156, v156, v157, s[48:49]
  v_cndmask_b32 v188, v188, v189, s[48:49]
  v_cndmask_b32 v158, v158, v159, s[48:49]
  v_cndmask_b32 v190, v190, v191, s[48:49]
  v_cndmask_b32 v44, v156, v188, s[50:51]
  v_cndmask_b32 v45, v158, v190, s[52:53]
  v_mul_f32 v44, v44, v79
  v_mul_f32 v45, v45, v83
  v_cndmask_b32 v144, v144, v145, s[48:49]
  v_cndmask_b32 v176, v176, v177, s[48:49]
  v_cndmask_b32 v146, v146, v147, s[48:49]
  v_cndmask_b32 v178, v178, v179, s[48:49]
  v_cndmask_b32 v32, v144, v176, s[50:51]
  v_cndmask_b32 v33, v146, v178, s[52:53]
  v_mul_f32 v32, v32, v76
  v_mul_f32 v33, v33, v80
  v_mov_b32 v48, 0xceabfb8f
  v_cndmask_b32 v32, v32, v48, s[54:55]
  v_cndmask_b32 v33, v33, v48, s[14:15]
  v_max_f32 v34, v32, v33
  v_max_f32 v38, v36, v37
  v_max_f32 v42, v40, v41
  v_max_f32 v46, v44, v45
  v_mov_b32 v35, v34
  v_mov_b32 v39, v38
  v_mov_b32 v43, v42
  v_mov_b32 v47, v46
  v_permlane32_swap_b32 v34, v35
  v_permlane32_swap_b32 v38, v39
  v_permlane32_swap_b32 v42, v43
  v_permlane32_swap_b32 v46, v47
  v_max_f32 v34, v34, v35
  v_max_f32 v38, v38, v39
  v_max_f32 v42, v42, v43
  v_max_f32 v46, v46, v47
  v_mov_b32 v35, v34
  v_mov_b32 v39, v38
  v_mov_b32 v43, v42
  v_mov_b32 v47, v46
  v_permlane16_swap_b32 v34, v35
  v_permlane16_swap_b32 v38, v39
  v_permlane16_swap_b32 v42, v43
  v_permlane16_swap_b32 v46, v47
  v_max_f32 v34, v34, v35
  v_max_f32 v38, v38, v39
  v_max_f32 v42, v42, v43
  v_max_f32 v46, v46, v47
  v_sub_f32 v32, v32, v34
  v_sub_f32 v33, v33, v34
  v_sub_f32 v36, v36, v38
  v_sub_f32 v37, v37, v38
  v_sub_f32 v40, v40, v42
  v_sub_f32 v41, v41, v42
  v_sub_f32 v44, v44, v46
  v_sub_f32 v45, v45, v46
  v_exp_f32 v32, v32
  v_exp_f32 v33, v33
  v_exp_f32 v36, v36
  v_exp_f32 v37, v37
  v_exp_f32 v40, v40
  v_exp_f32 v41, v41
  v_exp_f32 v44, v44
  v_exp_f32 v45, v45
  v_cvt_pk_bf16_f32 v32, v32, v32
  v_cvt_pk_bf16_f32 v33, v33, v33
  v_and_b32 v128, v32, v27
  v_and_b32 v129, v33, v29
  v_and_b32 v130, v32, v28
  v_and_b32 v131, v33, v30
  v_cvt_pk_bf16_f32 v36, v36, v36
  v_cvt_pk_bf16_f32 v37, v37, v37
  v_and_b32 v132, v36, v27
  v_and_b32 v133, v37, v29
  v_and_b32 v134, v36, v28
  v_and_b32 v135, v37, v30
  v_mfma_f32_16x16x32_bf16 v[144:147], v[236:239], v[128:131], 0
  v_mfma_f32_16x16x32_bf16 v[192:195], v[240:243], v[128:131], 0
  v_mfma_f32_16x16x32_bf16 v[208:211], v[224:227], v[128:131], 0
  v_cvt_pk_bf16_f32 v40, v40, v40
  v_cvt_pk_bf16_f32 v41, v41, v41
  v_and_b32 v136, v40, v27
  v_and_b32 v137, v41, v29
  v_and_b32 v138, v40, v28
  v_and_b32 v139, v41, v30
  v_mfma_f32_16x16x32_bf16 v[148:151], v[236:239], v[132:135], 0
  v_mfma_f32_16x16x32_bf16 v[196:199], v[242:245], v[132:135], 0
  v_mfma_f32_16x16x32_bf16 v[212:215], v[226:229], v[132:135], 0
  v_cvt_pk_bf16_f32 v44, v44, v44
  v_cvt_pk_bf16_f32 v45, v45, v45
  v_and_b32 v140, v44, v27
  v_and_b32 v141, v45, v29
  v_and_b32 v142, v44, v28
  v_and_b32 v143, v45, v30
  v_mfma_f32_16x16x32_bf16 v[152:155], v[236:239], v[136:139], 0
  v_mfma_f32_16x16x32_bf16 v[200:203], v[244:247], v[136:139], 0
  v_mfma_f32_16x16x32_bf16 v[216:219], v[228:231], v[136:139], 0
  v_mfma_f32_16x16x32_bf16 v[156:159], v[236:239], v[140:143], 0
  v_mfma_f32_16x16x32_bf16 v[204:207], v[246:249], v[140:143], 0
  v_mfma_f32_16x16x32_bf16 v[220:223], v[230:233], v[140:143], 0
  v_rcp_f32 v144, v144
  s_mov_b32 s3, 0
  v_pk_mul_f32 v[192:193], v[192:193], v[144:145] op_sel_hi:[1,0]
  v_pk_mul_f32 v[194:195], v[194:195], v[144:145] op_sel_hi:[1,0]
  v_pk_mul_f32 v[208:209], v[208:209], v[144:145] op_sel_hi:[1,0]
  v_pk_mul_f32 v[210:211], v[210:211], v[144:145] op_sel_hi:[1,0]
  v_cvt_pk_bf16_f32 v48, v192, v193
  v_cvt_pk_bf16_f32 v49, v194, v195
  v_cvt_pk_bf16_f32 v50, v208, v209
  v_cvt_pk_bf16_f32 v51, v210, v211
  s_nop 1
  v_permlane16_swap_b32 v48, v50
  v_permlane16_swap_b32 v49, v51
  buffer_store_dwordx4 v[48:51], v31, s[44:47], s3 offen sc1
  v_rcp_f32 v148, v148
  s_mov_b32 s3, 32768
  v_pk_mul_f32 v[196:197], v[196:197], v[148:149] op_sel_hi:[1,0]
  v_pk_mul_f32 v[198:199], v[198:199], v[148:149] op_sel_hi:[1,0]
  v_pk_mul_f32 v[212:213], v[212:213], v[148:149] op_sel_hi:[1,0]
  v_pk_mul_f32 v[214:215], v[214:215], v[148:149] op_sel_hi:[1,0]
  v_cvt_pk_bf16_f32 v52, v196, v197
  v_cvt_pk_bf16_f32 v53, v198, v199
  v_cvt_pk_bf16_f32 v54, v212, v213
  v_cvt_pk_bf16_f32 v55, v214, v215
  s_nop 1
  v_permlane16_swap_b32 v52, v54
  v_permlane16_swap_b32 v53, v55
  buffer_store_dwordx4 v[52:55], v31, s[44:47], s3 offen sc1
  v_rcp_f32 v152, v152
  s_mov_b32 s3, 65536
  v_pk_mul_f32 v[200:201], v[200:201], v[152:153] op_sel_hi:[1,0]
  v_pk_mul_f32 v[202:203], v[202:203], v[152:153] op_sel_hi:[1,0]
  v_pk_mul_f32 v[216:217], v[216:217], v[152:153] op_sel_hi:[1,0]
  v_pk_mul_f32 v[218:219], v[218:219], v[152:153] op_sel_hi:[1,0]
  v_cvt_pk_bf16_f32 v56, v200, v201
  v_cvt_pk_bf16_f32 v57, v202, v203
  v_cvt_pk_bf16_f32 v58, v216, v217
  v_cvt_pk_bf16_f32 v59, v218, v219
  s_nop 1
  v_permlane16_swap_b32 v56, v58
  v_permlane16_swap_b32 v57, v59
  buffer_store_dwordx4 v[56:59], v31, s[44:47], s3 offen sc1
  v_rcp_f32 v156, v156
  s_mov_b32 s3, 98304
  v_pk_mul_f32 v[204:205], v[204:205], v[156:157] op_sel_hi:[1,0]
  v_pk_mul_f32 v[206:207], v[206:207], v[156:157] op_sel_hi:[1,0]
  v_pk_mul_f32 v[220:221], v[220:221], v[156:157] op_sel_hi:[1,0]
  v_pk_mul_f32 v[222:223], v[222:223], v[156:157] op_sel_hi:[1,0]
  v_cvt_pk_bf16_f32 v60, v204, v205
  v_cvt_pk_bf16_f32 v61, v206, v207
  v_cvt_pk_bf16_f32 v62, v220, v221
  v_cvt_pk_bf16_f32 v63, v222, v223
  s_nop 1
  v_permlane16_swap_b32 v60, v62
  v_permlane16_swap_b32 v61, v63
  buffer_store_dwordx4 v[60:63], v31, s[44:47], s3 offen sc1
  s_cmp_eq_u32 s96, 0
  s_cbranch_scc1 L_attn_end
  s_waitcnt vmcnt(0)
  s_barrier
  s_add_u32 s97, s97, 1
  s_branch L_wo_body
.section .rodata,"a"
.p2align 6
.amdhsa_kernel attnl0_kernel
  .amdhsa_next_free_vgpr 256
  .amdhsa_next_free_sgpr 102
  .amdhsa_accum_offset 256
  .amdhsa_group_segment_fixed_size 0
  .amdhsa_kernarg_size 88
  .amdhsa_user_sgpr_count 2
  .amdhsa_user_sgpr_kernarg_segment_ptr 1
  .amdhsa_system_sgpr_workgroup_id_x 1
  .amdhsa_float_denorm_mode_32 3
  .amdhsa_float_denorm_mode_16_64 3
.end_amdhsa_kernel
.text
L_attn_c1:
L_wo_c0:
.text
.globl wol0_kernel
.p2align 8
.type wol0_kernel,@function
wol0_kernel:
  s_load_dwordx4 s[16:19], s[0:1], 0
  s_load_dwordx2 s[20:21], s[0:1], 16
  s_load_dwordx2 s[22:23], s[0:1], 80
  s_load_dwordx8 s[24:31], s[0:1], 32
  s_load_dwordx2 s[32:33], s[0:1], 64
  s_load_dwordx2 s[34:35], s[0:1], 80
  s_load_dwordx2 s[12:13], s[0:1], 0
  s_mov_b32 s96, 0
  s_mov_b32 s97, 1
L_wo_body:
  s_cmp_ge_u32 s2, 256
  s_cbranch_scc1 L_wo_end
  v_lshrrev_b32 v2, 6, v0
  v_and_b32 v1, 63, v0
  v_readfirstlane_b32 s70, v2
  s_and_b32 s3, s2, 7
  s_lshr_b32 s99, s2, 3
  s_and_b32 s5, s3, 3
  s_lshl_b32 s5, s5, 2
  s_and_b32 s6, s99, 3
  s_add_u32 s68, s5, s6
  s_lshr_b32 s5, s3, 2
  s_lshl_b32 s5, s5, 3
  s_lshr_b32 s6, s99, 2
  s_add_u32 s69, s5, s6
  s_cmp_lt_u32 s70, 4
  s_cbranch_scc1 L_wo_compute
L_wo_loader:
  s_add_u32 s8, s70, s69
  s_and_b32 s8, s8, 3
  s_add_u32 s9, s70, s68
  s_and_b32 s9, s9, 3
  s_lshl_b32 s76, s8, 12
  s_lshl_b32 s77, s9, 11
  s_add_u32 s77, s77, 16384
  s_lshl_b32 s11, s68, 7
  v_and_b32 v10, 7, v1
  s_lshr_b32 s10, s76, 11
  s_lshl_b32 s3, s68, 3
  s_add_u32 s10, s10, s3
  s_mul_i32 s10, s10, 32768
  v_lshl_add_u32 v4, v1, 4, s10
  v_add_u32 v5, 32768, v4
  v_lshrrev_b32 v3, 3, v1
  s_lshl_b32 s10, s9, 4
  v_add_u32 v3, s10, v3
  v_mul_u32_u24 v3, 2048, v3
  v_lshrrev_b32 v2, 3, v1
  v_and_b32 v2, 2, v2
  v_xor_b32 v2, v2, v10
  s_mul_i32 s10, s69, 128
  v_add_u32 v3, s10, v3
  v_lshl_add_u32 v8, v2, 4, v3
  v_xor_b32 v2, 4, v2
  v_add_u32 v3, 16384, v3
  v_lshl_add_u32 v9, v2, 4, v3
  s_mov_b32 s75, 0
  s_add_u32 s100, s68, s69
  s_mov_b32 s101, -1
  s_add_u32 s101, s101, 1
  s_sub_u32 s73, s101, s100
  s_lshl_b32 s73, s73, 3
  s_lshr_b32 s73, 0xf0f02, s73
  s_and_b32 s73, s73, 255
  s_add_u32 s73, s73, s101
  s_and_b32 s73, s73, 15
  s_mul_i32 s74, s73, 131072
  s_lshl_b32 s73, s73, 11
  s_waitcnt lgkmcnt(0)
  s_mov_b32 s36, s34
  s_and_b32 s37, s35, 0xffff
  s_mov_b32 s38, 4194304
  s_mov_b32 s39, 0x00020000
  s_mov_b32 s40, s20
  s_and_b32 s41, s21, 0xffff
  s_mov_b32 s42, 2097152
  s_mov_b32 s43, 0x00020000
  s_mov_b32 s88, s73
  s_add_u32 m0, s77, 0
  s_add_u32 s4, s74, 0
  buffer_load_dwordx4 v8, s[40:43], s4 offen lds
  s_add_u32 m0, s77, 1024
  s_nop 0
  buffer_load_dwordx4 v9, s[40:43], s4 offen lds
  s_add_u32 s101, s101, 1
  s_sub_u32 s73, s101, s100
  s_lshl_b32 s73, s73, 3
  s_lshr_b32 s73, 0xf0f02, s73
  s_and_b32 s73, s73, 255
  s_add_u32 s73, s73, s101
  s_and_b32 s73, s73, 15
  s_mul_i32 s74, s73, 131072
  s_lshl_b32 s73, s73, 11
  s_mov_b32 s89, s73
  s_add_u32 m0, s77, 24576
  s_add_u32 s4, s74, 0
  buffer_load_dwordx4 v8, s[40:43], s4 offen lds
  s_add_u32 m0, s77, 25600
  s_nop 0
  buffer_load_dwordx4 v9, s[40:43], s4 offen lds
  s_add_u32 s101, s101, 1
  s_sub_u32 s73, s101, s100
  s_lshl_b32 s73, s73, 3
  s_lshr_b32 s73, 0xf0f02, s73
  s_and_b32 s73, s73, 255
  s_add_u32 s73, s73, s101
  s_and_b32 s73, s73, 15
  s_mul_i32 s74, s73, 131072
  s_lshl_b32 s73, s73, 11
  s_mov_b32 s90, s73
  s_add_u32 m0, s77, 49152
  s_add_u32 s4, s74, 0
  buffer_load_dwordx4 v8, s[40:43], s4 offen lds
  s_add_u32 m0, s77, 50176
  s_nop 0
  buffer_load_dwordx4 v9, s[40:43], s4 offen lds
  s_add_u32 s101, s101, 1
  s_sub_u32 s73, s101, s100
  s_lshl_b32 s73, s73, 3
  s_lshr_b32 s73, 0xf0f02, s73
  s_and_b32 s73, s73, 255
  s_add_u32 s73, s73, s101
  s_and_b32 s73, s73, 15
  s_mul_i32 s74, s73, 131072
  s_lshl_b32 s73, s73, 11
  s_mov_b32 s91, s73
  s_add_u32 m0, s77, 73728
  s_add_u32 s4, s74, 0
  buffer_load_dwordx4 v8, s[40:43], s4 offen lds
  s_add_u32 m0, s77, 74752
  s_nop 0
  buffer_load_dwordx4 v9, s[40:43], s4 offen lds
  s_add_u32 s101, s101, 1
  s_sub_u32 s73, s101, s100
  s_lshl_b32 s73, s73, 3
  s_lshr_b32 s73, 0xf0f02, s73
  s_and_b32 s73, s73, 255
  s_add_u32 s73, s73, s101
  s_and_b32 s73, s73, 15
  s_mul_i32 s74, s73, 131072
  s_lshl_b32 s73, s73, 11
  s_mov_b32 s92, s73
  s_add_u32 m0, s77, 98304
  s_add_u32 s4, s74, 0
  buffer_load_dwordx4 v8, s[40:43], s4 offen lds
  s_add_u32 m0, s77, 99328
  s_nop 0
  buffer_load_dwordx4 v9, s[40:43], s4 offen lds
  s_add_u32 s101, s101, 1
  s_sub_u32 s73, s101, s100
  s_lshl_b32 s73, s73, 3
  s_lshr_b32 s73, 0xf0f02, s73
  s_and_b32 s73, s73, 255
  s_add_u32 s73, s73, s101
  s_and_b32 s73, s73, 15
  s_mul_i32 s74, s73, 131072
  s_lshl_b32 s73, s73, 11
  s_mov_b32 s75, 122880
  s_cmp_eq_u32 s97, 1
  s_cbranch_scc1 L_wo_dep
  s_add_u32 s44, s22, 24903680
  s_addc_u32 s45, s23, 0
  s_and_b32 s45, s45, 0xffff
  s_mov_b32 s46, 32768
  s_mov_b32 s47, 0x00020000
  s_lshl_b32 s3, s97, 12
  s_lshl_b32 s4, s68, 8
  s_add_u32 s3, s3, s4
  s_sub_u32 s3, s3, 4096
  v_and_b32 v2, 15, v1
  v_lshlrev_b32 v2, 2, v2
  v_mov_b32 v3, 1
  s_mov_b32 s79, 0x100000
  s_cmp_lg_u32 s70, 4
  s_barrier
  s_cbranch_scc1 L_wo_dep
  s_mov_b64 exec, 1
  buffer_store_dword v3, off, s[44:47], s87 sc1
  s_mov_b64 exec, -1
L_wo_poll:
  buffer_load_dword v3, v2, s[44:47], s3 offen sc1
  s_sub_u32 s79, s79, 1
  s_cbranch_scc1 L_wo_dep
  s_waitcnt vmcnt(0)
  v_cmp_ne_u32 vcc, 1, v3
  s_cbranch_vccnz L_wo_poll
L_wo_dep:
  s_barrier
  s_add_u32 m0, s76, 0
  s_nop 0
  buffer_load_dwordx4 v4, s[36:39], s88 offen offset:0 lds
  buffer_load_dwordx4 v4, s[36:39], s88 offen offset:1024 lds
  s_add_u32 m0, s76, 2048
  s_nop 0
  buffer_load_dwordx4 v5, s[36:39], s88 offen offset:0 lds
  buffer_load_dwordx4 v5, s[36:39], s88 offen offset:1024 lds
  s_add_u32 m0, s76, 24576
  s_nop 0
  buffer_load_dwordx4 v4, s[36:39], s89 offen offset:0 lds
  buffer_load_dwordx4 v4, s[36:39], s89 offen offset:1024 lds
  s_add_u32 m0, s76, 26624
  s_nop 0
  buffer_load_dwordx4 v5, s[36:39], s89 offen offset:0 lds
  buffer_load_dwordx4 v5, s[36:39], s89 offen offset:1024 lds
  s_add_u32 m0, s76, 49152
  s_nop 0
  buffer_load_dwordx4 v4, s[36:39], s90 offen offset:0 lds
  buffer_load_dwordx4 v4, s[36:39], s90 offen offset:1024 lds
  s_add_u32 m0, s76, 51200
  s_nop 0
  buffer_load_dwordx4 v5, s[36:39], s90 offen offset:0 lds
  buffer_load_dwordx4 v5, s[36:39], s90 offen offset:1024 lds
  s_add_u32 m0, s76, 73728
  s_nop 0
  buffer_load_dwordx4 v4, s[36:39], s91 offen offset:0 lds
  buffer_load_dwordx4 v4, s[36:39], s91 offen offset:1024 lds
  s_add_u32 m0, s76, 75776
  s_nop 0
  buffer_load_dwordx4 v5, s[36:39], s91 offen offset:0 lds
  buffer_load_dwordx4 v5, s[36:39], s91 offen offset:1024 lds
  s_add_u32 m0, s76, 98304
  s_nop 0
  buffer_load_dwordx4 v4, s[36:39], s92 offen offset:0 lds
  buffer_load_dwordx4 v4, s[36:39], s92 offen offset:1024 lds
  s_add_u32 m0, s76, 100352
  s_nop 0
  buffer_load_dwordx4 v5, s[36:39], s92 offen offset:0 lds
  buffer_load_dwordx4 v5, s[36:39], s92 offen offset:1024 lds
  s_waitcnt vmcnt(16)
  s_barrier
  s_add_u32 s3, s75, s76
  s_add_u32 m0, s3, 0
  s_nop 0
  buffer_load_dwordx4 v4, s[36:39], s73 offen offset:0 lds
  buffer_load_dwordx4 v4, s[36:39], s73 offen offset:1024 lds
  s_add_u32 m0, s3, 2048
  s_nop 0
  buffer_load_dwordx4 v5, s[36:39], s73 offen offset:0 lds
  buffer_load_dwordx4 v5, s[36:39], s73 offen offset:1024 lds
  s_add_u32 s3, s75, s77
  s_add_u32 m0, s3, 0
  s_add_u32 s4, s74, 0
  buffer_load_dwordx4 v8, s[40:43], s4 offen lds
  s_add_u32 m0, s3, 1024
  s_nop 0
  buffer_load_dwordx4 v9, s[40:43], s4 offen lds
  s_add_u32 s101, s101, 1
  s_sub_u32 s73, s101, s100
  s_lshl_b32 s73, s73, 3
  s_lshr_b32 s73, 0xf0f02, s73
  s_and_b32 s73, s73, 255
  s_add_u32 s73, s73, s101
  s_and_b32 s73, s73, 15
  s_mul_i32 s74, s73, 131072
  s_lshl_b32 s73, s73, 11
  s_add_u32 s75, s75, 24576
  s_cmp_eq_u32 s75, 147456
  s_cselect_b32 s75, 0, s75
  s_waitcnt vmcnt(18)
  s_barrier
  s_add_u32 s3, s75, s76
  s_add_u32 m0, s3, 0
  s_nop 0
  buffer_load_dwordx4 v4, s[36:39], s73 offen offset:0 lds
  buffer_load_dwordx4 v4, s[36:39], s73 offen offset:1024 lds
  s_add_u32 m0, s3, 2048
  s_nop 0
  buffer_load_dwordx4 v5, s[36:39], s73 offen offset:0 lds
  buffer_load_dwordx4 v5, s[36:39], s73 offen offset:1024 lds
  s_add_u32 s3, s75, s77
  s_add_u32 m0, s3, 0
  s_add_u32 s4, s74, 0
  buffer_load_dwordx4 v8, s[40:43], s4 offen lds
  s_add_u32 m0, s3, 1024
  s_nop 0
  buffer_load_dwordx4 v9, s[40:43], s4 offen lds
  s_add_u32 s101, s101, 1
  s_sub_u32 s73, s101, s100
  s_lshl_b32 s73, s73, 3
  s_lshr_b32 s73, 0xf0f02, s73
  s_and_b32 s73, s73, 255
  s_add_u32 s73, s73, s101
  s_and_b32 s73, s73, 15
  s_mul_i32 s74, s73, 131072
  s_lshl_b32 s73, s73, 11
  s_add_u32 s75, s75, 24576
  s_cmp_eq_u32 s75, 147456
  s_cselect_b32 s75, 0, s75
  s_waitcnt vmcnt(20)
  s_barrier
  s_add_u32 s3, s75, s76
  s_add_u32 m0, s3, 0
  s_nop 0
  buffer_load_dwordx4 v4, s[36:39], s73 offen offset:0 lds
  buffer_load_dwordx4 v4, s[36:39], s73 offen offset:1024 lds
  s_add_u32 m0, s3, 2048
  s_nop 0
  buffer_load_dwordx4 v5, s[36:39], s73 offen offset:0 lds
  buffer_load_dwordx4 v5, s[36:39], s73 offen offset:1024 lds
  s_add_u32 s3, s75, s77
  s_add_u32 m0, s3, 0
  s_add_u32 s4, s74, 0
  buffer_load_dwordx4 v8, s[40:43], s4 offen lds
  s_add_u32 m0, s3, 1024
  s_nop 0
  buffer_load_dwordx4 v9, s[40:43], s4 offen lds
  s_add_u32 s101, s101, 1
  s_sub_u32 s73, s101, s100
  s_lshl_b32 s73, s73, 3
  s_lshr_b32 s73, 0xf0f02, s73
  s_and_b32 s73, s73, 255
  s_add_u32 s73, s73, s101
  s_and_b32 s73, s73, 15
  s_mul_i32 s74, s73, 131072
  s_lshl_b32 s73, s73, 11
  s_add_u32 s75, s75, 24576
  s_cmp_eq_u32 s75, 147456
  s_cselect_b32 s75, 0, s75
  s_waitcnt vmcnt(22)
  s_barrier
  s_mov_b32 s79, 7
L_wol_ld1:
  s_add_u32 s3, s75, s76
  s_add_u32 m0, s3, 0
  s_nop 0
  buffer_load_dwordx4 v4, s[36:39], s73 offen offset:0 lds
  buffer_load_dwordx4 v4, s[36:39], s73 offen offset:1024 lds
  s_add_u32 m0, s3, 2048
  s_nop 0
  buffer_load_dwordx4 v5, s[36:39], s73 offen offset:0 lds
  buffer_load_dwordx4 v5, s[36:39], s73 offen offset:1024 lds
  s_add_u32 s3, s75, s77
  s_add_u32 m0, s3, 0
  s_add_u32 s4, s74, 0
  buffer_load_dwordx4 v8, s[40:43], s4 offen lds
  s_add_u32 m0, s3, 1024
  s_nop 0
  buffer_load_dwordx4 v9, s[40:43], s4 offen lds
  s_add_u32 s101, s101, 1
  s_sub_u32 s73, s101, s100
  s_lshl_b32 s73, s73, 3
  s_lshr_b32 s73, 0xf0f02, s73
  s_and_b32 s73, s73, 255
  s_add_u32 s73, s73, s101
  s_and_b32 s73, s73, 15
  s_mul_i32 s74, s73, 131072
  s_lshl_b32 s73, s73, 11
  s_add_u32 s75, s75, 24576
  s_cmp_eq_u32 s75, 147456
  s_cselect_b32 s75, 0, s75
  s_waitcnt vmcnt(24)
  s_barrier
  s_sub_u32 s79, s79, 1
  s_cmp_lg_u32 s79, 0
  s_cbranch_scc1 L_wol_ld1
  s_add_u32 s3, s75, s76
  s_add_u32 m0, s3, 0
  s_nop 0
  buffer_load_dwordx4 v4, s[36:39], s73 offen offset:0 lds
  buffer_load_dwordx4 v4, s[36:39], s73 offen offset:1024 lds
  s_add_u32 m0, s3, 2048
  s_nop 0
  buffer_load_dwordx4 v5, s[36:39], s73 offen offset:0 lds
  buffer_load_dwordx4 v5, s[36:39], s73 offen offset:1024 lds
  s_add_u32 s3, s75, s77
  s_add_u32 m0, s3, 0
  s_add_u32 s4, s74, 0
  buffer_load_dwordx4 v8, s[40:43], s4 offen lds
  s_add_u32 m0, s3, 1024
  s_nop 0
  buffer_load_dwordx4 v9, s[40:43], s4 offen lds
  s_add_u32 s101, s101, 1
  s_sub_u32 s73, s101, s100
  s_lshl_b32 s73, s73, 3
  s_lshr_b32 s73, 0xf0f02, s73
  s_and_b32 s73, s73, 255
  s_add_u32 s73, s73, s101
  s_and_b32 s73, s73, 15
  s_mul_i32 s74, s73, 131072
  s_lshl_b32 s73, s73, 11
  s_add_u32 s75, s75, 24576
  s_cmp_eq_u32 s75, 147456
  s_cselect_b32 s75, 0, s75
  s_mov_b32 s48, s12
  s_and_b32 s49, s13, 0xffff
  s_mov_b32 s50, 4194304
  s_mov_b32 s51, 0x00020000
  v_lshrrev_b32 v3, 3, v1
  s_lshr_b32 s10, s76, 7
  s_lshl_b32 s3, s68, 7
  s_add_u32 s10, s10, s3
  v_add_u32 v3, s10, v3
  v_mul_u32_u24 v3, 2048, v3
  v_lshrrev_b32 v2, 4, v1
  v_xor_b32 v4, v2, v10
  v_lshl_add_u32 v4, v4, 4, v3
  v_add_u32 v3, 16384, v3
  v_add_u32 v5, 4, v2
  v_xor_b32 v5, v5, v10
  v_lshl_add_u32 v5, v5, 4, v3
  v_add_u32 v3, 16384, v3
  v_xor_b32 v6, v2, v10
  v_lshl_add_u32 v6, v6, 4, v3
  v_add_u32 v3, 16384, v3
  v_add_u32 v7, 4, v2
  v_xor_b32 v7, v7, v10
  v_lshl_add_u32 v7, v7, 4, v3
  s_lshl_b32 s4, s69, 7
  s_add_u32 m0, s76, 147456
  s_nop 0
  buffer_load_dwordx4 v4, s[48:51], s4 offen lds
  s_add_u32 m0, s76, 148480
  s_nop 0
  buffer_load_dwordx4 v5, s[48:51], s4 offen lds
  s_add_u32 m0, s76, 149504
  s_nop 0
  buffer_load_dwordx4 v6, s[48:51], s4 offen lds
  s_add_u32 m0, s76, 150528
  s_nop 0
  buffer_load_dwordx4 v7, s[48:51], s4 offen lds
  s_waitcnt vmcnt(28)
  s_barrier
  s_waitcnt vmcnt(22)
  s_barrier
  s_waitcnt vmcnt(16)
  s_barrier
  s_waitcnt vmcnt(10)
  s_barrier
  s_waitcnt vmcnt(4)
  s_barrier
  s_waitcnt vmcnt(0)
  s_barrier
  s_waitcnt vmcnt(0)
  s_lshl_b32 s87, s97, 12
  s_lshl_b32 s4, s68, 8
  s_add_u32 s87, s87, s4
  s_lshl_b32 s4, s69, 2
  s_add_u32 s87, s87, s4
  s_add_u32 s97, s97, 1
  s_branch L_w1_body
L_wo_end:
  s_endpgm
L_wo_compute:
  v_and_b32 v3, 15, v1
  v_lshrrev_b32 v2, 4, v1
  s_lshl_b32 s8, s68, 7
  s_lshl_b32 s9, s70, 5
  s_add_u32 s8, s8, s9
  v_add_u32 v13, s8, v3
  s_lshl_b32 s10, s69, 7
  v_lshl_add_u32 v14, v2, 3, s10
  v_and_b32 v16, 1, v2
  v_lshrrev_b32 v17, 1, v2
  v_lshl_add_u32 v16, v16, 1, v17
  v_lshlrev_b32 v16, 8, v16
  v_lshl_add_u32 v16, v3, 4, v16
  s_add_u32 s9, s8, s69
  s_lshl_b32 s9, s9, 11
  v_add_u32 v12, s9, v16
  v_lshl_add_u32 v18, v17, 4, v13
  v_lshlrev_b32 v18, 3, v18
  v_and_b32 v16, 1, v2
  v_lshl_add_u32 v18, v16, 2, v18
  s_lshl_b32 s10, s69, 14
  v_add_u32 v18, s10, v18
  s_lshl_b32 s8, s70, 12
  v_lshl_add_u32 v5, v1, 4, s8
  v_bfe_u32 v6, v1, 2, 2
  v_lshl_add_u32 v6, v2, 3, v6
  v_lshlrev_b32 v6, 7, v6
  v_and_b32 v17, 3, v1
  v_lshl_add_u32 v6, v17, 3, v6
  v_bfe_u32 v17, v1, 3, 2
  v_lshl_add_u32 v6, v17, 5, v6
  v_add_u32 v6, 16384, v6
  v_xor_b32 v7, 32, v6
  v_xor_b32 v8, 64, v6
  v_xor_b32 v9, 96, v6
  v_lshrrev_b32 v15, 1, v2
  v_lshrrev_b32 v17, 1, v3
  v_xor_b32 v15, v15, v17
  v_lshlrev_b32 v15, 4, v15
  v_lshl_add_u32 v15, v3, 7, v15
  v_lshl_add_u32 v15, v16, 3, v15
  s_add_u32 s8, s8, 147456
  v_add_u32 v15, s8, v15
  s_mov_b32 s11, 0xffff0000
  s_mov_b32 s75, 0
  v_mov_b32 v128, 0
  v_mov_b32 v129, 0
  v_mov_b32 v130, 0
  v_mov_b32 v131, 0
  v_mov_b32 v132, 0
  v_mov_b32 v133, 0
  v_mov_b32 v134, 0
  v_mov_b32 v135, 0
  v_mov_b32 v136, 0
  v_mov_b32 v137, 0
  v_mov_b32 v138, 0
  v_mov_b32 v139, 0
  v_mov_b32 v140, 0
  v_mov_b32 v141, 0
  v_mov_b32 v142, 0
  v_mov_b32 v143, 0
  v_mov_b32 v144, 0
  v_mov_b32 v145, 0
  v_mov_b32 v146, 0
  v_mov_b32 v147, 0
  v_mov_b32 v148, 0
  v_mov_b32 v149, 0
  v_mov_b32 v150, 0
  v_mov_b32 v151, 0
  v_mov_b32 v152, 0
  v_mov_b32 v153, 0
  v_mov_b32 v154, 0
  v_mov_b32 v155, 0
  v_mov_b32 v156, 0
  v_mov_b32 v157, 0
  v_mov_b32 v158, 0
  v_mov_b32 v159, 0
  s_waitcnt lgkmcnt(0)
  s_add_u32 s44, s34, 4194304
  s_addc_u32 s45, s35, 0
  s_and_b32 s45, s45, 0xffff
  s_mov_b32 s46, 4194304
  s_mov_b32 s47, 0x00020000
  s_add_u32 s56, s34, 24117248
  s_addc_u32 s57, s35, 0
  s_and_b32 s57, s57, 0xffff
  s_mov_b32 s58, 262144
  s_mov_b32 s59, 0x00020000
  s_cmp_lg_u32 s96, 0
  s_cbranch_scc1 L_pfc2_skip
  s_getpc_b64 s[4:5]
L_pfc2:
  s_lshl_b32 s3, s99, 2
  s_add_u32 s3, s3, s70
  s_mul_i32 s3, s3, 128
  s_min_u32 s3, s3, L_w1_c1-L_w1_c0-128
  s_add_i32 s3, s3, L_w1_c0-L_pfc2
  s_ashr_i32 s6, s3, 31
  s_add_u32 s4, s4, s3
  s_addc_u32 s5, s5, s6
  s_load_dword s36, s[4:5], 0
  s_load_dword s37, s[4:5], 64
L_pfc2_skip:
  s_barrier
  v_add_u32_e64 v25, s75, v5
  v_add_u32_e64 v26, s75, v6
  v_add_u32_e64 v27, s75, v7
  v_add_u32_e64 v28, s75, v8
  v_add_u32_e64 v29, s75, v9
  s_add_u32 s75, s75, 24576
  s_cmp_eq_u32 s75, 147456
  s_cselect_b32 s75, 0, s75
  s_barrier
  ds_read_b128 v[32:35], v25 offset:0
  ds_read_b128 v[36:39], v25 offset:2048
  ds_read_b64_tr_b16 v[48:49], v26 offset:0
  ds_read_b64_tr_b16 v[50:51], v26 offset:512
  ds_read_b64_tr_b16 v[52:53], v27 offset:0
  ds_read_b64_tr_b16 v[54:55], v27 offset:512
  ds_read_b64_tr_b16 v[56:57], v28 offset:0
  ds_read_b64_tr_b16 v[58:59], v28 offset:512
  ds_read_b64_tr_b16 v[60:61], v29 offset:0
  ds_read_b64_tr_b16 v[62:63], v29 offset:512
  ds_read_b128 v[40:43], v25 offset:1024
  ds_read_b128 v[44:47], v25 offset:3072
  ds_read_b64_tr_b16 v[64:65], v26 offset:4096
  ds_read_b64_tr_b16 v[66:67], v26 offset:4608
  ds_read_b64_tr_b16 v[68:69], v27 offset:4096
  ds_read_b64_tr_b16 v[70:71], v27 offset:4608
  ds_read_b64_tr_b16 v[72:73], v28 offset:4096
  ds_read_b64_tr_b16 v[74:75], v28 offset:4608
  ds_read_b64_tr_b16 v[76:77], v29 offset:4096
  ds_read_b64_tr_b16 v[78:79], v29 offset:4608
  s_mov_b32 s79, 8
  v_add_u32_e64 v25, s75, v5
  v_add_u32_e64 v26, s75, v6
  v_add_u32_e64 v27, s75, v7
  v_add_u32_e64 v28, s75, v8
  v_add_u32_e64 v29, s75, v9
  s_add_u32 s75, s75, 24576
  s_cmp_eq_u32 s75, 147456
  s_cselect_b32 s75, 0, s75
  s_waitcnt lgkmcnt(0)
.p2align 3
L_wo_loop:
  s_barrier
  s_sub_u32 s79, s79, 1
  v_mfma_f32_16x16x32_bf16 v[128:131], v[48:51], v[32:35], v[128:131]
  ds_read_b128 v[80:83], v25 offset:0
  ds_read_b128 v[84:87], v25 offset:2048
  v_mfma_f32_16x16x32_bf16 v[132:135], v[48:51], v[36:39], v[132:135]
  ds_read_b64_tr_b16 v[96:97], v26 offset:0
  ds_read_b64_tr_b16 v[98:99], v26 offset:512
  v_mfma_f32_16x16x32_bf16 v[136:139], v[52:55], v[32:35], v[136:139]
  ds_read_b64_tr_b16 v[100:101], v27 offset:0
  ds_read_b64_tr_b16 v[102:103], v27 offset:512
  v_mfma_f32_16x16x32_bf16 v[140:143], v[52:55], v[36:39], v[140:143]
  ds_read_b64_tr_b16 v[104:105], v28 offset:0
  ds_read_b64_tr_b16 v[106:107], v28 offset:512
  v_mfma_f32_16x16x32_bf16 v[144:147], v[56:59], v[32:35], v[144:147]
  ds_read_b64_tr_b16 v[108:109], v29 offset:0
  ds_read_b64_tr_b16 v[110:111], v29 offset:512
  v_mfma_f32_16x16x32_bf16 v[148:151], v[56:59], v[36:39], v[148:151]
  ds_read_b128 v[88:91], v25 offset:1024
  ds_read_b128 v[92:95], v25 offset:3072
  v_mfma_f32_16x16x32_bf16 v[152:155], v[60:63], v[32:35], v[152:155]
  ds_read_b64_tr_b16 v[112:113], v26 offset:4096
  ds_read_b64_tr_b16 v[114:115], v26 offset:4608
  v_mfma_f32_16x16x32_bf16 v[156:159], v[60:63], v[36:39], v[156:159]
  ds_read_b64_tr_b16 v[116:117], v27 offset:4096
  ds_read_b64_tr_b16 v[118:119], v27 offset:4608
  v_mfma_f32_16x16x32_bf16 v[128:131], v[64:67], v[40:43], v[128:131]
  ds_read_b64_tr_b16 v[120:121], v28 offset:4096
  ds_read_b64_tr_b16 v[122:123], v28 offset:4608
  v_mfma_f32_16x16x32_bf16 v[132:135], v[64:67], v[44:47], v[132:135]
  ds_read_b64_tr_b16 v[124:125], v29 offset:4096
  ds_read_b64_tr_b16 v[126:127], v29 offset:4608
  v_mfma_f32_16x16x32_bf16 v[136:139], v[68:71], v[40:43], v[136:139]
  v_add_u32_e64 v25, s75, v5
  v_add_u32_e64 v26, s75, v6
  v_mfma_f32_16x16x32_bf16 v[140:143], v[68:71], v[44:47], v[140:143]
  v_add_u32_e64 v27, s75, v7
  v_add_u32_e64 v28, s75, v8
  v_mfma_f32_16x16x32_bf16 v[144:147], v[72:75], v[40:43], v[144:147]
  v_add_u32_e64 v29, s75, v9
  s_add_u32 s75, s75, 24576
  v_mfma_f32_16x16x32_bf16 v[148:151], v[72:75], v[44:47], v[148:151]
  s_cmp_eq_u32 s75, 147456
  s_cselect_b32 s75, 0, s75
  s_nop 0
  v_mfma_f32_16x16x32_bf16 v[152:155], v[76:79], v[40:43], v[152:155]
  v_mfma_f32_16x16x32_bf16 v[156:159], v[76:79], v[44:47], v[156:159]
  s_waitcnt lgkmcnt(0)
  s_barrier
  v_mfma_f32_16x16x32_bf16 v[128:131], v[96:99], v[80:83], v[128:131]
  ds_read_b128 v[32:35], v25 offset:0
  ds_read_b128 v[36:39], v25 offset:2048
  v_mfma_f32_16x16x32_bf16 v[132:135], v[96:99], v[84:87], v[132:135]
  ds_read_b64_tr_b16 v[48:49], v26 offset:0
  ds_read_b64_tr_b16 v[50:51], v26 offset:512
  v_mfma_f32_16x16x32_bf16 v[136:139], v[100:103], v[80:83], v[136:139]
  ds_read_b64_tr_b16 v[52:53], v27 offset:0
  ds_read_b64_tr_b16 v[54:55], v27 offset:512
  v_mfma_f32_16x16x32_bf16 v[140:143], v[100:103], v[84:87], v[140:143]
  ds_read_b64_tr_b16 v[56:57], v28 offset:0
  ds_read_b64_tr_b16 v[58:59], v28 offset:512
  v_mfma_f32_16x16x32_bf16 v[144:147], v[104:107], v[80:83], v[144:147]
  ds_read_b64_tr_b16 v[60:61], v29 offset:0
  ds_read_b64_tr_b16 v[62:63], v29 offset:512
  v_mfma_f32_16x16x32_bf16 v[148:151], v[104:107], v[84:87], v[148:151]
  ds_read_b128 v[40:43], v25 offset:1024
  ds_read_b128 v[44:47], v25 offset:3072
  v_mfma_f32_16x16x32_bf16 v[152:155], v[108:111], v[80:83], v[152:155]
  ds_read_b64_tr_b16 v[64:65], v26 offset:4096
  ds_read_b64_tr_b16 v[66:67], v26 offset:4608
  v_mfma_f32_16x16x32_bf16 v[156:159], v[108:111], v[84:87], v[156:159]
  ds_read_b64_tr_b16 v[68:69], v27 offset:4096
  ds_read_b64_tr_b16 v[70:71], v27 offset:4608
  v_mfma_f32_16x16x32_bf16 v[128:131], v[112:115], v[88:91], v[128:131]
  ds_read_b64_tr_b16 v[72:73], v28 offset:4096
  ds_read_b64_tr_b16 v[74:75], v28 offset:4608
  v_mfma_f32_16x16x32_bf16 v[132:135], v[112:115], v[92:95], v[132:135]
  ds_read_b64_tr_b16 v[76:77], v29 offset:4096
  ds_read_b64_tr_b16 v[78:79], v29 offset:4608
  v_mfma_f32_16x16x32_bf16 v[136:139], v[116:119], v[88:91], v[136:139]
  v_add_u32_e64 v25, s75, v5
  v_add_u32_e64 v26, s75, v6
  v_mfma_f32_16x16x32_bf16 v[140:143], v[116:119], v[92:95], v[140:143]
  v_add_u32_e64 v27, s75, v7
  v_add_u32_e64 v28, s75, v8
  v_mfma_f32_16x16x32_bf16 v[144:147], v[120:123], v[88:91], v[144:147]
  v_add_u32_e64 v29, s75, v9
  s_add_u32 s75, s75, 24576
  v_mfma_f32_16x16x32_bf16 v[148:151], v[120:123], v[92:95], v[148:151]
  s_cmp_eq_u32 s75, 147456
  s_cselect_b32 s75, 0, s75
  s_cmp_lg_u32 s79, 0
  v_mfma_f32_16x16x32_bf16 v[152:155], v[124:127], v[88:91], v[152:155]
  v_mfma_f32_16x16x32_bf16 v[156:159], v[124:127], v[92:95], v[156:159]
  s_waitcnt lgkmcnt(0)
  s_cbranch_scc1 L_wo_loop
  v_xor_b32 v26, 32, v15
  v_xor_b32 v27, 64, v15
  v_xor_b32 v28, 96, v15
  ds_read_b64 v[160:161], v15 offset:0
  ds_read_b64 v[164:165], v26 offset:0
  ds_read_b64 v[168:169], v27 offset:0
  ds_read_b64 v[172:173], v28 offset:0
  ds_read_b64 v[162:163], v15 offset:2048
  ds_read_b64 v[166:167], v26 offset:2048
  ds_read_b64 v[170:171], v27 offset:2048
  ds_read_b64 v[174:175], v28 offset:2048
  v_mov_b32 v20, 0
  v_mov_b32 v21, 0
  v_mov_b32 v22, 0
  v_mov_b32 v23, 0
  s_mov_b32 s3, 32768
  s_mov_b32 s10, 0x3f803f80
  s_waitcnt lgkmcnt(7)
  v_lshlrev_b32 v184, 16, v160
  v_and_b32 v185, s11, v160
  v_lshlrev_b32 v186, 16, v161
  v_and_b32 v187, s11, v161
  v_pk_add_f32 v[128:129], v[128:129], v[184:185]
  v_pk_add_f32 v[130:131], v[130:131], v[186:187]
  v_cvt_pk_bf16_f32 v32, v128, v129
  v_cvt_pk_bf16_f32 v33, v130, v131
  s_waitcnt lgkmcnt(6)
  v_lshlrev_b32 v184, 16, v164
  v_and_b32 v185, s11, v164
  v_lshlrev_b32 v186, 16, v165
  v_and_b32 v187, s11, v165
  v_pk_add_f32 v[136:137], v[136:137], v[184:185]
  v_pk_add_f32 v[138:139], v[138:139], v[186:187]
  v_cvt_pk_bf16_f32 v34, v136, v137
  v_cvt_pk_bf16_f32 v35, v138, v139
  s_nop 1
  v_permlane16_swap_b32 v32, v34
  v_permlane16_swap_b32 v33, v35
  buffer_store_dwordx4 v[32:35], v12, s[44:47], 0 offen offset:0 sc1
  s_waitcnt lgkmcnt(5)
  v_lshlrev_b32 v184, 16, v168
  v_and_b32 v185, s11, v168
  v_lshlrev_b32 v186, 16, v169
  v_and_b32 v187, s11, v169
  v_pk_add_f32 v[144:145], v[144:145], v[184:185]
  v_pk_add_f32 v[146:147], v[146:147], v[186:187]
  v_cvt_pk_bf16_f32 v36, v144, v145
  v_cvt_pk_bf16_f32 v37, v146, v147
  s_waitcnt lgkmcnt(4)
  v_lshlrev_b32 v184, 16, v172
  v_and_b32 v185, s11, v172
  v_lshlrev_b32 v186, 16, v173
  v_and_b32 v187, s11, v173
  v_pk_add_f32 v[152:153], v[152:153], v[184:185]
  v_pk_add_f32 v[154:155], v[154:155], v[186:187]
  v_cvt_pk_bf16_f32 v38, v152, v153
  v_cvt_pk_bf16_f32 v39, v154, v155
  s_nop 1
  v_permlane16_swap_b32 v36, v38
  v_permlane16_swap_b32 v37, v39
  buffer_store_dwordx4 v[36:39], v12, s[44:47], 0 offen offset:1024 sc1
  s_waitcnt lgkmcnt(3)
  v_lshlrev_b32 v184, 16, v162
  v_and_b32 v185, s11, v162
  v_lshlrev_b32 v186, 16, v163
  v_and_b32 v187, s11, v163
  v_pk_add_f32 v[132:133], v[132:133], v[184:185]
  v_pk_add_f32 v[134:135], v[134:135], v[186:187]
  v_cvt_pk_bf16_f32 v40, v132, v133
  v_cvt_pk_bf16_f32 v41, v134, v135
  s_waitcnt lgkmcnt(2)
  v_lshlrev_b32 v184, 16, v166
  v_and_b32 v185, s11, v166
  v_lshlrev_b32 v186, 16, v167
  v_and_b32 v187, s11, v167
  v_pk_add_f32 v[140:141], v[140:141], v[184:185]
  v_pk_add_f32 v[142:143], v[142:143], v[186:187]
  v_cvt_pk_bf16_f32 v42, v140, v141
  v_cvt_pk_bf16_f32 v43, v142, v143
  s_nop 1
  v_permlane16_swap_b32 v40, v42
  v_permlane16_swap_b32 v41, v43
  buffer_store_dwordx4 v[40:43], v12, s[44:47], s3 offen offset:0 sc1
  s_waitcnt lgkmcnt(1)
  v_lshlrev_b32 v184, 16, v170
  v_and_b32 v185, s11, v170
  v_lshlrev_b32 v186, 16, v171
  v_and_b32 v187, s11, v171
  v_pk_add_f32 v[148:149], v[148:149], v[184:185]
  v_pk_add_f32 v[150:151], v[150:151], v[186:187]
  v_cvt_pk_bf16_f32 v44, v148, v149
  v_cvt_pk_bf16_f32 v45, v150, v151
  s_waitcnt lgkmcnt(0)
  v_lshlrev_b32 v184, 16, v174
  v_and_b32 v185, s11, v174
  v_lshlrev_b32 v186, 16, v175
  v_and_b32 v187, s11, v175
  v_pk_add_f32 v[156:157], v[156:157], v[184:185]
  v_pk_add_f32 v[158:159], v[158:159], v[186:187]
  v_cvt_pk_bf16_f32 v46, v156, v157
  v_cvt_pk_bf16_f32 v47, v158, v159
  s_nop 1
  v_permlane16_swap_b32 v44, v46
  v_permlane16_swap_b32 v45, v47
  buffer_store_dwordx4 v[44:47], v12, s[44:47], s3 offen offset:1024 sc1
  v_dot2_f32_bf16 v20, v32, s10, v20
  v_dot2_f32_bf16 v22, v32, v32, v22
  v_dot2_f32_bf16 v20, v33, s10, v20
  v_dot2_f32_bf16 v22, v33, v33, v22
  v_dot2_f32_bf16 v20, v34, s10, v20
  v_dot2_f32_bf16 v22, v34, v34, v22
  v_dot2_f32_bf16 v20, v35, s10, v20
  v_dot2_f32_bf16 v22, v35, v35, v22
  v_dot2_f32_bf16 v20, v36, s10, v20
  v_dot2_f32_bf16 v22, v36, v36, v22
  v_dot2_f32_bf16 v20, v37, s10, v20
  v_dot2_f32_bf16 v22, v37, v37, v22
  v_dot2_f32_bf16 v20, v38, s10, v20
  v_dot2_f32_bf16 v22, v38, v38, v22
  v_dot2_f32_bf16 v20, v39, s10, v20
  v_dot2_f32_bf16 v22, v39, v39, v22
  v_dot2_f32_bf16 v21, v40, s10, v21
  v_dot2_f32_bf16 v23, v40, v40, v23
  v_dot2_f32_bf16 v21, v41, s10, v21
  v_dot2_f32_bf16 v23, v41, v41, v23
  v_dot2_f32_bf16 v21, v42, s10, v21
  v_dot2_f32_bf16 v23, v42, v42, v23
  v_dot2_f32_bf16 v21, v43, s10, v21
  v_dot2_f32_bf16 v23, v43, v43, v23
  v_dot2_f32_bf16 v21, v44, s10, v21
  v_dot2_f32_bf16 v23, v44, v44, v23
  v_dot2_f32_bf16 v21, v45, s10, v21
  v_dot2_f32_bf16 v23, v45, v45, v23
  v_dot2_f32_bf16 v21, v46, s10, v21
  v_dot2_f32_bf16 v23, v46, v46, v23
  v_dot2_f32_bf16 v21, v47, s10, v21
  v_dot2_f32_bf16 v23, v47, v47, v23
  s_nop 2
  v_permlane32_swap_b32 v20, v21
  v_permlane32_swap_b32 v22, v23
  v_add_f32 v20, v20, v21
  v_add_f32 v22, v22, v23
  s_nop 1
  v_permlane16_swap_b32 v20, v22
  v_add_f32 v20, v20, v22
  buffer_store_dword v20, v18, s[56:59], 0 offen sc1
  s_waitcnt vmcnt(0)
  s_barrier
  s_add_u32 s97, s97, 1
  s_branch L_w1_body
.section .rodata,"a"
.p2align 6
.amdhsa_kernel wol0_kernel
  .amdhsa_next_free_vgpr 256
  .amdhsa_next_free_sgpr 102
  .amdhsa_accum_offset 256
  .amdhsa_group_segment_fixed_size 0
  .amdhsa_kernarg_size 88
  .amdhsa_user_sgpr_count 2
  .amdhsa_user_sgpr_kernarg_segment_ptr 1
  .amdhsa_system_sgpr_workgroup_id_x 1
  .amdhsa_float_denorm_mode_32 3
  .amdhsa_float_denorm_mode_16_64 3
.end_amdhsa_kernel
.text
L_wo_c1:
L_w1_c0:
L_w1_body:
  s_cmp_ge_u32 s2, 256
  s_cbranch_scc1 L_w1_end
  v_lshrrev_b32 v2, 6, v0
  v_and_b32 v1, 63, v0
  v_readfirstlane_b32 s70, v2
  s_and_b32 s3, s2, 7
  s_lshr_b32 s99, s2, 3
  s_and_b32 s5, s3, 1
  s_lshl_b32 s5, s5, 3
  s_and_b32 s6, s99, 7
  s_add_u32 s68, s5, s6
  s_lshr_b32 s5, s3, 1
  s_lshl_b32 s5, s5, 2
  s_lshr_b32 s6, s99, 3
  s_add_u32 s69, s5, s6
  s_cmp_lt_u32 s70, 4
  s_cbranch_scc1 L_w1_compute
L_w1_loader:
  s_add_u32 s8, s70, s69
  s_and_b32 s8, s8, 3
  s_add_u32 s9, s70, s68
  s_and_b32 s9, s9, 3
  s_lshl_b32 s76, s8, 12
  s_lshl_b32 s77, s9, 11
  s_add_u32 s77, s77, 16384
  s_lshl_b32 s11, s68, 7
  v_and_b32 v10, 7, v1
  s_lshr_b32 s10, s76, 11
  s_lshl_b32 s3, s68, 3
  s_add_u32 s10, s10, s3
  s_mul_i32 s10, s10, 32768
  v_lshl_add_u32 v4, v1, 4, s10
  v_add_u32 v5, 32768, v4
  v_lshrrev_b32 v3, 3, v1
  s_lshl_b32 s10, s9, 4
  v_add_u32 v3, s10, v3
  v_mul_u32_u24 v3, 7168, v3
  v_lshrrev_b32 v2, 3, v1
  v_and_b32 v2, 2, v2
  v_xor_b32 v2, v2, v10
  s_mul_i32 s10, s69, 448
  s_andn2_b32 s10, s10, 127
  v_add_u32 v3, s10, v3
  v_lshl_add_u32 v8, v2, 4, v3
  v_xor_b32 v2, 4, v2
  v_add_u32 v3, 57344, v3
  v_lshl_add_u32 v9, v2, 4, v3
  s_mov_b32 s75, 0
  s_add_u32 s100, s68, s69
  s_mov_b32 s101, -1
  s_add_u32 s101, s101, 1
  s_sub_u32 s73, s101, s100
  s_lshl_b32 s73, s73, 3
  s_lshr_b32 s73, 0xf0f02, s73
  s_and_b32 s73, s73, 255
  s_add_u32 s73, s73, s101
  s_and_b32 s73, s73, 15
  s_mul_i32 s74, s73, 458752
  s_lshl_b32 s73, s73, 11
  s_waitcnt lgkmcnt(0)
  s_add_u32 s36, s34, 4194304
  s_addc_u32 s37, s35, 0
  s_and_b32 s37, s37, 0xffff
  s_mov_b32 s38, 4194304
  s_mov_b32 s39, 0x00020000
  s_mov_b32 s40, s24
  s_and_b32 s41, s25, 0xffff
  s_mov_b32 s42, 7340032
  s_mov_b32 s43, 0x00020000
  s_add_u32 s56, s34, 24117248
  s_addc_u32 s57, s35, 0
  s_and_b32 s57, s57, 0xffff
  s_mov_b32 s58, 262144
  s_mov_b32 s59, 0x00020000
  s_add_u32 s64, s22, 24641536
  s_addc_u32 s65, s23, 0
  s_and_b32 s65, s65, 0xffff
  s_mov_b32 s66, 262144
  s_mov_b32 s67, 0x00020000
  s_mov_b32 s52, s26
  s_and_b32 s53, s27, 0xffff
  s_mov_b32 s54, 7168
  s_mov_b32 s55, 0x00020000
  s_mov_b32 s60, s28
  s_and_b32 s61, s29, 0xffff
  s_mov_b32 s62, 7340032
  s_mov_b32 s63, 0x00020000
  s_cmp_eq_u32 s96, 0
  s_cselect_b32 s62, s62, 0
  s_and_b32 s3, s70, 3
  s_lshl_b32 s4, s2, 2
  s_add_u32 s3, s3, s4
  s_mul_i32 s98, s3, 7168
  s_mov_b32 s88, s73
  s_add_u32 m0, s77, 0
  s_add_u32 s4, s74, 0
  buffer_load_dwordx4 v8, s[40:43], s4 offen lds
  s_add_u32 m0, s77, 1024
  s_nop 0
  buffer_load_dwordx4 v9, s[40:43], s4 offen lds
  s_add_u32 m0, s77, 8192
  s_add_u32 s4, s74, 128
  buffer_load_dwordx4 v8, s[40:43], s4 offen lds
  s_add_u32 m0, s77, 9216
  s_nop 0
  buffer_load_dwordx4 v9, s[40:43], s4 offen lds
  s_add_u32 m0, s77, 16384
  s_add_u32 s4, s74, 256
  buffer_load_dwordx4 v8, s[40:43], s4 offen lds
  s_add_u32 m0, s77, 17408
  s_nop 0
  buffer_load_dwordx4 v9, s[40:43], s4 offen lds
  s_add_u32 m0, s77, 24576
  s_add_u32 s4, s74, 384
  buffer_load_dwordx4 v8, s[40:43], s4 offen lds
  s_add_u32 m0, s77, 25600
  s_nop 0
  buffer_load_dwordx4 v9, s[40:43], s4 offen lds
  s_add_u32 s101, s101, 1
  s_sub_u32 s73, s101, s100
  s_lshl_b32 s73, s73, 3
  s_lshr_b32 s73, 0xf0f02, s73
  s_and_b32 s73, s73, 255
  s_add_u32 s73, s73, s101
  s_and_b32 s73, s73, 15
  s_mul_i32 s74, s73, 458752
  s_lshl_b32 s73, s73, 11
  s_mov_b32 s89, s73
  s_add_u32 m0, s77, 49152
  s_add_u32 s4, s74, 0
  buffer_load_dwordx4 v8, s[40:43], s4 offen lds
  s_add_u32 m0, s77, 50176
  s_nop 0
  buffer_load_dwordx4 v9, s[40:43], s4 offen lds
  s_add_u32 m0, s77, 57344
  s_add_u32 s4, s74, 128
  buffer_load_dwordx4 v8, s[40:43], s4 offen lds
  s_add_u32 m0, s77, 58368
  s_nop 0
  buffer_load_dwordx4 v9, s[40:43], s4 offen lds
  s_add_u32 m0, s77, 65536
  s_add_u32 s4, s74, 256
  buffer_load_dwordx4 v8, s[40:43], s4 offen lds
  s_add_u32 m0, s77, 66560
  s_nop 0
  buffer_load_dwordx4 v9, s[40:43], s4 offen lds
  s_add_u32 m0, s77, 73728
  s_add_u32 s4, s74, 384
  buffer_load_dwordx4 v8, s[40:43], s4 offen lds
  s_add_u32 m0, s77, 74752
  s_nop 0
  buffer_load_dwordx4 v9, s[40:43], s4 offen lds
  s_add_u32 s101, s101, 1
  s_sub_u32 s73, s101, s100
  s_lshl_b32 s73, s73, 3
  s_lshr_b32 s73, 0xf0f02, s73
  s_and_b32 s73, s73, 255
  s_add_u32 s73, s73, s101
  s_and_b32 s73, s73, 15
  s_mul_i32 s74, s73, 458752
  s_lshl_b32 s73, s73, 11
  s_mov_b32 s75, 98304
  s_add_u32 s44, s22, 24903680
  s_addc_u32 s45, s23, 0
  s_and_b32 s45, s45, 0xffff
  s_mov_b32 s46, 32768
  s_mov_b32 s47, 0x00020000
  s_lshl_b32 s3, s97, 12
  s_lshl_b32 s4, s68, 8
  s_add_u32 s3, s3, s4
  s_sub_u32 s3, s3, 4096
  v_and_b32 v2, 15, v1
  v_lshlrev_b32 v2, 2, v2
  v_mov_b32 v3, 1
  s_mov_b32 s79, 0x100000
  s_cmp_lg_u32 s70, 4
  s_barrier
  s_cbranch_scc1 L_w1_dep
  s_mov_b64 exec, 1
  buffer_store_dword v3, off, s[44:47], s87 sc1
  s_mov_b64 exec, -1
L_w1_poll:
  buffer_load_dword v3, v2, s[44:47], s3 offen sc1
  s_sub_u32 s79, s79, 1
  s_cbranch_scc1 L_w1_dep
  s_waitcnt vmcnt(0)
  v_cmp_ne_u32 vcc, 1, v3
  s_cbranch_vccnz L_w1_poll
L_w1_dep:
  s_barrier
  s_add_u32 m0, s76, 0
  s_nop 0
  buffer_load_dwordx4 v4, s[36:39], s88 offen offset:0 lds
  buffer_load_dwordx4 v4, s[36:39], s88 offen offset:1024 lds
  s_add_u32 m0, s76, 2048
  s_nop 0
  buffer_load_dwordx4 v5, s[36:39], s88 offen offset:0 lds
  buffer_load_dwordx4 v5, s[36:39], s88 offen offset:1024 lds
  s_add_u32 m0, s76, 49152
  s_nop 0
  buffer_load_dwordx4 v4, s[36:39], s89 offen offset:0 lds
  buffer_load_dwordx4 v4, s[36:39], s89 offen offset:1024 lds
  s_add_u32 m0, s76, 51200
  s_nop 0
  buffer_load_dwordx4 v5, s[36:39], s89 offen offset:0 lds
  buffer_load_dwordx4 v5, s[36:39], s89 offen offset:1024 lds
  s_waitcnt vmcnt(4)
  s_barrier
  s_mov_b32 s79, 13
L_w1_ld1:
  s_add_u32 s3, s75, s76
  s_add_u32 m0, s3, 0
  s_nop 0
  buffer_load_dwordx4 v4, s[36:39], s73 offen offset:0 lds
  buffer_load_dwordx4 v4, s[36:39], s73 offen offset:1024 lds
  s_add_u32 m0, s3, 2048
  s_nop 0
  buffer_load_dwordx4 v5, s[36:39], s73 offen offset:0 lds
  buffer_load_dwordx4 v5, s[36:39], s73 offen offset:1024 lds
  s_add_u32 s3, s75, s77
  s_add_u32 m0, s3, 0
  s_add_u32 s4, s74, 0
  buffer_load_dwordx4 v8, s[40:43], s4 offen lds
  s_add_u32 m0, s3, 1024
  s_nop 0
  buffer_load_dwordx4 v9, s[40:43], s4 offen lds
  s_add_u32 m0, s3, 8192
  s_add_u32 s4, s74, 128
  buffer_load_dwordx4 v8, s[40:43], s4 offen lds
  s_add_u32 m0, s3, 9216
  s_nop 0
  buffer_load_dwordx4 v9, s[40:43], s4 offen lds
  s_add_u32 m0, s3, 16384
  s_add_u32 s4, s74, 256
  buffer_load_dwordx4 v8, s[40:43], s4 offen lds
  s_add_u32 m0, s3, 17408
  s_nop 0
  buffer_load_dwordx4 v9, s[40:43], s4 offen lds
  s_add_u32 m0, s3, 24576
  s_add_u32 s4, s74, 384
  buffer_load_dwordx4 v8, s[40:43], s4 offen lds
  s_add_u32 m0, s3, 25600
  s_nop 0
  buffer_load_dwordx4 v9, s[40:43], s4 offen lds
  s_add_u32 s101, s101, 1
  s_sub_u32 s73, s101, s100
  s_lshl_b32 s73, s73, 3
  s_lshr_b32 s73, 0xf0f02, s73
  s_and_b32 s73, s73, 255
  s_add_u32 s73, s73, s101
  s_and_b32 s73, s73, 15
  s_mul_i32 s74, s73, 458752
  s_lshl_b32 s73, s73, 11
  s_add_u32 s75, s75, 49152
  s_cmp_eq_u32 s75, 147456
  s_cselect_b32 s75, 0, s75
  s_buffer_load_dword s84, s[60:63], s98 offset:3584
  s_buffer_load_dword s84, s[60:63], s98 offset:3648
  s_buffer_load_dword s84, s[60:63], s98 offset:3712
  s_buffer_load_dword s84, s[60:63], s98 offset:3776
  s_add_u32 s98, s98, 256
  s_waitcnt vmcnt(12)
  s_barrier
  s_sub_u32 s79, s79, 1
  s_cmp_lg_u32 s79, 0
  s_cbranch_scc1 L_w1_ld1
  s_add_u32 s3, s75, s76
  s_add_u32 m0, s3, 0
  s_nop 0
  buffer_load_dwordx4 v4, s[36:39], s73 offen offset:0 lds
  buffer_load_dwordx4 v4, s[36:39], s73 offen offset:1024 lds
  s_add_u32 m0, s3, 2048
  s_nop 0
  buffer_load_dwordx4 v5, s[36:39], s73 offen offset:0 lds
  buffer_load_dwordx4 v5, s[36:39], s73 offen offset:1024 lds
  s_add_u32 s3, s75, s77
  s_add_u32 m0, s3, 0
  s_add_u32 s4, s74, 0
  buffer_load_dwordx4 v8, s[40:43], s4 offen lds
  s_add_u32 m0, s3, 1024
  s_nop 0
  buffer_load_dwordx4 v9, s[40:43], s4 offen lds
  s_add_u32 m0, s3, 8192
  s_add_u32 s4, s74, 128
  buffer_load_dwordx4 v8, s[40:43], s4 offen lds
  s_add_u32 m0, s3, 9216
  s_nop 0
  buffer_load_dwordx4 v9, s[40:43], s4 offen lds
  s_add_u32 m0, s3, 16384
  s_add_u32 s4, s74, 256
  buffer_load_dwordx4 v8, s[40:43], s4 offen lds
  s_add_u32 m0, s3, 17408
  s_nop 0
  buffer_load_dwordx4 v9, s[40:43], s4 offen lds
  s_add_u32 m0, s3, 24576
  s_add_u32 s4, s74, 384
  buffer_load_dwordx4 v8, s[40:43], s4 offen lds
  s_add_u32 m0, s3, 25600
  s_nop 0
  buffer_load_dwordx4 v9, s[40:43], s4 offen lds
  s_add_u32 s101, s101, 1
  s_sub_u32 s73, s101, s100
  s_lshl_b32 s73, s73, 3
  s_lshr_b32 s73, 0xf0f02, s73
  s_and_b32 s73, s73, 255
  s_add_u32 s73, s73, s101
  s_and_b32 s73, s73, 15
  s_mul_i32 s74, s73, 458752
  s_lshl_b32 s73, s73, 11
  s_add_u32 s75, s75, 49152
  s_cmp_eq_u32 s75, 147456
  s_cselect_b32 s75, 0, s75
  s_buffer_load_dword s84, s[60:63], s98 offset:3584
  s_buffer_load_dword s84, s[60:63], s98 offset:3648
  s_buffer_load_dword s84, s[60:63], s98 offset:3712
  s_buffer_load_dword s84, s[60:63], s98 offset:3776
  s_add_u32 s98, s98, 256
  s_and_b32 s3, s70, 3
  s_lshl_b32 s4, s68, 7
  s_lshl_b32 s5, s3, 6
  s_add_u32 s5, s5, s4
  v_add_u32 v2, s5, v1
  s_sub_u32 s4, s4, 16
  v_and_b32 v3, 15, v1
  v_add_u32 v3, s4, v3
  v_max_i32 v3, 0, v3
  s_cmp_ge_u32 s3, 2
  s_cselect_b64 vcc, -1, 0
  v_cndmask_b32 v2, v2, v3, vcc
  v_lshlrev_b32 v2, 3, v2
  s_mov_b32 s3, 0
  buffer_load_dwordx2 v[32:33], v2, s[56:59], s3 offen
  s_add_u32 s3, s3, 16384
  buffer_load_dwordx2 v[34:35], v2, s[56:59], s3 offen
  s_add_u32 s3, s3, 16384
  buffer_load_dwordx2 v[36:37], v2, s[56:59], s3 offen
  s_add_u32 s3, s3, 16384
  buffer_load_dwordx2 v[38:39], v2, s[56:59], s3 offen
  s_add_u32 s3, s3, 16384
  buffer_load_dwordx2 v[40:41], v2, s[56:59], s3 offen
  s_add_u32 s3, s3, 16384
  buffer_load_dwordx2 v[42:43], v2, s[56:59], s3 offen
  s_add_u32 s3, s3, 16384
  buffer_load_dwordx2 v[44:45], v2, s[56:59], s3 offen
  s_add_u32 s3, s3, 16384
  buffer_load_dwordx2 v[46:47], v2, s[56:59], s3 offen
  s_add_u32 s3, s3, 16384
  buffer_load_dwordx2 v[48:49], v2, s[56:59], s3 offen
  s_add_u32 s3, s3, 16384
  buffer_load_dwordx2 v[50:51], v2, s[56:59], s3 offen
  s_add_u32 s3, s3, 16384
  buffer_load_dwordx2 v[52:53], v2, s[56:59], s3 offen
  s_add_u32 s3, s3, 16384
  buffer_load_dwordx2 v[54:55], v2, s[56:59], s3 offen
  s_add_u32 s3, s3, 16384
  buffer_load_dwordx2 v[56:57], v2, s[56:59], s3 offen
  s_add_u32 s3, s3, 16384
  buffer_load_dwordx2 v[58:59], v2, s[56:59], s3 offen
  s_add_u32 s3, s3, 16384
  buffer_load_dwordx2 v[60:61], v2, s[56:59], s3 offen
  s_add_u32 s3, s3, 16384
  buffer_load_dwordx2 v[62:63], v2, s[56:59], s3 offen
  s_mul_i32 s4, s69, 224
  s_sub_u32 s4, s4, 256
  v_add_u32 v3, s4, v0
  v_lshlrev_b32 v2, 2, v3
  v_lshlrev_b32 v3, 1, v3
  s_mov_b32 s3, 0
  buffer_load_dword v64, v2, s[64:67], s3 offen
  s_add_u32 s3, s3, 16384
  buffer_load_dword v65, v2, s[64:67], s3 offen
  s_add_u32 s3, s3, 16384
  buffer_load_dword v66, v2, s[64:67], s3 offen
  s_add_u32 s3, s3, 16384
  buffer_load_dword v67, v2, s[64:67], s3 offen
  s_add_u32 s3, s3, 16384
  buffer_load_dword v68, v2, s[64:67], s3 offen
  s_add_u32 s3, s3, 16384
  buffer_load_dword v69, v2, s[64:67], s3 offen
  s_add_u32 s3, s3, 16384
  buffer_load_dword v70, v2, s[64:67], s3 offen
  s_add_u32 s3, s3, 16384
  buffer_load_dword v71, v2, s[64:67], s3 offen
  s_add_u32 s3, s3, 16384
  buffer_load_dword v72, v2, s[64:67], s3 offen
  s_add_u32 s3, s3, 16384
  buffer_load_dword v73, v2, s[64:67], s3 offen
  s_add_u32 s3, s3, 16384
  buffer_load_dword v74, v2, s[64:67], s3 offen
  s_add_u32 s3, s3, 16384
  buffer_load_dword v75, v2, s[64:67], s3 offen
  s_add_u32 s3, s3, 16384
  buffer_load_dword v76, v2, s[64:67], s3 offen
  s_add_u32 s3, s3, 16384
  buffer_load_dword v77, v2, s[64:67], s3 offen
  s_add_u32 s3, s3, 16384
  buffer_load_dword v78, v2, s[64:67], s3 offen
  s_add_u32 s3, s3, 16384
  buffer_load_dword v79, v2, s[64:67], s3 offen
  buffer_load_ushort v80, v3, s[52:55], 0 offen
  s_waitcnt vmcnt(45)
  s_barrier
  s_waitcnt vmcnt(33)
  s_barrier
  s_waitcnt vmcnt(0)
  v_add_f32 v32, v32, v34
  v_add_f32 v33, v33, v35
  v_add_f32 v48, v48, v50
  v_add_f32 v49, v49, v51
  v_add_f32 v32, v32, v36
  v_add_f32 v33, v33, v37
  v_add_f32 v48, v48, v52
  v_add_f32 v49, v49, v53
  v_add_f32 v32, v32, v38
  v_add_f32 v33, v33, v39
  v_add_f32 v48, v48, v54
  v_add_f32 v49, v49, v55
  v_add_f32 v32, v32, v40
  v_add_f32 v33, v33, v41
  v_add_f32 v48, v48, v56
  v_add_f32 v49, v49, v57
  v_add_f32 v32, v32, v42
  v_add_f32 v33, v33, v43
  v_add_f32 v48, v48, v58
  v_add_f32 v49, v49, v59
  v_add_f32 v32, v32, v44
  v_add_f32 v33, v33, v45
  v_add_f32 v48, v48, v60
  v_add_f32 v49, v49, v61
  v_add_f32 v32, v32, v46
  v_add_f32 v33, v33, v47
  v_add_f32 v48, v48, v62
  v_add_f32 v49, v49, v63
  v_add_f32 v32, v32, v48
  v_add_f32 v33, v33, v49
  v_mul_f32 v32, 0x3a800000, v32
  v_mul_f32 v33, 0x3a800000, v33
  v_fma_f32 v33, -v32, v32, v33
  v_max_f32 v33, 0, v33
  v_add_f32 v33, 0x3727c5ac, v33
  v_rsq_f32 v33, v33
  s_nop 0
  s_and_b32 s3, s70, 3
  s_lshl_b32 s5, s3, 6
  s_add_u32 s5, s5, 16
  v_add_u32 v2, s5, v1
  v_and_b32 v3, 15, v1
  s_cmp_ge_u32 s3, 2
  s_cselect_b64 vcc, -1, 0
  v_cndmask_b32 v2, v2, v3, vcc
  v_lshlrev_b32 v2, 2, v2
  v_add_u32 v2, 147456, v2
  ds_write2_b32 v2, v32, v33 offset0:0 offset1:160
  v_add_f32 v64, v64, v72
  v_add_f32 v65, v65, v73
  v_add_f32 v66, v66, v74
  v_add_f32 v67, v67, v75
  v_add_f32 v68, v68, v76
  v_add_f32 v69, v69, v77
  v_add_f32 v70, v70, v78
  v_add_f32 v71, v71, v79
  v_add_f32 v64, v64, v68
  v_add_f32 v65, v65, v69
  v_add_f32 v66, v66, v70
  v_add_f32 v67, v67, v71
  v_add_f32 v64, v64, v65
  v_add_f32 v66, v66, v67
  v_add_f32 v64, v64, v66
  v_lshlrev_b32 v80, 16, v80
  v_lshlrev_b32 v2, 2, v0
  v_add_u32 v2, 147712, v2
  ds_write_b32 v2, v64
  ds_write_b32 v2, v80 offset:1024
  s_waitcnt lgkmcnt(0)
  s_barrier
  s_waitcnt vmcnt(0)
  s_lshl_b32 s87, s97, 12
  s_lshl_b32 s4, s68, 8
  s_add_u32 s87, s87, s4
  s_lshl_b32 s4, s69, 2
  s_add_u32 s87, s87, s4
  s_add_u32 s97, s97, 1
  s_branch L_w2_body
L_w1_end:
  s_endpgm
L_w1_compute:
  s_and_b32 s71, s70, 1
  s_lshr_b32 s72, s70, 1
  v_and_b32 v3, 15, v1
  v_lshrrev_b32 v2, 4, v1
  s_lshl_b32 s8, s71, 13
  v_lshl_add_u32 v4, v1, 4, s8
  v_bfe_u32 v13, v1, 2, 2
  v_lshl_add_u32 v13, v2, 3, v13
  v_lshlrev_b32 v13, 7, v13
  v_and_b32 v17, 3, v1
  v_lshl_add_u32 v13, v17, 3, v13
  v_bfe_u32 v17, v1, 3, 2
  v_lshl_add_u32 v13, v17, 5, v13
  s_and_b32 s8, s69, 1
  s_lshl_b32 s8, s8, 1
  s_lshl_b32 s9, s72, 3
  s_add_u32 s11, s8, s72
  s_add_u32 s8, s8, s9
  s_add_u32 s9, s8, 0
  s_and_b32 s10, s9, 3
  s_lshl_b32 s10, s10, 5
  s_lshr_b32 s9, s9, 2
  s_lshl_b32 s9, s9, 13
  s_add_u32 s9, s9, 16384
  v_xor_b32 v5, s10, v13
  v_add_u32 v5, s9, v5
  s_add_u32 s9, s8, 1
  s_and_b32 s10, s9, 3
  s_lshl_b32 s10, s10, 5
  s_lshr_b32 s9, s9, 2
  s_lshl_b32 s9, s9, 13
  s_add_u32 s9, s9, 16384
  v_xor_b32 v6, s10, v13
  v_add_u32 v6, s9, v6
  s_add_u32 s9, s8, 2
  s_and_b32 s10, s9, 3
  s_lshl_b32 s10, s10, 5
  s_lshr_b32 s9, s9, 2
  s_lshl_b32 s9, s9, 13
  s_add_u32 s9, s9, 16384
  v_xor_b32 v7, s10, v13
  v_add_u32 v7, s9, v7
  s_add_u32 s9, s8, 3
  s_and_b32 s10, s9, 3
  s_lshl_b32 s10, s10, 5
  s_lshr_b32 s9, s9, 2
  s_lshl_b32 s9, s9, 13
  s_add_u32 s9, s9, 16384
  v_xor_b32 v8, s10, v13
  v_add_u32 v8, s9, v8
  s_add_u32 s9, s11, 6
  s_and_b32 s10, s9, 3
  s_lshl_b32 s10, s10, 5
  s_lshr_b32 s9, s9, 2
  s_lshl_b32 s9, s9, 13
  s_add_u32 s9, s9, 16384
  v_xor_b32 v9, s10, v13
  v_add_u32 v9, s9, v9
  s_lshl_b32 s8, s68, 7
  s_lshl_b32 s9, s71, 6
  s_add_u32 s8, s8, s9
  s_add_u32 s8, s8, s69
  s_mul_i32 s8, s8, 7168
  v_and_b32 v16, 1, v2
  v_lshrrev_b32 v17, 1, v2
  v_lshlrev_b32 v14, 8, v17
  v_lshl_add_u32 v14, v3, 4, v14
  v_add_u32 v14, s8, v14
  s_lshl_b32 s9, s72, 12
  v_lshl_add_u32 v12, v16, 9, v14
  v_add_u32 v12, s9, v12
  v_mul_u32_u24 v16, 114688, v16
  s_lshl_b32 s9, s72, 9
  v_add3_u32 v13, v16, v14, s9
  s_lshl_b32 s9, s71, 8
  s_add_u32 s9, s9, 147520
  v_lshl_add_u32 v14, v3, 2, s9
  s_lshl_b32 s9, s72, 9
  s_add_u32 s9, s9, 148736
  v_lshl_add_u32 v15, v2, 4, s9
  s_lshl_b32 s9, s72, 6
  s_add_u32 s9, s9, 148736
  v_lshl_add_u32 v16, v2, 4, s9
  v_mov_b32 v128, 0
  v_mov_b32 v129, 0
  v_mov_b32 v130, 0
  v_mov_b32 v131, 0
  v_mov_b32 v132, 0
  v_mov_b32 v133, 0
  v_mov_b32 v134, 0
  v_mov_b32 v135, 0
  v_mov_b32 v136, 0
  v_mov_b32 v137, 0
  v_mov_b32 v138, 0
  v_mov_b32 v139, 0
  v_mov_b32 v140, 0
  v_mov_b32 v141, 0
  v_mov_b32 v142, 0
  v_mov_b32 v143, 0
  v_mov_b32 v144, 0
  v_mov_b32 v145, 0
  v_mov_b32 v146, 0
  v_mov_b32 v147, 0
  v_mov_b32 v148, 0
  v_mov_b32 v149, 0
  v_mov_b32 v150, 0
  v_mov_b32 v151, 0
  v_mov_b32 v152, 0
  v_mov_b32 v153, 0
  v_mov_b32 v154, 0
  v_mov_b32 v155, 0
  v_mov_b32 v156, 0
  v_mov_b32 v157, 0
  v_mov_b32 v158, 0
  v_mov_b32 v159, 0
  v_mov_b32 v160, 0
  v_mov_b32 v161, 0
  v_mov_b32 v162, 0
  v_mov_b32 v163, 0
  v_mov_b32 v164, 0
  v_mov_b32 v165, 0
  v_mov_b32 v166, 0
  v_mov_b32 v167, 0
  v_mov_b32 v168, 0
  v_mov_b32 v169, 0
  v_mov_b32 v170, 0
  v_mov_b32 v171, 0
  v_mov_b32 v172, 0
  v_mov_b32 v173, 0
  v_mov_b32 v174, 0
  v_mov_b32 v175, 0
  v_mov_b32 v176, 0
  v_mov_b32 v177, 0
  v_mov_b32 v178, 0
  v_mov_b32 v179, 0
  v_mov_b32 v180, 0
  v_mov_b32 v181, 0
  v_mov_b32 v182, 0
  v_mov_b32 v183, 0
  v_mov_b32 v184, 0
  v_mov_b32 v185, 0
  v_mov_b32 v186, 0
  v_mov_b32 v187, 0
  v_mov_b32 v188, 0
  v_mov_b32 v189, 0
  v_mov_b32 v190, 0
  v_mov_b32 v191, 0
  v_mov_b32 v192, 0
  v_mov_b32 v193, 0
  v_mov_b32 v194, 0
  v_mov_b32 v195, 0
  v_mov_b32 v196, 0
  v_mov_b32 v197, 0
  v_mov_b32 v198, 0
  v_mov_b32 v199, 0
  v_mov_b32 v200, 0
  v_mov_b32 v201, 0
  v_mov_b32 v202, 0
  v_mov_b32 v203, 0
  v_mov_b32 v204, 0
  v_mov_b32 v205, 0
  v_mov_b32 v206, 0
  v_mov_b32 v207, 0
  v_mov_b32 v208, 0
  v_mov_b32 v209, 0
  v_mov_b32 v210, 0
  v_mov_b32 v211, 0
  v_mov_b32 v212, 0
  v_mov_b32 v213, 0
  v_mov_b32 v214, 0
  v_mov_b32 v215, 0
  v_mov_b32 v216, 0
  v_mov_b32 v217, 0
  v_mov_b32 v218, 0
  v_mov_b32 v219, 0
  v_mov_b32 v220, 0
  v_mov_b32 v221, 0
  v_mov_b32 v222, 0
  v_mov_b32 v223, 0
  v_mov_b32 v224, 0
  v_mov_b32 v225, 0
  v_mov_b32 v226, 0
  v_mov_b32 v227, 0
  v_mov_b32 v228, 0
  v_mov_b32 v229, 0
  v_mov_b32 v230, 0
  v_mov_b32 v231, 0
  v_mov_b32 v232, 0
  v_mov_b32 v233, 0
  v_mov_b32 v234, 0
  v_mov_b32 v235, 0
  v_mov_b32 v236, 0
  v_mov_b32 v237, 0
  v_mov_b32 v238, 0
  v_mov_b32 v239, 0
  s_waitcnt lgkmcnt(0)
  s_add_u32 s44, s34, 8388608
  s_addc_u32 s45, s35, 0
  s_and_b32 s45, s45, 0xffff
  s_mov_b32 s46, 14680064
  s_mov_b32 s47, 0x00020000
  s_cmp_lg_u32 s96, 0
  s_cbranch_scc1 L_pfc3_skip
  s_getpc_b64 s[4:5]
L_pfc3:
  s_lshl_b32 s3, s99, 2
  s_add_u32 s3, s3, s70
  s_mul_i32 s3, s3, 64
  s_min_u32 s3, s3, L_w2_c1-L_w2_c0-64
  s_add_i32 s3, s3, L_w2_c0-L_pfc3
  s_ashr_i32 s6, s3, 31
  s_add_u32 s4, s4, s3
  s_addc_u32 s5, s5, s6
  s_load_dword s36, s[4:5], 0
L_pfc3_skip:
  s_mov_b32 s75, 0
  v_add_u32_e64 v20, s75, v4
  v_add_u32_e64 v21, s75, v5
  v_add_u32_e64 v22, s75, v6
  v_add_u32_e64 v23, s75, v7
  v_add_u32_e64 v24, s75, v8
  v_add_u32_e64 v25, s75, v9
  s_add_u32 s75, s75, 49152
  s_cmp_eq_u32 s75, 147456
  s_cselect_b32 s75, 0, s75
  s_mov_b32 s79, 16
  s_barrier
  s_barrier
  ds_read_b128 v[32:35], v20 offset:0
  ds_read_b128 v[36:39], v20 offset:2048
  ds_read_b128 v[40:43], v20 offset:4096
  ds_read_b128 v[44:47], v20 offset:6144
  ds_read_b64_tr_b16 v[48:49], v21 offset:0
  ds_read_b64_tr_b16 v[50:51], v21 offset:512
  ds_read_b64_tr_b16 v[52:53], v22 offset:0
  ds_read_b64_tr_b16 v[54:55], v22 offset:512
  ds_read_b64_tr_b16 v[56:57], v23 offset:0
  ds_read_b64_tr_b16 v[58:59], v23 offset:512
  ds_read_b64_tr_b16 v[60:61], v24 offset:0
  ds_read_b64_tr_b16 v[62:63], v24 offset:512
  ds_read_b64_tr_b16 v[64:65], v21 offset:8192
  ds_read_b64_tr_b16 v[66:67], v21 offset:8704
  ds_read_b64_tr_b16 v[68:69], v22 offset:8192
  ds_read_b64_tr_b16 v[70:71], v22 offset:8704
  ds_read_b64_tr_b16 v[72:73], v25 offset:0
  ds_read_b64_tr_b16 v[74:75], v25 offset:512
  s_waitcnt lgkmcnt(0)
.p2align 3
L_w1_loop:
  v_mfma_f32_16x16x32_bf16 v[128:131], v[48:51], v[32:35], v[128:131]
  ds_read_b128 v[80:83], v20 offset:1024
  v_mfma_f32_16x16x32_bf16 v[132:135], v[48:51], v[36:39], v[132:135]
  ds_read_b128 v[84:87], v20 offset:3072
  v_mfma_f32_16x16x32_bf16 v[136:139], v[48:51], v[40:43], v[136:139]
  ds_read_b128 v[88:91], v20 offset:5120
  v_mfma_f32_16x16x32_bf16 v[140:143], v[48:51], v[44:47], v[140:143]
  ds_read_b128 v[92:95], v20 offset:7168
  v_mfma_f32_16x16x32_bf16 v[144:147], v[52:55], v[32:35], v[144:147]
  ds_read_b64_tr_b16 v[96:97], v21 offset:4096
  v_mfma_f32_16x16x32_bf16 v[148:151], v[52:55], v[36:39], v[148:151]
  ds_read_b64_tr_b16 v[98:99], v21 offset:4608
  v_mfma_f32_16x16x32_bf16 v[152:155], v[52:55], v[40:43], v[152:155]
  ds_read_b64_tr_b16 v[100:101], v22 offset:4096
  v_mfma_f32_16x16x32_bf16 v[156:159], v[52:55], v[44:47], v[156:159]
  ds_read_b64_tr_b16 v[102:103], v22 offset:4608
  v_mfma_f32_16x16x32_bf16 v[160:163], v[56:59], v[32:35], v[160:163]
  ds_read_b64_tr_b16 v[104:105], v23 offset:4096
  v_mfma_f32_16x16x32_bf16 v[164:167], v[56:59], v[36:39], v[164:167]
  ds_read_b64_tr_b16 v[106:107], v23 offset:4608
  v_mfma_f32_16x16x32_bf16 v[168:171], v[56:59], v[40:43], v[168:171]
  ds_read_b64_tr_b16 v[108:109], v24 offset:4096
  v_mfma_f32_16x16x32_bf16 v[172:175], v[56:59], v[44:47], v[172:175]
  ds_read_b64_tr_b16 v[110:111], v24 offset:4608
  v_mfma_f32_16x16x32_bf16 v[176:179], v[60:63], v[32:35], v[176:179]
  ds_read_b64_tr_b16 v[112:113], v21 offset:12288
  v_mfma_f32_16x16x32_bf16 v[180:183], v[60:63], v[36:39], v[180:183]
  ds_read_b64_tr_b16 v[114:115], v21 offset:12800
  v_mfma_f32_16x16x32_bf16 v[184:187], v[60:63], v[40:43], v[184:187]
  ds_read_b64_tr_b16 v[116:117], v22 offset:12288
  v_mfma_f32_16x16x32_bf16 v[188:191], v[60:63], v[44:47], v[188:191]
  ds_read_b64_tr_b16 v[118:119], v22 offset:12800
  v_mfma_f32_16x16x32_bf16 v[192:195], v[64:67], v[32:35], v[192:195]
  ds_read_b64_tr_b16 v[120:121], v25 offset:4096
  v_mfma_f32_16x16x32_bf16 v[196:199], v[64:67], v[36:39], v[196:199]
  ds_read_b64_tr_b16 v[122:123], v25 offset:4608
  v_mfma_f32_16x16x32_bf16 v[200:203], v[64:67], v[40:43], v[200:203]
  v_add_u32_e64 v20, s75, v4
  v_mfma_f32_16x16x32_bf16 v[204:207], v[64:67], v[44:47], v[204:207]
  v_add_u32_e64 v21, s75, v5
  v_mfma_f32_16x16x32_bf16 v[208:211], v[68:71], v[32:35], v[208:211]
  v_add_u32_e64 v22, s75, v6
  v_mfma_f32_16x16x32_bf16 v[212:215], v[68:71], v[36:39], v[212:215]
  v_add_u32_e64 v23, s75, v7
  v_mfma_f32_16x16x32_bf16 v[216:219], v[68:71], v[40:43], v[216:219]
  v_add_u32_e64 v24, s75, v8
  v_mfma_f32_16x16x32_bf16 v[220:223], v[68:71], v[44:47], v[220:223]
  v_add_u32_e64 v25, s75, v9
  v_mfma_f32_16x16x32_bf16 v[224:227], v[72:75], v[32:35], v[224:227]
  s_add_u32 s75, s75, 49152
  v_mfma_f32_16x16x32_bf16 v[228:231], v[72:75], v[36:39], v[228:231]
  s_cmp_eq_u32 s75, 147456
  v_mfma_f32_16x16x32_bf16 v[232:235], v[72:75], v[40:43], v[232:235]
  s_cselect_b32 s75, 0, s75
  s_sub_u32 s79, s79, 1
  v_mfma_f32_16x16x32_bf16 v[236:239], v[72:75], v[44:47], v[236:239]
  s_waitcnt lgkmcnt(0)
  s_barrier
  v_mfma_f32_16x16x32_bf16 v[128:131], v[96:99], v[80:83], v[128:131]
  ds_read_b128 v[32:35], v20 offset:0
  v_mfma_f32_16x16x32_bf16 v[132:135], v[96:99], v[84:87], v[132:135]
  ds_read_b128 v[36:39], v20 offset:2048
  v_mfma_f32_16x16x32_bf16 v[136:139], v[96:99], v[88:91], v[136:139]
  ds_read_b128 v[40:43], v20 offset:4096
  v_mfma_f32_16x16x32_bf16 v[140:143], v[96:99], v[92:95], v[140:143]
  ds_read_b128 v[44:47], v20 offset:6144
  v_mfma_f32_16x16x32_bf16 v[144:147], v[100:103], v[80:83], v[144:147]
  ds_read_b64_tr_b16 v[48:49], v21 offset:0
  v_mfma_f32_16x16x32_bf16 v[148:151], v[100:103], v[84:87], v[148:151]
  ds_read_b64_tr_b16 v[50:51], v21 offset:512
  v_mfma_f32_16x16x32_bf16 v[152:155], v[100:103], v[88:91], v[152:155]
  ds_read_b64_tr_b16 v[52:53], v22 offset:0
  v_mfma_f32_16x16x32_bf16 v[156:159], v[100:103], v[92:95], v[156:159]
  ds_read_b64_tr_b16 v[54:55], v22 offset:512
  v_mfma_f32_16x16x32_bf16 v[160:163], v[104:107], v[80:83], v[160:163]
  ds_read_b64_tr_b16 v[56:57], v23 offset:0
  v_mfma_f32_16x16x32_bf16 v[164:167], v[104:107], v[84:87], v[164:167]
  ds_read_b64_tr_b16 v[58:59], v23 offset:512
  v_mfma_f32_16x16x32_bf16 v[168:171], v[104:107], v[88:91], v[168:171]
  ds_read_b64_tr_b16 v[60:61], v24 offset:0
  v_mfma_f32_16x16x32_bf16 v[172:175], v[104:107], v[92:95], v[172:175]
  ds_read_b64_tr_b16 v[62:63], v24 offset:512
  v_mfma_f32_16x16x32_bf16 v[176:179], v[108:111], v[80:83], v[176:179]
  ds_read_b64_tr_b16 v[64:65], v21 offset:8192
  v_mfma_f32_16x16x32_bf16 v[180:183], v[108:111], v[84:87], v[180:183]
  ds_read_b64_tr_b16 v[66:67], v21 offset:8704
  v_mfma_f32_16x16x32_bf16 v[184:187], v[108:111], v[88:91], v[184:187]
  ds_read_b64_tr_b16 v[68:69], v22 offset:8192
  v_mfma_f32_16x16x32_bf16 v[188:191], v[108:111], v[92:95], v[188:191]
  ds_read_b64_tr_b16 v[70:71], v22 offset:8704
  v_mfma_f32_16x16x32_bf16 v[192:195], v[112:115], v[80:83], v[192:195]
  ds_read_b64_tr_b16 v[72:73], v25 offset:0
  v_mfma_f32_16x16x32_bf16 v[196:199], v[112:115], v[84:87], v[196:199]
  ds_read_b64_tr_b16 v[74:75], v25 offset:512
  v_mfma_f32_16x16x32_bf16 v[200:203], v[112:115], v[88:91], v[200:203]
  s_cmp_lg_u32 s79, 0
  s_nop 0
  v_mfma_f32_16x16x32_bf16 v[204:207], v[112:115], v[92:95], v[204:207]
  v_mfma_f32_16x16x32_bf16 v[208:211], v[116:119], v[80:83], v[208:211]
  v_mfma_f32_16x16x32_bf16 v[212:215], v[116:119], v[84:87], v[212:215]
  v_mfma_f32_16x16x32_bf16 v[216:219], v[116:119], v[88:91], v[216:219]
  v_mfma_f32_16x16x32_bf16 v[220:223], v[116:119], v[92:95], v[220:223]
  v_mfma_f32_16x16x32_bf16 v[224:227], v[120:123], v[80:83], v[224:227]
  v_mfma_f32_16x16x32_bf16 v[228:231], v[120:123], v[84:87], v[228:231]
  v_mfma_f32_16x16x32_bf16 v[232:235], v[120:123], v[88:91], v[232:235]
  v_mfma_f32_16x16x32_bf16 v[236:239], v[120:123], v[92:95], v[236:239]
  s_waitcnt lgkmcnt(0)
  s_cbranch_scc1 L_w1_loop
L_w1_exit:
  ds_read2_b32 v[88:89], v14 offset0:0 offset1:160
  ds_read2_b32 v[90:91], v14 offset0:16 offset1:176
  ds_read2_b32 v[92:93], v14 offset0:32 offset1:192
  ds_read2_b32 v[94:95], v14 offset0:48 offset1:208
  ds_read_b128 v[32:35], v15 offset:0
  ds_read_b128 v[60:63], v15 offset:1024
  ds_read_b128 v[36:39], v15 offset:64
  ds_read_b128 v[64:67], v15 offset:1088
  ds_read_b128 v[40:43], v15 offset:128
  ds_read_b128 v[68:71], v15 offset:1152
  ds_read_b128 v[44:47], v15 offset:192
  ds_read_b128 v[72:75], v15 offset:1216
  ds_read_b128 v[48:51], v15 offset:256
  ds_read_b128 v[76:79], v15 offset:1280
  ds_read_b128 v[52:55], v15 offset:320
  ds_read_b128 v[80:83], v15 offset:1344
  ds_read_b128 v[56:59], v16 offset:384
  ds_read_b128 v[84:87], v16 offset:1408
  v_mov_b32 v96, 0xc0135761
  v_mov_b32 v97, 0xbdd2d3e8
  v_mov_b32 v98, 1.0
  s_waitcnt lgkmcnt(0)
  v_mul_f32 v88, v88, v89
  v_mul_f32 v90, v90, v91
  v_mul_f32 v92, v92, v93
  v_mul_f32 v94, v94, v95
  v_pk_fma_f32 v[100:101], v[32:33], v[88:89], v[60:61] op_sel:[0,0,0] op_sel_hi:[1,0,1] neg_lo:[0,1,0] neg_hi:[0,1,0]
  v_pk_fma_f32 v[102:103], v[34:35], v[88:89], v[62:63] op_sel:[0,0,0] op_sel_hi:[1,0,1] neg_lo:[0,1,0] neg_hi:[0,1,0]
  v_pk_fma_f32 v[128:129], v[128:129], v[88:89], v[100:101] op_sel:[0,1,0] op_sel_hi:[1,1,1]
  v_pk_fma_f32 v[130:131], v[130:131], v[88:89], v[102:103] op_sel:[0,1,0] op_sel_hi:[1,1,1]
  v_pk_mul_f32 v[100:101], v[128:129], v[128:129]
  v_pk_mul_f32 v[102:103], v[130:131], v[130:131]
  v_pk_fma_f32 v[100:101], v[100:101], v[96:97], v[96:97] op_sel:[0,1,0] op_sel_hi:[1,1,0]
  v_pk_fma_f32 v[102:103], v[102:103], v[96:97], v[96:97] op_sel:[0,1,0] op_sel_hi:[1,1,0]
  v_pk_mul_f32 v[100:101], v[100:101], v[128:129]
  v_pk_mul_f32 v[102:103], v[102:103], v[130:131]
  v_exp_f32 v100, v100
  v_exp_f32 v101, v101
  v_exp_f32 v102, v102
  v_exp_f32 v103, v103
  v_pk_add_f32 v[100:101], v[100:101], v[98:99] op_sel_hi:[1,0]
  v_pk_add_f32 v[102:103], v[102:103], v[98:99] op_sel_hi:[1,0]
  v_rcp_f32 v100, v100
  v_rcp_f32 v101, v101
  v_rcp_f32 v102, v102
  v_rcp_f32 v103, v103
  v_pk_mul_f32 v[128:129], v[128:129], v[100:101]
  v_pk_mul_f32 v[130:131], v[130:131], v[102:103]
  v_cvt_pk_bf16_f32 v108, v128, v129
  v_cvt_pk_bf16_f32 v109, v130, v131
  v_pk_fma_f32 v[104:105], v[36:37], v[88:89], v[64:65] op_sel:[0,0,0] op_sel_hi:[1,0,1] neg_lo:[0,1,0] neg_hi:[0,1,0]
  v_pk_fma_f32 v[106:107], v[38:39], v[88:89], v[66:67] op_sel:[0,0,0] op_sel_hi:[1,0,1] neg_lo:[0,1,0] neg_hi:[0,1,0]
  v_pk_fma_f32 v[144:145], v[144:145], v[88:89], v[104:105] op_sel:[0,1,0] op_sel_hi:[1,1,1]
  v_pk_fma_f32 v[146:147], v[146:147], v[88:89], v[106:107] op_sel:[0,1,0] op_sel_hi:[1,1,1]
  v_pk_mul_f32 v[104:105], v[144:145], v[144:145]
  v_pk_mul_f32 v[106:107], v[146:147], v[146:147]
  v_pk_fma_f32 v[104:105], v[104:105], v[96:97], v[96:97] op_sel:[0,1,0] op_sel_hi:[1,1,0]
  v_pk_fma_f32 v[106:107], v[106:107], v[96:97], v[96:97] op_sel:[0,1,0] op_sel_hi:[1,1,0]
  v_pk_mul_f32 v[104:105], v[104:105], v[144:145]
  v_pk_mul_f32 v[106:107], v[106:107], v[146:147]
  v_exp_f32 v104, v104
  v_exp_f32 v105, v105
  v_exp_f32 v106, v106
  v_exp_f32 v107, v107
  v_pk_add_f32 v[104:105], v[104:105], v[98:99] op_sel_hi:[1,0]
  v_pk_add_f32 v[106:107], v[106:107], v[98:99] op_sel_hi:[1,0]
  v_rcp_f32 v104, v104
  v_rcp_f32 v105, v105
  v_rcp_f32 v106, v106
  v_rcp_f32 v107, v107
  v_pk_mul_f32 v[144:145], v[144:145], v[104:105]
  v_pk_mul_f32 v[146:147], v[146:147], v[106:107]
  v_cvt_pk_bf16_f32 v110, v144, v145
  v_cvt_pk_bf16_f32 v111, v146, v147
  s_mov_b32 s3, 0
  s_nop 0
  v_permlane16_swap_b32 v108, v110
  v_permlane16_swap_b32 v109, v111
  buffer_store_dwordx4 v[108:111], v12, s[44:47], s3 offen sc1
  v_pk_fma_f32 v[100:101], v[40:41], v[88:89], v[68:69] op_sel:[0,0,0] op_sel_hi:[1,0,1] neg_lo:[0,1,0] neg_hi:[0,1,0]
  v_pk_fma_f32 v[102:103], v[42:43], v[88:89], v[70:71] op_sel:[0,0,0] op_sel_hi:[1,0,1] neg_lo:[0,1,0] neg_hi:[0,1,0]
  v_pk_fma_f32 v[160:161], v[160:161], v[88:89], v[100:101] op_sel:[0,1,0] op_sel_hi:[1,1,1]
  v_pk_fma_f32 v[162:163], v[162:163], v[88:89], v[102:103] op_sel:[0,1,0] op_sel_hi:[1,1,1]
  v_pk_mul_f32 v[100:101], v[160:161], v[160:161]
  v_pk_mul_f32 v[102:103], v[162:163], v[162:163]
  v_pk_fma_f32 v[100:101], v[100:101], v[96:97], v[96:97] op_sel:[0,1,0] op_sel_hi:[1,1,0]
  v_pk_fma_f32 v[102:103], v[102:103], v[96:97], v[96:97] op_sel:[0,1,0] op_sel_hi:[1,1,0]
  v_pk_mul_f32 v[100:101], v[100:101], v[160:161]
  v_pk_mul_f32 v[102:103], v[102:103], v[162:163]
  v_exp_f32 v100, v100
  v_exp_f32 v101, v101
  v_exp_f32 v102, v102
  v_exp_f32 v103, v103
  v_pk_add_f32 v[100:101], v[100:101], v[98:99] op_sel_hi:[1,0]
  v_pk_add_f32 v[102:103], v[102:103], v[98:99] op_sel_hi:[1,0]
  v_rcp_f32 v100, v100
  v_rcp_f32 v101, v101
  v_rcp_f32 v102, v102
  v_rcp_f32 v103, v103
  v_pk_mul_f32 v[160:161], v[160:161], v[100:101]
  v_pk_mul_f32 v[162:163], v[162:163], v[102:103]
  v_cvt_pk_bf16_f32 v112, v160, v161
  v_cvt_pk_bf16_f32 v113, v162, v163
  v_pk_fma_f32 v[104:105], v[44:45], v[88:89], v[72:73] op_sel:[0,0,0] op_sel_hi:[1,0,1] neg_lo:[0,1,0] neg_hi:[0,1,0]
  v_pk_fma_f32 v[106:107], v[46:47], v[88:89], v[74:75] op_sel:[0,0,0] op_sel_hi:[1,0,1] neg_lo:[0,1,0] neg_hi:[0,1,0]
  v_pk_fma_f32 v[176:177], v[176:177], v[88:89], v[104:105] op_sel:[0,1,0] op_sel_hi:[1,1,1]
  v_pk_fma_f32 v[178:179], v[178:179], v[88:89], v[106:107] op_sel:[0,1,0] op_sel_hi:[1,1,1]
  v_pk_mul_f32 v[104:105], v[176:177], v[176:177]
  v_pk_mul_f32 v[106:107], v[178:179], v[178:179]
  v_pk_fma_f32 v[104:105], v[104:105], v[96:97], v[96:97] op_sel:[0,1,0] op_sel_hi:[1,1,0]
  v_pk_fma_f32 v[106:107], v[106:107], v[96:97], v[96:97] op_sel:[0,1,0] op_sel_hi:[1,1,0]
  v_pk_mul_f32 v[104:105], v[104:105], v[176:177]
  v_pk_mul_f32 v[106:107], v[106:107], v[178:179]
  v_exp_f32 v104, v104
  v_exp_f32 v105, v105
  v_exp_f32 v106, v106
  v_exp_f32 v107, v107
  v_pk_add_f32 v[104:105], v[104:105], v[98:99] op_sel_hi:[1,0]
  v_pk_add_f32 v[106:107], v[106:107], v[98:99] op_sel_hi:[1,0]
  v_rcp_f32 v104, v104
  v_rcp_f32 v105, v105
  v_rcp_f32 v106, v106
  v_rcp_f32 v107, v107
  v_pk_mul_f32 v[176:177], v[176:177], v[104:105]
  v_pk_mul_f32 v[178:179], v[178:179], v[106:107]
  v_cvt_pk_bf16_f32 v114, v176, v177
  v_cvt_pk_bf16_f32 v115, v178, v179
  s_mov_b32 s3, 1024
  s_nop 0
  v_permlane16_swap_b32 v112, v114
  v_permlane16_swap_b32 v113, v115
  buffer_store_dwordx4 v[112:115], v12, s[44:47], s3 offen sc1
  v_pk_fma_f32 v[100:101], v[48:49], v[88:89], v[76:77] op_sel:[0,0,0] op_sel_hi:[1,0,1] neg_lo:[0,1,0] neg_hi:[0,1,0]
  v_pk_fma_f32 v[102:103], v[50:51], v[88:89], v[78:79] op_sel:[0,0,0] op_sel_hi:[1,0,1] neg_lo:[0,1,0] neg_hi:[0,1,0]
  v_pk_fma_f32 v[192:193], v[192:193], v[88:89], v[100:101] op_sel:[0,1,0] op_sel_hi:[1,1,1]
  v_pk_fma_f32 v[194:195], v[194:195], v[88:89], v[102:103] op_sel:[0,1,0] op_sel_hi:[1,1,1]
  v_pk_mul_f32 v[100:101], v[192:193], v[192:193]
  v_pk_mul_f32 v[102:103], v[194:195], v[194:195]
  v_pk_fma_f32 v[100:101], v[100:101], v[96:97], v[96:97] op_sel:[0,1,0] op_sel_hi:[1,1,0]
  v_pk_fma_f32 v[102:103], v[102:103], v[96:97], v[96:97] op_sel:[0,1,0] op_sel_hi:[1,1,0]
  v_pk_mul_f32 v[100:101], v[100:101], v[192:193]
  v_pk_mul_f32 v[102:103], v[102:103], v[194:195]
  v_exp_f32 v100, v100
  v_exp_f32 v101, v101
  v_exp_f32 v102, v102
  v_exp_f32 v103, v103
  v_pk_add_f32 v[100:101], v[100:101], v[98:99] op_sel_hi:[1,0]
  v_pk_add_f32 v[102:103], v[102:103], v[98:99] op_sel_hi:[1,0]
  v_rcp_f32 v100, v100
  v_rcp_f32 v101, v101
  v_rcp_f32 v102, v102
  v_rcp_f32 v103, v103
  v_pk_mul_f32 v[192:193], v[192:193], v[100:101]
  v_pk_mul_f32 v[194:195], v[194:195], v[102:103]
  v_cvt_pk_bf16_f32 v116, v192, v193
  v_cvt_pk_bf16_f32 v117, v194, v195
  v_pk_fma_f32 v[104:105], v[52:53], v[88:89], v[80:81] op_sel:[0,0,0] op_sel_hi:[1,0,1] neg_lo:[0,1,0] neg_hi:[0,1,0]
  v_pk_fma_f32 v[106:107], v[54:55], v[88:89], v[82:83] op_sel:[0,0,0] op_sel_hi:[1,0,1] neg_lo:[0,1,0] neg_hi:[0,1,0]
  v_pk_fma_f32 v[208:209], v[208:209], v[88:89], v[104:105] op_sel:[0,1,0] op_sel_hi:[1,1,1]
  v_pk_fma_f32 v[210:211], v[210:211], v[88:89], v[106:107] op_sel:[0,1,0] op_sel_hi:[1,1,1]
  v_pk_mul_f32 v[104:105], v[208:209], v[208:209]
  v_pk_mul_f32 v[106:107], v[210:211], v[210:211]
  v_pk_fma_f32 v[104:105], v[104:105], v[96:97], v[96:97] op_sel:[0,1,0] op_sel_hi:[1,1,0]
  v_pk_fma_f32 v[106:107], v[106:107], v[96:97], v[96:97] op_sel:[0,1,0] op_sel_hi:[1,1,0]
  v_pk_mul_f32 v[104:105], v[104:105], v[208:209]
  v_pk_mul_f32 v[106:107], v[106:107], v[210:211]
  v_exp_f32 v104, v104
  v_exp_f32 v105, v105
  v_exp_f32 v106, v106
  v_exp_f32 v107, v107
  v_pk_add_f32 v[104:105], v[104:105], v[98:99] op_sel_hi:[1,0]
  v_pk_add_f32 v[106:107], v[106:107], v[98:99] op_sel_hi:[1,0]
  v_rcp_f32 v104, v104
  v_rcp_f32 v105, v105
  v_rcp_f32 v106, v106
  v_rcp_f32 v107, v107
  v_pk_mul_f32 v[208:209], v[208:209], v[104:105]
  v_pk_mul_f32 v[210:211], v[210:211], v[106:107]
  v_cvt_pk_bf16_f32 v118, v208, v209
  v_cvt_pk_bf16_f32 v119, v210, v211
  s_mov_b32 s3, 2048
  s_nop 0
  v_permlane16_swap_b32 v116, v118
  v_permlane16_swap_b32 v117, v119
  buffer_store_dwordx4 v[116:119], v12, s[44:47], s3 offen sc1
  v_pk_fma_f32 v[100:101], v[32:33], v[90:91], v[60:61] op_sel:[0,0,0] op_sel_hi:[1,0,1] neg_lo:[0,1,0] neg_hi:[0,1,0]
  v_pk_fma_f32 v[102:103], v[34:35], v[90:91], v[62:63] op_sel:[0,0,0] op_sel_hi:[1,0,1] neg_lo:[0,1,0] neg_hi:[0,1,0]
  v_pk_fma_f32 v[132:133], v[132:133], v[90:91], v[100:101] op_sel:[0,1,0] op_sel_hi:[1,1,1]
  v_pk_fma_f32 v[134:135], v[134:135], v[90:91], v[102:103] op_sel:[0,1,0] op_sel_hi:[1,1,1]
  v_pk_mul_f32 v[100:101], v[132:133], v[132:133]
  v_pk_mul_f32 v[102:103], v[134:135], v[134:135]
  v_pk_fma_f32 v[100:101], v[100:101], v[96:97], v[96:97] op_sel:[0,1,0] op_sel_hi:[1,1,0]
  v_pk_fma_f32 v[102:103], v[102:103], v[96:97], v[96:97] op_sel:[0,1,0] op_sel_hi:[1,1,0]
  v_pk_mul_f32 v[100:101], v[100:101], v[132:133]
  v_pk_mul_f32 v[102:103], v[102:103], v[134:135]
  v_exp_f32 v100, v100
  v_exp_f32 v101, v101
  v_exp_f32 v102, v102
  v_exp_f32 v103, v103
  v_pk_add_f32 v[100:101], v[100:101], v[98:99] op_sel_hi:[1,0]
  v_pk_add_f32 v[102:103], v[102:103], v[98:99] op_sel_hi:[1,0]
  v_rcp_f32 v100, v100
  v_rcp_f32 v101, v101
  v_rcp_f32 v102, v102
  v_rcp_f32 v103, v103
  v_pk_mul_f32 v[132:133], v[132:133], v[100:101]
  v_pk_mul_f32 v[134:135], v[134:135], v[102:103]
  v_cvt_pk_bf16_f32 v120, v132, v133
  v_cvt_pk_bf16_f32 v121, v134, v135
  v_pk_fma_f32 v[104:105], v[36:37], v[90:91], v[64:65] op_sel:[0,0,0] op_sel_hi:[1,0,1] neg_lo:[0,1,0] neg_hi:[0,1,0]
  v_pk_fma_f32 v[106:107], v[38:39], v[90:91], v[66:67] op_sel:[0,0,0] op_sel_hi:[1,0,1] neg_lo:[0,1,0] neg_hi:[0,1,0]
  v_pk_fma_f32 v[148:149], v[148:149], v[90:91], v[104:105] op_sel:[0,1,0] op_sel_hi:[1,1,1]
  v_pk_fma_f32 v[150:151], v[150:151], v[90:91], v[106:107] op_sel:[0,1,0] op_sel_hi:[1,1,1]
  v_pk_mul_f32 v[104:105], v[148:149], v[148:149]
  v_pk_mul_f32 v[106:107], v[150:151], v[150:151]
  v_pk_fma_f32 v[104:105], v[104:105], v[96:97], v[96:97] op_sel:[0,1,0] op_sel_hi:[1,1,0]
  v_pk_fma_f32 v[106:107], v[106:107], v[96:97], v[96:97] op_sel:[0,1,0] op_sel_hi:[1,1,0]
  v_pk_mul_f32 v[104:105], v[104:105], v[148:149]
  v_pk_mul_f32 v[106:107], v[106:107], v[150:151]
  v_exp_f32 v104, v104
  v_exp_f32 v105, v105
  v_exp_f32 v106, v106
  v_exp_f32 v107, v107
  v_pk_add_f32 v[104:105], v[104:105], v[98:99] op_sel_hi:[1,0]
  v_pk_add_f32 v[106:107], v[106:107], v[98:99] op_sel_hi:[1,0]
  v_rcp_f32 v104, v104
  v_rcp_f32 v105, v105
  v_rcp_f32 v106, v106
  v_rcp_f32 v107, v107
  v_pk_mul_f32 v[148:149], v[148:149], v[104:105]
  v_pk_mul_f32 v[150:151], v[150:151], v[106:107]
  v_cvt_pk_bf16_f32 v122, v148, v149
  v_cvt_pk_bf16_f32 v123, v150, v151
  s_mov_b32 s3, 114688
  s_nop 0
  v_permlane16_swap_b32 v120, v122
  v_permlane16_swap_b32 v121, v123
  buffer_store_dwordx4 v[120:123], v12, s[44:47], s3 offen sc1
  v_pk_fma_f32 v[100:101], v[40:41], v[90:91], v[68:69] op_sel:[0,0,0] op_sel_hi:[1,0,1] neg_lo:[0,1,0] neg_hi:[0,1,0]
  v_pk_fma_f32 v[102:103], v[42:43], v[90:91], v[70:71] op_sel:[0,0,0] op_sel_hi:[1,0,1] neg_lo:[0,1,0] neg_hi:[0,1,0]
  v_pk_fma_f32 v[164:165], v[164:165], v[90:91], v[100:101] op_sel:[0,1,0] op_sel_hi:[1,1,1]
  v_pk_fma_f32 v[166:167], v[166:167], v[90:91], v[102:103] op_sel:[0,1,0] op_sel_hi:[1,1,1]
  v_pk_mul_f32 v[100:101], v[164:165], v[164:165]
  v_pk_mul_f32 v[102:103], v[166:167], v[166:167]
  v_pk_fma_f32 v[100:101], v[100:101], v[96:97], v[96:97] op_sel:[0,1,0] op_sel_hi:[1,1,0]
  v_pk_fma_f32 v[102:103], v[102:103], v[96:97], v[96:97] op_sel:[0,1,0] op_sel_hi:[1,1,0]
  v_pk_mul_f32 v[100:101], v[100:101], v[164:165]
  v_pk_mul_f32 v[102:103], v[102:103], v[166:167]
  v_exp_f32 v100, v100
  v_exp_f32 v101, v101
  v_exp_f32 v102, v102
  v_exp_f32 v103, v103
  v_pk_add_f32 v[100:101], v[100:101], v[98:99] op_sel_hi:[1,0]
  v_pk_add_f32 v[102:103], v[102:103], v[98:99] op_sel_hi:[1,0]
  v_rcp_f32 v100, v100
  v_rcp_f32 v101, v101
  v_rcp_f32 v102, v102
  v_rcp_f32 v103, v103
  v_pk_mul_f32 v[164:165], v[164:165], v[100:101]
  v_pk_mul_f32 v[166:167], v[166:167], v[102:103]
  v_cvt_pk_bf16_f32 v108, v164, v165
  v_cvt_pk_bf16_f32 v109, v166, v167
  v_pk_fma_f32 v[104:105], v[44:45], v[90:91], v[72:73] op_sel:[0,0,0] op_sel_hi:[1,0,1] neg_lo:[0,1,0] neg_hi:[0,1,0]
  v_pk_fma_f32 v[106:107], v[46:47], v[90:91], v[74:75] op_sel:[0,0,0] op_sel_hi:[1,0,1] neg_lo:[0,1,0] neg_hi:[0,1,0]
  v_pk_fma_f32 v[180:181], v[180:181], v[90:91], v[104:105] op_sel:[0,1,0] op_sel_hi:[1,1,1]
  v_pk_fma_f32 v[182:183], v[182:183], v[90:91], v[106:107] op_sel:[0,1,0] op_sel_hi:[1,1,1]
  v_pk_mul_f32 v[104:105], v[180:181], v[180:181]
  v_pk_mul_f32 v[106:107], v[182:183], v[182:183]
  v_pk_fma_f32 v[104:105], v[104:105], v[96:97], v[96:97] op_sel:[0,1,0] op_sel_hi:[1,1,0]
  v_pk_fma_f32 v[106:107], v[106:107], v[96:97], v[96:97] op_sel:[0,1,0] op_sel_hi:[1,1,0]
  v_pk_mul_f32 v[104:105], v[104:105], v[180:181]
  v_pk_mul_f32 v[106:107], v[106:107], v[182:183]
  v_exp_f32 v104, v104
  v_exp_f32 v105, v105
  v_exp_f32 v106, v106
  v_exp_f32 v107, v107
  v_pk_add_f32 v[104:105], v[104:105], v[98:99] op_sel_hi:[1,0]
  v_pk_add_f32 v[106:107], v[106:107], v[98:99] op_sel_hi:[1,0]
  v_rcp_f32 v104, v104
  v_rcp_f32 v105, v105
  v_rcp_f32 v106, v106
  v_rcp_f32 v107, v107
  v_pk_mul_f32 v[180:181], v[180:181], v[104:105]
  v_pk_mul_f32 v[182:183], v[182:183], v[106:107]
  v_cvt_pk_bf16_f32 v110, v180, v181
  v_cvt_pk_bf16_f32 v111, v182, v183
  s_mov_b32 s3, 115712
  s_nop 0
  v_permlane16_swap_b32 v108, v110
  v_permlane16_swap_b32 v109, v111
  buffer_store_dwordx4 v[108:111], v12, s[44:47], s3 offen sc1
  v_pk_fma_f32 v[100:101], v[48:49], v[90:91], v[76:77] op_sel:[0,0,0] op_sel_hi:[1,0,1] neg_lo:[0,1,0] neg_hi:[0,1,0]
  v_pk_fma_f32 v[102:103], v[50:51], v[90:91], v[78:79] op_sel:[0,0,0] op_sel_hi:[1,0,1] neg_lo:[0,1,0] neg_hi:[0,1,0]
  v_pk_fma_f32 v[196:197], v[196:197], v[90:91], v[100:101] op_sel:[0,1,0] op_sel_hi:[1,1,1]
  v_pk_fma_f32 v[198:199], v[198:199], v[90:91], v[102:103] op_sel:[0,1,0] op_sel_hi:[1,1,1]
  v_pk_mul_f32 v[100:101], v[196:197], v[196:197]
  v_pk_mul_f32 v[102:103], v[198:199], v[198:199]
  v_pk_fma_f32 v[100:101], v[100:101], v[96:97], v[96:97] op_sel:[0,1,0] op_sel_hi:[1,1,0]
  v_pk_fma_f32 v[102:103], v[102:103], v[96:97], v[96:97] op_sel:[0,1,0] op_sel_hi:[1,1,0]
  v_pk_mul_f32 v[100:101], v[100:101], v[196:197]
  v_pk_mul_f32 v[102:103], v[102:103], v[198:199]
  v_exp_f32 v100, v100
  v_exp_f32 v101, v101
  v_exp_f32 v102, v102
  v_exp_f32 v103, v103
  v_pk_add_f32 v[100:101], v[100:101], v[98:99] op_sel_hi:[1,0]
  v_pk_add_f32 v[102:103], v[102:103], v[98:99] op_sel_hi:[1,0]
  v_rcp_f32 v100, v100
  v_rcp_f32 v101, v101
  v_rcp_f32 v102, v102
  v_rcp_f32 v103, v103
  v_pk_mul_f32 v[196:197], v[196:197], v[100:101]
  v_pk_mul_f32 v[198:199], v[198:199], v[102:103]
  v_cvt_pk_bf16_f32 v112, v196, v197
  v_cvt_pk_bf16_f32 v113, v198, v199
  v_pk_fma_f32 v[104:105], v[52:53], v[90:91], v[80:81] op_sel:[0,0,0] op_sel_hi:[1,0,1] neg_lo:[0,1,0] neg_hi:[0,1,0]
  v_pk_fma_f32 v[106:107], v[54:55], v[90:91], v[82:83] op_sel:[0,0,0] op_sel_hi:[1,0,1] neg_lo:[0,1,0] neg_hi:[0,1,0]
  v_pk_fma_f32 v[212:213], v[212:213], v[90:91], v[104:105] op_sel:[0,1,0] op_sel_hi:[1,1,1]
  v_pk_fma_f32 v[214:215], v[214:215], v[90:91], v[106:107] op_sel:[0,1,0] op_sel_hi:[1,1,1]
  v_pk_mul_f32 v[104:105], v[212:213], v[212:213]
  v_pk_mul_f32 v[106:107], v[214:215], v[214:215]
  v_pk_fma_f32 v[104:105], v[104:105], v[96:97], v[96:97] op_sel:[0,1,0] op_sel_hi:[1,1,0]
  v_pk_fma_f32 v[106:107], v[106:107], v[96:97], v[96:97] op_sel:[0,1,0] op_sel_hi:[1,1,0]
  v_pk_mul_f32 v[104:105], v[104:105], v[212:213]
  v_pk_mul_f32 v[106:107], v[106:107], v[214:215]
  v_exp_f32 v104, v104
  v_exp_f32 v105, v105
  v_exp_f32 v106, v106
  v_exp_f32 v107, v107
  v_pk_add_f32 v[104:105], v[104:105], v[98:99] op_sel_hi:[1,0]
  v_pk_add_f32 v[106:107], v[106:107], v[98:99] op_sel_hi:[1,0]
  v_rcp_f32 v104, v104
  v_rcp_f32 v105, v105
  v_rcp_f32 v106, v106
  v_rcp_f32 v107, v107
  v_pk_mul_f32 v[212:213], v[212:213], v[104:105]
  v_pk_mul_f32 v[214:215], v[214:215], v[106:107]
  v_cvt_pk_bf16_f32 v114, v212, v213
  v_cvt_pk_bf16_f32 v115, v214, v215
  s_mov_b32 s3, 116736
  s_nop 0
  v_permlane16_swap_b32 v112, v114
  v_permlane16_swap_b32 v113, v115
  buffer_store_dwordx4 v[112:115], v12, s[44:47], s3 offen sc1
  v_pk_fma_f32 v[100:101], v[56:57], v[88:89], v[84:85] op_sel:[0,0,0] op_sel_hi:[1,0,1] neg_lo:[0,1,0] neg_hi:[0,1,0]
  v_pk_fma_f32 v[102:103], v[58:59], v[88:89], v[86:87] op_sel:[0,0,0] op_sel_hi:[1,0,1] neg_lo:[0,1,0] neg_hi:[0,1,0]
  v_pk_fma_f32 v[224:225], v[224:225], v[88:89], v[100:101] op_sel:[0,1,0] op_sel_hi:[1,1,1]
  v_pk_fma_f32 v[226:227], v[226:227], v[88:89], v[102:103] op_sel:[0,1,0] op_sel_hi:[1,1,1]
  v_pk_mul_f32 v[100:101], v[224:225], v[224:225]
  v_pk_mul_f32 v[102:103], v[226:227], v[226:227]
  v_pk_fma_f32 v[100:101], v[100:101], v[96:97], v[96:97] op_sel:[0,1,0] op_sel_hi:[1,1,0]
  v_pk_fma_f32 v[102:103], v[102:103], v[96:97], v[96:97] op_sel:[0,1,0] op_sel_hi:[1,1,0]
  v_pk_mul_f32 v[100:101], v[100:101], v[224:225]
  v_pk_mul_f32 v[102:103], v[102:103], v[226:227]
  v_exp_f32 v100, v100
  v_exp_f32 v101, v101
  v_exp_f32 v102, v102
  v_exp_f32 v103, v103
  v_pk_add_f32 v[100:101], v[100:101], v[98:99] op_sel_hi:[1,0]
  v_pk_add_f32 v[102:103], v[102:103], v[98:99] op_sel_hi:[1,0]
  v_rcp_f32 v100, v100
  v_rcp_f32 v101, v101
  v_rcp_f32 v102, v102
  v_rcp_f32 v103, v103
  v_pk_mul_f32 v[224:225], v[224:225], v[100:101]
  v_pk_mul_f32 v[226:227], v[226:227], v[102:103]
  v_cvt_pk_bf16_f32 v116, v224, v225
  v_cvt_pk_bf16_f32 v117, v226, v227
  v_pk_fma_f32 v[100:101], v[56:57], v[90:91], v[84:85] op_sel:[0,0,0] op_sel_hi:[1,0,1] neg_lo:[0,1,0] neg_hi:[0,1,0]
  v_pk_fma_f32 v[102:103], v[58:59], v[90:91], v[86:87] op_sel:[0,0,0] op_sel_hi:[1,0,1] neg_lo:[0,1,0] neg_hi:[0,1,0]
  v_pk_fma_f32 v[228:229], v[228:229], v[90:91], v[100:101] op_sel:[0,1,0] op_sel_hi:[1,1,1]
  v_pk_fma_f32 v[230:231], v[230:231], v[90:91], v[102:103] op_sel:[0,1,0] op_sel_hi:[1,1,1]
  v_pk_mul_f32 v[100:101], v[228:229], v[228:229]
  v_pk_mul_f32 v[102:103], v[230:231], v[230:231]
  v_pk_fma_f32 v[100:101], v[100:101], v[96:97], v[96:97] op_sel:[0,1,0] op_sel_hi:[1,1,0]
  v_pk_fma_f32 v[102:103], v[102:103], v[96:97], v[96:97] op_sel:[0,1,0] op_sel_hi:[1,1,0]
  v_pk_mul_f32 v[100:101], v[100:101], v[228:229]
  v_pk_mul_f32 v[102:103], v[102:103], v[230:231]
  v_exp_f32 v100, v100
  v_exp_f32 v101, v101
  v_exp_f32 v102, v102
  v_exp_f32 v103, v103
  v_pk_add_f32 v[100:101], v[100:101], v[98:99] op_sel_hi:[1,0]
  v_pk_add_f32 v[102:103], v[102:103], v[98:99] op_sel_hi:[1,0]
  v_rcp_f32 v100, v100
  v_rcp_f32 v101, v101
  v_rcp_f32 v102, v102
  v_rcp_f32 v103, v103
  v_pk_mul_f32 v[228:229], v[228:229], v[100:101]
  v_pk_mul_f32 v[230:231], v[230:231], v[102:103]
  v_cvt_pk_bf16_f32 v118, v228, v229
  v_cvt_pk_bf16_f32 v119, v230, v231
  s_mov_b32 s3, 3072
  s_nop 0
  v_permlane16_swap_b32 v116, v118
  v_permlane16_swap_b32 v117, v119
  buffer_store_dwordx4 v[116:119], v13, s[44:47], s3 offen sc1
  v_pk_fma_f32 v[100:101], v[32:33], v[92:93], v[60:61] op_sel:[0,0,0] op_sel_hi:[1,0,1] neg_lo:[0,1,0] neg_hi:[0,1,0]
  v_pk_fma_f32 v[102:103], v[34:35], v[92:93], v[62:63] op_sel:[0,0,0] op_sel_hi:[1,0,1] neg_lo:[0,1,0] neg_hi:[0,1,0]
  v_pk_fma_f32 v[136:137], v[136:137], v[92:93], v[100:101] op_sel:[0,1,0] op_sel_hi:[1,1,1]
  v_pk_fma_f32 v[138:139], v[138:139], v[92:93], v[102:103] op_sel:[0,1,0] op_sel_hi:[1,1,1]
  v_pk_mul_f32 v[100:101], v[136:137], v[136:137]
  v_pk_mul_f32 v[102:103], v[138:139], v[138:139]
  v_pk_fma_f32 v[100:101], v[100:101], v[96:97], v[96:97] op_sel:[0,1,0] op_sel_hi:[1,1,0]
  v_pk_fma_f32 v[102:103], v[102:103], v[96:97], v[96:97] op_sel:[0,1,0] op_sel_hi:[1,1,0]
  v_pk_mul_f32 v[100:101], v[100:101], v[136:137]
  v_pk_mul_f32 v[102:103], v[102:103], v[138:139]
  v_exp_f32 v100, v100
  v_exp_f32 v101, v101
  v_exp_f32 v102, v102
  v_exp_f32 v103, v103
  v_pk_add_f32 v[100:101], v[100:101], v[98:99] op_sel_hi:[1,0]
  v_pk_add_f32 v[102:103], v[102:103], v[98:99] op_sel_hi:[1,0]
  v_rcp_f32 v100, v100
  v_rcp_f32 v101, v101
  v_rcp_f32 v102, v102
  v_rcp_f32 v103, v103
  v_pk_mul_f32 v[136:137], v[136:137], v[100:101]
  v_pk_mul_f32 v[138:139], v[138:139], v[102:103]
  v_cvt_pk_bf16_f32 v120, v136, v137
  v_cvt_pk_bf16_f32 v121, v138, v139
  v_pk_fma_f32 v[104:105], v[36:37], v[92:93], v[64:65] op_sel:[0,0,0] op_sel_hi:[1,0,1] neg_lo:[0,1,0] neg_hi:[0,1,0]
  v_pk_fma_f32 v[106:107], v[38:39], v[92:93], v[66:67] op_sel:[0,0,0] op_sel_hi:[1,0,1] neg_lo:[0,1,0] neg_hi:[0,1,0]
  v_pk_fma_f32 v[152:153], v[152:153], v[92:93], v[104:105] op_sel:[0,1,0] op_sel_hi:[1,1,1]
  v_pk_fma_f32 v[154:155], v[154:155], v[92:93], v[106:107] op_sel:[0,1,0] op_sel_hi:[1,1,1]
  v_pk_mul_f32 v[104:105], v[152:153], v[152:153]
  v_pk_mul_f32 v[106:107], v[154:155], v[154:155]
  v_pk_fma_f32 v[104:105], v[104:105], v[96:97], v[96:97] op_sel:[0,1,0] op_sel_hi:[1,1,0]
  v_pk_fma_f32 v[106:107], v[106:107], v[96:97], v[96:97] op_sel:[0,1,0] op_sel_hi:[1,1,0]
  v_pk_mul_f32 v[104:105], v[104:105], v[152:153]
  v_pk_mul_f32 v[106:107], v[106:107], v[154:155]
  v_exp_f32 v104, v104
  v_exp_f32 v105, v105
  v_exp_f32 v106, v106
  v_exp_f32 v107, v107
  v_pk_add_f32 v[104:105], v[104:105], v[98:99] op_sel_hi:[1,0]
  v_pk_add_f32 v[106:107], v[106:107], v[98:99] op_sel_hi:[1,0]
  v_rcp_f32 v104, v104
  v_rcp_f32 v105, v105
  v_rcp_f32 v106, v106
  v_rcp_f32 v107, v107
  v_pk_mul_f32 v[152:153], v[152:153], v[104:105]
  v_pk_mul_f32 v[154:155], v[154:155], v[106:107]
  v_cvt_pk_bf16_f32 v122, v152, v153
  v_cvt_pk_bf16_f32 v123, v154, v155
  s_mov_b32 s3, 229376
  s_nop 0
  v_permlane16_swap_b32 v120, v122
  v_permlane16_swap_b32 v121, v123
  buffer_store_dwordx4 v[120:123], v12, s[44:47], s3 offen sc1
  v_pk_fma_f32 v[100:101], v[40:41], v[92:93], v[68:69] op_sel:[0,0,0] op_sel_hi:[1,0,1] neg_lo:[0,1,0] neg_hi:[0,1,0]
  v_pk_fma_f32 v[102:103], v[42:43], v[92:93], v[70:71] op_sel:[0,0,0] op_sel_hi:[1,0,1] neg_lo:[0,1,0] neg_hi:[0,1,0]
  v_pk_fma_f32 v[168:169], v[168:169], v[92:93], v[100:101] op_sel:[0,1,0] op_sel_hi:[1,1,1]
  v_pk_fma_f32 v[170:171], v[170:171], v[92:93], v[102:103] op_sel:[0,1,0] op_sel_hi:[1,1,1]
  v_pk_mul_f32 v[100:101], v[168:169], v[168:169]
  v_pk_mul_f32 v[102:103], v[170:171], v[170:171]
  v_pk_fma_f32 v[100:101], v[100:101], v[96:97], v[96:97] op_sel:[0,1,0] op_sel_hi:[1,1,0]
  v_pk_fma_f32 v[102:103], v[102:103], v[96:97], v[96:97] op_sel:[0,1,0] op_sel_hi:[1,1,0]
  v_pk_mul_f32 v[100:101], v[100:101], v[168:169]
  v_pk_mul_f32 v[102:103], v[102:103], v[170:171]
  v_exp_f32 v100, v100
  v_exp_f32 v101, v101
  v_exp_f32 v102, v102
  v_exp_f32 v103, v103
  v_pk_add_f32 v[100:101], v[100:101], v[98:99] op_sel_hi:[1,0]
  v_pk_add_f32 v[102:103], v[102:103], v[98:99] op_sel_hi:[1,0]
  v_rcp_f32 v100, v100
  v_rcp_f32 v101, v101
  v_rcp_f32 v102, v102
  v_rcp_f32 v103, v103
  v_pk_mul_f32 v[168:169], v[168:169], v[100:101]
  v_pk_mul_f32 v[170:171], v[170:171], v[102:103]
  v_cvt_pk_bf16_f32 v108, v168, v169
  v_cvt_pk_bf16_f32 v109, v170, v171
  v_pk_fma_f32 v[104:105], v[44:45], v[92:93], v[72:73] op_sel:[0,0,0] op_sel_hi:[1,0,1] neg_lo:[0,1,0] neg_hi:[0,1,0]
  v_pk_fma_f32 v[106:107], v[46:47], v[92:93], v[74:75] op_sel:[0,0,0] op_sel_hi:[1,0,1] neg_lo:[0,1,0] neg_hi:[0,1,0]
  v_pk_fma_f32 v[184:185], v[184:185], v[92:93], v[104:105] op_sel:[0,1,0] op_sel_hi:[1,1,1]
  v_pk_fma_f32 v[186:187], v[186:187], v[92:93], v[106:107] op_sel:[0,1,0] op_sel_hi:[1,1,1]
  v_pk_mul_f32 v[104:105], v[184:185], v[184:185]
  v_pk_mul_f32 v[106:107], v[186:187], v[186:187]
  v_pk_fma_f32 v[104:105], v[104:105], v[96:97], v[96:97] op_sel:[0,1,0] op_sel_hi:[1,1,0]
  v_pk_fma_f32 v[106:107], v[106:107], v[96:97], v[96:97] op_sel:[0,1,0] op_sel_hi:[1,1,0]
  v_pk_mul_f32 v[104:105], v[104:105], v[184:185]
  v_pk_mul_f32 v[106:107], v[106:107], v[186:187]
  v_exp_f32 v104, v104
  v_exp_f32 v105, v105
  v_exp_f32 v106, v106
  v_exp_f32 v107, v107
  v_pk_add_f32 v[104:105], v[104:105], v[98:99] op_sel_hi:[1,0]
  v_pk_add_f32 v[106:107], v[106:107], v[98:99] op_sel_hi:[1,0]
  v_rcp_f32 v104, v104
  v_rcp_f32 v105, v105
  v_rcp_f32 v106, v106
  v_rcp_f32 v107, v107
  v_pk_mul_f32 v[184:185], v[184:185], v[104:105]
  v_pk_mul_f32 v[186:187], v[186:187], v[106:107]
  v_cvt_pk_bf16_f32 v110, v184, v185
  v_cvt_pk_bf16_f32 v111, v186, v187
  s_mov_b32 s3, 230400
  s_nop 0
  v_permlane16_swap_b32 v108, v110
  v_permlane16_swap_b32 v109, v111
  buffer_store_dwordx4 v[108:111], v12, s[44:47], s3 offen sc1
  v_pk_fma_f32 v[100:101], v[48:49], v[92:93], v[76:77] op_sel:[0,0,0] op_sel_hi:[1,0,1] neg_lo:[0,1,0] neg_hi:[0,1,0]
  v_pk_fma_f32 v[102:103], v[50:51], v[92:93], v[78:79] op_sel:[0,0,0] op_sel_hi:[1,0,1] neg_lo:[0,1,0] neg_hi:[0,1,0]
  v_pk_fma_f32 v[200:201], v[200:201], v[92:93], v[100:101] op_sel:[0,1,0] op_sel_hi:[1,1,1]
  v_pk_fma_f32 v[202:203], v[202:203], v[92:93], v[102:103] op_sel:[0,1,0] op_sel_hi:[1,1,1]
  v_pk_mul_f32 v[100:101], v[200:201], v[200:201]
  v_pk_mul_f32 v[102:103], v[202:203], v[202:203]
  v_pk_fma_f32 v[100:101], v[100:101], v[96:97], v[96:97] op_sel:[0,1,0] op_sel_hi:[1,1,0]
  v_pk_fma_f32 v[102:103], v[102:103], v[96:97], v[96:97] op_sel:[0,1,0] op_sel_hi:[1,1,0]
  v_pk_mul_f32 v[100:101], v[100:101], v[200:201]
  v_pk_mul_f32 v[102:103], v[102:103], v[202:203]
  v_exp_f32 v100, v100
  v_exp_f32 v101, v101
  v_exp_f32 v102, v102
  v_exp_f32 v103, v103
  v_pk_add_f32 v[100:101], v[100:101], v[98:99] op_sel_hi:[1,0]
  v_pk_add_f32 v[102:103], v[102:103], v[98:99] op_sel_hi:[1,0]
  v_rcp_f32 v100, v100
  v_rcp_f32 v101, v101
  v_rcp_f32 v102, v102
  v_rcp_f32 v103, v103
  v_pk_mul_f32 v[200:201], v[200:201], v[100:101]
  v_pk_mul_f32 v[202:203], v[202:203], v[102:103]
  v_cvt_pk_bf16_f32 v112, v200, v201
  v_cvt_pk_bf16_f32 v113, v202, v203
  v_pk_fma_f32 v[104:105], v[52:53], v[92:93], v[80:81] op_sel:[0,0,0] op_sel_hi:[1,0,1] neg_lo:[0,1,0] neg_hi:[0,1,0]
  v_pk_fma_f32 v[106:107], v[54:55], v[92:93], v[82:83] op_sel:[0,0,0] op_sel_hi:[1,0,1] neg_lo:[0,1,0] neg_hi:[0,1,0]
  v_pk_fma_f32 v[216:217], v[216:217], v[92:93], v[104:105] op_sel:[0,1,0] op_sel_hi:[1,1,1]
  v_pk_fma_f32 v[218:219], v[218:219], v[92:93], v[106:107] op_sel:[0,1,0] op_sel_hi:[1,1,1]
  v_pk_mul_f32 v[104:105], v[216:217], v[216:217]
  v_pk_mul_f32 v[106:107], v[218:219], v[218:219]
  v_pk_fma_f32 v[104:105], v[104:105], v[96:97], v[96:97] op_sel:[0,1,0] op_sel_hi:[1,1,0]
  v_pk_fma_f32 v[106:107], v[106:107], v[96:97], v[96:97] op_sel:[0,1,0] op_sel_hi:[1,1,0]
  v_pk_mul_f32 v[104:105], v[104:105], v[216:217]
  v_pk_mul_f32 v[106:107], v[106:107], v[218:219]
  v_exp_f32 v104, v104
  v_exp_f32 v105, v105
  v_exp_f32 v106, v106
  v_exp_f32 v107, v107
  v_pk_add_f32 v[104:105], v[104:105], v[98:99] op_sel_hi:[1,0]
  v_pk_add_f32 v[106:107], v[106:107], v[98:99] op_sel_hi:[1,0]
  v_rcp_f32 v104, v104
  v_rcp_f32 v105, v105
  v_rcp_f32 v106, v106
  v_rcp_f32 v107, v107
  v_pk_mul_f32 v[216:217], v[216:217], v[104:105]
  v_pk_mul_f32 v[218:219], v[218:219], v[106:107]
  v_cvt_pk_bf16_f32 v114, v216, v217
  v_cvt_pk_bf16_f32 v115, v218, v219
  s_mov_b32 s3, 231424
  s_nop 0
  v_permlane16_swap_b32 v112, v114
  v_permlane16_swap_b32 v113, v115
  buffer_store_dwordx4 v[112:115], v12, s[44:47], s3 offen sc1
  v_pk_fma_f32 v[100:101], v[32:33], v[94:95], v[60:61] op_sel:[0,0,0] op_sel_hi:[1,0,1] neg_lo:[0,1,0] neg_hi:[0,1,0]
  v_pk_fma_f32 v[102:103], v[34:35], v[94:95], v[62:63] op_sel:[0,0,0] op_sel_hi:[1,0,1] neg_lo:[0,1,0] neg_hi:[0,1,0]
  v_pk_fma_f32 v[140:141], v[140:141], v[94:95], v[100:101] op_sel:[0,1,0] op_sel_hi:[1,1,1]
  v_pk_fma_f32 v[142:143], v[142:143], v[94:95], v[102:103] op_sel:[0,1,0] op_sel_hi:[1,1,1]
  v_pk_mul_f32 v[100:101], v[140:141], v[140:141]
  v_pk_mul_f32 v[102:103], v[142:143], v[142:143]
  v_pk_fma_f32 v[100:101], v[100:101], v[96:97], v[96:97] op_sel:[0,1,0] op_sel_hi:[1,1,0]
  v_pk_fma_f32 v[102:103], v[102:103], v[96:97], v[96:97] op_sel:[0,1,0] op_sel_hi:[1,1,0]
  v_pk_mul_f32 v[100:101], v[100:101], v[140:141]
  v_pk_mul_f32 v[102:103], v[102:103], v[142:143]
  v_exp_f32 v100, v100
  v_exp_f32 v101, v101
  v_exp_f32 v102, v102
  v_exp_f32 v103, v103
  v_pk_add_f32 v[100:101], v[100:101], v[98:99] op_sel_hi:[1,0]
  v_pk_add_f32 v[102:103], v[102:103], v[98:99] op_sel_hi:[1,0]
  v_rcp_f32 v100, v100
  v_rcp_f32 v101, v101
  v_rcp_f32 v102, v102
  v_rcp_f32 v103, v103
  v_pk_mul_f32 v[140:141], v[140:141], v[100:101]
  v_pk_mul_f32 v[142:143], v[142:143], v[102:103]
  v_cvt_pk_bf16_f32 v116, v140, v141
  v_cvt_pk_bf16_f32 v117, v142, v143
  v_pk_fma_f32 v[104:105], v[36:37], v[94:95], v[64:65] op_sel:[0,0,0] op_sel_hi:[1,0,1] neg_lo:[0,1,0] neg_hi:[0,1,0]
  v_pk_fma_f32 v[106:107], v[38:39], v[94:95], v[66:67] op_sel:[0,0,0] op_sel_hi:[1,0,1] neg_lo:[0,1,0] neg_hi:[0,1,0]
  v_pk_fma_f32 v[156:157], v[156:157], v[94:95], v[104:105] op_sel:[0,1,0] op_sel_hi:[1,1,1]
  v_pk_fma_f32 v[158:159], v[158:159], v[94:95], v[106:107] op_sel:[0,1,0] op_sel_hi:[1,1,1]
  v_pk_mul_f32 v[104:105], v[156:157], v[156:157]
  v_pk_mul_f32 v[106:107], v[158:159], v[158:159]
  v_pk_fma_f32 v[104:105], v[104:105], v[96:97], v[96:97] op_sel:[0,1,0] op_sel_hi:[1,1,0]
  v_pk_fma_f32 v[106:107], v[106:107], v[96:97], v[96:97] op_sel:[0,1,0] op_sel_hi:[1,1,0]
  v_pk_mul_f32 v[104:105], v[104:105], v[156:157]
  v_pk_mul_f32 v[106:107], v[106:107], v[158:159]
  v_exp_f32 v104, v104
  v_exp_f32 v105, v105
  v_exp_f32 v106, v106
  v_exp_f32 v107, v107
  v_pk_add_f32 v[104:105], v[104:105], v[98:99] op_sel_hi:[1,0]
  v_pk_add_f32 v[106:107], v[106:107], v[98:99] op_sel_hi:[1,0]
  v_rcp_f32 v104, v104
  v_rcp_f32 v105, v105
  v_rcp_f32 v106, v106
  v_rcp_f32 v107, v107
  v_pk_mul_f32 v[156:157], v[156:157], v[104:105]
  v_pk_mul_f32 v[158:159], v[158:159], v[106:107]
  v_cvt_pk_bf16_f32 v118, v156, v157
  v_cvt_pk_bf16_f32 v119, v158, v159
  s_mov_b32 s3, 344064
  s_nop 0
  v_permlane16_swap_b32 v116, v118
  v_permlane16_swap_b32 v117, v119
  buffer_store_dwordx4 v[116:119], v12, s[44:47], s3 offen sc1
  v_pk_fma_f32 v[100:101], v[40:41], v[94:95], v[68:69] op_sel:[0,0,0] op_sel_hi:[1,0,1] neg_lo:[0,1,0] neg_hi:[0,1,0]
  v_pk_fma_f32 v[102:103], v[42:43], v[94:95], v[70:71] op_sel:[0,0,0] op_sel_hi:[1,0,1] neg_lo:[0,1,0] neg_hi:[0,1,0]
  v_pk_fma_f32 v[172:173], v[172:173], v[94:95], v[100:101] op_sel:[0,1,0] op_sel_hi:[1,1,1]
  v_pk_fma_f32 v[174:175], v[174:175], v[94:95], v[102:103] op_sel:[0,1,0] op_sel_hi:[1,1,1]
  v_pk_mul_f32 v[100:101], v[172:173], v[172:173]
  v_pk_mul_f32 v[102:103], v[174:175], v[174:175]
  v_pk_fma_f32 v[100:101], v[100:101], v[96:97], v[96:97] op_sel:[0,1,0] op_sel_hi:[1,1,0]
  v_pk_fma_f32 v[102:103], v[102:103], v[96:97], v[96:97] op_sel:[0,1,0] op_sel_hi:[1,1,0]
  v_pk_mul_f32 v[100:101], v[100:101], v[172:173]
  v_pk_mul_f32 v[102:103], v[102:103], v[174:175]
  v_exp_f32 v100, v100
  v_exp_f32 v101, v101
  v_exp_f32 v102, v102
  v_exp_f32 v103, v103
  v_pk_add_f32 v[100:101], v[100:101], v[98:99] op_sel_hi:[1,0]
  v_pk_add_f32 v[102:103], v[102:103], v[98:99] op_sel_hi:[1,0]
  v_rcp_f32 v100, v100
  v_rcp_f32 v101, v101
  v_rcp_f32 v102, v102
  v_rcp_f32 v103, v103
  v_pk_mul_f32 v[172:173], v[172:173], v[100:101]
  v_pk_mul_f32 v[174:175], v[174:175], v[102:103]
  v_cvt_pk_bf16_f32 v120, v172, v173
  v_cvt_pk_bf16_f32 v121, v174, v175
  v_pk_fma_f32 v[104:105], v[44:45], v[94:95], v[72:73] op_sel:[0,0,0] op_sel_hi:[1,0,1] neg_lo:[0,1,0] neg_hi:[0,1,0]
  v_pk_fma_f32 v[106:107], v[46:47], v[94:95], v[74:75] op_sel:[0,0,0] op_sel_hi:[1,0,1] neg_lo:[0,1,0] neg_hi:[0,1,0]
  v_pk_fma_f32 v[188:189], v[188:189], v[94:95], v[104:105] op_sel:[0,1,0] op_sel_hi:[1,1,1]
  v_pk_fma_f32 v[190:191], v[190:191], v[94:95], v[106:107] op_sel:[0,1,0] op_sel_hi:[1,1,1]
  v_pk_mul_f32 v[104:105], v[188:189], v[188:189]
  v_pk_mul_f32 v[106:107], v[190:191], v[190:191]
  v_pk_fma_f32 v[104:105], v[104:105], v[96:97], v[96:97] op_sel:[0,1,0] op_sel_hi:[1,1,0]
  v_pk_fma_f32 v[106:107], v[106:107], v[96:97], v[96:97] op_sel:[0,1,0] op_sel_hi:[1,1,0]
  v_pk_mul_f32 v[104:105], v[104:105], v[188:189]
  v_pk_mul_f32 v[106:107], v[106:107], v[190:191]
  v_exp_f32 v104, v104
  v_exp_f32 v105, v105
  v_exp_f32 v106, v106
  v_exp_f32 v107, v107
  v_pk_add_f32 v[104:105], v[104:105], v[98:99] op_sel_hi:[1,0]
  v_pk_add_f32 v[106:107], v[106:107], v[98:99] op_sel_hi:[1,0]
  v_rcp_f32 v104, v104
  v_rcp_f32 v105, v105
  v_rcp_f32 v106, v106
  v_rcp_f32 v107, v107
  v_pk_mul_f32 v[188:189], v[188:189], v[104:105]
  v_pk_mul_f32 v[190:191], v[190:191], v[106:107]
  v_cvt_pk_bf16_f32 v122, v188, v189
  v_cvt_pk_bf16_f32 v123, v190, v191
  s_mov_b32 s3, 345088
  s_nop 0
  v_permlane16_swap_b32 v120, v122
  v_permlane16_swap_b32 v121, v123
  buffer_store_dwordx4 v[120:123], v12, s[44:47], s3 offen sc1
  v_pk_fma_f32 v[100:101], v[48:49], v[94:95], v[76:77] op_sel:[0,0,0] op_sel_hi:[1,0,1] neg_lo:[0,1,0] neg_hi:[0,1,0]
  v_pk_fma_f32 v[102:103], v[50:51], v[94:95], v[78:79] op_sel:[0,0,0] op_sel_hi:[1,0,1] neg_lo:[0,1,0] neg_hi:[0,1,0]
  v_pk_fma_f32 v[204:205], v[204:205], v[94:95], v[100:101] op_sel:[0,1,0] op_sel_hi:[1,1,1]
  v_pk_fma_f32 v[206:207], v[206:207], v[94:95], v[102:103] op_sel:[0,1,0] op_sel_hi:[1,1,1]
  v_pk_mul_f32 v[100:101], v[204:205], v[204:205]
  v_pk_mul_f32 v[102:103], v[206:207], v[206:207]
  v_pk_fma_f32 v[100:101], v[100:101], v[96:97], v[96:97] op_sel:[0,1,0] op_sel_hi:[1,1,0]
  v_pk_fma_f32 v[102:103], v[102:103], v[96:97], v[96:97] op_sel:[0,1,0] op_sel_hi:[1,1,0]
  v_pk_mul_f32 v[100:101], v[100:101], v[204:205]
  v_pk_mul_f32 v[102:103], v[102:103], v[206:207]
  v_exp_f32 v100, v100
  v_exp_f32 v101, v101
  v_exp_f32 v102, v102
  v_exp_f32 v103, v103
  v_pk_add_f32 v[100:101], v[100:101], v[98:99] op_sel_hi:[1,0]
  v_pk_add_f32 v[102:103], v[102:103], v[98:99] op_sel_hi:[1,0]
  v_rcp_f32 v100, v100
  v_rcp_f32 v101, v101
  v_rcp_f32 v102, v102
  v_rcp_f32 v103, v103
  v_pk_mul_f32 v[204:205], v[204:205], v[100:101]
  v_pk_mul_f32 v[206:207], v[206:207], v[102:103]
  v_cvt_pk_bf16_f32 v108, v204, v205
  v_cvt_pk_bf16_f32 v109, v206, v207
  v_pk_fma_f32 v[104:105], v[52:53], v[94:95], v[80:81] op_sel:[0,0,0] op_sel_hi:[1,0,1] neg_lo:[0,1,0] neg_hi:[0,1,0]
  v_pk_fma_f32 v[106:107], v[54:55], v[94:95], v[82:83] op_sel:[0,0,0] op_sel_hi:[1,0,1] neg_lo:[0,1,0] neg_hi:[0,1,0]
  v_pk_fma_f32 v[220:221], v[220:221], v[94:95], v[104:105] op_sel:[0,1,0] op_sel_hi:[1,1,1]
  v_pk_fma_f32 v[222:223], v[222:223], v[94:95], v[106:107] op_sel:[0,1,0] op_sel_hi:[1,1,1]
  v_pk_mul_f32 v[104:105], v[220:221], v[220:221]
  v_pk_mul_f32 v[106:107], v[222:223], v[222:223]
  v_pk_fma_f32 v[104:105], v[104:105], v[96:97], v[96:97] op_sel:[0,1,0] op_sel_hi:[1,1,0]
  v_pk_fma_f32 v[106:107], v[106:107], v[96:97], v[96:97] op_sel:[0,1,0] op_sel_hi:[1,1,0]
  v_pk_mul_f32 v[104:105], v[104:105], v[220:221]
  v_pk_mul_f32 v[106:107], v[106:107], v[222:223]
  v_exp_f32 v104, v104
  v_exp_f32 v105, v105
  v_exp_f32 v106, v106
  v_exp_f32 v107, v107
  v_pk_add_f32 v[104:105], v[104:105], v[98:99] op_sel_hi:[1,0]
  v_pk_add_f32 v[106:107], v[106:107], v[98:99] op_sel_hi:[1,0]
  v_rcp_f32 v104, v104
  v_rcp_f32 v105, v105
  v_rcp_f32 v106, v106
  v_rcp_f32 v107, v107
  v_pk_mul_f32 v[220:221], v[220:221], v[104:105]
  v_pk_mul_f32 v[222:223], v[222:223], v[106:107]
  v_cvt_pk_bf16_f32 v110, v220, v221
  v_cvt_pk_bf16_f32 v111, v222, v223
  s_mov_b32 s3, 346112
  s_nop 0
  v_permlane16_swap_b32 v108, v110
  v_permlane16_swap_b32 v109, v111
  buffer_store_dwordx4 v[108:111], v12, s[44:47], s3 offen sc1
  v_pk_fma_f32 v[100:101], v[56:57], v[92:93], v[84:85] op_sel:[0,0,0] op_sel_hi:[1,0,1] neg_lo:[0,1,0] neg_hi:[0,1,0]
  v_pk_fma_f32 v[102:103], v[58:59], v[92:93], v[86:87] op_sel:[0,0,0] op_sel_hi:[1,0,1] neg_lo:[0,1,0] neg_hi:[0,1,0]
  v_pk_fma_f32 v[232:233], v[232:233], v[92:93], v[100:101] op_sel:[0,1,0] op_sel_hi:[1,1,1]
  v_pk_fma_f32 v[234:235], v[234:235], v[92:93], v[102:103] op_sel:[0,1,0] op_sel_hi:[1,1,1]
  v_pk_mul_f32 v[100:101], v[232:233], v[232:233]
  v_pk_mul_f32 v[102:103], v[234:235], v[234:235]
  v_pk_fma_f32 v[100:101], v[100:101], v[96:97], v[96:97] op_sel:[0,1,0] op_sel_hi:[1,1,0]
  v_pk_fma_f32 v[102:103], v[102:103], v[96:97], v[96:97] op_sel:[0,1,0] op_sel_hi:[1,1,0]
  v_pk_mul_f32 v[100:101], v[100:101], v[232:233]
  v_pk_mul_f32 v[102:103], v[102:103], v[234:235]
  v_exp_f32 v100, v100
  v_exp_f32 v101, v101
  v_exp_f32 v102, v102
  v_exp_f32 v103, v103
  v_pk_add_f32 v[100:101], v[100:101], v[98:99] op_sel_hi:[1,0]
  v_pk_add_f32 v[102:103], v[102:103], v[98:99] op_sel_hi:[1,0]
  v_rcp_f32 v100, v100
  v_rcp_f32 v101, v101
  v_rcp_f32 v102, v102
  v_rcp_f32 v103, v103
  v_pk_mul_f32 v[232:233], v[232:233], v[100:101]
  v_pk_mul_f32 v[234:235], v[234:235], v[102:103]
  v_cvt_pk_bf16_f32 v112, v232, v233
  v_cvt_pk_bf16_f32 v113, v234, v235
  v_pk_fma_f32 v[100:101], v[56:57], v[94:95], v[84:85] op_sel:[0,0,0] op_sel_hi:[1,0,1] neg_lo:[0,1,0] neg_hi:[0,1,0]
  v_pk_fma_f32 v[102:103], v[58:59], v[94:95], v[86:87] op_sel:[0,0,0] op_sel_hi:[1,0,1] neg_lo:[0,1,0] neg_hi:[0,1,0]
  v_pk_fma_f32 v[236:237], v[236:237], v[94:95], v[100:101] op_sel:[0,1,0] op_sel_hi:[1,1,1]
  v_pk_fma_f32 v[238:239], v[238:239], v[94:95], v[102:103] op_sel:[0,1,0] op_sel_hi:[1,1,1]
  v_pk_mul_f32 v[100:101], v[236:237], v[236:237]
  v_pk_mul_f32 v[102:103], v[238:239], v[238:239]
  v_pk_fma_f32 v[100:101], v[100:101], v[96:97], v[96:97] op_sel:[0,1,0] op_sel_hi:[1,1,0]
  v_pk_fma_f32 v[102:103], v[102:103], v[96:97], v[96:97] op_sel:[0,1,0] op_sel_hi:[1,1,0]
  v_pk_mul_f32 v[100:101], v[100:101], v[236:237]
  v_pk_mul_f32 v[102:103], v[102:103], v[238:239]
  v_exp_f32 v100, v100
  v_exp_f32 v101, v101
  v_exp_f32 v102, v102
  v_exp_f32 v103, v103
  v_pk_add_f32 v[100:101], v[100:101], v[98:99] op_sel_hi:[1,0]
  v_pk_add_f32 v[102:103], v[102:103], v[98:99] op_sel_hi:[1,0]
  v_rcp_f32 v100, v100
  v_rcp_f32 v101, v101
  v_rcp_f32 v102, v102
  v_rcp_f32 v103, v103
  v_pk_mul_f32 v[236:237], v[236:237], v[100:101]
  v_pk_mul_f32 v[238:239], v[238:239], v[102:103]
  v_cvt_pk_bf16_f32 v114, v236, v237
  v_cvt_pk_bf16_f32 v115, v238, v239
  s_mov_b32 s3, 232448
  s_nop 0
  v_permlane16_swap_b32 v112, v114
  v_permlane16_swap_b32 v113, v115
  buffer_store_dwordx4 v[112:115], v13, s[44:47], s3 offen sc1
  s_waitcnt vmcnt(0)
  s_barrier
  s_add_u32 s97, s97, 1
  s_branch L_w2_body
L_w1_c1:
L_w2_c0:
L_w2_body:
  s_cmp_ge_u32 s2, 256
  s_cbranch_scc1 L_w2_end
  v_lshrrev_b32 v2, 6, v0
  v_and_b32 v1, 63, v0
  v_readfirstlane_b32 s70, v2
  s_and_b32 s3, s2, 7
  s_lshr_b32 s99, s2, 3
  s_and_b32 s5, s3, 3
  s_lshl_b32 s5, s5, 2
  s_and_b32 s6, s99, 3
  s_add_u32 s68, s5, s6
  s_lshr_b32 s5, s3, 2
  s_lshl_b32 s5, s5, 3
  s_lshr_b32 s6, s99, 2
  s_add_u32 s69, s5, s6
  s_cmp_lt_u32 s70, 4
  s_cbranch_scc1 L_w2_compute
L_w2_loader:
  s_add_u32 s8, s70, s69
  s_and_b32 s8, s8, 3
  s_add_u32 s9, s70, s68
  s_and_b32 s9, s9, 3
  s_lshl_b32 s76, s8, 12
  s_lshl_b32 s77, s9, 11
  s_add_u32 s77, s77, 16384
  s_lshl_b32 s11, s68, 7
  v_and_b32 v10, 7, v1
  s_lshr_b32 s10, s76, 11
  s_lshl_b32 s3, s68, 3
  s_add_u32 s10, s10, s3
  s_mul_i32 s10, s10, 114688
  v_lshl_add_u32 v4, v1, 4, s10
  v_add_u32 v5, 114688, v4
  v_lshrrev_b32 v3, 3, v1
  s_lshl_b32 s10, s9, 4
  v_add_u32 v3, s10, v3
  v_mul_u32_u24 v3, 2048, v3
  v_lshrrev_b32 v2, 3, v1
  v_and_b32 v2, 2, v2
  v_xor_b32 v2, v2, v10
  s_mul_i32 s10, s69, 128
  v_add_u32 v3, s10, v3
  v_lshl_add_u32 v8, v2, 4, v3
  v_xor_b32 v2, 4, v2
  v_add_u32 v3, 16384, v3
  v_lshl_add_u32 v9, v2, 4, v3
  s_mov_b32 s75, 0
  s_add_u32 s100, s68, s69
  s_mov_b32 s101, -1
  s_add_u32 s101, s101, 1
  s_sub_u32 s73, s101, s100
  s_lshl_b32 s73, s73, 3
  s_lshr_b32 s73, 0x373702, s73
  s_and_b32 s73, s73, 255
  s_add_u32 s73, s73, s101
  s_sub_u32 s74, s73, 56
  s_cselect_b32 s73, s73, s74
  s_mul_i32 s74, s73, 131072
  s_lshl_b32 s73, s73, 11
  s_waitcnt lgkmcnt(0)
  s_add_u32 s36, s34, 8388608
  s_addc_u32 s37, s35, 0
  s_and_b32 s37, s37, 0xffff
  s_mov_b32 s38, 14680064
  s_mov_b32 s39, 0x00020000
  s_mov_b32 s40, s28
  s_and_b32 s41, s29, 0xffff
  s_mov_b32 s42, 7340032
  s_mov_b32 s43, 0x00020000
  s_mov_b32 s88, s73
  s_add_u32 m0, s77, 0
  s_add_u32 s4, s74, 0
  buffer_load_dwordx4 v8, s[40:43], s4 offen lds
  s_add_u32 m0, s77, 1024
  s_nop 0
  buffer_load_dwordx4 v9, s[40:43], s4 offen lds
  s_add_u32 s101, s101, 1
  s_sub_u32 s73, s101, s100
  s_lshl_b32 s73, s73, 3
  s_lshr_b32 s73, 0x373702, s73
  s_and_b32 s73, s73, 255
  s_add_u32 s73, s73, s101
  s_sub_u32 s74, s73, 56
  s_cselect_b32 s73, s73, s74
  s_mul_i32 s74, s73, 131072
  s_lshl_b32 s73, s73, 11
  s_mov_b32 s89, s73
  s_add_u32 m0, s77, 24576
  s_add_u32 s4, s74, 0
  buffer_load_dwordx4 v8, s[40:43], s4 offen lds
  s_add_u32 m0, s77, 25600
  s_nop 0
  buffer_load_dwordx4 v9, s[40:43], s4 offen lds
  s_add_u32 s101, s101, 1
  s_sub_u32 s73, s101, s100
  s_lshl_b32 s73, s73, 3
  s_lshr_b32 s73, 0x373702, s73
  s_and_b32 s73, s73, 255
  s_add_u32 s73, s73, s101
  s_sub_u32 s74, s73, 56
  s_cselect_b32 s73, s73, s74
  s_mul_i32 s74, s73, 131072
  s_lshl_b32 s73, s73, 11
  s_mov_b32 s90, s73
  s_add_u32 m0, s77, 49152
  s_add_u32 s4, s74, 0
  buffer_load_dwordx4 v8, s[40:43], s4 offen lds
  s_add_u32 m0, s77, 50176
  s_nop 0
  buffer_load_dwordx4 v9, s[40:43], s4 offen lds
  s_add_u32 s101, s101, 1
  s_sub_u32 s73, s101, s100
  s_lshl_b32 s73, s73, 3
  s_lshr_b32 s73, 0x373702, s73
  s_and_b32 s73, s73, 255
  s_add_u32 s73, s73, s101
  s_sub_u32 s74, s73, 56
  s_cselect_b32 s73, s73, s74
  s_mul_i32 s74, s73, 131072
  s_lshl_b32 s73, s73, 11
  s_mov_b32 s91, s73
  s_add_u32 m0, s77, 73728
  s_add_u32 s4, s74, 0
  buffer_load_dwordx4 v8, s[40:43], s4 offen lds
  s_add_u32 m0, s77, 74752
  s_nop 0
  buffer_load_dwordx4 v9, s[40:43], s4 offen lds
  s_add_u32 s101, s101, 1
  s_sub_u32 s73, s101, s100
  s_lshl_b32 s73, s73, 3
  s_lshr_b32 s73, 0x373702, s73
  s_and_b32 s73, s73, 255
  s_add_u32 s73, s73, s101
  s_sub_u32 s74, s73, 56
  s_cselect_b32 s73, s73, s74
  s_mul_i32 s74, s73, 131072
  s_lshl_b32 s73, s73, 11
  s_mov_b32 s92, s73
  s_add_u32 m0, s77, 98304
  s_add_u32 s4, s74, 0
  buffer_load_dwordx4 v8, s[40:43], s4 offen lds
  s_add_u32 m0, s77, 99328
  s_nop 0
  buffer_load_dwordx4 v9, s[40:43], s4 offen lds
  s_add_u32 s101, s101, 1
  s_sub_u32 s73, s101, s100
  s_lshl_b32 s73, s73, 3
  s_lshr_b32 s73, 0x373702, s73
  s_and_b32 s73, s73, 255
  s_add_u32 s73, s73, s101
  s_sub_u32 s74, s73, 56
  s_cselect_b32 s73, s73, s74
  s_mul_i32 s74, s73, 131072
  s_lshl_b32 s73, s73, 11
  s_mov_b32 s75, 122880
  s_add_u32 s44, s22, 24903680
  s_addc_u32 s45, s23, 0
  s_and_b32 s45, s45, 0xffff
  s_mov_b32 s46, 32768
  s_mov_b32 s47, 0x00020000
  s_lshl_b32 s3, s97, 12
  s_lshl_b32 s4, s68, 8
  s_add_u32 s3, s3, s4
  s_sub_u32 s3, s3, 4096
  v_and_b32 v2, 15, v1
  v_lshlrev_b32 v2, 2, v2
  v_mov_b32 v3, 1
  s_mov_b32 s79, 0x100000
  s_cmp_lg_u32 s70, 4
  s_barrier
  s_cbranch_scc1 L_w2_dep
  s_mov_b64 exec, 1
  buffer_store_dword v3, off, s[44:47], s87 sc1
  s_mov_b64 exec, -1
L_w2_poll:
  buffer_load_dword v3, v2, s[44:47], s3 offen sc1
  s_sub_u32 s79, s79, 1
  s_cbranch_scc1 L_w2_dep
  s_waitcnt vmcnt(0)
  v_cmp_ne_u32 vcc, 1, v3
  s_cbranch_vccnz L_w2_poll
L_w2_dep:
  s_barrier
  s_add_u32 m0, s76, 0
  s_nop 0
  buffer_load_dwordx4 v4, s[36:39], s88 offen offset:0 lds
  buffer_load_dwordx4 v4, s[36:39], s88 offen offset:1024 lds
  s_add_u32 m0, s76, 2048
  s_nop 0
  buffer_load_dwordx4 v5, s[36:39], s88 offen offset:0 lds
  buffer_load_dwordx4 v5, s[36:39], s88 offen offset:1024 lds
  s_add_u32 m0, s76, 24576
  s_nop 0
  buffer_load_dwordx4 v4, s[36:39], s89 offen offset:0 lds
  buffer_load_dwordx4 v4, s[36:39], s89 offen offset:1024 lds
  s_add_u32 m0, s76, 26624
  s_nop 0
  buffer_load_dwordx4 v5, s[36:39], s89 offen offset:0 lds
  buffer_load_dwordx4 v5, s[36:39], s89 offen offset:1024 lds
  s_add_u32 m0, s76, 49152
  s_nop 0
  buffer_load_dwordx4 v4, s[36:39], s90 offen offset:0 lds
  buffer_load_dwordx4 v4, s[36:39], s90 offen offset:1024 lds
  s_add_u32 m0, s76, 51200
  s_nop 0
  buffer_load_dwordx4 v5, s[36:39], s90 offen offset:0 lds
  buffer_load_dwordx4 v5, s[36:39], s90 offen offset:1024 lds
  s_add_u32 m0, s76, 73728
  s_nop 0
  buffer_load_dwordx4 v4, s[36:39], s91 offen offset:0 lds
  buffer_load_dwordx4 v4, s[36:39], s91 offen offset:1024 lds
  s_add_u32 m0, s76, 75776
  s_nop 0
  buffer_load_dwordx4 v5, s[36:39], s91 offen offset:0 lds
  buffer_load_dwordx4 v5, s[36:39], s91 offen offset:1024 lds
  s_add_u32 m0, s76, 98304
  s_nop 0
  buffer_load_dwordx4 v4, s[36:39], s92 offen offset:0 lds
  buffer_load_dwordx4 v4, s[36:39], s92 offen offset:1024 lds
  s_add_u32 m0, s76, 100352
  s_nop 0
  buffer_load_dwordx4 v5, s[36:39], s92 offen offset:0 lds
  buffer_load_dwordx4 v5, s[36:39], s92 offen offset:1024 lds
  s_waitcnt vmcnt(16)
  s_barrier
  s_add_u32 s3, s75, s76
  s_add_u32 m0, s3, 0
  s_nop 0
  buffer_load_dwordx4 v4, s[36:39], s73 offen offset:0 lds
  buffer_load_dwordx4 v4, s[36:39], s73 offen offset:1024 lds
  s_add_u32 m0, s3, 2048
  s_nop 0
  buffer_load_dwordx4 v5, s[36:39], s73 offen offset:0 lds
  buffer_load_dwordx4 v5, s[36:39], s73 offen offset:1024 lds
  s_add_u32 s3, s75, s77
  s_add_u32 m0, s3, 0
  s_add_u32 s4, s74, 0
  buffer_load_dwordx4 v8, s[40:43], s4 offen lds
  s_add_u32 m0, s3, 1024
  s_nop 0
  buffer_load_dwordx4 v9, s[40:43], s4 offen lds
  s_add_u32 s101, s101, 1
  s_sub_u32 s73, s101, s100
  s_lshl_b32 s73, s73, 3
  s_lshr_b32 s73, 0x373702, s73
  s_and_b32 s73, s73, 255
  s_add_u32 s73, s73, s101
  s_sub_u32 s74, s73, 56
  s_cselect_b32 s73, s73, s74
  s_mul_i32 s74, s73, 131072
  s_lshl_b32 s73, s73, 11
  s_add_u32 s75, s75, 24576
  s_cmp_eq_u32 s75, 147456
  s_cselect_b32 s75, 0, s75
  s_waitcnt vmcnt(18)
  s_barrier
  s_add_u32 s3, s75, s76
  s_add_u32 m0, s3, 0
  s_nop 0
  buffer_load_dwordx4 v4, s[36:39], s73 offen offset:0 lds
  buffer_load_dwordx4 v4, s[36:39], s73 offen offset:1024 lds
  s_add_u32 m0, s3, 2048
  s_nop 0
  buffer_load_dwordx4 v5, s[36:39], s73 offen offset:0 lds
  buffer_load_dwordx4 v5, s[36:39], s73 offen offset:1024 lds
  s_add_u32 s3, s75, s77
  s_add_u32 m0, s3, 0
  s_add_u32 s4, s74, 0
  buffer_load_dwordx4 v8, s[40:43], s4 offen lds
  s_add_u32 m0, s3, 1024
  s_nop 0
  buffer_load_dwordx4 v9, s[40:43], s4 offen lds
  s_add_u32 s101, s101, 1
  s_sub_u32 s73, s101, s100
  s_lshl_b32 s73, s73, 3
  s_lshr_b32 s73, 0x373702, s73
  s_and_b32 s73, s73, 255
  s_add_u32 s73, s73, s101
  s_sub_u32 s74, s73, 56
  s_cselect_b32 s73, s73, s74
  s_mul_i32 s74, s73, 131072
  s_lshl_b32 s73, s73, 11
  s_add_u32 s75, s75, 24576
  s_cmp_eq_u32 s75, 147456
  s_cselect_b32 s75, 0, s75
  s_waitcnt vmcnt(20)
  s_barrier
  s_add_u32 s3, s75, s76
  s_add_u32 m0, s3, 0
  s_nop 0
  buffer_load_dwordx4 v4, s[36:39], s73 offen offset:0 lds
  buffer_load_dwordx4 v4, s[36:39], s73 offen offset:1024 lds
  s_add_u32 m0, s3, 2048
  s_nop 0
  buffer_load_dwordx4 v5, s[36:39], s73 offen offset:0 lds
  buffer_load_dwordx4 v5, s[36:39], s73 offen offset:1024 lds
  s_add_u32 s3, s75, s77
  s_add_u32 m0, s3, 0
  s_add_u32 s4, s74, 0
  buffer_load_dwordx4 v8, s[40:43], s4 offen lds
  s_add_u32 m0, s3, 1024
  s_nop 0
  buffer_load_dwordx4 v9, s[40:43], s4 offen lds
  s_add_u32 s101, s101, 1
  s_sub_u32 s73, s101, s100
  s_lshl_b32 s73, s73, 3
  s_lshr_b32 s73, 0x373702, s73
  s_and_b32 s73, s73, 255
  s_add_u32 s73, s73, s101
  s_sub_u32 s74, s73, 56
  s_cselect_b32 s73, s73, s74
  s_mul_i32 s74, s73, 131072
  s_lshl_b32 s73, s73, 11
  s_add_u32 s75, s75, 24576
  s_cmp_eq_u32 s75, 147456
  s_cselect_b32 s75, 0, s75
  s_waitcnt vmcnt(22)
  s_barrier
  s_mov_b32 s79, 47
L_w2l_ld1:
  s_add_u32 s3, s75, s76
  s_add_u32 m0, s3, 0
  s_nop 0
  buffer_load_dwordx4 v4, s[36:39], s73 offen offset:0 lds
  buffer_load_dwordx4 v4, s[36:39], s73 offen offset:1024 lds
  s_add_u32 m0, s3, 2048
  s_nop 0
  buffer_load_dwordx4 v5, s[36:39], s73 offen offset:0 lds
  buffer_load_dwordx4 v5, s[36:39], s73 offen offset:1024 lds
  s_add_u32 s3, s75, s77
  s_add_u32 m0, s3, 0
  s_add_u32 s4, s74, 0
  buffer_load_dwordx4 v8, s[40:43], s4 offen lds
  s_add_u32 m0, s3, 1024
  s_nop 0
  buffer_load_dwordx4 v9, s[40:43], s4 offen lds
  s_add_u32 s101, s101, 1
  s_sub_u32 s73, s101, s100
  s_lshl_b32 s73, s73, 3
  s_lshr_b32 s73, 0x373702, s73
  s_and_b32 s73, s73, 255
  s_add_u32 s73, s73, s101
  s_sub_u32 s74, s73, 56
  s_cselect_b32 s73, s73, s74
  s_mul_i32 s74, s73, 131072
  s_lshl_b32 s73, s73, 11
  s_add_u32 s75, s75, 24576
  s_cmp_eq_u32 s75, 147456
  s_cselect_b32 s75, 0, s75
  s_waitcnt vmcnt(24)
  s_barrier
  s_sub_u32 s79, s79, 1
  s_cmp_lg_u32 s79, 0
  s_cbranch_scc1 L_w2l_ld1
  s_add_u32 s3, s75, s76
  s_add_u32 m0, s3, 0
  s_nop 0
  buffer_load_dwordx4 v4, s[36:39], s73 offen offset:0 lds
  buffer_load_dwordx4 v4, s[36:39], s73 offen offset:1024 lds
  s_add_u32 m0, s3, 2048
  s_nop 0
  buffer_load_dwordx4 v5, s[36:39], s73 offen offset:0 lds
  buffer_load_dwordx4 v5, s[36:39], s73 offen offset:1024 lds
  s_add_u32 s3, s75, s77
  s_add_u32 m0, s3, 0
  s_add_u32 s4, s74, 0
  buffer_load_dwordx4 v8, s[40:43], s4 offen lds
  s_add_u32 m0, s3, 1024
  s_nop 0
  buffer_load_dwordx4 v9, s[40:43], s4 offen lds
  s_add_u32 s101, s101, 1
  s_sub_u32 s73, s101, s100
  s_lshl_b32 s73, s73, 3
  s_lshr_b32 s73, 0x373702, s73
  s_and_b32 s73, s73, 255
  s_add_u32 s73, s73, s101
  s_sub_u32 s74, s73, 56
  s_cselect_b32 s73, s73, s74
  s_mul_i32 s74, s73, 131072
  s_lshl_b32 s73, s73, 11
  s_add_u32 s75, s75, 24576
  s_cmp_eq_u32 s75, 147456
  s_cselect_b32 s75, 0, s75
  s_add_u32 s48, s34, 4194304
  s_addc_u32 s49, s35, 0
  s_and_b32 s49, s49, 0xffff
  s_mov_b32 s50, 4194304
  s_mov_b32 s51, 0x00020000
  s_lshr_b32 s10, s76, 11
  s_lshl_b32 s3, s68, 3
  s_add_u32 s10, s10, s3
  s_mul_i32 s10, s10, 32768
  v_lshl_add_u32 v4, v1, 4, s10
  v_add_u32 v5, 32768, v4
  s_lshl_b32 s4, s69, 11
  s_add_u32 m0, s76, 147456
  s_nop 0
  buffer_load_dwordx4 v4, s[48:51], s4 offen offset:0 lds
  buffer_load_dwordx4 v4, s[48:51], s4 offen offset:1024 lds
  s_add_u32 m0, s76, 149504
  s_nop 0
  buffer_load_dwordx4 v5, s[48:51], s4 offen offset:0 lds
  buffer_load_dwordx4 v5, s[48:51], s4 offen offset:1024 lds
  s_waitcnt vmcnt(28)
  s_barrier
  s_waitcnt vmcnt(22)
  s_barrier
  s_waitcnt vmcnt(16)
  s_barrier
  s_waitcnt vmcnt(10)
  s_barrier
  s_waitcnt vmcnt(4)
  s_barrier
  s_waitcnt vmcnt(0)
  s_barrier
  s_cmp_eq_u32 s96, 1
  s_cbranch_scc1 L_w2_end
  s_lshl_b32 s87, s97, 12
  s_lshl_b32 s4, s68, 8
  s_add_u32 s87, s87, s4
  s_lshl_b32 s4, s69, 2
  s_add_u32 s87, s87, s4
  s_mov_b32 s96, 1
  s_add_u32 s12, s22, 33554432
  s_addc_u32 s13, s23, 0
  s_add_u32 s34, s22, 67108864
  s_addc_u32 s35, s23, 0
  s_add_u32 s97, s97, 1
  s_branch L_attn_body
L_w2_end:
  s_endpgm
L_w2_compute:
  v_and_b32 v3, 15, v1
  v_lshrrev_b32 v2, 4, v1
  s_lshl_b32 s8, s68, 7
  s_lshl_b32 s9, s70, 5
  s_add_u32 s8, s8, s9
  v_add_u32 v13, s8, v3
  s_lshl_b32 s10, s69, 7
  v_lshl_add_u32 v14, v2, 3, s10
  v_and_b32 v16, 1, v2
  v_lshrrev_b32 v17, 1, v2
  v_lshlrev_b32 v16, 5, v16
  v_lshl_add_u32 v16, v17, 4, v16
  v_add_u32 v16, s10, v16
  v_lshl_add_u32 v12, v13, 11, v16
  v_lshl_add_u32 v18, v17, 4, v13
  v_lshlrev_b32 v18, 3, v18
  v_and_b32 v16, 1, v2
  v_lshl_add_u32 v18, v16, 2, v18
  s_lshl_b32 s10, s69, 14
  v_add_u32 v18, s10, v18
  s_lshl_b32 s8, s70, 12
  v_lshl_add_u32 v5, v1, 4, s8
  v_bfe_u32 v6, v1, 2, 2
  v_lshl_add_u32 v6, v2, 3, v6
  v_lshlrev_b32 v6, 7, v6
  v_and_b32 v17, 3, v1
  v_lshl_add_u32 v6, v17, 3, v6
  v_bfe_u32 v17, v1, 3, 2
  v_lshl_add_u32 v6, v17, 5, v6
  v_add_u32 v6, 16384, v6
  v_xor_b32 v7, 32, v6
  v_xor_b32 v8, 64, v6
  v_xor_b32 v9, 96, v6
  v_lshrrev_b32 v15, 1, v2
  v_lshlrev_b32 v15, 8, v15
  v_lshl_add_u32 v15, v3, 4, v15
  v_lshl_add_u32 v15, v16, 3, v15
  s_add_u32 s8, s8, 147456
  v_add_u32 v15, s8, v15
  s_mov_b32 s11, 0xffff0000
  s_mov_b32 s75, 0
  s_waitcnt lgkmcnt(0)
  s_mov_b32 s52, s30
  s_and_b32 s53, s31, 0xffff
  s_mov_b32 s54, 2048
  s_mov_b32 s55, 0x00020000
  buffer_load_dwordx2 v[176:177], v14, s[52:55], 0 offen offset:0
  buffer_load_dwordx2 v[178:179], v14, s[52:55], 0 offen offset:32
  buffer_load_dwordx2 v[180:181], v14, s[52:55], 0 offen offset:64
  buffer_load_dwordx2 v[182:183], v14, s[52:55], 0 offen offset:96
  s_mov_b32 s44, s32
  s_and_b32 s45, s33, 0xffff
  s_mov_b32 s46, 4194304
  s_mov_b32 s47, 0x00020000
  s_add_u32 s48, s22, 33554432
  s_addc_u32 s49, s23, 0
  s_and_b32 s49, s49, 0xffff
  s_mov_b32 s50, 4194304
  s_mov_b32 s51, 0x00020000
  s_cmp_eq_u32 s96, 0
  s_cselect_b64 s[44:45], s[48:49], s[44:45]
  s_add_u32 s56, s34, 24379392
  s_addc_u32 s57, s35, 0
  s_and_b32 s57, s57, 0xffff
  s_mov_b32 s58, 262144
  s_mov_b32 s59, 0x00020000
  s_barrier
  s_waitcnt vmcnt(0)
  v_lshlrev_b32 v128, 16, v176
  v_and_b32 v129, s11, v176
  v_lshlrev_b32 v130, 16, v177
  v_and_b32 v131, s11, v177
  v_lshlrev_b32 v132, 16, v176
  v_and_b32 v133, s11, v176
  v_lshlrev_b32 v134, 16, v177
  v_and_b32 v135, s11, v177
  v_lshlrev_b32 v136, 16, v178
  v_and_b32 v137, s11, v178
  v_lshlrev_b32 v138, 16, v179
  v_and_b32 v139, s11, v179
  v_lshlrev_b32 v140, 16, v178
  v_and_b32 v141, s11, v178
  v_lshlrev_b32 v142, 16, v179
  v_and_b32 v143, s11, v179
  v_lshlrev_b32 v144, 16, v180
  v_and_b32 v145, s11, v180
  v_lshlrev_b32 v146, 16, v181
  v_and_b32 v147, s11, v181
  v_lshlrev_b32 v148, 16, v180
  v_and_b32 v149, s11, v180
  v_lshlrev_b32 v150, 16, v181
  v_and_b32 v151, s11, v181
  v_lshlrev_b32 v152, 16, v182
  v_and_b32 v153, s11, v182
  v_lshlrev_b32 v154, 16, v183
  v_and_b32 v155, s11, v183
  v_lshlrev_b32 v156, 16, v182
  v_and_b32 v157, s11, v182
  v_lshlrev_b32 v158, 16, v183
  v_and_b32 v159, s11, v183
  v_add_u32_e64 v25, s75, v5
  v_add_u32_e64 v26, s75, v6
  v_add_u32_e64 v27, s75, v7
  v_add_u32_e64 v28, s75, v8
  v_add_u32_e64 v29, s75, v9
  s_add_u32 s75, s75, 24576
  s_cmp_eq_u32 s75, 147456
  s_cselect_b32 s75, 0, s75
  s_barrier
  ds_read_b128 v[32:35], v25 offset:0
  ds_read_b128 v[36:39], v25 offset:2048
  ds_read_b64_tr_b16 v[48:49], v26 offset:0
  ds_read_b64_tr_b16 v[50:51], v26 offset:512
  ds_read_b64_tr_b16 v[52:53], v27 offset:0
  ds_read_b64_tr_b16 v[54:55], v27 offset:512
  ds_read_b64_tr_b16 v[56:57], v28 offset:0
  ds_read_b64_tr_b16 v[58:59], v28 offset:512
  ds_read_b64_tr_b16 v[60:61], v29 offset:0
  ds_read_b64_tr_b16 v[62:63], v29 offset:512
  ds_read_b128 v[40:43], v25 offset:1024
  ds_read_b128 v[44:47], v25 offset:3072
  ds_read_b64_tr_b16 v[64:65], v26 offset:4096
  ds_read_b64_tr_b16 v[66:67], v26 offset:4608
  ds_read_b64_tr_b16 v[68:69], v27 offset:4096
  ds_read_b64_tr_b16 v[70:71], v27 offset:4608
  ds_read_b64_tr_b16 v[72:73], v28 offset:4096
  ds_read_b64_tr_b16 v[74:75], v28 offset:4608
  ds_read_b64_tr_b16 v[76:77], v29 offset:4096
  ds_read_b64_tr_b16 v[78:79], v29 offset:4608
  s_mov_b32 s79, 28
  v_add_u32_e64 v25, s75, v5
  v_add_u32_e64 v26, s75, v6
  v_add_u32_e64 v27, s75, v7
  v_add_u32_e64 v28, s75, v8
  v_add_u32_e64 v29, s75, v9
  s_add_u32 s75, s75, 24576
  s_cmp_eq_u32 s75, 147456
  s_cselect_b32 s75, 0, s75
  s_waitcnt lgkmcnt(0)
.p2align 3
L_w2_loop:
  s_barrier
  s_sub_u32 s79, s79, 1
  v_mfma_f32_16x16x32_bf16 v[128:131], v[48:51], v[32:35], v[128:131]
  ds_read_b128 v[80:83], v25 offset:0
  ds_read_b128 v[84:87], v25 offset:2048
  v_mfma_f32_16x16x32_bf16 v[132:135], v[48:51], v[36:39], v[132:135]
  ds_read_b64_tr_b16 v[96:97], v26 offset:0
  ds_read_b64_tr_b16 v[98:99], v26 offset:512
  v_mfma_f32_16x16x32_bf16 v[136:139], v[52:55], v[32:35], v[136:139]
  ds_read_b64_tr_b16 v[100:101], v27 offset:0
  ds_read_b64_tr_b16 v[102:103], v27 offset:512
  v_mfma_f32_16x16x32_bf16 v[140:143], v[52:55], v[36:39], v[140:143]
  ds_read_b64_tr_b16 v[104:105], v28 offset:0
  ds_read_b64_tr_b16 v[106:107], v28 offset:512
  v_mfma_f32_16x16x32_bf16 v[144:147], v[56:59], v[32:35], v[144:147]
  ds_read_b64_tr_b16 v[108:109], v29 offset:0
  ds_read_b64_tr_b16 v[110:111], v29 offset:512
  v_mfma_f32_16x16x32_bf16 v[148:151], v[56:59], v[36:39], v[148:151]
  ds_read_b128 v[88:91], v25 offset:1024
  ds_read_b128 v[92:95], v25 offset:3072
  v_mfma_f32_16x16x32_bf16 v[152:155], v[60:63], v[32:35], v[152:155]
  ds_read_b64_tr_b16 v[112:113], v26 offset:4096
  ds_read_b64_tr_b16 v[114:115], v26 offset:4608
  v_mfma_f32_16x16x32_bf16 v[156:159], v[60:63], v[36:39], v[156:159]
  ds_read_b64_tr_b16 v[116:117], v27 offset:4096
  ds_read_b64_tr_b16 v[118:119], v27 offset:4608
  v_mfma_f32_16x16x32_bf16 v[128:131], v[64:67], v[40:43], v[128:131]
  ds_read_b64_tr_b16 v[120:121], v28 offset:4096
  ds_read_b64_tr_b16 v[122:123], v28 offset:4608
  v_mfma_f32_16x16x32_bf16 v[132:135], v[64:67], v[44:47], v[132:135]
  ds_read_b64_tr_b16 v[124:125], v29 offset:4096
  ds_read_b64_tr_b16 v[126:127], v29 offset:4608
  v_mfma_f32_16x16x32_bf16 v[136:139], v[68:71], v[40:43], v[136:139]
  v_add_u32_e64 v25, s75, v5
  v_add_u32_e64 v26, s75, v6
  v_mfma_f32_16x16x32_bf16 v[140:143], v[68:71], v[44:47], v[140:143]
  v_add_u32_e64 v27, s75, v7
  v_add_u32_e64 v28, s75, v8
  v_mfma_f32_16x16x32_bf16 v[144:147], v[72:75], v[40:43], v[144:147]
  v_add_u32_e64 v29, s75, v9
  s_add_u32 s75, s75, 24576
  v_mfma_f32_16x16x32_bf16 v[148:151], v[72:75], v[44:47], v[148:151]
  s_cmp_eq_u32 s75, 147456
  s_cselect_b32 s75, 0, s75
  s_nop 0
  v_mfma_f32_16x16x32_bf16 v[152:155], v[76:79], v[40:43], v[152:155]
  v_mfma_f32_16x16x32_bf16 v[156:159], v[76:79], v[44:47], v[156:159]
  s_waitcnt lgkmcnt(0)
  s_barrier
  v_mfma_f32_16x16x32_bf16 v[128:131], v[96:99], v[80:83], v[128:131]
  ds_read_b128 v[32:35], v25 offset:0
  ds_read_b128 v[36:39], v25 offset:2048
  v_mfma_f32_16x16x32_bf16 v[132:135], v[96:99], v[84:87], v[132:135]
  ds_read_b64_tr_b16 v[48:49], v26 offset:0
  ds_read_b64_tr_b16 v[50:51], v26 offset:512
  v_mfma_f32_16x16x32_bf16 v[136:139], v[100:103], v[80:83], v[136:139]
  ds_read_b64_tr_b16 v[52:53], v27 offset:0
  ds_read_b64_tr_b16 v[54:55], v27 offset:512
  v_mfma_f32_16x16x32_bf16 v[140:143], v[100:103], v[84:87], v[140:143]
  ds_read_b64_tr_b16 v[56:57], v28 offset:0
  ds_read_b64_tr_b16 v[58:59], v28 offset:512
  v_mfma_f32_16x16x32_bf16 v[144:147], v[104:107], v[80:83], v[144:147]
  ds_read_b64_tr_b16 v[60:61], v29 offset:0
  ds_read_b64_tr_b16 v[62:63], v29 offset:512
  v_mfma_f32_16x16x32_bf16 v[148:151], v[104:107], v[84:87], v[148:151]
  ds_read_b128 v[40:43], v25 offset:1024
  ds_read_b128 v[44:47], v25 offset:3072
  v_mfma_f32_16x16x32_bf16 v[152:155], v[108:111], v[80:83], v[152:155]
  ds_read_b64_tr_b16 v[64:65], v26 offset:4096
  ds_read_b64_tr_b16 v[66:67], v26 offset:4608
  v_mfma_f32_16x16x32_bf16 v[156:159], v[108:111], v[84:87], v[156:159]
  ds_read_b64_tr_b16 v[68:69], v27 offset:4096
  ds_read_b64_tr_b16 v[70:71], v27 offset:4608
  v_mfma_f32_16x16x32_bf16 v[128:131], v[112:115], v[88:91], v[128:131]
  ds_read_b64_tr_b16 v[72:73], v28 offset:4096
  ds_read_b64_tr_b16 v[74:75], v28 offset:4608
  v_mfma_f32_16x16x32_bf16 v[132:135], v[112:115], v[92:95], v[132:135]
  ds_read_b64_tr_b16 v[76:77], v29 offset:4096
  ds_read_b64_tr_b16 v[78:79], v29 offset:4608
  v_mfma_f32_16x16x32_bf16 v[136:139], v[116:119], v[88:91], v[136:139]
  v_add_u32_e64 v25, s75, v5
  v_add_u32_e64 v26, s75, v6
  v_mfma_f32_16x16x32_bf16 v[140:143], v[116:119], v[92:95], v[140:143]
  v_add_u32_e64 v27, s75, v7
  v_add_u32_e64 v28, s75, v8
  v_mfma_f32_16x16x32_bf16 v[144:147], v[120:123], v[88:91], v[144:147]
  v_add_u32_e64 v29, s75, v9
  s_add_u32 s75, s75, 24576
  v_mfma_f32_16x16x32_bf16 v[148:151], v[120:123], v[92:95], v[148:151]
  s_cmp_eq_u32 s75, 147456
  s_cselect_b32 s75, 0, s75
  s_cmp_lg_u32 s79, 0
  v_mfma_f32_16x16x32_bf16 v[152:155], v[124:127], v[88:91], v[152:155]
  v_mfma_f32_16x16x32_bf16 v[156:159], v[124:127], v[92:95], v[156:159]
  s_waitcnt lgkmcnt(0)
  s_cbranch_scc1 L_w2_loop
  ds_read_b64 v[160:161], v15 offset:0
  ds_read_b64 v[164:165], v15 offset:512
  ds_read_b64 v[168:169], v15 offset:1024
  ds_read_b64 v[172:173], v15 offset:1536
  ds_read_b64 v[162:163], v15 offset:2048
  ds_read_b64 v[166:167], v15 offset:2560
  ds_read_b64 v[170:171], v15 offset:3072
  ds_read_b64 v[174:175], v15 offset:3584
  v_mov_b32 v20, 0
  v_mov_b32 v21, 0
  v_mov_b32 v22, 0
  v_mov_b32 v23, 0
  s_mov_b32 s3, 32768
  s_mov_b32 s10, 0x3f803f80
  s_waitcnt lgkmcnt(7)
  v_lshlrev_b32 v184, 16, v160
  v_and_b32 v185, s11, v160
  v_lshlrev_b32 v186, 16, v161
  v_and_b32 v187, s11, v161
  v_pk_add_f32 v[128:129], v[128:129], v[184:185]
  v_pk_add_f32 v[130:131], v[130:131], v[186:187]
  v_cvt_pk_bf16_f32 v32, v128, v129
  v_cvt_pk_bf16_f32 v33, v130, v131
  s_waitcnt lgkmcnt(6)
  v_lshlrev_b32 v184, 16, v164
  v_and_b32 v185, s11, v164
  v_lshlrev_b32 v186, 16, v165
  v_and_b32 v187, s11, v165
  v_pk_add_f32 v[136:137], v[136:137], v[184:185]
  v_pk_add_f32 v[138:139], v[138:139], v[186:187]
  v_cvt_pk_bf16_f32 v34, v136, v137
  v_cvt_pk_bf16_f32 v35, v138, v139
  s_nop 1
  v_permlane16_swap_b32 v32, v34
  v_permlane16_swap_b32 v33, v35
  buffer_store_dwordx4 v[32:35], v12, s[44:47], 0 offen offset:0 sc1
  s_waitcnt lgkmcnt(5)
  v_lshlrev_b32 v184, 16, v168
  v_and_b32 v185, s11, v168
  v_lshlrev_b32 v186, 16, v169
  v_and_b32 v187, s11, v169
  v_pk_add_f32 v[144:145], v[144:145], v[184:185]
  v_pk_add_f32 v[146:147], v[146:147], v[186:187]
  v_cvt_pk_bf16_f32 v36, v144, v145
  v_cvt_pk_bf16_f32 v37, v146, v147
  s_waitcnt lgkmcnt(4)
  v_lshlrev_b32 v184, 16, v172
  v_and_b32 v185, s11, v172
  v_lshlrev_b32 v186, 16, v173
  v_and_b32 v187, s11, v173
  v_pk_add_f32 v[152:153], v[152:153], v[184:185]
  v_pk_add_f32 v[154:155], v[154:155], v[186:187]
  v_cvt_pk_bf16_f32 v38, v152, v153
  v_cvt_pk_bf16_f32 v39, v154, v155
  s_nop 1
  v_permlane16_swap_b32 v36, v38
  v_permlane16_swap_b32 v37, v39
  buffer_store_dwordx4 v[36:39], v12, s[44:47], 0 offen offset:64 sc1
  s_waitcnt lgkmcnt(3)
  v_lshlrev_b32 v184, 16, v162
  v_and_b32 v185, s11, v162
  v_lshlrev_b32 v186, 16, v163
  v_and_b32 v187, s11, v163
  v_pk_add_f32 v[132:133], v[132:133], v[184:185]
  v_pk_add_f32 v[134:135], v[134:135], v[186:187]
  v_cvt_pk_bf16_f32 v40, v132, v133
  v_cvt_pk_bf16_f32 v41, v134, v135
  s_waitcnt lgkmcnt(2)
  v_lshlrev_b32 v184, 16, v166
  v_and_b32 v185, s11, v166
  v_lshlrev_b32 v186, 16, v167
  v_and_b32 v187, s11, v167
  v_pk_add_f32 v[140:141], v[140:141], v[184:185]
  v_pk_add_f32 v[142:143], v[142:143], v[186:187]
  v_cvt_pk_bf16_f32 v42, v140, v141
  v_cvt_pk_bf16_f32 v43, v142, v143
  s_nop 1
  v_permlane16_swap_b32 v40, v42
  v_permlane16_swap_b32 v41, v43
  buffer_store_dwordx4 v[40:43], v12, s[44:47], s3 offen offset:0 sc1
  s_waitcnt lgkmcnt(1)
  v_lshlrev_b32 v184, 16, v170
  v_and_b32 v185, s11, v170
  v_lshlrev_b32 v186, 16, v171
  v_and_b32 v187, s11, v171
  v_pk_add_f32 v[148:149], v[148:149], v[184:185]
  v_pk_add_f32 v[150:151], v[150:151], v[186:187]
  v_cvt_pk_bf16_f32 v44, v148, v149
  v_cvt_pk_bf16_f32 v45, v150, v151
  s_waitcnt lgkmcnt(0)
  v_lshlrev_b32 v184, 16, v174
  v_and_b32 v185, s11, v174
  v_lshlrev_b32 v186, 16, v175
  v_and_b32 v187, s11, v175
  v_pk_add_f32 v[156:157], v[156:157], v[184:185]
  v_pk_add_f32 v[158:159], v[158:159], v[186:187]
  v_cvt_pk_bf16_f32 v46, v156, v157
  v_cvt_pk_bf16_f32 v47, v158, v159
  s_nop 1
  v_permlane16_swap_b32 v44, v46
  v_permlane16_swap_b32 v45, v47
  buffer_store_dwordx4 v[44:47], v12, s[44:47], s3 offen offset:64 sc1
  v_dot2_f32_bf16 v20, v32, s10, v20
  v_dot2_f32_bf16 v22, v32, v32, v22
  v_dot2_f32_bf16 v20, v33, s10, v20
  v_dot2_f32_bf16 v22, v33, v33, v22
  v_dot2_f32_bf16 v20, v34, s10, v20
  v_dot2_f32_bf16 v22, v34, v34, v22
  v_dot2_f32_bf16 v20, v35, s10, v20
  v_dot2_f32_bf16 v22, v35, v35, v22
  v_dot2_f32_bf16 v20, v36, s10, v20
  v_dot2_f32_bf16 v22, v36, v36, v22
  v_dot2_f32_bf16 v20, v37, s10, v20
  v_dot2_f32_bf16 v22, v37, v37, v22
  v_dot2_f32_bf16 v20, v38, s10, v20
  v_dot2_f32_bf16 v22, v38, v38, v22
  v_dot2_f32_bf16 v20, v39, s10, v20
  v_dot2_f32_bf16 v22, v39, v39, v22
  v_dot2_f32_bf16 v21, v40, s10, v21
  v_dot2_f32_bf16 v23, v40, v40, v23
  v_dot2_f32_bf16 v21, v41, s10, v21
  v_dot2_f32_bf16 v23, v41, v41, v23
  v_dot2_f32_bf16 v21, v42, s10, v21
  v_dot2_f32_bf16 v23, v42, v42, v23
  v_dot2_f32_bf16 v21, v43, s10, v21
  v_dot2_f32_bf16 v23, v43, v43, v23
  v_dot2_f32_bf16 v21, v44, s10, v21
  v_dot2_f32_bf16 v23, v44, v44, v23
  v_dot2_f32_bf16 v21, v45, s10, v21
  v_dot2_f32_bf16 v23, v45, v45, v23
  v_dot2_f32_bf16 v21, v46, s10, v21
  v_dot2_f32_bf16 v23, v46, v46, v23
  v_dot2_f32_bf16 v21, v47, s10, v21
  v_dot2_f32_bf16 v23, v47, v47, v23
  s_nop 2
  v_permlane32_swap_b32 v20, v21
  v_permlane32_swap_b32 v22, v23
  v_add_f32 v20, v20, v21
  v_add_f32 v22, v22, v23
  s_nop 1
  v_permlane16_swap_b32 v20, v22
  v_add_f32 v20, v20, v22
  buffer_store_dword v20, v18, s[56:59], 0 offen sc1
  s_cmp_eq_u32 s96, 1
  s_cbranch_scc1 L_w2_end
  s_waitcnt vmcnt(0)
  s_barrier
  s_mov_b32 s96, 1
  s_add_u32 s12, s22, 33554432
  s_addc_u32 s13, s23, 0
  s_add_u32 s34, s22, 67108864
  s_addc_u32 s35, s23, 0
  s_add_u32 s97, s97, 1
  s_branch L_attn_body
L_w2_c1:
```

```asm
; @launch kernel=attnl0_kernel grid=(256,1,1) block=(512,1,1) lds=163840
.amdgcn_target "amdgcn-amd-amdhsa--gfx950"
L_attn_c0:
.text
.globl attnl0_kernel
.p2align 8
.type attnl0_kernel,@function
attnl0_kernel:
  s_load_dwordx4 s[16:19], s[0:1], 0
  s_load_dwordx2 s[20:21], s[0:1], 16
  s_load_dwordx2 s[22:23], s[0:1], 80
  s_load_dwordx8 s[24:31], s[0:1], 32
  s_load_dwordx2 s[32:33], s[0:1], 64
  s_load_dwordx2 s[34:35], s[0:1], 80
  s_load_dwordx2 s[12:13], s[0:1], 0
  s_mov_b32 s96, 0
  s_mov_b32 s97, 0
L_attn_body:
  s_cmp_ge_u32 s2, 256
  s_cbranch_scc1 L_attn_end
  v_lshrrev_b32 v2, 6, v0
  v_and_b32 v1, 63, v0
  v_readfirstlane_b32 s70, v2
  s_and_b32 s3, s2, 7
  s_lshr_b32 s99, s2, 3
  s_and_b32 s5, s3, 1
  s_lshl_b32 s5, s5, 3
  s_and_b32 s6, s99, 7
  s_add_u32 s68, s5, s6
  s_lshr_b32 s5, s3, 1
  s_lshl_b32 s5, s5, 2
  s_lshr_b32 s6, s99, 3
  s_add_u32 s69, s5, s6
  s_cmp_lt_u32 s70, 4
  s_cbranch_scc1 L_attn_compute
L_attn_loader:
  s_add_u32 s8, s70, s69
  s_and_b32 s8, s8, 3
  s_add_u32 s9, s70, s68
  s_and_b32 s9, s9, 3
  s_lshl_b32 s76, s8, 12
  s_lshl_b32 s77, s9, 11
  s_add_u32 s77, s77, 16384
  s_lshl_b32 s11, s68, 7
  v_and_b32 v10, 7, v1
  v_lshrrev_b32 v3, 3, v1
  s_lshr_b32 s10, s76, 7
  s_lshl_b32 s3, s68, 7
  s_add_u32 s10, s10, s3
  v_add_u32 v3, s10, v3
  s_cmp_eq_u32 s96, 1
  s_cselect_b32 s5, 128, 0
  s_add_u32 s5, s5, 2048
  s_lshl_b32 s6, s5, 3
  v_mul_u32_u24 v3, s5, v3
  v_lshrrev_b32 v2, 4, v1
  v_xor_b32 v4, v2, v10
  v_lshl_add_u32 v4, v4, 4, v3
  v_add_u32 v3, s6, v3
  v_add_u32 v5, 4, v2
  v_xor_b32 v5, v5, v10
  v_lshl_add_u32 v5, v5, 4, v3
  v_add_u32 v3, s6, v3
  v_xor_b32 v6, v2, v10
  v_lshl_add_u32 v6, v6, 4, v3
  v_add_u32 v3, s6, v3
  v_add_u32 v7, 4, v2
  v_xor_b32 v7, v7, v10
  v_lshl_add_u32 v7, v7, 4, v3
  v_lshrrev_b32 v3, 3, v1
  s_lshl_b32 s10, s9, 4
  v_add_u32 v3, s10, v3
  v_mul_u32_u24 v3, 6144, v3
  v_lshrrev_b32 v2, 3, v1
  v_and_b32 v2, 2, v2
  v_xor_b32 v2, v2, v10
  s_mul_i32 s10, s69, 128
  v_add_u32 v3, s10, v3
  v_lshl_add_u32 v8, v2, 4, v3
  v_xor_b32 v2, 4, v2
  v_add_u32 v3, 49152, v3
  v_lshl_add_u32 v9, v2, 4, v3
  s_and_b32 s10, s70, 3
  s_lshl_b32 s78, s10, 9
  s_add_u32 s78, s78, 40960
  s_lshl_b32 s14, s10, 2
  s_add_u32 s14, s14, s11
  s_sub_u32 s14, s14, 16
  v_lshrrev_b32 v3, 3, v1
  v_add_u32 v3, s14, v3
  v_max_i32 v3, 0, v3
  v_mul_u32_u24 v3, s5, v3
  s_lshl_b32 s14, s10, 1
  v_lshrrev_b32 v2, 4, v1
  v_add_u32 v2, s14, v2
  v_and_b32 v2, 7, v2
  v_xor_b32 v2, v2, v10
  v_lshl_add_u32 v28, v2, 4, v3
  s_cmp_eq_u32 s10, 0
  s_cselect_b32 s14, 0xffffff00, -1
  s_mov_b32 s15, 0
  s_mov_b32 s75, 0
  s_add_u32 s100, s68, s69
  s_mov_b32 s101, -1
  s_add_u32 s101, s101, 1
  s_sub_u32 s73, s101, s100
  s_lshl_b32 s73, s73, 3
  s_lshr_b32 s73, 0xf0f02, s73
  s_and_b32 s73, s73, 255
  s_add_u32 s73, s73, s101
  s_and_b32 s73, s73, 15
  s_mul_i32 s74, s73, 393216
  s_lshl_b32 s73, s73, 7
  s_waitcnt lgkmcnt(0)
  s_mov_b32 s36, s12
  s_and_b32 s37, s13, 0xffff
  s_mov_b32 s38, 4194304
  s_mov_b32 s39, 0x00020000
  s_cmp_eq_u32 s96, 1
  s_cselect_b32 s38, 128, 0
  s_add_u32 s38, s38, 2048
  s_lshl_b32 s38, s38, 11
  s_mov_b32 s40, s18
  s_and_b32 s41, s19, 0xffff
  s_mov_b32 s42, 6291456
  s_mov_b32 s43, 0x00020000
  s_cmp_lg_u32 s96, 0
  s_cbranch_scc1 L_attn_ld1
  s_mov_b32 s48, s28
  s_and_b32 s49, s29, 0xffff
  s_mov_b32 s50, 7340032
  s_mov_b32 s51, 0x00020000
  s_cmp_eq_u32 s96, 0
  s_cselect_b32 s50, s50, 0
  s_and_b32 s3, s70, 3
  s_lshl_b32 s4, s2, 2
  s_add_u32 s3, s3, s4
  s_mul_i32 s98, s3, 7168
  s_add_u32 s3, s75, s76
  s_add_u32 m0, s3, 0
  s_nop 0
  buffer_load_dwordx4 v4, s[36:39], s73 offen lds
  s_add_u32 m0, s3, 1024
  s_nop 0
  buffer_load_dwordx4 v5, s[36:39], s73 offen lds
  s_add_u32 m0, s3, 2048
  s_nop 0
  buffer_load_dwordx4 v6, s[36:39], s73 offen lds
  s_add_u32 m0, s3, 3072
  s_nop 0
  buffer_load_dwordx4 v7, s[36:39], s73 offen lds
  s_add_u32 m0, s78, s75
  s_mov_b64 exec, s[14:15]
  buffer_load_dwordx4 v28, s[36:39], s73 offen lds
  s_mov_b64 exec, -1
  s_add_u32 s3, s75, s77
  s_add_u32 m0, s3, 0
  s_add_u32 s4, s74, 0
  buffer_load_dwordx4 v8, s[40:43], s4 offen lds
  s_add_u32 m0, s3, 1024
  s_nop 0
  buffer_load_dwordx4 v9, s[40:43], s4 offen lds
  s_add_u32 m0, s3, 8192
  s_add_u32 s4, s74, 2048
  buffer_load_dwordx4 v8, s[40:43], s4 offen lds
  s_add_u32 m0, s3, 9216
  s_nop 0
  buffer_load_dwordx4 v9, s[40:43], s4 offen lds
  s_add_u32 m0, s3, 16384
  s_add_u32 s4, s74, 4096
  buffer_load_dwordx4 v8, s[40:43], s4 offen lds
  s_add_u32 m0, s3, 17408
  s_nop 0
  buffer_load_dwordx4 v9, s[40:43], s4 offen lds
  s_add_u32 s101, s101, 1
  s_sub_u32 s73, s101, s100
  s_lshl_b32 s73, s73, 3
  s_lshr_b32 s73, 0xf0f02, s73
  s_and_b32 s73, s73, 255
  s_add_u32 s73, s73, s101
  s_and_b32 s73, s73, 15
  s_mul_i32 s74, s73, 393216
  s_lshl_b32 s73, s73, 7
  s_add_u32 s75, s75, 43008
  s_cmp_eq_u32 s75, 129024
  s_cselect_b32 s75, 0, s75
  s_add_u32 s3, s75, s76
  s_add_u32 m0, s3, 0
  s_nop 0
  buffer_load_dwordx4 v4, s[36:39], s73 offen lds
  s_add_u32 m0, s3, 1024
  s_nop 0
  buffer_load_dwordx4 v5, s[36:39], s73 offen lds
  s_add_u32 m0, s3, 2048
  s_nop 0
  buffer_load_dwordx4 v6, s[36:39], s73 offen lds
  s_add_u32 m0, s3, 3072
  s_nop 0
  buffer_load_dwordx4 v7, s[36:39], s73 offen lds
  s_add_u32 m0, s78, s75
  s_mov_b64 exec, s[14:15]
  buffer_load_dwordx4 v28, s[36:39], s73 offen lds
  s_mov_b64 exec, -1
  s_add_u32 s3, s75, s77
  s_add_u32 m0, s3, 0
  s_add_u32 s4, s74, 0
  buffer_load_dwordx4 v8, s[40:43], s4 offen lds
  s_add_u32 m0, s3, 1024
  s_nop 0
  buffer_load_dwordx4 v9, s[40:43], s4 offen lds
  s_add_u32 m0, s3, 8192
  s_add_u32 s4, s74, 2048
  buffer_load_dwordx4 v8, s[40:43], s4 offen lds
  s_add_u32 m0, s3, 9216
  s_nop 0
  buffer_load_dwordx4 v9, s[40:43], s4 offen lds
  s_add_u32 m0, s3, 16384
  s_add_u32 s4, s74, 4096
  buffer_load_dwordx4 v8, s[40:43], s4 offen lds
  s_add_u32 m0, s3, 17408
  s_nop 0
  buffer_load_dwordx4 v9, s[40:43], s4 offen lds
  s_add_u32 s101, s101, 1
  s_sub_u32 s73, s101, s100
  s_lshl_b32 s73, s73, 3
  s_lshr_b32 s73, 0xf0f02, s73
  s_and_b32 s73, s73, 255
  s_add_u32 s73, s73, s101
  s_and_b32 s73, s73, 15
  s_mul_i32 s74, s73, 393216
  s_lshl_b32 s73, s73, 7
  s_add_u32 s75, s75, 43008
  s_cmp_eq_u32 s75, 129024
  s_cselect_b32 s75, 0, s75
  s_and_b32 s3, s70, 3
  s_lshl_b32 s4, s2, 2
  s_add_u32 s3, s3, s4
  s_sub_u32 s4, 384, s40
  s_and_b32 s4, s4, 0x380
  s_mul_i32 s5, s3, 6144
  s_add_u32 s5, s5, s4
  s_buffer_load_dword s84, s[40:43], s5 offset:0
  s_buffer_load_dword s84, s[40:43], s5 offset:64
  s_buffer_load_dword s84, s[40:43], s5 offset:1024
  s_buffer_load_dword s84, s[40:43], s5 offset:1088
  s_buffer_load_dword s84, s[40:43], s5 offset:2048
  s_buffer_load_dword s84, s[40:43], s5 offset:2112
  s_buffer_load_dword s84, s[40:43], s5 offset:3072
  s_buffer_load_dword s84, s[40:43], s5 offset:3136
  s_buffer_load_dword s84, s[40:43], s5 offset:4096
  s_buffer_load_dword s84, s[40:43], s5 offset:4160
  s_buffer_load_dword s84, s[40:43], s5 offset:5120
  s_buffer_load_dword s84, s[40:43], s5 offset:5184
  s_waitcnt vmcnt(11)
  s_barrier
  s_mov_b32 s79, 13
L_attn0_ld1:
  s_add_u32 s3, s75, s76
  s_add_u32 m0, s3, 0
  s_nop 0
  buffer_load_dwordx4 v4, s[36:39], s73 offen lds
  s_add_u32 m0, s3, 1024
  s_nop 0
  buffer_load_dwordx4 v5, s[36:39], s73 offen lds
  s_add_u32 m0, s3, 2048
  s_nop 0
  buffer_load_dwordx4 v6, s[36:39], s73 offen lds
  s_add_u32 m0, s3, 3072
  s_nop 0
  buffer_load_dwordx4 v7, s[36:39], s73 offen lds
  s_add_u32 m0, s78, s75
  s_mov_b64 exec, s[14:15]
  buffer_load_dwordx4 v28, s[36:39], s73 offen lds
  s_mov_b64 exec, -1
  s_add_u32 s3, s75, s77
  s_add_u32 m0, s3, 0
  s_add_u32 s4, s74, 0
  buffer_load_dwordx4 v8, s[40:43], s4 offen lds
  s_add_u32 m0, s3, 1024
  s_nop 0
  buffer_load_dwordx4 v9, s[40:43], s4 offen lds
  s_add_u32 m0, s3, 8192
  s_add_u32 s4, s74, 2048
  buffer_load_dwordx4 v8, s[40:43], s4 offen lds
  s_add_u32 m0, s3, 9216
  s_nop 0
  buffer_load_dwordx4 v9, s[40:43], s4 offen lds
  s_add_u32 m0, s3, 16384
  s_add_u32 s4, s74, 4096
  buffer_load_dwordx4 v8, s[40:43], s4 offen lds
  s_add_u32 m0, s3, 17408
  s_nop 0
  buffer_load_dwordx4 v9, s[40:43], s4 offen lds
  s_add_u32 s101, s101, 1
  s_sub_u32 s73, s101, s100
  s_lshl_b32 s73, s73, 3
  s_lshr_b32 s73, 0xf0f02, s73
  s_and_b32 s73, s73, 255
  s_add_u32 s73, s73, s101
  s_and_b32 s73, s73, 15
  s_mul_i32 s74, s73, 393216
  s_lshl_b32 s73, s73, 7
  s_add_u32 s75, s75, 43008
  s_cmp_eq_u32 s75, 129024
  s_cselect_b32 s75, 0, s75
  s_buffer_load_dword s84, s[48:51], s98 offset:0
  s_buffer_load_dword s84, s[48:51], s98 offset:64
  s_buffer_load_dword s84, s[48:51], s98 offset:128
  s_buffer_load_dword s84, s[48:51], s98 offset:192
  s_add_u32 s98, s98, 256
  s_waitcnt vmcnt(11)
  s_barrier
  s_sub_u32 s79, s79, 1
  s_cmp_lg_u32 s79, 0
  s_cbranch_scc1 L_attn0_ld1
  s_add_u32 s3, s75, s76
  s_add_u32 m0, s3, 0
  s_nop 0
  buffer_load_dwordx4 v4, s[36:39], s73 offen lds
  s_add_u32 m0, s3, 1024
  s_nop 0
  buffer_load_dwordx4 v5, s[36:39], s73 offen lds
  s_add_u32 m0, s3, 2048
  s_nop 0
  buffer_load_dwordx4 v6, s[36:39], s73 offen lds
  s_add_u32 m0, s3, 3072
  s_nop 0
  buffer_load_dwordx4 v7, s[36:39], s73 offen lds
  s_add_u32 m0, s78, s75
  s_mov_b64 exec, s[14:15]
  buffer_load_dwordx4 v28, s[36:39], s73 offen lds
  s_mov_b64 exec, -1
  s_add_u32 s3, s75, s77
  s_add_u32 m0, s3, 0
  s_add_u32 s4, s74, 0
  buffer_load_dwordx4 v8, s[40:43], s4 offen lds
  s_add_u32 m0, s3, 1024
  s_nop 0
  buffer_load_dwordx4 v9, s[40:43], s4 offen lds
  s_add_u32 m0, s3, 8192
  s_add_u32 s4, s74, 2048
  buffer_load_dwordx4 v8, s[40:43], s4 offen lds
  s_add_u32 m0, s3, 9216
  s_nop 0
  buffer_load_dwordx4 v9, s[40:43], s4 offen lds
  s_add_u32 m0, s3, 16384
  s_add_u32 s4, s74, 4096
  buffer_load_dwordx4 v8, s[40:43], s4 offen lds
  s_add_u32 m0, s3, 17408
  s_nop 0
  buffer_load_dwordx4 v9, s[40:43], s4 offen lds
  s_add_u32 s101, s101, 1
  s_sub_u32 s73, s101, s100
  s_lshl_b32 s73, s73, 3
  s_lshr_b32 s73, 0xf0f02, s73
  s_and_b32 s73, s73, 255
  s_add_u32 s73, s73, s101
  s_and_b32 s73, s73, 15
  s_mul_i32 s74, s73, 393216
  s_lshl_b32 s73, s73, 7
  s_add_u32 s75, s75, 43008
  s_cmp_eq_u32 s75, 129024
  s_cselect_b32 s75, 0, s75
  s_buffer_load_dword s84, s[48:51], s98 offset:0
  s_buffer_load_dword s84, s[48:51], s98 offset:64
  s_buffer_load_dword s84, s[48:51], s98 offset:128
  s_buffer_load_dword s84, s[48:51], s98 offset:192
  s_add_u32 s98, s98, 256
  s_mov_b32 s64, s24
  s_and_b32 s65, s25, 0xffff
  s_mov_b32 s66, 7340032
  s_mov_b32 s67, 0x00020000
  s_min_u32 s3, s2, 223
  s_mul_i32 s4, s3, 4682
  s_lshr_b32 s4, s4, 16
  s_mul_i32 s5, s4, 14
  s_sub_u32 s3, s3, s5
  s_lshl_b32 s3, s3, 2
  s_and_b32 s5, s70, 3
  s_add_u32 s3, s3, s5
  s_mul_i32 s5, s4, 458752
  s_lshl_b32 s8, s3, 7
  s_add_u32 s5, s5, s8
  s_lshl_b32 s9, s4, 14
  s_lshl_b32 s8, s3, 8
  s_add_u32 s94, s9, s8
  v_lshrrev_b32 v2, 3, v1
  v_mul_u32_u24 v2, 7168, v2
  v_and_b32 v3, 7, v1
  v_lshl_add_u32 v2, v3, 4, v2
  buffer_load_dwordx4 v[64:67], v2, s[64:67], s5 offen
  s_add_u32 s5, s5, 57344
  buffer_load_dwordx4 v[68:71], v2, s[64:67], s5 offen
  s_add_u32 s5, s5, 57344
  buffer_load_dwordx4 v[72:75], v2, s[64:67], s5 offen
  s_add_u32 s5, s5, 57344
  buffer_load_dwordx4 v[76:79], v2, s[64:67], s5 offen
  s_add_u32 s5, s5, 57344
  buffer_load_dwordx4 v[80:83], v2, s[64:67], s5 offen
  s_add_u32 s5, s5, 57344
  buffer_load_dwordx4 v[84:87], v2, s[64:67], s5 offen
  s_add_u32 s5, s5, 57344
  buffer_load_dwordx4 v[88:91], v2, s[64:67], s5 offen
  s_add_u32 s5, s5, 57344
  buffer_load_dwordx4 v[92:95], v2, s[64:67], s5 offen
  s_mov_b32 s60, s20
  s_and_b32 s61, s21, 0xffff
  s_mov_b32 s62, 2097152
  s_mov_b32 s63, 0x00020000
  s_and_b32 s3, s70, 3
  s_mul_i32 s3, s3, 8
  s_mul_i32 s4, s99, 32
  s_add_u32 s3, s3, s4
  v_lshrrev_b32 v2, 3, v1
  v_add_u32 v2, s3, v2
  v_mul_u32_u24 v2, 2048, v2
  v_and_b32 v3, 7, v1
  v_lshl_add_u32 v2, v3, 7, v2
  s_and_b32 s3, s2, 7
  s_lshr_b32 s3, s3, 2
  s_mul_i32 s3, s3, 1024
  buffer_load_dword v96, v2, s[60:63], s3 offen
  s_waitcnt vmcnt(20)
  s_barrier
  s_waitcnt vmcnt(9)
  s_barrier
  s_barrier
  s_barrier
  s_barrier
  s_branch L_attn_ldend
L_attn_ld1:
  s_add_u32 s56, s22, 24379392
  s_addc_u32 s57, s23, 0
  s_and_b32 s57, s57, 0xffff
  s_mov_b32 s58, 262144
  s_mov_b32 s59, 0x00020000
  s_mov_b32 s88, s73
  s_add_u32 m0, s77, 0
  s_add_u32 s4, s74, 0
  buffer_load_dwordx4 v8, s[40:43], s4 offen lds
  s_add_u32 m0, s77, 1024
  s_nop 0
  buffer_load_dwordx4 v9, s[40:43], s4 offen lds
  s_add_u32 m0, s77, 8192
  s_add_u32 s4, s74, 2048
  buffer_load_dwordx4 v8, s[40:43], s4 offen lds
  s_add_u32 m0, s77, 9216
  s_nop 0
  buffer_load_dwordx4 v9, s[40:43], s4 offen lds
  s_add_u32 m0, s77, 16384
  s_add_u32 s4, s74, 4096
  buffer_load_dwordx4 v8, s[40:43], s4 offen lds
  s_add_u32 m0, s77, 17408
  s_nop 0
  buffer_load_dwordx4 v9, s[40:43], s4 offen lds
  s_add_u32 s101, s101, 1
  s_sub_u32 s73, s101, s100
  s_lshl_b32 s73, s73, 3
  s_lshr_b32 s73, 0xf0f02, s73
  s_and_b32 s73, s73, 255
  s_add_u32 s73, s73, s101
  s_and_b32 s73, s73, 15
  s_mul_i32 s74, s73, 393216
  s_lshl_b32 s73, s73, 7
  s_mov_b32 s89, s73
  s_add_u32 m0, s77, 43008
  s_add_u32 s4, s74, 0
  buffer_load_dwordx4 v8, s[40:43], s4 offen lds
  s_add_u32 m0, s77, 44032
  s_nop 0
  buffer_load_dwordx4 v9, s[40:43], s4 offen lds
  s_add_u32 m0, s77, 51200
  s_add_u32 s4, s74, 2048
  buffer_load_dwordx4 v8, s[40:43], s4 offen lds
  s_add_u32 m0, s77, 52224
  s_nop 0
  buffer_load_dwordx4 v9, s[40:43], s4 offen lds
  s_add_u32 m0, s77, 59392
  s_add_u32 s4, s74, 4096
  buffer_load_dwordx4 v8, s[40:43], s4 offen lds
  s_add_u32 m0, s77, 60416
  s_nop 0
  buffer_load_dwordx4 v9, s[40:43], s4 offen lds
  s_add_u32 s101, s101, 1
  s_sub_u32 s73, s101, s100
  s_lshl_b32 s73, s73, 3
  s_lshr_b32 s73, 0xf0f02, s73
  s_and_b32 s73, s73, 255
  s_add_u32 s73, s73, s101
  s_and_b32 s73, s73, 15
  s_mul_i32 s74, s73, 393216
  s_lshl_b32 s73, s73, 7
  s_mov_b32 s75, 86016
  s_add_u32 s44, s22, 24903680
  s_addc_u32 s45, s23, 0
  s_and_b32 s45, s45, 0xffff
  s_mov_b32 s46, 32768
  s_mov_b32 s47, 0x00020000
  s_lshl_b32 s3, s97, 12
  s_lshl_b32 s4, s68, 8
  s_add_u32 s3, s3, s4
  s_sub_u32 s3, s3, 4096
  v_and_b32 v2, 15, v1
  v_lshlrev_b32 v2, 2, v2
  s_min_u32 s4, s4, 256
  s_sub_u32 s3, s3, s4
  v_lshlrev_b32 v3, 4, v1
  v_and_b32 v3, s4, v3
  v_add_u32 v2, v2, v3
  v_mov_b32 v3, 1
  s_mov_b32 s79, 0x100000
  s_cmp_lg_u32 s70, 4
  s_barrier
  s_cbranch_scc1 L_attn_dep
  s_mov_b64 exec, 1
  buffer_store_dword v3, off, s[44:47], s87 sc1
  s_mov_b64 exec, -1
L_attn_poll:
  buffer_load_dword v3, v2, s[44:47], s3 offen sc1
  s_sub_u32 s79, s79, 1
  s_cbranch_scc1 L_attn_dep
  s_waitcnt vmcnt(0)
  v_cmp_ne_u32 vcc, 1, v3
  s_cbranch_vccnz L_attn_poll
L_attn_dep:
  s_barrier
  s_add_u32 m0, s76, 0
  s_nop 0
  buffer_load_dwordx4 v4, s[36:39], s88 offen lds
  s_add_u32 m0, s76, 1024
  s_nop 0
  buffer_load_dwordx4 v5, s[36:39], s88 offen lds
  s_add_u32 m0, s76, 2048
  s_nop 0
  buffer_load_dwordx4 v6, s[36:39], s88 offen lds
  s_add_u32 m0, s76, 3072
  s_nop 0
  buffer_load_dwordx4 v7, s[36:39], s88 offen lds
  s_add_u32 m0, s78, 0
  s_mov_b64 exec, s[14:15]
  buffer_load_dwordx4 v28, s[36:39], s88 offen lds
  s_mov_b64 exec, -1
  s_add_u32 m0, s76, 43008
  s_nop 0
  buffer_load_dwordx4 v4, s[36:39], s89 offen lds
  s_add_u32 m0, s76, 44032
  s_nop 0
  buffer_load_dwordx4 v5, s[36:39], s89 offen lds
  s_add_u32 m0, s76, 45056
  s_nop 0
  buffer_load_dwordx4 v6, s[36:39], s89 offen lds
  s_add_u32 m0, s76, 46080
  s_nop 0
  buffer_load_dwordx4 v7, s[36:39], s89 offen lds
  s_add_u32 m0, s78, 43008
  s_mov_b64 exec, s[14:15]
  buffer_load_dwordx4 v28, s[36:39], s89 offen lds
  s_mov_b64 exec, -1
  s_waitcnt vmcnt(5)
  s_barrier
  s_mov_b32 s79, 13
L_attn1_ld1:
  s_add_u32 s3, s75, s76
  s_add_u32 m0, s3, 0
  s_nop 0
  buffer_load_dwordx4 v4, s[36:39], s73 offen lds
  s_add_u32 m0, s3, 1024
  s_nop 0
  buffer_load_dwordx4 v5, s[36:39], s73 offen lds
  s_add_u32 m0, s3, 2048
  s_nop 0
  buffer_load_dwordx4 v6, s[36:39], s73 offen lds
  s_add_u32 m0, s3, 3072
  s_nop 0
  buffer_load_dwordx4 v7, s[36:39], s73 offen lds
  s_add_u32 m0, s78, s75
  s_mov_b64 exec, s[14:15]
  buffer_load_dwordx4 v28, s[36:39], s73 offen lds
  s_mov_b64 exec, -1
  s_add_u32 s3, s75, s77
  s_add_u32 m0, s3, 0
  s_add_u32 s4, s74, 0
  buffer_load_dwordx4 v8, s[40:43], s4 offen lds
  s_add_u32 m0, s3, 1024
  s_nop 0
  buffer_load_dwordx4 v9, s[40:43], s4 offen lds
  s_add_u32 m0, s3, 8192
  s_add_u32 s4, s74, 2048
  buffer_load_dwordx4 v8, s[40:43], s4 offen lds
  s_add_u32 m0, s3, 9216
  s_nop 0
  buffer_load_dwordx4 v9, s[40:43], s4 offen lds
  s_add_u32 m0, s3, 16384
  s_add_u32 s4, s74, 4096
  buffer_load_dwordx4 v8, s[40:43], s4 offen lds
  s_add_u32 m0, s3, 17408
  s_nop 0
  buffer_load_dwordx4 v9, s[40:43], s4 offen lds
  s_add_u32 s101, s101, 1
  s_sub_u32 s73, s101, s100
  s_lshl_b32 s73, s73, 3
  s_lshr_b32 s73, 0xf0f02, s73
  s_and_b32 s73, s73, 255
  s_add_u32 s73, s73, s101
  s_and_b32 s73, s73, 15
  s_mul_i32 s74, s73, 393216
  s_lshl_b32 s73, s73, 7
  s_add_u32 s75, s75, 43008
  s_cmp_eq_u32 s75, 129024
  s_cselect_b32 s75, 0, s75
  s_waitcnt vmcnt(11)
  s_barrier
  s_sub_u32 s79, s79, 1
  s_cmp_lg_u32 s79, 0
  s_cbranch_scc1 L_attn1_ld1
  s_add_u32 s3, s75, s76
  s_add_u32 m0, s3, 0
  s_nop 0
  buffer_load_dwordx4 v4, s[36:39], s73 offen lds
  s_add_u32 m0, s3, 1024
  s_nop 0
  buffer_load_dwordx4 v5, s[36:39], s73 offen lds
  s_add_u32 m0, s3, 2048
  s_nop 0
  buffer_load_dwordx4 v6, s[36:39], s73 offen lds
  s_add_u32 m0, s3, 3072
  s_nop 0
  buffer_load_dwordx4 v7, s[36:39], s73 offen lds
  s_add_u32 m0, s78, s75
  s_mov_b64 exec, s[14:15]
  buffer_load_dwordx4 v28, s[36:39], s73 offen lds
  s_mov_b64 exec, -1
  s_add_u32 s3, s75, s77
  s_add_u32 m0, s3, 0
  s_add_u32 s4, s74, 0
  buffer_load_dwordx4 v8, s[40:43], s4 offen lds
  s_add_u32 m0, s3, 1024
  s_nop 0
  buffer_load_dwordx4 v9, s[40:43], s4 offen lds
  s_add_u32 m0, s3, 8192
  s_add_u32 s4, s74, 2048
  buffer_load_dwordx4 v8, s[40:43], s4 offen lds
  s_add_u32 m0, s3, 9216
  s_nop 0
  buffer_load_dwordx4 v9, s[40:43], s4 offen lds
  s_add_u32 m0, s3, 16384
  s_add_u32 s4, s74, 4096
  buffer_load_dwordx4 v8, s[40:43], s4 offen lds
  s_add_u32 m0, s3, 17408
  s_nop 0
  buffer_load_dwordx4 v9, s[40:43], s4 offen lds
  s_add_u32 s101, s101, 1
  s_sub_u32 s73, s101, s100
  s_lshl_b32 s73, s73, 3
  s_lshr_b32 s73, 0xf0f02, s73
  s_and_b32 s73, s73, 255
  s_add_u32 s73, s73, s101
  s_and_b32 s73, s73, 15
  s_mul_i32 s74, s73, 393216
  s_lshl_b32 s73, s73, 7
  s_add_u32 s75, s75, 43008
  s_cmp_eq_u32 s75, 129024
  s_cselect_b32 s75, 0, s75
  s_and_b32 s3, s70, 3
  s_lshl_b32 s4, s68, 7
  s_lshl_b32 s5, s3, 6
  s_add_u32 s5, s5, s4
  v_add_u32 v2, s5, v1
  s_sub_u32 s4, s4, 16
  v_and_b32 v3, 15, v1
  v_add_u32 v3, s4, v3
  v_max_i32 v3, 0, v3
  s_cmp_ge_u32 s3, 2
  s_cselect_b64 vcc, -1, 0
  v_cndmask_b32 v2, v2, v3, vcc
  v_lshlrev_b32 v2, 3, v2
  s_mov_b32 s3, 0
  buffer_load_dwordx2 v[32:33], v2, s[56:59], s3 offen
  s_add_u32 s3, s3, 16384
  buffer_load_dwordx2 v[34:35], v2, s[56:59], s3 offen
  s_add_u32 s3, s3, 16384
  buffer_load_dwordx2 v[36:37], v2, s[56:59], s3 offen
  s_add_u32 s3, s3, 16384
  buffer_load_dwordx2 v[38:39], v2, s[56:59], s3 offen
  s_add_u32 s3, s3, 16384
  buffer_load_dwordx2 v[40:41], v2, s[56:59], s3 offen
  s_add_u32 s3, s3, 16384
  buffer_load_dwordx2 v[42:43], v2, s[56:59], s3 offen
  s_add_u32 s3, s3, 16384
  buffer_load_dwordx2 v[44:45], v2, s[56:59], s3 offen
  s_add_u32 s3, s3, 16384
  buffer_load_dwordx2 v[46:47], v2, s[56:59], s3 offen
  s_add_u32 s3, s3, 16384
  buffer_load_dwordx2 v[48:49], v2, s[56:59], s3 offen
  s_add_u32 s3, s3, 16384
  buffer_load_dwordx2 v[50:51], v2, s[56:59], s3 offen
  s_add_u32 s3, s3, 16384
  buffer_load_dwordx2 v[52:53], v2, s[56:59], s3 offen
  s_add_u32 s3, s3, 16384
  buffer_load_dwordx2 v[54:55], v2, s[56:59], s3 offen
  s_add_u32 s3, s3, 16384
  buffer_load_dwordx2 v[56:57], v2, s[56:59], s3 offen
  s_add_u32 s3, s3, 16384
  buffer_load_dwordx2 v[58:59], v2, s[56:59], s3 offen
  s_add_u32 s3, s3, 16384
  buffer_load_dwordx2 v[60:61], v2, s[56:59], s3 offen
  s_add_u32 s3, s3, 16384
  buffer_load_dwordx2 v[62:63], v2, s[56:59], s3 offen
  s_mov_b32 s60, s20
  s_and_b32 s61, s21, 0xffff
  s_mov_b32 s62, 2097152
  s_mov_b32 s63, 0x00020000
  s_and_b32 s3, s70, 3
  s_mul_i32 s3, s3, 8
  s_mul_i32 s4, s99, 32
  s_add_u32 s3, s3, s4
  v_lshrrev_b32 v2, 3, v1
  v_add_u32 v2, s3, v2
  v_mul_u32_u24 v2, 2048, v2
  v_and_b32 v3, 7, v1
  v_lshl_add_u32 v2, v3, 7, v2
  s_and_b32 s3, s2, 7
  s_lshr_b32 s3, s3, 2
  s_mul_i32 s3, s3, 1024
  buffer_load_dword v96, v2, s[60:63], s3 offen
  s_waitcnt vmcnt(28)
  s_barrier
  s_waitcnt vmcnt(17)
  s_barrier
  s_waitcnt vmcnt(1)
  v_add_f32 v32, v32, v34
  v_add_f32 v33, v33, v35
  v_add_f32 v48, v48, v50
  v_add_f32 v49, v49, v51
  v_add_f32 v32, v32, v36
  v_add_f32 v33, v33, v37
  v_add_f32 v48, v48, v52
  v_add_f32 v49, v49, v53
  v_add_f32 v32, v32, v38
  v_add_f32 v33, v33, v39
  v_add_f32 v48, v48, v54
  v_add_f32 v49, v49, v55
  v_add_f32 v32, v32, v40
  v_add_f32 v33, v33, v41
  v_add_f32 v48, v48, v56
  v_add_f32 v49, v49, v57
  v_add_f32 v32, v32, v42
  v_add_f32 v33, v33, v43
  v_add_f32 v48, v48, v58
  v_add_f32 v49, v49, v59
  v_add_f32 v32, v32, v44
  v_add_f32 v33, v33, v45
  v_add_f32 v48, v48, v60
  v_add_f32 v49, v49, v61
  v_add_f32 v32, v32, v46
  v_add_f32 v33, v33, v47
  v_add_f32 v48, v48, v62
  v_add_f32 v49, v49, v63
  v_add_f32 v32, v32, v48
  v_add_f32 v33, v33, v49
  v_mul_f32 v32, 0x3a800000, v32
  v_mul_f32 v33, 0x3a800000, v33
  v_fma_f32 v33, -v32, v32, v33
  v_max_f32 v33, 0, v33
  v_add_f32 v33, 0x3727c5ac, v33
  v_rsq_f32 v33, v33
  s_nop 0
  s_and_b32 s3, s70, 3
  s_lshl_b32 s5, s3, 6
  s_add_u32 s5, s5, 16
  v_add_u32 v2, s5, v1
  v_and_b32 v3, 15, v1
  s_cmp_ge_u32 s3, 2
  s_cselect_b64 vcc, -1, 0
  v_cndmask_b32 v2, v2, v3, vcc
  v_lshlrev_b32 v2, 2, v2
  v_add_u32 v2, 129024, v2
  ds_write2_b32 v2, v32, v33 offset0:0 offset1:160
  s_waitcnt lgkmcnt(0)
  s_barrier
  s_barrier
L_attn_ldend:
  s_lshl_b32 s87, s97, 12
  s_lshl_b32 s4, s68, 8
  s_add_u32 s87, s87, s4
  s_lshl_b32 s4, s69, 2
  s_add_u32 s87, s87, s4
  s_add_u32 s97, s97, 1
  s_branch L_wo_body
L_attn_end:
  s_endpgm
L_attn_compute:
  s_and_b32 s71, s70, 1
  s_lshr_b32 s72, s70, 1
  v_and_b32 v3, 31, v1
  v_lshlrev_b32 v3, 2, v3
  v_add_u32 v3, 40960, v3
  v_mov_b32 v236, 0x3f803f80
  v_mov_b32 v237, 0x3f803f80
  v_mov_b32 v238, 0x3f803f80
  v_mov_b32 v239, 0x3f803f80
  ds_write_b32 v3, v236
  ds_write_b32 v3, v236 offset:43008
  v_add_u32 v3, 86016, v3
  ds_write_b32 v3, v236
  v_and_b32 v3, 15, v1
  v_lshrrev_b32 v2, 4, v1
  v_lshrrev_b32 v33, 1, v3
  s_lshl_b32 s8, s71, 13
  v_xor_b32 v4, v2, v33
  v_lshlrev_b32 v4, 4, v4
  v_lshl_add_u32 v4, v3, 7, v4
  v_add_u32 v8, 40960, v4
  v_add_u32 v4, s8, v4
  v_add_u32 v5, 4, v2
  v_xor_b32 v5, v5, v33
  v_lshlrev_b32 v5, 4, v5
  v_lshl_add_u32 v5, v3, 7, v5
  v_add_u32 v9, 40960, v5
  v_add_u32 v5, s8, v5
  v_bfe_u32 v34, v1, 2, 2
  v_lshl_add_u32 v34, v2, 3, v34
  v_lshlrev_b32 v34, 7, v34
  v_and_b32 v33, 3, v1
  v_lshl_add_u32 v34, v33, 3, v34
  v_bfe_u32 v33, v1, 3, 2
  v_lshl_add_u32 v34, v33, 5, v34
  v_and_b32 v35, 1, v2
  v_xor_b32 v35, s71, v35
  s_lshl_b32 s8, s70, 5
  v_xor_b32 v34, s8, v34
  v_add_u32 v6, 16384, v34
  v_xor_b32 v7, 32, v6
  s_lshl_b32 s8, s68, 7
  s_lshl_b32 s9, s71, 6
  s_add_u32 s8, s8, s9
  s_add_u32 s10, s8, s69
  s_lshl_b32 s10, s10, 11
  s_lshl_b32 s11, s72, 10
  s_add_u32 s10, s10, s11
  v_lshl_add_u32 v33, v3, 4, s10
  v_lshl_add_u32 v33, v35, 9, v33
  v_lshrrev_b32 v34, 1, v2
  v_lshl_add_u32 v31, v34, 8, v33
  s_mul_i32 s10, s72, 24576
  s_add_u32 s10, s10, 1024
  s_lshl_b32 s11, s71, 10
  s_add_u32 s4, s10, s11
  s_sub_u32 s5, s10, s11
  s_mul_i32 s6, s71, 6144
  v_lshl_add_u32 v16, v1, 4, s4
  v_add_u32 v17, s6, v16
  v_lshl_add_u32 v18, v1, 4, s5
  v_add_u32 v18, s6, v18
  v_lshl_add_u32 v19, v2, 8, s4
  v_lshl_add_u32 v20, v2, 8, s5
  v_lshl_add_u32 v21, v3, 4, s4
  v_lshl_add_u32 v22, v3, 4, s5
  s_lshl_b32 s10, s71, 8
  s_add_u32 s10, s10, 129024
  v_lshl_add_u32 v23, v3, 2, s10
  v_lshl_add_u32 v24, v2, 4, s10
  v_and_b32 v33, 1, v3
  v_cmp_eq_u32 s[48:49], 1, v33
  v_lshl_add_u32 v34, v2, 2, v33
  v_add_u32 v35, 2, v34
  v_cmp_gt_u32 s[50:51], v34, v3
  v_cmp_gt_u32 s[52:53], v35, v3
  v_mov_b32 v36, 0xffff
  v_mov_b32 v37, 0xffff0000
  v_cndmask_b32 v36, v36, v37, s[48:49]
  s_add_u32 s10, s10, 704
  v_lshl_add_u32 v34, v34, 2, s10
  v_lshl_add_u32 v35, v35, 2, s10
  v_subrev_u32 v38, 64, v34
  v_subrev_u32 v39, 64, v35
  v_cndmask_b32 v25, v34, v38, s[50:51]
  v_cndmask_b32 v26, v35, v39, s[52:53]
  v_cndmask_b32 v27, 0, v36, s[50:51]
  v_cndmask_b32 v29, 0, v36, s[52:53]
  v_xor_b32 v28, v27, v36
  v_xor_b32 v30, v29, v36
  s_cmp_eq_u32 s8, 0
  s_cselect_b64 s[54:55], s[50:51], 0
  s_cselect_b64 s[14:15], s[52:53], 0
  v_mov_b32 v120, 0
  v_mov_b32 v121, 0
  v_mov_b32 v122, 0
  v_mov_b32 v123, 0
  v_mov_b32 v124, 0
  v_mov_b32 v125, 0
  v_mov_b32 v126, 0
  v_mov_b32 v127, 0
  v_mov_b32 v128, 0
  v_mov_b32 v129, 0
  v_mov_b32 v130, 0
  v_mov_b32 v131, 0
  v_mov_b32 v132, 0
  v_mov_b32 v133, 0
  v_mov_b32 v134, 0
  v_mov_b32 v135, 0
  v_mov_b32 v136, 0
  v_mov_b32 v137, 0
  v_mov_b32 v138, 0
  v_mov_b32 v139, 0
  v_mov_b32 v140, 0
  v_mov_b32 v141, 0
  v_mov_b32 v142, 0
  v_mov_b32 v143, 0
  v_mov_b32 v144, 0
  v_mov_b32 v145, 0
  v_mov_b32 v146, 0
  v_mov_b32 v147, 0
  v_mov_b32 v148, 0
  v_mov_b32 v149, 0
  v_mov_b32 v150, 0
  v_mov_b32 v151, 0
  v_mov_b32 v152, 0
  v_mov_b32 v153, 0
  v_mov_b32 v154, 0
  v_mov_b32 v155, 0
  v_mov_b32 v156, 0
  v_mov_b32 v157, 0
  v_mov_b32 v158, 0
  v_mov_b32 v159, 0
  v_mov_b32 v160, 0
  v_mov_b32 v161, 0
  v_mov_b32 v162, 0
  v_mov_b32 v163, 0
  v_mov_b32 v164, 0
  v_mov_b32 v165, 0
  v_mov_b32 v166, 0
  v_mov_b32 v167, 0
  v_mov_b32 v168, 0
  v_mov_b32 v169, 0
  v_mov_b32 v170, 0
  v_mov_b32 v171, 0
  v_mov_b32 v172, 0
  v_mov_b32 v173, 0
  v_mov_b32 v174, 0
  v_mov_b32 v175, 0
  v_mov_b32 v176, 0
  v_mov_b32 v177, 0
  v_mov_b32 v178, 0
  v_mov_b32 v179, 0
  v_mov_b32 v180, 0
  v_mov_b32 v181, 0
  v_mov_b32 v182, 0
  v_mov_b32 v183, 0
  v_mov_b32 v184, 0
  v_mov_b32 v185, 0
  v_mov_b32 v186, 0
  v_mov_b32 v187, 0
  v_mov_b32 v188, 0
  v_mov_b32 v189, 0
  v_mov_b32 v190, 0
  v_mov_b32 v191, 0
  v_mov_b32 v192, 0
  v_mov_b32 v193, 0
  v_mov_b32 v194, 0
  v_mov_b32 v195, 0
  v_mov_b32 v196, 0
  v_mov_b32 v197, 0
  v_mov_b32 v198, 0
  v_mov_b32 v199, 0
  v_mov_b32 v200, 0
  v_mov_b32 v201, 0
  v_mov_b32 v202, 0
  v_mov_b32 v203, 0
  v_mov_b32 v204, 0
  v_mov_b32 v205, 0
  v_mov_b32 v206, 0
  v_mov_b32 v207, 0
  v_mov_b32 v208, 0
  v_mov_b32 v209, 0
  v_mov_b32 v210, 0
  v_mov_b32 v211, 0
  v_mov_b32 v212, 0
  v_mov_b32 v213, 0
  v_mov_b32 v214, 0
  v_mov_b32 v215, 0
  v_mov_b32 v216, 0
  v_mov_b32 v217, 0
  v_mov_b32 v218, 0
  v_mov_b32 v219, 0
  v_mov_b32 v220, 0
  v_mov_b32 v221, 0
  v_mov_b32 v222, 0
  v_mov_b32 v223, 0
  v_mov_b32 v224, 0
  v_mov_b32 v225, 0
  v_mov_b32 v226, 0
  v_mov_b32 v227, 0
  v_mov_b32 v228, 0
  v_mov_b32 v229, 0
  v_mov_b32 v230, 0
  v_mov_b32 v231, 0
  v_mov_b32 v232, 0
  v_mov_b32 v233, 0
  v_mov_b32 v234, 0
  v_mov_b32 v235, 0
  v_mov_b32 v240, 0
  v_mov_b32 v241, 0
  v_mov_b32 v242, 0
  v_mov_b32 v243, 0
  v_mov_b32 v244, 0
  v_mov_b32 v245, 0
  v_mov_b32 v246, 0
  v_mov_b32 v247, 0
  v_mov_b32 v248, 0
  v_mov_b32 v249, 0
  v_mov_b32 v250, 0
  v_mov_b32 v251, 0
  v_mov_b32 v252, 0
  v_mov_b32 v253, 0
  v_mov_b32 v254, 0
  v_mov_b32 v255, 0
  s_waitcnt lgkmcnt(0)
  s_mov_b32 s44, s34
  s_and_b32 s45, s35, 0xffff
  s_mov_b32 s46, 4194304
  s_mov_b32 s47, 0x00020000
  s_load_dwordx2 s[64:65], s[0:1], 72
  s_or_b32 s3, s96, s70
  s_cbranch_scc1 L_clr_skip0
  s_add_u32 s60, s22, 24903680
  s_addc_u32 s61, s23, 0
  s_and_b32 s61, s61, 0xffff
  s_mov_b32 s62, 262144
  s_mov_b32 s63, 0x00020000
  s_lshl_b32 s3, s2, 10
  v_lshlrev_b32 v2, 4, v1
  buffer_store_dwordx4 v[128:131], v2, s[60:63], s3 offen sc1
L_clr_skip0:
  s_cmp_lg_u32 s96, 0
  s_cbranch_scc1 L_pfc1_skip
  s_getpc_b64 s[4:5]
L_pfc1:
  s_lshl_b32 s3, s99, 2
  s_add_u32 s3, s3, s70
  s_mul_i32 s3, s3, 256
  s_min_u32 s3, s3, L_w2_c1-L_attn_c0-256
  s_add_i32 s3, s3, L_attn_c0-L_pfc1
  s_ashr_i32 s6, s3, 31
  s_add_u32 s4, s4, s3
  s_addc_u32 s5, s5, s6
  s_load_dword s36, s[4:5], 0
  s_load_dword s37, s[4:5], 64
  s_load_dword s38, s[4:5], 128
  s_load_dword s39, s[4:5], 192
L_pfc1_skip:
  s_mov_b32 s75, 0
  v_add_u32_e64 v10, s75, v4
  v_add_u32_e64 v11, s75, v5
  v_add_u32_e64 v12, s75, v6
  v_add_u32_e64 v13, s75, v7
  v_add_u32_e64 v14, s75, v8
  v_add_u32_e64 v15, s75, v9
  s_add_u32 s75, s75, 43008
  s_cmp_eq_u32 s75, 129024
  s_cselect_b32 s75, 0, s75
  s_mov_b32 s79, 16
  s_cmp_eq_u32 s96, 0
  s_cbranch_scc1 L_attn_nog
  s_barrier
L_attn_nog:
  s_barrier
  ds_read_b128 v[32:35], v10 offset:0
  ds_read_b128 v[36:39], v10 offset:2048
  ds_read_b128 v[40:43], v10 offset:4096
  ds_read_b128 v[44:47], v10 offset:6144
  ds_read_b128 v[48:51], v14
  ds_read_b64_tr_b16 v[52:53], v12 offset:0
  ds_read_b64_tr_b16 v[54:55], v12 offset:512
  ds_read_b64_tr_b16 v[56:57], v13 offset:0
  ds_read_b64_tr_b16 v[58:59], v13 offset:512
  ds_read_b64_tr_b16 v[60:61], v12 offset:8192
  ds_read_b64_tr_b16 v[62:63], v12 offset:8704
  ds_read_b64_tr_b16 v[64:65], v13 offset:8192
  ds_read_b64_tr_b16 v[66:67], v13 offset:8704
  ds_read_b64_tr_b16 v[68:69], v12 offset:16384
  ds_read_b64_tr_b16 v[70:71], v12 offset:16896
  ds_read_b64_tr_b16 v[72:73], v13 offset:16384
  ds_read_b64_tr_b16 v[74:75], v13 offset:16896
  s_waitcnt lgkmcnt(0)
  s_cmp_lg_u32 s96, 0
  s_cbranch_scc1 L_attn_loop
  s_cmp_lg_u32 s72, 0
  s_cbranch_scc1 L_attn_loopb
  s_or_b32 s3, s96, s70
  s_cbranch_scc1 L_clr_skip1
  v_mov_b32 v3, 1
  s_and_b32 s65, s65, 0xffff
  s_mov_b32 s66, 256
  s_mov_b32 s67, 0x00020000
  s_mov_b64 exec, 1
  s_waitcnt vmcnt(0)
  buffer_store_byte v3, off, s[64:67], s2 sc1
  s_mov_b64 exec, -1
L_clr_skip1:
.p2align 3
L_attn_loopa:
  v_mfma_f32_16x16x32_bf16 v[240:243], v[236:239], v[32:35], v[240:243]
  ds_read_b128 v[76:79], v11 offset:0
  v_mfma_f32_16x16x32_bf16 v[244:247], v[32:35], v[32:35], v[244:247]
  ds_read_b128 v[80:83], v11 offset:2048
  v_mfma_f32_16x16x32_bf16 v[248:251], v[236:239], v[36:39], v[248:251]
  ds_read_b128 v[84:87], v11 offset:4096
  v_mfma_f32_16x16x32_bf16 v[252:255], v[36:39], v[36:39], v[252:255]
  ds_read_b128 v[88:91], v11 offset:6144
  v_mfma_f32_16x16x32_bf16 v[120:123], v[236:239], v[48:51], v[120:123]
  ds_read_b128 v[92:95], v15
  v_mfma_f32_16x16x32_bf16 v[124:127], v[48:51], v[48:51], v[124:127]
  ds_read_b64_tr_b16 v[96:97], v12 offset:4096
  v_mfma_f32_16x16x32_bf16 v[128:131], v[52:55], v[32:35], v[128:131]
  ds_read_b64_tr_b16 v[98:99], v12 offset:4608
  v_mfma_f32_16x16x32_bf16 v[132:135], v[52:55], v[36:39], v[132:135]
  ds_read_b64_tr_b16 v[100:101], v13 offset:4096
  v_mfma_f32_16x16x32_bf16 v[136:139], v[52:55], v[40:43], v[136:139]
  ds_read_b64_tr_b16 v[102:103], v13 offset:4608
  v_mfma_f32_16x16x32_bf16 v[140:143], v[52:55], v[44:47], v[140:143]
  ds_read_b64_tr_b16 v[104:105], v12 offset:12288
  v_mfma_f32_16x16x32_bf16 v[224:227], v[52:55], v[48:51], v[224:227]
  ds_read_b64_tr_b16 v[106:107], v12 offset:12800
  v_mfma_f32_16x16x32_bf16 v[144:147], v[56:59], v[32:35], v[144:147]
  ds_read_b64_tr_b16 v[108:109], v13 offset:12288
  v_mfma_f32_16x16x32_bf16 v[148:151], v[56:59], v[36:39], v[148:151]
  ds_read_b64_tr_b16 v[110:111], v13 offset:12800
  v_mfma_f32_16x16x32_bf16 v[152:155], v[56:59], v[40:43], v[152:155]
  ds_read_b64_tr_b16 v[112:113], v12 offset:20480
  v_mfma_f32_16x16x32_bf16 v[156:159], v[56:59], v[44:47], v[156:159]
  ds_read_b64_tr_b16 v[114:115], v12 offset:20992
  v_mfma_f32_16x16x32_bf16 v[160:163], v[60:63], v[32:35], v[160:163]
  ds_read_b64_tr_b16 v[116:117], v13 offset:20480
  v_mfma_f32_16x16x32_bf16 v[164:167], v[60:63], v[36:39], v[164:167]
  ds_read_b64_tr_b16 v[118:119], v13 offset:20992
  v_mfma_f32_16x16x32_bf16 v[168:171], v[60:63], v[40:43], v[168:171]
  v_add_u32_e64 v10, s75, v4
  v_mfma_f32_16x16x32_bf16 v[172:175], v[60:63], v[44:47], v[172:175]
  v_add_u32_e64 v11, s75, v5
  v_mfma_f32_16x16x32_bf16 v[228:231], v[60:63], v[48:51], v[228:231]
  v_add_u32_e64 v12, s75, v6
  v_mfma_f32_16x16x32_bf16 v[176:179], v[64:67], v[32:35], v[176:179]
  v_add_u32_e64 v13, s75, v7
  v_mfma_f32_16x16x32_bf16 v[180:183], v[64:67], v[36:39], v[180:183]
  v_add_u32_e64 v14, s75, v8
  v_mfma_f32_16x16x32_bf16 v[184:187], v[64:67], v[40:43], v[184:187]
  v_add_u32_e64 v15, s75, v9
  v_mfma_f32_16x16x32_bf16 v[188:191], v[64:67], v[44:47], v[188:191]
  s_add_u32 s75, s75, 43008
  v_mfma_f32_16x16x32_bf16 v[192:195], v[32:35], v[68:71], v[192:195]
  s_cmp_eq_u32 s75, 129024
  v_mfma_f32_16x16x32_bf16 v[196:199], v[36:39], v[68:71], v[196:199]
  s_cselect_b32 s75, 0, s75
  s_sub_u32 s79, s79, 1
  v_mfma_f32_16x16x32_bf16 v[200:203], v[40:43], v[68:71], v[200:203]
  v_mfma_f32_16x16x32_bf16 v[204:207], v[44:47], v[68:71], v[204:207]
  v_mfma_f32_16x16x32_bf16 v[232:235], v[48:51], v[68:71], v[232:235]
  v_mfma_f32_16x16x32_bf16 v[208:211], v[32:35], v[72:75], v[208:211]
  v_mfma_f32_16x16x32_bf16 v[212:215], v[36:39], v[72:75], v[212:215]
  v_mfma_f32_16x16x32_bf16 v[216:219], v[40:43], v[72:75], v[216:219]
  v_mfma_f32_16x16x32_bf16 v[220:223], v[44:47], v[72:75], v[220:223]
  s_waitcnt lgkmcnt(0)
  s_barrier
  v_mfma_f32_16x16x32_bf16 v[240:243], v[236:239], v[76:79], v[240:243]
  ds_read_b128 v[32:35], v10 offset:0
  v_mfma_f32_16x16x32_bf16 v[244:247], v[76:79], v[76:79], v[244:247]
  ds_read_b128 v[36:39], v10 offset:2048
  v_mfma_f32_16x16x32_bf16 v[248:251], v[236:239], v[80:83], v[248:251]
  ds_read_b128 v[40:43], v10 offset:4096
  v_mfma_f32_16x16x32_bf16 v[252:255], v[80:83], v[80:83], v[252:255]
  ds_read_b128 v[44:47], v10 offset:6144
  v_mfma_f32_16x16x32_bf16 v[120:123], v[236:239], v[92:95], v[120:123]
  ds_read_b128 v[48:51], v14
  v_mfma_f32_16x16x32_bf16 v[124:127], v[92:95], v[92:95], v[124:127]
  ds_read_b64_tr_b16 v[52:53], v12 offset:0
  v_mfma_f32_16x16x32_bf16 v[128:131], v[96:99], v[76:79], v[128:131]
  ds_read_b64_tr_b16 v[54:55], v12 offset:512
  v_mfma_f32_16x16x32_bf16 v[132:135], v[96:99], v[80:83], v[132:135]
  ds_read_b64_tr_b16 v[56:57], v13 offset:0
  v_mfma_f32_16x16x32_bf16 v[136:139], v[96:99], v[84:87], v[136:139]
  ds_read_b64_tr_b16 v[58:59], v13 offset:512
  v_mfma_f32_16x16x32_bf16 v[140:143], v[96:99], v[88:91], v[140:143]
  ds_read_b64_tr_b16 v[60:61], v12 offset:8192
  v_mfma_f32_16x16x32_bf16 v[224:227], v[96:99], v[92:95], v[224:227]
  ds_read_b64_tr_b16 v[62:63], v12 offset:8704
  v_mfma_f32_16x16x32_bf16 v[144:147], v[100:103], v[76:79], v[144:147]
  ds_read_b64_tr_b16 v[64:65], v13 offset:8192
  v_mfma_f32_16x16x32_bf16 v[148:151], v[100:103], v[80:83], v[148:151]
  ds_read_b64_tr_b16 v[66:67], v13 offset:8704
  v_mfma_f32_16x16x32_bf16 v[152:155], v[100:103], v[84:87], v[152:155]
  ds_read_b64_tr_b16 v[68:69], v12 offset:16384
  v_mfma_f32_16x16x32_bf16 v[156:159], v[100:103], v[88:91], v[156:159]
  ds_read_b64_tr_b16 v[70:71], v12 offset:16896
  v_mfma_f32_16x16x32_bf16 v[160:163], v[104:107], v[76:79], v[160:163]
  ds_read_b64_tr_b16 v[72:73], v13 offset:16384
  v_mfma_f32_16x16x32_bf16 v[164:167], v[104:107], v[80:83], v[164:167]
  ds_read_b64_tr_b16 v[74:75], v13 offset:16896
  v_mfma_f32_16x16x32_bf16 v[168:171], v[104:107], v[84:87], v[168:171]
  s_cmp_lg_u32 s79, 0
  s_nop 0
  v_mfma_f32_16x16x32_bf16 v[172:175], v[104:107], v[88:91], v[172:175]
  v_mfma_f32_16x16x32_bf16 v[228:231], v[104:107], v[92:95], v[228:231]
  v_mfma_f32_16x16x32_bf16 v[176:179], v[108:111], v[76:79], v[176:179]
  v_mfma_f32_16x16x32_bf16 v[180:183], v[108:111], v[80:83], v[180:183]
  v_mfma_f32_16x16x32_bf16 v[184:187], v[108:111], v[84:87], v[184:187]
  v_mfma_f32_16x16x32_bf16 v[188:191], v[108:111], v[88:91], v[188:191]
  v_mfma_f32_16x16x32_bf16 v[192:195], v[76:79], v[112:115], v[192:195]
  v_mfma_f32_16x16x32_bf16 v[196:199], v[80:83], v[112:115], v[196:199]
  v_mfma_f32_16x16x32_bf16 v[200:203], v[84:87], v[112:115], v[200:203]
  v_mfma_f32_16x16x32_bf16 v[204:207], v[88:91], v[112:115], v[204:207]
  v_mfma_f32_16x16x32_bf16 v[232:235], v[92:95], v[112:115], v[232:235]
  v_mfma_f32_16x16x32_bf16 v[208:211], v[76:79], v[116:119], v[208:211]
  v_mfma_f32_16x16x32_bf16 v[212:215], v[80:83], v[116:119], v[212:215]
  v_mfma_f32_16x16x32_bf16 v[216:219], v[84:87], v[116:119], v[216:219]
  v_mfma_f32_16x16x32_bf16 v[220:223], v[88:91], v[116:119], v[220:223]
  s_waitcnt lgkmcnt(0)
  s_cbranch_scc1 L_attn_loopa
  s_branch L_attn_post
.p2align 3
L_attn_loopb:
  v_mfma_f32_16x16x32_bf16 v[240:243], v[236:239], v[40:43], v[240:243]
  ds_read_b128 v[76:79], v11 offset:0
  v_mfma_f32_16x16x32_bf16 v[244:247], v[40:43], v[40:43], v[244:247]
  ds_read_b128 v[80:83], v11 offset:2048
  v_mfma_f32_16x16x32_bf16 v[248:251], v[236:239], v[44:47], v[248:251]
  ds_read_b128 v[84:87], v11 offset:4096
  v_mfma_f32_16x16x32_bf16 v[252:255], v[44:47], v[44:47], v[252:255]
  ds_read_b128 v[88:91], v11 offset:6144
  v_mfma_f32_16x16x32_bf16 v[128:131], v[52:55], v[32:35], v[128:131]
  ds_read_b128 v[92:95], v15
  v_mfma_f32_16x16x32_bf16 v[132:135], v[52:55], v[36:39], v[132:135]
  ds_read_b64_tr_b16 v[96:97], v12 offset:4096
  v_mfma_f32_16x16x32_bf16 v[136:139], v[52:55], v[40:43], v[136:139]
  ds_read_b64_tr_b16 v[98:99], v12 offset:4608
  v_mfma_f32_16x16x32_bf16 v[140:143], v[52:55], v[44:47], v[140:143]
  ds_read_b64_tr_b16 v[100:101], v13 offset:4096
  v_mfma_f32_16x16x32_bf16 v[224:227], v[52:55], v[48:51], v[224:227]
  ds_read_b64_tr_b16 v[102:103], v13 offset:4608
  v_mfma_f32_16x16x32_bf16 v[144:147], v[56:59], v[32:35], v[144:147]
  ds_read_b64_tr_b16 v[104:105], v12 offset:12288
  v_mfma_f32_16x16x32_bf16 v[148:151], v[56:59], v[36:39], v[148:151]
  ds_read_b64_tr_b16 v[106:107], v12 offset:12800
  v_mfma_f32_16x16x32_bf16 v[152:155], v[56:59], v[40:43], v[152:155]
  ds_read_b64_tr_b16 v[108:109], v13 offset:12288
  v_mfma_f32_16x16x32_bf16 v[156:159], v[56:59], v[44:47], v[156:159]
  ds_read_b64_tr_b16 v[110:111], v13 offset:12800
  v_mfma_f32_16x16x32_bf16 v[160:163], v[60:63], v[32:35], v[160:163]
  ds_read_b64_tr_b16 v[112:113], v12 offset:20480
  v_mfma_f32_16x16x32_bf16 v[164:167], v[60:63], v[36:39], v[164:167]
  ds_read_b64_tr_b16 v[114:115], v12 offset:20992
  v_mfma_f32_16x16x32_bf16 v[168:171], v[60:63], v[40:43], v[168:171]
  ds_read_b64_tr_b16 v[116:117], v13 offset:20480
  v_mfma_f32_16x16x32_bf16 v[172:175], v[60:63], v[44:47], v[172:175]
  ds_read_b64_tr_b16 v[118:119], v13 offset:20992
  v_mfma_f32_16x16x32_bf16 v[228:231], v[60:63], v[48:51], v[228:231]
  v_add_u32_e64 v10, s75, v4
  v_mfma_f32_16x16x32_bf16 v[176:179], v[64:67], v[32:35], v[176:179]
  v_add_u32_e64 v11, s75, v5
  v_mfma_f32_16x16x32_bf16 v[180:183], v[64:67], v[36:39], v[180:183]
  v_add_u32_e64 v12, s75, v6
  v_mfma_f32_16x16x32_bf16 v[184:187], v[64:67], v[40:43], v[184:187]
  v_add_u32_e64 v13, s75, v7
  v_mfma_f32_16x16x32_bf16 v[188:191], v[64:67], v[44:47], v[188:191]
  v_add_u32_e64 v14, s75, v8
  v_mfma_f32_16x16x32_bf16 v[192:195], v[32:35], v[68:71], v[192:195]
  v_add_u32_e64 v15, s75, v9
  v_mfma_f32_16x16x32_bf16 v[196:199], v[36:39], v[68:71], v[196:199]
  s_add_u32 s75, s75, 43008
  v_mfma_f32_16x16x32_bf16 v[200:203], v[40:43], v[68:71], v[200:203]
  s_cmp_eq_u32 s75, 129024
  v_mfma_f32_16x16x32_bf16 v[204:207], v[44:47], v[68:71], v[204:207]
  s_cselect_b32 s75, 0, s75
  s_sub_u32 s79, s79, 1
  v_mfma_f32_16x16x32_bf16 v[232:235], v[48:51], v[68:71], v[232:235]
  v_mfma_f32_16x16x32_bf16 v[208:211], v[32:35], v[72:75], v[208:211]
  v_mfma_f32_16x16x32_bf16 v[212:215], v[36:39], v[72:75], v[212:215]
  v_mfma_f32_16x16x32_bf16 v[216:219], v[40:43], v[72:75], v[216:219]
  v_mfma_f32_16x16x32_bf16 v[220:223], v[44:47], v[72:75], v[220:223]
  s_waitcnt lgkmcnt(0)
  s_barrier
  v_mfma_f32_16x16x32_bf16 v[240:243], v[236:239], v[84:87], v[240:243]
  ds_read_b128 v[32:35], v10 offset:0
  v_mfma_f32_16x16x32_bf16 v[244:247], v[84:87], v[84:87], v[244:247]
  ds_read_b128 v[36:39], v10 offset:2048
  v_mfma_f32_16x16x32_bf16 v[248:251], v[236:239], v[88:91], v[248:251]
  ds_read_b128 v[40:43], v10 offset:4096
  v_mfma_f32_16x16x32_bf16 v[252:255], v[88:91], v[88:91], v[252:255]
  ds_read_b128 v[44:47], v10 offset:6144
  v_mfma_f32_16x16x32_bf16 v[128:131], v[96:99], v[76:79], v[128:131]
  ds_read_b128 v[48:51], v14
  v_mfma_f32_16x16x32_bf16 v[132:135], v[96:99], v[80:83], v[132:135]
  ds_read_b64_tr_b16 v[52:53], v12 offset:0
  v_mfma_f32_16x16x32_bf16 v[136:139], v[96:99], v[84:87], v[136:139]
  ds_read_b64_tr_b16 v[54:55], v12 offset:512
  v_mfma_f32_16x16x32_bf16 v[140:143], v[96:99], v[88:91], v[140:143]
  ds_read_b64_tr_b16 v[56:57], v13 offset:0
  v_mfma_f32_16x16x32_bf16 v[224:227], v[96:99], v[92:95], v[224:227]
  ds_read_b64_tr_b16 v[58:59], v13 offset:512
  v_mfma_f32_16x16x32_bf16 v[144:147], v[100:103], v[76:79], v[144:147]
  ds_read_b64_tr_b16 v[60:61], v12 offset:8192
  v_mfma_f32_16x16x32_bf16 v[148:151], v[100:103], v[80:83], v[148:151]
  ds_read_b64_tr_b16 v[62:63], v12 offset:8704
  v_mfma_f32_16x16x32_bf16 v[152:155], v[100:103], v[84:87], v[152:155]
  ds_read_b64_tr_b16 v[64:65], v13 offset:8192
  v_mfma_f32_16x16x32_bf16 v[156:159], v[100:103], v[88:91], v[156:159]
  ds_read_b64_tr_b16 v[66:67], v13 offset:8704
  v_mfma_f32_16x16x32_bf16 v[160:163], v[104:107], v[76:79], v[160:163]
  ds_read_b64_tr_b16 v[68:69], v12 offset:16384
  v_mfma_f32_16x16x32_bf16 v[164:167], v[104:107], v[80:83], v[164:167]
  ds_read_b64_tr_b16 v[70:71], v12 offset:16896
  v_mfma_f32_16x16x32_bf16 v[168:171], v[104:107], v[84:87], v[168:171]
  ds_read_b64_tr_b16 v[72:73], v13 offset:16384
  v_mfma_f32_16x16x32_bf16 v[172:175], v[104:107], v[88:91], v[172:175]
  ds_read_b64_tr_b16 v[74:75], v13 offset:16896
  v_mfma_f32_16x16x32_bf16 v[228:231], v[104:107], v[92:95], v[228:231]
  s_cmp_lg_u32 s79, 0
  s_nop 0
  v_mfma_f32_16x16x32_bf16 v[176:179], v[108:111], v[76:79], v[176:179]
  v_mfma_f32_16x16x32_bf16 v[180:183], v[108:111], v[80:83], v[180:183]
  v_mfma_f32_16x16x32_bf16 v[184:187], v[108:111], v[84:87], v[184:187]
  v_mfma_f32_16x16x32_bf16 v[188:191], v[108:111], v[88:91], v[188:191]
  v_mfma_f32_16x16x32_bf16 v[192:195], v[76:79], v[112:115], v[192:195]
  v_mfma_f32_16x16x32_bf16 v[196:199], v[80:83], v[112:115], v[196:199]
  v_mfma_f32_16x16x32_bf16 v[200:203], v[84:87], v[112:115], v[200:203]
  v_mfma_f32_16x16x32_bf16 v[204:207], v[88:91], v[112:115], v[204:207]
  v_mfma_f32_16x16x32_bf16 v[232:235], v[92:95], v[112:115], v[232:235]
  v_mfma_f32_16x16x32_bf16 v[208:211], v[76:79], v[116:119], v[208:211]
  v_mfma_f32_16x16x32_bf16 v[212:215], v[80:83], v[116:119], v[212:215]
  v_mfma_f32_16x16x32_bf16 v[216:219], v[84:87], v[116:119], v[216:219]
  v_mfma_f32_16x16x32_bf16 v[220:223], v[88:91], v[116:119], v[220:223]
  s_waitcnt lgkmcnt(0)
  s_cbranch_scc1 L_attn_loopb
L_attn_post:
  v_and_b32 v32, 3, v1
  v_cmp_eq_u32 s[4:5], 1, v32
  v_cmp_eq_u32 s[6:7], 2, v32
  v_cmp_eq_u32 s[8:9], 3, v32
  v_bfe_u32 v33, v1, 2, 2
  v_lshrrev_b32 v34, 4, v1
  v_cmp_eq_u32 s[10:11], v33, v34
  s_lshl_b32 s3, s72, 7
  v_add_u32 v35, s3, v23
  v_and_b32 v36, 15, v1
  s_cmp_eq_u32 s70, 0
  s_cselect_b32 s3, 0, 576
  s_add_u32 s3, s3, 129024
  v_lshl_add_u32 v36, v36, 2, s3
  v_cndmask_b32 v241, v244, v245, s[4:5]
  v_cndmask_b32 v249, v252, v253, s[4:5]
  v_cndmask_b32 v121, v124, v125, s[4:5]
  v_cndmask_b32 v241, v241, v246, s[6:7]
  v_cndmask_b32 v249, v249, v254, s[6:7]
  v_cndmask_b32 v121, v121, v126, s[6:7]
  v_cndmask_b32 v241, v241, v247, s[8:9]
  v_cndmask_b32 v249, v249, v255, s[8:9]
  v_cndmask_b32 v121, v121, v127, s[8:9]
  v_mul_f32 v240, 0x3a800000, v240
  v_mul_f32 v241, 0x3a800000, v241
  v_fma_f32 v241, -v240, v240, v241
  v_max_f32 v241, 0, v241
  v_add_f32 v241, 0x3727c5ac, v241
  v_rsq_f32 v241, v241
  s_nop 0
  v_mul_f32 v248, 0x3a800000, v248
  v_mul_f32 v249, 0x3a800000, v249
  v_fma_f32 v249, -v248, v248, v249
  v_max_f32 v249, 0, v249
  v_add_f32 v249, 0x3727c5ac, v249
  v_rsq_f32 v249, v249
  s_nop 0
  v_mul_f32 v120, 0x3a800000, v120
  v_mul_f32 v121, 0x3a800000, v121
  v_fma_f32 v121, -v120, v120, v121
  v_max_f32 v121, 0, v121
  v_add_f32 v121, 0x3727c5ac, v121
  v_rsq_f32 v121, v121
  s_nop 0
  s_mov_b64 exec, s[10:11]
  ds_write2_b32 v35, v240, v241 offset0:16 offset1:176
  ds_write2_b32 v35, v248, v249 offset0:32 offset1:192
  ds_write2_b32 v36, v120, v121 offset0:0 offset1:160
  s_mov_b64 exec, -1
  s_waitcnt lgkmcnt(0)
  s_barrier
  s_branch L_attn_exit
.p2align 3
L_attn_loop:
  v_mfma_f32_16x16x32_bf16 v[128:131], v[52:55], v[32:35], v[128:131]
  ds_read_b128 v[76:79], v11 offset:0
  v_mfma_f32_16x16x32_bf16 v[132:135], v[52:55], v[36:39], v[132:135]
  ds_read_b128 v[80:83], v11 offset:2048
  v_mfma_f32_16x16x32_bf16 v[136:139], v[52:55], v[40:43], v[136:139]
  ds_read_b128 v[84:87], v11 offset:4096
  v_mfma_f32_16x16x32_bf16 v[140:143], v[52:55], v[44:47], v[140:143]
  ds_read_b128 v[88:91], v11 offset:6144
  v_mfma_f32_16x16x32_bf16 v[224:227], v[52:55], v[48:51], v[224:227]
  ds_read_b128 v[92:95], v15
  v_mfma_f32_16x16x32_bf16 v[144:147], v[56:59], v[32:35], v[144:147]
  ds_read_b64_tr_b16 v[96:97], v12 offset:4096
  v_mfma_f32_16x16x32_bf16 v[148:151], v[56:59], v[36:39], v[148:151]
  ds_read_b64_tr_b16 v[98:99], v12 offset:4608
  v_mfma_f32_16x16x32_bf16 v[152:155], v[56:59], v[40:43], v[152:155]
  ds_read_b64_tr_b16 v[100:101], v13 offset:4096
  v_mfma_f32_16x16x32_bf16 v[156:159], v[56:59], v[44:47], v[156:159]
  ds_read_b64_tr_b16 v[102:103], v13 offset:4608
  v_mfma_f32_16x16x32_bf16 v[160:163], v[60:63], v[32:35], v[160:163]
  ds_read_b64_tr_b16 v[104:105], v12 offset:12288
  v_mfma_f32_16x16x32_bf16 v[164:167], v[60:63], v[36:39], v[164:167]
  ds_read_b64_tr_b16 v[106:107], v12 offset:12800
  v_mfma_f32_16x16x32_bf16 v[168:171], v[60:63], v[40:43], v[168:171]
  ds_read_b64_tr_b16 v[108:109], v13 offset:12288
  v_mfma_f32_16x16x32_bf16 v[172:175], v[60:63], v[44:47], v[172:175]
  ds_read_b64_tr_b16 v[110:111], v13 offset:12800
  v_mfma_f32_16x16x32_bf16 v[228:231], v[60:63], v[48:51], v[228:231]
  ds_read_b64_tr_b16 v[112:113], v12 offset:20480
  v_mfma_f32_16x16x32_bf16 v[176:179], v[64:67], v[32:35], v[176:179]
  ds_read_b64_tr_b16 v[114:115], v12 offset:20992
  v_mfma_f32_16x16x32_bf16 v[180:183], v[64:67], v[36:39], v[180:183]
  ds_read_b64_tr_b16 v[116:117], v13 offset:20480
  v_mfma_f32_16x16x32_bf16 v[184:187], v[64:67], v[40:43], v[184:187]
  ds_read_b64_tr_b16 v[118:119], v13 offset:20992
  v_mfma_f32_16x16x32_bf16 v[188:191], v[64:67], v[44:47], v[188:191]
  v_add_u32_e64 v10, s75, v4
  v_mfma_f32_16x16x32_bf16 v[192:195], v[32:35], v[68:71], v[192:195]
  v_add_u32_e64 v11, s75, v5
  v_mfma_f32_16x16x32_bf16 v[196:199], v[36:39], v[68:71], v[196:199]
  v_add_u32_e64 v12, s75, v6
  v_mfma_f32_16x16x32_bf16 v[200:203], v[40:43], v[68:71], v[200:203]
  v_add_u32_e64 v13, s75, v7
  v_mfma_f32_16x16x32_bf16 v[204:207], v[44:47], v[68:71], v[204:207]
  v_add_u32_e64 v14, s75, v8
  v_mfma_f32_16x16x32_bf16 v[232:235], v[48:51], v[68:71], v[232:235]
  v_add_u32_e64 v15, s75, v9
  v_mfma_f32_16x16x32_bf16 v[208:211], v[32:35], v[72:75], v[208:211]
  s_add_u32 s75, s75, 43008
  v_mfma_f32_16x16x32_bf16 v[212:215], v[36:39], v[72:75], v[212:215]
  s_cmp_eq_u32 s75, 129024
  v_mfma_f32_16x16x32_bf16 v[216:219], v[40:43], v[72:75], v[216:219]
  s_cselect_b32 s75, 0, s75
  s_sub_u32 s79, s79, 1
  v_mfma_f32_16x16x32_bf16 v[220:223], v[44:47], v[72:75], v[220:223]
  s_waitcnt lgkmcnt(0)
  s_barrier
  v_mfma_f32_16x16x32_bf16 v[128:131], v[96:99], v[76:79], v[128:131]
  ds_read_b128 v[32:35], v10 offset:0
  v_mfma_f32_16x16x32_bf16 v[132:135], v[96:99], v[80:83], v[132:135]
  ds_read_b128 v[36:39], v10 offset:2048
  v_mfma_f32_16x16x32_bf16 v[136:139], v[96:99], v[84:87], v[136:139]
  ds_read_b128 v[40:43], v10 offset:4096
  v_mfma_f32_16x16x32_bf16 v[140:143], v[96:99], v[88:91], v[140:143]
  ds_read_b128 v[44:47], v10 offset:6144
  v_mfma_f32_16x16x32_bf16 v[224:227], v[96:99], v[92:95], v[224:227]
  ds_read_b128 v[48:51], v14
  v_mfma_f32_16x16x32_bf16 v[144:147], v[100:103], v[76:79], v[144:147]
  ds_read_b64_tr_b16 v[52:53], v12 offset:0
  v_mfma_f32_16x16x32_bf16 v[148:151], v[100:103], v[80:83], v[148:151]
  ds_read_b64_tr_b16 v[54:55], v12 offset:512
  v_mfma_f32_16x16x32_bf16 v[152:155], v[100:103], v[84:87], v[152:155]
  ds_read_b64_tr_b16 v[56:57], v13 offset:0
  v_mfma_f32_16x16x32_bf16 v[156:159], v[100:103], v[88:91], v[156:159]
  ds_read_b64_tr_b16 v[58:59], v13 offset:512
  v_mfma_f32_16x16x32_bf16 v[160:163], v[104:107], v[76:79], v[160:163]
  ds_read_b64_tr_b16 v[60:61], v12 offset:8192
  v_mfma_f32_16x16x32_bf16 v[164:167], v[104:107], v[80:83], v[164:167]
  ds_read_b64_tr_b16 v[62:63], v12 offset:8704
  v_mfma_f32_16x16x32_bf16 v[168:171], v[104:107], v[84:87], v[168:171]
  ds_read_b64_tr_b16 v[64:65], v13 offset:8192
  v_mfma_f32_16x16x32_bf16 v[172:175], v[104:107], v[88:91], v[172:175]
  ds_read_b64_tr_b16 v[66:67], v13 offset:8704
  v_mfma_f32_16x16x32_bf16 v[228:231], v[104:107], v[92:95], v[228:231]
  ds_read_b64_tr_b16 v[68:69], v12 offset:16384
  v_mfma_f32_16x16x32_bf16 v[176:179], v[108:111], v[76:79], v[176:179]
  ds_read_b64_tr_b16 v[70:71], v12 offset:16896
  v_mfma_f32_16x16x32_bf16 v[180:183], v[108:111], v[80:83], v[180:183]
  ds_read_b64_tr_b16 v[72:73], v13 offset:16384
  v_mfma_f32_16x16x32_bf16 v[184:187], v[108:111], v[84:87], v[184:187]
  ds_read_b64_tr_b16 v[74:75], v13 offset:16896
  v_mfma_f32_16x16x32_bf16 v[188:191], v[108:111], v[88:91], v[188:191]
  s_cmp_lg_u32 s79, 0
  s_nop 0
  v_mfma_f32_16x16x32_bf16 v[192:195], v[76:79], v[112:115], v[192:195]
  v_mfma_f32_16x16x32_bf16 v[196:199], v[80:83], v[112:115], v[196:199]
  v_mfma_f32_16x16x32_bf16 v[200:203], v[84:87], v[112:115], v[200:203]
  v_mfma_f32_16x16x32_bf16 v[204:207], v[88:91], v[112:115], v[204:207]
  v_mfma_f32_16x16x32_bf16 v[232:235], v[92:95], v[112:115], v[232:235]
  v_mfma_f32_16x16x32_bf16 v[208:211], v[76:79], v[116:119], v[208:211]
  v_mfma_f32_16x16x32_bf16 v[212:215], v[80:83], v[116:119], v[212:215]
  v_mfma_f32_16x16x32_bf16 v[216:219], v[84:87], v[116:119], v[216:219]
  v_mfma_f32_16x16x32_bf16 v[220:223], v[88:91], v[116:119], v[220:223]
  s_waitcnt lgkmcnt(0)
  s_cbranch_scc1 L_attn_loop
L_attn_exit:
  ds_read2_b32 v[66:67], v23 offset0:0 offset1:160
  ds_read2_b32 v[68:69], v23 offset0:16 offset1:176
  ds_read2_b32 v[70:71], v23 offset0:32 offset1:192
  ds_read2_b32 v[72:73], v23 offset0:48 offset1:208
  ds_read2_b32 v[74:75], v23 offset0:64 offset1:224
  ds_read2_b32 v[76:77], v25 offset0:0 offset1:16
  ds_read2_b32 v[80:81], v26 offset0:0 offset1:16
  ds_read2_b32 v[78:79], v25 offset0:32 offset1:48
  ds_read2_b32 v[82:83], v26 offset0:32 offset1:48
  ds_write_b128 v16, v[224:227] offset:0
  ds_write_b128 v16, v[228:231] offset:2048
  ds_write_b128 v16, v[232:235] offset:4096
  s_cmp_eq_u32 s71, 1
  s_cbranch_scc1 L_attn_nop3
  ds_write_b128 v16, v[172:175] offset:8192
  ds_write_b128 v16, v[188:191] offset:9216
  ds_write_b128 v16, v[204:207] offset:10240
  ds_write_b128 v16, v[220:223] offset:11264
L_attn_nop3:
  ds_read_b128 v[84:87], v24 offset:0
  ds_read_b128 v[104:107], v24 offset:640
  ds_read_b128 v[88:91], v24 offset:64
  ds_read_b128 v[108:111], v24 offset:704
  ds_read_b128 v[92:95], v24 offset:128
  ds_read_b128 v[112:115], v24 offset:768
  ds_read_b128 v[96:99], v24 offset:192
  ds_read_b128 v[116:119], v24 offset:832
  ds_read_b128 v[100:103], v24 offset:256
  ds_read_b128 v[120:123], v24 offset:896
  s_waitcnt lgkmcnt(10)
  s_barrier
  ds_read_b128 v[48:51], v19 offset:0
  ds_read_b128 v[52:55], v20 offset:1024
  ds_read_b128 v[56:59], v19 offset:2048
  ds_read_b128 v[60:63], v20 offset:3072
  ds_read_b32 v64, v21 offset:4096
  ds_read_b32 v65, v22 offset:5120
  ds_read_b128 v[32:35], v17 offset:2048
  ds_read_b128 v[36:39], v18 offset:3072
  ds_read_b128 v[40:43], v17 offset:4096
  ds_read_b128 v[44:47], v18 offset:5120
  v_mul_f32 v69, 0x3e8293ee, v69
  v_mul_f32 v71, 0x3e8293ee, v71
  v_mul_f32 v73, 0x3e8293ee, v73
  v_mul_f32 v75, 0x3e8293ee, v75
  v_mul_f32 v76, v76, v69
  v_mul_f32 v80, v80, v69
  v_mul_f32 v77, v77, v71
  v_mul_f32 v81, v81, v71
  v_mul_f32 v78, v78, v73
  v_mul_f32 v82, v82, v73
  v_mul_f32 v79, v79, v75
  v_mul_f32 v83, v83, v75
  s_waitcnt lgkmcnt(6)
  v_pk_fma_f32 v[128:129], v[48:49], v[68:69], v[128:129] op_sel:[0,0,0] op_sel_hi:[1,0,1] neg_lo:[0,1,0] neg_hi:[0,1,0]
  v_pk_fma_f32 v[130:131], v[50:51], v[68:69], v[130:131] op_sel:[0,0,0] op_sel_hi:[1,0,1] neg_lo:[0,1,0] neg_hi:[0,1,0]
  v_pk_fma_f32 v[144:145], v[52:53], v[68:69], v[144:145] op_sel:[0,0,0] op_sel_hi:[1,0,1] neg_lo:[0,1,0] neg_hi:[0,1,0]
  v_pk_fma_f32 v[146:147], v[54:55], v[68:69], v[146:147] op_sel:[0,0,0] op_sel_hi:[1,0,1] neg_lo:[0,1,0] neg_hi:[0,1,0]
  v_cvt_pk_bf16_f32 v128, v128, v129
  v_cvt_pk_bf16_f32 v129, v130, v131
  v_cvt_pk_bf16_f32 v130, v144, v145
  v_cvt_pk_bf16_f32 v131, v146, v147
  v_pk_fma_f32 v[160:161], v[56:57], v[68:69], v[160:161] op_sel:[0,0,0] op_sel_hi:[1,0,1] neg_lo:[0,1,0] neg_hi:[0,1,0]
  v_pk_fma_f32 v[162:163], v[58:59], v[68:69], v[162:163] op_sel:[0,0,0] op_sel_hi:[1,0,1] neg_lo:[0,1,0] neg_hi:[0,1,0]
  v_pk_fma_f32 v[176:177], v[60:61], v[68:69], v[176:177] op_sel:[0,0,0] op_sel_hi:[1,0,1] neg_lo:[0,1,0] neg_hi:[0,1,0]
  v_pk_fma_f32 v[178:179], v[62:63], v[68:69], v[178:179] op_sel:[0,0,0] op_sel_hi:[1,0,1] neg_lo:[0,1,0] neg_hi:[0,1,0]
  v_cvt_pk_bf16_f32 v160, v160, v161
  v_cvt_pk_bf16_f32 v161, v162, v163
  v_cvt_pk_bf16_f32 v162, v176, v177
  v_cvt_pk_bf16_f32 v163, v178, v179
  v_pk_fma_f32 v[132:133], v[48:49], v[70:71], v[132:133] op_sel:[0,0,0] op_sel_hi:[1,0,1] neg_lo:[0,1,0] neg_hi:[0,1,0]
  v_pk_fma_f32 v[134:135], v[50:51], v[70:71], v[134:135] op_sel:[0,0,0] op_sel_hi:[1,0,1] neg_lo:[0,1,0] neg_hi:[0,1,0]
  v_pk_fma_f32 v[148:149], v[52:53], v[70:71], v[148:149] op_sel:[0,0,0] op_sel_hi:[1,0,1] neg_lo:[0,1,0] neg_hi:[0,1,0]
  v_pk_fma_f32 v[150:151], v[54:55], v[70:71], v[150:151] op_sel:[0,0,0] op_sel_hi:[1,0,1] neg_lo:[0,1,0] neg_hi:[0,1,0]
  v_cvt_pk_bf16_f32 v132, v132, v133
  v_cvt_pk_bf16_f32 v133, v134, v135
  v_cvt_pk_bf16_f32 v134, v148, v149
  v_cvt_pk_bf16_f32 v135, v150, v151
  v_pk_fma_f32 v[164:165], v[56:57], v[70:71], v[164:165] op_sel:[0,0,0] op_sel_hi:[1,0,1] neg_lo:[0,1,0] neg_hi:[0,1,0]
  v_pk_fma_f32 v[166:167], v[58:59], v[70:71], v[166:167] op_sel:[0,0,0] op_sel_hi:[1,0,1] neg_lo:[0,1,0] neg_hi:[0,1,0]
  v_pk_fma_f32 v[180:181], v[60:61], v[70:71], v[180:181] op_sel:[0,0,0] op_sel_hi:[1,0,1] neg_lo:[0,1,0] neg_hi:[0,1,0]
  v_pk_fma_f32 v[182:183], v[62:63], v[70:71], v[182:183] op_sel:[0,0,0] op_sel_hi:[1,0,1] neg_lo:[0,1,0] neg_hi:[0,1,0]
  v_cvt_pk_bf16_f32 v164, v164, v165
  v_cvt_pk_bf16_f32 v165, v166, v167
  v_cvt_pk_bf16_f32 v166, v180, v181
  v_cvt_pk_bf16_f32 v167, v182, v183
  v_mfma_f32_16x16x32_bf16 v[144:147], v[160:163], v[128:131], 0
  v_pk_fma_f32 v[136:137], v[48:49], v[72:73], v[136:137] op_sel:[0,0,0] op_sel_hi:[1,0,1] neg_lo:[0,1,0] neg_hi:[0,1,0]
  v_pk_fma_f32 v[138:139], v[50:51], v[72:73], v[138:139] op_sel:[0,0,0] op_sel_hi:[1,0,1] neg_lo:[0,1,0] neg_hi:[0,1,0]
  v_pk_fma_f32 v[152:153], v[52:53], v[72:73], v[152:153] op_sel:[0,0,0] op_sel_hi:[1,0,1] neg_lo:[0,1,0] neg_hi:[0,1,0]
  v_pk_fma_f32 v[154:155], v[54:55], v[72:73], v[154:155] op_sel:[0,0,0] op_sel_hi:[1,0,1] neg_lo:[0,1,0] neg_hi:[0,1,0]
  v_cvt_pk_bf16_f32 v136, v136, v137
  v_cvt_pk_bf16_f32 v137, v138, v139
  v_cvt_pk_bf16_f32 v138, v152, v153
  v_cvt_pk_bf16_f32 v139, v154, v155
  v_pk_fma_f32 v[168:169], v[56:57], v[72:73], v[168:169] op_sel:[0,0,0] op_sel_hi:[1,0,1] neg_lo:[0,1,0] neg_hi:[0,1,0]
  v_pk_fma_f32 v[170:171], v[58:59], v[72:73], v[170:171] op_sel:[0,0,0] op_sel_hi:[1,0,1] neg_lo:[0,1,0] neg_hi:[0,1,0]
  v_pk_fma_f32 v[184:185], v[60:61], v[72:73], v[184:185] op_sel:[0,0,0] op_sel_hi:[1,0,1] neg_lo:[0,1,0] neg_hi:[0,1,0]
  v_pk_fma_f32 v[186:187], v[62:63], v[72:73], v[186:187] op_sel:[0,0,0] op_sel_hi:[1,0,1] neg_lo:[0,1,0] neg_hi:[0,1,0]
  v_cvt_pk_bf16_f32 v168, v168, v169
  v_cvt_pk_bf16_f32 v169, v170, v171
  v_cvt_pk_bf16_f32 v170, v184, v185
  v_cvt_pk_bf16_f32 v171, v186, v187
  v_mfma_f32_16x16x32_bf16 v[148:151], v[164:167], v[132:135], 0
  v_mfma_f32_16x16x32_bf16 v[180:183], v[160:163], v[132:135], 0
  v_pk_fma_f32 v[140:141], v[48:49], v[74:75], v[140:141] op_sel:[0,0,0] op_sel_hi:[1,0,1] neg_lo:[0,1,0] neg_hi:[0,1,0]
  v_pk_fma_f32 v[142:143], v[50:51], v[74:75], v[142:143] op_sel:[0,0,0] op_sel_hi:[1,0,1] neg_lo:[0,1,0] neg_hi:[0,1,0]
  v_pk_fma_f32 v[156:157], v[52:53], v[74:75], v[156:157] op_sel:[0,0,0] op_sel_hi:[1,0,1] neg_lo:[0,1,0] neg_hi:[0,1,0]
  v_pk_fma_f32 v[158:159], v[54:55], v[74:75], v[158:159] op_sel:[0,0,0] op_sel_hi:[1,0,1] neg_lo:[0,1,0] neg_hi:[0,1,0]
  v_cvt_pk_bf16_f32 v140, v140, v141
  v_cvt_pk_bf16_f32 v141, v142, v143
  v_cvt_pk_bf16_f32 v142, v156, v157
  v_cvt_pk_bf16_f32 v143, v158, v159
  v_pk_fma_f32 v[172:173], v[56:57], v[74:75], v[172:173] op_sel:[0,0,0] op_sel_hi:[1,0,1] neg_lo:[0,1,0] neg_hi:[0,1,0]
  v_pk_fma_f32 v[174:175], v[58:59], v[74:75], v[174:175] op_sel:[0,0,0] op_sel_hi:[1,0,1] neg_lo:[0,1,0] neg_hi:[0,1,0]
  v_pk_fma_f32 v[188:189], v[60:61], v[74:75], v[188:189] op_sel:[0,0,0] op_sel_hi:[1,0,1] neg_lo:[0,1,0] neg_hi:[0,1,0]
  v_pk_fma_f32 v[190:191], v[62:63], v[74:75], v[190:191] op_sel:[0,0,0] op_sel_hi:[1,0,1] neg_lo:[0,1,0] neg_hi:[0,1,0]
  v_cvt_pk_bf16_f32 v172, v172, v173
  v_cvt_pk_bf16_f32 v173, v174, v175
  v_cvt_pk_bf16_f32 v174, v188, v189
  v_cvt_pk_bf16_f32 v175, v190, v191
  s_waitcnt lgkmcnt(0)
  v_pk_fma_f32 v[32:33], v[56:57], v[66:67], v[32:33] op_sel:[0,0,0] op_sel_hi:[1,0,1] neg_lo:[0,1,0] neg_hi:[0,1,0]
  v_pk_fma_f32 v[34:35], v[58:59], v[66:67], v[34:35] op_sel:[0,0,0] op_sel_hi:[1,0,1] neg_lo:[0,1,0] neg_hi:[0,1,0]
  v_pk_fma_f32 v[36:37], v[60:61], v[66:67], v[36:37] op_sel:[0,0,0] op_sel_hi:[1,0,1] neg_lo:[0,1,0] neg_hi:[0,1,0]
  v_pk_fma_f32 v[38:39], v[62:63], v[66:67], v[38:39] op_sel:[0,0,0] op_sel_hi:[1,0,1] neg_lo:[0,1,0] neg_hi:[0,1,0]
  v_cvt_pk_bf16_f32 v32, v32, v33
  v_cvt_pk_bf16_f32 v33, v34, v35
  v_cvt_pk_bf16_f32 v34, v36, v37
  v_cvt_pk_bf16_f32 v35, v38, v39
  v_mfma_f32_16x16x32_bf16 v[152:155], v[168:171], v[136:139], 0
  v_mfma_f32_16x16x32_bf16 v[184:187], v[164:167], v[136:139], 0
  v_mfma_f32_16x16x32_bf16 v[156:159], v[172:175], v[140:143], 0
  v_mfma_f32_16x16x32_bf16 v[188:191], v[168:171], v[140:143], 0
  v_mfma_f32_16x16x32_bf16 v[176:179], v[32:35], v[128:131], 0
  v_pk_fma_f32 v[40:41], v[84:85], v[64:65], v[40:41] op_sel:[0,0,0] op_sel_hi:[1,0,1] neg_lo:[1,0,0] neg_hi:[1,0,0]
  v_pk_fma_f32 v[42:43], v[86:87], v[64:65], v[42:43] op_sel:[0,0,0] op_sel_hi:[1,0,1] neg_lo:[1,0,0] neg_hi:[1,0,0]
  v_pk_mul_f32 v[40:41], v[40:41], v[104:105]
  v_pk_mul_f32 v[42:43], v[42:43], v[106:107]
  v_cvt_pk_bf16_f32 v240, v40, v41
  v_cvt_pk_bf16_f32 v241, v42, v43
  v_pk_fma_f32 v[192:193], v[88:89], v[64:65], v[192:193] op_sel:[0,0,0] op_sel_hi:[1,0,1] neg_lo:[1,0,0] neg_hi:[1,0,0]
  v_pk_fma_f32 v[194:195], v[90:91], v[64:65], v[194:195] op_sel:[0,0,0] op_sel_hi:[1,0,1] neg_lo:[1,0,0] neg_hi:[1,0,0]
  v_pk_mul_f32 v[192:193], v[192:193], v[108:109]
  v_pk_mul_f32 v[194:195], v[194:195], v[110:111]
  v_cvt_pk_bf16_f32 v242, v192, v193
  v_cvt_pk_bf16_f32 v243, v194, v195
  v_pk_fma_f32 v[196:197], v[92:93], v[64:65], v[196:197] op_sel:[0,0,0] op_sel_hi:[1,0,1] neg_lo:[1,0,0] neg_hi:[1,0,0]
  v_pk_fma_f32 v[198:199], v[94:95], v[64:65], v[198:199] op_sel:[0,0,0] op_sel_hi:[1,0,1] neg_lo:[1,0,0] neg_hi:[1,0,0]
  v_pk_mul_f32 v[196:197], v[196:197], v[112:113]
  v_pk_mul_f32 v[198:199], v[198:199], v[114:115]
  v_cvt_pk_bf16_f32 v244, v196, v197
  v_cvt_pk_bf16_f32 v245, v198, v199
  v_pk_fma_f32 v[200:201], v[96:97], v[64:65], v[200:201] op_sel:[0,0,0] op_sel_hi:[1,0,1] neg_lo:[1,0,0] neg_hi:[1,0,0]
  v_pk_fma_f32 v[202:203], v[98:99], v[64:65], v[202:203] op_sel:[0,0,0] op_sel_hi:[1,0,1] neg_lo:[1,0,0] neg_hi:[1,0,0]
  v_pk_mul_f32 v[200:201], v[200:201], v[116:117]
  v_pk_mul_f32 v[202:203], v[202:203], v[118:119]
  v_cvt_pk_bf16_f32 v246, v200, v201
  v_cvt_pk_bf16_f32 v247, v202, v203
  v_pk_fma_f32 v[204:205], v[100:101], v[64:65], v[204:205] op_sel:[0,0,0] op_sel_hi:[1,0,1] neg_lo:[1,0,0] neg_hi:[1,0,0]
  v_pk_fma_f32 v[206:207], v[102:103], v[64:65], v[206:207] op_sel:[0,0,0] op_sel_hi:[1,0,1] neg_lo:[1,0,0] neg_hi:[1,0,0]
  v_pk_mul_f32 v[204:205], v[204:205], v[120:121]
  v_pk_mul_f32 v[206:207], v[206:207], v[122:123]
  v_cvt_pk_bf16_f32 v248, v204, v205
  v_cvt_pk_bf16_f32 v249, v206, v207
  v_pk_fma_f32 v[44:45], v[84:85], v[64:65], v[44:45] op_sel:[0,1,0] op_sel_hi:[1,1,1] neg_lo:[1,0,0] neg_hi:[1,0,0]
  v_pk_fma_f32 v[46:47], v[86:87], v[64:65], v[46:47] op_sel:[0,1,0] op_sel_hi:[1,1,1] neg_lo:[1,0,0] neg_hi:[1,0,0]
  v_pk_mul_f32 v[44:45], v[44:45], v[104:105]
  v_pk_mul_f32 v[46:47], v[46:47], v[106:107]
  v_cvt_pk_bf16_f32 v224, v44, v45
  v_cvt_pk_bf16_f32 v225, v46, v47
  v_pk_fma_f32 v[208:209], v[88:89], v[64:65], v[208:209] op_sel:[0,1,0] op_sel_hi:[1,1,1] neg_lo:[1,0,0] neg_hi:[1,0,0]
  v_pk_fma_f32 v[210:211], v[90:91], v[64:65], v[210:211] op_sel:[0,1,0] op_sel_hi:[1,1,1] neg_lo:[1,0,0] neg_hi:[1,0,0]
  v_pk_mul_f32 v[208:209], v[208:209], v[108:109]
  v_pk_mul_f32 v[210:211], v[210:211], v[110:111]
  v_cvt_pk_bf16_f32 v226, v208, v209
  v_cvt_pk_bf16_f32 v227, v210, v211
  v_pk_fma_f32 v[212:213], v[92:93], v[64:65], v[212:213] op_sel:[0,1,0] op_sel_hi:[1,1,1] neg_lo:[1,0,0] neg_hi:[1,0,0]
  v_pk_fma_f32 v[214:215], v[94:95], v[64:65], v[214:215] op_sel:[0,1,0] op_sel_hi:[1,1,1] neg_lo:[1,0,0] neg_hi:[1,0,0]
  v_pk_mul_f32 v[212:213], v[212:213], v[112:113]
  v_pk_mul_f32 v[214:215], v[214:215], v[114:115]
  v_cvt_pk_bf16_f32 v228, v212, v213
  v_cvt_pk_bf16_f32 v229, v214, v215
  v_pk_fma_f32 v[216:217], v[96:97], v[64:65], v[216:217] op_sel:[0,1,0] op_sel_hi:[1,1,1] neg_lo:[1,0,0] neg_hi:[1,0,0]
  v_pk_fma_f32 v[218:219], v[98:99], v[64:65], v[218:219] op_sel:[0,1,0] op_sel_hi:[1,1,1] neg_lo:[1,0,0] neg_hi:[1,0,0]
  v_pk_mul_f32 v[216:217], v[216:217], v[116:117]
  v_pk_mul_f32 v[218:219], v[218:219], v[118:119]
  v_cvt_pk_bf16_f32 v230, v216, v217
  v_cvt_pk_bf16_f32 v231, v218, v219
  v_pk_fma_f32 v[220:221], v[100:101], v[64:65], v[220:221] op_sel:[0,1,0] op_sel_hi:[1,1,1] neg_lo:[1,0,0] neg_hi:[1,0,0]
  v_pk_fma_f32 v[222:223], v[102:103], v[64:65], v[222:223] op_sel:[0,1,0] op_sel_hi:[1,1,1] neg_lo:[1,0,0] neg_hi:[1,0,0]
  v_pk_mul_f32 v[220:221], v[220:221], v[120:121]
  v_pk_mul_f32 v[222:223], v[222:223], v[122:123]
  v_cvt_pk_bf16_f32 v232, v220, v221
  v_cvt_pk_bf16_f32 v233, v222, v223
  v_cndmask_b32 v148, v148, v149, s[48:49]
  v_cndmask_b32 v180, v180, v181, s[48:49]
  v_cndmask_b32 v150, v150, v151, s[48:49]
  v_cndmask_b32 v182, v182, v183, s[48:49]
  v_cndmask_b32 v36, v148, v180, s[50:51]
  v_cndmask_b32 v37, v150, v182, s[52:53]
  v_mul_f32 v36, v36, v77
  v_mul_f32 v37, v37, v81
  v_cndmask_b32 v152, v152, v153, s[48:49]
  v_cndmask_b32 v184, v184, v185, s[48:49]
  v_cndmask_b32 v154, v154, v155, s[48:49]
  v_cndmask_b32 v186, v186, v187, s[48:49]
  v_cndmask_b32 v40, v152, v184, s[50:51]
  v_cndmask_b32 v41, v154, v186, s[52:53]
  v_mul_f32 v40, v40, v78
  v_mul_f32 v41, v41, v82
  v_cndmask_b32 v156, v156, v157, s[48:49]
  v_cndmask_b32 v188, v188, v189, s[48:49]
  v_cndmask_b32 v158, v158, v159, s[48:49]
  v_cndmask_b32 v190, v190, v191, s[48:49]
  v_cndmask_b32 v44, v156, v188, s[50:51]
  v_cndmask_b32 v45, v158, v190, s[52:53]
  v_mul_f32 v44, v44, v79
  v_mul_f32 v45, v45, v83
  v_cndmask_b32 v144, v144, v145, s[48:49]
  v_cndmask_b32 v176, v176, v177, s[48:49]
  v_cndmask_b32 v146, v146, v147, s[48:49]
  v_cndmask_b32 v178, v178, v179, s[48:49]
  v_cndmask_b32 v32, v144, v176, s[50:51]
  v_cndmask_b32 v33, v146, v178, s[52:53]
  v_mul_f32 v32, v32, v76
  v_mul_f32 v33, v33, v80
  v_mov_b32 v48, 0xceabfb8f
  v_cndmask_b32 v32, v32, v48, s[54:55]
  v_cndmask_b32 v33, v33, v48, s[14:15]
  v_max_f32 v34, v32, v33
  v_max_f32 v38, v36, v37
  v_max_f32 v42, v40, v41
  v_max_f32 v46, v44, v45
  v_mov_b32 v35, v34
  v_mov_b32 v39, v38
  v_mov_b32 v43, v42
  v_mov_b32 v47, v46
  v_permlane32_swap_b32 v34, v35
  v_permlane32_swap_b32 v38, v39
  v_permlane32_swap_b32 v42, v43
  v_permlane32_swap_b32 v46, v47
  v_max_f32 v34, v34, v35
  v_max_f32 v38, v38, v39
  v_max_f32 v42, v42, v43
  v_max_f32 v46, v46, v47
  v_mov_b32 v35, v34
  v_mov_b32 v39, v38
  v_mov_b32 v43, v42
  v_mov_b32 v47, v46
  v_permlane16_swap_b32 v34, v35
  v_permlane16_swap_b32 v38, v39
  v_permlane16_swap_b32 v42, v43
  v_permlane16_swap_b32 v46, v47
  v_max_f32 v34, v34, v35
  v_max_f32 v38, v38, v39
  v_max_f32 v42, v42, v43
  v_max_f32 v46, v46, v47
  v_sub_f32 v32, v32, v34
  v_sub_f32 v33, v33, v34
  v_sub_f32 v36, v36, v38
  v_sub_f32 v37, v37, v38
  v_sub_f32 v40, v40, v42
  v_sub_f32 v41, v41, v42
  v_sub_f32 v44, v44, v46
  v_sub_f32 v45, v45, v46
  v_exp_f32 v32, v32
  v_exp_f32 v33, v33
  v_exp_f32 v36, v36
  v_exp_f32 v37, v37
  v_exp_f32 v40, v40
  v_exp_f32 v41, v41
  v_exp_f32 v44, v44
  v_exp_f32 v45, v45
  v_cvt_pk_bf16_f32 v32, v32, v32
  v_cvt_pk_bf16_f32 v33, v33, v33
  v_and_b32 v128, v32, v27
  v_and_b32 v129, v33, v29
  v_and_b32 v130, v32, v28
  v_and_b32 v131, v33, v30
  v_cvt_pk_bf16_f32 v36, v36, v36
  v_cvt_pk_bf16_f32 v37, v37, v37
  v_and_b32 v132, v36, v27
  v_and_b32 v133, v37, v29
  v_and_b32 v134, v36, v28
  v_and_b32 v135, v37, v30
  v_mfma_f32_16x16x32_bf16 v[144:147], v[236:239], v[128:131], 0
  v_mfma_f32_16x16x32_bf16 v[192:195], v[240:243], v[128:131], 0
  v_mfma_f32_16x16x32_bf16 v[208:211], v[224:227], v[128:131], 0
  v_cvt_pk_bf16_f32 v40, v40, v40
  v_cvt_pk_bf16_f32 v41, v41, v41
  v_and_b32 v136, v40, v27
  v_and_b32 v137, v41, v29
  v_and_b32 v138, v40, v28
  v_and_b32 v139, v41, v30
  v_mfma_f32_16x16x32_bf16 v[148:151], v[236:239], v[132:135], 0
  v_mfma_f32_16x16x32_bf16 v[196:199], v[242:245], v[132:135], 0
  v_mfma_f32_16x16x32_bf16 v[212:215], v[226:229], v[132:135], 0
  v_cvt_pk_bf16_f32 v44, v44, v44
  v_cvt_pk_bf16_f32 v45, v45, v45
  v_and_b32 v140, v44, v27
  v_and_b32 v141, v45, v29
  v_and_b32 v142, v44, v28
  v_and_b32 v143, v45, v30
  v_mfma_f32_16x16x32_bf16 v[152:155], v[236:239], v[136:139], 0
  v_mfma_f32_16x16x32_bf16 v[200:203], v[244:247], v[136:139], 0
  v_mfma_f32_16x16x32_bf16 v[216:219], v[228:231], v[136:139], 0
  v_mfma_f32_16x16x32_bf16 v[156:159], v[236:239], v[140:143], 0
  v_mfma_f32_16x16x32_bf16 v[204:207], v[246:249], v[140:143], 0
  v_mfma_f32_16x16x32_bf16 v[220:223], v[230:233], v[140:143], 0
  v_rcp_f32 v144, v144
  s_mov_b32 s3, 0
  v_pk_mul_f32 v[192:193], v[192:193], v[144:145] op_sel_hi:[1,0]
  v_pk_mul_f32 v[194:195], v[194:195], v[144:145] op_sel_hi:[1,0]
  v_pk_mul_f32 v[208:209], v[208:209], v[144:145] op_sel_hi:[1,0]
  v_pk_mul_f32 v[210:211], v[210:211], v[144:145] op_sel_hi:[1,0]
  v_cvt_pk_bf16_f32 v48, v192, v193
  v_cvt_pk_bf16_f32 v49, v194, v195
  v_cvt_pk_bf16_f32 v50, v208, v209
  v_cvt_pk_bf16_f32 v51, v210, v211
  s_nop 1
  v_permlane16_swap_b32 v48, v50
  v_permlane16_swap_b32 v49, v51
  buffer_store_dwordx4 v[48:51], v31, s[44:47], s3 offen sc1
  v_rcp_f32 v148, v148
  s_mov_b32 s3, 32768
  v_pk_mul_f32 v[196:197], v[196:197], v[148:149] op_sel_hi:[1,0]
  v_pk_mul_f32 v[198:199], v[198:199], v[148:149] op_sel_hi:[1,0]
  v_pk_mul_f32 v[212:213], v[212:213], v[148:149] op_sel_hi:[1,0]
  v_pk_mul_f32 v[214:215], v[214:215], v[148:149] op_sel_hi:[1,0]
  v_cvt_pk_bf16_f32 v52, v196, v197
  v_cvt_pk_bf16_f32 v53, v198, v199
  v_cvt_pk_bf16_f32 v54, v212, v213
  v_cvt_pk_bf16_f32 v55, v214, v215
  s_nop 1
  v_permlane16_swap_b32 v52, v54
  v_permlane16_swap_b32 v53, v55
  buffer_store_dwordx4 v[52:55], v31, s[44:47], s3 offen sc1
  v_rcp_f32 v152, v152
  s_mov_b32 s3, 65536
  v_pk_mul_f32 v[200:201], v[200:201], v[152:153] op_sel_hi:[1,0]
  v_pk_mul_f32 v[202:203], v[202:203], v[152:153] op_sel_hi:[1,0]
  v_pk_mul_f32 v[216:217], v[216:217], v[152:153] op_sel_hi:[1,0]
  v_pk_mul_f32 v[218:219], v[218:219], v[152:153] op_sel_hi:[1,0]
  v_cvt_pk_bf16_f32 v56, v200, v201
  v_cvt_pk_bf16_f32 v57, v202, v203
  v_cvt_pk_bf16_f32 v58, v216, v217
  v_cvt_pk_bf16_f32 v59, v218, v219
  s_nop 1
  v_permlane16_swap_b32 v56, v58
  v_permlane16_swap_b32 v57, v59
  buffer_store_dwordx4 v[56:59], v31, s[44:47], s3 offen sc1
  v_rcp_f32 v156, v156
  s_mov_b32 s3, 98304
  v_pk_mul_f32 v[204:205], v[204:205], v[156:157] op_sel_hi:[1,0]
  v_pk_mul_f32 v[206:207], v[206:207], v[156:157] op_sel_hi:[1,0]
  v_pk_mul_f32 v[220:221], v[220:221], v[156:157] op_sel_hi:[1,0]
  v_pk_mul_f32 v[222:223], v[222:223], v[156:157] op_sel_hi:[1,0]
  v_cvt_pk_bf16_f32 v60, v204, v205
  v_cvt_pk_bf16_f32 v61, v206, v207
  v_cvt_pk_bf16_f32 v62, v220, v221
  v_cvt_pk_bf16_f32 v63, v222, v223
  s_nop 1
  v_permlane16_swap_b32 v60, v62
  v_permlane16_swap_b32 v61, v63
  buffer_store_dwordx4 v[60:63], v31, s[44:47], s3 offen sc1
  s_waitcnt vmcnt(0)
  s_barrier
  s_add_u32 s97, s97, 1
  s_branch L_wo_body
.section .rodata,"a"
.p2align 6
.amdhsa_kernel attnl0_kernel
  .amdhsa_next_free_vgpr 256
  .amdhsa_next_free_sgpr 102
  .amdhsa_accum_offset 256
  .amdhsa_group_segment_fixed_size 0
  .amdhsa_kernarg_size 88
  .amdhsa_user_sgpr_count 2
  .amdhsa_user_sgpr_kernarg_segment_ptr 1
  .amdhsa_system_sgpr_workgroup_id_x 1
  .amdhsa_float_denorm_mode_32 3
  .amdhsa_float_denorm_mode_16_64 3
.end_amdhsa_kernel
.text
L_attn_c1:
L_wo_c0:
L_wo_body:
  s_cmp_ge_u32 s2, 256
  s_cbranch_scc1 L_wo_end
  v_lshrrev_b32 v2, 6, v0
  v_and_b32 v1, 63, v0
  v_readfirstlane_b32 s70, v2
  s_and_b32 s3, s2, 7
  s_lshr_b32 s99, s2, 3
  s_and_b32 s5, s3, 3
  s_lshl_b32 s5, s5, 2
  s_and_b32 s6, s99, 3
  s_add_u32 s68, s5, s6
  s_lshr_b32 s5, s3, 2
  s_lshl_b32 s5, s5, 3
  s_lshr_b32 s6, s99, 2
  s_add_u32 s69, s5, s6
  s_cmp_lt_u32 s70, 4
  s_cbranch_scc1 L_wo_compute
L_wo_loader:
  s_add_u32 s8, s70, s69
  s_and_b32 s8, s8, 3
  s_add_u32 s9, s70, s68
  s_and_b32 s9, s9, 3
  s_lshl_b32 s76, s8, 12
  s_lshl_b32 s77, s9, 11
  s_add_u32 s77, s77, 16384
  s_lshl_b32 s11, s68, 7
  v_and_b32 v10, 7, v1
  s_lshr_b32 s10, s76, 11
  s_lshl_b32 s3, s68, 3
  s_add_u32 s10, s10, s3
  s_mul_i32 s10, s10, 32768
  v_lshl_add_u32 v4, v1, 4, s10
  v_add_u32 v5, 32768, v4
  v_lshrrev_b32 v3, 3, v1
  s_lshl_b32 s10, s9, 4
  v_add_u32 v3, s10, v3
  v_mul_u32_u24 v3, 2048, v3
  v_lshrrev_b32 v2, 3, v1
  v_and_b32 v2, 2, v2
  v_xor_b32 v2, v2, v10
  s_mul_i32 s10, s69, 128
  v_add_u32 v3, s10, v3
  v_lshl_add_u32 v8, v2, 4, v3
  v_xor_b32 v2, 4, v2
  v_add_u32 v3, 16384, v3
  v_lshl_add_u32 v9, v2, 4, v3
  s_mov_b32 s75, 0
  s_add_u32 s100, s68, s69
  s_mov_b32 s101, -1
  s_add_u32 s101, s101, 1
  s_sub_u32 s73, s101, s100
  s_lshl_b32 s73, s73, 3
  s_lshr_b32 s73, 0xf0f02, s73
  s_and_b32 s73, s73, 255
  s_add_u32 s73, s73, s101
  s_and_b32 s73, s73, 15
  s_mul_i32 s74, s73, 131072
  s_lshl_b32 s73, s73, 11
  s_waitcnt lgkmcnt(0)
  s_mov_b32 s36, s34
  s_and_b32 s37, s35, 0xffff
  s_mov_b32 s38, 4194304
  s_mov_b32 s39, 0x00020000
  s_mov_b32 s40, s20
  s_and_b32 s41, s21, 0xffff
  s_mov_b32 s42, 2097152
  s_mov_b32 s43, 0x00020000
  s_add_u32 s3, s96, s70
  s_cmp_lg_u32 s3, 4
  s_cbranch_scc1 L_wo_chk
  s_load_dwordx2 s[64:65], s[0:1], 72
  s_mov_b32 s79, 0x100000
  s_waitcnt lgkmcnt(0)
  s_and_b32 s65, s65, 0xffff
  s_mov_b32 s66, 256
  s_mov_b32 s67, 0x00020000
  v_lshlrev_b32 v2, 2, v1
L_wo_chkl:
  buffer_load_dword v12, v2, s[64:67], 0 offen sc1
  s_sub_u32 s79, s79, 1
  s_cbranch_scc1 L_wo_chk
  s_waitcnt vmcnt(0)
  v_cmp_ne_u32 vcc, 0x01010101, v12
  s_cbranch_vccnz L_wo_chkl
L_wo_chk:
  s_mov_b32 s88, s73
  s_add_u32 m0, s77, 0
  s_add_u32 s4, s74, 0
  buffer_load_dwordx4 v8, s[40:43], s4 offen lds
  s_add_u32 m0, s77, 1024
  s_nop 0
  buffer_load_dwordx4 v9, s[40:43], s4 offen lds
  s_add_u32 s101, s101, 1
  s_sub_u32 s73, s101, s100
  s_lshl_b32 s73, s73, 3
  s_lshr_b32 s73, 0xf0f02, s73
  s_and_b32 s73, s73, 255
  s_add_u32 s73, s73, s101
  s_and_b32 s73, s73, 15
  s_mul_i32 s74, s73, 131072
  s_lshl_b32 s73, s73, 11
  s_mov_b32 s89, s73
  s_add_u32 m0, s77, 24576
  s_add_u32 s4, s74, 0
  buffer_load_dwordx4 v8, s[40:43], s4 offen lds
  s_add_u32 m0, s77, 25600
  s_nop 0
  buffer_load_dwordx4 v9, s[40:43], s4 offen lds
  s_add_u32 s101, s101, 1
  s_sub_u32 s73, s101, s100
  s_lshl_b32 s73, s73, 3
  s_lshr_b32 s73, 0xf0f02, s73
  s_and_b32 s73, s73, 255
  s_add_u32 s73, s73, s101
  s_and_b32 s73, s73, 15
  s_mul_i32 s74, s73, 131072
  s_lshl_b32 s73, s73, 11
  s_mov_b32 s90, s73
  s_add_u32 m0, s77, 49152
  s_add_u32 s4, s74, 0
  buffer_load_dwordx4 v8, s[40:43], s4 offen lds
  s_add_u32 m0, s77, 50176
  s_nop 0
  buffer_load_dwordx4 v9, s[40:43], s4 offen lds
  s_add_u32 s101, s101, 1
  s_sub_u32 s73, s101, s100
  s_lshl_b32 s73, s73, 3
  s_lshr_b32 s73, 0xf0f02, s73
  s_and_b32 s73, s73, 255
  s_add_u32 s73, s73, s101
  s_and_b32 s73, s73, 15
  s_mul_i32 s74, s73, 131072
  s_lshl_b32 s73, s73, 11
  s_mov_b32 s91, s73
  s_add_u32 m0, s77, 73728
  s_add_u32 s4, s74, 0
  buffer_load_dwordx4 v8, s[40:43], s4 offen lds
  s_add_u32 m0, s77, 74752
  s_nop 0
  buffer_load_dwordx4 v9, s[40:43], s4 offen lds
  s_add_u32 s101, s101, 1
  s_sub_u32 s73, s101, s100
  s_lshl_b32 s73, s73, 3
  s_lshr_b32 s73, 0xf0f02, s73
  s_and_b32 s73, s73, 255
  s_add_u32 s73, s73, s101
  s_and_b32 s73, s73, 15
  s_mul_i32 s74, s73, 131072
  s_lshl_b32 s73, s73, 11
  s_mov_b32 s92, s73
  s_add_u32 m0, s77, 98304
  s_add_u32 s4, s74, 0
  buffer_load_dwordx4 v8, s[40:43], s4 offen lds
  s_add_u32 m0, s77, 99328
  s_nop 0
  buffer_load_dwordx4 v9, s[40:43], s4 offen lds
  s_add_u32 s101, s101, 1
  s_sub_u32 s73, s101, s100
  s_lshl_b32 s73, s73, 3
  s_lshr_b32 s73, 0xf0f02, s73
  s_and_b32 s73, s73, 255
  s_add_u32 s73, s73, s101
  s_and_b32 s73, s73, 15
  s_mul_i32 s74, s73, 131072
  s_lshl_b32 s73, s73, 11
  s_mov_b32 s75, 122880
  s_add_u32 s44, s22, 24903680
  s_addc_u32 s45, s23, 0
  s_and_b32 s45, s45, 0xffff
  s_mov_b32 s46, 32768
  s_mov_b32 s47, 0x00020000
  s_cmp_lg_u32 s96, 0
  s_cbranch_scc1 L_wo_nofirst
  s_waitcnt vmcnt(10)
  s_mov_b32 s7, 0xffff0000
  v_lshlrev_b32 v32, 16, v64
  v_and_b32 v33, s7, v64
  v_lshlrev_b32 v34, 16, v65
  v_and_b32 v35, s7, v65
  v_lshlrev_b32 v36, 16, v66
  v_and_b32 v37, s7, v66
  v_lshlrev_b32 v38, 16, v67
  v_and_b32 v39, s7, v67
  v_lshlrev_b32 v40, 16, v68
  v_and_b32 v41, s7, v68
  v_pk_add_f32 v[32:33], v[32:33], v[40:41]
  v_lshlrev_b32 v40, 16, v69
  v_and_b32 v41, s7, v69
  v_pk_add_f32 v[34:35], v[34:35], v[40:41]
  v_lshlrev_b32 v40, 16, v70
  v_and_b32 v41, s7, v70
  v_pk_add_f32 v[36:37], v[36:37], v[40:41]
  v_lshlrev_b32 v40, 16, v71
  v_and_b32 v41, s7, v71
  v_pk_add_f32 v[38:39], v[38:39], v[40:41]
  v_lshlrev_b32 v40, 16, v72
  v_and_b32 v41, s7, v72
  v_pk_add_f32 v[32:33], v[32:33], v[40:41]
  v_lshlrev_b32 v40, 16, v73
  v_and_b32 v41, s7, v73
  v_pk_add_f32 v[34:35], v[34:35], v[40:41]
  v_lshlrev_b32 v40, 16, v74
  v_and_b32 v41, s7, v74
  v_pk_add_f32 v[36:37], v[36:37], v[40:41]
  v_lshlrev_b32 v40, 16, v75
  v_and_b32 v41, s7, v75
  v_pk_add_f32 v[38:39], v[38:39], v[40:41]
  v_lshlrev_b32 v40, 16, v76
  v_and_b32 v41, s7, v76
  v_pk_add_f32 v[32:33], v[32:33], v[40:41]
  v_lshlrev_b32 v40, 16, v77
  v_and_b32 v41, s7, v77
  v_pk_add_f32 v[34:35], v[34:35], v[40:41]
  v_lshlrev_b32 v40, 16, v78
  v_and_b32 v41, s7, v78
  v_pk_add_f32 v[36:37], v[36:37], v[40:41]
  v_lshlrev_b32 v40, 16, v79
  v_and_b32 v41, s7, v79
  v_pk_add_f32 v[38:39], v[38:39], v[40:41]
  v_lshlrev_b32 v40, 16, v80
  v_and_b32 v41, s7, v80
  v_pk_add_f32 v[32:33], v[32:33], v[40:41]
  v_lshlrev_b32 v40, 16, v81
  v_and_b32 v41, s7, v81
  v_pk_add_f32 v[34:35], v[34:35], v[40:41]
  v_lshlrev_b32 v40, 16, v82
  v_and_b32 v41, s7, v82
  v_pk_add_f32 v[36:37], v[36:37], v[40:41]
  v_lshlrev_b32 v40, 16, v83
  v_and_b32 v41, s7, v83
  v_pk_add_f32 v[38:39], v[38:39], v[40:41]
  v_lshlrev_b32 v40, 16, v84
  v_and_b32 v41, s7, v84
  v_pk_add_f32 v[32:33], v[32:33], v[40:41]
  v_lshlrev_b32 v40, 16, v85
  v_and_b32 v41, s7, v85
  v_pk_add_f32 v[34:35], v[34:35], v[40:41]
  v_lshlrev_b32 v40, 16, v86
  v_and_b32 v41, s7, v86
  v_pk_add_f32 v[36:37], v[36:37], v[40:41]
  v_lshlrev_b32 v40, 16, v87
  v_and_b32 v41, s7, v87
  v_pk_add_f32 v[38:39], v[38:39], v[40:41]
  v_lshlrev_b32 v40, 16, v88
  v_and_b32 v41, s7, v88
  v_pk_add_f32 v[32:33], v[32:33], v[40:41]
  v_lshlrev_b32 v40, 16, v89
  v_and_b32 v41, s7, v89
  v_pk_add_f32 v[34:35], v[34:35], v[40:41]
  v_lshlrev_b32 v40, 16, v90
  v_and_b32 v41, s7, v90
  v_pk_add_f32 v[36:37], v[36:37], v[40:41]
  v_lshlrev_b32 v40, 16, v91
  v_and_b32 v41, s7, v91
  v_pk_add_f32 v[38:39], v[38:39], v[40:41]
  v_lshlrev_b32 v40, 16, v92
  v_and_b32 v41, s7, v92
  v_pk_add_f32 v[32:33], v[32:33], v[40:41]
  v_lshlrev_b32 v40, 16, v93
  v_and_b32 v41, s7, v93
  v_pk_add_f32 v[34:35], v[34:35], v[40:41]
  v_lshlrev_b32 v40, 16, v94
  v_and_b32 v41, s7, v94
  v_pk_add_f32 v[36:37], v[36:37], v[40:41]
  v_lshlrev_b32 v40, 16, v95
  v_and_b32 v41, s7, v95
  v_pk_add_f32 v[38:39], v[38:39], v[40:41]
  s_add_u32 s52, s22, 24641536
  s_addc_u32 s53, s23, 0
  s_and_b32 s53, s53, 0xffff
  s_mov_b32 s54, 262144
  s_mov_b32 s55, 0x00020000
  v_permlane32_swap_b32 v32, v36
  v_permlane32_swap_b32 v33, v37
  v_permlane32_swap_b32 v34, v38
  v_permlane32_swap_b32 v35, v39
  v_add_f32 v32, v32, v36
  v_add_f32 v33, v33, v37
  v_add_f32 v34, v34, v38
  v_add_f32 v35, v35, v39
  v_and_b32 v2, 7, v1
  v_lshlrev_b32 v2, 5, v2
  v_permlane16_swap_b32 v32, v34
  v_permlane16_swap_b32 v33, v35
  v_add_f32 v32, v32, v34
  v_add_f32 v33, v33, v35
  v_lshrrev_b32 v3, 4, v1
  v_lshl_add_u32 v2, v3, 3, v2
  v_add_f32_dpp v32, v32, v32 row_ror:8 row_mask:0xf bank_mask:0xf
  v_add_f32_dpp v33, v33, v33 row_ror:8 row_mask:0xf bank_mask:0xf
  buffer_store_dwordx2 v[32:33], v2, s[52:55], s94 offen sc1
  s_waitcnt vmcnt(0)
L_wo_nofirst:
  s_lshl_b32 s3, s97, 12
  s_lshl_b32 s4, s68, 8
  s_add_u32 s3, s3, s4
  s_sub_u32 s3, s3, 4096
  v_and_b32 v2, 15, v1
  v_lshlrev_b32 v2, 2, v2
  v_mov_b32 v3, 1
  s_mov_b32 s79, 0x100000
  s_cmp_lg_u32 s70, 4
  s_barrier
  s_cbranch_scc1 L_wo_dep
  s_mov_b64 exec, 1
  buffer_store_dword v3, off, s[44:47], s87 sc1
  s_mov_b64 exec, -1
L_wo_poll:
  buffer_load_dword v3, v2, s[44:47], s3 offen sc1
  s_sub_u32 s79, s79, 1
  s_cbranch_scc1 L_wo_dep
  s_waitcnt vmcnt(0)
  v_cmp_ne_u32 vcc, 1, v3
  s_cbranch_vccnz L_wo_poll
L_wo_dep:
  s_barrier
  s_add_u32 m0, s76, 0
  s_nop 0
  buffer_load_dwordx4 v4, s[36:39], s88 offen offset:0 lds
  buffer_load_dwordx4 v4, s[36:39], s88 offen offset:1024 lds
  s_add_u32 m0, s76, 2048
  s_nop 0
  buffer_load_dwordx4 v5, s[36:39], s88 offen offset:0 lds
  buffer_load_dwordx4 v5, s[36:39], s88 offen offset:1024 lds
  s_add_u32 m0, s76, 24576
  s_nop 0
  buffer_load_dwordx4 v4, s[36:39], s89 offen offset:0 lds
  buffer_load_dwordx4 v4, s[36:39], s89 offen offset:1024 lds
  s_add_u32 m0, s76, 26624
  s_nop 0
  buffer_load_dwordx4 v5, s[36:39], s89 offen offset:0 lds
  buffer_load_dwordx4 v5, s[36:39], s89 offen offset:1024 lds
  s_add_u32 m0, s76, 49152
  s_nop 0
  buffer_load_dwordx4 v4, s[36:39], s90 offen offset:0 lds
  buffer_load_dwordx4 v4, s[36:39], s90 offen offset:1024 lds
  s_add_u32 m0, s76, 51200
  s_nop 0
  buffer_load_dwordx4 v5, s[36:39], s90 offen offset:0 lds
  buffer_load_dwordx4 v5, s[36:39], s90 offen offset:1024 lds
  s_add_u32 m0, s76, 73728
  s_nop 0
  buffer_load_dwordx4 v4, s[36:39], s91 offen offset:0 lds
  buffer_load_dwordx4 v4, s[36:39], s91 offen offset:1024 lds
  s_add_u32 m0, s76, 75776
  s_nop 0
  buffer_load_dwordx4 v5, s[36:39], s91 offen offset:0 lds
  buffer_load_dwordx4 v5, s[36:39], s91 offen offset:1024 lds
  s_add_u32 m0, s76, 98304
  s_nop 0
  buffer_load_dwordx4 v4, s[36:39], s92 offen offset:0 lds
  buffer_load_dwordx4 v4, s[36:39], s92 offen offset:1024 lds
  s_add_u32 m0, s76, 100352
  s_nop 0
  buffer_load_dwordx4 v5, s[36:39], s92 offen offset:0 lds
  buffer_load_dwordx4 v5, s[36:39], s92 offen offset:1024 lds
  s_waitcnt vmcnt(16)
  s_barrier
  s_add_u32 s3, s75, s76
  s_add_u32 m0, s3, 0
  s_nop 0
  buffer_load_dwordx4 v4, s[36:39], s73 offen offset:0 lds
  buffer_load_dwordx4 v4, s[36:39], s73 offen offset:1024 lds
  s_add_u32 m0, s3, 2048
  s_nop 0
  buffer_load_dwordx4 v5, s[36:39], s73 offen offset:0 lds
  buffer_load_dwordx4 v5, s[36:39], s73 offen offset:1024 lds
  s_add_u32 s3, s75, s77
  s_add_u32 m0, s3, 0
  s_add_u32 s4, s74, 0
  buffer_load_dwordx4 v8, s[40:43], s4 offen lds
  s_add_u32 m0, s3, 1024
  s_nop 0
  buffer_load_dwordx4 v9, s[40:43], s4 offen lds
  s_add_u32 s101, s101, 1
  s_sub_u32 s73, s101, s100
  s_lshl_b32 s73, s73, 3
  s_lshr_b32 s73, 0xf0f02, s73
  s_and_b32 s73, s73, 255
  s_add_u32 s73, s73, s101
  s_and_b32 s73, s73, 15
  s_mul_i32 s74, s73, 131072
  s_lshl_b32 s73, s73, 11
  s_add_u32 s75, s75, 24576
  s_cmp_eq_u32 s75, 147456
  s_cselect_b32 s75, 0, s75
  s_waitcnt vmcnt(18)
  s_barrier
  s_add_u32 s3, s75, s76
  s_add_u32 m0, s3, 0
  s_nop 0
  buffer_load_dwordx4 v4, s[36:39], s73 offen offset:0 lds
  buffer_load_dwordx4 v4, s[36:39], s73 offen offset:1024 lds
  s_add_u32 m0, s3, 2048
  s_nop 0
  buffer_load_dwordx4 v5, s[36:39], s73 offen offset:0 lds
  buffer_load_dwordx4 v5, s[36:39], s73 offen offset:1024 lds
  s_add_u32 s3, s75, s77
  s_add_u32 m0, s3, 0
  s_add_u32 s4, s74, 0
  buffer_load_dwordx4 v8, s[40:43], s4 offen lds
  s_add_u32 m0, s3, 1024
  s_nop 0
  buffer_load_dwordx4 v9, s[40:43], s4 offen lds
  s_add_u32 s101, s101, 1
  s_sub_u32 s73, s101, s100
  s_lshl_b32 s73, s73, 3
  s_lshr_b32 s73, 0xf0f02, s73
  s_and_b32 s73, s73, 255
  s_add_u32 s73, s73, s101
  s_and_b32 s73, s73, 15
  s_mul_i32 s74, s73, 131072
  s_lshl_b32 s73, s73, 11
  s_add_u32 s75, s75, 24576
  s_cmp_eq_u32 s75, 147456
  s_cselect_b32 s75, 0, s75
  s_waitcnt vmcnt(20)
  s_barrier
  s_add_u32 s3, s75, s76
  s_add_u32 m0, s3, 0
  s_nop 0
  buffer_load_dwordx4 v4, s[36:39], s73 offen offset:0 lds
  buffer_load_dwordx4 v4, s[36:39], s73 offen offset:1024 lds
  s_add_u32 m0, s3, 2048
  s_nop 0
  buffer_load_dwordx4 v5, s[36:39], s73 offen offset:0 lds
  buffer_load_dwordx4 v5, s[36:39], s73 offen offset:1024 lds
  s_add_u32 s3, s75, s77
  s_add_u32 m0, s3, 0
  s_add_u32 s4, s74, 0
  buffer_load_dwordx4 v8, s[40:43], s4 offen lds
  s_add_u32 m0, s3, 1024
  s_nop 0
  buffer_load_dwordx4 v9, s[40:43], s4 offen lds
  s_add_u32 s101, s101, 1
  s_sub_u32 s73, s101, s100
  s_lshl_b32 s73, s73, 3
  s_lshr_b32 s73, 0xf0f02, s73
  s_and_b32 s73, s73, 255
  s_add_u32 s73, s73, s101
  s_and_b32 s73, s73, 15
  s_mul_i32 s74, s73, 131072
  s_lshl_b32 s73, s73, 11
  s_add_u32 s75, s75, 24576
  s_cmp_eq_u32 s75, 147456
  s_cselect_b32 s75, 0, s75
  s_waitcnt vmcnt(22)
  s_barrier
  s_mov_b32 s79, 7
L_wol_ld1:
  s_add_u32 s3, s75, s76
  s_add_u32 m0, s3, 0
  s_nop 0
  buffer_load_dwordx4 v4, s[36:39], s73 offen offset:0 lds
  buffer_load_dwordx4 v4, s[36:39], s73 offen offset:1024 lds
  s_add_u32 m0, s3, 2048
  s_nop 0
  buffer_load_dwordx4 v5, s[36:39], s73 offen offset:0 lds
  buffer_load_dwordx4 v5, s[36:39], s73 offen offset:1024 lds
  s_add_u32 s3, s75, s77
  s_add_u32 m0, s3, 0
  s_add_u32 s4, s74, 0
  buffer_load_dwordx4 v8, s[40:43], s4 offen lds
  s_add_u32 m0, s3, 1024
  s_nop 0
  buffer_load_dwordx4 v9, s[40:43], s4 offen lds
  s_add_u32 s101, s101, 1
  s_sub_u32 s73, s101, s100
  s_lshl_b32 s73, s73, 3
  s_lshr_b32 s73, 0xf0f02, s73
  s_and_b32 s73, s73, 255
  s_add_u32 s73, s73, s101
  s_and_b32 s73, s73, 15
  s_mul_i32 s74, s73, 131072
  s_lshl_b32 s73, s73, 11
  s_add_u32 s75, s75, 24576
  s_cmp_eq_u32 s75, 147456
  s_cselect_b32 s75, 0, s75
  s_waitcnt vmcnt(24)
  s_barrier
  s_sub_u32 s79, s79, 1
  s_cmp_lg_u32 s79, 0
  s_cbranch_scc1 L_wol_ld1
  s_add_u32 s3, s75, s76
  s_add_u32 m0, s3, 0
  s_nop 0
  buffer_load_dwordx4 v4, s[36:39], s73 offen offset:0 lds
  buffer_load_dwordx4 v4, s[36:39], s73 offen offset:1024 lds
  s_add_u32 m0, s3, 2048
  s_nop 0
  buffer_load_dwordx4 v5, s[36:39], s73 offen offset:0 lds
  buffer_load_dwordx4 v5, s[36:39], s73 offen offset:1024 lds
  s_add_u32 s3, s75, s77
  s_add_u32 m0, s3, 0
  s_add_u32 s4, s74, 0
  buffer_load_dwordx4 v8, s[40:43], s4 offen lds
  s_add_u32 m0, s3, 1024
  s_nop 0
  buffer_load_dwordx4 v9, s[40:43], s4 offen lds
  s_add_u32 s101, s101, 1
  s_sub_u32 s73, s101, s100
  s_lshl_b32 s73, s73, 3
  s_lshr_b32 s73, 0xf0f02, s73
  s_and_b32 s73, s73, 255
  s_add_u32 s73, s73, s101
  s_and_b32 s73, s73, 15
  s_mul_i32 s74, s73, 131072
  s_lshl_b32 s73, s73, 11
  s_add_u32 s75, s75, 24576
  s_cmp_eq_u32 s75, 147456
  s_cselect_b32 s75, 0, s75
  s_mov_b32 s48, s12
  s_and_b32 s49, s13, 0xffff
  s_mov_b32 s50, 4194304
  s_mov_b32 s51, 0x00020000
  s_cmp_eq_u32 s96, 1
  s_cselect_b32 s50, 128, 0
  s_add_u32 s50, s50, 2048
  s_lshl_b32 s50, s50, 11
  v_lshrrev_b32 v3, 3, v1
  s_lshr_b32 s10, s76, 7
  s_lshl_b32 s3, s68, 7
  s_add_u32 s10, s10, s3
  v_add_u32 v3, s10, v3
  s_cmp_eq_u32 s96, 1
  s_cselect_b32 s5, 128, 0
  s_add_u32 s5, s5, 2048
  s_lshl_b32 s6, s5, 3
  v_mul_u32_u24 v3, s5, v3
  v_lshrrev_b32 v2, 4, v1
  v_xor_b32 v4, v2, v10
  v_lshl_add_u32 v4, v4, 4, v3
  v_add_u32 v3, s6, v3
  v_add_u32 v5, 4, v2
  v_xor_b32 v5, v5, v10
  v_lshl_add_u32 v5, v5, 4, v3
  v_add_u32 v3, s6, v3
  v_xor_b32 v6, v2, v10
  v_lshl_add_u32 v6, v6, 4, v3
  v_add_u32 v3, s6, v3
  v_add_u32 v7, 4, v2
  v_xor_b32 v7, v7, v10
  v_lshl_add_u32 v7, v7, 4, v3
  s_lshl_b32 s4, s69, 7
  s_add_u32 m0, s76, 147456
  s_nop 0
  buffer_load_dwordx4 v4, s[48:51], s4 offen lds
  s_add_u32 m0, s76, 148480
  s_nop 0
  buffer_load_dwordx4 v5, s[48:51], s4 offen lds
  s_add_u32 m0, s76, 149504
  s_nop 0
  buffer_load_dwordx4 v6, s[48:51], s4 offen lds
  s_add_u32 m0, s76, 150528
  s_nop 0
  buffer_load_dwordx4 v7, s[48:51], s4 offen lds
  s_waitcnt vmcnt(28)
  s_barrier
  s_waitcnt vmcnt(22)
  s_barrier
  s_waitcnt vmcnt(16)
  s_barrier
  s_waitcnt vmcnt(10)
  s_barrier
  s_waitcnt vmcnt(4)
  s_barrier
  s_waitcnt vmcnt(0)
  s_barrier
  s_waitcnt vmcnt(0)
  s_lshl_b32 s87, s97, 12
  s_lshl_b32 s4, s68, 8
  s_add_u32 s87, s87, s4
  s_lshl_b32 s4, s69, 2
  s_add_u32 s87, s87, s4
  s_add_u32 s97, s97, 1
  s_branch L_w1_body
L_wo_end:
  s_endpgm
L_wo_compute:
  v_and_b32 v3, 15, v1
  v_lshrrev_b32 v2, 4, v1
  s_lshl_b32 s8, s68, 7
  s_lshl_b32 s9, s70, 5
  s_add_u32 s8, s8, s9
  v_add_u32 v13, s8, v3
  s_lshl_b32 s10, s69, 7
  v_lshl_add_u32 v14, v2, 3, s10
  v_and_b32 v16, 1, v2
  v_lshrrev_b32 v17, 1, v2
  v_lshl_add_u32 v16, v16, 1, v17
  v_lshlrev_b32 v16, 8, v16
  v_lshl_add_u32 v16, v3, 4, v16
  s_add_u32 s9, s8, s69
  s_lshl_b32 s9, s9, 11
  v_add_u32 v12, s9, v16
  v_lshl_add_u32 v18, v17, 4, v13
  v_lshlrev_b32 v18, 3, v18
  v_and_b32 v16, 1, v2
  v_lshl_add_u32 v18, v16, 2, v18
  s_lshl_b32 s10, s69, 14
  v_add_u32 v18, s10, v18
  s_lshl_b32 s8, s70, 12
  v_lshl_add_u32 v5, v1, 4, s8
  v_bfe_u32 v6, v1, 2, 2
  v_lshl_add_u32 v6, v2, 3, v6
  v_lshlrev_b32 v6, 7, v6
  v_and_b32 v17, 3, v1
  v_lshl_add_u32 v6, v17, 3, v6
  v_bfe_u32 v17, v1, 3, 2
  v_lshl_add_u32 v6, v17, 5, v6
  v_add_u32 v6, 16384, v6
  v_xor_b32 v7, 32, v6
  v_xor_b32 v8, 64, v6
  v_xor_b32 v9, 96, v6
  v_lshrrev_b32 v15, 1, v2
  v_lshrrev_b32 v17, 1, v3
  v_xor_b32 v15, v15, v17
  v_lshlrev_b32 v15, 4, v15
  v_lshl_add_u32 v15, v3, 7, v15
  v_lshl_add_u32 v15, v16, 3, v15
  s_add_u32 s8, s8, 147456
  v_add_u32 v15, s8, v15
  s_mov_b32 s11, 0xffff0000
  s_mov_b32 s75, 0
  v_mov_b32 v128, 0
  v_mov_b32 v129, 0
  v_mov_b32 v130, 0
  v_mov_b32 v131, 0
  v_mov_b32 v132, 0
  v_mov_b32 v133, 0
  v_mov_b32 v134, 0
  v_mov_b32 v135, 0
  v_mov_b32 v136, 0
  v_mov_b32 v137, 0
  v_mov_b32 v138, 0
  v_mov_b32 v139, 0
  v_mov_b32 v140, 0
  v_mov_b32 v141, 0
  v_mov_b32 v142, 0
  v_mov_b32 v143, 0
  v_mov_b32 v144, 0
  v_mov_b32 v145, 0
  v_mov_b32 v146, 0
  v_mov_b32 v147, 0
  v_mov_b32 v148, 0
  v_mov_b32 v149, 0
  v_mov_b32 v150, 0
  v_mov_b32 v151, 0
  v_mov_b32 v152, 0
  v_mov_b32 v153, 0
  v_mov_b32 v154, 0
  v_mov_b32 v155, 0
  v_mov_b32 v156, 0
  v_mov_b32 v157, 0
  v_mov_b32 v158, 0
  v_mov_b32 v159, 0
  s_waitcnt lgkmcnt(0)
  s_add_u32 s44, s34, 4194304
  s_addc_u32 s45, s35, 0
  s_and_b32 s45, s45, 0xffff
  s_mov_b32 s46, 4194304
  s_mov_b32 s47, 0x00020000
  s_add_u32 s56, s34, 24117248
  s_addc_u32 s57, s35, 0
  s_and_b32 s57, s57, 0xffff
  s_mov_b32 s58, 262144
  s_mov_b32 s59, 0x00020000
  s_cmp_lg_u32 s96, 0
  s_cbranch_scc1 L_pfc2_skip
  s_getpc_b64 s[4:5]
L_pfc2:
  s_lshl_b32 s3, s99, 2
  s_add_u32 s3, s3, s70
  s_mul_i32 s3, s3, 128
  s_min_u32 s3, s3, L_w1_c1-L_w1_c0-128
  s_add_i32 s3, s3, L_w1_c0-L_pfc2
  s_ashr_i32 s6, s3, 31
  s_add_u32 s4, s4, s3
  s_addc_u32 s5, s5, s6
  s_load_dword s36, s[4:5], 0
  s_load_dword s37, s[4:5], 64
L_pfc2_skip:
  s_barrier
  v_add_u32_e64 v25, s75, v5
  v_add_u32_e64 v26, s75, v6
  v_add_u32_e64 v27, s75, v7
  v_add_u32_e64 v28, s75, v8
  v_add_u32_e64 v29, s75, v9
  s_add_u32 s75, s75, 24576
  s_cmp_eq_u32 s75, 147456
  s_cselect_b32 s75, 0, s75
  s_barrier
  ds_read_b128 v[32:35], v25 offset:0
  ds_read_b128 v[36:39], v25 offset:2048
  ds_read_b64_tr_b16 v[48:49], v26 offset:0
  ds_read_b64_tr_b16 v[50:51], v26 offset:512
  ds_read_b64_tr_b16 v[52:53], v27 offset:0
  ds_read_b64_tr_b16 v[54:55], v27 offset:512
  ds_read_b64_tr_b16 v[56:57], v28 offset:0
  ds_read_b64_tr_b16 v[58:59], v28 offset:512
  ds_read_b64_tr_b16 v[60:61], v29 offset:0
  ds_read_b64_tr_b16 v[62:63], v29 offset:512
  ds_read_b128 v[40:43], v25 offset:1024
  ds_read_b128 v[44:47], v25 offset:3072
  ds_read_b64_tr_b16 v[64:65], v26 offset:4096
  ds_read_b64_tr_b16 v[66:67], v26 offset:4608
  ds_read_b64_tr_b16 v[68:69], v27 offset:4096
  ds_read_b64_tr_b16 v[70:71], v27 offset:4608
  ds_read_b64_tr_b16 v[72:73], v28 offset:4096
  ds_read_b64_tr_b16 v[74:75], v28 offset:4608
  ds_read_b64_tr_b16 v[76:77], v29 offset:4096
  ds_read_b64_tr_b16 v[78:79], v29 offset:4608
  s_mov_b32 s79, 8
  v_add_u32_e64 v25, s75, v5
  v_add_u32_e64 v26, s75, v6
  v_add_u32_e64 v27, s75, v7
  v_add_u32_e64 v28, s75, v8
  v_add_u32_e64 v29, s75, v9
  s_add_u32 s75, s75, 24576
  s_cmp_eq_u32 s75, 147456
  s_cselect_b32 s75, 0, s75
  s_waitcnt lgkmcnt(0)
.p2align 3
L_wo_loop:
  s_barrier
  s_sub_u32 s79, s79, 1
  v_mfma_f32_16x16x32_bf16 v[128:131], v[48:51], v[32:35], v[128:131]
  ds_read_b128 v[80:83], v25 offset:0
  ds_read_b128 v[84:87], v25 offset:2048
  v_mfma_f32_16x16x32_bf16 v[132:135], v[48:51], v[36:39], v[132:135]
  ds_read_b64_tr_b16 v[96:97], v26 offset:0
  ds_read_b64_tr_b16 v[98:99], v26 offset:512
  v_mfma_f32_16x16x32_bf16 v[136:139], v[52:55], v[32:35], v[136:139]
  ds_read_b64_tr_b16 v[100:101], v27 offset:0
  ds_read_b64_tr_b16 v[102:103], v27 offset:512
  v_mfma_f32_16x16x32_bf16 v[140:143], v[52:55], v[36:39], v[140:143]
  ds_read_b64_tr_b16 v[104:105], v28 offset:0
  ds_read_b64_tr_b16 v[106:107], v28 offset:512
  v_mfma_f32_16x16x32_bf16 v[144:147], v[56:59], v[32:35], v[144:147]
  ds_read_b64_tr_b16 v[108:109], v29 offset:0
  ds_read_b64_tr_b16 v[110:111], v29 offset:512
  v_mfma_f32_16x16x32_bf16 v[148:151], v[56:59], v[36:39], v[148:151]
  ds_read_b128 v[88:91], v25 offset:1024
  ds_read_b128 v[92:95], v25 offset:3072
  v_mfma_f32_16x16x32_bf16 v[152:155], v[60:63], v[32:35], v[152:155]
  ds_read_b64_tr_b16 v[112:113], v26 offset:4096
  ds_read_b64_tr_b16 v[114:115], v26 offset:4608
  v_mfma_f32_16x16x32_bf16 v[156:159], v[60:63], v[36:39], v[156:159]
  ds_read_b64_tr_b16 v[116:117], v27 offset:4096
  ds_read_b64_tr_b16 v[118:119], v27 offset:4608
  v_mfma_f32_16x16x32_bf16 v[128:131], v[64:67], v[40:43], v[128:131]
  ds_read_b64_tr_b16 v[120:121], v28 offset:4096
  ds_read_b64_tr_b16 v[122:123], v28 offset:4608
  v_mfma_f32_16x16x32_bf16 v[132:135], v[64:67], v[44:47], v[132:135]
  ds_read_b64_tr_b16 v[124:125], v29 offset:4096
  ds_read_b64_tr_b16 v[126:127], v29 offset:4608
  v_mfma_f32_16x16x32_bf16 v[136:139], v[68:71], v[40:43], v[136:139]
  v_add_u32_e64 v25, s75, v5
  v_add_u32_e64 v26, s75, v6
  v_mfma_f32_16x16x32_bf16 v[140:143], v[68:71], v[44:47], v[140:143]
  v_add_u32_e64 v27, s75, v7
  v_add_u32_e64 v28, s75, v8
  v_mfma_f32_16x16x32_bf16 v[144:147], v[72:75], v[40:43], v[144:147]
  v_add_u32_e64 v29, s75, v9
  s_add_u32 s75, s75, 24576
  v_mfma_f32_16x16x32_bf16 v[148:151], v[72:75], v[44:47], v[148:151]
  s_cmp_eq_u32 s75, 147456
  s_cselect_b32 s75, 0, s75
  s_nop 0
  v_mfma_f32_16x16x32_bf16 v[152:155], v[76:79], v[40:43], v[152:155]
  v_mfma_f32_16x16x32_bf16 v[156:159], v[76:79], v[44:47], v[156:159]
  s_waitcnt lgkmcnt(0)
  s_barrier
  v_mfma_f32_16x16x32_bf16 v[128:131], v[96:99], v[80:83], v[128:131]
  ds_read_b128 v[32:35], v25 offset:0
  ds_read_b128 v[36:39], v25 offset:2048
  v_mfma_f32_16x16x32_bf16 v[132:135], v[96:99], v[84:87], v[132:135]
  ds_read_b64_tr_b16 v[48:49], v26 offset:0
  ds_read_b64_tr_b16 v[50:51], v26 offset:512
  v_mfma_f32_16x16x32_bf16 v[136:139], v[100:103], v[80:83], v[136:139]
  ds_read_b64_tr_b16 v[52:53], v27 offset:0
  ds_read_b64_tr_b16 v[54:55], v27 offset:512
  v_mfma_f32_16x16x32_bf16 v[140:143], v[100:103], v[84:87], v[140:143]
  ds_read_b64_tr_b16 v[56:57], v28 offset:0
  ds_read_b64_tr_b16 v[58:59], v28 offset:512
  v_mfma_f32_16x16x32_bf16 v[144:147], v[104:107], v[80:83], v[144:147]
  ds_read_b64_tr_b16 v[60:61], v29 offset:0
  ds_read_b64_tr_b16 v[62:63], v29 offset:512
  v_mfma_f32_16x16x32_bf16 v[148:151], v[104:107], v[84:87], v[148:151]
  ds_read_b128 v[40:43], v25 offset:1024
  ds_read_b128 v[44:47], v25 offset:3072
  v_mfma_f32_16x16x32_bf16 v[152:155], v[108:111], v[80:83], v[152:155]
  ds_read_b64_tr_b16 v[64:65], v26 offset:4096
  ds_read_b64_tr_b16 v[66:67], v26 offset:4608
  v_mfma_f32_16x16x32_bf16 v[156:159], v[108:111], v[84:87], v[156:159]
  ds_read_b64_tr_b16 v[68:69], v27 offset:4096
  ds_read_b64_tr_b16 v[70:71], v27 offset:4608
  v_mfma_f32_16x16x32_bf16 v[128:131], v[112:115], v[88:91], v[128:131]
  ds_read_b64_tr_b16 v[72:73], v28 offset:4096
  ds_read_b64_tr_b16 v[74:75], v28 offset:4608
  v_mfma_f32_16x16x32_bf16 v[132:135], v[112:115], v[92:95], v[132:135]
  ds_read_b64_tr_b16 v[76:77], v29 offset:4096
  ds_read_b64_tr_b16 v[78:79], v29 offset:4608
  v_mfma_f32_16x16x32_bf16 v[136:139], v[116:119], v[88:91], v[136:139]
  v_add_u32_e64 v25, s75, v5
  v_add_u32_e64 v26, s75, v6
  v_mfma_f32_16x16x32_bf16 v[140:143], v[116:119], v[92:95], v[140:143]
  v_add_u32_e64 v27, s75, v7
  v_add_u32_e64 v28, s75, v8
  v_mfma_f32_16x16x32_bf16 v[144:147], v[120:123], v[88:91], v[144:147]
  v_add_u32_e64 v29, s75, v9
  s_add_u32 s75, s75, 24576
  v_mfma_f32_16x16x32_bf16 v[148:151], v[120:123], v[92:95], v[148:151]
  s_cmp_eq_u32 s75, 147456
  s_cselect_b32 s75, 0, s75
  s_cmp_lg_u32 s79, 0
  v_mfma_f32_16x16x32_bf16 v[152:155], v[124:127], v[88:91], v[152:155]
  v_mfma_f32_16x16x32_bf16 v[156:159], v[124:127], v[92:95], v[156:159]
  s_waitcnt lgkmcnt(0)
  s_cbranch_scc1 L_wo_loop
  v_xor_b32 v26, 32, v15
  v_xor_b32 v27, 64, v15
  v_xor_b32 v28, 96, v15
  ds_read_b64 v[160:161], v15 offset:0
  ds_read_b64 v[164:165], v26 offset:0
  ds_read_b64 v[168:169], v27 offset:0
  ds_read_b64 v[172:173], v28 offset:0
  ds_read_b64 v[162:163], v15 offset:2048
  ds_read_b64 v[166:167], v26 offset:2048
  ds_read_b64 v[170:171], v27 offset:2048
  ds_read_b64 v[174:175], v28 offset:2048
  v_mov_b32 v20, 0
  v_mov_b32 v21, 0
  v_mov_b32 v22, 0
  v_mov_b32 v23, 0
  s_mov_b32 s3, 32768
  s_mov_b32 s10, 0x3f803f80
  s_waitcnt lgkmcnt(7)
  v_lshlrev_b32 v184, 16, v160
  v_and_b32 v185, s11, v160
  v_lshlrev_b32 v186, 16, v161
  v_and_b32 v187, s11, v161
  v_pk_add_f32 v[128:129], v[128:129], v[184:185]
  v_pk_add_f32 v[130:131], v[130:131], v[186:187]
  v_cvt_pk_bf16_f32 v32, v128, v129
  v_cvt_pk_bf16_f32 v33, v130, v131
  s_waitcnt lgkmcnt(6)
  v_lshlrev_b32 v184, 16, v164
  v_and_b32 v185, s11, v164
  v_lshlrev_b32 v186, 16, v165
  v_and_b32 v187, s11, v165
  v_pk_add_f32 v[136:137], v[136:137], v[184:185]
  v_pk_add_f32 v[138:139], v[138:139], v[186:187]
  v_cvt_pk_bf16_f32 v34, v136, v137
  v_cvt_pk_bf16_f32 v35, v138, v139
  s_nop 1
  v_permlane16_swap_b32 v32, v34
  v_permlane16_swap_b32 v33, v35
  buffer_store_dwordx4 v[32:35], v12, s[44:47], 0 offen offset:0 sc1
  s_waitcnt lgkmcnt(5)
  v_lshlrev_b32 v184, 16, v168
  v_and_b32 v185, s11, v168
  v_lshlrev_b32 v186, 16, v169
  v_and_b32 v187, s11, v169
  v_pk_add_f32 v[144:145], v[144:145], v[184:185]
  v_pk_add_f32 v[146:147], v[146:147], v[186:187]
  v_cvt_pk_bf16_f32 v36, v144, v145
  v_cvt_pk_bf16_f32 v37, v146, v147
  s_waitcnt lgkmcnt(4)
  v_lshlrev_b32 v184, 16, v172
  v_and_b32 v185, s11, v172
  v_lshlrev_b32 v186, 16, v173
  v_and_b32 v187, s11, v173
  v_pk_add_f32 v[152:153], v[152:153], v[184:185]
  v_pk_add_f32 v[154:155], v[154:155], v[186:187]
  v_cvt_pk_bf16_f32 v38, v152, v153
  v_cvt_pk_bf16_f32 v39, v154, v155
  s_nop 1
  v_permlane16_swap_b32 v36, v38
  v_permlane16_swap_b32 v37, v39
  buffer_store_dwordx4 v[36:39], v12, s[44:47], 0 offen offset:1024 sc1
  s_waitcnt lgkmcnt(3)
  v_lshlrev_b32 v184, 16, v162
  v_and_b32 v185, s11, v162
  v_lshlrev_b32 v186, 16, v163
  v_and_b32 v187, s11, v163
  v_pk_add_f32 v[132:133], v[132:133], v[184:185]
  v_pk_add_f32 v[134:135], v[134:135], v[186:187]
  v_cvt_pk_bf16_f32 v40, v132, v133
  v_cvt_pk_bf16_f32 v41, v134, v135
  s_waitcnt lgkmcnt(2)
  v_lshlrev_b32 v184, 16, v166
  v_and_b32 v185, s11, v166
  v_lshlrev_b32 v186, 16, v167
  v_and_b32 v187, s11, v167
  v_pk_add_f32 v[140:141], v[140:141], v[184:185]
  v_pk_add_f32 v[142:143], v[142:143], v[186:187]
  v_cvt_pk_bf16_f32 v42, v140, v141
  v_cvt_pk_bf16_f32 v43, v142, v143
  s_nop 1
  v_permlane16_swap_b32 v40, v42
  v_permlane16_swap_b32 v41, v43
  buffer_store_dwordx4 v[40:43], v12, s[44:47], s3 offen offset:0 sc1
  s_waitcnt lgkmcnt(1)
  v_lshlrev_b32 v184, 16, v170
  v_and_b32 v185, s11, v170
  v_lshlrev_b32 v186, 16, v171
  v_and_b32 v187, s11, v171
  v_pk_add_f32 v[148:149], v[148:149], v[184:185]
  v_pk_add_f32 v[150:151], v[150:151], v[186:187]
  v_cvt_pk_bf16_f32 v44, v148, v149
  v_cvt_pk_bf16_f32 v45, v150, v151
  s_waitcnt lgkmcnt(0)
  v_lshlrev_b32 v184, 16, v174
  v_and_b32 v185, s11, v174
  v_lshlrev_b32 v186, 16, v175
  v_and_b32 v187, s11, v175
  v_pk_add_f32 v[156:157], v[156:157], v[184:185]
  v_pk_add_f32 v[158:159], v[158:159], v[186:187]
  v_cvt_pk_bf16_f32 v46, v156, v157
  v_cvt_pk_bf16_f32 v47, v158, v159
  s_nop 1
  v_permlane16_swap_b32 v44, v46
  v_permlane16_swap_b32 v45, v47
  buffer_store_dwordx4 v[44:47], v12, s[44:47], s3 offen offset:1024 sc1
  v_dot2_f32_bf16 v20, v32, s10, v20
  v_dot2_f32_bf16 v22, v32, v32, v22
  v_dot2_f32_bf16 v20, v33, s10, v20
  v_dot2_f32_bf16 v22, v33, v33, v22
  v_dot2_f32_bf16 v20, v34, s10, v20
  v_dot2_f32_bf16 v22, v34, v34, v22
  v_dot2_f32_bf16 v20, v35, s10, v20
  v_dot2_f32_bf16 v22, v35, v35, v22
  v_dot2_f32_bf16 v20, v36, s10, v20
  v_dot2_f32_bf16 v22, v36, v36, v22
  v_dot2_f32_bf16 v20, v37, s10, v20
  v_dot2_f32_bf16 v22, v37, v37, v22
  v_dot2_f32_bf16 v20, v38, s10, v20
  v_dot2_f32_bf16 v22, v38, v38, v22
  v_dot2_f32_bf16 v20, v39, s10, v20
  v_dot2_f32_bf16 v22, v39, v39, v22
  v_dot2_f32_bf16 v21, v40, s10, v21
  v_dot2_f32_bf16 v23, v40, v40, v23
  v_dot2_f32_bf16 v21, v41, s10, v21
  v_dot2_f32_bf16 v23, v41, v41, v23
  v_dot2_f32_bf16 v21, v42, s10, v21
  v_dot2_f32_bf16 v23, v42, v42, v23
  v_dot2_f32_bf16 v21, v43, s10, v21
  v_dot2_f32_bf16 v23, v43, v43, v23
  v_dot2_f32_bf16 v21, v44, s10, v21
  v_dot2_f32_bf16 v23, v44, v44, v23
  v_dot2_f32_bf16 v21, v45, s10, v21
  v_dot2_f32_bf16 v23, v45, v45, v23
  v_dot2_f32_bf16 v21, v46, s10, v21
  v_dot2_f32_bf16 v23, v46, v46, v23
  v_dot2_f32_bf16 v21, v47, s10, v21
  v_dot2_f32_bf16 v23, v47, v47, v23
  s_nop 2
  v_permlane32_swap_b32 v20, v21
  v_permlane32_swap_b32 v22, v23
  v_add_f32 v20, v20, v21
  v_add_f32 v22, v22, v23
  s_nop 1
  v_permlane16_swap_b32 v20, v22
  v_add_f32 v20, v20, v22
  buffer_store_dword v20, v18, s[56:59], 0 offen sc1
  s_waitcnt vmcnt(0)
  s_barrier
  s_add_u32 s97, s97, 1
  s_branch L_w1_body
L_wo_c1:
L_w1_c0:
L_w1_body:
  s_cmp_ge_u32 s2, 256
  s_cbranch_scc1 L_w1_end
  v_lshrrev_b32 v2, 6, v0
  v_and_b32 v1, 63, v0
  v_readfirstlane_b32 s70, v2
  s_and_b32 s3, s2, 7
  s_lshr_b32 s99, s2, 3
  s_and_b32 s5, s3, 1
  s_lshl_b32 s5, s5, 3
  s_and_b32 s6, s99, 7
  s_add_u32 s68, s5, s6
  s_lshr_b32 s5, s3, 1
  s_lshl_b32 s5, s5, 2
  s_lshr_b32 s6, s99, 3
  s_add_u32 s69, s5, s6
  s_cmp_lt_u32 s70, 4
  s_cbranch_scc1 L_w1_compute
L_w1_loader:
  s_add_u32 s8, s70, s69
  s_and_b32 s8, s8, 3
  s_add_u32 s9, s70, s68
  s_and_b32 s9, s9, 3
  s_lshl_b32 s76, s8, 12
  s_lshl_b32 s77, s9, 11
  s_add_u32 s77, s77, 16384
  s_lshl_b32 s11, s68, 7
  v_and_b32 v10, 7, v1
  s_lshr_b32 s10, s76, 11
  s_lshl_b32 s3, s68, 3
  s_add_u32 s10, s10, s3
  s_mul_i32 s10, s10, 32768
  v_lshl_add_u32 v4, v1, 4, s10
  v_add_u32 v5, 32768, v4
  v_lshrrev_b32 v3, 3, v1
  s_lshl_b32 s10, s9, 4
  v_add_u32 v3, s10, v3
  v_mul_u32_u24 v3, 7168, v3
  v_lshrrev_b32 v2, 3, v1
  v_and_b32 v2, 2, v2
  v_xor_b32 v2, v2, v10
  s_mul_i32 s10, s69, 128
  v_add_u32 v3, s10, v3
  v_lshl_add_u32 v8, v2, 4, v3
  v_xor_b32 v2, 4, v2
  v_add_u32 v3, 57344, v3
  v_lshl_add_u32 v9, v2, 4, v3
  v_lshrrev_b32 v3, 2, v1
  s_lshl_b32 s10, s9, 4
  v_add_u32 v3, s10, v3
  v_mul_u32_u24 v3, 7168, v3
  v_lshrrev_b32 v2, 4, v1
  v_and_b32 v2, 2, v2
  v_xor_b32 v2, v2, v1
  v_and_b32 v2, 3, v2
  s_lshl_b32 s10, s69, 6
  s_add_u32 s10, s10, 2048
  v_add_u32 v3, s10, v3
  v_lshl_add_u32 v28, v2, 4, v3
  s_lshl_b32 s78, s69, 7
  s_add_u32 s78, s78, 3072
  s_mov_b32 s75, 0
  s_add_u32 s100, s68, s69
  s_mov_b32 s101, -1
  s_add_u32 s101, s101, 1
  s_sub_u32 s73, s101, s100
  s_lshl_b32 s73, s73, 3
  s_lshr_b32 s73, 0xf0f02, s73
  s_and_b32 s73, s73, 255
  s_add_u32 s73, s73, s101
  s_and_b32 s73, s73, 15
  s_mul_i32 s74, s73, 458752
  s_lshl_b32 s73, s73, 11
  s_waitcnt lgkmcnt(0)
  s_add_u32 s36, s34, 4194304
  s_addc_u32 s37, s35, 0
  s_and_b32 s37, s37, 0xffff
  s_mov_b32 s38, 4194304
  s_mov_b32 s39, 0x00020000
  s_mov_b32 s40, s24
  s_and_b32 s41, s25, 0xffff
  s_mov_b32 s42, 7340032
  s_mov_b32 s43, 0x00020000
  s_add_u32 s56, s34, 24117248
  s_addc_u32 s57, s35, 0
  s_and_b32 s57, s57, 0xffff
  s_mov_b32 s58, 262144
  s_mov_b32 s59, 0x00020000
  s_add_u32 s64, s22, 24641536
  s_addc_u32 s65, s23, 0
  s_and_b32 s65, s65, 0xffff
  s_mov_b32 s66, 262144
  s_mov_b32 s67, 0x00020000
  s_mov_b32 s52, s26
  s_and_b32 s53, s27, 0xffff
  s_mov_b32 s54, 7168
  s_mov_b32 s55, 0x00020000
  s_mov_b32 s60, s28
  s_and_b32 s61, s29, 0xffff
  s_mov_b32 s62, 7340032
  s_mov_b32 s63, 0x00020000
  s_cmp_eq_u32 s96, 0
  s_cselect_b32 s62, s62, 0
  s_and_b32 s3, s70, 3
  s_lshl_b32 s4, s2, 2
  s_add_u32 s3, s3, s4
  s_mul_i32 s98, s3, 7168
  s_add_u32 s3, s96, s70
  s_cmp_lg_u32 s3, 4
  s_cbranch_scc1 L_w1_chk
  s_add_u32 s44, s22, 24903680
  s_addc_u32 s45, s23, 0
  s_and_b32 s45, s45, 0xffff
  s_mov_b32 s46, 32768
  s_mov_b32 s47, 0x00020000
  s_mov_b32 s79, 0x100000
  v_lshrrev_b32 v2, 2, v1
  v_and_b32 v3, 3, v1
  v_lshlrev_b32 v2, 8, v2
  v_lshl_add_u32 v2, v3, 4, v2
L_w1_chkl:
  buffer_load_dwordx4 v[12:15], v2, s[44:47], 0 offen sc1
  s_sub_u32 s79, s79, 1
  s_cbranch_scc1 L_w1_chk
  s_waitcnt vmcnt(0)
  v_and_b32 v12, v12, v13
  v_and_b32 v14, v14, v15
  v_and_b32 v12, v12, v14
  v_cmp_ne_u32 vcc, 1, v12
  s_cbranch_vccnz L_w1_chkl
L_w1_chk:
  s_mov_b32 s88, s73
  s_add_u32 m0, s77, 0
  s_add_u32 s4, s74, 0
  buffer_load_dwordx4 v8, s[40:43], s4 offen lds
  s_add_u32 m0, s77, 1024
  s_nop 0
  buffer_load_dwordx4 v9, s[40:43], s4 offen lds
  s_add_u32 m0, s77, 8192
  s_add_u32 s4, s74, s78
  buffer_load_dwordx4 v8, s[40:43], s4 offen lds
  s_add_u32 m0, s77, 9216
  s_nop 0
  buffer_load_dwordx4 v9, s[40:43], s4 offen lds
  s_add_u32 m0, s77, 16384
  s_add_u32 s4, s4, 128
  buffer_load_dwordx4 v8, s[40:43], s4 offen lds
  s_add_u32 m0, s77, 17408
  s_nop 0
  buffer_load_dwordx4 v9, s[40:43], s4 offen lds
  s_add_u32 m0, s77, 24576
  s_nop 0
  buffer_load_dwordx4 v28, s[40:43], s74 offen lds
  s_add_u32 s101, s101, 1
  s_sub_u32 s73, s101, s100
  s_lshl_b32 s73, s73, 3
  s_lshr_b32 s73, 0xf0f02, s73
  s_and_b32 s73, s73, 255
  s_add_u32 s73, s73, s101
  s_and_b32 s73, s73, 15
  s_mul_i32 s74, s73, 458752
  s_lshl_b32 s73, s73, 11
  s_mov_b32 s89, s73
  s_add_u32 m0, s77, 49152
  s_add_u32 s4, s74, 0
  buffer_load_dwordx4 v8, s[40:43], s4 offen lds
  s_add_u32 m0, s77, 50176
  s_nop 0
  buffer_load_dwordx4 v9, s[40:43], s4 offen lds
  s_add_u32 m0, s77, 57344
  s_add_u32 s4, s74, s78
  buffer_load_dwordx4 v8, s[40:43], s4 offen lds
  s_add_u32 m0, s77, 58368
  s_nop 0
  buffer_load_dwordx4 v9, s[40:43], s4 offen lds
  s_add_u32 m0, s77, 65536
  s_add_u32 s4, s4, 128
  buffer_load_dwordx4 v8, s[40:43], s4 offen lds
  s_add_u32 m0, s77, 66560
  s_nop 0
  buffer_load_dwordx4 v9, s[40:43], s4 offen lds
  s_add_u32 m0, s77, 73728
  s_nop 0
  buffer_load_dwordx4 v28, s[40:43], s74 offen lds
  s_add_u32 s101, s101, 1
  s_sub_u32 s73, s101, s100
  s_lshl_b32 s73, s73, 3
  s_lshr_b32 s73, 0xf0f02, s73
  s_and_b32 s73, s73, 255
  s_add_u32 s73, s73, s101
  s_and_b32 s73, s73, 15
  s_mul_i32 s74, s73, 458752
  s_lshl_b32 s73, s73, 11
  s_mov_b32 s75, 98304
  s_add_u32 s44, s22, 24903680
  s_addc_u32 s45, s23, 0
  s_and_b32 s45, s45, 0xffff
  s_mov_b32 s46, 32768
  s_mov_b32 s47, 0x00020000
  s_lshl_b32 s3, s97, 12
  s_lshl_b32 s4, s68, 8
  s_add_u32 s3, s3, s4
  s_sub_u32 s3, s3, 4096
  v_and_b32 v2, 15, v1
  v_lshlrev_b32 v2, 2, v2
  v_mov_b32 v3, 1
  s_mov_b32 s79, 0x100000
  s_cmp_lg_u32 s70, 4
  s_barrier
  s_cbranch_scc1 L_w1_dep
  s_mov_b64 exec, 1
  buffer_store_dword v3, off, s[44:47], s87 sc1
  s_mov_b64 exec, -1
L_w1_poll:
  buffer_load_dword v3, v2, s[44:47], s3 offen sc1
  s_sub_u32 s79, s79, 1
  s_cbranch_scc1 L_w1_dep
  s_waitcnt vmcnt(0)
  v_cmp_ne_u32 vcc, 1, v3
  s_cbranch_vccnz L_w1_poll
L_w1_dep:
  s_barrier
  s_add_u32 m0, s76, 0
  s_nop 0
  buffer_load_dwordx4 v4, s[36:39], s88 offen offset:0 lds
  buffer_load_dwordx4 v4, s[36:39], s88 offen offset:1024 lds
  s_add_u32 m0, s76, 2048
  s_nop 0
  buffer_load_dwordx4 v5, s[36:39], s88 offen offset:0 lds
  buffer_load_dwordx4 v5, s[36:39], s88 offen offset:1024 lds
  s_add_u32 m0, s76, 49152
  s_nop 0
  buffer_load_dwordx4 v4, s[36:39], s89 offen offset:0 lds
  buffer_load_dwordx4 v4, s[36:39], s89 offen offset:1024 lds
  s_add_u32 m0, s76, 51200
  s_nop 0
  buffer_load_dwordx4 v5, s[36:39], s89 offen offset:0 lds
  buffer_load_dwordx4 v5, s[36:39], s89 offen offset:1024 lds
  s_waitcnt vmcnt(4)
  s_barrier
  s_mov_b32 s79, 13
L_w1_ld1:
  s_add_u32 s3, s75, s76
  s_add_u32 m0, s3, 0
  s_nop 0
  buffer_load_dwordx4 v4, s[36:39], s73 offen offset:0 lds
  buffer_load_dwordx4 v4, s[36:39], s73 offen offset:1024 lds
  s_add_u32 m0, s3, 2048
  s_nop 0
  buffer_load_dwordx4 v5, s[36:39], s73 offen offset:0 lds
  buffer_load_dwordx4 v5, s[36:39], s73 offen offset:1024 lds
  s_add_u32 s3, s75, s77
  s_add_u32 m0, s3, 0
  s_add_u32 s4, s74, 0
  buffer_load_dwordx4 v8, s[40:43], s4 offen lds
  s_add_u32 m0, s3, 1024
  s_nop 0
  buffer_load_dwordx4 v9, s[40:43], s4 offen lds
  s_add_u32 m0, s3, 8192
  s_add_u32 s4, s74, s78
  buffer_load_dwordx4 v8, s[40:43], s4 offen lds
  s_add_u32 m0, s3, 9216
  s_nop 0
  buffer_load_dwordx4 v9, s[40:43], s4 offen lds
  s_add_u32 m0, s3, 16384
  s_add_u32 s4, s4, 128
  buffer_load_dwordx4 v8, s[40:43], s4 offen lds
  s_add_u32 m0, s3, 17408
  s_nop 0
  buffer_load_dwordx4 v9, s[40:43], s4 offen lds
  s_add_u32 m0, s3, 24576
  s_nop 0
  buffer_load_dwordx4 v28, s[40:43], s74 offen lds
  s_add_u32 s101, s101, 1
  s_sub_u32 s73, s101, s100
  s_lshl_b32 s73, s73, 3
  s_lshr_b32 s73, 0xf0f02, s73
  s_and_b32 s73, s73, 255
  s_add_u32 s73, s73, s101
  s_and_b32 s73, s73, 15
  s_mul_i32 s74, s73, 458752
  s_lshl_b32 s73, s73, 11
  s_add_u32 s75, s75, 49152
  s_cmp_eq_u32 s75, 147456
  s_cselect_b32 s75, 0, s75
  s_buffer_load_dword s84, s[60:63], s98 offset:3584
  s_buffer_load_dword s84, s[60:63], s98 offset:3648
  s_buffer_load_dword s84, s[60:63], s98 offset:3712
  s_buffer_load_dword s84, s[60:63], s98 offset:3776
  s_add_u32 s98, s98, 256
  s_waitcnt vmcnt(11)
  s_barrier
  s_sub_u32 s79, s79, 1
  s_cmp_lg_u32 s79, 0
  s_cbranch_scc1 L_w1_ld1
  s_add_u32 s3, s75, s76
  s_add_u32 m0, s3, 0
  s_nop 0
  buffer_load_dwordx4 v4, s[36:39], s73 offen offset:0 lds
  buffer_load_dwordx4 v4, s[36:39], s73 offen offset:1024 lds
  s_add_u32 m0, s3, 2048
  s_nop 0
  buffer_load_dwordx4 v5, s[36:39], s73 offen offset:0 lds
  buffer_load_dwordx4 v5, s[36:39], s73 offen offset:1024 lds
  s_add_u32 s3, s75, s77
  s_add_u32 m0, s3, 0
  s_add_u32 s4, s74, 0
  buffer_load_dwordx4 v8, s[40:43], s4 offen lds
  s_add_u32 m0, s3, 1024
  s_nop 0
  buffer_load_dwordx4 v9, s[40:43], s4 offen lds
  s_add_u32 m0, s3, 8192
  s_add_u32 s4, s74, s78
  buffer_load_dwordx4 v8, s[40:43], s4 offen lds
  s_add_u32 m0, s3, 9216
  s_nop 0
  buffer_load_dwordx4 v9, s[40:43], s4 offen lds
  s_add_u32 m0, s3, 16384
  s_add_u32 s4, s4, 128
  buffer_load_dwordx4 v8, s[40:43], s4 offen lds
  s_add_u32 m0, s3, 17408
  s_nop 0
  buffer_load_dwordx4 v9, s[40:43], s4 offen lds
  s_add_u32 m0, s3, 24576
  s_nop 0
  buffer_load_dwordx4 v28, s[40:43], s74 offen lds
  s_add_u32 s101, s101, 1
  s_sub_u32 s73, s101, s100
  s_lshl_b32 s73, s73, 3
  s_lshr_b32 s73, 0xf0f02, s73
  s_and_b32 s73, s73, 255
  s_add_u32 s73, s73, s101
  s_and_b32 s73, s73, 15
  s_mul_i32 s74, s73, 458752
  s_lshl_b32 s73, s73, 11
  s_add_u32 s75, s75, 49152
  s_cmp_eq_u32 s75, 147456
  s_cselect_b32 s75, 0, s75
  s_buffer_load_dword s84, s[60:63], s98 offset:3584
  s_buffer_load_dword s84, s[60:63], s98 offset:3648
  s_buffer_load_dword s84, s[60:63], s98 offset:3712
  s_buffer_load_dword s84, s[60:63], s98 offset:3776
  s_add_u32 s98, s98, 256
  s_and_b32 s3, s70, 3
  s_lshl_b32 s4, s68, 7
  s_lshl_b32 s5, s3, 6
  s_add_u32 s5, s5, s4
  v_add_u32 v2, s5, v1
  s_sub_u32 s4, s4, 16
  v_and_b32 v3, 15, v1
  v_add_u32 v3, s4, v3
  v_max_i32 v3, 0, v3
  s_cmp_ge_u32 s3, 2
  s_cselect_b64 vcc, -1, 0
  v_cndmask_b32 v2, v2, v3, vcc
  v_lshlrev_b32 v2, 3, v2
  s_mov_b32 s3, 0
  buffer_load_dwordx2 v[32:33], v2, s[56:59], s3 offen
  s_add_u32 s3, s3, 16384
  buffer_load_dwordx2 v[34:35], v2, s[56:59], s3 offen
  s_add_u32 s3, s3, 16384
  buffer_load_dwordx2 v[36:37], v2, s[56:59], s3 offen
  s_add_u32 s3, s3, 16384
  buffer_load_dwordx2 v[38:39], v2, s[56:59], s3 offen
  s_add_u32 s3, s3, 16384
  buffer_load_dwordx2 v[40:41], v2, s[56:59], s3 offen
  s_add_u32 s3, s3, 16384
  buffer_load_dwordx2 v[42:43], v2, s[56:59], s3 offen
  s_add_u32 s3, s3, 16384
  buffer_load_dwordx2 v[44:45], v2, s[56:59], s3 offen
  s_add_u32 s3, s3, 16384
  buffer_load_dwordx2 v[46:47], v2, s[56:59], s3 offen
  s_add_u32 s3, s3, 16384
  buffer_load_dwordx2 v[48:49], v2, s[56:59], s3 offen
  s_add_u32 s3, s3, 16384
  buffer_load_dwordx2 v[50:51], v2, s[56:59], s3 offen
  s_add_u32 s3, s3, 16384
  buffer_load_dwordx2 v[52:53], v2, s[56:59], s3 offen
  s_add_u32 s3, s3, 16384
  buffer_load_dwordx2 v[54:55], v2, s[56:59], s3 offen
  s_add_u32 s3, s3, 16384
  buffer_load_dwordx2 v[56:57], v2, s[56:59], s3 offen
  s_add_u32 s3, s3, 16384
  buffer_load_dwordx2 v[58:59], v2, s[56:59], s3 offen
  s_add_u32 s3, s3, 16384
  buffer_load_dwordx2 v[60:61], v2, s[56:59], s3 offen
  s_add_u32 s3, s3, 16384
  buffer_load_dwordx2 v[62:63], v2, s[56:59], s3 offen
  s_lshl_b32 s4, s69, 7
  s_lshl_b32 s5, s70, 6
  s_add_u32 s4, s4, s5
  s_add_u32 s4, s4, 1216
  s_lshl_b32 s5, s69, 6
  s_cmp_eq_u32 s70, 4
  s_cselect_b32 s4, s5, s4
  s_lshr_b32 s5, s5, 1
  s_add_u32 s5, s5, 1024
  s_cmp_eq_u32 s70, 7
  s_cselect_b32 s4, s5, s4
  v_add_u32 v3, s4, v1
  v_lshlrev_b32 v2, 2, v3
  v_lshlrev_b32 v3, 1, v3
  s_mov_b32 s3, 0
  buffer_load_dword v64, v2, s[64:67], s3 offen
  s_add_u32 s3, s3, 16384
  buffer_load_dword v65, v2, s[64:67], s3 offen
  s_add_u32 s3, s3, 16384
  buffer_load_dword v66, v2, s[64:67], s3 offen
  s_add_u32 s3, s3, 16384
  buffer_load_dword v67, v2, s[64:67], s3 offen
  s_add_u32 s3, s3, 16384
  buffer_load_dword v68, v2, s[64:67], s3 offen
  s_add_u32 s3, s3, 16384
  buffer_load_dword v69, v2, s[64:67], s3 offen
  s_add_u32 s3, s3, 16384
  buffer_load_dword v70, v2, s[64:67], s3 offen
  s_add_u32 s3, s3, 16384
  buffer_load_dword v71, v2, s[64:67], s3 offen
  s_add_u32 s3, s3, 16384
  buffer_load_dword v72, v2, s[64:67], s3 offen
  s_add_u32 s3, s3, 16384
  buffer_load_dword v73, v2, s[64:67], s3 offen
  s_add_u32 s3, s3, 16384
  buffer_load_dword v74, v2, s[64:67], s3 offen
  s_add_u32 s3, s3, 16384
  buffer_load_dword v75, v2, s[64:67], s3 offen
  s_add_u32 s3, s3, 16384
  buffer_load_dword v76, v2, s[64:67], s3 offen
  s_add_u32 s3, s3, 16384
  buffer_load_dword v77, v2, s[64:67], s3 offen
  s_add_u32 s3, s3, 16384
  buffer_load_dword v78, v2, s[64:67], s3 offen
  s_add_u32 s3, s3, 16384
  buffer_load_dword v79, v2, s[64:67], s3 offen
  buffer_load_ushort v80, v3, s[52:55], 0 offen
  s_waitcnt vmcnt(44)
  s_barrier
  s_waitcnt vmcnt(33)
  s_barrier
  s_waitcnt vmcnt(0)
  v_add_f32 v32, v32, v34
  v_add_f32 v33, v33, v35
  v_add_f32 v48, v48, v50
  v_add_f32 v49, v49, v51
  v_add_f32 v32, v32, v36
  v_add_f32 v33, v33, v37
  v_add_f32 v48, v48, v52
  v_add_f32 v49, v49, v53
  v_add_f32 v32, v32, v38
  v_add_f32 v33, v33, v39
  v_add_f32 v48, v48, v54
  v_add_f32 v49, v49, v55
  v_add_f32 v32, v32, v40
  v_add_f32 v33, v33, v41
  v_add_f32 v48, v48, v56
  v_add_f32 v49, v49, v57
  v_add_f32 v32, v32, v42
  v_add_f32 v33, v33, v43
  v_add_f32 v48, v48, v58
  v_add_f32 v49, v49, v59
  v_add_f32 v32, v32, v44
  v_add_f32 v33, v33, v45
  v_add_f32 v48, v48, v60
  v_add_f32 v49, v49, v61
  v_add_f32 v32, v32, v46
  v_add_f32 v33, v33, v47
  v_add_f32 v48, v48, v62
  v_add_f32 v49, v49, v63
  v_add_f32 v32, v32, v48
  v_add_f32 v33, v33, v49
  v_mul_f32 v32, 0x3a800000, v32
  v_mul_f32 v33, 0x3a800000, v33
  v_fma_f32 v33, -v32, v32, v33
  v_max_f32 v33, 0, v33
  v_add_f32 v33, 0x3727c5ac, v33
  v_rsq_f32 v33, v33
  s_nop 0
  s_and_b32 s3, s70, 3
  s_lshl_b32 s5, s3, 6
  s_add_u32 s5, s5, 16
  v_add_u32 v2, s5, v1
  v_and_b32 v3, 15, v1
  s_cmp_ge_u32 s3, 2
  s_cselect_b64 vcc, -1, 0
  v_cndmask_b32 v2, v2, v3, vcc
  v_lshlrev_b32 v2, 2, v2
  v_add_u32 v2, 147456, v2
  ds_write2_b32 v2, v32, v33 offset0:0 offset1:160
  v_add_f32 v64, v64, v72
  v_add_f32 v65, v65, v73
  v_add_f32 v66, v66, v74
  v_add_f32 v67, v67, v75
  v_add_f32 v68, v68, v76
  v_add_f32 v69, v69, v77
  v_add_f32 v70, v70, v78
  v_add_f32 v71, v71, v79
  v_add_f32 v64, v64, v68
  v_add_f32 v65, v65, v69
  v_add_f32 v66, v66, v70
  v_add_f32 v67, v67, v71
  v_add_f32 v64, v64, v65
  v_add_f32 v66, v66, v67
  v_add_f32 v64, v64, v66
  v_lshlrev_b32 v80, 16, v80
  v_lshlrev_b32 v2, 2, v0
  v_add_u32 v2, 147712, v2
  ds_write_b32 v2, v64
  ds_write_b32 v2, v80 offset:1024
  s_waitcnt lgkmcnt(0)
  s_barrier
  s_waitcnt vmcnt(0)
  s_lshl_b32 s87, s97, 12
  s_lshl_b32 s4, s68, 8
  s_add_u32 s87, s87, s4
  s_lshl_b32 s4, s69, 2
  s_add_u32 s87, s87, s4
  s_add_u32 s97, s97, 1
  s_branch L_w2_body
L_w1_end:
  s_endpgm
L_w1_compute:
  s_and_b32 s71, s70, 1
  s_lshr_b32 s72, s70, 1
  v_and_b32 v3, 15, v1
  v_lshrrev_b32 v2, 4, v1
  s_lshl_b32 s8, s71, 13
  v_lshl_add_u32 v4, v1, 4, s8
  v_bfe_u32 v13, v1, 2, 2
  v_lshl_add_u32 v13, v2, 3, v13
  v_lshlrev_b32 v13, 7, v13
  v_and_b32 v17, 3, v1
  v_lshl_add_u32 v13, v17, 3, v13
  v_bfe_u32 v17, v1, 3, 2
  v_lshl_add_u32 v13, v17, 5, v13
  s_lshl_b32 s9, s72, 6
  v_xor_b32 v13, s9, v13
  v_add_u32 v5, 16384, v13
  v_xor_b32 v6, 32, v5
  v_and_b32 v16, 1, v2
  v_lshrrev_b32 v17, 1, v2
  v_bfe_u32 v13, v1, 2, 2
  v_lshl_add_u32 v13, v16, 3, v13
  v_lshl_add_u32 v13, v17, 5, v13
  v_xor_b32 v14, s72, v16
  v_lshl_add_u32 v13, v13, 1, v14
  v_and_b32 v14, 3, v1
  v_lshl_add_u32 v13, v13, 2, v14
  v_lshlrev_b32 v13, 3, v13
  v_add_u32 v7, 40960, v13
  s_lshl_b32 s8, s68, 7
  s_lshl_b32 s9, s71, 6
  s_add_u32 s8, s8, s9
  s_mul_i32 s8, s8, 7168
  v_lshlrev_b32 v14, 8, v17
  v_lshl_add_u32 v14, v3, 4, v14
  v_add_u32 v14, s8, v14
  s_lshl_b32 s10, s69, 11
  s_lshl_b32 s9, s72, 10
  s_add_u32 s9, s9, s10
  v_lshl_add_u32 v12, v16, 9, v14
  v_add_u32 v12, s9, v12
  v_mul_u32_u24 v16, 114688, v16
  s_lshr_b32 s9, s9, 1
  v_add3_u32 v13, v16, v14, s9
  s_lshl_b32 s9, s71, 8
  s_add_u32 s9, s9, 147520
  v_lshl_add_u32 v14, v3, 2, s9
  s_lshl_b32 s9, s72, 7
  s_add_u32 s9, s9, 148736
  v_lshl_add_u32 v15, v2, 4, s9
  s_lshl_b32 s9, s72, 6
  s_add_u32 s9, s9, 148736
  v_lshl_add_u32 v16, v2, 4, s9
  v_mov_b32 v128, 0
  v_mov_b32 v129, 0
  v_mov_b32 v130, 0
  v_mov_b32 v131, 0
  v_mov_b32 v132, 0
  v_mov_b32 v133, 0
  v_mov_b32 v134, 0
  v_mov_b32 v135, 0
  v_mov_b32 v136, 0
  v_mov_b32 v137, 0
  v_mov_b32 v138, 0
  v_mov_b32 v139, 0
  v_mov_b32 v140, 0
  v_mov_b32 v141, 0
  v_mov_b32 v142, 0
  v_mov_b32 v143, 0
  v_mov_b32 v144, 0
  v_mov_b32 v145, 0
  v_mov_b32 v146, 0
  v_mov_b32 v147, 0
  v_mov_b32 v148, 0
  v_mov_b32 v149, 0
  v_mov_b32 v150, 0
  v_mov_b32 v151, 0
  v_mov_b32 v152, 0
  v_mov_b32 v153, 0
  v_mov_b32 v154, 0
  v_mov_b32 v155, 0
  v_mov_b32 v156, 0
  v_mov_b32 v157, 0
  v_mov_b32 v158, 0
  v_mov_b32 v159, 0
  v_mov_b32 v160, 0
  v_mov_b32 v161, 0
  v_mov_b32 v162, 0
  v_mov_b32 v163, 0
  v_mov_b32 v164, 0
  v_mov_b32 v165, 0
  v_mov_b32 v166, 0
  v_mov_b32 v167, 0
  v_mov_b32 v168, 0
  v_mov_b32 v169, 0
  v_mov_b32 v170, 0
  v_mov_b32 v171, 0
  v_mov_b32 v172, 0
  v_mov_b32 v173, 0
  v_mov_b32 v174, 0
  v_mov_b32 v175, 0
  v_mov_b32 v176, 0
  v_mov_b32 v177, 0
  v_mov_b32 v178, 0
  v_mov_b32 v179, 0
  v_mov_b32 v180, 0
  v_mov_b32 v181, 0
  v_mov_b32 v182, 0
  v_mov_b32 v183, 0
  v_mov_b32 v184, 0
  v_mov_b32 v185, 0
  v_mov_b32 v186, 0
  v_mov_b32 v187, 0
  v_mov_b32 v188, 0
  v_mov_b32 v189, 0
  v_mov_b32 v190, 0
  v_mov_b32 v191, 0
  v_mov_b32 v192, 0
  v_mov_b32 v193, 0
  v_mov_b32 v194, 0
  v_mov_b32 v195, 0
  v_mov_b32 v196, 0
  v_mov_b32 v197, 0
  v_mov_b32 v198, 0
  v_mov_b32 v199, 0
  v_mov_b32 v200, 0
  v_mov_b32 v201, 0
  v_mov_b32 v202, 0
  v_mov_b32 v203, 0
  v_mov_b32 v204, 0
  v_mov_b32 v205, 0
  v_mov_b32 v206, 0
  v_mov_b32 v207, 0
  v_mov_b32 v208, 0
  v_mov_b32 v209, 0
  v_mov_b32 v210, 0
  v_mov_b32 v211, 0
  v_mov_b32 v212, 0
  v_mov_b32 v213, 0
  v_mov_b32 v214, 0
  v_mov_b32 v215, 0
  v_mov_b32 v216, 0
  v_mov_b32 v217, 0
  v_mov_b32 v218, 0
  v_mov_b32 v219, 0
  v_mov_b32 v220, 0
  v_mov_b32 v221, 0
  v_mov_b32 v222, 0
  v_mov_b32 v223, 0
  v_mov_b32 v224, 0
  v_mov_b32 v225, 0
  v_mov_b32 v226, 0
  v_mov_b32 v227, 0
  v_mov_b32 v228, 0
  v_mov_b32 v229, 0
  v_mov_b32 v230, 0
  v_mov_b32 v231, 0
  v_mov_b32 v232, 0
  v_mov_b32 v233, 0
  v_mov_b32 v234, 0
  v_mov_b32 v235, 0
  v_mov_b32 v236, 0
  v_mov_b32 v237, 0
  v_mov_b32 v238, 0
  v_mov_b32 v239, 0
  s_waitcnt lgkmcnt(0)
  s_add_u32 s44, s34, 8388608
  s_addc_u32 s45, s35, 0
  s_and_b32 s45, s45, 0xffff
  s_mov_b32 s46, 14680064
  s_mov_b32 s47, 0x00020000
  s_cmp_lg_u32 s96, 0
  s_cbranch_scc1 L_pfc3_skip
  s_getpc_b64 s[4:5]
L_pfc3:
  s_lshl_b32 s3, s99, 2
  s_add_u32 s3, s3, s70
  s_mul_i32 s3, s3, 64
  s_min_u32 s3, s3, L_w2_c1-L_w2_c0-64
  s_add_i32 s3, s3, L_w2_c0-L_pfc3
  s_ashr_i32 s6, s3, 31
  s_add_u32 s4, s4, s3
  s_addc_u32 s5, s5, s6
  s_load_dword s36, s[4:5], 0
L_pfc3_skip:
  s_mov_b32 s75, 0
  v_add_u32_e64 v20, s75, v4
  v_add_u32_e64 v21, s75, v5
  v_add_u32_e64 v22, s75, v6
  v_add_u32_e64 v23, s75, v7
  s_add_u32 s75, s75, 49152
  s_cmp_eq_u32 s75, 147456
  s_cselect_b32 s75, 0, s75
  s_mov_b32 s79, 16
  s_barrier
  s_barrier
  ds_read_b128 v[32:35], v20 offset:0
  ds_read_b128 v[36:39], v20 offset:2048
  ds_read_b128 v[40:43], v20 offset:4096
  ds_read_b128 v[44:47], v20 offset:6144
  ds_read_b64_tr_b16 v[48:49], v21 offset:0
  ds_read_b64_tr_b16 v[50:51], v21 offset:512
  ds_read_b64_tr_b16 v[52:53], v22 offset:0
  ds_read_b64_tr_b16 v[54:55], v22 offset:512
  ds_read_b64_tr_b16 v[56:57], v21 offset:8192
  ds_read_b64_tr_b16 v[58:59], v21 offset:8704
  ds_read_b64_tr_b16 v[60:61], v22 offset:8192
  ds_read_b64_tr_b16 v[62:63], v22 offset:8704
  ds_read_b64_tr_b16 v[64:65], v21 offset:16384
  ds_read_b64_tr_b16 v[66:67], v21 offset:16896
  ds_read_b64_tr_b16 v[68:69], v22 offset:16384
  ds_read_b64_tr_b16 v[70:71], v22 offset:16896
  ds_read_b64_tr_b16 v[72:73], v23 offset:0
  ds_read_b64_tr_b16 v[74:75], v23 offset:256
  s_waitcnt lgkmcnt(0)
.p2align 3
L_w1_loop:
  v_mfma_f32_16x16x32_bf16 v[128:131], v[48:51], v[32:35], v[128:131]
  ds_read_b128 v[80:83], v20 offset:1024
  v_mfma_f32_16x16x32_bf16 v[132:135], v[48:51], v[36:39], v[132:135]
  ds_read_b128 v[84:87], v20 offset:3072
  v_mfma_f32_16x16x32_bf16 v[136:139], v[48:51], v[40:43], v[136:139]
  ds_read_b128 v[88:91], v20 offset:5120
  v_mfma_f32_16x16x32_bf16 v[140:143], v[48:51], v[44:47], v[140:143]
  ds_read_b128 v[92:95], v20 offset:7168
  v_mfma_f32_16x16x32_bf16 v[144:147], v[52:55], v[32:35], v[144:147]
  ds_read_b64_tr_b16 v[96:97], v21 offset:4096
  v_mfma_f32_16x16x32_bf16 v[148:151], v[52:55], v[36:39], v[148:151]
  ds_read_b64_tr_b16 v[98:99], v21 offset:4608
  v_mfma_f32_16x16x32_bf16 v[152:155], v[52:55], v[40:43], v[152:155]
  ds_read_b64_tr_b16 v[100:101], v22 offset:4096
  v_mfma_f32_16x16x32_bf16 v[156:159], v[52:55], v[44:47], v[156:159]
  ds_read_b64_tr_b16 v[102:103], v22 offset:4608
  v_mfma_f32_16x16x32_bf16 v[160:163], v[56:59], v[32:35], v[160:163]
  ds_read_b64_tr_b16 v[104:105], v21 offset:12288
  v_mfma_f32_16x16x32_bf16 v[164:167], v[56:59], v[36:39], v[164:167]
  ds_read_b64_tr_b16 v[106:107], v21 offset:12800
  v_mfma_f32_16x16x32_bf16 v[168:171], v[56:59], v[40:43], v[168:171]
  ds_read_b64_tr_b16 v[108:109], v22 offset:12288
  v_mfma_f32_16x16x32_bf16 v[172:175], v[56:59], v[44:47], v[172:175]
  ds_read_b64_tr_b16 v[110:111], v22 offset:12800
  v_mfma_f32_16x16x32_bf16 v[176:179], v[60:63], v[32:35], v[176:179]
  ds_read_b64_tr_b16 v[112:113], v21 offset:20480
  v_mfma_f32_16x16x32_bf16 v[180:183], v[60:63], v[36:39], v[180:183]
  ds_read_b64_tr_b16 v[114:115], v21 offset:20992
  v_mfma_f32_16x16x32_bf16 v[184:187], v[60:63], v[40:43], v[184:187]
  ds_read_b64_tr_b16 v[116:117], v22 offset:20480
  v_mfma_f32_16x16x32_bf16 v[188:191], v[60:63], v[44:47], v[188:191]
  ds_read_b64_tr_b16 v[118:119], v22 offset:20992
  v_mfma_f32_16x16x32_bf16 v[192:195], v[64:67], v[32:35], v[192:195]
  ds_read_b64_tr_b16 v[120:121], v23 offset:4096
  v_mfma_f32_16x16x32_bf16 v[196:199], v[64:67], v[36:39], v[196:199]
  ds_read_b64_tr_b16 v[122:123], v23 offset:4352
  v_mfma_f32_16x16x32_bf16 v[200:203], v[64:67], v[40:43], v[200:203]
  v_add_u32_e64 v20, s75, v4
  v_mfma_f32_16x16x32_bf16 v[204:207], v[64:67], v[44:47], v[204:207]
  v_add_u32_e64 v21, s75, v5
  v_mfma_f32_16x16x32_bf16 v[208:211], v[68:71], v[32:35], v[208:211]
  v_add_u32_e64 v22, s75, v6
  v_mfma_f32_16x16x32_bf16 v[212:215], v[68:71], v[36:39], v[212:215]
  v_add_u32_e64 v23, s75, v7
  v_mfma_f32_16x16x32_bf16 v[216:219], v[68:71], v[40:43], v[216:219]
  s_add_u32 s75, s75, 49152
  v_mfma_f32_16x16x32_bf16 v[220:223], v[68:71], v[44:47], v[220:223]
  s_cmp_eq_u32 s75, 147456
  v_mfma_f32_16x16x32_bf16 v[224:227], v[72:75], v[32:35], v[224:227]
  s_cselect_b32 s75, 0, s75
  s_sub_u32 s79, s79, 1
  v_mfma_f32_16x16x32_bf16 v[228:231], v[72:75], v[36:39], v[228:231]
  v_mfma_f32_16x16x32_bf16 v[232:235], v[72:75], v[40:43], v[232:235]
  v_mfma_f32_16x16x32_bf16 v[236:239], v[72:75], v[44:47], v[236:239]
  s_waitcnt lgkmcnt(0)
  s_barrier
  v_mfma_f32_16x16x32_bf16 v[128:131], v[96:99], v[80:83], v[128:131]
  ds_read_b128 v[32:35], v20 offset:0
  v_mfma_f32_16x16x32_bf16 v[132:135], v[96:99], v[84:87], v[132:135]
  ds_read_b128 v[36:39], v20 offset:2048
  v_mfma_f32_16x16x32_bf16 v[136:139], v[96:99], v[88:91], v[136:139]
  ds_read_b128 v[40:43], v20 offset:4096
  v_mfma_f32_16x16x32_bf16 v[140:143], v[96:99], v[92:95], v[140:143]
  ds_read_b128 v[44:47], v20 offset:6144
  v_mfma_f32_16x16x32_bf16 v[144:147], v[100:103], v[80:83], v[144:147]
  ds_read_b64_tr_b16 v[48:49], v21 offset:0
  v_mfma_f32_16x16x32_bf16 v[148:151], v[100:103], v[84:87], v[148:151]
  ds_read_b64_tr_b16 v[50:51], v21 offset:512
  v_mfma_f32_16x16x32_bf16 v[152:155], v[100:103], v[88:91], v[152:155]
  ds_read_b64_tr_b16 v[52:53], v22 offset:0
  v_mfma_f32_16x16x32_bf16 v[156:159], v[100:103], v[92:95], v[156:159]
  ds_read_b64_tr_b16 v[54:55], v22 offset:512
  v_mfma_f32_16x16x32_bf16 v[160:163], v[104:107], v[80:83], v[160:163]
  ds_read_b64_tr_b16 v[56:57], v21 offset:8192
  v_mfma_f32_16x16x32_bf16 v[164:167], v[104:107], v[84:87], v[164:167]
  ds_read_b64_tr_b16 v[58:59], v21 offset:8704
  v_mfma_f32_16x16x32_bf16 v[168:171], v[104:107], v[88:91], v[168:171]
  ds_read_b64_tr_b16 v[60:61], v22 offset:8192
  v_mfma_f32_16x16x32_bf16 v[172:175], v[104:107], v[92:95], v[172:175]
  ds_read_b64_tr_b16 v[62:63], v22 offset:8704
  v_mfma_f32_16x16x32_bf16 v[176:179], v[108:111], v[80:83], v[176:179]
  ds_read_b64_tr_b16 v[64:65], v21 offset:16384
  v_mfma_f32_16x16x32_bf16 v[180:183], v[108:111], v[84:87], v[180:183]
  ds_read_b64_tr_b16 v[66:67], v21 offset:16896
  v_mfma_f32_16x16x32_bf16 v[184:187], v[108:111], v[88:91], v[184:187]
  ds_read_b64_tr_b16 v[68:69], v22 offset:16384
  v_mfma_f32_16x16x32_bf16 v[188:191], v[108:111], v[92:95], v[188:191]
  ds_read_b64_tr_b16 v[70:71], v22 offset:16896
  v_mfma_f32_16x16x32_bf16 v[192:195], v[112:115], v[80:83], v[192:195]
  ds_read_b64_tr_b16 v[72:73], v23 offset:0
  v_mfma_f32_16x16x32_bf16 v[196:199], v[112:115], v[84:87], v[196:199]
  ds_read_b64_tr_b16 v[74:75], v23 offset:256
  v_mfma_f32_16x16x32_bf16 v[200:203], v[112:115], v[88:91], v[200:203]
  s_cmp_lg_u32 s79, 0
  s_nop 0
  v_mfma_f32_16x16x32_bf16 v[204:207], v[112:115], v[92:95], v[204:207]
  v_mfma_f32_16x16x32_bf16 v[208:211], v[116:119], v[80:83], v[208:211]
  v_mfma_f32_16x16x32_bf16 v[212:215], v[116:119], v[84:87], v[212:215]
  v_mfma_f32_16x16x32_bf16 v[216:219], v[116:119], v[88:91], v[216:219]
  v_mfma_f32_16x16x32_bf16 v[220:223], v[116:119], v[92:95], v[220:223]
  v_mfma_f32_16x16x32_bf16 v[224:227], v[120:123], v[80:83], v[224:227]
  v_mfma_f32_16x16x32_bf16 v[228:231], v[120:123], v[84:87], v[228:231]
  v_mfma_f32_16x16x32_bf16 v[232:235], v[120:123], v[88:91], v[232:235]
  v_mfma_f32_16x16x32_bf16 v[236:239], v[120:123], v[92:95], v[236:239]
  s_waitcnt lgkmcnt(0)
  s_cbranch_scc1 L_w1_loop
L_w1_exit:
  ds_read2_b32 v[88:89], v14 offset0:0 offset1:160
  ds_read2_b32 v[90:91], v14 offset0:16 offset1:176
  ds_read2_b32 v[92:93], v14 offset0:32 offset1:192
  ds_read2_b32 v[94:95], v14 offset0:48 offset1:208
  ds_read_b128 v[32:35], v15 offset:0
  ds_read_b128 v[60:63], v15 offset:1024
  ds_read_b128 v[36:39], v15 offset:64
  ds_read_b128 v[64:67], v15 offset:1088
  ds_read_b128 v[40:43], v15 offset:256
  ds_read_b128 v[68:71], v15 offset:1280
  ds_read_b128 v[44:47], v15 offset:320
  ds_read_b128 v[72:75], v15 offset:1344
  ds_read_b128 v[48:51], v15 offset:512
  ds_read_b128 v[76:79], v15 offset:1536
  ds_read_b128 v[52:55], v15 offset:576
  ds_read_b128 v[80:83], v15 offset:1600
  ds_read_b128 v[56:59], v16 offset:768
  ds_read_b128 v[84:87], v16 offset:1792
  v_mov_b32 v96, 0xc0135761
  v_mov_b32 v97, 0xbdd2d3e8
  v_mov_b32 v98, 1.0
  s_waitcnt lgkmcnt(0)
  v_mul_f32 v88, v88, v89
  v_mul_f32 v90, v90, v91
  v_mul_f32 v92, v92, v93
  v_mul_f32 v94, v94, v95
  v_pk_fma_f32 v[100:101], v[32:33], v[88:89], v[60:61] op_sel:[0,0,0] op_sel_hi:[1,0,1] neg_lo:[0,1,0] neg_hi:[0,1,0]
  v_pk_fma_f32 v[102:103], v[34:35], v[88:89], v[62:63] op_sel:[0,0,0] op_sel_hi:[1,0,1] neg_lo:[0,1,0] neg_hi:[0,1,0]
  v_pk_fma_f32 v[128:129], v[128:129], v[88:89], v[100:101] op_sel:[0,1,0] op_sel_hi:[1,1,1]
  v_pk_fma_f32 v[130:131], v[130:131], v[88:89], v[102:103] op_sel:[0,1,0] op_sel_hi:[1,1,1]
  v_pk_mul_f32 v[100:101], v[128:129], v[128:129]
  v_pk_mul_f32 v[102:103], v[130:131], v[130:131]
  v_pk_fma_f32 v[100:101], v[100:101], v[96:97], v[96:97] op_sel:[0,1,0] op_sel_hi:[1,1,0]
  v_pk_fma_f32 v[102:103], v[102:103], v[96:97], v[96:97] op_sel:[0,1,0] op_sel_hi:[1,1,0]
  v_pk_mul_f32 v[100:101], v[100:101], v[128:129]
  v_pk_mul_f32 v[102:103], v[102:103], v[130:131]
  v_exp_f32 v100, v100
  v_exp_f32 v101, v101
  v_exp_f32 v102, v102
  v_exp_f32 v103, v103
  v_pk_add_f32 v[100:101], v[100:101], v[98:99] op_sel_hi:[1,0]
  v_pk_add_f32 v[102:103], v[102:103], v[98:99] op_sel_hi:[1,0]
  v_rcp_f32 v100, v100
  v_rcp_f32 v101, v101
  v_rcp_f32 v102, v102
  v_rcp_f32 v103, v103
  v_pk_mul_f32 v[128:129], v[128:129], v[100:101]
  v_pk_mul_f32 v[130:131], v[130:131], v[102:103]
  v_cvt_pk_bf16_f32 v108, v128, v129
  v_cvt_pk_bf16_f32 v109, v130, v131
  v_pk_fma_f32 v[104:105], v[36:37], v[88:89], v[64:65] op_sel:[0,0,0] op_sel_hi:[1,0,1] neg_lo:[0,1,0] neg_hi:[0,1,0]
  v_pk_fma_f32 v[106:107], v[38:39], v[88:89], v[66:67] op_sel:[0,0,0] op_sel_hi:[1,0,1] neg_lo:[0,1,0] neg_hi:[0,1,0]
  v_pk_fma_f32 v[144:145], v[144:145], v[88:89], v[104:105] op_sel:[0,1,0] op_sel_hi:[1,1,1]
  v_pk_fma_f32 v[146:147], v[146:147], v[88:89], v[106:107] op_sel:[0,1,0] op_sel_hi:[1,1,1]
  v_pk_mul_f32 v[104:105], v[144:145], v[144:145]
  v_pk_mul_f32 v[106:107], v[146:147], v[146:147]
  v_pk_fma_f32 v[104:105], v[104:105], v[96:97], v[96:97] op_sel:[0,1,0] op_sel_hi:[1,1,0]
  v_pk_fma_f32 v[106:107], v[106:107], v[96:97], v[96:97] op_sel:[0,1,0] op_sel_hi:[1,1,0]
  v_pk_mul_f32 v[104:105], v[104:105], v[144:145]
  v_pk_mul_f32 v[106:107], v[106:107], v[146:147]
  v_exp_f32 v104, v104
  v_exp_f32 v105, v105
  v_exp_f32 v106, v106
  v_exp_f32 v107, v107
  v_pk_add_f32 v[104:105], v[104:105], v[98:99] op_sel_hi:[1,0]
  v_pk_add_f32 v[106:107], v[106:107], v[98:99] op_sel_hi:[1,0]
  v_rcp_f32 v104, v104
  v_rcp_f32 v105, v105
  v_rcp_f32 v106, v106
  v_rcp_f32 v107, v107
  v_pk_mul_f32 v[144:145], v[144:145], v[104:105]
  v_pk_mul_f32 v[146:147], v[146:147], v[106:107]
  v_cvt_pk_bf16_f32 v110, v144, v145
  v_cvt_pk_bf16_f32 v111, v146, v147
  s_mov_b32 s3, 0
  s_nop 0
  v_permlane16_swap_b32 v108, v110
  v_permlane16_swap_b32 v109, v111
  buffer_store_dwordx4 v[108:111], v12, s[44:47], s3 offen sc1
  v_pk_fma_f32 v[100:101], v[32:33], v[90:91], v[60:61] op_sel:[0,0,0] op_sel_hi:[1,0,1] neg_lo:[0,1,0] neg_hi:[0,1,0]
  v_pk_fma_f32 v[102:103], v[34:35], v[90:91], v[62:63] op_sel:[0,0,0] op_sel_hi:[1,0,1] neg_lo:[0,1,0] neg_hi:[0,1,0]
  v_pk_fma_f32 v[132:133], v[132:133], v[90:91], v[100:101] op_sel:[0,1,0] op_sel_hi:[1,1,1]
  v_pk_fma_f32 v[134:135], v[134:135], v[90:91], v[102:103] op_sel:[0,1,0] op_sel_hi:[1,1,1]
  v_pk_mul_f32 v[100:101], v[132:133], v[132:133]
  v_pk_mul_f32 v[102:103], v[134:135], v[134:135]
  v_pk_fma_f32 v[100:101], v[100:101], v[96:97], v[96:97] op_sel:[0,1,0] op_sel_hi:[1,1,0]
  v_pk_fma_f32 v[102:103], v[102:103], v[96:97], v[96:97] op_sel:[0,1,0] op_sel_hi:[1,1,0]
  v_pk_mul_f32 v[100:101], v[100:101], v[132:133]
  v_pk_mul_f32 v[102:103], v[102:103], v[134:135]
  v_exp_f32 v100, v100
  v_exp_f32 v101, v101
  v_exp_f32 v102, v102
  v_exp_f32 v103, v103
  v_pk_add_f32 v[100:101], v[100:101], v[98:99] op_sel_hi:[1,0]
  v_pk_add_f32 v[102:103], v[102:103], v[98:99] op_sel_hi:[1,0]
  v_rcp_f32 v100, v100
  v_rcp_f32 v101, v101
  v_rcp_f32 v102, v102
  v_rcp_f32 v103, v103
  v_pk_mul_f32 v[132:133], v[132:133], v[100:101]
  v_pk_mul_f32 v[134:135], v[134:135], v[102:103]
  v_cvt_pk_bf16_f32 v112, v132, v133
  v_cvt_pk_bf16_f32 v113, v134, v135
  v_pk_fma_f32 v[104:105], v[36:37], v[90:91], v[64:65] op_sel:[0,0,0] op_sel_hi:[1,0,1] neg_lo:[0,1,0] neg_hi:[0,1,0]
  v_pk_fma_f32 v[106:107], v[38:39], v[90:91], v[66:67] op_sel:[0,0,0] op_sel_hi:[1,0,1] neg_lo:[0,1,0] neg_hi:[0,1,0]
  v_pk_fma_f32 v[148:149], v[148:149], v[90:91], v[104:105] op_sel:[0,1,0] op_sel_hi:[1,1,1]
  v_pk_fma_f32 v[150:151], v[150:151], v[90:91], v[106:107] op_sel:[0,1,0] op_sel_hi:[1,1,1]
  v_pk_mul_f32 v[104:105], v[148:149], v[148:149]
  v_pk_mul_f32 v[106:107], v[150:151], v[150:151]
  v_pk_fma_f32 v[104:105], v[104:105], v[96:97], v[96:97] op_sel:[0,1,0] op_sel_hi:[1,1,0]
  v_pk_fma_f32 v[106:107], v[106:107], v[96:97], v[96:97] op_sel:[0,1,0] op_sel_hi:[1,1,0]
  v_pk_mul_f32 v[104:105], v[104:105], v[148:149]
  v_pk_mul_f32 v[106:107], v[106:107], v[150:151]
  v_exp_f32 v104, v104
  v_exp_f32 v105, v105
  v_exp_f32 v106, v106
  v_exp_f32 v107, v107
  v_pk_add_f32 v[104:105], v[104:105], v[98:99] op_sel_hi:[1,0]
  v_pk_add_f32 v[106:107], v[106:107], v[98:99] op_sel_hi:[1,0]
  v_rcp_f32 v104, v104
  v_rcp_f32 v105, v105
  v_rcp_f32 v106, v106
  v_rcp_f32 v107, v107
  v_pk_mul_f32 v[148:149], v[148:149], v[104:105]
  v_pk_mul_f32 v[150:151], v[150:151], v[106:107]
  v_cvt_pk_bf16_f32 v114, v148, v149
  v_cvt_pk_bf16_f32 v115, v150, v151
  s_mov_b32 s3, 114688
  s_nop 0
  v_permlane16_swap_b32 v112, v114
  v_permlane16_swap_b32 v113, v115
  buffer_store_dwordx4 v[112:115], v12, s[44:47], s3 offen sc1
  v_pk_fma_f32 v[100:101], v[32:33], v[92:93], v[60:61] op_sel:[0,0,0] op_sel_hi:[1,0,1] neg_lo:[0,1,0] neg_hi:[0,1,0]
  v_pk_fma_f32 v[102:103], v[34:35], v[92:93], v[62:63] op_sel:[0,0,0] op_sel_hi:[1,0,1] neg_lo:[0,1,0] neg_hi:[0,1,0]
  v_pk_fma_f32 v[136:137], v[136:137], v[92:93], v[100:101] op_sel:[0,1,0] op_sel_hi:[1,1,1]
  v_pk_fma_f32 v[138:139], v[138:139], v[92:93], v[102:103] op_sel:[0,1,0] op_sel_hi:[1,1,1]
  v_pk_mul_f32 v[100:101], v[136:137], v[136:137]
  v_pk_mul_f32 v[102:103], v[138:139], v[138:139]
  v_pk_fma_f32 v[100:101], v[100:101], v[96:97], v[96:97] op_sel:[0,1,0] op_sel_hi:[1,1,0]
  v_pk_fma_f32 v[102:103], v[102:103], v[96:97], v[96:97] op_sel:[0,1,0] op_sel_hi:[1,1,0]
  v_pk_mul_f32 v[100:101], v[100:101], v[136:137]
  v_pk_mul_f32 v[102:103], v[102:103], v[138:139]
  v_exp_f32 v100, v100
  v_exp_f32 v101, v101
  v_exp_f32 v102, v102
  v_exp_f32 v103, v103
  v_pk_add_f32 v[100:101], v[100:101], v[98:99] op_sel_hi:[1,0]
  v_pk_add_f32 v[102:103], v[102:103], v[98:99] op_sel_hi:[1,0]
  v_rcp_f32 v100, v100
  v_rcp_f32 v101, v101
  v_rcp_f32 v102, v102
  v_rcp_f32 v103, v103
  v_pk_mul_f32 v[136:137], v[136:137], v[100:101]
  v_pk_mul_f32 v[138:139], v[138:139], v[102:103]
  v_cvt_pk_bf16_f32 v116, v136, v137
  v_cvt_pk_bf16_f32 v117, v138, v139
  v_pk_fma_f32 v[104:105], v[36:37], v[92:93], v[64:65] op_sel:[0,0,0] op_sel_hi:[1,0,1] neg_lo:[0,1,0] neg_hi:[0,1,0]
  v_pk_fma_f32 v[106:107], v[38:39], v[92:93], v[66:67] op_sel:[0,0,0] op_sel_hi:[1,0,1] neg_lo:[0,1,0] neg_hi:[0,1,0]
  v_pk_fma_f32 v[152:153], v[152:153], v[92:93], v[104:105] op_sel:[0,1,0] op_sel_hi:[1,1,1]
  v_pk_fma_f32 v[154:155], v[154:155], v[92:93], v[106:107] op_sel:[0,1,0] op_sel_hi:[1,1,1]
  v_pk_mul_f32 v[104:105], v[152:153], v[152:153]
  v_pk_mul_f32 v[106:107], v[154:155], v[154:155]
  v_pk_fma_f32 v[104:105], v[104:105], v[96:97], v[96:97] op_sel:[0,1,0] op_sel_hi:[1,1,0]
  v_pk_fma_f32 v[106:107], v[106:107], v[96:97], v[96:97] op_sel:[0,1,0] op_sel_hi:[1,1,0]
  v_pk_mul_f32 v[104:105], v[104:105], v[152:153]
  v_pk_mul_f32 v[106:107], v[106:107], v[154:155]
  v_exp_f32 v104, v104
  v_exp_f32 v105, v105
  v_exp_f32 v106, v106
  v_exp_f32 v107, v107
  v_pk_add_f32 v[104:105], v[104:105], v[98:99] op_sel_hi:[1,0]
  v_pk_add_f32 v[106:107], v[106:107], v[98:99] op_sel_hi:[1,0]
  v_rcp_f32 v104, v104
  v_rcp_f32 v105, v105
  v_rcp_f32 v106, v106
  v_rcp_f32 v107, v107
  v_pk_mul_f32 v[152:153], v[152:153], v[104:105]
  v_pk_mul_f32 v[154:155], v[154:155], v[106:107]
  v_cvt_pk_bf16_f32 v118, v152, v153
  v_cvt_pk_bf16_f32 v119, v154, v155
  s_mov_b32 s3, 229376
  s_nop 0
  v_permlane16_swap_b32 v116, v118
  v_permlane16_swap_b32 v117, v119
  buffer_store_dwordx4 v[116:119], v12, s[44:47], s3 offen sc1
  v_pk_fma_f32 v[100:101], v[32:33], v[94:95], v[60:61] op_sel:[0,0,0] op_sel_hi:[1,0,1] neg_lo:[0,1,0] neg_hi:[0,1,0]
  v_pk_fma_f32 v[102:103], v[34:35], v[94:95], v[62:63] op_sel:[0,0,0] op_sel_hi:[1,0,1] neg_lo:[0,1,0] neg_hi:[0,1,0]
  v_pk_fma_f32 v[140:141], v[140:141], v[94:95], v[100:101] op_sel:[0,1,0] op_sel_hi:[1,1,1]
  v_pk_fma_f32 v[142:143], v[142:143], v[94:95], v[102:103] op_sel:[0,1,0] op_sel_hi:[1,1,1]
  v_pk_mul_f32 v[100:101], v[140:141], v[140:141]
  v_pk_mul_f32 v[102:103], v[142:143], v[142:143]
  v_pk_fma_f32 v[100:101], v[100:101], v[96:97], v[96:97] op_sel:[0,1,0] op_sel_hi:[1,1,0]
  v_pk_fma_f32 v[102:103], v[102:103], v[96:97], v[96:97] op_sel:[0,1,0] op_sel_hi:[1,1,0]
  v_pk_mul_f32 v[100:101], v[100:101], v[140:141]
  v_pk_mul_f32 v[102:103], v[102:103], v[142:143]
  v_exp_f32 v100, v100
  v_exp_f32 v101, v101
  v_exp_f32 v102, v102
  v_exp_f32 v103, v103
  v_pk_add_f32 v[100:101], v[100:101], v[98:99] op_sel_hi:[1,0]
  v_pk_add_f32 v[102:103], v[102:103], v[98:99] op_sel_hi:[1,0]
  v_rcp_f32 v100, v100
  v_rcp_f32 v101, v101
  v_rcp_f32 v102, v102
  v_rcp_f32 v103, v103
  v_pk_mul_f32 v[140:141], v[140:141], v[100:101]
  v_pk_mul_f32 v[142:143], v[142:143], v[102:103]
  v_cvt_pk_bf16_f32 v120, v140, v141
  v_cvt_pk_bf16_f32 v121, v142, v143
  v_pk_fma_f32 v[104:105], v[36:37], v[94:95], v[64:65] op_sel:[0,0,0] op_sel_hi:[1,0,1] neg_lo:[0,1,0] neg_hi:[0,1,0]
  v_pk_fma_f32 v[106:107], v[38:39], v[94:95], v[66:67] op_sel:[0,0,0] op_sel_hi:[1,0,1] neg_lo:[0,1,0] neg_hi:[0,1,0]
  v_pk_fma_f32 v[156:157], v[156:157], v[94:95], v[104:105] op_sel:[0,1,0] op_sel_hi:[1,1,1]
  v_pk_fma_f32 v[158:159], v[158:159], v[94:95], v[106:107] op_sel:[0,1,0] op_sel_hi:[1,1,1]
  v_pk_mul_f32 v[104:105], v[156:157], v[156:157]
  v_pk_mul_f32 v[106:107], v[158:159], v[158:159]
  v_pk_fma_f32 v[104:105], v[104:105], v[96:97], v[96:97] op_sel:[0,1,0] op_sel_hi:[1,1,0]
  v_pk_fma_f32 v[106:107], v[106:107], v[96:97], v[96:97] op_sel:[0,1,0] op_sel_hi:[1,1,0]
  v_pk_mul_f32 v[104:105], v[104:105], v[156:157]
  v_pk_mul_f32 v[106:107], v[106:107], v[158:159]
  v_exp_f32 v104, v104
  v_exp_f32 v105, v105
  v_exp_f32 v106, v106
  v_exp_f32 v107, v107
  v_pk_add_f32 v[104:105], v[104:105], v[98:99] op_sel_hi:[1,0]
  v_pk_add_f32 v[106:107], v[106:107], v[98:99] op_sel_hi:[1,0]
  v_rcp_f32 v104, v104
  v_rcp_f32 v105, v105
  v_rcp_f32 v106, v106
  v_rcp_f32 v107, v107
  v_pk_mul_f32 v[156:157], v[156:157], v[104:105]
  v_pk_mul_f32 v[158:159], v[158:159], v[106:107]
  v_cvt_pk_bf16_f32 v122, v156, v157
  v_cvt_pk_bf16_f32 v123, v158, v159
  s_mov_b32 s3, 344064
  s_nop 0
  v_permlane16_swap_b32 v120, v122
  v_permlane16_swap_b32 v121, v123
  buffer_store_dwordx4 v[120:123], v12, s[44:47], s3 offen sc1
  v_pk_fma_f32 v[100:101], v[56:57], v[88:89], v[84:85] op_sel:[0,0,0] op_sel_hi:[1,0,1] neg_lo:[0,1,0] neg_hi:[0,1,0]
  v_pk_fma_f32 v[102:103], v[58:59], v[88:89], v[86:87] op_sel:[0,0,0] op_sel_hi:[1,0,1] neg_lo:[0,1,0] neg_hi:[0,1,0]
  v_pk_fma_f32 v[224:225], v[224:225], v[88:89], v[100:101] op_sel:[0,1,0] op_sel_hi:[1,1,1]
  v_pk_fma_f32 v[226:227], v[226:227], v[88:89], v[102:103] op_sel:[0,1,0] op_sel_hi:[1,1,1]
  v_pk_mul_f32 v[100:101], v[224:225], v[224:225]
  v_pk_mul_f32 v[102:103], v[226:227], v[226:227]
  v_pk_fma_f32 v[100:101], v[100:101], v[96:97], v[96:97] op_sel:[0,1,0] op_sel_hi:[1,1,0]
  v_pk_fma_f32 v[102:103], v[102:103], v[96:97], v[96:97] op_sel:[0,1,0] op_sel_hi:[1,1,0]
  v_pk_mul_f32 v[100:101], v[100:101], v[224:225]
  v_pk_mul_f32 v[102:103], v[102:103], v[226:227]
  v_exp_f32 v100, v100
  v_exp_f32 v101, v101
  v_exp_f32 v102, v102
  v_exp_f32 v103, v103
  v_pk_add_f32 v[100:101], v[100:101], v[98:99] op_sel_hi:[1,0]
  v_pk_add_f32 v[102:103], v[102:103], v[98:99] op_sel_hi:[1,0]
  v_rcp_f32 v100, v100
  v_rcp_f32 v101, v101
  v_rcp_f32 v102, v102
  v_rcp_f32 v103, v103
  v_pk_mul_f32 v[224:225], v[224:225], v[100:101]
  v_pk_mul_f32 v[226:227], v[226:227], v[102:103]
  v_cvt_pk_bf16_f32 v108, v224, v225
  v_cvt_pk_bf16_f32 v109, v226, v227
  v_pk_fma_f32 v[100:101], v[56:57], v[90:91], v[84:85] op_sel:[0,0,0] op_sel_hi:[1,0,1] neg_lo:[0,1,0] neg_hi:[0,1,0]
  v_pk_fma_f32 v[102:103], v[58:59], v[90:91], v[86:87] op_sel:[0,0,0] op_sel_hi:[1,0,1] neg_lo:[0,1,0] neg_hi:[0,1,0]
  v_pk_fma_f32 v[228:229], v[228:229], v[90:91], v[100:101] op_sel:[0,1,0] op_sel_hi:[1,1,1]
  v_pk_fma_f32 v[230:231], v[230:231], v[90:91], v[102:103] op_sel:[0,1,0] op_sel_hi:[1,1,1]
  v_pk_mul_f32 v[100:101], v[228:229], v[228:229]
  v_pk_mul_f32 v[102:103], v[230:231], v[230:231]
  v_pk_fma_f32 v[100:101], v[100:101], v[96:97], v[96:97] op_sel:[0,1,0] op_sel_hi:[1,1,0]
  v_pk_fma_f32 v[102:103], v[102:103], v[96:97], v[96:97] op_sel:[0,1,0] op_sel_hi:[1,1,0]
  v_pk_mul_f32 v[100:101], v[100:101], v[228:229]
  v_pk_mul_f32 v[102:103], v[102:103], v[230:231]
  v_exp_f32 v100, v100
  v_exp_f32 v101, v101
  v_exp_f32 v102, v102
  v_exp_f32 v103, v103
  v_pk_add_f32 v[100:101], v[100:101], v[98:99] op_sel_hi:[1,0]
  v_pk_add_f32 v[102:103], v[102:103], v[98:99] op_sel_hi:[1,0]
  v_rcp_f32 v100, v100
  v_rcp_f32 v101, v101
  v_rcp_f32 v102, v102
  v_rcp_f32 v103, v103
  v_pk_mul_f32 v[228:229], v[228:229], v[100:101]
  v_pk_mul_f32 v[230:231], v[230:231], v[102:103]
  v_cvt_pk_bf16_f32 v110, v228, v229
  v_cvt_pk_bf16_f32 v111, v230, v231
  s_mov_b32 s3, 32768
  s_nop 0
  v_permlane16_swap_b32 v108, v110
  v_permlane16_swap_b32 v109, v111
  buffer_store_dwordx4 v[108:111], v13, s[44:47], s3 offen sc1
  v_pk_fma_f32 v[100:101], v[56:57], v[92:93], v[84:85] op_sel:[0,0,0] op_sel_hi:[1,0,1] neg_lo:[0,1,0] neg_hi:[0,1,0]
  v_pk_fma_f32 v[102:103], v[58:59], v[92:93], v[86:87] op_sel:[0,0,0] op_sel_hi:[1,0,1] neg_lo:[0,1,0] neg_hi:[0,1,0]
  v_pk_fma_f32 v[232:233], v[232:233], v[92:93], v[100:101] op_sel:[0,1,0] op_sel_hi:[1,1,1]
  v_pk_fma_f32 v[234:235], v[234:235], v[92:93], v[102:103] op_sel:[0,1,0] op_sel_hi:[1,1,1]
  v_pk_mul_f32 v[100:101], v[232:233], v[232:233]
  v_pk_mul_f32 v[102:103], v[234:235], v[234:235]
  v_pk_fma_f32 v[100:101], v[100:101], v[96:97], v[96:97] op_sel:[0,1,0] op_sel_hi:[1,1,0]
  v_pk_fma_f32 v[102:103], v[102:103], v[96:97], v[96:97] op_sel:[0,1,0] op_sel_hi:[1,1,0]
  v_pk_mul_f32 v[100:101], v[100:101], v[232:233]
  v_pk_mul_f32 v[102:103], v[102:103], v[234:235]
  v_exp_f32 v100, v100
  v_exp_f32 v101, v101
  v_exp_f32 v102, v102
  v_exp_f32 v103, v103
  v_pk_add_f32 v[100:101], v[100:101], v[98:99] op_sel_hi:[1,0]
  v_pk_add_f32 v[102:103], v[102:103], v[98:99] op_sel_hi:[1,0]
  v_rcp_f32 v100, v100
  v_rcp_f32 v101, v101
  v_rcp_f32 v102, v102
  v_rcp_f32 v103, v103
  v_pk_mul_f32 v[232:233], v[232:233], v[100:101]
  v_pk_mul_f32 v[234:235], v[234:235], v[102:103]
  v_cvt_pk_bf16_f32 v112, v232, v233
  v_cvt_pk_bf16_f32 v113, v234, v235
  v_pk_fma_f32 v[100:101], v[56:57], v[94:95], v[84:85] op_sel:[0,0,0] op_sel_hi:[1,0,1] neg_lo:[0,1,0] neg_hi:[0,1,0]
  v_pk_fma_f32 v[102:103], v[58:59], v[94:95], v[86:87] op_sel:[0,0,0] op_sel_hi:[1,0,1] neg_lo:[0,1,0] neg_hi:[0,1,0]
  v_pk_fma_f32 v[236:237], v[236:237], v[94:95], v[100:101] op_sel:[0,1,0] op_sel_hi:[1,1,1]
  v_pk_fma_f32 v[238:239], v[238:239], v[94:95], v[102:103] op_sel:[0,1,0] op_sel_hi:[1,1,1]
  v_pk_mul_f32 v[100:101], v[236:237], v[236:237]
  v_pk_mul_f32 v[102:103], v[238:239], v[238:239]
  v_pk_fma_f32 v[100:101], v[100:101], v[96:97], v[96:97] op_sel:[0,1,0] op_sel_hi:[1,1,0]
  v_pk_fma_f32 v[102:103], v[102:103], v[96:97], v[96:97] op_sel:[0,1,0] op_sel_hi:[1,1,0]
  v_pk_mul_f32 v[100:101], v[100:101], v[236:237]
  v_pk_mul_f32 v[102:103], v[102:103], v[238:239]
  v_exp_f32 v100, v100
  v_exp_f32 v101, v101
  v_exp_f32 v102, v102
  v_exp_f32 v103, v103
  v_pk_add_f32 v[100:101], v[100:101], v[98:99] op_sel_hi:[1,0]
  v_pk_add_f32 v[102:103], v[102:103], v[98:99] op_sel_hi:[1,0]
  v_rcp_f32 v100, v100
  v_rcp_f32 v101, v101
  v_rcp_f32 v102, v102
  v_rcp_f32 v103, v103
  v_pk_mul_f32 v[236:237], v[236:237], v[100:101]
  v_pk_mul_f32 v[238:239], v[238:239], v[102:103]
  v_cvt_pk_bf16_f32 v114, v236, v237
  v_cvt_pk_bf16_f32 v115, v238, v239
  s_mov_b32 s3, 262144
  s_nop 0
  v_permlane16_swap_b32 v112, v114
  v_permlane16_swap_b32 v113, v115
  buffer_store_dwordx4 v[112:115], v13, s[44:47], s3 offen sc1
  v_pk_fma_f32 v[100:101], v[40:41], v[88:89], v[68:69] op_sel:[0,0,0] op_sel_hi:[1,0,1] neg_lo:[0,1,0] neg_hi:[0,1,0]
  v_pk_fma_f32 v[102:103], v[42:43], v[88:89], v[70:71] op_sel:[0,0,0] op_sel_hi:[1,0,1] neg_lo:[0,1,0] neg_hi:[0,1,0]
  v_pk_fma_f32 v[160:161], v[160:161], v[88:89], v[100:101] op_sel:[0,1,0] op_sel_hi:[1,1,1]
  v_pk_fma_f32 v[162:163], v[162:163], v[88:89], v[102:103] op_sel:[0,1,0] op_sel_hi:[1,1,1]
  v_pk_mul_f32 v[100:101], v[160:161], v[160:161]
  v_pk_mul_f32 v[102:103], v[162:163], v[162:163]
  v_pk_fma_f32 v[100:101], v[100:101], v[96:97], v[96:97] op_sel:[0,1,0] op_sel_hi:[1,1,0]
  v_pk_fma_f32 v[102:103], v[102:103], v[96:97], v[96:97] op_sel:[0,1,0] op_sel_hi:[1,1,0]
  v_pk_mul_f32 v[100:101], v[100:101], v[160:161]
  v_pk_mul_f32 v[102:103], v[102:103], v[162:163]
  v_exp_f32 v100, v100
  v_exp_f32 v101, v101
  v_exp_f32 v102, v102
  v_exp_f32 v103, v103
  v_pk_add_f32 v[100:101], v[100:101], v[98:99] op_sel_hi:[1,0]
  v_pk_add_f32 v[102:103], v[102:103], v[98:99] op_sel_hi:[1,0]
  v_rcp_f32 v100, v100
  v_rcp_f32 v101, v101
  v_rcp_f32 v102, v102
  v_rcp_f32 v103, v103
  v_pk_mul_f32 v[160:161], v[160:161], v[100:101]
  v_pk_mul_f32 v[162:163], v[162:163], v[102:103]
  v_cvt_pk_bf16_f32 v116, v160, v161
  v_cvt_pk_bf16_f32 v117, v162, v163
  v_pk_fma_f32 v[104:105], v[44:45], v[88:89], v[72:73] op_sel:[0,0,0] op_sel_hi:[1,0,1] neg_lo:[0,1,0] neg_hi:[0,1,0]
  v_pk_fma_f32 v[106:107], v[46:47], v[88:89], v[74:75] op_sel:[0,0,0] op_sel_hi:[1,0,1] neg_lo:[0,1,0] neg_hi:[0,1,0]
  v_pk_fma_f32 v[176:177], v[176:177], v[88:89], v[104:105] op_sel:[0,1,0] op_sel_hi:[1,1,1]
  v_pk_fma_f32 v[178:179], v[178:179], v[88:89], v[106:107] op_sel:[0,1,0] op_sel_hi:[1,1,1]
  v_pk_mul_f32 v[104:105], v[176:177], v[176:177]
  v_pk_mul_f32 v[106:107], v[178:179], v[178:179]
  v_pk_fma_f32 v[104:105], v[104:105], v[96:97], v[96:97] op_sel:[0,1,0] op_sel_hi:[1,1,0]
  v_pk_fma_f32 v[106:107], v[106:107], v[96:97], v[96:97] op_sel:[0,1,0] op_sel_hi:[1,1,0]
  v_pk_mul_f32 v[104:105], v[104:105], v[176:177]
  v_pk_mul_f32 v[106:107], v[106:107], v[178:179]
  v_exp_f32 v104, v104
  v_exp_f32 v105, v105
  v_exp_f32 v106, v106
  v_exp_f32 v107, v107
  v_pk_add_f32 v[104:105], v[104:105], v[98:99] op_sel_hi:[1,0]
  v_pk_add_f32 v[106:107], v[106:107], v[98:99] op_sel_hi:[1,0]
  v_rcp_f32 v104, v104
  v_rcp_f32 v105, v105
  v_rcp_f32 v106, v106
  v_rcp_f32 v107, v107
  v_pk_mul_f32 v[176:177], v[176:177], v[104:105]
  v_pk_mul_f32 v[178:179], v[178:179], v[106:107]
  v_cvt_pk_bf16_f32 v118, v176, v177
  v_cvt_pk_bf16_f32 v119, v178, v179
  s_add_u32 s3, s10, 49152
  s_nop 0
  v_permlane16_swap_b32 v116, v118
  v_permlane16_swap_b32 v117, v119
  buffer_store_dwordx4 v[116:119], v12, s[44:47], s3 offen sc1
  v_pk_fma_f32 v[100:101], v[48:49], v[88:89], v[76:77] op_sel:[0,0,0] op_sel_hi:[1,0,1] neg_lo:[0,1,0] neg_hi:[0,1,0]
  v_pk_fma_f32 v[102:103], v[50:51], v[88:89], v[78:79] op_sel:[0,0,0] op_sel_hi:[1,0,1] neg_lo:[0,1,0] neg_hi:[0,1,0]
  v_pk_fma_f32 v[192:193], v[192:193], v[88:89], v[100:101] op_sel:[0,1,0] op_sel_hi:[1,1,1]
  v_pk_fma_f32 v[194:195], v[194:195], v[88:89], v[102:103] op_sel:[0,1,0] op_sel_hi:[1,1,1]
  v_pk_mul_f32 v[100:101], v[192:193], v[192:193]
  v_pk_mul_f32 v[102:103], v[194:195], v[194:195]
  v_pk_fma_f32 v[100:101], v[100:101], v[96:97], v[96:97] op_sel:[0,1,0] op_sel_hi:[1,1,0]
  v_pk_fma_f32 v[102:103], v[102:103], v[96:97], v[96:97] op_sel:[0,1,0] op_sel_hi:[1,1,0]
  v_pk_mul_f32 v[100:101], v[100:101], v[192:193]
  v_pk_mul_f32 v[102:103], v[102:103], v[194:195]
  v_exp_f32 v100, v100
  v_exp_f32 v101, v101
  v_exp_f32 v102, v102
  v_exp_f32 v103, v103
  v_pk_add_f32 v[100:101], v[100:101], v[98:99] op_sel_hi:[1,0]
  v_pk_add_f32 v[102:103], v[102:103], v[98:99] op_sel_hi:[1,0]
  v_rcp_f32 v100, v100
  v_rcp_f32 v101, v101
  v_rcp_f32 v102, v102
  v_rcp_f32 v103, v103
  v_pk_mul_f32 v[192:193], v[192:193], v[100:101]
  v_pk_mul_f32 v[194:195], v[194:195], v[102:103]
  v_cvt_pk_bf16_f32 v120, v192, v193
  v_cvt_pk_bf16_f32 v121, v194, v195
  v_pk_fma_f32 v[104:105], v[52:53], v[88:89], v[80:81] op_sel:[0,0,0] op_sel_hi:[1,0,1] neg_lo:[0,1,0] neg_hi:[0,1,0]
  v_pk_fma_f32 v[106:107], v[54:55], v[88:89], v[82:83] op_sel:[0,0,0] op_sel_hi:[1,0,1] neg_lo:[0,1,0] neg_hi:[0,1,0]
  v_pk_fma_f32 v[208:209], v[208:209], v[88:89], v[104:105] op_sel:[0,1,0] op_sel_hi:[1,1,1]
  v_pk_fma_f32 v[210:211], v[210:211], v[88:89], v[106:107] op_sel:[0,1,0] op_sel_hi:[1,1,1]
  v_pk_mul_f32 v[104:105], v[208:209], v[208:209]
  v_pk_mul_f32 v[106:107], v[210:211], v[210:211]
  v_pk_fma_f32 v[104:105], v[104:105], v[96:97], v[96:97] op_sel:[0,1,0] op_sel_hi:[1,1,0]
  v_pk_fma_f32 v[106:107], v[106:107], v[96:97], v[96:97] op_sel:[0,1,0] op_sel_hi:[1,1,0]
  v_pk_mul_f32 v[104:105], v[104:105], v[208:209]
  v_pk_mul_f32 v[106:107], v[106:107], v[210:211]
  v_exp_f32 v104, v104
  v_exp_f32 v105, v105
  v_exp_f32 v106, v106
  v_exp_f32 v107, v107
  v_pk_add_f32 v[104:105], v[104:105], v[98:99] op_sel_hi:[1,0]
  v_pk_add_f32 v[106:107], v[106:107], v[98:99] op_sel_hi:[1,0]
  v_rcp_f32 v104, v104
  v_rcp_f32 v105, v105
  v_rcp_f32 v106, v106
  v_rcp_f32 v107, v107
  v_pk_mul_f32 v[208:209], v[208:209], v[104:105]
  v_pk_mul_f32 v[210:211], v[210:211], v[106:107]
  v_cvt_pk_bf16_f32 v122, v208, v209
  v_cvt_pk_bf16_f32 v123, v210, v211
  s_add_u32 s3, s10, 51200
  s_nop 0
  v_permlane16_swap_b32 v120, v122
  v_permlane16_swap_b32 v121, v123
  buffer_store_dwordx4 v[120:123], v12, s[44:47], s3 offen sc1
  v_pk_fma_f32 v[100:101], v[40:41], v[90:91], v[68:69] op_sel:[0,0,0] op_sel_hi:[1,0,1] neg_lo:[0,1,0] neg_hi:[0,1,0]
  v_pk_fma_f32 v[102:103], v[42:43], v[90:91], v[70:71] op_sel:[0,0,0] op_sel_hi:[1,0,1] neg_lo:[0,1,0] neg_hi:[0,1,0]
  v_pk_fma_f32 v[164:165], v[164:165], v[90:91], v[100:101] op_sel:[0,1,0] op_sel_hi:[1,1,1]
  v_pk_fma_f32 v[166:167], v[166:167], v[90:91], v[102:103] op_sel:[0,1,0] op_sel_hi:[1,1,1]
  v_pk_mul_f32 v[100:101], v[164:165], v[164:165]
  v_pk_mul_f32 v[102:103], v[166:167], v[166:167]
  v_pk_fma_f32 v[100:101], v[100:101], v[96:97], v[96:97] op_sel:[0,1,0] op_sel_hi:[1,1,0]
  v_pk_fma_f32 v[102:103], v[102:103], v[96:97], v[96:97] op_sel:[0,1,0] op_sel_hi:[1,1,0]
  v_pk_mul_f32 v[100:101], v[100:101], v[164:165]
  v_pk_mul_f32 v[102:103], v[102:103], v[166:167]
  v_exp_f32 v100, v100
  v_exp_f32 v101, v101
  v_exp_f32 v102, v102
  v_exp_f32 v103, v103
  v_pk_add_f32 v[100:101], v[100:101], v[98:99] op_sel_hi:[1,0]
  v_pk_add_f32 v[102:103], v[102:103], v[98:99] op_sel_hi:[1,0]
  v_rcp_f32 v100, v100
  v_rcp_f32 v101, v101
  v_rcp_f32 v102, v102
  v_rcp_f32 v103, v103
  v_pk_mul_f32 v[164:165], v[164:165], v[100:101]
  v_pk_mul_f32 v[166:167], v[166:167], v[102:103]
  v_cvt_pk_bf16_f32 v108, v164, v165
  v_cvt_pk_bf16_f32 v109, v166, v167
  v_pk_fma_f32 v[104:105], v[44:45], v[90:91], v[72:73] op_sel:[0,0,0] op_sel_hi:[1,0,1] neg_lo:[0,1,0] neg_hi:[0,1,0]
  v_pk_fma_f32 v[106:107], v[46:47], v[90:91], v[74:75] op_sel:[0,0,0] op_sel_hi:[1,0,1] neg_lo:[0,1,0] neg_hi:[0,1,0]
  v_pk_fma_f32 v[180:181], v[180:181], v[90:91], v[104:105] op_sel:[0,1,0] op_sel_hi:[1,1,1]
  v_pk_fma_f32 v[182:183], v[182:183], v[90:91], v[106:107] op_sel:[0,1,0] op_sel_hi:[1,1,1]
  v_pk_mul_f32 v[104:105], v[180:181], v[180:181]
  v_pk_mul_f32 v[106:107], v[182:183], v[182:183]
  v_pk_fma_f32 v[104:105], v[104:105], v[96:97], v[96:97] op_sel:[0,1,0] op_sel_hi:[1,1,0]
  v_pk_fma_f32 v[106:107], v[106:107], v[96:97], v[96:97] op_sel:[0,1,0] op_sel_hi:[1,1,0]
  v_pk_mul_f32 v[104:105], v[104:105], v[180:181]
  v_pk_mul_f32 v[106:107], v[106:107], v[182:183]
  v_exp_f32 v104, v104
  v_exp_f32 v105, v105
  v_exp_f32 v106, v106
  v_exp_f32 v107, v107
  v_pk_add_f32 v[104:105], v[104:105], v[98:99] op_sel_hi:[1,0]
  v_pk_add_f32 v[106:107], v[106:107], v[98:99] op_sel_hi:[1,0]
  v_rcp_f32 v104, v104
  v_rcp_f32 v105, v105
  v_rcp_f32 v106, v106
  v_rcp_f32 v107, v107
  v_pk_mul_f32 v[180:181], v[180:181], v[104:105]
  v_pk_mul_f32 v[182:183], v[182:183], v[106:107]
  v_cvt_pk_bf16_f32 v110, v180, v181
  v_cvt_pk_bf16_f32 v111, v182, v183
  s_add_u32 s3, s10, 163840
  s_nop 0
  v_permlane16_swap_b32 v108, v110
  v_permlane16_swap_b32 v109, v111
  buffer_store_dwordx4 v[108:111], v12, s[44:47], s3 offen sc1
  v_pk_fma_f32 v[100:101], v[48:49], v[90:91], v[76:77] op_sel:[0,0,0] op_sel_hi:[1,0,1] neg_lo:[0,1,0] neg_hi:[0,1,0]
  v_pk_fma_f32 v[102:103], v[50:51], v[90:91], v[78:79] op_sel:[0,0,0] op_sel_hi:[1,0,1] neg_lo:[0,1,0] neg_hi:[0,1,0]
  v_pk_fma_f32 v[196:197], v[196:197], v[90:91], v[100:101] op_sel:[0,1,0] op_sel_hi:[1,1,1]
  v_pk_fma_f32 v[198:199], v[198:199], v[90:91], v[102:103] op_sel:[0,1,0] op_sel_hi:[1,1,1]
  v_pk_mul_f32 v[100:101], v[196:197], v[196:197]
  v_pk_mul_f32 v[102:103], v[198:199], v[198:199]
  v_pk_fma_f32 v[100:101], v[100:101], v[96:97], v[96:97] op_sel:[0,1,0] op_sel_hi:[1,1,0]
  v_pk_fma_f32 v[102:103], v[102:103], v[96:97], v[96:97] op_sel:[0,1,0] op_sel_hi:[1,1,0]
  v_pk_mul_f32 v[100:101], v[100:101], v[196:197]
  v_pk_mul_f32 v[102:103], v[102:103], v[198:199]
  v_exp_f32 v100, v100
  v_exp_f32 v101, v101
  v_exp_f32 v102, v102
  v_exp_f32 v103, v103
  v_pk_add_f32 v[100:101], v[100:101], v[98:99] op_sel_hi:[1,0]
  v_pk_add_f32 v[102:103], v[102:103], v[98:99] op_sel_hi:[1,0]
  v_rcp_f32 v100, v100
  v_rcp_f32 v101, v101
  v_rcp_f32 v102, v102
  v_rcp_f32 v103, v103
  v_pk_mul_f32 v[196:197], v[196:197], v[100:101]
  v_pk_mul_f32 v[198:199], v[198:199], v[102:103]
  v_cvt_pk_bf16_f32 v112, v196, v197
  v_cvt_pk_bf16_f32 v113, v198, v199
  v_pk_fma_f32 v[104:105], v[52:53], v[90:91], v[80:81] op_sel:[0,0,0] op_sel_hi:[1,0,1] neg_lo:[0,1,0] neg_hi:[0,1,0]
  v_pk_fma_f32 v[106:107], v[54:55], v[90:91], v[82:83] op_sel:[0,0,0] op_sel_hi:[1,0,1] neg_lo:[0,1,0] neg_hi:[0,1,0]
  v_pk_fma_f32 v[212:213], v[212:213], v[90:91], v[104:105] op_sel:[0,1,0] op_sel_hi:[1,1,1]
  v_pk_fma_f32 v[214:215], v[214:215], v[90:91], v[106:107] op_sel:[0,1,0] op_sel_hi:[1,1,1]
  v_pk_mul_f32 v[104:105], v[212:213], v[212:213]
  v_pk_mul_f32 v[106:107], v[214:215], v[214:215]
  v_pk_fma_f32 v[104:105], v[104:105], v[96:97], v[96:97] op_sel:[0,1,0] op_sel_hi:[1,1,0]
  v_pk_fma_f32 v[106:107], v[106:107], v[96:97], v[96:97] op_sel:[0,1,0] op_sel_hi:[1,1,0]
  v_pk_mul_f32 v[104:105], v[104:105], v[212:213]
  v_pk_mul_f32 v[106:107], v[106:107], v[214:215]
  v_exp_f32 v104, v104
  v_exp_f32 v105, v105
  v_exp_f32 v106, v106
  v_exp_f32 v107, v107
  v_pk_add_f32 v[104:105], v[104:105], v[98:99] op_sel_hi:[1,0]
  v_pk_add_f32 v[106:107], v[106:107], v[98:99] op_sel_hi:[1,0]
  v_rcp_f32 v104, v104
  v_rcp_f32 v105, v105
  v_rcp_f32 v106, v106
  v_rcp_f32 v107, v107
  v_pk_mul_f32 v[212:213], v[212:213], v[104:105]
  v_pk_mul_f32 v[214:215], v[214:215], v[106:107]
  v_cvt_pk_bf16_f32 v114, v212, v213
  v_cvt_pk_bf16_f32 v115, v214, v215
  s_add_u32 s3, s10, 165888
  s_nop 0
  v_permlane16_swap_b32 v112, v114
  v_permlane16_swap_b32 v113, v115
  buffer_store_dwordx4 v[112:115], v12, s[44:47], s3 offen sc1
  v_pk_fma_f32 v[100:101], v[40:41], v[92:93], v[68:69] op_sel:[0,0,0] op_sel_hi:[1,0,1] neg_lo:[0,1,0] neg_hi:[0,1,0]
  v_pk_fma_f32 v[102:103], v[42:43], v[92:93], v[70:71] op_sel:[0,0,0] op_sel_hi:[1,0,1] neg_lo:[0,1,0] neg_hi:[0,1,0]
  v_pk_fma_f32 v[168:169], v[168:169], v[92:93], v[100:101] op_sel:[0,1,0] op_sel_hi:[1,1,1]
  v_pk_fma_f32 v[170:171], v[170:171], v[92:93], v[102:103] op_sel:[0,1,0] op_sel_hi:[1,1,1]
  v_pk_mul_f32 v[100:101], v[168:169], v[168:169]
  v_pk_mul_f32 v[102:103], v[170:171], v[170:171]
  v_pk_fma_f32 v[100:101], v[100:101], v[96:97], v[96:97] op_sel:[0,1,0] op_sel_hi:[1,1,0]
  v_pk_fma_f32 v[102:103], v[102:103], v[96:97], v[96:97] op_sel:[0,1,0] op_sel_hi:[1,1,0]
  v_pk_mul_f32 v[100:101], v[100:101], v[168:169]
  v_pk_mul_f32 v[102:103], v[102:103], v[170:171]
  v_exp_f32 v100, v100
  v_exp_f32 v101, v101
  v_exp_f32 v102, v102
  v_exp_f32 v103, v103
  v_pk_add_f32 v[100:101], v[100:101], v[98:99] op_sel_hi:[1,0]
  v_pk_add_f32 v[102:103], v[102:103], v[98:99] op_sel_hi:[1,0]
  v_rcp_f32 v100, v100
  v_rcp_f32 v101, v101
  v_rcp_f32 v102, v102
  v_rcp_f32 v103, v103
  v_pk_mul_f32 v[168:169], v[168:169], v[100:101]
  v_pk_mul_f32 v[170:171], v[170:171], v[102:103]
  v_cvt_pk_bf16_f32 v116, v168, v169
  v_cvt_pk_bf16_f32 v117, v170, v171
  v_pk_fma_f32 v[104:105], v[44:45], v[92:93], v[72:73] op_sel:[0,0,0] op_sel_hi:[1,0,1] neg_lo:[0,1,0] neg_hi:[0,1,0]
  v_pk_fma_f32 v[106:107], v[46:47], v[92:93], v[74:75] op_sel:[0,0,0] op_sel_hi:[1,0,1] neg_lo:[0,1,0] neg_hi:[0,1,0]
  v_pk_fma_f32 v[184:185], v[184:185], v[92:93], v[104:105] op_sel:[0,1,0] op_sel_hi:[1,1,1]
  v_pk_fma_f32 v[186:187], v[186:187], v[92:93], v[106:107] op_sel:[0,1,0] op_sel_hi:[1,1,1]
  v_pk_mul_f32 v[104:105], v[184:185], v[184:185]
  v_pk_mul_f32 v[106:107], v[186:187], v[186:187]
  v_pk_fma_f32 v[104:105], v[104:105], v[96:97], v[96:97] op_sel:[0,1,0] op_sel_hi:[1,1,0]
  v_pk_fma_f32 v[106:107], v[106:107], v[96:97], v[96:97] op_sel:[0,1,0] op_sel_hi:[1,1,0]
  v_pk_mul_f32 v[104:105], v[104:105], v[184:185]
  v_pk_mul_f32 v[106:107], v[106:107], v[186:187]
  v_exp_f32 v104, v104
  v_exp_f32 v105, v105
  v_exp_f32 v106, v106
  v_exp_f32 v107, v107
  v_pk_add_f32 v[104:105], v[104:105], v[98:99] op_sel_hi:[1,0]
  v_pk_add_f32 v[106:107], v[106:107], v[98:99] op_sel_hi:[1,0]
  v_rcp_f32 v104, v104
  v_rcp_f32 v105, v105
  v_rcp_f32 v106, v106
  v_rcp_f32 v107, v107
  v_pk_mul_f32 v[184:185], v[184:185], v[104:105]
  v_pk_mul_f32 v[186:187], v[186:187], v[106:107]
  v_cvt_pk_bf16_f32 v118, v184, v185
  v_cvt_pk_bf16_f32 v119, v186, v187
  s_add_u32 s3, s10, 278528
  s_nop 0
  v_permlane16_swap_b32 v116, v118
  v_permlane16_swap_b32 v117, v119
  buffer_store_dwordx4 v[116:119], v12, s[44:47], s3 offen sc1
  v_pk_fma_f32 v[100:101], v[48:49], v[92:93], v[76:77] op_sel:[0,0,0] op_sel_hi:[1,0,1] neg_lo:[0,1,0] neg_hi:[0,1,0]
  v_pk_fma_f32 v[102:103], v[50:51], v[92:93], v[78:79] op_sel:[0,0,0] op_sel_hi:[1,0,1] neg_lo:[0,1,0] neg_hi:[0,1,0]
  v_pk_fma_f32 v[200:201], v[200:201], v[92:93], v[100:101] op_sel:[0,1,0] op_sel_hi:[1,1,1]
  v_pk_fma_f32 v[202:203], v[202:203], v[92:93], v[102:103] op_sel:[0,1,0] op_sel_hi:[1,1,1]
  v_pk_mul_f32 v[100:101], v[200:201], v[200:201]
  v_pk_mul_f32 v[102:103], v[202:203], v[202:203]
  v_pk_fma_f32 v[100:101], v[100:101], v[96:97], v[96:97] op_sel:[0,1,0] op_sel_hi:[1,1,0]
  v_pk_fma_f32 v[102:103], v[102:103], v[96:97], v[96:97] op_sel:[0,1,0] op_sel_hi:[1,1,0]
  v_pk_mul_f32 v[100:101], v[100:101], v[200:201]
  v_pk_mul_f32 v[102:103], v[102:103], v[202:203]
  v_exp_f32 v100, v100
  v_exp_f32 v101, v101
  v_exp_f32 v102, v102
  v_exp_f32 v103, v103
  v_pk_add_f32 v[100:101], v[100:101], v[98:99] op_sel_hi:[1,0]
  v_pk_add_f32 v[102:103], v[102:103], v[98:99] op_sel_hi:[1,0]
  v_rcp_f32 v100, v100
  v_rcp_f32 v101, v101
  v_rcp_f32 v102, v102
  v_rcp_f32 v103, v103
  v_pk_mul_f32 v[200:201], v[200:201], v[100:101]
  v_pk_mul_f32 v[202:203], v[202:203], v[102:103]
  v_cvt_pk_bf16_f32 v120, v200, v201
  v_cvt_pk_bf16_f32 v121, v202, v203
  v_pk_fma_f32 v[104:105], v[52:53], v[92:93], v[80:81] op_sel:[0,0,0] op_sel_hi:[1,0,1] neg_lo:[0,1,0] neg_hi:[0,1,0]
  v_pk_fma_f32 v[106:107], v[54:55], v[92:93], v[82:83] op_sel:[0,0,0] op_sel_hi:[1,0,1] neg_lo:[0,1,0] neg_hi:[0,1,0]
  v_pk_fma_f32 v[216:217], v[216:217], v[92:93], v[104:105] op_sel:[0,1,0] op_sel_hi:[1,1,1]
  v_pk_fma_f32 v[218:219], v[218:219], v[92:93], v[106:107] op_sel:[0,1,0] op_sel_hi:[1,1,1]
  v_pk_mul_f32 v[104:105], v[216:217], v[216:217]
  v_pk_mul_f32 v[106:107], v[218:219], v[218:219]
  v_pk_fma_f32 v[104:105], v[104:105], v[96:97], v[96:97] op_sel:[0,1,0] op_sel_hi:[1,1,0]
  v_pk_fma_f32 v[106:107], v[106:107], v[96:97], v[96:97] op_sel:[0,1,0] op_sel_hi:[1,1,0]
  v_pk_mul_f32 v[104:105], v[104:105], v[216:217]
  v_pk_mul_f32 v[106:107], v[106:107], v[218:219]
  v_exp_f32 v104, v104
  v_exp_f32 v105, v105
  v_exp_f32 v106, v106
  v_exp_f32 v107, v107
  v_pk_add_f32 v[104:105], v[104:105], v[98:99] op_sel_hi:[1,0]
  v_pk_add_f32 v[106:107], v[106:107], v[98:99] op_sel_hi:[1,0]
  v_rcp_f32 v104, v104
  v_rcp_f32 v105, v105
  v_rcp_f32 v106, v106
  v_rcp_f32 v107, v107
  v_pk_mul_f32 v[216:217], v[216:217], v[104:105]
  v_pk_mul_f32 v[218:219], v[218:219], v[106:107]
  v_cvt_pk_bf16_f32 v122, v216, v217
  v_cvt_pk_bf16_f32 v123, v218, v219
  s_add_u32 s3, s10, 280576
  s_nop 0
  v_permlane16_swap_b32 v120, v122
  v_permlane16_swap_b32 v121, v123
  buffer_store_dwordx4 v[120:123], v12, s[44:47], s3 offen sc1
  v_pk_fma_f32 v[100:101], v[40:41], v[94:95], v[68:69] op_sel:[0,0,0] op_sel_hi:[1,0,1] neg_lo:[0,1,0] neg_hi:[0,1,0]
  v_pk_fma_f32 v[102:103], v[42:43], v[94:95], v[70:71] op_sel:[0,0,0] op_sel_hi:[1,0,1] neg_lo:[0,1,0] neg_hi:[0,1,0]
  v_pk_fma_f32 v[172:173], v[172:173], v[94:95], v[100:101] op_sel:[0,1,0] op_sel_hi:[1,1,1]
  v_pk_fma_f32 v[174:175], v[174:175], v[94:95], v[102:103] op_sel:[0,1,0] op_sel_hi:[1,1,1]
  v_pk_mul_f32 v[100:101], v[172:173], v[172:173]
  v_pk_mul_f32 v[102:103], v[174:175], v[174:175]
  v_pk_fma_f32 v[100:101], v[100:101], v[96:97], v[96:97] op_sel:[0,1,0] op_sel_hi:[1,1,0]
  v_pk_fma_f32 v[102:103], v[102:103], v[96:97], v[96:97] op_sel:[0,1,0] op_sel_hi:[1,1,0]
  v_pk_mul_f32 v[100:101], v[100:101], v[172:173]
  v_pk_mul_f32 v[102:103], v[102:103], v[174:175]
  v_exp_f32 v100, v100
  v_exp_f32 v101, v101
  v_exp_f32 v102, v102
  v_exp_f32 v103, v103
  v_pk_add_f32 v[100:101], v[100:101], v[98:99] op_sel_hi:[1,0]
  v_pk_add_f32 v[102:103], v[102:103], v[98:99] op_sel_hi:[1,0]
  v_rcp_f32 v100, v100
  v_rcp_f32 v101, v101
  v_rcp_f32 v102, v102
  v_rcp_f32 v103, v103
  v_pk_mul_f32 v[172:173], v[172:173], v[100:101]
  v_pk_mul_f32 v[174:175], v[174:175], v[102:103]
  v_cvt_pk_bf16_f32 v108, v172, v173
  v_cvt_pk_bf16_f32 v109, v174, v175
  v_pk_fma_f32 v[104:105], v[44:45], v[94:95], v[72:73] op_sel:[0,0,0] op_sel_hi:[1,0,1] neg_lo:[0,1,0] neg_hi:[0,1,0]
  v_pk_fma_f32 v[106:107], v[46:47], v[94:95], v[74:75] op_sel:[0,0,0] op_sel_hi:[1,0,1] neg_lo:[0,1,0] neg_hi:[0,1,0]
  v_pk_fma_f32 v[188:189], v[188:189], v[94:95], v[104:105] op_sel:[0,1,0] op_sel_hi:[1,1,1]
  v_pk_fma_f32 v[190:191], v[190:191], v[94:95], v[106:107] op_sel:[0,1,0] op_sel_hi:[1,1,1]
  v_pk_mul_f32 v[104:105], v[188:189], v[188:189]
  v_pk_mul_f32 v[106:107], v[190:191], v[190:191]
  v_pk_fma_f32 v[104:105], v[104:105], v[96:97], v[96:97] op_sel:[0,1,0] op_sel_hi:[1,1,0]
  v_pk_fma_f32 v[106:107], v[106:107], v[96:97], v[96:97] op_sel:[0,1,0] op_sel_hi:[1,1,0]
  v_pk_mul_f32 v[104:105], v[104:105], v[188:189]
  v_pk_mul_f32 v[106:107], v[106:107], v[190:191]
  v_exp_f32 v104, v104
  v_exp_f32 v105, v105
  v_exp_f32 v106, v106
  v_exp_f32 v107, v107
  v_pk_add_f32 v[104:105], v[104:105], v[98:99] op_sel_hi:[1,0]
  v_pk_add_f32 v[106:107], v[106:107], v[98:99] op_sel_hi:[1,0]
  v_rcp_f32 v104, v104
  v_rcp_f32 v105, v105
  v_rcp_f32 v106, v106
  v_rcp_f32 v107, v107
  v_pk_mul_f32 v[188:189], v[188:189], v[104:105]
  v_pk_mul_f32 v[190:191], v[190:191], v[106:107]
  v_cvt_pk_bf16_f32 v110, v188, v189
  v_cvt_pk_bf16_f32 v111, v190, v191
  s_add_u32 s3, s10, 393216
  s_nop 0
  v_permlane16_swap_b32 v108, v110
  v_permlane16_swap_b32 v109, v111
  buffer_store_dwordx4 v[108:111], v12, s[44:47], s3 offen sc1
  v_pk_fma_f32 v[100:101], v[48:49], v[94:95], v[76:77] op_sel:[0,0,0] op_sel_hi:[1,0,1] neg_lo:[0,1,0] neg_hi:[0,1,0]
  v_pk_fma_f32 v[102:103], v[50:51], v[94:95], v[78:79] op_sel:[0,0,0] op_sel_hi:[1,0,1] neg_lo:[0,1,0] neg_hi:[0,1,0]
  v_pk_fma_f32 v[204:205], v[204:205], v[94:95], v[100:101] op_sel:[0,1,0] op_sel_hi:[1,1,1]
  v_pk_fma_f32 v[206:207], v[206:207], v[94:95], v[102:103] op_sel:[0,1,0] op_sel_hi:[1,1,1]
  v_pk_mul_f32 v[100:101], v[204:205], v[204:205]
  v_pk_mul_f32 v[102:103], v[206:207], v[206:207]
  v_pk_fma_f32 v[100:101], v[100:101], v[96:97], v[96:97] op_sel:[0,1,0] op_sel_hi:[1,1,0]
  v_pk_fma_f32 v[102:103], v[102:103], v[96:97], v[96:97] op_sel:[0,1,0] op_sel_hi:[1,1,0]
  v_pk_mul_f32 v[100:101], v[100:101], v[204:205]
  v_pk_mul_f32 v[102:103], v[102:103], v[206:207]
  v_exp_f32 v100, v100
  v_exp_f32 v101, v101
  v_exp_f32 v102, v102
  v_exp_f32 v103, v103
  v_pk_add_f32 v[100:101], v[100:101], v[98:99] op_sel_hi:[1,0]
  v_pk_add_f32 v[102:103], v[102:103], v[98:99] op_sel_hi:[1,0]
  v_rcp_f32 v100, v100
  v_rcp_f32 v101, v101
  v_rcp_f32 v102, v102
  v_rcp_f32 v103, v103
  v_pk_mul_f32 v[204:205], v[204:205], v[100:101]
  v_pk_mul_f32 v[206:207], v[206:207], v[102:103]
  v_cvt_pk_bf16_f32 v112, v204, v205
  v_cvt_pk_bf16_f32 v113, v206, v207
  v_pk_fma_f32 v[104:105], v[52:53], v[94:95], v[80:81] op_sel:[0,0,0] op_sel_hi:[1,0,1] neg_lo:[0,1,0] neg_hi:[0,1,0]
  v_pk_fma_f32 v[106:107], v[54:55], v[94:95], v[82:83] op_sel:[0,0,0] op_sel_hi:[1,0,1] neg_lo:[0,1,0] neg_hi:[0,1,0]
  v_pk_fma_f32 v[220:221], v[220:221], v[94:95], v[104:105] op_sel:[0,1,0] op_sel_hi:[1,1,1]
  v_pk_fma_f32 v[222:223], v[222:223], v[94:95], v[106:107] op_sel:[0,1,0] op_sel_hi:[1,1,1]
  v_pk_mul_f32 v[104:105], v[220:221], v[220:221]
  v_pk_mul_f32 v[106:107], v[222:223], v[222:223]
  v_pk_fma_f32 v[104:105], v[104:105], v[96:97], v[96:97] op_sel:[0,1,0] op_sel_hi:[1,1,0]
  v_pk_fma_f32 v[106:107], v[106:107], v[96:97], v[96:97] op_sel:[0,1,0] op_sel_hi:[1,1,0]
  v_pk_mul_f32 v[104:105], v[104:105], v[220:221]
  v_pk_mul_f32 v[106:107], v[106:107], v[222:223]
  v_exp_f32 v104, v104
  v_exp_f32 v105, v105
  v_exp_f32 v106, v106
  v_exp_f32 v107, v107
  v_pk_add_f32 v[104:105], v[104:105], v[98:99] op_sel_hi:[1,0]
  v_pk_add_f32 v[106:107], v[106:107], v[98:99] op_sel_hi:[1,0]
  v_rcp_f32 v104, v104
  v_rcp_f32 v105, v105
  v_rcp_f32 v106, v106
  v_rcp_f32 v107, v107
  v_pk_mul_f32 v[220:221], v[220:221], v[104:105]
  v_pk_mul_f32 v[222:223], v[222:223], v[106:107]
  v_cvt_pk_bf16_f32 v114, v220, v221
  v_cvt_pk_bf16_f32 v115, v222, v223
  s_add_u32 s3, s10, 395264
  s_nop 0
  v_permlane16_swap_b32 v112, v114
  v_permlane16_swap_b32 v113, v115
  buffer_store_dwordx4 v[112:115], v12, s[44:47], s3 offen sc1
  s_waitcnt vmcnt(0)
  s_barrier
  s_add_u32 s97, s97, 1
  s_branch L_w2_body
L_w1_c1:
L_w2_c0:
L_w2_body:
  s_cmp_ge_u32 s2, 256
  s_cbranch_scc1 L_w2_end
  v_lshrrev_b32 v2, 6, v0
  v_and_b32 v1, 63, v0
  v_readfirstlane_b32 s70, v2
  s_and_b32 s3, s2, 7
  s_lshr_b32 s99, s2, 3
  s_and_b32 s5, s3, 3
  s_lshl_b32 s5, s5, 2
  s_and_b32 s6, s99, 3
  s_add_u32 s68, s5, s6
  s_lshr_b32 s5, s3, 2
  s_lshl_b32 s5, s5, 3
  s_lshr_b32 s6, s99, 2
  s_add_u32 s69, s5, s6
  s_cmp_lt_u32 s70, 4
  s_cbranch_scc1 L_w2_compute
L_w2_loader:
  s_add_u32 s8, s70, s69
  s_and_b32 s8, s8, 3
  s_add_u32 s9, s70, s68
  s_and_b32 s9, s9, 3
  s_lshl_b32 s76, s8, 12
  s_lshl_b32 s77, s9, 11
  s_add_u32 s77, s77, 16384
  s_lshl_b32 s11, s68, 7
  v_and_b32 v10, 7, v1
  s_lshr_b32 s10, s76, 11
  s_lshl_b32 s3, s68, 3
  s_add_u32 s10, s10, s3
  s_mul_i32 s10, s10, 114688
  v_lshl_add_u32 v4, v1, 4, s10
  v_add_u32 v5, 114688, v4
  v_lshrrev_b32 v3, 3, v1
  s_lshl_b32 s10, s9, 4
  v_add_u32 v3, s10, v3
  v_mul_u32_u24 v3, 2048, v3
  v_lshrrev_b32 v2, 3, v1
  v_and_b32 v2, 2, v2
  v_xor_b32 v2, v2, v10
  s_mul_i32 s10, s69, 128
  v_add_u32 v3, s10, v3
  v_lshl_add_u32 v8, v2, 4, v3
  v_xor_b32 v2, 4, v2
  v_add_u32 v3, 16384, v3
  v_lshl_add_u32 v9, v2, 4, v3
  s_mov_b32 s75, 0
  s_add_u32 s100, s68, s69
  s_mov_b32 s101, -1
  s_add_u32 s101, s101, 1
  s_sub_u32 s73, s101, s100
  s_lshl_b32 s73, s73, 3
  s_lshr_b32 s73, 0x373702, s73
  s_and_b32 s73, s73, 255
  s_add_u32 s73, s73, s101
  s_sub_u32 s74, s73, 56
  s_cselect_b32 s73, s73, s74
  s_mul_i32 s74, s73, 131072
  s_lshl_b32 s73, s73, 11
  s_waitcnt lgkmcnt(0)
  s_add_u32 s36, s34, 8388608
  s_addc_u32 s37, s35, 0
  s_and_b32 s37, s37, 0xffff
  s_mov_b32 s38, 14680064
  s_mov_b32 s39, 0x00020000
  s_mov_b32 s40, s28
  s_and_b32 s41, s29, 0xffff
  s_mov_b32 s42, 7340032
  s_mov_b32 s43, 0x00020000
  s_and_b32 s3, s70, 3
  s_lshl_b32 s4, s99, 2
  s_add_u32 s3, s3, s4
  s_lshl_b32 s4, s3, 6
  s_and_b32 s4, s4, 64
  s_lshr_b32 s3, s3, 1
  s_lshl_b32 s98, s3, 11
  s_add_u32 s98, s98, s4
  s_sub_u32 s4, 384, s40
  s_and_b32 s4, s4, 0x380
  s_add_u32 s98, s98, s4
  s_lshl_b32 s4, s69, 7
  s_and_b32 s4, s4, 1024
  s_add_u32 s98, s98, s4
  s_add_u32 s98, s98, 524288
  s_buffer_load_dword s84, s[40:43], s98
  s_add_u32 s98, s98, 131072
  s_buffer_load_dword s84, s[40:43], s98
  s_add_u32 s98, s98, 131072
  s_buffer_load_dword s84, s[40:43], s98
  s_add_u32 s98, s98, 131072
  s_buffer_load_dword s84, s[40:43], s98
  s_add_u32 s98, s98, 131072
  s_buffer_load_dword s84, s[40:43], s98
  s_add_u32 s98, s98, 131072
  s_buffer_load_dword s84, s[40:43], s98
  s_add_u32 s98, s98, 131072
  s_buffer_load_dword s84, s[40:43], s98
  s_add_u32 s98, s98, 131072
  s_buffer_load_dword s84, s[40:43], s98
  s_add_u32 s98, s98, 131072
  s_buffer_load_dword s84, s[40:43], s98
  s_add_u32 s98, s98, 131072
  s_mov_b32 s88, s73
  s_add_u32 m0, s77, 0
  s_add_u32 s4, s74, 0
  buffer_load_dwordx4 v8, s[40:43], s4 offen lds
  s_add_u32 m0, s77, 1024
  s_nop 0
  buffer_load_dwordx4 v9, s[40:43], s4 offen lds
  s_add_u32 s101, s101, 1
  s_sub_u32 s73, s101, s100
  s_lshl_b32 s73, s73, 3
  s_lshr_b32 s73, 0x373702, s73
  s_and_b32 s73, s73, 255
  s_add_u32 s73, s73, s101
  s_sub_u32 s74, s73, 56
  s_cselect_b32 s73, s73, s74
  s_mul_i32 s74, s73, 131072
  s_lshl_b32 s73, s73, 11
  s_mov_b32 s89, s73
  s_add_u32 m0, s77, 24576
  s_add_u32 s4, s74, 0
  buffer_load_dwordx4 v8, s[40:43], s4 offen lds
  s_add_u32 m0, s77, 25600
  s_nop 0
  buffer_load_dwordx4 v9, s[40:43], s4 offen lds
  s_add_u32 s101, s101, 1
  s_sub_u32 s73, s101, s100
  s_lshl_b32 s73, s73, 3
  s_lshr_b32 s73, 0x373702, s73
  s_and_b32 s73, s73, 255
  s_add_u32 s73, s73, s101
  s_sub_u32 s74, s73, 56
  s_cselect_b32 s73, s73, s74
  s_mul_i32 s74, s73, 131072
  s_lshl_b32 s73, s73, 11
  s_mov_b32 s90, s73
  s_add_u32 m0, s77, 49152
  s_add_u32 s4, s74, 0
  buffer_load_dwordx4 v8, s[40:43], s4 offen lds
  s_add_u32 m0, s77, 50176
  s_nop 0
  buffer_load_dwordx4 v9, s[40:43], s4 offen lds
  s_add_u32 s101, s101, 1
  s_sub_u32 s73, s101, s100
  s_lshl_b32 s73, s73, 3
  s_lshr_b32 s73, 0x373702, s73
  s_and_b32 s73, s73, 255
  s_add_u32 s73, s73, s101
  s_sub_u32 s74, s73, 56
  s_cselect_b32 s73, s73, s74
  s_mul_i32 s74, s73, 131072
  s_lshl_b32 s73, s73, 11
  s_mov_b32 s91, s73
  s_add_u32 m0, s77, 73728
  s_add_u32 s4, s74, 0
  buffer_load_dwordx4 v8, s[40:43], s4 offen lds
  s_add_u32 m0, s77, 74752
  s_nop 0
  buffer_load_dwordx4 v9, s[40:43], s4 offen lds
  s_add_u32 s101, s101, 1
  s_sub_u32 s73, s101, s100
  s_lshl_b32 s73, s73, 3
  s_lshr_b32 s73, 0x373702, s73
  s_and_b32 s73, s73, 255
  s_add_u32 s73, s73, s101
  s_sub_u32 s74, s73, 56
  s_cselect_b32 s73, s73, s74
  s_mul_i32 s74, s73, 131072
  s_lshl_b32 s73, s73, 11
  s_mov_b32 s92, s73
  s_add_u32 m0, s77, 98304
  s_add_u32 s4, s74, 0
  buffer_load_dwordx4 v8, s[40:43], s4 offen lds
  s_add_u32 m0, s77, 99328
  s_nop 0
  buffer_load_dwordx4 v9, s[40:43], s4 offen lds
  s_add_u32 s101, s101, 1
  s_sub_u32 s73, s101, s100
  s_lshl_b32 s73, s73, 3
  s_lshr_b32 s73, 0x373702, s73
  s_and_b32 s73, s73, 255
  s_add_u32 s73, s73, s101
  s_sub_u32 s74, s73, 56
  s_cselect_b32 s73, s73, s74
  s_mul_i32 s74, s73, 131072
  s_lshl_b32 s73, s73, 11
  s_mov_b32 s75, 122880
  s_add_u32 s44, s22, 24903680
  s_addc_u32 s45, s23, 0
  s_and_b32 s45, s45, 0xffff
  s_mov_b32 s46, 32768
  s_mov_b32 s47, 0x00020000
  s_lshl_b32 s3, s97, 12
  s_lshl_b32 s4, s68, 8
  s_add_u32 s3, s3, s4
  s_sub_u32 s3, s3, 4096
  v_and_b32 v2, 15, v1
  v_lshlrev_b32 v2, 2, v2
  v_mov_b32 v3, 1
  s_mov_b32 s79, 0x100000
  s_cmp_lg_u32 s70, 4
  s_barrier
  s_cbranch_scc1 L_w2_dep
  s_mov_b64 exec, 1
  buffer_store_dword v3, off, s[44:47], s87 sc1
  s_mov_b64 exec, -1
L_w2_poll:
  buffer_load_dword v3, v2, s[44:47], s3 offen sc1
  s_sub_u32 s79, s79, 1
  s_cbranch_scc1 L_w2_dep
  s_waitcnt vmcnt(0)
  v_cmp_ne_u32 vcc, 1, v3
  s_cbranch_vccnz L_w2_poll
L_w2_dep:
  s_barrier
  s_add_u32 m0, s76, 0
  s_nop 0
  buffer_load_dwordx4 v4, s[36:39], s88 offen offset:0 lds
  buffer_load_dwordx4 v4, s[36:39], s88 offen offset:1024 lds
  s_add_u32 m0, s76, 2048
  s_nop 0
  buffer_load_dwordx4 v5, s[36:39], s88 offen offset:0 lds
  buffer_load_dwordx4 v5, s[36:39], s88 offen offset:1024 lds
  s_add_u32 m0, s76, 24576
  s_nop 0
  buffer_load_dwordx4 v4, s[36:39], s89 offen offset:0 lds
  buffer_load_dwordx4 v4, s[36:39], s89 offen offset:1024 lds
  s_add_u32 m0, s76, 26624
  s_nop 0
  buffer_load_dwordx4 v5, s[36:39], s89 offen offset:0 lds
  buffer_load_dwordx4 v5, s[36:39], s89 offen offset:1024 lds
  s_add_u32 m0, s76, 49152
  s_nop 0
  buffer_load_dwordx4 v4, s[36:39], s90 offen offset:0 lds
  buffer_load_dwordx4 v4, s[36:39], s90 offen offset:1024 lds
  s_add_u32 m0, s76, 51200
  s_nop 0
  buffer_load_dwordx4 v5, s[36:39], s90 offen offset:0 lds
  buffer_load_dwordx4 v5, s[36:39], s90 offen offset:1024 lds
  s_add_u32 m0, s76, 73728
  s_nop 0
  buffer_load_dwordx4 v4, s[36:39], s91 offen offset:0 lds
  buffer_load_dwordx4 v4, s[36:39], s91 offen offset:1024 lds
  s_add_u32 m0, s76, 75776
  s_nop 0
  buffer_load_dwordx4 v5, s[36:39], s91 offen offset:0 lds
  buffer_load_dwordx4 v5, s[36:39], s91 offen offset:1024 lds
  s_add_u32 m0, s76, 98304
  s_nop 0
  buffer_load_dwordx4 v4, s[36:39], s92 offen offset:0 lds
  buffer_load_dwordx4 v4, s[36:39], s92 offen offset:1024 lds
  s_add_u32 m0, s76, 100352
  s_nop 0
  buffer_load_dwordx4 v5, s[36:39], s92 offen offset:0 lds
  buffer_load_dwordx4 v5, s[36:39], s92 offen offset:1024 lds
  s_waitcnt vmcnt(16)
  s_barrier
  s_add_u32 s3, s75, s76
  s_add_u32 m0, s3, 0
  s_nop 0
  buffer_load_dwordx4 v4, s[36:39], s73 offen offset:0 lds
  buffer_load_dwordx4 v4, s[36:39], s73 offen offset:1024 lds
  s_add_u32 m0, s3, 2048
  s_nop 0
  buffer_load_dwordx4 v5, s[36:39], s73 offen offset:0 lds
  buffer_load_dwordx4 v5, s[36:39], s73 offen offset:1024 lds
  s_add_u32 s3, s75, s77
  s_add_u32 m0, s3, 0
  s_add_u32 s4, s74, 0
  buffer_load_dwordx4 v8, s[40:43], s4 offen lds
  s_add_u32 m0, s3, 1024
  s_nop 0
  buffer_load_dwordx4 v9, s[40:43], s4 offen lds
  s_add_u32 s101, s101, 1
  s_sub_u32 s73, s101, s100
  s_lshl_b32 s73, s73, 3
  s_lshr_b32 s73, 0x373702, s73
  s_and_b32 s73, s73, 255
  s_add_u32 s73, s73, s101
  s_sub_u32 s74, s73, 56
  s_cselect_b32 s73, s73, s74
  s_mul_i32 s74, s73, 131072
  s_lshl_b32 s73, s73, 11
  s_add_u32 s75, s75, 24576
  s_cmp_eq_u32 s75, 147456
  s_cselect_b32 s75, 0, s75
  s_buffer_load_dword s84, s[40:43], s98
  s_add_u32 s98, s98, 131072
  s_waitcnt vmcnt(18)
  s_barrier
  s_add_u32 s3, s75, s76
  s_add_u32 m0, s3, 0
  s_nop 0
  buffer_load_dwordx4 v4, s[36:39], s73 offen offset:0 lds
  buffer_load_dwordx4 v4, s[36:39], s73 offen offset:1024 lds
  s_add_u32 m0, s3, 2048
  s_nop 0
  buffer_load_dwordx4 v5, s[36:39], s73 offen offset:0 lds
  buffer_load_dwordx4 v5, s[36:39], s73 offen offset:1024 lds
  s_add_u32 s3, s75, s77
  s_add_u32 m0, s3, 0
  s_add_u32 s4, s74, 0
  buffer_load_dwordx4 v8, s[40:43], s4 offen lds
  s_add_u32 m0, s3, 1024
  s_nop 0
  buffer_load_dwordx4 v9, s[40:43], s4 offen lds
  s_add_u32 s101, s101, 1
  s_sub_u32 s73, s101, s100
  s_lshl_b32 s73, s73, 3
  s_lshr_b32 s73, 0x373702, s73
  s_and_b32 s73, s73, 255
  s_add_u32 s73, s73, s101
  s_sub_u32 s74, s73, 56
  s_cselect_b32 s73, s73, s74
  s_mul_i32 s74, s73, 131072
  s_lshl_b32 s73, s73, 11
  s_add_u32 s75, s75, 24576
  s_cmp_eq_u32 s75, 147456
  s_cselect_b32 s75, 0, s75
  s_buffer_load_dword s84, s[40:43], s98
  s_add_u32 s98, s98, 131072
  s_waitcnt vmcnt(20)
  s_barrier
  s_add_u32 s3, s75, s76
  s_add_u32 m0, s3, 0
  s_nop 0
  buffer_load_dwordx4 v4, s[36:39], s73 offen offset:0 lds
  buffer_load_dwordx4 v4, s[36:39], s73 offen offset:1024 lds
  s_add_u32 m0, s3, 2048
  s_nop 0
  buffer_load_dwordx4 v5, s[36:39], s73 offen offset:0 lds
  buffer_load_dwordx4 v5, s[36:39], s73 offen offset:1024 lds
  s_add_u32 s3, s75, s77
  s_add_u32 m0, s3, 0
  s_add_u32 s4, s74, 0
  buffer_load_dwordx4 v8, s[40:43], s4 offen lds
  s_add_u32 m0, s3, 1024
  s_nop 0
  buffer_load_dwordx4 v9, s[40:43], s4 offen lds
  s_add_u32 s101, s101, 1
  s_sub_u32 s73, s101, s100
  s_lshl_b32 s73, s73, 3
  s_lshr_b32 s73, 0x373702, s73
  s_and_b32 s73, s73, 255
  s_add_u32 s73, s73, s101
  s_sub_u32 s74, s73, 56
  s_cselect_b32 s73, s73, s74
  s_mul_i32 s74, s73, 131072
  s_lshl_b32 s73, s73, 11
  s_add_u32 s75, s75, 24576
  s_cmp_eq_u32 s75, 147456
  s_cselect_b32 s75, 0, s75
  s_buffer_load_dword s84, s[40:43], s98
  s_add_u32 s98, s98, 131072
  s_waitcnt vmcnt(22)
  s_barrier
  s_mov_b32 s79, 47
L_w2l_ld1:
  s_add_u32 s3, s75, s76
  s_add_u32 m0, s3, 0
  s_nop 0
  buffer_load_dwordx4 v4, s[36:39], s73 offen offset:0 lds
  buffer_load_dwordx4 v4, s[36:39], s73 offen offset:1024 lds
  s_add_u32 m0, s3, 2048
  s_nop 0
  buffer_load_dwordx4 v5, s[36:39], s73 offen offset:0 lds
  buffer_load_dwordx4 v5, s[36:39], s73 offen offset:1024 lds
  s_add_u32 s3, s75, s77
  s_add_u32 m0, s3, 0
  s_add_u32 s4, s74, 0
  buffer_load_dwordx4 v8, s[40:43], s4 offen lds
  s_add_u32 m0, s3, 1024
  s_nop 0
  buffer_load_dwordx4 v9, s[40:43], s4 offen lds
  s_add_u32 s101, s101, 1
  s_sub_u32 s73, s101, s100
  s_lshl_b32 s73, s73, 3
  s_lshr_b32 s73, 0x373702, s73
  s_and_b32 s73, s73, 255
  s_add_u32 s73, s73, s101
  s_sub_u32 s74, s73, 56
  s_cselect_b32 s73, s73, s74
  s_mul_i32 s74, s73, 131072
  s_lshl_b32 s73, s73, 11
  s_add_u32 s75, s75, 24576
  s_cmp_eq_u32 s75, 147456
  s_cselect_b32 s75, 0, s75
  s_buffer_load_dword s84, s[40:43], s98
  s_add_u32 s98, s98, 131072
  s_waitcnt vmcnt(24)
  s_barrier
  s_sub_u32 s79, s79, 1
  s_cmp_lg_u32 s79, 0
  s_cbranch_scc1 L_w2l_ld1
  s_add_u32 s3, s75, s76
  s_add_u32 m0, s3, 0
  s_nop 0
  buffer_load_dwordx4 v4, s[36:39], s73 offen offset:0 lds
  buffer_load_dwordx4 v4, s[36:39], s73 offen offset:1024 lds
  s_add_u32 m0, s3, 2048
  s_nop 0
  buffer_load_dwordx4 v5, s[36:39], s73 offen offset:0 lds
  buffer_load_dwordx4 v5, s[36:39], s73 offen offset:1024 lds
  s_add_u32 s3, s75, s77
  s_add_u32 m0, s3, 0
  s_add_u32 s4, s74, 0
  buffer_load_dwordx4 v8, s[40:43], s4 offen lds
  s_add_u32 m0, s3, 1024
  s_nop 0
  buffer_load_dwordx4 v9, s[40:43], s4 offen lds
  s_add_u32 s101, s101, 1
  s_sub_u32 s73, s101, s100
  s_lshl_b32 s73, s73, 3
  s_lshr_b32 s73, 0x373702, s73
  s_and_b32 s73, s73, 255
  s_add_u32 s73, s73, s101
  s_sub_u32 s74, s73, 56
  s_cselect_b32 s73, s73, s74
  s_mul_i32 s74, s73, 131072
  s_lshl_b32 s73, s73, 11
  s_add_u32 s75, s75, 24576
  s_cmp_eq_u32 s75, 147456
  s_cselect_b32 s75, 0, s75
  s_buffer_load_dword s84, s[40:43], s98
  s_add_u32 s98, s98, 131072
  s_add_u32 s48, s34, 4194304
  s_addc_u32 s49, s35, 0
  s_and_b32 s49, s49, 0xffff
  s_mov_b32 s50, 4194304
  s_mov_b32 s51, 0x00020000
  s_lshr_b32 s10, s76, 11
  s_lshl_b32 s3, s68, 3
  s_add_u32 s10, s10, s3
  s_mul_i32 s10, s10, 32768
  v_lshl_add_u32 v4, v1, 4, s10
  v_add_u32 v5, 32768, v4
  s_lshl_b32 s4, s69, 11
  s_add_u32 m0, s76, 147456
  s_nop 0
  buffer_load_dwordx4 v4, s[48:51], s4 offen offset:0 lds
  buffer_load_dwordx4 v4, s[48:51], s4 offen offset:1024 lds
  s_add_u32 m0, s76, 149504
  s_nop 0
  buffer_load_dwordx4 v5, s[48:51], s4 offen offset:0 lds
  buffer_load_dwordx4 v5, s[48:51], s4 offen offset:1024 lds
  s_waitcnt vmcnt(28)
  s_barrier
  s_waitcnt vmcnt(22)
  s_barrier
  s_waitcnt vmcnt(16)
  s_barrier
  s_waitcnt vmcnt(10)
  s_barrier
  s_waitcnt vmcnt(4)
  s_barrier
  s_waitcnt vmcnt(0)
  s_barrier
  s_cmp_eq_u32 s96, 1
  s_cbranch_scc1 L_w2_end
  s_lshl_b32 s87, s97, 12
  s_lshl_b32 s4, s68, 8
  s_add_u32 s87, s87, s4
  s_lshl_b32 s4, s69, 2
  s_add_u32 s87, s87, s4
  s_mov_b32 s96, 1
  s_add_u32 s12, s22, 33554432
  s_addc_u32 s13, s23, 0
  s_add_u32 s34, s22, 67108864
  s_addc_u32 s35, s23, 0
  s_add_u32 s97, s97, 1
  s_branch L_attn_body
L_w2_end:
  s_endpgm
L_w2_compute:
  v_and_b32 v3, 15, v1
  v_lshrrev_b32 v2, 4, v1
  s_lshl_b32 s8, s68, 7
  s_lshl_b32 s9, s70, 5
  s_add_u32 s8, s8, s9
  v_add_u32 v13, s8, v3
  s_lshl_b32 s10, s69, 7
  v_lshl_add_u32 v14, v2, 3, s10
  v_and_b32 v16, 1, v2
  v_lshrrev_b32 v17, 1, v2
  v_lshlrev_b32 v16, 5, v16
  v_lshl_add_u32 v16, v17, 4, v16
  v_add_u32 v16, s10, v16
  s_cmp_eq_u32 s96, 0
  s_cselect_b32 s7, 128, 0
  s_add_u32 s7, s7, 2048
  v_mad_u32_u24 v12, v13, s7, v16
  v_lshl_add_u32 v18, v17, 4, v13
  v_lshlrev_b32 v18, 3, v18
  v_and_b32 v16, 1, v2
  v_lshl_add_u32 v18, v16, 2, v18
  s_lshl_b32 s10, s69, 14
  v_add_u32 v18, s10, v18
  s_lshl_b32 s8, s70, 12
  v_lshl_add_u32 v5, v1, 4, s8
  v_bfe_u32 v6, v1, 2, 2
  v_lshl_add_u32 v6, v2, 3, v6
  v_lshlrev_b32 v6, 7, v6
  v_and_b32 v17, 3, v1
  v_lshl_add_u32 v6, v17, 3, v6
  v_bfe_u32 v17, v1, 3, 2
  v_lshl_add_u32 v6, v17, 5, v6
  v_add_u32 v6, 16384, v6
  v_xor_b32 v7, 32, v6
  v_xor_b32 v8, 64, v6
  v_xor_b32 v9, 96, v6
  v_lshrrev_b32 v15, 1, v2
  v_lshlrev_b32 v15, 8, v15
  v_lshl_add_u32 v15, v3, 4, v15
  v_lshl_add_u32 v15, v16, 3, v15
  s_add_u32 s8, s8, 147456
  v_add_u32 v15, s8, v15
  s_mov_b32 s11, 0xffff0000
  s_mov_b32 s75, 0
  s_waitcnt lgkmcnt(0)
  s_mov_b32 s52, s30
  s_and_b32 s53, s31, 0xffff
  s_mov_b32 s54, 2048
  s_mov_b32 s55, 0x00020000
  buffer_load_dwordx2 v[176:177], v14, s[52:55], 0 offen offset:0
  buffer_load_dwordx2 v[178:179], v14, s[52:55], 0 offen offset:32
  buffer_load_dwordx2 v[180:181], v14, s[52:55], 0 offen offset:64
  buffer_load_dwordx2 v[182:183], v14, s[52:55], 0 offen offset:96
  s_mov_b32 s44, s32
  s_and_b32 s45, s33, 0xffff
  s_mov_b32 s46, 4194304
  s_mov_b32 s47, 0x00020000
  s_add_u32 s48, s22, 33554432
  s_addc_u32 s49, s23, 0
  s_and_b32 s49, s49, 0xffff
  s_mov_b32 s50, 4194304
  s_mov_b32 s51, 0x00020000
  s_cmp_eq_u32 s96, 0
  s_cselect_b64 s[44:45], s[48:49], s[44:45]
  s_lshl_b32 s46, s7, 11
  s_add_u32 s56, s34, 24379392
  s_addc_u32 s57, s35, 0
  s_and_b32 s57, s57, 0xffff
  s_mov_b32 s58, 262144
  s_mov_b32 s59, 0x00020000
  s_barrier
  s_waitcnt vmcnt(0)
  v_lshlrev_b32 v128, 16, v176
  v_and_b32 v129, s11, v176
  v_lshlrev_b32 v130, 16, v177
  v_and_b32 v131, s11, v177
  v_lshlrev_b32 v132, 16, v176
  v_and_b32 v133, s11, v176
  v_lshlrev_b32 v134, 16, v177
  v_and_b32 v135, s11, v177
  v_lshlrev_b32 v136, 16, v178
  v_and_b32 v137, s11, v178
  v_lshlrev_b32 v138, 16, v179
  v_and_b32 v139, s11, v179
  v_lshlrev_b32 v140, 16, v178
  v_and_b32 v141, s11, v178
  v_lshlrev_b32 v142, 16, v179
  v_and_b32 v143, s11, v179
  v_lshlrev_b32 v144, 16, v180
  v_and_b32 v145, s11, v180
  v_lshlrev_b32 v146, 16, v181
  v_and_b32 v147, s11, v181
  v_lshlrev_b32 v148, 16, v180
  v_and_b32 v149, s11, v180
  v_lshlrev_b32 v150, 16, v181
  v_and_b32 v151, s11, v181
  v_lshlrev_b32 v152, 16, v182
  v_and_b32 v153, s11, v182
  v_lshlrev_b32 v154, 16, v183
  v_and_b32 v155, s11, v183
  v_lshlrev_b32 v156, 16, v182
  v_and_b32 v157, s11, v182
  v_lshlrev_b32 v158, 16, v183
  v_and_b32 v159, s11, v183
  v_add_u32_e64 v25, s75, v5
  v_add_u32_e64 v26, s75, v6
  v_add_u32_e64 v27, s75, v7
  v_add_u32_e64 v28, s75, v8
  v_add_u32_e64 v29, s75, v9
  s_add_u32 s75, s75, 24576
  s_cmp_eq_u32 s75, 147456
  s_cselect_b32 s75, 0, s75
  s_barrier
  ds_read_b128 v[32:35], v25 offset:0
  ds_read_b128 v[36:39], v25 offset:2048
  ds_read_b64_tr_b16 v[48:49], v26 offset:0
  ds_read_b64_tr_b16 v[50:51], v26 offset:512
  ds_read_b64_tr_b16 v[52:53], v27 offset:0
  ds_read_b64_tr_b16 v[54:55], v27 offset:512
  ds_read_b64_tr_b16 v[56:57], v28 offset:0
  ds_read_b64_tr_b16 v[58:59], v28 offset:512
  ds_read_b64_tr_b16 v[60:61], v29 offset:0
  ds_read_b64_tr_b16 v[62:63], v29 offset:512
  ds_read_b128 v[40:43], v25 offset:1024
  ds_read_b128 v[44:47], v25 offset:3072
  ds_read_b64_tr_b16 v[64:65], v26 offset:4096
  ds_read_b64_tr_b16 v[66:67], v26 offset:4608
  ds_read_b64_tr_b16 v[68:69], v27 offset:4096
  ds_read_b64_tr_b16 v[70:71], v27 offset:4608
  ds_read_b64_tr_b16 v[72:73], v28 offset:4096
  ds_read_b64_tr_b16 v[74:75], v28 offset:4608
  ds_read_b64_tr_b16 v[76:77], v29 offset:4096
  ds_read_b64_tr_b16 v[78:79], v29 offset:4608
  s_mov_b32 s79, 28
  v_add_u32_e64 v25, s75, v5
  v_add_u32_e64 v26, s75, v6
  v_add_u32_e64 v27, s75, v7
  v_add_u32_e64 v28, s75, v8
  v_add_u32_e64 v29, s75, v9
  s_add_u32 s75, s75, 24576
  s_cmp_eq_u32 s75, 147456
  s_cselect_b32 s75, 0, s75
  s_waitcnt lgkmcnt(0)
.p2align 3
L_w2_loop:
  s_barrier
  s_sub_u32 s79, s79, 1
  v_mfma_f32_16x16x32_bf16 v[128:131], v[48:51], v[32:35], v[128:131]
  ds_read_b128 v[80:83], v25 offset:0
  ds_read_b128 v[84:87], v25 offset:2048
  v_mfma_f32_16x16x32_bf16 v[132:135], v[48:51], v[36:39], v[132:135]
  ds_read_b64_tr_b16 v[96:97], v26 offset:0
  ds_read_b64_tr_b16 v[98:99], v26 offset:512
  v_mfma_f32_16x16x32_bf16 v[136:139], v[52:55], v[32:35], v[136:139]
  ds_read_b64_tr_b16 v[100:101], v27 offset:0
  ds_read_b64_tr_b16 v[102:103], v27 offset:512
  v_mfma_f32_16x16x32_bf16 v[140:143], v[52:55], v[36:39], v[140:143]
  ds_read_b64_tr_b16 v[104:105], v28 offset:0
  ds_read_b64_tr_b16 v[106:107], v28 offset:512
  v_mfma_f32_16x16x32_bf16 v[144:147], v[56:59], v[32:35], v[144:147]
  ds_read_b64_tr_b16 v[108:109], v29 offset:0
  ds_read_b64_tr_b16 v[110:111], v29 offset:512
  v_mfma_f32_16x16x32_bf16 v[148:151], v[56:59], v[36:39], v[148:151]
  ds_read_b128 v[88:91], v25 offset:1024
  ds_read_b128 v[92:95], v25 offset:3072
  v_mfma_f32_16x16x32_bf16 v[152:155], v[60:63], v[32:35], v[152:155]
  ds_read_b64_tr_b16 v[112:113], v26 offset:4096
  ds_read_b64_tr_b16 v[114:115], v26 offset:4608
  v_mfma_f32_16x16x32_bf16 v[156:159], v[60:63], v[36:39], v[156:159]
  ds_read_b64_tr_b16 v[116:117], v27 offset:4096
  ds_read_b64_tr_b16 v[118:119], v27 offset:4608
  v_mfma_f32_16x16x32_bf16 v[128:131], v[64:67], v[40:43], v[128:131]
  ds_read_b64_tr_b16 v[120:121], v28 offset:4096
  ds_read_b64_tr_b16 v[122:123], v28 offset:4608
  v_mfma_f32_16x16x32_bf16 v[132:135], v[64:67], v[44:47], v[132:135]
  ds_read_b64_tr_b16 v[124:125], v29 offset:4096
  ds_read_b64_tr_b16 v[126:127], v29 offset:4608
  v_mfma_f32_16x16x32_bf16 v[136:139], v[68:71], v[40:43], v[136:139]
  v_add_u32_e64 v25, s75, v5
  v_add_u32_e64 v26, s75, v6
  v_mfma_f32_16x16x32_bf16 v[140:143], v[68:71], v[44:47], v[140:143]
  v_add_u32_e64 v27, s75, v7
  v_add_u32_e64 v28, s75, v8
  v_mfma_f32_16x16x32_bf16 v[144:147], v[72:75], v[40:43], v[144:147]
  v_add_u32_e64 v29, s75, v9
  s_add_u32 s75, s75, 24576
  v_mfma_f32_16x16x32_bf16 v[148:151], v[72:75], v[44:47], v[148:151]
  s_cmp_eq_u32 s75, 147456
  s_cselect_b32 s75, 0, s75
  s_nop 0
  v_mfma_f32_16x16x32_bf16 v[152:155], v[76:79], v[40:43], v[152:155]
  v_mfma_f32_16x16x32_bf16 v[156:159], v[76:79], v[44:47], v[156:159]
  s_waitcnt lgkmcnt(0)
  s_barrier
  v_mfma_f32_16x16x32_bf16 v[128:131], v[96:99], v[80:83], v[128:131]
  ds_read_b128 v[32:35], v25 offset:0
  ds_read_b128 v[36:39], v25 offset:2048
  v_mfma_f32_16x16x32_bf16 v[132:135], v[96:99], v[84:87], v[132:135]
  ds_read_b64_tr_b16 v[48:49], v26 offset:0
  ds_read_b64_tr_b16 v[50:51], v26 offset:512
  v_mfma_f32_16x16x32_bf16 v[136:139], v[100:103], v[80:83], v[136:139]
  ds_read_b64_tr_b16 v[52:53], v27 offset:0
  ds_read_b64_tr_b16 v[54:55], v27 offset:512
  v_mfma_f32_16x16x32_bf16 v[140:143], v[100:103], v[84:87], v[140:143]
  ds_read_b64_tr_b16 v[56:57], v28 offset:0
  ds_read_b64_tr_b16 v[58:59], v28 offset:512
  v_mfma_f32_16x16x32_bf16 v[144:147], v[104:107], v[80:83], v[144:147]
  ds_read_b64_tr_b16 v[60:61], v29 offset:0
  ds_read_b64_tr_b16 v[62:63], v29 offset:512
  v_mfma_f32_16x16x32_bf16 v[148:151], v[104:107], v[84:87], v[148:151]
  ds_read_b128 v[40:43], v25 offset:1024
  ds_read_b128 v[44:47], v25 offset:3072
  v_mfma_f32_16x16x32_bf16 v[152:155], v[108:111], v[80:83], v[152:155]
  ds_read_b64_tr_b16 v[64:65], v26 offset:4096
  ds_read_b64_tr_b16 v[66:67], v26 offset:4608
  v_mfma_f32_16x16x32_bf16 v[156:159], v[108:111], v[84:87], v[156:159]
  ds_read_b64_tr_b16 v[68:69], v27 offset:4096
  ds_read_b64_tr_b16 v[70:71], v27 offset:4608
  v_mfma_f32_16x16x32_bf16 v[128:131], v[112:115], v[88:91], v[128:131]
  ds_read_b64_tr_b16 v[72:73], v28 offset:4096
  ds_read_b64_tr_b16 v[74:75], v28 offset:4608
  v_mfma_f32_16x16x32_bf16 v[132:135], v[112:115], v[92:95], v[132:135]
  ds_read_b64_tr_b16 v[76:77], v29 offset:4096
  ds_read_b64_tr_b16 v[78:79], v29 offset:4608
  v_mfma_f32_16x16x32_bf16 v[136:139], v[116:119], v[88:91], v[136:139]
  v_add_u32_e64 v25, s75, v5
  v_add_u32_e64 v26, s75, v6
  v_mfma_f32_16x16x32_bf16 v[140:143], v[116:119], v[92:95], v[140:143]
  v_add_u32_e64 v27, s75, v7
  v_add_u32_e64 v28, s75, v8
  v_mfma_f32_16x16x32_bf16 v[144:147], v[120:123], v[88:91], v[144:147]
  v_add_u32_e64 v29, s75, v9
  s_add_u32 s75, s75, 24576
  v_mfma_f32_16x16x32_bf16 v[148:151], v[120:123], v[92:95], v[148:151]
  s_cmp_eq_u32 s75, 147456
  s_cselect_b32 s75, 0, s75
  s_cmp_lg_u32 s79, 0
  v_mfma_f32_16x16x32_bf16 v[152:155], v[124:127], v[88:91], v[152:155]
  v_mfma_f32_16x16x32_bf16 v[156:159], v[124:127], v[92:95], v[156:159]
  s_waitcnt lgkmcnt(0)
  s_cbranch_scc1 L_w2_loop
  ds_read_b64 v[160:161], v15 offset:0
  ds_read_b64 v[164:165], v15 offset:512
  ds_read_b64 v[168:169], v15 offset:1024
  ds_read_b64 v[172:173], v15 offset:1536
  ds_read_b64 v[162:163], v15 offset:2048
  ds_read_b64 v[166:167], v15 offset:2560
  ds_read_b64 v[170:171], v15 offset:3072
  ds_read_b64 v[174:175], v15 offset:3584
  v_mov_b32 v20, 0
  v_mov_b32 v21, 0
  v_mov_b32 v22, 0
  v_mov_b32 v23, 0
  s_lshl_b32 s3, s7, 4
  s_mov_b32 s10, 0x3f803f80
  s_waitcnt lgkmcnt(7)
  v_lshlrev_b32 v184, 16, v160
  v_and_b32 v185, s11, v160
  v_lshlrev_b32 v186, 16, v161
  v_and_b32 v187, s11, v161
  v_pk_add_f32 v[128:129], v[128:129], v[184:185]
  v_pk_add_f32 v[130:131], v[130:131], v[186:187]
  v_cvt_pk_bf16_f32 v32, v128, v129
  v_cvt_pk_bf16_f32 v33, v130, v131
  s_waitcnt lgkmcnt(6)
  v_lshlrev_b32 v184, 16, v164
  v_and_b32 v185, s11, v164
  v_lshlrev_b32 v186, 16, v165
  v_and_b32 v187, s11, v165
  v_pk_add_f32 v[136:137], v[136:137], v[184:185]
  v_pk_add_f32 v[138:139], v[138:139], v[186:187]
  v_cvt_pk_bf16_f32 v34, v136, v137
  v_cvt_pk_bf16_f32 v35, v138, v139
  s_nop 1
  v_permlane16_swap_b32 v32, v34
  v_permlane16_swap_b32 v33, v35
  buffer_store_dwordx4 v[32:35], v12, s[44:47], 0 offen offset:0 sc1
  s_waitcnt lgkmcnt(5)
  v_lshlrev_b32 v184, 16, v168
  v_and_b32 v185, s11, v168
  v_lshlrev_b32 v186, 16, v169
  v_and_b32 v187, s11, v169
  v_pk_add_f32 v[144:145], v[144:145], v[184:185]
  v_pk_add_f32 v[146:147], v[146:147], v[186:187]
  v_cvt_pk_bf16_f32 v36, v144, v145
  v_cvt_pk_bf16_f32 v37, v146, v147
  s_waitcnt lgkmcnt(4)
  v_lshlrev_b32 v184, 16, v172
  v_and_b32 v185, s11, v172
  v_lshlrev_b32 v186, 16, v173
  v_and_b32 v187, s11, v173
  v_pk_add_f32 v[152:153], v[152:153], v[184:185]
  v_pk_add_f32 v[154:155], v[154:155], v[186:187]
  v_cvt_pk_bf16_f32 v38, v152, v153
  v_cvt_pk_bf16_f32 v39, v154, v155
  s_nop 1
  v_permlane16_swap_b32 v36, v38
  v_permlane16_swap_b32 v37, v39
  buffer_store_dwordx4 v[36:39], v12, s[44:47], 0 offen offset:64 sc1
  s_waitcnt lgkmcnt(3)
  v_lshlrev_b32 v184, 16, v162
  v_and_b32 v185, s11, v162
  v_lshlrev_b32 v186, 16, v163
  v_and_b32 v187, s11, v163
  v_pk_add_f32 v[132:133], v[132:133], v[184:185]
  v_pk_add_f32 v[134:135], v[134:135], v[186:187]
  v_cvt_pk_bf16_f32 v40, v132, v133
  v_cvt_pk_bf16_f32 v41, v134, v135
  s_waitcnt lgkmcnt(2)
  v_lshlrev_b32 v184, 16, v166
  v_and_b32 v185, s11, v166
  v_lshlrev_b32 v186, 16, v167
  v_and_b32 v187, s11, v167
  v_pk_add_f32 v[140:141], v[140:141], v[184:185]
  v_pk_add_f32 v[142:143], v[142:143], v[186:187]
  v_cvt_pk_bf16_f32 v42, v140, v141
  v_cvt_pk_bf16_f32 v43, v142, v143
  s_nop 1
  v_permlane16_swap_b32 v40, v42
  v_permlane16_swap_b32 v41, v43
  buffer_store_dwordx4 v[40:43], v12, s[44:47], s3 offen offset:0 sc1
  s_waitcnt lgkmcnt(1)
  v_lshlrev_b32 v184, 16, v170
  v_and_b32 v185, s11, v170
  v_lshlrev_b32 v186, 16, v171
  v_and_b32 v187, s11, v171
  v_pk_add_f32 v[148:149], v[148:149], v[184:185]
  v_pk_add_f32 v[150:151], v[150:151], v[186:187]
  v_cvt_pk_bf16_f32 v44, v148, v149
  v_cvt_pk_bf16_f32 v45, v150, v151
  s_waitcnt lgkmcnt(0)
  v_lshlrev_b32 v184, 16, v174
  v_and_b32 v185, s11, v174
  v_lshlrev_b32 v186, 16, v175
  v_and_b32 v187, s11, v175
  v_pk_add_f32 v[156:157], v[156:157], v[184:185]
  v_pk_add_f32 v[158:159], v[158:159], v[186:187]
  v_cvt_pk_bf16_f32 v46, v156, v157
  v_cvt_pk_bf16_f32 v47, v158, v159
  s_nop 1
  v_permlane16_swap_b32 v44, v46
  v_permlane16_swap_b32 v45, v47
  buffer_store_dwordx4 v[44:47], v12, s[44:47], s3 offen offset:64 sc1
  v_dot2_f32_bf16 v20, v32, s10, v20
  v_dot2_f32_bf16 v22, v32, v32, v22
  v_dot2_f32_bf16 v20, v33, s10, v20
  v_dot2_f32_bf16 v22, v33, v33, v22
  v_dot2_f32_bf16 v20, v34, s10, v20
  v_dot2_f32_bf16 v22, v34, v34, v22
  v_dot2_f32_bf16 v20, v35, s10, v20
  v_dot2_f32_bf16 v22, v35, v35, v22
  v_dot2_f32_bf16 v20, v36, s10, v20
  v_dot2_f32_bf16 v22, v36, v36, v22
  v_dot2_f32_bf16 v20, v37, s10, v20
  v_dot2_f32_bf16 v22, v37, v37, v22
  v_dot2_f32_bf16 v20, v38, s10, v20
  v_dot2_f32_bf16 v22, v38, v38, v22
  v_dot2_f32_bf16 v20, v39, s10, v20
  v_dot2_f32_bf16 v22, v39, v39, v22
  v_dot2_f32_bf16 v21, v40, s10, v21
  v_dot2_f32_bf16 v23, v40, v40, v23
  v_dot2_f32_bf16 v21, v41, s10, v21
  v_dot2_f32_bf16 v23, v41, v41, v23
  v_dot2_f32_bf16 v21, v42, s10, v21
  v_dot2_f32_bf16 v23, v42, v42, v23
  v_dot2_f32_bf16 v21, v43, s10, v21
  v_dot2_f32_bf16 v23, v43, v43, v23
  v_dot2_f32_bf16 v21, v44, s10, v21
  v_dot2_f32_bf16 v23, v44, v44, v23
  v_dot2_f32_bf16 v21, v45, s10, v21
  v_dot2_f32_bf16 v23, v45, v45, v23
  v_dot2_f32_bf16 v21, v46, s10, v21
  v_dot2_f32_bf16 v23, v46, v46, v23
  v_dot2_f32_bf16 v21, v47, s10, v21
  v_dot2_f32_bf16 v23, v47, v47, v23
  s_nop 2
  v_permlane32_swap_b32 v20, v21
  v_permlane32_swap_b32 v22, v23
  v_add_f32 v20, v20, v21
  v_add_f32 v22, v22, v23
  s_nop 1
  v_permlane16_swap_b32 v20, v22
  v_add_f32 v20, v20, v22
  buffer_store_dword v20, v18, s[56:59], 0 offen sc1
  s_cmp_eq_u32 s96, 1
  s_cbranch_scc1 L_w2_end
  s_waitcnt vmcnt(0)
  s_barrier
  s_mov_b32 s96, 1
  s_add_u32 s12, s22, 33554432
  s_addc_u32 s13, s23, 0
  s_add_u32 s34, s22, 67108864
  s_addc_u32 s35, s23, 0
  s_add_u32 s97, s97, 1
  s_branch L_attn_body
L_w2_c1:
```

```asm
; @launch grid=(256,1,1) block=(512,1,1) lds=163840
.amdgcn_target "amdgcn-amd-amdhsa--gfx950"
L_attn_c0:
.text
.globl interleave_layers__sliding_local_dilated__dense_activation_gelu__prompt_kernel
.p2align 8
.type interleave_layers__sliding_local_dilated__dense_activation_gelu__prompt_kernel,@function
interleave_layers__sliding_local_dilated__dense_activation_gelu__prompt_kernel:
  s_load_dwordx4 s[16:19], s[0:1], 0
  s_load_dwordx2 s[20:21], s[0:1], 16
  s_load_dwordx2 s[22:23], s[0:1], 80
  s_load_dwordx8 s[24:31], s[0:1], 32
  s_load_dwordx2 s[32:33], s[0:1], 64
  s_load_dwordx2 s[34:35], s[0:1], 80
  s_load_dwordx2 s[12:13], s[0:1], 0
  s_mov_b32 s96, 0
  s_mov_b32 s97, 0
L_attn_body:
  s_cmp_ge_u32 s2, 256
  s_cbranch_scc1 L_attn_end
  v_lshrrev_b32 v2, 6, v0
  v_and_b32 v1, 63, v0
  v_readfirstlane_b32 s70, v2
  s_and_b32 s3, s2, 7
  s_lshr_b32 s99, s2, 3
  s_and_b32 s5, s3, 1
  s_lshl_b32 s5, s5, 3
  s_and_b32 s6, s99, 7
  s_add_u32 s68, s5, s6
  s_lshr_b32 s5, s3, 1
  s_lshl_b32 s5, s5, 2
  s_lshr_b32 s6, s99, 3
  s_add_u32 s69, s5, s6
  s_cmp_lt_u32 s70, 4
  s_cbranch_scc1 L_attn_compute
L_attn_loader:
  s_add_u32 s8, s70, s69
  s_and_b32 s8, s8, 3
  s_add_u32 s9, s70, s68
  s_and_b32 s9, s9, 3
  s_lshl_b32 s76, s8, 12
  s_lshl_b32 s77, s9, 11
  s_add_u32 s77, s77, 16384
  s_lshl_b32 s11, s68, 7
  v_and_b32 v10, 7, v1
  v_lshrrev_b32 v3, 3, v1
  s_lshr_b32 s10, s76, 7
  s_lshl_b32 s3, s68, 7
  s_add_u32 s10, s10, s3
  v_add_u32 v3, s10, v3
  s_cmp_eq_u32 s96, 1
  s_cselect_b32 s5, 128, 0
  s_add_u32 s5, s5, 2048
  s_lshl_b32 s6, s5, 3
  v_mul_u32_u24 v3, s5, v3
  v_lshrrev_b32 v2, 4, v1
  v_xor_b32 v4, v2, v10
  v_lshl_add_u32 v4, v4, 4, v3
  v_add_u32 v3, s6, v3
  v_add_u32 v5, 4, v2
  v_xor_b32 v5, v5, v10
  v_lshl_add_u32 v5, v5, 4, v3
  v_add_u32 v3, s6, v3
  v_xor_b32 v6, v2, v10
  v_lshl_add_u32 v6, v6, 4, v3
  v_add_u32 v3, s6, v3
  v_add_u32 v7, 4, v2
  v_xor_b32 v7, v7, v10
  v_lshl_add_u32 v7, v7, 4, v3
  v_lshrrev_b32 v3, 3, v1
  s_lshl_b32 s10, s9, 4
  v_add_u32 v3, s10, v3
  v_mul_u32_u24 v3, 6144, v3
  v_lshrrev_b32 v2, 3, v1
  v_and_b32 v2, 2, v2
  v_xor_b32 v2, v2, v10
  s_mul_i32 s10, s69, 128
  v_add_u32 v3, s10, v3
  v_lshl_add_u32 v8, v2, 4, v3
  v_xor_b32 v2, 4, v2
  v_add_u32 v3, 49152, v3
  v_lshl_add_u32 v9, v2, 4, v3
  s_and_b32 s10, s70, 3
  s_lshl_b32 s78, s10, 9
  s_add_u32 s78, s78, 40960
  s_lshl_b32 s14, s10, 2
  s_add_u32 s14, s14, s11
  s_sub_u32 s14, s14, 16
  v_lshrrev_b32 v3, 3, v1
  v_add_u32 v3, s14, v3
  v_max_i32 v3, 0, v3
  v_mul_u32_u24 v3, s5, v3
  s_lshl_b32 s14, s10, 1
  v_lshrrev_b32 v2, 4, v1
  v_add_u32 v2, s14, v2
  v_and_b32 v2, 7, v2
  v_xor_b32 v2, v2, v10
  v_lshl_add_u32 v28, v2, 4, v3
  s_cmp_eq_u32 s10, 0
  s_cselect_b32 s14, 0xffffff00, -1
  s_mov_b32 s15, 0
  s_mov_b32 s75, 0
  s_add_u32 s100, s68, s69
  s_mov_b32 s101, -1
  s_add_u32 s101, s101, 1
  s_sub_u32 s73, s101, s100
  s_lshl_b32 s73, s73, 3
  s_lshr_b32 s73, 0xf0f02, s73
  s_and_b32 s73, s73, 255
  s_add_u32 s73, s73, s101
  s_and_b32 s73, s73, 15
  s_mul_i32 s74, s73, 393216
  s_lshl_b32 s73, s73, 7
  s_waitcnt lgkmcnt(0)
  s_mov_b32 s36, s12
  s_and_b32 s37, s13, 0xffff
  s_mov_b32 s38, 4194304
  s_mov_b32 s39, 0x00020000
  s_cmp_eq_u32 s96, 1
  s_cselect_b32 s38, 128, 0
  s_add_u32 s38, s38, 2048
  s_lshl_b32 s38, s38, 11
  s_mov_b32 s40, s18
  s_and_b32 s41, s19, 0xffff
  s_mov_b32 s42, 6291456
  s_mov_b32 s43, 0x00020000
  s_cmp_lg_u32 s96, 0
  s_cbranch_scc1 L_attn_ld1
  s_mov_b32 s48, s28
  s_and_b32 s49, s29, 0xffff
  s_mov_b32 s50, 7340032
  s_mov_b32 s51, 0x00020000
  s_cmp_eq_u32 s96, 0
  s_cselect_b32 s50, s50, 0
  s_and_b32 s3, s70, 3
  s_lshl_b32 s4, s2, 2
  s_add_u32 s3, s3, s4
  s_mul_i32 s98, s3, 3584
  s_add_u32 s98, s98, 0
  s_add_u32 s3, s75, s76
  s_add_u32 m0, s3, 0
  s_nop 0
  buffer_load_dwordx4 v4, s[36:39], s73 offen lds
  s_add_u32 m0, s3, 1024
  s_nop 0
  buffer_load_dwordx4 v5, s[36:39], s73 offen lds
  s_add_u32 m0, s3, 2048
  s_nop 0
  buffer_load_dwordx4 v6, s[36:39], s73 offen lds
  s_add_u32 m0, s3, 3072
  s_nop 0
  buffer_load_dwordx4 v7, s[36:39], s73 offen lds
  s_add_u32 m0, s78, s75
  s_mov_b64 exec, s[14:15]
  buffer_load_dwordx4 v28, s[36:39], s73 offen lds
  s_mov_b64 exec, -1
  s_add_u32 s3, s75, s77
  s_add_u32 m0, s3, 0
  s_add_u32 s4, s74, 0
  buffer_load_dwordx4 v8, s[40:43], s4 offen lds
  s_add_u32 m0, s3, 1024
  s_nop 0
  buffer_load_dwordx4 v9, s[40:43], s4 offen lds
  s_add_u32 m0, s3, 8192
  s_add_u32 s4, s74, 2048
  buffer_load_dwordx4 v8, s[40:43], s4 offen lds
  s_add_u32 m0, s3, 9216
  s_nop 0
  buffer_load_dwordx4 v9, s[40:43], s4 offen lds
  s_add_u32 m0, s3, 16384
  s_add_u32 s4, s74, 4096
  buffer_load_dwordx4 v8, s[40:43], s4 offen lds
  s_add_u32 m0, s3, 17408
  s_nop 0
  buffer_load_dwordx4 v9, s[40:43], s4 offen lds
  s_add_u32 s101, s101, 1
  s_sub_u32 s73, s101, s100
  s_lshl_b32 s73, s73, 3
  s_lshr_b32 s73, 0xf0f02, s73
  s_and_b32 s73, s73, 255
  s_add_u32 s73, s73, s101
  s_and_b32 s73, s73, 15
  s_mul_i32 s74, s73, 393216
  s_lshl_b32 s73, s73, 7
  s_add_u32 s75, s75, 43008
  s_cmp_eq_u32 s75, 129024
  s_cselect_b32 s75, 0, s75
  s_add_u32 s3, s75, s76
  s_add_u32 m0, s3, 0
  s_nop 0
  buffer_load_dwordx4 v4, s[36:39], s73 offen lds
  s_add_u32 m0, s3, 1024
  s_nop 0
  buffer_load_dwordx4 v5, s[36:39], s73 offen lds
  s_add_u32 m0, s3, 2048
  s_nop 0
  buffer_load_dwordx4 v6, s[36:39], s73 offen lds
  s_add_u32 m0, s3, 3072
  s_nop 0
  buffer_load_dwordx4 v7, s[36:39], s73 offen lds
  s_add_u32 m0, s78, s75
  s_mov_b64 exec, s[14:15]
  buffer_load_dwordx4 v28, s[36:39], s73 offen lds
  s_mov_b64 exec, -1
  s_add_u32 s3, s75, s77
  s_add_u32 m0, s3, 0
  s_add_u32 s4, s74, 0
  buffer_load_dwordx4 v8, s[40:43], s4 offen lds
  s_add_u32 m0, s3, 1024
  s_nop 0
  buffer_load_dwordx4 v9, s[40:43], s4 offen lds
  s_add_u32 m0, s3, 8192
  s_add_u32 s4, s74, 2048
  buffer_load_dwordx4 v8, s[40:43], s4 offen lds
  s_add_u32 m0, s3, 9216
  s_nop 0
  buffer_load_dwordx4 v9, s[40:43], s4 offen lds
  s_add_u32 m0, s3, 16384
  s_add_u32 s4, s74, 4096
  buffer_load_dwordx4 v8, s[40:43], s4 offen lds
  s_add_u32 m0, s3, 17408
  s_nop 0
  buffer_load_dwordx4 v9, s[40:43], s4 offen lds
  s_add_u32 s101, s101, 1
  s_sub_u32 s73, s101, s100
  s_lshl_b32 s73, s73, 3
  s_lshr_b32 s73, 0xf0f02, s73
  s_and_b32 s73, s73, 255
  s_add_u32 s73, s73, s101
  s_and_b32 s73, s73, 15
  s_mul_i32 s74, s73, 393216
  s_lshl_b32 s73, s73, 7
  s_add_u32 s75, s75, 43008
  s_cmp_eq_u32 s75, 129024
  s_cselect_b32 s75, 0, s75
  s_and_b32 s3, s70, 3
  s_lshl_b32 s4, s2, 2
  s_add_u32 s3, s3, s4
  s_sub_u32 s4, 384, s40
  s_and_b32 s4, s4, 0x380
  s_mul_i32 s5, s3, 6144
  s_add_u32 s5, s5, s4
  s_buffer_load_dword s84, s[40:43], s5 offset:0
  s_buffer_load_dword s84, s[40:43], s5 offset:64
  s_buffer_load_dword s84, s[40:43], s5 offset:1024
  s_buffer_load_dword s84, s[40:43], s5 offset:1088
  s_buffer_load_dword s84, s[40:43], s5 offset:2048
  s_buffer_load_dword s84, s[40:43], s5 offset:2112
  s_buffer_load_dword s84, s[40:43], s5 offset:3072
  s_buffer_load_dword s84, s[40:43], s5 offset:3136
  s_buffer_load_dword s84, s[40:43], s5 offset:4096
  s_buffer_load_dword s84, s[40:43], s5 offset:4160
  s_buffer_load_dword s84, s[40:43], s5 offset:5120
  s_buffer_load_dword s84, s[40:43], s5 offset:5184
  s_waitcnt vmcnt(11)
  s_barrier
  s_mov_b32 s79, 13
L_attn0_ld1:
  s_add_u32 s3, s75, s76
  s_add_u32 m0, s3, 0
  s_nop 0
  buffer_load_dwordx4 v4, s[36:39], s73 offen lds
  s_add_u32 m0, s3, 1024
  s_nop 0
  buffer_load_dwordx4 v5, s[36:39], s73 offen lds
  s_add_u32 m0, s3, 2048
  s_nop 0
  buffer_load_dwordx4 v6, s[36:39], s73 offen lds
  s_add_u32 m0, s3, 3072
  s_nop 0
  buffer_load_dwordx4 v7, s[36:39], s73 offen lds
  s_add_u32 m0, s78, s75
  s_mov_b64 exec, s[14:15]
  buffer_load_dwordx4 v28, s[36:39], s73 offen lds
  s_mov_b64 exec, -1
  s_add_u32 s3, s75, s77
  s_add_u32 m0, s3, 0
  s_add_u32 s4, s74, 0
  buffer_load_dwordx4 v8, s[40:43], s4 offen lds
  s_add_u32 m0, s3, 1024
  s_nop 0
  buffer_load_dwordx4 v9, s[40:43], s4 offen lds
  s_add_u32 m0, s3, 8192
  s_add_u32 s4, s74, 2048
  buffer_load_dwordx4 v8, s[40:43], s4 offen lds
  s_add_u32 m0, s3, 9216
  s_nop 0
  buffer_load_dwordx4 v9, s[40:43], s4 offen lds
  s_add_u32 m0, s3, 16384
  s_add_u32 s4, s74, 4096
  buffer_load_dwordx4 v8, s[40:43], s4 offen lds
  s_add_u32 m0, s3, 17408
  s_nop 0
  buffer_load_dwordx4 v9, s[40:43], s4 offen lds
  s_add_u32 s101, s101, 1
  s_sub_u32 s73, s101, s100
  s_lshl_b32 s73, s73, 3
  s_lshr_b32 s73, 0xf0f02, s73
  s_and_b32 s73, s73, 255
  s_add_u32 s73, s73, s101
  s_and_b32 s73, s73, 15
  s_mul_i32 s74, s73, 393216
  s_lshl_b32 s73, s73, 7
  s_add_u32 s75, s75, 43008
  s_cmp_eq_u32 s75, 129024
  s_cselect_b32 s75, 0, s75
  s_buffer_load_dword s84, s[48:51], s98 offset:0
  s_buffer_load_dword s84, s[48:51], s98 offset:64
  s_buffer_load_dword s84, s[48:51], s98 offset:128
  s_buffer_load_dword s84, s[48:51], s98 offset:192
  s_add_u32 s98, s98, 256
  s_waitcnt vmcnt(11)
  s_barrier
  s_sub_u32 s79, s79, 1
  s_cmp_lg_u32 s79, 0
  s_cbranch_scc1 L_attn0_ld1
  s_add_u32 s3, s75, s76
  s_add_u32 m0, s3, 0
  s_nop 0
  buffer_load_dwordx4 v4, s[36:39], s73 offen lds
  s_add_u32 m0, s3, 1024
  s_nop 0
  buffer_load_dwordx4 v5, s[36:39], s73 offen lds
  s_add_u32 m0, s3, 2048
  s_nop 0
  buffer_load_dwordx4 v6, s[36:39], s73 offen lds
  s_add_u32 m0, s3, 3072
  s_nop 0
  buffer_load_dwordx4 v7, s[36:39], s73 offen lds
  s_add_u32 m0, s78, s75
  s_mov_b64 exec, s[14:15]
  buffer_load_dwordx4 v28, s[36:39], s73 offen lds
  s_mov_b64 exec, -1
  s_add_u32 s3, s75, s77
  s_add_u32 m0, s3, 0
  s_add_u32 s4, s74, 0
  buffer_load_dwordx4 v8, s[40:43], s4 offen lds
  s_add_u32 m0, s3, 1024
  s_nop 0
  buffer_load_dwordx4 v9, s[40:43], s4 offen lds
  s_add_u32 m0, s3, 8192
  s_add_u32 s4, s74, 2048
  buffer_load_dwordx4 v8, s[40:43], s4 offen lds
  s_add_u32 m0, s3, 9216
  s_nop 0
  buffer_load_dwordx4 v9, s[40:43], s4 offen lds
  s_add_u32 m0, s3, 16384
  s_add_u32 s4, s74, 4096
  buffer_load_dwordx4 v8, s[40:43], s4 offen lds
  s_add_u32 m0, s3, 17408
  s_nop 0
  buffer_load_dwordx4 v9, s[40:43], s4 offen lds
  s_add_u32 s101, s101, 1
  s_sub_u32 s73, s101, s100
  s_lshl_b32 s73, s73, 3
  s_lshr_b32 s73, 0xf0f02, s73
  s_and_b32 s73, s73, 255
  s_add_u32 s73, s73, s101
  s_and_b32 s73, s73, 15
  s_mul_i32 s74, s73, 393216
  s_lshl_b32 s73, s73, 7
  s_add_u32 s75, s75, 43008
  s_cmp_eq_u32 s75, 129024
  s_cselect_b32 s75, 0, s75
  s_buffer_load_dword s84, s[48:51], s98 offset:0
  s_buffer_load_dword s84, s[48:51], s98 offset:64
  s_buffer_load_dword s84, s[48:51], s98 offset:128
  s_buffer_load_dword s84, s[48:51], s98 offset:192
  s_add_u32 s98, s98, 256
  s_mov_b32 s64, s24
  s_and_b32 s65, s25, 0xffff
  s_mov_b32 s66, 7340032
  s_mov_b32 s67, 0x00020000
  s_min_u32 s3, s2, 223
  s_mul_i32 s4, s3, 4682
  s_lshr_b32 s4, s4, 16
  s_mul_i32 s5, s4, 14
  s_sub_u32 s3, s3, s5
  s_lshl_b32 s3, s3, 2
  s_and_b32 s5, s70, 3
  s_add_u32 s3, s3, s5
  s_mul_i32 s5, s4, 458752
  s_lshl_b32 s8, s3, 7
  s_add_u32 s5, s5, s8
  s_lshl_b32 s9, s4, 14
  s_lshl_b32 s8, s3, 8
  s_add_u32 s94, s9, s8
  v_lshrrev_b32 v2, 3, v1
  v_mul_u32_u24 v2, 7168, v2
  v_and_b32 v3, 7, v1
  v_lshl_add_u32 v2, v3, 4, v2
  buffer_load_dwordx4 v[64:67], v2, s[64:67], s5 offen
  s_add_u32 s5, s5, 57344
  buffer_load_dwordx4 v[68:71], v2, s[64:67], s5 offen
  s_add_u32 s5, s5, 57344
  buffer_load_dwordx4 v[72:75], v2, s[64:67], s5 offen
  s_add_u32 s5, s5, 57344
  buffer_load_dwordx4 v[76:79], v2, s[64:67], s5 offen
  s_add_u32 s5, s5, 57344
  buffer_load_dwordx4 v[80:83], v2, s[64:67], s5 offen
  s_add_u32 s5, s5, 57344
  buffer_load_dwordx4 v[84:87], v2, s[64:67], s5 offen
  s_add_u32 s5, s5, 57344
  buffer_load_dwordx4 v[88:91], v2, s[64:67], s5 offen
  s_add_u32 s5, s5, 57344
  buffer_load_dwordx4 v[92:95], v2, s[64:67], s5 offen
  s_mov_b32 s60, s20
  s_and_b32 s61, s21, 0xffff
  s_mov_b32 s62, 2097152
  s_mov_b32 s63, 0x00020000
  s_and_b32 s3, s70, 3
  s_mul_i32 s3, s3, 8
  s_mul_i32 s4, s99, 32
  s_add_u32 s3, s3, s4
  v_lshrrev_b32 v2, 3, v1
  v_add_u32 v2, s3, v2
  v_mul_u32_u24 v2, 2048, v2
  v_and_b32 v3, 7, v1
  v_lshl_add_u32 v2, v3, 7, v2
  s_and_b32 s3, s2, 7
  s_lshr_b32 s3, s3, 2
  s_mul_i32 s3, s3, 1024
  buffer_load_dword v96, v2, s[60:63], s3 offen
  s_waitcnt vmcnt(20)
  s_barrier
  s_waitcnt vmcnt(9)
  s_barrier
  s_barrier
  s_barrier
  s_barrier
  s_branch L_attn_ldend
L_attn_ld1:
  s_add_u32 s56, s22, 24379392
  s_addc_u32 s57, s23, 0
  s_and_b32 s57, s57, 0xffff
  s_mov_b32 s58, 262144
  s_mov_b32 s59, 0x00020000
  s_mov_b32 s88, s73
  s_add_u32 m0, s77, 0
  s_add_u32 s4, s74, 0
  buffer_load_dwordx4 v8, s[40:43], s4 offen lds
  s_add_u32 m0, s77, 1024
  s_nop 0
  buffer_load_dwordx4 v9, s[40:43], s4 offen lds
  s_add_u32 m0, s77, 8192
  s_add_u32 s4, s74, 2048
  buffer_load_dwordx4 v8, s[40:43], s4 offen lds
  s_add_u32 m0, s77, 9216
  s_nop 0
  buffer_load_dwordx4 v9, s[40:43], s4 offen lds
  s_add_u32 m0, s77, 16384
  s_add_u32 s4, s74, 4096
  buffer_load_dwordx4 v8, s[40:43], s4 offen lds
  s_add_u32 m0, s77, 17408
  s_nop 0
  buffer_load_dwordx4 v9, s[40:43], s4 offen lds
  s_add_u32 s101, s101, 1
  s_sub_u32 s73, s101, s100
  s_lshl_b32 s73, s73, 3
  s_lshr_b32 s73, 0xf0f02, s73
  s_and_b32 s73, s73, 255
  s_add_u32 s73, s73, s101
  s_and_b32 s73, s73, 15
  s_mul_i32 s74, s73, 393216
  s_lshl_b32 s73, s73, 7
  s_mov_b32 s89, s73
  s_add_u32 m0, s77, 43008
  s_add_u32 s4, s74, 0
  buffer_load_dwordx4 v8, s[40:43], s4 offen lds
  s_add_u32 m0, s77, 44032
  s_nop 0
  buffer_load_dwordx4 v9, s[40:43], s4 offen lds
  s_add_u32 m0, s77, 51200
  s_add_u32 s4, s74, 2048
  buffer_load_dwordx4 v8, s[40:43], s4 offen lds
  s_add_u32 m0, s77, 52224
  s_nop 0
  buffer_load_dwordx4 v9, s[40:43], s4 offen lds
  s_add_u32 m0, s77, 59392
  s_add_u32 s4, s74, 4096
  buffer_load_dwordx4 v8, s[40:43], s4 offen lds
  s_add_u32 m0, s77, 60416
  s_nop 0
  buffer_load_dwordx4 v9, s[40:43], s4 offen lds
  s_add_u32 s101, s101, 1
  s_sub_u32 s73, s101, s100
  s_lshl_b32 s73, s73, 3
  s_lshr_b32 s73, 0xf0f02, s73
  s_and_b32 s73, s73, 255
  s_add_u32 s73, s73, s101
  s_and_b32 s73, s73, 15
  s_mul_i32 s74, s73, 393216
  s_lshl_b32 s73, s73, 7
  s_mov_b32 s75, 86016
  s_add_u32 s44, s22, 24903680
  s_addc_u32 s45, s23, 0
  s_and_b32 s45, s45, 0xffff
  s_mov_b32 s46, 32768
  s_mov_b32 s47, 0x00020000
  s_lshl_b32 s3, s97, 12
  s_lshl_b32 s4, s68, 8
  s_add_u32 s3, s3, s4
  s_sub_u32 s3, s3, 4096
  v_and_b32 v2, 15, v1
  v_lshlrev_b32 v2, 2, v2
  s_min_u32 s4, s4, 256
  s_sub_u32 s3, s3, s4
  v_lshlrev_b32 v3, 4, v1
  v_and_b32 v3, s4, v3
  v_add_u32 v2, v2, v3
  v_mov_b32 v3, 1
  s_mov_b32 s79, 0x100000
  s_cmp_lg_u32 s70, 4
  s_barrier
  s_cbranch_scc1 L_attn_dep
  s_mov_b64 exec, 1
  buffer_store_dword v3, off, s[44:47], s87 sc1
  s_mov_b64 exec, -1
L_attn_poll:
  buffer_load_dword v3, v2, s[44:47], s3 offen sc1
  s_sub_u32 s79, s79, 1
  s_cbranch_scc1 L_attn_dep
  s_waitcnt vmcnt(0)
  v_cmp_ne_u32 vcc, 1, v3
  s_cbranch_vccnz L_attn_poll
L_attn_dep:
  s_barrier
  s_add_u32 m0, s76, 0
  s_nop 0
  buffer_load_dwordx4 v4, s[36:39], s88 offen lds
  s_add_u32 m0, s76, 1024
  s_nop 0
  buffer_load_dwordx4 v5, s[36:39], s88 offen lds
  s_add_u32 m0, s76, 2048
  s_nop 0
  buffer_load_dwordx4 v6, s[36:39], s88 offen lds
  s_add_u32 m0, s76, 3072
  s_nop 0
  buffer_load_dwordx4 v7, s[36:39], s88 offen lds
  s_add_u32 m0, s78, 0
  s_mov_b64 exec, s[14:15]
  buffer_load_dwordx4 v28, s[36:39], s88 offen lds
  s_mov_b64 exec, -1
  s_add_u32 m0, s76, 43008
  s_nop 0
  buffer_load_dwordx4 v4, s[36:39], s89 offen lds
  s_add_u32 m0, s76, 44032
  s_nop 0
  buffer_load_dwordx4 v5, s[36:39], s89 offen lds
  s_add_u32 m0, s76, 45056
  s_nop 0
  buffer_load_dwordx4 v6, s[36:39], s89 offen lds
  s_add_u32 m0, s76, 46080
  s_nop 0
  buffer_load_dwordx4 v7, s[36:39], s89 offen lds
  s_add_u32 m0, s78, 43008
  s_mov_b64 exec, s[14:15]
  buffer_load_dwordx4 v28, s[36:39], s89 offen lds
  s_mov_b64 exec, -1
  s_waitcnt vmcnt(5)
  s_barrier
  s_mov_b32 s79, 13
L_attn1_ld1:
  s_add_u32 s3, s75, s76
  s_add_u32 m0, s3, 0
  s_nop 0
  buffer_load_dwordx4 v4, s[36:39], s73 offen lds
  s_add_u32 m0, s3, 1024
  s_nop 0
  buffer_load_dwordx4 v5, s[36:39], s73 offen lds
  s_add_u32 m0, s3, 2048
  s_nop 0
  buffer_load_dwordx4 v6, s[36:39], s73 offen lds
  s_add_u32 m0, s3, 3072
  s_nop 0
  buffer_load_dwordx4 v7, s[36:39], s73 offen lds
  s_add_u32 m0, s78, s75
  s_mov_b64 exec, s[14:15]
  buffer_load_dwordx4 v28, s[36:39], s73 offen lds
  s_mov_b64 exec, -1
  s_add_u32 s3, s75, s77
  s_add_u32 m0, s3, 0
  s_add_u32 s4, s74, 0
  buffer_load_dwordx4 v8, s[40:43], s4 offen lds
  s_add_u32 m0, s3, 1024
  s_nop 0
  buffer_load_dwordx4 v9, s[40:43], s4 offen lds
  s_add_u32 m0, s3, 8192
  s_add_u32 s4, s74, 2048
  buffer_load_dwordx4 v8, s[40:43], s4 offen lds
  s_add_u32 m0, s3, 9216
  s_nop 0
  buffer_load_dwordx4 v9, s[40:43], s4 offen lds
  s_add_u32 m0, s3, 16384
  s_add_u32 s4, s74, 4096
  buffer_load_dwordx4 v8, s[40:43], s4 offen lds
  s_add_u32 m0, s3, 17408
  s_nop 0
  buffer_load_dwordx4 v9, s[40:43], s4 offen lds
  s_add_u32 s101, s101, 1
  s_sub_u32 s73, s101, s100
  s_lshl_b32 s73, s73, 3
  s_lshr_b32 s73, 0xf0f02, s73
  s_and_b32 s73, s73, 255
  s_add_u32 s73, s73, s101
  s_and_b32 s73, s73, 15
  s_mul_i32 s74, s73, 393216
  s_lshl_b32 s73, s73, 7
  s_add_u32 s75, s75, 43008
  s_cmp_eq_u32 s75, 129024
  s_cselect_b32 s75, 0, s75
  s_waitcnt vmcnt(11)
  s_barrier
  s_sub_u32 s79, s79, 1
  s_cmp_lg_u32 s79, 0
  s_cbranch_scc1 L_attn1_ld1
  s_add_u32 s3, s75, s76
  s_add_u32 m0, s3, 0
  s_nop 0
  buffer_load_dwordx4 v4, s[36:39], s73 offen lds
  s_add_u32 m0, s3, 1024
  s_nop 0
  buffer_load_dwordx4 v5, s[36:39], s73 offen lds
  s_add_u32 m0, s3, 2048
  s_nop 0
  buffer_load_dwordx4 v6, s[36:39], s73 offen lds
  s_add_u32 m0, s3, 3072
  s_nop 0
  buffer_load_dwordx4 v7, s[36:39], s73 offen lds
  s_add_u32 m0, s78, s75
  s_mov_b64 exec, s[14:15]
  buffer_load_dwordx4 v28, s[36:39], s73 offen lds
  s_mov_b64 exec, -1
  s_add_u32 s3, s75, s77
  s_add_u32 m0, s3, 0
  s_add_u32 s4, s74, 0
  buffer_load_dwordx4 v8, s[40:43], s4 offen lds
  s_add_u32 m0, s3, 1024
  s_nop 0
  buffer_load_dwordx4 v9, s[40:43], s4 offen lds
  s_add_u32 m0, s3, 8192
  s_add_u32 s4, s74, 2048
  buffer_load_dwordx4 v8, s[40:43], s4 offen lds
  s_add_u32 m0, s3, 9216
  s_nop 0
  buffer_load_dwordx4 v9, s[40:43], s4 offen lds
  s_add_u32 m0, s3, 16384
  s_add_u32 s4, s74, 4096
  buffer_load_dwordx4 v8, s[40:43], s4 offen lds
  s_add_u32 m0, s3, 17408
  s_nop 0
  buffer_load_dwordx4 v9, s[40:43], s4 offen lds
  s_add_u32 s101, s101, 1
  s_sub_u32 s73, s101, s100
  s_lshl_b32 s73, s73, 3
  s_lshr_b32 s73, 0xf0f02, s73
  s_and_b32 s73, s73, 255
  s_add_u32 s73, s73, s101
  s_and_b32 s73, s73, 15
  s_mul_i32 s74, s73, 393216
  s_lshl_b32 s73, s73, 7
  s_add_u32 s75, s75, 43008
  s_cmp_eq_u32 s75, 129024
  s_cselect_b32 s75, 0, s75
  s_and_b32 s3, s70, 3
  s_lshl_b32 s4, s68, 7
  s_lshl_b32 s5, s3, 6
  s_add_u32 s5, s5, s4
  v_add_u32 v2, s5, v1
  s_sub_u32 s4, s4, 16
  v_and_b32 v3, 15, v1
  v_add_u32 v3, s4, v3
  v_max_i32 v3, 0, v3
  s_cmp_ge_u32 s3, 2
  s_cselect_b64 vcc, -1, 0
  v_cndmask_b32 v2, v2, v3, vcc
  v_lshlrev_b32 v2, 3, v2
  s_mov_b32 s3, 0
  buffer_load_dwordx2 v[32:33], v2, s[56:59], s3 offen
  s_add_u32 s3, s3, 16384
  buffer_load_dwordx2 v[34:35], v2, s[56:59], s3 offen
  s_add_u32 s3, s3, 16384
  buffer_load_dwordx2 v[36:37], v2, s[56:59], s3 offen
  s_add_u32 s3, s3, 16384
  buffer_load_dwordx2 v[38:39], v2, s[56:59], s3 offen
  s_add_u32 s3, s3, 16384
  buffer_load_dwordx2 v[40:41], v2, s[56:59], s3 offen
  s_add_u32 s3, s3, 16384
  buffer_load_dwordx2 v[42:43], v2, s[56:59], s3 offen
  s_add_u32 s3, s3, 16384
  buffer_load_dwordx2 v[44:45], v2, s[56:59], s3 offen
  s_add_u32 s3, s3, 16384
  buffer_load_dwordx2 v[46:47], v2, s[56:59], s3 offen
  s_add_u32 s3, s3, 16384
  buffer_load_dwordx2 v[48:49], v2, s[56:59], s3 offen
  s_add_u32 s3, s3, 16384
  buffer_load_dwordx2 v[50:51], v2, s[56:59], s3 offen
  s_add_u32 s3, s3, 16384
  buffer_load_dwordx2 v[52:53], v2, s[56:59], s3 offen
  s_add_u32 s3, s3, 16384
  buffer_load_dwordx2 v[54:55], v2, s[56:59], s3 offen
  s_add_u32 s3, s3, 16384
  buffer_load_dwordx2 v[56:57], v2, s[56:59], s3 offen
  s_add_u32 s3, s3, 16384
  buffer_load_dwordx2 v[58:59], v2, s[56:59], s3 offen
  s_add_u32 s3, s3, 16384
  buffer_load_dwordx2 v[60:61], v2, s[56:59], s3 offen
  s_add_u32 s3, s3, 16384
  buffer_load_dwordx2 v[62:63], v2, s[56:59], s3 offen
  s_mov_b32 s60, s20
  s_and_b32 s61, s21, 0xffff
  s_mov_b32 s62, 2097152
  s_mov_b32 s63, 0x00020000
  s_and_b32 s3, s70, 3
  s_mul_i32 s3, s3, 8
  s_mul_i32 s4, s99, 32
  s_add_u32 s3, s3, s4
  v_lshrrev_b32 v2, 3, v1
  v_add_u32 v2, s3, v2
  v_mul_u32_u24 v2, 2048, v2
  v_and_b32 v3, 7, v1
  v_lshl_add_u32 v2, v3, 7, v2
  s_and_b32 s3, s2, 7
  s_lshr_b32 s3, s3, 2
  s_mul_i32 s3, s3, 1024
  buffer_load_dword v96, v2, s[60:63], s3 offen
  s_waitcnt vmcnt(28)
  s_barrier
  s_waitcnt vmcnt(17)
  s_barrier
  s_waitcnt vmcnt(1)
  v_add_f32 v32, v32, v34
  v_add_f32 v33, v33, v35
  v_add_f32 v48, v48, v50
  v_add_f32 v49, v49, v51
  v_add_f32 v32, v32, v36
  v_add_f32 v33, v33, v37
  v_add_f32 v48, v48, v52
  v_add_f32 v49, v49, v53
  v_add_f32 v32, v32, v38
  v_add_f32 v33, v33, v39
  v_add_f32 v48, v48, v54
  v_add_f32 v49, v49, v55
  v_add_f32 v32, v32, v40
  v_add_f32 v33, v33, v41
  v_add_f32 v48, v48, v56
  v_add_f32 v49, v49, v57
  v_add_f32 v32, v32, v42
  v_add_f32 v33, v33, v43
  v_add_f32 v48, v48, v58
  v_add_f32 v49, v49, v59
  v_add_f32 v32, v32, v44
  v_add_f32 v33, v33, v45
  v_add_f32 v48, v48, v60
  v_add_f32 v49, v49, v61
  v_add_f32 v32, v32, v46
  v_add_f32 v33, v33, v47
  v_add_f32 v48, v48, v62
  v_add_f32 v49, v49, v63
  v_add_f32 v32, v32, v48
  v_add_f32 v33, v33, v49
  v_mul_f32 v32, 0x3a800000, v32
  v_mul_f32 v33, 0x3a800000, v33
  v_fma_f32 v33, -v32, v32, v33
  v_max_f32 v33, 0, v33
  v_add_f32 v33, 0x3727c5ac, v33
  v_rsq_f32 v33, v33
  s_nop 0
  s_and_b32 s3, s70, 3
  s_lshl_b32 s5, s3, 6
  s_add_u32 s5, s5, 16
  v_add_u32 v2, s5, v1
  v_and_b32 v3, 15, v1
  s_cmp_ge_u32 s3, 2
  s_cselect_b64 vcc, -1, 0
  v_cndmask_b32 v2, v2, v3, vcc
  v_lshlrev_b32 v2, 2, v2
  v_add_u32 v2, 129024, v2
  ds_write2_b32 v2, v32, v33 offset0:0 offset1:160
  s_waitcnt lgkmcnt(0)
  s_barrier
  s_barrier
L_attn_ldend:
  s_lshl_b32 s87, s97, 12
  s_lshl_b32 s4, s68, 8
  s_add_u32 s87, s87, s4
  s_lshl_b32 s4, s69, 2
  s_add_u32 s87, s87, s4
  s_add_u32 s97, s97, 1
  s_branch L_wo_body
L_attn_end:
  s_endpgm
L_attn_compute:
  s_and_b32 s71, s70, 1
  s_lshr_b32 s72, s70, 1
  v_and_b32 v3, 31, v1
  v_lshlrev_b32 v3, 2, v3
  v_add_u32 v3, 40960, v3
  v_mov_b32 v236, 0x3f803f80
  v_mov_b32 v237, 0x3f803f80
  v_mov_b32 v238, 0x3f803f80
  v_mov_b32 v239, 0x3f803f80
  ds_write_b32 v3, v236
  ds_write_b32 v3, v236 offset:43008
  v_add_u32 v3, 86016, v3
  ds_write_b32 v3, v236
  v_and_b32 v3, 15, v1
  v_lshrrev_b32 v2, 4, v1
  v_lshrrev_b32 v33, 1, v3
  s_lshl_b32 s8, s71, 13
  v_xor_b32 v4, v2, v33
  v_lshlrev_b32 v4, 4, v4
  v_lshl_add_u32 v4, v3, 7, v4
  v_add_u32 v8, 40960, v4
  v_add_u32 v4, s8, v4
  v_add_u32 v5, 4, v2
  v_xor_b32 v5, v5, v33
  v_lshlrev_b32 v5, 4, v5
  v_lshl_add_u32 v5, v3, 7, v5
  v_add_u32 v9, 40960, v5
  v_add_u32 v5, s8, v5
  v_bfe_u32 v34, v1, 2, 2
  v_lshl_add_u32 v34, v2, 3, v34
  v_lshlrev_b32 v34, 7, v34
  v_and_b32 v33, 3, v1
  v_lshl_add_u32 v34, v33, 3, v34
  v_bfe_u32 v33, v1, 3, 2
  v_lshl_add_u32 v34, v33, 5, v34
  v_and_b32 v35, 1, v2
  v_xor_b32 v35, s71, v35
  s_lshl_b32 s8, s70, 5
  v_xor_b32 v34, s8, v34
  v_add_u32 v6, 16384, v34
  v_xor_b32 v7, 32, v6
  s_lshl_b32 s8, s68, 7
  s_lshl_b32 s9, s71, 6
  s_add_u32 s8, s8, s9
  s_add_u32 s10, s8, s69
  s_lshl_b32 s10, s10, 11
  s_lshl_b32 s11, s72, 10
  s_add_u32 s10, s10, s11
  v_lshl_add_u32 v33, v3, 4, s10
  v_lshl_add_u32 v33, v35, 9, v33
  v_lshrrev_b32 v34, 1, v2
  v_lshl_add_u32 v31, v34, 8, v33
  s_mul_i32 s10, s72, 14336
  s_add_u32 s10, s10, 1024
  s_lshl_b32 s11, s71, 10
  s_add_u32 s4, s10, s11
  s_sub_u32 s5, s10, s11
  s_mul_i32 s6, s71, 6144
  v_lshl_add_u32 v16, v1, 4, s4
  v_add_u32 v17, s6, v16
  v_lshl_add_u32 v18, v1, 4, s5
  v_add_u32 v18, s6, v18
  v_lshl_add_u32 v19, v2, 8, s4
  v_lshl_add_u32 v20, v2, 8, s5
  v_lshl_add_u32 v21, v3, 4, s4
  v_lshl_add_u32 v22, v3, 4, s5
  s_lshl_b32 s10, s71, 8
  s_add_u32 s10, s10, 129024
  v_lshl_add_u32 v23, v3, 2, s10
  v_lshl_add_u32 v24, v2, 4, s10
  v_and_b32 v33, 1, v3
  v_cmp_eq_u32 s[48:49], 1, v33
  v_lshl_add_u32 v34, v2, 2, v33
  v_add_u32 v35, 2, v34
  v_cmp_gt_u32 s[50:51], v34, v3
  v_cmp_gt_u32 s[52:53], v35, v3
  v_mov_b32 v36, 0xffff
  v_mov_b32 v37, 0xffff0000
  v_cndmask_b32 v36, v36, v37, s[48:49]
  s_add_u32 s10, s10, 704
  v_lshl_add_u32 v34, v34, 2, s10
  v_lshl_add_u32 v35, v35, 2, s10
  v_subrev_u32 v38, 64, v34
  v_subrev_u32 v39, 64, v35
  v_cndmask_b32 v25, v34, v38, s[50:51]
  v_cndmask_b32 v26, v35, v39, s[52:53]
  v_cndmask_b32 v27, 0, v36, s[50:51]
  v_cndmask_b32 v29, 0, v36, s[52:53]
  v_xor_b32 v28, v27, v36
  v_xor_b32 v30, v29, v36
  s_cmp_eq_u32 s8, 0
  s_cselect_b64 s[54:55], s[50:51], 0
  s_cselect_b64 s[14:15], s[52:53], 0
  v_mov_b32 v120, 0
  v_mov_b32 v121, 0
  v_mov_b32 v122, 0
  v_mov_b32 v123, 0
  v_mov_b32 v124, 0
  v_mov_b32 v125, 0
  v_mov_b32 v126, 0
  v_mov_b32 v127, 0
  v_mov_b32 v128, 0
  v_mov_b32 v129, 0
  v_mov_b32 v130, 0
  v_mov_b32 v131, 0
  v_mov_b32 v132, 0
  v_mov_b32 v133, 0
  v_mov_b32 v134, 0
  v_mov_b32 v135, 0
  v_mov_b32 v136, 0
  v_mov_b32 v137, 0
  v_mov_b32 v138, 0
  v_mov_b32 v139, 0
  v_mov_b32 v140, 0
  v_mov_b32 v141, 0
  v_mov_b32 v142, 0
  v_mov_b32 v143, 0
  v_mov_b32 v144, 0
  v_mov_b32 v145, 0
  v_mov_b32 v146, 0
  v_mov_b32 v147, 0
  v_mov_b32 v148, 0
  v_mov_b32 v149, 0
  v_mov_b32 v150, 0
  v_mov_b32 v151, 0
  v_mov_b32 v152, 0
  v_mov_b32 v153, 0
  v_mov_b32 v154, 0
  v_mov_b32 v155, 0
  v_mov_b32 v156, 0
  v_mov_b32 v157, 0
  v_mov_b32 v158, 0
  v_mov_b32 v159, 0
  v_mov_b32 v160, 0
  v_mov_b32 v161, 0
  v_mov_b32 v162, 0
  v_mov_b32 v163, 0
  v_mov_b32 v164, 0
  v_mov_b32 v165, 0
  v_mov_b32 v166, 0
  v_mov_b32 v167, 0
  v_mov_b32 v168, 0
  v_mov_b32 v169, 0
  v_mov_b32 v170, 0
  v_mov_b32 v171, 0
  v_mov_b32 v172, 0
  v_mov_b32 v173, 0
  v_mov_b32 v174, 0
  v_mov_b32 v175, 0
  v_mov_b32 v176, 0
  v_mov_b32 v177, 0
  v_mov_b32 v178, 0
  v_mov_b32 v179, 0
  v_mov_b32 v180, 0
  v_mov_b32 v181, 0
  v_mov_b32 v182, 0
  v_mov_b32 v183, 0
  v_mov_b32 v184, 0
  v_mov_b32 v185, 0
  v_mov_b32 v186, 0
  v_mov_b32 v187, 0
  v_mov_b32 v188, 0
  v_mov_b32 v189, 0
  v_mov_b32 v190, 0
  v_mov_b32 v191, 0
  v_mov_b32 v192, 0
  v_mov_b32 v193, 0
  v_mov_b32 v194, 0
  v_mov_b32 v195, 0
  v_mov_b32 v196, 0
  v_mov_b32 v197, 0
  v_mov_b32 v198, 0
  v_mov_b32 v199, 0
  v_mov_b32 v200, 0
  v_mov_b32 v201, 0
  v_mov_b32 v202, 0
  v_mov_b32 v203, 0
  v_mov_b32 v204, 0
  v_mov_b32 v205, 0
  v_mov_b32 v206, 0
  v_mov_b32 v207, 0
  v_mov_b32 v208, 0
  v_mov_b32 v209, 0
  v_mov_b32 v210, 0
  v_mov_b32 v211, 0
  v_mov_b32 v212, 0
  v_mov_b32 v213, 0
  v_mov_b32 v214, 0
  v_mov_b32 v215, 0
  v_mov_b32 v216, 0
  v_mov_b32 v217, 0
  v_mov_b32 v218, 0
  v_mov_b32 v219, 0
  v_mov_b32 v220, 0
  v_mov_b32 v221, 0
  v_mov_b32 v222, 0
  v_mov_b32 v223, 0
  v_mov_b32 v224, 0
  v_mov_b32 v225, 0
  v_mov_b32 v226, 0
  v_mov_b32 v227, 0
  v_mov_b32 v228, 0
  v_mov_b32 v229, 0
  v_mov_b32 v230, 0
  v_mov_b32 v231, 0
  v_mov_b32 v232, 0
  v_mov_b32 v233, 0
  v_mov_b32 v234, 0
  v_mov_b32 v235, 0
  v_mov_b32 v240, 0
  v_mov_b32 v241, 0
  v_mov_b32 v242, 0
  v_mov_b32 v243, 0
  v_mov_b32 v244, 0
  v_mov_b32 v245, 0
  v_mov_b32 v246, 0
  v_mov_b32 v247, 0
  v_mov_b32 v248, 0
  v_mov_b32 v249, 0
  v_mov_b32 v250, 0
  v_mov_b32 v251, 0
  v_mov_b32 v252, 0
  v_mov_b32 v253, 0
  v_mov_b32 v254, 0
  v_mov_b32 v255, 0
  s_waitcnt lgkmcnt(0)
  s_mov_b32 s44, s34
  s_and_b32 s45, s35, 0xffff
  s_mov_b32 s46, 4194304
  s_mov_b32 s47, 0x00020000
  s_load_dwordx2 s[64:65], s[0:1], 72
  s_or_b32 s3, s96, s70
  s_cbranch_scc1 L_clr_skip0
  s_add_u32 s60, s22, 24903680
  s_addc_u32 s61, s23, 0
  s_and_b32 s61, s61, 0xffff
  s_mov_b32 s62, 262144
  s_mov_b32 s63, 0x00020000
  s_lshl_b32 s3, s2, 10
  v_lshlrev_b32 v2, 4, v1
  buffer_store_dwordx4 v[128:131], v2, s[60:63], s3 offen sc1
L_clr_skip0:
  s_cmp_lg_u32 s96, 0
  s_cbranch_scc1 L_pfc1_skip
  s_getpc_b64 s[4:5]
L_pfc1:
  s_lshl_b32 s3, s99, 2
  s_add_u32 s3, s3, s70
  s_mul_i32 s3, s3, 256
  s_min_u32 s3, s3, L_w2_c1-L_attn_c0-256
  s_add_i32 s3, s3, L_attn_c0-L_pfc1
  s_ashr_i32 s6, s3, 31
  s_add_u32 s4, s4, s3
  s_addc_u32 s5, s5, s6
  s_load_dword s36, s[4:5], 0
  s_load_dword s37, s[4:5], 64
  s_load_dword s38, s[4:5], 128
  s_load_dword s39, s[4:5], 192
L_pfc1_skip:
  s_mov_b32 s75, 0
  v_add_u32_e64 v10, s75, v4
  v_add_u32_e64 v11, s75, v5
  v_add_u32_e64 v12, s75, v6
  v_add_u32_e64 v13, s75, v7
  v_add_u32_e64 v14, s75, v8
  v_add_u32_e64 v15, s75, v9
  s_add_u32 s75, s75, 43008
  s_cmp_eq_u32 s75, 129024
  s_cselect_b32 s75, 0, s75
  s_mov_b32 s79, 16
  s_cmp_eq_u32 s96, 0
  s_cbranch_scc1 L_attn_nog
  s_barrier
L_attn_nog:
  s_barrier
  ds_read_b128 v[32:35], v10 offset:0
  ds_read_b128 v[36:39], v10 offset:2048
  ds_read_b128 v[40:43], v10 offset:4096
  ds_read_b128 v[44:47], v10 offset:6144
  ds_read_b128 v[48:51], v14
  ds_read_b64_tr_b16 v[52:53], v12 offset:0
  ds_read_b64_tr_b16 v[54:55], v12 offset:512
  ds_read_b64_tr_b16 v[56:57], v13 offset:0
  ds_read_b64_tr_b16 v[58:59], v13 offset:512
  ds_read_b64_tr_b16 v[60:61], v12 offset:8192
  ds_read_b64_tr_b16 v[62:63], v12 offset:8704
  ds_read_b64_tr_b16 v[64:65], v13 offset:8192
  ds_read_b64_tr_b16 v[66:67], v13 offset:8704
  ds_read_b64_tr_b16 v[68:69], v12 offset:16384
  ds_read_b64_tr_b16 v[70:71], v12 offset:16896
  ds_read_b64_tr_b16 v[72:73], v13 offset:16384
  ds_read_b64_tr_b16 v[74:75], v13 offset:16896
  s_waitcnt lgkmcnt(0)
  s_cmp_lg_u32 s96, 0
  s_cbranch_scc1 L_attn_loop
  s_cmp_lg_u32 s72, 0
  s_cbranch_scc1 L_attn_loopb
  s_or_b32 s3, s96, s70
  s_cbranch_scc1 L_clr_skip1
  v_mov_b32 v3, 1
  s_and_b32 s65, s65, 0xffff
  s_mov_b32 s66, 256
  s_mov_b32 s67, 0x00020000
  s_mov_b64 exec, 1
  s_waitcnt vmcnt(0)
  buffer_store_byte v3, off, s[64:67], s2 sc1
  s_mov_b64 exec, -1
L_clr_skip1:
.p2align 3
L_attn_loopa:
  v_mfma_f32_16x16x32_bf16 v[240:243], v[236:239], v[32:35], v[240:243]
  ds_read_b128 v[76:79], v11 offset:0
  v_mfma_f32_16x16x32_bf16 v[244:247], v[32:35], v[32:35], v[244:247]
  ds_read_b128 v[80:83], v11 offset:2048
  v_mfma_f32_16x16x32_bf16 v[248:251], v[236:239], v[36:39], v[248:251]
  ds_read_b128 v[84:87], v11 offset:4096
  v_mfma_f32_16x16x32_bf16 v[252:255], v[36:39], v[36:39], v[252:255]
  ds_read_b128 v[88:91], v11 offset:6144
  v_mfma_f32_16x16x32_bf16 v[120:123], v[236:239], v[48:51], v[120:123]
  ds_read_b128 v[92:95], v15
  v_mfma_f32_16x16x32_bf16 v[124:127], v[48:51], v[48:51], v[124:127]
  ds_read_b64_tr_b16 v[96:97], v12 offset:4096
  v_mfma_f32_16x16x32_bf16 v[128:131], v[52:55], v[32:35], v[128:131]
  ds_read_b64_tr_b16 v[98:99], v12 offset:4608
  v_mfma_f32_16x16x32_bf16 v[132:135], v[52:55], v[36:39], v[132:135]
  ds_read_b64_tr_b16 v[100:101], v13 offset:4096
  v_mfma_f32_16x16x32_bf16 v[136:139], v[52:55], v[40:43], v[136:139]
  ds_read_b64_tr_b16 v[102:103], v13 offset:4608
  v_mfma_f32_16x16x32_bf16 v[140:143], v[52:55], v[44:47], v[140:143]
  ds_read_b64_tr_b16 v[104:105], v12 offset:12288
  v_mfma_f32_16x16x32_bf16 v[224:227], v[52:55], v[48:51], v[224:227]
  ds_read_b64_tr_b16 v[106:107], v12 offset:12800
  v_mfma_f32_16x16x32_bf16 v[144:147], v[56:59], v[32:35], v[144:147]
  ds_read_b64_tr_b16 v[108:109], v13 offset:12288
  v_mfma_f32_16x16x32_bf16 v[148:151], v[56:59], v[36:39], v[148:151]
  ds_read_b64_tr_b16 v[110:111], v13 offset:12800
  v_mfma_f32_16x16x32_bf16 v[152:155], v[56:59], v[40:43], v[152:155]
  ds_read_b64_tr_b16 v[112:113], v12 offset:20480
  v_mfma_f32_16x16x32_bf16 v[156:159], v[56:59], v[44:47], v[156:159]
  ds_read_b64_tr_b16 v[114:115], v12 offset:20992
  v_mfma_f32_16x16x32_bf16 v[160:163], v[60:63], v[32:35], v[160:163]
  ds_read_b64_tr_b16 v[116:117], v13 offset:20480
  v_mfma_f32_16x16x32_bf16 v[164:167], v[60:63], v[36:39], v[164:167]
  ds_read_b64_tr_b16 v[118:119], v13 offset:20992
  v_mfma_f32_16x16x32_bf16 v[168:171], v[60:63], v[40:43], v[168:171]
  v_add_u32_e64 v10, s75, v4
  v_mfma_f32_16x16x32_bf16 v[172:175], v[60:63], v[44:47], v[172:175]
  v_add_u32_e64 v11, s75, v5
  v_mfma_f32_16x16x32_bf16 v[228:231], v[60:63], v[48:51], v[228:231]
  v_add_u32_e64 v12, s75, v6
  v_mfma_f32_16x16x32_bf16 v[176:179], v[64:67], v[32:35], v[176:179]
  v_add_u32_e64 v13, s75, v7
  v_mfma_f32_16x16x32_bf16 v[180:183], v[64:67], v[36:39], v[180:183]
  v_add_u32_e64 v14, s75, v8
  v_mfma_f32_16x16x32_bf16 v[184:187], v[64:67], v[40:43], v[184:187]
  v_add_u32_e64 v15, s75, v9
  v_mfma_f32_16x16x32_bf16 v[188:191], v[64:67], v[44:47], v[188:191]
  s_add_u32 s75, s75, 43008
  v_mfma_f32_16x16x32_bf16 v[192:195], v[32:35], v[68:71], v[192:195]
  s_cmp_eq_u32 s75, 129024
  v_mfma_f32_16x16x32_bf16 v[196:199], v[36:39], v[68:71], v[196:199]
  s_cselect_b32 s75, 0, s75
  s_sub_u32 s79, s79, 1
  v_mfma_f32_16x16x32_bf16 v[200:203], v[40:43], v[68:71], v[200:203]
  v_mfma_f32_16x16x32_bf16 v[204:207], v[44:47], v[68:71], v[204:207]
  v_mfma_f32_16x16x32_bf16 v[232:235], v[48:51], v[68:71], v[232:235]
  v_mfma_f32_16x16x32_bf16 v[208:211], v[32:35], v[72:75], v[208:211]
  v_mfma_f32_16x16x32_bf16 v[212:215], v[36:39], v[72:75], v[212:215]
  v_mfma_f32_16x16x32_bf16 v[216:219], v[40:43], v[72:75], v[216:219]
  v_mfma_f32_16x16x32_bf16 v[220:223], v[44:47], v[72:75], v[220:223]
  s_waitcnt lgkmcnt(0)
  s_barrier
  v_mfma_f32_16x16x32_bf16 v[240:243], v[236:239], v[76:79], v[240:243]
  ds_read_b128 v[32:35], v10 offset:0
  v_mfma_f32_16x16x32_bf16 v[244:247], v[76:79], v[76:79], v[244:247]
  ds_read_b128 v[36:39], v10 offset:2048
  v_mfma_f32_16x16x32_bf16 v[248:251], v[236:239], v[80:83], v[248:251]
  ds_read_b128 v[40:43], v10 offset:4096
  v_mfma_f32_16x16x32_bf16 v[252:255], v[80:83], v[80:83], v[252:255]
  ds_read_b128 v[44:47], v10 offset:6144
  v_mfma_f32_16x16x32_bf16 v[120:123], v[236:239], v[92:95], v[120:123]
  ds_read_b128 v[48:51], v14
  v_mfma_f32_16x16x32_bf16 v[124:127], v[92:95], v[92:95], v[124:127]
  ds_read_b64_tr_b16 v[52:53], v12 offset:0
  v_mfma_f32_16x16x32_bf16 v[128:131], v[96:99], v[76:79], v[128:131]
  ds_read_b64_tr_b16 v[54:55], v12 offset:512
  v_mfma_f32_16x16x32_bf16 v[132:135], v[96:99], v[80:83], v[132:135]
  ds_read_b64_tr_b16 v[56:57], v13 offset:0
  v_mfma_f32_16x16x32_bf16 v[136:139], v[96:99], v[84:87], v[136:139]
  ds_read_b64_tr_b16 v[58:59], v13 offset:512
  v_mfma_f32_16x16x32_bf16 v[140:143], v[96:99], v[88:91], v[140:143]
  ds_read_b64_tr_b16 v[60:61], v12 offset:8192
  v_mfma_f32_16x16x32_bf16 v[224:227], v[96:99], v[92:95], v[224:227]
  ds_read_b64_tr_b16 v[62:63], v12 offset:8704
  v_mfma_f32_16x16x32_bf16 v[144:147], v[100:103], v[76:79], v[144:147]
  ds_read_b64_tr_b16 v[64:65], v13 offset:8192
  v_mfma_f32_16x16x32_bf16 v[148:151], v[100:103], v[80:83], v[148:151]
  ds_read_b64_tr_b16 v[66:67], v13 offset:8704
  v_mfma_f32_16x16x32_bf16 v[152:155], v[100:103], v[84:87], v[152:155]
  ds_read_b64_tr_b16 v[68:69], v12 offset:16384
  v_mfma_f32_16x16x32_bf16 v[156:159], v[100:103], v[88:91], v[156:159]
  ds_read_b64_tr_b16 v[70:71], v12 offset:16896
  v_mfma_f32_16x16x32_bf16 v[160:163], v[104:107], v[76:79], v[160:163]
  ds_read_b64_tr_b16 v[72:73], v13 offset:16384
  v_mfma_f32_16x16x32_bf16 v[164:167], v[104:107], v[80:83], v[164:167]
  ds_read_b64_tr_b16 v[74:75], v13 offset:16896
  v_mfma_f32_16x16x32_bf16 v[168:171], v[104:107], v[84:87], v[168:171]
  s_cmp_lg_u32 s79, 0
  s_nop 0
  v_mfma_f32_16x16x32_bf16 v[172:175], v[104:107], v[88:91], v[172:175]
  v_mfma_f32_16x16x32_bf16 v[228:231], v[104:107], v[92:95], v[228:231]
  v_mfma_f32_16x16x32_bf16 v[176:179], v[108:111], v[76:79], v[176:179]
  v_mfma_f32_16x16x32_bf16 v[180:183], v[108:111], v[80:83], v[180:183]
  v_mfma_f32_16x16x32_bf16 v[184:187], v[108:111], v[84:87], v[184:187]
  v_mfma_f32_16x16x32_bf16 v[188:191], v[108:111], v[88:91], v[188:191]
  v_mfma_f32_16x16x32_bf16 v[192:195], v[76:79], v[112:115], v[192:195]
  v_mfma_f32_16x16x32_bf16 v[196:199], v[80:83], v[112:115], v[196:199]
  v_mfma_f32_16x16x32_bf16 v[200:203], v[84:87], v[112:115], v[200:203]
  v_mfma_f32_16x16x32_bf16 v[204:207], v[88:91], v[112:115], v[204:207]
  v_mfma_f32_16x16x32_bf16 v[232:235], v[92:95], v[112:115], v[232:235]
  v_mfma_f32_16x16x32_bf16 v[208:211], v[76:79], v[116:119], v[208:211]
  v_mfma_f32_16x16x32_bf16 v[212:215], v[80:83], v[116:119], v[212:215]
  v_mfma_f32_16x16x32_bf16 v[216:219], v[84:87], v[116:119], v[216:219]
  v_mfma_f32_16x16x32_bf16 v[220:223], v[88:91], v[116:119], v[220:223]
  s_waitcnt lgkmcnt(0)
  s_cbranch_scc1 L_attn_loopa
  s_branch L_attn_post
.p2align 3
L_attn_loopb:
  v_mfma_f32_16x16x32_bf16 v[240:243], v[236:239], v[40:43], v[240:243]
  ds_read_b128 v[76:79], v11 offset:0
  v_mfma_f32_16x16x32_bf16 v[244:247], v[40:43], v[40:43], v[244:247]
  ds_read_b128 v[80:83], v11 offset:2048
  v_mfma_f32_16x16x32_bf16 v[248:251], v[236:239], v[44:47], v[248:251]
  ds_read_b128 v[84:87], v11 offset:4096
  v_mfma_f32_16x16x32_bf16 v[252:255], v[44:47], v[44:47], v[252:255]
  ds_read_b128 v[88:91], v11 offset:6144
  v_mfma_f32_16x16x32_bf16 v[128:131], v[52:55], v[32:35], v[128:131]
  ds_read_b128 v[92:95], v15
  v_mfma_f32_16x16x32_bf16 v[132:135], v[52:55], v[36:39], v[132:135]
  ds_read_b64_tr_b16 v[96:97], v12 offset:4096
  v_mfma_f32_16x16x32_bf16 v[136:139], v[52:55], v[40:43], v[136:139]
  ds_read_b64_tr_b16 v[98:99], v12 offset:4608
  v_mfma_f32_16x16x32_bf16 v[140:143], v[52:55], v[44:47], v[140:143]
  ds_read_b64_tr_b16 v[100:101], v13 offset:4096
  v_mfma_f32_16x16x32_bf16 v[224:227], v[52:55], v[48:51], v[224:227]
  ds_read_b64_tr_b16 v[102:103], v13 offset:4608
  v_mfma_f32_16x16x32_bf16 v[144:147], v[56:59], v[32:35], v[144:147]
  ds_read_b64_tr_b16 v[104:105], v12 offset:12288
  v_mfma_f32_16x16x32_bf16 v[148:151], v[56:59], v[36:39], v[148:151]
  ds_read_b64_tr_b16 v[106:107], v12 offset:12800
  v_mfma_f32_16x16x32_bf16 v[152:155], v[56:59], v[40:43], v[152:155]
  ds_read_b64_tr_b16 v[108:109], v13 offset:12288
  v_mfma_f32_16x16x32_bf16 v[156:159], v[56:59], v[44:47], v[156:159]
  ds_read_b64_tr_b16 v[110:111], v13 offset:12800
  v_mfma_f32_16x16x32_bf16 v[160:163], v[60:63], v[32:35], v[160:163]
  ds_read_b64_tr_b16 v[112:113], v12 offset:20480
  v_mfma_f32_16x16x32_bf16 v[164:167], v[60:63], v[36:39], v[164:167]
  ds_read_b64_tr_b16 v[114:115], v12 offset:20992
  v_mfma_f32_16x16x32_bf16 v[168:171], v[60:63], v[40:43], v[168:171]
  ds_read_b64_tr_b16 v[116:117], v13 offset:20480
  v_mfma_f32_16x16x32_bf16 v[172:175], v[60:63], v[44:47], v[172:175]
  ds_read_b64_tr_b16 v[118:119], v13 offset:20992
  v_mfma_f32_16x16x32_bf16 v[228:231], v[60:63], v[48:51], v[228:231]
  v_add_u32_e64 v10, s75, v4
  v_mfma_f32_16x16x32_bf16 v[176:179], v[64:67], v[32:35], v[176:179]
  v_add_u32_e64 v11, s75, v5
  v_mfma_f32_16x16x32_bf16 v[180:183], v[64:67], v[36:39], v[180:183]
  v_add_u32_e64 v12, s75, v6
  v_mfma_f32_16x16x32_bf16 v[184:187], v[64:67], v[40:43], v[184:187]
  v_add_u32_e64 v13, s75, v7
  v_mfma_f32_16x16x32_bf16 v[188:191], v[64:67], v[44:47], v[188:191]
  v_add_u32_e64 v14, s75, v8
  v_mfma_f32_16x16x32_bf16 v[192:195], v[32:35], v[68:71], v[192:195]
  v_add_u32_e64 v15, s75, v9
  v_mfma_f32_16x16x32_bf16 v[196:199], v[36:39], v[68:71], v[196:199]
  s_add_u32 s75, s75, 43008
  v_mfma_f32_16x16x32_bf16 v[200:203], v[40:43], v[68:71], v[200:203]
  s_cmp_eq_u32 s75, 129024
  v_mfma_f32_16x16x32_bf16 v[204:207], v[44:47], v[68:71], v[204:207]
  s_cselect_b32 s75, 0, s75
  s_sub_u32 s79, s79, 1
  v_mfma_f32_16x16x32_bf16 v[232:235], v[48:51], v[68:71], v[232:235]
  v_mfma_f32_16x16x32_bf16 v[208:211], v[32:35], v[72:75], v[208:211]
  v_mfma_f32_16x16x32_bf16 v[212:215], v[36:39], v[72:75], v[212:215]
  v_mfma_f32_16x16x32_bf16 v[216:219], v[40:43], v[72:75], v[216:219]
  v_mfma_f32_16x16x32_bf16 v[220:223], v[44:47], v[72:75], v[220:223]
  s_waitcnt lgkmcnt(0)
  s_barrier
  v_mfma_f32_16x16x32_bf16 v[240:243], v[236:239], v[84:87], v[240:243]
  ds_read_b128 v[32:35], v10 offset:0
  v_mfma_f32_16x16x32_bf16 v[244:247], v[84:87], v[84:87], v[244:247]
  ds_read_b128 v[36:39], v10 offset:2048
  v_mfma_f32_16x16x32_bf16 v[248:251], v[236:239], v[88:91], v[248:251]
  ds_read_b128 v[40:43], v10 offset:4096
  v_mfma_f32_16x16x32_bf16 v[252:255], v[88:91], v[88:91], v[252:255]
  ds_read_b128 v[44:47], v10 offset:6144
  v_mfma_f32_16x16x32_bf16 v[128:131], v[96:99], v[76:79], v[128:131]
  ds_read_b128 v[48:51], v14
  v_mfma_f32_16x16x32_bf16 v[132:135], v[96:99], v[80:83], v[132:135]
  ds_read_b64_tr_b16 v[52:53], v12 offset:0
  v_mfma_f32_16x16x32_bf16 v[136:139], v[96:99], v[84:87], v[136:139]
  ds_read_b64_tr_b16 v[54:55], v12 offset:512
  v_mfma_f32_16x16x32_bf16 v[140:143], v[96:99], v[88:91], v[140:143]
  ds_read_b64_tr_b16 v[56:57], v13 offset:0
  v_mfma_f32_16x16x32_bf16 v[224:227], v[96:99], v[92:95], v[224:227]
  ds_read_b64_tr_b16 v[58:59], v13 offset:512
  v_mfma_f32_16x16x32_bf16 v[144:147], v[100:103], v[76:79], v[144:147]
  ds_read_b64_tr_b16 v[60:61], v12 offset:8192
  v_mfma_f32_16x16x32_bf16 v[148:151], v[100:103], v[80:83], v[148:151]
  ds_read_b64_tr_b16 v[62:63], v12 offset:8704
  v_mfma_f32_16x16x32_bf16 v[152:155], v[100:103], v[84:87], v[152:155]
  ds_read_b64_tr_b16 v[64:65], v13 offset:8192
  v_mfma_f32_16x16x32_bf16 v[156:159], v[100:103], v[88:91], v[156:159]
  ds_read_b64_tr_b16 v[66:67], v13 offset:8704
  v_mfma_f32_16x16x32_bf16 v[160:163], v[104:107], v[76:79], v[160:163]
  ds_read_b64_tr_b16 v[68:69], v12 offset:16384
  v_mfma_f32_16x16x32_bf16 v[164:167], v[104:107], v[80:83], v[164:167]
  ds_read_b64_tr_b16 v[70:71], v12 offset:16896
  v_mfma_f32_16x16x32_bf16 v[168:171], v[104:107], v[84:87], v[168:171]
  ds_read_b64_tr_b16 v[72:73], v13 offset:16384
  v_mfma_f32_16x16x32_bf16 v[172:175], v[104:107], v[88:91], v[172:175]
  ds_read_b64_tr_b16 v[74:75], v13 offset:16896
  v_mfma_f32_16x16x32_bf16 v[228:231], v[104:107], v[92:95], v[228:231]
  s_cmp_lg_u32 s79, 0
  s_nop 0
  v_mfma_f32_16x16x32_bf16 v[176:179], v[108:111], v[76:79], v[176:179]
  v_mfma_f32_16x16x32_bf16 v[180:183], v[108:111], v[80:83], v[180:183]
  v_mfma_f32_16x16x32_bf16 v[184:187], v[108:111], v[84:87], v[184:187]
  v_mfma_f32_16x16x32_bf16 v[188:191], v[108:111], v[88:91], v[188:191]
  v_mfma_f32_16x16x32_bf16 v[192:195], v[76:79], v[112:115], v[192:195]
  v_mfma_f32_16x16x32_bf16 v[196:199], v[80:83], v[112:115], v[196:199]
  v_mfma_f32_16x16x32_bf16 v[200:203], v[84:87], v[112:115], v[200:203]
  v_mfma_f32_16x16x32_bf16 v[204:207], v[88:91], v[112:115], v[204:207]
  v_mfma_f32_16x16x32_bf16 v[232:235], v[92:95], v[112:115], v[232:235]
  v_mfma_f32_16x16x32_bf16 v[208:211], v[76:79], v[116:119], v[208:211]
  v_mfma_f32_16x16x32_bf16 v[212:215], v[80:83], v[116:119], v[212:215]
  v_mfma_f32_16x16x32_bf16 v[216:219], v[84:87], v[116:119], v[216:219]
  v_mfma_f32_16x16x32_bf16 v[220:223], v[88:91], v[116:119], v[220:223]
  s_waitcnt lgkmcnt(0)
  s_cbranch_scc1 L_attn_loopb
L_attn_post:
  v_and_b32 v32, 3, v1
  v_cmp_eq_u32 s[4:5], 1, v32
  v_cmp_eq_u32 s[6:7], 2, v32
  v_cmp_eq_u32 s[8:9], 3, v32
  v_bfe_u32 v33, v1, 2, 2
  v_lshrrev_b32 v34, 4, v1
  v_cmp_eq_u32 s[10:11], v33, v34
  s_lshl_b32 s3, s72, 7
  v_add_u32 v35, s3, v23
  v_and_b32 v36, 15, v1
  s_cmp_eq_u32 s70, 0
  s_cselect_b32 s3, 0, 576
  s_add_u32 s3, s3, 129024
  v_lshl_add_u32 v36, v36, 2, s3
  v_cndmask_b32 v241, v244, v245, s[4:5]
  v_cndmask_b32 v249, v252, v253, s[4:5]
  v_cndmask_b32 v121, v124, v125, s[4:5]
  v_cndmask_b32 v241, v241, v246, s[6:7]
  v_cndmask_b32 v249, v249, v254, s[6:7]
  v_cndmask_b32 v121, v121, v126, s[6:7]
  v_cndmask_b32 v241, v241, v247, s[8:9]
  v_cndmask_b32 v249, v249, v255, s[8:9]
  v_cndmask_b32 v121, v121, v127, s[8:9]
  v_mul_f32 v240, 0x3a800000, v240
  v_mul_f32 v241, 0x3a800000, v241
  v_fma_f32 v241, -v240, v240, v241
  v_max_f32 v241, 0, v241
  v_add_f32 v241, 0x3727c5ac, v241
  v_rsq_f32 v241, v241
  s_nop 0
  v_mul_f32 v248, 0x3a800000, v248
  v_mul_f32 v249, 0x3a800000, v249
  v_fma_f32 v249, -v248, v248, v249
  v_max_f32 v249, 0, v249
  v_add_f32 v249, 0x3727c5ac, v249
  v_rsq_f32 v249, v249
  s_nop 0
  v_mul_f32 v120, 0x3a800000, v120
  v_mul_f32 v121, 0x3a800000, v121
  v_fma_f32 v121, -v120, v120, v121
  v_max_f32 v121, 0, v121
  v_add_f32 v121, 0x3727c5ac, v121
  v_rsq_f32 v121, v121
  s_nop 0
  s_mov_b64 exec, s[10:11]
  ds_write2_b32 v35, v240, v241 offset0:16 offset1:176
  ds_write2_b32 v35, v248, v249 offset0:32 offset1:192
  ds_write2_b32 v36, v120, v121 offset0:0 offset1:160
  s_mov_b64 exec, -1
  s_waitcnt lgkmcnt(0)
  s_barrier
  s_branch L_attn_exit
.p2align 3
L_attn_loop:
  v_mfma_f32_16x16x32_bf16 v[128:131], v[52:55], v[32:35], v[128:131]
  ds_read_b128 v[76:79], v11 offset:0
  v_mfma_f32_16x16x32_bf16 v[132:135], v[52:55], v[36:39], v[132:135]
  ds_read_b128 v[80:83], v11 offset:2048
  v_mfma_f32_16x16x32_bf16 v[136:139], v[52:55], v[40:43], v[136:139]
  ds_read_b128 v[84:87], v11 offset:4096
  v_mfma_f32_16x16x32_bf16 v[140:143], v[52:55], v[44:47], v[140:143]
  ds_read_b128 v[88:91], v11 offset:6144
  v_mfma_f32_16x16x32_bf16 v[224:227], v[52:55], v[48:51], v[224:227]
  ds_read_b128 v[92:95], v15
  v_mfma_f32_16x16x32_bf16 v[144:147], v[56:59], v[32:35], v[144:147]
  ds_read_b64_tr_b16 v[96:97], v12 offset:4096
  v_mfma_f32_16x16x32_bf16 v[148:151], v[56:59], v[36:39], v[148:151]
  ds_read_b64_tr_b16 v[98:99], v12 offset:4608
  v_mfma_f32_16x16x32_bf16 v[152:155], v[56:59], v[40:43], v[152:155]
  ds_read_b64_tr_b16 v[100:101], v13 offset:4096
  v_mfma_f32_16x16x32_bf16 v[156:159], v[56:59], v[44:47], v[156:159]
  ds_read_b64_tr_b16 v[102:103], v13 offset:4608
  v_mfma_f32_16x16x32_bf16 v[160:163], v[60:63], v[32:35], v[160:163]
  ds_read_b64_tr_b16 v[104:105], v12 offset:12288
  v_mfma_f32_16x16x32_bf16 v[164:167], v[60:63], v[36:39], v[164:167]
  ds_read_b64_tr_b16 v[106:107], v12 offset:12800
  v_mfma_f32_16x16x32_bf16 v[168:171], v[60:63], v[40:43], v[168:171]
  ds_read_b64_tr_b16 v[108:109], v13 offset:12288
  v_mfma_f32_16x16x32_bf16 v[172:175], v[60:63], v[44:47], v[172:175]
  ds_read_b64_tr_b16 v[110:111], v13 offset:12800
  v_mfma_f32_16x16x32_bf16 v[228:231], v[60:63], v[48:51], v[228:231]
  ds_read_b64_tr_b16 v[112:113], v12 offset:20480
  v_mfma_f32_16x16x32_bf16 v[176:179], v[64:67], v[32:35], v[176:179]
  ds_read_b64_tr_b16 v[114:115], v12 offset:20992
  v_mfma_f32_16x16x32_bf16 v[180:183], v[64:67], v[36:39], v[180:183]
  ds_read_b64_tr_b16 v[116:117], v13 offset:20480
  v_mfma_f32_16x16x32_bf16 v[184:187], v[64:67], v[40:43], v[184:187]
  ds_read_b64_tr_b16 v[118:119], v13 offset:20992
  v_mfma_f32_16x16x32_bf16 v[188:191], v[64:67], v[44:47], v[188:191]
  v_add_u32_e64 v10, s75, v4
  v_mfma_f32_16x16x32_bf16 v[192:195], v[32:35], v[68:71], v[192:195]
  v_add_u32_e64 v11, s75, v5
  v_mfma_f32_16x16x32_bf16 v[196:199], v[36:39], v[68:71], v[196:199]
  v_add_u32_e64 v12, s75, v6
  v_mfma_f32_16x16x32_bf16 v[200:203], v[40:43], v[68:71], v[200:203]
  v_add_u32_e64 v13, s75, v7
  v_mfma_f32_16x16x32_bf16 v[204:207], v[44:47], v[68:71], v[204:207]
  v_add_u32_e64 v14, s75, v8
  v_mfma_f32_16x16x32_bf16 v[232:235], v[48:51], v[68:71], v[232:235]
  v_add_u32_e64 v15, s75, v9
  v_mfma_f32_16x16x32_bf16 v[208:211], v[32:35], v[72:75], v[208:211]
  s_add_u32 s75, s75, 43008
  v_mfma_f32_16x16x32_bf16 v[212:215], v[36:39], v[72:75], v[212:215]
  s_cmp_eq_u32 s75, 129024
  v_mfma_f32_16x16x32_bf16 v[216:219], v[40:43], v[72:75], v[216:219]
  s_cselect_b32 s75, 0, s75
  s_sub_u32 s79, s79, 1
  v_mfma_f32_16x16x32_bf16 v[220:223], v[44:47], v[72:75], v[220:223]
  s_waitcnt lgkmcnt(0)
  s_barrier
  v_mfma_f32_16x16x32_bf16 v[128:131], v[96:99], v[76:79], v[128:131]
  ds_read_b128 v[32:35], v10 offset:0
  v_mfma_f32_16x16x32_bf16 v[132:135], v[96:99], v[80:83], v[132:135]
  ds_read_b128 v[36:39], v10 offset:2048
  v_mfma_f32_16x16x32_bf16 v[136:139], v[96:99], v[84:87], v[136:139]
  ds_read_b128 v[40:43], v10 offset:4096
  v_mfma_f32_16x16x32_bf16 v[140:143], v[96:99], v[88:91], v[140:143]
  ds_read_b128 v[44:47], v10 offset:6144
  v_mfma_f32_16x16x32_bf16 v[224:227], v[96:99], v[92:95], v[224:227]
  ds_read_b128 v[48:51], v14
  v_mfma_f32_16x16x32_bf16 v[144:147], v[100:103], v[76:79], v[144:147]
  ds_read_b64_tr_b16 v[52:53], v12 offset:0
  v_mfma_f32_16x16x32_bf16 v[148:151], v[100:103], v[80:83], v[148:151]
  ds_read_b64_tr_b16 v[54:55], v12 offset:512
  v_mfma_f32_16x16x32_bf16 v[152:155], v[100:103], v[84:87], v[152:155]
  ds_read_b64_tr_b16 v[56:57], v13 offset:0
  v_mfma_f32_16x16x32_bf16 v[156:159], v[100:103], v[88:91], v[156:159]
  ds_read_b64_tr_b16 v[58:59], v13 offset:512
  v_mfma_f32_16x16x32_bf16 v[160:163], v[104:107], v[76:79], v[160:163]
  ds_read_b64_tr_b16 v[60:61], v12 offset:8192
  v_mfma_f32_16x16x32_bf16 v[164:167], v[104:107], v[80:83], v[164:167]
  ds_read_b64_tr_b16 v[62:63], v12 offset:8704
  v_mfma_f32_16x16x32_bf16 v[168:171], v[104:107], v[84:87], v[168:171]
  ds_read_b64_tr_b16 v[64:65], v13 offset:8192
  v_mfma_f32_16x16x32_bf16 v[172:175], v[104:107], v[88:91], v[172:175]
  ds_read_b64_tr_b16 v[66:67], v13 offset:8704
  v_mfma_f32_16x16x32_bf16 v[228:231], v[104:107], v[92:95], v[228:231]
  ds_read_b64_tr_b16 v[68:69], v12 offset:16384
  v_mfma_f32_16x16x32_bf16 v[176:179], v[108:111], v[76:79], v[176:179]
  ds_read_b64_tr_b16 v[70:71], v12 offset:16896
  v_mfma_f32_16x16x32_bf16 v[180:183], v[108:111], v[80:83], v[180:183]
  ds_read_b64_tr_b16 v[72:73], v13 offset:16384
  v_mfma_f32_16x16x32_bf16 v[184:187], v[108:111], v[84:87], v[184:187]
  ds_read_b64_tr_b16 v[74:75], v13 offset:16896
  v_mfma_f32_16x16x32_bf16 v[188:191], v[108:111], v[88:91], v[188:191]
  s_cmp_lg_u32 s79, 0
  s_nop 0
  v_mfma_f32_16x16x32_bf16 v[192:195], v[76:79], v[112:115], v[192:195]
  v_mfma_f32_16x16x32_bf16 v[196:199], v[80:83], v[112:115], v[196:199]
  v_mfma_f32_16x16x32_bf16 v[200:203], v[84:87], v[112:115], v[200:203]
  v_mfma_f32_16x16x32_bf16 v[204:207], v[88:91], v[112:115], v[204:207]
  v_mfma_f32_16x16x32_bf16 v[232:235], v[92:95], v[112:115], v[232:235]
  v_mfma_f32_16x16x32_bf16 v[208:211], v[76:79], v[116:119], v[208:211]
  v_mfma_f32_16x16x32_bf16 v[212:215], v[80:83], v[116:119], v[212:215]
  v_mfma_f32_16x16x32_bf16 v[216:219], v[84:87], v[116:119], v[216:219]
  v_mfma_f32_16x16x32_bf16 v[220:223], v[88:91], v[116:119], v[220:223]
  s_waitcnt lgkmcnt(0)
  s_cbranch_scc1 L_attn_loop
L_attn_exit:
  ds_read2_b32 v[66:67], v23 offset0:0 offset1:160
  ds_read2_b32 v[68:69], v23 offset0:16 offset1:176
  ds_read2_b32 v[70:71], v23 offset0:32 offset1:192
  ds_read2_b32 v[72:73], v23 offset0:48 offset1:208
  ds_read2_b32 v[74:75], v23 offset0:64 offset1:224
  ds_read2_b32 v[76:77], v25 offset0:0 offset1:16
  ds_read2_b32 v[80:81], v26 offset0:0 offset1:16
  ds_read2_b32 v[78:79], v25 offset0:32 offset1:48
  ds_read2_b32 v[82:83], v26 offset0:32 offset1:48
  ds_write_b128 v16, v[224:227] offset:0
  ds_write_b128 v16, v[228:231] offset:2048
  ds_write_b128 v16, v[232:235] offset:4096
  s_cmp_eq_u32 s71, 1
  s_cbranch_scc1 L_attn_nop3
  ds_write_b128 v16, v[172:175] offset:8192
  ds_write_b128 v16, v[188:191] offset:9216
  ds_write_b128 v16, v[204:207] offset:10240
  ds_write_b128 v16, v[220:223] offset:11264
L_attn_nop3:
  ds_read_b128 v[84:87], v24 offset:0
  ds_read_b128 v[104:107], v24 offset:640
  ds_read_b128 v[88:91], v24 offset:64
  ds_read_b128 v[108:111], v24 offset:704
  ds_read_b128 v[92:95], v24 offset:128
  ds_read_b128 v[112:115], v24 offset:768
  ds_read_b128 v[96:99], v24 offset:192
  ds_read_b128 v[116:119], v24 offset:832
  ds_read_b128 v[100:103], v24 offset:256
  ds_read_b128 v[120:123], v24 offset:896
  s_waitcnt lgkmcnt(10)
  s_barrier
  ds_read_b128 v[48:51], v19 offset:0
  ds_read_b128 v[52:55], v20 offset:1024
  ds_read_b128 v[56:59], v19 offset:2048
  ds_read_b128 v[60:63], v20 offset:3072
  ds_read_b32 v64, v21 offset:4096
  ds_read_b32 v65, v22 offset:5120
  ds_read_b128 v[32:35], v17 offset:2048
  ds_read_b128 v[36:39], v18 offset:3072
  ds_read_b128 v[40:43], v17 offset:4096
  ds_read_b128 v[44:47], v18 offset:5120
  v_mul_f32 v69, 0x3e8293ee, v69
  v_mul_f32 v71, 0x3e8293ee, v71
  v_mul_f32 v73, 0x3e8293ee, v73
  v_mul_f32 v75, 0x3e8293ee, v75
  v_mul_f32 v76, v76, v69
  v_mul_f32 v80, v80, v69
  v_mul_f32 v77, v77, v71
  v_mul_f32 v81, v81, v71
  v_mul_f32 v78, v78, v73
  v_mul_f32 v82, v82, v73
  v_mul_f32 v79, v79, v75
  v_mul_f32 v83, v83, v75
  s_waitcnt lgkmcnt(6)
  v_pk_fma_f32 v[128:129], v[48:49], v[68:69], v[128:129] op_sel:[0,0,0] op_sel_hi:[1,0,1] neg_lo:[0,1,0] neg_hi:[0,1,0]
  v_pk_fma_f32 v[130:131], v[50:51], v[68:69], v[130:131] op_sel:[0,0,0] op_sel_hi:[1,0,1] neg_lo:[0,1,0] neg_hi:[0,1,0]
  v_pk_fma_f32 v[144:145], v[52:53], v[68:69], v[144:145] op_sel:[0,0,0] op_sel_hi:[1,0,1] neg_lo:[0,1,0] neg_hi:[0,1,0]
  v_pk_fma_f32 v[146:147], v[54:55], v[68:69], v[146:147] op_sel:[0,0,0] op_sel_hi:[1,0,1] neg_lo:[0,1,0] neg_hi:[0,1,0]
  v_cvt_pk_bf16_f32 v128, v128, v129
  v_cvt_pk_bf16_f32 v129, v130, v131
  v_cvt_pk_bf16_f32 v130, v144, v145
  v_cvt_pk_bf16_f32 v131, v146, v147
  v_pk_fma_f32 v[160:161], v[56:57], v[68:69], v[160:161] op_sel:[0,0,0] op_sel_hi:[1,0,1] neg_lo:[0,1,0] neg_hi:[0,1,0]
  v_pk_fma_f32 v[162:163], v[58:59], v[68:69], v[162:163] op_sel:[0,0,0] op_sel_hi:[1,0,1] neg_lo:[0,1,0] neg_hi:[0,1,0]
  v_pk_fma_f32 v[176:177], v[60:61], v[68:69], v[176:177] op_sel:[0,0,0] op_sel_hi:[1,0,1] neg_lo:[0,1,0] neg_hi:[0,1,0]
  v_pk_fma_f32 v[178:179], v[62:63], v[68:69], v[178:179] op_sel:[0,0,0] op_sel_hi:[1,0,1] neg_lo:[0,1,0] neg_hi:[0,1,0]
  v_cvt_pk_bf16_f32 v160, v160, v161
  v_cvt_pk_bf16_f32 v161, v162, v163
  v_cvt_pk_bf16_f32 v162, v176, v177
  v_cvt_pk_bf16_f32 v163, v178, v179
  v_pk_fma_f32 v[132:133], v[48:49], v[70:71], v[132:133] op_sel:[0,0,0] op_sel_hi:[1,0,1] neg_lo:[0,1,0] neg_hi:[0,1,0]
  v_pk_fma_f32 v[134:135], v[50:51], v[70:71], v[134:135] op_sel:[0,0,0] op_sel_hi:[1,0,1] neg_lo:[0,1,0] neg_hi:[0,1,0]
  v_pk_fma_f32 v[148:149], v[52:53], v[70:71], v[148:149] op_sel:[0,0,0] op_sel_hi:[1,0,1] neg_lo:[0,1,0] neg_hi:[0,1,0]
  v_pk_fma_f32 v[150:151], v[54:55], v[70:71], v[150:151] op_sel:[0,0,0] op_sel_hi:[1,0,1] neg_lo:[0,1,0] neg_hi:[0,1,0]
  v_cvt_pk_bf16_f32 v132, v132, v133
  v_cvt_pk_bf16_f32 v133, v134, v135
  v_cvt_pk_bf16_f32 v134, v148, v149
  v_cvt_pk_bf16_f32 v135, v150, v151
  v_pk_fma_f32 v[164:165], v[56:57], v[70:71], v[164:165] op_sel:[0,0,0] op_sel_hi:[1,0,1] neg_lo:[0,1,0] neg_hi:[0,1,0]
  v_pk_fma_f32 v[166:167], v[58:59], v[70:71], v[166:167] op_sel:[0,0,0] op_sel_hi:[1,0,1] neg_lo:[0,1,0] neg_hi:[0,1,0]
  v_pk_fma_f32 v[180:181], v[60:61], v[70:71], v[180:181] op_sel:[0,0,0] op_sel_hi:[1,0,1] neg_lo:[0,1,0] neg_hi:[0,1,0]
  v_pk_fma_f32 v[182:183], v[62:63], v[70:71], v[182:183] op_sel:[0,0,0] op_sel_hi:[1,0,1] neg_lo:[0,1,0] neg_hi:[0,1,0]
  v_cvt_pk_bf16_f32 v164, v164, v165
  v_cvt_pk_bf16_f32 v165, v166, v167
  v_cvt_pk_bf16_f32 v166, v180, v181
  v_cvt_pk_bf16_f32 v167, v182, v183
  v_mfma_f32_16x16x32_bf16 v[144:147], v[160:163], v[128:131], 0
  v_pk_fma_f32 v[136:137], v[48:49], v[72:73], v[136:137] op_sel:[0,0,0] op_sel_hi:[1,0,1] neg_lo:[0,1,0] neg_hi:[0,1,0]
  v_pk_fma_f32 v[138:139], v[50:51], v[72:73], v[138:139] op_sel:[0,0,0] op_sel_hi:[1,0,1] neg_lo:[0,1,0] neg_hi:[0,1,0]
  v_pk_fma_f32 v[152:153], v[52:53], v[72:73], v[152:153] op_sel:[0,0,0] op_sel_hi:[1,0,1] neg_lo:[0,1,0] neg_hi:[0,1,0]
  v_pk_fma_f32 v[154:155], v[54:55], v[72:73], v[154:155] op_sel:[0,0,0] op_sel_hi:[1,0,1] neg_lo:[0,1,0] neg_hi:[0,1,0]
  v_cvt_pk_bf16_f32 v136, v136, v137
  v_cvt_pk_bf16_f32 v137, v138, v139
  v_cvt_pk_bf16_f32 v138, v152, v153
  v_cvt_pk_bf16_f32 v139, v154, v155
  v_pk_fma_f32 v[168:169], v[56:57], v[72:73], v[168:169] op_sel:[0,0,0] op_sel_hi:[1,0,1] neg_lo:[0,1,0] neg_hi:[0,1,0]
  v_pk_fma_f32 v[170:171], v[58:59], v[72:73], v[170:171] op_sel:[0,0,0] op_sel_hi:[1,0,1] neg_lo:[0,1,0] neg_hi:[0,1,0]
  v_pk_fma_f32 v[184:185], v[60:61], v[72:73], v[184:185] op_sel:[0,0,0] op_sel_hi:[1,0,1] neg_lo:[0,1,0] neg_hi:[0,1,0]
  v_pk_fma_f32 v[186:187], v[62:63], v[72:73], v[186:187] op_sel:[0,0,0] op_sel_hi:[1,0,1] neg_lo:[0,1,0] neg_hi:[0,1,0]
  v_cvt_pk_bf16_f32 v168, v168, v169
  v_cvt_pk_bf16_f32 v169, v170, v171
  v_cvt_pk_bf16_f32 v170, v184, v185
  v_cvt_pk_bf16_f32 v171, v186, v187
  v_mfma_f32_16x16x32_bf16 v[148:151], v[164:167], v[132:135], 0
  v_mfma_f32_16x16x32_bf16 v[180:183], v[160:163], v[132:135], 0
  v_pk_fma_f32 v[140:141], v[48:49], v[74:75], v[140:141] op_sel:[0,0,0] op_sel_hi:[1,0,1] neg_lo:[0,1,0] neg_hi:[0,1,0]
  v_pk_fma_f32 v[142:143], v[50:51], v[74:75], v[142:143] op_sel:[0,0,0] op_sel_hi:[1,0,1] neg_lo:[0,1,0] neg_hi:[0,1,0]
  v_pk_fma_f32 v[156:157], v[52:53], v[74:75], v[156:157] op_sel:[0,0,0] op_sel_hi:[1,0,1] neg_lo:[0,1,0] neg_hi:[0,1,0]
  v_pk_fma_f32 v[158:159], v[54:55], v[74:75], v[158:159] op_sel:[0,0,0] op_sel_hi:[1,0,1] neg_lo:[0,1,0] neg_hi:[0,1,0]
  v_cvt_pk_bf16_f32 v140, v140, v141
  v_cvt_pk_bf16_f32 v141, v142, v143
  v_cvt_pk_bf16_f32 v142, v156, v157
  v_cvt_pk_bf16_f32 v143, v158, v159
  v_pk_fma_f32 v[172:173], v[56:57], v[74:75], v[172:173] op_sel:[0,0,0] op_sel_hi:[1,0,1] neg_lo:[0,1,0] neg_hi:[0,1,0]
  v_pk_fma_f32 v[174:175], v[58:59], v[74:75], v[174:175] op_sel:[0,0,0] op_sel_hi:[1,0,1] neg_lo:[0,1,0] neg_hi:[0,1,0]
  v_pk_fma_f32 v[188:189], v[60:61], v[74:75], v[188:189] op_sel:[0,0,0] op_sel_hi:[1,0,1] neg_lo:[0,1,0] neg_hi:[0,1,0]
  v_pk_fma_f32 v[190:191], v[62:63], v[74:75], v[190:191] op_sel:[0,0,0] op_sel_hi:[1,0,1] neg_lo:[0,1,0] neg_hi:[0,1,0]
  v_cvt_pk_bf16_f32 v172, v172, v173
  v_cvt_pk_bf16_f32 v173, v174, v175
  v_cvt_pk_bf16_f32 v174, v188, v189
  v_cvt_pk_bf16_f32 v175, v190, v191
  s_waitcnt lgkmcnt(0)
  v_pk_fma_f32 v[32:33], v[56:57], v[66:67], v[32:33] op_sel:[0,0,0] op_sel_hi:[1,0,1] neg_lo:[0,1,0] neg_hi:[0,1,0]
  v_pk_fma_f32 v[34:35], v[58:59], v[66:67], v[34:35] op_sel:[0,0,0] op_sel_hi:[1,0,1] neg_lo:[0,1,0] neg_hi:[0,1,0]
  v_pk_fma_f32 v[36:37], v[60:61], v[66:67], v[36:37] op_sel:[0,0,0] op_sel_hi:[1,0,1] neg_lo:[0,1,0] neg_hi:[0,1,0]
  v_pk_fma_f32 v[38:39], v[62:63], v[66:67], v[38:39] op_sel:[0,0,0] op_sel_hi:[1,0,1] neg_lo:[0,1,0] neg_hi:[0,1,0]
  v_cvt_pk_bf16_f32 v32, v32, v33
  v_cvt_pk_bf16_f32 v33, v34, v35
  v_cvt_pk_bf16_f32 v34, v36, v37
  v_cvt_pk_bf16_f32 v35, v38, v39
  v_mfma_f32_16x16x32_bf16 v[152:155], v[168:171], v[136:139], 0
  v_mfma_f32_16x16x32_bf16 v[184:187], v[164:167], v[136:139], 0
  v_mfma_f32_16x16x32_bf16 v[156:159], v[172:175], v[140:143], 0
  v_mfma_f32_16x16x32_bf16 v[188:191], v[168:171], v[140:143], 0
  v_mfma_f32_16x16x32_bf16 v[176:179], v[32:35], v[128:131], 0
  v_pk_fma_f32 v[40:41], v[84:85], v[64:65], v[40:41] op_sel:[0,0,0] op_sel_hi:[1,0,1] neg_lo:[1,0,0] neg_hi:[1,0,0]
  v_pk_fma_f32 v[42:43], v[86:87], v[64:65], v[42:43] op_sel:[0,0,0] op_sel_hi:[1,0,1] neg_lo:[1,0,0] neg_hi:[1,0,0]
  v_pk_mul_f32 v[40:41], v[40:41], v[104:105]
  v_pk_mul_f32 v[42:43], v[42:43], v[106:107]
  v_cvt_pk_bf16_f32 v240, v40, v41
  v_cvt_pk_bf16_f32 v241, v42, v43
  v_pk_fma_f32 v[192:193], v[88:89], v[64:65], v[192:193] op_sel:[0,0,0] op_sel_hi:[1,0,1] neg_lo:[1,0,0] neg_hi:[1,0,0]
  v_pk_fma_f32 v[194:195], v[90:91], v[64:65], v[194:195] op_sel:[0,0,0] op_sel_hi:[1,0,1] neg_lo:[1,0,0] neg_hi:[1,0,0]
  v_pk_mul_f32 v[192:193], v[192:193], v[108:109]
  v_pk_mul_f32 v[194:195], v[194:195], v[110:111]
  v_cvt_pk_bf16_f32 v242, v192, v193
  v_cvt_pk_bf16_f32 v243, v194, v195
  v_pk_fma_f32 v[196:197], v[92:93], v[64:65], v[196:197] op_sel:[0,0,0] op_sel_hi:[1,0,1] neg_lo:[1,0,0] neg_hi:[1,0,0]
  v_pk_fma_f32 v[198:199], v[94:95], v[64:65], v[198:199] op_sel:[0,0,0] op_sel_hi:[1,0,1] neg_lo:[1,0,0] neg_hi:[1,0,0]
  v_pk_mul_f32 v[196:197], v[196:197], v[112:113]
  v_pk_mul_f32 v[198:199], v[198:199], v[114:115]
  v_cvt_pk_bf16_f32 v244, v196, v197
  v_cvt_pk_bf16_f32 v245, v198, v199
  v_pk_fma_f32 v[200:201], v[96:97], v[64:65], v[200:201] op_sel:[0,0,0] op_sel_hi:[1,0,1] neg_lo:[1,0,0] neg_hi:[1,0,0]
  v_pk_fma_f32 v[202:203], v[98:99], v[64:65], v[202:203] op_sel:[0,0,0] op_sel_hi:[1,0,1] neg_lo:[1,0,0] neg_hi:[1,0,0]
  v_pk_mul_f32 v[200:201], v[200:201], v[116:117]
  v_pk_mul_f32 v[202:203], v[202:203], v[118:119]
  v_cvt_pk_bf16_f32 v246, v200, v201
  v_cvt_pk_bf16_f32 v247, v202, v203
  v_pk_fma_f32 v[204:205], v[100:101], v[64:65], v[204:205] op_sel:[0,0,0] op_sel_hi:[1,0,1] neg_lo:[1,0,0] neg_hi:[1,0,0]
  v_pk_fma_f32 v[206:207], v[102:103], v[64:65], v[206:207] op_sel:[0,0,0] op_sel_hi:[1,0,1] neg_lo:[1,0,0] neg_hi:[1,0,0]
  v_pk_mul_f32 v[204:205], v[204:205], v[120:121]
  v_pk_mul_f32 v[206:207], v[206:207], v[122:123]
  v_cvt_pk_bf16_f32 v248, v204, v205
  v_cvt_pk_bf16_f32 v249, v206, v207
  v_pk_fma_f32 v[44:45], v[84:85], v[64:65], v[44:45] op_sel:[0,1,0] op_sel_hi:[1,1,1] neg_lo:[1,0,0] neg_hi:[1,0,0]
  v_pk_fma_f32 v[46:47], v[86:87], v[64:65], v[46:47] op_sel:[0,1,0] op_sel_hi:[1,1,1] neg_lo:[1,0,0] neg_hi:[1,0,0]
  v_pk_mul_f32 v[44:45], v[44:45], v[104:105]
  v_pk_mul_f32 v[46:47], v[46:47], v[106:107]
  v_cvt_pk_bf16_f32 v224, v44, v45
  v_cvt_pk_bf16_f32 v225, v46, v47
  v_pk_fma_f32 v[208:209], v[88:89], v[64:65], v[208:209] op_sel:[0,1,0] op_sel_hi:[1,1,1] neg_lo:[1,0,0] neg_hi:[1,0,0]
  v_pk_fma_f32 v[210:211], v[90:91], v[64:65], v[210:211] op_sel:[0,1,0] op_sel_hi:[1,1,1] neg_lo:[1,0,0] neg_hi:[1,0,0]
  v_pk_mul_f32 v[208:209], v[208:209], v[108:109]
  v_pk_mul_f32 v[210:211], v[210:211], v[110:111]
  v_cvt_pk_bf16_f32 v226, v208, v209
  v_cvt_pk_bf16_f32 v227, v210, v211
  v_pk_fma_f32 v[212:213], v[92:93], v[64:65], v[212:213] op_sel:[0,1,0] op_sel_hi:[1,1,1] neg_lo:[1,0,0] neg_hi:[1,0,0]
  v_pk_fma_f32 v[214:215], v[94:95], v[64:65], v[214:215] op_sel:[0,1,0] op_sel_hi:[1,1,1] neg_lo:[1,0,0] neg_hi:[1,0,0]
  v_pk_mul_f32 v[212:213], v[212:213], v[112:113]
  v_pk_mul_f32 v[214:215], v[214:215], v[114:115]
  v_cvt_pk_bf16_f32 v228, v212, v213
  v_cvt_pk_bf16_f32 v229, v214, v215
  v_pk_fma_f32 v[216:217], v[96:97], v[64:65], v[216:217] op_sel:[0,1,0] op_sel_hi:[1,1,1] neg_lo:[1,0,0] neg_hi:[1,0,0]
  v_pk_fma_f32 v[218:219], v[98:99], v[64:65], v[218:219] op_sel:[0,1,0] op_sel_hi:[1,1,1] neg_lo:[1,0,0] neg_hi:[1,0,0]
  v_pk_mul_f32 v[216:217], v[216:217], v[116:117]
  v_pk_mul_f32 v[218:219], v[218:219], v[118:119]
  v_cvt_pk_bf16_f32 v230, v216, v217
  v_cvt_pk_bf16_f32 v231, v218, v219
  v_pk_fma_f32 v[220:221], v[100:101], v[64:65], v[220:221] op_sel:[0,1,0] op_sel_hi:[1,1,1] neg_lo:[1,0,0] neg_hi:[1,0,0]
  v_pk_fma_f32 v[222:223], v[102:103], v[64:65], v[222:223] op_sel:[0,1,0] op_sel_hi:[1,1,1] neg_lo:[1,0,0] neg_hi:[1,0,0]
  v_pk_mul_f32 v[220:221], v[220:221], v[120:121]
  v_pk_mul_f32 v[222:223], v[222:223], v[122:123]
  v_cvt_pk_bf16_f32 v232, v220, v221
  v_cvt_pk_bf16_f32 v233, v222, v223
  v_cndmask_b32 v148, v148, v149, s[48:49]
  v_cndmask_b32 v180, v180, v181, s[48:49]
  v_cndmask_b32 v150, v150, v151, s[48:49]
  v_cndmask_b32 v182, v182, v183, s[48:49]
  v_cndmask_b32 v36, v148, v180, s[50:51]
  v_cndmask_b32 v37, v150, v182, s[52:53]
  v_mul_f32 v36, v36, v77
  v_mul_f32 v37, v37, v81
  v_cndmask_b32 v152, v152, v153, s[48:49]
  v_cndmask_b32 v184, v184, v185, s[48:49]
  v_cndmask_b32 v154, v154, v155, s[48:49]
  v_cndmask_b32 v186, v186, v187, s[48:49]
  v_cndmask_b32 v40, v152, v184, s[50:51]
  v_cndmask_b32 v41, v154, v186, s[52:53]
  v_mul_f32 v40, v40, v78
  v_mul_f32 v41, v41, v82
  v_cndmask_b32 v156, v156, v157, s[48:49]
  v_cndmask_b32 v188, v188, v189, s[48:49]
  v_cndmask_b32 v158, v158, v159, s[48:49]
  v_cndmask_b32 v190, v190, v191, s[48:49]
  v_cndmask_b32 v44, v156, v188, s[50:51]
  v_cndmask_b32 v45, v158, v190, s[52:53]
  v_mul_f32 v44, v44, v79
  v_mul_f32 v45, v45, v83
  v_cndmask_b32 v144, v144, v145, s[48:49]
  v_cndmask_b32 v176, v176, v177, s[48:49]
  v_cndmask_b32 v146, v146, v147, s[48:49]
  v_cndmask_b32 v178, v178, v179, s[48:49]
  v_cndmask_b32 v32, v144, v176, s[50:51]
  v_cndmask_b32 v33, v146, v178, s[52:53]
  v_mul_f32 v32, v32, v76
  v_mul_f32 v33, v33, v80
  v_mov_b32 v48, 0xceabfb8f
  v_cndmask_b32 v32, v32, v48, s[54:55]
  v_cndmask_b32 v33, v33, v48, s[14:15]
  v_max_f32 v34, v32, v33
  v_max_f32 v38, v36, v37
  v_max_f32 v42, v40, v41
  v_max_f32 v46, v44, v45
  v_mov_b32 v35, v34
  v_mov_b32 v39, v38
  v_mov_b32 v43, v42
  v_mov_b32 v47, v46
  v_permlane32_swap_b32 v34, v35
  v_permlane32_swap_b32 v38, v39
  v_permlane32_swap_b32 v42, v43
  v_permlane32_swap_b32 v46, v47
  v_max_f32 v34, v34, v35
  v_max_f32 v38, v38, v39
  v_max_f32 v42, v42, v43
  v_max_f32 v46, v46, v47
  v_mov_b32 v35, v34
  v_mov_b32 v39, v38
  v_mov_b32 v43, v42
  v_mov_b32 v47, v46
  v_permlane16_swap_b32 v34, v35
  v_permlane16_swap_b32 v38, v39
  v_permlane16_swap_b32 v42, v43
  v_permlane16_swap_b32 v46, v47
  v_max_f32 v34, v34, v35
  v_max_f32 v38, v38, v39
  v_max_f32 v42, v42, v43
  v_max_f32 v46, v46, v47
  v_sub_f32 v32, v32, v34
  v_sub_f32 v33, v33, v34
  v_sub_f32 v36, v36, v38
  v_sub_f32 v37, v37, v38
  v_sub_f32 v40, v40, v42
  v_sub_f32 v41, v41, v42
  v_sub_f32 v44, v44, v46
  v_sub_f32 v45, v45, v46
  v_exp_f32 v32, v32
  v_exp_f32 v33, v33
  v_exp_f32 v36, v36
  v_exp_f32 v37, v37
  v_exp_f32 v40, v40
  v_exp_f32 v41, v41
  v_exp_f32 v44, v44
  v_exp_f32 v45, v45
  v_cvt_pk_bf16_f32 v32, v32, v32
  v_cvt_pk_bf16_f32 v33, v33, v33
  v_and_b32 v128, v32, v27
  v_and_b32 v129, v33, v29
  v_and_b32 v130, v32, v28
  v_and_b32 v131, v33, v30
  v_cvt_pk_bf16_f32 v36, v36, v36
  v_cvt_pk_bf16_f32 v37, v37, v37
  v_and_b32 v132, v36, v27
  v_and_b32 v133, v37, v29
  v_and_b32 v134, v36, v28
  v_and_b32 v135, v37, v30
  v_mfma_f32_16x16x32_bf16 v[144:147], v[236:239], v[128:131], 0
  v_mfma_f32_16x16x32_bf16 v[192:195], v[240:243], v[128:131], 0
  v_mfma_f32_16x16x32_bf16 v[208:211], v[224:227], v[128:131], 0
  v_cvt_pk_bf16_f32 v40, v40, v40
  v_cvt_pk_bf16_f32 v41, v41, v41
  v_and_b32 v136, v40, v27
  v_and_b32 v137, v41, v29
  v_and_b32 v138, v40, v28
  v_and_b32 v139, v41, v30
  v_mfma_f32_16x16x32_bf16 v[148:151], v[236:239], v[132:135], 0
  v_mfma_f32_16x16x32_bf16 v[196:199], v[242:245], v[132:135], 0
  v_mfma_f32_16x16x32_bf16 v[212:215], v[226:229], v[132:135], 0
  v_cvt_pk_bf16_f32 v44, v44, v44
  v_cvt_pk_bf16_f32 v45, v45, v45
  v_and_b32 v140, v44, v27
  v_and_b32 v141, v45, v29
  v_and_b32 v142, v44, v28
  v_and_b32 v143, v45, v30
  v_mfma_f32_16x16x32_bf16 v[152:155], v[236:239], v[136:139], 0
  v_mfma_f32_16x16x32_bf16 v[200:203], v[244:247], v[136:139], 0
  v_mfma_f32_16x16x32_bf16 v[216:219], v[228:231], v[136:139], 0
  v_mfma_f32_16x16x32_bf16 v[156:159], v[236:239], v[140:143], 0
  v_mfma_f32_16x16x32_bf16 v[204:207], v[246:249], v[140:143], 0
  v_mfma_f32_16x16x32_bf16 v[220:223], v[230:233], v[140:143], 0
  v_rcp_f32 v144, v144
  s_mov_b32 s3, 0
  v_pk_mul_f32 v[192:193], v[192:193], v[144:145] op_sel_hi:[1,0]
  v_pk_mul_f32 v[194:195], v[194:195], v[144:145] op_sel_hi:[1,0]
  v_pk_mul_f32 v[208:209], v[208:209], v[144:145] op_sel_hi:[1,0]
  v_pk_mul_f32 v[210:211], v[210:211], v[144:145] op_sel_hi:[1,0]
  v_cvt_pk_bf16_f32 v48, v192, v193
  v_cvt_pk_bf16_f32 v49, v194, v195
  v_cvt_pk_bf16_f32 v50, v208, v209
  v_cvt_pk_bf16_f32 v51, v210, v211
  s_nop 1
  v_permlane16_swap_b32 v48, v50
  v_permlane16_swap_b32 v49, v51
  buffer_store_dwordx4 v[48:51], v31, s[44:47], s3 offen sc1
  v_rcp_f32 v148, v148
  s_mov_b32 s3, 32768
  v_pk_mul_f32 v[196:197], v[196:197], v[148:149] op_sel_hi:[1,0]
  v_pk_mul_f32 v[198:199], v[198:199], v[148:149] op_sel_hi:[1,0]
  v_pk_mul_f32 v[212:213], v[212:213], v[148:149] op_sel_hi:[1,0]
  v_pk_mul_f32 v[214:215], v[214:215], v[148:149] op_sel_hi:[1,0]
  v_cvt_pk_bf16_f32 v52, v196, v197
  v_cvt_pk_bf16_f32 v53, v198, v199
  v_cvt_pk_bf16_f32 v54, v212, v213
  v_cvt_pk_bf16_f32 v55, v214, v215
  s_nop 1
  v_permlane16_swap_b32 v52, v54
  v_permlane16_swap_b32 v53, v55
  buffer_store_dwordx4 v[52:55], v31, s[44:47], s3 offen sc1
  v_rcp_f32 v152, v152
  s_mov_b32 s3, 65536
  v_pk_mul_f32 v[200:201], v[200:201], v[152:153] op_sel_hi:[1,0]
  v_pk_mul_f32 v[202:203], v[202:203], v[152:153] op_sel_hi:[1,0]
  v_pk_mul_f32 v[216:217], v[216:217], v[152:153] op_sel_hi:[1,0]
  v_pk_mul_f32 v[218:219], v[218:219], v[152:153] op_sel_hi:[1,0]
  v_cvt_pk_bf16_f32 v56, v200, v201
  v_cvt_pk_bf16_f32 v57, v202, v203
  v_cvt_pk_bf16_f32 v58, v216, v217
  v_cvt_pk_bf16_f32 v59, v218, v219
  s_nop 1
  v_permlane16_swap_b32 v56, v58
  v_permlane16_swap_b32 v57, v59
  buffer_store_dwordx4 v[56:59], v31, s[44:47], s3 offen sc1
  v_rcp_f32 v156, v156
  s_mov_b32 s3, 98304
  v_pk_mul_f32 v[204:205], v[204:205], v[156:157] op_sel_hi:[1,0]
  v_pk_mul_f32 v[206:207], v[206:207], v[156:157] op_sel_hi:[1,0]
  v_pk_mul_f32 v[220:221], v[220:221], v[156:157] op_sel_hi:[1,0]
  v_pk_mul_f32 v[222:223], v[222:223], v[156:157] op_sel_hi:[1,0]
  v_cvt_pk_bf16_f32 v60, v204, v205
  v_cvt_pk_bf16_f32 v61, v206, v207
  v_cvt_pk_bf16_f32 v62, v220, v221
  v_cvt_pk_bf16_f32 v63, v222, v223
  s_nop 1
  v_permlane16_swap_b32 v60, v62
  v_permlane16_swap_b32 v61, v63
  buffer_store_dwordx4 v[60:63], v31, s[44:47], s3 offen sc1
  s_waitcnt vmcnt(0)
  s_barrier
  s_add_u32 s97, s97, 1
  s_branch L_wo_body
.section .rodata,"a"
.p2align 6
.amdhsa_kernel interleave_layers__sliding_local_dilated__dense_activation_gelu__prompt_kernel
  .amdhsa_next_free_vgpr 256
  .amdhsa_next_free_sgpr 102
  .amdhsa_accum_offset 256
  .amdhsa_group_segment_fixed_size 0
  .amdhsa_kernarg_size 88
  .amdhsa_user_sgpr_count 2
  .amdhsa_user_sgpr_kernarg_segment_ptr 1
  .amdhsa_system_sgpr_workgroup_id_x 1
  .amdhsa_float_denorm_mode_32 3
  .amdhsa_float_denorm_mode_16_64 3
.end_amdhsa_kernel
.text
L_attn_c1:
L_wo_c0:
L_wo_body:
  s_cmp_ge_u32 s2, 256
  s_cbranch_scc1 L_wo_end
  v_lshrrev_b32 v2, 6, v0
  v_and_b32 v1, 63, v0
  v_readfirstlane_b32 s70, v2
  s_and_b32 s3, s2, 7
  s_lshr_b32 s99, s2, 3
  s_and_b32 s5, s3, 3
  s_lshl_b32 s5, s5, 2
  s_and_b32 s6, s99, 3
  s_add_u32 s68, s5, s6
  s_lshr_b32 s5, s3, 2
  s_lshl_b32 s5, s5, 3
  s_lshr_b32 s6, s99, 2
  s_add_u32 s69, s5, s6
  s_cmp_lt_u32 s70, 4
  s_cbranch_scc1 L_wo_compute
L_wo_loader:
  s_add_u32 s9, s70, s68
  s_and_b32 s9, s9, 3
  s_lshl_b32 s76, s9, 12
  s_lshl_b32 s77, s9, 11
  v_and_b32 v10, 7, v1
  v_lshrrev_b32 v3, 3, v1
  s_lshl_b32 s10, s9, 4
  v_add_u32 v3, s10, v3
  v_mul_u32_u24 v3, 2048, v3
  v_lshrrev_b32 v2, 3, v1
  v_and_b32 v2, 2, v2
  v_xor_b32 v2, v2, v10
  s_lshl_b32 s10, s69, 7
  v_add_u32 v3, s10, v3
  v_lshl_add_u32 v8, v2, 4, v3
  v_xor_b32 v2, 4, v2
  v_add_u32 v3, 16384, v3
  v_lshl_add_u32 v9, v2, 4, v3
  s_mov_b32 s40, s20
  s_and_b32 s41, s21, 0xffff
  s_mov_b32 s42, 2097152
  s_mov_b32 s43, 0x00020000
  s_add_u32 s3, s68, s69
  s_lshl_b32 s3, s3, 3
  s_lshl_b32 s85, 0xffff02, s3
  s_sub_u32 s3, 0, s3
  s_lshr_b32 s3, 0xffff02, s3
  s_or_b32 s85, s85, s3
  s_and_b32 s86, s68, 3
  s_lshl_b32 s86, s86, 2
  v_lshl_add_u32 v14, v1, 4, s77
  s_add_u32 s3, s96, s70
  s_cmp_lg_u32 s3, 4
  s_cbranch_scc1 L_wo_chk
  s_load_dwordx2 s[64:65], s[0:1], 72
  s_mov_b32 s79, 0x100000
  s_waitcnt lgkmcnt(0)
  s_and_b32 s65, s65, 0xffff
  s_mov_b32 s66, 256
  s_mov_b32 s67, 0x00020000
  v_lshlrev_b32 v2, 2, v1
L_wo_chkl:
  buffer_load_dword v12, v2, s[64:67], 0 offen sc1
  s_sub_u32 s79, s79, 1
  s_cbranch_scc1 L_wo_chk
  s_waitcnt vmcnt(0)
  v_cmp_ne_u32 vcc, 0x01010101, v12
  s_cbranch_vccnz L_wo_chkl
L_wo_chk:
  s_bfe_i32 s74, s85, 0x80000
  s_add_i32 s74, s74, 0
  s_cmp_lt_i32 s74, 0
  s_cselect_b32 s74, 15, s74
  s_add_u32 s74, s74, s86
  s_and_b32 s74, s74, 15
  s_lshl_b32 s74, s74, 17
  s_add_u32 m0, s77, 131072
  s_add_u32 s4, s74, 0
  buffer_load_dwordx4 v8, s[40:43], s4 offen lds
  s_add_u32 m0, s77, 132096
  s_nop 0
  buffer_load_dwordx4 v9, s[40:43], s4 offen lds
  s_bfe_i32 s74, s85, 0x80008
  s_add_i32 s74, s74, 1
  s_add_u32 s74, s74, s86
  s_and_b32 s74, s74, 15
  s_lshl_b32 s74, s74, 17
  s_add_u32 m0, s77, 139264
  s_add_u32 s4, s74, 0
  buffer_load_dwordx4 v8, s[40:43], s4 offen lds
  s_add_u32 m0, s77, 140288
  s_nop 0
  buffer_load_dwordx4 v9, s[40:43], s4 offen lds
  s_bfe_i32 s74, s85, 0x80010
  s_add_i32 s74, s74, 2
  s_add_u32 s74, s74, s86
  s_and_b32 s74, s74, 15
  s_lshl_b32 s74, s74, 17
  s_add_u32 m0, s77, 147456
  s_add_u32 s4, s74, 0
  buffer_load_dwordx4 v8, s[40:43], s4 offen lds
  s_add_u32 m0, s77, 148480
  s_nop 0
  buffer_load_dwordx4 v9, s[40:43], s4 offen lds
  s_bfe_i32 s74, s85, 0x80018
  s_add_i32 s74, s74, 3
  s_add_u32 s74, s74, s86
  s_and_b32 s74, s74, 15
  s_lshl_b32 s74, s74, 17
  s_add_u32 m0, s77, 155648
  s_add_u32 s4, s74, 0
  buffer_load_dwordx4 v8, s[40:43], s4 offen lds
  s_add_u32 m0, s77, 156672
  s_nop 0
  buffer_load_dwordx4 v9, s[40:43], s4 offen lds
  s_bfe_i32 s74, s85, 0x80000
  s_add_i32 s74, s74, 4
  s_add_u32 s74, s74, s86
  s_and_b32 s74, s74, 15
  s_lshl_b32 s74, s74, 17
  s_add_u32 m0, s77, 28672
  s_add_u32 s4, s74, 0
  buffer_load_dwordx4 v8, s[40:43], s4 offen lds
  s_add_u32 m0, s77, 29696
  s_nop 0
  buffer_load_dwordx4 v9, s[40:43], s4 offen lds
  s_bfe_i32 s74, s85, 0x80008
  s_add_i32 s74, s74, 5
  s_add_u32 s74, s74, s86
  s_and_b32 s74, s74, 15
  s_lshl_b32 s74, s74, 17
  s_add_u32 m0, s77, 36864
  s_add_u32 s4, s74, 0
  buffer_load_dwordx4 v8, s[40:43], s4 offen lds
  s_add_u32 m0, s77, 37888
  s_nop 0
  buffer_load_dwordx4 v9, s[40:43], s4 offen lds
  s_add_u32 s44, s22, 24903680
  s_addc_u32 s45, s23, 0
  s_and_b32 s45, s45, 0xffff
  s_mov_b32 s46, 32768
  s_mov_b32 s47, 0x00020000
  s_cmp_lg_u32 s96, 0
  s_cbranch_scc1 L_wo_nofirst
  s_waitcnt vmcnt(12)
  s_mov_b32 s7, 0xffff0000
  v_lshlrev_b32 v32, 16, v64
  v_and_b32 v33, s7, v64
  v_lshlrev_b32 v34, 16, v65
  v_and_b32 v35, s7, v65
  v_lshlrev_b32 v36, 16, v66
  v_and_b32 v37, s7, v66
  v_lshlrev_b32 v38, 16, v67
  v_and_b32 v39, s7, v67
  v_lshlrev_b32 v40, 16, v68
  v_and_b32 v41, s7, v68
  v_pk_add_f32 v[32:33], v[32:33], v[40:41]
  v_lshlrev_b32 v40, 16, v69
  v_and_b32 v41, s7, v69
  v_pk_add_f32 v[34:35], v[34:35], v[40:41]
  v_lshlrev_b32 v40, 16, v70
  v_and_b32 v41, s7, v70
  v_pk_add_f32 v[36:37], v[36:37], v[40:41]
  v_lshlrev_b32 v40, 16, v71
  v_and_b32 v41, s7, v71
  v_pk_add_f32 v[38:39], v[38:39], v[40:41]
  v_lshlrev_b32 v40, 16, v72
  v_and_b32 v41, s7, v72
  v_pk_add_f32 v[32:33], v[32:33], v[40:41]
  v_lshlrev_b32 v40, 16, v73
  v_and_b32 v41, s7, v73
  v_pk_add_f32 v[34:35], v[34:35], v[40:41]
  v_lshlrev_b32 v40, 16, v74
  v_and_b32 v41, s7, v74
  v_pk_add_f32 v[36:37], v[36:37], v[40:41]
  v_lshlrev_b32 v40, 16, v75
  v_and_b32 v41, s7, v75
  v_pk_add_f32 v[38:39], v[38:39], v[40:41]
  v_lshlrev_b32 v40, 16, v76
  v_and_b32 v41, s7, v76
  v_pk_add_f32 v[32:33], v[32:33], v[40:41]
  v_lshlrev_b32 v40, 16, v77
  v_and_b32 v41, s7, v77
  v_pk_add_f32 v[34:35], v[34:35], v[40:41]
  v_lshlrev_b32 v40, 16, v78
  v_and_b32 v41, s7, v78
  v_pk_add_f32 v[36:37], v[36:37], v[40:41]
  v_lshlrev_b32 v40, 16, v79
  v_and_b32 v41, s7, v79
  v_pk_add_f32 v[38:39], v[38:39], v[40:41]
  v_lshlrev_b32 v40, 16, v80
  v_and_b32 v41, s7, v80
  v_pk_add_f32 v[32:33], v[32:33], v[40:41]
  v_lshlrev_b32 v40, 16, v81
  v_and_b32 v41, s7, v81
  v_pk_add_f32 v[34:35], v[34:35], v[40:41]
  v_lshlrev_b32 v40, 16, v82
  v_and_b32 v41, s7, v82
  v_pk_add_f32 v[36:37], v[36:37], v[40:41]
  v_lshlrev_b32 v40, 16, v83
  v_and_b32 v41, s7, v83
  v_pk_add_f32 v[38:39], v[38:39], v[40:41]
  v_lshlrev_b32 v40, 16, v84
  v_and_b32 v41, s7, v84
  v_pk_add_f32 v[32:33], v[32:33], v[40:41]
  v_lshlrev_b32 v40, 16, v85
  v_and_b32 v41, s7, v85
  v_pk_add_f32 v[34:35], v[34:35], v[40:41]
  v_lshlrev_b32 v40, 16, v86
  v_and_b32 v41, s7, v86
  v_pk_add_f32 v[36:37], v[36:37], v[40:41]
  v_lshlrev_b32 v40, 16, v87
  v_and_b32 v41, s7, v87
  v_pk_add_f32 v[38:39], v[38:39], v[40:41]
  v_lshlrev_b32 v40, 16, v88
  v_and_b32 v41, s7, v88
  v_pk_add_f32 v[32:33], v[32:33], v[40:41]
  v_lshlrev_b32 v40, 16, v89
  v_and_b32 v41, s7, v89
  v_pk_add_f32 v[34:35], v[34:35], v[40:41]
  v_lshlrev_b32 v40, 16, v90
  v_and_b32 v41, s7, v90
  v_pk_add_f32 v[36:37], v[36:37], v[40:41]
  v_lshlrev_b32 v40, 16, v91
  v_and_b32 v41, s7, v91
  v_pk_add_f32 v[38:39], v[38:39], v[40:41]
  v_lshlrev_b32 v40, 16, v92
  v_and_b32 v41, s7, v92
  v_pk_add_f32 v[32:33], v[32:33], v[40:41]
  v_lshlrev_b32 v40, 16, v93
  v_and_b32 v41, s7, v93
  v_pk_add_f32 v[34:35], v[34:35], v[40:41]
  v_lshlrev_b32 v40, 16, v94
  v_and_b32 v41, s7, v94
  v_pk_add_f32 v[36:37], v[36:37], v[40:41]
  v_lshlrev_b32 v40, 16, v95
  v_and_b32 v41, s7, v95
  v_pk_add_f32 v[38:39], v[38:39], v[40:41]
  s_add_u32 s52, s22, 24641536
  s_addc_u32 s53, s23, 0
  s_and_b32 s53, s53, 0xffff
  s_mov_b32 s54, 262144
  s_mov_b32 s55, 0x00020000
  v_permlane32_swap_b32 v32, v36
  v_permlane32_swap_b32 v33, v37
  v_permlane32_swap_b32 v34, v38
  v_permlane32_swap_b32 v35, v39
  v_add_f32 v32, v32, v36
  v_add_f32 v33, v33, v37
  v_add_f32 v34, v34, v38
  v_add_f32 v35, v35, v39
  v_and_b32 v2, 7, v1
  v_lshlrev_b32 v2, 5, v2
  v_permlane16_swap_b32 v32, v34
  v_permlane16_swap_b32 v33, v35
  v_add_f32 v32, v32, v34
  v_add_f32 v33, v33, v35
  v_lshrrev_b32 v3, 4, v1
  v_lshl_add_u32 v2, v3, 3, v2
  v_add_f32_dpp v32, v32, v32 row_ror:8 row_mask:0xf bank_mask:0xf
  v_add_f32_dpp v33, v33, v33 row_ror:8 row_mask:0xf bank_mask:0xf
  buffer_store_dwordx2 v[32:33], v2, s[52:55], s94 offen sc1
  s_waitcnt vmcnt(0)
L_wo_nofirst:
  s_lshl_b32 s3, s97, 12
  s_lshl_b32 s4, s68, 8
  s_add_u32 s3, s3, s4
  s_sub_u32 s3, s3, 4096
  v_and_b32 v2, 15, v1
  v_lshlrev_b32 v2, 2, v2
  v_mov_b32 v3, 1
  s_mov_b32 s79, 0x100000
  s_cmp_lg_u32 s70, 4
  s_barrier
  s_cbranch_scc1 L_wo_nofl
  s_mov_b64 exec, 1
  buffer_store_dword v3, off, s[44:47], s87 sc1
  s_mov_b64 exec, -1
L_wo_nofl:
  s_mov_b32 s5, s3
  s_bfe_i32 s74, s85, 0x80010
  s_add_i32 s74, s74, 6
  s_add_u32 s74, s74, s86
  s_and_b32 s74, s74, 15
  s_lshl_b32 s74, s74, 17
  s_add_u32 m0, s77, 45056
  s_add_u32 s4, s74, 0
  buffer_load_dwordx4 v8, s[40:43], s4 offen lds
  s_add_u32 m0, s77, 46080
  s_nop 0
  buffer_load_dwordx4 v9, s[40:43], s4 offen lds
  s_bfe_i32 s74, s85, 0x80018
  s_add_i32 s74, s74, 7
  s_add_u32 s74, s74, s86
  s_and_b32 s74, s74, 15
  s_lshl_b32 s74, s74, 17
  s_add_u32 m0, s77, 53248
  s_add_u32 s4, s74, 0
  buffer_load_dwordx4 v8, s[40:43], s4 offen lds
  s_add_u32 m0, s77, 54272
  s_nop 0
  buffer_load_dwordx4 v9, s[40:43], s4 offen lds
  s_bfe_i32 s74, s85, 0x80000
  s_add_i32 s74, s74, 8
  s_add_u32 s74, s74, s86
  s_and_b32 s74, s74, 15
  s_lshl_b32 s74, s74, 17
  s_add_u32 m0, s77, 61440
  s_add_u32 s4, s74, 0
  buffer_load_dwordx4 v8, s[40:43], s4 offen lds
  s_add_u32 m0, s77, 62464
  s_nop 0
  buffer_load_dwordx4 v9, s[40:43], s4 offen lds
  s_bfe_i32 s74, s85, 0x80008
  s_add_i32 s74, s74, 9
  s_add_u32 s74, s74, s86
  s_and_b32 s74, s74, 15
  s_lshl_b32 s74, s74, 17
  s_add_u32 m0, s77, 69632
  s_add_u32 s4, s74, 0
  buffer_load_dwordx4 v8, s[40:43], s4 offen lds
  s_add_u32 m0, s77, 70656
  s_nop 0
  buffer_load_dwordx4 v9, s[40:43], s4 offen lds
  s_bfe_i32 s74, s85, 0x80010
  s_add_i32 s74, s74, 10
  s_add_u32 s74, s74, s86
  s_and_b32 s74, s74, 15
  s_lshl_b32 s74, s74, 17
  s_add_u32 m0, s77, 77824
  s_add_u32 s4, s74, 0
  buffer_load_dwordx4 v8, s[40:43], s4 offen lds
  s_add_u32 m0, s77, 78848
  s_nop 0
  buffer_load_dwordx4 v9, s[40:43], s4 offen lds
  s_bfe_i32 s74, s85, 0x80018
  s_add_i32 s74, s74, 11
  s_add_u32 s74, s74, s86
  s_and_b32 s74, s74, 15
  s_lshl_b32 s74, s74, 17
  s_add_u32 m0, s77, 86016
  s_add_u32 s4, s74, 0
  buffer_load_dwordx4 v8, s[40:43], s4 offen lds
  s_add_u32 m0, s77, 87040
  s_nop 0
  buffer_load_dwordx4 v9, s[40:43], s4 offen lds
  s_bfe_i32 s74, s85, 0x80000
  s_add_i32 s74, s74, 12
  s_add_u32 s74, s74, s86
  s_and_b32 s74, s74, 15
  s_lshl_b32 s74, s74, 17
  s_add_u32 m0, s77, 94208
  s_add_u32 s4, s74, 0
  buffer_load_dwordx4 v8, s[40:43], s4 offen lds
  s_add_u32 m0, s77, 95232
  s_nop 0
  buffer_load_dwordx4 v9, s[40:43], s4 offen lds
  s_bfe_i32 s74, s85, 0x80008
  s_add_i32 s74, s74, 13
  s_sub_u32 s3, s74, 16
  s_cmp_ge_i32 s74, 16
  s_cselect_b32 s74, s3, s74
  s_add_u32 s74, s74, s86
  s_and_b32 s74, s74, 15
  s_lshl_b32 s74, s74, 17
  s_add_u32 m0, s77, 102400
  s_add_u32 s4, s74, 0
  buffer_load_dwordx4 v8, s[40:43], s4 offen lds
  s_add_u32 m0, s77, 103424
  s_nop 0
  buffer_load_dwordx4 v9, s[40:43], s4 offen lds
  s_bfe_i32 s74, s85, 0x80010
  s_add_i32 s74, s74, 14
  s_sub_u32 s3, s74, 16
  s_cmp_ge_i32 s74, 16
  s_cselect_b32 s74, s3, s74
  s_add_u32 s74, s74, s86
  s_and_b32 s74, s74, 15
  s_lshl_b32 s74, s74, 17
  s_add_u32 m0, s77, 110592
  s_add_u32 s4, s74, 0
  buffer_load_dwordx4 v8, s[40:43], s4 offen lds
  s_add_u32 m0, s77, 111616
  s_nop 0
  buffer_load_dwordx4 v9, s[40:43], s4 offen lds
  s_bfe_i32 s74, s85, 0x80018
  s_add_i32 s74, s74, 15
  s_sub_u32 s3, s74, 16
  s_cmp_ge_i32 s74, 16
  s_cselect_b32 s74, s3, s74
  s_add_u32 s74, s74, s86
  s_and_b32 s74, s74, 15
  s_lshl_b32 s74, s74, 17
  s_add_u32 m0, s77, 118784
  s_add_u32 s4, s74, 0
  buffer_load_dwordx4 v8, s[40:43], s4 offen lds
  s_add_u32 m0, s77, 119808
  s_nop 0
  buffer_load_dwordx4 v9, s[40:43], s4 offen lds
  s_mov_b32 s3, s5
  s_cmp_lg_u32 s70, 4
  s_cbranch_scc1 L_wo_dep
L_wo_poll:
  buffer_load_dword v3, v2, s[44:47], s3 offen sc1
  s_sub_u32 s79, s79, 1
  s_cbranch_scc1 L_wo_dep
  s_waitcnt vmcnt(0)
  v_cmp_ne_u32 vcc, 1, v3
  s_cbranch_vccnz L_wo_poll
L_wo_dep:
  s_waitcnt vmcnt(24) lgkmcnt(0)
  s_barrier
  s_waitcnt vmcnt(16)
  s_barrier
  s_waitcnt vmcnt(8)
  s_barrier
  s_mov_b32 s48, s12
  s_and_b32 s49, s13, 0xffff
  s_mov_b32 s50, 4194304
  s_mov_b32 s51, 0x00020000
  s_cmp_eq_u32 s96, 1
  s_cselect_b32 s50, 128, 0
  s_add_u32 s50, s50, 2048
  s_lshl_b32 s50, s50, 11
  v_lshrrev_b32 v3, 3, v1
  s_lshr_b32 s10, s76, 7
  s_lshl_b32 s3, s68, 7
  s_add_u32 s10, s10, s3
  v_add_u32 v3, s10, v3
  s_cmp_eq_u32 s96, 1
  s_cselect_b32 s5, 128, 0
  s_add_u32 s5, s5, 2048
  s_lshl_b32 s6, s5, 3
  v_mul_u32_u24 v3, s5, v3
  v_lshrrev_b32 v2, 4, v1
  v_xor_b32 v4, v2, v10
  v_lshl_add_u32 v4, v4, 4, v3
  v_add_u32 v3, s6, v3
  v_add_u32 v5, 4, v2
  v_xor_b32 v5, v5, v10
  v_lshl_add_u32 v5, v5, 4, v3
  v_add_u32 v3, s6, v3
  v_xor_b32 v6, v2, v10
  v_lshl_add_u32 v6, v6, 4, v3
  v_add_u32 v3, s6, v3
  v_add_u32 v7, 4, v2
  v_xor_b32 v7, v7, v10
  v_lshl_add_u32 v7, v7, 4, v3
  s_lshl_b32 s4, s69, 7
  s_add_u32 m0, s76, 0
  s_nop 0
  buffer_load_dwordx4 v4, s[48:51], s4 offen lds
  s_add_u32 m0, s76, 1024
  s_nop 0
  buffer_load_dwordx4 v5, s[48:51], s4 offen lds
  s_add_u32 m0, s76, 2048
  s_nop 0
  buffer_load_dwordx4 v6, s[48:51], s4 offen lds
  s_add_u32 m0, s76, 3072
  s_nop 0
  buffer_load_dwordx4 v7, s[48:51], s4 offen lds
  s_waitcnt vmcnt(4)
  s_barrier
  s_waitcnt vmcnt(0)
  s_barrier
  s_lshl_b32 s87, s97, 12
  s_lshl_b32 s4, s68, 8
  s_add_u32 s87, s87, s4
  s_lshl_b32 s4, s69, 2
  s_add_u32 s87, s87, s4
  s_add_u32 s97, s97, 1
  s_branch L_w1_body
L_wo_end:
  s_endpgm
L_wo_compute:
  v_and_b32 v3, 15, v1
  v_lshrrev_b32 v2, 4, v1
  s_lshl_b32 s8, s68, 7
  s_lshl_b32 s9, s70, 5
  s_add_u32 s8, s8, s9
  s_mul_i32 s9, s8, 2048
  v_lshl_add_u32 v4, v1, 4, s9
  v_add_u32 v5, 32768, v4
  v_add_u32 v13, s8, v3
  s_lshl_b32 s10, s69, 7
  v_lshl_add_u32 v14, v2, 3, s10
  v_and_b32 v16, 1, v2
  v_lshrrev_b32 v17, 1, v2
  v_lshl_add_u32 v16, v16, 1, v17
  v_lshlrev_b32 v16, 8, v16
  v_lshl_add_u32 v16, v3, 4, v16
  s_add_u32 s9, s8, s69
  s_lshl_b32 s9, s9, 11
  v_add_u32 v12, s9, v16
  v_lshl_add_u32 v18, v17, 4, v13
  v_lshlrev_b32 v18, 3, v18
  v_and_b32 v16, 1, v2
  v_lshl_add_u32 v18, v16, 2, v18
  s_lshl_b32 s10, s69, 14
  v_add_u32 v18, s10, v18
  v_bfe_u32 v6, v1, 2, 2
  v_lshl_add_u32 v6, v2, 3, v6
  v_lshlrev_b32 v6, 7, v6
  v_and_b32 v17, 3, v1
  v_lshl_add_u32 v6, v17, 3, v6
  v_bfe_u32 v17, v1, 3, 2
  v_lshl_add_u32 v6, v17, 5, v6
  v_xor_b32 v7, 32, v6
  v_xor_b32 v8, 64, v6
  v_xor_b32 v9, 96, v6
  v_lshrrev_b32 v15, 1, v2
  v_lshrrev_b32 v17, 1, v3
  v_xor_b32 v15, v15, v17
  v_lshlrev_b32 v15, 4, v15
  v_lshl_add_u32 v15, v3, 7, v15
  v_lshl_add_u32 v15, v16, 3, v15
  s_lshl_b32 s8, s70, 12
  v_add_u32 v15, s8, v15
  s_mov_b32 s11, 0xffff0000
  s_mov_b32 s75, 131072
  s_add_u32 s3, s68, s69
  s_lshl_b32 s3, s3, 3
  s_lshl_b32 s8, 0xffff02, s3
  s_sub_u32 s3, 0, s3
  s_lshr_b32 s3, 0xffff02, s3
  s_or_b32 s8, s8, s3
  s_bfe_i32 s64, s8, 0x80000
  s_add_i32 s64, s64, 0
  s_cmp_lt_i32 s64, 0
  s_cselect_b32 s64, 15, s64
  s_lshl_b32 s64, s64, 11
  s_bfe_i32 s65, s8, 0x80008
  s_add_i32 s65, s65, 1
  s_lshl_b32 s65, s65, 11
  s_bfe_i32 s66, s8, 0x80010
  s_add_i32 s66, s66, 2
  s_lshl_b32 s66, s66, 11
  s_bfe_i32 s67, s8, 0x80018
  s_add_i32 s67, s67, 3
  s_lshl_b32 s67, s67, 11
  s_and_b32 s100, s68, 3
  s_lshl_b32 s100, s100, 13
  s_mov_b32 s101, s100
  v_mov_b32 v224, 0
  v_mov_b32 v225, 0
  v_mov_b32 v226, 0
  v_mov_b32 v227, 0
  v_mov_b32 v228, 0
  v_mov_b32 v229, 0
  v_mov_b32 v230, 0
  v_mov_b32 v231, 0
  v_mov_b32 v232, 0
  v_mov_b32 v233, 0
  v_mov_b32 v234, 0
  v_mov_b32 v235, 0
  v_mov_b32 v236, 0
  v_mov_b32 v237, 0
  v_mov_b32 v238, 0
  v_mov_b32 v239, 0
  v_mov_b32 v240, 0
  v_mov_b32 v241, 0
  v_mov_b32 v242, 0
  v_mov_b32 v243, 0
  v_mov_b32 v244, 0
  v_mov_b32 v245, 0
  v_mov_b32 v246, 0
  v_mov_b32 v247, 0
  v_mov_b32 v248, 0
  v_mov_b32 v249, 0
  v_mov_b32 v250, 0
  v_mov_b32 v251, 0
  v_mov_b32 v252, 0
  v_mov_b32 v253, 0
  v_mov_b32 v254, 0
  v_mov_b32 v255, 0
  s_mov_b32 s36, s34
  s_and_b32 s37, s35, 0xffff
  s_mov_b32 s38, 4194304
  s_mov_b32 s39, 0x00020000
  s_add_u32 s44, s34, 4194304
  s_addc_u32 s45, s35, 0
  s_and_b32 s45, s45, 0xffff
  s_mov_b32 s46, 4194304
  s_mov_b32 s47, 0x00020000
  s_add_u32 s56, s34, 24117248
  s_addc_u32 s57, s35, 0
  s_and_b32 s57, s57, 0xffff
  s_mov_b32 s58, 262144
  s_mov_b32 s59, 0x00020000
  s_cmp_lg_u32 s96, 0
  s_cbranch_scc1 L_pfc2_skip
  s_getpc_b64 s[4:5]
L_pfc2:
  s_lshl_b32 s3, s99, 2
  s_add_u32 s3, s3, s70
  s_mul_i32 s3, s3, 128
  s_min_u32 s3, s3, L_w1_c1-L_w1_c0-128
  s_add_i32 s3, s3, L_w1_c0-L_pfc2
  s_ashr_i32 s6, s3, 31
  s_add_u32 s4, s4, s3
  s_addc_u32 s5, s5, s6
  s_load_dword s40, s[4:5], 0
  s_load_dword s41, s[4:5], 64
L_pfc2_skip:
  v_add_u32_e64 v26, s75, v6
  v_add_u32_e64 v27, s75, v7
  v_add_u32_e64 v28, s75, v8
  v_add_u32_e64 v29, s75, v9
  s_add_u32 s75, s75, 32768
  s_cmp_eq_u32 s75, 163840
  s_cselect_b32 s75, 28672, s75
  s_mov_b32 s79, 4
  s_add_u32 s73, s101, s64
  s_and_b32 s73, s73, 0x7fff
  s_mov_b32 s48, s73
  s_add_u32 s73, s101, s65
  s_and_b32 s73, s73, 0x7fff
  s_mov_b32 s49, s73
  s_add_u32 s73, s101, s66
  s_and_b32 s73, s73, 0x7fff
  s_mov_b32 s50, s73
  s_waitcnt lgkmcnt(0)
  s_barrier
  buffer_load_dwordx4 v[32:35], v4, s[36:39], s48 offen offset:0
  buffer_load_dwordx4 v[40:43], v4, s[36:39], s48 offen offset:1024
  buffer_load_dwordx4 v[36:39], v5, s[36:39], s48 offen offset:0
  buffer_load_dwordx4 v[44:47], v5, s[36:39], s48 offen offset:1024
  buffer_load_dwordx4 v[48:51], v4, s[36:39], s49 offen offset:0
  buffer_load_dwordx4 v[56:59], v4, s[36:39], s49 offen offset:1024
  buffer_load_dwordx4 v[52:55], v5, s[36:39], s49 offen offset:0
  buffer_load_dwordx4 v[60:63], v5, s[36:39], s49 offen offset:1024
  buffer_load_dwordx4 v[64:67], v4, s[36:39], s50 offen offset:0
  buffer_load_dwordx4 v[72:75], v4, s[36:39], s50 offen offset:1024
  buffer_load_dwordx4 v[68:71], v5, s[36:39], s50 offen offset:0
  buffer_load_dwordx4 v[76:79], v5, s[36:39], s50 offen offset:1024
  ds_read_b64_tr_b16 v[160:161], v26 offset:0
  ds_read_b64_tr_b16 v[162:163], v26 offset:512
  ds_read_b64_tr_b16 v[164:165], v27 offset:0
  ds_read_b64_tr_b16 v[166:167], v27 offset:512
  ds_read_b64_tr_b16 v[168:169], v28 offset:0
  ds_read_b64_tr_b16 v[170:171], v28 offset:512
  ds_read_b64_tr_b16 v[172:173], v29 offset:0
  ds_read_b64_tr_b16 v[174:175], v29 offset:512
  ds_read_b64_tr_b16 v[176:177], v26 offset:4096
  ds_read_b64_tr_b16 v[178:179], v26 offset:4608
  ds_read_b64_tr_b16 v[180:181], v27 offset:4096
  ds_read_b64_tr_b16 v[182:183], v27 offset:4608
  ds_read_b64_tr_b16 v[184:185], v28 offset:4096
  ds_read_b64_tr_b16 v[186:187], v28 offset:4608
  ds_read_b64_tr_b16 v[188:189], v29 offset:4096
  ds_read_b64_tr_b16 v[190:191], v29 offset:4608
.p2align 3
L_wo_loop:
  s_waitcnt vmcnt(8) lgkmcnt(0)
  v_mfma_f32_16x16x32_bf16 v[224:227], v[160:163], v[32:35], v[224:227]
  ds_read_b64_tr_b16 v[192:193], v26 offset:8192
  ds_read_b64_tr_b16 v[194:195], v26 offset:8704
  v_mfma_f32_16x16x32_bf16 v[228:231], v[160:163], v[36:39], v[228:231]
  ds_read_b64_tr_b16 v[196:197], v27 offset:8192
  ds_read_b64_tr_b16 v[198:199], v27 offset:8704
  v_mfma_f32_16x16x32_bf16 v[232:235], v[164:167], v[32:35], v[232:235]
  ds_read_b64_tr_b16 v[200:201], v28 offset:8192
  ds_read_b64_tr_b16 v[202:203], v28 offset:8704
  v_mfma_f32_16x16x32_bf16 v[236:239], v[164:167], v[36:39], v[236:239]
  ds_read_b64_tr_b16 v[204:205], v29 offset:8192
  ds_read_b64_tr_b16 v[206:207], v29 offset:8704
  v_mfma_f32_16x16x32_bf16 v[240:243], v[168:171], v[32:35], v[240:243]
  ds_read_b64_tr_b16 v[208:209], v26 offset:12288
  ds_read_b64_tr_b16 v[210:211], v26 offset:12800
  v_mfma_f32_16x16x32_bf16 v[244:247], v[168:171], v[36:39], v[244:247]
  ds_read_b64_tr_b16 v[212:213], v27 offset:12288
  ds_read_b64_tr_b16 v[214:215], v27 offset:12800
  v_mfma_f32_16x16x32_bf16 v[248:251], v[172:175], v[32:35], v[248:251]
  ds_read_b64_tr_b16 v[216:217], v28 offset:12288
  ds_read_b64_tr_b16 v[218:219], v28 offset:12800
  v_mfma_f32_16x16x32_bf16 v[252:255], v[172:175], v[36:39], v[252:255]
  ds_read_b64_tr_b16 v[220:221], v29 offset:12288
  ds_read_b64_tr_b16 v[222:223], v29 offset:12800
  v_mfma_f32_16x16x32_bf16 v[224:227], v[176:179], v[40:43], v[224:227]
  s_add_u32 s73, s101, s67
  s_and_b32 s73, s73, 0x7fff
  v_mfma_f32_16x16x32_bf16 v[228:231], v[176:179], v[44:47], v[228:231]
  buffer_load_dwordx4 v[80:83], v4, s[36:39], s73 offen offset:0
  v_mfma_f32_16x16x32_bf16 v[232:235], v[180:183], v[40:43], v[232:235]
  buffer_load_dwordx4 v[88:91], v4, s[36:39], s73 offen offset:1024
  v_mfma_f32_16x16x32_bf16 v[236:239], v[180:183], v[44:47], v[236:239]
  buffer_load_dwordx4 v[84:87], v5, s[36:39], s73 offen offset:0
  v_mfma_f32_16x16x32_bf16 v[240:243], v[184:187], v[40:43], v[240:243]
  buffer_load_dwordx4 v[92:95], v5, s[36:39], s73 offen offset:1024
  v_mfma_f32_16x16x32_bf16 v[244:247], v[184:187], v[44:47], v[244:247]
  s_add_u32 s101, s101, 8192
  v_mfma_f32_16x16x32_bf16 v[248:251], v[188:191], v[40:43], v[248:251]
  s_sub_u32 s79, s79, 1
  s_cmp_eq_u32 s79, 0
  s_cselect_b32 s38, 0, s38
  v_mfma_f32_16x16x32_bf16 v[252:255], v[188:191], v[44:47], v[252:255]
  s_waitcnt vmcnt(8) lgkmcnt(0)
  v_mfma_f32_16x16x32_bf16 v[224:227], v[192:195], v[48:51], v[224:227]
  ds_read_b64_tr_b16 v[160:161], v26 offset:16384
  ds_read_b64_tr_b16 v[162:163], v26 offset:16896
  v_mfma_f32_16x16x32_bf16 v[228:231], v[192:195], v[52:55], v[228:231]
  ds_read_b64_tr_b16 v[164:165], v27 offset:16384
  ds_read_b64_tr_b16 v[166:167], v27 offset:16896
  v_mfma_f32_16x16x32_bf16 v[232:235], v[196:199], v[48:51], v[232:235]
  ds_read_b64_tr_b16 v[168:169], v28 offset:16384
  ds_read_b64_tr_b16 v[170:171], v28 offset:16896
  v_mfma_f32_16x16x32_bf16 v[236:239], v[196:199], v[52:55], v[236:239]
  ds_read_b64_tr_b16 v[172:173], v29 offset:16384
  ds_read_b64_tr_b16 v[174:175], v29 offset:16896
  v_mfma_f32_16x16x32_bf16 v[240:243], v[200:203], v[48:51], v[240:243]
  ds_read_b64_tr_b16 v[176:177], v26 offset:20480
  ds_read_b64_tr_b16 v[178:179], v26 offset:20992
  v_mfma_f32_16x16x32_bf16 v[244:247], v[200:203], v[52:55], v[244:247]
  ds_read_b64_tr_b16 v[180:181], v27 offset:20480
  ds_read_b64_tr_b16 v[182:183], v27 offset:20992
  v_mfma_f32_16x16x32_bf16 v[248:251], v[204:207], v[48:51], v[248:251]
  ds_read_b64_tr_b16 v[184:185], v28 offset:20480
  ds_read_b64_tr_b16 v[186:187], v28 offset:20992
  v_mfma_f32_16x16x32_bf16 v[252:255], v[204:207], v[52:55], v[252:255]
  ds_read_b64_tr_b16 v[188:189], v29 offset:20480
  ds_read_b64_tr_b16 v[190:191], v29 offset:20992
  v_mfma_f32_16x16x32_bf16 v[224:227], v[208:211], v[56:59], v[224:227]
  s_add_u32 s73, s101, s64
  s_and_b32 s73, s73, 0x7fff
  v_mfma_f32_16x16x32_bf16 v[228:231], v[208:211], v[60:63], v[228:231]
  buffer_load_dwordx4 v[32:35], v4, s[36:39], s73 offen offset:0
  v_mfma_f32_16x16x32_bf16 v[232:235], v[212:215], v[56:59], v[232:235]
  buffer_load_dwordx4 v[40:43], v4, s[36:39], s73 offen offset:1024
  v_mfma_f32_16x16x32_bf16 v[236:239], v[212:215], v[60:63], v[236:239]
  buffer_load_dwordx4 v[36:39], v5, s[36:39], s73 offen offset:0
  v_mfma_f32_16x16x32_bf16 v[240:243], v[216:219], v[56:59], v[240:243]
  buffer_load_dwordx4 v[44:47], v5, s[36:39], s73 offen offset:1024
  v_mfma_f32_16x16x32_bf16 v[244:247], v[216:219], v[60:63], v[244:247]
  v_mfma_f32_16x16x32_bf16 v[248:251], v[220:223], v[56:59], v[248:251]
  v_mfma_f32_16x16x32_bf16 v[252:255], v[220:223], v[60:63], v[252:255]
  s_waitcnt vmcnt(8) lgkmcnt(0)
  v_mfma_f32_16x16x32_bf16 v[224:227], v[160:163], v[64:67], v[224:227]
  ds_read_b64_tr_b16 v[192:193], v26 offset:24576
  ds_read_b64_tr_b16 v[194:195], v26 offset:25088
  v_mfma_f32_16x16x32_bf16 v[228:231], v[160:163], v[68:71], v[228:231]
  ds_read_b64_tr_b16 v[196:197], v27 offset:24576
  ds_read_b64_tr_b16 v[198:199], v27 offset:25088
  v_mfma_f32_16x16x32_bf16 v[232:235], v[164:167], v[64:67], v[232:235]
  ds_read_b64_tr_b16 v[200:201], v28 offset:24576
  ds_read_b64_tr_b16 v[202:203], v28 offset:25088
  v_mfma_f32_16x16x32_bf16 v[236:239], v[164:167], v[68:71], v[236:239]
  ds_read_b64_tr_b16 v[204:205], v29 offset:24576
  ds_read_b64_tr_b16 v[206:207], v29 offset:25088
  v_mfma_f32_16x16x32_bf16 v[240:243], v[168:171], v[64:67], v[240:243]
  ds_read_b64_tr_b16 v[208:209], v26 offset:28672
  ds_read_b64_tr_b16 v[210:211], v26 offset:29184
  v_mfma_f32_16x16x32_bf16 v[244:247], v[168:171], v[68:71], v[244:247]
  ds_read_b64_tr_b16 v[212:213], v27 offset:28672
  ds_read_b64_tr_b16 v[214:215], v27 offset:29184
  v_mfma_f32_16x16x32_bf16 v[248:251], v[172:175], v[64:67], v[248:251]
  ds_read_b64_tr_b16 v[216:217], v28 offset:28672
  ds_read_b64_tr_b16 v[218:219], v28 offset:29184
  v_mfma_f32_16x16x32_bf16 v[252:255], v[172:175], v[68:71], v[252:255]
  ds_read_b64_tr_b16 v[220:221], v29 offset:28672
  ds_read_b64_tr_b16 v[222:223], v29 offset:29184
  v_mfma_f32_16x16x32_bf16 v[224:227], v[176:179], v[72:75], v[224:227]
  s_add_u32 s73, s101, s65
  s_and_b32 s73, s73, 0x7fff
  v_mfma_f32_16x16x32_bf16 v[228:231], v[176:179], v[76:79], v[228:231]
  buffer_load_dwordx4 v[48:51], v4, s[36:39], s73 offen offset:0
  v_mfma_f32_16x16x32_bf16 v[232:235], v[180:183], v[72:75], v[232:235]
  buffer_load_dwordx4 v[56:59], v4, s[36:39], s73 offen offset:1024
  v_mfma_f32_16x16x32_bf16 v[236:239], v[180:183], v[76:79], v[236:239]
  buffer_load_dwordx4 v[52:55], v5, s[36:39], s73 offen offset:0
  v_mfma_f32_16x16x32_bf16 v[240:243], v[184:187], v[72:75], v[240:243]
  buffer_load_dwordx4 v[60:63], v5, s[36:39], s73 offen offset:1024
  v_mfma_f32_16x16x32_bf16 v[244:247], v[184:187], v[76:79], v[244:247]
  v_mfma_f32_16x16x32_bf16 v[248:251], v[188:191], v[72:75], v[248:251]
  v_mfma_f32_16x16x32_bf16 v[252:255], v[188:191], v[76:79], v[252:255]
  s_waitcnt vmcnt(8) lgkmcnt(0)
  s_barrier
  v_mfma_f32_16x16x32_bf16 v[224:227], v[192:195], v[80:83], v[224:227]
  v_add_u32_e64 v26, s75, v6
  v_add_u32_e64 v27, s75, v7
  v_add_u32_e64 v28, s75, v8
  v_mfma_f32_16x16x32_bf16 v[228:231], v[192:195], v[84:87], v[228:231]
  v_add_u32_e64 v29, s75, v9
  s_add_u32 s75, s75, 32768
  s_cmp_eq_u32 s75, 163840
  v_mfma_f32_16x16x32_bf16 v[232:235], v[196:199], v[80:83], v[232:235]
  s_cselect_b32 s75, 28672, s75
  ds_read_b64_tr_b16 v[160:161], v26 offset:0
  ds_read_b64_tr_b16 v[162:163], v26 offset:512
  v_mfma_f32_16x16x32_bf16 v[236:239], v[196:199], v[84:87], v[236:239]
  ds_read_b64_tr_b16 v[164:165], v27 offset:0
  ds_read_b64_tr_b16 v[166:167], v27 offset:512
  ds_read_b64_tr_b16 v[168:169], v28 offset:0
  v_mfma_f32_16x16x32_bf16 v[240:243], v[200:203], v[80:83], v[240:243]
  ds_read_b64_tr_b16 v[170:171], v28 offset:512
  ds_read_b64_tr_b16 v[172:173], v29 offset:0
  ds_read_b64_tr_b16 v[174:175], v29 offset:512
  v_mfma_f32_16x16x32_bf16 v[244:247], v[200:203], v[84:87], v[244:247]
  ds_read_b64_tr_b16 v[176:177], v26 offset:4096
  ds_read_b64_tr_b16 v[178:179], v26 offset:4608
  ds_read_b64_tr_b16 v[180:181], v27 offset:4096
  v_mfma_f32_16x16x32_bf16 v[248:251], v[204:207], v[80:83], v[248:251]
  ds_read_b64_tr_b16 v[182:183], v27 offset:4608
  ds_read_b64_tr_b16 v[184:185], v28 offset:4096
  ds_read_b64_tr_b16 v[186:187], v28 offset:4608
  v_mfma_f32_16x16x32_bf16 v[252:255], v[204:207], v[84:87], v[252:255]
  ds_read_b64_tr_b16 v[188:189], v29 offset:4096
  ds_read_b64_tr_b16 v[190:191], v29 offset:4608
  v_mfma_f32_16x16x32_bf16 v[224:227], v[208:211], v[88:91], v[224:227]
  s_add_u32 s73, s101, s66
  s_and_b32 s73, s73, 0x7fff
  v_mfma_f32_16x16x32_bf16 v[228:231], v[208:211], v[92:95], v[228:231]
  buffer_load_dwordx4 v[64:67], v4, s[36:39], s73 offen offset:0
  v_mfma_f32_16x16x32_bf16 v[232:235], v[212:215], v[88:91], v[232:235]
  buffer_load_dwordx4 v[72:75], v4, s[36:39], s73 offen offset:1024
  v_mfma_f32_16x16x32_bf16 v[236:239], v[212:215], v[92:95], v[236:239]
  buffer_load_dwordx4 v[68:71], v5, s[36:39], s73 offen offset:0
  v_mfma_f32_16x16x32_bf16 v[240:243], v[216:219], v[88:91], v[240:243]
  buffer_load_dwordx4 v[76:79], v5, s[36:39], s73 offen offset:1024
  v_mfma_f32_16x16x32_bf16 v[244:247], v[216:219], v[92:95], v[244:247]
  s_cmp_lg_u32 s79, 0
  v_mfma_f32_16x16x32_bf16 v[248:251], v[220:223], v[88:91], v[248:251]
  v_mfma_f32_16x16x32_bf16 v[252:255], v[220:223], v[92:95], v[252:255]
  s_cbranch_scc1 L_wo_loop
  s_waitcnt lgkmcnt(0)
  v_xor_b32 v27, 32, v15
  v_xor_b32 v28, 64, v15
  v_xor_b32 v29, 96, v15
  ds_read_b64 v[160:161], v15 offset:0
  ds_read_b64 v[164:165], v27 offset:0
  ds_read_b64 v[168:169], v28 offset:0
  ds_read_b64 v[172:173], v29 offset:0
  ds_read_b64 v[162:163], v15 offset:2048
  ds_read_b64 v[166:167], v27 offset:2048
  ds_read_b64 v[170:171], v28 offset:2048
  ds_read_b64 v[174:175], v29 offset:2048
  v_mov_b32 v20, 0
  v_mov_b32 v21, 0
  v_mov_b32 v22, 0
  v_mov_b32 v23, 0
  s_mov_b32 s3, 32768
  s_mov_b32 s10, 0x3f803f80
  s_waitcnt lgkmcnt(7)
  v_lshlrev_b32 v6, 16, v160
  v_and_b32 v7, s11, v160
  v_lshlrev_b32 v8, 16, v161
  v_and_b32 v9, s11, v161
  v_pk_add_f32 v[224:225], v[224:225], v[6:7]
  v_pk_add_f32 v[226:227], v[226:227], v[8:9]
  v_cvt_pk_bf16_f32 v176, v224, v225
  v_cvt_pk_bf16_f32 v177, v226, v227
  s_waitcnt lgkmcnt(6)
  v_lshlrev_b32 v6, 16, v164
  v_and_b32 v7, s11, v164
  v_lshlrev_b32 v8, 16, v165
  v_and_b32 v9, s11, v165
  v_pk_add_f32 v[232:233], v[232:233], v[6:7]
  v_pk_add_f32 v[234:235], v[234:235], v[8:9]
  v_cvt_pk_bf16_f32 v178, v232, v233
  v_cvt_pk_bf16_f32 v179, v234, v235
  s_nop 1
  v_permlane16_swap_b32 v176, v178
  v_permlane16_swap_b32 v177, v179
  buffer_store_dwordx4 v[176:179], v12, s[44:47], 0 offen offset:0 sc1
  s_waitcnt lgkmcnt(5)
  v_lshlrev_b32 v6, 16, v168
  v_and_b32 v7, s11, v168
  v_lshlrev_b32 v8, 16, v169
  v_and_b32 v9, s11, v169
  v_pk_add_f32 v[240:241], v[240:241], v[6:7]
  v_pk_add_f32 v[242:243], v[242:243], v[8:9]
  v_cvt_pk_bf16_f32 v180, v240, v241
  v_cvt_pk_bf16_f32 v181, v242, v243
  s_waitcnt lgkmcnt(4)
  v_lshlrev_b32 v6, 16, v172
  v_and_b32 v7, s11, v172
  v_lshlrev_b32 v8, 16, v173
  v_and_b32 v9, s11, v173
  v_pk_add_f32 v[248:249], v[248:249], v[6:7]
  v_pk_add_f32 v[250:251], v[250:251], v[8:9]
  v_cvt_pk_bf16_f32 v182, v248, v249
  v_cvt_pk_bf16_f32 v183, v250, v251
  s_nop 1
  v_permlane16_swap_b32 v180, v182
  v_permlane16_swap_b32 v181, v183
  buffer_store_dwordx4 v[180:183], v12, s[44:47], 0 offen offset:1024 sc1
  s_waitcnt lgkmcnt(3)
  v_lshlrev_b32 v6, 16, v162
  v_and_b32 v7, s11, v162
  v_lshlrev_b32 v8, 16, v163
  v_and_b32 v9, s11, v163
  v_pk_add_f32 v[228:229], v[228:229], v[6:7]
  v_pk_add_f32 v[230:231], v[230:231], v[8:9]
  v_cvt_pk_bf16_f32 v184, v228, v229
  v_cvt_pk_bf16_f32 v185, v230, v231
  s_waitcnt lgkmcnt(2)
  v_lshlrev_b32 v6, 16, v166
  v_and_b32 v7, s11, v166
  v_lshlrev_b32 v8, 16, v167
  v_and_b32 v9, s11, v167
  v_pk_add_f32 v[236:237], v[236:237], v[6:7]
  v_pk_add_f32 v[238:239], v[238:239], v[8:9]
  v_cvt_pk_bf16_f32 v186, v236, v237
  v_cvt_pk_bf16_f32 v187, v238, v239
  s_nop 1
  v_permlane16_swap_b32 v184, v186
  v_permlane16_swap_b32 v185, v187
  buffer_store_dwordx4 v[184:187], v12, s[44:47], s3 offen offset:0 sc1
  s_waitcnt lgkmcnt(1)
  v_lshlrev_b32 v6, 16, v170
  v_and_b32 v7, s11, v170
  v_lshlrev_b32 v8, 16, v171
  v_and_b32 v9, s11, v171
  v_pk_add_f32 v[244:245], v[244:245], v[6:7]
  v_pk_add_f32 v[246:247], v[246:247], v[8:9]
  v_cvt_pk_bf16_f32 v188, v244, v245
  v_cvt_pk_bf16_f32 v189, v246, v247
  s_waitcnt lgkmcnt(0)
  v_lshlrev_b32 v6, 16, v174
  v_and_b32 v7, s11, v174
  v_lshlrev_b32 v8, 16, v175
  v_and_b32 v9, s11, v175
  v_pk_add_f32 v[252:253], v[252:253], v[6:7]
  v_pk_add_f32 v[254:255], v[254:255], v[8:9]
  v_cvt_pk_bf16_f32 v190, v252, v253
  v_cvt_pk_bf16_f32 v191, v254, v255
  s_nop 1
  v_permlane16_swap_b32 v188, v190
  v_permlane16_swap_b32 v189, v191
  buffer_store_dwordx4 v[188:191], v12, s[44:47], s3 offen offset:1024 sc1
  v_dot2_f32_bf16 v20, v176, s10, v20
  v_dot2_f32_bf16 v22, v176, v176, v22
  v_dot2_f32_bf16 v20, v177, s10, v20
  v_dot2_f32_bf16 v22, v177, v177, v22
  v_dot2_f32_bf16 v20, v178, s10, v20
  v_dot2_f32_bf16 v22, v178, v178, v22
  v_dot2_f32_bf16 v20, v179, s10, v20
  v_dot2_f32_bf16 v22, v179, v179, v22
  v_dot2_f32_bf16 v20, v180, s10, v20
  v_dot2_f32_bf16 v22, v180, v180, v22
  v_dot2_f32_bf16 v20, v181, s10, v20
  v_dot2_f32_bf16 v22, v181, v181, v22
  v_dot2_f32_bf16 v20, v182, s10, v20
  v_dot2_f32_bf16 v22, v182, v182, v22
  v_dot2_f32_bf16 v20, v183, s10, v20
  v_dot2_f32_bf16 v22, v183, v183, v22
  v_dot2_f32_bf16 v21, v184, s10, v21
  v_dot2_f32_bf16 v23, v184, v184, v23
  v_dot2_f32_bf16 v21, v185, s10, v21
  v_dot2_f32_bf16 v23, v185, v185, v23
  v_dot2_f32_bf16 v21, v186, s10, v21
  v_dot2_f32_bf16 v23, v186, v186, v23
  v_dot2_f32_bf16 v21, v187, s10, v21
  v_dot2_f32_bf16 v23, v187, v187, v23
  v_dot2_f32_bf16 v21, v188, s10, v21
  v_dot2_f32_bf16 v23, v188, v188, v23
  v_dot2_f32_bf16 v21, v189, s10, v21
  v_dot2_f32_bf16 v23, v189, v189, v23
  v_dot2_f32_bf16 v21, v190, s10, v21
  v_dot2_f32_bf16 v23, v190, v190, v23
  v_dot2_f32_bf16 v21, v191, s10, v21
  v_dot2_f32_bf16 v23, v191, v191, v23
  s_nop 2
  v_permlane32_swap_b32 v20, v21
  v_permlane32_swap_b32 v22, v23
  v_add_f32 v20, v20, v21
  v_add_f32 v22, v22, v23
  s_nop 1
  v_permlane16_swap_b32 v20, v22
  v_add_f32 v20, v20, v22
  buffer_store_dword v20, v18, s[56:59], 0 offen sc1
  s_waitcnt vmcnt(0)
  s_barrier
  s_add_u32 s97, s97, 1
  s_branch L_w1_body
L_wo_c1:
L_w1_c0:
L_w1_body:
  s_cmp_ge_u32 s2, 256
  s_cbranch_scc1 L_w1_end
  v_lshrrev_b32 v2, 6, v0
  v_and_b32 v1, 63, v0
  v_readfirstlane_b32 s70, v2
  s_and_b32 s3, s2, 7
  s_lshr_b32 s99, s2, 3
  s_and_b32 s5, s3, 1
  s_lshl_b32 s5, s5, 3
  s_and_b32 s6, s99, 7
  s_add_u32 s68, s5, s6
  s_lshr_b32 s5, s3, 1
  s_lshl_b32 s5, s5, 2
  s_lshr_b32 s6, s99, 3
  s_add_u32 s69, s5, s6
  s_cmp_lt_u32 s70, 4
  s_cbranch_scc1 L_w1_compute
L_w1_loader:
  s_add_u32 s8, s70, s69
  s_and_b32 s8, s8, 3
  s_add_u32 s9, s70, s68
  s_and_b32 s9, s9, 3
  s_lshl_b32 s76, s8, 12
  s_lshl_b32 s77, s9, 11
  s_add_u32 s77, s77, 16384
  s_lshl_b32 s11, s68, 7
  v_and_b32 v10, 7, v1
  s_lshr_b32 s10, s76, 11
  s_lshl_b32 s3, s68, 3
  s_add_u32 s10, s10, s3
  s_mul_i32 s10, s10, 32768
  v_lshl_add_u32 v4, v1, 4, s10
  v_add_u32 v5, 32768, v4
  v_lshrrev_b32 v3, 3, v1
  s_lshl_b32 s10, s9, 4
  v_add_u32 v3, s10, v3
  v_mul_u32_u24 v3, 7168, v3
  v_lshrrev_b32 v2, 3, v1
  v_and_b32 v2, 2, v2
  v_xor_b32 v2, v2, v10
  s_mul_i32 s10, s69, 128
  v_add_u32 v3, s10, v3
  v_lshl_add_u32 v8, v2, 4, v3
  v_xor_b32 v2, 4, v2
  v_add_u32 v3, 57344, v3
  v_lshl_add_u32 v9, v2, 4, v3
  v_lshrrev_b32 v3, 2, v1
  s_lshl_b32 s10, s9, 4
  v_add_u32 v3, s10, v3
  v_mul_u32_u24 v3, 7168, v3
  v_lshrrev_b32 v2, 4, v1
  v_and_b32 v2, 2, v2
  v_xor_b32 v2, v2, v1
  v_and_b32 v2, 3, v2
  s_lshl_b32 s10, s69, 6
  s_add_u32 s10, s10, 2048
  v_add_u32 v3, s10, v3
  v_lshl_add_u32 v28, v2, 4, v3
  s_lshl_b32 s78, s69, 7
  s_add_u32 s78, s78, 3072
  s_mov_b32 s75, 0
  s_add_u32 s100, s68, s69
  s_mov_b32 s101, -1
  s_add_u32 s101, s101, 1
  s_sub_u32 s73, s101, s100
  s_lshl_b32 s73, s73, 3
  s_lshr_b32 s73, 0xf0f02, s73
  s_and_b32 s73, s73, 255
  s_add_u32 s73, s73, s101
  s_and_b32 s73, s73, 15
  s_mul_i32 s74, s73, 458752
  s_lshl_b32 s73, s73, 11
  s_waitcnt lgkmcnt(0)
  s_add_u32 s36, s34, 4194304
  s_addc_u32 s37, s35, 0
  s_and_b32 s37, s37, 0xffff
  s_mov_b32 s38, 4194304
  s_mov_b32 s39, 0x00020000
  s_mov_b32 s40, s24
  s_and_b32 s41, s25, 0xffff
  s_mov_b32 s42, 7340032
  s_mov_b32 s43, 0x00020000
  s_add_u32 s56, s34, 24117248
  s_addc_u32 s57, s35, 0
  s_and_b32 s57, s57, 0xffff
  s_mov_b32 s58, 262144
  s_mov_b32 s59, 0x00020000
  s_add_u32 s64, s22, 24641536
  s_addc_u32 s65, s23, 0
  s_and_b32 s65, s65, 0xffff
  s_mov_b32 s66, 262144
  s_mov_b32 s67, 0x00020000
  s_mov_b32 s52, s26
  s_and_b32 s53, s27, 0xffff
  s_mov_b32 s54, 7168
  s_mov_b32 s55, 0x00020000
  s_mov_b32 s60, s28
  s_and_b32 s61, s29, 0xffff
  s_mov_b32 s62, 7340032
  s_mov_b32 s63, 0x00020000
  s_cmp_eq_u32 s96, 0
  s_cselect_b32 s62, s62, 0
  s_and_b32 s3, s70, 3
  s_lshl_b32 s4, s2, 2
  s_add_u32 s3, s3, s4
  s_mul_i32 s98, s3, 3584
  s_add_u32 s98, s98, 3670016
  s_add_u32 s3, s96, s70
  s_cmp_lg_u32 s3, 4
  s_cbranch_scc1 L_w1_chk
  s_add_u32 s44, s22, 24903680
  s_addc_u32 s45, s23, 0
  s_and_b32 s45, s45, 0xffff
  s_mov_b32 s46, 32768
  s_mov_b32 s47, 0x00020000
  s_mov_b32 s79, 0x100000
  v_lshrrev_b32 v2, 2, v1
  v_and_b32 v3, 3, v1
  v_lshlrev_b32 v2, 8, v2
  v_lshl_add_u32 v2, v3, 4, v2
L_w1_chkl:
  buffer_load_dwordx4 v[12:15], v2, s[44:47], 0 offen sc1
  s_sub_u32 s79, s79, 1
  s_cbranch_scc1 L_w1_chk
  s_waitcnt vmcnt(0)
  v_and_b32 v12, v12, v13
  v_and_b32 v14, v14, v15
  v_and_b32 v12, v12, v14
  v_cmp_ne_u32 vcc, 1, v12
  s_cbranch_vccnz L_w1_chkl
L_w1_chk:
  s_mov_b32 s88, s73
  s_add_u32 m0, s77, 0
  s_add_u32 s4, s74, 0
  buffer_load_dwordx4 v8, s[40:43], s4 offen lds
  s_add_u32 m0, s77, 1024
  s_nop 0
  buffer_load_dwordx4 v9, s[40:43], s4 offen lds
  s_add_u32 m0, s77, 8192
  s_add_u32 s4, s74, s78
  buffer_load_dwordx4 v8, s[40:43], s4 offen lds
  s_add_u32 m0, s77, 9216
  s_nop 0
  buffer_load_dwordx4 v9, s[40:43], s4 offen lds
  s_add_u32 m0, s77, 16384
  s_add_u32 s4, s4, 128
  buffer_load_dwordx4 v8, s[40:43], s4 offen lds
  s_add_u32 m0, s77, 17408
  s_nop 0
  buffer_load_dwordx4 v9, s[40:43], s4 offen lds
  s_add_u32 m0, s77, 24576
  s_nop 0
  buffer_load_dwordx4 v28, s[40:43], s74 offen lds
  s_add_u32 s101, s101, 1
  s_sub_u32 s73, s101, s100
  s_lshl_b32 s73, s73, 3
  s_lshr_b32 s73, 0xf0f02, s73
  s_and_b32 s73, s73, 255
  s_add_u32 s73, s73, s101
  s_and_b32 s73, s73, 15
  s_mul_i32 s74, s73, 458752
  s_lshl_b32 s73, s73, 11
  s_mov_b32 s89, s73
  s_add_u32 m0, s77, 49152
  s_add_u32 s4, s74, 0
  buffer_load_dwordx4 v8, s[40:43], s4 offen lds
  s_add_u32 m0, s77, 50176
  s_nop 0
  buffer_load_dwordx4 v9, s[40:43], s4 offen lds
  s_add_u32 m0, s77, 57344
  s_add_u32 s4, s74, s78
  buffer_load_dwordx4 v8, s[40:43], s4 offen lds
  s_add_u32 m0, s77, 58368
  s_nop 0
  buffer_load_dwordx4 v9, s[40:43], s4 offen lds
  s_add_u32 m0, s77, 65536
  s_add_u32 s4, s4, 128
  buffer_load_dwordx4 v8, s[40:43], s4 offen lds
  s_add_u32 m0, s77, 66560
  s_nop 0
  buffer_load_dwordx4 v9, s[40:43], s4 offen lds
  s_add_u32 m0, s77, 73728
  s_nop 0
  buffer_load_dwordx4 v28, s[40:43], s74 offen lds
  s_add_u32 s101, s101, 1
  s_sub_u32 s73, s101, s100
  s_lshl_b32 s73, s73, 3
  s_lshr_b32 s73, 0xf0f02, s73
  s_and_b32 s73, s73, 255
  s_add_u32 s73, s73, s101
  s_and_b32 s73, s73, 15
  s_mul_i32 s74, s73, 458752
  s_lshl_b32 s73, s73, 11
  s_mov_b32 s75, 98304
  s_add_u32 s44, s22, 24903680
  s_addc_u32 s45, s23, 0
  s_and_b32 s45, s45, 0xffff
  s_mov_b32 s46, 32768
  s_mov_b32 s47, 0x00020000
  s_lshl_b32 s3, s97, 12
  s_lshl_b32 s4, s68, 8
  s_add_u32 s3, s3, s4
  s_sub_u32 s3, s3, 4096
  v_and_b32 v2, 15, v1
  v_lshlrev_b32 v2, 2, v2
  v_mov_b32 v3, 1
  s_mov_b32 s79, 0x100000
  s_cmp_lg_u32 s70, 4
  s_barrier
  s_cbranch_scc1 L_w1_dep
  s_mov_b64 exec, 1
  buffer_store_dword v3, off, s[44:47], s87 sc1
  s_mov_b64 exec, -1
L_w1_poll:
  buffer_load_dword v3, v2, s[44:47], s3 offen sc1
  s_sub_u32 s79, s79, 1
  s_cbranch_scc1 L_w1_dep
  s_waitcnt vmcnt(0)
  v_cmp_ne_u32 vcc, 1, v3
  s_cbranch_vccnz L_w1_poll
L_w1_dep:
  s_barrier
  s_add_u32 m0, s76, 0
  s_nop 0
  buffer_load_dwordx4 v4, s[36:39], s88 offen offset:0 lds
  buffer_load_dwordx4 v4, s[36:39], s88 offen offset:1024 lds
  s_add_u32 m0, s76, 2048
  s_nop 0
  buffer_load_dwordx4 v5, s[36:39], s88 offen offset:0 lds
  buffer_load_dwordx4 v5, s[36:39], s88 offen offset:1024 lds
  s_add_u32 m0, s76, 49152
  s_nop 0
  buffer_load_dwordx4 v4, s[36:39], s89 offen offset:0 lds
  buffer_load_dwordx4 v4, s[36:39], s89 offen offset:1024 lds
  s_add_u32 m0, s76, 51200
  s_nop 0
  buffer_load_dwordx4 v5, s[36:39], s89 offen offset:0 lds
  buffer_load_dwordx4 v5, s[36:39], s89 offen offset:1024 lds
  s_waitcnt vmcnt(4)
  s_barrier
  s_mov_b32 s79, 13
L_w1_ld1:
  s_add_u32 s3, s75, s76
  s_add_u32 m0, s3, 0
  s_nop 0
  buffer_load_dwordx4 v4, s[36:39], s73 offen offset:0 lds
  buffer_load_dwordx4 v4, s[36:39], s73 offen offset:1024 lds
  s_add_u32 m0, s3, 2048
  s_nop 0
  buffer_load_dwordx4 v5, s[36:39], s73 offen offset:0 lds
  buffer_load_dwordx4 v5, s[36:39], s73 offen offset:1024 lds
  s_add_u32 s3, s75, s77
  s_add_u32 m0, s3, 0
  s_add_u32 s4, s74, 0
  buffer_load_dwordx4 v8, s[40:43], s4 offen lds
  s_add_u32 m0, s3, 1024
  s_nop 0
  buffer_load_dwordx4 v9, s[40:43], s4 offen lds
  s_add_u32 m0, s3, 8192
  s_add_u32 s4, s74, s78
  buffer_load_dwordx4 v8, s[40:43], s4 offen lds
  s_add_u32 m0, s3, 9216
  s_nop 0
  buffer_load_dwordx4 v9, s[40:43], s4 offen lds
  s_add_u32 m0, s3, 16384
  s_add_u32 s4, s4, 128
  buffer_load_dwordx4 v8, s[40:43], s4 offen lds
  s_add_u32 m0, s3, 17408
  s_nop 0
  buffer_load_dwordx4 v9, s[40:43], s4 offen lds
  s_add_u32 m0, s3, 24576
  s_nop 0
  buffer_load_dwordx4 v28, s[40:43], s74 offen lds
  s_add_u32 s101, s101, 1
  s_sub_u32 s73, s101, s100
  s_lshl_b32 s73, s73, 3
  s_lshr_b32 s73, 0xf0f02, s73
  s_and_b32 s73, s73, 255
  s_add_u32 s73, s73, s101
  s_and_b32 s73, s73, 15
  s_mul_i32 s74, s73, 458752
  s_lshl_b32 s73, s73, 11
  s_add_u32 s75, s75, 49152
  s_cmp_eq_u32 s75, 147456
  s_cselect_b32 s75, 0, s75
  s_buffer_load_dword s84, s[60:63], s98 offset:0
  s_buffer_load_dword s84, s[60:63], s98 offset:64
  s_buffer_load_dword s84, s[60:63], s98 offset:128
  s_buffer_load_dword s84, s[60:63], s98 offset:192
  s_add_u32 s98, s98, 256
  s_waitcnt vmcnt(11)
  s_barrier
  s_sub_u32 s79, s79, 1
  s_cmp_lg_u32 s79, 0
  s_cbranch_scc1 L_w1_ld1
  s_add_u32 s3, s75, s76
  s_add_u32 m0, s3, 0
  s_nop 0
  buffer_load_dwordx4 v4, s[36:39], s73 offen offset:0 lds
  buffer_load_dwordx4 v4, s[36:39], s73 offen offset:1024 lds
  s_add_u32 m0, s3, 2048
  s_nop 0
  buffer_load_dwordx4 v5, s[36:39], s73 offen offset:0 lds
  buffer_load_dwordx4 v5, s[36:39], s73 offen offset:1024 lds
  s_add_u32 s3, s75, s77
  s_add_u32 m0, s3, 0
  s_add_u32 s4, s74, 0
  buffer_load_dwordx4 v8, s[40:43], s4 offen lds
  s_add_u32 m0, s3, 1024
  s_nop 0
  buffer_load_dwordx4 v9, s[40:43], s4 offen lds
  s_add_u32 m0, s3, 8192
  s_add_u32 s4, s74, s78
  buffer_load_dwordx4 v8, s[40:43], s4 offen lds
  s_add_u32 m0, s3, 9216
  s_nop 0
  buffer_load_dwordx4 v9, s[40:43], s4 offen lds
  s_add_u32 m0, s3, 16384
  s_add_u32 s4, s4, 128
  buffer_load_dwordx4 v8, s[40:43], s4 offen lds
  s_add_u32 m0, s3, 17408
  s_nop 0
  buffer_load_dwordx4 v9, s[40:43], s4 offen lds
  s_add_u32 m0, s3, 24576
  s_nop 0
  buffer_load_dwordx4 v28, s[40:43], s74 offen lds
  s_add_u32 s101, s101, 1
  s_sub_u32 s73, s101, s100
  s_lshl_b32 s73, s73, 3
  s_lshr_b32 s73, 0xf0f02, s73
  s_and_b32 s73, s73, 255
  s_add_u32 s73, s73, s101
  s_and_b32 s73, s73, 15
  s_mul_i32 s74, s73, 458752
  s_lshl_b32 s73, s73, 11
  s_add_u32 s75, s75, 49152
  s_cmp_eq_u32 s75, 147456
  s_cselect_b32 s75, 0, s75
  s_buffer_load_dword s84, s[60:63], s98 offset:0
  s_buffer_load_dword s84, s[60:63], s98 offset:64
  s_buffer_load_dword s84, s[60:63], s98 offset:128
  s_buffer_load_dword s84, s[60:63], s98 offset:192
  s_add_u32 s98, s98, 256
  s_and_b32 s3, s70, 3
  s_lshl_b32 s4, s68, 7
  s_lshl_b32 s5, s3, 6
  s_add_u32 s5, s5, s4
  v_add_u32 v2, s5, v1
  s_sub_u32 s4, s4, 16
  v_and_b32 v3, 15, v1
  v_add_u32 v3, s4, v3
  v_max_i32 v3, 0, v3
  s_cmp_ge_u32 s3, 2
  s_cselect_b64 vcc, -1, 0
  v_cndmask_b32 v2, v2, v3, vcc
  v_lshlrev_b32 v2, 3, v2
  s_mov_b32 s3, 0
  buffer_load_dwordx2 v[32:33], v2, s[56:59], s3 offen
  s_add_u32 s3, s3, 16384
  buffer_load_dwordx2 v[34:35], v2, s[56:59], s3 offen
  s_add_u32 s3, s3, 16384
  buffer_load_dwordx2 v[36:37], v2, s[56:59], s3 offen
  s_add_u32 s3, s3, 16384
  buffer_load_dwordx2 v[38:39], v2, s[56:59], s3 offen
  s_add_u32 s3, s3, 16384
  buffer_load_dwordx2 v[40:41], v2, s[56:59], s3 offen
  s_add_u32 s3, s3, 16384
  buffer_load_dwordx2 v[42:43], v2, s[56:59], s3 offen
  s_add_u32 s3, s3, 16384
  buffer_load_dwordx2 v[44:45], v2, s[56:59], s3 offen
  s_add_u32 s3, s3, 16384
  buffer_load_dwordx2 v[46:47], v2, s[56:59], s3 offen
  s_add_u32 s3, s3, 16384
  buffer_load_dwordx2 v[48:49], v2, s[56:59], s3 offen
  s_add_u32 s3, s3, 16384
  buffer_load_dwordx2 v[50:51], v2, s[56:59], s3 offen
  s_add_u32 s3, s3, 16384
  buffer_load_dwordx2 v[52:53], v2, s[56:59], s3 offen
  s_add_u32 s3, s3, 16384
  buffer_load_dwordx2 v[54:55], v2, s[56:59], s3 offen
  s_add_u32 s3, s3, 16384
  buffer_load_dwordx2 v[56:57], v2, s[56:59], s3 offen
  s_add_u32 s3, s3, 16384
  buffer_load_dwordx2 v[58:59], v2, s[56:59], s3 offen
  s_add_u32 s3, s3, 16384
  buffer_load_dwordx2 v[60:61], v2, s[56:59], s3 offen
  s_add_u32 s3, s3, 16384
  buffer_load_dwordx2 v[62:63], v2, s[56:59], s3 offen
  s_lshl_b32 s4, s69, 7
  s_lshl_b32 s5, s70, 6
  s_add_u32 s4, s4, s5
  s_add_u32 s4, s4, 1216
  s_lshl_b32 s5, s69, 6
  s_cmp_eq_u32 s70, 4
  s_cselect_b32 s4, s5, s4
  s_lshr_b32 s5, s5, 1
  s_add_u32 s5, s5, 1024
  s_cmp_eq_u32 s70, 7
  s_cselect_b32 s4, s5, s4
  v_add_u32 v3, s4, v1
  v_lshlrev_b32 v2, 2, v3
  v_lshlrev_b32 v3, 1, v3
  s_mov_b32 s3, 0
  buffer_load_dword v64, v2, s[64:67], s3 offen
  s_add_u32 s3, s3, 16384
  buffer_load_dword v65, v2, s[64:67], s3 offen
  s_add_u32 s3, s3, 16384
  buffer_load_dword v66, v2, s[64:67], s3 offen
  s_add_u32 s3, s3, 16384
  buffer_load_dword v67, v2, s[64:67], s3 offen
  s_add_u32 s3, s3, 16384
  buffer_load_dword v68, v2, s[64:67], s3 offen
  s_add_u32 s3, s3, 16384
  buffer_load_dword v69, v2, s[64:67], s3 offen
  s_add_u32 s3, s3, 16384
  buffer_load_dword v70, v2, s[64:67], s3 offen
  s_add_u32 s3, s3, 16384
  buffer_load_dword v71, v2, s[64:67], s3 offen
  s_add_u32 s3, s3, 16384
  buffer_load_dword v72, v2, s[64:67], s3 offen
  s_add_u32 s3, s3, 16384
  buffer_load_dword v73, v2, s[64:67], s3 offen
  s_add_u32 s3, s3, 16384
  buffer_load_dword v74, v2, s[64:67], s3 offen
  s_add_u32 s3, s3, 16384
  buffer_load_dword v75, v2, s[64:67], s3 offen
  s_add_u32 s3, s3, 16384
  buffer_load_dword v76, v2, s[64:67], s3 offen
  s_add_u32 s3, s3, 16384
  buffer_load_dword v77, v2, s[64:67], s3 offen
  s_add_u32 s3, s3, 16384
  buffer_load_dword v78, v2, s[64:67], s3 offen
  s_add_u32 s3, s3, 16384
  buffer_load_dword v79, v2, s[64:67], s3 offen
  buffer_load_ushort v80, v3, s[52:55], 0 offen
  s_waitcnt vmcnt(44)
  s_barrier
  s_waitcnt vmcnt(33)
  s_barrier
  s_waitcnt vmcnt(0)
  v_add_f32 v32, v32, v34
  v_add_f32 v33, v33, v35
  v_add_f32 v48, v48, v50
  v_add_f32 v49, v49, v51
  v_add_f32 v32, v32, v36
  v_add_f32 v33, v33, v37
  v_add_f32 v48, v48, v52
  v_add_f32 v49, v49, v53
  v_add_f32 v32, v32, v38
  v_add_f32 v33, v33, v39
  v_add_f32 v48, v48, v54
  v_add_f32 v49, v49, v55
  v_add_f32 v32, v32, v40
  v_add_f32 v33, v33, v41
  v_add_f32 v48, v48, v56
  v_add_f32 v49, v49, v57
  v_add_f32 v32, v32, v42
  v_add_f32 v33, v33, v43
  v_add_f32 v48, v48, v58
  v_add_f32 v49, v49, v59
  v_add_f32 v32, v32, v44
  v_add_f32 v33, v33, v45
  v_add_f32 v48, v48, v60
  v_add_f32 v49, v49, v61
  v_add_f32 v32, v32, v46
  v_add_f32 v33, v33, v47
  v_add_f32 v48, v48, v62
  v_add_f32 v49, v49, v63
  v_add_f32 v32, v32, v48
  v_add_f32 v33, v33, v49
  v_mul_f32 v32, 0x3a800000, v32
  v_mul_f32 v33, 0x3a800000, v33
  v_fma_f32 v33, -v32, v32, v33
  v_max_f32 v33, 0, v33
  v_add_f32 v33, 0x3727c5ac, v33
  v_rsq_f32 v33, v33
  s_nop 0
  s_and_b32 s3, s70, 3
  s_lshl_b32 s5, s3, 6
  s_add_u32 s5, s5, 16
  v_add_u32 v2, s5, v1
  v_and_b32 v3, 15, v1
  s_cmp_ge_u32 s3, 2
  s_cselect_b64 vcc, -1, 0
  v_cndmask_b32 v2, v2, v3, vcc
  v_lshlrev_b32 v2, 2, v2
  v_add_u32 v2, 147456, v2
  ds_write2_b32 v2, v32, v33 offset0:0 offset1:160
  v_add_f32 v64, v64, v72
  v_add_f32 v65, v65, v73
  v_add_f32 v66, v66, v74
  v_add_f32 v67, v67, v75
  v_add_f32 v68, v68, v76
  v_add_f32 v69, v69, v77
  v_add_f32 v70, v70, v78
  v_add_f32 v71, v71, v79
  v_add_f32 v64, v64, v68
  v_add_f32 v65, v65, v69
  v_add_f32 v66, v66, v70
  v_add_f32 v67, v67, v71
  v_add_f32 v64, v64, v65
  v_add_f32 v66, v66, v67
  v_add_f32 v64, v64, v66
  v_lshlrev_b32 v80, 16, v80
  v_lshlrev_b32 v2, 2, v0
  v_add_u32 v2, 147712, v2
  ds_write_b32 v2, v64
  ds_write_b32 v2, v80 offset:1024
  s_waitcnt lgkmcnt(0)
  s_barrier
  s_lshl_b32 s87, s97, 12
  s_lshl_b32 s4, s68, 8
  s_add_u32 s87, s87, s4
  s_lshl_b32 s4, s69, 2
  s_add_u32 s87, s87, s4
  s_add_u32 s97, s97, 1
  s_branch L_w2_body
L_w1_end:
  s_endpgm
L_w1_compute:
  s_and_b32 s71, s70, 1
  s_lshr_b32 s72, s70, 1
  v_and_b32 v3, 15, v1
  v_lshrrev_b32 v2, 4, v1
  s_lshl_b32 s8, s71, 13
  v_lshl_add_u32 v4, v1, 4, s8
  v_bfe_u32 v13, v1, 2, 2
  v_lshl_add_u32 v13, v2, 3, v13
  v_lshlrev_b32 v13, 7, v13
  v_and_b32 v17, 3, v1
  v_lshl_add_u32 v13, v17, 3, v13
  v_bfe_u32 v17, v1, 3, 2
  v_lshl_add_u32 v13, v17, 5, v13
  s_lshl_b32 s9, s72, 6
  v_xor_b32 v13, s9, v13
  v_add_u32 v5, 16384, v13
  v_xor_b32 v6, 32, v5
  v_and_b32 v16, 1, v2
  v_lshrrev_b32 v17, 1, v2
  v_bfe_u32 v13, v1, 2, 2
  v_lshl_add_u32 v13, v16, 3, v13
  v_lshl_add_u32 v13, v17, 5, v13
  v_xor_b32 v14, s72, v16
  v_lshl_add_u32 v13, v13, 1, v14
  v_and_b32 v14, 3, v1
  v_lshl_add_u32 v13, v13, 2, v14
  v_lshlrev_b32 v13, 3, v13
  v_add_u32 v7, 40960, v13
  s_lshl_b32 s8, s68, 7
  s_lshl_b32 s9, s71, 6
  s_add_u32 s8, s8, s9
  s_mul_i32 s8, s8, 7168
  v_lshlrev_b32 v14, 8, v17
  v_lshl_add_u32 v14, v3, 4, v14
  v_add_u32 v14, s8, v14
  s_lshl_b32 s10, s69, 11
  s_lshl_b32 s9, s72, 10
  s_add_u32 s9, s9, s10
  v_lshl_add_u32 v12, v16, 9, v14
  v_add_u32 v12, s9, v12
  v_mul_u32_u24 v16, 114688, v16
  s_lshr_b32 s9, s9, 1
  v_add3_u32 v13, v16, v14, s9
  s_lshl_b32 s9, s71, 8
  s_add_u32 s9, s9, 147520
  v_lshl_add_u32 v14, v3, 2, s9
  s_lshl_b32 s9, s72, 7
  s_add_u32 s9, s9, 148736
  v_lshl_add_u32 v15, v2, 4, s9
  s_lshl_b32 s9, s72, 6
  s_add_u32 s9, s9, 148736
  v_lshl_add_u32 v16, v2, 4, s9
  v_mov_b32 v128, 0
  v_mov_b32 v129, 0
  v_mov_b32 v130, 0
  v_mov_b32 v131, 0
  v_mov_b32 v132, 0
  v_mov_b32 v133, 0
  v_mov_b32 v134, 0
  v_mov_b32 v135, 0
  v_mov_b32 v136, 0
  v_mov_b32 v137, 0
  v_mov_b32 v138, 0
  v_mov_b32 v139, 0
  v_mov_b32 v140, 0
  v_mov_b32 v141, 0
  v_mov_b32 v142, 0
  v_mov_b32 v143, 0
  v_mov_b32 v144, 0
  v_mov_b32 v145, 0
  v_mov_b32 v146, 0
  v_mov_b32 v147, 0
  v_mov_b32 v148, 0
  v_mov_b32 v149, 0
  v_mov_b32 v150, 0
  v_mov_b32 v151, 0
  v_mov_b32 v152, 0
  v_mov_b32 v153, 0
  v_mov_b32 v154, 0
  v_mov_b32 v155, 0
  v_mov_b32 v156, 0
  v_mov_b32 v157, 0
  v_mov_b32 v158, 0
  v_mov_b32 v159, 0
  v_mov_b32 v160, 0
  v_mov_b32 v161, 0
  v_mov_b32 v162, 0
  v_mov_b32 v163, 0
  v_mov_b32 v164, 0
  v_mov_b32 v165, 0
  v_mov_b32 v166, 0
  v_mov_b32 v167, 0
  v_mov_b32 v168, 0
  v_mov_b32 v169, 0
  v_mov_b32 v170, 0
  v_mov_b32 v171, 0
  v_mov_b32 v172, 0
  v_mov_b32 v173, 0
  v_mov_b32 v174, 0
  v_mov_b32 v175, 0
  v_mov_b32 v176, 0
  v_mov_b32 v177, 0
  v_mov_b32 v178, 0
  v_mov_b32 v179, 0
  v_mov_b32 v180, 0
  v_mov_b32 v181, 0
  v_mov_b32 v182, 0
  v_mov_b32 v183, 0
  v_mov_b32 v184, 0
  v_mov_b32 v185, 0
  v_mov_b32 v186, 0
  v_mov_b32 v187, 0
  v_mov_b32 v188, 0
  v_mov_b32 v189, 0
  v_mov_b32 v190, 0
  v_mov_b32 v191, 0
  v_mov_b32 v192, 0
  v_mov_b32 v193, 0
  v_mov_b32 v194, 0
  v_mov_b32 v195, 0
  v_mov_b32 v196, 0
  v_mov_b32 v197, 0
  v_mov_b32 v198, 0
  v_mov_b32 v199, 0
  v_mov_b32 v200, 0
  v_mov_b32 v201, 0
  v_mov_b32 v202, 0
  v_mov_b32 v203, 0
  v_mov_b32 v204, 0
  v_mov_b32 v205, 0
  v_mov_b32 v206, 0
  v_mov_b32 v207, 0
  v_mov_b32 v208, 0
  v_mov_b32 v209, 0
  v_mov_b32 v210, 0
  v_mov_b32 v211, 0
  v_mov_b32 v212, 0
  v_mov_b32 v213, 0
  v_mov_b32 v214, 0
  v_mov_b32 v215, 0
  v_mov_b32 v216, 0
  v_mov_b32 v217, 0
  v_mov_b32 v218, 0
  v_mov_b32 v219, 0
  v_mov_b32 v220, 0
  v_mov_b32 v221, 0
  v_mov_b32 v222, 0
  v_mov_b32 v223, 0
  v_mov_b32 v224, 0
  v_mov_b32 v225, 0
  v_mov_b32 v226, 0
  v_mov_b32 v227, 0
  v_mov_b32 v228, 0
  v_mov_b32 v229, 0
  v_mov_b32 v230, 0
  v_mov_b32 v231, 0
  v_mov_b32 v232, 0
  v_mov_b32 v233, 0
  v_mov_b32 v234, 0
  v_mov_b32 v235, 0
  v_mov_b32 v236, 0
  v_mov_b32 v237, 0
  v_mov_b32 v238, 0
  v_mov_b32 v239, 0
  s_waitcnt lgkmcnt(0)
  s_add_u32 s44, s34, 8388608
  s_addc_u32 s45, s35, 0
  s_and_b32 s45, s45, 0xffff
  s_mov_b32 s46, 14680064
  s_mov_b32 s47, 0x00020000
  s_cmp_lg_u32 s96, 0
  s_cbranch_scc1 L_pfc3_skip
  s_getpc_b64 s[4:5]
L_pfc3:
  s_lshl_b32 s3, s99, 2
  s_add_u32 s3, s3, s70
  s_mul_i32 s3, s3, 128
  s_min_u32 s3, s3, L_w2_c1-L_w2_c0-128
  s_add_i32 s3, s3, L_w2_c0-L_pfc3
  s_ashr_i32 s6, s3, 31
  s_add_u32 s4, s4, s3
  s_addc_u32 s5, s5, s6
  s_load_dword s36, s[4:5], 0
  s_load_dword s37, s[4:5], 64
L_pfc3_skip:
  s_mov_b32 s75, 0
  v_add_u32_e64 v20, s75, v4
  v_add_u32_e64 v21, s75, v5
  v_add_u32_e64 v22, s75, v6
  v_add_u32_e64 v23, s75, v7
  s_add_u32 s75, s75, 49152
  s_cmp_eq_u32 s75, 147456
  s_cselect_b32 s75, 0, s75
  s_mov_b32 s79, 16
  s_barrier
  s_barrier
  ds_read_b128 v[32:35], v20 offset:0
  ds_read_b128 v[36:39], v20 offset:2048
  ds_read_b128 v[40:43], v20 offset:4096
  ds_read_b128 v[44:47], v20 offset:6144
  ds_read_b64_tr_b16 v[48:49], v21 offset:0
  ds_read_b64_tr_b16 v[50:51], v21 offset:512
  ds_read_b64_tr_b16 v[52:53], v22 offset:0
  ds_read_b64_tr_b16 v[54:55], v22 offset:512
  ds_read_b64_tr_b16 v[56:57], v21 offset:8192
  ds_read_b64_tr_b16 v[58:59], v21 offset:8704
  ds_read_b64_tr_b16 v[60:61], v22 offset:8192
  ds_read_b64_tr_b16 v[62:63], v22 offset:8704
  ds_read_b64_tr_b16 v[64:65], v21 offset:16384
  ds_read_b64_tr_b16 v[66:67], v21 offset:16896
  ds_read_b64_tr_b16 v[68:69], v22 offset:16384
  ds_read_b64_tr_b16 v[70:71], v22 offset:16896
  ds_read_b64_tr_b16 v[72:73], v23 offset:0
  ds_read_b64_tr_b16 v[74:75], v23 offset:256
  s_waitcnt lgkmcnt(0)
.p2align 3
L_w1_loop:
  v_mfma_f32_16x16x32_bf16 v[128:131], v[48:51], v[32:35], v[128:131]
  ds_read_b128 v[80:83], v20 offset:1024
  v_mfma_f32_16x16x32_bf16 v[132:135], v[48:51], v[36:39], v[132:135]
  ds_read_b128 v[84:87], v20 offset:3072
  v_mfma_f32_16x16x32_bf16 v[136:139], v[48:51], v[40:43], v[136:139]
  ds_read_b128 v[88:91], v20 offset:5120
  v_mfma_f32_16x16x32_bf16 v[140:143], v[48:51], v[44:47], v[140:143]
  ds_read_b128 v[92:95], v20 offset:7168
  v_mfma_f32_16x16x32_bf16 v[144:147], v[52:55], v[32:35], v[144:147]
  ds_read_b64_tr_b16 v[96:97], v21 offset:4096
  v_mfma_f32_16x16x32_bf16 v[148:151], v[52:55], v[36:39], v[148:151]
  ds_read_b64_tr_b16 v[98:99], v21 offset:4608
  v_mfma_f32_16x16x32_bf16 v[152:155], v[52:55], v[40:43], v[152:155]
  ds_read_b64_tr_b16 v[100:101], v22 offset:4096
  v_mfma_f32_16x16x32_bf16 v[156:159], v[52:55], v[44:47], v[156:159]
  ds_read_b64_tr_b16 v[102:103], v22 offset:4608
  v_mfma_f32_16x16x32_bf16 v[160:163], v[56:59], v[32:35], v[160:163]
  ds_read_b64_tr_b16 v[104:105], v21 offset:12288
  v_mfma_f32_16x16x32_bf16 v[164:167], v[56:59], v[36:39], v[164:167]
  ds_read_b64_tr_b16 v[106:107], v21 offset:12800
  v_mfma_f32_16x16x32_bf16 v[168:171], v[56:59], v[40:43], v[168:171]
  ds_read_b64_tr_b16 v[108:109], v22 offset:12288
  v_mfma_f32_16x16x32_bf16 v[172:175], v[56:59], v[44:47], v[172:175]
  ds_read_b64_tr_b16 v[110:111], v22 offset:12800
  v_mfma_f32_16x16x32_bf16 v[176:179], v[60:63], v[32:35], v[176:179]
  ds_read_b64_tr_b16 v[112:113], v21 offset:20480
  v_mfma_f32_16x16x32_bf16 v[180:183], v[60:63], v[36:39], v[180:183]
  ds_read_b64_tr_b16 v[114:115], v21 offset:20992
  v_mfma_f32_16x16x32_bf16 v[184:187], v[60:63], v[40:43], v[184:187]
  ds_read_b64_tr_b16 v[116:117], v22 offset:20480
  v_mfma_f32_16x16x32_bf16 v[188:191], v[60:63], v[44:47], v[188:191]
  ds_read_b64_tr_b16 v[118:119], v22 offset:20992
  v_mfma_f32_16x16x32_bf16 v[192:195], v[64:67], v[32:35], v[192:195]
  ds_read_b64_tr_b16 v[120:121], v23 offset:4096
  v_mfma_f32_16x16x32_bf16 v[196:199], v[64:67], v[36:39], v[196:199]
  ds_read_b64_tr_b16 v[122:123], v23 offset:4352
  v_mfma_f32_16x16x32_bf16 v[200:203], v[64:67], v[40:43], v[200:203]
  v_add_u32_e64 v20, s75, v4
  v_mfma_f32_16x16x32_bf16 v[204:207], v[64:67], v[44:47], v[204:207]
  v_add_u32_e64 v21, s75, v5
  v_mfma_f32_16x16x32_bf16 v[208:211], v[68:71], v[32:35], v[208:211]
  v_add_u32_e64 v22, s75, v6
  v_mfma_f32_16x16x32_bf16 v[212:215], v[68:71], v[36:39], v[212:215]
  v_add_u32_e64 v23, s75, v7
  v_mfma_f32_16x16x32_bf16 v[216:219], v[68:71], v[40:43], v[216:219]
  s_add_u32 s75, s75, 49152
  v_mfma_f32_16x16x32_bf16 v[220:223], v[68:71], v[44:47], v[220:223]
  s_cmp_eq_u32 s75, 147456
  v_mfma_f32_16x16x32_bf16 v[224:227], v[72:75], v[32:35], v[224:227]
  s_cselect_b32 s75, 0, s75
  s_sub_u32 s79, s79, 1
  v_mfma_f32_16x16x32_bf16 v[228:231], v[72:75], v[36:39], v[228:231]
  v_mfma_f32_16x16x32_bf16 v[232:235], v[72:75], v[40:43], v[232:235]
  v_mfma_f32_16x16x32_bf16 v[236:239], v[72:75], v[44:47], v[236:239]
  s_waitcnt lgkmcnt(0)
  s_barrier
  v_mfma_f32_16x16x32_bf16 v[128:131], v[96:99], v[80:83], v[128:131]
  ds_read_b128 v[32:35], v20 offset:0
  v_mfma_f32_16x16x32_bf16 v[132:135], v[96:99], v[84:87], v[132:135]
  ds_read_b128 v[36:39], v20 offset:2048
  v_mfma_f32_16x16x32_bf16 v[136:139], v[96:99], v[88:91], v[136:139]
  ds_read_b128 v[40:43], v20 offset:4096
  v_mfma_f32_16x16x32_bf16 v[140:143], v[96:99], v[92:95], v[140:143]
  ds_read_b128 v[44:47], v20 offset:6144
  v_mfma_f32_16x16x32_bf16 v[144:147], v[100:103], v[80:83], v[144:147]
  ds_read_b64_tr_b16 v[48:49], v21 offset:0
  v_mfma_f32_16x16x32_bf16 v[148:151], v[100:103], v[84:87], v[148:151]
  ds_read_b64_tr_b16 v[50:51], v21 offset:512
  v_mfma_f32_16x16x32_bf16 v[152:155], v[100:103], v[88:91], v[152:155]
  ds_read_b64_tr_b16 v[52:53], v22 offset:0
  v_mfma_f32_16x16x32_bf16 v[156:159], v[100:103], v[92:95], v[156:159]
  ds_read_b64_tr_b16 v[54:55], v22 offset:512
  v_mfma_f32_16x16x32_bf16 v[160:163], v[104:107], v[80:83], v[160:163]
  ds_read_b64_tr_b16 v[56:57], v21 offset:8192
  v_mfma_f32_16x16x32_bf16 v[164:167], v[104:107], v[84:87], v[164:167]
  ds_read_b64_tr_b16 v[58:59], v21 offset:8704
  v_mfma_f32_16x16x32_bf16 v[168:171], v[104:107], v[88:91], v[168:171]
  ds_read_b64_tr_b16 v[60:61], v22 offset:8192
  v_mfma_f32_16x16x32_bf16 v[172:175], v[104:107], v[92:95], v[172:175]
  ds_read_b64_tr_b16 v[62:63], v22 offset:8704
  v_mfma_f32_16x16x32_bf16 v[176:179], v[108:111], v[80:83], v[176:179]
  ds_read_b64_tr_b16 v[64:65], v21 offset:16384
  v_mfma_f32_16x16x32_bf16 v[180:183], v[108:111], v[84:87], v[180:183]
  ds_read_b64_tr_b16 v[66:67], v21 offset:16896
  v_mfma_f32_16x16x32_bf16 v[184:187], v[108:111], v[88:91], v[184:187]
  ds_read_b64_tr_b16 v[68:69], v22 offset:16384
  v_mfma_f32_16x16x32_bf16 v[188:191], v[108:111], v[92:95], v[188:191]
  ds_read_b64_tr_b16 v[70:71], v22 offset:16896
  v_mfma_f32_16x16x32_bf16 v[192:195], v[112:115], v[80:83], v[192:195]
  ds_read_b64_tr_b16 v[72:73], v23 offset:0
  v_mfma_f32_16x16x32_bf16 v[196:199], v[112:115], v[84:87], v[196:199]
  ds_read_b64_tr_b16 v[74:75], v23 offset:256
  v_mfma_f32_16x16x32_bf16 v[200:203], v[112:115], v[88:91], v[200:203]
  s_cmp_lg_u32 s79, 0
  s_nop 0
  v_mfma_f32_16x16x32_bf16 v[204:207], v[112:115], v[92:95], v[204:207]
  v_mfma_f32_16x16x32_bf16 v[208:211], v[116:119], v[80:83], v[208:211]
  v_mfma_f32_16x16x32_bf16 v[212:215], v[116:119], v[84:87], v[212:215]
  v_mfma_f32_16x16x32_bf16 v[216:219], v[116:119], v[88:91], v[216:219]
  v_mfma_f32_16x16x32_bf16 v[220:223], v[116:119], v[92:95], v[220:223]
  v_mfma_f32_16x16x32_bf16 v[224:227], v[120:123], v[80:83], v[224:227]
  v_mfma_f32_16x16x32_bf16 v[228:231], v[120:123], v[84:87], v[228:231]
  v_mfma_f32_16x16x32_bf16 v[232:235], v[120:123], v[88:91], v[232:235]
  v_mfma_f32_16x16x32_bf16 v[236:239], v[120:123], v[92:95], v[236:239]
  s_waitcnt lgkmcnt(0)
  s_cbranch_scc1 L_w1_loop
L_w1_exit:
  ds_read2_b32 v[88:89], v14 offset0:0 offset1:160
  ds_read2_b32 v[90:91], v14 offset0:16 offset1:176
  ds_read2_b32 v[92:93], v14 offset0:32 offset1:192
  ds_read2_b32 v[94:95], v14 offset0:48 offset1:208
  ds_read_b128 v[32:35], v15 offset:0
  ds_read_b128 v[60:63], v15 offset:1024
  ds_read_b128 v[36:39], v15 offset:64
  ds_read_b128 v[64:67], v15 offset:1088
  ds_read_b128 v[40:43], v15 offset:256
  ds_read_b128 v[68:71], v15 offset:1280
  ds_read_b128 v[44:47], v15 offset:320
  ds_read_b128 v[72:75], v15 offset:1344
  ds_read_b128 v[48:51], v15 offset:512
  ds_read_b128 v[76:79], v15 offset:1536
  ds_read_b128 v[52:55], v15 offset:576
  ds_read_b128 v[80:83], v15 offset:1600
  ds_read_b128 v[56:59], v16 offset:768
  ds_read_b128 v[84:87], v16 offset:1792
  v_mov_b32 v96, 0xc0135761
  v_mov_b32 v97, 0xbdd2d3e8
  v_mov_b32 v98, 1.0
  s_waitcnt lgkmcnt(0)
  v_mul_f32 v88, v88, v89
  v_mul_f32 v90, v90, v91
  v_mul_f32 v92, v92, v93
  v_mul_f32 v94, v94, v95
  v_pk_fma_f32 v[100:101], v[32:33], v[88:89], v[60:61] op_sel:[0,0,0] op_sel_hi:[1,0,1] neg_lo:[0,1,0] neg_hi:[0,1,0]
  v_pk_fma_f32 v[102:103], v[34:35], v[88:89], v[62:63] op_sel:[0,0,0] op_sel_hi:[1,0,1] neg_lo:[0,1,0] neg_hi:[0,1,0]
  v_pk_fma_f32 v[128:129], v[128:129], v[88:89], v[100:101] op_sel:[0,1,0] op_sel_hi:[1,1,1]
  v_pk_fma_f32 v[130:131], v[130:131], v[88:89], v[102:103] op_sel:[0,1,0] op_sel_hi:[1,1,1]
  v_pk_mul_f32 v[100:101], v[128:129], v[128:129]
  v_pk_mul_f32 v[102:103], v[130:131], v[130:131]
  v_pk_fma_f32 v[100:101], v[100:101], v[96:97], v[96:97] op_sel:[0,1,0] op_sel_hi:[1,1,0]
  v_pk_fma_f32 v[102:103], v[102:103], v[96:97], v[96:97] op_sel:[0,1,0] op_sel_hi:[1,1,0]
  v_pk_mul_f32 v[100:101], v[100:101], v[128:129]
  v_pk_mul_f32 v[102:103], v[102:103], v[130:131]
  v_exp_f32 v100, v100
  v_exp_f32 v101, v101
  v_exp_f32 v102, v102
  v_exp_f32 v103, v103
  v_pk_add_f32 v[100:101], v[100:101], v[98:99] op_sel_hi:[1,0]
  v_pk_add_f32 v[102:103], v[102:103], v[98:99] op_sel_hi:[1,0]
  v_rcp_f32 v100, v100
  v_rcp_f32 v101, v101
  v_rcp_f32 v102, v102
  v_rcp_f32 v103, v103
  v_pk_mul_f32 v[128:129], v[128:129], v[100:101]
  v_pk_mul_f32 v[130:131], v[130:131], v[102:103]
  v_cvt_pk_bf16_f32 v108, v128, v129
  v_cvt_pk_bf16_f32 v109, v130, v131
  v_pk_fma_f32 v[104:105], v[36:37], v[88:89], v[64:65] op_sel:[0,0,0] op_sel_hi:[1,0,1] neg_lo:[0,1,0] neg_hi:[0,1,0]
  v_pk_fma_f32 v[106:107], v[38:39], v[88:89], v[66:67] op_sel:[0,0,0] op_sel_hi:[1,0,1] neg_lo:[0,1,0] neg_hi:[0,1,0]
  v_pk_fma_f32 v[144:145], v[144:145], v[88:89], v[104:105] op_sel:[0,1,0] op_sel_hi:[1,1,1]
  v_pk_fma_f32 v[146:147], v[146:147], v[88:89], v[106:107] op_sel:[0,1,0] op_sel_hi:[1,1,1]
  v_pk_mul_f32 v[104:105], v[144:145], v[144:145]
  v_pk_mul_f32 v[106:107], v[146:147], v[146:147]
  v_pk_fma_f32 v[104:105], v[104:105], v[96:97], v[96:97] op_sel:[0,1,0] op_sel_hi:[1,1,0]
  v_pk_fma_f32 v[106:107], v[106:107], v[96:97], v[96:97] op_sel:[0,1,0] op_sel_hi:[1,1,0]
  v_pk_mul_f32 v[104:105], v[104:105], v[144:145]
  v_pk_mul_f32 v[106:107], v[106:107], v[146:147]
  v_exp_f32 v104, v104
  v_exp_f32 v105, v105
  v_exp_f32 v106, v106
  v_exp_f32 v107, v107
  v_pk_add_f32 v[104:105], v[104:105], v[98:99] op_sel_hi:[1,0]
  v_pk_add_f32 v[106:107], v[106:107], v[98:99] op_sel_hi:[1,0]
  v_rcp_f32 v104, v104
  v_rcp_f32 v105, v105
  v_rcp_f32 v106, v106
  v_rcp_f32 v107, v107
  v_pk_mul_f32 v[144:145], v[144:145], v[104:105]
  v_pk_mul_f32 v[146:147], v[146:147], v[106:107]
  v_cvt_pk_bf16_f32 v110, v144, v145
  v_cvt_pk_bf16_f32 v111, v146, v147
  s_mov_b32 s3, 0
  s_nop 0
  v_permlane16_swap_b32 v108, v110
  v_permlane16_swap_b32 v109, v111
  buffer_store_dwordx4 v[108:111], v12, s[44:47], s3 offen sc1
  v_pk_fma_f32 v[100:101], v[32:33], v[90:91], v[60:61] op_sel:[0,0,0] op_sel_hi:[1,0,1] neg_lo:[0,1,0] neg_hi:[0,1,0]
  v_pk_fma_f32 v[102:103], v[34:35], v[90:91], v[62:63] op_sel:[0,0,0] op_sel_hi:[1,0,1] neg_lo:[0,1,0] neg_hi:[0,1,0]
  v_pk_fma_f32 v[132:133], v[132:133], v[90:91], v[100:101] op_sel:[0,1,0] op_sel_hi:[1,1,1]
  v_pk_fma_f32 v[134:135], v[134:135], v[90:91], v[102:103] op_sel:[0,1,0] op_sel_hi:[1,1,1]
  v_pk_mul_f32 v[100:101], v[132:133], v[132:133]
  v_pk_mul_f32 v[102:103], v[134:135], v[134:135]
  v_pk_fma_f32 v[100:101], v[100:101], v[96:97], v[96:97] op_sel:[0,1,0] op_sel_hi:[1,1,0]
  v_pk_fma_f32 v[102:103], v[102:103], v[96:97], v[96:97] op_sel:[0,1,0] op_sel_hi:[1,1,0]
  v_pk_mul_f32 v[100:101], v[100:101], v[132:133]
  v_pk_mul_f32 v[102:103], v[102:103], v[134:135]
  v_exp_f32 v100, v100
  v_exp_f32 v101, v101
  v_exp_f32 v102, v102
  v_exp_f32 v103, v103
  v_pk_add_f32 v[100:101], v[100:101], v[98:99] op_sel_hi:[1,0]
  v_pk_add_f32 v[102:103], v[102:103], v[98:99] op_sel_hi:[1,0]
  v_rcp_f32 v100, v100
  v_rcp_f32 v101, v101
  v_rcp_f32 v102, v102
  v_rcp_f32 v103, v103
  v_pk_mul_f32 v[132:133], v[132:133], v[100:101]
  v_pk_mul_f32 v[134:135], v[134:135], v[102:103]
  v_cvt_pk_bf16_f32 v112, v132, v133
  v_cvt_pk_bf16_f32 v113, v134, v135
  v_pk_fma_f32 v[104:105], v[36:37], v[90:91], v[64:65] op_sel:[0,0,0] op_sel_hi:[1,0,1] neg_lo:[0,1,0] neg_hi:[0,1,0]
  v_pk_fma_f32 v[106:107], v[38:39], v[90:91], v[66:67] op_sel:[0,0,0] op_sel_hi:[1,0,1] neg_lo:[0,1,0] neg_hi:[0,1,0]
  v_pk_fma_f32 v[148:149], v[148:149], v[90:91], v[104:105] op_sel:[0,1,0] op_sel_hi:[1,1,1]
  v_pk_fma_f32 v[150:151], v[150:151], v[90:91], v[106:107] op_sel:[0,1,0] op_sel_hi:[1,1,1]
  v_pk_mul_f32 v[104:105], v[148:149], v[148:149]
  v_pk_mul_f32 v[106:107], v[150:151], v[150:151]
  v_pk_fma_f32 v[104:105], v[104:105], v[96:97], v[96:97] op_sel:[0,1,0] op_sel_hi:[1,1,0]
  v_pk_fma_f32 v[106:107], v[106:107], v[96:97], v[96:97] op_sel:[0,1,0] op_sel_hi:[1,1,0]
  v_pk_mul_f32 v[104:105], v[104:105], v[148:149]
  v_pk_mul_f32 v[106:107], v[106:107], v[150:151]
  v_exp_f32 v104, v104
  v_exp_f32 v105, v105
  v_exp_f32 v106, v106
  v_exp_f32 v107, v107
  v_pk_add_f32 v[104:105], v[104:105], v[98:99] op_sel_hi:[1,0]
  v_pk_add_f32 v[106:107], v[106:107], v[98:99] op_sel_hi:[1,0]
  v_rcp_f32 v104, v104
  v_rcp_f32 v105, v105
  v_rcp_f32 v106, v106
  v_rcp_f32 v107, v107
  v_pk_mul_f32 v[148:149], v[148:149], v[104:105]
  v_pk_mul_f32 v[150:151], v[150:151], v[106:107]
  v_cvt_pk_bf16_f32 v114, v148, v149
  v_cvt_pk_bf16_f32 v115, v150, v151
  s_mov_b32 s3, 114688
  s_nop 0
  v_permlane16_swap_b32 v112, v114
  v_permlane16_swap_b32 v113, v115
  buffer_store_dwordx4 v[112:115], v12, s[44:47], s3 offen sc1
  v_pk_fma_f32 v[100:101], v[32:33], v[92:93], v[60:61] op_sel:[0,0,0] op_sel_hi:[1,0,1] neg_lo:[0,1,0] neg_hi:[0,1,0]
  v_pk_fma_f32 v[102:103], v[34:35], v[92:93], v[62:63] op_sel:[0,0,0] op_sel_hi:[1,0,1] neg_lo:[0,1,0] neg_hi:[0,1,0]
  v_pk_fma_f32 v[136:137], v[136:137], v[92:93], v[100:101] op_sel:[0,1,0] op_sel_hi:[1,1,1]
  v_pk_fma_f32 v[138:139], v[138:139], v[92:93], v[102:103] op_sel:[0,1,0] op_sel_hi:[1,1,1]
  v_pk_mul_f32 v[100:101], v[136:137], v[136:137]
  v_pk_mul_f32 v[102:103], v[138:139], v[138:139]
  v_pk_fma_f32 v[100:101], v[100:101], v[96:97], v[96:97] op_sel:[0,1,0] op_sel_hi:[1,1,0]
  v_pk_fma_f32 v[102:103], v[102:103], v[96:97], v[96:97] op_sel:[0,1,0] op_sel_hi:[1,1,0]
  v_pk_mul_f32 v[100:101], v[100:101], v[136:137]
  v_pk_mul_f32 v[102:103], v[102:103], v[138:139]
  v_exp_f32 v100, v100
  v_exp_f32 v101, v101
  v_exp_f32 v102, v102
  v_exp_f32 v103, v103
  v_pk_add_f32 v[100:101], v[100:101], v[98:99] op_sel_hi:[1,0]
  v_pk_add_f32 v[102:103], v[102:103], v[98:99] op_sel_hi:[1,0]
  v_rcp_f32 v100, v100
  v_rcp_f32 v101, v101
  v_rcp_f32 v102, v102
  v_rcp_f32 v103, v103
  v_pk_mul_f32 v[136:137], v[136:137], v[100:101]
  v_pk_mul_f32 v[138:139], v[138:139], v[102:103]
  v_cvt_pk_bf16_f32 v116, v136, v137
  v_cvt_pk_bf16_f32 v117, v138, v139
  v_pk_fma_f32 v[104:105], v[36:37], v[92:93], v[64:65] op_sel:[0,0,0] op_sel_hi:[1,0,1] neg_lo:[0,1,0] neg_hi:[0,1,0]
  v_pk_fma_f32 v[106:107], v[38:39], v[92:93], v[66:67] op_sel:[0,0,0] op_sel_hi:[1,0,1] neg_lo:[0,1,0] neg_hi:[0,1,0]
  v_pk_fma_f32 v[152:153], v[152:153], v[92:93], v[104:105] op_sel:[0,1,0] op_sel_hi:[1,1,1]
  v_pk_fma_f32 v[154:155], v[154:155], v[92:93], v[106:107] op_sel:[0,1,0] op_sel_hi:[1,1,1]
  v_pk_mul_f32 v[104:105], v[152:153], v[152:153]
  v_pk_mul_f32 v[106:107], v[154:155], v[154:155]
  v_pk_fma_f32 v[104:105], v[104:105], v[96:97], v[96:97] op_sel:[0,1,0] op_sel_hi:[1,1,0]
  v_pk_fma_f32 v[106:107], v[106:107], v[96:97], v[96:97] op_sel:[0,1,0] op_sel_hi:[1,1,0]
  v_pk_mul_f32 v[104:105], v[104:105], v[152:153]
  v_pk_mul_f32 v[106:107], v[106:107], v[154:155]
  v_exp_f32 v104, v104
  v_exp_f32 v105, v105
  v_exp_f32 v106, v106
  v_exp_f32 v107, v107
  v_pk_add_f32 v[104:105], v[104:105], v[98:99] op_sel_hi:[1,0]
  v_pk_add_f32 v[106:107], v[106:107], v[98:99] op_sel_hi:[1,0]
  v_rcp_f32 v104, v104
  v_rcp_f32 v105, v105
  v_rcp_f32 v106, v106
  v_rcp_f32 v107, v107
  v_pk_mul_f32 v[152:153], v[152:153], v[104:105]
  v_pk_mul_f32 v[154:155], v[154:155], v[106:107]
  v_cvt_pk_bf16_f32 v118, v152, v153
  v_cvt_pk_bf16_f32 v119, v154, v155
  s_mov_b32 s3, 229376
  s_nop 0
  v_permlane16_swap_b32 v116, v118
  v_permlane16_swap_b32 v117, v119
  buffer_store_dwordx4 v[116:119], v12, s[44:47], s3 offen sc1
  v_pk_fma_f32 v[100:101], v[32:33], v[94:95], v[60:61] op_sel:[0,0,0] op_sel_hi:[1,0,1] neg_lo:[0,1,0] neg_hi:[0,1,0]
  v_pk_fma_f32 v[102:103], v[34:35], v[94:95], v[62:63] op_sel:[0,0,0] op_sel_hi:[1,0,1] neg_lo:[0,1,0] neg_hi:[0,1,0]
  v_pk_fma_f32 v[140:141], v[140:141], v[94:95], v[100:101] op_sel:[0,1,0] op_sel_hi:[1,1,1]
  v_pk_fma_f32 v[142:143], v[142:143], v[94:95], v[102:103] op_sel:[0,1,0] op_sel_hi:[1,1,1]
  v_pk_mul_f32 v[100:101], v[140:141], v[140:141]
  v_pk_mul_f32 v[102:103], v[142:143], v[142:143]
  v_pk_fma_f32 v[100:101], v[100:101], v[96:97], v[96:97] op_sel:[0,1,0] op_sel_hi:[1,1,0]
  v_pk_fma_f32 v[102:103], v[102:103], v[96:97], v[96:97] op_sel:[0,1,0] op_sel_hi:[1,1,0]
  v_pk_mul_f32 v[100:101], v[100:101], v[140:141]
  v_pk_mul_f32 v[102:103], v[102:103], v[142:143]
  v_exp_f32 v100, v100
  v_exp_f32 v101, v101
  v_exp_f32 v102, v102
  v_exp_f32 v103, v103
  v_pk_add_f32 v[100:101], v[100:101], v[98:99] op_sel_hi:[1,0]
  v_pk_add_f32 v[102:103], v[102:103], v[98:99] op_sel_hi:[1,0]
  v_rcp_f32 v100, v100
  v_rcp_f32 v101, v101
  v_rcp_f32 v102, v102
  v_rcp_f32 v103, v103
  v_pk_mul_f32 v[140:141], v[140:141], v[100:101]
  v_pk_mul_f32 v[142:143], v[142:143], v[102:103]
  v_cvt_pk_bf16_f32 v120, v140, v141
  v_cvt_pk_bf16_f32 v121, v142, v143
  v_pk_fma_f32 v[104:105], v[36:37], v[94:95], v[64:65] op_sel:[0,0,0] op_sel_hi:[1,0,1] neg_lo:[0,1,0] neg_hi:[0,1,0]
  v_pk_fma_f32 v[106:107], v[38:39], v[94:95], v[66:67] op_sel:[0,0,0] op_sel_hi:[1,0,1] neg_lo:[0,1,0] neg_hi:[0,1,0]
  v_pk_fma_f32 v[156:157], v[156:157], v[94:95], v[104:105] op_sel:[0,1,0] op_sel_hi:[1,1,1]
  v_pk_fma_f32 v[158:159], v[158:159], v[94:95], v[106:107] op_sel:[0,1,0] op_sel_hi:[1,1,1]
  v_pk_mul_f32 v[104:105], v[156:157], v[156:157]
  v_pk_mul_f32 v[106:107], v[158:159], v[158:159]
  v_pk_fma_f32 v[104:105], v[104:105], v[96:97], v[96:97] op_sel:[0,1,0] op_sel_hi:[1,1,0]
  v_pk_fma_f32 v[106:107], v[106:107], v[96:97], v[96:97] op_sel:[0,1,0] op_sel_hi:[1,1,0]
  v_pk_mul_f32 v[104:105], v[104:105], v[156:157]
  v_pk_mul_f32 v[106:107], v[106:107], v[158:159]
  v_exp_f32 v104, v104
  v_exp_f32 v105, v105
  v_exp_f32 v106, v106
  v_exp_f32 v107, v107
  v_pk_add_f32 v[104:105], v[104:105], v[98:99] op_sel_hi:[1,0]
  v_pk_add_f32 v[106:107], v[106:107], v[98:99] op_sel_hi:[1,0]
  v_rcp_f32 v104, v104
  v_rcp_f32 v105, v105
  v_rcp_f32 v106, v106
  v_rcp_f32 v107, v107
  v_pk_mul_f32 v[156:157], v[156:157], v[104:105]
  v_pk_mul_f32 v[158:159], v[158:159], v[106:107]
  v_cvt_pk_bf16_f32 v122, v156, v157
  v_cvt_pk_bf16_f32 v123, v158, v159
  s_mov_b32 s3, 344064
  s_nop 0
  v_permlane16_swap_b32 v120, v122
  v_permlane16_swap_b32 v121, v123
  buffer_store_dwordx4 v[120:123], v12, s[44:47], s3 offen sc1
  v_pk_fma_f32 v[100:101], v[56:57], v[88:89], v[84:85] op_sel:[0,0,0] op_sel_hi:[1,0,1] neg_lo:[0,1,0] neg_hi:[0,1,0]
  v_pk_fma_f32 v[102:103], v[58:59], v[88:89], v[86:87] op_sel:[0,0,0] op_sel_hi:[1,0,1] neg_lo:[0,1,0] neg_hi:[0,1,0]
  v_pk_fma_f32 v[224:225], v[224:225], v[88:89], v[100:101] op_sel:[0,1,0] op_sel_hi:[1,1,1]
  v_pk_fma_f32 v[226:227], v[226:227], v[88:89], v[102:103] op_sel:[0,1,0] op_sel_hi:[1,1,1]
  v_pk_mul_f32 v[100:101], v[224:225], v[224:225]
  v_pk_mul_f32 v[102:103], v[226:227], v[226:227]
  v_pk_fma_f32 v[100:101], v[100:101], v[96:97], v[96:97] op_sel:[0,1,0] op_sel_hi:[1,1,0]
  v_pk_fma_f32 v[102:103], v[102:103], v[96:97], v[96:97] op_sel:[0,1,0] op_sel_hi:[1,1,0]
  v_pk_mul_f32 v[100:101], v[100:101], v[224:225]
  v_pk_mul_f32 v[102:103], v[102:103], v[226:227]
  v_exp_f32 v100, v100
  v_exp_f32 v101, v101
  v_exp_f32 v102, v102
  v_exp_f32 v103, v103
  v_pk_add_f32 v[100:101], v[100:101], v[98:99] op_sel_hi:[1,0]
  v_pk_add_f32 v[102:103], v[102:103], v[98:99] op_sel_hi:[1,0]
  v_rcp_f32 v100, v100
  v_rcp_f32 v101, v101
  v_rcp_f32 v102, v102
  v_rcp_f32 v103, v103
  v_pk_mul_f32 v[224:225], v[224:225], v[100:101]
  v_pk_mul_f32 v[226:227], v[226:227], v[102:103]
  v_cvt_pk_bf16_f32 v108, v224, v225
  v_cvt_pk_bf16_f32 v109, v226, v227
  v_pk_fma_f32 v[100:101], v[56:57], v[90:91], v[84:85] op_sel:[0,0,0] op_sel_hi:[1,0,1] neg_lo:[0,1,0] neg_hi:[0,1,0]
  v_pk_fma_f32 v[102:103], v[58:59], v[90:91], v[86:87] op_sel:[0,0,0] op_sel_hi:[1,0,1] neg_lo:[0,1,0] neg_hi:[0,1,0]
  v_pk_fma_f32 v[228:229], v[228:229], v[90:91], v[100:101] op_sel:[0,1,0] op_sel_hi:[1,1,1]
  v_pk_fma_f32 v[230:231], v[230:231], v[90:91], v[102:103] op_sel:[0,1,0] op_sel_hi:[1,1,1]
  v_pk_mul_f32 v[100:101], v[228:229], v[228:229]
  v_pk_mul_f32 v[102:103], v[230:231], v[230:231]
  v_pk_fma_f32 v[100:101], v[100:101], v[96:97], v[96:97] op_sel:[0,1,0] op_sel_hi:[1,1,0]
  v_pk_fma_f32 v[102:103], v[102:103], v[96:97], v[96:97] op_sel:[0,1,0] op_sel_hi:[1,1,0]
  v_pk_mul_f32 v[100:101], v[100:101], v[228:229]
  v_pk_mul_f32 v[102:103], v[102:103], v[230:231]
  v_exp_f32 v100, v100
  v_exp_f32 v101, v101
  v_exp_f32 v102, v102
  v_exp_f32 v103, v103
  v_pk_add_f32 v[100:101], v[100:101], v[98:99] op_sel_hi:[1,0]
  v_pk_add_f32 v[102:103], v[102:103], v[98:99] op_sel_hi:[1,0]
  v_rcp_f32 v100, v100
  v_rcp_f32 v101, v101
  v_rcp_f32 v102, v102
  v_rcp_f32 v103, v103
  v_pk_mul_f32 v[228:229], v[228:229], v[100:101]
  v_pk_mul_f32 v[230:231], v[230:231], v[102:103]
  v_cvt_pk_bf16_f32 v110, v228, v229
  v_cvt_pk_bf16_f32 v111, v230, v231
  s_mov_b32 s3, 32768
  s_nop 0
  v_permlane16_swap_b32 v108, v110
  v_permlane16_swap_b32 v109, v111
  buffer_store_dwordx4 v[108:111], v13, s[44:47], s3 offen sc1
  v_pk_fma_f32 v[100:101], v[56:57], v[92:93], v[84:85] op_sel:[0,0,0] op_sel_hi:[1,0,1] neg_lo:[0,1,0] neg_hi:[0,1,0]
  v_pk_fma_f32 v[102:103], v[58:59], v[92:93], v[86:87] op_sel:[0,0,0] op_sel_hi:[1,0,1] neg_lo:[0,1,0] neg_hi:[0,1,0]
  v_pk_fma_f32 v[232:233], v[232:233], v[92:93], v[100:101] op_sel:[0,1,0] op_sel_hi:[1,1,1]
  v_pk_fma_f32 v[234:235], v[234:235], v[92:93], v[102:103] op_sel:[0,1,0] op_sel_hi:[1,1,1]
  v_pk_mul_f32 v[100:101], v[232:233], v[232:233]
  v_pk_mul_f32 v[102:103], v[234:235], v[234:235]
  v_pk_fma_f32 v[100:101], v[100:101], v[96:97], v[96:97] op_sel:[0,1,0] op_sel_hi:[1,1,0]
  v_pk_fma_f32 v[102:103], v[102:103], v[96:97], v[96:97] op_sel:[0,1,0] op_sel_hi:[1,1,0]
  v_pk_mul_f32 v[100:101], v[100:101], v[232:233]
  v_pk_mul_f32 v[102:103], v[102:103], v[234:235]
  v_exp_f32 v100, v100
  v_exp_f32 v101, v101
  v_exp_f32 v102, v102
  v_exp_f32 v103, v103
  v_pk_add_f32 v[100:101], v[100:101], v[98:99] op_sel_hi:[1,0]
  v_pk_add_f32 v[102:103], v[102:103], v[98:99] op_sel_hi:[1,0]
  v_rcp_f32 v100, v100
  v_rcp_f32 v101, v101
  v_rcp_f32 v102, v102
  v_rcp_f32 v103, v103
  v_pk_mul_f32 v[232:233], v[232:233], v[100:101]
  v_pk_mul_f32 v[234:235], v[234:235], v[102:103]
  v_cvt_pk_bf16_f32 v112, v232, v233
  v_cvt_pk_bf16_f32 v113, v234, v235
  v_pk_fma_f32 v[100:101], v[56:57], v[94:95], v[84:85] op_sel:[0,0,0] op_sel_hi:[1,0,1] neg_lo:[0,1,0] neg_hi:[0,1,0]
  v_pk_fma_f32 v[102:103], v[58:59], v[94:95], v[86:87] op_sel:[0,0,0] op_sel_hi:[1,0,1] neg_lo:[0,1,0] neg_hi:[0,1,0]
  v_pk_fma_f32 v[236:237], v[236:237], v[94:95], v[100:101] op_sel:[0,1,0] op_sel_hi:[1,1,1]
  v_pk_fma_f32 v[238:239], v[238:239], v[94:95], v[102:103] op_sel:[0,1,0] op_sel_hi:[1,1,1]
  v_pk_mul_f32 v[100:101], v[236:237], v[236:237]
  v_pk_mul_f32 v[102:103], v[238:239], v[238:239]
  v_pk_fma_f32 v[100:101], v[100:101], v[96:97], v[96:97] op_sel:[0,1,0] op_sel_hi:[1,1,0]
  v_pk_fma_f32 v[102:103], v[102:103], v[96:97], v[96:97] op_sel:[0,1,0] op_sel_hi:[1,1,0]
  v_pk_mul_f32 v[100:101], v[100:101], v[236:237]
  v_pk_mul_f32 v[102:103], v[102:103], v[238:239]
  v_exp_f32 v100, v100
  v_exp_f32 v101, v101
  v_exp_f32 v102, v102
  v_exp_f32 v103, v103
  v_pk_add_f32 v[100:101], v[100:101], v[98:99] op_sel_hi:[1,0]
  v_pk_add_f32 v[102:103], v[102:103], v[98:99] op_sel_hi:[1,0]
  v_rcp_f32 v100, v100
  v_rcp_f32 v101, v101
  v_rcp_f32 v102, v102
  v_rcp_f32 v103, v103
  v_pk_mul_f32 v[236:237], v[236:237], v[100:101]
  v_pk_mul_f32 v[238:239], v[238:239], v[102:103]
  v_cvt_pk_bf16_f32 v114, v236, v237
  v_cvt_pk_bf16_f32 v115, v238, v239
  s_mov_b32 s3, 262144
  s_nop 0
  v_permlane16_swap_b32 v112, v114
  v_permlane16_swap_b32 v113, v115
  buffer_store_dwordx4 v[112:115], v13, s[44:47], s3 offen sc1
  v_pk_fma_f32 v[100:101], v[40:41], v[88:89], v[68:69] op_sel:[0,0,0] op_sel_hi:[1,0,1] neg_lo:[0,1,0] neg_hi:[0,1,0]
  v_pk_fma_f32 v[102:103], v[42:43], v[88:89], v[70:71] op_sel:[0,0,0] op_sel_hi:[1,0,1] neg_lo:[0,1,0] neg_hi:[0,1,0]
  v_pk_fma_f32 v[160:161], v[160:161], v[88:89], v[100:101] op_sel:[0,1,0] op_sel_hi:[1,1,1]
  v_pk_fma_f32 v[162:163], v[162:163], v[88:89], v[102:103] op_sel:[0,1,0] op_sel_hi:[1,1,1]
  v_pk_mul_f32 v[100:101], v[160:161], v[160:161]
  v_pk_mul_f32 v[102:103], v[162:163], v[162:163]
  v_pk_fma_f32 v[100:101], v[100:101], v[96:97], v[96:97] op_sel:[0,1,0] op_sel_hi:[1,1,0]
  v_pk_fma_f32 v[102:103], v[102:103], v[96:97], v[96:97] op_sel:[0,1,0] op_sel_hi:[1,1,0]
  v_pk_mul_f32 v[100:101], v[100:101], v[160:161]
  v_pk_mul_f32 v[102:103], v[102:103], v[162:163]
  v_exp_f32 v100, v100
  v_exp_f32 v101, v101
  v_exp_f32 v102, v102
  v_exp_f32 v103, v103
  v_pk_add_f32 v[100:101], v[100:101], v[98:99] op_sel_hi:[1,0]
  v_pk_add_f32 v[102:103], v[102:103], v[98:99] op_sel_hi:[1,0]
  v_rcp_f32 v100, v100
  v_rcp_f32 v101, v101
  v_rcp_f32 v102, v102
  v_rcp_f32 v103, v103
  v_pk_mul_f32 v[160:161], v[160:161], v[100:101]
  v_pk_mul_f32 v[162:163], v[162:163], v[102:103]
  v_cvt_pk_bf16_f32 v116, v160, v161
  v_cvt_pk_bf16_f32 v117, v162, v163
  v_pk_fma_f32 v[104:105], v[44:45], v[88:89], v[72:73] op_sel:[0,0,0] op_sel_hi:[1,0,1] neg_lo:[0,1,0] neg_hi:[0,1,0]
  v_pk_fma_f32 v[106:107], v[46:47], v[88:89], v[74:75] op_sel:[0,0,0] op_sel_hi:[1,0,1] neg_lo:[0,1,0] neg_hi:[0,1,0]
  v_pk_fma_f32 v[176:177], v[176:177], v[88:89], v[104:105] op_sel:[0,1,0] op_sel_hi:[1,1,1]
  v_pk_fma_f32 v[178:179], v[178:179], v[88:89], v[106:107] op_sel:[0,1,0] op_sel_hi:[1,1,1]
  v_pk_mul_f32 v[104:105], v[176:177], v[176:177]
  v_pk_mul_f32 v[106:107], v[178:179], v[178:179]
  v_pk_fma_f32 v[104:105], v[104:105], v[96:97], v[96:97] op_sel:[0,1,0] op_sel_hi:[1,1,0]
  v_pk_fma_f32 v[106:107], v[106:107], v[96:97], v[96:97] op_sel:[0,1,0] op_sel_hi:[1,1,0]
  v_pk_mul_f32 v[104:105], v[104:105], v[176:177]
  v_pk_mul_f32 v[106:107], v[106:107], v[178:179]
  v_exp_f32 v104, v104
  v_exp_f32 v105, v105
  v_exp_f32 v106, v106
  v_exp_f32 v107, v107
  v_pk_add_f32 v[104:105], v[104:105], v[98:99] op_sel_hi:[1,0]
  v_pk_add_f32 v[106:107], v[106:107], v[98:99] op_sel_hi:[1,0]
  v_rcp_f32 v104, v104
  v_rcp_f32 v105, v105
  v_rcp_f32 v106, v106
  v_rcp_f32 v107, v107
  v_pk_mul_f32 v[176:177], v[176:177], v[104:105]
  v_pk_mul_f32 v[178:179], v[178:179], v[106:107]
  v_cvt_pk_bf16_f32 v118, v176, v177
  v_cvt_pk_bf16_f32 v119, v178, v179
  s_add_u32 s3, s10, 49152
  s_nop 0
  v_permlane16_swap_b32 v116, v118
  v_permlane16_swap_b32 v117, v119
  buffer_store_dwordx4 v[116:119], v12, s[44:47], s3 offen sc1
  v_pk_fma_f32 v[100:101], v[48:49], v[88:89], v[76:77] op_sel:[0,0,0] op_sel_hi:[1,0,1] neg_lo:[0,1,0] neg_hi:[0,1,0]
  v_pk_fma_f32 v[102:103], v[50:51], v[88:89], v[78:79] op_sel:[0,0,0] op_sel_hi:[1,0,1] neg_lo:[0,1,0] neg_hi:[0,1,0]
  v_pk_fma_f32 v[192:193], v[192:193], v[88:89], v[100:101] op_sel:[0,1,0] op_sel_hi:[1,1,1]
  v_pk_fma_f32 v[194:195], v[194:195], v[88:89], v[102:103] op_sel:[0,1,0] op_sel_hi:[1,1,1]
  v_pk_mul_f32 v[100:101], v[192:193], v[192:193]
  v_pk_mul_f32 v[102:103], v[194:195], v[194:195]
  v_pk_fma_f32 v[100:101], v[100:101], v[96:97], v[96:97] op_sel:[0,1,0] op_sel_hi:[1,1,0]
  v_pk_fma_f32 v[102:103], v[102:103], v[96:97], v[96:97] op_sel:[0,1,0] op_sel_hi:[1,1,0]
  v_pk_mul_f32 v[100:101], v[100:101], v[192:193]
  v_pk_mul_f32 v[102:103], v[102:103], v[194:195]
  v_exp_f32 v100, v100
  v_exp_f32 v101, v101
  v_exp_f32 v102, v102
  v_exp_f32 v103, v103
  v_pk_add_f32 v[100:101], v[100:101], v[98:99] op_sel_hi:[1,0]
  v_pk_add_f32 v[102:103], v[102:103], v[98:99] op_sel_hi:[1,0]
  v_rcp_f32 v100, v100
  v_rcp_f32 v101, v101
  v_rcp_f32 v102, v102
  v_rcp_f32 v103, v103
  v_pk_mul_f32 v[192:193], v[192:193], v[100:101]
  v_pk_mul_f32 v[194:195], v[194:195], v[102:103]
  v_cvt_pk_bf16_f32 v120, v192, v193
  v_cvt_pk_bf16_f32 v121, v194, v195
  v_pk_fma_f32 v[104:105], v[52:53], v[88:89], v[80:81] op_sel:[0,0,0] op_sel_hi:[1,0,1] neg_lo:[0,1,0] neg_hi:[0,1,0]
  v_pk_fma_f32 v[106:107], v[54:55], v[88:89], v[82:83] op_sel:[0,0,0] op_sel_hi:[1,0,1] neg_lo:[0,1,0] neg_hi:[0,1,0]
  v_pk_fma_f32 v[208:209], v[208:209], v[88:89], v[104:105] op_sel:[0,1,0] op_sel_hi:[1,1,1]
  v_pk_fma_f32 v[210:211], v[210:211], v[88:89], v[106:107] op_sel:[0,1,0] op_sel_hi:[1,1,1]
  v_pk_mul_f32 v[104:105], v[208:209], v[208:209]
  v_pk_mul_f32 v[106:107], v[210:211], v[210:211]
  v_pk_fma_f32 v[104:105], v[104:105], v[96:97], v[96:97] op_sel:[0,1,0] op_sel_hi:[1,1,0]
  v_pk_fma_f32 v[106:107], v[106:107], v[96:97], v[96:97] op_sel:[0,1,0] op_sel_hi:[1,1,0]
  v_pk_mul_f32 v[104:105], v[104:105], v[208:209]
  v_pk_mul_f32 v[106:107], v[106:107], v[210:211]
  v_exp_f32 v104, v104
  v_exp_f32 v105, v105
  v_exp_f32 v106, v106
  v_exp_f32 v107, v107
  v_pk_add_f32 v[104:105], v[104:105], v[98:99] op_sel_hi:[1,0]
  v_pk_add_f32 v[106:107], v[106:107], v[98:99] op_sel_hi:[1,0]
  v_rcp_f32 v104, v104
  v_rcp_f32 v105, v105
  v_rcp_f32 v106, v106
  v_rcp_f32 v107, v107
  v_pk_mul_f32 v[208:209], v[208:209], v[104:105]
  v_pk_mul_f32 v[210:211], v[210:211], v[106:107]
  v_cvt_pk_bf16_f32 v122, v208, v209
  v_cvt_pk_bf16_f32 v123, v210, v211
  s_add_u32 s3, s10, 51200
  s_nop 0
  v_permlane16_swap_b32 v120, v122
  v_permlane16_swap_b32 v121, v123
  buffer_store_dwordx4 v[120:123], v12, s[44:47], s3 offen sc1
  v_pk_fma_f32 v[100:101], v[40:41], v[90:91], v[68:69] op_sel:[0,0,0] op_sel_hi:[1,0,1] neg_lo:[0,1,0] neg_hi:[0,1,0]
  v_pk_fma_f32 v[102:103], v[42:43], v[90:91], v[70:71] op_sel:[0,0,0] op_sel_hi:[1,0,1] neg_lo:[0,1,0] neg_hi:[0,1,0]
  v_pk_fma_f32 v[164:165], v[164:165], v[90:91], v[100:101] op_sel:[0,1,0] op_sel_hi:[1,1,1]
  v_pk_fma_f32 v[166:167], v[166:167], v[90:91], v[102:103] op_sel:[0,1,0] op_sel_hi:[1,1,1]
  v_pk_mul_f32 v[100:101], v[164:165], v[164:165]
  v_pk_mul_f32 v[102:103], v[166:167], v[166:167]
  v_pk_fma_f32 v[100:101], v[100:101], v[96:97], v[96:97] op_sel:[0,1,0] op_sel_hi:[1,1,0]
  v_pk_fma_f32 v[102:103], v[102:103], v[96:97], v[96:97] op_sel:[0,1,0] op_sel_hi:[1,1,0]
  v_pk_mul_f32 v[100:101], v[100:101], v[164:165]
  v_pk_mul_f32 v[102:103], v[102:103], v[166:167]
  v_exp_f32 v100, v100
  v_exp_f32 v101, v101
  v_exp_f32 v102, v102
  v_exp_f32 v103, v103
  v_pk_add_f32 v[100:101], v[100:101], v[98:99] op_sel_hi:[1,0]
  v_pk_add_f32 v[102:103], v[102:103], v[98:99] op_sel_hi:[1,0]
  v_rcp_f32 v100, v100
  v_rcp_f32 v101, v101
  v_rcp_f32 v102, v102
  v_rcp_f32 v103, v103
  v_pk_mul_f32 v[164:165], v[164:165], v[100:101]
  v_pk_mul_f32 v[166:167], v[166:167], v[102:103]
  v_cvt_pk_bf16_f32 v108, v164, v165
  v_cvt_pk_bf16_f32 v109, v166, v167
  v_pk_fma_f32 v[104:105], v[44:45], v[90:91], v[72:73] op_sel:[0,0,0] op_sel_hi:[1,0,1] neg_lo:[0,1,0] neg_hi:[0,1,0]
  v_pk_fma_f32 v[106:107], v[46:47], v[90:91], v[74:75] op_sel:[0,0,0] op_sel_hi:[1,0,1] neg_lo:[0,1,0] neg_hi:[0,1,0]
  v_pk_fma_f32 v[180:181], v[180:181], v[90:91], v[104:105] op_sel:[0,1,0] op_sel_hi:[1,1,1]
  v_pk_fma_f32 v[182:183], v[182:183], v[90:91], v[106:107] op_sel:[0,1,0] op_sel_hi:[1,1,1]
  v_pk_mul_f32 v[104:105], v[180:181], v[180:181]
  v_pk_mul_f32 v[106:107], v[182:183], v[182:183]
  v_pk_fma_f32 v[104:105], v[104:105], v[96:97], v[96:97] op_sel:[0,1,0] op_sel_hi:[1,1,0]
  v_pk_fma_f32 v[106:107], v[106:107], v[96:97], v[96:97] op_sel:[0,1,0] op_sel_hi:[1,1,0]
  v_pk_mul_f32 v[104:105], v[104:105], v[180:181]
  v_pk_mul_f32 v[106:107], v[106:107], v[182:183]
  v_exp_f32 v104, v104
  v_exp_f32 v105, v105
  v_exp_f32 v106, v106
  v_exp_f32 v107, v107
  v_pk_add_f32 v[104:105], v[104:105], v[98:99] op_sel_hi:[1,0]
  v_pk_add_f32 v[106:107], v[106:107], v[98:99] op_sel_hi:[1,0]
  v_rcp_f32 v104, v104
  v_rcp_f32 v105, v105
  v_rcp_f32 v106, v106
  v_rcp_f32 v107, v107
  v_pk_mul_f32 v[180:181], v[180:181], v[104:105]
  v_pk_mul_f32 v[182:183], v[182:183], v[106:107]
  v_cvt_pk_bf16_f32 v110, v180, v181
  v_cvt_pk_bf16_f32 v111, v182, v183
  s_add_u32 s3, s10, 163840
  s_nop 0
  v_permlane16_swap_b32 v108, v110
  v_permlane16_swap_b32 v109, v111
  buffer_store_dwordx4 v[108:111], v12, s[44:47], s3 offen sc1
  v_pk_fma_f32 v[100:101], v[48:49], v[90:91], v[76:77] op_sel:[0,0,0] op_sel_hi:[1,0,1] neg_lo:[0,1,0] neg_hi:[0,1,0]
  v_pk_fma_f32 v[102:103], v[50:51], v[90:91], v[78:79] op_sel:[0,0,0] op_sel_hi:[1,0,1] neg_lo:[0,1,0] neg_hi:[0,1,0]
  v_pk_fma_f32 v[196:197], v[196:197], v[90:91], v[100:101] op_sel:[0,1,0] op_sel_hi:[1,1,1]
  v_pk_fma_f32 v[198:199], v[198:199], v[90:91], v[102:103] op_sel:[0,1,0] op_sel_hi:[1,1,1]
  v_pk_mul_f32 v[100:101], v[196:197], v[196:197]
  v_pk_mul_f32 v[102:103], v[198:199], v[198:199]
  v_pk_fma_f32 v[100:101], v[100:101], v[96:97], v[96:97] op_sel:[0,1,0] op_sel_hi:[1,1,0]
  v_pk_fma_f32 v[102:103], v[102:103], v[96:97], v[96:97] op_sel:[0,1,0] op_sel_hi:[1,1,0]
  v_pk_mul_f32 v[100:101], v[100:101], v[196:197]
  v_pk_mul_f32 v[102:103], v[102:103], v[198:199]
  v_exp_f32 v100, v100
  v_exp_f32 v101, v101
  v_exp_f32 v102, v102
  v_exp_f32 v103, v103
  v_pk_add_f32 v[100:101], v[100:101], v[98:99] op_sel_hi:[1,0]
  v_pk_add_f32 v[102:103], v[102:103], v[98:99] op_sel_hi:[1,0]
  v_rcp_f32 v100, v100
  v_rcp_f32 v101, v101
  v_rcp_f32 v102, v102
  v_rcp_f32 v103, v103
  v_pk_mul_f32 v[196:197], v[196:197], v[100:101]
  v_pk_mul_f32 v[198:199], v[198:199], v[102:103]
  v_cvt_pk_bf16_f32 v112, v196, v197
  v_cvt_pk_bf16_f32 v113, v198, v199
  v_pk_fma_f32 v[104:105], v[52:53], v[90:91], v[80:81] op_sel:[0,0,0] op_sel_hi:[1,0,1] neg_lo:[0,1,0] neg_hi:[0,1,0]
  v_pk_fma_f32 v[106:107], v[54:55], v[90:91], v[82:83] op_sel:[0,0,0] op_sel_hi:[1,0,1] neg_lo:[0,1,0] neg_hi:[0,1,0]
  v_pk_fma_f32 v[212:213], v[212:213], v[90:91], v[104:105] op_sel:[0,1,0] op_sel_hi:[1,1,1]
  v_pk_fma_f32 v[214:215], v[214:215], v[90:91], v[106:107] op_sel:[0,1,0] op_sel_hi:[1,1,1]
  v_pk_mul_f32 v[104:105], v[212:213], v[212:213]
  v_pk_mul_f32 v[106:107], v[214:215], v[214:215]
  v_pk_fma_f32 v[104:105], v[104:105], v[96:97], v[96:97] op_sel:[0,1,0] op_sel_hi:[1,1,0]
  v_pk_fma_f32 v[106:107], v[106:107], v[96:97], v[96:97] op_sel:[0,1,0] op_sel_hi:[1,1,0]
  v_pk_mul_f32 v[104:105], v[104:105], v[212:213]
  v_pk_mul_f32 v[106:107], v[106:107], v[214:215]
  v_exp_f32 v104, v104
  v_exp_f32 v105, v105
  v_exp_f32 v106, v106
  v_exp_f32 v107, v107
  v_pk_add_f32 v[104:105], v[104:105], v[98:99] op_sel_hi:[1,0]
  v_pk_add_f32 v[106:107], v[106:107], v[98:99] op_sel_hi:[1,0]
  v_rcp_f32 v104, v104
  v_rcp_f32 v105, v105
  v_rcp_f32 v106, v106
  v_rcp_f32 v107, v107
  v_pk_mul_f32 v[212:213], v[212:213], v[104:105]
  v_pk_mul_f32 v[214:215], v[214:215], v[106:107]
  v_cvt_pk_bf16_f32 v114, v212, v213
  v_cvt_pk_bf16_f32 v115, v214, v215
  s_add_u32 s3, s10, 165888
  s_nop 0
  v_permlane16_swap_b32 v112, v114
  v_permlane16_swap_b32 v113, v115
  buffer_store_dwordx4 v[112:115], v12, s[44:47], s3 offen sc1
  v_pk_fma_f32 v[100:101], v[40:41], v[92:93], v[68:69] op_sel:[0,0,0] op_sel_hi:[1,0,1] neg_lo:[0,1,0] neg_hi:[0,1,0]
  v_pk_fma_f32 v[102:103], v[42:43], v[92:93], v[70:71] op_sel:[0,0,0] op_sel_hi:[1,0,1] neg_lo:[0,1,0] neg_hi:[0,1,0]
  v_pk_fma_f32 v[168:169], v[168:169], v[92:93], v[100:101] op_sel:[0,1,0] op_sel_hi:[1,1,1]
  v_pk_fma_f32 v[170:171], v[170:171], v[92:93], v[102:103] op_sel:[0,1,0] op_sel_hi:[1,1,1]
  v_pk_mul_f32 v[100:101], v[168:169], v[168:169]
  v_pk_mul_f32 v[102:103], v[170:171], v[170:171]
  v_pk_fma_f32 v[100:101], v[100:101], v[96:97], v[96:97] op_sel:[0,1,0] op_sel_hi:[1,1,0]
  v_pk_fma_f32 v[102:103], v[102:103], v[96:97], v[96:97] op_sel:[0,1,0] op_sel_hi:[1,1,0]
  v_pk_mul_f32 v[100:101], v[100:101], v[168:169]
  v_pk_mul_f32 v[102:103], v[102:103], v[170:171]
  v_exp_f32 v100, v100
  v_exp_f32 v101, v101
  v_exp_f32 v102, v102
  v_exp_f32 v103, v103
  v_pk_add_f32 v[100:101], v[100:101], v[98:99] op_sel_hi:[1,0]
  v_pk_add_f32 v[102:103], v[102:103], v[98:99] op_sel_hi:[1,0]
  v_rcp_f32 v100, v100
  v_rcp_f32 v101, v101
  v_rcp_f32 v102, v102
  v_rcp_f32 v103, v103
  v_pk_mul_f32 v[168:169], v[168:169], v[100:101]
  v_pk_mul_f32 v[170:171], v[170:171], v[102:103]
  v_cvt_pk_bf16_f32 v116, v168, v169
  v_cvt_pk_bf16_f32 v117, v170, v171
  v_pk_fma_f32 v[104:105], v[44:45], v[92:93], v[72:73] op_sel:[0,0,0] op_sel_hi:[1,0,1] neg_lo:[0,1,0] neg_hi:[0,1,0]
  v_pk_fma_f32 v[106:107], v[46:47], v[92:93], v[74:75] op_sel:[0,0,0] op_sel_hi:[1,0,1] neg_lo:[0,1,0] neg_hi:[0,1,0]
  v_pk_fma_f32 v[184:185], v[184:185], v[92:93], v[104:105] op_sel:[0,1,0] op_sel_hi:[1,1,1]
  v_pk_fma_f32 v[186:187], v[186:187], v[92:93], v[106:107] op_sel:[0,1,0] op_sel_hi:[1,1,1]
  v_pk_mul_f32 v[104:105], v[184:185], v[184:185]
  v_pk_mul_f32 v[106:107], v[186:187], v[186:187]
  v_pk_fma_f32 v[104:105], v[104:105], v[96:97], v[96:97] op_sel:[0,1,0] op_sel_hi:[1,1,0]
  v_pk_fma_f32 v[106:107], v[106:107], v[96:97], v[96:97] op_sel:[0,1,0] op_sel_hi:[1,1,0]
  v_pk_mul_f32 v[104:105], v[104:105], v[184:185]
  v_pk_mul_f32 v[106:107], v[106:107], v[186:187]
  v_exp_f32 v104, v104
  v_exp_f32 v105, v105
  v_exp_f32 v106, v106
  v_exp_f32 v107, v107
  v_pk_add_f32 v[104:105], v[104:105], v[98:99] op_sel_hi:[1,0]
  v_pk_add_f32 v[106:107], v[106:107], v[98:99] op_sel_hi:[1,0]
  v_rcp_f32 v104, v104
  v_rcp_f32 v105, v105
  v_rcp_f32 v106, v106
  v_rcp_f32 v107, v107
  v_pk_mul_f32 v[184:185], v[184:185], v[104:105]
  v_pk_mul_f32 v[186:187], v[186:187], v[106:107]
  v_cvt_pk_bf16_f32 v118, v184, v185
  v_cvt_pk_bf16_f32 v119, v186, v187
  s_add_u32 s3, s10, 278528
  s_nop 0
  v_permlane16_swap_b32 v116, v118
  v_permlane16_swap_b32 v117, v119
  buffer_store_dwordx4 v[116:119], v12, s[44:47], s3 offen sc1
  v_pk_fma_f32 v[100:101], v[48:49], v[92:93], v[76:77] op_sel:[0,0,0] op_sel_hi:[1,0,1] neg_lo:[0,1,0] neg_hi:[0,1,0]
  v_pk_fma_f32 v[102:103], v[50:51], v[92:93], v[78:79] op_sel:[0,0,0] op_sel_hi:[1,0,1] neg_lo:[0,1,0] neg_hi:[0,1,0]
  v_pk_fma_f32 v[200:201], v[200:201], v[92:93], v[100:101] op_sel:[0,1,0] op_sel_hi:[1,1,1]
  v_pk_fma_f32 v[202:203], v[202:203], v[92:93], v[102:103] op_sel:[0,1,0] op_sel_hi:[1,1,1]
  v_pk_mul_f32 v[100:101], v[200:201], v[200:201]
  v_pk_mul_f32 v[102:103], v[202:203], v[202:203]
  v_pk_fma_f32 v[100:101], v[100:101], v[96:97], v[96:97] op_sel:[0,1,0] op_sel_hi:[1,1,0]
  v_pk_fma_f32 v[102:103], v[102:103], v[96:97], v[96:97] op_sel:[0,1,0] op_sel_hi:[1,1,0]
  v_pk_mul_f32 v[100:101], v[100:101], v[200:201]
  v_pk_mul_f32 v[102:103], v[102:103], v[202:203]
  v_exp_f32 v100, v100
  v_exp_f32 v101, v101
  v_exp_f32 v102, v102
  v_exp_f32 v103, v103
  v_pk_add_f32 v[100:101], v[100:101], v[98:99] op_sel_hi:[1,0]
  v_pk_add_f32 v[102:103], v[102:103], v[98:99] op_sel_hi:[1,0]
  v_rcp_f32 v100, v100
  v_rcp_f32 v101, v101
  v_rcp_f32 v102, v102
  v_rcp_f32 v103, v103
  v_pk_mul_f32 v[200:201], v[200:201], v[100:101]
  v_pk_mul_f32 v[202:203], v[202:203], v[102:103]
  v_cvt_pk_bf16_f32 v120, v200, v201
  v_cvt_pk_bf16_f32 v121, v202, v203
  v_pk_fma_f32 v[104:105], v[52:53], v[92:93], v[80:81] op_sel:[0,0,0] op_sel_hi:[1,0,1] neg_lo:[0,1,0] neg_hi:[0,1,0]
  v_pk_fma_f32 v[106:107], v[54:55], v[92:93], v[82:83] op_sel:[0,0,0] op_sel_hi:[1,0,1] neg_lo:[0,1,0] neg_hi:[0,1,0]
  v_pk_fma_f32 v[216:217], v[216:217], v[92:93], v[104:105] op_sel:[0,1,0] op_sel_hi:[1,1,1]
  v_pk_fma_f32 v[218:219], v[218:219], v[92:93], v[106:107] op_sel:[0,1,0] op_sel_hi:[1,1,1]
  v_pk_mul_f32 v[104:105], v[216:217], v[216:217]
  v_pk_mul_f32 v[106:107], v[218:219], v[218:219]
  v_pk_fma_f32 v[104:105], v[104:105], v[96:97], v[96:97] op_sel:[0,1,0] op_sel_hi:[1,1,0]
  v_pk_fma_f32 v[106:107], v[106:107], v[96:97], v[96:97] op_sel:[0,1,0] op_sel_hi:[1,1,0]
  v_pk_mul_f32 v[104:105], v[104:105], v[216:217]
  v_pk_mul_f32 v[106:107], v[106:107], v[218:219]
  v_exp_f32 v104, v104
  v_exp_f32 v105, v105
  v_exp_f32 v106, v106
  v_exp_f32 v107, v107
  v_pk_add_f32 v[104:105], v[104:105], v[98:99] op_sel_hi:[1,0]
  v_pk_add_f32 v[106:107], v[106:107], v[98:99] op_sel_hi:[1,0]
  v_rcp_f32 v104, v104
  v_rcp_f32 v105, v105
  v_rcp_f32 v106, v106
  v_rcp_f32 v107, v107
  v_pk_mul_f32 v[216:217], v[216:217], v[104:105]
  v_pk_mul_f32 v[218:219], v[218:219], v[106:107]
  v_cvt_pk_bf16_f32 v122, v216, v217
  v_cvt_pk_bf16_f32 v123, v218, v219
  s_add_u32 s3, s10, 280576
  s_nop 0
  v_permlane16_swap_b32 v120, v122
  v_permlane16_swap_b32 v121, v123
  buffer_store_dwordx4 v[120:123], v12, s[44:47], s3 offen sc1
  v_pk_fma_f32 v[100:101], v[40:41], v[94:95], v[68:69] op_sel:[0,0,0] op_sel_hi:[1,0,1] neg_lo:[0,1,0] neg_hi:[0,1,0]
  v_pk_fma_f32 v[102:103], v[42:43], v[94:95], v[70:71] op_sel:[0,0,0] op_sel_hi:[1,0,1] neg_lo:[0,1,0] neg_hi:[0,1,0]
  v_pk_fma_f32 v[172:173], v[172:173], v[94:95], v[100:101] op_sel:[0,1,0] op_sel_hi:[1,1,1]
  v_pk_fma_f32 v[174:175], v[174:175], v[94:95], v[102:103] op_sel:[0,1,0] op_sel_hi:[1,1,1]
  v_pk_mul_f32 v[100:101], v[172:173], v[172:173]
  v_pk_mul_f32 v[102:103], v[174:175], v[174:175]
  v_pk_fma_f32 v[100:101], v[100:101], v[96:97], v[96:97] op_sel:[0,1,0] op_sel_hi:[1,1,0]
  v_pk_fma_f32 v[102:103], v[102:103], v[96:97], v[96:97] op_sel:[0,1,0] op_sel_hi:[1,1,0]
  v_pk_mul_f32 v[100:101], v[100:101], v[172:173]
  v_pk_mul_f32 v[102:103], v[102:103], v[174:175]
  v_exp_f32 v100, v100
  v_exp_f32 v101, v101
  v_exp_f32 v102, v102
  v_exp_f32 v103, v103
  v_pk_add_f32 v[100:101], v[100:101], v[98:99] op_sel_hi:[1,0]
  v_pk_add_f32 v[102:103], v[102:103], v[98:99] op_sel_hi:[1,0]
  v_rcp_f32 v100, v100
  v_rcp_f32 v101, v101
  v_rcp_f32 v102, v102
  v_rcp_f32 v103, v103
  v_pk_mul_f32 v[172:173], v[172:173], v[100:101]
  v_pk_mul_f32 v[174:175], v[174:175], v[102:103]
  v_cvt_pk_bf16_f32 v108, v172, v173
  v_cvt_pk_bf16_f32 v109, v174, v175
  v_pk_fma_f32 v[104:105], v[44:45], v[94:95], v[72:73] op_sel:[0,0,0] op_sel_hi:[1,0,1] neg_lo:[0,1,0] neg_hi:[0,1,0]
  v_pk_fma_f32 v[106:107], v[46:47], v[94:95], v[74:75] op_sel:[0,0,0] op_sel_hi:[1,0,1] neg_lo:[0,1,0] neg_hi:[0,1,0]
  v_pk_fma_f32 v[188:189], v[188:189], v[94:95], v[104:105] op_sel:[0,1,0] op_sel_hi:[1,1,1]
  v_pk_fma_f32 v[190:191], v[190:191], v[94:95], v[106:107] op_sel:[0,1,0] op_sel_hi:[1,1,1]
  v_pk_mul_f32 v[104:105], v[188:189], v[188:189]
  v_pk_mul_f32 v[106:107], v[190:191], v[190:191]
  v_pk_fma_f32 v[104:105], v[104:105], v[96:97], v[96:97] op_sel:[0,1,0] op_sel_hi:[1,1,0]
  v_pk_fma_f32 v[106:107], v[106:107], v[96:97], v[96:97] op_sel:[0,1,0] op_sel_hi:[1,1,0]
  v_pk_mul_f32 v[104:105], v[104:105], v[188:189]
  v_pk_mul_f32 v[106:107], v[106:107], v[190:191]
  v_exp_f32 v104, v104
  v_exp_f32 v105, v105
  v_exp_f32 v106, v106
  v_exp_f32 v107, v107
  v_pk_add_f32 v[104:105], v[104:105], v[98:99] op_sel_hi:[1,0]
  v_pk_add_f32 v[106:107], v[106:107], v[98:99] op_sel_hi:[1,0]
  v_rcp_f32 v104, v104
  v_rcp_f32 v105, v105
  v_rcp_f32 v106, v106
  v_rcp_f32 v107, v107
  v_pk_mul_f32 v[188:189], v[188:189], v[104:105]
  v_pk_mul_f32 v[190:191], v[190:191], v[106:107]
  v_cvt_pk_bf16_f32 v110, v188, v189
  v_cvt_pk_bf16_f32 v111, v190, v191
  s_add_u32 s3, s10, 393216
  s_nop 0
  v_permlane16_swap_b32 v108, v110
  v_permlane16_swap_b32 v109, v111
  buffer_store_dwordx4 v[108:111], v12, s[44:47], s3 offen sc1
  v_pk_fma_f32 v[100:101], v[48:49], v[94:95], v[76:77] op_sel:[0,0,0] op_sel_hi:[1,0,1] neg_lo:[0,1,0] neg_hi:[0,1,0]
  v_pk_fma_f32 v[102:103], v[50:51], v[94:95], v[78:79] op_sel:[0,0,0] op_sel_hi:[1,0,1] neg_lo:[0,1,0] neg_hi:[0,1,0]
  v_pk_fma_f32 v[204:205], v[204:205], v[94:95], v[100:101] op_sel:[0,1,0] op_sel_hi:[1,1,1]
  v_pk_fma_f32 v[206:207], v[206:207], v[94:95], v[102:103] op_sel:[0,1,0] op_sel_hi:[1,1,1]
  v_pk_mul_f32 v[100:101], v[204:205], v[204:205]
  v_pk_mul_f32 v[102:103], v[206:207], v[206:207]
  v_pk_fma_f32 v[100:101], v[100:101], v[96:97], v[96:97] op_sel:[0,1,0] op_sel_hi:[1,1,0]
  v_pk_fma_f32 v[102:103], v[102:103], v[96:97], v[96:97] op_sel:[0,1,0] op_sel_hi:[1,1,0]
  v_pk_mul_f32 v[100:101], v[100:101], v[204:205]
  v_pk_mul_f32 v[102:103], v[102:103], v[206:207]
  v_exp_f32 v100, v100
  v_exp_f32 v101, v101
  v_exp_f32 v102, v102
  v_exp_f32 v103, v103
  v_pk_add_f32 v[100:101], v[100:101], v[98:99] op_sel_hi:[1,0]
  v_pk_add_f32 v[102:103], v[102:103], v[98:99] op_sel_hi:[1,0]
  v_rcp_f32 v100, v100
  v_rcp_f32 v101, v101
  v_rcp_f32 v102, v102
  v_rcp_f32 v103, v103
  v_pk_mul_f32 v[204:205], v[204:205], v[100:101]
  v_pk_mul_f32 v[206:207], v[206:207], v[102:103]
  v_cvt_pk_bf16_f32 v112, v204, v205
  v_cvt_pk_bf16_f32 v113, v206, v207
  v_pk_fma_f32 v[104:105], v[52:53], v[94:95], v[80:81] op_sel:[0,0,0] op_sel_hi:[1,0,1] neg_lo:[0,1,0] neg_hi:[0,1,0]
  v_pk_fma_f32 v[106:107], v[54:55], v[94:95], v[82:83] op_sel:[0,0,0] op_sel_hi:[1,0,1] neg_lo:[0,1,0] neg_hi:[0,1,0]
  v_pk_fma_f32 v[220:221], v[220:221], v[94:95], v[104:105] op_sel:[0,1,0] op_sel_hi:[1,1,1]
  v_pk_fma_f32 v[222:223], v[222:223], v[94:95], v[106:107] op_sel:[0,1,0] op_sel_hi:[1,1,1]
  v_pk_mul_f32 v[104:105], v[220:221], v[220:221]
  v_pk_mul_f32 v[106:107], v[222:223], v[222:223]
  v_pk_fma_f32 v[104:105], v[104:105], v[96:97], v[96:97] op_sel:[0,1,0] op_sel_hi:[1,1,0]
  v_pk_fma_f32 v[106:107], v[106:107], v[96:97], v[96:97] op_sel:[0,1,0] op_sel_hi:[1,1,0]
  v_pk_mul_f32 v[104:105], v[104:105], v[220:221]
  v_pk_mul_f32 v[106:107], v[106:107], v[222:223]
  v_exp_f32 v104, v104
  v_exp_f32 v105, v105
  v_exp_f32 v106, v106
  v_exp_f32 v107, v107
  v_pk_add_f32 v[104:105], v[104:105], v[98:99] op_sel_hi:[1,0]
  v_pk_add_f32 v[106:107], v[106:107], v[98:99] op_sel_hi:[1,0]
  v_rcp_f32 v104, v104
  v_rcp_f32 v105, v105
  v_rcp_f32 v106, v106
  v_rcp_f32 v107, v107
  v_pk_mul_f32 v[220:221], v[220:221], v[104:105]
  v_pk_mul_f32 v[222:223], v[222:223], v[106:107]
  v_cvt_pk_bf16_f32 v114, v220, v221
  v_cvt_pk_bf16_f32 v115, v222, v223
  s_add_u32 s3, s10, 395264
  s_nop 0
  v_permlane16_swap_b32 v112, v114
  v_permlane16_swap_b32 v113, v115
  buffer_store_dwordx4 v[112:115], v12, s[44:47], s3 offen sc1
  s_waitcnt vmcnt(0)
  s_barrier
  s_add_u32 s97, s97, 1
  s_branch L_w2_body
L_w1_c1:
L_w2_c0:
L_w2_body:
  s_cmp_ge_u32 s2, 256
  s_cbranch_scc1 L_w2_end
  v_lshrrev_b32 v2, 6, v0
  v_and_b32 v1, 63, v0
  v_readfirstlane_b32 s70, v2
  s_and_b32 s3, s2, 7
  s_lshr_b32 s99, s2, 3
  s_and_b32 s5, s3, 3
  s_lshl_b32 s5, s5, 2
  s_and_b32 s6, s99, 3
  s_add_u32 s68, s5, s6
  s_lshr_b32 s5, s3, 2
  s_lshl_b32 s5, s5, 3
  s_lshr_b32 s6, s99, 2
  s_add_u32 s69, s5, s6
  s_cmp_lt_u32 s70, 4
  s_cbranch_scc1 L_w2_compute
L_w2_loader:
  s_add_u32 s9, s70, s68
  s_and_b32 s9, s9, 3
  s_lshl_b32 s76, s9, 12
  s_lshl_b32 s77, s9, 11
  v_and_b32 v10, 7, v1
  v_lshrrev_b32 v3, 3, v1
  s_lshl_b32 s10, s9, 4
  v_add_u32 v3, s10, v3
  v_mul_u32_u24 v3, 2048, v3
  v_lshrrev_b32 v2, 3, v1
  v_and_b32 v2, 2, v2
  v_xor_b32 v2, v2, v10
  s_lshl_b32 s10, s69, 7
  v_add_u32 v3, s10, v3
  v_lshl_add_u32 v8, v2, 4, v3
  v_xor_b32 v2, 4, v2
  v_add_u32 v3, 16384, v3
  v_lshl_add_u32 v9, v2, 4, v3
  s_mov_b32 s40, s28
  s_and_b32 s41, s29, 0xffff
  s_mov_b32 s42, 7340032
  s_mov_b32 s43, 0x00020000
  s_add_u32 s3, s68, s69
  s_lshl_b32 s3, s3, 3
  s_lshl_b32 s85, 0xffff02, s3
  s_sub_u32 s3, 0, s3
  s_lshr_b32 s3, 0xffff02, s3
  s_or_b32 s85, s85, s3
  s_and_b32 s86, s68, 3
  s_lshl_b32 s86, s86, 2
  v_lshl_add_u32 v14, v1, 4, s77
  s_and_b32 s3, s70, 3
  s_lshl_b32 s4, s99, 2
  s_add_u32 s3, s3, s4
  s_lshl_b32 s4, s3, 6
  s_and_b32 s4, s4, 64
  s_lshr_b32 s3, s3, 1
  s_lshl_b32 s98, s3, 11
  s_add_u32 s98, s98, s4
  s_sub_u32 s4, 384, s40
  s_and_b32 s4, s4, 0x380
  s_add_u32 s98, s98, s4
  s_lshl_b32 s4, s69, 7
  s_and_b32 s4, s4, 1024
  s_add_u32 s98, s98, s4
  s_add_u32 s98, s98, 2097152
  s_buffer_load_dword s84, s[40:43], s98
  s_add_u32 s98, s98, 131072
  s_buffer_load_dword s84, s[40:43], s98
  s_add_u32 s98, s98, 131072
  s_buffer_load_dword s84, s[40:43], s98
  s_add_u32 s98, s98, 131072
  s_buffer_load_dword s84, s[40:43], s98
  s_add_u32 s98, s98, 131072
  s_buffer_load_dword s84, s[40:43], s98
  s_add_u32 s98, s98, 131072
  s_buffer_load_dword s84, s[40:43], s98
  s_add_u32 s98, s98, 131072
  s_buffer_load_dword s84, s[40:43], s98
  s_add_u32 s98, s98, 131072
  s_buffer_load_dword s84, s[40:43], s98
  s_add_u32 s98, s98, 131072
  s_buffer_load_dword s84, s[40:43], s98
  s_add_u32 s98, s98, 131072
  s_bfe_i32 s74, s85, 0x80000
  s_add_i32 s74, s74, 0
  s_cmp_lt_i32 s74, 0
  s_cselect_b32 s74, 55, s74
  s_add_u32 s3, s74, s86
  s_and_b32 s3, s3, 15
  s_cmp_lt_u32 s74, 16
  s_cselect_b32 s74, s3, s74
  s_lshl_b32 s74, s74, 17
  s_add_u32 m0, s77, 0
  s_add_u32 s4, s74, 0
  buffer_load_dwordx4 v8, s[40:43], s4 offen lds
  s_add_u32 m0, s77, 1024
  s_nop 0
  buffer_load_dwordx4 v9, s[40:43], s4 offen lds
  s_bfe_i32 s74, s85, 0x80008
  s_add_i32 s74, s74, 1
  s_add_u32 s74, s74, s86
  s_and_b32 s74, s74, 15
  s_lshl_b32 s74, s74, 17
  s_add_u32 m0, s77, 8192
  s_add_u32 s4, s74, 0
  buffer_load_dwordx4 v8, s[40:43], s4 offen lds
  s_add_u32 m0, s77, 9216
  s_nop 0
  buffer_load_dwordx4 v9, s[40:43], s4 offen lds
  s_bfe_i32 s74, s85, 0x80010
  s_add_i32 s74, s74, 2
  s_add_u32 s74, s74, s86
  s_and_b32 s74, s74, 15
  s_lshl_b32 s74, s74, 17
  s_add_u32 m0, s77, 16384
  s_add_u32 s4, s74, 0
  buffer_load_dwordx4 v8, s[40:43], s4 offen lds
  s_add_u32 m0, s77, 17408
  s_nop 0
  buffer_load_dwordx4 v9, s[40:43], s4 offen lds
  s_bfe_i32 s74, s85, 0x80018
  s_add_i32 s74, s74, 3
  s_add_u32 s74, s74, s86
  s_and_b32 s74, s74, 15
  s_lshl_b32 s74, s74, 17
  s_add_u32 m0, s77, 24576
  s_add_u32 s4, s74, 0
  buffer_load_dwordx4 v8, s[40:43], s4 offen lds
  s_add_u32 m0, s77, 25600
  s_nop 0
  buffer_load_dwordx4 v9, s[40:43], s4 offen lds
  s_bfe_i32 s74, s85, 0x80000
  s_add_i32 s74, s74, 4
  s_add_u32 s74, s74, s86
  s_and_b32 s74, s74, 15
  s_lshl_b32 s74, s74, 17
  s_add_u32 m0, s77, 32768
  s_add_u32 s4, s74, 0
  buffer_load_dwordx4 v8, s[40:43], s4 offen lds
  s_add_u32 m0, s77, 33792
  s_nop 0
  buffer_load_dwordx4 v9, s[40:43], s4 offen lds
  s_bfe_i32 s74, s85, 0x80008
  s_add_i32 s74, s74, 5
  s_add_u32 s74, s74, s86
  s_and_b32 s74, s74, 15
  s_lshl_b32 s74, s74, 17
  s_add_u32 m0, s77, 40960
  s_add_u32 s4, s74, 0
  buffer_load_dwordx4 v8, s[40:43], s4 offen lds
  s_add_u32 m0, s77, 41984
  s_nop 0
  buffer_load_dwordx4 v9, s[40:43], s4 offen lds
  s_bfe_i32 s74, s85, 0x80010
  s_add_i32 s74, s74, 6
  s_add_u32 s74, s74, s86
  s_and_b32 s74, s74, 15
  s_lshl_b32 s74, s74, 17
  s_add_u32 m0, s77, 49152
  s_add_u32 s4, s74, 0
  buffer_load_dwordx4 v8, s[40:43], s4 offen lds
  s_add_u32 m0, s77, 50176
  s_nop 0
  buffer_load_dwordx4 v9, s[40:43], s4 offen lds
  s_bfe_i32 s74, s85, 0x80018
  s_add_i32 s74, s74, 7
  s_add_u32 s74, s74, s86
  s_and_b32 s74, s74, 15
  s_lshl_b32 s74, s74, 17
  s_add_u32 m0, s77, 57344
  s_add_u32 s4, s74, 0
  buffer_load_dwordx4 v8, s[40:43], s4 offen lds
  s_add_u32 m0, s77, 58368
  s_nop 0
  buffer_load_dwordx4 v9, s[40:43], s4 offen lds
  s_bfe_i32 s74, s85, 0x80000
  s_add_i32 s74, s74, 8
  s_add_u32 s74, s74, s86
  s_and_b32 s74, s74, 15
  s_lshl_b32 s74, s74, 17
  s_add_u32 m0, s77, 65536
  s_add_u32 s4, s74, 0
  buffer_load_dwordx4 v8, s[40:43], s4 offen lds
  s_add_u32 m0, s77, 66560
  s_nop 0
  buffer_load_dwordx4 v9, s[40:43], s4 offen lds
  s_bfe_i32 s74, s85, 0x80008
  s_add_i32 s74, s74, 9
  s_add_u32 s74, s74, s86
  s_and_b32 s74, s74, 15
  s_lshl_b32 s74, s74, 17
  s_add_u32 m0, s77, 73728
  s_add_u32 s4, s74, 0
  buffer_load_dwordx4 v8, s[40:43], s4 offen lds
  s_add_u32 m0, s77, 74752
  s_nop 0
  buffer_load_dwordx4 v9, s[40:43], s4 offen lds
  s_add_u32 s44, s22, 24903680
  s_addc_u32 s45, s23, 0
  s_and_b32 s45, s45, 0xffff
  s_mov_b32 s46, 32768
  s_mov_b32 s47, 0x00020000
  s_lshl_b32 s3, s97, 12
  s_lshl_b32 s4, s68, 8
  s_add_u32 s3, s3, s4
  s_sub_u32 s3, s3, 4096
  v_and_b32 v2, 15, v1
  v_lshlrev_b32 v2, 2, v2
  v_mov_b32 v3, 1
  s_mov_b32 s79, 0x100000
  s_cmp_lg_u32 s70, 4
  s_barrier
  s_cbranch_scc1 L_w2_nofl
  s_mov_b64 exec, 1
  buffer_store_dword v3, off, s[44:47], s87 sc1
  s_mov_b64 exec, -1
L_w2_nofl:
  s_mov_b32 s5, s3
  s_bfe_i32 s74, s85, 0x80010
  s_add_i32 s74, s74, 10
  s_add_u32 s74, s74, s86
  s_and_b32 s74, s74, 15
  s_lshl_b32 s74, s74, 17
  s_add_u32 m0, s77, 81920
  s_add_u32 s4, s74, 0
  buffer_load_dwordx4 v8, s[40:43], s4 offen lds
  s_add_u32 m0, s77, 82944
  s_nop 0
  buffer_load_dwordx4 v9, s[40:43], s4 offen lds
  s_bfe_i32 s74, s85, 0x80018
  s_add_i32 s74, s74, 11
  s_add_u32 s74, s74, s86
  s_and_b32 s74, s74, 15
  s_lshl_b32 s74, s74, 17
  s_add_u32 m0, s77, 90112
  s_add_u32 s4, s74, 0
  buffer_load_dwordx4 v8, s[40:43], s4 offen lds
  s_add_u32 m0, s77, 91136
  s_nop 0
  buffer_load_dwordx4 v9, s[40:43], s4 offen lds
  s_bfe_i32 s74, s85, 0x80000
  s_add_i32 s74, s74, 12
  s_add_u32 s74, s74, s86
  s_and_b32 s74, s74, 15
  s_lshl_b32 s74, s74, 17
  s_add_u32 m0, s77, 98304
  s_add_u32 s4, s74, 0
  buffer_load_dwordx4 v8, s[40:43], s4 offen lds
  s_add_u32 m0, s77, 99328
  s_nop 0
  buffer_load_dwordx4 v9, s[40:43], s4 offen lds
  s_bfe_i32 s74, s85, 0x80008
  s_add_i32 s74, s74, 13
  s_add_u32 s3, s74, s86
  s_and_b32 s3, s3, 15
  s_cmp_lt_u32 s74, 16
  s_cselect_b32 s74, s3, s74
  s_lshl_b32 s74, s74, 17
  s_add_u32 m0, s77, 106496
  s_add_u32 s4, s74, 0
  buffer_load_dwordx4 v8, s[40:43], s4 offen lds
  s_add_u32 m0, s77, 107520
  s_nop 0
  buffer_load_dwordx4 v9, s[40:43], s4 offen lds
  s_bfe_i32 s74, s85, 0x80010
  s_add_i32 s74, s74, 14
  s_add_u32 s3, s74, s86
  s_and_b32 s3, s3, 15
  s_cmp_lt_u32 s74, 16
  s_cselect_b32 s74, s3, s74
  s_lshl_b32 s74, s74, 17
  s_add_u32 m0, s77, 114688
  s_add_u32 s4, s74, 0
  buffer_load_dwordx4 v8, s[40:43], s4 offen lds
  s_add_u32 m0, s77, 115712
  s_nop 0
  buffer_load_dwordx4 v9, s[40:43], s4 offen lds
  s_bfe_i32 s74, s85, 0x80018
  s_add_i32 s74, s74, 15
  s_add_u32 s3, s74, s86
  s_and_b32 s3, s3, 15
  s_cmp_lt_u32 s74, 16
  s_cselect_b32 s74, s3, s74
  s_lshl_b32 s74, s74, 17
  s_add_u32 m0, s77, 122880
  s_add_u32 s4, s74, 0
  buffer_load_dwordx4 v8, s[40:43], s4 offen lds
  s_add_u32 m0, s77, 123904
  s_nop 0
  buffer_load_dwordx4 v9, s[40:43], s4 offen lds
  s_bfe_i32 s74, s85, 0x80000
  s_add_i32 s74, s74, 16
  s_add_u32 s3, s74, s86
  s_and_b32 s3, s3, 15
  s_cmp_lt_u32 s74, 16
  s_cselect_b32 s74, s3, s74
  s_lshl_b32 s74, s74, 17
  s_add_u32 m0, s77, 131072
  s_add_u32 s4, s74, 0
  buffer_load_dwordx4 v8, s[40:43], s4 offen lds
  s_add_u32 m0, s77, 132096
  s_nop 0
  buffer_load_dwordx4 v9, s[40:43], s4 offen lds
  s_bfe_i32 s74, s85, 0x80008
  s_add_i32 s74, s74, 17
  s_lshl_b32 s74, s74, 17
  s_add_u32 m0, s77, 139264
  s_add_u32 s4, s74, 0
  buffer_load_dwordx4 v8, s[40:43], s4 offen lds
  s_add_u32 m0, s77, 140288
  s_nop 0
  buffer_load_dwordx4 v9, s[40:43], s4 offen lds
  s_bfe_i32 s74, s85, 0x80010
  s_add_i32 s74, s74, 18
  s_lshl_b32 s74, s74, 17
  s_add_u32 m0, s77, 147456
  s_add_u32 s4, s74, 0
  buffer_load_dwordx4 v8, s[40:43], s4 offen lds
  s_add_u32 m0, s77, 148480
  s_nop 0
  buffer_load_dwordx4 v9, s[40:43], s4 offen lds
  s_bfe_i32 s74, s85, 0x80018
  s_add_i32 s74, s74, 19
  s_lshl_b32 s74, s74, 17
  s_add_u32 m0, s77, 155648
  s_add_u32 s4, s74, 0
  buffer_load_dwordx4 v8, s[40:43], s4 offen lds
  s_add_u32 m0, s77, 156672
  s_nop 0
  buffer_load_dwordx4 v9, s[40:43], s4 offen lds
  s_mov_b32 s3, s5
  s_cmp_lg_u32 s70, 4
  s_cbranch_scc1 L_w2_dep
L_w2_poll:
  buffer_load_dword v3, v2, s[44:47], s3 offen sc1
  s_sub_u32 s79, s79, 1
  s_cbranch_scc1 L_w2_dep
  s_waitcnt vmcnt(0)
  v_cmp_ne_u32 vcc, 1, v3
  s_cbranch_vccnz L_w2_poll
L_w2_dep:
  s_waitcnt vmcnt(32) lgkmcnt(0)
  s_barrier
  s_waitcnt vmcnt(24)
  s_barrier
  s_buffer_load_dword s84, s[40:43], s98
  s_add_u32 s98, s98, 131072
  s_bfe_i32 s74, s85, 0x80000
  s_add_i32 s74, s74, 20
  s_lshl_b32 s74, s74, 17
  s_add_u32 m0, s77, 0
  s_add_u32 s4, s74, 0
  buffer_load_dwordx4 v8, s[40:43], s4 offen lds
  s_add_u32 m0, s77, 1024
  s_nop 0
  buffer_load_dwordx4 v9, s[40:43], s4 offen lds
  s_buffer_load_dword s84, s[40:43], s98
  s_add_u32 s98, s98, 131072
  s_bfe_i32 s74, s85, 0x80008
  s_add_i32 s74, s74, 21
  s_lshl_b32 s74, s74, 17
  s_add_u32 m0, s77, 8192
  s_add_u32 s4, s74, 0
  buffer_load_dwordx4 v8, s[40:43], s4 offen lds
  s_add_u32 m0, s77, 9216
  s_nop 0
  buffer_load_dwordx4 v9, s[40:43], s4 offen lds
  s_buffer_load_dword s84, s[40:43], s98
  s_add_u32 s98, s98, 131072
  s_bfe_i32 s74, s85, 0x80010
  s_add_i32 s74, s74, 22
  s_lshl_b32 s74, s74, 17
  s_add_u32 m0, s77, 16384
  s_add_u32 s4, s74, 0
  buffer_load_dwordx4 v8, s[40:43], s4 offen lds
  s_add_u32 m0, s77, 17408
  s_nop 0
  buffer_load_dwordx4 v9, s[40:43], s4 offen lds
  s_buffer_load_dword s84, s[40:43], s98
  s_add_u32 s98, s98, 131072
  s_bfe_i32 s74, s85, 0x80018
  s_add_i32 s74, s74, 23
  s_lshl_b32 s74, s74, 17
  s_add_u32 m0, s77, 24576
  s_add_u32 s4, s74, 0
  buffer_load_dwordx4 v8, s[40:43], s4 offen lds
  s_add_u32 m0, s77, 25600
  s_nop 0
  buffer_load_dwordx4 v9, s[40:43], s4 offen lds
  s_waitcnt vmcnt(24)
  s_barrier
  s_buffer_load_dword s84, s[40:43], s98
  s_add_u32 s98, s98, 131072
  s_bfe_i32 s74, s85, 0x80000
  s_add_i32 s74, s74, 24
  s_lshl_b32 s74, s74, 17
  s_add_u32 m0, s77, 32768
  s_add_u32 s4, s74, 0
  buffer_load_dwordx4 v8, s[40:43], s4 offen lds
  s_add_u32 m0, s77, 33792
  s_nop 0
  buffer_load_dwordx4 v9, s[40:43], s4 offen lds
  s_buffer_load_dword s84, s[40:43], s98
  s_add_u32 s98, s98, 131072
  s_bfe_i32 s74, s85, 0x80008
  s_add_i32 s74, s74, 25
  s_lshl_b32 s74, s74, 17
  s_add_u32 m0, s77, 40960
  s_add_u32 s4, s74, 0
  buffer_load_dwordx4 v8, s[40:43], s4 offen lds
  s_add_u32 m0, s77, 41984
  s_nop 0
  buffer_load_dwordx4 v9, s[40:43], s4 offen lds
  s_buffer_load_dword s84, s[40:43], s98
  s_add_u32 s98, s98, 131072
  s_bfe_i32 s74, s85, 0x80010
  s_add_i32 s74, s74, 26
  s_lshl_b32 s74, s74, 17
  s_add_u32 m0, s77, 49152
  s_add_u32 s4, s74, 0
  buffer_load_dwordx4 v8, s[40:43], s4 offen lds
  s_add_u32 m0, s77, 50176
  s_nop 0
  buffer_load_dwordx4 v9, s[40:43], s4 offen lds
  s_buffer_load_dword s84, s[40:43], s98
  s_add_u32 s98, s98, 131072
  s_bfe_i32 s74, s85, 0x80018
  s_add_i32 s74, s74, 27
  s_lshl_b32 s74, s74, 17
  s_add_u32 m0, s77, 57344
  s_add_u32 s4, s74, 0
  buffer_load_dwordx4 v8, s[40:43], s4 offen lds
  s_add_u32 m0, s77, 58368
  s_nop 0
  buffer_load_dwordx4 v9, s[40:43], s4 offen lds
  s_waitcnt vmcnt(24)
  s_barrier
  s_buffer_load_dword s84, s[40:43], s98
  s_add_u32 s98, s98, 131072
  s_bfe_i32 s74, s85, 0x80000
  s_add_i32 s74, s74, 28
  s_lshl_b32 s74, s74, 17
  s_add_u32 m0, s77, 65536
  s_add_u32 s4, s74, 0
  buffer_load_dwordx4 v8, s[40:43], s4 offen lds
  s_add_u32 m0, s77, 66560
  s_nop 0
  buffer_load_dwordx4 v9, s[40:43], s4 offen lds
  s_buffer_load_dword s84, s[40:43], s98
  s_add_u32 s98, s98, 131072
  s_bfe_i32 s74, s85, 0x80008
  s_add_i32 s74, s74, 29
  s_lshl_b32 s74, s74, 17
  s_add_u32 m0, s77, 73728
  s_add_u32 s4, s74, 0
  buffer_load_dwordx4 v8, s[40:43], s4 offen lds
  s_add_u32 m0, s77, 74752
  s_nop 0
  buffer_load_dwordx4 v9, s[40:43], s4 offen lds
  s_buffer_load_dword s84, s[40:43], s98
  s_add_u32 s98, s98, 131072
  s_bfe_i32 s74, s85, 0x80010
  s_add_i32 s74, s74, 30
  s_lshl_b32 s74, s74, 17
  s_add_u32 m0, s77, 81920
  s_add_u32 s4, s74, 0
  buffer_load_dwordx4 v8, s[40:43], s4 offen lds
  s_add_u32 m0, s77, 82944
  s_nop 0
  buffer_load_dwordx4 v9, s[40:43], s4 offen lds
  s_buffer_load_dword s84, s[40:43], s98
  s_add_u32 s98, s98, 131072
  s_bfe_i32 s74, s85, 0x80018
  s_add_i32 s74, s74, 31
  s_lshl_b32 s74, s74, 17
  s_add_u32 m0, s77, 90112
  s_add_u32 s4, s74, 0
  buffer_load_dwordx4 v8, s[40:43], s4 offen lds
  s_add_u32 m0, s77, 91136
  s_nop 0
  buffer_load_dwordx4 v9, s[40:43], s4 offen lds
  s_waitcnt vmcnt(24)
  s_barrier
  s_buffer_load_dword s84, s[40:43], s98
  s_add_u32 s98, s98, 131072
  s_bfe_i32 s74, s85, 0x80000
  s_add_i32 s74, s74, 32
  s_lshl_b32 s74, s74, 17
  s_add_u32 m0, s77, 98304
  s_add_u32 s4, s74, 0
  buffer_load_dwordx4 v8, s[40:43], s4 offen lds
  s_add_u32 m0, s77, 99328
  s_nop 0
  buffer_load_dwordx4 v9, s[40:43], s4 offen lds
  s_buffer_load_dword s84, s[40:43], s98
  s_add_u32 s98, s98, 131072
  s_bfe_i32 s74, s85, 0x80008
  s_add_i32 s74, s74, 33
  s_lshl_b32 s74, s74, 17
  s_add_u32 m0, s77, 106496
  s_add_u32 s4, s74, 0
  buffer_load_dwordx4 v8, s[40:43], s4 offen lds
  s_add_u32 m0, s77, 107520
  s_nop 0
  buffer_load_dwordx4 v9, s[40:43], s4 offen lds
  s_buffer_load_dword s84, s[40:43], s98
  s_add_u32 s98, s98, 131072
  s_bfe_i32 s74, s85, 0x80010
  s_add_i32 s74, s74, 34
  s_lshl_b32 s74, s74, 17
  s_add_u32 m0, s77, 114688
  s_add_u32 s4, s74, 0
  buffer_load_dwordx4 v8, s[40:43], s4 offen lds
  s_add_u32 m0, s77, 115712
  s_nop 0
  buffer_load_dwordx4 v9, s[40:43], s4 offen lds
  s_waitcnt vmcnt(22)
  s_barrier
  s_buffer_load_dword s84, s[40:43], s98
  s_add_u32 s98, s98, 131072
  s_bfe_i32 s74, s85, 0x80018
  s_add_i32 s74, s74, 35
  s_lshl_b32 s74, s74, 17
  s_add_u32 m0, s77, 122880
  s_add_u32 s4, s74, 0
  buffer_load_dwordx4 v8, s[40:43], s4 offen lds
  s_add_u32 m0, s77, 123904
  s_nop 0
  buffer_load_dwordx4 v9, s[40:43], s4 offen lds
  s_buffer_load_dword s84, s[40:43], s98
  s_add_u32 s98, s98, 131072
  s_bfe_i32 s74, s85, 0x80000
  s_add_i32 s74, s74, 36
  s_lshl_b32 s74, s74, 17
  s_add_u32 m0, s77, 131072
  s_add_u32 s4, s74, 0
  buffer_load_dwordx4 v8, s[40:43], s4 offen lds
  s_add_u32 m0, s77, 132096
  s_nop 0
  buffer_load_dwordx4 v9, s[40:43], s4 offen lds
  s_buffer_load_dword s84, s[40:43], s98
  s_add_u32 s98, s98, 131072
  s_bfe_i32 s74, s85, 0x80008
  s_add_i32 s74, s74, 37
  s_lshl_b32 s74, s74, 17
  s_add_u32 m0, s77, 139264
  s_add_u32 s4, s74, 0
  buffer_load_dwordx4 v8, s[40:43], s4 offen lds
  s_add_u32 m0, s77, 140288
  s_nop 0
  buffer_load_dwordx4 v9, s[40:43], s4 offen lds
  s_waitcnt vmcnt(20)
  s_barrier
  s_buffer_load_dword s84, s[40:43], s98
  s_add_u32 s98, s98, 131072
  s_bfe_i32 s74, s85, 0x80010
  s_add_i32 s74, s74, 38
  s_lshl_b32 s74, s74, 17
  s_add_u32 m0, s77, 147456
  s_add_u32 s4, s74, 0
  buffer_load_dwordx4 v8, s[40:43], s4 offen lds
  s_add_u32 m0, s77, 148480
  s_nop 0
  buffer_load_dwordx4 v9, s[40:43], s4 offen lds
  s_buffer_load_dword s84, s[40:43], s98
  s_add_u32 s98, s98, 131072
  s_bfe_i32 s74, s85, 0x80018
  s_add_i32 s74, s74, 39
  s_lshl_b32 s74, s74, 17
  s_add_u32 m0, s77, 155648
  s_add_u32 s4, s74, 0
  buffer_load_dwordx4 v8, s[40:43], s4 offen lds
  s_add_u32 m0, s77, 156672
  s_nop 0
  buffer_load_dwordx4 v9, s[40:43], s4 offen lds
  s_buffer_load_dword s84, s[40:43], s98
  s_add_u32 s98, s98, 131072
  s_bfe_i32 s74, s85, 0x80000
  s_add_i32 s74, s74, 40
  s_lshl_b32 s74, s74, 17
  s_add_u32 m0, s77, 0
  s_add_u32 s4, s74, 0
  buffer_load_dwordx4 v8, s[40:43], s4 offen lds
  s_add_u32 m0, s77, 1024
  s_nop 0
  buffer_load_dwordx4 v9, s[40:43], s4 offen lds
  s_waitcnt vmcnt(18)
  s_barrier
  s_buffer_load_dword s84, s[40:43], s98
  s_add_u32 s98, s98, 131072
  s_bfe_i32 s74, s85, 0x80008
  s_add_i32 s74, s74, 41
  s_lshl_b32 s74, s74, 17
  s_add_u32 m0, s77, 8192
  s_add_u32 s4, s74, 0
  buffer_load_dwordx4 v8, s[40:43], s4 offen lds
  s_add_u32 m0, s77, 9216
  s_nop 0
  buffer_load_dwordx4 v9, s[40:43], s4 offen lds
  s_buffer_load_dword s84, s[40:43], s98
  s_add_u32 s98, s98, 131072
  s_bfe_i32 s74, s85, 0x80010
  s_add_i32 s74, s74, 42
  s_lshl_b32 s74, s74, 17
  s_add_u32 m0, s77, 16384
  s_add_u32 s4, s74, 0
  buffer_load_dwordx4 v8, s[40:43], s4 offen lds
  s_add_u32 m0, s77, 17408
  s_nop 0
  buffer_load_dwordx4 v9, s[40:43], s4 offen lds
  s_buffer_load_dword s84, s[40:43], s98
  s_add_u32 s98, s98, 131072
  s_bfe_i32 s74, s85, 0x80018
  s_add_i32 s74, s74, 43
  s_lshl_b32 s74, s74, 17
  s_add_u32 m0, s77, 24576
  s_add_u32 s4, s74, 0
  buffer_load_dwordx4 v8, s[40:43], s4 offen lds
  s_add_u32 m0, s77, 25600
  s_nop 0
  buffer_load_dwordx4 v9, s[40:43], s4 offen lds
  s_waitcnt vmcnt(16)
  s_barrier
  s_buffer_load_dword s84, s[40:43], s98
  s_add_u32 s98, s98, 131072
  s_bfe_i32 s74, s85, 0x80000
  s_add_i32 s74, s74, 44
  s_lshl_b32 s74, s74, 17
  s_add_u32 m0, s77, 32768
  s_add_u32 s4, s74, 0
  buffer_load_dwordx4 v8, s[40:43], s4 offen lds
  s_add_u32 m0, s77, 33792
  s_nop 0
  buffer_load_dwordx4 v9, s[40:43], s4 offen lds
  s_buffer_load_dword s84, s[40:43], s98
  s_add_u32 s98, s98, 131072
  s_bfe_i32 s74, s85, 0x80008
  s_add_i32 s74, s74, 45
  s_lshl_b32 s74, s74, 17
  s_add_u32 m0, s77, 40960
  s_add_u32 s4, s74, 0
  buffer_load_dwordx4 v8, s[40:43], s4 offen lds
  s_add_u32 m0, s77, 41984
  s_nop 0
  buffer_load_dwordx4 v9, s[40:43], s4 offen lds
  s_buffer_load_dword s84, s[40:43], s98
  s_add_u32 s98, s98, 131072
  s_bfe_i32 s74, s85, 0x80010
  s_add_i32 s74, s74, 46
  s_lshl_b32 s74, s74, 17
  s_add_u32 m0, s77, 49152
  s_add_u32 s4, s74, 0
  buffer_load_dwordx4 v8, s[40:43], s4 offen lds
  s_add_u32 m0, s77, 50176
  s_nop 0
  buffer_load_dwordx4 v9, s[40:43], s4 offen lds
  s_waitcnt vmcnt(14)
  s_barrier
  s_buffer_load_dword s84, s[40:43], s98
  s_add_u32 s98, s98, 131072
  s_bfe_i32 s74, s85, 0x80018
  s_add_i32 s74, s74, 47
  s_lshl_b32 s74, s74, 17
  s_add_u32 m0, s77, 57344
  s_add_u32 s4, s74, 0
  buffer_load_dwordx4 v8, s[40:43], s4 offen lds
  s_add_u32 m0, s77, 58368
  s_nop 0
  buffer_load_dwordx4 v9, s[40:43], s4 offen lds
  s_buffer_load_dword s84, s[40:43], s98
  s_add_u32 s98, s98, 131072
  s_bfe_i32 s74, s85, 0x80000
  s_add_i32 s74, s74, 48
  s_lshl_b32 s74, s74, 17
  s_add_u32 m0, s77, 65536
  s_add_u32 s4, s74, 0
  buffer_load_dwordx4 v8, s[40:43], s4 offen lds
  s_add_u32 m0, s77, 66560
  s_nop 0
  buffer_load_dwordx4 v9, s[40:43], s4 offen lds
  s_buffer_load_dword s84, s[40:43], s98
  s_add_u32 s98, s98, 131072
  s_bfe_i32 s74, s85, 0x80008
  s_add_i32 s74, s74, 49
  s_lshl_b32 s74, s74, 17
  s_add_u32 m0, s77, 73728
  s_add_u32 s4, s74, 0
  buffer_load_dwordx4 v8, s[40:43], s4 offen lds
  s_add_u32 m0, s77, 74752
  s_nop 0
  buffer_load_dwordx4 v9, s[40:43], s4 offen lds
  s_waitcnt vmcnt(12)
  s_barrier
  s_buffer_load_dword s84, s[40:43], s98
  s_add_u32 s98, s98, 131072
  s_bfe_i32 s74, s85, 0x80010
  s_add_i32 s74, s74, 50
  s_lshl_b32 s74, s74, 17
  s_add_u32 m0, s77, 81920
  s_add_u32 s4, s74, 0
  buffer_load_dwordx4 v8, s[40:43], s4 offen lds
  s_add_u32 m0, s77, 82944
  s_nop 0
  buffer_load_dwordx4 v9, s[40:43], s4 offen lds
  s_buffer_load_dword s84, s[40:43], s98
  s_add_u32 s98, s98, 131072
  s_bfe_i32 s74, s85, 0x80018
  s_add_i32 s74, s74, 51
  s_lshl_b32 s74, s74, 17
  s_add_u32 m0, s77, 90112
  s_add_u32 s4, s74, 0
  buffer_load_dwordx4 v8, s[40:43], s4 offen lds
  s_add_u32 m0, s77, 91136
  s_nop 0
  buffer_load_dwordx4 v9, s[40:43], s4 offen lds
  s_buffer_load_dword s84, s[40:43], s98
  s_add_u32 s98, s98, 131072
  s_bfe_i32 s74, s85, 0x80000
  s_add_i32 s74, s74, 52
  s_lshl_b32 s74, s74, 17
  s_add_u32 m0, s77, 98304
  s_add_u32 s4, s74, 0
  buffer_load_dwordx4 v8, s[40:43], s4 offen lds
  s_add_u32 m0, s77, 99328
  s_nop 0
  buffer_load_dwordx4 v9, s[40:43], s4 offen lds
  s_waitcnt vmcnt(10)
  s_barrier
  s_buffer_load_dword s84, s[40:43], s98
  s_add_u32 s98, s98, 131072
  s_bfe_i32 s74, s85, 0x80008
  s_add_i32 s74, s74, 53
  s_sub_u32 s3, s74, 56
  s_cmp_ge_i32 s74, 56
  s_cselect_b32 s74, s3, s74
  s_add_u32 s3, s74, s86
  s_and_b32 s3, s3, 15
  s_cmp_lt_u32 s74, 16
  s_cselect_b32 s74, s3, s74
  s_lshl_b32 s74, s74, 17
  s_add_u32 m0, s77, 106496
  s_add_u32 s4, s74, 0
  buffer_load_dwordx4 v8, s[40:43], s4 offen lds
  s_add_u32 m0, s77, 107520
  s_nop 0
  buffer_load_dwordx4 v9, s[40:43], s4 offen lds
  s_buffer_load_dword s84, s[40:43], s98
  s_add_u32 s98, s98, 131072
  s_bfe_i32 s74, s85, 0x80010
  s_add_i32 s74, s74, 54
  s_sub_u32 s3, s74, 56
  s_cmp_ge_i32 s74, 56
  s_cselect_b32 s74, s3, s74
  s_add_u32 s3, s74, s86
  s_and_b32 s3, s3, 15
  s_cmp_lt_u32 s74, 16
  s_cselect_b32 s74, s3, s74
  s_lshl_b32 s74, s74, 17
  s_add_u32 m0, s77, 114688
  s_add_u32 s4, s74, 0
  buffer_load_dwordx4 v8, s[40:43], s4 offen lds
  s_add_u32 m0, s77, 115712
  s_nop 0
  buffer_load_dwordx4 v9, s[40:43], s4 offen lds
  s_buffer_load_dword s84, s[40:43], s98
  s_add_u32 s98, s98, 131072
  s_bfe_i32 s74, s85, 0x80018
  s_add_i32 s74, s74, 55
  s_sub_u32 s3, s74, 56
  s_cmp_ge_i32 s74, 56
  s_cselect_b32 s74, s3, s74
  s_add_u32 s3, s74, s86
  s_and_b32 s3, s3, 15
  s_cmp_lt_u32 s74, 16
  s_cselect_b32 s74, s3, s74
  s_lshl_b32 s74, s74, 17
  s_add_u32 m0, s77, 122880
  s_add_u32 s4, s74, 0
  buffer_load_dwordx4 v8, s[40:43], s4 offen lds
  s_add_u32 m0, s77, 123904
  s_nop 0
  buffer_load_dwordx4 v9, s[40:43], s4 offen lds
  s_add_u32 s48, s34, 4194304
  s_addc_u32 s49, s35, 0
  s_and_b32 s49, s49, 0xffff
  s_mov_b32 s50, 4194304
  s_mov_b32 s51, 0x00020000
  s_lshr_b32 s10, s76, 11
  s_lshl_b32 s3, s68, 3
  s_add_u32 s10, s10, s3
  s_mul_i32 s10, s10, 32768
  v_lshl_add_u32 v4, v1, 4, s10
  v_add_u32 v5, 32768, v4
  s_lshl_b32 s4, s69, 11
  s_add_u32 m0, s76, 131072
  s_nop 0
  buffer_load_dwordx4 v4, s[48:51], s4 offen offset:0 lds
  buffer_load_dwordx4 v4, s[48:51], s4 offen offset:1024 lds
  s_add_u32 m0, s76, 133120
  s_nop 0
  buffer_load_dwordx4 v5, s[48:51], s4 offen offset:0 lds
  buffer_load_dwordx4 v5, s[48:51], s4 offen offset:1024 lds
  s_waitcnt vmcnt(12)
  s_barrier
  s_waitcnt vmcnt(4)
  s_barrier
  s_waitcnt vmcnt(0)
  s_barrier
  s_cmp_eq_u32 s96, 1
  s_cbranch_scc1 L_w2_end
  s_lshl_b32 s87, s97, 12
  s_lshl_b32 s4, s68, 8
  s_add_u32 s87, s87, s4
  s_lshl_b32 s4, s69, 2
  s_add_u32 s87, s87, s4
  s_mov_b32 s96, 1
  s_add_u32 s12, s22, 33554432
  s_addc_u32 s13, s23, 0
  s_add_u32 s34, s22, 67108864
  s_addc_u32 s35, s23, 0
  s_add_u32 s97, s97, 1
  s_branch L_attn_body
L_w2_end:
  s_endpgm
L_w2_compute:
  v_and_b32 v3, 15, v1
  v_lshrrev_b32 v2, 4, v1
  s_lshl_b32 s8, s68, 7
  s_lshl_b32 s9, s70, 5
  s_add_u32 s8, s8, s9
  s_mul_i32 s9, s8, 7168
  v_lshl_add_u32 v4, v1, 4, s9
  v_add_u32 v5, 114688, v4
  v_add_u32 v13, s8, v3
  s_lshl_b32 s10, s69, 7
  v_lshl_add_u32 v14, v2, 3, s10
  v_and_b32 v16, 1, v2
  v_lshrrev_b32 v17, 1, v2
  v_lshlrev_b32 v16, 5, v16
  v_lshl_add_u32 v16, v17, 4, v16
  v_add_u32 v16, s10, v16
  s_cmp_eq_u32 s96, 0
  s_cselect_b32 s7, 128, 0
  s_add_u32 s7, s7, 2048
  v_mad_u32_u24 v12, v13, s7, v16
  v_lshl_add_u32 v18, v17, 4, v13
  v_lshlrev_b32 v18, 3, v18
  v_and_b32 v16, 1, v2
  v_lshl_add_u32 v18, v16, 2, v18
  s_lshl_b32 s10, s69, 14
  v_add_u32 v18, s10, v18
  v_bfe_u32 v6, v1, 2, 2
  v_lshl_add_u32 v6, v2, 3, v6
  v_lshlrev_b32 v6, 7, v6
  v_and_b32 v17, 3, v1
  v_lshl_add_u32 v6, v17, 3, v6
  v_bfe_u32 v17, v1, 3, 2
  v_lshl_add_u32 v6, v17, 5, v6
  v_xor_b32 v7, 32, v6
  v_xor_b32 v8, 64, v6
  v_xor_b32 v9, 96, v6
  v_lshrrev_b32 v15, 1, v2
  v_lshlrev_b32 v15, 8, v15
  v_lshl_add_u32 v15, v3, 4, v15
  v_lshl_add_u32 v15, v16, 3, v15
  s_lshl_b32 s8, s70, 12
  s_add_u32 s8, s8, 131072
  v_add_u32 v15, s8, v15
  s_mov_b32 s11, 0xffff0000
  s_mov_b32 s75, 0
  s_add_u32 s3, s68, s69
  s_lshl_b32 s3, s3, 3
  s_lshl_b32 s8, 0xffff02, s3
  s_sub_u32 s3, 0, s3
  s_lshr_b32 s3, 0xffff02, s3
  s_or_b32 s8, s8, s3
  s_bfe_i32 s64, s8, 0x80000
  s_add_i32 s64, s64, 0
  s_cmp_lt_i32 s64, 0
  s_cselect_b32 s64, 55, s64
  s_lshl_b32 s64, s64, 11
  s_bfe_i32 s65, s8, 0x80008
  s_add_i32 s65, s65, 1
  s_lshl_b32 s65, s65, 11
  s_bfe_i32 s66, s8, 0x80010
  s_add_i32 s66, s66, 2
  s_lshl_b32 s66, s66, 11
  s_bfe_i32 s67, s8, 0x80018
  s_add_i32 s67, s67, 3
  s_lshl_b32 s67, s67, 11
  s_and_b32 s100, s68, 3
  s_lshl_b32 s100, s100, 13
  s_mov_b32 s101, 0
  s_mov_b32 s52, s30
  s_and_b32 s53, s31, 0xffff
  s_mov_b32 s54, 2048
  s_mov_b32 s55, 0x00020000
  buffer_load_dwordx2 v[192:193], v14, s[52:55], 0 offen offset:0
  buffer_load_dwordx2 v[194:195], v14, s[52:55], 0 offen offset:32
  buffer_load_dwordx2 v[196:197], v14, s[52:55], 0 offen offset:64
  buffer_load_dwordx2 v[198:199], v14, s[52:55], 0 offen offset:96
  s_add_u32 s36, s34, 8388608
  s_addc_u32 s37, s35, 0
  s_and_b32 s37, s37, 0xffff
  s_mov_b32 s38, 14680064
  s_mov_b32 s39, 0x00020000
  s_mov_b32 s44, s32
  s_and_b32 s45, s33, 0xffff
  s_mov_b32 s46, 4194304
  s_mov_b32 s47, 0x00020000
  s_add_u32 s48, s22, 33554432
  s_addc_u32 s49, s23, 0
  s_and_b32 s49, s49, 0xffff
  s_mov_b32 s50, 4194304
  s_mov_b32 s51, 0x00020000
  s_cmp_eq_u32 s96, 0
  s_cselect_b64 s[44:45], s[48:49], s[44:45]
  s_lshl_b32 s46, s7, 11
  s_add_u32 s56, s34, 24379392
  s_addc_u32 s57, s35, 0
  s_and_b32 s57, s57, 0xffff
  s_mov_b32 s58, 262144
  s_mov_b32 s59, 0x00020000
  v_add_u32_e64 v26, s75, v6
  v_add_u32_e64 v27, s75, v7
  v_add_u32_e64 v28, s75, v8
  v_add_u32_e64 v29, s75, v9
  s_add_u32 s75, s75, 32768
  s_cmp_eq_u32 s75, 163840
  s_cselect_b32 s75, 0, s75
  s_waitcnt vmcnt(0)
  v_lshlrev_b32 v224, 16, v192
  v_and_b32 v225, s11, v192
  v_lshlrev_b32 v226, 16, v193
  v_and_b32 v227, s11, v193
  v_lshlrev_b32 v228, 16, v192
  v_and_b32 v229, s11, v192
  v_lshlrev_b32 v230, 16, v193
  v_and_b32 v231, s11, v193
  v_lshlrev_b32 v232, 16, v194
  v_and_b32 v233, s11, v194
  v_lshlrev_b32 v234, 16, v195
  v_and_b32 v235, s11, v195
  v_lshlrev_b32 v236, 16, v194
  v_and_b32 v237, s11, v194
  v_lshlrev_b32 v238, 16, v195
  v_and_b32 v239, s11, v195
  v_lshlrev_b32 v240, 16, v196
  v_and_b32 v241, s11, v196
  v_lshlrev_b32 v242, 16, v197
  v_and_b32 v243, s11, v197
  v_lshlrev_b32 v244, 16, v196
  v_and_b32 v245, s11, v196
  v_lshlrev_b32 v246, 16, v197
  v_and_b32 v247, s11, v197
  v_lshlrev_b32 v248, 16, v198
  v_and_b32 v249, s11, v198
  v_lshlrev_b32 v250, 16, v199
  v_and_b32 v251, s11, v199
  v_lshlrev_b32 v252, 16, v198
  v_and_b32 v253, s11, v198
  v_lshlrev_b32 v254, 16, v199
  v_and_b32 v255, s11, v199
  s_mov_b32 s79, 14
  s_add_u32 s73, s101, s64
  s_sub_u32 s74, s73, 114688
  s_cselect_b32 s73, s73, s74
  s_add_u32 s74, s73, s100
  s_and_b32 s74, s74, 0x7fff
  s_cmp_lt_u32 s73, 0x8000
  s_cselect_b32 s73, s74, s73
  s_mov_b32 s48, s73
  s_add_u32 s73, s101, s65
  s_sub_u32 s74, s73, 114688
  s_cselect_b32 s73, s73, s74
  s_add_u32 s74, s73, s100
  s_and_b32 s74, s74, 0x7fff
  s_cmp_lt_u32 s73, 0x8000
  s_cselect_b32 s73, s74, s73
  s_mov_b32 s49, s73
  s_add_u32 s73, s101, s66
  s_sub_u32 s74, s73, 114688
  s_cselect_b32 s73, s73, s74
  s_add_u32 s74, s73, s100
  s_and_b32 s74, s74, 0x7fff
  s_cmp_lt_u32 s73, 0x8000
  s_cselect_b32 s73, s74, s73
  s_mov_b32 s50, s73
  s_waitcnt lgkmcnt(0)
  s_barrier
  buffer_load_dwordx4 v[32:35], v4, s[36:39], s48 offen offset:0
  buffer_load_dwordx4 v[40:43], v4, s[36:39], s48 offen offset:1024
  buffer_load_dwordx4 v[36:39], v5, s[36:39], s48 offen offset:0
  buffer_load_dwordx4 v[44:47], v5, s[36:39], s48 offen offset:1024
  buffer_load_dwordx4 v[48:51], v4, s[36:39], s49 offen offset:0
  buffer_load_dwordx4 v[56:59], v4, s[36:39], s49 offen offset:1024
  buffer_load_dwordx4 v[52:55], v5, s[36:39], s49 offen offset:0
  buffer_load_dwordx4 v[60:63], v5, s[36:39], s49 offen offset:1024
  buffer_load_dwordx4 v[64:67], v4, s[36:39], s50 offen offset:0
  buffer_load_dwordx4 v[72:75], v4, s[36:39], s50 offen offset:1024
  buffer_load_dwordx4 v[68:71], v5, s[36:39], s50 offen offset:0
  buffer_load_dwordx4 v[76:79], v5, s[36:39], s50 offen offset:1024
  ds_read_b64_tr_b16 v[160:161], v26 offset:0
  ds_read_b64_tr_b16 v[162:163], v26 offset:512
  ds_read_b64_tr_b16 v[164:165], v27 offset:0
  ds_read_b64_tr_b16 v[166:167], v27 offset:512
  ds_read_b64_tr_b16 v[168:169], v28 offset:0
  ds_read_b64_tr_b16 v[170:171], v28 offset:512
  ds_read_b64_tr_b16 v[172:173], v29 offset:0
  ds_read_b64_tr_b16 v[174:175], v29 offset:512
  ds_read_b64_tr_b16 v[176:177], v26 offset:4096
  ds_read_b64_tr_b16 v[178:179], v26 offset:4608
  ds_read_b64_tr_b16 v[180:181], v27 offset:4096
  ds_read_b64_tr_b16 v[182:183], v27 offset:4608
  ds_read_b64_tr_b16 v[184:185], v28 offset:4096
  ds_read_b64_tr_b16 v[186:187], v28 offset:4608
  ds_read_b64_tr_b16 v[188:189], v29 offset:4096
  ds_read_b64_tr_b16 v[190:191], v29 offset:4608
.p2align 3
L_w2_loop:
  s_waitcnt vmcnt(8) lgkmcnt(0)
  v_mfma_f32_16x16x32_bf16 v[224:227], v[160:163], v[32:35], v[224:227]
  ds_read_b64_tr_b16 v[192:193], v26 offset:8192
  ds_read_b64_tr_b16 v[194:195], v26 offset:8704
  v_mfma_f32_16x16x32_bf16 v[228:231], v[160:163], v[36:39], v[228:231]
  ds_read_b64_tr_b16 v[196:197], v27 offset:8192
  ds_read_b64_tr_b16 v[198:199], v27 offset:8704
  v_mfma_f32_16x16x32_bf16 v[232:235], v[164:167], v[32:35], v[232:235]
  ds_read_b64_tr_b16 v[200:201], v28 offset:8192
  ds_read_b64_tr_b16 v[202:203], v28 offset:8704
  v_mfma_f32_16x16x32_bf16 v[236:239], v[164:167], v[36:39], v[236:239]
  ds_read_b64_tr_b16 v[204:205], v29 offset:8192
  ds_read_b64_tr_b16 v[206:207], v29 offset:8704
  v_mfma_f32_16x16x32_bf16 v[240:243], v[168:171], v[32:35], v[240:243]
  ds_read_b64_tr_b16 v[208:209], v26 offset:12288
  ds_read_b64_tr_b16 v[210:211], v26 offset:12800
  v_mfma_f32_16x16x32_bf16 v[244:247], v[168:171], v[36:39], v[244:247]
  ds_read_b64_tr_b16 v[212:213], v27 offset:12288
  ds_read_b64_tr_b16 v[214:215], v27 offset:12800
  v_mfma_f32_16x16x32_bf16 v[248:251], v[172:175], v[32:35], v[248:251]
  ds_read_b64_tr_b16 v[216:217], v28 offset:12288
  ds_read_b64_tr_b16 v[218:219], v28 offset:12800
  v_mfma_f32_16x16x32_bf16 v[252:255], v[172:175], v[36:39], v[252:255]
  ds_read_b64_tr_b16 v[220:221], v29 offset:12288
  ds_read_b64_tr_b16 v[222:223], v29 offset:12800
  v_mfma_f32_16x16x32_bf16 v[224:227], v[176:179], v[40:43], v[224:227]
  s_add_u32 s73, s101, s67
  s_sub_u32 s74, s73, 114688
  s_cselect_b32 s73, s73, s74
  v_mfma_f32_16x16x32_bf16 v[228:231], v[176:179], v[44:47], v[228:231]
  s_add_u32 s74, s73, s100
  s_and_b32 s74, s74, 0x7fff
  s_cmp_lt_u32 s73, 0x8000
  s_cselect_b32 s73, s74, s73
  v_mfma_f32_16x16x32_bf16 v[232:235], v[180:183], v[40:43], v[232:235]
  buffer_load_dwordx4 v[80:83], v4, s[36:39], s73 offen offset:0
  v_mfma_f32_16x16x32_bf16 v[236:239], v[180:183], v[44:47], v[236:239]
  buffer_load_dwordx4 v[88:91], v4, s[36:39], s73 offen offset:1024
  v_mfma_f32_16x16x32_bf16 v[240:243], v[184:187], v[40:43], v[240:243]
  buffer_load_dwordx4 v[84:87], v5, s[36:39], s73 offen offset:0
  v_mfma_f32_16x16x32_bf16 v[244:247], v[184:187], v[44:47], v[244:247]
  buffer_load_dwordx4 v[92:95], v5, s[36:39], s73 offen offset:1024
  v_mfma_f32_16x16x32_bf16 v[248:251], v[188:191], v[40:43], v[248:251]
  s_add_u32 s101, s101, 8192
  v_mfma_f32_16x16x32_bf16 v[252:255], v[188:191], v[44:47], v[252:255]
  s_sub_u32 s79, s79, 1
  s_cmp_eq_u32 s79, 0
  s_cselect_b32 s38, 0, s38
  s_waitcnt vmcnt(8) lgkmcnt(0)
  v_mfma_f32_16x16x32_bf16 v[224:227], v[192:195], v[48:51], v[224:227]
  ds_read_b64_tr_b16 v[160:161], v26 offset:16384
  ds_read_b64_tr_b16 v[162:163], v26 offset:16896
  v_mfma_f32_16x16x32_bf16 v[228:231], v[192:195], v[52:55], v[228:231]
  ds_read_b64_tr_b16 v[164:165], v27 offset:16384
  ds_read_b64_tr_b16 v[166:167], v27 offset:16896
  v_mfma_f32_16x16x32_bf16 v[232:235], v[196:199], v[48:51], v[232:235]
  ds_read_b64_tr_b16 v[168:169], v28 offset:16384
  ds_read_b64_tr_b16 v[170:171], v28 offset:16896
  v_mfma_f32_16x16x32_bf16 v[236:239], v[196:199], v[52:55], v[236:239]
  ds_read_b64_tr_b16 v[172:173], v29 offset:16384
  ds_read_b64_tr_b16 v[174:175], v29 offset:16896
  v_mfma_f32_16x16x32_bf16 v[240:243], v[200:203], v[48:51], v[240:243]
  ds_read_b64_tr_b16 v[176:177], v26 offset:20480
  ds_read_b64_tr_b16 v[178:179], v26 offset:20992
  v_mfma_f32_16x16x32_bf16 v[244:247], v[200:203], v[52:55], v[244:247]
  ds_read_b64_tr_b16 v[180:181], v27 offset:20480
  ds_read_b64_tr_b16 v[182:183], v27 offset:20992
  v_mfma_f32_16x16x32_bf16 v[248:251], v[204:207], v[48:51], v[248:251]
  ds_read_b64_tr_b16 v[184:185], v28 offset:20480
  ds_read_b64_tr_b16 v[186:187], v28 offset:20992
  v_mfma_f32_16x16x32_bf16 v[252:255], v[204:207], v[52:55], v[252:255]
  ds_read_b64_tr_b16 v[188:189], v29 offset:20480
  ds_read_b64_tr_b16 v[190:191], v29 offset:20992
  v_mfma_f32_16x16x32_bf16 v[224:227], v[208:211], v[56:59], v[224:227]
  s_add_u32 s73, s101, s64
  s_sub_u32 s74, s73, 114688
  s_cselect_b32 s73, s73, s74
  v_mfma_f32_16x16x32_bf16 v[228:231], v[208:211], v[60:63], v[228:231]
  s_add_u32 s74, s73, s100
  s_and_b32 s74, s74, 0x7fff
  s_cmp_lt_u32 s73, 0x8000
  s_cselect_b32 s73, s74, s73
  v_mfma_f32_16x16x32_bf16 v[232:235], v[212:215], v[56:59], v[232:235]
  buffer_load_dwordx4 v[32:35], v4, s[36:39], s73 offen offset:0
  v_mfma_f32_16x16x32_bf16 v[236:239], v[212:215], v[60:63], v[236:239]
  buffer_load_dwordx4 v[40:43], v4, s[36:39], s73 offen offset:1024
  v_mfma_f32_16x16x32_bf16 v[240:243], v[216:219], v[56:59], v[240:243]
  buffer_load_dwordx4 v[36:39], v5, s[36:39], s73 offen offset:0
  v_mfma_f32_16x16x32_bf16 v[244:247], v[216:219], v[60:63], v[244:247]
  buffer_load_dwordx4 v[44:47], v5, s[36:39], s73 offen offset:1024
  v_mfma_f32_16x16x32_bf16 v[248:251], v[220:223], v[56:59], v[248:251]
  v_mfma_f32_16x16x32_bf16 v[252:255], v[220:223], v[60:63], v[252:255]
  s_waitcnt vmcnt(8) lgkmcnt(0)
  v_mfma_f32_16x16x32_bf16 v[224:227], v[160:163], v[64:67], v[224:227]
  ds_read_b64_tr_b16 v[192:193], v26 offset:24576
  ds_read_b64_tr_b16 v[194:195], v26 offset:25088
  v_mfma_f32_16x16x32_bf16 v[228:231], v[160:163], v[68:71], v[228:231]
  ds_read_b64_tr_b16 v[196:197], v27 offset:24576
  ds_read_b64_tr_b16 v[198:199], v27 offset:25088
  v_mfma_f32_16x16x32_bf16 v[232:235], v[164:167], v[64:67], v[232:235]
  ds_read_b64_tr_b16 v[200:201], v28 offset:24576
  ds_read_b64_tr_b16 v[202:203], v28 offset:25088
  v_mfma_f32_16x16x32_bf16 v[236:239], v[164:167], v[68:71], v[236:239]
  ds_read_b64_tr_b16 v[204:205], v29 offset:24576
  ds_read_b64_tr_b16 v[206:207], v29 offset:25088
  v_mfma_f32_16x16x32_bf16 v[240:243], v[168:171], v[64:67], v[240:243]
  ds_read_b64_tr_b16 v[208:209], v26 offset:28672
  ds_read_b64_tr_b16 v[210:211], v26 offset:29184
  v_mfma_f32_16x16x32_bf16 v[244:247], v[168:171], v[68:71], v[244:247]
  ds_read_b64_tr_b16 v[212:213], v27 offset:28672
  ds_read_b64_tr_b16 v[214:215], v27 offset:29184
  v_mfma_f32_16x16x32_bf16 v[248:251], v[172:175], v[64:67], v[248:251]
  ds_read_b64_tr_b16 v[216:217], v28 offset:28672
  ds_read_b64_tr_b16 v[218:219], v28 offset:29184
  v_mfma_f32_16x16x32_bf16 v[252:255], v[172:175], v[68:71], v[252:255]
  ds_read_b64_tr_b16 v[220:221], v29 offset:28672
  ds_read_b64_tr_b16 v[222:223], v29 offset:29184
  v_mfma_f32_16x16x32_bf16 v[224:227], v[176:179], v[72:75], v[224:227]
  s_add_u32 s73, s101, s65
  s_sub_u32 s74, s73, 114688
  s_cselect_b32 s73, s73, s74
  v_mfma_f32_16x16x32_bf16 v[228:231], v[176:179], v[76:79], v[228:231]
  s_add_u32 s74, s73, s100
  s_and_b32 s74, s74, 0x7fff
  s_cmp_lt_u32 s73, 0x8000
  s_cselect_b32 s73, s74, s73
  v_mfma_f32_16x16x32_bf16 v[232:235], v[180:183], v[72:75], v[232:235]
  buffer_load_dwordx4 v[48:51], v4, s[36:39], s73 offen offset:0
  v_mfma_f32_16x16x32_bf16 v[236:239], v[180:183], v[76:79], v[236:239]
  buffer_load_dwordx4 v[56:59], v4, s[36:39], s73 offen offset:1024
  v_mfma_f32_16x16x32_bf16 v[240:243], v[184:187], v[72:75], v[240:243]
  buffer_load_dwordx4 v[52:55], v5, s[36:39], s73 offen offset:0
  v_mfma_f32_16x16x32_bf16 v[244:247], v[184:187], v[76:79], v[244:247]
  buffer_load_dwordx4 v[60:63], v5, s[36:39], s73 offen offset:1024
  v_mfma_f32_16x16x32_bf16 v[248:251], v[188:191], v[72:75], v[248:251]
  v_mfma_f32_16x16x32_bf16 v[252:255], v[188:191], v[76:79], v[252:255]
  s_waitcnt vmcnt(8) lgkmcnt(0)
  s_barrier
  v_mfma_f32_16x16x32_bf16 v[224:227], v[192:195], v[80:83], v[224:227]
  v_add_u32_e64 v26, s75, v6
  v_add_u32_e64 v27, s75, v7
  v_add_u32_e64 v28, s75, v8
  v_mfma_f32_16x16x32_bf16 v[228:231], v[192:195], v[84:87], v[228:231]
  v_add_u32_e64 v29, s75, v9
  s_add_u32 s75, s75, 32768
  s_cmp_eq_u32 s75, 163840
  v_mfma_f32_16x16x32_bf16 v[232:235], v[196:199], v[80:83], v[232:235]
  s_cselect_b32 s75, 0, s75
  ds_read_b64_tr_b16 v[160:161], v26 offset:0
  ds_read_b64_tr_b16 v[162:163], v26 offset:512
  v_mfma_f32_16x16x32_bf16 v[236:239], v[196:199], v[84:87], v[236:239]
  ds_read_b64_tr_b16 v[164:165], v27 offset:0
  ds_read_b64_tr_b16 v[166:167], v27 offset:512
  ds_read_b64_tr_b16 v[168:169], v28 offset:0
  v_mfma_f32_16x16x32_bf16 v[240:243], v[200:203], v[80:83], v[240:243]
  ds_read_b64_tr_b16 v[170:171], v28 offset:512
  ds_read_b64_tr_b16 v[172:173], v29 offset:0
  ds_read_b64_tr_b16 v[174:175], v29 offset:512
  v_mfma_f32_16x16x32_bf16 v[244:247], v[200:203], v[84:87], v[244:247]
  ds_read_b64_tr_b16 v[176:177], v26 offset:4096
  ds_read_b64_tr_b16 v[178:179], v26 offset:4608
  ds_read_b64_tr_b16 v[180:181], v27 offset:4096
  v_mfma_f32_16x16x32_bf16 v[248:251], v[204:207], v[80:83], v[248:251]
  ds_read_b64_tr_b16 v[182:183], v27 offset:4608
  ds_read_b64_tr_b16 v[184:185], v28 offset:4096
  ds_read_b64_tr_b16 v[186:187], v28 offset:4608
  v_mfma_f32_16x16x32_bf16 v[252:255], v[204:207], v[84:87], v[252:255]
  ds_read_b64_tr_b16 v[188:189], v29 offset:4096
  ds_read_b64_tr_b16 v[190:191], v29 offset:4608
  v_mfma_f32_16x16x32_bf16 v[224:227], v[208:211], v[88:91], v[224:227]
  s_add_u32 s73, s101, s66
  s_sub_u32 s74, s73, 114688
  s_cselect_b32 s73, s73, s74
  v_mfma_f32_16x16x32_bf16 v[228:231], v[208:211], v[92:95], v[228:231]
  s_add_u32 s74, s73, s100
  s_and_b32 s74, s74, 0x7fff
  s_cmp_lt_u32 s73, 0x8000
  s_cselect_b32 s73, s74, s73
  v_mfma_f32_16x16x32_bf16 v[232:235], v[212:215], v[88:91], v[232:235]
  buffer_load_dwordx4 v[64:67], v4, s[36:39], s73 offen offset:0
  v_mfma_f32_16x16x32_bf16 v[236:239], v[212:215], v[92:95], v[236:239]
  buffer_load_dwordx4 v[72:75], v4, s[36:39], s73 offen offset:1024
  v_mfma_f32_16x16x32_bf16 v[240:243], v[216:219], v[88:91], v[240:243]
  buffer_load_dwordx4 v[68:71], v5, s[36:39], s73 offen offset:0
  v_mfma_f32_16x16x32_bf16 v[244:247], v[216:219], v[92:95], v[244:247]
  buffer_load_dwordx4 v[76:79], v5, s[36:39], s73 offen offset:1024
  v_mfma_f32_16x16x32_bf16 v[248:251], v[220:223], v[88:91], v[248:251]
  s_cmp_lg_u32 s79, 0
  v_mfma_f32_16x16x32_bf16 v[252:255], v[220:223], v[92:95], v[252:255]
  s_cbranch_scc1 L_w2_loop
  s_waitcnt lgkmcnt(0)
  ds_read_b64 v[160:161], v15 offset:0
  ds_read_b64 v[164:165], v15 offset:512
  ds_read_b64 v[168:169], v15 offset:1024
  ds_read_b64 v[172:173], v15 offset:1536
  ds_read_b64 v[162:163], v15 offset:2048
  ds_read_b64 v[166:167], v15 offset:2560
  ds_read_b64 v[170:171], v15 offset:3072
  ds_read_b64 v[174:175], v15 offset:3584
  v_mov_b32 v20, 0
  v_mov_b32 v21, 0
  v_mov_b32 v22, 0
  v_mov_b32 v23, 0
  s_lshl_b32 s3, s7, 4
  s_mov_b32 s10, 0x3f803f80
  s_waitcnt lgkmcnt(7)
  v_lshlrev_b32 v6, 16, v160
  v_and_b32 v7, s11, v160
  v_lshlrev_b32 v8, 16, v161
  v_and_b32 v9, s11, v161
  v_pk_add_f32 v[224:225], v[224:225], v[6:7]
  v_pk_add_f32 v[226:227], v[226:227], v[8:9]
  v_cvt_pk_bf16_f32 v176, v224, v225
  v_cvt_pk_bf16_f32 v177, v226, v227
  s_waitcnt lgkmcnt(6)
  v_lshlrev_b32 v6, 16, v164
  v_and_b32 v7, s11, v164
  v_lshlrev_b32 v8, 16, v165
  v_and_b32 v9, s11, v165
  v_pk_add_f32 v[232:233], v[232:233], v[6:7]
  v_pk_add_f32 v[234:235], v[234:235], v[8:9]
  v_cvt_pk_bf16_f32 v178, v232, v233
  v_cvt_pk_bf16_f32 v179, v234, v235
  s_nop 1
  v_permlane16_swap_b32 v176, v178
  v_permlane16_swap_b32 v177, v179
  buffer_store_dwordx4 v[176:179], v12, s[44:47], 0 offen offset:0 sc1
  s_waitcnt lgkmcnt(5)
  v_lshlrev_b32 v6, 16, v168
  v_and_b32 v7, s11, v168
  v_lshlrev_b32 v8, 16, v169
  v_and_b32 v9, s11, v169
  v_pk_add_f32 v[240:241], v[240:241], v[6:7]
  v_pk_add_f32 v[242:243], v[242:243], v[8:9]
  v_cvt_pk_bf16_f32 v180, v240, v241
  v_cvt_pk_bf16_f32 v181, v242, v243
  s_waitcnt lgkmcnt(4)
  v_lshlrev_b32 v6, 16, v172
  v_and_b32 v7, s11, v172
  v_lshlrev_b32 v8, 16, v173
  v_and_b32 v9, s11, v173
  v_pk_add_f32 v[248:249], v[248:249], v[6:7]
  v_pk_add_f32 v[250:251], v[250:251], v[8:9]
  v_cvt_pk_bf16_f32 v182, v248, v249
  v_cvt_pk_bf16_f32 v183, v250, v251
  s_nop 1
  v_permlane16_swap_b32 v180, v182
  v_permlane16_swap_b32 v181, v183
  buffer_store_dwordx4 v[180:183], v12, s[44:47], 0 offen offset:64 sc1
  s_waitcnt lgkmcnt(3)
  v_lshlrev_b32 v6, 16, v162
  v_and_b32 v7, s11, v162
  v_lshlrev_b32 v8, 16, v163
  v_and_b32 v9, s11, v163
  v_pk_add_f32 v[228:229], v[228:229], v[6:7]
  v_pk_add_f32 v[230:231], v[230:231], v[8:9]
  v_cvt_pk_bf16_f32 v184, v228, v229
  v_cvt_pk_bf16_f32 v185, v230, v231
  s_waitcnt lgkmcnt(2)
  v_lshlrev_b32 v6, 16, v166
  v_and_b32 v7, s11, v166
  v_lshlrev_b32 v8, 16, v167
  v_and_b32 v9, s11, v167
  v_pk_add_f32 v[236:237], v[236:237], v[6:7]
  v_pk_add_f32 v[238:239], v[238:239], v[8:9]
  v_cvt_pk_bf16_f32 v186, v236, v237
  v_cvt_pk_bf16_f32 v187, v238, v239
  s_nop 1
  v_permlane16_swap_b32 v184, v186
  v_permlane16_swap_b32 v185, v187
  buffer_store_dwordx4 v[184:187], v12, s[44:47], s3 offen offset:0 sc1
  s_waitcnt lgkmcnt(1)
  v_lshlrev_b32 v6, 16, v170
  v_and_b32 v7, s11, v170
  v_lshlrev_b32 v8, 16, v171
  v_and_b32 v9, s11, v171
  v_pk_add_f32 v[244:245], v[244:245], v[6:7]
  v_pk_add_f32 v[246:247], v[246:247], v[8:9]
  v_cvt_pk_bf16_f32 v188, v244, v245
  v_cvt_pk_bf16_f32 v189, v246, v247
  s_waitcnt lgkmcnt(0)
  v_lshlrev_b32 v6, 16, v174
  v_and_b32 v7, s11, v174
  v_lshlrev_b32 v8, 16, v175
  v_and_b32 v9, s11, v175
  v_pk_add_f32 v[252:253], v[252:253], v[6:7]
  v_pk_add_f32 v[254:255], v[254:255], v[8:9]
  v_cvt_pk_bf16_f32 v190, v252, v253
  v_cvt_pk_bf16_f32 v191, v254, v255
  s_nop 1
  v_permlane16_swap_b32 v188, v190
  v_permlane16_swap_b32 v189, v191
  buffer_store_dwordx4 v[188:191], v12, s[44:47], s3 offen offset:64 sc1
  v_dot2_f32_bf16 v20, v176, s10, v20
  v_dot2_f32_bf16 v22, v176, v176, v22
  v_dot2_f32_bf16 v20, v177, s10, v20
  v_dot2_f32_bf16 v22, v177, v177, v22
  v_dot2_f32_bf16 v20, v178, s10, v20
  v_dot2_f32_bf16 v22, v178, v178, v22
  v_dot2_f32_bf16 v20, v179, s10, v20
  v_dot2_f32_bf16 v22, v179, v179, v22
  v_dot2_f32_bf16 v20, v180, s10, v20
  v_dot2_f32_bf16 v22, v180, v180, v22
  v_dot2_f32_bf16 v20, v181, s10, v20
  v_dot2_f32_bf16 v22, v181, v181, v22
  v_dot2_f32_bf16 v20, v182, s10, v20
  v_dot2_f32_bf16 v22, v182, v182, v22
  v_dot2_f32_bf16 v20, v183, s10, v20
  v_dot2_f32_bf16 v22, v183, v183, v22
  v_dot2_f32_bf16 v21, v184, s10, v21
  v_dot2_f32_bf16 v23, v184, v184, v23
  v_dot2_f32_bf16 v21, v185, s10, v21
  v_dot2_f32_bf16 v23, v185, v185, v23
  v_dot2_f32_bf16 v21, v186, s10, v21
  v_dot2_f32_bf16 v23, v186, v186, v23
  v_dot2_f32_bf16 v21, v187, s10, v21
  v_dot2_f32_bf16 v23, v187, v187, v23
  v_dot2_f32_bf16 v21, v188, s10, v21
  v_dot2_f32_bf16 v23, v188, v188, v23
  v_dot2_f32_bf16 v21, v189, s10, v21
  v_dot2_f32_bf16 v23, v189, v189, v23
  v_dot2_f32_bf16 v21, v190, s10, v21
  v_dot2_f32_bf16 v23, v190, v190, v23
  v_dot2_f32_bf16 v21, v191, s10, v21
  v_dot2_f32_bf16 v23, v191, v191, v23
  s_nop 2
  v_permlane32_swap_b32 v20, v21
  v_permlane32_swap_b32 v22, v23
  v_add_f32 v20, v20, v21
  v_add_f32 v22, v22, v23
  s_nop 1
  v_permlane16_swap_b32 v20, v22
  v_add_f32 v20, v20, v22
  buffer_store_dword v20, v18, s[56:59], 0 offen sc1
  s_cmp_eq_u32 s96, 1
  s_cbranch_scc1 L_w2_end
  s_waitcnt vmcnt(0)
  s_barrier
  s_mov_b32 s96, 1
  s_add_u32 s12, s22, 33554432
  s_addc_u32 s13, s23, 0
  s_add_u32 s34, s22, 67108864
  s_addc_u32 s35, s23, 0
  s_add_u32 s97, s97, 1
  s_branch L_attn_body
L_w2_c1:
```

```asm
; @launch grid=(256,1,1) block=(512,1,1) lds=163840
.amdgcn_target "amdgcn-amd-amdhsa--gfx950"
L_attn_c0:
.text
.globl interleave_layers__sliding_local_dilated__dense_activation_gelu__prompt_kernel
.p2align 8
.type interleave_layers__sliding_local_dilated__dense_activation_gelu__prompt_kernel,@function
interleave_layers__sliding_local_dilated__dense_activation_gelu__prompt_kernel:
  s_load_dwordx4 s[16:19], s[0:1], 0
  s_load_dwordx2 s[20:21], s[0:1], 16
  s_load_dwordx2 s[22:23], s[0:1], 80
  s_load_dwordx8 s[24:31], s[0:1], 32
  s_load_dwordx2 s[32:33], s[0:1], 64
  s_load_dwordx2 s[34:35], s[0:1], 80
  s_load_dwordx2 s[12:13], s[0:1], 0
  s_mov_b32 s96, 0
  s_mov_b32 s97, 0
L_attn_body:
  s_cmp_ge_u32 s2, 256
  s_cbranch_scc1 L_attn_end
  v_lshrrev_b32 v2, 6, v0
  v_and_b32 v1, 63, v0
  v_readfirstlane_b32 s70, v2
  s_and_b32 s3, s2, 7
  s_lshr_b32 s99, s2, 3
  s_and_b32 s5, s3, 1
  s_lshl_b32 s5, s5, 3
  s_and_b32 s6, s99, 7
  s_add_u32 s68, s5, s6
  s_lshr_b32 s5, s3, 1
  s_lshl_b32 s5, s5, 2
  s_lshr_b32 s6, s99, 3
  s_add_u32 s69, s5, s6
  s_cmp_lt_u32 s70, 4
  s_cbranch_scc1 L_attn_compute
L_attn_loader:
  s_add_u32 s8, s70, s69
  s_and_b32 s8, s8, 3
  s_add_u32 s9, s70, s68
  s_and_b32 s9, s9, 3
  s_lshl_b32 s76, s8, 12
  s_lshl_b32 s77, s9, 11
  s_add_u32 s77, s77, 16384
  s_lshl_b32 s11, s68, 7
  v_and_b32 v10, 7, v1
  v_lshrrev_b32 v3, 3, v1
  s_lshr_b32 s10, s76, 7
  s_lshl_b32 s3, s68, 7
  s_add_u32 s10, s10, s3
  v_add_u32 v3, s10, v3
  s_cmp_eq_u32 s96, 1
  s_cselect_b32 s5, 128, 0
  s_add_u32 s5, s5, 2048
  s_lshl_b32 s6, s5, 3
  v_mul_u32_u24 v3, s5, v3
  v_lshrrev_b32 v2, 4, v1
  v_xor_b32 v4, v2, v10
  v_lshl_add_u32 v4, v4, 4, v3
  v_add_u32 v3, s6, v3
  v_add_u32 v5, 4, v2
  v_xor_b32 v5, v5, v10
  v_lshl_add_u32 v5, v5, 4, v3
  v_add_u32 v3, s6, v3
  v_xor_b32 v6, v2, v10
  v_lshl_add_u32 v6, v6, 4, v3
  v_add_u32 v3, s6, v3
  v_add_u32 v7, 4, v2
  v_xor_b32 v7, v7, v10
  v_lshl_add_u32 v7, v7, 4, v3
  v_lshrrev_b32 v3, 3, v1
  s_lshl_b32 s10, s9, 4
  v_add_u32 v3, s10, v3
  v_mul_u32_u24 v3, 6144, v3
  v_lshrrev_b32 v2, 3, v1
  v_and_b32 v2, 2, v2
  v_xor_b32 v2, v2, v10
  s_mul_i32 s10, s69, 128
  v_add_u32 v3, s10, v3
  v_lshl_add_u32 v8, v2, 4, v3
  v_xor_b32 v2, 4, v2
  v_add_u32 v3, 49152, v3
  v_lshl_add_u32 v9, v2, 4, v3
  s_and_b32 s10, s70, 3
  s_lshl_b32 s78, s10, 9
  s_add_u32 s78, s78, 40960
  s_lshl_b32 s14, s10, 2
  s_add_u32 s14, s14, s11
  s_sub_u32 s14, s14, 16
  v_lshrrev_b32 v3, 3, v1
  v_add_u32 v3, s14, v3
  v_max_i32 v3, 0, v3
  v_mul_u32_u24 v3, s5, v3
  s_lshl_b32 s14, s10, 1
  v_lshrrev_b32 v2, 4, v1
  v_add_u32 v2, s14, v2
  v_and_b32 v2, 7, v2
  v_xor_b32 v2, v2, v10
  v_lshl_add_u32 v28, v2, 4, v3
  s_cmp_eq_u32 s10, 0
  s_cselect_b32 s14, 0xffffff00, -1
  s_mov_b32 s15, 0
  s_mov_b32 s75, 0
  s_add_u32 s100, s68, s69
  s_mov_b32 s101, -1
  s_add_u32 s101, s101, 1
  s_sub_u32 s73, s101, s100
  s_lshl_b32 s73, s73, 3
  s_lshr_b32 s73, 0xf0f02, s73
  s_and_b32 s73, s73, 255
  s_add_u32 s73, s73, s101
  s_and_b32 s73, s73, 15
  s_mul_i32 s74, s73, 393216
  s_lshl_b32 s73, s73, 7
  s_waitcnt lgkmcnt(0)
  s_mov_b32 s36, s12
  s_and_b32 s37, s13, 0xffff
  s_mov_b32 s38, 4194304
  s_mov_b32 s39, 0x00020000
  s_cmp_eq_u32 s96, 1
  s_cselect_b32 s38, 128, 0
  s_add_u32 s38, s38, 2048
  s_lshl_b32 s38, s38, 11
  s_mov_b32 s40, s18
  s_and_b32 s41, s19, 0xffff
  s_mov_b32 s42, 6291456
  s_mov_b32 s43, 0x00020000
  s_cmp_lg_u32 s96, 0
  s_cbranch_scc1 L_attn_ld1
  s_mov_b32 s48, s28
  s_and_b32 s49, s29, 0xffff
  s_mov_b32 s50, 7340032
  s_mov_b32 s51, 0x00020000
  s_cmp_eq_u32 s96, 0
  s_cselect_b32 s50, s50, 0
  s_and_b32 s3, s70, 3
  s_lshl_b32 s4, s2, 2
  s_add_u32 s3, s3, s4
  s_mul_i32 s98, s3, 3584
  s_add_u32 s98, s98, 0
  s_add_u32 s3, s75, s76
  s_add_u32 m0, s3, 0
  s_nop 0
  buffer_load_dwordx4 v4, s[36:39], s73 offen lds
  s_add_u32 m0, s3, 1024
  s_nop 0
  buffer_load_dwordx4 v5, s[36:39], s73 offen lds
  s_add_u32 m0, s3, 2048
  s_nop 0
  buffer_load_dwordx4 v6, s[36:39], s73 offen lds
  s_add_u32 m0, s3, 3072
  s_nop 0
  buffer_load_dwordx4 v7, s[36:39], s73 offen lds
  s_add_u32 m0, s78, s75
  s_mov_b64 exec, s[14:15]
  buffer_load_dwordx4 v28, s[36:39], s73 offen lds
  s_mov_b64 exec, -1
  s_add_u32 s3, s75, s77
  s_add_u32 m0, s3, 0
  s_add_u32 s4, s74, 0
  buffer_load_dwordx4 v8, s[40:43], s4 offen lds
  s_add_u32 m0, s3, 1024
  s_nop 0
  buffer_load_dwordx4 v9, s[40:43], s4 offen lds
  s_add_u32 m0, s3, 8192
  s_add_u32 s4, s74, 2048
  buffer_load_dwordx4 v8, s[40:43], s4 offen lds
  s_add_u32 m0, s3, 9216
  s_nop 0
  buffer_load_dwordx4 v9, s[40:43], s4 offen lds
  s_add_u32 m0, s3, 16384
  s_add_u32 s4, s74, 4096
  buffer_load_dwordx4 v8, s[40:43], s4 offen lds
  s_add_u32 m0, s3, 17408
  s_nop 0
  buffer_load_dwordx4 v9, s[40:43], s4 offen lds
  s_add_u32 s101, s101, 1
  s_sub_u32 s73, s101, s100
  s_lshl_b32 s73, s73, 3
  s_lshr_b32 s73, 0xf0f02, s73
  s_and_b32 s73, s73, 255
  s_add_u32 s73, s73, s101
  s_and_b32 s73, s73, 15
  s_mul_i32 s74, s73, 393216
  s_lshl_b32 s73, s73, 7
  s_add_u32 s75, s75, 43008
  s_cmp_eq_u32 s75, 129024
  s_cselect_b32 s75, 0, s75
  s_add_u32 s3, s75, s76
  s_add_u32 m0, s3, 0
  s_nop 0
  buffer_load_dwordx4 v4, s[36:39], s73 offen lds
  s_add_u32 m0, s3, 1024
  s_nop 0
  buffer_load_dwordx4 v5, s[36:39], s73 offen lds
  s_add_u32 m0, s3, 2048
  s_nop 0
  buffer_load_dwordx4 v6, s[36:39], s73 offen lds
  s_add_u32 m0, s3, 3072
  s_nop 0
  buffer_load_dwordx4 v7, s[36:39], s73 offen lds
  s_add_u32 m0, s78, s75
  s_mov_b64 exec, s[14:15]
  buffer_load_dwordx4 v28, s[36:39], s73 offen lds
  s_mov_b64 exec, -1
  s_add_u32 s3, s75, s77
  s_add_u32 m0, s3, 0
  s_add_u32 s4, s74, 0
  buffer_load_dwordx4 v8, s[40:43], s4 offen lds
  s_add_u32 m0, s3, 1024
  s_nop 0
  buffer_load_dwordx4 v9, s[40:43], s4 offen lds
  s_add_u32 m0, s3, 8192
  s_add_u32 s4, s74, 2048
  buffer_load_dwordx4 v8, s[40:43], s4 offen lds
  s_add_u32 m0, s3, 9216
  s_nop 0
  buffer_load_dwordx4 v9, s[40:43], s4 offen lds
  s_add_u32 m0, s3, 16384
  s_add_u32 s4, s74, 4096
  buffer_load_dwordx4 v8, s[40:43], s4 offen lds
  s_add_u32 m0, s3, 17408
  s_nop 0
  buffer_load_dwordx4 v9, s[40:43], s4 offen lds
  s_add_u32 s101, s101, 1
  s_sub_u32 s73, s101, s100
  s_lshl_b32 s73, s73, 3
  s_lshr_b32 s73, 0xf0f02, s73
  s_and_b32 s73, s73, 255
  s_add_u32 s73, s73, s101
  s_and_b32 s73, s73, 15
  s_mul_i32 s74, s73, 393216
  s_lshl_b32 s73, s73, 7
  s_add_u32 s75, s75, 43008
  s_cmp_eq_u32 s75, 129024
  s_cselect_b32 s75, 0, s75
  s_and_b32 s3, s70, 3
  s_lshl_b32 s4, s2, 2
  s_add_u32 s3, s3, s4
  s_sub_u32 s4, 384, s40
  s_and_b32 s4, s4, 0x380
  s_mul_i32 s5, s3, 6144
  s_add_u32 s5, s5, s4
  s_buffer_load_dword s84, s[40:43], s5 offset:0
  s_buffer_load_dword s84, s[40:43], s5 offset:64
  s_buffer_load_dword s84, s[40:43], s5 offset:1024
  s_buffer_load_dword s84, s[40:43], s5 offset:1088
  s_buffer_load_dword s84, s[40:43], s5 offset:2048
  s_buffer_load_dword s84, s[40:43], s5 offset:2112
  s_buffer_load_dword s84, s[40:43], s5 offset:3072
  s_buffer_load_dword s84, s[40:43], s5 offset:3136
  s_buffer_load_dword s84, s[40:43], s5 offset:4096
  s_buffer_load_dword s84, s[40:43], s5 offset:4160
  s_buffer_load_dword s84, s[40:43], s5 offset:5120
  s_buffer_load_dword s84, s[40:43], s5 offset:5184
  s_waitcnt vmcnt(11)
  s_barrier
  s_mov_b32 s79, 13
L_attn0_ld1:
  s_add_u32 s3, s75, s76
  s_add_u32 m0, s3, 0
  s_nop 0
  buffer_load_dwordx4 v4, s[36:39], s73 offen lds
  s_add_u32 m0, s3, 1024
  s_nop 0
  buffer_load_dwordx4 v5, s[36:39], s73 offen lds
  s_add_u32 m0, s3, 2048
  s_nop 0
  buffer_load_dwordx4 v6, s[36:39], s73 offen lds
  s_add_u32 m0, s3, 3072
  s_nop 0
  buffer_load_dwordx4 v7, s[36:39], s73 offen lds
  s_add_u32 m0, s78, s75
  s_mov_b64 exec, s[14:15]
  buffer_load_dwordx4 v28, s[36:39], s73 offen lds
  s_mov_b64 exec, -1
  s_add_u32 s3, s75, s77
  s_add_u32 m0, s3, 0
  s_add_u32 s4, s74, 0
  buffer_load_dwordx4 v8, s[40:43], s4 offen lds
  s_add_u32 m0, s3, 1024
  s_nop 0
  buffer_load_dwordx4 v9, s[40:43], s4 offen lds
  s_add_u32 m0, s3, 8192
  s_add_u32 s4, s74, 2048
  buffer_load_dwordx4 v8, s[40:43], s4 offen lds
  s_add_u32 m0, s3, 9216
  s_nop 0
  buffer_load_dwordx4 v9, s[40:43], s4 offen lds
  s_add_u32 m0, s3, 16384
  s_add_u32 s4, s74, 4096
  buffer_load_dwordx4 v8, s[40:43], s4 offen lds
  s_add_u32 m0, s3, 17408
  s_nop 0
  buffer_load_dwordx4 v9, s[40:43], s4 offen lds
  s_add_u32 s101, s101, 1
  s_sub_u32 s73, s101, s100
  s_lshl_b32 s73, s73, 3
  s_lshr_b32 s73, 0xf0f02, s73
  s_and_b32 s73, s73, 255
  s_add_u32 s73, s73, s101
  s_and_b32 s73, s73, 15
  s_mul_i32 s74, s73, 393216
  s_lshl_b32 s73, s73, 7
  s_add_u32 s75, s75, 43008
  s_cmp_eq_u32 s75, 129024
  s_cselect_b32 s75, 0, s75
  s_buffer_load_dword s84, s[48:51], s98 offset:0
  s_buffer_load_dword s84, s[48:51], s98 offset:64
  s_buffer_load_dword s84, s[48:51], s98 offset:128
  s_buffer_load_dword s84, s[48:51], s98 offset:192
  s_add_u32 s98, s98, 256
  s_waitcnt vmcnt(11)
  s_barrier
  s_sub_u32 s79, s79, 1
  s_cmp_lg_u32 s79, 0
  s_cbranch_scc1 L_attn0_ld1
  s_add_u32 s3, s75, s76
  s_add_u32 m0, s3, 0
  s_nop 0
  buffer_load_dwordx4 v4, s[36:39], s73 offen lds
  s_add_u32 m0, s3, 1024
  s_nop 0
  buffer_load_dwordx4 v5, s[36:39], s73 offen lds
  s_add_u32 m0, s3, 2048
  s_nop 0
  buffer_load_dwordx4 v6, s[36:39], s73 offen lds
  s_add_u32 m0, s3, 3072
  s_nop 0
  buffer_load_dwordx4 v7, s[36:39], s73 offen lds
  s_add_u32 m0, s78, s75
  s_mov_b64 exec, s[14:15]
  buffer_load_dwordx4 v28, s[36:39], s73 offen lds
  s_mov_b64 exec, -1
  s_add_u32 s3, s75, s77
  s_add_u32 m0, s3, 0
  s_add_u32 s4, s74, 0
  buffer_load_dwordx4 v8, s[40:43], s4 offen lds
  s_add_u32 m0, s3, 1024
  s_nop 0
  buffer_load_dwordx4 v9, s[40:43], s4 offen lds
  s_add_u32 m0, s3, 8192
  s_add_u32 s4, s74, 2048
  buffer_load_dwordx4 v8, s[40:43], s4 offen lds
  s_add_u32 m0, s3, 9216
  s_nop 0
  buffer_load_dwordx4 v9, s[40:43], s4 offen lds
  s_add_u32 m0, s3, 16384
  s_add_u32 s4, s74, 4096
  buffer_load_dwordx4 v8, s[40:43], s4 offen lds
  s_add_u32 m0, s3, 17408
  s_nop 0
  buffer_load_dwordx4 v9, s[40:43], s4 offen lds
  s_add_u32 s101, s101, 1
  s_sub_u32 s73, s101, s100
  s_lshl_b32 s73, s73, 3
  s_lshr_b32 s73, 0xf0f02, s73
  s_and_b32 s73, s73, 255
  s_add_u32 s73, s73, s101
  s_and_b32 s73, s73, 15
  s_mul_i32 s74, s73, 393216
  s_lshl_b32 s73, s73, 7
  s_add_u32 s75, s75, 43008
  s_cmp_eq_u32 s75, 129024
  s_cselect_b32 s75, 0, s75
  s_buffer_load_dword s84, s[48:51], s98 offset:0
  s_buffer_load_dword s84, s[48:51], s98 offset:64
  s_buffer_load_dword s84, s[48:51], s98 offset:128
  s_buffer_load_dword s84, s[48:51], s98 offset:192
  s_add_u32 s98, s98, 256
  s_mov_b32 s64, s24
  s_and_b32 s65, s25, 0xffff
  s_mov_b32 s66, 7340032
  s_mov_b32 s67, 0x00020000
  s_min_u32 s3, s2, 223
  s_mul_i32 s4, s3, 4682
  s_lshr_b32 s4, s4, 16
  s_mul_i32 s5, s4, 14
  s_sub_u32 s3, s3, s5
  s_lshl_b32 s3, s3, 2
  s_and_b32 s5, s70, 3
  s_add_u32 s3, s3, s5
  s_mul_i32 s5, s4, 458752
  s_lshl_b32 s8, s3, 7
  s_add_u32 s5, s5, s8
  s_lshl_b32 s9, s4, 14
  s_lshl_b32 s8, s3, 8
  s_add_u32 s94, s9, s8
  v_lshrrev_b32 v2, 3, v1
  v_mul_u32_u24 v2, 7168, v2
  v_and_b32 v3, 7, v1
  v_lshl_add_u32 v2, v3, 4, v2
  buffer_load_dwordx4 v[64:67], v2, s[64:67], s5 offen
  s_add_u32 s5, s5, 57344
  buffer_load_dwordx4 v[68:71], v2, s[64:67], s5 offen
  s_add_u32 s5, s5, 57344
  buffer_load_dwordx4 v[72:75], v2, s[64:67], s5 offen
  s_add_u32 s5, s5, 57344
  buffer_load_dwordx4 v[76:79], v2, s[64:67], s5 offen
  s_add_u32 s5, s5, 57344
  buffer_load_dwordx4 v[80:83], v2, s[64:67], s5 offen
  s_add_u32 s5, s5, 57344
  buffer_load_dwordx4 v[84:87], v2, s[64:67], s5 offen
  s_add_u32 s5, s5, 57344
  buffer_load_dwordx4 v[88:91], v2, s[64:67], s5 offen
  s_add_u32 s5, s5, 57344
  buffer_load_dwordx4 v[92:95], v2, s[64:67], s5 offen
  s_mov_b32 s60, s20
  s_and_b32 s61, s21, 0xffff
  s_mov_b32 s62, 2097152
  s_mov_b32 s63, 0x00020000
  s_and_b32 s3, s70, 3
  s_mul_i32 s3, s3, 8
  s_mul_i32 s4, s99, 32
  s_add_u32 s3, s3, s4
  v_lshrrev_b32 v2, 3, v1
  v_add_u32 v2, s3, v2
  v_mul_u32_u24 v2, 2048, v2
  v_and_b32 v3, 7, v1
  v_lshl_add_u32 v2, v3, 7, v2
  s_and_b32 s3, s2, 7
  s_lshr_b32 s3, s3, 2
  s_mul_i32 s3, s3, 1024
  buffer_load_dword v96, v2, s[60:63], s3 offen
  s_waitcnt vmcnt(20)
  s_barrier
  s_waitcnt vmcnt(9)
  s_barrier
  s_barrier
  s_barrier
  s_barrier
  s_branch L_attn_ldend
L_attn_ld1:
  s_add_u32 s56, s22, 24379392
  s_addc_u32 s57, s23, 0
  s_and_b32 s57, s57, 0xffff
  s_mov_b32 s58, 262144
  s_mov_b32 s59, 0x00020000
  s_mov_b32 s88, s73
  s_add_u32 m0, s77, 0
  s_add_u32 s4, s74, 0
  buffer_load_dwordx4 v8, s[40:43], s4 offen lds
  s_add_u32 m0, s77, 1024
  s_nop 0
  buffer_load_dwordx4 v9, s[40:43], s4 offen lds
  s_add_u32 m0, s77, 8192
  s_add_u32 s4, s74, 2048
  buffer_load_dwordx4 v8, s[40:43], s4 offen lds
  s_add_u32 m0, s77, 9216
  s_nop 0
  buffer_load_dwordx4 v9, s[40:43], s4 offen lds
  s_add_u32 m0, s77, 16384
  s_add_u32 s4, s74, 4096
  buffer_load_dwordx4 v8, s[40:43], s4 offen lds
  s_add_u32 m0, s77, 17408
  s_nop 0
  buffer_load_dwordx4 v9, s[40:43], s4 offen lds
  s_add_u32 s101, s101, 1
  s_sub_u32 s73, s101, s100
  s_lshl_b32 s73, s73, 3
  s_lshr_b32 s73, 0xf0f02, s73
  s_and_b32 s73, s73, 255
  s_add_u32 s73, s73, s101
  s_and_b32 s73, s73, 15
  s_mul_i32 s74, s73, 393216
  s_lshl_b32 s73, s73, 7
  s_mov_b32 s89, s73
  s_add_u32 m0, s77, 43008
  s_add_u32 s4, s74, 0
  buffer_load_dwordx4 v8, s[40:43], s4 offen lds
  s_add_u32 m0, s77, 44032
  s_nop 0
  buffer_load_dwordx4 v9, s[40:43], s4 offen lds
  s_add_u32 m0, s77, 51200
  s_add_u32 s4, s74, 2048
  buffer_load_dwordx4 v8, s[40:43], s4 offen lds
  s_add_u32 m0, s77, 52224
  s_nop 0
  buffer_load_dwordx4 v9, s[40:43], s4 offen lds
  s_add_u32 m0, s77, 59392
  s_add_u32 s4, s74, 4096
  buffer_load_dwordx4 v8, s[40:43], s4 offen lds
  s_add_u32 m0, s77, 60416
  s_nop 0
  buffer_load_dwordx4 v9, s[40:43], s4 offen lds
  s_add_u32 s101, s101, 1
  s_sub_u32 s73, s101, s100
  s_lshl_b32 s73, s73, 3
  s_lshr_b32 s73, 0xf0f02, s73
  s_and_b32 s73, s73, 255
  s_add_u32 s73, s73, s101
  s_and_b32 s73, s73, 15
  s_mul_i32 s74, s73, 393216
  s_lshl_b32 s73, s73, 7
  s_mov_b32 s75, 86016
  s_add_u32 s44, s22, 24903680
  s_addc_u32 s45, s23, 0
  s_and_b32 s45, s45, 0xffff
  s_mov_b32 s46, 32768
  s_mov_b32 s47, 0x00020000
  s_lshl_b32 s3, s97, 12
  s_lshl_b32 s4, s68, 8
  s_add_u32 s3, s3, s4
  s_sub_u32 s3, s3, 4096
  v_and_b32 v2, 15, v1
  v_lshlrev_b32 v2, 2, v2
  s_min_u32 s4, s4, 256
  s_sub_u32 s3, s3, s4
  v_lshlrev_b32 v3, 4, v1
  v_and_b32 v3, s4, v3
  v_add_u32 v2, v2, v3
  v_mov_b32 v3, 1
  s_mov_b32 s79, 0x100000
  s_cmp_lg_u32 s70, 4
  s_barrier
  s_cbranch_scc1 L_attn_dep
  s_mov_b64 exec, 1
  buffer_store_dword v3, off, s[44:47], s87 sc1
  s_mov_b64 exec, -1
L_attn_poll:
  buffer_load_dword v3, v2, s[44:47], s3 offen sc1
  s_sub_u32 s79, s79, 1
  s_cbranch_scc1 L_attn_dep
  s_waitcnt vmcnt(0)
  v_cmp_ne_u32 vcc, 1, v3
  s_cbranch_vccnz L_attn_poll
L_attn_dep:
  s_barrier
  s_add_u32 m0, s76, 0
  s_nop 0
  buffer_load_dwordx4 v4, s[36:39], s88 offen lds
  s_add_u32 m0, s76, 1024
  s_nop 0
  buffer_load_dwordx4 v5, s[36:39], s88 offen lds
  s_add_u32 m0, s76, 2048
  s_nop 0
  buffer_load_dwordx4 v6, s[36:39], s88 offen lds
  s_add_u32 m0, s76, 3072
  s_nop 0
  buffer_load_dwordx4 v7, s[36:39], s88 offen lds
  s_add_u32 m0, s78, 0
  s_mov_b64 exec, s[14:15]
  buffer_load_dwordx4 v28, s[36:39], s88 offen lds
  s_mov_b64 exec, -1
  s_add_u32 m0, s76, 43008
  s_nop 0
  buffer_load_dwordx4 v4, s[36:39], s89 offen lds
  s_add_u32 m0, s76, 44032
  s_nop 0
  buffer_load_dwordx4 v5, s[36:39], s89 offen lds
  s_add_u32 m0, s76, 45056
  s_nop 0
  buffer_load_dwordx4 v6, s[36:39], s89 offen lds
  s_add_u32 m0, s76, 46080
  s_nop 0
  buffer_load_dwordx4 v7, s[36:39], s89 offen lds
  s_add_u32 m0, s78, 43008
  s_mov_b64 exec, s[14:15]
  buffer_load_dwordx4 v28, s[36:39], s89 offen lds
  s_mov_b64 exec, -1
  s_waitcnt vmcnt(5)
  s_barrier
  s_mov_b32 s79, 13
L_attn1_ld1:
  s_add_u32 s3, s75, s76
  s_add_u32 m0, s3, 0
  s_nop 0
  buffer_load_dwordx4 v4, s[36:39], s73 offen lds
  s_add_u32 m0, s3, 1024
  s_nop 0
  buffer_load_dwordx4 v5, s[36:39], s73 offen lds
  s_add_u32 m0, s3, 2048
  s_nop 0
  buffer_load_dwordx4 v6, s[36:39], s73 offen lds
  s_add_u32 m0, s3, 3072
  s_nop 0
  buffer_load_dwordx4 v7, s[36:39], s73 offen lds
  s_add_u32 m0, s78, s75
  s_mov_b64 exec, s[14:15]
  buffer_load_dwordx4 v28, s[36:39], s73 offen lds
  s_mov_b64 exec, -1
  s_add_u32 s3, s75, s77
  s_add_u32 m0, s3, 0
  s_add_u32 s4, s74, 0
  buffer_load_dwordx4 v8, s[40:43], s4 offen lds
  s_add_u32 m0, s3, 1024
  s_nop 0
  buffer_load_dwordx4 v9, s[40:43], s4 offen lds
  s_add_u32 m0, s3, 8192
  s_add_u32 s4, s74, 2048
  buffer_load_dwordx4 v8, s[40:43], s4 offen lds
  s_add_u32 m0, s3, 9216
  s_nop 0
  buffer_load_dwordx4 v9, s[40:43], s4 offen lds
  s_add_u32 m0, s3, 16384
  s_add_u32 s4, s74, 4096
  buffer_load_dwordx4 v8, s[40:43], s4 offen lds
  s_add_u32 m0, s3, 17408
  s_nop 0
  buffer_load_dwordx4 v9, s[40:43], s4 offen lds
  s_add_u32 s101, s101, 1
  s_sub_u32 s73, s101, s100
  s_lshl_b32 s73, s73, 3
  s_lshr_b32 s73, 0xf0f02, s73
  s_and_b32 s73, s73, 255
  s_add_u32 s73, s73, s101
  s_and_b32 s73, s73, 15
  s_mul_i32 s74, s73, 393216
  s_lshl_b32 s73, s73, 7
  s_add_u32 s75, s75, 43008
  s_cmp_eq_u32 s75, 129024
  s_cselect_b32 s75, 0, s75
  s_waitcnt vmcnt(11)
  s_barrier
  s_sub_u32 s79, s79, 1
  s_cmp_lg_u32 s79, 0
  s_cbranch_scc1 L_attn1_ld1
  s_add_u32 s3, s75, s76
  s_add_u32 m0, s3, 0
  s_nop 0
  buffer_load_dwordx4 v4, s[36:39], s73 offen lds
  s_add_u32 m0, s3, 1024
  s_nop 0
  buffer_load_dwordx4 v5, s[36:39], s73 offen lds
  s_add_u32 m0, s3, 2048
  s_nop 0
  buffer_load_dwordx4 v6, s[36:39], s73 offen lds
  s_add_u32 m0, s3, 3072
  s_nop 0
  buffer_load_dwordx4 v7, s[36:39], s73 offen lds
  s_add_u32 m0, s78, s75
  s_mov_b64 exec, s[14:15]
  buffer_load_dwordx4 v28, s[36:39], s73 offen lds
  s_mov_b64 exec, -1
  s_add_u32 s3, s75, s77
  s_add_u32 m0, s3, 0
  s_add_u32 s4, s74, 0
  buffer_load_dwordx4 v8, s[40:43], s4 offen lds
  s_add_u32 m0, s3, 1024
  s_nop 0
  buffer_load_dwordx4 v9, s[40:43], s4 offen lds
  s_add_u32 m0, s3, 8192
  s_add_u32 s4, s74, 2048
  buffer_load_dwordx4 v8, s[40:43], s4 offen lds
  s_add_u32 m0, s3, 9216
  s_nop 0
  buffer_load_dwordx4 v9, s[40:43], s4 offen lds
  s_add_u32 m0, s3, 16384
  s_add_u32 s4, s74, 4096
  buffer_load_dwordx4 v8, s[40:43], s4 offen lds
  s_add_u32 m0, s3, 17408
  s_nop 0
  buffer_load_dwordx4 v9, s[40:43], s4 offen lds
  s_add_u32 s101, s101, 1
  s_sub_u32 s73, s101, s100
  s_lshl_b32 s73, s73, 3
  s_lshr_b32 s73, 0xf0f02, s73
  s_and_b32 s73, s73, 255
  s_add_u32 s73, s73, s101
  s_and_b32 s73, s73, 15
  s_mul_i32 s74, s73, 393216
  s_lshl_b32 s73, s73, 7
  s_add_u32 s75, s75, 43008
  s_cmp_eq_u32 s75, 129024
  s_cselect_b32 s75, 0, s75
  s_and_b32 s3, s70, 3
  s_lshl_b32 s4, s68, 7
  s_lshl_b32 s5, s3, 6
  s_add_u32 s5, s5, s4
  v_add_u32 v2, s5, v1
  s_sub_u32 s4, s4, 16
  v_and_b32 v3, 15, v1
  v_add_u32 v3, s4, v3
  v_max_i32 v3, 0, v3
  s_cmp_ge_u32 s3, 2
  s_cselect_b64 vcc, -1, 0
  v_cndmask_b32 v2, v2, v3, vcc
  v_lshlrev_b32 v2, 3, v2
  s_mov_b32 s3, 0
  buffer_load_dwordx2 v[32:33], v2, s[56:59], s3 offen
  s_add_u32 s3, s3, 16384
  buffer_load_dwordx2 v[34:35], v2, s[56:59], s3 offen
  s_add_u32 s3, s3, 16384
  buffer_load_dwordx2 v[36:37], v2, s[56:59], s3 offen
  s_add_u32 s3, s3, 16384
  buffer_load_dwordx2 v[38:39], v2, s[56:59], s3 offen
  s_add_u32 s3, s3, 16384
  buffer_load_dwordx2 v[40:41], v2, s[56:59], s3 offen
  s_add_u32 s3, s3, 16384
  buffer_load_dwordx2 v[42:43], v2, s[56:59], s3 offen
  s_add_u32 s3, s3, 16384
  buffer_load_dwordx2 v[44:45], v2, s[56:59], s3 offen
  s_add_u32 s3, s3, 16384
  buffer_load_dwordx2 v[46:47], v2, s[56:59], s3 offen
  s_add_u32 s3, s3, 16384
  buffer_load_dwordx2 v[48:49], v2, s[56:59], s3 offen
  s_add_u32 s3, s3, 16384
  buffer_load_dwordx2 v[50:51], v2, s[56:59], s3 offen
  s_add_u32 s3, s3, 16384
  buffer_load_dwordx2 v[52:53], v2, s[56:59], s3 offen
  s_add_u32 s3, s3, 16384
  buffer_load_dwordx2 v[54:55], v2, s[56:59], s3 offen
  s_add_u32 s3, s3, 16384
  buffer_load_dwordx2 v[56:57], v2, s[56:59], s3 offen
  s_add_u32 s3, s3, 16384
  buffer_load_dwordx2 v[58:59], v2, s[56:59], s3 offen
  s_add_u32 s3, s3, 16384
  buffer_load_dwordx2 v[60:61], v2, s[56:59], s3 offen
  s_add_u32 s3, s3, 16384
  buffer_load_dwordx2 v[62:63], v2, s[56:59], s3 offen
  s_mov_b32 s60, s20
  s_and_b32 s61, s21, 0xffff
  s_mov_b32 s62, 2097152
  s_mov_b32 s63, 0x00020000
  s_and_b32 s3, s70, 3
  s_mul_i32 s3, s3, 8
  s_mul_i32 s4, s99, 32
  s_add_u32 s3, s3, s4
  v_lshrrev_b32 v2, 3, v1
  v_add_u32 v2, s3, v2
  v_mul_u32_u24 v2, 2048, v2
  v_and_b32 v3, 7, v1
  v_lshl_add_u32 v2, v3, 7, v2
  s_and_b32 s3, s2, 7
  s_lshr_b32 s3, s3, 2
  s_mul_i32 s3, s3, 1024
  buffer_load_dword v96, v2, s[60:63], s3 offen
  s_waitcnt vmcnt(28)
  s_barrier
  s_waitcnt vmcnt(17)
  s_barrier
  s_waitcnt vmcnt(1)
  v_add_f32 v32, v32, v34
  v_add_f32 v33, v33, v35
  v_add_f32 v48, v48, v50
  v_add_f32 v49, v49, v51
  v_add_f32 v32, v32, v36
  v_add_f32 v33, v33, v37
  v_add_f32 v48, v48, v52
  v_add_f32 v49, v49, v53
  v_add_f32 v32, v32, v38
  v_add_f32 v33, v33, v39
  v_add_f32 v48, v48, v54
  v_add_f32 v49, v49, v55
  v_add_f32 v32, v32, v40
  v_add_f32 v33, v33, v41
  v_add_f32 v48, v48, v56
  v_add_f32 v49, v49, v57
  v_add_f32 v32, v32, v42
  v_add_f32 v33, v33, v43
  v_add_f32 v48, v48, v58
  v_add_f32 v49, v49, v59
  v_add_f32 v32, v32, v44
  v_add_f32 v33, v33, v45
  v_add_f32 v48, v48, v60
  v_add_f32 v49, v49, v61
  v_add_f32 v32, v32, v46
  v_add_f32 v33, v33, v47
  v_add_f32 v48, v48, v62
  v_add_f32 v49, v49, v63
  v_add_f32 v32, v32, v48
  v_add_f32 v33, v33, v49
  v_mul_f32 v32, 0x3a800000, v32
  v_mul_f32 v33, 0x3a800000, v33
  v_fma_f32 v33, -v32, v32, v33
  v_max_f32 v33, 0, v33
  v_add_f32 v33, 0x3727c5ac, v33
  v_rsq_f32 v33, v33
  s_nop 0
  s_and_b32 s3, s70, 3
  s_lshl_b32 s5, s3, 6
  s_add_u32 s5, s5, 16
  v_add_u32 v2, s5, v1
  v_and_b32 v3, 15, v1
  s_cmp_ge_u32 s3, 2
  s_cselect_b64 vcc, -1, 0
  v_cndmask_b32 v2, v2, v3, vcc
  v_lshlrev_b32 v2, 2, v2
  v_add_u32 v2, 129024, v2
  ds_write2_b32 v2, v32, v33 offset0:0 offset1:160
  s_waitcnt lgkmcnt(0)
  s_barrier
  s_barrier
L_attn_ldend:
  s_lshl_b32 s87, s97, 12
  s_lshl_b32 s4, s68, 8
  s_add_u32 s87, s87, s4
  s_lshl_b32 s4, s69, 2
  s_add_u32 s87, s87, s4
  s_add_u32 s97, s97, 1
  s_branch L_wo_body
L_attn_end:
  s_endpgm
L_attn_compute:
  s_and_b32 s71, s70, 1
  s_lshr_b32 s72, s70, 1
  v_and_b32 v3, 31, v1
  v_lshlrev_b32 v3, 2, v3
  v_add_u32 v3, 40960, v3
  v_mov_b32 v236, 0x3f803f80
  v_mov_b32 v237, 0x3f803f80
  v_mov_b32 v238, 0x3f803f80
  v_mov_b32 v239, 0x3f803f80
  ds_write_b32 v3, v236
  ds_write_b32 v3, v236 offset:43008
  v_add_u32 v3, 86016, v3
  ds_write_b32 v3, v236
  v_and_b32 v3, 15, v1
  v_lshrrev_b32 v2, 4, v1
  v_lshrrev_b32 v33, 1, v3
  s_lshl_b32 s8, s71, 13
  v_xor_b32 v4, v2, v33
  v_lshlrev_b32 v4, 4, v4
  v_lshl_add_u32 v4, v3, 7, v4
  v_add_u32 v8, 40960, v4
  v_add_u32 v4, s8, v4
  v_add_u32 v5, 4, v2
  v_xor_b32 v5, v5, v33
  v_lshlrev_b32 v5, 4, v5
  v_lshl_add_u32 v5, v3, 7, v5
  v_add_u32 v9, 40960, v5
  v_add_u32 v5, s8, v5
  v_bfe_u32 v34, v1, 2, 2
  v_lshl_add_u32 v34, v2, 3, v34
  v_lshlrev_b32 v34, 7, v34
  v_and_b32 v33, 3, v1
  v_lshl_add_u32 v34, v33, 3, v34
  v_bfe_u32 v33, v1, 3, 2
  v_lshl_add_u32 v34, v33, 5, v34
  v_and_b32 v35, 1, v2
  v_xor_b32 v35, s71, v35
  s_lshl_b32 s8, s70, 5
  v_xor_b32 v34, s8, v34
  v_add_u32 v6, 16384, v34
  v_xor_b32 v7, 32, v6
  s_lshl_b32 s8, s68, 7
  s_lshl_b32 s9, s71, 6
  s_add_u32 s8, s8, s9
  s_add_u32 s10, s8, s69
  s_lshl_b32 s10, s10, 11
  s_lshl_b32 s11, s72, 10
  s_add_u32 s10, s10, s11
  v_lshl_add_u32 v33, v3, 4, s10
  v_lshl_add_u32 v33, v35, 9, v33
  v_lshrrev_b32 v34, 1, v2
  v_lshl_add_u32 v31, v34, 8, v33
  s_mul_i32 s10, s72, 14336
  s_add_u32 s10, s10, 1024
  s_lshl_b32 s11, s71, 10
  s_add_u32 s4, s10, s11
  s_sub_u32 s5, s10, s11
  s_mul_i32 s6, s71, 6144
  v_lshl_add_u32 v16, v1, 4, s4
  v_add_u32 v17, s6, v16
  v_lshl_add_u32 v18, v1, 4, s5
  v_add_u32 v18, s6, v18
  v_lshl_add_u32 v19, v2, 8, s4
  v_lshl_add_u32 v20, v2, 8, s5
  v_lshl_add_u32 v21, v3, 4, s4
  v_lshl_add_u32 v22, v3, 4, s5
  s_lshl_b32 s10, s71, 8
  s_add_u32 s10, s10, 129024
  v_lshl_add_u32 v23, v3, 2, s10
  v_lshl_add_u32 v24, v2, 4, s10
  v_and_b32 v33, 1, v3
  v_cmp_eq_u32 s[48:49], 1, v33
  v_lshl_add_u32 v34, v2, 2, v33
  v_add_u32 v35, 2, v34
  v_cmp_gt_u32 s[50:51], v34, v3
  v_cmp_gt_u32 s[52:53], v35, v3
  v_mov_b32 v36, 0xffff
  v_mov_b32 v37, 0xffff0000
  v_cndmask_b32 v36, v36, v37, s[48:49]
  s_add_u32 s10, s10, 704
  v_lshl_add_u32 v34, v34, 2, s10
  v_lshl_add_u32 v35, v35, 2, s10
  v_subrev_u32 v38, 64, v34
  v_subrev_u32 v39, 64, v35
  v_cndmask_b32 v25, v34, v38, s[50:51]
  v_cndmask_b32 v26, v35, v39, s[52:53]
  v_cndmask_b32 v27, 0, v36, s[50:51]
  v_cndmask_b32 v29, 0, v36, s[52:53]
  v_xor_b32 v28, v27, v36
  v_xor_b32 v30, v29, v36
  s_cmp_eq_u32 s8, 0
  s_cselect_b64 s[54:55], s[50:51], 0
  s_cselect_b64 s[14:15], s[52:53], 0
  v_mov_b32 v120, 0
  v_mov_b32 v121, 0
  v_mov_b32 v122, 0
  v_mov_b32 v123, 0
  v_mov_b32 v124, 0
  v_mov_b32 v125, 0
  v_mov_b32 v126, 0
  v_mov_b32 v127, 0
  v_mov_b32 v128, 0
  v_mov_b32 v129, 0
  v_mov_b32 v130, 0
  v_mov_b32 v131, 0
  v_mov_b32 v132, 0
  v_mov_b32 v133, 0
  v_mov_b32 v134, 0
  v_mov_b32 v135, 0
  v_mov_b32 v136, 0
  v_mov_b32 v137, 0
  v_mov_b32 v138, 0
  v_mov_b32 v139, 0
  v_mov_b32 v140, 0
  v_mov_b32 v141, 0
  v_mov_b32 v142, 0
  v_mov_b32 v143, 0
  v_mov_b32 v144, 0
  v_mov_b32 v145, 0
  v_mov_b32 v146, 0
  v_mov_b32 v147, 0
  v_mov_b32 v148, 0
  v_mov_b32 v149, 0
  v_mov_b32 v150, 0
  v_mov_b32 v151, 0
  v_mov_b32 v152, 0
  v_mov_b32 v153, 0
  v_mov_b32 v154, 0
  v_mov_b32 v155, 0
  v_mov_b32 v156, 0
  v_mov_b32 v157, 0
  v_mov_b32 v158, 0
  v_mov_b32 v159, 0
  v_mov_b32 v160, 0
  v_mov_b32 v161, 0
  v_mov_b32 v162, 0
  v_mov_b32 v163, 0
  v_mov_b32 v164, 0
  v_mov_b32 v165, 0
  v_mov_b32 v166, 0
  v_mov_b32 v167, 0
  v_mov_b32 v168, 0
  v_mov_b32 v169, 0
  v_mov_b32 v170, 0
  v_mov_b32 v171, 0
  v_mov_b32 v172, 0
  v_mov_b32 v173, 0
  v_mov_b32 v174, 0
  v_mov_b32 v175, 0
  v_mov_b32 v176, 0
  v_mov_b32 v177, 0
  v_mov_b32 v178, 0
  v_mov_b32 v179, 0
  v_mov_b32 v180, 0
  v_mov_b32 v181, 0
  v_mov_b32 v182, 0
  v_mov_b32 v183, 0
  v_mov_b32 v184, 0
  v_mov_b32 v185, 0
  v_mov_b32 v186, 0
  v_mov_b32 v187, 0
  v_mov_b32 v188, 0
  v_mov_b32 v189, 0
  v_mov_b32 v190, 0
  v_mov_b32 v191, 0
  v_mov_b32 v192, 0
  v_mov_b32 v193, 0
  v_mov_b32 v194, 0
  v_mov_b32 v195, 0
  v_mov_b32 v196, 0
  v_mov_b32 v197, 0
  v_mov_b32 v198, 0
  v_mov_b32 v199, 0
  v_mov_b32 v200, 0
  v_mov_b32 v201, 0
  v_mov_b32 v202, 0
  v_mov_b32 v203, 0
  v_mov_b32 v204, 0
  v_mov_b32 v205, 0
  v_mov_b32 v206, 0
  v_mov_b32 v207, 0
  v_mov_b32 v208, 0
  v_mov_b32 v209, 0
  v_mov_b32 v210, 0
  v_mov_b32 v211, 0
  v_mov_b32 v212, 0
  v_mov_b32 v213, 0
  v_mov_b32 v214, 0
  v_mov_b32 v215, 0
  v_mov_b32 v216, 0
  v_mov_b32 v217, 0
  v_mov_b32 v218, 0
  v_mov_b32 v219, 0
  v_mov_b32 v220, 0
  v_mov_b32 v221, 0
  v_mov_b32 v222, 0
  v_mov_b32 v223, 0
  v_mov_b32 v224, 0
  v_mov_b32 v225, 0
  v_mov_b32 v226, 0
  v_mov_b32 v227, 0
  v_mov_b32 v228, 0
  v_mov_b32 v229, 0
  v_mov_b32 v230, 0
  v_mov_b32 v231, 0
  v_mov_b32 v232, 0
  v_mov_b32 v233, 0
  v_mov_b32 v234, 0
  v_mov_b32 v235, 0
  s_waitcnt lgkmcnt(0)
  s_mov_b32 s44, s34
  s_and_b32 s45, s35, 0xffff
  s_mov_b32 s46, 4194304
  s_mov_b32 s47, 0x00020000
  s_load_dwordx2 s[64:65], s[0:1], 72
  s_or_b32 s3, s96, s70
  s_cbranch_scc1 L_clr_skip0
  s_add_u32 s60, s22, 24903680
  s_addc_u32 s61, s23, 0
  s_and_b32 s61, s61, 0xffff
  s_mov_b32 s62, 262144
  s_mov_b32 s63, 0x00020000
  s_lshl_b32 s3, s2, 10
  v_lshlrev_b32 v2, 4, v1
  buffer_store_dwordx4 v[128:131], v2, s[60:63], s3 offen sc1
L_clr_skip0:
  s_cmp_lg_u32 s96, 0
  s_cbranch_scc1 L_pfc1_skip
  s_getpc_b64 s[4:5]
L_pfc1:
  s_lshl_b32 s3, s99, 2
  s_add_u32 s3, s3, s70
  s_mul_i32 s3, s3, 256
  s_min_u32 s3, s3, L_w2_c1-L_attn_c0-256
  s_add_i32 s3, s3, L_attn_c0-L_pfc1
  s_ashr_i32 s6, s3, 31
  s_add_u32 s4, s4, s3
  s_addc_u32 s5, s5, s6
  s_load_dword s36, s[4:5], 0
  s_load_dword s37, s[4:5], 64
  s_load_dword s38, s[4:5], 128
  s_load_dword s39, s[4:5], 192
L_pfc1_skip:
  s_mov_b32 s75, 0
  v_add_u32_e64 v10, s75, v4
  v_add_u32_e64 v11, s75, v5
  v_add_u32_e64 v12, s75, v6
  v_add_u32_e64 v13, s75, v7
  v_add_u32_e64 v14, s75, v8
  v_add_u32_e64 v15, s75, v9
  s_add_u32 s75, s75, 43008
  s_cmp_eq_u32 s75, 129024
  s_cselect_b32 s75, 0, s75
  s_mov_b32 s79, 16
  s_cmp_eq_u32 s96, 0
  s_cbranch_scc1 L_attn_nog
  s_barrier
L_attn_nog:
  s_barrier
  ds_read_b128 v[32:35], v10 offset:0
  ds_read_b128 v[36:39], v10 offset:2048
  ds_read_b128 v[40:43], v10 offset:4096
  ds_read_b128 v[44:47], v10 offset:6144
  ds_read_b128 v[48:51], v14
  ds_read_b64_tr_b16 v[52:53], v12 offset:0
  ds_read_b64_tr_b16 v[54:55], v12 offset:512
  ds_read_b64_tr_b16 v[56:57], v13 offset:0
  ds_read_b64_tr_b16 v[58:59], v13 offset:512
  ds_read_b64_tr_b16 v[60:61], v12 offset:8192
  ds_read_b64_tr_b16 v[62:63], v12 offset:8704
  ds_read_b64_tr_b16 v[64:65], v13 offset:8192
  ds_read_b64_tr_b16 v[66:67], v13 offset:8704
  ds_read_b64_tr_b16 v[68:69], v12 offset:16384
  ds_read_b64_tr_b16 v[70:71], v12 offset:16896
  ds_read_b64_tr_b16 v[72:73], v13 offset:16384
  ds_read_b64_tr_b16 v[74:75], v13 offset:16896
  s_waitcnt lgkmcnt(0)
  s_cmp_lg_u32 s96, 0
  s_cbranch_scc1 L_attn_loop
  v_mov_b32 v240, 0
  v_mov_b32 v241, 0
  v_mov_b32 v242, 0
  v_mov_b32 v243, 0
  v_mov_b32 v244, 0
  v_mov_b32 v245, 0
  v_mov_b32 v246, 0
  v_mov_b32 v247, 0
  v_mov_b32 v248, 0
  v_mov_b32 v249, 0
  v_mov_b32 v250, 0
  v_mov_b32 v251, 0
  v_mov_b32 v252, 0
  v_mov_b32 v253, 0
  v_mov_b32 v254, 0
  v_mov_b32 v255, 0
  s_cmp_lg_u32 s72, 0
  s_cbranch_scc1 L_attn_loopb
  s_or_b32 s3, s96, s70
  s_cbranch_scc1 L_clr_skip1
  v_mov_b32 v3, 1
  s_and_b32 s65, s65, 0xffff
  s_mov_b32 s66, 256
  s_mov_b32 s67, 0x00020000
  s_mov_b64 exec, 1
  s_waitcnt vmcnt(0)
  buffer_store_byte v3, off, s[64:67], s2 sc1
  s_mov_b64 exec, -1
L_clr_skip1:
.p2align 3
L_attn_loopa:
  v_mfma_f32_16x16x32_bf16 v[240:243], v[236:239], v[32:35], v[240:243]
  ds_read_b128 v[76:79], v11 offset:0
  v_mfma_f32_16x16x32_bf16 v[244:247], v[32:35], v[32:35], v[244:247]
  ds_read_b128 v[80:83], v11 offset:2048
  v_mfma_f32_16x16x32_bf16 v[248:251], v[236:239], v[36:39], v[248:251]
  ds_read_b128 v[84:87], v11 offset:4096
  v_mfma_f32_16x16x32_bf16 v[252:255], v[36:39], v[36:39], v[252:255]
  ds_read_b128 v[88:91], v11 offset:6144
  v_mfma_f32_16x16x32_bf16 v[120:123], v[236:239], v[48:51], v[120:123]
  ds_read_b128 v[92:95], v15
  v_mfma_f32_16x16x32_bf16 v[124:127], v[48:51], v[48:51], v[124:127]
  ds_read_b64_tr_b16 v[96:97], v12 offset:4096
  v_mfma_f32_16x16x32_bf16 v[128:131], v[52:55], v[32:35], v[128:131]
  ds_read_b64_tr_b16 v[98:99], v12 offset:4608
  v_mfma_f32_16x16x32_bf16 v[132:135], v[52:55], v[36:39], v[132:135]
  ds_read_b64_tr_b16 v[100:101], v13 offset:4096
  v_mfma_f32_16x16x32_bf16 v[136:139], v[52:55], v[40:43], v[136:139]
  ds_read_b64_tr_b16 v[102:103], v13 offset:4608
  v_mfma_f32_16x16x32_bf16 v[140:143], v[52:55], v[44:47], v[140:143]
  ds_read_b64_tr_b16 v[104:105], v12 offset:12288
  v_mfma_f32_16x16x32_bf16 v[224:227], v[52:55], v[48:51], v[224:227]
  ds_read_b64_tr_b16 v[106:107], v12 offset:12800
  v_mfma_f32_16x16x32_bf16 v[144:147], v[56:59], v[32:35], v[144:147]
  ds_read_b64_tr_b16 v[108:109], v13 offset:12288
  v_mfma_f32_16x16x32_bf16 v[148:151], v[56:59], v[36:39], v[148:151]
  ds_read_b64_tr_b16 v[110:111], v13 offset:12800
  v_mfma_f32_16x16x32_bf16 v[152:155], v[56:59], v[40:43], v[152:155]
  ds_read_b64_tr_b16 v[112:113], v12 offset:20480
  v_mfma_f32_16x16x32_bf16 v[156:159], v[56:59], v[44:47], v[156:159]
  ds_read_b64_tr_b16 v[114:115], v12 offset:20992
  v_mfma_f32_16x16x32_bf16 v[160:163], v[60:63], v[32:35], v[160:163]
  ds_read_b64_tr_b16 v[116:117], v13 offset:20480
  v_mfma_f32_16x16x32_bf16 v[164:167], v[60:63], v[36:39], v[164:167]
  ds_read_b64_tr_b16 v[118:119], v13 offset:20992
  v_mfma_f32_16x16x32_bf16 v[168:171], v[60:63], v[40:43], v[168:171]
  v_add_u32_e64 v10, s75, v4
  v_mfma_f32_16x16x32_bf16 v[172:175], v[60:63], v[44:47], v[172:175]
  v_add_u32_e64 v11, s75, v5
  v_mfma_f32_16x16x32_bf16 v[228:231], v[60:63], v[48:51], v[228:231]
  v_add_u32_e64 v12, s75, v6
  v_mfma_f32_16x16x32_bf16 v[176:179], v[64:67], v[32:35], v[176:179]
  v_add_u32_e64 v13, s75, v7
  v_mfma_f32_16x16x32_bf16 v[180:183], v[64:67], v[36:39], v[180:183]
  v_add_u32_e64 v14, s75, v8
  v_mfma_f32_16x16x32_bf16 v[184:187], v[64:67], v[40:43], v[184:187]
  v_add_u32_e64 v15, s75, v9
  v_mfma_f32_16x16x32_bf16 v[188:191], v[64:67], v[44:47], v[188:191]
  s_add_u32 s75, s75, 43008
  v_mfma_f32_16x16x32_bf16 v[192:195], v[32:35], v[68:71], v[192:195]
  s_cmp_eq_u32 s75, 129024
  v_mfma_f32_16x16x32_bf16 v[196:199], v[36:39], v[68:71], v[196:199]
  s_cselect_b32 s75, 0, s75
  s_sub_u32 s79, s79, 1
  v_mfma_f32_16x16x32_bf16 v[200:203], v[40:43], v[68:71], v[200:203]
  v_mfma_f32_16x16x32_bf16 v[204:207], v[44:47], v[68:71], v[204:207]
  v_mfma_f32_16x16x32_bf16 v[232:235], v[48:51], v[68:71], v[232:235]
  v_mfma_f32_16x16x32_bf16 v[208:211], v[32:35], v[72:75], v[208:211]
  v_mfma_f32_16x16x32_bf16 v[212:215], v[36:39], v[72:75], v[212:215]
  v_mfma_f32_16x16x32_bf16 v[216:219], v[40:43], v[72:75], v[216:219]
  v_mfma_f32_16x16x32_bf16 v[220:223], v[44:47], v[72:75], v[220:223]
  s_waitcnt lgkmcnt(0)
  s_barrier
  v_mfma_f32_16x16x32_bf16 v[240:243], v[236:239], v[76:79], v[240:243]
  ds_read_b128 v[32:35], v10 offset:0
  v_mfma_f32_16x16x32_bf16 v[244:247], v[76:79], v[76:79], v[244:247]
  ds_read_b128 v[36:39], v10 offset:2048
  v_mfma_f32_16x16x32_bf16 v[248:251], v[236:239], v[80:83], v[248:251]
  ds_read_b128 v[40:43], v10 offset:4096
  v_mfma_f32_16x16x32_bf16 v[252:255], v[80:83], v[80:83], v[252:255]
  ds_read_b128 v[44:47], v10 offset:6144
  v_mfma_f32_16x16x32_bf16 v[120:123], v[236:239], v[92:95], v[120:123]
  ds_read_b128 v[48:51], v14
  v_mfma_f32_16x16x32_bf16 v[124:127], v[92:95], v[92:95], v[124:127]
  ds_read_b64_tr_b16 v[52:53], v12 offset:0
  v_mfma_f32_16x16x32_bf16 v[128:131], v[96:99], v[76:79], v[128:131]
  ds_read_b64_tr_b16 v[54:55], v12 offset:512
  v_mfma_f32_16x16x32_bf16 v[132:135], v[96:99], v[80:83], v[132:135]
  ds_read_b64_tr_b16 v[56:57], v13 offset:0
  v_mfma_f32_16x16x32_bf16 v[136:139], v[96:99], v[84:87], v[136:139]
  ds_read_b64_tr_b16 v[58:59], v13 offset:512
  v_mfma_f32_16x16x32_bf16 v[140:143], v[96:99], v[88:91], v[140:143]
  ds_read_b64_tr_b16 v[60:61], v12 offset:8192
  v_mfma_f32_16x16x32_bf16 v[224:227], v[96:99], v[92:95], v[224:227]
  ds_read_b64_tr_b16 v[62:63], v12 offset:8704
  v_mfma_f32_16x16x32_bf16 v[144:147], v[100:103], v[76:79], v[144:147]
  ds_read_b64_tr_b16 v[64:65], v13 offset:8192
  v_mfma_f32_16x16x32_bf16 v[148:151], v[100:103], v[80:83], v[148:151]
  ds_read_b64_tr_b16 v[66:67], v13 offset:8704
  v_mfma_f32_16x16x32_bf16 v[152:155], v[100:103], v[84:87], v[152:155]
  ds_read_b64_tr_b16 v[68:69], v12 offset:16384
  v_mfma_f32_16x16x32_bf16 v[156:159], v[100:103], v[88:91], v[156:159]
  ds_read_b64_tr_b16 v[70:71], v12 offset:16896
  v_mfma_f32_16x16x32_bf16 v[160:163], v[104:107], v[76:79], v[160:163]
  ds_read_b64_tr_b16 v[72:73], v13 offset:16384
  v_mfma_f32_16x16x32_bf16 v[164:167], v[104:107], v[80:83], v[164:167]
  ds_read_b64_tr_b16 v[74:75], v13 offset:16896
  v_mfma_f32_16x16x32_bf16 v[168:171], v[104:107], v[84:87], v[168:171]
  s_cmp_lg_u32 s79, 0
  s_nop 0
  v_mfma_f32_16x16x32_bf16 v[172:175], v[104:107], v[88:91], v[172:175]
  v_mfma_f32_16x16x32_bf16 v[228:231], v[104:107], v[92:95], v[228:231]
  v_mfma_f32_16x16x32_bf16 v[176:179], v[108:111], v[76:79], v[176:179]
  v_mfma_f32_16x16x32_bf16 v[180:183], v[108:111], v[80:83], v[180:183]
  v_mfma_f32_16x16x32_bf16 v[184:187], v[108:111], v[84:87], v[184:187]
  v_mfma_f32_16x16x32_bf16 v[188:191], v[108:111], v[88:91], v[188:191]
  v_mfma_f32_16x16x32_bf16 v[192:195], v[76:79], v[112:115], v[192:195]
  v_mfma_f32_16x16x32_bf16 v[196:199], v[80:83], v[112:115], v[196:199]
  v_mfma_f32_16x16x32_bf16 v[200:203], v[84:87], v[112:115], v[200:203]
  v_mfma_f32_16x16x32_bf16 v[204:207], v[88:91], v[112:115], v[204:207]
  v_mfma_f32_16x16x32_bf16 v[232:235], v[92:95], v[112:115], v[232:235]
  v_mfma_f32_16x16x32_bf16 v[208:211], v[76:79], v[116:119], v[208:211]
  v_mfma_f32_16x16x32_bf16 v[212:215], v[80:83], v[116:119], v[212:215]
  v_mfma_f32_16x16x32_bf16 v[216:219], v[84:87], v[116:119], v[216:219]
  v_mfma_f32_16x16x32_bf16 v[220:223], v[88:91], v[116:119], v[220:223]
  s_waitcnt lgkmcnt(0)
  s_cbranch_scc1 L_attn_loopa
  s_branch L_attn_post
.p2align 3
L_attn_loopb:
  v_mfma_f32_16x16x32_bf16 v[240:243], v[236:239], v[40:43], v[240:243]
  ds_read_b128 v[76:79], v11 offset:0
  v_mfma_f32_16x16x32_bf16 v[244:247], v[40:43], v[40:43], v[244:247]
  ds_read_b128 v[80:83], v11 offset:2048
  v_mfma_f32_16x16x32_bf16 v[248:251], v[236:239], v[44:47], v[248:251]
  ds_read_b128 v[84:87], v11 offset:4096
  v_mfma_f32_16x16x32_bf16 v[252:255], v[44:47], v[44:47], v[252:255]
  ds_read_b128 v[88:91], v11 offset:6144
  v_mfma_f32_16x16x32_bf16 v[128:131], v[52:55], v[32:35], v[128:131]
  ds_read_b128 v[92:95], v15
  v_mfma_f32_16x16x32_bf16 v[132:135], v[52:55], v[36:39], v[132:135]
  ds_read_b64_tr_b16 v[96:97], v12 offset:4096
  v_mfma_f32_16x16x32_bf16 v[136:139], v[52:55], v[40:43], v[136:139]
  ds_read_b64_tr_b16 v[98:99], v12 offset:4608
  v_mfma_f32_16x16x32_bf16 v[140:143], v[52:55], v[44:47], v[140:143]
  ds_read_b64_tr_b16 v[100:101], v13 offset:4096
  v_mfma_f32_16x16x32_bf16 v[224:227], v[52:55], v[48:51], v[224:227]
  ds_read_b64_tr_b16 v[102:103], v13 offset:4608
  v_mfma_f32_16x16x32_bf16 v[144:147], v[56:59], v[32:35], v[144:147]
  ds_read_b64_tr_b16 v[104:105], v12 offset:12288
  v_mfma_f32_16x16x32_bf16 v[148:151], v[56:59], v[36:39], v[148:151]
  ds_read_b64_tr_b16 v[106:107], v12 offset:12800
  v_mfma_f32_16x16x32_bf16 v[152:155], v[56:59], v[40:43], v[152:155]
  ds_read_b64_tr_b16 v[108:109], v13 offset:12288
  v_mfma_f32_16x16x32_bf16 v[156:159], v[56:59], v[44:47], v[156:159]
  ds_read_b64_tr_b16 v[110:111], v13 offset:12800
  v_mfma_f32_16x16x32_bf16 v[160:163], v[60:63], v[32:35], v[160:163]
  ds_read_b64_tr_b16 v[112:113], v12 offset:20480
  v_mfma_f32_16x16x32_bf16 v[164:167], v[60:63], v[36:39], v[164:167]
  ds_read_b64_tr_b16 v[114:115], v12 offset:20992
  v_mfma_f32_16x16x32_bf16 v[168:171], v[60:63], v[40:43], v[168:171]
  ds_read_b64_tr_b16 v[116:117], v13 offset:20480
  v_mfma_f32_16x16x32_bf16 v[172:175], v[60:63], v[44:47], v[172:175]
  ds_read_b64_tr_b16 v[118:119], v13 offset:20992
  v_mfma_f32_16x16x32_bf16 v[228:231], v[60:63], v[48:51], v[228:231]
  v_add_u32_e64 v10, s75, v4
  v_mfma_f32_16x16x32_bf16 v[176:179], v[64:67], v[32:35], v[176:179]
  v_add_u32_e64 v11, s75, v5
  v_mfma_f32_16x16x32_bf16 v[180:183], v[64:67], v[36:39], v[180:183]
  v_add_u32_e64 v12, s75, v6
  v_mfma_f32_16x16x32_bf16 v[184:187], v[64:67], v[40:43], v[184:187]
  v_add_u32_e64 v13, s75, v7
  v_mfma_f32_16x16x32_bf16 v[188:191], v[64:67], v[44:47], v[188:191]
  v_add_u32_e64 v14, s75, v8
  v_mfma_f32_16x16x32_bf16 v[192:195], v[32:35], v[68:71], v[192:195]
  v_add_u32_e64 v15, s75, v9
  v_mfma_f32_16x16x32_bf16 v[196:199], v[36:39], v[68:71], v[196:199]
  s_add_u32 s75, s75, 43008
  v_mfma_f32_16x16x32_bf16 v[200:203], v[40:43], v[68:71], v[200:203]
  s_cmp_eq_u32 s75, 129024
  v_mfma_f32_16x16x32_bf16 v[204:207], v[44:47], v[68:71], v[204:207]
  s_cselect_b32 s75, 0, s75
  s_sub_u32 s79, s79, 1
  v_mfma_f32_16x16x32_bf16 v[232:235], v[48:51], v[68:71], v[232:235]
  v_mfma_f32_16x16x32_bf16 v[208:211], v[32:35], v[72:75], v[208:211]
  v_mfma_f32_16x16x32_bf16 v[212:215], v[36:39], v[72:75], v[212:215]
  v_mfma_f32_16x16x32_bf16 v[216:219], v[40:43], v[72:75], v[216:219]
  v_mfma_f32_16x16x32_bf16 v[220:223], v[44:47], v[72:75], v[220:223]
  s_waitcnt lgkmcnt(0)
  s_barrier
  v_mfma_f32_16x16x32_bf16 v[240:243], v[236:239], v[84:87], v[240:243]
  ds_read_b128 v[32:35], v10 offset:0
  v_mfma_f32_16x16x32_bf16 v[244:247], v[84:87], v[84:87], v[244:247]
  ds_read_b128 v[36:39], v10 offset:2048
  v_mfma_f32_16x16x32_bf16 v[248:251], v[236:239], v[88:91], v[248:251]
  ds_read_b128 v[40:43], v10 offset:4096
  v_mfma_f32_16x16x32_bf16 v[252:255], v[88:91], v[88:91], v[252:255]
  ds_read_b128 v[44:47], v10 offset:6144
  v_mfma_f32_16x16x32_bf16 v[128:131], v[96:99], v[76:79], v[128:131]
  ds_read_b128 v[48:51], v14
  v_mfma_f32_16x16x32_bf16 v[132:135], v[96:99], v[80:83], v[132:135]
  ds_read_b64_tr_b16 v[52:53], v12 offset:0
  v_mfma_f32_16x16x32_bf16 v[136:139], v[96:99], v[84:87], v[136:139]
  ds_read_b64_tr_b16 v[54:55], v12 offset:512
  v_mfma_f32_16x16x32_bf16 v[140:143], v[96:99], v[88:91], v[140:143]
  ds_read_b64_tr_b16 v[56:57], v13 offset:0
  v_mfma_f32_16x16x32_bf16 v[224:227], v[96:99], v[92:95], v[224:227]
  ds_read_b64_tr_b16 v[58:59], v13 offset:512
  v_mfma_f32_16x16x32_bf16 v[144:147], v[100:103], v[76:79], v[144:147]
  ds_read_b64_tr_b16 v[60:61], v12 offset:8192
  v_mfma_f32_16x16x32_bf16 v[148:151], v[100:103], v[80:83], v[148:151]
  ds_read_b64_tr_b16 v[62:63], v12 offset:8704
  v_mfma_f32_16x16x32_bf16 v[152:155], v[100:103], v[84:87], v[152:155]
  ds_read_b64_tr_b16 v[64:65], v13 offset:8192
  v_mfma_f32_16x16x32_bf16 v[156:159], v[100:103], v[88:91], v[156:159]
  ds_read_b64_tr_b16 v[66:67], v13 offset:8704
  v_mfma_f32_16x16x32_bf16 v[160:163], v[104:107], v[76:79], v[160:163]
  ds_read_b64_tr_b16 v[68:69], v12 offset:16384
  v_mfma_f32_16x16x32_bf16 v[164:167], v[104:107], v[80:83], v[164:167]
  ds_read_b64_tr_b16 v[70:71], v12 offset:16896
  v_mfma_f32_16x16x32_bf16 v[168:171], v[104:107], v[84:87], v[168:171]
  ds_read_b64_tr_b16 v[72:73], v13 offset:16384
  v_mfma_f32_16x16x32_bf16 v[172:175], v[104:107], v[88:91], v[172:175]
  ds_read_b64_tr_b16 v[74:75], v13 offset:16896
  v_mfma_f32_16x16x32_bf16 v[228:231], v[104:107], v[92:95], v[228:231]
  s_cmp_lg_u32 s79, 0
  s_nop 0
  v_mfma_f32_16x16x32_bf16 v[176:179], v[108:111], v[76:79], v[176:179]
  v_mfma_f32_16x16x32_bf16 v[180:183], v[108:111], v[80:83], v[180:183]
  v_mfma_f32_16x16x32_bf16 v[184:187], v[108:111], v[84:87], v[184:187]
  v_mfma_f32_16x16x32_bf16 v[188:191], v[108:111], v[88:91], v[188:191]
  v_mfma_f32_16x16x32_bf16 v[192:195], v[76:79], v[112:115], v[192:195]
  v_mfma_f32_16x16x32_bf16 v[196:199], v[80:83], v[112:115], v[196:199]
  v_mfma_f32_16x16x32_bf16 v[200:203], v[84:87], v[112:115], v[200:203]
  v_mfma_f32_16x16x32_bf16 v[204:207], v[88:91], v[112:115], v[204:207]
  v_mfma_f32_16x16x32_bf16 v[232:235], v[92:95], v[112:115], v[232:235]
  v_mfma_f32_16x16x32_bf16 v[208:211], v[76:79], v[116:119], v[208:211]
  v_mfma_f32_16x16x32_bf16 v[212:215], v[80:83], v[116:119], v[212:215]
  v_mfma_f32_16x16x32_bf16 v[216:219], v[84:87], v[116:119], v[216:219]
  v_mfma_f32_16x16x32_bf16 v[220:223], v[88:91], v[116:119], v[220:223]
  s_waitcnt lgkmcnt(0)
  s_cbranch_scc1 L_attn_loopb
L_attn_post:
  v_and_b32 v32, 3, v1
  v_cmp_eq_u32 s[4:5], 1, v32
  v_cmp_eq_u32 s[6:7], 2, v32
  v_cmp_eq_u32 s[8:9], 3, v32
  v_bfe_u32 v33, v1, 2, 2
  v_lshrrev_b32 v34, 4, v1
  v_cmp_eq_u32 s[10:11], v33, v34
  s_lshl_b32 s3, s72, 7
  v_add_u32 v35, s3, v23
  v_and_b32 v36, 15, v1
  s_cmp_eq_u32 s70, 0
  s_cselect_b32 s3, 0, 576
  s_add_u32 s3, s3, 129024
  v_lshl_add_u32 v36, v36, 2, s3
  v_cndmask_b32 v241, v244, v245, s[4:5]
  v_cndmask_b32 v249, v252, v253, s[4:5]
  v_cndmask_b32 v121, v124, v125, s[4:5]
  v_cndmask_b32 v241, v241, v246, s[6:7]
  v_cndmask_b32 v249, v249, v254, s[6:7]
  v_cndmask_b32 v121, v121, v126, s[6:7]
  v_cndmask_b32 v241, v241, v247, s[8:9]
  v_cndmask_b32 v249, v249, v255, s[8:9]
  v_cndmask_b32 v121, v121, v127, s[8:9]
  v_mul_f32 v240, 0x3a800000, v240
  v_mul_f32 v241, 0x3a800000, v241
  v_fma_f32 v241, -v240, v240, v241
  v_max_f32 v241, 0, v241
  v_add_f32 v241, 0x3727c5ac, v241
  v_rsq_f32 v241, v241
  s_nop 0
  v_mul_f32 v248, 0x3a800000, v248
  v_mul_f32 v249, 0x3a800000, v249
  v_fma_f32 v249, -v248, v248, v249
  v_max_f32 v249, 0, v249
  v_add_f32 v249, 0x3727c5ac, v249
  v_rsq_f32 v249, v249
  s_nop 0
  v_mul_f32 v120, 0x3a800000, v120
  v_mul_f32 v121, 0x3a800000, v121
  v_fma_f32 v121, -v120, v120, v121
  v_max_f32 v121, 0, v121
  v_add_f32 v121, 0x3727c5ac, v121
  v_rsq_f32 v121, v121
  s_nop 0
  s_mov_b64 exec, s[10:11]
  ds_write2_b32 v35, v240, v241 offset0:16 offset1:176
  ds_write2_b32 v35, v248, v249 offset0:32 offset1:192
  ds_write2_b32 v36, v120, v121 offset0:0 offset1:160
  s_mov_b64 exec, -1
  s_mov_b32 s36, s16
  s_and_b32 s37, s17, 0xffff
  s_mov_b32 s38, 4194304
  s_mov_b32 s39, 0x00020000
  s_and_b32 s3, s2, 3
  s_and_b32 s4, s99, 3
  s_lshl2_add_u32 s3, s3, s4
  s_lshl2_add_u32 s3, s3, s70
  s_lshl_b32 s3, s3, 16
  s_and_b32 s4, s2, 4
  s_lshr_b32 s5, s99, 2
  s_lshl1_add_u32 s4, s4, s5
  s_lshl_b32 s4, s4, 7
  s_add_u32 s3, s3, s4
  s_add_u32 s4, s3, 32768
  v_and_b32 v32, 15, v1
  v_lshlrev_b32 v33, 1, v1
  v_and_b32 v33, 32, v33
  v_lshl_add_u32 v32, v32, 11, v33
  v_lshrrev_b32 v33, 1, v1
  v_and_b32 v33, 16, v33
  v_add_u32 v32, v32, v33
  s_waitcnt lgkmcnt(0)
  buffer_load_dwordx4 v[240:243], v32, s[36:39], s3 offen offset:0
  buffer_load_dwordx4 v[244:247], v32, s[36:39], s3 offen offset:64
  buffer_load_dwordx4 v[248:251], v32, s[36:39], s4 offen offset:0
  buffer_load_dwordx4 v[252:255], v32, s[36:39], s4 offen offset:64
  s_barrier
  s_branch L_attn_exit
.p2align 3
L_attn_loop:
  v_mfma_f32_16x16x32_bf16 v[128:131], v[52:55], v[32:35], v[128:131]
  ds_read_b128 v[76:79], v11 offset:0
  v_mfma_f32_16x16x32_bf16 v[132:135], v[52:55], v[36:39], v[132:135]
  ds_read_b128 v[80:83], v11 offset:2048
  v_mfma_f32_16x16x32_bf16 v[136:139], v[52:55], v[40:43], v[136:139]
  ds_read_b128 v[84:87], v11 offset:4096
  v_mfma_f32_16x16x32_bf16 v[140:143], v[52:55], v[44:47], v[140:143]
  ds_read_b128 v[88:91], v11 offset:6144
  v_mfma_f32_16x16x32_bf16 v[224:227], v[52:55], v[48:51], v[224:227]
  ds_read_b128 v[92:95], v15
  v_mfma_f32_16x16x32_bf16 v[144:147], v[56:59], v[32:35], v[144:147]
  ds_read_b64_tr_b16 v[96:97], v12 offset:4096
  v_mfma_f32_16x16x32_bf16 v[148:151], v[56:59], v[36:39], v[148:151]
  ds_read_b64_tr_b16 v[98:99], v12 offset:4608
  v_mfma_f32_16x16x32_bf16 v[152:155], v[56:59], v[40:43], v[152:155]
  ds_read_b64_tr_b16 v[100:101], v13 offset:4096
  v_mfma_f32_16x16x32_bf16 v[156:159], v[56:59], v[44:47], v[156:159]
  ds_read_b64_tr_b16 v[102:103], v13 offset:4608
  v_mfma_f32_16x16x32_bf16 v[160:163], v[60:63], v[32:35], v[160:163]
  ds_read_b64_tr_b16 v[104:105], v12 offset:12288
  v_mfma_f32_16x16x32_bf16 v[164:167], v[60:63], v[36:39], v[164:167]
  ds_read_b64_tr_b16 v[106:107], v12 offset:12800
  v_mfma_f32_16x16x32_bf16 v[168:171], v[60:63], v[40:43], v[168:171]
  ds_read_b64_tr_b16 v[108:109], v13 offset:12288
  v_mfma_f32_16x16x32_bf16 v[172:175], v[60:63], v[44:47], v[172:175]
  ds_read_b64_tr_b16 v[110:111], v13 offset:12800
  v_mfma_f32_16x16x32_bf16 v[228:231], v[60:63], v[48:51], v[228:231]
  ds_read_b64_tr_b16 v[112:113], v12 offset:20480
  v_mfma_f32_16x16x32_bf16 v[176:179], v[64:67], v[32:35], v[176:179]
  ds_read_b64_tr_b16 v[114:115], v12 offset:20992
  v_mfma_f32_16x16x32_bf16 v[180:183], v[64:67], v[36:39], v[180:183]
  ds_read_b64_tr_b16 v[116:117], v13 offset:20480
  v_mfma_f32_16x16x32_bf16 v[184:187], v[64:67], v[40:43], v[184:187]
  ds_read_b64_tr_b16 v[118:119], v13 offset:20992
  v_mfma_f32_16x16x32_bf16 v[188:191], v[64:67], v[44:47], v[188:191]
  v_add_u32_e64 v10, s75, v4
  v_mfma_f32_16x16x32_bf16 v[192:195], v[32:35], v[68:71], v[192:195]
  v_add_u32_e64 v11, s75, v5
  v_mfma_f32_16x16x32_bf16 v[196:199], v[36:39], v[68:71], v[196:199]
  v_add_u32_e64 v12, s75, v6
  v_mfma_f32_16x16x32_bf16 v[200:203], v[40:43], v[68:71], v[200:203]
  v_add_u32_e64 v13, s75, v7
  v_mfma_f32_16x16x32_bf16 v[204:207], v[44:47], v[68:71], v[204:207]
  v_add_u32_e64 v14, s75, v8
  v_mfma_f32_16x16x32_bf16 v[232:235], v[48:51], v[68:71], v[232:235]
  v_add_u32_e64 v15, s75, v9
  v_mfma_f32_16x16x32_bf16 v[208:211], v[32:35], v[72:75], v[208:211]
  s_add_u32 s75, s75, 43008
  v_mfma_f32_16x16x32_bf16 v[212:215], v[36:39], v[72:75], v[212:215]
  s_cmp_eq_u32 s75, 129024
  v_mfma_f32_16x16x32_bf16 v[216:219], v[40:43], v[72:75], v[216:219]
  s_cselect_b32 s75, 0, s75
  s_sub_u32 s79, s79, 1
  v_mfma_f32_16x16x32_bf16 v[220:223], v[44:47], v[72:75], v[220:223]
  s_waitcnt lgkmcnt(0)
  s_barrier
  v_mfma_f32_16x16x32_bf16 v[128:131], v[96:99], v[76:79], v[128:131]
  ds_read_b128 v[32:35], v10 offset:0
  v_mfma_f32_16x16x32_bf16 v[132:135], v[96:99], v[80:83], v[132:135]
  ds_read_b128 v[36:39], v10 offset:2048
  v_mfma_f32_16x16x32_bf16 v[136:139], v[96:99], v[84:87], v[136:139]
  ds_read_b128 v[40:43], v10 offset:4096
  v_mfma_f32_16x16x32_bf16 v[140:143], v[96:99], v[88:91], v[140:143]
  ds_read_b128 v[44:47], v10 offset:6144
  v_mfma_f32_16x16x32_bf16 v[224:227], v[96:99], v[92:95], v[224:227]
  ds_read_b128 v[48:51], v14
  v_mfma_f32_16x16x32_bf16 v[144:147], v[100:103], v[76:79], v[144:147]
  ds_read_b64_tr_b16 v[52:53], v12 offset:0
  v_mfma_f32_16x16x32_bf16 v[148:151], v[100:103], v[80:83], v[148:151]
  ds_read_b64_tr_b16 v[54:55], v12 offset:512
  v_mfma_f32_16x16x32_bf16 v[152:155], v[100:103], v[84:87], v[152:155]
  ds_read_b64_tr_b16 v[56:57], v13 offset:0
  v_mfma_f32_16x16x32_bf16 v[156:159], v[100:103], v[88:91], v[156:159]
  ds_read_b64_tr_b16 v[58:59], v13 offset:512
  v_mfma_f32_16x16x32_bf16 v[160:163], v[104:107], v[76:79], v[160:163]
  ds_read_b64_tr_b16 v[60:61], v12 offset:8192
  v_mfma_f32_16x16x32_bf16 v[164:167], v[104:107], v[80:83], v[164:167]
  ds_read_b64_tr_b16 v[62:63], v12 offset:8704
  v_mfma_f32_16x16x32_bf16 v[168:171], v[104:107], v[84:87], v[168:171]
  ds_read_b64_tr_b16 v[64:65], v13 offset:8192
  v_mfma_f32_16x16x32_bf16 v[172:175], v[104:107], v[88:91], v[172:175]
  ds_read_b64_tr_b16 v[66:67], v13 offset:8704
  v_mfma_f32_16x16x32_bf16 v[228:231], v[104:107], v[92:95], v[228:231]
  ds_read_b64_tr_b16 v[68:69], v12 offset:16384
  v_mfma_f32_16x16x32_bf16 v[176:179], v[108:111], v[76:79], v[176:179]
  ds_read_b64_tr_b16 v[70:71], v12 offset:16896
  v_mfma_f32_16x16x32_bf16 v[180:183], v[108:111], v[80:83], v[180:183]
  ds_read_b64_tr_b16 v[72:73], v13 offset:16384
  v_mfma_f32_16x16x32_bf16 v[184:187], v[108:111], v[84:87], v[184:187]
  ds_read_b64_tr_b16 v[74:75], v13 offset:16896
  v_mfma_f32_16x16x32_bf16 v[188:191], v[108:111], v[88:91], v[188:191]
  s_cmp_lg_u32 s79, 0
  s_nop 0
  v_mfma_f32_16x16x32_bf16 v[192:195], v[76:79], v[112:115], v[192:195]
  v_mfma_f32_16x16x32_bf16 v[196:199], v[80:83], v[112:115], v[196:199]
  v_mfma_f32_16x16x32_bf16 v[200:203], v[84:87], v[112:115], v[200:203]
  v_mfma_f32_16x16x32_bf16 v[204:207], v[88:91], v[112:115], v[204:207]
  v_mfma_f32_16x16x32_bf16 v[232:235], v[92:95], v[112:115], v[232:235]
  v_mfma_f32_16x16x32_bf16 v[208:211], v[76:79], v[116:119], v[208:211]
  v_mfma_f32_16x16x32_bf16 v[212:215], v[80:83], v[116:119], v[212:215]
  v_mfma_f32_16x16x32_bf16 v[216:219], v[84:87], v[116:119], v[216:219]
  v_mfma_f32_16x16x32_bf16 v[220:223], v[88:91], v[116:119], v[220:223]
  s_waitcnt lgkmcnt(0)
  s_cbranch_scc1 L_attn_loop
L_attn_exit:
  ds_read2_b32 v[66:67], v23 offset0:0 offset1:160
  ds_read2_b32 v[68:69], v23 offset0:16 offset1:176
  ds_read2_b32 v[70:71], v23 offset0:32 offset1:192
  ds_read2_b32 v[72:73], v23 offset0:48 offset1:208
  ds_read2_b32 v[74:75], v23 offset0:64 offset1:224
  ds_read2_b32 v[76:77], v25 offset0:0 offset1:16
  ds_read2_b32 v[80:81], v26 offset0:0 offset1:16
  ds_read2_b32 v[78:79], v25 offset0:32 offset1:48
  ds_read2_b32 v[82:83], v26 offset0:32 offset1:48
  ds_write_b128 v16, v[224:227] offset:0
  ds_write_b128 v16, v[228:231] offset:2048
  ds_write_b128 v16, v[232:235] offset:4096
  s_cmp_eq_u32 s71, 1
  s_cbranch_scc1 L_attn_nop3
  ds_write_b128 v16, v[172:175] offset:8192
  ds_write_b128 v16, v[188:191] offset:9216
  ds_write_b128 v16, v[204:207] offset:10240
  ds_write_b128 v16, v[220:223] offset:11264
L_attn_nop3:
  ds_read_b128 v[84:87], v24 offset:0
  ds_read_b128 v[104:107], v24 offset:640
  ds_read_b128 v[88:91], v24 offset:64
  ds_read_b128 v[108:111], v24 offset:704
  ds_read_b128 v[92:95], v24 offset:128
  ds_read_b128 v[112:115], v24 offset:768
  ds_read_b128 v[96:99], v24 offset:192
  ds_read_b128 v[116:119], v24 offset:832
  ds_read_b128 v[100:103], v24 offset:256
  ds_read_b128 v[120:123], v24 offset:896
  s_waitcnt lgkmcnt(10)
  s_barrier
  ds_read_b128 v[48:51], v19 offset:0
  ds_read_b128 v[52:55], v20 offset:1024
  ds_read_b128 v[56:59], v19 offset:2048
  ds_read_b128 v[60:63], v20 offset:3072
  ds_read_b32 v64, v21 offset:4096
  ds_read_b32 v65, v22 offset:5120
  ds_read_b128 v[32:35], v17 offset:2048
  ds_read_b128 v[36:39], v18 offset:3072
  ds_read_b128 v[40:43], v17 offset:4096
  ds_read_b128 v[44:47], v18 offset:5120
  v_mul_f32 v69, 0x3e8293ee, v69
  v_mul_f32 v71, 0x3e8293ee, v71
  v_mul_f32 v73, 0x3e8293ee, v73
  v_mul_f32 v75, 0x3e8293ee, v75
  v_mul_f32 v76, v76, v69
  v_mul_f32 v80, v80, v69
  v_mul_f32 v77, v77, v71
  v_mul_f32 v81, v81, v71
  v_mul_f32 v78, v78, v73
  v_mul_f32 v82, v82, v73
  v_mul_f32 v79, v79, v75
  v_mul_f32 v83, v83, v75
  s_waitcnt lgkmcnt(6)
  v_pk_fma_f32 v[128:129], v[48:49], v[68:69], v[128:129] op_sel:[0,0,0] op_sel_hi:[1,0,1] neg_lo:[0,1,0] neg_hi:[0,1,0]
  v_pk_fma_f32 v[130:131], v[50:51], v[68:69], v[130:131] op_sel:[0,0,0] op_sel_hi:[1,0,1] neg_lo:[0,1,0] neg_hi:[0,1,0]
  v_pk_fma_f32 v[144:145], v[52:53], v[68:69], v[144:145] op_sel:[0,0,0] op_sel_hi:[1,0,1] neg_lo:[0,1,0] neg_hi:[0,1,0]
  v_pk_fma_f32 v[146:147], v[54:55], v[68:69], v[146:147] op_sel:[0,0,0] op_sel_hi:[1,0,1] neg_lo:[0,1,0] neg_hi:[0,1,0]
  v_cvt_pk_bf16_f32 v128, v128, v129
  v_cvt_pk_bf16_f32 v129, v130, v131
  v_cvt_pk_bf16_f32 v130, v144, v145
  v_cvt_pk_bf16_f32 v131, v146, v147
  v_pk_fma_f32 v[160:161], v[56:57], v[68:69], v[160:161] op_sel:[0,0,0] op_sel_hi:[1,0,1] neg_lo:[0,1,0] neg_hi:[0,1,0]
  v_pk_fma_f32 v[162:163], v[58:59], v[68:69], v[162:163] op_sel:[0,0,0] op_sel_hi:[1,0,1] neg_lo:[0,1,0] neg_hi:[0,1,0]
  v_pk_fma_f32 v[176:177], v[60:61], v[68:69], v[176:177] op_sel:[0,0,0] op_sel_hi:[1,0,1] neg_lo:[0,1,0] neg_hi:[0,1,0]
  v_pk_fma_f32 v[178:179], v[62:63], v[68:69], v[178:179] op_sel:[0,0,0] op_sel_hi:[1,0,1] neg_lo:[0,1,0] neg_hi:[0,1,0]
  v_cvt_pk_bf16_f32 v160, v160, v161
  v_cvt_pk_bf16_f32 v161, v162, v163
  v_cvt_pk_bf16_f32 v162, v176, v177
  v_cvt_pk_bf16_f32 v163, v178, v179
  v_pk_fma_f32 v[132:133], v[48:49], v[70:71], v[132:133] op_sel:[0,0,0] op_sel_hi:[1,0,1] neg_lo:[0,1,0] neg_hi:[0,1,0]
  v_pk_fma_f32 v[134:135], v[50:51], v[70:71], v[134:135] op_sel:[0,0,0] op_sel_hi:[1,0,1] neg_lo:[0,1,0] neg_hi:[0,1,0]
  v_pk_fma_f32 v[148:149], v[52:53], v[70:71], v[148:149] op_sel:[0,0,0] op_sel_hi:[1,0,1] neg_lo:[0,1,0] neg_hi:[0,1,0]
  v_pk_fma_f32 v[150:151], v[54:55], v[70:71], v[150:151] op_sel:[0,0,0] op_sel_hi:[1,0,1] neg_lo:[0,1,0] neg_hi:[0,1,0]
  v_cvt_pk_bf16_f32 v132, v132, v133
  v_cvt_pk_bf16_f32 v133, v134, v135
  v_cvt_pk_bf16_f32 v134, v148, v149
  v_cvt_pk_bf16_f32 v135, v150, v151
  v_pk_fma_f32 v[164:165], v[56:57], v[70:71], v[164:165] op_sel:[0,0,0] op_sel_hi:[1,0,1] neg_lo:[0,1,0] neg_hi:[0,1,0]
  v_pk_fma_f32 v[166:167], v[58:59], v[70:71], v[166:167] op_sel:[0,0,0] op_sel_hi:[1,0,1] neg_lo:[0,1,0] neg_hi:[0,1,0]
  v_pk_fma_f32 v[180:181], v[60:61], v[70:71], v[180:181] op_sel:[0,0,0] op_sel_hi:[1,0,1] neg_lo:[0,1,0] neg_hi:[0,1,0]
  v_pk_fma_f32 v[182:183], v[62:63], v[70:71], v[182:183] op_sel:[0,0,0] op_sel_hi:[1,0,1] neg_lo:[0,1,0] neg_hi:[0,1,0]
  v_cvt_pk_bf16_f32 v164, v164, v165
  v_cvt_pk_bf16_f32 v165, v166, v167
  v_cvt_pk_bf16_f32 v166, v180, v181
  v_cvt_pk_bf16_f32 v167, v182, v183
  v_mfma_f32_16x16x32_bf16 v[144:147], v[160:163], v[128:131], 0
  v_pk_fma_f32 v[136:137], v[48:49], v[72:73], v[136:137] op_sel:[0,0,0] op_sel_hi:[1,0,1] neg_lo:[0,1,0] neg_hi:[0,1,0]
  v_pk_fma_f32 v[138:139], v[50:51], v[72:73], v[138:139] op_sel:[0,0,0] op_sel_hi:[1,0,1] neg_lo:[0,1,0] neg_hi:[0,1,0]
  v_pk_fma_f32 v[152:153], v[52:53], v[72:73], v[152:153] op_sel:[0,0,0] op_sel_hi:[1,0,1] neg_lo:[0,1,0] neg_hi:[0,1,0]
  v_pk_fma_f32 v[154:155], v[54:55], v[72:73], v[154:155] op_sel:[0,0,0] op_sel_hi:[1,0,1] neg_lo:[0,1,0] neg_hi:[0,1,0]
  v_cvt_pk_bf16_f32 v136, v136, v137
  v_cvt_pk_bf16_f32 v137, v138, v139
  v_cvt_pk_bf16_f32 v138, v152, v153
  v_cvt_pk_bf16_f32 v139, v154, v155
  v_pk_fma_f32 v[168:169], v[56:57], v[72:73], v[168:169] op_sel:[0,0,0] op_sel_hi:[1,0,1] neg_lo:[0,1,0] neg_hi:[0,1,0]
  v_pk_fma_f32 v[170:171], v[58:59], v[72:73], v[170:171] op_sel:[0,0,0] op_sel_hi:[1,0,1] neg_lo:[0,1,0] neg_hi:[0,1,0]
  v_pk_fma_f32 v[184:185], v[60:61], v[72:73], v[184:185] op_sel:[0,0,0] op_sel_hi:[1,0,1] neg_lo:[0,1,0] neg_hi:[0,1,0]
  v_pk_fma_f32 v[186:187], v[62:63], v[72:73], v[186:187] op_sel:[0,0,0] op_sel_hi:[1,0,1] neg_lo:[0,1,0] neg_hi:[0,1,0]
  v_cvt_pk_bf16_f32 v168, v168, v169
  v_cvt_pk_bf16_f32 v169, v170, v171
  v_cvt_pk_bf16_f32 v170, v184, v185
  v_cvt_pk_bf16_f32 v171, v186, v187
  v_mfma_f32_16x16x32_bf16 v[148:151], v[164:167], v[132:135], 0
  v_mfma_f32_16x16x32_bf16 v[180:183], v[160:163], v[132:135], 0
  v_pk_fma_f32 v[140:141], v[48:49], v[74:75], v[140:141] op_sel:[0,0,0] op_sel_hi:[1,0,1] neg_lo:[0,1,0] neg_hi:[0,1,0]
  v_pk_fma_f32 v[142:143], v[50:51], v[74:75], v[142:143] op_sel:[0,0,0] op_sel_hi:[1,0,1] neg_lo:[0,1,0] neg_hi:[0,1,0]
  v_pk_fma_f32 v[156:157], v[52:53], v[74:75], v[156:157] op_sel:[0,0,0] op_sel_hi:[1,0,1] neg_lo:[0,1,0] neg_hi:[0,1,0]
  v_pk_fma_f32 v[158:159], v[54:55], v[74:75], v[158:159] op_sel:[0,0,0] op_sel_hi:[1,0,1] neg_lo:[0,1,0] neg_hi:[0,1,0]
  v_cvt_pk_bf16_f32 v140, v140, v141
  v_cvt_pk_bf16_f32 v141, v142, v143
  v_cvt_pk_bf16_f32 v142, v156, v157
  v_cvt_pk_bf16_f32 v143, v158, v159
  v_pk_fma_f32 v[172:173], v[56:57], v[74:75], v[172:173] op_sel:[0,0,0] op_sel_hi:[1,0,1] neg_lo:[0,1,0] neg_hi:[0,1,0]
  v_pk_fma_f32 v[174:175], v[58:59], v[74:75], v[174:175] op_sel:[0,0,0] op_sel_hi:[1,0,1] neg_lo:[0,1,0] neg_hi:[0,1,0]
  v_pk_fma_f32 v[188:189], v[60:61], v[74:75], v[188:189] op_sel:[0,0,0] op_sel_hi:[1,0,1] neg_lo:[0,1,0] neg_hi:[0,1,0]
  v_pk_fma_f32 v[190:191], v[62:63], v[74:75], v[190:191] op_sel:[0,0,0] op_sel_hi:[1,0,1] neg_lo:[0,1,0] neg_hi:[0,1,0]
  v_cvt_pk_bf16_f32 v172, v172, v173
  v_cvt_pk_bf16_f32 v173, v174, v175
  v_cvt_pk_bf16_f32 v174, v188, v189
  v_cvt_pk_bf16_f32 v175, v190, v191
  s_waitcnt lgkmcnt(0)
  v_pk_fma_f32 v[32:33], v[56:57], v[66:67], v[32:33] op_sel:[0,0,0] op_sel_hi:[1,0,1] neg_lo:[0,1,0] neg_hi:[0,1,0]
  v_pk_fma_f32 v[34:35], v[58:59], v[66:67], v[34:35] op_sel:[0,0,0] op_sel_hi:[1,0,1] neg_lo:[0,1,0] neg_hi:[0,1,0]
  v_pk_fma_f32 v[36:37], v[60:61], v[66:67], v[36:37] op_sel:[0,0,0] op_sel_hi:[1,0,1] neg_lo:[0,1,0] neg_hi:[0,1,0]
  v_pk_fma_f32 v[38:39], v[62:63], v[66:67], v[38:39] op_sel:[0,0,0] op_sel_hi:[1,0,1] neg_lo:[0,1,0] neg_hi:[0,1,0]
  v_cvt_pk_bf16_f32 v32, v32, v33
  v_cvt_pk_bf16_f32 v33, v34, v35
  v_cvt_pk_bf16_f32 v34, v36, v37
  v_cvt_pk_bf16_f32 v35, v38, v39
  v_mfma_f32_16x16x32_bf16 v[152:155], v[168:171], v[136:139], 0
  v_mfma_f32_16x16x32_bf16 v[184:187], v[164:167], v[136:139], 0
  v_mfma_f32_16x16x32_bf16 v[156:159], v[172:175], v[140:143], 0
  v_mfma_f32_16x16x32_bf16 v[188:191], v[168:171], v[140:143], 0
  v_mfma_f32_16x16x32_bf16 v[176:179], v[32:35], v[128:131], 0
  v_pk_fma_f32 v[40:41], v[84:85], v[64:65], v[40:41] op_sel:[0,0,0] op_sel_hi:[1,0,1] neg_lo:[1,0,0] neg_hi:[1,0,0]
  v_pk_fma_f32 v[42:43], v[86:87], v[64:65], v[42:43] op_sel:[0,0,0] op_sel_hi:[1,0,1] neg_lo:[1,0,0] neg_hi:[1,0,0]
  v_pk_mul_f32 v[40:41], v[40:41], v[104:105]
  v_pk_mul_f32 v[42:43], v[42:43], v[106:107]
  v_cvt_pk_bf16_f32 v4, v40, v41
  v_cvt_pk_bf16_f32 v5, v42, v43
  v_pk_fma_f32 v[192:193], v[88:89], v[64:65], v[192:193] op_sel:[0,0,0] op_sel_hi:[1,0,1] neg_lo:[1,0,0] neg_hi:[1,0,0]
  v_pk_fma_f32 v[194:195], v[90:91], v[64:65], v[194:195] op_sel:[0,0,0] op_sel_hi:[1,0,1] neg_lo:[1,0,0] neg_hi:[1,0,0]
  v_pk_mul_f32 v[192:193], v[192:193], v[108:109]
  v_pk_mul_f32 v[194:195], v[194:195], v[110:111]
  v_cvt_pk_bf16_f32 v6, v192, v193
  v_cvt_pk_bf16_f32 v7, v194, v195
  v_pk_fma_f32 v[196:197], v[92:93], v[64:65], v[196:197] op_sel:[0,0,0] op_sel_hi:[1,0,1] neg_lo:[1,0,0] neg_hi:[1,0,0]
  v_pk_fma_f32 v[198:199], v[94:95], v[64:65], v[198:199] op_sel:[0,0,0] op_sel_hi:[1,0,1] neg_lo:[1,0,0] neg_hi:[1,0,0]
  v_pk_mul_f32 v[196:197], v[196:197], v[112:113]
  v_pk_mul_f32 v[198:199], v[198:199], v[114:115]
  v_cvt_pk_bf16_f32 v8, v196, v197
  v_cvt_pk_bf16_f32 v9, v198, v199
  v_pk_fma_f32 v[200:201], v[96:97], v[64:65], v[200:201] op_sel:[0,0,0] op_sel_hi:[1,0,1] neg_lo:[1,0,0] neg_hi:[1,0,0]
  v_pk_fma_f32 v[202:203], v[98:99], v[64:65], v[202:203] op_sel:[0,0,0] op_sel_hi:[1,0,1] neg_lo:[1,0,0] neg_hi:[1,0,0]
  v_pk_mul_f32 v[200:201], v[200:201], v[116:117]
  v_pk_mul_f32 v[202:203], v[202:203], v[118:119]
  v_cvt_pk_bf16_f32 v10, v200, v201
  v_cvt_pk_bf16_f32 v11, v202, v203
  v_pk_fma_f32 v[204:205], v[100:101], v[64:65], v[204:205] op_sel:[0,0,0] op_sel_hi:[1,0,1] neg_lo:[1,0,0] neg_hi:[1,0,0]
  v_pk_fma_f32 v[206:207], v[102:103], v[64:65], v[206:207] op_sel:[0,0,0] op_sel_hi:[1,0,1] neg_lo:[1,0,0] neg_hi:[1,0,0]
  v_pk_mul_f32 v[204:205], v[204:205], v[120:121]
  v_pk_mul_f32 v[206:207], v[206:207], v[122:123]
  v_cvt_pk_bf16_f32 v12, v204, v205
  v_cvt_pk_bf16_f32 v13, v206, v207
  v_pk_fma_f32 v[44:45], v[84:85], v[64:65], v[44:45] op_sel:[0,1,0] op_sel_hi:[1,1,1] neg_lo:[1,0,0] neg_hi:[1,0,0]
  v_pk_fma_f32 v[46:47], v[86:87], v[64:65], v[46:47] op_sel:[0,1,0] op_sel_hi:[1,1,1] neg_lo:[1,0,0] neg_hi:[1,0,0]
  v_pk_mul_f32 v[44:45], v[44:45], v[104:105]
  v_pk_mul_f32 v[46:47], v[46:47], v[106:107]
  v_cvt_pk_bf16_f32 v224, v44, v45
  v_cvt_pk_bf16_f32 v225, v46, v47
  v_pk_fma_f32 v[208:209], v[88:89], v[64:65], v[208:209] op_sel:[0,1,0] op_sel_hi:[1,1,1] neg_lo:[1,0,0] neg_hi:[1,0,0]
  v_pk_fma_f32 v[210:211], v[90:91], v[64:65], v[210:211] op_sel:[0,1,0] op_sel_hi:[1,1,1] neg_lo:[1,0,0] neg_hi:[1,0,0]
  v_pk_mul_f32 v[208:209], v[208:209], v[108:109]
  v_pk_mul_f32 v[210:211], v[210:211], v[110:111]
  v_cvt_pk_bf16_f32 v226, v208, v209
  v_cvt_pk_bf16_f32 v227, v210, v211
  v_pk_fma_f32 v[212:213], v[92:93], v[64:65], v[212:213] op_sel:[0,1,0] op_sel_hi:[1,1,1] neg_lo:[1,0,0] neg_hi:[1,0,0]
  v_pk_fma_f32 v[214:215], v[94:95], v[64:65], v[214:215] op_sel:[0,1,0] op_sel_hi:[1,1,1] neg_lo:[1,0,0] neg_hi:[1,0,0]
  v_pk_mul_f32 v[212:213], v[212:213], v[112:113]
  v_pk_mul_f32 v[214:215], v[214:215], v[114:115]
  v_cvt_pk_bf16_f32 v228, v212, v213
  v_cvt_pk_bf16_f32 v229, v214, v215
  v_pk_fma_f32 v[216:217], v[96:97], v[64:65], v[216:217] op_sel:[0,1,0] op_sel_hi:[1,1,1] neg_lo:[1,0,0] neg_hi:[1,0,0]
  v_pk_fma_f32 v[218:219], v[98:99], v[64:65], v[218:219] op_sel:[0,1,0] op_sel_hi:[1,1,1] neg_lo:[1,0,0] neg_hi:[1,0,0]
  v_pk_mul_f32 v[216:217], v[216:217], v[116:117]
  v_pk_mul_f32 v[218:219], v[218:219], v[118:119]
  v_cvt_pk_bf16_f32 v230, v216, v217
  v_cvt_pk_bf16_f32 v231, v218, v219
  v_pk_fma_f32 v[220:221], v[100:101], v[64:65], v[220:221] op_sel:[0,1,0] op_sel_hi:[1,1,1] neg_lo:[1,0,0] neg_hi:[1,0,0]
  v_pk_fma_f32 v[222:223], v[102:103], v[64:65], v[222:223] op_sel:[0,1,0] op_sel_hi:[1,1,1] neg_lo:[1,0,0] neg_hi:[1,0,0]
  v_pk_mul_f32 v[220:221], v[220:221], v[120:121]
  v_pk_mul_f32 v[222:223], v[222:223], v[122:123]
  v_cvt_pk_bf16_f32 v232, v220, v221
  v_cvt_pk_bf16_f32 v233, v222, v223
  v_cndmask_b32 v148, v148, v149, s[48:49]
  v_cndmask_b32 v180, v180, v181, s[48:49]
  v_cndmask_b32 v150, v150, v151, s[48:49]
  v_cndmask_b32 v182, v182, v183, s[48:49]
  v_cndmask_b32 v36, v148, v180, s[50:51]
  v_cndmask_b32 v37, v150, v182, s[52:53]
  v_mul_f32 v36, v36, v77
  v_mul_f32 v37, v37, v81
  v_cndmask_b32 v152, v152, v153, s[48:49]
  v_cndmask_b32 v184, v184, v185, s[48:49]
  v_cndmask_b32 v154, v154, v155, s[48:49]
  v_cndmask_b32 v186, v186, v187, s[48:49]
  v_cndmask_b32 v40, v152, v184, s[50:51]
  v_cndmask_b32 v41, v154, v186, s[52:53]
  v_mul_f32 v40, v40, v78
  v_mul_f32 v41, v41, v82
  v_cndmask_b32 v156, v156, v157, s[48:49]
  v_cndmask_b32 v188, v188, v189, s[48:49]
  v_cndmask_b32 v158, v158, v159, s[48:49]
  v_cndmask_b32 v190, v190, v191, s[48:49]
  v_cndmask_b32 v44, v156, v188, s[50:51]
  v_cndmask_b32 v45, v158, v190, s[52:53]
  v_mul_f32 v44, v44, v79
  v_mul_f32 v45, v45, v83
  v_cndmask_b32 v144, v144, v145, s[48:49]
  v_cndmask_b32 v176, v176, v177, s[48:49]
  v_cndmask_b32 v146, v146, v147, s[48:49]
  v_cndmask_b32 v178, v178, v179, s[48:49]
  v_cndmask_b32 v32, v144, v176, s[50:51]
  v_cndmask_b32 v33, v146, v178, s[52:53]
  v_mul_f32 v32, v32, v76
  v_mul_f32 v33, v33, v80
  v_mov_b32 v48, 0xceabfb8f
  v_cndmask_b32 v32, v32, v48, s[54:55]
  v_cndmask_b32 v33, v33, v48, s[14:15]
  v_max_f32 v34, v32, v33
  v_max_f32 v38, v36, v37
  v_max_f32 v42, v40, v41
  v_max_f32 v46, v44, v45
  v_mov_b32 v35, v34
  v_mov_b32 v39, v38
  v_mov_b32 v43, v42
  v_mov_b32 v47, v46
  v_permlane32_swap_b32 v34, v35
  v_permlane32_swap_b32 v38, v39
  v_permlane32_swap_b32 v42, v43
  v_permlane32_swap_b32 v46, v47
  v_max_f32 v34, v34, v35
  v_max_f32 v38, v38, v39
  v_max_f32 v42, v42, v43
  v_max_f32 v46, v46, v47
  v_mov_b32 v35, v34
  v_mov_b32 v39, v38
  v_mov_b32 v43, v42
  v_mov_b32 v47, v46
  v_permlane16_swap_b32 v34, v35
  v_permlane16_swap_b32 v38, v39
  v_permlane16_swap_b32 v42, v43
  v_permlane16_swap_b32 v46, v47
  v_max_f32 v34, v34, v35
  v_max_f32 v38, v38, v39
  v_max_f32 v42, v42, v43
  v_max_f32 v46, v46, v47
  v_sub_f32 v32, v32, v34
  v_sub_f32 v33, v33, v34
  v_sub_f32 v36, v36, v38
  v_sub_f32 v37, v37, v38
  v_sub_f32 v40, v40, v42
  v_sub_f32 v41, v41, v42
  v_sub_f32 v44, v44, v46
  v_sub_f32 v45, v45, v46
  v_exp_f32 v32, v32
  v_exp_f32 v33, v33
  v_exp_f32 v36, v36
  v_exp_f32 v37, v37
  v_exp_f32 v40, v40
  v_exp_f32 v41, v41
  v_exp_f32 v44, v44
  v_exp_f32 v45, v45
  v_cvt_pk_bf16_f32 v32, v32, v32
  v_cvt_pk_bf16_f32 v33, v33, v33
  v_and_b32 v128, v32, v27
  v_and_b32 v129, v33, v29
  v_and_b32 v130, v32, v28
  v_and_b32 v131, v33, v30
  v_cvt_pk_bf16_f32 v36, v36, v36
  v_cvt_pk_bf16_f32 v37, v37, v37
  v_and_b32 v132, v36, v27
  v_and_b32 v133, v37, v29
  v_and_b32 v134, v36, v28
  v_and_b32 v135, v37, v30
  v_mfma_f32_16x16x32_bf16 v[144:147], v[236:239], v[128:131], 0
  v_mfma_f32_16x16x32_bf16 v[192:195], v[4:7], v[128:131], 0
  v_mfma_f32_16x16x32_bf16 v[208:211], v[224:227], v[128:131], 0
  v_cvt_pk_bf16_f32 v40, v40, v40
  v_cvt_pk_bf16_f32 v41, v41, v41
  v_and_b32 v136, v40, v27
  v_and_b32 v137, v41, v29
  v_and_b32 v138, v40, v28
  v_and_b32 v139, v41, v30
  v_mfma_f32_16x16x32_bf16 v[148:151], v[236:239], v[132:135], 0
  v_mfma_f32_16x16x32_bf16 v[196:199], v[6:9], v[132:135], 0
  v_mfma_f32_16x16x32_bf16 v[212:215], v[226:229], v[132:135], 0
  v_cvt_pk_bf16_f32 v44, v44, v44
  v_cvt_pk_bf16_f32 v45, v45, v45
  v_and_b32 v140, v44, v27
  v_and_b32 v141, v45, v29
  v_and_b32 v142, v44, v28
  v_and_b32 v143, v45, v30
  v_mfma_f32_16x16x32_bf16 v[152:155], v[236:239], v[136:139], 0
  v_mfma_f32_16x16x32_bf16 v[200:203], v[8:11], v[136:139], 0
  v_mfma_f32_16x16x32_bf16 v[216:219], v[228:231], v[136:139], 0
  v_mfma_f32_16x16x32_bf16 v[156:159], v[236:239], v[140:143], 0
  v_mfma_f32_16x16x32_bf16 v[204:207], v[10:13], v[140:143], 0
  v_mfma_f32_16x16x32_bf16 v[220:223], v[230:233], v[140:143], 0
  v_rcp_f32 v144, v144
  s_mov_b32 s3, 0
  v_pk_mul_f32 v[192:193], v[192:193], v[144:145] op_sel_hi:[1,0]
  v_pk_mul_f32 v[194:195], v[194:195], v[144:145] op_sel_hi:[1,0]
  v_pk_mul_f32 v[208:209], v[208:209], v[144:145] op_sel_hi:[1,0]
  v_pk_mul_f32 v[210:211], v[210:211], v[144:145] op_sel_hi:[1,0]
  v_cvt_pk_bf16_f32 v48, v192, v193
  v_cvt_pk_bf16_f32 v49, v194, v195
  v_cvt_pk_bf16_f32 v50, v208, v209
  v_cvt_pk_bf16_f32 v51, v210, v211
  s_nop 1
  v_permlane16_swap_b32 v48, v50
  v_permlane16_swap_b32 v49, v51
  buffer_store_dwordx4 v[48:51], v31, s[44:47], s3 offen sc1
  v_rcp_f32 v148, v148
  s_mov_b32 s3, 32768
  v_pk_mul_f32 v[196:197], v[196:197], v[148:149] op_sel_hi:[1,0]
  v_pk_mul_f32 v[198:199], v[198:199], v[148:149] op_sel_hi:[1,0]
  v_pk_mul_f32 v[212:213], v[212:213], v[148:149] op_sel_hi:[1,0]
  v_pk_mul_f32 v[214:215], v[214:215], v[148:149] op_sel_hi:[1,0]
  v_cvt_pk_bf16_f32 v52, v196, v197
  v_cvt_pk_bf16_f32 v53, v198, v199
  v_cvt_pk_bf16_f32 v54, v212, v213
  v_cvt_pk_bf16_f32 v55, v214, v215
  s_nop 1
  v_permlane16_swap_b32 v52, v54
  v_permlane16_swap_b32 v53, v55
  buffer_store_dwordx4 v[52:55], v31, s[44:47], s3 offen sc1
  v_rcp_f32 v152, v152
  s_mov_b32 s3, 65536
  v_pk_mul_f32 v[200:201], v[200:201], v[152:153] op_sel_hi:[1,0]
  v_pk_mul_f32 v[202:203], v[202:203], v[152:153] op_sel_hi:[1,0]
  v_pk_mul_f32 v[216:217], v[216:217], v[152:153] op_sel_hi:[1,0]
  v_pk_mul_f32 v[218:219], v[218:219], v[152:153] op_sel_hi:[1,0]
  v_cvt_pk_bf16_f32 v56, v200, v201
  v_cvt_pk_bf16_f32 v57, v202, v203
  v_cvt_pk_bf16_f32 v58, v216, v217
  v_cvt_pk_bf16_f32 v59, v218, v219
  s_nop 1
  v_permlane16_swap_b32 v56, v58
  v_permlane16_swap_b32 v57, v59
  buffer_store_dwordx4 v[56:59], v31, s[44:47], s3 offen sc1
  v_rcp_f32 v156, v156
  s_mov_b32 s3, 98304
  v_pk_mul_f32 v[204:205], v[204:205], v[156:157] op_sel_hi:[1,0]
  v_pk_mul_f32 v[206:207], v[206:207], v[156:157] op_sel_hi:[1,0]
  v_pk_mul_f32 v[220:221], v[220:221], v[156:157] op_sel_hi:[1,0]
  v_pk_mul_f32 v[222:223], v[222:223], v[156:157] op_sel_hi:[1,0]
  v_cvt_pk_bf16_f32 v60, v204, v205
  v_cvt_pk_bf16_f32 v61, v206, v207
  v_cvt_pk_bf16_f32 v62, v220, v221
  v_cvt_pk_bf16_f32 v63, v222, v223
  s_nop 1
  v_permlane16_swap_b32 v60, v62
  v_permlane16_swap_b32 v61, v63
  buffer_store_dwordx4 v[60:63], v31, s[44:47], s3 offen sc1
  s_waitcnt vmcnt(0) lgkmcnt(0)
  s_barrier
  s_add_u32 s97, s97, 1
  s_branch L_wo_body
.section .rodata,"a"
.p2align 6
.amdhsa_kernel interleave_layers__sliding_local_dilated__dense_activation_gelu__prompt_kernel
  .amdhsa_next_free_vgpr 256
  .amdhsa_next_free_sgpr 102
  .amdhsa_accum_offset 256
  .amdhsa_group_segment_fixed_size 0
  .amdhsa_kernarg_size 88
  .amdhsa_user_sgpr_count 2
  .amdhsa_user_sgpr_kernarg_segment_ptr 1
  .amdhsa_system_sgpr_workgroup_id_x 1
  .amdhsa_float_denorm_mode_32 3
  .amdhsa_float_denorm_mode_16_64 3
.end_amdhsa_kernel
.text
L_attn_c1:
L_wo_c0:
L_wo_body:
  s_cmp_ge_u32 s2, 256
  s_cbranch_scc1 L_wo_end
  v_lshrrev_b32 v2, 6, v0
  v_and_b32 v1, 63, v0
  v_readfirstlane_b32 s70, v2
  s_and_b32 s3, s2, 7
  s_lshr_b32 s99, s2, 3
  s_and_b32 s5, s3, 3
  s_lshl_b32 s5, s5, 2
  s_and_b32 s6, s99, 3
  s_add_u32 s68, s5, s6
  s_lshr_b32 s5, s3, 2
  s_lshl_b32 s5, s5, 3
  s_lshr_b32 s6, s99, 2
  s_add_u32 s69, s5, s6
  s_cmp_lt_u32 s70, 4
  s_cbranch_scc1 L_wo_compute
L_wo_loader:
  s_add_u32 s9, s70, s68
  s_and_b32 s9, s9, 3
  s_lshl_b32 s76, s9, 12
  s_lshl_b32 s77, s9, 11
  v_and_b32 v10, 7, v1
  v_lshrrev_b32 v3, 3, v1
  s_lshl_b32 s10, s9, 4
  v_add_u32 v3, s10, v3
  v_mul_u32_u24 v3, 2048, v3
  v_lshrrev_b32 v2, 3, v1
  v_and_b32 v2, 2, v2
  v_xor_b32 v2, v2, v10
  s_lshl_b32 s10, s69, 7
  v_add_u32 v3, s10, v3
  v_lshl_add_u32 v8, v2, 4, v3
  v_xor_b32 v2, 4, v2
  v_add_u32 v3, 16384, v3
  v_lshl_add_u32 v9, v2, 4, v3
  s_mov_b32 s40, s20
  s_and_b32 s41, s21, 0xffff
  s_mov_b32 s42, 2097152
  s_mov_b32 s43, 0x00020000
  s_add_u32 s3, s68, s69
  s_lshl_b32 s3, s3, 3
  s_lshl_b32 s85, 0xffff02, s3
  s_sub_u32 s3, 0, s3
  s_lshr_b32 s3, 0xffff02, s3
  s_or_b32 s85, s85, s3
  s_and_b32 s86, s68, 3
  s_lshl_b32 s86, s86, 2
  v_lshl_add_u32 v14, v1, 4, s77
  s_add_u32 s3, s96, s70
  s_cmp_lg_u32 s3, 4
  s_cbranch_scc1 L_wo_chk
  s_load_dwordx2 s[64:65], s[0:1], 72
  s_mov_b32 s79, 0x100000
  s_waitcnt lgkmcnt(0)
  s_and_b32 s65, s65, 0xffff
  s_mov_b32 s66, 256
  s_mov_b32 s67, 0x00020000
  v_lshlrev_b32 v2, 2, v1
L_wo_chkl:
  buffer_load_dword v12, v2, s[64:67], 0 offen sc1
  s_sub_u32 s79, s79, 1
  s_cbranch_scc1 L_wo_chk
  s_waitcnt vmcnt(0)
  v_cmp_ne_u32 vcc, 0x01010101, v12
  s_cbranch_vccnz L_wo_chkl
L_wo_chk:
  s_bfe_i32 s74, s85, 0x80000
  s_add_i32 s74, s74, 0
  s_cmp_lt_i32 s74, 0
  s_cselect_b32 s74, 15, s74
  s_add_u32 s74, s74, s86
  s_and_b32 s74, s74, 15
  s_lshl_b32 s74, s74, 17
  s_add_u32 m0, s77, 131072
  s_add_u32 s4, s74, 0
  buffer_load_dwordx4 v8, s[40:43], s4 offen lds
  s_add_u32 m0, s77, 132096
  s_nop 0
  buffer_load_dwordx4 v9, s[40:43], s4 offen lds
  s_bfe_i32 s74, s85, 0x80008
  s_add_i32 s74, s74, 1
  s_add_u32 s74, s74, s86
  s_and_b32 s74, s74, 15
  s_lshl_b32 s74, s74, 17
  s_add_u32 m0, s77, 139264
  s_add_u32 s4, s74, 0
  buffer_load_dwordx4 v8, s[40:43], s4 offen lds
  s_add_u32 m0, s77, 140288
  s_nop 0
  buffer_load_dwordx4 v9, s[40:43], s4 offen lds
  s_bfe_i32 s74, s85, 0x80010
  s_add_i32 s74, s74, 2
  s_add_u32 s74, s74, s86
  s_and_b32 s74, s74, 15
  s_lshl_b32 s74, s74, 17
  s_add_u32 m0, s77, 147456
  s_add_u32 s4, s74, 0
  buffer_load_dwordx4 v8, s[40:43], s4 offen lds
  s_add_u32 m0, s77, 148480
  s_nop 0
  buffer_load_dwordx4 v9, s[40:43], s4 offen lds
  s_bfe_i32 s74, s85, 0x80018
  s_add_i32 s74, s74, 3
  s_add_u32 s74, s74, s86
  s_and_b32 s74, s74, 15
  s_lshl_b32 s74, s74, 17
  s_add_u32 m0, s77, 155648
  s_add_u32 s4, s74, 0
  buffer_load_dwordx4 v8, s[40:43], s4 offen lds
  s_add_u32 m0, s77, 156672
  s_nop 0
  buffer_load_dwordx4 v9, s[40:43], s4 offen lds
  s_bfe_i32 s74, s85, 0x80000
  s_add_i32 s74, s74, 4
  s_add_u32 s74, s74, s86
  s_and_b32 s74, s74, 15
  s_lshl_b32 s74, s74, 17
  s_add_u32 m0, s77, 28672
  s_add_u32 s4, s74, 0
  buffer_load_dwordx4 v8, s[40:43], s4 offen lds
  s_add_u32 m0, s77, 29696
  s_nop 0
  buffer_load_dwordx4 v9, s[40:43], s4 offen lds
  s_bfe_i32 s74, s85, 0x80008
  s_add_i32 s74, s74, 5
  s_add_u32 s74, s74, s86
  s_and_b32 s74, s74, 15
  s_lshl_b32 s74, s74, 17
  s_add_u32 m0, s77, 36864
  s_add_u32 s4, s74, 0
  buffer_load_dwordx4 v8, s[40:43], s4 offen lds
  s_add_u32 m0, s77, 37888
  s_nop 0
  buffer_load_dwordx4 v9, s[40:43], s4 offen lds
  s_add_u32 s44, s22, 24903680
  s_addc_u32 s45, s23, 0
  s_and_b32 s45, s45, 0xffff
  s_mov_b32 s46, 32768
  s_mov_b32 s47, 0x00020000
  s_cmp_lg_u32 s96, 0
  s_cbranch_scc1 L_wo_nofirst
  s_waitcnt vmcnt(12)
  s_mov_b32 s7, 0xffff0000
  v_lshlrev_b32 v32, 16, v64
  v_and_b32 v33, s7, v64
  v_lshlrev_b32 v34, 16, v65
  v_and_b32 v35, s7, v65
  v_lshlrev_b32 v36, 16, v66
  v_and_b32 v37, s7, v66
  v_lshlrev_b32 v38, 16, v67
  v_and_b32 v39, s7, v67
  v_lshlrev_b32 v40, 16, v68
  v_and_b32 v41, s7, v68
  v_pk_add_f32 v[32:33], v[32:33], v[40:41]
  v_lshlrev_b32 v40, 16, v69
  v_and_b32 v41, s7, v69
  v_pk_add_f32 v[34:35], v[34:35], v[40:41]
  v_lshlrev_b32 v40, 16, v70
  v_and_b32 v41, s7, v70
  v_pk_add_f32 v[36:37], v[36:37], v[40:41]
  v_lshlrev_b32 v40, 16, v71
  v_and_b32 v41, s7, v71
  v_pk_add_f32 v[38:39], v[38:39], v[40:41]
  v_lshlrev_b32 v40, 16, v72
  v_and_b32 v41, s7, v72
  v_pk_add_f32 v[32:33], v[32:33], v[40:41]
  v_lshlrev_b32 v40, 16, v73
  v_and_b32 v41, s7, v73
  v_pk_add_f32 v[34:35], v[34:35], v[40:41]
  v_lshlrev_b32 v40, 16, v74
  v_and_b32 v41, s7, v74
  v_pk_add_f32 v[36:37], v[36:37], v[40:41]
  v_lshlrev_b32 v40, 16, v75
  v_and_b32 v41, s7, v75
  v_pk_add_f32 v[38:39], v[38:39], v[40:41]
  v_lshlrev_b32 v40, 16, v76
  v_and_b32 v41, s7, v76
  v_pk_add_f32 v[32:33], v[32:33], v[40:41]
  v_lshlrev_b32 v40, 16, v77
  v_and_b32 v41, s7, v77
  v_pk_add_f32 v[34:35], v[34:35], v[40:41]
  v_lshlrev_b32 v40, 16, v78
  v_and_b32 v41, s7, v78
  v_pk_add_f32 v[36:37], v[36:37], v[40:41]
  v_lshlrev_b32 v40, 16, v79
  v_and_b32 v41, s7, v79
  v_pk_add_f32 v[38:39], v[38:39], v[40:41]
  v_lshlrev_b32 v40, 16, v80
  v_and_b32 v41, s7, v80
  v_pk_add_f32 v[32:33], v[32:33], v[40:41]
  v_lshlrev_b32 v40, 16, v81
  v_and_b32 v41, s7, v81
  v_pk_add_f32 v[34:35], v[34:35], v[40:41]
  v_lshlrev_b32 v40, 16, v82
  v_and_b32 v41, s7, v82
  v_pk_add_f32 v[36:37], v[36:37], v[40:41]
  v_lshlrev_b32 v40, 16, v83
  v_and_b32 v41, s7, v83
  v_pk_add_f32 v[38:39], v[38:39], v[40:41]
  v_lshlrev_b32 v40, 16, v84
  v_and_b32 v41, s7, v84
  v_pk_add_f32 v[32:33], v[32:33], v[40:41]
  v_lshlrev_b32 v40, 16, v85
  v_and_b32 v41, s7, v85
  v_pk_add_f32 v[34:35], v[34:35], v[40:41]
  v_lshlrev_b32 v40, 16, v86
  v_and_b32 v41, s7, v86
  v_pk_add_f32 v[36:37], v[36:37], v[40:41]
  v_lshlrev_b32 v40, 16, v87
  v_and_b32 v41, s7, v87
  v_pk_add_f32 v[38:39], v[38:39], v[40:41]
  v_lshlrev_b32 v40, 16, v88
  v_and_b32 v41, s7, v88
  v_pk_add_f32 v[32:33], v[32:33], v[40:41]
  v_lshlrev_b32 v40, 16, v89
  v_and_b32 v41, s7, v89
  v_pk_add_f32 v[34:35], v[34:35], v[40:41]
  v_lshlrev_b32 v40, 16, v90
  v_and_b32 v41, s7, v90
  v_pk_add_f32 v[36:37], v[36:37], v[40:41]
  v_lshlrev_b32 v40, 16, v91
  v_and_b32 v41, s7, v91
  v_pk_add_f32 v[38:39], v[38:39], v[40:41]
  v_lshlrev_b32 v40, 16, v92
  v_and_b32 v41, s7, v92
  v_pk_add_f32 v[32:33], v[32:33], v[40:41]
  v_lshlrev_b32 v40, 16, v93
  v_and_b32 v41, s7, v93
  v_pk_add_f32 v[34:35], v[34:35], v[40:41]
  v_lshlrev_b32 v40, 16, v94
  v_and_b32 v41, s7, v94
  v_pk_add_f32 v[36:37], v[36:37], v[40:41]
  v_lshlrev_b32 v40, 16, v95
  v_and_b32 v41, s7, v95
  v_pk_add_f32 v[38:39], v[38:39], v[40:41]
  s_add_u32 s52, s22, 24641536
  s_addc_u32 s53, s23, 0
  s_and_b32 s53, s53, 0xffff
  s_mov_b32 s54, 262144
  s_mov_b32 s55, 0x00020000
  v_permlane32_swap_b32 v32, v36
  v_permlane32_swap_b32 v33, v37
  v_permlane32_swap_b32 v34, v38
  v_permlane32_swap_b32 v35, v39
  v_add_f32 v32, v32, v36
  v_add_f32 v33, v33, v37
  v_add_f32 v34, v34, v38
  v_add_f32 v35, v35, v39
  v_and_b32 v2, 7, v1
  v_lshlrev_b32 v2, 5, v2
  v_permlane16_swap_b32 v32, v34
  v_permlane16_swap_b32 v33, v35
  v_add_f32 v32, v32, v34
  v_add_f32 v33, v33, v35
  v_lshrrev_b32 v3, 4, v1
  v_lshl_add_u32 v2, v3, 3, v2
  v_add_f32_dpp v32, v32, v32 row_ror:8 row_mask:0xf bank_mask:0xf
  v_add_f32_dpp v33, v33, v33 row_ror:8 row_mask:0xf bank_mask:0xf
  buffer_store_dwordx2 v[32:33], v2, s[52:55], s94 offen sc1
  s_waitcnt vmcnt(0)
L_wo_nofirst:
  s_lshl_b32 s3, s97, 12
  s_lshl_b32 s4, s68, 8
  s_add_u32 s3, s3, s4
  s_sub_u32 s3, s3, 4096
  v_and_b32 v2, 15, v1
  v_lshlrev_b32 v2, 2, v2
  v_mov_b32 v3, 1
  s_mov_b32 s79, 0x100000
  s_cmp_lg_u32 s70, 4
  s_barrier
  s_cbranch_scc1 L_wo_nofl
  s_mov_b64 exec, 1
  buffer_store_dword v3, off, s[44:47], s87 sc1
  s_mov_b64 exec, -1
L_wo_nofl:
  s_mov_b32 s5, s3
  s_bfe_i32 s74, s85, 0x80010
  s_add_i32 s74, s74, 6
  s_add_u32 s74, s74, s86
  s_and_b32 s74, s74, 15
  s_lshl_b32 s74, s74, 17
  s_add_u32 m0, s77, 45056
  s_add_u32 s4, s74, 0
  buffer_load_dwordx4 v8, s[40:43], s4 offen lds
  s_add_u32 m0, s77, 46080
  s_nop 0
  buffer_load_dwordx4 v9, s[40:43], s4 offen lds
  s_bfe_i32 s74, s85, 0x80018
  s_add_i32 s74, s74, 7
  s_add_u32 s74, s74, s86
  s_and_b32 s74, s74, 15
  s_lshl_b32 s74, s74, 17
  s_add_u32 m0, s77, 53248
  s_add_u32 s4, s74, 0
  buffer_load_dwordx4 v8, s[40:43], s4 offen lds
  s_add_u32 m0, s77, 54272
  s_nop 0
  buffer_load_dwordx4 v9, s[40:43], s4 offen lds
  s_bfe_i32 s74, s85, 0x80000
  s_add_i32 s74, s74, 8
  s_add_u32 s74, s74, s86
  s_and_b32 s74, s74, 15
  s_lshl_b32 s74, s74, 17
  s_add_u32 m0, s77, 61440
  s_add_u32 s4, s74, 0
  buffer_load_dwordx4 v8, s[40:43], s4 offen lds
  s_add_u32 m0, s77, 62464
  s_nop 0
  buffer_load_dwordx4 v9, s[40:43], s4 offen lds
  s_bfe_i32 s74, s85, 0x80008
  s_add_i32 s74, s74, 9
  s_add_u32 s74, s74, s86
  s_and_b32 s74, s74, 15
  s_lshl_b32 s74, s74, 17
  s_add_u32 m0, s77, 69632
  s_add_u32 s4, s74, 0
  buffer_load_dwordx4 v8, s[40:43], s4 offen lds
  s_add_u32 m0, s77, 70656
  s_nop 0
  buffer_load_dwordx4 v9, s[40:43], s4 offen lds
  s_bfe_i32 s74, s85, 0x80010
  s_add_i32 s74, s74, 10
  s_add_u32 s74, s74, s86
  s_and_b32 s74, s74, 15
  s_lshl_b32 s74, s74, 17
  s_add_u32 m0, s77, 77824
  s_add_u32 s4, s74, 0
  buffer_load_dwordx4 v8, s[40:43], s4 offen lds
  s_add_u32 m0, s77, 78848
  s_nop 0
  buffer_load_dwordx4 v9, s[40:43], s4 offen lds
  s_bfe_i32 s74, s85, 0x80018
  s_add_i32 s74, s74, 11
  s_add_u32 s74, s74, s86
  s_and_b32 s74, s74, 15
  s_lshl_b32 s74, s74, 17
  s_add_u32 m0, s77, 86016
  s_add_u32 s4, s74, 0
  buffer_load_dwordx4 v8, s[40:43], s4 offen lds
  s_add_u32 m0, s77, 87040
  s_nop 0
  buffer_load_dwordx4 v9, s[40:43], s4 offen lds
  s_bfe_i32 s74, s85, 0x80000
  s_add_i32 s74, s74, 12
  s_add_u32 s74, s74, s86
  s_and_b32 s74, s74, 15
  s_lshl_b32 s74, s74, 17
  s_add_u32 m0, s77, 94208
  s_add_u32 s4, s74, 0
  buffer_load_dwordx4 v8, s[40:43], s4 offen lds
  s_add_u32 m0, s77, 95232
  s_nop 0
  buffer_load_dwordx4 v9, s[40:43], s4 offen lds
  s_bfe_i32 s74, s85, 0x80008
  s_add_i32 s74, s74, 13
  s_sub_u32 s3, s74, 16
  s_cmp_ge_i32 s74, 16
  s_cselect_b32 s74, s3, s74
  s_add_u32 s74, s74, s86
  s_and_b32 s74, s74, 15
  s_lshl_b32 s74, s74, 17
  s_add_u32 m0, s77, 102400
  s_add_u32 s4, s74, 0
  buffer_load_dwordx4 v8, s[40:43], s4 offen lds
  s_add_u32 m0, s77, 103424
  s_nop 0
  buffer_load_dwordx4 v9, s[40:43], s4 offen lds
  s_bfe_i32 s74, s85, 0x80010
  s_add_i32 s74, s74, 14
  s_sub_u32 s3, s74, 16
  s_cmp_ge_i32 s74, 16
  s_cselect_b32 s74, s3, s74
  s_add_u32 s74, s74, s86
  s_and_b32 s74, s74, 15
  s_lshl_b32 s74, s74, 17
  s_add_u32 m0, s77, 110592
  s_add_u32 s4, s74, 0
  buffer_load_dwordx4 v8, s[40:43], s4 offen lds
  s_add_u32 m0, s77, 111616
  s_nop 0
  buffer_load_dwordx4 v9, s[40:43], s4 offen lds
  s_bfe_i32 s74, s85, 0x80018
  s_add_i32 s74, s74, 15
  s_sub_u32 s3, s74, 16
  s_cmp_ge_i32 s74, 16
  s_cselect_b32 s74, s3, s74
  s_add_u32 s74, s74, s86
  s_and_b32 s74, s74, 15
  s_lshl_b32 s74, s74, 17
  s_add_u32 m0, s77, 118784
  s_add_u32 s4, s74, 0
  buffer_load_dwordx4 v8, s[40:43], s4 offen lds
  s_add_u32 m0, s77, 119808
  s_nop 0
  buffer_load_dwordx4 v9, s[40:43], s4 offen lds
  s_mov_b32 s3, s5
  s_cmp_lg_u32 s70, 4
  s_cbranch_scc1 L_wo_dep
L_wo_poll:
  buffer_load_dword v3, v2, s[44:47], s3 offen sc1
  s_sub_u32 s79, s79, 1
  s_cbranch_scc1 L_wo_dep
  s_waitcnt vmcnt(0)
  v_cmp_ne_u32 vcc, 1, v3
  s_cbranch_vccnz L_wo_poll
L_wo_dep:
  s_waitcnt vmcnt(24) lgkmcnt(0)
  s_barrier
  s_waitcnt vmcnt(16)
  s_barrier
  s_waitcnt vmcnt(8)
  s_barrier
  s_waitcnt vmcnt(0)
  s_barrier
  s_waitcnt vmcnt(0)
  s_barrier
  s_lshl_b32 s87, s97, 12
  s_lshl_b32 s4, s68, 8
  s_add_u32 s87, s87, s4
  s_lshl_b32 s4, s69, 2
  s_add_u32 s87, s87, s4
  s_add_u32 s97, s97, 1
  s_branch L_w1_body
L_wo_end:
  s_endpgm
L_wo_compute:
  v_and_b32 v3, 15, v1
  v_lshrrev_b32 v2, 4, v1
  s_lshl_b32 s8, s68, 7
  s_lshl_b32 s9, s70, 5
  s_add_u32 s8, s8, s9
  s_mul_i32 s9, s8, 2048
  v_lshl_add_u32 v4, v1, 4, s9
  v_add_u32 v5, 32768, v4
  v_add_u32 v13, s8, v3
  s_lshl_b32 s10, s69, 7
  v_lshl_add_u32 v14, v2, 3, s10
  v_and_b32 v16, 1, v2
  v_lshrrev_b32 v17, 1, v2
  v_lshl_add_u32 v16, v16, 1, v17
  v_lshlrev_b32 v16, 8, v16
  v_lshl_add_u32 v16, v3, 4, v16
  s_add_u32 s9, s8, s69
  s_lshl_b32 s9, s9, 11
  v_add_u32 v12, s9, v16
  v_lshl_add_u32 v18, v17, 4, v13
  v_lshlrev_b32 v18, 3, v18
  v_and_b32 v16, 1, v2
  v_lshl_add_u32 v18, v16, 2, v18
  s_lshl_b32 s10, s69, 14
  v_add_u32 v18, s10, v18
  v_bfe_u32 v6, v1, 2, 2
  v_lshl_add_u32 v6, v2, 3, v6
  v_lshlrev_b32 v6, 7, v6
  v_and_b32 v17, 3, v1
  v_lshl_add_u32 v6, v17, 3, v6
  v_bfe_u32 v17, v1, 3, 2
  v_lshl_add_u32 v6, v17, 5, v6
  v_xor_b32 v7, 32, v6
  v_xor_b32 v8, 64, v6
  v_xor_b32 v9, 96, v6
  s_mov_b32 s11, 0xffff0000
  s_mov_b32 s75, 131072
  s_add_u32 s3, s68, s69
  s_lshl_b32 s3, s3, 3
  s_lshl_b32 s8, 0xffff02, s3
  s_sub_u32 s3, 0, s3
  s_lshr_b32 s3, 0xffff02, s3
  s_or_b32 s8, s8, s3
  s_bfe_i32 s64, s8, 0x80000
  s_add_i32 s64, s64, 0
  s_cmp_lt_i32 s64, 0
  s_cselect_b32 s64, 15, s64
  s_lshl_b32 s64, s64, 11
  s_bfe_i32 s65, s8, 0x80008
  s_add_i32 s65, s65, 1
  s_lshl_b32 s65, s65, 11
  s_bfe_i32 s66, s8, 0x80010
  s_add_i32 s66, s66, 2
  s_lshl_b32 s66, s66, 11
  s_bfe_i32 s67, s8, 0x80018
  s_add_i32 s67, s67, 3
  s_lshl_b32 s67, s67, 11
  s_and_b32 s100, s68, 3
  s_lshl_b32 s100, s100, 13
  s_mov_b32 s101, s100
  s_mov_b32 s36, s34
  s_and_b32 s37, s35, 0xffff
  s_mov_b32 s38, 4194304
  s_mov_b32 s39, 0x00020000
  s_add_u32 s44, s34, 4194304
  s_addc_u32 s45, s35, 0
  s_and_b32 s45, s45, 0xffff
  s_mov_b32 s46, 4194304
  s_mov_b32 s47, 0x00020000
  s_add_u32 s56, s34, 24117248
  s_addc_u32 s57, s35, 0
  s_and_b32 s57, s57, 0xffff
  s_mov_b32 s58, 262144
  s_mov_b32 s59, 0x00020000
  s_cmp_lg_u32 s96, 0
  s_cbranch_scc1 L_pfc2_skip
  s_getpc_b64 s[4:5]
L_pfc2:
  s_lshl_b32 s3, s99, 2
  s_add_u32 s3, s3, s70
  s_mul_i32 s3, s3, 128
  s_min_u32 s3, s3, L_w1_c1-L_w1_c0-128
  s_add_i32 s3, s3, L_w1_c0-L_pfc2
  s_ashr_i32 s6, s3, 31
  s_add_u32 s4, s4, s3
  s_addc_u32 s5, s5, s6
  s_load_dword s40, s[4:5], 0
  s_load_dword s41, s[4:5], 64
L_pfc2_skip:
  v_add_u32_e64 v26, s75, v6
  v_add_u32_e64 v27, s75, v7
  v_add_u32_e64 v28, s75, v8
  v_add_u32_e64 v29, s75, v9
  s_add_u32 s75, s75, 32768
  s_cmp_eq_u32 s75, 163840
  s_cselect_b32 s75, 28672, s75
  s_mov_b32 s79, 4
  s_add_u32 s73, s101, s64
  s_and_b32 s73, s73, 0x7fff
  s_mov_b32 s48, s73
  s_add_u32 s73, s101, s65
  s_and_b32 s73, s73, 0x7fff
  s_mov_b32 s49, s73
  s_add_u32 s73, s101, s66
  s_and_b32 s73, s73, 0x7fff
  s_mov_b32 s50, s73
  s_waitcnt lgkmcnt(0)
  s_barrier
  buffer_load_dwordx4 v[32:35], v4, s[36:39], s48 offen offset:0
  buffer_load_dwordx4 v[40:43], v4, s[36:39], s48 offen offset:1024
  buffer_load_dwordx4 v[36:39], v5, s[36:39], s48 offen offset:0
  buffer_load_dwordx4 v[44:47], v5, s[36:39], s48 offen offset:1024
  buffer_load_dwordx4 v[48:51], v4, s[36:39], s49 offen offset:0
  buffer_load_dwordx4 v[56:59], v4, s[36:39], s49 offen offset:1024
  buffer_load_dwordx4 v[52:55], v5, s[36:39], s49 offen offset:0
  buffer_load_dwordx4 v[60:63], v5, s[36:39], s49 offen offset:1024
  buffer_load_dwordx4 v[64:67], v4, s[36:39], s50 offen offset:0
  buffer_load_dwordx4 v[72:75], v4, s[36:39], s50 offen offset:1024
  buffer_load_dwordx4 v[68:71], v5, s[36:39], s50 offen offset:0
  buffer_load_dwordx4 v[76:79], v5, s[36:39], s50 offen offset:1024
  ds_read_b64_tr_b16 v[160:161], v26 offset:0
  ds_read_b64_tr_b16 v[162:163], v26 offset:512
  ds_read_b64_tr_b16 v[164:165], v27 offset:0
  ds_read_b64_tr_b16 v[166:167], v27 offset:512
  ds_read_b64_tr_b16 v[168:169], v28 offset:0
  ds_read_b64_tr_b16 v[170:171], v28 offset:512
  ds_read_b64_tr_b16 v[172:173], v29 offset:0
  ds_read_b64_tr_b16 v[174:175], v29 offset:512
  ds_read_b64_tr_b16 v[176:177], v26 offset:4096
  ds_read_b64_tr_b16 v[178:179], v26 offset:4608
  ds_read_b64_tr_b16 v[180:181], v27 offset:4096
  ds_read_b64_tr_b16 v[182:183], v27 offset:4608
  ds_read_b64_tr_b16 v[184:185], v28 offset:4096
  ds_read_b64_tr_b16 v[186:187], v28 offset:4608
  ds_read_b64_tr_b16 v[188:189], v29 offset:4096
  ds_read_b64_tr_b16 v[190:191], v29 offset:4608
  v_permlane16_swap_b32 v240, v242
  v_permlane16_swap_b32 v241, v243
  v_permlane16_swap_b32 v244, v246
  v_permlane16_swap_b32 v245, v247
  v_permlane16_swap_b32 v248, v250
  v_permlane16_swap_b32 v249, v251
  v_permlane16_swap_b32 v252, v254
  v_permlane16_swap_b32 v253, v255
  v_lshlrev_b32 v96, 16, v240
  v_and_b32 v97, s11, v240
  v_lshlrev_b32 v98, 16, v241
  v_and_b32 v99, s11, v241
  v_lshlrev_b32 v100, 16, v248
  v_and_b32 v101, s11, v248
  v_lshlrev_b32 v102, 16, v249
  v_and_b32 v103, s11, v249
  v_lshlrev_b32 v104, 16, v242
  v_and_b32 v105, s11, v242
  v_lshlrev_b32 v106, 16, v243
  v_and_b32 v107, s11, v243
  v_lshlrev_b32 v108, 16, v250
  v_and_b32 v109, s11, v250
  v_lshlrev_b32 v110, 16, v251
  v_and_b32 v111, s11, v251
  v_lshlrev_b32 v112, 16, v244
  v_and_b32 v113, s11, v244
  v_lshlrev_b32 v114, 16, v245
  v_and_b32 v115, s11, v245
  v_lshlrev_b32 v116, 16, v252
  v_and_b32 v117, s11, v252
  v_lshlrev_b32 v118, 16, v253
  v_and_b32 v119, s11, v253
  v_lshlrev_b32 v120, 16, v246
  v_and_b32 v121, s11, v246
  v_lshlrev_b32 v122, 16, v247
  v_and_b32 v123, s11, v247
  v_lshlrev_b32 v124, 16, v254
  v_and_b32 v125, s11, v254
  v_lshlrev_b32 v126, 16, v255
  v_and_b32 v127, s11, v255
.p2align 3
L_wo_loop:
  s_waitcnt vmcnt(8) lgkmcnt(0)
  v_mfma_f32_16x16x32_bf16 v[96:99], v[160:163], v[32:35], v[96:99]
  ds_read_b64_tr_b16 v[192:193], v26 offset:8192
  ds_read_b64_tr_b16 v[194:195], v26 offset:8704
  v_mfma_f32_16x16x32_bf16 v[100:103], v[160:163], v[36:39], v[100:103]
  ds_read_b64_tr_b16 v[196:197], v27 offset:8192
  ds_read_b64_tr_b16 v[198:199], v27 offset:8704
  v_mfma_f32_16x16x32_bf16 v[104:107], v[164:167], v[32:35], v[104:107]
  ds_read_b64_tr_b16 v[200:201], v28 offset:8192
  ds_read_b64_tr_b16 v[202:203], v28 offset:8704
  v_mfma_f32_16x16x32_bf16 v[108:111], v[164:167], v[36:39], v[108:111]
  ds_read_b64_tr_b16 v[204:205], v29 offset:8192
  ds_read_b64_tr_b16 v[206:207], v29 offset:8704
  v_mfma_f32_16x16x32_bf16 v[112:115], v[168:171], v[32:35], v[112:115]
  ds_read_b64_tr_b16 v[208:209], v26 offset:12288
  ds_read_b64_tr_b16 v[210:211], v26 offset:12800
  v_mfma_f32_16x16x32_bf16 v[116:119], v[168:171], v[36:39], v[116:119]
  ds_read_b64_tr_b16 v[212:213], v27 offset:12288
  ds_read_b64_tr_b16 v[214:215], v27 offset:12800
  v_mfma_f32_16x16x32_bf16 v[120:123], v[172:175], v[32:35], v[120:123]
  ds_read_b64_tr_b16 v[216:217], v28 offset:12288
  ds_read_b64_tr_b16 v[218:219], v28 offset:12800
  v_mfma_f32_16x16x32_bf16 v[124:127], v[172:175], v[36:39], v[124:127]
  ds_read_b64_tr_b16 v[220:221], v29 offset:12288
  ds_read_b64_tr_b16 v[222:223], v29 offset:12800
  v_mfma_f32_16x16x32_bf16 v[96:99], v[176:179], v[40:43], v[96:99]
  s_add_u32 s73, s101, s67
  s_and_b32 s73, s73, 0x7fff
  v_mfma_f32_16x16x32_bf16 v[100:103], v[176:179], v[44:47], v[100:103]
  buffer_load_dwordx4 v[80:83], v4, s[36:39], s73 offen offset:0
  v_mfma_f32_16x16x32_bf16 v[104:107], v[180:183], v[40:43], v[104:107]
  buffer_load_dwordx4 v[88:91], v4, s[36:39], s73 offen offset:1024
  v_mfma_f32_16x16x32_bf16 v[108:111], v[180:183], v[44:47], v[108:111]
  buffer_load_dwordx4 v[84:87], v5, s[36:39], s73 offen offset:0
  v_mfma_f32_16x16x32_bf16 v[112:115], v[184:187], v[40:43], v[112:115]
  buffer_load_dwordx4 v[92:95], v5, s[36:39], s73 offen offset:1024
  v_mfma_f32_16x16x32_bf16 v[116:119], v[184:187], v[44:47], v[116:119]
  s_add_u32 s101, s101, 8192
  v_mfma_f32_16x16x32_bf16 v[120:123], v[188:191], v[40:43], v[120:123]
  s_sub_u32 s79, s79, 1
  s_cmp_eq_u32 s79, 0
  s_cselect_b32 s38, 0, s38
  v_mfma_f32_16x16x32_bf16 v[124:127], v[188:191], v[44:47], v[124:127]
  s_waitcnt vmcnt(8) lgkmcnt(0)
  v_mfma_f32_16x16x32_bf16 v[96:99], v[192:195], v[48:51], v[96:99]
  ds_read_b64_tr_b16 v[160:161], v26 offset:16384
  ds_read_b64_tr_b16 v[162:163], v26 offset:16896
  v_mfma_f32_16x16x32_bf16 v[100:103], v[192:195], v[52:55], v[100:103]
  ds_read_b64_tr_b16 v[164:165], v27 offset:16384
  ds_read_b64_tr_b16 v[166:167], v27 offset:16896
  v_mfma_f32_16x16x32_bf16 v[104:107], v[196:199], v[48:51], v[104:107]
  ds_read_b64_tr_b16 v[168:169], v28 offset:16384
  ds_read_b64_tr_b16 v[170:171], v28 offset:16896
  v_mfma_f32_16x16x32_bf16 v[108:111], v[196:199], v[52:55], v[108:111]
  ds_read_b64_tr_b16 v[172:173], v29 offset:16384
  ds_read_b64_tr_b16 v[174:175], v29 offset:16896
  v_mfma_f32_16x16x32_bf16 v[112:115], v[200:203], v[48:51], v[112:115]
  ds_read_b64_tr_b16 v[176:177], v26 offset:20480
  ds_read_b64_tr_b16 v[178:179], v26 offset:20992
  v_mfma_f32_16x16x32_bf16 v[116:119], v[200:203], v[52:55], v[116:119]
  ds_read_b64_tr_b16 v[180:181], v27 offset:20480
  ds_read_b64_tr_b16 v[182:183], v27 offset:20992
  v_mfma_f32_16x16x32_bf16 v[120:123], v[204:207], v[48:51], v[120:123]
  ds_read_b64_tr_b16 v[184:185], v28 offset:20480
  ds_read_b64_tr_b16 v[186:187], v28 offset:20992
  v_mfma_f32_16x16x32_bf16 v[124:127], v[204:207], v[52:55], v[124:127]
  ds_read_b64_tr_b16 v[188:189], v29 offset:20480
  ds_read_b64_tr_b16 v[190:191], v29 offset:20992
  v_mfma_f32_16x16x32_bf16 v[96:99], v[208:211], v[56:59], v[96:99]
  s_add_u32 s73, s101, s64
  s_and_b32 s73, s73, 0x7fff
  v_mfma_f32_16x16x32_bf16 v[100:103], v[208:211], v[60:63], v[100:103]
  buffer_load_dwordx4 v[32:35], v4, s[36:39], s73 offen offset:0
  v_mfma_f32_16x16x32_bf16 v[104:107], v[212:215], v[56:59], v[104:107]
  buffer_load_dwordx4 v[40:43], v4, s[36:39], s73 offen offset:1024
  v_mfma_f32_16x16x32_bf16 v[108:111], v[212:215], v[60:63], v[108:111]
  buffer_load_dwordx4 v[36:39], v5, s[36:39], s73 offen offset:0
  v_mfma_f32_16x16x32_bf16 v[112:115], v[216:219], v[56:59], v[112:115]
  buffer_load_dwordx4 v[44:47], v5, s[36:39], s73 offen offset:1024
  v_mfma_f32_16x16x32_bf16 v[116:119], v[216:219], v[60:63], v[116:119]
  v_mfma_f32_16x16x32_bf16 v[120:123], v[220:223], v[56:59], v[120:123]
  v_mfma_f32_16x16x32_bf16 v[124:127], v[220:223], v[60:63], v[124:127]
  s_waitcnt vmcnt(8) lgkmcnt(0)
  v_mfma_f32_16x16x32_bf16 v[96:99], v[160:163], v[64:67], v[96:99]
  ds_read_b64_tr_b16 v[192:193], v26 offset:24576
  ds_read_b64_tr_b16 v[194:195], v26 offset:25088
  v_mfma_f32_16x16x32_bf16 v[100:103], v[160:163], v[68:71], v[100:103]
  ds_read_b64_tr_b16 v[196:197], v27 offset:24576
  ds_read_b64_tr_b16 v[198:199], v27 offset:25088
  v_mfma_f32_16x16x32_bf16 v[104:107], v[164:167], v[64:67], v[104:107]
  ds_read_b64_tr_b16 v[200:201], v28 offset:24576
  ds_read_b64_tr_b16 v[202:203], v28 offset:25088
  v_mfma_f32_16x16x32_bf16 v[108:111], v[164:167], v[68:71], v[108:111]
  ds_read_b64_tr_b16 v[204:205], v29 offset:24576
  ds_read_b64_tr_b16 v[206:207], v29 offset:25088
  v_mfma_f32_16x16x32_bf16 v[112:115], v[168:171], v[64:67], v[112:115]
  ds_read_b64_tr_b16 v[208:209], v26 offset:28672
  ds_read_b64_tr_b16 v[210:211], v26 offset:29184
  v_mfma_f32_16x16x32_bf16 v[116:119], v[168:171], v[68:71], v[116:119]
  ds_read_b64_tr_b16 v[212:213], v27 offset:28672
  ds_read_b64_tr_b16 v[214:215], v27 offset:29184
  v_mfma_f32_16x16x32_bf16 v[120:123], v[172:175], v[64:67], v[120:123]
  ds_read_b64_tr_b16 v[216:217], v28 offset:28672
  ds_read_b64_tr_b16 v[218:219], v28 offset:29184
  v_mfma_f32_16x16x32_bf16 v[124:127], v[172:175], v[68:71], v[124:127]
  ds_read_b64_tr_b16 v[220:221], v29 offset:28672
  ds_read_b64_tr_b16 v[222:223], v29 offset:29184
  v_mfma_f32_16x16x32_bf16 v[96:99], v[176:179], v[72:75], v[96:99]
  s_add_u32 s73, s101, s65
  s_and_b32 s73, s73, 0x7fff
  v_mfma_f32_16x16x32_bf16 v[100:103], v[176:179], v[76:79], v[100:103]
  buffer_load_dwordx4 v[48:51], v4, s[36:39], s73 offen offset:0
  v_mfma_f32_16x16x32_bf16 v[104:107], v[180:183], v[72:75], v[104:107]
  buffer_load_dwordx4 v[56:59], v4, s[36:39], s73 offen offset:1024
  v_mfma_f32_16x16x32_bf16 v[108:111], v[180:183], v[76:79], v[108:111]
  buffer_load_dwordx4 v[52:55], v5, s[36:39], s73 offen offset:0
  v_mfma_f32_16x16x32_bf16 v[112:115], v[184:187], v[72:75], v[112:115]
  buffer_load_dwordx4 v[60:63], v5, s[36:39], s73 offen offset:1024
  v_mfma_f32_16x16x32_bf16 v[116:119], v[184:187], v[76:79], v[116:119]
  v_mfma_f32_16x16x32_bf16 v[120:123], v[188:191], v[72:75], v[120:123]
  v_mfma_f32_16x16x32_bf16 v[124:127], v[188:191], v[76:79], v[124:127]
  s_waitcnt vmcnt(8) lgkmcnt(0)
  s_barrier
  v_mfma_f32_16x16x32_bf16 v[96:99], v[192:195], v[80:83], v[96:99]
  v_add_u32_e64 v26, s75, v6
  v_add_u32_e64 v27, s75, v7
  v_add_u32_e64 v28, s75, v8
  v_mfma_f32_16x16x32_bf16 v[100:103], v[192:195], v[84:87], v[100:103]
  v_add_u32_e64 v29, s75, v9
  s_add_u32 s75, s75, 32768
  s_cmp_eq_u32 s75, 163840
  v_mfma_f32_16x16x32_bf16 v[104:107], v[196:199], v[80:83], v[104:107]
  s_cselect_b32 s75, 28672, s75
  ds_read_b64_tr_b16 v[160:161], v26 offset:0
  ds_read_b64_tr_b16 v[162:163], v26 offset:512
  v_mfma_f32_16x16x32_bf16 v[108:111], v[196:199], v[84:87], v[108:111]
  ds_read_b64_tr_b16 v[164:165], v27 offset:0
  ds_read_b64_tr_b16 v[166:167], v27 offset:512
  ds_read_b64_tr_b16 v[168:169], v28 offset:0
  v_mfma_f32_16x16x32_bf16 v[112:115], v[200:203], v[80:83], v[112:115]
  ds_read_b64_tr_b16 v[170:171], v28 offset:512
  ds_read_b64_tr_b16 v[172:173], v29 offset:0
  ds_read_b64_tr_b16 v[174:175], v29 offset:512
  v_mfma_f32_16x16x32_bf16 v[116:119], v[200:203], v[84:87], v[116:119]
  ds_read_b64_tr_b16 v[176:177], v26 offset:4096
  ds_read_b64_tr_b16 v[178:179], v26 offset:4608
  ds_read_b64_tr_b16 v[180:181], v27 offset:4096
  v_mfma_f32_16x16x32_bf16 v[120:123], v[204:207], v[80:83], v[120:123]
  ds_read_b64_tr_b16 v[182:183], v27 offset:4608
  ds_read_b64_tr_b16 v[184:185], v28 offset:4096
  ds_read_b64_tr_b16 v[186:187], v28 offset:4608
  v_mfma_f32_16x16x32_bf16 v[124:127], v[204:207], v[84:87], v[124:127]
  ds_read_b64_tr_b16 v[188:189], v29 offset:4096
  ds_read_b64_tr_b16 v[190:191], v29 offset:4608
  v_mfma_f32_16x16x32_bf16 v[96:99], v[208:211], v[88:91], v[96:99]
  s_add_u32 s73, s101, s66
  s_and_b32 s73, s73, 0x7fff
  v_mfma_f32_16x16x32_bf16 v[100:103], v[208:211], v[92:95], v[100:103]
  buffer_load_dwordx4 v[64:67], v4, s[36:39], s73 offen offset:0
  v_mfma_f32_16x16x32_bf16 v[104:107], v[212:215], v[88:91], v[104:107]
  buffer_load_dwordx4 v[72:75], v4, s[36:39], s73 offen offset:1024
  v_mfma_f32_16x16x32_bf16 v[108:111], v[212:215], v[92:95], v[108:111]
  buffer_load_dwordx4 v[68:71], v5, s[36:39], s73 offen offset:0
  v_mfma_f32_16x16x32_bf16 v[112:115], v[216:219], v[88:91], v[112:115]
  buffer_load_dwordx4 v[76:79], v5, s[36:39], s73 offen offset:1024
  v_mfma_f32_16x16x32_bf16 v[116:119], v[216:219], v[92:95], v[116:119]
  s_cmp_lg_u32 s79, 0
  v_mfma_f32_16x16x32_bf16 v[120:123], v[220:223], v[88:91], v[120:123]
  v_mfma_f32_16x16x32_bf16 v[124:127], v[220:223], v[92:95], v[124:127]
  s_cbranch_scc1 L_wo_loop
  v_mov_b32 v20, 0
  v_mov_b32 v21, 0
  v_mov_b32 v22, 0
  v_mov_b32 v23, 0
  s_mov_b32 s3, 32768
  s_mov_b32 s10, 0x3f803f80
  s_nop 4
  v_cvt_pk_bf16_f32 v240, v96, v97
  v_cvt_pk_bf16_f32 v241, v98, v99
  v_cvt_pk_bf16_f32 v242, v104, v105
  v_cvt_pk_bf16_f32 v243, v106, v107
  s_nop 1
  v_permlane16_swap_b32 v240, v242
  v_permlane16_swap_b32 v241, v243
  buffer_store_dwordx4 v[240:243], v12, s[44:47], 0 offen offset:0 sc1
  v_cvt_pk_bf16_f32 v244, v112, v113
  v_cvt_pk_bf16_f32 v245, v114, v115
  v_cvt_pk_bf16_f32 v246, v120, v121
  v_cvt_pk_bf16_f32 v247, v122, v123
  s_nop 1
  v_permlane16_swap_b32 v244, v246
  v_permlane16_swap_b32 v245, v247
  buffer_store_dwordx4 v[244:247], v12, s[44:47], 0 offen offset:1024 sc1
  v_cvt_pk_bf16_f32 v248, v100, v101
  v_cvt_pk_bf16_f32 v249, v102, v103
  v_cvt_pk_bf16_f32 v250, v108, v109
  v_cvt_pk_bf16_f32 v251, v110, v111
  s_nop 1
  v_permlane16_swap_b32 v248, v250
  v_permlane16_swap_b32 v249, v251
  buffer_store_dwordx4 v[248:251], v12, s[44:47], s3 offen offset:0 sc1
  v_cvt_pk_bf16_f32 v252, v116, v117
  v_cvt_pk_bf16_f32 v253, v118, v119
  v_cvt_pk_bf16_f32 v254, v124, v125
  v_cvt_pk_bf16_f32 v255, v126, v127
  s_nop 1
  v_permlane16_swap_b32 v252, v254
  v_permlane16_swap_b32 v253, v255
  buffer_store_dwordx4 v[252:255], v12, s[44:47], s3 offen offset:1024 sc1
  v_dot2_f32_bf16 v20, v240, s10, v20
  v_dot2_f32_bf16 v22, v240, v240, v22
  v_dot2_f32_bf16 v20, v241, s10, v20
  v_dot2_f32_bf16 v22, v241, v241, v22
  v_dot2_f32_bf16 v20, v242, s10, v20
  v_dot2_f32_bf16 v22, v242, v242, v22
  v_dot2_f32_bf16 v20, v243, s10, v20
  v_dot2_f32_bf16 v22, v243, v243, v22
  v_dot2_f32_bf16 v20, v244, s10, v20
  v_dot2_f32_bf16 v22, v244, v244, v22
  v_dot2_f32_bf16 v20, v245, s10, v20
  v_dot2_f32_bf16 v22, v245, v245, v22
  v_dot2_f32_bf16 v20, v246, s10, v20
  v_dot2_f32_bf16 v22, v246, v246, v22
  v_dot2_f32_bf16 v20, v247, s10, v20
  v_dot2_f32_bf16 v22, v247, v247, v22
  v_dot2_f32_bf16 v21, v248, s10, v21
  v_dot2_f32_bf16 v23, v248, v248, v23
  v_dot2_f32_bf16 v21, v249, s10, v21
  v_dot2_f32_bf16 v23, v249, v249, v23
  v_dot2_f32_bf16 v21, v250, s10, v21
  v_dot2_f32_bf16 v23, v250, v250, v23
  v_dot2_f32_bf16 v21, v251, s10, v21
  v_dot2_f32_bf16 v23, v251, v251, v23
  v_dot2_f32_bf16 v21, v252, s10, v21
  v_dot2_f32_bf16 v23, v252, v252, v23
  v_dot2_f32_bf16 v21, v253, s10, v21
  v_dot2_f32_bf16 v23, v253, v253, v23
  v_dot2_f32_bf16 v21, v254, s10, v21
  v_dot2_f32_bf16 v23, v254, v254, v23
  v_dot2_f32_bf16 v21, v255, s10, v21
  v_dot2_f32_bf16 v23, v255, v255, v23
  s_nop 2
  v_permlane32_swap_b32 v20, v21
  v_permlane32_swap_b32 v22, v23
  v_add_f32 v20, v20, v21
  v_add_f32 v22, v22, v23
  s_nop 1
  v_permlane16_swap_b32 v20, v22
  v_add_f32 v20, v20, v22
  buffer_store_dword v20, v18, s[56:59], 0 offen sc1
  s_waitcnt vmcnt(0) lgkmcnt(0)
  s_barrier
  s_add_u32 s97, s97, 1
  s_branch L_w1_body
L_wo_c1:
L_w1_c0:
L_w1_body:
  s_cmp_ge_u32 s2, 256
  s_cbranch_scc1 L_w1_end
  v_lshrrev_b32 v2, 6, v0
  v_and_b32 v1, 63, v0
  v_readfirstlane_b32 s70, v2
  s_and_b32 s3, s2, 7
  s_lshr_b32 s99, s2, 3
  s_and_b32 s5, s3, 1
  s_lshl_b32 s5, s5, 3
  s_and_b32 s6, s99, 7
  s_add_u32 s68, s5, s6
  s_lshr_b32 s5, s3, 1
  s_lshl_b32 s5, s5, 2
  s_lshr_b32 s6, s99, 3
  s_add_u32 s69, s5, s6
  s_cmp_lt_u32 s70, 4
  s_cbranch_scc1 L_w1_compute
L_w1_loader:
  s_add_u32 s8, s70, s69
  s_and_b32 s8, s8, 3
  s_add_u32 s9, s70, s68
  s_and_b32 s9, s9, 3
  s_lshl_b32 s76, s8, 12
  s_lshl_b32 s77, s9, 11
  s_add_u32 s77, s77, 16384
  s_lshl_b32 s11, s68, 7
  v_and_b32 v10, 7, v1
  s_lshr_b32 s10, s76, 11
  s_lshl_b32 s3, s68, 3
  s_add_u32 s10, s10, s3
  s_mul_i32 s10, s10, 32768
  v_lshl_add_u32 v4, v1, 4, s10
  v_add_u32 v5, 32768, v4
  v_lshrrev_b32 v3, 3, v1
  s_lshl_b32 s10, s9, 4
  v_add_u32 v3, s10, v3
  v_mul_u32_u24 v3, 7168, v3
  v_lshrrev_b32 v2, 3, v1
  v_and_b32 v2, 2, v2
  v_xor_b32 v2, v2, v10
  s_mul_i32 s10, s69, 128
  v_add_u32 v3, s10, v3
  v_lshl_add_u32 v8, v2, 4, v3
  v_xor_b32 v2, 4, v2
  v_add_u32 v3, 57344, v3
  v_lshl_add_u32 v9, v2, 4, v3
  v_lshrrev_b32 v3, 2, v1
  s_lshl_b32 s10, s9, 4
  v_add_u32 v3, s10, v3
  v_mul_u32_u24 v3, 7168, v3
  v_lshrrev_b32 v2, 4, v1
  v_and_b32 v2, 2, v2
  v_xor_b32 v2, v2, v1
  v_and_b32 v2, 3, v2
  s_lshl_b32 s10, s69, 6
  s_add_u32 s10, s10, 2048
  v_add_u32 v3, s10, v3
  v_lshl_add_u32 v28, v2, 4, v3
  s_lshl_b32 s78, s69, 7
  s_add_u32 s78, s78, 3072
  s_mov_b32 s75, 0
  s_add_u32 s100, s68, s69
  s_mov_b32 s101, -1
  s_add_u32 s101, s101, 1
  s_sub_u32 s73, s101, s100
  s_lshl_b32 s73, s73, 3
  s_lshr_b32 s73, 0xf0f02, s73
  s_and_b32 s73, s73, 255
  s_add_u32 s73, s73, s101
  s_and_b32 s73, s73, 15
  s_mul_i32 s74, s73, 458752
  s_lshl_b32 s73, s73, 11
  s_waitcnt lgkmcnt(0)
  s_add_u32 s36, s34, 4194304
  s_addc_u32 s37, s35, 0
  s_and_b32 s37, s37, 0xffff
  s_mov_b32 s38, 4194304
  s_mov_b32 s39, 0x00020000
  s_mov_b32 s40, s24
  s_and_b32 s41, s25, 0xffff
  s_mov_b32 s42, 7340032
  s_mov_b32 s43, 0x00020000
  s_add_u32 s56, s34, 24117248
  s_addc_u32 s57, s35, 0
  s_and_b32 s57, s57, 0xffff
  s_mov_b32 s58, 262144
  s_mov_b32 s59, 0x00020000
  s_add_u32 s64, s22, 24641536
  s_addc_u32 s65, s23, 0
  s_and_b32 s65, s65, 0xffff
  s_mov_b32 s66, 262144
  s_mov_b32 s67, 0x00020000
  s_mov_b32 s52, s26
  s_and_b32 s53, s27, 0xffff
  s_mov_b32 s54, 7168
  s_mov_b32 s55, 0x00020000
  s_mov_b32 s60, s28
  s_and_b32 s61, s29, 0xffff
  s_mov_b32 s62, 7340032
  s_mov_b32 s63, 0x00020000
  s_cmp_eq_u32 s96, 0
  s_cselect_b32 s62, s62, 0
  s_and_b32 s3, s70, 3
  s_lshl_b32 s4, s2, 2
  s_add_u32 s3, s3, s4
  s_mul_i32 s98, s3, 3584
  s_add_u32 s98, s98, 3670016
  s_add_u32 s3, s96, s70
  s_cmp_lg_u32 s3, 4
  s_cbranch_scc1 L_w1_chk
  s_add_u32 s44, s22, 24903680
  s_addc_u32 s45, s23, 0
  s_and_b32 s45, s45, 0xffff
  s_mov_b32 s46, 32768
  s_mov_b32 s47, 0x00020000
  s_mov_b32 s79, 0x100000
  v_lshrrev_b32 v2, 2, v1
  v_and_b32 v3, 3, v1
  v_lshlrev_b32 v2, 8, v2
  v_lshl_add_u32 v2, v3, 4, v2
L_w1_chkl:
  buffer_load_dwordx4 v[12:15], v2, s[44:47], 0 offen sc1
  s_sub_u32 s79, s79, 1
  s_cbranch_scc1 L_w1_chk
  s_waitcnt vmcnt(0)
  v_and_b32 v12, v12, v13
  v_and_b32 v14, v14, v15
  v_and_b32 v12, v12, v14
  v_cmp_ne_u32 vcc, 1, v12
  s_cbranch_vccnz L_w1_chkl
L_w1_chk:
  s_mov_b32 s88, s73
  s_add_u32 m0, s77, 0
  s_add_u32 s4, s74, 0
  buffer_load_dwordx4 v8, s[40:43], s4 offen lds
  s_add_u32 m0, s77, 1024
  s_nop 0
  buffer_load_dwordx4 v9, s[40:43], s4 offen lds
  s_add_u32 m0, s77, 8192
  s_add_u32 s4, s74, s78
  buffer_load_dwordx4 v8, s[40:43], s4 offen lds
  s_add_u32 m0, s77, 9216
  s_nop 0
  buffer_load_dwordx4 v9, s[40:43], s4 offen lds
  s_add_u32 m0, s77, 16384
  s_add_u32 s4, s4, 128
  buffer_load_dwordx4 v8, s[40:43], s4 offen lds
  s_add_u32 m0, s77, 17408
  s_nop 0
  buffer_load_dwordx4 v9, s[40:43], s4 offen lds
  s_add_u32 m0, s77, 24576
  s_nop 0
  buffer_load_dwordx4 v28, s[40:43], s74 offen lds
  s_add_u32 s101, s101, 1
  s_sub_u32 s73, s101, s100
  s_lshl_b32 s73, s73, 3
  s_lshr_b32 s73, 0xf0f02, s73
  s_and_b32 s73, s73, 255
  s_add_u32 s73, s73, s101
  s_and_b32 s73, s73, 15
  s_mul_i32 s74, s73, 458752
  s_lshl_b32 s73, s73, 11
  s_mov_b32 s89, s73
  s_add_u32 m0, s77, 49152
  s_add_u32 s4, s74, 0
  buffer_load_dwordx4 v8, s[40:43], s4 offen lds
  s_add_u32 m0, s77, 50176
  s_nop 0
  buffer_load_dwordx4 v9, s[40:43], s4 offen lds
  s_add_u32 m0, s77, 57344
  s_add_u32 s4, s74, s78
  buffer_load_dwordx4 v8, s[40:43], s4 offen lds
  s_add_u32 m0, s77, 58368
  s_nop 0
  buffer_load_dwordx4 v9, s[40:43], s4 offen lds
  s_add_u32 m0, s77, 65536
  s_add_u32 s4, s4, 128
  buffer_load_dwordx4 v8, s[40:43], s4 offen lds
  s_add_u32 m0, s77, 66560
  s_nop 0
  buffer_load_dwordx4 v9, s[40:43], s4 offen lds
  s_add_u32 m0, s77, 73728
  s_nop 0
  buffer_load_dwordx4 v28, s[40:43], s74 offen lds
  s_add_u32 s101, s101, 1
  s_sub_u32 s73, s101, s100
  s_lshl_b32 s73, s73, 3
  s_lshr_b32 s73, 0xf0f02, s73
  s_and_b32 s73, s73, 255
  s_add_u32 s73, s73, s101
  s_and_b32 s73, s73, 15
  s_mul_i32 s74, s73, 458752
  s_lshl_b32 s73, s73, 11
  s_mov_b32 s75, 98304
  s_add_u32 s44, s22, 24903680
  s_addc_u32 s45, s23, 0
  s_and_b32 s45, s45, 0xffff
  s_mov_b32 s46, 32768
  s_mov_b32 s47, 0x00020000
  s_lshl_b32 s3, s97, 12
  s_lshl_b32 s4, s68, 8
  s_add_u32 s3, s3, s4
  s_sub_u32 s3, s3, 4096
  v_and_b32 v2, 15, v1
  v_lshlrev_b32 v2, 2, v2
  v_mov_b32 v3, 1
  s_mov_b32 s79, 0x100000
  s_cmp_lg_u32 s70, 4
  s_barrier
  s_cbranch_scc1 L_w1_dep
  s_mov_b64 exec, 1
  buffer_store_dword v3, off, s[44:47], s87 sc1
  s_mov_b64 exec, -1
L_w1_poll:
  buffer_load_dword v3, v2, s[44:47], s3 offen sc1
  s_sub_u32 s79, s79, 1
  s_cbranch_scc1 L_w1_dep
  s_waitcnt vmcnt(0)
  v_cmp_ne_u32 vcc, 1, v3
  s_cbranch_vccnz L_w1_poll
L_w1_dep:
  s_barrier
  s_add_u32 m0, s76, 0
  s_nop 0
  buffer_load_dwordx4 v4, s[36:39], s88 offen offset:0 lds
  buffer_load_dwordx4 v4, s[36:39], s88 offen offset:1024 lds
  s_add_u32 m0, s76, 2048
  s_nop 0
  buffer_load_dwordx4 v5, s[36:39], s88 offen offset:0 lds
  buffer_load_dwordx4 v5, s[36:39], s88 offen offset:1024 lds
  s_add_u32 m0, s76, 49152
  s_nop 0
  buffer_load_dwordx4 v4, s[36:39], s89 offen offset:0 lds
  buffer_load_dwordx4 v4, s[36:39], s89 offen offset:1024 lds
  s_add_u32 m0, s76, 51200
  s_nop 0
  buffer_load_dwordx4 v5, s[36:39], s89 offen offset:0 lds
  buffer_load_dwordx4 v5, s[36:39], s89 offen offset:1024 lds
  s_waitcnt vmcnt(4)
  s_barrier
  s_mov_b32 s79, 13
L_w1_ld1:
  s_add_u32 s3, s75, s76
  s_add_u32 m0, s3, 0
  s_nop 0
  buffer_load_dwordx4 v4, s[36:39], s73 offen offset:0 lds
  buffer_load_dwordx4 v4, s[36:39], s73 offen offset:1024 lds
  s_add_u32 m0, s3, 2048
  s_nop 0
  buffer_load_dwordx4 v5, s[36:39], s73 offen offset:0 lds
  buffer_load_dwordx4 v5, s[36:39], s73 offen offset:1024 lds
  s_add_u32 s3, s75, s77
  s_add_u32 m0, s3, 0
  s_add_u32 s4, s74, 0
  buffer_load_dwordx4 v8, s[40:43], s4 offen lds
  s_add_u32 m0, s3, 1024
  s_nop 0
  buffer_load_dwordx4 v9, s[40:43], s4 offen lds
  s_add_u32 m0, s3, 8192
  s_add_u32 s4, s74, s78
  buffer_load_dwordx4 v8, s[40:43], s4 offen lds
  s_add_u32 m0, s3, 9216
  s_nop 0
  buffer_load_dwordx4 v9, s[40:43], s4 offen lds
  s_add_u32 m0, s3, 16384
  s_add_u32 s4, s4, 128
  buffer_load_dwordx4 v8, s[40:43], s4 offen lds
  s_add_u32 m0, s3, 17408
  s_nop 0
  buffer_load_dwordx4 v9, s[40:43], s4 offen lds
  s_add_u32 m0, s3, 24576
  s_nop 0
  buffer_load_dwordx4 v28, s[40:43], s74 offen lds
  s_add_u32 s101, s101, 1
  s_sub_u32 s73, s101, s100
  s_lshl_b32 s73, s73, 3
  s_lshr_b32 s73, 0xf0f02, s73
  s_and_b32 s73, s73, 255
  s_add_u32 s73, s73, s101
  s_and_b32 s73, s73, 15
  s_mul_i32 s74, s73, 458752
  s_lshl_b32 s73, s73, 11
  s_add_u32 s75, s75, 49152
  s_cmp_eq_u32 s75, 147456
  s_cselect_b32 s75, 0, s75
  s_buffer_load_dword s84, s[60:63], s98 offset:0
  s_buffer_load_dword s84, s[60:63], s98 offset:64
  s_buffer_load_dword s84, s[60:63], s98 offset:128
  s_buffer_load_dword s84, s[60:63], s98 offset:192
  s_add_u32 s98, s98, 256
  s_waitcnt vmcnt(11)
  s_barrier
  s_sub_u32 s79, s79, 1
  s_cmp_lg_u32 s79, 0
  s_cbranch_scc1 L_w1_ld1
  s_add_u32 s3, s75, s76
  s_add_u32 m0, s3, 0
  s_nop 0
  buffer_load_dwordx4 v4, s[36:39], s73 offen offset:0 lds
  buffer_load_dwordx4 v4, s[36:39], s73 offen offset:1024 lds
  s_add_u32 m0, s3, 2048
  s_nop 0
  buffer_load_dwordx4 v5, s[36:39], s73 offen offset:0 lds
  buffer_load_dwordx4 v5, s[36:39], s73 offen offset:1024 lds
  s_add_u32 s3, s75, s77
  s_add_u32 m0, s3, 0
  s_add_u32 s4, s74, 0
  buffer_load_dwordx4 v8, s[40:43], s4 offen lds
  s_add_u32 m0, s3, 1024
  s_nop 0
  buffer_load_dwordx4 v9, s[40:43], s4 offen lds
  s_add_u32 m0, s3, 8192
  s_add_u32 s4, s74, s78
  buffer_load_dwordx4 v8, s[40:43], s4 offen lds
  s_add_u32 m0, s3, 9216
  s_nop 0
  buffer_load_dwordx4 v9, s[40:43], s4 offen lds
  s_add_u32 m0, s3, 16384
  s_add_u32 s4, s4, 128
  buffer_load_dwordx4 v8, s[40:43], s4 offen lds
  s_add_u32 m0, s3, 17408
  s_nop 0
  buffer_load_dwordx4 v9, s[40:43], s4 offen lds
  s_add_u32 m0, s3, 24576
  s_nop 0
  buffer_load_dwordx4 v28, s[40:43], s74 offen lds
  s_add_u32 s101, s101, 1
  s_sub_u32 s73, s101, s100
  s_lshl_b32 s73, s73, 3
  s_lshr_b32 s73, 0xf0f02, s73
  s_and_b32 s73, s73, 255
  s_add_u32 s73, s73, s101
  s_and_b32 s73, s73, 15
  s_mul_i32 s74, s73, 458752
  s_lshl_b32 s73, s73, 11
  s_add_u32 s75, s75, 49152
  s_cmp_eq_u32 s75, 147456
  s_cselect_b32 s75, 0, s75
  s_buffer_load_dword s84, s[60:63], s98 offset:0
  s_buffer_load_dword s84, s[60:63], s98 offset:64
  s_buffer_load_dword s84, s[60:63], s98 offset:128
  s_buffer_load_dword s84, s[60:63], s98 offset:192
  s_add_u32 s98, s98, 256
  s_and_b32 s3, s70, 3
  s_lshl_b32 s4, s68, 7
  s_lshl_b32 s5, s3, 6
  s_add_u32 s5, s5, s4
  v_add_u32 v2, s5, v1
  s_sub_u32 s4, s4, 16
  v_and_b32 v3, 15, v1
  v_add_u32 v3, s4, v3
  v_max_i32 v3, 0, v3
  s_cmp_ge_u32 s3, 2
  s_cselect_b64 vcc, -1, 0
  v_cndmask_b32 v2, v2, v3, vcc
  v_lshlrev_b32 v2, 3, v2
  s_mov_b32 s3, 0
  buffer_load_dwordx2 v[32:33], v2, s[56:59], s3 offen
  s_add_u32 s3, s3, 16384
  buffer_load_dwordx2 v[34:35], v2, s[56:59], s3 offen
  s_add_u32 s3, s3, 16384
  buffer_load_dwordx2 v[36:37], v2, s[56:59], s3 offen
  s_add_u32 s3, s3, 16384
  buffer_load_dwordx2 v[38:39], v2, s[56:59], s3 offen
  s_add_u32 s3, s3, 16384
  buffer_load_dwordx2 v[40:41], v2, s[56:59], s3 offen
  s_add_u32 s3, s3, 16384
  buffer_load_dwordx2 v[42:43], v2, s[56:59], s3 offen
  s_add_u32 s3, s3, 16384
  buffer_load_dwordx2 v[44:45], v2, s[56:59], s3 offen
  s_add_u32 s3, s3, 16384
  buffer_load_dwordx2 v[46:47], v2, s[56:59], s3 offen
  s_add_u32 s3, s3, 16384
  buffer_load_dwordx2 v[48:49], v2, s[56:59], s3 offen
  s_add_u32 s3, s3, 16384
  buffer_load_dwordx2 v[50:51], v2, s[56:59], s3 offen
  s_add_u32 s3, s3, 16384
  buffer_load_dwordx2 v[52:53], v2, s[56:59], s3 offen
  s_add_u32 s3, s3, 16384
  buffer_load_dwordx2 v[54:55], v2, s[56:59], s3 offen
  s_add_u32 s3, s3, 16384
  buffer_load_dwordx2 v[56:57], v2, s[56:59], s3 offen
  s_add_u32 s3, s3, 16384
  buffer_load_dwordx2 v[58:59], v2, s[56:59], s3 offen
  s_add_u32 s3, s3, 16384
  buffer_load_dwordx2 v[60:61], v2, s[56:59], s3 offen
  s_add_u32 s3, s3, 16384
  buffer_load_dwordx2 v[62:63], v2, s[56:59], s3 offen
  s_lshl_b32 s4, s69, 7
  s_lshl_b32 s5, s70, 6
  s_add_u32 s4, s4, s5
  s_add_u32 s4, s4, 1216
  s_lshl_b32 s5, s69, 6
  s_cmp_eq_u32 s70, 4
  s_cselect_b32 s4, s5, s4
  s_lshr_b32 s5, s5, 1
  s_add_u32 s5, s5, 1024
  s_cmp_eq_u32 s70, 7
  s_cselect_b32 s4, s5, s4
  v_add_u32 v3, s4, v1
  v_lshlrev_b32 v2, 2, v3
  v_lshlrev_b32 v3, 1, v3
  s_mov_b32 s3, 0
  buffer_load_dword v64, v2, s[64:67], s3 offen
  s_add_u32 s3, s3, 16384
  buffer_load_dword v65, v2, s[64:67], s3 offen
  s_add_u32 s3, s3, 16384
  buffer_load_dword v66, v2, s[64:67], s3 offen
  s_add_u32 s3, s3, 16384
  buffer_load_dword v67, v2, s[64:67], s3 offen
  s_add_u32 s3, s3, 16384
  buffer_load_dword v68, v2, s[64:67], s3 offen
  s_add_u32 s3, s3, 16384
  buffer_load_dword v69, v2, s[64:67], s3 offen
  s_add_u32 s3, s3, 16384
  buffer_load_dword v70, v2, s[64:67], s3 offen
  s_add_u32 s3, s3, 16384
  buffer_load_dword v71, v2, s[64:67], s3 offen
  s_add_u32 s3, s3, 16384
  buffer_load_dword v72, v2, s[64:67], s3 offen
  s_add_u32 s3, s3, 16384
  buffer_load_dword v73, v2, s[64:67], s3 offen
  s_add_u32 s3, s3, 16384
  buffer_load_dword v74, v2, s[64:67], s3 offen
  s_add_u32 s3, s3, 16384
  buffer_load_dword v75, v2, s[64:67], s3 offen
  s_add_u32 s3, s3, 16384
  buffer_load_dword v76, v2, s[64:67], s3 offen
  s_add_u32 s3, s3, 16384
  buffer_load_dword v77, v2, s[64:67], s3 offen
  s_add_u32 s3, s3, 16384
  buffer_load_dword v78, v2, s[64:67], s3 offen
  s_add_u32 s3, s3, 16384
  buffer_load_dword v79, v2, s[64:67], s3 offen
  buffer_load_ushort v80, v3, s[52:55], 0 offen
  s_waitcnt vmcnt(44)
  s_barrier
  s_waitcnt vmcnt(33)
  s_barrier
  s_waitcnt vmcnt(0)
  v_add_f32 v32, v32, v34
  v_add_f32 v33, v33, v35
  v_add_f32 v48, v48, v50
  v_add_f32 v49, v49, v51
  v_add_f32 v32, v32, v36
  v_add_f32 v33, v33, v37
  v_add_f32 v48, v48, v52
  v_add_f32 v49, v49, v53
  v_add_f32 v32, v32, v38
  v_add_f32 v33, v33, v39
  v_add_f32 v48, v48, v54
  v_add_f32 v49, v49, v55
  v_add_f32 v32, v32, v40
  v_add_f32 v33, v33, v41
  v_add_f32 v48, v48, v56
  v_add_f32 v49, v49, v57
  v_add_f32 v32, v32, v42
  v_add_f32 v33, v33, v43
  v_add_f32 v48, v48, v58
  v_add_f32 v49, v49, v59
  v_add_f32 v32, v32, v44
  v_add_f32 v33, v33, v45
  v_add_f32 v48, v48, v60
  v_add_f32 v49, v49, v61
  v_add_f32 v32, v32, v46
  v_add_f32 v33, v33, v47
  v_add_f32 v48, v48, v62
  v_add_f32 v49, v49, v63
  v_add_f32 v32, v32, v48
  v_add_f32 v33, v33, v49
  v_mul_f32 v32, 0x3a800000, v32
  v_mul_f32 v33, 0x3a800000, v33
  v_fma_f32 v33, -v32, v32, v33
  v_max_f32 v33, 0, v33
  v_add_f32 v33, 0x3727c5ac, v33
  v_rsq_f32 v33, v33
  s_nop 0
  s_and_b32 s3, s70, 3
  s_lshl_b32 s5, s3, 6
  s_add_u32 s5, s5, 16
  v_add_u32 v2, s5, v1
  v_and_b32 v3, 15, v1
  s_cmp_ge_u32 s3, 2
  s_cselect_b64 vcc, -1, 0
  v_cndmask_b32 v2, v2, v3, vcc
  v_lshlrev_b32 v2, 2, v2
  v_add_u32 v2, 147456, v2
  ds_write2_b32 v2, v32, v33 offset0:0 offset1:160
  v_add_f32 v64, v64, v72
  v_add_f32 v65, v65, v73
  v_add_f32 v66, v66, v74
  v_add_f32 v67, v67, v75
  v_add_f32 v68, v68, v76
  v_add_f32 v69, v69, v77
  v_add_f32 v70, v70, v78
  v_add_f32 v71, v71, v79
  v_add_f32 v64, v64, v68
  v_add_f32 v65, v65, v69
  v_add_f32 v66, v66, v70
  v_add_f32 v67, v67, v71
  v_add_f32 v64, v64, v65
  v_add_f32 v66, v66, v67
  v_add_f32 v64, v64, v66
  v_lshlrev_b32 v80, 16, v80
  v_lshlrev_b32 v2, 2, v0
  v_add_u32 v2, 147712, v2
  ds_write_b32 v2, v64
  ds_write_b32 v2, v80 offset:1024
  s_waitcnt lgkmcnt(0)
  s_barrier
  s_lshl_b32 s87, s97, 12
  s_lshl_b32 s4, s68, 8
  s_add_u32 s87, s87, s4
  s_lshl_b32 s4, s69, 2
  s_add_u32 s87, s87, s4
  s_add_u32 s97, s97, 1
  s_branch L_w2_body
L_w1_end:
  s_endpgm
L_w1_compute:
  s_and_b32 s71, s70, 1
  s_lshr_b32 s72, s70, 1
  v_and_b32 v3, 15, v1
  v_lshrrev_b32 v2, 4, v1
  s_lshl_b32 s8, s71, 13
  v_lshl_add_u32 v4, v1, 4, s8
  v_bfe_u32 v13, v1, 2, 2
  v_lshl_add_u32 v13, v2, 3, v13
  v_lshlrev_b32 v13, 7, v13
  v_and_b32 v17, 3, v1
  v_lshl_add_u32 v13, v17, 3, v13
  v_bfe_u32 v17, v1, 3, 2
  v_lshl_add_u32 v13, v17, 5, v13
  s_lshl_b32 s9, s72, 6
  v_xor_b32 v13, s9, v13
  v_add_u32 v5, 16384, v13
  v_xor_b32 v6, 32, v5
  v_and_b32 v16, 1, v2
  v_lshrrev_b32 v17, 1, v2
  v_bfe_u32 v13, v1, 2, 2
  v_lshl_add_u32 v13, v16, 3, v13
  v_lshl_add_u32 v13, v17, 5, v13
  v_xor_b32 v14, s72, v16
  v_lshl_add_u32 v13, v13, 1, v14
  v_and_b32 v14, 3, v1
  v_lshl_add_u32 v13, v13, 2, v14
  v_lshlrev_b32 v13, 3, v13
  v_add_u32 v7, 40960, v13
  s_lshl_b32 s8, s68, 7
  s_lshl_b32 s9, s71, 6
  s_add_u32 s8, s8, s9
  s_mul_i32 s8, s8, 7168
  v_lshlrev_b32 v14, 8, v17
  v_lshl_add_u32 v14, v3, 4, v14
  v_add_u32 v14, s8, v14
  s_lshl_b32 s10, s69, 11
  s_lshl_b32 s9, s72, 10
  s_add_u32 s9, s9, s10
  v_lshl_add_u32 v12, v16, 9, v14
  v_add_u32 v12, s9, v12
  v_mul_u32_u24 v16, 114688, v16
  s_lshr_b32 s9, s9, 1
  v_add3_u32 v13, v16, v14, s9
  s_lshl_b32 s9, s71, 8
  s_add_u32 s9, s9, 147520
  v_lshl_add_u32 v14, v3, 2, s9
  s_lshl_b32 s9, s72, 7
  s_add_u32 s9, s9, 148736
  v_lshl_add_u32 v15, v2, 4, s9
  s_lshl_b32 s9, s72, 6
  s_add_u32 s9, s9, 148736
  v_lshl_add_u32 v16, v2, 4, s9
  v_mov_b32 v128, 0
  v_mov_b32 v129, 0
  v_mov_b32 v130, 0
  v_mov_b32 v131, 0
  v_mov_b32 v132, 0
  v_mov_b32 v133, 0
  v_mov_b32 v134, 0
  v_mov_b32 v135, 0
  v_mov_b32 v136, 0
  v_mov_b32 v137, 0
  v_mov_b32 v138, 0
  v_mov_b32 v139, 0
  v_mov_b32 v140, 0
  v_mov_b32 v141, 0
  v_mov_b32 v142, 0
  v_mov_b32 v143, 0
  v_mov_b32 v144, 0
  v_mov_b32 v145, 0
  v_mov_b32 v146, 0
  v_mov_b32 v147, 0
  v_mov_b32 v148, 0
  v_mov_b32 v149, 0
  v_mov_b32 v150, 0
  v_mov_b32 v151, 0
  v_mov_b32 v152, 0
  v_mov_b32 v153, 0
  v_mov_b32 v154, 0
  v_mov_b32 v155, 0
  v_mov_b32 v156, 0
  v_mov_b32 v157, 0
  v_mov_b32 v158, 0
  v_mov_b32 v159, 0
  v_mov_b32 v160, 0
  v_mov_b32 v161, 0
  v_mov_b32 v162, 0
  v_mov_b32 v163, 0
  v_mov_b32 v164, 0
  v_mov_b32 v165, 0
  v_mov_b32 v166, 0
  v_mov_b32 v167, 0
  v_mov_b32 v168, 0
  v_mov_b32 v169, 0
  v_mov_b32 v170, 0
  v_mov_b32 v171, 0
  v_mov_b32 v172, 0
  v_mov_b32 v173, 0
  v_mov_b32 v174, 0
  v_mov_b32 v175, 0
  v_mov_b32 v176, 0
  v_mov_b32 v177, 0
  v_mov_b32 v178, 0
  v_mov_b32 v179, 0
  v_mov_b32 v180, 0
  v_mov_b32 v181, 0
  v_mov_b32 v182, 0
  v_mov_b32 v183, 0
  v_mov_b32 v184, 0
  v_mov_b32 v185, 0
  v_mov_b32 v186, 0
  v_mov_b32 v187, 0
  v_mov_b32 v188, 0
  v_mov_b32 v189, 0
  v_mov_b32 v190, 0
  v_mov_b32 v191, 0
  v_mov_b32 v192, 0
  v_mov_b32 v193, 0
  v_mov_b32 v194, 0
  v_mov_b32 v195, 0
  v_mov_b32 v196, 0
  v_mov_b32 v197, 0
  v_mov_b32 v198, 0
  v_mov_b32 v199, 0
  v_mov_b32 v200, 0
  v_mov_b32 v201, 0
  v_mov_b32 v202, 0
  v_mov_b32 v203, 0
  v_mov_b32 v204, 0
  v_mov_b32 v205, 0
  v_mov_b32 v206, 0
  v_mov_b32 v207, 0
  v_mov_b32 v208, 0
  v_mov_b32 v209, 0
  v_mov_b32 v210, 0
  v_mov_b32 v211, 0
  v_mov_b32 v212, 0
  v_mov_b32 v213, 0
  v_mov_b32 v214, 0
  v_mov_b32 v215, 0
  v_mov_b32 v216, 0
  v_mov_b32 v217, 0
  v_mov_b32 v218, 0
  v_mov_b32 v219, 0
  v_mov_b32 v220, 0
  v_mov_b32 v221, 0
  v_mov_b32 v222, 0
  v_mov_b32 v223, 0
  v_mov_b32 v224, 0
  v_mov_b32 v225, 0
  v_mov_b32 v226, 0
  v_mov_b32 v227, 0
  v_mov_b32 v228, 0
  v_mov_b32 v229, 0
  v_mov_b32 v230, 0
  v_mov_b32 v231, 0
  v_mov_b32 v232, 0
  v_mov_b32 v233, 0
  v_mov_b32 v234, 0
  v_mov_b32 v235, 0
  v_mov_b32 v236, 0
  v_mov_b32 v237, 0
  v_mov_b32 v238, 0
  v_mov_b32 v239, 0
  s_waitcnt lgkmcnt(0)
  s_add_u32 s44, s34, 8388608
  s_addc_u32 s45, s35, 0
  s_and_b32 s45, s45, 0xffff
  s_mov_b32 s46, 14680064
  s_mov_b32 s47, 0x00020000
  s_cmp_lg_u32 s96, 0
  s_cbranch_scc1 L_pfc3_skip
  s_getpc_b64 s[4:5]
L_pfc3:
  s_lshl_b32 s3, s99, 2
  s_add_u32 s3, s3, s70
  s_mul_i32 s3, s3, 128
  s_min_u32 s3, s3, L_w2_c1-L_w2_c0-128
  s_add_i32 s3, s3, L_w2_c0-L_pfc3
  s_ashr_i32 s6, s3, 31
  s_add_u32 s4, s4, s3
  s_addc_u32 s5, s5, s6
  s_load_dword s36, s[4:5], 0
  s_load_dword s37, s[4:5], 64
L_pfc3_skip:
  s_mov_b32 s75, 0
  v_add_u32_e64 v20, s75, v4
  v_add_u32_e64 v21, s75, v5
  v_add_u32_e64 v22, s75, v6
  v_add_u32_e64 v23, s75, v7
  s_add_u32 s75, s75, 49152
  s_cmp_eq_u32 s75, 147456
  s_cselect_b32 s75, 0, s75
  s_mov_b32 s79, 16
  s_barrier
  s_barrier
  ds_read_b128 v[32:35], v20 offset:0
  ds_read_b128 v[36:39], v20 offset:2048
  ds_read_b128 v[40:43], v20 offset:4096
  ds_read_b128 v[44:47], v20 offset:6144
  ds_read_b64_tr_b16 v[48:49], v21 offset:0
  ds_read_b64_tr_b16 v[50:51], v21 offset:512
  ds_read_b64_tr_b16 v[52:53], v22 offset:0
  ds_read_b64_tr_b16 v[54:55], v22 offset:512
  ds_read_b64_tr_b16 v[56:57], v21 offset:8192
  ds_read_b64_tr_b16 v[58:59], v21 offset:8704
  ds_read_b64_tr_b16 v[60:61], v22 offset:8192
  ds_read_b64_tr_b16 v[62:63], v22 offset:8704
  ds_read_b64_tr_b16 v[64:65], v21 offset:16384
  ds_read_b64_tr_b16 v[66:67], v21 offset:16896
  ds_read_b64_tr_b16 v[68:69], v22 offset:16384
  ds_read_b64_tr_b16 v[70:71], v22 offset:16896
  ds_read_b64_tr_b16 v[72:73], v23 offset:0
  ds_read_b64_tr_b16 v[74:75], v23 offset:256
  s_waitcnt lgkmcnt(0)
.p2align 3
L_w1_loop:
  v_mfma_f32_16x16x32_bf16 v[128:131], v[48:51], v[32:35], v[128:131]
  ds_read_b128 v[80:83], v20 offset:1024
  v_mfma_f32_16x16x32_bf16 v[132:135], v[48:51], v[36:39], v[132:135]
  ds_read_b128 v[84:87], v20 offset:3072
  v_mfma_f32_16x16x32_bf16 v[136:139], v[48:51], v[40:43], v[136:139]
  ds_read_b128 v[88:91], v20 offset:5120
  v_mfma_f32_16x16x32_bf16 v[140:143], v[48:51], v[44:47], v[140:143]
  ds_read_b128 v[92:95], v20 offset:7168
  v_mfma_f32_16x16x32_bf16 v[144:147], v[52:55], v[32:35], v[144:147]
  ds_read_b64_tr_b16 v[96:97], v21 offset:4096
  v_mfma_f32_16x16x32_bf16 v[148:151], v[52:55], v[36:39], v[148:151]
  ds_read_b64_tr_b16 v[98:99], v21 offset:4608
  v_mfma_f32_16x16x32_bf16 v[152:155], v[52:55], v[40:43], v[152:155]
  ds_read_b64_tr_b16 v[100:101], v22 offset:4096
  v_mfma_f32_16x16x32_bf16 v[156:159], v[52:55], v[44:47], v[156:159]
  ds_read_b64_tr_b16 v[102:103], v22 offset:4608
  v_mfma_f32_16x16x32_bf16 v[160:163], v[56:59], v[32:35], v[160:163]
  ds_read_b64_tr_b16 v[104:105], v21 offset:12288
  v_mfma_f32_16x16x32_bf16 v[164:167], v[56:59], v[36:39], v[164:167]
  ds_read_b64_tr_b16 v[106:107], v21 offset:12800
  v_mfma_f32_16x16x32_bf16 v[168:171], v[56:59], v[40:43], v[168:171]
  ds_read_b64_tr_b16 v[108:109], v22 offset:12288
  v_mfma_f32_16x16x32_bf16 v[172:175], v[56:59], v[44:47], v[172:175]
  ds_read_b64_tr_b16 v[110:111], v22 offset:12800
  v_mfma_f32_16x16x32_bf16 v[176:179], v[60:63], v[32:35], v[176:179]
  ds_read_b64_tr_b16 v[112:113], v21 offset:20480
  v_mfma_f32_16x16x32_bf16 v[180:183], v[60:63], v[36:39], v[180:183]
  ds_read_b64_tr_b16 v[114:115], v21 offset:20992
  v_mfma_f32_16x16x32_bf16 v[184:187], v[60:63], v[40:43], v[184:187]
  ds_read_b64_tr_b16 v[116:117], v22 offset:20480
  v_mfma_f32_16x16x32_bf16 v[188:191], v[60:63], v[44:47], v[188:191]
  ds_read_b64_tr_b16 v[118:119], v22 offset:20992
  v_mfma_f32_16x16x32_bf16 v[192:195], v[64:67], v[32:35], v[192:195]
  ds_read_b64_tr_b16 v[120:121], v23 offset:4096
  v_mfma_f32_16x16x32_bf16 v[196:199], v[64:67], v[36:39], v[196:199]
  ds_read_b64_tr_b16 v[122:123], v23 offset:4352
  v_mfma_f32_16x16x32_bf16 v[200:203], v[64:67], v[40:43], v[200:203]
  v_add_u32_e64 v20, s75, v4
  v_mfma_f32_16x16x32_bf16 v[204:207], v[64:67], v[44:47], v[204:207]
  v_add_u32_e64 v21, s75, v5
  v_mfma_f32_16x16x32_bf16 v[208:211], v[68:71], v[32:35], v[208:211]
  v_add_u32_e64 v22, s75, v6
  v_mfma_f32_16x16x32_bf16 v[212:215], v[68:71], v[36:39], v[212:215]
  v_add_u32_e64 v23, s75, v7
  v_mfma_f32_16x16x32_bf16 v[216:219], v[68:71], v[40:43], v[216:219]
  s_add_u32 s75, s75, 49152
  v_mfma_f32_16x16x32_bf16 v[220:223], v[68:71], v[44:47], v[220:223]
  s_cmp_eq_u32 s75, 147456
  v_mfma_f32_16x16x32_bf16 v[224:227], v[72:75], v[32:35], v[224:227]
  s_cselect_b32 s75, 0, s75
  s_sub_u32 s79, s79, 1
  v_mfma_f32_16x16x32_bf16 v[228:231], v[72:75], v[36:39], v[228:231]
  v_mfma_f32_16x16x32_bf16 v[232:235], v[72:75], v[40:43], v[232:235]
  v_mfma_f32_16x16x32_bf16 v[236:239], v[72:75], v[44:47], v[236:239]
  s_waitcnt lgkmcnt(0)
  s_barrier
  v_mfma_f32_16x16x32_bf16 v[128:131], v[96:99], v[80:83], v[128:131]
  ds_read_b128 v[32:35], v20 offset:0
  v_mfma_f32_16x16x32_bf16 v[132:135], v[96:99], v[84:87], v[132:135]
  ds_read_b128 v[36:39], v20 offset:2048
  v_mfma_f32_16x16x32_bf16 v[136:139], v[96:99], v[88:91], v[136:139]
  ds_read_b128 v[40:43], v20 offset:4096
  v_mfma_f32_16x16x32_bf16 v[140:143], v[96:99], v[92:95], v[140:143]
  ds_read_b128 v[44:47], v20 offset:6144
  v_mfma_f32_16x16x32_bf16 v[144:147], v[100:103], v[80:83], v[144:147]
  ds_read_b64_tr_b16 v[48:49], v21 offset:0
  v_mfma_f32_16x16x32_bf16 v[148:151], v[100:103], v[84:87], v[148:151]
  ds_read_b64_tr_b16 v[50:51], v21 offset:512
  v_mfma_f32_16x16x32_bf16 v[152:155], v[100:103], v[88:91], v[152:155]
  ds_read_b64_tr_b16 v[52:53], v22 offset:0
  v_mfma_f32_16x16x32_bf16 v[156:159], v[100:103], v[92:95], v[156:159]
  ds_read_b64_tr_b16 v[54:55], v22 offset:512
  v_mfma_f32_16x16x32_bf16 v[160:163], v[104:107], v[80:83], v[160:163]
  ds_read_b64_tr_b16 v[56:57], v21 offset:8192
  v_mfma_f32_16x16x32_bf16 v[164:167], v[104:107], v[84:87], v[164:167]
  ds_read_b64_tr_b16 v[58:59], v21 offset:8704
  v_mfma_f32_16x16x32_bf16 v[168:171], v[104:107], v[88:91], v[168:171]
  ds_read_b64_tr_b16 v[60:61], v22 offset:8192
  v_mfma_f32_16x16x32_bf16 v[172:175], v[104:107], v[92:95], v[172:175]
  ds_read_b64_tr_b16 v[62:63], v22 offset:8704
  v_mfma_f32_16x16x32_bf16 v[176:179], v[108:111], v[80:83], v[176:179]
  ds_read_b64_tr_b16 v[64:65], v21 offset:16384
  v_mfma_f32_16x16x32_bf16 v[180:183], v[108:111], v[84:87], v[180:183]
  ds_read_b64_tr_b16 v[66:67], v21 offset:16896
  v_mfma_f32_16x16x32_bf16 v[184:187], v[108:111], v[88:91], v[184:187]
  ds_read_b64_tr_b16 v[68:69], v22 offset:16384
  v_mfma_f32_16x16x32_bf16 v[188:191], v[108:111], v[92:95], v[188:191]
  ds_read_b64_tr_b16 v[70:71], v22 offset:16896
  v_mfma_f32_16x16x32_bf16 v[192:195], v[112:115], v[80:83], v[192:195]
  ds_read_b64_tr_b16 v[72:73], v23 offset:0
  v_mfma_f32_16x16x32_bf16 v[196:199], v[112:115], v[84:87], v[196:199]
  ds_read_b64_tr_b16 v[74:75], v23 offset:256
  v_mfma_f32_16x16x32_bf16 v[200:203], v[112:115], v[88:91], v[200:203]
  s_cmp_lg_u32 s79, 0
  s_nop 0
  v_mfma_f32_16x16x32_bf16 v[204:207], v[112:115], v[92:95], v[204:207]
  v_mfma_f32_16x16x32_bf16 v[208:211], v[116:119], v[80:83], v[208:211]
  v_mfma_f32_16x16x32_bf16 v[212:215], v[116:119], v[84:87], v[212:215]
  v_mfma_f32_16x16x32_bf16 v[216:219], v[116:119], v[88:91], v[216:219]
  v_mfma_f32_16x16x32_bf16 v[220:223], v[116:119], v[92:95], v[220:223]
  v_mfma_f32_16x16x32_bf16 v[224:227], v[120:123], v[80:83], v[224:227]
  v_mfma_f32_16x16x32_bf16 v[228:231], v[120:123], v[84:87], v[228:231]
  v_mfma_f32_16x16x32_bf16 v[232:235], v[120:123], v[88:91], v[232:235]
  v_mfma_f32_16x16x32_bf16 v[236:239], v[120:123], v[92:95], v[236:239]
  s_waitcnt lgkmcnt(0)
  s_cbranch_scc1 L_w1_loop
L_w1_exit:
  ds_read2_b32 v[88:89], v14 offset0:0 offset1:160
  ds_read2_b32 v[90:91], v14 offset0:16 offset1:176
  ds_read2_b32 v[92:93], v14 offset0:32 offset1:192
  ds_read2_b32 v[94:95], v14 offset0:48 offset1:208
  ds_read_b128 v[32:35], v15 offset:0
  ds_read_b128 v[60:63], v15 offset:1024
  ds_read_b128 v[36:39], v15 offset:64
  ds_read_b128 v[64:67], v15 offset:1088
  ds_read_b128 v[40:43], v15 offset:256
  ds_read_b128 v[68:71], v15 offset:1280
  ds_read_b128 v[44:47], v15 offset:320
  ds_read_b128 v[72:75], v15 offset:1344
  ds_read_b128 v[48:51], v15 offset:512
  ds_read_b128 v[76:79], v15 offset:1536
  ds_read_b128 v[52:55], v15 offset:576
  ds_read_b128 v[80:83], v15 offset:1600
  ds_read_b128 v[56:59], v16 offset:768
  ds_read_b128 v[84:87], v16 offset:1792
  v_mov_b32 v96, 0xc0135761
  v_mov_b32 v97, 0xbdd2d3e8
  v_mov_b32 v98, 1.0
  s_waitcnt lgkmcnt(0)
  v_mul_f32 v88, v88, v89
  v_mul_f32 v90, v90, v91
  v_mul_f32 v92, v92, v93
  v_mul_f32 v94, v94, v95
  v_pk_fma_f32 v[100:101], v[32:33], v[88:89], v[60:61] op_sel:[0,0,0] op_sel_hi:[1,0,1] neg_lo:[0,1,0] neg_hi:[0,1,0]
  v_pk_fma_f32 v[102:103], v[34:35], v[88:89], v[62:63] op_sel:[0,0,0] op_sel_hi:[1,0,1] neg_lo:[0,1,0] neg_hi:[0,1,0]
  v_pk_fma_f32 v[128:129], v[128:129], v[88:89], v[100:101] op_sel:[0,1,0] op_sel_hi:[1,1,1]
  v_pk_fma_f32 v[130:131], v[130:131], v[88:89], v[102:103] op_sel:[0,1,0] op_sel_hi:[1,1,1]
  v_pk_mul_f32 v[100:101], v[128:129], v[128:129]
  v_pk_mul_f32 v[102:103], v[130:131], v[130:131]
  v_pk_fma_f32 v[100:101], v[100:101], v[96:97], v[96:97] op_sel:[0,1,0] op_sel_hi:[1,1,0]
  v_pk_fma_f32 v[102:103], v[102:103], v[96:97], v[96:97] op_sel:[0,1,0] op_sel_hi:[1,1,0]
  v_pk_mul_f32 v[100:101], v[100:101], v[128:129]
  v_pk_mul_f32 v[102:103], v[102:103], v[130:131]
  v_exp_f32 v100, v100
  v_exp_f32 v101, v101
  v_exp_f32 v102, v102
  v_exp_f32 v103, v103
  v_pk_add_f32 v[100:101], v[100:101], v[98:99] op_sel_hi:[1,0]
  v_pk_add_f32 v[102:103], v[102:103], v[98:99] op_sel_hi:[1,0]
  v_rcp_f32 v100, v100
  v_rcp_f32 v101, v101
  v_rcp_f32 v102, v102
  v_rcp_f32 v103, v103
  v_pk_mul_f32 v[128:129], v[128:129], v[100:101]
  v_pk_mul_f32 v[130:131], v[130:131], v[102:103]
  v_cvt_pk_bf16_f32 v108, v128, v129
  v_cvt_pk_bf16_f32 v109, v130, v131
  v_pk_fma_f32 v[104:105], v[36:37], v[88:89], v[64:65] op_sel:[0,0,0] op_sel_hi:[1,0,1] neg_lo:[0,1,0] neg_hi:[0,1,0]
  v_pk_fma_f32 v[106:107], v[38:39], v[88:89], v[66:67] op_sel:[0,0,0] op_sel_hi:[1,0,1] neg_lo:[0,1,0] neg_hi:[0,1,0]
  v_pk_fma_f32 v[144:145], v[144:145], v[88:89], v[104:105] op_sel:[0,1,0] op_sel_hi:[1,1,1]
  v_pk_fma_f32 v[146:147], v[146:147], v[88:89], v[106:107] op_sel:[0,1,0] op_sel_hi:[1,1,1]
  v_pk_mul_f32 v[104:105], v[144:145], v[144:145]
  v_pk_mul_f32 v[106:107], v[146:147], v[146:147]
  v_pk_fma_f32 v[104:105], v[104:105], v[96:97], v[96:97] op_sel:[0,1,0] op_sel_hi:[1,1,0]
  v_pk_fma_f32 v[106:107], v[106:107], v[96:97], v[96:97] op_sel:[0,1,0] op_sel_hi:[1,1,0]
  v_pk_mul_f32 v[104:105], v[104:105], v[144:145]
  v_pk_mul_f32 v[106:107], v[106:107], v[146:147]
  v_exp_f32 v104, v104
  v_exp_f32 v105, v105
  v_exp_f32 v106, v106
  v_exp_f32 v107, v107
  v_pk_add_f32 v[104:105], v[104:105], v[98:99] op_sel_hi:[1,0]
  v_pk_add_f32 v[106:107], v[106:107], v[98:99] op_sel_hi:[1,0]
  v_rcp_f32 v104, v104
  v_rcp_f32 v105, v105
  v_rcp_f32 v106, v106
  v_rcp_f32 v107, v107
  v_pk_mul_f32 v[144:145], v[144:145], v[104:105]
  v_pk_mul_f32 v[146:147], v[146:147], v[106:107]
  v_cvt_pk_bf16_f32 v110, v144, v145
  v_cvt_pk_bf16_f32 v111, v146, v147
  s_mov_b32 s3, 0
  s_nop 0
  v_permlane16_swap_b32 v108, v110
  v_permlane16_swap_b32 v109, v111
  buffer_store_dwordx4 v[108:111], v12, s[44:47], s3 offen sc1
  v_pk_fma_f32 v[100:101], v[32:33], v[90:91], v[60:61] op_sel:[0,0,0] op_sel_hi:[1,0,1] neg_lo:[0,1,0] neg_hi:[0,1,0]
  v_pk_fma_f32 v[102:103], v[34:35], v[90:91], v[62:63] op_sel:[0,0,0] op_sel_hi:[1,0,1] neg_lo:[0,1,0] neg_hi:[0,1,0]
  v_pk_fma_f32 v[132:133], v[132:133], v[90:91], v[100:101] op_sel:[0,1,0] op_sel_hi:[1,1,1]
  v_pk_fma_f32 v[134:135], v[134:135], v[90:91], v[102:103] op_sel:[0,1,0] op_sel_hi:[1,1,1]
  v_pk_mul_f32 v[100:101], v[132:133], v[132:133]
  v_pk_mul_f32 v[102:103], v[134:135], v[134:135]
  v_pk_fma_f32 v[100:101], v[100:101], v[96:97], v[96:97] op_sel:[0,1,0] op_sel_hi:[1,1,0]
  v_pk_fma_f32 v[102:103], v[102:103], v[96:97], v[96:97] op_sel:[0,1,0] op_sel_hi:[1,1,0]
  v_pk_mul_f32 v[100:101], v[100:101], v[132:133]
  v_pk_mul_f32 v[102:103], v[102:103], v[134:135]
  v_exp_f32 v100, v100
  v_exp_f32 v101, v101
  v_exp_f32 v102, v102
  v_exp_f32 v103, v103
  v_pk_add_f32 v[100:101], v[100:101], v[98:99] op_sel_hi:[1,0]
  v_pk_add_f32 v[102:103], v[102:103], v[98:99] op_sel_hi:[1,0]
  v_rcp_f32 v100, v100
  v_rcp_f32 v101, v101
  v_rcp_f32 v102, v102
  v_rcp_f32 v103, v103
  v_pk_mul_f32 v[132:133], v[132:133], v[100:101]
  v_pk_mul_f32 v[134:135], v[134:135], v[102:103]
  v_cvt_pk_bf16_f32 v112, v132, v133
  v_cvt_pk_bf16_f32 v113, v134, v135
  v_pk_fma_f32 v[104:105], v[36:37], v[90:91], v[64:65] op_sel:[0,0,0] op_sel_hi:[1,0,1] neg_lo:[0,1,0] neg_hi:[0,1,0]
  v_pk_fma_f32 v[106:107], v[38:39], v[90:91], v[66:67] op_sel:[0,0,0] op_sel_hi:[1,0,1] neg_lo:[0,1,0] neg_hi:[0,1,0]
  v_pk_fma_f32 v[148:149], v[148:149], v[90:91], v[104:105] op_sel:[0,1,0] op_sel_hi:[1,1,1]
  v_pk_fma_f32 v[150:151], v[150:151], v[90:91], v[106:107] op_sel:[0,1,0] op_sel_hi:[1,1,1]
  v_pk_mul_f32 v[104:105], v[148:149], v[148:149]
  v_pk_mul_f32 v[106:107], v[150:151], v[150:151]
  v_pk_fma_f32 v[104:105], v[104:105], v[96:97], v[96:97] op_sel:[0,1,0] op_sel_hi:[1,1,0]
  v_pk_fma_f32 v[106:107], v[106:107], v[96:97], v[96:97] op_sel:[0,1,0] op_sel_hi:[1,1,0]
  v_pk_mul_f32 v[104:105], v[104:105], v[148:149]
  v_pk_mul_f32 v[106:107], v[106:107], v[150:151]
  v_exp_f32 v104, v104
  v_exp_f32 v105, v105
  v_exp_f32 v106, v106
  v_exp_f32 v107, v107
  v_pk_add_f32 v[104:105], v[104:105], v[98:99] op_sel_hi:[1,0]
  v_pk_add_f32 v[106:107], v[106:107], v[98:99] op_sel_hi:[1,0]
  v_rcp_f32 v104, v104
  v_rcp_f32 v105, v105
  v_rcp_f32 v106, v106
  v_rcp_f32 v107, v107
  v_pk_mul_f32 v[148:149], v[148:149], v[104:105]
  v_pk_mul_f32 v[150:151], v[150:151], v[106:107]
  v_cvt_pk_bf16_f32 v114, v148, v149
  v_cvt_pk_bf16_f32 v115, v150, v151
  s_mov_b32 s3, 114688
  s_nop 0
  v_permlane16_swap_b32 v112, v114
  v_permlane16_swap_b32 v113, v115
  buffer_store_dwordx4 v[112:115], v12, s[44:47], s3 offen sc1
  v_pk_fma_f32 v[100:101], v[32:33], v[92:93], v[60:61] op_sel:[0,0,0] op_sel_hi:[1,0,1] neg_lo:[0,1,0] neg_hi:[0,1,0]
  v_pk_fma_f32 v[102:103], v[34:35], v[92:93], v[62:63] op_sel:[0,0,0] op_sel_hi:[1,0,1] neg_lo:[0,1,0] neg_hi:[0,1,0]
  v_pk_fma_f32 v[136:137], v[136:137], v[92:93], v[100:101] op_sel:[0,1,0] op_sel_hi:[1,1,1]
  v_pk_fma_f32 v[138:139], v[138:139], v[92:93], v[102:103] op_sel:[0,1,0] op_sel_hi:[1,1,1]
  v_pk_mul_f32 v[100:101], v[136:137], v[136:137]
  v_pk_mul_f32 v[102:103], v[138:139], v[138:139]
  v_pk_fma_f32 v[100:101], v[100:101], v[96:97], v[96:97] op_sel:[0,1,0] op_sel_hi:[1,1,0]
  v_pk_fma_f32 v[102:103], v[102:103], v[96:97], v[96:97] op_sel:[0,1,0] op_sel_hi:[1,1,0]
  v_pk_mul_f32 v[100:101], v[100:101], v[136:137]
  v_pk_mul_f32 v[102:103], v[102:103], v[138:139]
  v_exp_f32 v100, v100
  v_exp_f32 v101, v101
  v_exp_f32 v102, v102
  v_exp_f32 v103, v103
  v_pk_add_f32 v[100:101], v[100:101], v[98:99] op_sel_hi:[1,0]
  v_pk_add_f32 v[102:103], v[102:103], v[98:99] op_sel_hi:[1,0]
  v_rcp_f32 v100, v100
  v_rcp_f32 v101, v101
  v_rcp_f32 v102, v102
  v_rcp_f32 v103, v103
  v_pk_mul_f32 v[136:137], v[136:137], v[100:101]
  v_pk_mul_f32 v[138:139], v[138:139], v[102:103]
  v_cvt_pk_bf16_f32 v116, v136, v137
  v_cvt_pk_bf16_f32 v117, v138, v139
  v_pk_fma_f32 v[104:105], v[36:37], v[92:93], v[64:65] op_sel:[0,0,0] op_sel_hi:[1,0,1] neg_lo:[0,1,0] neg_hi:[0,1,0]
  v_pk_fma_f32 v[106:107], v[38:39], v[92:93], v[66:67] op_sel:[0,0,0] op_sel_hi:[1,0,1] neg_lo:[0,1,0] neg_hi:[0,1,0]
  v_pk_fma_f32 v[152:153], v[152:153], v[92:93], v[104:105] op_sel:[0,1,0] op_sel_hi:[1,1,1]
  v_pk_fma_f32 v[154:155], v[154:155], v[92:93], v[106:107] op_sel:[0,1,0] op_sel_hi:[1,1,1]
  v_pk_mul_f32 v[104:105], v[152:153], v[152:153]
  v_pk_mul_f32 v[106:107], v[154:155], v[154:155]
  v_pk_fma_f32 v[104:105], v[104:105], v[96:97], v[96:97] op_sel:[0,1,0] op_sel_hi:[1,1,0]
  v_pk_fma_f32 v[106:107], v[106:107], v[96:97], v[96:97] op_sel:[0,1,0] op_sel_hi:[1,1,0]
  v_pk_mul_f32 v[104:105], v[104:105], v[152:153]
  v_pk_mul_f32 v[106:107], v[106:107], v[154:155]
  v_exp_f32 v104, v104
  v_exp_f32 v105, v105
  v_exp_f32 v106, v106
  v_exp_f32 v107, v107
  v_pk_add_f32 v[104:105], v[104:105], v[98:99] op_sel_hi:[1,0]
  v_pk_add_f32 v[106:107], v[106:107], v[98:99] op_sel_hi:[1,0]
  v_rcp_f32 v104, v104
  v_rcp_f32 v105, v105
  v_rcp_f32 v106, v106
  v_rcp_f32 v107, v107
  v_pk_mul_f32 v[152:153], v[152:153], v[104:105]
  v_pk_mul_f32 v[154:155], v[154:155], v[106:107]
  v_cvt_pk_bf16_f32 v118, v152, v153
  v_cvt_pk_bf16_f32 v119, v154, v155
  s_mov_b32 s3, 229376
  s_nop 0
  v_permlane16_swap_b32 v116, v118
  v_permlane16_swap_b32 v117, v119
  buffer_store_dwordx4 v[116:119], v12, s[44:47], s3 offen sc1
  v_pk_fma_f32 v[100:101], v[32:33], v[94:95], v[60:61] op_sel:[0,0,0] op_sel_hi:[1,0,1] neg_lo:[0,1,0] neg_hi:[0,1,0]
  v_pk_fma_f32 v[102:103], v[34:35], v[94:95], v[62:63] op_sel:[0,0,0] op_sel_hi:[1,0,1] neg_lo:[0,1,0] neg_hi:[0,1,0]
  v_pk_fma_f32 v[140:141], v[140:141], v[94:95], v[100:101] op_sel:[0,1,0] op_sel_hi:[1,1,1]
  v_pk_fma_f32 v[142:143], v[142:143], v[94:95], v[102:103] op_sel:[0,1,0] op_sel_hi:[1,1,1]
  v_pk_mul_f32 v[100:101], v[140:141], v[140:141]
  v_pk_mul_f32 v[102:103], v[142:143], v[142:143]
  v_pk_fma_f32 v[100:101], v[100:101], v[96:97], v[96:97] op_sel:[0,1,0] op_sel_hi:[1,1,0]
  v_pk_fma_f32 v[102:103], v[102:103], v[96:97], v[96:97] op_sel:[0,1,0] op_sel_hi:[1,1,0]
  v_pk_mul_f32 v[100:101], v[100:101], v[140:141]
  v_pk_mul_f32 v[102:103], v[102:103], v[142:143]
  v_exp_f32 v100, v100
  v_exp_f32 v101, v101
  v_exp_f32 v102, v102
  v_exp_f32 v103, v103
  v_pk_add_f32 v[100:101], v[100:101], v[98:99] op_sel_hi:[1,0]
  v_pk_add_f32 v[102:103], v[102:103], v[98:99] op_sel_hi:[1,0]
  v_rcp_f32 v100, v100
  v_rcp_f32 v101, v101
  v_rcp_f32 v102, v102
  v_rcp_f32 v103, v103
  v_pk_mul_f32 v[140:141], v[140:141], v[100:101]
  v_pk_mul_f32 v[142:143], v[142:143], v[102:103]
  v_cvt_pk_bf16_f32 v120, v140, v141
  v_cvt_pk_bf16_f32 v121, v142, v143
  v_pk_fma_f32 v[104:105], v[36:37], v[94:95], v[64:65] op_sel:[0,0,0] op_sel_hi:[1,0,1] neg_lo:[0,1,0] neg_hi:[0,1,0]
  v_pk_fma_f32 v[106:107], v[38:39], v[94:95], v[66:67] op_sel:[0,0,0] op_sel_hi:[1,0,1] neg_lo:[0,1,0] neg_hi:[0,1,0]
  v_pk_fma_f32 v[156:157], v[156:157], v[94:95], v[104:105] op_sel:[0,1,0] op_sel_hi:[1,1,1]
  v_pk_fma_f32 v[158:159], v[158:159], v[94:95], v[106:107] op_sel:[0,1,0] op_sel_hi:[1,1,1]
  v_pk_mul_f32 v[104:105], v[156:157], v[156:157]
  v_pk_mul_f32 v[106:107], v[158:159], v[158:159]
  v_pk_fma_f32 v[104:105], v[104:105], v[96:97], v[96:97] op_sel:[0,1,0] op_sel_hi:[1,1,0]
  v_pk_fma_f32 v[106:107], v[106:107], v[96:97], v[96:97] op_sel:[0,1,0] op_sel_hi:[1,1,0]
  v_pk_mul_f32 v[104:105], v[104:105], v[156:157]
  v_pk_mul_f32 v[106:107], v[106:107], v[158:159]
  v_exp_f32 v104, v104
  v_exp_f32 v105, v105
  v_exp_f32 v106, v106
  v_exp_f32 v107, v107
  v_pk_add_f32 v[104:105], v[104:105], v[98:99] op_sel_hi:[1,0]
  v_pk_add_f32 v[106:107], v[106:107], v[98:99] op_sel_hi:[1,0]
  v_rcp_f32 v104, v104
  v_rcp_f32 v105, v105
  v_rcp_f32 v106, v106
  v_rcp_f32 v107, v107
  v_pk_mul_f32 v[156:157], v[156:157], v[104:105]
  v_pk_mul_f32 v[158:159], v[158:159], v[106:107]
  v_cvt_pk_bf16_f32 v122, v156, v157
  v_cvt_pk_bf16_f32 v123, v158, v159
  s_mov_b32 s3, 344064
  s_nop 0
  v_permlane16_swap_b32 v120, v122
  v_permlane16_swap_b32 v121, v123
  buffer_store_dwordx4 v[120:123], v12, s[44:47], s3 offen sc1
  v_pk_fma_f32 v[100:101], v[56:57], v[88:89], v[84:85] op_sel:[0,0,0] op_sel_hi:[1,0,1] neg_lo:[0,1,0] neg_hi:[0,1,0]
  v_pk_fma_f32 v[102:103], v[58:59], v[88:89], v[86:87] op_sel:[0,0,0] op_sel_hi:[1,0,1] neg_lo:[0,1,0] neg_hi:[0,1,0]
  v_pk_fma_f32 v[224:225], v[224:225], v[88:89], v[100:101] op_sel:[0,1,0] op_sel_hi:[1,1,1]
  v_pk_fma_f32 v[226:227], v[226:227], v[88:89], v[102:103] op_sel:[0,1,0] op_sel_hi:[1,1,1]
  v_pk_mul_f32 v[100:101], v[224:225], v[224:225]
  v_pk_mul_f32 v[102:103], v[226:227], v[226:227]
  v_pk_fma_f32 v[100:101], v[100:101], v[96:97], v[96:97] op_sel:[0,1,0] op_sel_hi:[1,1,0]
  v_pk_fma_f32 v[102:103], v[102:103], v[96:97], v[96:97] op_sel:[0,1,0] op_sel_hi:[1,1,0]
  v_pk_mul_f32 v[100:101], v[100:101], v[224:225]
  v_pk_mul_f32 v[102:103], v[102:103], v[226:227]
  v_exp_f32 v100, v100
  v_exp_f32 v101, v101
  v_exp_f32 v102, v102
  v_exp_f32 v103, v103
  v_pk_add_f32 v[100:101], v[100:101], v[98:99] op_sel_hi:[1,0]
  v_pk_add_f32 v[102:103], v[102:103], v[98:99] op_sel_hi:[1,0]
  v_rcp_f32 v100, v100
  v_rcp_f32 v101, v101
  v_rcp_f32 v102, v102
  v_rcp_f32 v103, v103
  v_pk_mul_f32 v[224:225], v[224:225], v[100:101]
  v_pk_mul_f32 v[226:227], v[226:227], v[102:103]
  v_cvt_pk_bf16_f32 v108, v224, v225
  v_cvt_pk_bf16_f32 v109, v226, v227
  v_pk_fma_f32 v[100:101], v[56:57], v[90:91], v[84:85] op_sel:[0,0,0] op_sel_hi:[1,0,1] neg_lo:[0,1,0] neg_hi:[0,1,0]
  v_pk_fma_f32 v[102:103], v[58:59], v[90:91], v[86:87] op_sel:[0,0,0] op_sel_hi:[1,0,1] neg_lo:[0,1,0] neg_hi:[0,1,0]
  v_pk_fma_f32 v[228:229], v[228:229], v[90:91], v[100:101] op_sel:[0,1,0] op_sel_hi:[1,1,1]
  v_pk_fma_f32 v[230:231], v[230:231], v[90:91], v[102:103] op_sel:[0,1,0] op_sel_hi:[1,1,1]
  v_pk_mul_f32 v[100:101], v[228:229], v[228:229]
  v_pk_mul_f32 v[102:103], v[230:231], v[230:231]
  v_pk_fma_f32 v[100:101], v[100:101], v[96:97], v[96:97] op_sel:[0,1,0] op_sel_hi:[1,1,0]
  v_pk_fma_f32 v[102:103], v[102:103], v[96:97], v[96:97] op_sel:[0,1,0] op_sel_hi:[1,1,0]
  v_pk_mul_f32 v[100:101], v[100:101], v[228:229]
  v_pk_mul_f32 v[102:103], v[102:103], v[230:231]
  v_exp_f32 v100, v100
  v_exp_f32 v101, v101
  v_exp_f32 v102, v102
  v_exp_f32 v103, v103
  v_pk_add_f32 v[100:101], v[100:101], v[98:99] op_sel_hi:[1,0]
  v_pk_add_f32 v[102:103], v[102:103], v[98:99] op_sel_hi:[1,0]
  v_rcp_f32 v100, v100
  v_rcp_f32 v101, v101
  v_rcp_f32 v102, v102
  v_rcp_f32 v103, v103
  v_pk_mul_f32 v[228:229], v[228:229], v[100:101]
  v_pk_mul_f32 v[230:231], v[230:231], v[102:103]
  v_cvt_pk_bf16_f32 v110, v228, v229
  v_cvt_pk_bf16_f32 v111, v230, v231
  s_mov_b32 s3, 32768
  s_nop 0
  v_permlane16_swap_b32 v108, v110
  v_permlane16_swap_b32 v109, v111
  buffer_store_dwordx4 v[108:111], v13, s[44:47], s3 offen sc1
  v_pk_fma_f32 v[100:101], v[56:57], v[92:93], v[84:85] op_sel:[0,0,0] op_sel_hi:[1,0,1] neg_lo:[0,1,0] neg_hi:[0,1,0]
  v_pk_fma_f32 v[102:103], v[58:59], v[92:93], v[86:87] op_sel:[0,0,0] op_sel_hi:[1,0,1] neg_lo:[0,1,0] neg_hi:[0,1,0]
  v_pk_fma_f32 v[232:233], v[232:233], v[92:93], v[100:101] op_sel:[0,1,0] op_sel_hi:[1,1,1]
  v_pk_fma_f32 v[234:235], v[234:235], v[92:93], v[102:103] op_sel:[0,1,0] op_sel_hi:[1,1,1]
  v_pk_mul_f32 v[100:101], v[232:233], v[232:233]
  v_pk_mul_f32 v[102:103], v[234:235], v[234:235]
  v_pk_fma_f32 v[100:101], v[100:101], v[96:97], v[96:97] op_sel:[0,1,0] op_sel_hi:[1,1,0]
  v_pk_fma_f32 v[102:103], v[102:103], v[96:97], v[96:97] op_sel:[0,1,0] op_sel_hi:[1,1,0]
  v_pk_mul_f32 v[100:101], v[100:101], v[232:233]
  v_pk_mul_f32 v[102:103], v[102:103], v[234:235]
  v_exp_f32 v100, v100
  v_exp_f32 v101, v101
  v_exp_f32 v102, v102
  v_exp_f32 v103, v103
  v_pk_add_f32 v[100:101], v[100:101], v[98:99] op_sel_hi:[1,0]
  v_pk_add_f32 v[102:103], v[102:103], v[98:99] op_sel_hi:[1,0]
  v_rcp_f32 v100, v100
  v_rcp_f32 v101, v101
  v_rcp_f32 v102, v102
  v_rcp_f32 v103, v103
  v_pk_mul_f32 v[232:233], v[232:233], v[100:101]
  v_pk_mul_f32 v[234:235], v[234:235], v[102:103]
  v_cvt_pk_bf16_f32 v112, v232, v233
  v_cvt_pk_bf16_f32 v113, v234, v235
  v_pk_fma_f32 v[100:101], v[56:57], v[94:95], v[84:85] op_sel:[0,0,0] op_sel_hi:[1,0,1] neg_lo:[0,1,0] neg_hi:[0,1,0]
  v_pk_fma_f32 v[102:103], v[58:59], v[94:95], v[86:87] op_sel:[0,0,0] op_sel_hi:[1,0,1] neg_lo:[0,1,0] neg_hi:[0,1,0]
  v_pk_fma_f32 v[236:237], v[236:237], v[94:95], v[100:101] op_sel:[0,1,0] op_sel_hi:[1,1,1]
  v_pk_fma_f32 v[238:239], v[238:239], v[94:95], v[102:103] op_sel:[0,1,0] op_sel_hi:[1,1,1]
  v_pk_mul_f32 v[100:101], v[236:237], v[236:237]
  v_pk_mul_f32 v[102:103], v[238:239], v[238:239]
  v_pk_fma_f32 v[100:101], v[100:101], v[96:97], v[96:97] op_sel:[0,1,0] op_sel_hi:[1,1,0]
  v_pk_fma_f32 v[102:103], v[102:103], v[96:97], v[96:97] op_sel:[0,1,0] op_sel_hi:[1,1,0]
  v_pk_mul_f32 v[100:101], v[100:101], v[236:237]
  v_pk_mul_f32 v[102:103], v[102:103], v[238:239]
  v_exp_f32 v100, v100
  v_exp_f32 v101, v101
  v_exp_f32 v102, v102
  v_exp_f32 v103, v103
  v_pk_add_f32 v[100:101], v[100:101], v[98:99] op_sel_hi:[1,0]
  v_pk_add_f32 v[102:103], v[102:103], v[98:99] op_sel_hi:[1,0]
  v_rcp_f32 v100, v100
  v_rcp_f32 v101, v101
  v_rcp_f32 v102, v102
  v_rcp_f32 v103, v103
  v_pk_mul_f32 v[236:237], v[236:237], v[100:101]
  v_pk_mul_f32 v[238:239], v[238:239], v[102:103]
  v_cvt_pk_bf16_f32 v114, v236, v237
  v_cvt_pk_bf16_f32 v115, v238, v239
  s_mov_b32 s3, 262144
  s_nop 0
  v_permlane16_swap_b32 v112, v114
  v_permlane16_swap_b32 v113, v115
  buffer_store_dwordx4 v[112:115], v13, s[44:47], s3 offen sc1
  v_pk_fma_f32 v[100:101], v[40:41], v[88:89], v[68:69] op_sel:[0,0,0] op_sel_hi:[1,0,1] neg_lo:[0,1,0] neg_hi:[0,1,0]
  v_pk_fma_f32 v[102:103], v[42:43], v[88:89], v[70:71] op_sel:[0,0,0] op_sel_hi:[1,0,1] neg_lo:[0,1,0] neg_hi:[0,1,0]
  v_pk_fma_f32 v[160:161], v[160:161], v[88:89], v[100:101] op_sel:[0,1,0] op_sel_hi:[1,1,1]
  v_pk_fma_f32 v[162:163], v[162:163], v[88:89], v[102:103] op_sel:[0,1,0] op_sel_hi:[1,1,1]
  v_pk_mul_f32 v[100:101], v[160:161], v[160:161]
  v_pk_mul_f32 v[102:103], v[162:163], v[162:163]
  v_pk_fma_f32 v[100:101], v[100:101], v[96:97], v[96:97] op_sel:[0,1,0] op_sel_hi:[1,1,0]
  v_pk_fma_f32 v[102:103], v[102:103], v[96:97], v[96:97] op_sel:[0,1,0] op_sel_hi:[1,1,0]
  v_pk_mul_f32 v[100:101], v[100:101], v[160:161]
  v_pk_mul_f32 v[102:103], v[102:103], v[162:163]
  v_exp_f32 v100, v100
  v_exp_f32 v101, v101
  v_exp_f32 v102, v102
  v_exp_f32 v103, v103
  v_pk_add_f32 v[100:101], v[100:101], v[98:99] op_sel_hi:[1,0]
  v_pk_add_f32 v[102:103], v[102:103], v[98:99] op_sel_hi:[1,0]
  v_rcp_f32 v100, v100
  v_rcp_f32 v101, v101
  v_rcp_f32 v102, v102
  v_rcp_f32 v103, v103
  v_pk_mul_f32 v[160:161], v[160:161], v[100:101]
  v_pk_mul_f32 v[162:163], v[162:163], v[102:103]
  v_cvt_pk_bf16_f32 v116, v160, v161
  v_cvt_pk_bf16_f32 v117, v162, v163
  v_pk_fma_f32 v[104:105], v[44:45], v[88:89], v[72:73] op_sel:[0,0,0] op_sel_hi:[1,0,1] neg_lo:[0,1,0] neg_hi:[0,1,0]
  v_pk_fma_f32 v[106:107], v[46:47], v[88:89], v[74:75] op_sel:[0,0,0] op_sel_hi:[1,0,1] neg_lo:[0,1,0] neg_hi:[0,1,0]
  v_pk_fma_f32 v[176:177], v[176:177], v[88:89], v[104:105] op_sel:[0,1,0] op_sel_hi:[1,1,1]
  v_pk_fma_f32 v[178:179], v[178:179], v[88:89], v[106:107] op_sel:[0,1,0] op_sel_hi:[1,1,1]
  v_pk_mul_f32 v[104:105], v[176:177], v[176:177]
  v_pk_mul_f32 v[106:107], v[178:179], v[178:179]
  v_pk_fma_f32 v[104:105], v[104:105], v[96:97], v[96:97] op_sel:[0,1,0] op_sel_hi:[1,1,0]
  v_pk_fma_f32 v[106:107], v[106:107], v[96:97], v[96:97] op_sel:[0,1,0] op_sel_hi:[1,1,0]
  v_pk_mul_f32 v[104:105], v[104:105], v[176:177]
  v_pk_mul_f32 v[106:107], v[106:107], v[178:179]
  v_exp_f32 v104, v104
  v_exp_f32 v105, v105
  v_exp_f32 v106, v106
  v_exp_f32 v107, v107
  v_pk_add_f32 v[104:105], v[104:105], v[98:99] op_sel_hi:[1,0]
  v_pk_add_f32 v[106:107], v[106:107], v[98:99] op_sel_hi:[1,0]
  v_rcp_f32 v104, v104
  v_rcp_f32 v105, v105
  v_rcp_f32 v106, v106
  v_rcp_f32 v107, v107
  v_pk_mul_f32 v[176:177], v[176:177], v[104:105]
  v_pk_mul_f32 v[178:179], v[178:179], v[106:107]
  v_cvt_pk_bf16_f32 v118, v176, v177
  v_cvt_pk_bf16_f32 v119, v178, v179
  s_add_u32 s3, s10, 49152
  s_nop 0
  v_permlane16_swap_b32 v116, v118
  v_permlane16_swap_b32 v117, v119
  buffer_store_dwordx4 v[116:119], v12, s[44:47], s3 offen sc1
  v_pk_fma_f32 v[100:101], v[48:49], v[88:89], v[76:77] op_sel:[0,0,0] op_sel_hi:[1,0,1] neg_lo:[0,1,0] neg_hi:[0,1,0]
  v_pk_fma_f32 v[102:103], v[50:51], v[88:89], v[78:79] op_sel:[0,0,0] op_sel_hi:[1,0,1] neg_lo:[0,1,0] neg_hi:[0,1,0]
  v_pk_fma_f32 v[192:193], v[192:193], v[88:89], v[100:101] op_sel:[0,1,0] op_sel_hi:[1,1,1]
  v_pk_fma_f32 v[194:195], v[194:195], v[88:89], v[102:103] op_sel:[0,1,0] op_sel_hi:[1,1,1]
  v_pk_mul_f32 v[100:101], v[192:193], v[192:193]
  v_pk_mul_f32 v[102:103], v[194:195], v[194:195]
  v_pk_fma_f32 v[100:101], v[100:101], v[96:97], v[96:97] op_sel:[0,1,0] op_sel_hi:[1,1,0]
  v_pk_fma_f32 v[102:103], v[102:103], v[96:97], v[96:97] op_sel:[0,1,0] op_sel_hi:[1,1,0]
  v_pk_mul_f32 v[100:101], v[100:101], v[192:193]
  v_pk_mul_f32 v[102:103], v[102:103], v[194:195]
  v_exp_f32 v100, v100
  v_exp_f32 v101, v101
  v_exp_f32 v102, v102
  v_exp_f32 v103, v103
  v_pk_add_f32 v[100:101], v[100:101], v[98:99] op_sel_hi:[1,0]
  v_pk_add_f32 v[102:103], v[102:103], v[98:99] op_sel_hi:[1,0]
  v_rcp_f32 v100, v100
  v_rcp_f32 v101, v101
  v_rcp_f32 v102, v102
  v_rcp_f32 v103, v103
  v_pk_mul_f32 v[192:193], v[192:193], v[100:101]
  v_pk_mul_f32 v[194:195], v[194:195], v[102:103]
  v_cvt_pk_bf16_f32 v120, v192, v193
  v_cvt_pk_bf16_f32 v121, v194, v195
  v_pk_fma_f32 v[104:105], v[52:53], v[88:89], v[80:81] op_sel:[0,0,0] op_sel_hi:[1,0,1] neg_lo:[0,1,0] neg_hi:[0,1,0]
  v_pk_fma_f32 v[106:107], v[54:55], v[88:89], v[82:83] op_sel:[0,0,0] op_sel_hi:[1,0,1] neg_lo:[0,1,0] neg_hi:[0,1,0]
  v_pk_fma_f32 v[208:209], v[208:209], v[88:89], v[104:105] op_sel:[0,1,0] op_sel_hi:[1,1,1]
  v_pk_fma_f32 v[210:211], v[210:211], v[88:89], v[106:107] op_sel:[0,1,0] op_sel_hi:[1,1,1]
  v_pk_mul_f32 v[104:105], v[208:209], v[208:209]
  v_pk_mul_f32 v[106:107], v[210:211], v[210:211]
  v_pk_fma_f32 v[104:105], v[104:105], v[96:97], v[96:97] op_sel:[0,1,0] op_sel_hi:[1,1,0]
  v_pk_fma_f32 v[106:107], v[106:107], v[96:97], v[96:97] op_sel:[0,1,0] op_sel_hi:[1,1,0]
  v_pk_mul_f32 v[104:105], v[104:105], v[208:209]
  v_pk_mul_f32 v[106:107], v[106:107], v[210:211]
  v_exp_f32 v104, v104
  v_exp_f32 v105, v105
  v_exp_f32 v106, v106
  v_exp_f32 v107, v107
  v_pk_add_f32 v[104:105], v[104:105], v[98:99] op_sel_hi:[1,0]
  v_pk_add_f32 v[106:107], v[106:107], v[98:99] op_sel_hi:[1,0]
  v_rcp_f32 v104, v104
  v_rcp_f32 v105, v105
  v_rcp_f32 v106, v106
  v_rcp_f32 v107, v107
  v_pk_mul_f32 v[208:209], v[208:209], v[104:105]
  v_pk_mul_f32 v[210:211], v[210:211], v[106:107]
  v_cvt_pk_bf16_f32 v122, v208, v209
  v_cvt_pk_bf16_f32 v123, v210, v211
  s_add_u32 s3, s10, 51200
  s_nop 0
  v_permlane16_swap_b32 v120, v122
  v_permlane16_swap_b32 v121, v123
  buffer_store_dwordx4 v[120:123], v12, s[44:47], s3 offen sc1
  v_pk_fma_f32 v[100:101], v[40:41], v[90:91], v[68:69] op_sel:[0,0,0] op_sel_hi:[1,0,1] neg_lo:[0,1,0] neg_hi:[0,1,0]
  v_pk_fma_f32 v[102:103], v[42:43], v[90:91], v[70:71] op_sel:[0,0,0] op_sel_hi:[1,0,1] neg_lo:[0,1,0] neg_hi:[0,1,0]
  v_pk_fma_f32 v[164:165], v[164:165], v[90:91], v[100:101] op_sel:[0,1,0] op_sel_hi:[1,1,1]
  v_pk_fma_f32 v[166:167], v[166:167], v[90:91], v[102:103] op_sel:[0,1,0] op_sel_hi:[1,1,1]
  v_pk_mul_f32 v[100:101], v[164:165], v[164:165]
  v_pk_mul_f32 v[102:103], v[166:167], v[166:167]
  v_pk_fma_f32 v[100:101], v[100:101], v[96:97], v[96:97] op_sel:[0,1,0] op_sel_hi:[1,1,0]
  v_pk_fma_f32 v[102:103], v[102:103], v[96:97], v[96:97] op_sel:[0,1,0] op_sel_hi:[1,1,0]
  v_pk_mul_f32 v[100:101], v[100:101], v[164:165]
  v_pk_mul_f32 v[102:103], v[102:103], v[166:167]
  v_exp_f32 v100, v100
  v_exp_f32 v101, v101
  v_exp_f32 v102, v102
  v_exp_f32 v103, v103
  v_pk_add_f32 v[100:101], v[100:101], v[98:99] op_sel_hi:[1,0]
  v_pk_add_f32 v[102:103], v[102:103], v[98:99] op_sel_hi:[1,0]
  v_rcp_f32 v100, v100
  v_rcp_f32 v101, v101
  v_rcp_f32 v102, v102
  v_rcp_f32 v103, v103
  v_pk_mul_f32 v[164:165], v[164:165], v[100:101]
  v_pk_mul_f32 v[166:167], v[166:167], v[102:103]
  v_cvt_pk_bf16_f32 v108, v164, v165
  v_cvt_pk_bf16_f32 v109, v166, v167
  v_pk_fma_f32 v[104:105], v[44:45], v[90:91], v[72:73] op_sel:[0,0,0] op_sel_hi:[1,0,1] neg_lo:[0,1,0] neg_hi:[0,1,0]
  v_pk_fma_f32 v[106:107], v[46:47], v[90:91], v[74:75] op_sel:[0,0,0] op_sel_hi:[1,0,1] neg_lo:[0,1,0] neg_hi:[0,1,0]
  v_pk_fma_f32 v[180:181], v[180:181], v[90:91], v[104:105] op_sel:[0,1,0] op_sel_hi:[1,1,1]
  v_pk_fma_f32 v[182:183], v[182:183], v[90:91], v[106:107] op_sel:[0,1,0] op_sel_hi:[1,1,1]
  v_pk_mul_f32 v[104:105], v[180:181], v[180:181]
  v_pk_mul_f32 v[106:107], v[182:183], v[182:183]
  v_pk_fma_f32 v[104:105], v[104:105], v[96:97], v[96:97] op_sel:[0,1,0] op_sel_hi:[1,1,0]
  v_pk_fma_f32 v[106:107], v[106:107], v[96:97], v[96:97] op_sel:[0,1,0] op_sel_hi:[1,1,0]
  v_pk_mul_f32 v[104:105], v[104:105], v[180:181]
  v_pk_mul_f32 v[106:107], v[106:107], v[182:183]
  v_exp_f32 v104, v104
  v_exp_f32 v105, v105
  v_exp_f32 v106, v106
  v_exp_f32 v107, v107
  v_pk_add_f32 v[104:105], v[104:105], v[98:99] op_sel_hi:[1,0]
  v_pk_add_f32 v[106:107], v[106:107], v[98:99] op_sel_hi:[1,0]
  v_rcp_f32 v104, v104
  v_rcp_f32 v105, v105
  v_rcp_f32 v106, v106
  v_rcp_f32 v107, v107
  v_pk_mul_f32 v[180:181], v[180:181], v[104:105]
  v_pk_mul_f32 v[182:183], v[182:183], v[106:107]
  v_cvt_pk_bf16_f32 v110, v180, v181
  v_cvt_pk_bf16_f32 v111, v182, v183
  s_add_u32 s3, s10, 163840
  s_nop 0
  v_permlane16_swap_b32 v108, v110
  v_permlane16_swap_b32 v109, v111
  buffer_store_dwordx4 v[108:111], v12, s[44:47], s3 offen sc1
  v_pk_fma_f32 v[100:101], v[48:49], v[90:91], v[76:77] op_sel:[0,0,0] op_sel_hi:[1,0,1] neg_lo:[0,1,0] neg_hi:[0,1,0]
  v_pk_fma_f32 v[102:103], v[50:51], v[90:91], v[78:79] op_sel:[0,0,0] op_sel_hi:[1,0,1] neg_lo:[0,1,0] neg_hi:[0,1,0]
  v_pk_fma_f32 v[196:197], v[196:197], v[90:91], v[100:101] op_sel:[0,1,0] op_sel_hi:[1,1,1]
  v_pk_fma_f32 v[198:199], v[198:199], v[90:91], v[102:103] op_sel:[0,1,0] op_sel_hi:[1,1,1]
  v_pk_mul_f32 v[100:101], v[196:197], v[196:197]
  v_pk_mul_f32 v[102:103], v[198:199], v[198:199]
  v_pk_fma_f32 v[100:101], v[100:101], v[96:97], v[96:97] op_sel:[0,1,0] op_sel_hi:[1,1,0]
  v_pk_fma_f32 v[102:103], v[102:103], v[96:97], v[96:97] op_sel:[0,1,0] op_sel_hi:[1,1,0]
  v_pk_mul_f32 v[100:101], v[100:101], v[196:197]
  v_pk_mul_f32 v[102:103], v[102:103], v[198:199]
  v_exp_f32 v100, v100
  v_exp_f32 v101, v101
  v_exp_f32 v102, v102
  v_exp_f32 v103, v103
  v_pk_add_f32 v[100:101], v[100:101], v[98:99] op_sel_hi:[1,0]
  v_pk_add_f32 v[102:103], v[102:103], v[98:99] op_sel_hi:[1,0]
  v_rcp_f32 v100, v100
  v_rcp_f32 v101, v101
  v_rcp_f32 v102, v102
  v_rcp_f32 v103, v103
  v_pk_mul_f32 v[196:197], v[196:197], v[100:101]
  v_pk_mul_f32 v[198:199], v[198:199], v[102:103]
  v_cvt_pk_bf16_f32 v112, v196, v197
  v_cvt_pk_bf16_f32 v113, v198, v199
  v_pk_fma_f32 v[104:105], v[52:53], v[90:91], v[80:81] op_sel:[0,0,0] op_sel_hi:[1,0,1] neg_lo:[0,1,0] neg_hi:[0,1,0]
  v_pk_fma_f32 v[106:107], v[54:55], v[90:91], v[82:83] op_sel:[0,0,0] op_sel_hi:[1,0,1] neg_lo:[0,1,0] neg_hi:[0,1,0]
  v_pk_fma_f32 v[212:213], v[212:213], v[90:91], v[104:105] op_sel:[0,1,0] op_sel_hi:[1,1,1]
  v_pk_fma_f32 v[214:215], v[214:215], v[90:91], v[106:107] op_sel:[0,1,0] op_sel_hi:[1,1,1]
  v_pk_mul_f32 v[104:105], v[212:213], v[212:213]
  v_pk_mul_f32 v[106:107], v[214:215], v[214:215]
  v_pk_fma_f32 v[104:105], v[104:105], v[96:97], v[96:97] op_sel:[0,1,0] op_sel_hi:[1,1,0]
  v_pk_fma_f32 v[106:107], v[106:107], v[96:97], v[96:97] op_sel:[0,1,0] op_sel_hi:[1,1,0]
  v_pk_mul_f32 v[104:105], v[104:105], v[212:213]
  v_pk_mul_f32 v[106:107], v[106:107], v[214:215]
  v_exp_f32 v104, v104
  v_exp_f32 v105, v105
  v_exp_f32 v106, v106
  v_exp_f32 v107, v107
  v_pk_add_f32 v[104:105], v[104:105], v[98:99] op_sel_hi:[1,0]
  v_pk_add_f32 v[106:107], v[106:107], v[98:99] op_sel_hi:[1,0]
  v_rcp_f32 v104, v104
  v_rcp_f32 v105, v105
  v_rcp_f32 v106, v106
  v_rcp_f32 v107, v107
  v_pk_mul_f32 v[212:213], v[212:213], v[104:105]
  v_pk_mul_f32 v[214:215], v[214:215], v[106:107]
  v_cvt_pk_bf16_f32 v114, v212, v213
  v_cvt_pk_bf16_f32 v115, v214, v215
  s_add_u32 s3, s10, 165888
  s_nop 0
  v_permlane16_swap_b32 v112, v114
  v_permlane16_swap_b32 v113, v115
  buffer_store_dwordx4 v[112:115], v12, s[44:47], s3 offen sc1
  v_pk_fma_f32 v[100:101], v[40:41], v[92:93], v[68:69] op_sel:[0,0,0] op_sel_hi:[1,0,1] neg_lo:[0,1,0] neg_hi:[0,1,0]
  v_pk_fma_f32 v[102:103], v[42:43], v[92:93], v[70:71] op_sel:[0,0,0] op_sel_hi:[1,0,1] neg_lo:[0,1,0] neg_hi:[0,1,0]
  v_pk_fma_f32 v[168:169], v[168:169], v[92:93], v[100:101] op_sel:[0,1,0] op_sel_hi:[1,1,1]
  v_pk_fma_f32 v[170:171], v[170:171], v[92:93], v[102:103] op_sel:[0,1,0] op_sel_hi:[1,1,1]
  v_pk_mul_f32 v[100:101], v[168:169], v[168:169]
  v_pk_mul_f32 v[102:103], v[170:171], v[170:171]
  v_pk_fma_f32 v[100:101], v[100:101], v[96:97], v[96:97] op_sel:[0,1,0] op_sel_hi:[1,1,0]
  v_pk_fma_f32 v[102:103], v[102:103], v[96:97], v[96:97] op_sel:[0,1,0] op_sel_hi:[1,1,0]
  v_pk_mul_f32 v[100:101], v[100:101], v[168:169]
  v_pk_mul_f32 v[102:103], v[102:103], v[170:171]
  v_exp_f32 v100, v100
  v_exp_f32 v101, v101
  v_exp_f32 v102, v102
  v_exp_f32 v103, v103
  v_pk_add_f32 v[100:101], v[100:101], v[98:99] op_sel_hi:[1,0]
  v_pk_add_f32 v[102:103], v[102:103], v[98:99] op_sel_hi:[1,0]
  v_rcp_f32 v100, v100
  v_rcp_f32 v101, v101
  v_rcp_f32 v102, v102
  v_rcp_f32 v103, v103
  v_pk_mul_f32 v[168:169], v[168:169], v[100:101]
  v_pk_mul_f32 v[170:171], v[170:171], v[102:103]
  v_cvt_pk_bf16_f32 v116, v168, v169
  v_cvt_pk_bf16_f32 v117, v170, v171
  v_pk_fma_f32 v[104:105], v[44:45], v[92:93], v[72:73] op_sel:[0,0,0] op_sel_hi:[1,0,1] neg_lo:[0,1,0] neg_hi:[0,1,0]
  v_pk_fma_f32 v[106:107], v[46:47], v[92:93], v[74:75] op_sel:[0,0,0] op_sel_hi:[1,0,1] neg_lo:[0,1,0] neg_hi:[0,1,0]
  v_pk_fma_f32 v[184:185], v[184:185], v[92:93], v[104:105] op_sel:[0,1,0] op_sel_hi:[1,1,1]
  v_pk_fma_f32 v[186:187], v[186:187], v[92:93], v[106:107] op_sel:[0,1,0] op_sel_hi:[1,1,1]
  v_pk_mul_f32 v[104:105], v[184:185], v[184:185]
  v_pk_mul_f32 v[106:107], v[186:187], v[186:187]
  v_pk_fma_f32 v[104:105], v[104:105], v[96:97], v[96:97] op_sel:[0,1,0] op_sel_hi:[1,1,0]
  v_pk_fma_f32 v[106:107], v[106:107], v[96:97], v[96:97] op_sel:[0,1,0] op_sel_hi:[1,1,0]
  v_pk_mul_f32 v[104:105], v[104:105], v[184:185]
  v_pk_mul_f32 v[106:107], v[106:107], v[186:187]
  v_exp_f32 v104, v104
  v_exp_f32 v105, v105
  v_exp_f32 v106, v106
  v_exp_f32 v107, v107
  v_pk_add_f32 v[104:105], v[104:105], v[98:99] op_sel_hi:[1,0]
  v_pk_add_f32 v[106:107], v[106:107], v[98:99] op_sel_hi:[1,0]
  v_rcp_f32 v104, v104
  v_rcp_f32 v105, v105
  v_rcp_f32 v106, v106
  v_rcp_f32 v107, v107
  v_pk_mul_f32 v[184:185], v[184:185], v[104:105]
  v_pk_mul_f32 v[186:187], v[186:187], v[106:107]
  v_cvt_pk_bf16_f32 v118, v184, v185
  v_cvt_pk_bf16_f32 v119, v186, v187
  s_add_u32 s3, s10, 278528
  s_nop 0
  v_permlane16_swap_b32 v116, v118
  v_permlane16_swap_b32 v117, v119
  buffer_store_dwordx4 v[116:119], v12, s[44:47], s3 offen sc1
  v_pk_fma_f32 v[100:101], v[48:49], v[92:93], v[76:77] op_sel:[0,0,0] op_sel_hi:[1,0,1] neg_lo:[0,1,0] neg_hi:[0,1,0]
  v_pk_fma_f32 v[102:103], v[50:51], v[92:93], v[78:79] op_sel:[0,0,0] op_sel_hi:[1,0,1] neg_lo:[0,1,0] neg_hi:[0,1,0]
  v_pk_fma_f32 v[200:201], v[200:201], v[92:93], v[100:101] op_sel:[0,1,0] op_sel_hi:[1,1,1]
  v_pk_fma_f32 v[202:203], v[202:203], v[92:93], v[102:103] op_sel:[0,1,0] op_sel_hi:[1,1,1]
  v_pk_mul_f32 v[100:101], v[200:201], v[200:201]
  v_pk_mul_f32 v[102:103], v[202:203], v[202:203]
  v_pk_fma_f32 v[100:101], v[100:101], v[96:97], v[96:97] op_sel:[0,1,0] op_sel_hi:[1,1,0]
  v_pk_fma_f32 v[102:103], v[102:103], v[96:97], v[96:97] op_sel:[0,1,0] op_sel_hi:[1,1,0]
  v_pk_mul_f32 v[100:101], v[100:101], v[200:201]
  v_pk_mul_f32 v[102:103], v[102:103], v[202:203]
  v_exp_f32 v100, v100
  v_exp_f32 v101, v101
  v_exp_f32 v102, v102
  v_exp_f32 v103, v103
  v_pk_add_f32 v[100:101], v[100:101], v[98:99] op_sel_hi:[1,0]
  v_pk_add_f32 v[102:103], v[102:103], v[98:99] op_sel_hi:[1,0]
  v_rcp_f32 v100, v100
  v_rcp_f32 v101, v101
  v_rcp_f32 v102, v102
  v_rcp_f32 v103, v103
  v_pk_mul_f32 v[200:201], v[200:201], v[100:101]
  v_pk_mul_f32 v[202:203], v[202:203], v[102:103]
  v_cvt_pk_bf16_f32 v120, v200, v201
  v_cvt_pk_bf16_f32 v121, v202, v203
  v_pk_fma_f32 v[104:105], v[52:53], v[92:93], v[80:81] op_sel:[0,0,0] op_sel_hi:[1,0,1] neg_lo:[0,1,0] neg_hi:[0,1,0]
  v_pk_fma_f32 v[106:107], v[54:55], v[92:93], v[82:83] op_sel:[0,0,0] op_sel_hi:[1,0,1] neg_lo:[0,1,0] neg_hi:[0,1,0]
  v_pk_fma_f32 v[216:217], v[216:217], v[92:93], v[104:105] op_sel:[0,1,0] op_sel_hi:[1,1,1]
  v_pk_fma_f32 v[218:219], v[218:219], v[92:93], v[106:107] op_sel:[0,1,0] op_sel_hi:[1,1,1]
  v_pk_mul_f32 v[104:105], v[216:217], v[216:217]
  v_pk_mul_f32 v[106:107], v[218:219], v[218:219]
  v_pk_fma_f32 v[104:105], v[104:105], v[96:97], v[96:97] op_sel:[0,1,0] op_sel_hi:[1,1,0]
  v_pk_fma_f32 v[106:107], v[106:107], v[96:97], v[96:97] op_sel:[0,1,0] op_sel_hi:[1,1,0]
  v_pk_mul_f32 v[104:105], v[104:105], v[216:217]
  v_pk_mul_f32 v[106:107], v[106:107], v[218:219]
  v_exp_f32 v104, v104
  v_exp_f32 v105, v105
  v_exp_f32 v106, v106
  v_exp_f32 v107, v107
  v_pk_add_f32 v[104:105], v[104:105], v[98:99] op_sel_hi:[1,0]
  v_pk_add_f32 v[106:107], v[106:107], v[98:99] op_sel_hi:[1,0]
  v_rcp_f32 v104, v104
  v_rcp_f32 v105, v105
  v_rcp_f32 v106, v106
  v_rcp_f32 v107, v107
  v_pk_mul_f32 v[216:217], v[216:217], v[104:105]
  v_pk_mul_f32 v[218:219], v[218:219], v[106:107]
  v_cvt_pk_bf16_f32 v122, v216, v217
  v_cvt_pk_bf16_f32 v123, v218, v219
  s_add_u32 s3, s10, 280576
  s_nop 0
  v_permlane16_swap_b32 v120, v122
  v_permlane16_swap_b32 v121, v123
  buffer_store_dwordx4 v[120:123], v12, s[44:47], s3 offen sc1
  v_pk_fma_f32 v[100:101], v[40:41], v[94:95], v[68:69] op_sel:[0,0,0] op_sel_hi:[1,0,1] neg_lo:[0,1,0] neg_hi:[0,1,0]
  v_pk_fma_f32 v[102:103], v[42:43], v[94:95], v[70:71] op_sel:[0,0,0] op_sel_hi:[1,0,1] neg_lo:[0,1,0] neg_hi:[0,1,0]
  v_pk_fma_f32 v[172:173], v[172:173], v[94:95], v[100:101] op_sel:[0,1,0] op_sel_hi:[1,1,1]
  v_pk_fma_f32 v[174:175], v[174:175], v[94:95], v[102:103] op_sel:[0,1,0] op_sel_hi:[1,1,1]
  v_pk_mul_f32 v[100:101], v[172:173], v[172:173]
  v_pk_mul_f32 v[102:103], v[174:175], v[174:175]
  v_pk_fma_f32 v[100:101], v[100:101], v[96:97], v[96:97] op_sel:[0,1,0] op_sel_hi:[1,1,0]
  v_pk_fma_f32 v[102:103], v[102:103], v[96:97], v[96:97] op_sel:[0,1,0] op_sel_hi:[1,1,0]
  v_pk_mul_f32 v[100:101], v[100:101], v[172:173]
  v_pk_mul_f32 v[102:103], v[102:103], v[174:175]
  v_exp_f32 v100, v100
  v_exp_f32 v101, v101
  v_exp_f32 v102, v102
  v_exp_f32 v103, v103
  v_pk_add_f32 v[100:101], v[100:101], v[98:99] op_sel_hi:[1,0]
  v_pk_add_f32 v[102:103], v[102:103], v[98:99] op_sel_hi:[1,0]
  v_rcp_f32 v100, v100
  v_rcp_f32 v101, v101
  v_rcp_f32 v102, v102
  v_rcp_f32 v103, v103
  v_pk_mul_f32 v[172:173], v[172:173], v[100:101]
  v_pk_mul_f32 v[174:175], v[174:175], v[102:103]
  v_cvt_pk_bf16_f32 v108, v172, v173
  v_cvt_pk_bf16_f32 v109, v174, v175
  v_pk_fma_f32 v[104:105], v[44:45], v[94:95], v[72:73] op_sel:[0,0,0] op_sel_hi:[1,0,1] neg_lo:[0,1,0] neg_hi:[0,1,0]
  v_pk_fma_f32 v[106:107], v[46:47], v[94:95], v[74:75] op_sel:[0,0,0] op_sel_hi:[1,0,1] neg_lo:[0,1,0] neg_hi:[0,1,0]
  v_pk_fma_f32 v[188:189], v[188:189], v[94:95], v[104:105] op_sel:[0,1,0] op_sel_hi:[1,1,1]
  v_pk_fma_f32 v[190:191], v[190:191], v[94:95], v[106:107] op_sel:[0,1,0] op_sel_hi:[1,1,1]
  v_pk_mul_f32 v[104:105], v[188:189], v[188:189]
  v_pk_mul_f32 v[106:107], v[190:191], v[190:191]
  v_pk_fma_f32 v[104:105], v[104:105], v[96:97], v[96:97] op_sel:[0,1,0] op_sel_hi:[1,1,0]
  v_pk_fma_f32 v[106:107], v[106:107], v[96:97], v[96:97] op_sel:[0,1,0] op_sel_hi:[1,1,0]
  v_pk_mul_f32 v[104:105], v[104:105], v[188:189]
  v_pk_mul_f32 v[106:107], v[106:107], v[190:191]
  v_exp_f32 v104, v104
  v_exp_f32 v105, v105
  v_exp_f32 v106, v106
  v_exp_f32 v107, v107
  v_pk_add_f32 v[104:105], v[104:105], v[98:99] op_sel_hi:[1,0]
  v_pk_add_f32 v[106:107], v[106:107], v[98:99] op_sel_hi:[1,0]
  v_rcp_f32 v104, v104
  v_rcp_f32 v105, v105
  v_rcp_f32 v106, v106
  v_rcp_f32 v107, v107
  v_pk_mul_f32 v[188:189], v[188:189], v[104:105]
  v_pk_mul_f32 v[190:191], v[190:191], v[106:107]
  v_cvt_pk_bf16_f32 v110, v188, v189
  v_cvt_pk_bf16_f32 v111, v190, v191
  s_add_u32 s3, s10, 393216
  s_nop 0
  v_permlane16_swap_b32 v108, v110
  v_permlane16_swap_b32 v109, v111
  buffer_store_dwordx4 v[108:111], v12, s[44:47], s3 offen sc1
  v_pk_fma_f32 v[100:101], v[48:49], v[94:95], v[76:77] op_sel:[0,0,0] op_sel_hi:[1,0,1] neg_lo:[0,1,0] neg_hi:[0,1,0]
  v_pk_fma_f32 v[102:103], v[50:51], v[94:95], v[78:79] op_sel:[0,0,0] op_sel_hi:[1,0,1] neg_lo:[0,1,0] neg_hi:[0,1,0]
  v_pk_fma_f32 v[204:205], v[204:205], v[94:95], v[100:101] op_sel:[0,1,0] op_sel_hi:[1,1,1]
  v_pk_fma_f32 v[206:207], v[206:207], v[94:95], v[102:103] op_sel:[0,1,0] op_sel_hi:[1,1,1]
  v_pk_mul_f32 v[100:101], v[204:205], v[204:205]
  v_pk_mul_f32 v[102:103], v[206:207], v[206:207]
  v_pk_fma_f32 v[100:101], v[100:101], v[96:97], v[96:97] op_sel:[0,1,0] op_sel_hi:[1,1,0]
  v_pk_fma_f32 v[102:103], v[102:103], v[96:97], v[96:97] op_sel:[0,1,0] op_sel_hi:[1,1,0]
  v_pk_mul_f32 v[100:101], v[100:101], v[204:205]
  v_pk_mul_f32 v[102:103], v[102:103], v[206:207]
  v_exp_f32 v100, v100
  v_exp_f32 v101, v101
  v_exp_f32 v102, v102
  v_exp_f32 v103, v103
  v_pk_add_f32 v[100:101], v[100:101], v[98:99] op_sel_hi:[1,0]
  v_pk_add_f32 v[102:103], v[102:103], v[98:99] op_sel_hi:[1,0]
  v_rcp_f32 v100, v100
  v_rcp_f32 v101, v101
  v_rcp_f32 v102, v102
  v_rcp_f32 v103, v103
  v_pk_mul_f32 v[204:205], v[204:205], v[100:101]
  v_pk_mul_f32 v[206:207], v[206:207], v[102:103]
  v_cvt_pk_bf16_f32 v112, v204, v205
  v_cvt_pk_bf16_f32 v113, v206, v207
  v_pk_fma_f32 v[104:105], v[52:53], v[94:95], v[80:81] op_sel:[0,0,0] op_sel_hi:[1,0,1] neg_lo:[0,1,0] neg_hi:[0,1,0]
  v_pk_fma_f32 v[106:107], v[54:55], v[94:95], v[82:83] op_sel:[0,0,0] op_sel_hi:[1,0,1] neg_lo:[0,1,0] neg_hi:[0,1,0]
  v_pk_fma_f32 v[220:221], v[220:221], v[94:95], v[104:105] op_sel:[0,1,0] op_sel_hi:[1,1,1]
  v_pk_fma_f32 v[222:223], v[222:223], v[94:95], v[106:107] op_sel:[0,1,0] op_sel_hi:[1,1,1]
  v_pk_mul_f32 v[104:105], v[220:221], v[220:221]
  v_pk_mul_f32 v[106:107], v[222:223], v[222:223]
  v_pk_fma_f32 v[104:105], v[104:105], v[96:97], v[96:97] op_sel:[0,1,0] op_sel_hi:[1,1,0]
  v_pk_fma_f32 v[106:107], v[106:107], v[96:97], v[96:97] op_sel:[0,1,0] op_sel_hi:[1,1,0]
  v_pk_mul_f32 v[104:105], v[104:105], v[220:221]
  v_pk_mul_f32 v[106:107], v[106:107], v[222:223]
  v_exp_f32 v104, v104
  v_exp_f32 v105, v105
  v_exp_f32 v106, v106
  v_exp_f32 v107, v107
  v_pk_add_f32 v[104:105], v[104:105], v[98:99] op_sel_hi:[1,0]
  v_pk_add_f32 v[106:107], v[106:107], v[98:99] op_sel_hi:[1,0]
  v_rcp_f32 v104, v104
  v_rcp_f32 v105, v105
  v_rcp_f32 v106, v106
  v_rcp_f32 v107, v107
  v_pk_mul_f32 v[220:221], v[220:221], v[104:105]
  v_pk_mul_f32 v[222:223], v[222:223], v[106:107]
  v_cvt_pk_bf16_f32 v114, v220, v221
  v_cvt_pk_bf16_f32 v115, v222, v223
  s_add_u32 s3, s10, 395264
  s_nop 0
  v_permlane16_swap_b32 v112, v114
  v_permlane16_swap_b32 v113, v115
  buffer_store_dwordx4 v[112:115], v12, s[44:47], s3 offen sc1
  s_waitcnt vmcnt(0) lgkmcnt(0)
  s_barrier
  s_add_u32 s97, s97, 1
  s_branch L_w2_body
L_w1_c1:
L_w2_c0:
L_w2_body:
  s_cmp_ge_u32 s2, 256
  s_cbranch_scc1 L_w2_end
  v_lshrrev_b32 v2, 6, v0
  v_and_b32 v1, 63, v0
  v_readfirstlane_b32 s70, v2
  s_and_b32 s3, s2, 7
  s_lshr_b32 s99, s2, 3
  s_and_b32 s5, s3, 3
  s_lshl_b32 s5, s5, 2
  s_and_b32 s6, s99, 3
  s_add_u32 s68, s5, s6
  s_lshr_b32 s5, s3, 2
  s_lshl_b32 s5, s5, 3
  s_lshr_b32 s6, s99, 2
  s_add_u32 s69, s5, s6
  s_cmp_lt_u32 s70, 4
  s_cbranch_scc1 L_w2_compute
L_w2_loader:
  s_add_u32 s9, s70, s68
  s_and_b32 s9, s9, 3
  s_lshl_b32 s76, s9, 12
  s_lshl_b32 s77, s9, 11
  v_and_b32 v10, 7, v1
  v_lshrrev_b32 v3, 3, v1
  s_lshl_b32 s10, s9, 4
  v_add_u32 v3, s10, v3
  v_mul_u32_u24 v3, 2048, v3
  v_lshrrev_b32 v2, 3, v1
  v_and_b32 v2, 2, v2
  v_xor_b32 v2, v2, v10
  s_lshl_b32 s10, s69, 7
  v_add_u32 v3, s10, v3
  v_lshl_add_u32 v8, v2, 4, v3
  v_xor_b32 v2, 4, v2
  v_add_u32 v3, 16384, v3
  v_lshl_add_u32 v9, v2, 4, v3
  s_mov_b32 s40, s28
  s_and_b32 s41, s29, 0xffff
  s_mov_b32 s42, 7340032
  s_mov_b32 s43, 0x00020000
  s_add_u32 s3, s68, s69
  s_lshl_b32 s3, s3, 3
  s_lshl_b32 s85, 0xffff02, s3
  s_sub_u32 s3, 0, s3
  s_lshr_b32 s3, 0xffff02, s3
  s_or_b32 s85, s85, s3
  s_and_b32 s86, s68, 3
  s_lshl_b32 s86, s86, 2
  v_lshl_add_u32 v14, v1, 4, s77
  s_and_b32 s3, s70, 3
  s_lshl_b32 s4, s99, 2
  s_add_u32 s3, s3, s4
  s_lshl_b32 s4, s3, 6
  s_and_b32 s4, s4, 64
  s_lshr_b32 s3, s3, 1
  s_lshl_b32 s98, s3, 11
  s_add_u32 s98, s98, s4
  s_sub_u32 s4, 384, s40
  s_and_b32 s4, s4, 0x380
  s_add_u32 s98, s98, s4
  s_lshl_b32 s4, s69, 7
  s_and_b32 s4, s4, 1024
  s_add_u32 s98, s98, s4
  s_add_u32 s98, s98, 2097152
  s_buffer_load_dword s84, s[40:43], s98
  s_add_u32 s98, s98, 131072
  s_buffer_load_dword s84, s[40:43], s98
  s_add_u32 s98, s98, 131072
  s_buffer_load_dword s84, s[40:43], s98
  s_add_u32 s98, s98, 131072
  s_buffer_load_dword s84, s[40:43], s98
  s_add_u32 s98, s98, 131072
  s_buffer_load_dword s84, s[40:43], s98
  s_add_u32 s98, s98, 131072
  s_buffer_load_dword s84, s[40:43], s98
  s_add_u32 s98, s98, 131072
  s_buffer_load_dword s84, s[40:43], s98
  s_add_u32 s98, s98, 131072
  s_buffer_load_dword s84, s[40:43], s98
  s_add_u32 s98, s98, 131072
  s_buffer_load_dword s84, s[40:43], s98
  s_add_u32 s98, s98, 131072
  s_bfe_i32 s74, s85, 0x80000
  s_add_i32 s74, s74, 0
  s_cmp_lt_i32 s74, 0
  s_cselect_b32 s74, 55, s74
  s_add_u32 s3, s74, s86
  s_and_b32 s3, s3, 15
  s_cmp_lt_u32 s74, 16
  s_cselect_b32 s74, s3, s74
  s_lshl_b32 s74, s74, 17
  s_add_u32 m0, s77, 0
  s_add_u32 s4, s74, 0
  buffer_load_dwordx4 v8, s[40:43], s4 offen lds
  s_add_u32 m0, s77, 1024
  s_nop 0
  buffer_load_dwordx4 v9, s[40:43], s4 offen lds
  s_bfe_i32 s74, s85, 0x80008
  s_add_i32 s74, s74, 1
  s_add_u32 s74, s74, s86
  s_and_b32 s74, s74, 15
  s_lshl_b32 s74, s74, 17
  s_add_u32 m0, s77, 8192
  s_add_u32 s4, s74, 0
  buffer_load_dwordx4 v8, s[40:43], s4 offen lds
  s_add_u32 m0, s77, 9216
  s_nop 0
  buffer_load_dwordx4 v9, s[40:43], s4 offen lds
  s_bfe_i32 s74, s85, 0x80010
  s_add_i32 s74, s74, 2
  s_add_u32 s74, s74, s86
  s_and_b32 s74, s74, 15
  s_lshl_b32 s74, s74, 17
  s_add_u32 m0, s77, 16384
  s_add_u32 s4, s74, 0
  buffer_load_dwordx4 v8, s[40:43], s4 offen lds
  s_add_u32 m0, s77, 17408
  s_nop 0
  buffer_load_dwordx4 v9, s[40:43], s4 offen lds
  s_bfe_i32 s74, s85, 0x80018
  s_add_i32 s74, s74, 3
  s_add_u32 s74, s74, s86
  s_and_b32 s74, s74, 15
  s_lshl_b32 s74, s74, 17
  s_add_u32 m0, s77, 24576
  s_add_u32 s4, s74, 0
  buffer_load_dwordx4 v8, s[40:43], s4 offen lds
  s_add_u32 m0, s77, 25600
  s_nop 0
  buffer_load_dwordx4 v9, s[40:43], s4 offen lds
  s_bfe_i32 s74, s85, 0x80000
  s_add_i32 s74, s74, 4
  s_add_u32 s74, s74, s86
  s_and_b32 s74, s74, 15
  s_lshl_b32 s74, s74, 17
  s_add_u32 m0, s77, 32768
  s_add_u32 s4, s74, 0
  buffer_load_dwordx4 v8, s[40:43], s4 offen lds
  s_add_u32 m0, s77, 33792
  s_nop 0
  buffer_load_dwordx4 v9, s[40:43], s4 offen lds
  s_bfe_i32 s74, s85, 0x80008
  s_add_i32 s74, s74, 5
  s_add_u32 s74, s74, s86
  s_and_b32 s74, s74, 15
  s_lshl_b32 s74, s74, 17
  s_add_u32 m0, s77, 40960
  s_add_u32 s4, s74, 0
  buffer_load_dwordx4 v8, s[40:43], s4 offen lds
  s_add_u32 m0, s77, 41984
  s_nop 0
  buffer_load_dwordx4 v9, s[40:43], s4 offen lds
  s_bfe_i32 s74, s85, 0x80010
  s_add_i32 s74, s74, 6
  s_add_u32 s74, s74, s86
  s_and_b32 s74, s74, 15
  s_lshl_b32 s74, s74, 17
  s_add_u32 m0, s77, 49152
  s_add_u32 s4, s74, 0
  buffer_load_dwordx4 v8, s[40:43], s4 offen lds
  s_add_u32 m0, s77, 50176
  s_nop 0
  buffer_load_dwordx4 v9, s[40:43], s4 offen lds
  s_bfe_i32 s74, s85, 0x80018
  s_add_i32 s74, s74, 7
  s_add_u32 s74, s74, s86
  s_and_b32 s74, s74, 15
  s_lshl_b32 s74, s74, 17
  s_add_u32 m0, s77, 57344
  s_add_u32 s4, s74, 0
  buffer_load_dwordx4 v8, s[40:43], s4 offen lds
  s_add_u32 m0, s77, 58368
  s_nop 0
  buffer_load_dwordx4 v9, s[40:43], s4 offen lds
  s_bfe_i32 s74, s85, 0x80000
  s_add_i32 s74, s74, 8
  s_add_u32 s74, s74, s86
  s_and_b32 s74, s74, 15
  s_lshl_b32 s74, s74, 17
  s_add_u32 m0, s77, 65536
  s_add_u32 s4, s74, 0
  buffer_load_dwordx4 v8, s[40:43], s4 offen lds
  s_add_u32 m0, s77, 66560
  s_nop 0
  buffer_load_dwordx4 v9, s[40:43], s4 offen lds
  s_bfe_i32 s74, s85, 0x80008
  s_add_i32 s74, s74, 9
  s_add_u32 s74, s74, s86
  s_and_b32 s74, s74, 15
  s_lshl_b32 s74, s74, 17
  s_add_u32 m0, s77, 73728
  s_add_u32 s4, s74, 0
  buffer_load_dwordx4 v8, s[40:43], s4 offen lds
  s_add_u32 m0, s77, 74752
  s_nop 0
  buffer_load_dwordx4 v9, s[40:43], s4 offen lds
  s_add_u32 s44, s22, 24903680
  s_addc_u32 s45, s23, 0
  s_and_b32 s45, s45, 0xffff
  s_mov_b32 s46, 32768
  s_mov_b32 s47, 0x00020000
  s_lshl_b32 s3, s97, 12
  s_lshl_b32 s4, s68, 8
  s_add_u32 s3, s3, s4
  s_sub_u32 s3, s3, 4096
  v_and_b32 v2, 15, v1
  v_lshlrev_b32 v2, 2, v2
  v_mov_b32 v3, 1
  s_mov_b32 s79, 0x100000
  s_cmp_lg_u32 s70, 4
  s_barrier
  s_cbranch_scc1 L_w2_nofl
  s_mov_b64 exec, 1
  buffer_store_dword v3, off, s[44:47], s87 sc1
  s_mov_b64 exec, -1
L_w2_nofl:
  s_mov_b32 s5, s3
  s_bfe_i32 s74, s85, 0x80010
  s_add_i32 s74, s74, 10
  s_add_u32 s74, s74, s86
  s_and_b32 s74, s74, 15
  s_lshl_b32 s74, s74, 17
  s_add_u32 m0, s77, 81920
  s_add_u32 s4, s74, 0
  buffer_load_dwordx4 v8, s[40:43], s4 offen lds
  s_add_u32 m0, s77, 82944
  s_nop 0
  buffer_load_dwordx4 v9, s[40:43], s4 offen lds
  s_bfe_i32 s74, s85, 0x80018
  s_add_i32 s74, s74, 11
  s_add_u32 s74, s74, s86
  s_and_b32 s74, s74, 15
  s_lshl_b32 s74, s74, 17
  s_add_u32 m0, s77, 90112
  s_add_u32 s4, s74, 0
  buffer_load_dwordx4 v8, s[40:43], s4 offen lds
  s_add_u32 m0, s77, 91136
  s_nop 0
  buffer_load_dwordx4 v9, s[40:43], s4 offen lds
  s_bfe_i32 s74, s85, 0x80000
  s_add_i32 s74, s74, 12
  s_add_u32 s74, s74, s86
  s_and_b32 s74, s74, 15
  s_lshl_b32 s74, s74, 17
  s_add_u32 m0, s77, 98304
  s_add_u32 s4, s74, 0
  buffer_load_dwordx4 v8, s[40:43], s4 offen lds
  s_add_u32 m0, s77, 99328
  s_nop 0
  buffer_load_dwordx4 v9, s[40:43], s4 offen lds
  s_bfe_i32 s74, s85, 0x80008
  s_add_i32 s74, s74, 13
  s_add_u32 s3, s74, s86
  s_and_b32 s3, s3, 15
  s_cmp_lt_u32 s74, 16
  s_cselect_b32 s74, s3, s74
  s_lshl_b32 s74, s74, 17
  s_add_u32 m0, s77, 106496
  s_add_u32 s4, s74, 0
  buffer_load_dwordx4 v8, s[40:43], s4 offen lds
  s_add_u32 m0, s77, 107520
  s_nop 0
  buffer_load_dwordx4 v9, s[40:43], s4 offen lds
  s_bfe_i32 s74, s85, 0x80010
  s_add_i32 s74, s74, 14
  s_add_u32 s3, s74, s86
  s_and_b32 s3, s3, 15
  s_cmp_lt_u32 s74, 16
  s_cselect_b32 s74, s3, s74
  s_lshl_b32 s74, s74, 17
  s_add_u32 m0, s77, 114688
  s_add_u32 s4, s74, 0
  buffer_load_dwordx4 v8, s[40:43], s4 offen lds
  s_add_u32 m0, s77, 115712
  s_nop 0
  buffer_load_dwordx4 v9, s[40:43], s4 offen lds
  s_bfe_i32 s74, s85, 0x80018
  s_add_i32 s74, s74, 15
  s_add_u32 s3, s74, s86
  s_and_b32 s3, s3, 15
  s_cmp_lt_u32 s74, 16
  s_cselect_b32 s74, s3, s74
  s_lshl_b32 s74, s74, 17
  s_add_u32 m0, s77, 122880
  s_add_u32 s4, s74, 0
  buffer_load_dwordx4 v8, s[40:43], s4 offen lds
  s_add_u32 m0, s77, 123904
  s_nop 0
  buffer_load_dwordx4 v9, s[40:43], s4 offen lds
  s_bfe_i32 s74, s85, 0x80000
  s_add_i32 s74, s74, 16
  s_add_u32 s3, s74, s86
  s_and_b32 s3, s3, 15
  s_cmp_lt_u32 s74, 16
  s_cselect_b32 s74, s3, s74
  s_lshl_b32 s74, s74, 17
  s_add_u32 m0, s77, 131072
  s_add_u32 s4, s74, 0
  buffer_load_dwordx4 v8, s[40:43], s4 offen lds
  s_add_u32 m0, s77, 132096
  s_nop 0
  buffer_load_dwordx4 v9, s[40:43], s4 offen lds
  s_bfe_i32 s74, s85, 0x80008
  s_add_i32 s74, s74, 17
  s_lshl_b32 s74, s74, 17
  s_add_u32 m0, s77, 139264
  s_add_u32 s4, s74, 0
  buffer_load_dwordx4 v8, s[40:43], s4 offen lds
  s_add_u32 m0, s77, 140288
  s_nop 0
  buffer_load_dwordx4 v9, s[40:43], s4 offen lds
  s_bfe_i32 s74, s85, 0x80010
  s_add_i32 s74, s74, 18
  s_lshl_b32 s74, s74, 17
  s_add_u32 m0, s77, 147456
  s_add_u32 s4, s74, 0
  buffer_load_dwordx4 v8, s[40:43], s4 offen lds
  s_add_u32 m0, s77, 148480
  s_nop 0
  buffer_load_dwordx4 v9, s[40:43], s4 offen lds
  s_bfe_i32 s74, s85, 0x80018
  s_add_i32 s74, s74, 19
  s_lshl_b32 s74, s74, 17
  s_add_u32 m0, s77, 155648
  s_add_u32 s4, s74, 0
  buffer_load_dwordx4 v8, s[40:43], s4 offen lds
  s_add_u32 m0, s77, 156672
  s_nop 0
  buffer_load_dwordx4 v9, s[40:43], s4 offen lds
  s_mov_b32 s3, s5
  s_cmp_lg_u32 s70, 4
  s_cbranch_scc1 L_w2_dep
L_w2_poll:
  buffer_load_dword v3, v2, s[44:47], s3 offen sc1
  s_sub_u32 s79, s79, 1
  s_cbranch_scc1 L_w2_dep
  s_waitcnt vmcnt(0)
  v_cmp_ne_u32 vcc, 1, v3
  s_cbranch_vccnz L_w2_poll
L_w2_dep:
  s_waitcnt vmcnt(32) lgkmcnt(0)
  s_barrier
  s_waitcnt vmcnt(24)
  s_barrier
  s_buffer_load_dword s84, s[40:43], s98
  s_add_u32 s98, s98, 131072
  s_bfe_i32 s74, s85, 0x80000
  s_add_i32 s74, s74, 20
  s_lshl_b32 s74, s74, 17
  s_add_u32 m0, s77, 0
  s_add_u32 s4, s74, 0
  buffer_load_dwordx4 v8, s[40:43], s4 offen lds
  s_add_u32 m0, s77, 1024
  s_nop 0
  buffer_load_dwordx4 v9, s[40:43], s4 offen lds
  s_buffer_load_dword s84, s[40:43], s98
  s_add_u32 s98, s98, 131072
  s_bfe_i32 s74, s85, 0x80008
  s_add_i32 s74, s74, 21
  s_lshl_b32 s74, s74, 17
  s_add_u32 m0, s77, 8192
  s_add_u32 s4, s74, 0
  buffer_load_dwordx4 v8, s[40:43], s4 offen lds
  s_add_u32 m0, s77, 9216
  s_nop 0
  buffer_load_dwordx4 v9, s[40:43], s4 offen lds
  s_buffer_load_dword s84, s[40:43], s98
  s_add_u32 s98, s98, 131072
  s_bfe_i32 s74, s85, 0x80010
  s_add_i32 s74, s74, 22
  s_lshl_b32 s74, s74, 17
  s_add_u32 m0, s77, 16384
  s_add_u32 s4, s74, 0
  buffer_load_dwordx4 v8, s[40:43], s4 offen lds
  s_add_u32 m0, s77, 17408
  s_nop 0
  buffer_load_dwordx4 v9, s[40:43], s4 offen lds
  s_buffer_load_dword s84, s[40:43], s98
  s_add_u32 s98, s98, 131072
  s_bfe_i32 s74, s85, 0x80018
  s_add_i32 s74, s74, 23
  s_lshl_b32 s74, s74, 17
  s_add_u32 m0, s77, 24576
  s_add_u32 s4, s74, 0
  buffer_load_dwordx4 v8, s[40:43], s4 offen lds
  s_add_u32 m0, s77, 25600
  s_nop 0
  buffer_load_dwordx4 v9, s[40:43], s4 offen lds
  s_waitcnt vmcnt(24)
  s_barrier
  s_buffer_load_dword s84, s[40:43], s98
  s_add_u32 s98, s98, 131072
  s_bfe_i32 s74, s85, 0x80000
  s_add_i32 s74, s74, 24
  s_lshl_b32 s74, s74, 17
  s_add_u32 m0, s77, 32768
  s_add_u32 s4, s74, 0
  buffer_load_dwordx4 v8, s[40:43], s4 offen lds
  s_add_u32 m0, s77, 33792
  s_nop 0
  buffer_load_dwordx4 v9, s[40:43], s4 offen lds
  s_buffer_load_dword s84, s[40:43], s98
  s_add_u32 s98, s98, 131072
  s_bfe_i32 s74, s85, 0x80008
  s_add_i32 s74, s74, 25
  s_lshl_b32 s74, s74, 17
  s_add_u32 m0, s77, 40960
  s_add_u32 s4, s74, 0
  buffer_load_dwordx4 v8, s[40:43], s4 offen lds
  s_add_u32 m0, s77, 41984
  s_nop 0
  buffer_load_dwordx4 v9, s[40:43], s4 offen lds
  s_buffer_load_dword s84, s[40:43], s98
  s_add_u32 s98, s98, 131072
  s_bfe_i32 s74, s85, 0x80010
  s_add_i32 s74, s74, 26
  s_lshl_b32 s74, s74, 17
  s_add_u32 m0, s77, 49152
  s_add_u32 s4, s74, 0
  buffer_load_dwordx4 v8, s[40:43], s4 offen lds
  s_add_u32 m0, s77, 50176
  s_nop 0
  buffer_load_dwordx4 v9, s[40:43], s4 offen lds
  s_buffer_load_dword s84, s[40:43], s98
  s_add_u32 s98, s98, 131072
  s_bfe_i32 s74, s85, 0x80018
  s_add_i32 s74, s74, 27
  s_lshl_b32 s74, s74, 17
  s_add_u32 m0, s77, 57344
  s_add_u32 s4, s74, 0
  buffer_load_dwordx4 v8, s[40:43], s4 offen lds
  s_add_u32 m0, s77, 58368
  s_nop 0
  buffer_load_dwordx4 v9, s[40:43], s4 offen lds
  s_waitcnt vmcnt(24)
  s_barrier
  s_buffer_load_dword s84, s[40:43], s98
  s_add_u32 s98, s98, 131072
  s_bfe_i32 s74, s85, 0x80000
  s_add_i32 s74, s74, 28
  s_lshl_b32 s74, s74, 17
  s_add_u32 m0, s77, 65536
  s_add_u32 s4, s74, 0
  buffer_load_dwordx4 v8, s[40:43], s4 offen lds
  s_add_u32 m0, s77, 66560
  s_nop 0
  buffer_load_dwordx4 v9, s[40:43], s4 offen lds
  s_buffer_load_dword s84, s[40:43], s98
  s_add_u32 s98, s98, 131072
  s_bfe_i32 s74, s85, 0x80008
  s_add_i32 s74, s74, 29
  s_lshl_b32 s74, s74, 17
  s_add_u32 m0, s77, 73728
  s_add_u32 s4, s74, 0
  buffer_load_dwordx4 v8, s[40:43], s4 offen lds
  s_add_u32 m0, s77, 74752
  s_nop 0
  buffer_load_dwordx4 v9, s[40:43], s4 offen lds
  s_buffer_load_dword s84, s[40:43], s98
  s_add_u32 s98, s98, 131072
  s_bfe_i32 s74, s85, 0x80010
  s_add_i32 s74, s74, 30
  s_lshl_b32 s74, s74, 17
  s_add_u32 m0, s77, 81920
  s_add_u32 s4, s74, 0
  buffer_load_dwordx4 v8, s[40:43], s4 offen lds
  s_add_u32 m0, s77, 82944
  s_nop 0
  buffer_load_dwordx4 v9, s[40:43], s4 offen lds
  s_buffer_load_dword s84, s[40:43], s98
  s_add_u32 s98, s98, 131072
  s_bfe_i32 s74, s85, 0x80018
  s_add_i32 s74, s74, 31
  s_lshl_b32 s74, s74, 17
  s_add_u32 m0, s77, 90112
  s_add_u32 s4, s74, 0
  buffer_load_dwordx4 v8, s[40:43], s4 offen lds
  s_add_u32 m0, s77, 91136
  s_nop 0
  buffer_load_dwordx4 v9, s[40:43], s4 offen lds
  s_waitcnt vmcnt(24)
  s_barrier
  s_buffer_load_dword s84, s[40:43], s98
  s_add_u32 s98, s98, 131072
  s_bfe_i32 s74, s85, 0x80000
  s_add_i32 s74, s74, 32
  s_lshl_b32 s74, s74, 17
  s_add_u32 m0, s77, 98304
  s_add_u32 s4, s74, 0
  buffer_load_dwordx4 v8, s[40:43], s4 offen lds
  s_add_u32 m0, s77, 99328
  s_nop 0
  buffer_load_dwordx4 v9, s[40:43], s4 offen lds
  s_buffer_load_dword s84, s[40:43], s98
  s_add_u32 s98, s98, 131072
  s_bfe_i32 s74, s85, 0x80008
  s_add_i32 s74, s74, 33
  s_lshl_b32 s74, s74, 17
  s_add_u32 m0, s77, 106496
  s_add_u32 s4, s74, 0
  buffer_load_dwordx4 v8, s[40:43], s4 offen lds
  s_add_u32 m0, s77, 107520
  s_nop 0
  buffer_load_dwordx4 v9, s[40:43], s4 offen lds
  s_buffer_load_dword s84, s[40:43], s98
  s_add_u32 s98, s98, 131072
  s_bfe_i32 s74, s85, 0x80010
  s_add_i32 s74, s74, 34
  s_lshl_b32 s74, s74, 17
  s_add_u32 m0, s77, 114688
  s_add_u32 s4, s74, 0
  buffer_load_dwordx4 v8, s[40:43], s4 offen lds
  s_add_u32 m0, s77, 115712
  s_nop 0
  buffer_load_dwordx4 v9, s[40:43], s4 offen lds
  s_waitcnt vmcnt(22)
  s_barrier
  s_buffer_load_dword s84, s[40:43], s98
  s_add_u32 s98, s98, 131072
  s_bfe_i32 s74, s85, 0x80018
  s_add_i32 s74, s74, 35
  s_lshl_b32 s74, s74, 17
  s_add_u32 m0, s77, 122880
  s_add_u32 s4, s74, 0
  buffer_load_dwordx4 v8, s[40:43], s4 offen lds
  s_add_u32 m0, s77, 123904
  s_nop 0
  buffer_load_dwordx4 v9, s[40:43], s4 offen lds
  s_buffer_load_dword s84, s[40:43], s98
  s_add_u32 s98, s98, 131072
  s_bfe_i32 s74, s85, 0x80000
  s_add_i32 s74, s74, 36
  s_lshl_b32 s74, s74, 17
  s_add_u32 m0, s77, 131072
  s_add_u32 s4, s74, 0
  buffer_load_dwordx4 v8, s[40:43], s4 offen lds
  s_add_u32 m0, s77, 132096
  s_nop 0
  buffer_load_dwordx4 v9, s[40:43], s4 offen lds
  s_buffer_load_dword s84, s[40:43], s98
  s_add_u32 s98, s98, 131072
  s_bfe_i32 s74, s85, 0x80008
  s_add_i32 s74, s74, 37
  s_lshl_b32 s74, s74, 17
  s_add_u32 m0, s77, 139264
  s_add_u32 s4, s74, 0
  buffer_load_dwordx4 v8, s[40:43], s4 offen lds
  s_add_u32 m0, s77, 140288
  s_nop 0
  buffer_load_dwordx4 v9, s[40:43], s4 offen lds
  s_waitcnt vmcnt(20)
  s_barrier
  s_buffer_load_dword s84, s[40:43], s98
  s_add_u32 s98, s98, 131072
  s_bfe_i32 s74, s85, 0x80010
  s_add_i32 s74, s74, 38
  s_lshl_b32 s74, s74, 17
  s_add_u32 m0, s77, 147456
  s_add_u32 s4, s74, 0
  buffer_load_dwordx4 v8, s[40:43], s4 offen lds
  s_add_u32 m0, s77, 148480
  s_nop 0
  buffer_load_dwordx4 v9, s[40:43], s4 offen lds
  s_buffer_load_dword s84, s[40:43], s98
  s_add_u32 s98, s98, 131072
  s_bfe_i32 s74, s85, 0x80018
  s_add_i32 s74, s74, 39
  s_lshl_b32 s74, s74, 17
  s_add_u32 m0, s77, 155648
  s_add_u32 s4, s74, 0
  buffer_load_dwordx4 v8, s[40:43], s4 offen lds
  s_add_u32 m0, s77, 156672
  s_nop 0
  buffer_load_dwordx4 v9, s[40:43], s4 offen lds
  s_buffer_load_dword s84, s[40:43], s98
  s_add_u32 s98, s98, 131072
  s_bfe_i32 s74, s85, 0x80000
  s_add_i32 s74, s74, 40
  s_lshl_b32 s74, s74, 17
  s_add_u32 m0, s77, 0
  s_add_u32 s4, s74, 0
  buffer_load_dwordx4 v8, s[40:43], s4 offen lds
  s_add_u32 m0, s77, 1024
  s_nop 0
  buffer_load_dwordx4 v9, s[40:43], s4 offen lds
  s_waitcnt vmcnt(18)
  s_barrier
  s_buffer_load_dword s84, s[40:43], s98
  s_add_u32 s98, s98, 131072
  s_bfe_i32 s74, s85, 0x80008
  s_add_i32 s74, s74, 41
  s_lshl_b32 s74, s74, 17
  s_add_u32 m0, s77, 8192
  s_add_u32 s4, s74, 0
  buffer_load_dwordx4 v8, s[40:43], s4 offen lds
  s_add_u32 m0, s77, 9216
  s_nop 0
  buffer_load_dwordx4 v9, s[40:43], s4 offen lds
  s_buffer_load_dword s84, s[40:43], s98
  s_add_u32 s98, s98, 131072
  s_bfe_i32 s74, s85, 0x80010
  s_add_i32 s74, s74, 42
  s_lshl_b32 s74, s74, 17
  s_add_u32 m0, s77, 16384
  s_add_u32 s4, s74, 0
  buffer_load_dwordx4 v8, s[40:43], s4 offen lds
  s_add_u32 m0, s77, 17408
  s_nop 0
  buffer_load_dwordx4 v9, s[40:43], s4 offen lds
  s_buffer_load_dword s84, s[40:43], s98
  s_add_u32 s98, s98, 131072
  s_bfe_i32 s74, s85, 0x80018
  s_add_i32 s74, s74, 43
  s_lshl_b32 s74, s74, 17
  s_add_u32 m0, s77, 24576
  s_add_u32 s4, s74, 0
  buffer_load_dwordx4 v8, s[40:43], s4 offen lds
  s_add_u32 m0, s77, 25600
  s_nop 0
  buffer_load_dwordx4 v9, s[40:43], s4 offen lds
  s_waitcnt vmcnt(16)
  s_barrier
  s_buffer_load_dword s84, s[40:43], s98
  s_add_u32 s98, s98, 131072
  s_bfe_i32 s74, s85, 0x80000
  s_add_i32 s74, s74, 44
  s_lshl_b32 s74, s74, 17
  s_add_u32 m0, s77, 32768
  s_add_u32 s4, s74, 0
  buffer_load_dwordx4 v8, s[40:43], s4 offen lds
  s_add_u32 m0, s77, 33792
  s_nop 0
  buffer_load_dwordx4 v9, s[40:43], s4 offen lds
  s_buffer_load_dword s84, s[40:43], s98
  s_add_u32 s98, s98, 131072
  s_bfe_i32 s74, s85, 0x80008
  s_add_i32 s74, s74, 45
  s_lshl_b32 s74, s74, 17
  s_add_u32 m0, s77, 40960
  s_add_u32 s4, s74, 0
  buffer_load_dwordx4 v8, s[40:43], s4 offen lds
  s_add_u32 m0, s77, 41984
  s_nop 0
  buffer_load_dwordx4 v9, s[40:43], s4 offen lds
  s_buffer_load_dword s84, s[40:43], s98
  s_add_u32 s98, s98, 131072
  s_bfe_i32 s74, s85, 0x80010
  s_add_i32 s74, s74, 46
  s_lshl_b32 s74, s74, 17
  s_add_u32 m0, s77, 49152
  s_add_u32 s4, s74, 0
  buffer_load_dwordx4 v8, s[40:43], s4 offen lds
  s_add_u32 m0, s77, 50176
  s_nop 0
  buffer_load_dwordx4 v9, s[40:43], s4 offen lds
  s_waitcnt vmcnt(14)
  s_barrier
  s_buffer_load_dword s84, s[40:43], s98
  s_add_u32 s98, s98, 131072
  s_bfe_i32 s74, s85, 0x80018
  s_add_i32 s74, s74, 47
  s_lshl_b32 s74, s74, 17
  s_add_u32 m0, s77, 57344
  s_add_u32 s4, s74, 0
  buffer_load_dwordx4 v8, s[40:43], s4 offen lds
  s_add_u32 m0, s77, 58368
  s_nop 0
  buffer_load_dwordx4 v9, s[40:43], s4 offen lds
  s_buffer_load_dword s84, s[40:43], s98
  s_add_u32 s98, s98, 131072
  s_bfe_i32 s74, s85, 0x80000
  s_add_i32 s74, s74, 48
  s_lshl_b32 s74, s74, 17
  s_add_u32 m0, s77, 65536
  s_add_u32 s4, s74, 0
  buffer_load_dwordx4 v8, s[40:43], s4 offen lds
  s_add_u32 m0, s77, 66560
  s_nop 0
  buffer_load_dwordx4 v9, s[40:43], s4 offen lds
  s_buffer_load_dword s84, s[40:43], s98
  s_add_u32 s98, s98, 131072
  s_bfe_i32 s74, s85, 0x80008
  s_add_i32 s74, s74, 49
  s_lshl_b32 s74, s74, 17
  s_add_u32 m0, s77, 73728
  s_add_u32 s4, s74, 0
  buffer_load_dwordx4 v8, s[40:43], s4 offen lds
  s_add_u32 m0, s77, 74752
  s_nop 0
  buffer_load_dwordx4 v9, s[40:43], s4 offen lds
  s_waitcnt vmcnt(12)
  s_barrier
  s_buffer_load_dword s84, s[40:43], s98
  s_add_u32 s98, s98, 131072
  s_bfe_i32 s74, s85, 0x80010
  s_add_i32 s74, s74, 50
  s_lshl_b32 s74, s74, 17
  s_add_u32 m0, s77, 81920
  s_add_u32 s4, s74, 0
  buffer_load_dwordx4 v8, s[40:43], s4 offen lds
  s_add_u32 m0, s77, 82944
  s_nop 0
  buffer_load_dwordx4 v9, s[40:43], s4 offen lds
  s_buffer_load_dword s84, s[40:43], s98
  s_add_u32 s98, s98, 131072
  s_bfe_i32 s74, s85, 0x80018
  s_add_i32 s74, s74, 51
  s_lshl_b32 s74, s74, 17
  s_add_u32 m0, s77, 90112
  s_add_u32 s4, s74, 0
  buffer_load_dwordx4 v8, s[40:43], s4 offen lds
  s_add_u32 m0, s77, 91136
  s_nop 0
  buffer_load_dwordx4 v9, s[40:43], s4 offen lds
  s_buffer_load_dword s84, s[40:43], s98
  s_add_u32 s98, s98, 131072
  s_bfe_i32 s74, s85, 0x80000
  s_add_i32 s74, s74, 52
  s_lshl_b32 s74, s74, 17
  s_add_u32 m0, s77, 98304
  s_add_u32 s4, s74, 0
  buffer_load_dwordx4 v8, s[40:43], s4 offen lds
  s_add_u32 m0, s77, 99328
  s_nop 0
  buffer_load_dwordx4 v9, s[40:43], s4 offen lds
  s_waitcnt vmcnt(10)
  s_barrier
  s_buffer_load_dword s84, s[40:43], s98
  s_add_u32 s98, s98, 131072
  s_bfe_i32 s74, s85, 0x80008
  s_add_i32 s74, s74, 53
  s_sub_u32 s3, s74, 56
  s_cmp_ge_i32 s74, 56
  s_cselect_b32 s74, s3, s74
  s_add_u32 s3, s74, s86
  s_and_b32 s3, s3, 15
  s_cmp_lt_u32 s74, 16
  s_cselect_b32 s74, s3, s74
  s_lshl_b32 s74, s74, 17
  s_add_u32 m0, s77, 106496
  s_add_u32 s4, s74, 0
  buffer_load_dwordx4 v8, s[40:43], s4 offen lds
  s_add_u32 m0, s77, 107520
  s_nop 0
  buffer_load_dwordx4 v9, s[40:43], s4 offen lds
  s_buffer_load_dword s84, s[40:43], s98
  s_add_u32 s98, s98, 131072
  s_bfe_i32 s74, s85, 0x80010
  s_add_i32 s74, s74, 54
  s_sub_u32 s3, s74, 56
  s_cmp_ge_i32 s74, 56
  s_cselect_b32 s74, s3, s74
  s_add_u32 s3, s74, s86
  s_and_b32 s3, s3, 15
  s_cmp_lt_u32 s74, 16
  s_cselect_b32 s74, s3, s74
  s_lshl_b32 s74, s74, 17
  s_add_u32 m0, s77, 114688
  s_add_u32 s4, s74, 0
  buffer_load_dwordx4 v8, s[40:43], s4 offen lds
  s_add_u32 m0, s77, 115712
  s_nop 0
  buffer_load_dwordx4 v9, s[40:43], s4 offen lds
  s_buffer_load_dword s84, s[40:43], s98
  s_add_u32 s98, s98, 131072
  s_bfe_i32 s74, s85, 0x80018
  s_add_i32 s74, s74, 55
  s_sub_u32 s3, s74, 56
  s_cmp_ge_i32 s74, 56
  s_cselect_b32 s74, s3, s74
  s_add_u32 s3, s74, s86
  s_and_b32 s3, s3, 15
  s_cmp_lt_u32 s74, 16
  s_cselect_b32 s74, s3, s74
  s_lshl_b32 s74, s74, 17
  s_add_u32 m0, s77, 122880
  s_add_u32 s4, s74, 0
  buffer_load_dwordx4 v8, s[40:43], s4 offen lds
  s_add_u32 m0, s77, 123904
  s_nop 0
  buffer_load_dwordx4 v9, s[40:43], s4 offen lds
  s_waitcnt vmcnt(8)
  s_barrier
  s_waitcnt vmcnt(0)
  s_barrier
  s_waitcnt vmcnt(0)
  s_barrier
  s_cmp_eq_u32 s96, 1
  s_cbranch_scc1 L_w2_end
  s_lshl_b32 s87, s97, 12
  s_lshl_b32 s4, s68, 8
  s_add_u32 s87, s87, s4
  s_lshl_b32 s4, s69, 2
  s_add_u32 s87, s87, s4
  s_mov_b32 s96, 1
  s_add_u32 s12, s22, 33554432
  s_addc_u32 s13, s23, 0
  s_add_u32 s34, s22, 67108864
  s_addc_u32 s35, s23, 0
  s_add_u32 s97, s97, 1
  s_branch L_attn_body
L_w2_end:
  s_endpgm
L_w2_compute:
  v_and_b32 v3, 15, v1
  v_lshrrev_b32 v2, 4, v1
  s_lshl_b32 s8, s68, 7
  s_lshl_b32 s9, s70, 5
  s_add_u32 s8, s8, s9
  s_mul_i32 s9, s8, 7168
  v_lshl_add_u32 v4, v1, 4, s9
  v_add_u32 v5, 114688, v4
  v_add_u32 v13, s8, v3
  s_lshl_b32 s10, s69, 7
  v_lshl_add_u32 v14, v2, 3, s10
  v_and_b32 v16, 1, v2
  v_lshrrev_b32 v17, 1, v2
  v_lshlrev_b32 v16, 5, v16
  v_lshl_add_u32 v16, v17, 4, v16
  v_add_u32 v16, s10, v16
  s_cmp_eq_u32 s96, 0
  s_cselect_b32 s7, 128, 0
  s_add_u32 s7, s7, 2048
  v_mad_u32_u24 v12, v13, s7, v16
  v_lshl_add_u32 v18, v17, 4, v13
  v_lshlrev_b32 v18, 3, v18
  v_and_b32 v16, 1, v2
  v_lshl_add_u32 v18, v16, 2, v18
  s_lshl_b32 s10, s69, 14
  v_add_u32 v18, s10, v18
  v_bfe_u32 v6, v1, 2, 2
  v_lshl_add_u32 v6, v2, 3, v6
  v_lshlrev_b32 v6, 7, v6
  v_and_b32 v17, 3, v1
  v_lshl_add_u32 v6, v17, 3, v6
  v_bfe_u32 v17, v1, 3, 2
  v_lshl_add_u32 v6, v17, 5, v6
  v_xor_b32 v7, 32, v6
  v_xor_b32 v8, 64, v6
  v_xor_b32 v9, 96, v6
  s_mov_b32 s11, 0xffff0000
  s_mov_b32 s75, 0
  s_add_u32 s3, s68, s69
  s_lshl_b32 s3, s3, 3
  s_lshl_b32 s8, 0xffff02, s3
  s_sub_u32 s3, 0, s3
  s_lshr_b32 s3, 0xffff02, s3
  s_or_b32 s8, s8, s3
  s_bfe_i32 s64, s8, 0x80000
  s_add_i32 s64, s64, 0
  s_cmp_lt_i32 s64, 0
  s_cselect_b32 s64, 55, s64
  s_lshl_b32 s64, s64, 11
  s_bfe_i32 s65, s8, 0x80008
  s_add_i32 s65, s65, 1
  s_lshl_b32 s65, s65, 11
  s_bfe_i32 s66, s8, 0x80010
  s_add_i32 s66, s66, 2
  s_lshl_b32 s66, s66, 11
  s_bfe_i32 s67, s8, 0x80018
  s_add_i32 s67, s67, 3
  s_lshl_b32 s67, s67, 11
  s_and_b32 s100, s68, 3
  s_lshl_b32 s100, s100, 13
  s_mov_b32 s101, 0
  s_mov_b32 s52, s30
  s_and_b32 s53, s31, 0xffff
  s_mov_b32 s54, 2048
  s_mov_b32 s55, 0x00020000
  buffer_load_dwordx2 v[192:193], v14, s[52:55], 0 offen offset:0
  buffer_load_dwordx2 v[194:195], v14, s[52:55], 0 offen offset:32
  buffer_load_dwordx2 v[196:197], v14, s[52:55], 0 offen offset:64
  buffer_load_dwordx2 v[198:199], v14, s[52:55], 0 offen offset:96
  s_add_u32 s36, s34, 8388608
  s_addc_u32 s37, s35, 0
  s_and_b32 s37, s37, 0xffff
  s_mov_b32 s38, 14680064
  s_mov_b32 s39, 0x00020000
  s_mov_b32 s44, s32
  s_and_b32 s45, s33, 0xffff
  s_mov_b32 s46, 4194304
  s_mov_b32 s47, 0x00020000
  s_add_u32 s48, s22, 33554432
  s_addc_u32 s49, s23, 0
  s_and_b32 s49, s49, 0xffff
  s_mov_b32 s50, 4194304
  s_mov_b32 s51, 0x00020000
  s_cmp_eq_u32 s96, 0
  s_cselect_b64 s[44:45], s[48:49], s[44:45]
  s_lshl_b32 s46, s7, 11
  s_add_u32 s56, s34, 24379392
  s_addc_u32 s57, s35, 0
  s_and_b32 s57, s57, 0xffff
  s_mov_b32 s58, 262144
  s_mov_b32 s59, 0x00020000
  v_add_u32_e64 v26, s75, v6
  v_add_u32_e64 v27, s75, v7
  v_add_u32_e64 v28, s75, v8
  v_add_u32_e64 v29, s75, v9
  s_add_u32 s75, s75, 32768
  s_cmp_eq_u32 s75, 163840
  s_cselect_b32 s75, 0, s75
  s_mov_b32 s79, 14
  s_add_u32 s73, s101, s64
  s_sub_u32 s74, s73, 114688
  s_cselect_b32 s73, s73, s74
  s_add_u32 s74, s73, s100
  s_and_b32 s74, s74, 0x7fff
  s_cmp_lt_u32 s73, 0x8000
  s_cselect_b32 s73, s74, s73
  s_mov_b32 s48, s73
  s_add_u32 s73, s101, s65
  s_sub_u32 s74, s73, 114688
  s_cselect_b32 s73, s73, s74
  s_add_u32 s74, s73, s100
  s_and_b32 s74, s74, 0x7fff
  s_cmp_lt_u32 s73, 0x8000
  s_cselect_b32 s73, s74, s73
  s_mov_b32 s49, s73
  s_add_u32 s73, s101, s66
  s_sub_u32 s74, s73, 114688
  s_cselect_b32 s73, s73, s74
  s_add_u32 s74, s73, s100
  s_and_b32 s74, s74, 0x7fff
  s_cmp_lt_u32 s73, 0x8000
  s_cselect_b32 s73, s74, s73
  s_mov_b32 s50, s73
  s_waitcnt lgkmcnt(0)
  s_barrier
  buffer_load_dwordx4 v[32:35], v4, s[36:39], s48 offen offset:0
  buffer_load_dwordx4 v[40:43], v4, s[36:39], s48 offen offset:1024
  buffer_load_dwordx4 v[36:39], v5, s[36:39], s48 offen offset:0
  buffer_load_dwordx4 v[44:47], v5, s[36:39], s48 offen offset:1024
  buffer_load_dwordx4 v[48:51], v4, s[36:39], s49 offen offset:0
  buffer_load_dwordx4 v[56:59], v4, s[36:39], s49 offen offset:1024
  buffer_load_dwordx4 v[52:55], v5, s[36:39], s49 offen offset:0
  buffer_load_dwordx4 v[60:63], v5, s[36:39], s49 offen offset:1024
  buffer_load_dwordx4 v[64:67], v4, s[36:39], s50 offen offset:0
  buffer_load_dwordx4 v[72:75], v4, s[36:39], s50 offen offset:1024
  buffer_load_dwordx4 v[68:71], v5, s[36:39], s50 offen offset:0
  buffer_load_dwordx4 v[76:79], v5, s[36:39], s50 offen offset:1024
  ds_read_b64_tr_b16 v[160:161], v26 offset:0
  ds_read_b64_tr_b16 v[162:163], v26 offset:512
  ds_read_b64_tr_b16 v[164:165], v27 offset:0
  ds_read_b64_tr_b16 v[166:167], v27 offset:512
  ds_read_b64_tr_b16 v[168:169], v28 offset:0
  ds_read_b64_tr_b16 v[170:171], v28 offset:512
  ds_read_b64_tr_b16 v[172:173], v29 offset:0
  ds_read_b64_tr_b16 v[174:175], v29 offset:512
  ds_read_b64_tr_b16 v[176:177], v26 offset:4096
  ds_read_b64_tr_b16 v[178:179], v26 offset:4608
  ds_read_b64_tr_b16 v[180:181], v27 offset:4096
  ds_read_b64_tr_b16 v[182:183], v27 offset:4608
  ds_read_b64_tr_b16 v[184:185], v28 offset:4096
  ds_read_b64_tr_b16 v[186:187], v28 offset:4608
  ds_read_b64_tr_b16 v[188:189], v29 offset:4096
  ds_read_b64_tr_b16 v[190:191], v29 offset:4608
  v_permlane16_swap_b32 v240, v242
  v_permlane16_swap_b32 v241, v243
  v_permlane16_swap_b32 v244, v246
  v_permlane16_swap_b32 v245, v247
  v_permlane16_swap_b32 v248, v250
  v_permlane16_swap_b32 v249, v251
  v_permlane16_swap_b32 v252, v254
  v_permlane16_swap_b32 v253, v255
  s_waitcnt vmcnt(12)
  v_lshlrev_b32 v216, 16, v192
  v_and_b32 v217, s11, v192
  v_lshlrev_b32 v218, 16, v193
  v_and_b32 v219, s11, v193
  v_lshlrev_b32 v96, 16, v240
  v_and_b32 v97, s11, v240
  v_pk_add_f32 v[96:97], v[96:97], v[216:217]
  v_lshlrev_b32 v98, 16, v241
  v_and_b32 v99, s11, v241
  v_pk_add_f32 v[98:99], v[98:99], v[218:219]
  v_lshlrev_b32 v100, 16, v248
  v_and_b32 v101, s11, v248
  v_pk_add_f32 v[100:101], v[100:101], v[216:217]
  v_lshlrev_b32 v102, 16, v249
  v_and_b32 v103, s11, v249
  v_pk_add_f32 v[102:103], v[102:103], v[218:219]
  v_lshlrev_b32 v216, 16, v194
  v_and_b32 v217, s11, v194
  v_lshlrev_b32 v218, 16, v195
  v_and_b32 v219, s11, v195
  v_lshlrev_b32 v104, 16, v242
  v_and_b32 v105, s11, v242
  v_pk_add_f32 v[104:105], v[104:105], v[216:217]
  v_lshlrev_b32 v106, 16, v243
  v_and_b32 v107, s11, v243
  v_pk_add_f32 v[106:107], v[106:107], v[218:219]
  v_lshlrev_b32 v108, 16, v250
  v_and_b32 v109, s11, v250
  v_pk_add_f32 v[108:109], v[108:109], v[216:217]
  v_lshlrev_b32 v110, 16, v251
  v_and_b32 v111, s11, v251
  v_pk_add_f32 v[110:111], v[110:111], v[218:219]
  v_lshlrev_b32 v216, 16, v196
  v_and_b32 v217, s11, v196
  v_lshlrev_b32 v218, 16, v197
  v_and_b32 v219, s11, v197
  v_lshlrev_b32 v112, 16, v244
  v_and_b32 v113, s11, v244
  v_pk_add_f32 v[112:113], v[112:113], v[216:217]
  v_lshlrev_b32 v114, 16, v245
  v_and_b32 v115, s11, v245
  v_pk_add_f32 v[114:115], v[114:115], v[218:219]
  v_lshlrev_b32 v116, 16, v252
  v_and_b32 v117, s11, v252
  v_pk_add_f32 v[116:117], v[116:117], v[216:217]
  v_lshlrev_b32 v118, 16, v253
  v_and_b32 v119, s11, v253
  v_pk_add_f32 v[118:119], v[118:119], v[218:219]
  v_lshlrev_b32 v216, 16, v198
  v_and_b32 v217, s11, v198
  v_lshlrev_b32 v218, 16, v199
  v_and_b32 v219, s11, v199
  v_lshlrev_b32 v120, 16, v246
  v_and_b32 v121, s11, v246
  v_pk_add_f32 v[120:121], v[120:121], v[216:217]
  v_lshlrev_b32 v122, 16, v247
  v_and_b32 v123, s11, v247
  v_pk_add_f32 v[122:123], v[122:123], v[218:219]
  v_lshlrev_b32 v124, 16, v254
  v_and_b32 v125, s11, v254
  v_pk_add_f32 v[124:125], v[124:125], v[216:217]
  v_lshlrev_b32 v126, 16, v255
  v_and_b32 v127, s11, v255
  v_pk_add_f32 v[126:127], v[126:127], v[218:219]
.p2align 3
L_w2_loop:
  s_waitcnt vmcnt(8) lgkmcnt(0)
  v_mfma_f32_16x16x32_bf16 v[96:99], v[160:163], v[32:35], v[96:99]
  ds_read_b64_tr_b16 v[192:193], v26 offset:8192
  ds_read_b64_tr_b16 v[194:195], v26 offset:8704
  v_mfma_f32_16x16x32_bf16 v[100:103], v[160:163], v[36:39], v[100:103]
  ds_read_b64_tr_b16 v[196:197], v27 offset:8192
  ds_read_b64_tr_b16 v[198:199], v27 offset:8704
  v_mfma_f32_16x16x32_bf16 v[104:107], v[164:167], v[32:35], v[104:107]
  ds_read_b64_tr_b16 v[200:201], v28 offset:8192
  ds_read_b64_tr_b16 v[202:203], v28 offset:8704
  v_mfma_f32_16x16x32_bf16 v[108:111], v[164:167], v[36:39], v[108:111]
  ds_read_b64_tr_b16 v[204:205], v29 offset:8192
  ds_read_b64_tr_b16 v[206:207], v29 offset:8704
  v_mfma_f32_16x16x32_bf16 v[112:115], v[168:171], v[32:35], v[112:115]
  ds_read_b64_tr_b16 v[208:209], v26 offset:12288
  ds_read_b64_tr_b16 v[210:211], v26 offset:12800
  v_mfma_f32_16x16x32_bf16 v[116:119], v[168:171], v[36:39], v[116:119]
  ds_read_b64_tr_b16 v[212:213], v27 offset:12288
  ds_read_b64_tr_b16 v[214:215], v27 offset:12800
  v_mfma_f32_16x16x32_bf16 v[120:123], v[172:175], v[32:35], v[120:123]
  ds_read_b64_tr_b16 v[216:217], v28 offset:12288
  ds_read_b64_tr_b16 v[218:219], v28 offset:12800
  v_mfma_f32_16x16x32_bf16 v[124:127], v[172:175], v[36:39], v[124:127]
  ds_read_b64_tr_b16 v[220:221], v29 offset:12288
  ds_read_b64_tr_b16 v[222:223], v29 offset:12800
  v_mfma_f32_16x16x32_bf16 v[96:99], v[176:179], v[40:43], v[96:99]
  s_add_u32 s73, s101, s67
  s_sub_u32 s74, s73, 114688
  s_cselect_b32 s73, s73, s74
  v_mfma_f32_16x16x32_bf16 v[100:103], v[176:179], v[44:47], v[100:103]
  s_add_u32 s74, s73, s100
  s_and_b32 s74, s74, 0x7fff
  s_cmp_lt_u32 s73, 0x8000
  s_cselect_b32 s73, s74, s73
  v_mfma_f32_16x16x32_bf16 v[104:107], v[180:183], v[40:43], v[104:107]
  buffer_load_dwordx4 v[80:83], v4, s[36:39], s73 offen offset:0
  v_mfma_f32_16x16x32_bf16 v[108:111], v[180:183], v[44:47], v[108:111]
  buffer_load_dwordx4 v[88:91], v4, s[36:39], s73 offen offset:1024
  v_mfma_f32_16x16x32_bf16 v[112:115], v[184:187], v[40:43], v[112:115]
  buffer_load_dwordx4 v[84:87], v5, s[36:39], s73 offen offset:0
  v_mfma_f32_16x16x32_bf16 v[116:119], v[184:187], v[44:47], v[116:119]
  buffer_load_dwordx4 v[92:95], v5, s[36:39], s73 offen offset:1024
  v_mfma_f32_16x16x32_bf16 v[120:123], v[188:191], v[40:43], v[120:123]
  s_add_u32 s101, s101, 8192
  v_mfma_f32_16x16x32_bf16 v[124:127], v[188:191], v[44:47], v[124:127]
  s_sub_u32 s79, s79, 1
  s_cmp_eq_u32 s79, 0
  s_cselect_b32 s38, 0, s38
  s_waitcnt vmcnt(8) lgkmcnt(0)
  v_mfma_f32_16x16x32_bf16 v[96:99], v[192:195], v[48:51], v[96:99]
  ds_read_b64_tr_b16 v[160:161], v26 offset:16384
  ds_read_b64_tr_b16 v[162:163], v26 offset:16896
  v_mfma_f32_16x16x32_bf16 v[100:103], v[192:195], v[52:55], v[100:103]
  ds_read_b64_tr_b16 v[164:165], v27 offset:16384
  ds_read_b64_tr_b16 v[166:167], v27 offset:16896
  v_mfma_f32_16x16x32_bf16 v[104:107], v[196:199], v[48:51], v[104:107]
  ds_read_b64_tr_b16 v[168:169], v28 offset:16384
  ds_read_b64_tr_b16 v[170:171], v28 offset:16896
  v_mfma_f32_16x16x32_bf16 v[108:111], v[196:199], v[52:55], v[108:111]
  ds_read_b64_tr_b16 v[172:173], v29 offset:16384
  ds_read_b64_tr_b16 v[174:175], v29 offset:16896
  v_mfma_f32_16x16x32_bf16 v[112:115], v[200:203], v[48:51], v[112:115]
  ds_read_b64_tr_b16 v[176:177], v26 offset:20480
  ds_read_b64_tr_b16 v[178:179], v26 offset:20992
  v_mfma_f32_16x16x32_bf16 v[116:119], v[200:203], v[52:55], v[116:119]
  ds_read_b64_tr_b16 v[180:181], v27 offset:20480
  ds_read_b64_tr_b16 v[182:183], v27 offset:20992
  v_mfma_f32_16x16x32_bf16 v[120:123], v[204:207], v[48:51], v[120:123]
  ds_read_b64_tr_b16 v[184:185], v28 offset:20480
  ds_read_b64_tr_b16 v[186:187], v28 offset:20992
  v_mfma_f32_16x16x32_bf16 v[124:127], v[204:207], v[52:55], v[124:127]
  ds_read_b64_tr_b16 v[188:189], v29 offset:20480
  ds_read_b64_tr_b16 v[190:191], v29 offset:20992
  v_mfma_f32_16x16x32_bf16 v[96:99], v[208:211], v[56:59], v[96:99]
  s_add_u32 s73, s101, s64
  s_sub_u32 s74, s73, 114688
  s_cselect_b32 s73, s73, s74
  v_mfma_f32_16x16x32_bf16 v[100:103], v[208:211], v[60:63], v[100:103]
  s_add_u32 s74, s73, s100
  s_and_b32 s74, s74, 0x7fff
  s_cmp_lt_u32 s73, 0x8000
  s_cselect_b32 s73, s74, s73
  v_mfma_f32_16x16x32_bf16 v[104:107], v[212:215], v[56:59], v[104:107]
  buffer_load_dwordx4 v[32:35], v4, s[36:39], s73 offen offset:0
  v_mfma_f32_16x16x32_bf16 v[108:111], v[212:215], v[60:63], v[108:111]
  buffer_load_dwordx4 v[40:43], v4, s[36:39], s73 offen offset:1024
  v_mfma_f32_16x16x32_bf16 v[112:115], v[216:219], v[56:59], v[112:115]
  buffer_load_dwordx4 v[36:39], v5, s[36:39], s73 offen offset:0
  v_mfma_f32_16x16x32_bf16 v[116:119], v[216:219], v[60:63], v[116:119]
  buffer_load_dwordx4 v[44:47], v5, s[36:39], s73 offen offset:1024
  v_mfma_f32_16x16x32_bf16 v[120:123], v[220:223], v[56:59], v[120:123]
  v_mfma_f32_16x16x32_bf16 v[124:127], v[220:223], v[60:63], v[124:127]
  s_waitcnt vmcnt(8) lgkmcnt(0)
  v_mfma_f32_16x16x32_bf16 v[96:99], v[160:163], v[64:67], v[96:99]
  ds_read_b64_tr_b16 v[192:193], v26 offset:24576
  ds_read_b64_tr_b16 v[194:195], v26 offset:25088
  v_mfma_f32_16x16x32_bf16 v[100:103], v[160:163], v[68:71], v[100:103]
  ds_read_b64_tr_b16 v[196:197], v27 offset:24576
  ds_read_b64_tr_b16 v[198:199], v27 offset:25088
  v_mfma_f32_16x16x32_bf16 v[104:107], v[164:167], v[64:67], v[104:107]
  ds_read_b64_tr_b16 v[200:201], v28 offset:24576
  ds_read_b64_tr_b16 v[202:203], v28 offset:25088
  v_mfma_f32_16x16x32_bf16 v[108:111], v[164:167], v[68:71], v[108:111]
  ds_read_b64_tr_b16 v[204:205], v29 offset:24576
  ds_read_b64_tr_b16 v[206:207], v29 offset:25088
  v_mfma_f32_16x16x32_bf16 v[112:115], v[168:171], v[64:67], v[112:115]
  ds_read_b64_tr_b16 v[208:209], v26 offset:28672
  ds_read_b64_tr_b16 v[210:211], v26 offset:29184
  v_mfma_f32_16x16x32_bf16 v[116:119], v[168:171], v[68:71], v[116:119]
  ds_read_b64_tr_b16 v[212:213], v27 offset:28672
  ds_read_b64_tr_b16 v[214:215], v27 offset:29184
  v_mfma_f32_16x16x32_bf16 v[120:123], v[172:175], v[64:67], v[120:123]
  ds_read_b64_tr_b16 v[216:217], v28 offset:28672
  ds_read_b64_tr_b16 v[218:219], v28 offset:29184
  v_mfma_f32_16x16x32_bf16 v[124:127], v[172:175], v[68:71], v[124:127]
  ds_read_b64_tr_b16 v[220:221], v29 offset:28672
  ds_read_b64_tr_b16 v[222:223], v29 offset:29184
  v_mfma_f32_16x16x32_bf16 v[96:99], v[176:179], v[72:75], v[96:99]
  s_add_u32 s73, s101, s65
  s_sub_u32 s74, s73, 114688
  s_cselect_b32 s73, s73, s74
  v_mfma_f32_16x16x32_bf16 v[100:103], v[176:179], v[76:79], v[100:103]
  s_add_u32 s74, s73, s100
  s_and_b32 s74, s74, 0x7fff
  s_cmp_lt_u32 s73, 0x8000
  s_cselect_b32 s73, s74, s73
  v_mfma_f32_16x16x32_bf16 v[104:107], v[180:183], v[72:75], v[104:107]
  buffer_load_dwordx4 v[48:51], v4, s[36:39], s73 offen offset:0
  v_mfma_f32_16x16x32_bf16 v[108:111], v[180:183], v[76:79], v[108:111]
  buffer_load_dwordx4 v[56:59], v4, s[36:39], s73 offen offset:1024
  v_mfma_f32_16x16x32_bf16 v[112:115], v[184:187], v[72:75], v[112:115]
  buffer_load_dwordx4 v[52:55], v5, s[36:39], s73 offen offset:0
  v_mfma_f32_16x16x32_bf16 v[116:119], v[184:187], v[76:79], v[116:119]
  buffer_load_dwordx4 v[60:63], v5, s[36:39], s73 offen offset:1024
  v_mfma_f32_16x16x32_bf16 v[120:123], v[188:191], v[72:75], v[120:123]
  v_mfma_f32_16x16x32_bf16 v[124:127], v[188:191], v[76:79], v[124:127]
  s_waitcnt vmcnt(8) lgkmcnt(0)
  s_barrier
  v_mfma_f32_16x16x32_bf16 v[96:99], v[192:195], v[80:83], v[96:99]
  v_add_u32_e64 v26, s75, v6
  v_add_u32_e64 v27, s75, v7
  v_add_u32_e64 v28, s75, v8
  v_mfma_f32_16x16x32_bf16 v[100:103], v[192:195], v[84:87], v[100:103]
  v_add_u32_e64 v29, s75, v9
  s_add_u32 s75, s75, 32768
  s_cmp_eq_u32 s75, 163840
  v_mfma_f32_16x16x32_bf16 v[104:107], v[196:199], v[80:83], v[104:107]
  s_cselect_b32 s75, 0, s75
  ds_read_b64_tr_b16 v[160:161], v26 offset:0
  ds_read_b64_tr_b16 v[162:163], v26 offset:512
  v_mfma_f32_16x16x32_bf16 v[108:111], v[196:199], v[84:87], v[108:111]
  ds_read_b64_tr_b16 v[164:165], v27 offset:0
  ds_read_b64_tr_b16 v[166:167], v27 offset:512
  ds_read_b64_tr_b16 v[168:169], v28 offset:0
  v_mfma_f32_16x16x32_bf16 v[112:115], v[200:203], v[80:83], v[112:115]
  ds_read_b64_tr_b16 v[170:171], v28 offset:512
  ds_read_b64_tr_b16 v[172:173], v29 offset:0
  ds_read_b64_tr_b16 v[174:175], v29 offset:512
  v_mfma_f32_16x16x32_bf16 v[116:119], v[200:203], v[84:87], v[116:119]
  ds_read_b64_tr_b16 v[176:177], v26 offset:4096
  ds_read_b64_tr_b16 v[178:179], v26 offset:4608
  ds_read_b64_tr_b16 v[180:181], v27 offset:4096
  v_mfma_f32_16x16x32_bf16 v[120:123], v[204:207], v[80:83], v[120:123]
  ds_read_b64_tr_b16 v[182:183], v27 offset:4608
  ds_read_b64_tr_b16 v[184:185], v28 offset:4096
  ds_read_b64_tr_b16 v[186:187], v28 offset:4608
  v_mfma_f32_16x16x32_bf16 v[124:127], v[204:207], v[84:87], v[124:127]
  ds_read_b64_tr_b16 v[188:189], v29 offset:4096
  ds_read_b64_tr_b16 v[190:191], v29 offset:4608
  v_mfma_f32_16x16x32_bf16 v[96:99], v[208:211], v[88:91], v[96:99]
  s_add_u32 s73, s101, s66
  s_sub_u32 s74, s73, 114688
  s_cselect_b32 s73, s73, s74
  v_mfma_f32_16x16x32_bf16 v[100:103], v[208:211], v[92:95], v[100:103]
  s_add_u32 s74, s73, s100
  s_and_b32 s74, s74, 0x7fff
  s_cmp_lt_u32 s73, 0x8000
  s_cselect_b32 s73, s74, s73
  v_mfma_f32_16x16x32_bf16 v[104:107], v[212:215], v[88:91], v[104:107]
  buffer_load_dwordx4 v[64:67], v4, s[36:39], s73 offen offset:0
  v_mfma_f32_16x16x32_bf16 v[108:111], v[212:215], v[92:95], v[108:111]
  buffer_load_dwordx4 v[72:75], v4, s[36:39], s73 offen offset:1024
  v_mfma_f32_16x16x32_bf16 v[112:115], v[216:219], v[88:91], v[112:115]
  buffer_load_dwordx4 v[68:71], v5, s[36:39], s73 offen offset:0
  v_mfma_f32_16x16x32_bf16 v[116:119], v[216:219], v[92:95], v[116:119]
  buffer_load_dwordx4 v[76:79], v5, s[36:39], s73 offen offset:1024
  v_mfma_f32_16x16x32_bf16 v[120:123], v[220:223], v[88:91], v[120:123]
  s_cmp_lg_u32 s79, 0
  v_mfma_f32_16x16x32_bf16 v[124:127], v[220:223], v[92:95], v[124:127]
  s_cbranch_scc1 L_w2_loop
  v_mov_b32 v20, 0
  v_mov_b32 v21, 0
  v_mov_b32 v22, 0
  v_mov_b32 v23, 0
  s_lshl_b32 s3, s7, 4
  s_mov_b32 s10, 0x3f803f80
  s_nop 4
  v_cvt_pk_bf16_f32 v240, v96, v97
  v_cvt_pk_bf16_f32 v241, v98, v99
  v_cvt_pk_bf16_f32 v242, v104, v105
  v_cvt_pk_bf16_f32 v243, v106, v107
  s_nop 1
  v_permlane16_swap_b32 v240, v242
  v_permlane16_swap_b32 v241, v243
  buffer_store_dwordx4 v[240:243], v12, s[44:47], 0 offen offset:0 sc1
  v_cvt_pk_bf16_f32 v244, v112, v113
  v_cvt_pk_bf16_f32 v245, v114, v115
  v_cvt_pk_bf16_f32 v246, v120, v121
  v_cvt_pk_bf16_f32 v247, v122, v123
  s_nop 1
  v_permlane16_swap_b32 v244, v246
  v_permlane16_swap_b32 v245, v247
  buffer_store_dwordx4 v[244:247], v12, s[44:47], 0 offen offset:64 sc1
  v_cvt_pk_bf16_f32 v248, v100, v101
  v_cvt_pk_bf16_f32 v249, v102, v103
  v_cvt_pk_bf16_f32 v250, v108, v109
  v_cvt_pk_bf16_f32 v251, v110, v111
  s_nop 1
  v_permlane16_swap_b32 v248, v250
  v_permlane16_swap_b32 v249, v251
  buffer_store_dwordx4 v[248:251], v12, s[44:47], s3 offen offset:0 sc1
  v_cvt_pk_bf16_f32 v252, v116, v117
  v_cvt_pk_bf16_f32 v253, v118, v119
  v_cvt_pk_bf16_f32 v254, v124, v125
  v_cvt_pk_bf16_f32 v255, v126, v127
  s_nop 1
  v_permlane16_swap_b32 v252, v254
  v_permlane16_swap_b32 v253, v255
  buffer_store_dwordx4 v[252:255], v12, s[44:47], s3 offen offset:64 sc1
  v_dot2_f32_bf16 v20, v240, s10, v20
  v_dot2_f32_bf16 v22, v240, v240, v22
  v_dot2_f32_bf16 v20, v241, s10, v20
  v_dot2_f32_bf16 v22, v241, v241, v22
  v_dot2_f32_bf16 v20, v242, s10, v20
  v_dot2_f32_bf16 v22, v242, v242, v22
  v_dot2_f32_bf16 v20, v243, s10, v20
  v_dot2_f32_bf16 v22, v243, v243, v22
  v_dot2_f32_bf16 v20, v244, s10, v20
  v_dot2_f32_bf16 v22, v244, v244, v22
  v_dot2_f32_bf16 v20, v245, s10, v20
  v_dot2_f32_bf16 v22, v245, v245, v22
  v_dot2_f32_bf16 v20, v246, s10, v20
  v_dot2_f32_bf16 v22, v246, v246, v22
  v_dot2_f32_bf16 v20, v247, s10, v20
  v_dot2_f32_bf16 v22, v247, v247, v22
  v_dot2_f32_bf16 v21, v248, s10, v21
  v_dot2_f32_bf16 v23, v248, v248, v23
  v_dot2_f32_bf16 v21, v249, s10, v21
  v_dot2_f32_bf16 v23, v249, v249, v23
  v_dot2_f32_bf16 v21, v250, s10, v21
  v_dot2_f32_bf16 v23, v250, v250, v23
  v_dot2_f32_bf16 v21, v251, s10, v21
  v_dot2_f32_bf16 v23, v251, v251, v23
  v_dot2_f32_bf16 v21, v252, s10, v21
  v_dot2_f32_bf16 v23, v252, v252, v23
  v_dot2_f32_bf16 v21, v253, s10, v21
  v_dot2_f32_bf16 v23, v253, v253, v23
  v_dot2_f32_bf16 v21, v254, s10, v21
  v_dot2_f32_bf16 v23, v254, v254, v23
  v_dot2_f32_bf16 v21, v255, s10, v21
  v_dot2_f32_bf16 v23, v255, v255, v23
  s_nop 2
  v_permlane32_swap_b32 v20, v21
  v_permlane32_swap_b32 v22, v23
  v_add_f32 v20, v20, v21
  v_add_f32 v22, v22, v23
  s_nop 1
  v_permlane16_swap_b32 v20, v22
  v_add_f32 v20, v20, v22
  buffer_store_dword v20, v18, s[56:59], 0 offen sc1
  s_cmp_eq_u32 s96, 1
  s_cbranch_scc1 L_w2_end
  s_waitcnt vmcnt(0) lgkmcnt(0)
  s_barrier
  s_mov_b32 s96, 1
  s_add_u32 s12, s22, 33554432
  s_addc_u32 s13, s23, 0
  s_add_u32 s34, s22, 67108864
  s_addc_u32 s35, s23, 0
  s_add_u32 s97, s97, 1
  s_branch L_attn_body
L_w2_c1:
```

```asm
; @launch grid=(256,1,1) block=(512,1,1) lds=163840
.amdgcn_target "amdgcn-amd-amdhsa--gfx950"
L_attn_c0:
.text
.globl interleave_layers__sliding_local_dilated__dense_activation_gelu__prompt_kernel
.p2align 8
.type interleave_layers__sliding_local_dilated__dense_activation_gelu__prompt_kernel,@function
interleave_layers__sliding_local_dilated__dense_activation_gelu__prompt_kernel:
  s_load_dwordx4 s[16:19], s[0:1], 0
  s_load_dwordx2 s[20:21], s[0:1], 16
  s_load_dwordx2 s[22:23], s[0:1], 80
  s_load_dwordx8 s[24:31], s[0:1], 32
  s_load_dwordx2 s[32:33], s[0:1], 64
  s_load_dwordx2 s[34:35], s[0:1], 80
  s_load_dwordx2 s[12:13], s[0:1], 0
  s_mov_b32 s96, 0
  s_mov_b32 s97, 0
L_attn_body:
  s_cmp_ge_u32 s2, 256
  s_cbranch_scc1 L_attn_end
  v_lshrrev_b32 v2, 6, v0
  v_and_b32 v1, 63, v0
  v_readfirstlane_b32 s70, v2
  s_and_b32 s3, s2, 7
  s_lshr_b32 s99, s2, 3
  s_and_b32 s5, s3, 1
  s_lshl_b32 s5, s5, 3
  s_and_b32 s6, s99, 7
  s_add_u32 s68, s5, s6
  s_lshr_b32 s5, s3, 1
  s_lshl_b32 s5, s5, 2
  s_lshr_b32 s6, s99, 3
  s_add_u32 s69, s5, s6
  s_cmp_lt_u32 s70, 4
  s_cbranch_scc1 L_attn_compute
L_attn_loader:
  s_add_u32 s8, s70, s69
  s_and_b32 s8, s8, 3
  s_add_u32 s9, s70, s68
  s_and_b32 s9, s9, 3
  s_lshl_b32 s76, s8, 12
  s_lshl_b32 s77, s9, 11
  s_add_u32 s77, s77, 16384
  s_lshl_b32 s11, s68, 7
  v_and_b32 v10, 7, v1
  v_lshrrev_b32 v3, 3, v1
  s_lshr_b32 s10, s76, 7
  s_lshl_b32 s3, s68, 7
  s_add_u32 s10, s10, s3
  v_add_u32 v3, s10, v3
  s_cmp_eq_u32 s96, 1
  s_cselect_b32 s5, 128, 0
  s_add_u32 s5, s5, 2048
  s_lshl_b32 s6, s5, 3
  v_mul_u32_u24 v3, s5, v3
  v_lshrrev_b32 v2, 4, v1
  v_xor_b32 v4, v2, v10
  v_lshl_add_u32 v4, v4, 4, v3
  v_add_u32 v3, s6, v3
  v_add_u32 v5, 4, v2
  v_xor_b32 v5, v5, v10
  v_lshl_add_u32 v5, v5, 4, v3
  v_add_u32 v3, s6, v3
  v_xor_b32 v6, v2, v10
  v_lshl_add_u32 v6, v6, 4, v3
  v_add_u32 v3, s6, v3
  v_add_u32 v7, 4, v2
  v_xor_b32 v7, v7, v10
  v_lshl_add_u32 v7, v7, 4, v3
  v_lshrrev_b32 v3, 3, v1
  s_lshl_b32 s10, s9, 4
  v_add_u32 v3, s10, v3
  v_mul_u32_u24 v3, 6144, v3
  v_lshrrev_b32 v2, 3, v1
  v_and_b32 v2, 2, v2
  v_xor_b32 v2, v2, v10
  s_mul_i32 s10, s69, 128
  v_add_u32 v3, s10, v3
  v_lshl_add_u32 v8, v2, 4, v3
  v_xor_b32 v2, 4, v2
  v_add_u32 v3, 49152, v3
  v_lshl_add_u32 v9, v2, 4, v3
  s_and_b32 s10, s70, 3
  s_lshl_b32 s78, s10, 9
  s_add_u32 s78, s78, 40960
  s_lshl_b32 s14, s10, 2
  s_add_u32 s14, s14, s11
  s_sub_u32 s14, s14, 16
  v_lshrrev_b32 v3, 3, v1
  v_add_u32 v3, s14, v3
  v_max_i32 v3, 0, v3
  v_mul_u32_u24 v3, s5, v3
  s_lshl_b32 s14, s10, 1
  v_lshrrev_b32 v2, 4, v1
  v_add_u32 v2, s14, v2
  v_and_b32 v2, 7, v2
  v_xor_b32 v2, v2, v10
  v_lshl_add_u32 v28, v2, 4, v3
  s_cmp_eq_u32 s10, 0
  s_cselect_b32 s14, 0xffffff00, -1
  s_mov_b32 s15, 0
  s_mov_b32 s75, 0
  s_add_u32 s100, s68, s69
  s_mov_b32 s101, -1
  s_add_u32 s101, s101, 1
  s_sub_u32 s73, s101, s100
  s_lshl_b32 s73, s73, 3
  s_lshr_b32 s73, 0xf0f02, s73
  s_and_b32 s73, s73, 255
  s_add_u32 s73, s73, s101
  s_and_b32 s73, s73, 15
  s_mul_i32 s74, s73, 393216
  s_lshl_b32 s73, s73, 7
  s_waitcnt lgkmcnt(0)
  s_mov_b32 s36, s12
  s_and_b32 s37, s13, 0xffff
  s_mov_b32 s38, 4194304
  s_mov_b32 s39, 0x00020000
  s_cmp_eq_u32 s96, 1
  s_cselect_b32 s38, 128, 0
  s_add_u32 s38, s38, 2048
  s_lshl_b32 s38, s38, 11
  s_mov_b32 s40, s18
  s_and_b32 s41, s19, 0xffff
  s_mov_b32 s42, 6291456
  s_mov_b32 s43, 0x00020000
  s_cmp_lg_u32 s96, 0
  s_cbranch_scc1 L_attn_ld1
  s_mov_b32 s48, s28
  s_and_b32 s49, s29, 0xffff
  s_mov_b32 s50, 7340032
  s_mov_b32 s51, 0x00020000
  s_cmp_eq_u32 s96, 0
  s_cselect_b32 s50, s50, 0
  s_and_b32 s3, s70, 3
  s_lshl_b32 s4, s2, 2
  s_add_u32 s3, s3, s4
  s_mul_i32 s98, s3, 3584
  s_add_u32 s98, s98, 0
  s_add_u32 s3, s75, s76
  s_add_u32 m0, s3, 0
  s_nop 0
  buffer_load_dwordx4 v4, s[36:39], s73 offen lds
  s_add_u32 m0, s3, 1024
  s_nop 0
  buffer_load_dwordx4 v5, s[36:39], s73 offen lds
  s_add_u32 m0, s3, 2048
  s_nop 0
  buffer_load_dwordx4 v6, s[36:39], s73 offen lds
  s_add_u32 m0, s3, 3072
  s_nop 0
  buffer_load_dwordx4 v7, s[36:39], s73 offen lds
  s_add_u32 m0, s78, s75
  s_mov_b64 exec, s[14:15]
  buffer_load_dwordx4 v28, s[36:39], s73 offen lds
  s_mov_b64 exec, -1
  s_add_u32 s3, s75, s77
  s_add_u32 m0, s3, 0
  s_add_u32 s4, s74, 0
  buffer_load_dwordx4 v8, s[40:43], s4 offen lds
  s_add_u32 m0, s3, 1024
  s_nop 0
  buffer_load_dwordx4 v9, s[40:43], s4 offen lds
  s_add_u32 m0, s3, 8192
  s_add_u32 s4, s74, 2048
  buffer_load_dwordx4 v8, s[40:43], s4 offen lds
  s_add_u32 m0, s3, 9216
  s_nop 0
  buffer_load_dwordx4 v9, s[40:43], s4 offen lds
  s_add_u32 m0, s3, 16384
  s_add_u32 s4, s74, 4096
  buffer_load_dwordx4 v8, s[40:43], s4 offen lds
  s_add_u32 m0, s3, 17408
  s_nop 0
  buffer_load_dwordx4 v9, s[40:43], s4 offen lds
  s_add_u32 s101, s101, 1
  s_sub_u32 s73, s101, s100
  s_lshl_b32 s73, s73, 3
  s_lshr_b32 s73, 0xf0f02, s73
  s_and_b32 s73, s73, 255
  s_add_u32 s73, s73, s101
  s_and_b32 s73, s73, 15
  s_mul_i32 s74, s73, 393216
  s_lshl_b32 s73, s73, 7
  s_add_u32 s75, s75, 43008
  s_cmp_eq_u32 s75, 129024
  s_cselect_b32 s75, 0, s75
  s_add_u32 s3, s75, s76
  s_add_u32 m0, s3, 0
  s_nop 0
  buffer_load_dwordx4 v4, s[36:39], s73 offen lds
  s_add_u32 m0, s3, 1024
  s_nop 0
  buffer_load_dwordx4 v5, s[36:39], s73 offen lds
  s_add_u32 m0, s3, 2048
  s_nop 0
  buffer_load_dwordx4 v6, s[36:39], s73 offen lds
  s_add_u32 m0, s3, 3072
  s_nop 0
  buffer_load_dwordx4 v7, s[36:39], s73 offen lds
  s_add_u32 m0, s78, s75
  s_mov_b64 exec, s[14:15]
  buffer_load_dwordx4 v28, s[36:39], s73 offen lds
  s_mov_b64 exec, -1
  s_add_u32 s3, s75, s77
  s_add_u32 m0, s3, 0
  s_add_u32 s4, s74, 0
  buffer_load_dwordx4 v8, s[40:43], s4 offen lds
  s_add_u32 m0, s3, 1024
  s_nop 0
  buffer_load_dwordx4 v9, s[40:43], s4 offen lds
  s_add_u32 m0, s3, 8192
  s_add_u32 s4, s74, 2048
  buffer_load_dwordx4 v8, s[40:43], s4 offen lds
  s_add_u32 m0, s3, 9216
  s_nop 0
  buffer_load_dwordx4 v9, s[40:43], s4 offen lds
  s_add_u32 m0, s3, 16384
  s_add_u32 s4, s74, 4096
  buffer_load_dwordx4 v8, s[40:43], s4 offen lds
  s_add_u32 m0, s3, 17408
  s_nop 0
  buffer_load_dwordx4 v9, s[40:43], s4 offen lds
  s_add_u32 s101, s101, 1
  s_sub_u32 s73, s101, s100
  s_lshl_b32 s73, s73, 3
  s_lshr_b32 s73, 0xf0f02, s73
  s_and_b32 s73, s73, 255
  s_add_u32 s73, s73, s101
  s_and_b32 s73, s73, 15
  s_mul_i32 s74, s73, 393216
  s_lshl_b32 s73, s73, 7
  s_add_u32 s75, s75, 43008
  s_cmp_eq_u32 s75, 129024
  s_cselect_b32 s75, 0, s75
  s_and_b32 s3, s70, 3
  s_lshl_b32 s4, s2, 2
  s_add_u32 s3, s3, s4
  s_sub_u32 s4, 384, s40
  s_and_b32 s4, s4, 0x380
  s_mul_i32 s5, s3, 6144
  s_add_u32 s5, s5, s4
  s_buffer_load_dword s84, s[40:43], s5 offset:0
  s_buffer_load_dword s84, s[40:43], s5 offset:64
  s_buffer_load_dword s84, s[40:43], s5 offset:1024
  s_buffer_load_dword s84, s[40:43], s5 offset:1088
  s_buffer_load_dword s84, s[40:43], s5 offset:2048
  s_buffer_load_dword s84, s[40:43], s5 offset:2112
  s_buffer_load_dword s84, s[40:43], s5 offset:3072
  s_buffer_load_dword s84, s[40:43], s5 offset:3136
  s_buffer_load_dword s84, s[40:43], s5 offset:4096
  s_buffer_load_dword s84, s[40:43], s5 offset:4160
  s_buffer_load_dword s84, s[40:43], s5 offset:5120
  s_buffer_load_dword s84, s[40:43], s5 offset:5184
  s_waitcnt vmcnt(11)
  s_barrier
  s_mov_b32 s79, 13
L_attn0_ld1:
  s_add_u32 s3, s75, s76
  s_add_u32 m0, s3, 0
  s_nop 0
  buffer_load_dwordx4 v4, s[36:39], s73 offen lds
  s_add_u32 m0, s3, 1024
  s_nop 0
  buffer_load_dwordx4 v5, s[36:39], s73 offen lds
  s_add_u32 m0, s3, 2048
  s_nop 0
  buffer_load_dwordx4 v6, s[36:39], s73 offen lds
  s_add_u32 m0, s3, 3072
  s_nop 0
  buffer_load_dwordx4 v7, s[36:39], s73 offen lds
  s_add_u32 m0, s78, s75
  s_mov_b64 exec, s[14:15]
  buffer_load_dwordx4 v28, s[36:39], s73 offen lds
  s_mov_b64 exec, -1
  s_add_u32 s3, s75, s77
  s_add_u32 m0, s3, 0
  s_add_u32 s4, s74, 0
  buffer_load_dwordx4 v8, s[40:43], s4 offen lds
  s_add_u32 m0, s3, 1024
  s_nop 0
  buffer_load_dwordx4 v9, s[40:43], s4 offen lds
  s_add_u32 m0, s3, 8192
  s_add_u32 s4, s74, 2048
  buffer_load_dwordx4 v8, s[40:43], s4 offen lds
  s_add_u32 m0, s3, 9216
  s_nop 0
  buffer_load_dwordx4 v9, s[40:43], s4 offen lds
  s_add_u32 m0, s3, 16384
  s_add_u32 s4, s74, 4096
  buffer_load_dwordx4 v8, s[40:43], s4 offen lds
  s_add_u32 m0, s3, 17408
  s_nop 0
  buffer_load_dwordx4 v9, s[40:43], s4 offen lds
  s_add_u32 s101, s101, 1
  s_sub_u32 s73, s101, s100
  s_lshl_b32 s73, s73, 3
  s_lshr_b32 s73, 0xf0f02, s73
  s_and_b32 s73, s73, 255
  s_add_u32 s73, s73, s101
  s_and_b32 s73, s73, 15
  s_mul_i32 s74, s73, 393216
  s_lshl_b32 s73, s73, 7
  s_add_u32 s75, s75, 43008
  s_cmp_eq_u32 s75, 129024
  s_cselect_b32 s75, 0, s75
  s_buffer_load_dword s84, s[48:51], s98 offset:0
  s_buffer_load_dword s84, s[48:51], s98 offset:64
  s_buffer_load_dword s84, s[48:51], s98 offset:128
  s_buffer_load_dword s84, s[48:51], s98 offset:192
  s_add_u32 s98, s98, 256
  s_waitcnt vmcnt(11)
  s_barrier
  s_sub_u32 s79, s79, 1
  s_cmp_lg_u32 s79, 0
  s_cbranch_scc1 L_attn0_ld1
  s_add_u32 s3, s75, s76
  s_add_u32 m0, s3, 0
  s_nop 0
  buffer_load_dwordx4 v4, s[36:39], s73 offen lds
  s_add_u32 m0, s3, 1024
  s_nop 0
  buffer_load_dwordx4 v5, s[36:39], s73 offen lds
  s_add_u32 m0, s3, 2048
  s_nop 0
  buffer_load_dwordx4 v6, s[36:39], s73 offen lds
  s_add_u32 m0, s3, 3072
  s_nop 0
  buffer_load_dwordx4 v7, s[36:39], s73 offen lds
  s_add_u32 m0, s78, s75
  s_mov_b64 exec, s[14:15]
  buffer_load_dwordx4 v28, s[36:39], s73 offen lds
  s_mov_b64 exec, -1
  s_add_u32 s3, s75, s77
  s_add_u32 m0, s3, 0
  s_add_u32 s4, s74, 0
  buffer_load_dwordx4 v8, s[40:43], s4 offen lds
  s_add_u32 m0, s3, 1024
  s_nop 0
  buffer_load_dwordx4 v9, s[40:43], s4 offen lds
  s_add_u32 m0, s3, 8192
  s_add_u32 s4, s74, 2048
  buffer_load_dwordx4 v8, s[40:43], s4 offen lds
  s_add_u32 m0, s3, 9216
  s_nop 0
  buffer_load_dwordx4 v9, s[40:43], s4 offen lds
  s_add_u32 m0, s3, 16384
  s_add_u32 s4, s74, 4096
  buffer_load_dwordx4 v8, s[40:43], s4 offen lds
  s_add_u32 m0, s3, 17408
  s_nop 0
  buffer_load_dwordx4 v9, s[40:43], s4 offen lds
  s_add_u32 s101, s101, 1
  s_sub_u32 s73, s101, s100
  s_lshl_b32 s73, s73, 3
  s_lshr_b32 s73, 0xf0f02, s73
  s_and_b32 s73, s73, 255
  s_add_u32 s73, s73, s101
  s_and_b32 s73, s73, 15
  s_mul_i32 s74, s73, 393216
  s_lshl_b32 s73, s73, 7
  s_add_u32 s75, s75, 43008
  s_cmp_eq_u32 s75, 129024
  s_cselect_b32 s75, 0, s75
  s_buffer_load_dword s84, s[48:51], s98 offset:0
  s_buffer_load_dword s84, s[48:51], s98 offset:64
  s_buffer_load_dword s84, s[48:51], s98 offset:128
  s_buffer_load_dword s84, s[48:51], s98 offset:192
  s_add_u32 s98, s98, 256
  s_mov_b32 s64, s24
  s_and_b32 s65, s25, 0xffff
  s_mov_b32 s66, 7340032
  s_mov_b32 s67, 0x00020000
  s_min_u32 s3, s2, 223
  s_mul_i32 s4, s3, 4682
  s_lshr_b32 s4, s4, 16
  s_mul_i32 s5, s4, 14
  s_sub_u32 s3, s3, s5
  s_lshl_b32 s3, s3, 2
  s_and_b32 s5, s70, 3
  s_add_u32 s3, s3, s5
  s_mul_i32 s5, s4, 458752
  s_lshl_b32 s8, s3, 7
  s_add_u32 s5, s5, s8
  s_lshl_b32 s9, s4, 14
  s_lshl_b32 s8, s3, 8
  s_add_u32 s94, s9, s8
  v_lshrrev_b32 v2, 3, v1
  v_mul_u32_u24 v2, 7168, v2
  v_and_b32 v3, 7, v1
  v_lshl_add_u32 v2, v3, 4, v2
  buffer_load_dwordx4 v[64:67], v2, s[64:67], s5 offen
  s_add_u32 s5, s5, 57344
  buffer_load_dwordx4 v[68:71], v2, s[64:67], s5 offen
  s_add_u32 s5, s5, 57344
  buffer_load_dwordx4 v[72:75], v2, s[64:67], s5 offen
  s_add_u32 s5, s5, 57344
  buffer_load_dwordx4 v[76:79], v2, s[64:67], s5 offen
  s_add_u32 s5, s5, 57344
  buffer_load_dwordx4 v[80:83], v2, s[64:67], s5 offen
  s_add_u32 s5, s5, 57344
  buffer_load_dwordx4 v[84:87], v2, s[64:67], s5 offen
  s_add_u32 s5, s5, 57344
  buffer_load_dwordx4 v[88:91], v2, s[64:67], s5 offen
  s_add_u32 s5, s5, 57344
  buffer_load_dwordx4 v[92:95], v2, s[64:67], s5 offen
  s_mov_b32 s60, s20
  s_and_b32 s61, s21, 0xffff
  s_mov_b32 s62, 2097152
  s_mov_b32 s63, 0x00020000
  s_and_b32 s3, s70, 3
  s_mul_i32 s3, s3, 8
  s_mul_i32 s4, s99, 32
  s_add_u32 s3, s3, s4
  v_lshrrev_b32 v2, 3, v1
  v_add_u32 v2, s3, v2
  v_mul_u32_u24 v2, 2048, v2
  v_and_b32 v3, 7, v1
  v_lshl_add_u32 v2, v3, 8, v2
  s_and_b32 s3, s2, 7
  s_lshr_b32 s3, s3, 2
  s_mul_i32 s3, s3, 128
  buffer_load_dword v96, v2, s[60:63], s3 offen
  s_waitcnt vmcnt(20)
  s_barrier
  s_waitcnt vmcnt(9)
  s_barrier
  s_barrier
  s_barrier
  s_barrier
  s_branch L_attn_ldend
L_attn_ld1:
  s_add_u32 s56, s22, 24379392
  s_addc_u32 s57, s23, 0
  s_and_b32 s57, s57, 0xffff
  s_mov_b32 s58, 262144
  s_mov_b32 s59, 0x00020000
  s_mov_b32 s88, s73
  s_add_u32 m0, s77, 0
  s_add_u32 s4, s74, 0
  buffer_load_dwordx4 v8, s[40:43], s4 offen lds
  s_add_u32 m0, s77, 1024
  s_nop 0
  buffer_load_dwordx4 v9, s[40:43], s4 offen lds
  s_add_u32 m0, s77, 8192
  s_add_u32 s4, s74, 2048
  buffer_load_dwordx4 v8, s[40:43], s4 offen lds
  s_add_u32 m0, s77, 9216
  s_nop 0
  buffer_load_dwordx4 v9, s[40:43], s4 offen lds
  s_add_u32 m0, s77, 16384
  s_add_u32 s4, s74, 4096
  buffer_load_dwordx4 v8, s[40:43], s4 offen lds
  s_add_u32 m0, s77, 17408
  s_nop 0
  buffer_load_dwordx4 v9, s[40:43], s4 offen lds
  s_add_u32 s101, s101, 1
  s_sub_u32 s73, s101, s100
  s_lshl_b32 s73, s73, 3
  s_lshr_b32 s73, 0xf0f02, s73
  s_and_b32 s73, s73, 255
  s_add_u32 s73, s73, s101
  s_and_b32 s73, s73, 15
  s_mul_i32 s74, s73, 393216
  s_lshl_b32 s73, s73, 7
  s_mov_b32 s89, s73
  s_add_u32 m0, s77, 43008
  s_add_u32 s4, s74, 0
  buffer_load_dwordx4 v8, s[40:43], s4 offen lds
  s_add_u32 m0, s77, 44032
  s_nop 0
  buffer_load_dwordx4 v9, s[40:43], s4 offen lds
  s_add_u32 m0, s77, 51200
  s_add_u32 s4, s74, 2048
  buffer_load_dwordx4 v8, s[40:43], s4 offen lds
  s_add_u32 m0, s77, 52224
  s_nop 0
  buffer_load_dwordx4 v9, s[40:43], s4 offen lds
  s_add_u32 m0, s77, 59392
  s_add_u32 s4, s74, 4096
  buffer_load_dwordx4 v8, s[40:43], s4 offen lds
  s_add_u32 m0, s77, 60416
  s_nop 0
  buffer_load_dwordx4 v9, s[40:43], s4 offen lds
  s_add_u32 s101, s101, 1
  s_sub_u32 s73, s101, s100
  s_lshl_b32 s73, s73, 3
  s_lshr_b32 s73, 0xf0f02, s73
  s_and_b32 s73, s73, 255
  s_add_u32 s73, s73, s101
  s_and_b32 s73, s73, 15
  s_mul_i32 s74, s73, 393216
  s_lshl_b32 s73, s73, 7
  s_mov_b32 s75, 86016
  s_add_u32 s44, s22, 24903680
  s_addc_u32 s45, s23, 0
  s_and_b32 s45, s45, 0xffff
  s_mov_b32 s46, 32768
  s_mov_b32 s47, 0x00020000
  s_lshl_b32 s3, s97, 12
  s_lshl_b32 s4, s68, 8
  s_add_u32 s3, s3, s4
  s_sub_u32 s3, s3, 4096
  v_and_b32 v2, 15, v1
  v_lshlrev_b32 v2, 2, v2
  s_min_u32 s4, s4, 256
  s_sub_u32 s3, s3, s4
  v_lshlrev_b32 v3, 4, v1
  v_and_b32 v3, s4, v3
  v_add_u32 v2, v2, v3
  v_mov_b32 v3, 1
  s_mov_b32 s79, 0x100000
  s_cmp_lg_u32 s70, 4
  s_barrier
  s_cbranch_scc1 L_attn_dep
  s_mov_b64 exec, 1
  buffer_store_dword v3, off, s[44:47], s87 sc1
  s_mov_b64 exec, -1
L_attn_poll:
  buffer_load_dword v3, v2, s[44:47], s3 offen sc1
  s_sub_u32 s79, s79, 1
  s_cbranch_scc1 L_attn_dep
  s_waitcnt vmcnt(0)
  v_cmp_ne_u32 vcc, 1, v3
  s_cbranch_vccnz L_attn_poll
L_attn_dep:
  s_barrier
  s_add_u32 m0, s76, 0
  s_nop 0
  buffer_load_dwordx4 v4, s[36:39], s88 offen lds
  s_add_u32 m0, s76, 1024
  s_nop 0
  buffer_load_dwordx4 v5, s[36:39], s88 offen lds
  s_add_u32 m0, s76, 2048
  s_nop 0
  buffer_load_dwordx4 v6, s[36:39], s88 offen lds
  s_add_u32 m0, s76, 3072
  s_nop 0
  buffer_load_dwordx4 v7, s[36:39], s88 offen lds
  s_add_u32 m0, s78, 0
  s_mov_b64 exec, s[14:15]
  buffer_load_dwordx4 v28, s[36:39], s88 offen lds
  s_mov_b64 exec, -1
  s_add_u32 m0, s76, 43008
  s_nop 0
  buffer_load_dwordx4 v4, s[36:39], s89 offen lds
  s_add_u32 m0, s76, 44032
  s_nop 0
  buffer_load_dwordx4 v5, s[36:39], s89 offen lds
  s_add_u32 m0, s76, 45056
  s_nop 0
  buffer_load_dwordx4 v6, s[36:39], s89 offen lds
  s_add_u32 m0, s76, 46080
  s_nop 0
  buffer_load_dwordx4 v7, s[36:39], s89 offen lds
  s_add_u32 m0, s78, 43008
  s_mov_b64 exec, s[14:15]
  buffer_load_dwordx4 v28, s[36:39], s89 offen lds
  s_mov_b64 exec, -1
  s_waitcnt vmcnt(5)
  s_barrier
  s_mov_b32 s79, 13
L_attn1_ld1:
  s_add_u32 s3, s75, s76
  s_add_u32 m0, s3, 0
  s_nop 0
  buffer_load_dwordx4 v4, s[36:39], s73 offen lds
  s_add_u32 m0, s3, 1024
  s_nop 0
  buffer_load_dwordx4 v5, s[36:39], s73 offen lds
  s_add_u32 m0, s3, 2048
  s_nop 0
  buffer_load_dwordx4 v6, s[36:39], s73 offen lds
  s_add_u32 m0, s3, 3072
  s_nop 0
  buffer_load_dwordx4 v7, s[36:39], s73 offen lds
  s_add_u32 m0, s78, s75
  s_mov_b64 exec, s[14:15]
  buffer_load_dwordx4 v28, s[36:39], s73 offen lds
  s_mov_b64 exec, -1
  s_add_u32 s3, s75, s77
  s_add_u32 m0, s3, 0
  s_add_u32 s4, s74, 0
  buffer_load_dwordx4 v8, s[40:43], s4 offen lds
  s_add_u32 m0, s3, 1024
  s_nop 0
  buffer_load_dwordx4 v9, s[40:43], s4 offen lds
  s_add_u32 m0, s3, 8192
  s_add_u32 s4, s74, 2048
  buffer_load_dwordx4 v8, s[40:43], s4 offen lds
  s_add_u32 m0, s3, 9216
  s_nop 0
  buffer_load_dwordx4 v9, s[40:43], s4 offen lds
  s_add_u32 m0, s3, 16384
  s_add_u32 s4, s74, 4096
  buffer_load_dwordx4 v8, s[40:43], s4 offen lds
  s_add_u32 m0, s3, 17408
  s_nop 0
  buffer_load_dwordx4 v9, s[40:43], s4 offen lds
  s_add_u32 s101, s101, 1
  s_sub_u32 s73, s101, s100
  s_lshl_b32 s73, s73, 3
  s_lshr_b32 s73, 0xf0f02, s73
  s_and_b32 s73, s73, 255
  s_add_u32 s73, s73, s101
  s_and_b32 s73, s73, 15
  s_mul_i32 s74, s73, 393216
  s_lshl_b32 s73, s73, 7
  s_add_u32 s75, s75, 43008
  s_cmp_eq_u32 s75, 129024
  s_cselect_b32 s75, 0, s75
  s_waitcnt vmcnt(11)
  s_barrier
  s_sub_u32 s79, s79, 1
  s_cmp_lg_u32 s79, 0
  s_cbranch_scc1 L_attn1_ld1
  s_add_u32 s3, s75, s76
  s_add_u32 m0, s3, 0
  s_nop 0
  buffer_load_dwordx4 v4, s[36:39], s73 offen lds
  s_add_u32 m0, s3, 1024
  s_nop 0
  buffer_load_dwordx4 v5, s[36:39], s73 offen lds
  s_add_u32 m0, s3, 2048
  s_nop 0
  buffer_load_dwordx4 v6, s[36:39], s73 offen lds
  s_add_u32 m0, s3, 3072
  s_nop 0
  buffer_load_dwordx4 v7, s[36:39], s73 offen lds
  s_add_u32 m0, s78, s75
  s_mov_b64 exec, s[14:15]
  buffer_load_dwordx4 v28, s[36:39], s73 offen lds
  s_mov_b64 exec, -1
  s_add_u32 s3, s75, s77
  s_add_u32 m0, s3, 0
  s_add_u32 s4, s74, 0
  buffer_load_dwordx4 v8, s[40:43], s4 offen lds
  s_add_u32 m0, s3, 1024
  s_nop 0
  buffer_load_dwordx4 v9, s[40:43], s4 offen lds
  s_add_u32 m0, s3, 8192
  s_add_u32 s4, s74, 2048
  buffer_load_dwordx4 v8, s[40:43], s4 offen lds
  s_add_u32 m0, s3, 9216
  s_nop 0
  buffer_load_dwordx4 v9, s[40:43], s4 offen lds
  s_add_u32 m0, s3, 16384
  s_add_u32 s4, s74, 4096
  buffer_load_dwordx4 v8, s[40:43], s4 offen lds
  s_add_u32 m0, s3, 17408
  s_nop 0
  buffer_load_dwordx4 v9, s[40:43], s4 offen lds
  s_add_u32 s101, s101, 1
  s_sub_u32 s73, s101, s100
  s_lshl_b32 s73, s73, 3
  s_lshr_b32 s73, 0xf0f02, s73
  s_and_b32 s73, s73, 255
  s_add_u32 s73, s73, s101
  s_and_b32 s73, s73, 15
  s_mul_i32 s74, s73, 393216
  s_lshl_b32 s73, s73, 7
  s_add_u32 s75, s75, 43008
  s_cmp_eq_u32 s75, 129024
  s_cselect_b32 s75, 0, s75
  s_and_b32 s3, s70, 3
  s_lshl_b32 s4, s68, 7
  s_lshl_b32 s5, s3, 6
  s_add_u32 s5, s5, s4
  v_add_u32 v2, s5, v1
  s_sub_u32 s4, s4, 16
  v_and_b32 v3, 15, v1
  v_add_u32 v3, s4, v3
  v_max_i32 v3, 0, v3
  s_cmp_ge_u32 s3, 2
  s_cselect_b64 vcc, -1, 0
  v_cndmask_b32 v2, v2, v3, vcc
  v_lshlrev_b32 v2, 3, v2
  s_mov_b32 s3, 0
  buffer_load_dwordx2 v[32:33], v2, s[56:59], s3 offen
  s_add_u32 s3, s3, 16384
  buffer_load_dwordx2 v[34:35], v2, s[56:59], s3 offen
  s_add_u32 s3, s3, 16384
  buffer_load_dwordx2 v[36:37], v2, s[56:59], s3 offen
  s_add_u32 s3, s3, 16384
  buffer_load_dwordx2 v[38:39], v2, s[56:59], s3 offen
  s_add_u32 s3, s3, 16384
  buffer_load_dwordx2 v[40:41], v2, s[56:59], s3 offen
  s_add_u32 s3, s3, 16384
  buffer_load_dwordx2 v[42:43], v2, s[56:59], s3 offen
  s_add_u32 s3, s3, 16384
  buffer_load_dwordx2 v[44:45], v2, s[56:59], s3 offen
  s_add_u32 s3, s3, 16384
  buffer_load_dwordx2 v[46:47], v2, s[56:59], s3 offen
  s_add_u32 s3, s3, 16384
  buffer_load_dwordx2 v[48:49], v2, s[56:59], s3 offen
  s_add_u32 s3, s3, 16384
  buffer_load_dwordx2 v[50:51], v2, s[56:59], s3 offen
  s_add_u32 s3, s3, 16384
  buffer_load_dwordx2 v[52:53], v2, s[56:59], s3 offen
  s_add_u32 s3, s3, 16384
  buffer_load_dwordx2 v[54:55], v2, s[56:59], s3 offen
  s_add_u32 s3, s3, 16384
  buffer_load_dwordx2 v[56:57], v2, s[56:59], s3 offen
  s_add_u32 s3, s3, 16384
  buffer_load_dwordx2 v[58:59], v2, s[56:59], s3 offen
  s_add_u32 s3, s3, 16384
  buffer_load_dwordx2 v[60:61], v2, s[56:59], s3 offen
  s_add_u32 s3, s3, 16384
  buffer_load_dwordx2 v[62:63], v2, s[56:59], s3 offen
  s_mov_b32 s60, s20
  s_and_b32 s61, s21, 0xffff
  s_mov_b32 s62, 2097152
  s_mov_b32 s63, 0x00020000
  s_and_b32 s3, s70, 3
  s_mul_i32 s3, s3, 8
  s_mul_i32 s4, s99, 32
  s_add_u32 s3, s3, s4
  v_lshrrev_b32 v2, 3, v1
  v_add_u32 v2, s3, v2
  v_mul_u32_u24 v2, 2048, v2
  v_and_b32 v3, 7, v1
  v_lshl_add_u32 v2, v3, 8, v2
  s_and_b32 s3, s2, 7
  s_lshr_b32 s3, s3, 2
  s_mul_i32 s3, s3, 128
  buffer_load_dword v96, v2, s[60:63], s3 offen
  s_waitcnt vmcnt(28)
  s_barrier
  s_waitcnt vmcnt(17)
  s_barrier
  s_waitcnt vmcnt(1)
  v_add_f32 v32, v32, v34
  v_add_f32 v33, v33, v35
  v_add_f32 v48, v48, v50
  v_add_f32 v49, v49, v51
  v_add_f32 v32, v32, v36
  v_add_f32 v33, v33, v37
  v_add_f32 v48, v48, v52
  v_add_f32 v49, v49, v53
  v_add_f32 v32, v32, v38
  v_add_f32 v33, v33, v39
  v_add_f32 v48, v48, v54
  v_add_f32 v49, v49, v55
  v_add_f32 v32, v32, v40
  v_add_f32 v33, v33, v41
  v_add_f32 v48, v48, v56
  v_add_f32 v49, v49, v57
  v_add_f32 v32, v32, v42
  v_add_f32 v33, v33, v43
  v_add_f32 v48, v48, v58
  v_add_f32 v49, v49, v59
  v_add_f32 v32, v32, v44
  v_add_f32 v33, v33, v45
  v_add_f32 v48, v48, v60
  v_add_f32 v49, v49, v61
  v_add_f32 v32, v32, v46
  v_add_f32 v33, v33, v47
  v_add_f32 v48, v48, v62
  v_add_f32 v49, v49, v63
  v_add_f32 v32, v32, v48
  v_add_f32 v33, v33, v49
  v_mul_f32 v32, 0x3a800000, v32
  v_mul_f32 v33, 0x3a800000, v33
  v_fma_f32 v33, -v32, v32, v33
  v_max_f32 v33, 0, v33
  v_add_f32 v33, 0x3727c5ac, v33
  v_rsq_f32 v33, v33
  s_nop 0
  s_and_b32 s3, s70, 3
  s_lshl_b32 s5, s3, 6
  s_add_u32 s5, s5, 16
  v_add_u32 v2, s5, v1
  v_and_b32 v3, 15, v1
  s_cmp_ge_u32 s3, 2
  s_cselect_b64 vcc, -1, 0
  v_cndmask_b32 v2, v2, v3, vcc
  v_lshlrev_b32 v2, 2, v2
  v_add_u32 v2, 129024, v2
  ds_write2_b32 v2, v32, v33 offset0:0 offset1:160
  s_waitcnt lgkmcnt(0)
  s_barrier
  s_barrier
L_attn_ldend:
  s_lshl_b32 s87, s97, 12
  s_lshl_b32 s4, s68, 8
  s_add_u32 s87, s87, s4
  s_lshl_b32 s4, s69, 2
  s_add_u32 s87, s87, s4
  s_add_u32 s97, s97, 1
  s_branch L_wo_body
L_attn_end:
  s_endpgm
L_attn_compute:
  s_and_b32 s71, s70, 1
  s_lshr_b32 s72, s70, 1
  v_and_b32 v3, 31, v1
  v_lshlrev_b32 v3, 2, v3
  v_add_u32 v3, 40960, v3
  v_mov_b32 v236, 0x3f803f80
  v_mov_b32 v237, 0x3f803f80
  v_mov_b32 v238, 0x3f803f80
  v_mov_b32 v239, 0x3f803f80
  ds_write_b32 v3, v236
  ds_write_b32 v3, v236 offset:43008
  v_add_u32 v3, 86016, v3
  ds_write_b32 v3, v236
  v_and_b32 v3, 15, v1
  v_lshrrev_b32 v2, 4, v1
  v_lshrrev_b32 v33, 1, v3
  s_lshl_b32 s8, s71, 13
  v_xor_b32 v4, v2, v33
  v_lshlrev_b32 v4, 4, v4
  v_lshl_add_u32 v4, v3, 7, v4
  v_add_u32 v8, 40960, v4
  v_add_u32 v4, s8, v4
  v_add_u32 v5, 4, v2
  v_xor_b32 v5, v5, v33
  v_lshlrev_b32 v5, 4, v5
  v_lshl_add_u32 v5, v3, 7, v5
  v_add_u32 v9, 40960, v5
  v_add_u32 v5, s8, v5
  v_bfe_u32 v34, v1, 2, 2
  v_lshl_add_u32 v34, v2, 3, v34
  v_lshlrev_b32 v34, 7, v34
  v_and_b32 v33, 3, v1
  v_lshl_add_u32 v34, v33, 3, v34
  v_bfe_u32 v33, v1, 3, 2
  v_lshl_add_u32 v34, v33, 5, v34
  v_and_b32 v35, 1, v2
  v_xor_b32 v35, s71, v35
  s_lshl_b32 s8, s70, 5
  v_xor_b32 v34, s8, v34
  v_add_u32 v6, 16384, v34
  v_xor_b32 v7, 32, v6
  s_lshl_b32 s8, s68, 7
  s_lshl_b32 s9, s71, 6
  s_add_u32 s8, s8, s9
  s_add_u32 s10, s8, s69
  s_lshl_b32 s10, s10, 11
  s_lshl_b32 s11, s72, 10
  s_add_u32 s10, s10, s11
  v_lshl_add_u32 v33, v3, 4, s10
  v_lshl_add_u32 v33, v35, 9, v33
  v_lshrrev_b32 v34, 1, v2
  v_lshl_add_u32 v31, v34, 8, v33
  s_mul_i32 s10, s72, 14336
  s_add_u32 s10, s10, 1024
  s_lshl_b32 s11, s71, 10
  s_add_u32 s4, s10, s11
  s_sub_u32 s5, s10, s11
  s_mul_i32 s6, s71, 6144
  v_lshl_add_u32 v16, v1, 4, s4
  v_add_u32 v17, s6, v16
  v_lshl_add_u32 v18, v1, 4, s5
  v_add_u32 v18, s6, v18
  v_lshl_add_u32 v19, v2, 8, s4
  v_lshl_add_u32 v20, v2, 8, s5
  v_lshl_add_u32 v21, v3, 4, s4
  v_lshl_add_u32 v22, v3, 4, s5
  s_lshl_b32 s10, s71, 8
  s_add_u32 s10, s10, 129024
  v_lshl_add_u32 v23, v3, 2, s10
  v_lshl_add_u32 v24, v2, 4, s10
  v_and_b32 v33, 1, v3
  v_cmp_eq_u32 s[48:49], 1, v33
  v_lshl_add_u32 v34, v2, 2, v33
  v_add_u32 v35, 2, v34
  v_cmp_gt_u32 s[50:51], v34, v3
  v_cmp_gt_u32 s[52:53], v35, v3
  v_mov_b32 v36, 0xffff
  v_mov_b32 v37, 0xffff0000
  v_cndmask_b32 v36, v36, v37, s[48:49]
  s_add_u32 s10, s10, 704
  v_lshl_add_u32 v34, v34, 2, s10
  v_lshl_add_u32 v35, v35, 2, s10
  v_subrev_u32 v38, 64, v34
  v_subrev_u32 v39, 64, v35
  v_cndmask_b32 v25, v34, v38, s[50:51]
  v_cndmask_b32 v26, v35, v39, s[52:53]
  v_cndmask_b32 v27, 0, v36, s[50:51]
  v_cndmask_b32 v29, 0, v36, s[52:53]
  v_xor_b32 v28, v27, v36
  v_xor_b32 v30, v29, v36
  s_cmp_eq_u32 s8, 0
  s_cselect_b64 s[54:55], s[50:51], 0
  s_cselect_b64 s[14:15], s[52:53], 0
  v_mov_b32 v120, 0
  v_mov_b32 v121, 0
  v_mov_b32 v122, 0
  v_mov_b32 v123, 0
  v_mov_b32 v124, 0
  v_mov_b32 v125, 0
  v_mov_b32 v126, 0
  v_mov_b32 v127, 0
  v_mov_b32 v128, 0
  v_mov_b32 v129, 0
  v_mov_b32 v130, 0
  v_mov_b32 v131, 0
  v_mov_b32 v132, 0
  v_mov_b32 v133, 0
  v_mov_b32 v134, 0
  v_mov_b32 v135, 0
  v_mov_b32 v136, 0
  v_mov_b32 v137, 0
  v_mov_b32 v138, 0
  v_mov_b32 v139, 0
  v_mov_b32 v140, 0
  v_mov_b32 v141, 0
  v_mov_b32 v142, 0
  v_mov_b32 v143, 0
  v_mov_b32 v144, 0
  v_mov_b32 v145, 0
  v_mov_b32 v146, 0
  v_mov_b32 v147, 0
  v_mov_b32 v148, 0
  v_mov_b32 v149, 0
  v_mov_b32 v150, 0
  v_mov_b32 v151, 0
  v_mov_b32 v152, 0
  v_mov_b32 v153, 0
  v_mov_b32 v154, 0
  v_mov_b32 v155, 0
  v_mov_b32 v156, 0
  v_mov_b32 v157, 0
  v_mov_b32 v158, 0
  v_mov_b32 v159, 0
  v_mov_b32 v160, 0
  v_mov_b32 v161, 0
  v_mov_b32 v162, 0
  v_mov_b32 v163, 0
  v_mov_b32 v164, 0
  v_mov_b32 v165, 0
  v_mov_b32 v166, 0
  v_mov_b32 v167, 0
  v_mov_b32 v168, 0
  v_mov_b32 v169, 0
  v_mov_b32 v170, 0
  v_mov_b32 v171, 0
  v_mov_b32 v172, 0
  v_mov_b32 v173, 0
  v_mov_b32 v174, 0
  v_mov_b32 v175, 0
  v_mov_b32 v176, 0
  v_mov_b32 v177, 0
  v_mov_b32 v178, 0
  v_mov_b32 v179, 0
  v_mov_b32 v180, 0
  v_mov_b32 v181, 0
  v_mov_b32 v182, 0
  v_mov_b32 v183, 0
  v_mov_b32 v184, 0
  v_mov_b32 v185, 0
  v_mov_b32 v186, 0
  v_mov_b32 v187, 0
  v_mov_b32 v188, 0
  v_mov_b32 v189, 0
  v_mov_b32 v190, 0
  v_mov_b32 v191, 0
  v_mov_b32 v192, 0
  v_mov_b32 v193, 0
  v_mov_b32 v194, 0
  v_mov_b32 v195, 0
  v_mov_b32 v196, 0
  v_mov_b32 v197, 0
  v_mov_b32 v198, 0
  v_mov_b32 v199, 0
  v_mov_b32 v200, 0
  v_mov_b32 v201, 0
  v_mov_b32 v202, 0
  v_mov_b32 v203, 0
  v_mov_b32 v204, 0
  v_mov_b32 v205, 0
  v_mov_b32 v206, 0
  v_mov_b32 v207, 0
  v_mov_b32 v208, 0
  v_mov_b32 v209, 0
  v_mov_b32 v210, 0
  v_mov_b32 v211, 0
  v_mov_b32 v212, 0
  v_mov_b32 v213, 0
  v_mov_b32 v214, 0
  v_mov_b32 v215, 0
  v_mov_b32 v216, 0
  v_mov_b32 v217, 0
  v_mov_b32 v218, 0
  v_mov_b32 v219, 0
  v_mov_b32 v220, 0
  v_mov_b32 v221, 0
  v_mov_b32 v222, 0
  v_mov_b32 v223, 0
  v_mov_b32 v224, 0
  v_mov_b32 v225, 0
  v_mov_b32 v226, 0
  v_mov_b32 v227, 0
  v_mov_b32 v228, 0
  v_mov_b32 v229, 0
  v_mov_b32 v230, 0
  v_mov_b32 v231, 0
  v_mov_b32 v232, 0
  v_mov_b32 v233, 0
  v_mov_b32 v234, 0
  v_mov_b32 v235, 0
  s_waitcnt lgkmcnt(0)
  s_mov_b32 s44, s34
  s_and_b32 s45, s35, 0xffff
  s_mov_b32 s46, 4194304
  s_mov_b32 s47, 0x00020000
  s_load_dwordx2 s[64:65], s[0:1], 72
  s_or_b32 s3, s96, s70
  s_cbranch_scc1 L_clr_skip0
  s_add_u32 s60, s22, 24903680
  s_addc_u32 s61, s23, 0
  s_and_b32 s61, s61, 0xffff
  s_mov_b32 s62, 262144
  s_mov_b32 s63, 0x00020000
  s_lshl_b32 s3, s2, 10
  v_lshlrev_b32 v2, 4, v1
  buffer_store_dwordx4 v[128:131], v2, s[60:63], s3 offen sc1
L_clr_skip0:
  s_cmp_lg_u32 s96, 0
  s_cbranch_scc1 L_pfc1_skip
  s_getpc_b64 s[4:5]
L_pfc1:
  s_lshl_b32 s3, s99, 2
  s_add_u32 s3, s3, s70
  s_mul_i32 s3, s3, 256
  s_min_u32 s3, s3, L_w2_c1-L_attn_c0-256
  s_add_i32 s3, s3, L_attn_c0-L_pfc1
  s_ashr_i32 s6, s3, 31
  s_add_u32 s4, s4, s3
  s_addc_u32 s5, s5, s6
  s_load_dword s36, s[4:5], 0
  s_load_dword s37, s[4:5], 64
  s_load_dword s38, s[4:5], 128
  s_load_dword s39, s[4:5], 192
L_pfc1_skip:
  s_mov_b32 s75, 0
  v_add_u32_e64 v10, s75, v4
  v_add_u32_e64 v11, s75, v5
  v_add_u32_e64 v12, s75, v6
  v_add_u32_e64 v13, s75, v7
  v_add_u32_e64 v14, s75, v8
  v_add_u32_e64 v15, s75, v9
  s_add_u32 s75, s75, 43008
  s_cmp_eq_u32 s75, 129024
  s_cselect_b32 s75, 0, s75
  s_mov_b32 s79, 16
  s_cmp_eq_u32 s96, 0
  s_cbranch_scc1 L_attn_nog
  s_barrier
L_attn_nog:
  s_barrier
  ds_read_b128 v[32:35], v10 offset:0
  ds_read_b128 v[36:39], v10 offset:2048
  ds_read_b128 v[40:43], v10 offset:4096
  ds_read_b128 v[44:47], v10 offset:6144
  ds_read_b128 v[48:51], v14
  ds_read_b64_tr_b16 v[52:53], v12 offset:0
  ds_read_b64_tr_b16 v[54:55], v12 offset:512
  ds_read_b64_tr_b16 v[56:57], v13 offset:0
  ds_read_b64_tr_b16 v[58:59], v13 offset:512
  ds_read_b64_tr_b16 v[60:61], v12 offset:8192
  ds_read_b64_tr_b16 v[62:63], v12 offset:8704
  ds_read_b64_tr_b16 v[64:65], v13 offset:8192
  ds_read_b64_tr_b16 v[66:67], v13 offset:8704
  ds_read_b64_tr_b16 v[68:69], v12 offset:16384
  ds_read_b64_tr_b16 v[70:71], v12 offset:16896
  ds_read_b64_tr_b16 v[72:73], v13 offset:16384
  ds_read_b64_tr_b16 v[74:75], v13 offset:16896
  s_waitcnt lgkmcnt(0)
  s_cmp_lg_u32 s96, 0
  s_cbranch_scc1 L_attn_loop
  v_mov_b32 v240, 0
  v_mov_b32 v241, 0
  v_mov_b32 v242, 0
  v_mov_b32 v243, 0
  v_mov_b32 v244, 0
  v_mov_b32 v245, 0
  v_mov_b32 v246, 0
  v_mov_b32 v247, 0
  v_mov_b32 v248, 0
  v_mov_b32 v249, 0
  v_mov_b32 v250, 0
  v_mov_b32 v251, 0
  v_mov_b32 v252, 0
  v_mov_b32 v253, 0
  v_mov_b32 v254, 0
  v_mov_b32 v255, 0
  s_cmp_lg_u32 s72, 0
  s_cbranch_scc1 L_attn_loopb
  s_or_b32 s3, s96, s70
  s_cbranch_scc1 L_clr_skip1
  v_mov_b32 v3, 1
  s_and_b32 s65, s65, 0xffff
  s_mov_b32 s66, 256
  s_mov_b32 s67, 0x00020000
  s_mov_b64 exec, 1
  s_waitcnt vmcnt(0)
  buffer_store_byte v3, off, s[64:67], s2 sc1
  s_mov_b64 exec, -1
L_clr_skip1:
.p2align 3
L_attn_loopa:
  v_mfma_f32_16x16x32_bf16 v[240:243], v[236:239], v[32:35], v[240:243]
  ds_read_b128 v[76:79], v11 offset:0
  v_mfma_f32_16x16x32_bf16 v[244:247], v[32:35], v[32:35], v[244:247]
  ds_read_b128 v[80:83], v11 offset:2048
  v_mfma_f32_16x16x32_bf16 v[248:251], v[236:239], v[36:39], v[248:251]
  ds_read_b128 v[84:87], v11 offset:4096
  v_mfma_f32_16x16x32_bf16 v[252:255], v[36:39], v[36:39], v[252:255]
  ds_read_b128 v[88:91], v11 offset:6144
  v_mfma_f32_16x16x32_bf16 v[120:123], v[236:239], v[48:51], v[120:123]
  ds_read_b128 v[92:95], v15
  v_mfma_f32_16x16x32_bf16 v[124:127], v[48:51], v[48:51], v[124:127]
  ds_read_b64_tr_b16 v[96:97], v12 offset:4096
  v_mfma_f32_16x16x32_bf16 v[128:131], v[52:55], v[32:35], v[128:131]
  ds_read_b64_tr_b16 v[98:99], v12 offset:4608
  v_mfma_f32_16x16x32_bf16 v[132:135], v[52:55], v[36:39], v[132:135]
  ds_read_b64_tr_b16 v[100:101], v13 offset:4096
  v_mfma_f32_16x16x32_bf16 v[136:139], v[52:55], v[40:43], v[136:139]
  ds_read_b64_tr_b16 v[102:103], v13 offset:4608
  v_mfma_f32_16x16x32_bf16 v[140:143], v[52:55], v[44:47], v[140:143]
  ds_read_b64_tr_b16 v[104:105], v12 offset:12288
  v_mfma_f32_16x16x32_bf16 v[224:227], v[52:55], v[48:51], v[224:227]
  ds_read_b64_tr_b16 v[106:107], v12 offset:12800
  v_mfma_f32_16x16x32_bf16 v[144:147], v[56:59], v[32:35], v[144:147]
  ds_read_b64_tr_b16 v[108:109], v13 offset:12288
  v_mfma_f32_16x16x32_bf16 v[148:151], v[56:59], v[36:39], v[148:151]
  ds_read_b64_tr_b16 v[110:111], v13 offset:12800
  v_mfma_f32_16x16x32_bf16 v[152:155], v[56:59], v[40:43], v[152:155]
  ds_read_b64_tr_b16 v[112:113], v12 offset:20480
  v_mfma_f32_16x16x32_bf16 v[156:159], v[56:59], v[44:47], v[156:159]
  ds_read_b64_tr_b16 v[114:115], v12 offset:20992
  v_mfma_f32_16x16x32_bf16 v[160:163], v[60:63], v[32:35], v[160:163]
  ds_read_b64_tr_b16 v[116:117], v13 offset:20480
  v_mfma_f32_16x16x32_bf16 v[164:167], v[60:63], v[36:39], v[164:167]
  ds_read_b64_tr_b16 v[118:119], v13 offset:20992
  v_mfma_f32_16x16x32_bf16 v[168:171], v[60:63], v[40:43], v[168:171]
  v_add_u32_e64 v10, s75, v4
  v_mfma_f32_16x16x32_bf16 v[172:175], v[60:63], v[44:47], v[172:175]
  v_add_u32_e64 v11, s75, v5
  v_mfma_f32_16x16x32_bf16 v[228:231], v[60:63], v[48:51], v[228:231]
  v_add_u32_e64 v12, s75, v6
  v_mfma_f32_16x16x32_bf16 v[176:179], v[64:67], v[32:35], v[176:179]
  v_add_u32_e64 v13, s75, v7
  v_mfma_f32_16x16x32_bf16 v[180:183], v[64:67], v[36:39], v[180:183]
  v_add_u32_e64 v14, s75, v8
  v_mfma_f32_16x16x32_bf16 v[184:187], v[64:67], v[40:43], v[184:187]
  v_add_u32_e64 v15, s75, v9
  v_mfma_f32_16x16x32_bf16 v[188:191], v[64:67], v[44:47], v[188:191]
  s_add_u32 s75, s75, 43008
  v_mfma_f32_16x16x32_bf16 v[192:195], v[32:35], v[68:71], v[192:195]
  s_cmp_eq_u32 s75, 129024
  v_mfma_f32_16x16x32_bf16 v[196:199], v[36:39], v[68:71], v[196:199]
  s_cselect_b32 s75, 0, s75
  s_sub_u32 s79, s79, 1
  v_mfma_f32_16x16x32_bf16 v[200:203], v[40:43], v[68:71], v[200:203]
  v_mfma_f32_16x16x32_bf16 v[204:207], v[44:47], v[68:71], v[204:207]
  v_mfma_f32_16x16x32_bf16 v[232:235], v[48:51], v[68:71], v[232:235]
  v_mfma_f32_16x16x32_bf16 v[208:211], v[32:35], v[72:75], v[208:211]
  v_mfma_f32_16x16x32_bf16 v[212:215], v[36:39], v[72:75], v[212:215]
  v_mfma_f32_16x16x32_bf16 v[216:219], v[40:43], v[72:75], v[216:219]
  v_mfma_f32_16x16x32_bf16 v[220:223], v[44:47], v[72:75], v[220:223]
  s_waitcnt lgkmcnt(0)
  s_barrier
  v_mfma_f32_16x16x32_bf16 v[240:243], v[236:239], v[76:79], v[240:243]
  ds_read_b128 v[32:35], v10 offset:0
  v_mfma_f32_16x16x32_bf16 v[244:247], v[76:79], v[76:79], v[244:247]
  ds_read_b128 v[36:39], v10 offset:2048
  v_mfma_f32_16x16x32_bf16 v[248:251], v[236:239], v[80:83], v[248:251]
  ds_read_b128 v[40:43], v10 offset:4096
  v_mfma_f32_16x16x32_bf16 v[252:255], v[80:83], v[80:83], v[252:255]
  ds_read_b128 v[44:47], v10 offset:6144
  v_mfma_f32_16x16x32_bf16 v[120:123], v[236:239], v[92:95], v[120:123]
  ds_read_b128 v[48:51], v14
  v_mfma_f32_16x16x32_bf16 v[124:127], v[92:95], v[92:95], v[124:127]
  ds_read_b64_tr_b16 v[52:53], v12 offset:0
  v_mfma_f32_16x16x32_bf16 v[128:131], v[96:99], v[76:79], v[128:131]
  ds_read_b64_tr_b16 v[54:55], v12 offset:512
  v_mfma_f32_16x16x32_bf16 v[132:135], v[96:99], v[80:83], v[132:135]
  ds_read_b64_tr_b16 v[56:57], v13 offset:0
  v_mfma_f32_16x16x32_bf16 v[136:139], v[96:99], v[84:87], v[136:139]
  ds_read_b64_tr_b16 v[58:59], v13 offset:512
  v_mfma_f32_16x16x32_bf16 v[140:143], v[96:99], v[88:91], v[140:143]
  ds_read_b64_tr_b16 v[60:61], v12 offset:8192
  v_mfma_f32_16x16x32_bf16 v[224:227], v[96:99], v[92:95], v[224:227]
  ds_read_b64_tr_b16 v[62:63], v12 offset:8704
  v_mfma_f32_16x16x32_bf16 v[144:147], v[100:103], v[76:79], v[144:147]
  ds_read_b64_tr_b16 v[64:65], v13 offset:8192
  v_mfma_f32_16x16x32_bf16 v[148:151], v[100:103], v[80:83], v[148:151]
  ds_read_b64_tr_b16 v[66:67], v13 offset:8704
  v_mfma_f32_16x16x32_bf16 v[152:155], v[100:103], v[84:87], v[152:155]
  ds_read_b64_tr_b16 v[68:69], v12 offset:16384
  v_mfma_f32_16x16x32_bf16 v[156:159], v[100:103], v[88:91], v[156:159]
  ds_read_b64_tr_b16 v[70:71], v12 offset:16896
  v_mfma_f32_16x16x32_bf16 v[160:163], v[104:107], v[76:79], v[160:163]
  ds_read_b64_tr_b16 v[72:73], v13 offset:16384
  v_mfma_f32_16x16x32_bf16 v[164:167], v[104:107], v[80:83], v[164:167]
  ds_read_b64_tr_b16 v[74:75], v13 offset:16896
  v_mfma_f32_16x16x32_bf16 v[168:171], v[104:107], v[84:87], v[168:171]
  s_cmp_lg_u32 s79, 0
  s_nop 0
  v_mfma_f32_16x16x32_bf16 v[172:175], v[104:107], v[88:91], v[172:175]
  v_mfma_f32_16x16x32_bf16 v[228:231], v[104:107], v[92:95], v[228:231]
  v_mfma_f32_16x16x32_bf16 v[176:179], v[108:111], v[76:79], v[176:179]
  v_mfma_f32_16x16x32_bf16 v[180:183], v[108:111], v[80:83], v[180:183]
  v_mfma_f32_16x16x32_bf16 v[184:187], v[108:111], v[84:87], v[184:187]
  v_mfma_f32_16x16x32_bf16 v[188:191], v[108:111], v[88:91], v[188:191]
  v_mfma_f32_16x16x32_bf16 v[192:195], v[76:79], v[112:115], v[192:195]
  v_mfma_f32_16x16x32_bf16 v[196:199], v[80:83], v[112:115], v[196:199]
  v_mfma_f32_16x16x32_bf16 v[200:203], v[84:87], v[112:115], v[200:203]
  v_mfma_f32_16x16x32_bf16 v[204:207], v[88:91], v[112:115], v[204:207]
  v_mfma_f32_16x16x32_bf16 v[232:235], v[92:95], v[112:115], v[232:235]
  v_mfma_f32_16x16x32_bf16 v[208:211], v[76:79], v[116:119], v[208:211]
  v_mfma_f32_16x16x32_bf16 v[212:215], v[80:83], v[116:119], v[212:215]
  v_mfma_f32_16x16x32_bf16 v[216:219], v[84:87], v[116:119], v[216:219]
  v_mfma_f32_16x16x32_bf16 v[220:223], v[88:91], v[116:119], v[220:223]
  s_waitcnt lgkmcnt(0)
  s_cbranch_scc1 L_attn_loopa
  s_branch L_attn_post
.p2align 3
L_attn_loopb:
  v_mfma_f32_16x16x32_bf16 v[240:243], v[236:239], v[40:43], v[240:243]
  ds_read_b128 v[76:79], v11 offset:0
  v_mfma_f32_16x16x32_bf16 v[244:247], v[40:43], v[40:43], v[244:247]
  ds_read_b128 v[80:83], v11 offset:2048
  v_mfma_f32_16x16x32_bf16 v[248:251], v[236:239], v[44:47], v[248:251]
  ds_read_b128 v[84:87], v11 offset:4096
  v_mfma_f32_16x16x32_bf16 v[252:255], v[44:47], v[44:47], v[252:255]
  ds_read_b128 v[88:91], v11 offset:6144
  v_mfma_f32_16x16x32_bf16 v[128:131], v[52:55], v[32:35], v[128:131]
  ds_read_b128 v[92:95], v15
  v_mfma_f32_16x16x32_bf16 v[132:135], v[52:55], v[36:39], v[132:135]
  ds_read_b64_tr_b16 v[96:97], v12 offset:4096
  v_mfma_f32_16x16x32_bf16 v[136:139], v[52:55], v[40:43], v[136:139]
  ds_read_b64_tr_b16 v[98:99], v12 offset:4608
  v_mfma_f32_16x16x32_bf16 v[140:143], v[52:55], v[44:47], v[140:143]
  ds_read_b64_tr_b16 v[100:101], v13 offset:4096
  v_mfma_f32_16x16x32_bf16 v[224:227], v[52:55], v[48:51], v[224:227]
  ds_read_b64_tr_b16 v[102:103], v13 offset:4608
  v_mfma_f32_16x16x32_bf16 v[144:147], v[56:59], v[32:35], v[144:147]
  ds_read_b64_tr_b16 v[104:105], v12 offset:12288
  v_mfma_f32_16x16x32_bf16 v[148:151], v[56:59], v[36:39], v[148:151]
  ds_read_b64_tr_b16 v[106:107], v12 offset:12800
  v_mfma_f32_16x16x32_bf16 v[152:155], v[56:59], v[40:43], v[152:155]
  ds_read_b64_tr_b16 v[108:109], v13 offset:12288
  v_mfma_f32_16x16x32_bf16 v[156:159], v[56:59], v[44:47], v[156:159]
  ds_read_b64_tr_b16 v[110:111], v13 offset:12800
  v_mfma_f32_16x16x32_bf16 v[160:163], v[60:63], v[32:35], v[160:163]
  ds_read_b64_tr_b16 v[112:113], v12 offset:20480
  v_mfma_f32_16x16x32_bf16 v[164:167], v[60:63], v[36:39], v[164:167]
  ds_read_b64_tr_b16 v[114:115], v12 offset:20992
  v_mfma_f32_16x16x32_bf16 v[168:171], v[60:63], v[40:43], v[168:171]
  ds_read_b64_tr_b16 v[116:117], v13 offset:20480
  v_mfma_f32_16x16x32_bf16 v[172:175], v[60:63], v[44:47], v[172:175]
  ds_read_b64_tr_b16 v[118:119], v13 offset:20992
  v_mfma_f32_16x16x32_bf16 v[228:231], v[60:63], v[48:51], v[228:231]
  v_add_u32_e64 v10, s75, v4
  v_mfma_f32_16x16x32_bf16 v[176:179], v[64:67], v[32:35], v[176:179]
  v_add_u32_e64 v11, s75, v5
  v_mfma_f32_16x16x32_bf16 v[180:183], v[64:67], v[36:39], v[180:183]
  v_add_u32_e64 v12, s75, v6
  v_mfma_f32_16x16x32_bf16 v[184:187], v[64:67], v[40:43], v[184:187]
  v_add_u32_e64 v13, s75, v7
  v_mfma_f32_16x16x32_bf16 v[188:191], v[64:67], v[44:47], v[188:191]
  v_add_u32_e64 v14, s75, v8
  v_mfma_f32_16x16x32_bf16 v[192:195], v[32:35], v[68:71], v[192:195]
  v_add_u32_e64 v15, s75, v9
  v_mfma_f32_16x16x32_bf16 v[196:199], v[36:39], v[68:71], v[196:199]
  s_add_u32 s75, s75, 43008
  v_mfma_f32_16x16x32_bf16 v[200:203], v[40:43], v[68:71], v[200:203]
  s_cmp_eq_u32 s75, 129024
  v_mfma_f32_16x16x32_bf16 v[204:207], v[44:47], v[68:71], v[204:207]
  s_cselect_b32 s75, 0, s75
  s_sub_u32 s79, s79, 1
  v_mfma_f32_16x16x32_bf16 v[232:235], v[48:51], v[68:71], v[232:235]
  v_mfma_f32_16x16x32_bf16 v[208:211], v[32:35], v[72:75], v[208:211]
  v_mfma_f32_16x16x32_bf16 v[212:215], v[36:39], v[72:75], v[212:215]
  v_mfma_f32_16x16x32_bf16 v[216:219], v[40:43], v[72:75], v[216:219]
  v_mfma_f32_16x16x32_bf16 v[220:223], v[44:47], v[72:75], v[220:223]
  s_waitcnt lgkmcnt(0)
  s_barrier
  v_mfma_f32_16x16x32_bf16 v[240:243], v[236:239], v[84:87], v[240:243]
  ds_read_b128 v[32:35], v10 offset:0
  v_mfma_f32_16x16x32_bf16 v[244:247], v[84:87], v[84:87], v[244:247]
  ds_read_b128 v[36:39], v10 offset:2048
  v_mfma_f32_16x16x32_bf16 v[248:251], v[236:239], v[88:91], v[248:251]
  ds_read_b128 v[40:43], v10 offset:4096
  v_mfma_f32_16x16x32_bf16 v[252:255], v[88:91], v[88:91], v[252:255]
  ds_read_b128 v[44:47], v10 offset:6144
  v_mfma_f32_16x16x32_bf16 v[128:131], v[96:99], v[76:79], v[128:131]
  ds_read_b128 v[48:51], v14
  v_mfma_f32_16x16x32_bf16 v[132:135], v[96:99], v[80:83], v[132:135]
  ds_read_b64_tr_b16 v[52:53], v12 offset:0
  v_mfma_f32_16x16x32_bf16 v[136:139], v[96:99], v[84:87], v[136:139]
  ds_read_b64_tr_b16 v[54:55], v12 offset:512
  v_mfma_f32_16x16x32_bf16 v[140:143], v[96:99], v[88:91], v[140:143]
  ds_read_b64_tr_b16 v[56:57], v13 offset:0
  v_mfma_f32_16x16x32_bf16 v[224:227], v[96:99], v[92:95], v[224:227]
  ds_read_b64_tr_b16 v[58:59], v13 offset:512
  v_mfma_f32_16x16x32_bf16 v[144:147], v[100:103], v[76:79], v[144:147]
  ds_read_b64_tr_b16 v[60:61], v12 offset:8192
  v_mfma_f32_16x16x32_bf16 v[148:151], v[100:103], v[80:83], v[148:151]
  ds_read_b64_tr_b16 v[62:63], v12 offset:8704
  v_mfma_f32_16x16x32_bf16 v[152:155], v[100:103], v[84:87], v[152:155]
  ds_read_b64_tr_b16 v[64:65], v13 offset:8192
  v_mfma_f32_16x16x32_bf16 v[156:159], v[100:103], v[88:91], v[156:159]
  ds_read_b64_tr_b16 v[66:67], v13 offset:8704
  v_mfma_f32_16x16x32_bf16 v[160:163], v[104:107], v[76:79], v[160:163]
  ds_read_b64_tr_b16 v[68:69], v12 offset:16384
  v_mfma_f32_16x16x32_bf16 v[164:167], v[104:107], v[80:83], v[164:167]
  ds_read_b64_tr_b16 v[70:71], v12 offset:16896
  v_mfma_f32_16x16x32_bf16 v[168:171], v[104:107], v[84:87], v[168:171]
  ds_read_b64_tr_b16 v[72:73], v13 offset:16384
  v_mfma_f32_16x16x32_bf16 v[172:175], v[104:107], v[88:91], v[172:175]
  ds_read_b64_tr_b16 v[74:75], v13 offset:16896
  v_mfma_f32_16x16x32_bf16 v[228:231], v[104:107], v[92:95], v[228:231]
  s_cmp_lg_u32 s79, 0
  s_nop 0
  v_mfma_f32_16x16x32_bf16 v[176:179], v[108:111], v[76:79], v[176:179]
  v_mfma_f32_16x16x32_bf16 v[180:183], v[108:111], v[80:83], v[180:183]
  v_mfma_f32_16x16x32_bf16 v[184:187], v[108:111], v[84:87], v[184:187]
  v_mfma_f32_16x16x32_bf16 v[188:191], v[108:111], v[88:91], v[188:191]
  v_mfma_f32_16x16x32_bf16 v[192:195], v[76:79], v[112:115], v[192:195]
  v_mfma_f32_16x16x32_bf16 v[196:199], v[80:83], v[112:115], v[196:199]
  v_mfma_f32_16x16x32_bf16 v[200:203], v[84:87], v[112:115], v[200:203]
  v_mfma_f32_16x16x32_bf16 v[204:207], v[88:91], v[112:115], v[204:207]
  v_mfma_f32_16x16x32_bf16 v[232:235], v[92:95], v[112:115], v[232:235]
  v_mfma_f32_16x16x32_bf16 v[208:211], v[76:79], v[116:119], v[208:211]
  v_mfma_f32_16x16x32_bf16 v[212:215], v[80:83], v[116:119], v[212:215]
  v_mfma_f32_16x16x32_bf16 v[216:219], v[84:87], v[116:119], v[216:219]
  v_mfma_f32_16x16x32_bf16 v[220:223], v[88:91], v[116:119], v[220:223]
  s_waitcnt lgkmcnt(0)
  s_cbranch_scc1 L_attn_loopb
L_attn_post:
  v_and_b32 v32, 3, v1
  v_cmp_eq_u32 s[4:5], 1, v32
  v_cmp_eq_u32 s[6:7], 2, v32
  v_cmp_eq_u32 s[8:9], 3, v32
  v_bfe_u32 v33, v1, 2, 2
  v_lshrrev_b32 v34, 4, v1
  v_cmp_eq_u32 s[10:11], v33, v34
  s_lshl_b32 s3, s72, 7
  v_add_u32 v35, s3, v23
  v_and_b32 v36, 15, v1
  s_cmp_eq_u32 s70, 0
  s_cselect_b32 s3, 0, 576
  s_add_u32 s3, s3, 129024
  v_lshl_add_u32 v36, v36, 2, s3
  v_cndmask_b32 v241, v244, v245, s[4:5]
  v_cndmask_b32 v249, v252, v253, s[4:5]
  v_cndmask_b32 v121, v124, v125, s[4:5]
  v_cndmask_b32 v241, v241, v246, s[6:7]
  v_cndmask_b32 v249, v249, v254, s[6:7]
  v_cndmask_b32 v121, v121, v126, s[6:7]
  v_cndmask_b32 v241, v241, v247, s[8:9]
  v_cndmask_b32 v249, v249, v255, s[8:9]
  v_cndmask_b32 v121, v121, v127, s[8:9]
  v_mul_f32 v240, 0x3a800000, v240
  v_mul_f32 v241, 0x3a800000, v241
  v_fma_f32 v241, -v240, v240, v241
  v_max_f32 v241, 0, v241
  v_add_f32 v241, 0x3727c5ac, v241
  v_rsq_f32 v241, v241
  s_nop 0
  v_mul_f32 v248, 0x3a800000, v248
  v_mul_f32 v249, 0x3a800000, v249
  v_fma_f32 v249, -v248, v248, v249
  v_max_f32 v249, 0, v249
  v_add_f32 v249, 0x3727c5ac, v249
  v_rsq_f32 v249, v249
  s_nop 0
  v_mul_f32 v120, 0x3a800000, v120
  v_mul_f32 v121, 0x3a800000, v121
  v_fma_f32 v121, -v120, v120, v121
  v_max_f32 v121, 0, v121
  v_add_f32 v121, 0x3727c5ac, v121
  v_rsq_f32 v121, v121
  s_nop 0
  s_mov_b64 exec, s[10:11]
  ds_write2_b32 v35, v240, v241 offset0:16 offset1:176
  ds_write2_b32 v35, v248, v249 offset0:32 offset1:192
  ds_write2_b32 v36, v120, v121 offset0:0 offset1:160
  s_mov_b64 exec, -1
  s_mov_b32 s36, s16
  s_and_b32 s37, s17, 0xffff
  s_mov_b32 s38, 4194304
  s_mov_b32 s39, 0x00020000
  s_and_b32 s3, s2, 3
  s_and_b32 s4, s99, 3
  s_lshl2_add_u32 s3, s3, s4
  s_lshl2_add_u32 s3, s3, s70
  s_lshl_b32 s3, s3, 16
  s_bfe_u32 s4, s2, 0x10002
  s_lshr_b32 s5, s99, 2
  s_lshl1_add_u32 s4, s5, s4
  s_lshl_b32 s4, s4, 7
  s_add_u32 s3, s3, s4
  s_add_u32 s4, s3, 32768
  v_and_b32 v32, 15, v1
  v_lshlrev_b32 v33, 1, v1
  v_and_b32 v33, 32, v33
  v_lshl_add_u32 v32, v32, 11, v33
  v_lshrrev_b32 v33, 1, v1
  v_and_b32 v33, 16, v33
  v_add_u32 v32, v32, v33
  s_waitcnt lgkmcnt(0)
  buffer_load_dwordx4 v[240:243], v32, s[36:39], s3 offen offset:0
  buffer_load_dwordx4 v[244:247], v32, s[36:39], s3 offen offset:64
  buffer_load_dwordx4 v[248:251], v32, s[36:39], s4 offen offset:0
  buffer_load_dwordx4 v[252:255], v32, s[36:39], s4 offen offset:64
  s_barrier
  s_branch L_attn_exit
.p2align 3
L_attn_loop:
  v_mfma_f32_16x16x32_bf16 v[128:131], v[52:55], v[32:35], v[128:131]
  ds_read_b128 v[76:79], v11 offset:0
  v_mfma_f32_16x16x32_bf16 v[132:135], v[52:55], v[36:39], v[132:135]
  ds_read_b128 v[80:83], v11 offset:2048
  v_mfma_f32_16x16x32_bf16 v[136:139], v[52:55], v[40:43], v[136:139]
  ds_read_b128 v[84:87], v11 offset:4096
  v_mfma_f32_16x16x32_bf16 v[140:143], v[52:55], v[44:47], v[140:143]
  ds_read_b128 v[88:91], v11 offset:6144
  v_mfma_f32_16x16x32_bf16 v[224:227], v[52:55], v[48:51], v[224:227]
  ds_read_b128 v[92:95], v15
  v_mfma_f32_16x16x32_bf16 v[144:147], v[56:59], v[32:35], v[144:147]
  ds_read_b64_tr_b16 v[96:97], v12 offset:4096
  v_mfma_f32_16x16x32_bf16 v[148:151], v[56:59], v[36:39], v[148:151]
  ds_read_b64_tr_b16 v[98:99], v12 offset:4608
  v_mfma_f32_16x16x32_bf16 v[152:155], v[56:59], v[40:43], v[152:155]
  ds_read_b64_tr_b16 v[100:101], v13 offset:4096
  v_mfma_f32_16x16x32_bf16 v[156:159], v[56:59], v[44:47], v[156:159]
  ds_read_b64_tr_b16 v[102:103], v13 offset:4608
  v_mfma_f32_16x16x32_bf16 v[160:163], v[60:63], v[32:35], v[160:163]
  ds_read_b64_tr_b16 v[104:105], v12 offset:12288
  v_mfma_f32_16x16x32_bf16 v[164:167], v[60:63], v[36:39], v[164:167]
  ds_read_b64_tr_b16 v[106:107], v12 offset:12800
  v_mfma_f32_16x16x32_bf16 v[168:171], v[60:63], v[40:43], v[168:171]
  ds_read_b64_tr_b16 v[108:109], v13 offset:12288
  v_mfma_f32_16x16x32_bf16 v[172:175], v[60:63], v[44:47], v[172:175]
  ds_read_b64_tr_b16 v[110:111], v13 offset:12800
  v_mfma_f32_16x16x32_bf16 v[228:231], v[60:63], v[48:51], v[228:231]
  ds_read_b64_tr_b16 v[112:113], v12 offset:20480
  v_mfma_f32_16x16x32_bf16 v[176:179], v[64:67], v[32:35], v[176:179]
  ds_read_b64_tr_b16 v[114:115], v12 offset:20992
  v_mfma_f32_16x16x32_bf16 v[180:183], v[64:67], v[36:39], v[180:183]
  ds_read_b64_tr_b16 v[116:117], v13 offset:20480
  v_mfma_f32_16x16x32_bf16 v[184:187], v[64:67], v[40:43], v[184:187]
  ds_read_b64_tr_b16 v[118:119], v13 offset:20992
  v_mfma_f32_16x16x32_bf16 v[188:191], v[64:67], v[44:47], v[188:191]
  v_add_u32_e64 v10, s75, v4
  v_mfma_f32_16x16x32_bf16 v[192:195], v[32:35], v[68:71], v[192:195]
  v_add_u32_e64 v11, s75, v5
  v_mfma_f32_16x16x32_bf16 v[196:199], v[36:39], v[68:71], v[196:199]
  v_add_u32_e64 v12, s75, v6
  v_mfma_f32_16x16x32_bf16 v[200:203], v[40:43], v[68:71], v[200:203]
  v_add_u32_e64 v13, s75, v7
  v_mfma_f32_16x16x32_bf16 v[204:207], v[44:47], v[68:71], v[204:207]
  v_add_u32_e64 v14, s75, v8
  v_mfma_f32_16x16x32_bf16 v[232:235], v[48:51], v[68:71], v[232:235]
  v_add_u32_e64 v15, s75, v9
  v_mfma_f32_16x16x32_bf16 v[208:211], v[32:35], v[72:75], v[208:211]
  s_add_u32 s75, s75, 43008
  v_mfma_f32_16x16x32_bf16 v[212:215], v[36:39], v[72:75], v[212:215]
  s_cmp_eq_u32 s75, 129024
  v_mfma_f32_16x16x32_bf16 v[216:219], v[40:43], v[72:75], v[216:219]
  s_cselect_b32 s75, 0, s75
  s_sub_u32 s79, s79, 1
  v_mfma_f32_16x16x32_bf16 v[220:223], v[44:47], v[72:75], v[220:223]
  s_waitcnt lgkmcnt(0)
  s_barrier
  v_mfma_f32_16x16x32_bf16 v[128:131], v[96:99], v[76:79], v[128:131]
  ds_read_b128 v[32:35], v10 offset:0
  v_mfma_f32_16x16x32_bf16 v[132:135], v[96:99], v[80:83], v[132:135]
  ds_read_b128 v[36:39], v10 offset:2048
  v_mfma_f32_16x16x32_bf16 v[136:139], v[96:99], v[84:87], v[136:139]
  ds_read_b128 v[40:43], v10 offset:4096
  v_mfma_f32_16x16x32_bf16 v[140:143], v[96:99], v[88:91], v[140:143]
  ds_read_b128 v[44:47], v10 offset:6144
  v_mfma_f32_16x16x32_bf16 v[224:227], v[96:99], v[92:95], v[224:227]
  ds_read_b128 v[48:51], v14
  v_mfma_f32_16x16x32_bf16 v[144:147], v[100:103], v[76:79], v[144:147]
  ds_read_b64_tr_b16 v[52:53], v12 offset:0
  v_mfma_f32_16x16x32_bf16 v[148:151], v[100:103], v[80:83], v[148:151]
  ds_read_b64_tr_b16 v[54:55], v12 offset:512
  v_mfma_f32_16x16x32_bf16 v[152:155], v[100:103], v[84:87], v[152:155]
  ds_read_b64_tr_b16 v[56:57], v13 offset:0
  v_mfma_f32_16x16x32_bf16 v[156:159], v[100:103], v[88:91], v[156:159]
  ds_read_b64_tr_b16 v[58:59], v13 offset:512
  v_mfma_f32_16x16x32_bf16 v[160:163], v[104:107], v[76:79], v[160:163]
  ds_read_b64_tr_b16 v[60:61], v12 offset:8192
  v_mfma_f32_16x16x32_bf16 v[164:167], v[104:107], v[80:83], v[164:167]
  ds_read_b64_tr_b16 v[62:63], v12 offset:8704
  v_mfma_f32_16x16x32_bf16 v[168:171], v[104:107], v[84:87], v[168:171]
  ds_read_b64_tr_b16 v[64:65], v13 offset:8192
  v_mfma_f32_16x16x32_bf16 v[172:175], v[104:107], v[88:91], v[172:175]
  ds_read_b64_tr_b16 v[66:67], v13 offset:8704
  v_mfma_f32_16x16x32_bf16 v[228:231], v[104:107], v[92:95], v[228:231]
  ds_read_b64_tr_b16 v[68:69], v12 offset:16384
  v_mfma_f32_16x16x32_bf16 v[176:179], v[108:111], v[76:79], v[176:179]
  ds_read_b64_tr_b16 v[70:71], v12 offset:16896
  v_mfma_f32_16x16x32_bf16 v[180:183], v[108:111], v[80:83], v[180:183]
  ds_read_b64_tr_b16 v[72:73], v13 offset:16384
  v_mfma_f32_16x16x32_bf16 v[184:187], v[108:111], v[84:87], v[184:187]
  ds_read_b64_tr_b16 v[74:75], v13 offset:16896
  v_mfma_f32_16x16x32_bf16 v[188:191], v[108:111], v[88:91], v[188:191]
  s_cmp_lg_u32 s79, 0
  s_nop 0
  v_mfma_f32_16x16x32_bf16 v[192:195], v[76:79], v[112:115], v[192:195]
  v_mfma_f32_16x16x32_bf16 v[196:199], v[80:83], v[112:115], v[196:199]
  v_mfma_f32_16x16x32_bf16 v[200:203], v[84:87], v[112:115], v[200:203]
  v_mfma_f32_16x16x32_bf16 v[204:207], v[88:91], v[112:115], v[204:207]
  v_mfma_f32_16x16x32_bf16 v[232:235], v[92:95], v[112:115], v[232:235]
  v_mfma_f32_16x16x32_bf16 v[208:211], v[76:79], v[116:119], v[208:211]
  v_mfma_f32_16x16x32_bf16 v[212:215], v[80:83], v[116:119], v[212:215]
  v_mfma_f32_16x16x32_bf16 v[216:219], v[84:87], v[116:119], v[216:219]
  v_mfma_f32_16x16x32_bf16 v[220:223], v[88:91], v[116:119], v[220:223]
  s_waitcnt lgkmcnt(0)
  s_cbranch_scc1 L_attn_loop
L_attn_exit:
  ds_read2_b32 v[66:67], v23 offset0:0 offset1:160
  ds_read2_b32 v[68:69], v23 offset0:16 offset1:176
  ds_read2_b32 v[70:71], v23 offset0:32 offset1:192
  ds_read2_b32 v[72:73], v23 offset0:48 offset1:208
  ds_read2_b32 v[74:75], v23 offset0:64 offset1:224
  ds_read2_b32 v[76:77], v25 offset0:0 offset1:16
  ds_read2_b32 v[80:81], v26 offset0:0 offset1:16
  ds_read2_b32 v[78:79], v25 offset0:32 offset1:48
  ds_read2_b32 v[82:83], v26 offset0:32 offset1:48
  ds_write_b128 v16, v[224:227] offset:0
  ds_write_b128 v16, v[228:231] offset:2048
  ds_write_b128 v16, v[232:235] offset:4096
  s_cmp_eq_u32 s71, 1
  s_cbranch_scc1 L_attn_nop3
  ds_write_b128 v16, v[172:175] offset:8192
  ds_write_b128 v16, v[188:191] offset:9216
  ds_write_b128 v16, v[204:207] offset:10240
  ds_write_b128 v16, v[220:223] offset:11264
L_attn_nop3:
  ds_read_b128 v[84:87], v24 offset:0
  ds_read_b128 v[104:107], v24 offset:640
  ds_read_b128 v[88:91], v24 offset:64
  ds_read_b128 v[108:111], v24 offset:704
  ds_read_b128 v[92:95], v24 offset:128
  ds_read_b128 v[112:115], v24 offset:768
  ds_read_b128 v[96:99], v24 offset:192
  ds_read_b128 v[116:119], v24 offset:832
  ds_read_b128 v[100:103], v24 offset:256
  ds_read_b128 v[120:123], v24 offset:896
  s_waitcnt lgkmcnt(10)
  s_barrier
  ds_read_b128 v[48:51], v19 offset:0
  ds_read_b128 v[52:55], v20 offset:1024
  ds_read_b128 v[56:59], v19 offset:2048
  ds_read_b128 v[60:63], v20 offset:3072
  ds_read_b32 v64, v21 offset:4096
  ds_read_b32 v65, v22 offset:5120
  ds_read_b128 v[32:35], v17 offset:2048
  ds_read_b128 v[36:39], v18 offset:3072
  ds_read_b128 v[40:43], v17 offset:4096
  ds_read_b128 v[44:47], v18 offset:5120
  v_mul_f32 v69, 0x3e8293ee, v69
  v_mul_f32 v71, 0x3e8293ee, v71
  v_mul_f32 v73, 0x3e8293ee, v73
  v_mul_f32 v75, 0x3e8293ee, v75
  v_mul_f32 v76, v76, v69
  v_mul_f32 v80, v80, v69
  v_mul_f32 v77, v77, v71
  v_mul_f32 v81, v81, v71
  v_mul_f32 v78, v78, v73
  v_mul_f32 v82, v82, v73
  v_mul_f32 v79, v79, v75
  v_mul_f32 v83, v83, v75
  s_waitcnt lgkmcnt(6)
  v_pk_fma_f32 v[128:129], v[48:49], v[68:69], v[128:129] op_sel:[0,0,0] op_sel_hi:[1,0,1] neg_lo:[0,1,0] neg_hi:[0,1,0]
  v_pk_fma_f32 v[130:131], v[50:51], v[68:69], v[130:131] op_sel:[0,0,0] op_sel_hi:[1,0,1] neg_lo:[0,1,0] neg_hi:[0,1,0]
  v_pk_fma_f32 v[144:145], v[52:53], v[68:69], v[144:145] op_sel:[0,0,0] op_sel_hi:[1,0,1] neg_lo:[0,1,0] neg_hi:[0,1,0]
  v_pk_fma_f32 v[146:147], v[54:55], v[68:69], v[146:147] op_sel:[0,0,0] op_sel_hi:[1,0,1] neg_lo:[0,1,0] neg_hi:[0,1,0]
  v_cvt_pk_bf16_f32 v128, v128, v129
  v_cvt_pk_bf16_f32 v129, v130, v131
  v_cvt_pk_bf16_f32 v130, v144, v145
  v_cvt_pk_bf16_f32 v131, v146, v147
  v_pk_fma_f32 v[160:161], v[56:57], v[68:69], v[160:161] op_sel:[0,0,0] op_sel_hi:[1,0,1] neg_lo:[0,1,0] neg_hi:[0,1,0]
  v_pk_fma_f32 v[162:163], v[58:59], v[68:69], v[162:163] op_sel:[0,0,0] op_sel_hi:[1,0,1] neg_lo:[0,1,0] neg_hi:[0,1,0]
  v_pk_fma_f32 v[176:177], v[60:61], v[68:69], v[176:177] op_sel:[0,0,0] op_sel_hi:[1,0,1] neg_lo:[0,1,0] neg_hi:[0,1,0]
  v_pk_fma_f32 v[178:179], v[62:63], v[68:69], v[178:179] op_sel:[0,0,0] op_sel_hi:[1,0,1] neg_lo:[0,1,0] neg_hi:[0,1,0]
  v_cvt_pk_bf16_f32 v160, v160, v161
  v_cvt_pk_bf16_f32 v161, v162, v163
  v_cvt_pk_bf16_f32 v162, v176, v177
  v_cvt_pk_bf16_f32 v163, v178, v179
  v_pk_fma_f32 v[132:133], v[48:49], v[70:71], v[132:133] op_sel:[0,0,0] op_sel_hi:[1,0,1] neg_lo:[0,1,0] neg_hi:[0,1,0]
  v_pk_fma_f32 v[134:135], v[50:51], v[70:71], v[134:135] op_sel:[0,0,0] op_sel_hi:[1,0,1] neg_lo:[0,1,0] neg_hi:[0,1,0]
  v_pk_fma_f32 v[148:149], v[52:53], v[70:71], v[148:149] op_sel:[0,0,0] op_sel_hi:[1,0,1] neg_lo:[0,1,0] neg_hi:[0,1,0]
  v_pk_fma_f32 v[150:151], v[54:55], v[70:71], v[150:151] op_sel:[0,0,0] op_sel_hi:[1,0,1] neg_lo:[0,1,0] neg_hi:[0,1,0]
  v_cvt_pk_bf16_f32 v132, v132, v133
  v_cvt_pk_bf16_f32 v133, v134, v135
  v_cvt_pk_bf16_f32 v134, v148, v149
  v_cvt_pk_bf16_f32 v135, v150, v151
  v_pk_fma_f32 v[164:165], v[56:57], v[70:71], v[164:165] op_sel:[0,0,0] op_sel_hi:[1,0,1] neg_lo:[0,1,0] neg_hi:[0,1,0]
  v_pk_fma_f32 v[166:167], v[58:59], v[70:71], v[166:167] op_sel:[0,0,0] op_sel_hi:[1,0,1] neg_lo:[0,1,0] neg_hi:[0,1,0]
  v_pk_fma_f32 v[180:181], v[60:61], v[70:71], v[180:181] op_sel:[0,0,0] op_sel_hi:[1,0,1] neg_lo:[0,1,0] neg_hi:[0,1,0]
  v_pk_fma_f32 v[182:183], v[62:63], v[70:71], v[182:183] op_sel:[0,0,0] op_sel_hi:[1,0,1] neg_lo:[0,1,0] neg_hi:[0,1,0]
  v_cvt_pk_bf16_f32 v164, v164, v165
  v_cvt_pk_bf16_f32 v165, v166, v167
  v_cvt_pk_bf16_f32 v166, v180, v181
  v_cvt_pk_bf16_f32 v167, v182, v183
  v_mfma_f32_16x16x32_bf16 v[144:147], v[160:163], v[128:131], 0
  v_pk_fma_f32 v[136:137], v[48:49], v[72:73], v[136:137] op_sel:[0,0,0] op_sel_hi:[1,0,1] neg_lo:[0,1,0] neg_hi:[0,1,0]
  v_pk_fma_f32 v[138:139], v[50:51], v[72:73], v[138:139] op_sel:[0,0,0] op_sel_hi:[1,0,1] neg_lo:[0,1,0] neg_hi:[0,1,0]
  v_pk_fma_f32 v[152:153], v[52:53], v[72:73], v[152:153] op_sel:[0,0,0] op_sel_hi:[1,0,1] neg_lo:[0,1,0] neg_hi:[0,1,0]
  v_pk_fma_f32 v[154:155], v[54:55], v[72:73], v[154:155] op_sel:[0,0,0] op_sel_hi:[1,0,1] neg_lo:[0,1,0] neg_hi:[0,1,0]
  v_cvt_pk_bf16_f32 v136, v136, v137
  v_cvt_pk_bf16_f32 v137, v138, v139
  v_cvt_pk_bf16_f32 v138, v152, v153
  v_cvt_pk_bf16_f32 v139, v154, v155
  v_pk_fma_f32 v[168:169], v[56:57], v[72:73], v[168:169] op_sel:[0,0,0] op_sel_hi:[1,0,1] neg_lo:[0,1,0] neg_hi:[0,1,0]
  v_pk_fma_f32 v[170:171], v[58:59], v[72:73], v[170:171] op_sel:[0,0,0] op_sel_hi:[1,0,1] neg_lo:[0,1,0] neg_hi:[0,1,0]
  v_pk_fma_f32 v[184:185], v[60:61], v[72:73], v[184:185] op_sel:[0,0,0] op_sel_hi:[1,0,1] neg_lo:[0,1,0] neg_hi:[0,1,0]
  v_pk_fma_f32 v[186:187], v[62:63], v[72:73], v[186:187] op_sel:[0,0,0] op_sel_hi:[1,0,1] neg_lo:[0,1,0] neg_hi:[0,1,0]
  v_cvt_pk_bf16_f32 v168, v168, v169
  v_cvt_pk_bf16_f32 v169, v170, v171
  v_cvt_pk_bf16_f32 v170, v184, v185
  v_cvt_pk_bf16_f32 v171, v186, v187
  v_mfma_f32_16x16x32_bf16 v[148:151], v[164:167], v[132:135], 0
  v_mfma_f32_16x16x32_bf16 v[180:183], v[160:163], v[132:135], 0
  v_pk_fma_f32 v[140:141], v[48:49], v[74:75], v[140:141] op_sel:[0,0,0] op_sel_hi:[1,0,1] neg_lo:[0,1,0] neg_hi:[0,1,0]
  v_pk_fma_f32 v[142:143], v[50:51], v[74:75], v[142:143] op_sel:[0,0,0] op_sel_hi:[1,0,1] neg_lo:[0,1,0] neg_hi:[0,1,0]
  v_pk_fma_f32 v[156:157], v[52:53], v[74:75], v[156:157] op_sel:[0,0,0] op_sel_hi:[1,0,1] neg_lo:[0,1,0] neg_hi:[0,1,0]
  v_pk_fma_f32 v[158:159], v[54:55], v[74:75], v[158:159] op_sel:[0,0,0] op_sel_hi:[1,0,1] neg_lo:[0,1,0] neg_hi:[0,1,0]
  v_cvt_pk_bf16_f32 v140, v140, v141
  v_cvt_pk_bf16_f32 v141, v142, v143
  v_cvt_pk_bf16_f32 v142, v156, v157
  v_cvt_pk_bf16_f32 v143, v158, v159
  v_pk_fma_f32 v[172:173], v[56:57], v[74:75], v[172:173] op_sel:[0,0,0] op_sel_hi:[1,0,1] neg_lo:[0,1,0] neg_hi:[0,1,0]
  v_pk_fma_f32 v[174:175], v[58:59], v[74:75], v[174:175] op_sel:[0,0,0] op_sel_hi:[1,0,1] neg_lo:[0,1,0] neg_hi:[0,1,0]
  v_pk_fma_f32 v[188:189], v[60:61], v[74:75], v[188:189] op_sel:[0,0,0] op_sel_hi:[1,0,1] neg_lo:[0,1,0] neg_hi:[0,1,0]
  v_pk_fma_f32 v[190:191], v[62:63], v[74:75], v[190:191] op_sel:[0,0,0] op_sel_hi:[1,0,1] neg_lo:[0,1,0] neg_hi:[0,1,0]
  v_cvt_pk_bf16_f32 v172, v172, v173
  v_cvt_pk_bf16_f32 v173, v174, v175
  v_cvt_pk_bf16_f32 v174, v188, v189
  v_cvt_pk_bf16_f32 v175, v190, v191
  s_waitcnt lgkmcnt(0)
  v_pk_fma_f32 v[32:33], v[56:57], v[66:67], v[32:33] op_sel:[0,0,0] op_sel_hi:[1,0,1] neg_lo:[0,1,0] neg_hi:[0,1,0]
  v_pk_fma_f32 v[34:35], v[58:59], v[66:67], v[34:35] op_sel:[0,0,0] op_sel_hi:[1,0,1] neg_lo:[0,1,0] neg_hi:[0,1,0]
  v_pk_fma_f32 v[36:37], v[60:61], v[66:67], v[36:37] op_sel:[0,0,0] op_sel_hi:[1,0,1] neg_lo:[0,1,0] neg_hi:[0,1,0]
  v_pk_fma_f32 v[38:39], v[62:63], v[66:67], v[38:39] op_sel:[0,0,0] op_sel_hi:[1,0,1] neg_lo:[0,1,0] neg_hi:[0,1,0]
  v_cvt_pk_bf16_f32 v32, v32, v33
  v_cvt_pk_bf16_f32 v33, v34, v35
  v_cvt_pk_bf16_f32 v34, v36, v37
  v_cvt_pk_bf16_f32 v35, v38, v39
  v_mfma_f32_16x16x32_bf16 v[152:155], v[168:171], v[136:139], 0
  v_mfma_f32_16x16x32_bf16 v[184:187], v[164:167], v[136:139], 0
  v_mfma_f32_16x16x32_bf16 v[156:159], v[172:175], v[140:143], 0
  v_mfma_f32_16x16x32_bf16 v[188:191], v[168:171], v[140:143], 0
  v_mfma_f32_16x16x32_bf16 v[176:179], v[32:35], v[128:131], 0
  v_pk_fma_f32 v[40:41], v[84:85], v[64:65], v[40:41] op_sel:[0,0,0] op_sel_hi:[1,0,1] neg_lo:[1,0,0] neg_hi:[1,0,0]
  v_pk_fma_f32 v[42:43], v[86:87], v[64:65], v[42:43] op_sel:[0,0,0] op_sel_hi:[1,0,1] neg_lo:[1,0,0] neg_hi:[1,0,0]
  v_pk_mul_f32 v[40:41], v[40:41], v[104:105]
  v_pk_mul_f32 v[42:43], v[42:43], v[106:107]
  v_cvt_pk_bf16_f32 v4, v40, v41
  v_cvt_pk_bf16_f32 v5, v42, v43
  v_pk_fma_f32 v[192:193], v[88:89], v[64:65], v[192:193] op_sel:[0,0,0] op_sel_hi:[1,0,1] neg_lo:[1,0,0] neg_hi:[1,0,0]
  v_pk_fma_f32 v[194:195], v[90:91], v[64:65], v[194:195] op_sel:[0,0,0] op_sel_hi:[1,0,1] neg_lo:[1,0,0] neg_hi:[1,0,0]
  v_pk_mul_f32 v[192:193], v[192:193], v[108:109]
  v_pk_mul_f32 v[194:195], v[194:195], v[110:111]
  v_cvt_pk_bf16_f32 v6, v192, v193
  v_cvt_pk_bf16_f32 v7, v194, v195
  v_pk_fma_f32 v[196:197], v[92:93], v[64:65], v[196:197] op_sel:[0,0,0] op_sel_hi:[1,0,1] neg_lo:[1,0,0] neg_hi:[1,0,0]
  v_pk_fma_f32 v[198:199], v[94:95], v[64:65], v[198:199] op_sel:[0,0,0] op_sel_hi:[1,0,1] neg_lo:[1,0,0] neg_hi:[1,0,0]
  v_pk_mul_f32 v[196:197], v[196:197], v[112:113]
  v_pk_mul_f32 v[198:199], v[198:199], v[114:115]
  v_cvt_pk_bf16_f32 v8, v196, v197
  v_cvt_pk_bf16_f32 v9, v198, v199
  v_pk_fma_f32 v[200:201], v[96:97], v[64:65], v[200:201] op_sel:[0,0,0] op_sel_hi:[1,0,1] neg_lo:[1,0,0] neg_hi:[1,0,0]
  v_pk_fma_f32 v[202:203], v[98:99], v[64:65], v[202:203] op_sel:[0,0,0] op_sel_hi:[1,0,1] neg_lo:[1,0,0] neg_hi:[1,0,0]
  v_pk_mul_f32 v[200:201], v[200:201], v[116:117]
  v_pk_mul_f32 v[202:203], v[202:203], v[118:119]
  v_cvt_pk_bf16_f32 v10, v200, v201
  v_cvt_pk_bf16_f32 v11, v202, v203
  v_pk_fma_f32 v[204:205], v[100:101], v[64:65], v[204:205] op_sel:[0,0,0] op_sel_hi:[1,0,1] neg_lo:[1,0,0] neg_hi:[1,0,0]
  v_pk_fma_f32 v[206:207], v[102:103], v[64:65], v[206:207] op_sel:[0,0,0] op_sel_hi:[1,0,1] neg_lo:[1,0,0] neg_hi:[1,0,0]
  v_pk_mul_f32 v[204:205], v[204:205], v[120:121]
  v_pk_mul_f32 v[206:207], v[206:207], v[122:123]
  v_cvt_pk_bf16_f32 v12, v204, v205
  v_cvt_pk_bf16_f32 v13, v206, v207
  v_pk_fma_f32 v[44:45], v[84:85], v[64:65], v[44:45] op_sel:[0,1,0] op_sel_hi:[1,1,1] neg_lo:[1,0,0] neg_hi:[1,0,0]
  v_pk_fma_f32 v[46:47], v[86:87], v[64:65], v[46:47] op_sel:[0,1,0] op_sel_hi:[1,1,1] neg_lo:[1,0,0] neg_hi:[1,0,0]
  v_pk_mul_f32 v[44:45], v[44:45], v[104:105]
  v_pk_mul_f32 v[46:47], v[46:47], v[106:107]
  v_cvt_pk_bf16_f32 v224, v44, v45
  v_cvt_pk_bf16_f32 v225, v46, v47
  v_pk_fma_f32 v[208:209], v[88:89], v[64:65], v[208:209] op_sel:[0,1,0] op_sel_hi:[1,1,1] neg_lo:[1,0,0] neg_hi:[1,0,0]
  v_pk_fma_f32 v[210:211], v[90:91], v[64:65], v[210:211] op_sel:[0,1,0] op_sel_hi:[1,1,1] neg_lo:[1,0,0] neg_hi:[1,0,0]
  v_pk_mul_f32 v[208:209], v[208:209], v[108:109]
  v_pk_mul_f32 v[210:211], v[210:211], v[110:111]
  v_cvt_pk_bf16_f32 v226, v208, v209
  v_cvt_pk_bf16_f32 v227, v210, v211
  v_pk_fma_f32 v[212:213], v[92:93], v[64:65], v[212:213] op_sel:[0,1,0] op_sel_hi:[1,1,1] neg_lo:[1,0,0] neg_hi:[1,0,0]
  v_pk_fma_f32 v[214:215], v[94:95], v[64:65], v[214:215] op_sel:[0,1,0] op_sel_hi:[1,1,1] neg_lo:[1,0,0] neg_hi:[1,0,0]
  v_pk_mul_f32 v[212:213], v[212:213], v[112:113]
  v_pk_mul_f32 v[214:215], v[214:215], v[114:115]
  v_cvt_pk_bf16_f32 v228, v212, v213
  v_cvt_pk_bf16_f32 v229, v214, v215
  v_pk_fma_f32 v[216:217], v[96:97], v[64:65], v[216:217] op_sel:[0,1,0] op_sel_hi:[1,1,1] neg_lo:[1,0,0] neg_hi:[1,0,0]
  v_pk_fma_f32 v[218:219], v[98:99], v[64:65], v[218:219] op_sel:[0,1,0] op_sel_hi:[1,1,1] neg_lo:[1,0,0] neg_hi:[1,0,0]
  v_pk_mul_f32 v[216:217], v[216:217], v[116:117]
  v_pk_mul_f32 v[218:219], v[218:219], v[118:119]
  v_cvt_pk_bf16_f32 v230, v216, v217
  v_cvt_pk_bf16_f32 v231, v218, v219
  v_pk_fma_f32 v[220:221], v[100:101], v[64:65], v[220:221] op_sel:[0,1,0] op_sel_hi:[1,1,1] neg_lo:[1,0,0] neg_hi:[1,0,0]
  v_pk_fma_f32 v[222:223], v[102:103], v[64:65], v[222:223] op_sel:[0,1,0] op_sel_hi:[1,1,1] neg_lo:[1,0,0] neg_hi:[1,0,0]
  v_pk_mul_f32 v[220:221], v[220:221], v[120:121]
  v_pk_mul_f32 v[222:223], v[222:223], v[122:123]
  v_cvt_pk_bf16_f32 v232, v220, v221
  v_cvt_pk_bf16_f32 v233, v222, v223
  v_cndmask_b32 v148, v148, v149, s[48:49]
  v_cndmask_b32 v180, v180, v181, s[48:49]
  v_cndmask_b32 v150, v150, v151, s[48:49]
  v_cndmask_b32 v182, v182, v183, s[48:49]
  v_cndmask_b32 v36, v148, v180, s[50:51]
  v_cndmask_b32 v37, v150, v182, s[52:53]
  v_mul_f32 v36, v36, v77
  v_mul_f32 v37, v37, v81
  v_cndmask_b32 v152, v152, v153, s[48:49]
  v_cndmask_b32 v184, v184, v185, s[48:49]
  v_cndmask_b32 v154, v154, v155, s[48:49]
  v_cndmask_b32 v186, v186, v187, s[48:49]
  v_cndmask_b32 v40, v152, v184, s[50:51]
  v_cndmask_b32 v41, v154, v186, s[52:53]
  v_mul_f32 v40, v40, v78
  v_mul_f32 v41, v41, v82
  v_cndmask_b32 v156, v156, v157, s[48:49]
  v_cndmask_b32 v188, v188, v189, s[48:49]
  v_cndmask_b32 v158, v158, v159, s[48:49]
  v_cndmask_b32 v190, v190, v191, s[48:49]
  v_cndmask_b32 v44, v156, v188, s[50:51]
  v_cndmask_b32 v45, v158, v190, s[52:53]
  v_mul_f32 v44, v44, v79
  v_mul_f32 v45, v45, v83
  v_cndmask_b32 v144, v144, v145, s[48:49]
  v_cndmask_b32 v176, v176, v177, s[48:49]
  v_cndmask_b32 v146, v146, v147, s[48:49]
  v_cndmask_b32 v178, v178, v179, s[48:49]
  v_cndmask_b32 v32, v144, v176, s[50:51]
  v_cndmask_b32 v33, v146, v178, s[52:53]
  v_mul_f32 v32, v32, v76
  v_mul_f32 v33, v33, v80
  v_mov_b32 v48, 0xceabfb8f
  v_cndmask_b32 v32, v32, v48, s[54:55]
  v_cndmask_b32 v33, v33, v48, s[14:15]
  v_max_f32 v34, v32, v33
  v_max_f32 v38, v36, v37
  v_max_f32 v42, v40, v41
  v_max_f32 v46, v44, v45
  v_mov_b32 v35, v34
  v_mov_b32 v39, v38
  v_mov_b32 v43, v42
  v_mov_b32 v47, v46
  v_permlane32_swap_b32 v34, v35
  v_permlane32_swap_b32 v38, v39
  v_permlane32_swap_b32 v42, v43
  v_permlane32_swap_b32 v46, v47
  v_max_f32 v34, v34, v35
  v_max_f32 v38, v38, v39
  v_max_f32 v42, v42, v43
  v_max_f32 v46, v46, v47
  v_mov_b32 v35, v34
  v_mov_b32 v39, v38
  v_mov_b32 v43, v42
  v_mov_b32 v47, v46
  v_permlane16_swap_b32 v34, v35
  v_permlane16_swap_b32 v38, v39
  v_permlane16_swap_b32 v42, v43
  v_permlane16_swap_b32 v46, v47
  v_max_f32 v34, v34, v35
  v_max_f32 v38, v38, v39
  v_max_f32 v42, v42, v43
  v_max_f32 v46, v46, v47
  v_sub_f32 v32, v32, v34
  v_sub_f32 v33, v33, v34
  v_sub_f32 v36, v36, v38
  v_sub_f32 v37, v37, v38
  v_sub_f32 v40, v40, v42
  v_sub_f32 v41, v41, v42
  v_sub_f32 v44, v44, v46
  v_sub_f32 v45, v45, v46
  v_exp_f32 v32, v32
  v_exp_f32 v33, v33
  v_exp_f32 v36, v36
  v_exp_f32 v37, v37
  v_exp_f32 v40, v40
  v_exp_f32 v41, v41
  v_exp_f32 v44, v44
  v_exp_f32 v45, v45
  v_cvt_pk_bf16_f32 v32, v32, v32
  v_cvt_pk_bf16_f32 v33, v33, v33
  v_and_b32 v128, v32, v27
  v_and_b32 v129, v33, v29
  v_and_b32 v130, v32, v28
  v_and_b32 v131, v33, v30
  v_cvt_pk_bf16_f32 v36, v36, v36
  v_cvt_pk_bf16_f32 v37, v37, v37
  v_and_b32 v132, v36, v27
  v_and_b32 v133, v37, v29
  v_and_b32 v134, v36, v28
  v_and_b32 v135, v37, v30
  v_mfma_f32_16x16x32_bf16 v[144:147], v[236:239], v[128:131], 0
  v_mfma_f32_16x16x32_bf16 v[192:195], v[4:7], v[128:131], 0
  v_mfma_f32_16x16x32_bf16 v[208:211], v[224:227], v[128:131], 0
  v_cvt_pk_bf16_f32 v40, v40, v40
  v_cvt_pk_bf16_f32 v41, v41, v41
  v_and_b32 v136, v40, v27
  v_and_b32 v137, v41, v29
  v_and_b32 v138, v40, v28
  v_and_b32 v139, v41, v30
  v_mfma_f32_16x16x32_bf16 v[148:151], v[236:239], v[132:135], 0
  v_mfma_f32_16x16x32_bf16 v[196:199], v[6:9], v[132:135], 0
  v_mfma_f32_16x16x32_bf16 v[212:215], v[226:229], v[132:135], 0
  v_cvt_pk_bf16_f32 v44, v44, v44
  v_cvt_pk_bf16_f32 v45, v45, v45
  v_and_b32 v140, v44, v27
  v_and_b32 v141, v45, v29
  v_and_b32 v142, v44, v28
  v_and_b32 v143, v45, v30
  v_mfma_f32_16x16x32_bf16 v[152:155], v[236:239], v[136:139], 0
  v_mfma_f32_16x16x32_bf16 v[200:203], v[8:11], v[136:139], 0
  v_mfma_f32_16x16x32_bf16 v[216:219], v[228:231], v[136:139], 0
  v_mfma_f32_16x16x32_bf16 v[156:159], v[236:239], v[140:143], 0
  v_mfma_f32_16x16x32_bf16 v[204:207], v[10:13], v[140:143], 0
  v_mfma_f32_16x16x32_bf16 v[220:223], v[230:233], v[140:143], 0
  v_rcp_f32 v144, v144
  s_mov_b32 s3, 0
  v_pk_mul_f32 v[192:193], v[192:193], v[144:145] op_sel_hi:[1,0]
  v_pk_mul_f32 v[194:195], v[194:195], v[144:145] op_sel_hi:[1,0]
  v_pk_mul_f32 v[208:209], v[208:209], v[144:145] op_sel_hi:[1,0]
  v_pk_mul_f32 v[210:211], v[210:211], v[144:145] op_sel_hi:[1,0]
  v_cvt_pk_bf16_f32 v48, v192, v193
  v_cvt_pk_bf16_f32 v49, v194, v195
  v_cvt_pk_bf16_f32 v50, v208, v209
  v_cvt_pk_bf16_f32 v51, v210, v211
  s_nop 1
  v_permlane16_swap_b32 v48, v50
  v_permlane16_swap_b32 v49, v51
  buffer_store_dwordx4 v[48:51], v31, s[44:47], s3 offen sc1
  v_rcp_f32 v148, v148
  s_mov_b32 s3, 32768
  v_pk_mul_f32 v[196:197], v[196:197], v[148:149] op_sel_hi:[1,0]
  v_pk_mul_f32 v[198:199], v[198:199], v[148:149] op_sel_hi:[1,0]
  v_pk_mul_f32 v[212:213], v[212:213], v[148:149] op_sel_hi:[1,0]
  v_pk_mul_f32 v[214:215], v[214:215], v[148:149] op_sel_hi:[1,0]
  v_cvt_pk_bf16_f32 v52, v196, v197
  v_cvt_pk_bf16_f32 v53, v198, v199
  v_cvt_pk_bf16_f32 v54, v212, v213
  v_cvt_pk_bf16_f32 v55, v214, v215
  s_nop 1
  v_permlane16_swap_b32 v52, v54
  v_permlane16_swap_b32 v53, v55
  buffer_store_dwordx4 v[52:55], v31, s[44:47], s3 offen sc1
  v_rcp_f32 v152, v152
  s_mov_b32 s3, 65536
  v_pk_mul_f32 v[200:201], v[200:201], v[152:153] op_sel_hi:[1,0]
  v_pk_mul_f32 v[202:203], v[202:203], v[152:153] op_sel_hi:[1,0]
  v_pk_mul_f32 v[216:217], v[216:217], v[152:153] op_sel_hi:[1,0]
  v_pk_mul_f32 v[218:219], v[218:219], v[152:153] op_sel_hi:[1,0]
  v_cvt_pk_bf16_f32 v56, v200, v201
  v_cvt_pk_bf16_f32 v57, v202, v203
  v_cvt_pk_bf16_f32 v58, v216, v217
  v_cvt_pk_bf16_f32 v59, v218, v219
  s_nop 1
  v_permlane16_swap_b32 v56, v58
  v_permlane16_swap_b32 v57, v59
  buffer_store_dwordx4 v[56:59], v31, s[44:47], s3 offen sc1
  v_rcp_f32 v156, v156
  s_mov_b32 s3, 98304
  v_pk_mul_f32 v[204:205], v[204:205], v[156:157] op_sel_hi:[1,0]
  v_pk_mul_f32 v[206:207], v[206:207], v[156:157] op_sel_hi:[1,0]
  v_pk_mul_f32 v[220:221], v[220:221], v[156:157] op_sel_hi:[1,0]
  v_pk_mul_f32 v[222:223], v[222:223], v[156:157] op_sel_hi:[1,0]
  v_cvt_pk_bf16_f32 v60, v204, v205
  v_cvt_pk_bf16_f32 v61, v206, v207
  v_cvt_pk_bf16_f32 v62, v220, v221
  v_cvt_pk_bf16_f32 v63, v222, v223
  s_nop 1
  v_permlane16_swap_b32 v60, v62
  v_permlane16_swap_b32 v61, v63
  buffer_store_dwordx4 v[60:63], v31, s[44:47], s3 offen sc1
  s_waitcnt vmcnt(0) lgkmcnt(0)
  s_barrier
  s_add_u32 s97, s97, 1
  s_branch L_wo_body
.section .rodata,"a"
.p2align 6
.amdhsa_kernel interleave_layers__sliding_local_dilated__dense_activation_gelu__prompt_kernel
  .amdhsa_next_free_vgpr 256
  .amdhsa_next_free_sgpr 102
  .amdhsa_accum_offset 256
  .amdhsa_group_segment_fixed_size 0
  .amdhsa_kernarg_size 88
  .amdhsa_user_sgpr_count 2
  .amdhsa_user_sgpr_kernarg_segment_ptr 1
  .amdhsa_system_sgpr_workgroup_id_x 1
  .amdhsa_float_denorm_mode_32 3
  .amdhsa_float_denorm_mode_16_64 3
.end_amdhsa_kernel
.text
L_attn_c1:
L_wo_c0:
L_wo_body:
  s_cmp_ge_u32 s2, 256
  s_cbranch_scc1 L_wo_end
  v_lshrrev_b32 v2, 6, v0
  v_and_b32 v1, 63, v0
  v_readfirstlane_b32 s70, v2
  s_and_b32 s3, s2, 7
  s_lshr_b32 s99, s2, 3
  s_and_b32 s5, s3, 3
  s_lshl_b32 s5, s5, 2
  s_and_b32 s6, s99, 3
  s_add_u32 s68, s5, s6
  s_lshr_b32 s5, s3, 2
  s_lshr_b32 s78, s99, 2
  s_lshl1_add_u32 s69, s78, s5
  s_add_u32 s3, s68, s78
  s_lshl_b32 s3, s3, 3
  s_lshl_b32 s85, 0xffff02, s3
  s_sub_u32 s3, 0, s3
  s_lshr_b32 s3, 0xffff02, s3
  s_or_b32 s85, s85, s3
  s_cmp_lt_u32 s70, 4
  s_cbranch_scc1 L_wo_compute
L_wo_loader:
  v_and_b32 v2, 3, v1
  v_lshlrev_b32 v2, 3, v2
  v_bfe_i32 v16, s85, v2, 8
  s_and_b32 s3, s68, 3
  s_mul_i32 s4, s3, 4
  v_add3_u32 v3, v16, v1, s4
  v_and_b32 v3, 15, v3
  v_lshlrev_b32 v16, 17, v3
  s_add_u32 s9, s70, s68
  s_and_b32 s9, s9, 3
  s_lshl_b32 s77, s9, 11
  v_and_b32 v10, 7, v1
  v_lshrrev_b32 v3, 3, v1
  s_lshl_b32 s10, s9, 4
  v_add_u32 v3, s10, v3
  v_mul_u32_u24 v3, 2048, v3
  v_lshrrev_b32 v2, 3, v1
  v_and_b32 v2, 2, v2
  v_xor_b32 v2, v2, v10
  s_lshl_b32 s10, s69, 7
  v_add_u32 v3, s10, v3
  v_lshl_add_u32 v8, v2, 4, v3
  v_xor_b32 v2, 4, v2
  v_add_u32 v3, 16384, v3
  v_lshl_add_u32 v9, v2, 4, v3
  s_mov_b32 s40, s20
  s_and_b32 s41, s21, 0xffff
  s_mov_b32 s42, 2097152
  s_mov_b32 s43, 0x00020000
  s_add_u32 s3, s96, s70
  s_cmp_lg_u32 s3, 4
  s_cbranch_scc1 L_wo_chk
  s_load_dwordx2 s[64:65], s[0:1], 72
  s_mov_b32 s79, 0x100000
  s_waitcnt lgkmcnt(0)
  s_and_b32 s65, s65, 0xffff
  s_mov_b32 s66, 256
  s_mov_b32 s67, 0x00020000
  v_lshlrev_b32 v2, 2, v1
L_wo_chkl:
  buffer_load_dword v12, v2, s[64:67], 0 offen sc1
  s_sub_u32 s79, s79, 1
  s_cbranch_scc1 L_wo_chk
  s_waitcnt vmcnt(0)
  v_cmp_ne_u32 vcc, 0x01010101, v12
  s_cbranch_vccnz L_wo_chkl
L_wo_chk:
  v_readlane_b32 s74, v16, 0
  s_add_u32 m0, s77, 131072
  s_add_u32 s4, s74, 0
  buffer_load_dwordx4 v8, s[40:43], s4 offen lds
  s_add_u32 m0, s77, 132096
  s_nop 0
  buffer_load_dwordx4 v9, s[40:43], s4 offen lds
  v_readlane_b32 s74, v16, 1
  s_add_u32 m0, s77, 139264
  s_add_u32 s4, s74, 0
  buffer_load_dwordx4 v8, s[40:43], s4 offen lds
  s_add_u32 m0, s77, 140288
  s_nop 0
  buffer_load_dwordx4 v9, s[40:43], s4 offen lds
  v_readlane_b32 s74, v16, 2
  s_add_u32 m0, s77, 147456
  s_add_u32 s4, s74, 0
  buffer_load_dwordx4 v8, s[40:43], s4 offen lds
  s_add_u32 m0, s77, 148480
  s_nop 0
  buffer_load_dwordx4 v9, s[40:43], s4 offen lds
  v_readlane_b32 s74, v16, 3
  s_add_u32 m0, s77, 155648
  s_add_u32 s4, s74, 0
  buffer_load_dwordx4 v8, s[40:43], s4 offen lds
  s_add_u32 m0, s77, 156672
  s_nop 0
  buffer_load_dwordx4 v9, s[40:43], s4 offen lds
  v_readlane_b32 s74, v16, 4
  s_add_u32 m0, s77, 28672
  s_add_u32 s4, s74, 0
  buffer_load_dwordx4 v8, s[40:43], s4 offen lds
  s_add_u32 m0, s77, 29696
  s_nop 0
  buffer_load_dwordx4 v9, s[40:43], s4 offen lds
  v_readlane_b32 s74, v16, 5
  s_add_u32 m0, s77, 36864
  s_add_u32 s4, s74, 0
  buffer_load_dwordx4 v8, s[40:43], s4 offen lds
  s_add_u32 m0, s77, 37888
  s_nop 0
  buffer_load_dwordx4 v9, s[40:43], s4 offen lds
  s_add_u32 s44, s22, 24903680
  s_addc_u32 s45, s23, 0
  s_and_b32 s45, s45, 0xffff
  s_mov_b32 s46, 32768
  s_mov_b32 s47, 0x00020000
  s_cmp_lg_u32 s96, 0
  s_cbranch_scc1 L_wo_nofirst
  s_waitcnt vmcnt(12)
  s_mov_b32 s7, 0xffff0000
  v_lshlrev_b32 v32, 16, v64
  v_and_b32 v33, s7, v64
  v_lshlrev_b32 v34, 16, v65
  v_and_b32 v35, s7, v65
  v_lshlrev_b32 v36, 16, v66
  v_and_b32 v37, s7, v66
  v_lshlrev_b32 v38, 16, v67
  v_and_b32 v39, s7, v67
  v_lshlrev_b32 v40, 16, v68
  v_and_b32 v41, s7, v68
  v_pk_add_f32 v[32:33], v[32:33], v[40:41]
  v_lshlrev_b32 v40, 16, v69
  v_and_b32 v41, s7, v69
  v_pk_add_f32 v[34:35], v[34:35], v[40:41]
  v_lshlrev_b32 v40, 16, v70
  v_and_b32 v41, s7, v70
  v_pk_add_f32 v[36:37], v[36:37], v[40:41]
  v_lshlrev_b32 v40, 16, v71
  v_and_b32 v41, s7, v71
  v_pk_add_f32 v[38:39], v[38:39], v[40:41]
  v_lshlrev_b32 v40, 16, v72
  v_and_b32 v41, s7, v72
  v_pk_add_f32 v[32:33], v[32:33], v[40:41]
  v_lshlrev_b32 v40, 16, v73
  v_and_b32 v41, s7, v73
  v_pk_add_f32 v[34:35], v[34:35], v[40:41]
  v_lshlrev_b32 v40, 16, v74
  v_and_b32 v41, s7, v74
  v_pk_add_f32 v[36:37], v[36:37], v[40:41]
  v_lshlrev_b32 v40, 16, v75
  v_and_b32 v41, s7, v75
  v_pk_add_f32 v[38:39], v[38:39], v[40:41]
  v_lshlrev_b32 v40, 16, v76
  v_and_b32 v41, s7, v76
  v_pk_add_f32 v[32:33], v[32:33], v[40:41]
  v_lshlrev_b32 v40, 16, v77
  v_and_b32 v41, s7, v77
  v_pk_add_f32 v[34:35], v[34:35], v[40:41]
  v_lshlrev_b32 v40, 16, v78
  v_and_b32 v41, s7, v78
  v_pk_add_f32 v[36:37], v[36:37], v[40:41]
  v_lshlrev_b32 v40, 16, v79
  v_and_b32 v41, s7, v79
  v_pk_add_f32 v[38:39], v[38:39], v[40:41]
  v_lshlrev_b32 v40, 16, v80
  v_and_b32 v41, s7, v80
  v_pk_add_f32 v[32:33], v[32:33], v[40:41]
  v_lshlrev_b32 v40, 16, v81
  v_and_b32 v41, s7, v81
  v_pk_add_f32 v[34:35], v[34:35], v[40:41]
  v_lshlrev_b32 v40, 16, v82
  v_and_b32 v41, s7, v82
  v_pk_add_f32 v[36:37], v[36:37], v[40:41]
  v_lshlrev_b32 v40, 16, v83
  v_and_b32 v41, s7, v83
  v_pk_add_f32 v[38:39], v[38:39], v[40:41]
  v_lshlrev_b32 v40, 16, v84
  v_and_b32 v41, s7, v84
  v_pk_add_f32 v[32:33], v[32:33], v[40:41]
  v_lshlrev_b32 v40, 16, v85
  v_and_b32 v41, s7, v85
  v_pk_add_f32 v[34:35], v[34:35], v[40:41]
  v_lshlrev_b32 v40, 16, v86
  v_and_b32 v41, s7, v86
  v_pk_add_f32 v[36:37], v[36:37], v[40:41]
  v_lshlrev_b32 v40, 16, v87
  v_and_b32 v41, s7, v87
  v_pk_add_f32 v[38:39], v[38:39], v[40:41]
  v_lshlrev_b32 v40, 16, v88
  v_and_b32 v41, s7, v88
  v_pk_add_f32 v[32:33], v[32:33], v[40:41]
  v_lshlrev_b32 v40, 16, v89
  v_and_b32 v41, s7, v89
  v_pk_add_f32 v[34:35], v[34:35], v[40:41]
  v_lshlrev_b32 v40, 16, v90
  v_and_b32 v41, s7, v90
  v_pk_add_f32 v[36:37], v[36:37], v[40:41]
  v_lshlrev_b32 v40, 16, v91
  v_and_b32 v41, s7, v91
  v_pk_add_f32 v[38:39], v[38:39], v[40:41]
  v_lshlrev_b32 v40, 16, v92
  v_and_b32 v41, s7, v92
  v_pk_add_f32 v[32:33], v[32:33], v[40:41]
  v_lshlrev_b32 v40, 16, v93
  v_and_b32 v41, s7, v93
  v_pk_add_f32 v[34:35], v[34:35], v[40:41]
  v_lshlrev_b32 v40, 16, v94
  v_and_b32 v41, s7, v94
  v_pk_add_f32 v[36:37], v[36:37], v[40:41]
  v_lshlrev_b32 v40, 16, v95
  v_and_b32 v41, s7, v95
  v_pk_add_f32 v[38:39], v[38:39], v[40:41]
  s_add_u32 s52, s22, 24641536
  s_addc_u32 s53, s23, 0
  s_and_b32 s53, s53, 0xffff
  s_mov_b32 s54, 262144
  s_mov_b32 s55, 0x00020000
  v_permlane32_swap_b32 v32, v36
  v_permlane32_swap_b32 v33, v37
  v_permlane32_swap_b32 v34, v38
  v_permlane32_swap_b32 v35, v39
  v_add_f32 v32, v32, v36
  v_add_f32 v33, v33, v37
  v_add_f32 v34, v34, v38
  v_add_f32 v35, v35, v39
  v_and_b32 v2, 7, v1
  v_lshlrev_b32 v2, 5, v2
  v_permlane16_swap_b32 v32, v34
  v_permlane16_swap_b32 v33, v35
  v_add_f32 v32, v32, v34
  v_add_f32 v33, v33, v35
  v_lshrrev_b32 v3, 4, v1
  v_lshl_add_u32 v2, v3, 3, v2
  v_add_f32_dpp v32, v32, v32 row_ror:8 row_mask:0xf bank_mask:0xf
  v_add_f32_dpp v33, v33, v33 row_ror:8 row_mask:0xf bank_mask:0xf
  buffer_store_dwordx2 v[32:33], v2, s[52:55], s94 offen sc1
  s_waitcnt vmcnt(0)
L_wo_nofirst:
  s_lshl_b32 s3, s97, 12
  s_lshl_b32 s4, s68, 8
  s_add_u32 s3, s3, s4
  s_sub_u32 s3, s3, 4096
  v_and_b32 v2, 15, v1
  v_lshlrev_b32 v2, 2, v2
  v_mov_b32 v3, 1
  s_mov_b32 s79, 0x100000
  s_cmp_lg_u32 s70, 4
  s_barrier
  s_cbranch_scc1 L_wo_nofl
  s_mov_b64 exec, 1
  buffer_store_dword v3, off, s[44:47], s87 sc1
  s_mov_b64 exec, -1
L_wo_nofl:
  s_mov_b32 s5, s3
  v_readlane_b32 s74, v16, 6
  s_add_u32 m0, s77, 45056
  s_add_u32 s4, s74, 0
  buffer_load_dwordx4 v8, s[40:43], s4 offen lds
  s_add_u32 m0, s77, 46080
  s_nop 0
  buffer_load_dwordx4 v9, s[40:43], s4 offen lds
  v_readlane_b32 s74, v16, 7
  s_add_u32 m0, s77, 53248
  s_add_u32 s4, s74, 0
  buffer_load_dwordx4 v8, s[40:43], s4 offen lds
  s_add_u32 m0, s77, 54272
  s_nop 0
  buffer_load_dwordx4 v9, s[40:43], s4 offen lds
  v_readlane_b32 s74, v16, 8
  s_add_u32 m0, s77, 61440
  s_add_u32 s4, s74, 0
  buffer_load_dwordx4 v8, s[40:43], s4 offen lds
  s_add_u32 m0, s77, 62464
  s_nop 0
  buffer_load_dwordx4 v9, s[40:43], s4 offen lds
  v_readlane_b32 s74, v16, 9
  s_add_u32 m0, s77, 69632
  s_add_u32 s4, s74, 0
  buffer_load_dwordx4 v8, s[40:43], s4 offen lds
  s_add_u32 m0, s77, 70656
  s_nop 0
  buffer_load_dwordx4 v9, s[40:43], s4 offen lds
  v_readlane_b32 s74, v16, 10
  s_add_u32 m0, s77, 77824
  s_add_u32 s4, s74, 0
  buffer_load_dwordx4 v8, s[40:43], s4 offen lds
  s_add_u32 m0, s77, 78848
  s_nop 0
  buffer_load_dwordx4 v9, s[40:43], s4 offen lds
  v_readlane_b32 s74, v16, 11
  s_add_u32 m0, s77, 86016
  s_add_u32 s4, s74, 0
  buffer_load_dwordx4 v8, s[40:43], s4 offen lds
  s_add_u32 m0, s77, 87040
  s_nop 0
  buffer_load_dwordx4 v9, s[40:43], s4 offen lds
  v_readlane_b32 s74, v16, 12
  s_add_u32 m0, s77, 94208
  s_add_u32 s4, s74, 0
  buffer_load_dwordx4 v8, s[40:43], s4 offen lds
  s_add_u32 m0, s77, 95232
  s_nop 0
  buffer_load_dwordx4 v9, s[40:43], s4 offen lds
  v_readlane_b32 s74, v16, 13
  s_add_u32 m0, s77, 102400
  s_add_u32 s4, s74, 0
  buffer_load_dwordx4 v8, s[40:43], s4 offen lds
  s_add_u32 m0, s77, 103424
  s_nop 0
  buffer_load_dwordx4 v9, s[40:43], s4 offen lds
  v_readlane_b32 s74, v16, 14
  s_add_u32 m0, s77, 110592
  s_add_u32 s4, s74, 0
  buffer_load_dwordx4 v8, s[40:43], s4 offen lds
  s_add_u32 m0, s77, 111616
  s_nop 0
  buffer_load_dwordx4 v9, s[40:43], s4 offen lds
  v_readlane_b32 s74, v16, 15
  s_add_u32 m0, s77, 118784
  s_add_u32 s4, s74, 0
  buffer_load_dwordx4 v8, s[40:43], s4 offen lds
  s_add_u32 m0, s77, 119808
  s_nop 0
  buffer_load_dwordx4 v9, s[40:43], s4 offen lds
  s_mov_b32 s3, s5
  s_cmp_lg_u32 s70, 4
  s_cbranch_scc1 L_wo_dep
L_wo_poll:
  buffer_load_dword v3, v2, s[44:47], s3 offen sc1
  s_sub_u32 s79, s79, 1
  s_cbranch_scc1 L_wo_dep
  s_waitcnt vmcnt(0)
  v_cmp_ne_u32 vcc, 1, v3
  s_cbranch_vccnz L_wo_poll
L_wo_dep:
  s_waitcnt vmcnt(22) lgkmcnt(0)
  s_barrier
  s_waitcnt vmcnt(14)
  s_barrier
  s_waitcnt vmcnt(6)
  s_barrier
  s_waitcnt vmcnt(0)
  s_barrier
  s_waitcnt vmcnt(0)
  s_barrier
  s_lshl_b32 s87, s97, 12
  s_lshl_b32 s4, s68, 8
  s_add_u32 s87, s87, s4
  s_lshl_b32 s4, s69, 2
  s_add_u32 s87, s87, s4
  s_add_u32 s97, s97, 1
  s_branch L_w1_body
L_wo_end:
  s_endpgm
L_wo_compute:
  v_and_b32 v2, 3, v1
  v_lshlrev_b32 v2, 3, v2
  v_bfe_i32 v15, s85, v2, 8
  s_and_b32 s3, s68, 3
  s_mul_i32 s4, s3, 4
  v_add3_u32 v3, v15, v1, s4
  v_and_b32 v3, 15, v3
  v_lshlrev_b32 v15, 11, v3
  v_and_b32 v3, 15, v1
  v_lshrrev_b32 v2, 4, v1
  s_lshl_b32 s8, s68, 7
  s_lshl_b32 s9, s70, 5
  s_add_u32 s8, s8, s9
  s_mul_i32 s9, s8, 2048
  v_lshl_add_u32 v4, v1, 4, s9
  v_add_u32 v5, 32768, v4
  v_add_u32 v13, s8, v3
  s_lshl_b32 s10, s69, 7
  v_lshl_add_u32 v14, v2, 3, s10
  v_and_b32 v16, 1, v2
  v_lshrrev_b32 v17, 1, v2
  v_lshl_add_u32 v16, v16, 1, v17
  v_lshlrev_b32 v16, 8, v16
  v_lshl_add_u32 v16, v3, 4, v16
  s_add_u32 s9, s8, s69
  s_lshl_b32 s9, s9, 11
  v_add_u32 v12, s9, v16
  v_lshl_add_u32 v18, v17, 4, v13
  v_lshlrev_b32 v18, 3, v18
  v_and_b32 v16, 1, v2
  v_lshl_add_u32 v18, v16, 2, v18
  s_lshl_b32 s10, s69, 14
  v_add_u32 v18, s10, v18
  v_bfe_u32 v6, v1, 2, 2
  v_lshl_add_u32 v6, v2, 3, v6
  v_lshlrev_b32 v6, 7, v6
  v_and_b32 v17, 3, v1
  v_lshl_add_u32 v6, v17, 3, v6
  v_bfe_u32 v17, v1, 3, 2
  v_lshl_add_u32 v6, v17, 5, v6
  v_xor_b32 v7, 32, v6
  v_xor_b32 v8, 64, v6
  v_xor_b32 v9, 96, v6
  s_mov_b32 s11, 0xffff0000
  s_mov_b32 s36, s34
  s_and_b32 s37, s35, 0xffff
  s_mov_b32 s38, 4194304
  s_mov_b32 s39, 0x00020000
  s_add_u32 s44, s34, 4194304
  s_addc_u32 s45, s35, 0
  s_and_b32 s45, s45, 0xffff
  s_mov_b32 s46, 4194304
  s_mov_b32 s47, 0x00020000
  s_add_u32 s56, s34, 24117248
  s_addc_u32 s57, s35, 0
  s_and_b32 s57, s57, 0xffff
  s_mov_b32 s58, 262144
  s_mov_b32 s59, 0x00020000
  s_cmp_lg_u32 s96, 0
  s_cbranch_scc1 L_pfc2_skip
  s_getpc_b64 s[4:5]
L_pfc2:
  s_lshl_b32 s3, s99, 2
  s_add_u32 s3, s3, s70
  s_mul_i32 s3, s3, 128
  s_min_u32 s3, s3, L_w1_c1-L_w1_c0-128
  s_add_i32 s3, s3, L_w1_c0-L_pfc2
  s_ashr_i32 s6, s3, 31
  s_add_u32 s4, s4, s3
  s_addc_u32 s5, s5, s6
  s_load_dword s40, s[4:5], 0
  s_load_dword s41, s[4:5], 64
L_pfc2_skip:
  v_add_u32 v26, 155648, v6
  v_add_u32 v27, 155648, v7
  v_add_u32 v28, 155648, v8
  v_add_u32 v29, 155648, v9
  v_add_u32 v20, 94208, v6
  v_add_u32 v21, 94208, v7
  v_add_u32 v22, 94208, v8
  v_add_u32 v23, 94208, v9
  v_add_u32 v6, 28672, v6
  v_add_u32 v7, 28672, v7
  v_add_u32 v8, 28672, v8
  v_add_u32 v9, 28672, v9
  v_readlane_b32 s48, v15, 0
  v_readlane_b32 s49, v15, 1
  v_readlane_b32 s50, v15, 2
  v_permlane16_swap_b32 v240, v242
  v_permlane16_swap_b32 v241, v243
  v_permlane16_swap_b32 v244, v246
  v_permlane16_swap_b32 v245, v247
  v_permlane16_swap_b32 v248, v250
  v_permlane16_swap_b32 v249, v251
  v_permlane16_swap_b32 v252, v254
  v_permlane16_swap_b32 v253, v255
  s_waitcnt lgkmcnt(0)
  s_barrier
  buffer_load_dwordx4 v[32:35], v4, s[36:39], s48 offen offset:0
  buffer_load_dwordx4 v[36:39], v5, s[36:39], s48 offen offset:0
  buffer_load_dwordx4 v[40:43], v4, s[36:39], s48 offen offset:1024
  buffer_load_dwordx4 v[44:47], v5, s[36:39], s48 offen offset:1024
  buffer_load_dwordx4 v[48:51], v4, s[36:39], s49 offen offset:0
  buffer_load_dwordx4 v[52:55], v5, s[36:39], s49 offen offset:0
  buffer_load_dwordx4 v[56:59], v4, s[36:39], s49 offen offset:1024
  buffer_load_dwordx4 v[60:63], v5, s[36:39], s49 offen offset:1024
  buffer_load_dwordx4 v[64:67], v4, s[36:39], s50 offen offset:0
  buffer_load_dwordx4 v[68:71], v5, s[36:39], s50 offen offset:0
  buffer_load_dwordx4 v[72:75], v4, s[36:39], s50 offen offset:1024
  buffer_load_dwordx4 v[76:79], v5, s[36:39], s50 offen offset:1024
  ds_read_b64_tr_b16 v[160:161], v20 offset:36864
  ds_read_b64_tr_b16 v[162:163], v20 offset:37376
  ds_read_b64_tr_b16 v[164:165], v21 offset:36864
  ds_read_b64_tr_b16 v[166:167], v21 offset:37376
  ds_read_b64_tr_b16 v[168:169], v22 offset:36864
  ds_read_b64_tr_b16 v[170:171], v22 offset:37376
  ds_read_b64_tr_b16 v[172:173], v23 offset:36864
  ds_read_b64_tr_b16 v[174:175], v23 offset:37376
  ds_read_b64_tr_b16 v[176:177], v20 offset:40960
  ds_read_b64_tr_b16 v[178:179], v20 offset:41472
  ds_read_b64_tr_b16 v[180:181], v21 offset:40960
  ds_read_b64_tr_b16 v[182:183], v21 offset:41472
  ds_read_b64_tr_b16 v[184:185], v22 offset:40960
  ds_read_b64_tr_b16 v[186:187], v22 offset:41472
  ds_read_b64_tr_b16 v[188:189], v23 offset:40960
  ds_read_b64_tr_b16 v[190:191], v23 offset:41472
  v_lshlrev_b32 v96, 16, v240
  v_and_b32 v97, s11, v240
  v_lshlrev_b32 v98, 16, v241
  v_and_b32 v99, s11, v241
  v_lshlrev_b32 v100, 16, v248
  v_and_b32 v101, s11, v248
  v_lshlrev_b32 v102, 16, v249
  v_and_b32 v103, s11, v249
  v_lshlrev_b32 v104, 16, v242
  v_and_b32 v105, s11, v242
  v_lshlrev_b32 v106, 16, v243
  v_and_b32 v107, s11, v243
  v_lshlrev_b32 v108, 16, v250
  v_and_b32 v109, s11, v250
  v_lshlrev_b32 v110, 16, v251
  v_and_b32 v111, s11, v251
  v_lshlrev_b32 v112, 16, v244
  v_and_b32 v113, s11, v244
  v_lshlrev_b32 v114, 16, v245
  v_and_b32 v115, s11, v245
  v_lshlrev_b32 v116, 16, v252
  v_and_b32 v117, s11, v252
  v_lshlrev_b32 v118, 16, v253
  v_and_b32 v119, s11, v253
  v_lshlrev_b32 v120, 16, v246
  v_and_b32 v121, s11, v246
  v_lshlrev_b32 v122, 16, v247
  v_and_b32 v123, s11, v247
  v_lshlrev_b32 v124, 16, v254
  v_and_b32 v125, s11, v254
  v_lshlrev_b32 v126, 16, v255
  v_and_b32 v127, s11, v255
  s_waitcnt vmcnt(10) lgkmcnt(8)
  v_mfma_f32_16x16x32_bf16 v[96:99], v[160:163], v[32:35], v[96:99]
  ds_read_b64_tr_b16 v[192:193], v20 offset:45056
  v_readlane_b32 s51, v15, 3
  v_mfma_f32_16x16x32_bf16 v[100:103], v[160:163], v[36:39], v[100:103]
  ds_read_b64_tr_b16 v[194:195], v20 offset:45568
  v_mfma_f32_16x16x32_bf16 v[104:107], v[164:167], v[32:35], v[104:107]
  ds_read_b64_tr_b16 v[196:197], v21 offset:45056
  v_mfma_f32_16x16x32_bf16 v[108:111], v[164:167], v[36:39], v[108:111]
  ds_read_b64_tr_b16 v[198:199], v21 offset:45568
  buffer_load_dwordx4 v[80:83], v4, s[36:39], s51 offen offset:0
  v_mfma_f32_16x16x32_bf16 v[112:115], v[168:171], v[32:35], v[112:115]
  ds_read_b64_tr_b16 v[200:201], v22 offset:45056
  v_mfma_f32_16x16x32_bf16 v[116:119], v[168:171], v[36:39], v[116:119]
  ds_read_b64_tr_b16 v[202:203], v22 offset:45568
  v_mfma_f32_16x16x32_bf16 v[120:123], v[172:175], v[32:35], v[120:123]
  ds_read_b64_tr_b16 v[204:205], v23 offset:45056
  buffer_load_dwordx4 v[84:87], v5, s[36:39], s51 offen offset:0
  v_mfma_f32_16x16x32_bf16 v[124:127], v[172:175], v[36:39], v[124:127]
  ds_read_b64_tr_b16 v[206:207], v23 offset:45568
  s_waitcnt vmcnt(10) lgkmcnt(8)
  v_mfma_f32_16x16x32_bf16 v[96:99], v[176:179], v[40:43], v[96:99]
  ds_read_b64_tr_b16 v[208:209], v20 offset:49152
  v_mfma_f32_16x16x32_bf16 v[100:103], v[176:179], v[44:47], v[100:103]
  ds_read_b64_tr_b16 v[210:211], v20 offset:49664
  buffer_load_dwordx4 v[88:91], v4, s[36:39], s51 offen offset:1024
  v_mfma_f32_16x16x32_bf16 v[104:107], v[180:183], v[40:43], v[104:107]
  ds_read_b64_tr_b16 v[212:213], v21 offset:49152
  v_mfma_f32_16x16x32_bf16 v[108:111], v[180:183], v[44:47], v[108:111]
  ds_read_b64_tr_b16 v[214:215], v21 offset:49664
  v_mfma_f32_16x16x32_bf16 v[112:115], v[184:187], v[40:43], v[112:115]
  ds_read_b64_tr_b16 v[216:217], v22 offset:49152
  buffer_load_dwordx4 v[92:95], v5, s[36:39], s51 offen offset:1024
  v_mfma_f32_16x16x32_bf16 v[116:119], v[184:187], v[44:47], v[116:119]
  ds_read_b64_tr_b16 v[218:219], v22 offset:49664
  v_readlane_b32 s48, v15, 4
  v_mfma_f32_16x16x32_bf16 v[120:123], v[188:191], v[40:43], v[120:123]
  ds_read_b64_tr_b16 v[220:221], v23 offset:49152
  v_mfma_f32_16x16x32_bf16 v[124:127], v[188:191], v[44:47], v[124:127]
  ds_read_b64_tr_b16 v[222:223], v23 offset:49664
  s_waitcnt vmcnt(10) lgkmcnt(8)
  v_mfma_f32_16x16x32_bf16 v[96:99], v[192:195], v[48:51], v[96:99]
  ds_read_b64_tr_b16 v[160:161], v20 offset:53248
  buffer_load_dwordx4 v[32:35], v4, s[36:39], s48 offen offset:0
  v_mfma_f32_16x16x32_bf16 v[100:103], v[192:195], v[52:55], v[100:103]
  ds_read_b64_tr_b16 v[162:163], v20 offset:53760
  v_mfma_f32_16x16x32_bf16 v[104:107], v[196:199], v[48:51], v[104:107]
  ds_read_b64_tr_b16 v[164:165], v21 offset:53248
  v_mfma_f32_16x16x32_bf16 v[108:111], v[196:199], v[52:55], v[108:111]
  ds_read_b64_tr_b16 v[166:167], v21 offset:53760
  buffer_load_dwordx4 v[36:39], v5, s[36:39], s48 offen offset:0
  v_mfma_f32_16x16x32_bf16 v[112:115], v[200:203], v[48:51], v[112:115]
  ds_read_b64_tr_b16 v[168:169], v22 offset:53248
  v_mfma_f32_16x16x32_bf16 v[116:119], v[200:203], v[52:55], v[116:119]
  ds_read_b64_tr_b16 v[170:171], v22 offset:53760
  v_mfma_f32_16x16x32_bf16 v[120:123], v[204:207], v[48:51], v[120:123]
  ds_read_b64_tr_b16 v[172:173], v23 offset:53248
  buffer_load_dwordx4 v[40:43], v4, s[36:39], s48 offen offset:1024
  v_mfma_f32_16x16x32_bf16 v[124:127], v[204:207], v[52:55], v[124:127]
  ds_read_b64_tr_b16 v[174:175], v23 offset:53760
  s_waitcnt vmcnt(11) lgkmcnt(8)
  v_mfma_f32_16x16x32_bf16 v[96:99], v[208:211], v[56:59], v[96:99]
  ds_read_b64_tr_b16 v[176:177], v20 offset:57344
  v_mfma_f32_16x16x32_bf16 v[100:103], v[208:211], v[60:63], v[100:103]
  ds_read_b64_tr_b16 v[178:179], v20 offset:57856
  buffer_load_dwordx4 v[44:47], v5, s[36:39], s48 offen offset:1024
  v_mfma_f32_16x16x32_bf16 v[104:107], v[212:215], v[56:59], v[104:107]
  ds_read_b64_tr_b16 v[180:181], v21 offset:57344
  v_mfma_f32_16x16x32_bf16 v[108:111], v[212:215], v[60:63], v[108:111]
  ds_read_b64_tr_b16 v[182:183], v21 offset:57856
  v_mfma_f32_16x16x32_bf16 v[112:115], v[216:219], v[56:59], v[112:115]
  ds_read_b64_tr_b16 v[184:185], v22 offset:57344
  v_mfma_f32_16x16x32_bf16 v[116:119], v[216:219], v[60:63], v[116:119]
  ds_read_b64_tr_b16 v[186:187], v22 offset:57856
  v_readlane_b32 s49, v15, 5
  v_mfma_f32_16x16x32_bf16 v[120:123], v[220:223], v[56:59], v[120:123]
  ds_read_b64_tr_b16 v[188:189], v23 offset:57344
  v_mfma_f32_16x16x32_bf16 v[124:127], v[220:223], v[60:63], v[124:127]
  ds_read_b64_tr_b16 v[190:191], v23 offset:57856
  s_waitcnt vmcnt(10) lgkmcnt(8)
  v_mfma_f32_16x16x32_bf16 v[96:99], v[160:163], v[64:67], v[96:99]
  ds_read_b64_tr_b16 v[192:193], v26 offset:0
  buffer_load_dwordx4 v[48:51], v4, s[36:39], s49 offen offset:0
  v_mfma_f32_16x16x32_bf16 v[100:103], v[160:163], v[68:71], v[100:103]
  ds_read_b64_tr_b16 v[194:195], v26 offset:512
  v_mfma_f32_16x16x32_bf16 v[104:107], v[164:167], v[64:67], v[104:107]
  ds_read_b64_tr_b16 v[196:197], v27 offset:0
  v_mfma_f32_16x16x32_bf16 v[108:111], v[164:167], v[68:71], v[108:111]
  ds_read_b64_tr_b16 v[198:199], v27 offset:512
  buffer_load_dwordx4 v[52:55], v5, s[36:39], s49 offen offset:0
  v_mfma_f32_16x16x32_bf16 v[112:115], v[168:171], v[64:67], v[112:115]
  ds_read_b64_tr_b16 v[200:201], v28 offset:0
  v_mfma_f32_16x16x32_bf16 v[116:119], v[168:171], v[68:71], v[116:119]
  ds_read_b64_tr_b16 v[202:203], v28 offset:512
  v_mfma_f32_16x16x32_bf16 v[120:123], v[172:175], v[64:67], v[120:123]
  ds_read_b64_tr_b16 v[204:205], v29 offset:0
  buffer_load_dwordx4 v[56:59], v4, s[36:39], s49 offen offset:1024
  v_mfma_f32_16x16x32_bf16 v[124:127], v[172:175], v[68:71], v[124:127]
  ds_read_b64_tr_b16 v[206:207], v29 offset:512
  s_waitcnt vmcnt(11) lgkmcnt(8)
  v_mfma_f32_16x16x32_bf16 v[96:99], v[176:179], v[72:75], v[96:99]
  ds_read_b64_tr_b16 v[208:209], v26 offset:4096
  v_mfma_f32_16x16x32_bf16 v[100:103], v[176:179], v[76:79], v[100:103]
  ds_read_b64_tr_b16 v[210:211], v26 offset:4608
  buffer_load_dwordx4 v[60:63], v5, s[36:39], s49 offen offset:1024
  v_mfma_f32_16x16x32_bf16 v[104:107], v[180:183], v[72:75], v[104:107]
  ds_read_b64_tr_b16 v[212:213], v27 offset:4096
  v_mfma_f32_16x16x32_bf16 v[108:111], v[180:183], v[76:79], v[108:111]
  ds_read_b64_tr_b16 v[214:215], v27 offset:4608
  v_mfma_f32_16x16x32_bf16 v[112:115], v[184:187], v[72:75], v[112:115]
  ds_read_b64_tr_b16 v[216:217], v28 offset:4096
  v_mfma_f32_16x16x32_bf16 v[116:119], v[184:187], v[76:79], v[116:119]
  ds_read_b64_tr_b16 v[218:219], v28 offset:4608
  v_readlane_b32 s50, v15, 6
  v_mfma_f32_16x16x32_bf16 v[120:123], v[188:191], v[72:75], v[120:123]
  ds_read_b64_tr_b16 v[220:221], v29 offset:4096
  v_mfma_f32_16x16x32_bf16 v[124:127], v[188:191], v[76:79], v[124:127]
  ds_read_b64_tr_b16 v[222:223], v29 offset:4608
  s_waitcnt vmcnt(10) lgkmcnt(8)
  v_mfma_f32_16x16x32_bf16 v[96:99], v[192:195], v[80:83], v[96:99]
  ds_read_b64_tr_b16 v[160:161], v6 offset:0
  buffer_load_dwordx4 v[64:67], v4, s[36:39], s50 offen offset:0
  v_mfma_f32_16x16x32_bf16 v[100:103], v[192:195], v[84:87], v[100:103]
  ds_read_b64_tr_b16 v[162:163], v6 offset:512
  v_mfma_f32_16x16x32_bf16 v[104:107], v[196:199], v[80:83], v[104:107]
  ds_read_b64_tr_b16 v[164:165], v7 offset:0
  v_mfma_f32_16x16x32_bf16 v[108:111], v[196:199], v[84:87], v[108:111]
  ds_read_b64_tr_b16 v[166:167], v7 offset:512
  buffer_load_dwordx4 v[68:71], v5, s[36:39], s50 offen offset:0
  v_mfma_f32_16x16x32_bf16 v[112:115], v[200:203], v[80:83], v[112:115]
  ds_read_b64_tr_b16 v[168:169], v8 offset:0
  v_mfma_f32_16x16x32_bf16 v[116:119], v[200:203], v[84:87], v[116:119]
  ds_read_b64_tr_b16 v[170:171], v8 offset:512
  v_mfma_f32_16x16x32_bf16 v[120:123], v[204:207], v[80:83], v[120:123]
  ds_read_b64_tr_b16 v[172:173], v9 offset:0
  buffer_load_dwordx4 v[72:75], v4, s[36:39], s50 offen offset:1024
  v_mfma_f32_16x16x32_bf16 v[124:127], v[204:207], v[84:87], v[124:127]
  ds_read_b64_tr_b16 v[174:175], v9 offset:512
  s_waitcnt vmcnt(11) lgkmcnt(8)
  s_barrier
  v_mfma_f32_16x16x32_bf16 v[96:99], v[208:211], v[88:91], v[96:99]
  ds_read_b64_tr_b16 v[176:177], v6 offset:4096
  v_mfma_f32_16x16x32_bf16 v[100:103], v[208:211], v[92:95], v[100:103]
  ds_read_b64_tr_b16 v[178:179], v6 offset:4608
  buffer_load_dwordx4 v[76:79], v5, s[36:39], s50 offen offset:1024
  v_mfma_f32_16x16x32_bf16 v[104:107], v[212:215], v[88:91], v[104:107]
  ds_read_b64_tr_b16 v[180:181], v7 offset:4096
  v_mfma_f32_16x16x32_bf16 v[108:111], v[212:215], v[92:95], v[108:111]
  ds_read_b64_tr_b16 v[182:183], v7 offset:4608
  v_mfma_f32_16x16x32_bf16 v[112:115], v[216:219], v[88:91], v[112:115]
  ds_read_b64_tr_b16 v[184:185], v8 offset:4096
  v_mfma_f32_16x16x32_bf16 v[116:119], v[216:219], v[92:95], v[116:119]
  ds_read_b64_tr_b16 v[186:187], v8 offset:4608
  v_readlane_b32 s51, v15, 7
  v_mfma_f32_16x16x32_bf16 v[120:123], v[220:223], v[88:91], v[120:123]
  ds_read_b64_tr_b16 v[188:189], v9 offset:4096
  v_mfma_f32_16x16x32_bf16 v[124:127], v[220:223], v[92:95], v[124:127]
  ds_read_b64_tr_b16 v[190:191], v9 offset:4608
  s_waitcnt vmcnt(10) lgkmcnt(8)
  v_mfma_f32_16x16x32_bf16 v[96:99], v[160:163], v[32:35], v[96:99]
  ds_read_b64_tr_b16 v[192:193], v6 offset:8192
  buffer_load_dwordx4 v[80:83], v4, s[36:39], s51 offen offset:0
  v_mfma_f32_16x16x32_bf16 v[100:103], v[160:163], v[36:39], v[100:103]
  ds_read_b64_tr_b16 v[194:195], v6 offset:8704
  v_mfma_f32_16x16x32_bf16 v[104:107], v[164:167], v[32:35], v[104:107]
  ds_read_b64_tr_b16 v[196:197], v7 offset:8192
  v_mfma_f32_16x16x32_bf16 v[108:111], v[164:167], v[36:39], v[108:111]
  ds_read_b64_tr_b16 v[198:199], v7 offset:8704
  buffer_load_dwordx4 v[84:87], v5, s[36:39], s51 offen offset:0
  v_mfma_f32_16x16x32_bf16 v[112:115], v[168:171], v[32:35], v[112:115]
  ds_read_b64_tr_b16 v[200:201], v8 offset:8192
  v_mfma_f32_16x16x32_bf16 v[116:119], v[168:171], v[36:39], v[116:119]
  ds_read_b64_tr_b16 v[202:203], v8 offset:8704
  v_mfma_f32_16x16x32_bf16 v[120:123], v[172:175], v[32:35], v[120:123]
  ds_read_b64_tr_b16 v[204:205], v9 offset:8192
  buffer_load_dwordx4 v[88:91], v4, s[36:39], s51 offen offset:1024
  v_mfma_f32_16x16x32_bf16 v[124:127], v[172:175], v[36:39], v[124:127]
  ds_read_b64_tr_b16 v[206:207], v9 offset:8704
  s_waitcnt vmcnt(11) lgkmcnt(8)
  v_mfma_f32_16x16x32_bf16 v[96:99], v[176:179], v[40:43], v[96:99]
  ds_read_b64_tr_b16 v[208:209], v6 offset:12288
  v_mfma_f32_16x16x32_bf16 v[100:103], v[176:179], v[44:47], v[100:103]
  ds_read_b64_tr_b16 v[210:211], v6 offset:12800
  buffer_load_dwordx4 v[92:95], v5, s[36:39], s51 offen offset:1024
  v_mfma_f32_16x16x32_bf16 v[104:107], v[180:183], v[40:43], v[104:107]
  ds_read_b64_tr_b16 v[212:213], v7 offset:12288
  v_mfma_f32_16x16x32_bf16 v[108:111], v[180:183], v[44:47], v[108:111]
  ds_read_b64_tr_b16 v[214:215], v7 offset:12800
  v_mfma_f32_16x16x32_bf16 v[112:115], v[184:187], v[40:43], v[112:115]
  ds_read_b64_tr_b16 v[216:217], v8 offset:12288
  v_mfma_f32_16x16x32_bf16 v[116:119], v[184:187], v[44:47], v[116:119]
  ds_read_b64_tr_b16 v[218:219], v8 offset:12800
  v_readlane_b32 s48, v15, 8
  v_mfma_f32_16x16x32_bf16 v[120:123], v[188:191], v[40:43], v[120:123]
  ds_read_b64_tr_b16 v[220:221], v9 offset:12288
  v_mfma_f32_16x16x32_bf16 v[124:127], v[188:191], v[44:47], v[124:127]
  ds_read_b64_tr_b16 v[222:223], v9 offset:12800
  s_waitcnt vmcnt(10) lgkmcnt(8)
  v_mfma_f32_16x16x32_bf16 v[96:99], v[192:195], v[48:51], v[96:99]
  ds_read_b64_tr_b16 v[160:161], v6 offset:16384
  buffer_load_dwordx4 v[32:35], v4, s[36:39], s48 offen offset:0
  v_mfma_f32_16x16x32_bf16 v[100:103], v[192:195], v[52:55], v[100:103]
  ds_read_b64_tr_b16 v[162:163], v6 offset:16896
  v_mfma_f32_16x16x32_bf16 v[104:107], v[196:199], v[48:51], v[104:107]
  ds_read_b64_tr_b16 v[164:165], v7 offset:16384
  v_mfma_f32_16x16x32_bf16 v[108:111], v[196:199], v[52:55], v[108:111]
  ds_read_b64_tr_b16 v[166:167], v7 offset:16896
  buffer_load_dwordx4 v[36:39], v5, s[36:39], s48 offen offset:0
  v_mfma_f32_16x16x32_bf16 v[112:115], v[200:203], v[48:51], v[112:115]
  ds_read_b64_tr_b16 v[168:169], v8 offset:16384
  v_mfma_f32_16x16x32_bf16 v[116:119], v[200:203], v[52:55], v[116:119]
  ds_read_b64_tr_b16 v[170:171], v8 offset:16896
  v_mfma_f32_16x16x32_bf16 v[120:123], v[204:207], v[48:51], v[120:123]
  ds_read_b64_tr_b16 v[172:173], v9 offset:16384
  buffer_load_dwordx4 v[40:43], v4, s[36:39], s48 offen offset:1024
  v_mfma_f32_16x16x32_bf16 v[124:127], v[204:207], v[52:55], v[124:127]
  ds_read_b64_tr_b16 v[174:175], v9 offset:16896
  s_waitcnt vmcnt(11) lgkmcnt(8)
  v_mfma_f32_16x16x32_bf16 v[96:99], v[208:211], v[56:59], v[96:99]
  ds_read_b64_tr_b16 v[176:177], v6 offset:20480
  v_mfma_f32_16x16x32_bf16 v[100:103], v[208:211], v[60:63], v[100:103]
  ds_read_b64_tr_b16 v[178:179], v6 offset:20992
  buffer_load_dwordx4 v[44:47], v5, s[36:39], s48 offen offset:1024
  v_mfma_f32_16x16x32_bf16 v[104:107], v[212:215], v[56:59], v[104:107]
  ds_read_b64_tr_b16 v[180:181], v7 offset:20480
  v_mfma_f32_16x16x32_bf16 v[108:111], v[212:215], v[60:63], v[108:111]
  ds_read_b64_tr_b16 v[182:183], v7 offset:20992
  v_mfma_f32_16x16x32_bf16 v[112:115], v[216:219], v[56:59], v[112:115]
  ds_read_b64_tr_b16 v[184:185], v8 offset:20480
  v_mfma_f32_16x16x32_bf16 v[116:119], v[216:219], v[60:63], v[116:119]
  ds_read_b64_tr_b16 v[186:187], v8 offset:20992
  v_readlane_b32 s49, v15, 9
  v_mfma_f32_16x16x32_bf16 v[120:123], v[220:223], v[56:59], v[120:123]
  ds_read_b64_tr_b16 v[188:189], v9 offset:20480
  v_mfma_f32_16x16x32_bf16 v[124:127], v[220:223], v[60:63], v[124:127]
  ds_read_b64_tr_b16 v[190:191], v9 offset:20992
  s_waitcnt vmcnt(10) lgkmcnt(8)
  v_mfma_f32_16x16x32_bf16 v[96:99], v[160:163], v[64:67], v[96:99]
  ds_read_b64_tr_b16 v[192:193], v6 offset:24576
  buffer_load_dwordx4 v[48:51], v4, s[36:39], s49 offen offset:0
  v_mfma_f32_16x16x32_bf16 v[100:103], v[160:163], v[68:71], v[100:103]
  ds_read_b64_tr_b16 v[194:195], v6 offset:25088
  v_mfma_f32_16x16x32_bf16 v[104:107], v[164:167], v[64:67], v[104:107]
  ds_read_b64_tr_b16 v[196:197], v7 offset:24576
  v_mfma_f32_16x16x32_bf16 v[108:111], v[164:167], v[68:71], v[108:111]
  ds_read_b64_tr_b16 v[198:199], v7 offset:25088
  buffer_load_dwordx4 v[52:55], v5, s[36:39], s49 offen offset:0
  v_mfma_f32_16x16x32_bf16 v[112:115], v[168:171], v[64:67], v[112:115]
  ds_read_b64_tr_b16 v[200:201], v8 offset:24576
  v_mfma_f32_16x16x32_bf16 v[116:119], v[168:171], v[68:71], v[116:119]
  ds_read_b64_tr_b16 v[202:203], v8 offset:25088
  v_mfma_f32_16x16x32_bf16 v[120:123], v[172:175], v[64:67], v[120:123]
  ds_read_b64_tr_b16 v[204:205], v9 offset:24576
  buffer_load_dwordx4 v[56:59], v4, s[36:39], s49 offen offset:1024
  v_mfma_f32_16x16x32_bf16 v[124:127], v[172:175], v[68:71], v[124:127]
  ds_read_b64_tr_b16 v[206:207], v9 offset:25088
  s_waitcnt vmcnt(11) lgkmcnt(8)
  v_mfma_f32_16x16x32_bf16 v[96:99], v[176:179], v[72:75], v[96:99]
  ds_read_b64_tr_b16 v[208:209], v6 offset:28672
  v_mfma_f32_16x16x32_bf16 v[100:103], v[176:179], v[76:79], v[100:103]
  ds_read_b64_tr_b16 v[210:211], v6 offset:29184
  buffer_load_dwordx4 v[60:63], v5, s[36:39], s49 offen offset:1024
  v_mfma_f32_16x16x32_bf16 v[104:107], v[180:183], v[72:75], v[104:107]
  ds_read_b64_tr_b16 v[212:213], v7 offset:28672
  v_mfma_f32_16x16x32_bf16 v[108:111], v[180:183], v[76:79], v[108:111]
  ds_read_b64_tr_b16 v[214:215], v7 offset:29184
  v_mfma_f32_16x16x32_bf16 v[112:115], v[184:187], v[72:75], v[112:115]
  ds_read_b64_tr_b16 v[216:217], v8 offset:28672
  v_mfma_f32_16x16x32_bf16 v[116:119], v[184:187], v[76:79], v[116:119]
  ds_read_b64_tr_b16 v[218:219], v8 offset:29184
  v_readlane_b32 s50, v15, 10
  v_mfma_f32_16x16x32_bf16 v[120:123], v[188:191], v[72:75], v[120:123]
  ds_read_b64_tr_b16 v[220:221], v9 offset:28672
  v_mfma_f32_16x16x32_bf16 v[124:127], v[188:191], v[76:79], v[124:127]
  ds_read_b64_tr_b16 v[222:223], v9 offset:29184
  s_waitcnt vmcnt(10) lgkmcnt(8)
  v_mfma_f32_16x16x32_bf16 v[96:99], v[192:195], v[80:83], v[96:99]
  ds_read_b64_tr_b16 v[160:161], v6 offset:32768
  buffer_load_dwordx4 v[64:67], v4, s[36:39], s50 offen offset:0
  v_mfma_f32_16x16x32_bf16 v[100:103], v[192:195], v[84:87], v[100:103]
  ds_read_b64_tr_b16 v[162:163], v6 offset:33280
  v_mfma_f32_16x16x32_bf16 v[104:107], v[196:199], v[80:83], v[104:107]
  ds_read_b64_tr_b16 v[164:165], v7 offset:32768
  v_mfma_f32_16x16x32_bf16 v[108:111], v[196:199], v[84:87], v[108:111]
  ds_read_b64_tr_b16 v[166:167], v7 offset:33280
  buffer_load_dwordx4 v[68:71], v5, s[36:39], s50 offen offset:0
  v_mfma_f32_16x16x32_bf16 v[112:115], v[200:203], v[80:83], v[112:115]
  ds_read_b64_tr_b16 v[168:169], v8 offset:32768
  v_mfma_f32_16x16x32_bf16 v[116:119], v[200:203], v[84:87], v[116:119]
  ds_read_b64_tr_b16 v[170:171], v8 offset:33280
  v_mfma_f32_16x16x32_bf16 v[120:123], v[204:207], v[80:83], v[120:123]
  ds_read_b64_tr_b16 v[172:173], v9 offset:32768
  buffer_load_dwordx4 v[72:75], v4, s[36:39], s50 offen offset:1024
  v_mfma_f32_16x16x32_bf16 v[124:127], v[204:207], v[84:87], v[124:127]
  ds_read_b64_tr_b16 v[174:175], v9 offset:33280
  s_waitcnt vmcnt(11) lgkmcnt(8)
  s_barrier
  v_mfma_f32_16x16x32_bf16 v[96:99], v[208:211], v[88:91], v[96:99]
  ds_read_b64_tr_b16 v[176:177], v6 offset:36864
  v_mfma_f32_16x16x32_bf16 v[100:103], v[208:211], v[92:95], v[100:103]
  ds_read_b64_tr_b16 v[178:179], v6 offset:37376
  buffer_load_dwordx4 v[76:79], v5, s[36:39], s50 offen offset:1024
  v_mfma_f32_16x16x32_bf16 v[104:107], v[212:215], v[88:91], v[104:107]
  ds_read_b64_tr_b16 v[180:181], v7 offset:36864
  v_mfma_f32_16x16x32_bf16 v[108:111], v[212:215], v[92:95], v[108:111]
  ds_read_b64_tr_b16 v[182:183], v7 offset:37376
  v_mfma_f32_16x16x32_bf16 v[112:115], v[216:219], v[88:91], v[112:115]
  ds_read_b64_tr_b16 v[184:185], v8 offset:36864
  v_mfma_f32_16x16x32_bf16 v[116:119], v[216:219], v[92:95], v[116:119]
  ds_read_b64_tr_b16 v[186:187], v8 offset:37376
  v_readlane_b32 s51, v15, 11
  v_mfma_f32_16x16x32_bf16 v[120:123], v[220:223], v[88:91], v[120:123]
  ds_read_b64_tr_b16 v[188:189], v9 offset:36864
  v_mfma_f32_16x16x32_bf16 v[124:127], v[220:223], v[92:95], v[124:127]
  ds_read_b64_tr_b16 v[190:191], v9 offset:37376
  s_waitcnt vmcnt(10) lgkmcnt(8)
  v_mfma_f32_16x16x32_bf16 v[96:99], v[160:163], v[32:35], v[96:99]
  ds_read_b64_tr_b16 v[192:193], v6 offset:40960
  buffer_load_dwordx4 v[80:83], v4, s[36:39], s51 offen offset:0
  v_mfma_f32_16x16x32_bf16 v[100:103], v[160:163], v[36:39], v[100:103]
  ds_read_b64_tr_b16 v[194:195], v6 offset:41472
  v_mfma_f32_16x16x32_bf16 v[104:107], v[164:167], v[32:35], v[104:107]
  ds_read_b64_tr_b16 v[196:197], v7 offset:40960
  v_mfma_f32_16x16x32_bf16 v[108:111], v[164:167], v[36:39], v[108:111]
  ds_read_b64_tr_b16 v[198:199], v7 offset:41472
  buffer_load_dwordx4 v[84:87], v5, s[36:39], s51 offen offset:0
  v_mfma_f32_16x16x32_bf16 v[112:115], v[168:171], v[32:35], v[112:115]
  ds_read_b64_tr_b16 v[200:201], v8 offset:40960
  v_mfma_f32_16x16x32_bf16 v[116:119], v[168:171], v[36:39], v[116:119]
  ds_read_b64_tr_b16 v[202:203], v8 offset:41472
  v_mfma_f32_16x16x32_bf16 v[120:123], v[172:175], v[32:35], v[120:123]
  ds_read_b64_tr_b16 v[204:205], v9 offset:40960
  buffer_load_dwordx4 v[88:91], v4, s[36:39], s51 offen offset:1024
  v_mfma_f32_16x16x32_bf16 v[124:127], v[172:175], v[36:39], v[124:127]
  ds_read_b64_tr_b16 v[206:207], v9 offset:41472
  s_waitcnt vmcnt(11) lgkmcnt(8)
  v_mfma_f32_16x16x32_bf16 v[96:99], v[176:179], v[40:43], v[96:99]
  ds_read_b64_tr_b16 v[208:209], v6 offset:45056
  v_mfma_f32_16x16x32_bf16 v[100:103], v[176:179], v[44:47], v[100:103]
  ds_read_b64_tr_b16 v[210:211], v6 offset:45568
  buffer_load_dwordx4 v[92:95], v5, s[36:39], s51 offen offset:1024
  v_mfma_f32_16x16x32_bf16 v[104:107], v[180:183], v[40:43], v[104:107]
  ds_read_b64_tr_b16 v[212:213], v7 offset:45056
  v_mfma_f32_16x16x32_bf16 v[108:111], v[180:183], v[44:47], v[108:111]
  ds_read_b64_tr_b16 v[214:215], v7 offset:45568
  v_mfma_f32_16x16x32_bf16 v[112:115], v[184:187], v[40:43], v[112:115]
  ds_read_b64_tr_b16 v[216:217], v8 offset:45056
  v_mfma_f32_16x16x32_bf16 v[116:119], v[184:187], v[44:47], v[116:119]
  ds_read_b64_tr_b16 v[218:219], v8 offset:45568
  v_readlane_b32 s48, v15, 12
  v_mfma_f32_16x16x32_bf16 v[120:123], v[188:191], v[40:43], v[120:123]
  ds_read_b64_tr_b16 v[220:221], v9 offset:45056
  v_mfma_f32_16x16x32_bf16 v[124:127], v[188:191], v[44:47], v[124:127]
  ds_read_b64_tr_b16 v[222:223], v9 offset:45568
  s_waitcnt vmcnt(10) lgkmcnt(8)
  v_mfma_f32_16x16x32_bf16 v[96:99], v[192:195], v[48:51], v[96:99]
  ds_read_b64_tr_b16 v[160:161], v6 offset:49152
  buffer_load_dwordx4 v[32:35], v4, s[36:39], s48 offen offset:0
  v_mfma_f32_16x16x32_bf16 v[100:103], v[192:195], v[52:55], v[100:103]
  ds_read_b64_tr_b16 v[162:163], v6 offset:49664
  v_mfma_f32_16x16x32_bf16 v[104:107], v[196:199], v[48:51], v[104:107]
  ds_read_b64_tr_b16 v[164:165], v7 offset:49152
  v_mfma_f32_16x16x32_bf16 v[108:111], v[196:199], v[52:55], v[108:111]
  ds_read_b64_tr_b16 v[166:167], v7 offset:49664
  buffer_load_dwordx4 v[36:39], v5, s[36:39], s48 offen offset:0
  v_mfma_f32_16x16x32_bf16 v[112:115], v[200:203], v[48:51], v[112:115]
  ds_read_b64_tr_b16 v[168:169], v8 offset:49152
  v_mfma_f32_16x16x32_bf16 v[116:119], v[200:203], v[52:55], v[116:119]
  ds_read_b64_tr_b16 v[170:171], v8 offset:49664
  v_mfma_f32_16x16x32_bf16 v[120:123], v[204:207], v[48:51], v[120:123]
  ds_read_b64_tr_b16 v[172:173], v9 offset:49152
  buffer_load_dwordx4 v[40:43], v4, s[36:39], s48 offen offset:1024
  v_mfma_f32_16x16x32_bf16 v[124:127], v[204:207], v[52:55], v[124:127]
  ds_read_b64_tr_b16 v[174:175], v9 offset:49664
  s_waitcnt vmcnt(11) lgkmcnt(8)
  v_mfma_f32_16x16x32_bf16 v[96:99], v[208:211], v[56:59], v[96:99]
  ds_read_b64_tr_b16 v[176:177], v6 offset:53248
  v_mfma_f32_16x16x32_bf16 v[100:103], v[208:211], v[60:63], v[100:103]
  ds_read_b64_tr_b16 v[178:179], v6 offset:53760
  buffer_load_dwordx4 v[44:47], v5, s[36:39], s48 offen offset:1024
  v_mfma_f32_16x16x32_bf16 v[104:107], v[212:215], v[56:59], v[104:107]
  ds_read_b64_tr_b16 v[180:181], v7 offset:53248
  v_mfma_f32_16x16x32_bf16 v[108:111], v[212:215], v[60:63], v[108:111]
  ds_read_b64_tr_b16 v[182:183], v7 offset:53760
  v_mfma_f32_16x16x32_bf16 v[112:115], v[216:219], v[56:59], v[112:115]
  ds_read_b64_tr_b16 v[184:185], v8 offset:53248
  v_mfma_f32_16x16x32_bf16 v[116:119], v[216:219], v[60:63], v[116:119]
  ds_read_b64_tr_b16 v[186:187], v8 offset:53760
  v_readlane_b32 s49, v15, 13
  v_mfma_f32_16x16x32_bf16 v[120:123], v[220:223], v[56:59], v[120:123]
  ds_read_b64_tr_b16 v[188:189], v9 offset:53248
  v_mfma_f32_16x16x32_bf16 v[124:127], v[220:223], v[60:63], v[124:127]
  ds_read_b64_tr_b16 v[190:191], v9 offset:53760
  s_waitcnt vmcnt(10) lgkmcnt(8)
  v_mfma_f32_16x16x32_bf16 v[96:99], v[160:163], v[64:67], v[96:99]
  ds_read_b64_tr_b16 v[192:193], v6 offset:57344
  buffer_load_dwordx4 v[48:51], v4, s[36:39], s49 offen offset:0
  v_mfma_f32_16x16x32_bf16 v[100:103], v[160:163], v[68:71], v[100:103]
  ds_read_b64_tr_b16 v[194:195], v6 offset:57856
  v_mfma_f32_16x16x32_bf16 v[104:107], v[164:167], v[64:67], v[104:107]
  ds_read_b64_tr_b16 v[196:197], v7 offset:57344
  v_mfma_f32_16x16x32_bf16 v[108:111], v[164:167], v[68:71], v[108:111]
  ds_read_b64_tr_b16 v[198:199], v7 offset:57856
  buffer_load_dwordx4 v[52:55], v5, s[36:39], s49 offen offset:0
  v_mfma_f32_16x16x32_bf16 v[112:115], v[168:171], v[64:67], v[112:115]
  ds_read_b64_tr_b16 v[200:201], v8 offset:57344
  v_mfma_f32_16x16x32_bf16 v[116:119], v[168:171], v[68:71], v[116:119]
  ds_read_b64_tr_b16 v[202:203], v8 offset:57856
  v_mfma_f32_16x16x32_bf16 v[120:123], v[172:175], v[64:67], v[120:123]
  ds_read_b64_tr_b16 v[204:205], v9 offset:57344
  buffer_load_dwordx4 v[56:59], v4, s[36:39], s49 offen offset:1024
  v_mfma_f32_16x16x32_bf16 v[124:127], v[172:175], v[68:71], v[124:127]
  ds_read_b64_tr_b16 v[206:207], v9 offset:57856
  s_waitcnt vmcnt(11) lgkmcnt(8)
  v_mfma_f32_16x16x32_bf16 v[96:99], v[176:179], v[72:75], v[96:99]
  ds_read_b64_tr_b16 v[208:209], v6 offset:61440
  v_mfma_f32_16x16x32_bf16 v[100:103], v[176:179], v[76:79], v[100:103]
  ds_read_b64_tr_b16 v[210:211], v6 offset:61952
  buffer_load_dwordx4 v[60:63], v5, s[36:39], s49 offen offset:1024
  v_mfma_f32_16x16x32_bf16 v[104:107], v[180:183], v[72:75], v[104:107]
  ds_read_b64_tr_b16 v[212:213], v7 offset:61440
  v_mfma_f32_16x16x32_bf16 v[108:111], v[180:183], v[76:79], v[108:111]
  ds_read_b64_tr_b16 v[214:215], v7 offset:61952
  v_mfma_f32_16x16x32_bf16 v[112:115], v[184:187], v[72:75], v[112:115]
  ds_read_b64_tr_b16 v[216:217], v8 offset:61440
  v_mfma_f32_16x16x32_bf16 v[116:119], v[184:187], v[76:79], v[116:119]
  ds_read_b64_tr_b16 v[218:219], v8 offset:61952
  v_readlane_b32 s50, v15, 14
  v_mfma_f32_16x16x32_bf16 v[120:123], v[188:191], v[72:75], v[120:123]
  ds_read_b64_tr_b16 v[220:221], v9 offset:61440
  v_mfma_f32_16x16x32_bf16 v[124:127], v[188:191], v[76:79], v[124:127]
  ds_read_b64_tr_b16 v[222:223], v9 offset:61952
  s_waitcnt vmcnt(10) lgkmcnt(8)
  v_mfma_f32_16x16x32_bf16 v[96:99], v[192:195], v[80:83], v[96:99]
  ds_read_b64_tr_b16 v[160:161], v20 offset:0
  buffer_load_dwordx4 v[64:67], v4, s[36:39], s50 offen offset:0
  v_mfma_f32_16x16x32_bf16 v[100:103], v[192:195], v[84:87], v[100:103]
  ds_read_b64_tr_b16 v[162:163], v20 offset:512
  v_mfma_f32_16x16x32_bf16 v[104:107], v[196:199], v[80:83], v[104:107]
  ds_read_b64_tr_b16 v[164:165], v21 offset:0
  v_mfma_f32_16x16x32_bf16 v[108:111], v[196:199], v[84:87], v[108:111]
  ds_read_b64_tr_b16 v[166:167], v21 offset:512
  buffer_load_dwordx4 v[68:71], v5, s[36:39], s50 offen offset:0
  v_mfma_f32_16x16x32_bf16 v[112:115], v[200:203], v[80:83], v[112:115]
  ds_read_b64_tr_b16 v[168:169], v22 offset:0
  v_mfma_f32_16x16x32_bf16 v[116:119], v[200:203], v[84:87], v[116:119]
  ds_read_b64_tr_b16 v[170:171], v22 offset:512
  v_mfma_f32_16x16x32_bf16 v[120:123], v[204:207], v[80:83], v[120:123]
  ds_read_b64_tr_b16 v[172:173], v23 offset:0
  buffer_load_dwordx4 v[72:75], v4, s[36:39], s50 offen offset:1024
  v_mfma_f32_16x16x32_bf16 v[124:127], v[204:207], v[84:87], v[124:127]
  ds_read_b64_tr_b16 v[174:175], v23 offset:512
  s_waitcnt vmcnt(11) lgkmcnt(8)
  s_barrier
  v_mfma_f32_16x16x32_bf16 v[96:99], v[208:211], v[88:91], v[96:99]
  ds_read_b64_tr_b16 v[176:177], v20 offset:4096
  v_mfma_f32_16x16x32_bf16 v[100:103], v[208:211], v[92:95], v[100:103]
  ds_read_b64_tr_b16 v[178:179], v20 offset:4608
  buffer_load_dwordx4 v[76:79], v5, s[36:39], s50 offen offset:1024
  v_mfma_f32_16x16x32_bf16 v[104:107], v[212:215], v[88:91], v[104:107]
  ds_read_b64_tr_b16 v[180:181], v21 offset:4096
  v_mfma_f32_16x16x32_bf16 v[108:111], v[212:215], v[92:95], v[108:111]
  ds_read_b64_tr_b16 v[182:183], v21 offset:4608
  v_mfma_f32_16x16x32_bf16 v[112:115], v[216:219], v[88:91], v[112:115]
  ds_read_b64_tr_b16 v[184:185], v22 offset:4096
  v_mfma_f32_16x16x32_bf16 v[116:119], v[216:219], v[92:95], v[116:119]
  ds_read_b64_tr_b16 v[186:187], v22 offset:4608
  v_readlane_b32 s51, v15, 15
  v_mfma_f32_16x16x32_bf16 v[120:123], v[220:223], v[88:91], v[120:123]
  ds_read_b64_tr_b16 v[188:189], v23 offset:4096
  v_mfma_f32_16x16x32_bf16 v[124:127], v[220:223], v[92:95], v[124:127]
  ds_read_b64_tr_b16 v[190:191], v23 offset:4608
  s_waitcnt vmcnt(10) lgkmcnt(8)
  v_mfma_f32_16x16x32_bf16 v[96:99], v[160:163], v[32:35], v[96:99]
  ds_read_b64_tr_b16 v[192:193], v20 offset:8192
  buffer_load_dwordx4 v[80:83], v4, s[36:39], s51 offen offset:0
  v_mfma_f32_16x16x32_bf16 v[100:103], v[160:163], v[36:39], v[100:103]
  ds_read_b64_tr_b16 v[194:195], v20 offset:8704
  v_mfma_f32_16x16x32_bf16 v[104:107], v[164:167], v[32:35], v[104:107]
  ds_read_b64_tr_b16 v[196:197], v21 offset:8192
  v_mfma_f32_16x16x32_bf16 v[108:111], v[164:167], v[36:39], v[108:111]
  ds_read_b64_tr_b16 v[198:199], v21 offset:8704
  buffer_load_dwordx4 v[84:87], v5, s[36:39], s51 offen offset:0
  v_mfma_f32_16x16x32_bf16 v[112:115], v[168:171], v[32:35], v[112:115]
  ds_read_b64_tr_b16 v[200:201], v22 offset:8192
  v_mfma_f32_16x16x32_bf16 v[116:119], v[168:171], v[36:39], v[116:119]
  ds_read_b64_tr_b16 v[202:203], v22 offset:8704
  v_mfma_f32_16x16x32_bf16 v[120:123], v[172:175], v[32:35], v[120:123]
  ds_read_b64_tr_b16 v[204:205], v23 offset:8192
  buffer_load_dwordx4 v[88:91], v4, s[36:39], s51 offen offset:1024
  v_mfma_f32_16x16x32_bf16 v[124:127], v[172:175], v[36:39], v[124:127]
  ds_read_b64_tr_b16 v[206:207], v23 offset:8704
  s_waitcnt vmcnt(11) lgkmcnt(8)
  v_mfma_f32_16x16x32_bf16 v[96:99], v[176:179], v[40:43], v[96:99]
  ds_read_b64_tr_b16 v[208:209], v20 offset:12288
  v_mfma_f32_16x16x32_bf16 v[100:103], v[176:179], v[44:47], v[100:103]
  ds_read_b64_tr_b16 v[210:211], v20 offset:12800
  buffer_load_dwordx4 v[92:95], v5, s[36:39], s51 offen offset:1024
  v_mfma_f32_16x16x32_bf16 v[104:107], v[180:183], v[40:43], v[104:107]
  ds_read_b64_tr_b16 v[212:213], v21 offset:12288
  v_mfma_f32_16x16x32_bf16 v[108:111], v[180:183], v[44:47], v[108:111]
  ds_read_b64_tr_b16 v[214:215], v21 offset:12800
  v_mfma_f32_16x16x32_bf16 v[112:115], v[184:187], v[40:43], v[112:115]
  ds_read_b64_tr_b16 v[216:217], v22 offset:12288
  v_mfma_f32_16x16x32_bf16 v[116:119], v[184:187], v[44:47], v[116:119]
  ds_read_b64_tr_b16 v[218:219], v22 offset:12800
  v_mfma_f32_16x16x32_bf16 v[120:123], v[188:191], v[40:43], v[120:123]
  ds_read_b64_tr_b16 v[220:221], v23 offset:12288
  v_mfma_f32_16x16x32_bf16 v[124:127], v[188:191], v[44:47], v[124:127]
  ds_read_b64_tr_b16 v[222:223], v23 offset:12800
  s_waitcnt vmcnt(10) lgkmcnt(8)
  v_mfma_f32_16x16x32_bf16 v[96:99], v[192:195], v[48:51], v[96:99]
  ds_read_b64_tr_b16 v[160:161], v20 offset:16384
  v_mfma_f32_16x16x32_bf16 v[100:103], v[192:195], v[52:55], v[100:103]
  ds_read_b64_tr_b16 v[162:163], v20 offset:16896
  v_mfma_f32_16x16x32_bf16 v[104:107], v[196:199], v[48:51], v[104:107]
  ds_read_b64_tr_b16 v[164:165], v21 offset:16384
  v_mfma_f32_16x16x32_bf16 v[108:111], v[196:199], v[52:55], v[108:111]
  ds_read_b64_tr_b16 v[166:167], v21 offset:16896
  v_mfma_f32_16x16x32_bf16 v[112:115], v[200:203], v[48:51], v[112:115]
  ds_read_b64_tr_b16 v[168:169], v22 offset:16384
  v_mfma_f32_16x16x32_bf16 v[116:119], v[200:203], v[52:55], v[116:119]
  ds_read_b64_tr_b16 v[170:171], v22 offset:16896
  v_mfma_f32_16x16x32_bf16 v[120:123], v[204:207], v[48:51], v[120:123]
  ds_read_b64_tr_b16 v[172:173], v23 offset:16384
  v_mfma_f32_16x16x32_bf16 v[124:127], v[204:207], v[52:55], v[124:127]
  ds_read_b64_tr_b16 v[174:175], v23 offset:16896
  s_waitcnt vmcnt(8) lgkmcnt(8)
  v_mfma_f32_16x16x32_bf16 v[96:99], v[208:211], v[56:59], v[96:99]
  ds_read_b64_tr_b16 v[176:177], v20 offset:20480
  v_mfma_f32_16x16x32_bf16 v[100:103], v[208:211], v[60:63], v[100:103]
  ds_read_b64_tr_b16 v[178:179], v20 offset:20992
  v_mfma_f32_16x16x32_bf16 v[104:107], v[212:215], v[56:59], v[104:107]
  ds_read_b64_tr_b16 v[180:181], v21 offset:20480
  v_mfma_f32_16x16x32_bf16 v[108:111], v[212:215], v[60:63], v[108:111]
  ds_read_b64_tr_b16 v[182:183], v21 offset:20992
  v_mfma_f32_16x16x32_bf16 v[112:115], v[216:219], v[56:59], v[112:115]
  ds_read_b64_tr_b16 v[184:185], v22 offset:20480
  v_mfma_f32_16x16x32_bf16 v[116:119], v[216:219], v[60:63], v[116:119]
  ds_read_b64_tr_b16 v[186:187], v22 offset:20992
  v_mfma_f32_16x16x32_bf16 v[120:123], v[220:223], v[56:59], v[120:123]
  ds_read_b64_tr_b16 v[188:189], v23 offset:20480
  v_mfma_f32_16x16x32_bf16 v[124:127], v[220:223], v[60:63], v[124:127]
  ds_read_b64_tr_b16 v[190:191], v23 offset:20992
  s_waitcnt vmcnt(6) lgkmcnt(8)
  v_mfma_f32_16x16x32_bf16 v[96:99], v[160:163], v[64:67], v[96:99]
  ds_read_b64_tr_b16 v[192:193], v20 offset:24576
  v_mfma_f32_16x16x32_bf16 v[100:103], v[160:163], v[68:71], v[100:103]
  ds_read_b64_tr_b16 v[194:195], v20 offset:25088
  v_mfma_f32_16x16x32_bf16 v[104:107], v[164:167], v[64:67], v[104:107]
  ds_read_b64_tr_b16 v[196:197], v21 offset:24576
  v_mfma_f32_16x16x32_bf16 v[108:111], v[164:167], v[68:71], v[108:111]
  ds_read_b64_tr_b16 v[198:199], v21 offset:25088
  v_mfma_f32_16x16x32_bf16 v[112:115], v[168:171], v[64:67], v[112:115]
  ds_read_b64_tr_b16 v[200:201], v22 offset:24576
  v_mfma_f32_16x16x32_bf16 v[116:119], v[168:171], v[68:71], v[116:119]
  ds_read_b64_tr_b16 v[202:203], v22 offset:25088
  v_mfma_f32_16x16x32_bf16 v[120:123], v[172:175], v[64:67], v[120:123]
  ds_read_b64_tr_b16 v[204:205], v23 offset:24576
  v_mfma_f32_16x16x32_bf16 v[124:127], v[172:175], v[68:71], v[124:127]
  ds_read_b64_tr_b16 v[206:207], v23 offset:25088
  s_waitcnt vmcnt(4) lgkmcnt(8)
  v_mfma_f32_16x16x32_bf16 v[96:99], v[176:179], v[72:75], v[96:99]
  ds_read_b64_tr_b16 v[208:209], v20 offset:28672
  v_mfma_f32_16x16x32_bf16 v[100:103], v[176:179], v[76:79], v[100:103]
  ds_read_b64_tr_b16 v[210:211], v20 offset:29184
  v_mfma_f32_16x16x32_bf16 v[104:107], v[180:183], v[72:75], v[104:107]
  ds_read_b64_tr_b16 v[212:213], v21 offset:28672
  v_mfma_f32_16x16x32_bf16 v[108:111], v[180:183], v[76:79], v[108:111]
  ds_read_b64_tr_b16 v[214:215], v21 offset:29184
  v_mfma_f32_16x16x32_bf16 v[112:115], v[184:187], v[72:75], v[112:115]
  ds_read_b64_tr_b16 v[216:217], v22 offset:28672
  v_mfma_f32_16x16x32_bf16 v[116:119], v[184:187], v[76:79], v[116:119]
  ds_read_b64_tr_b16 v[218:219], v22 offset:29184
  v_mfma_f32_16x16x32_bf16 v[120:123], v[188:191], v[72:75], v[120:123]
  ds_read_b64_tr_b16 v[220:221], v23 offset:28672
  v_mfma_f32_16x16x32_bf16 v[124:127], v[188:191], v[76:79], v[124:127]
  ds_read_b64_tr_b16 v[222:223], v23 offset:29184
  s_waitcnt vmcnt(2) lgkmcnt(8)
  v_mfma_f32_16x16x32_bf16 v[96:99], v[192:195], v[80:83], v[96:99]
  v_mov_b32 v20, 0
  v_mov_b32 v21, 0
  v_mfma_f32_16x16x32_bf16 v[100:103], v[192:195], v[84:87], v[100:103]
  v_mov_b32 v22, 0
  v_mov_b32 v23, 0
  v_mfma_f32_16x16x32_bf16 v[104:107], v[196:199], v[80:83], v[104:107]
  v_mfma_f32_16x16x32_bf16 v[108:111], v[196:199], v[84:87], v[108:111]
  v_mfma_f32_16x16x32_bf16 v[112:115], v[200:203], v[80:83], v[112:115]
  v_mfma_f32_16x16x32_bf16 v[116:119], v[200:203], v[84:87], v[116:119]
  v_mfma_f32_16x16x32_bf16 v[120:123], v[204:207], v[80:83], v[120:123]
  v_mfma_f32_16x16x32_bf16 v[124:127], v[204:207], v[84:87], v[124:127]
  s_waitcnt vmcnt(0) lgkmcnt(0)
  s_barrier
  v_mfma_f32_16x16x32_bf16 v[96:99], v[208:211], v[88:91], v[96:99]
  v_mfma_f32_16x16x32_bf16 v[100:103], v[208:211], v[92:95], v[100:103]
  v_mfma_f32_16x16x32_bf16 v[104:107], v[212:215], v[88:91], v[104:107]
  v_mfma_f32_16x16x32_bf16 v[108:111], v[212:215], v[92:95], v[108:111]
  v_mfma_f32_16x16x32_bf16 v[112:115], v[216:219], v[88:91], v[112:115]
  v_mfma_f32_16x16x32_bf16 v[116:119], v[216:219], v[92:95], v[116:119]
  v_mfma_f32_16x16x32_bf16 v[120:123], v[220:223], v[88:91], v[120:123]
  v_mfma_f32_16x16x32_bf16 v[124:127], v[220:223], v[92:95], v[124:127]
  s_mov_b32 s3, 32768
  s_mov_b32 s10, 0x3f803f80
  s_nop 4
  v_cvt_pk_bf16_f32 v240, v96, v97
  v_cvt_pk_bf16_f32 v241, v98, v99
  v_cvt_pk_bf16_f32 v242, v104, v105
  v_cvt_pk_bf16_f32 v243, v106, v107
  s_nop 1
  v_permlane16_swap_b32 v240, v242
  v_permlane16_swap_b32 v241, v243
  buffer_store_dwordx4 v[240:243], v12, s[44:47], 0 offen offset:0 sc1
  v_cvt_pk_bf16_f32 v244, v112, v113
  v_cvt_pk_bf16_f32 v245, v114, v115
  v_cvt_pk_bf16_f32 v246, v120, v121
  v_cvt_pk_bf16_f32 v247, v122, v123
  s_nop 1
  v_permlane16_swap_b32 v244, v246
  v_permlane16_swap_b32 v245, v247
  buffer_store_dwordx4 v[244:247], v12, s[44:47], 0 offen offset:1024 sc1
  v_cvt_pk_bf16_f32 v248, v100, v101
  v_cvt_pk_bf16_f32 v249, v102, v103
  v_cvt_pk_bf16_f32 v250, v108, v109
  v_cvt_pk_bf16_f32 v251, v110, v111
  s_nop 1
  v_permlane16_swap_b32 v248, v250
  v_permlane16_swap_b32 v249, v251
  buffer_store_dwordx4 v[248:251], v12, s[44:47], s3 offen offset:0 sc1
  v_cvt_pk_bf16_f32 v252, v116, v117
  v_cvt_pk_bf16_f32 v253, v118, v119
  v_cvt_pk_bf16_f32 v254, v124, v125
  v_cvt_pk_bf16_f32 v255, v126, v127
  s_nop 1
  v_permlane16_swap_b32 v252, v254
  v_permlane16_swap_b32 v253, v255
  buffer_store_dwordx4 v[252:255], v12, s[44:47], s3 offen offset:1024 sc1
  v_dot2_f32_bf16 v20, v240, s10, v20
  v_dot2_f32_bf16 v22, v240, v240, v22
  v_dot2_f32_bf16 v20, v241, s10, v20
  v_dot2_f32_bf16 v22, v241, v241, v22
  v_dot2_f32_bf16 v20, v242, s10, v20
  v_dot2_f32_bf16 v22, v242, v242, v22
  v_dot2_f32_bf16 v20, v243, s10, v20
  v_dot2_f32_bf16 v22, v243, v243, v22
  v_dot2_f32_bf16 v20, v244, s10, v20
  v_dot2_f32_bf16 v22, v244, v244, v22
  v_dot2_f32_bf16 v20, v245, s10, v20
  v_dot2_f32_bf16 v22, v245, v245, v22
  v_dot2_f32_bf16 v20, v246, s10, v20
  v_dot2_f32_bf16 v22, v246, v246, v22
  v_dot2_f32_bf16 v20, v247, s10, v20
  v_dot2_f32_bf16 v22, v247, v247, v22
  v_dot2_f32_bf16 v21, v248, s10, v21
  v_dot2_f32_bf16 v23, v248, v248, v23
  v_dot2_f32_bf16 v21, v249, s10, v21
  v_dot2_f32_bf16 v23, v249, v249, v23
  v_dot2_f32_bf16 v21, v250, s10, v21
  v_dot2_f32_bf16 v23, v250, v250, v23
  v_dot2_f32_bf16 v21, v251, s10, v21
  v_dot2_f32_bf16 v23, v251, v251, v23
  v_dot2_f32_bf16 v21, v252, s10, v21
  v_dot2_f32_bf16 v23, v252, v252, v23
  v_dot2_f32_bf16 v21, v253, s10, v21
  v_dot2_f32_bf16 v23, v253, v253, v23
  v_dot2_f32_bf16 v21, v254, s10, v21
  v_dot2_f32_bf16 v23, v254, v254, v23
  v_dot2_f32_bf16 v21, v255, s10, v21
  v_dot2_f32_bf16 v23, v255, v255, v23
  s_nop 2
  v_permlane32_swap_b32 v20, v21
  v_permlane32_swap_b32 v22, v23
  v_add_f32 v20, v20, v21
  v_add_f32 v22, v22, v23
  s_nop 1
  v_permlane16_swap_b32 v20, v22
  v_add_f32 v20, v20, v22
  buffer_store_dword v20, v18, s[56:59], 0 offen sc1
  s_waitcnt vmcnt(0) lgkmcnt(0)
  s_barrier
  s_add_u32 s97, s97, 1
  s_branch L_w1_body
L_wo_c1:
L_w1_c0:
L_w1_body:
  s_cmp_ge_u32 s2, 256
  s_cbranch_scc1 L_w1_end
  v_lshrrev_b32 v2, 6, v0
  v_and_b32 v1, 63, v0
  v_readfirstlane_b32 s70, v2
  s_and_b32 s3, s2, 7
  s_lshr_b32 s99, s2, 3
  s_and_b32 s5, s3, 1
  s_lshl_b32 s5, s5, 3
  s_and_b32 s6, s99, 7
  s_add_u32 s68, s5, s6
  s_lshr_b32 s5, s3, 1
  s_lshl_b32 s5, s5, 2
  s_lshr_b32 s6, s99, 3
  s_add_u32 s69, s5, s6
  s_cmp_lt_u32 s70, 4
  s_cbranch_scc1 L_w1_compute
L_w1_loader:
  s_add_u32 s8, s70, s69
  s_and_b32 s8, s8, 3
  s_add_u32 s9, s70, s68
  s_and_b32 s9, s9, 3
  s_lshl_b32 s76, s8, 12
  s_lshl_b32 s77, s9, 11
  s_add_u32 s77, s77, 16384
  s_lshl_b32 s11, s68, 7
  v_and_b32 v10, 7, v1
  s_lshr_b32 s10, s76, 11
  s_lshl_b32 s3, s68, 3
  s_add_u32 s10, s10, s3
  s_mul_i32 s10, s10, 32768
  v_lshl_add_u32 v4, v1, 4, s10
  v_add_u32 v5, 32768, v4
  v_lshrrev_b32 v3, 3, v1
  s_lshl_b32 s10, s9, 4
  v_add_u32 v3, s10, v3
  v_mul_u32_u24 v3, 7168, v3
  v_lshrrev_b32 v2, 3, v1
  v_and_b32 v2, 2, v2
  v_xor_b32 v2, v2, v10
  s_mul_i32 s10, s69, 128
  v_add_u32 v3, s10, v3
  v_lshl_add_u32 v8, v2, 4, v3
  v_xor_b32 v2, 4, v2
  v_add_u32 v3, 57344, v3
  v_lshl_add_u32 v9, v2, 4, v3
  v_lshrrev_b32 v3, 2, v1
  s_lshl_b32 s10, s9, 4
  v_add_u32 v3, s10, v3
  v_mul_u32_u24 v3, 7168, v3
  v_lshrrev_b32 v2, 4, v1
  v_and_b32 v2, 2, v2
  v_xor_b32 v2, v2, v1
  v_and_b32 v2, 3, v2
  s_lshl_b32 s10, s69, 6
  s_add_u32 s10, s10, 2048
  v_add_u32 v3, s10, v3
  v_lshl_add_u32 v28, v2, 4, v3
  s_lshl_b32 s78, s69, 7
  s_add_u32 s78, s78, 3072
  s_mov_b32 s75, 0
  s_add_u32 s100, s68, s69
  s_mov_b32 s101, -1
  s_add_u32 s101, s101, 1
  s_sub_u32 s73, s101, s100
  s_lshl_b32 s73, s73, 3
  s_lshr_b32 s73, 0xf0f02, s73
  s_and_b32 s73, s73, 255
  s_add_u32 s73, s73, s101
  s_and_b32 s73, s73, 15
  s_mul_i32 s74, s73, 458752
  s_lshl_b32 s73, s73, 11
  s_waitcnt lgkmcnt(0)
  s_add_u32 s36, s34, 4194304
  s_addc_u32 s37, s35, 0
  s_and_b32 s37, s37, 0xffff
  s_mov_b32 s38, 4194304
  s_mov_b32 s39, 0x00020000
  s_mov_b32 s40, s24
  s_and_b32 s41, s25, 0xffff
  s_mov_b32 s42, 7340032
  s_mov_b32 s43, 0x00020000
  s_add_u32 s56, s34, 24117248
  s_addc_u32 s57, s35, 0
  s_and_b32 s57, s57, 0xffff
  s_mov_b32 s58, 262144
  s_mov_b32 s59, 0x00020000
  s_add_u32 s64, s22, 24641536
  s_addc_u32 s65, s23, 0
  s_and_b32 s65, s65, 0xffff
  s_mov_b32 s66, 262144
  s_mov_b32 s67, 0x00020000
  s_mov_b32 s52, s26
  s_and_b32 s53, s27, 0xffff
  s_mov_b32 s54, 7168
  s_mov_b32 s55, 0x00020000
  s_mov_b32 s60, s28
  s_and_b32 s61, s29, 0xffff
  s_mov_b32 s62, 7340032
  s_mov_b32 s63, 0x00020000
  s_cmp_eq_u32 s96, 0
  s_cselect_b32 s62, s62, 0
  s_and_b32 s3, s70, 3
  s_lshl_b32 s4, s2, 2
  s_add_u32 s3, s3, s4
  s_mul_i32 s98, s3, 3584
  s_add_u32 s98, s98, 3670016
  s_add_u32 s3, s96, s70
  s_cmp_lg_u32 s3, 4
  s_cbranch_scc1 L_w1_chk
  s_add_u32 s44, s22, 24903680
  s_addc_u32 s45, s23, 0
  s_and_b32 s45, s45, 0xffff
  s_mov_b32 s46, 32768
  s_mov_b32 s47, 0x00020000
  s_mov_b32 s79, 0x100000
  v_lshrrev_b32 v2, 2, v1
  v_and_b32 v3, 3, v1
  v_lshlrev_b32 v2, 8, v2
  v_lshl_add_u32 v2, v3, 4, v2
L_w1_chkl:
  buffer_load_dwordx4 v[12:15], v2, s[44:47], 0 offen sc1
  s_sub_u32 s79, s79, 1
  s_cbranch_scc1 L_w1_chk
  s_waitcnt vmcnt(0)
  v_and_b32 v12, v12, v13
  v_and_b32 v14, v14, v15
  v_and_b32 v12, v12, v14
  v_cmp_ne_u32 vcc, 1, v12
  s_cbranch_vccnz L_w1_chkl
L_w1_chk:
  s_mov_b32 s88, s73
  s_add_u32 m0, s77, 0
  s_add_u32 s4, s74, 0
  buffer_load_dwordx4 v8, s[40:43], s4 offen lds
  s_add_u32 m0, s77, 1024
  s_nop 0
  buffer_load_dwordx4 v9, s[40:43], s4 offen lds
  s_add_u32 m0, s77, 8192
  s_add_u32 s4, s74, s78
  buffer_load_dwordx4 v8, s[40:43], s4 offen lds
  s_add_u32 m0, s77, 9216
  s_nop 0
  buffer_load_dwordx4 v9, s[40:43], s4 offen lds
  s_add_u32 m0, s77, 16384
  s_add_u32 s4, s4, 128
  buffer_load_dwordx4 v8, s[40:43], s4 offen lds
  s_add_u32 m0, s77, 17408
  s_nop 0
  buffer_load_dwordx4 v9, s[40:43], s4 offen lds
  s_add_u32 m0, s77, 24576
  s_nop 0
  buffer_load_dwordx4 v28, s[40:43], s74 offen lds
  s_add_u32 s101, s101, 1
  s_sub_u32 s73, s101, s100
  s_lshl_b32 s73, s73, 3
  s_lshr_b32 s73, 0xf0f02, s73
  s_and_b32 s73, s73, 255
  s_add_u32 s73, s73, s101
  s_and_b32 s73, s73, 15
  s_mul_i32 s74, s73, 458752
  s_lshl_b32 s73, s73, 11
  s_mov_b32 s89, s73
  s_add_u32 m0, s77, 49152
  s_add_u32 s4, s74, 0
  buffer_load_dwordx4 v8, s[40:43], s4 offen lds
  s_add_u32 m0, s77, 50176
  s_nop 0
  buffer_load_dwordx4 v9, s[40:43], s4 offen lds
  s_add_u32 m0, s77, 57344
  s_add_u32 s4, s74, s78
  buffer_load_dwordx4 v8, s[40:43], s4 offen lds
  s_add_u32 m0, s77, 58368
  s_nop 0
  buffer_load_dwordx4 v9, s[40:43], s4 offen lds
  s_add_u32 m0, s77, 65536
  s_add_u32 s4, s4, 128
  buffer_load_dwordx4 v8, s[40:43], s4 offen lds
  s_add_u32 m0, s77, 66560
  s_nop 0
  buffer_load_dwordx4 v9, s[40:43], s4 offen lds
  s_add_u32 m0, s77, 73728
  s_nop 0
  buffer_load_dwordx4 v28, s[40:43], s74 offen lds
  s_add_u32 s101, s101, 1
  s_sub_u32 s73, s101, s100
  s_lshl_b32 s73, s73, 3
  s_lshr_b32 s73, 0xf0f02, s73
  s_and_b32 s73, s73, 255
  s_add_u32 s73, s73, s101
  s_and_b32 s73, s73, 15
  s_mul_i32 s74, s73, 458752
  s_lshl_b32 s73, s73, 11
  s_mov_b32 s75, 98304
  s_add_u32 s44, s22, 24903680
  s_addc_u32 s45, s23, 0
  s_and_b32 s45, s45, 0xffff
  s_mov_b32 s46, 32768
  s_mov_b32 s47, 0x00020000
  s_lshl_b32 s3, s97, 12
  s_lshl_b32 s4, s68, 8
  s_add_u32 s3, s3, s4
  s_sub_u32 s3, s3, 4096
  v_and_b32 v2, 15, v1
  v_lshlrev_b32 v2, 2, v2
  v_mov_b32 v3, 1
  s_mov_b32 s79, 0x100000
  s_cmp_lg_u32 s70, 4
  s_barrier
  s_cbranch_scc1 L_w1_dep
  s_mov_b64 exec, 1
  buffer_store_dword v3, off, s[44:47], s87 sc1
  s_mov_b64 exec, -1
L_w1_poll:
  buffer_load_dword v3, v2, s[44:47], s3 offen sc1
  s_sub_u32 s79, s79, 1
  s_cbranch_scc1 L_w1_dep
  s_waitcnt vmcnt(0)
  v_cmp_ne_u32 vcc, 1, v3
  s_cbranch_vccnz L_w1_poll
L_w1_dep:
  s_barrier
  s_add_u32 m0, s76, 0
  s_nop 0
  buffer_load_dwordx4 v4, s[36:39], s88 offen offset:0 lds
  buffer_load_dwordx4 v4, s[36:39], s88 offen offset:1024 lds
  s_add_u32 m0, s76, 2048
  s_nop 0
  buffer_load_dwordx4 v5, s[36:39], s88 offen offset:0 lds
  buffer_load_dwordx4 v5, s[36:39], s88 offen offset:1024 lds
  s_add_u32 m0, s76, 49152
  s_nop 0
  buffer_load_dwordx4 v4, s[36:39], s89 offen offset:0 lds
  buffer_load_dwordx4 v4, s[36:39], s89 offen offset:1024 lds
  s_add_u32 m0, s76, 51200
  s_nop 0
  buffer_load_dwordx4 v5, s[36:39], s89 offen offset:0 lds
  buffer_load_dwordx4 v5, s[36:39], s89 offen offset:1024 lds
  s_waitcnt vmcnt(4)
  s_barrier
  s_mov_b32 s79, 13
L_w1_ld1:
  s_add_u32 s3, s75, s76
  s_add_u32 m0, s3, 0
  s_nop 0
  buffer_load_dwordx4 v4, s[36:39], s73 offen offset:0 lds
  buffer_load_dwordx4 v4, s[36:39], s73 offen offset:1024 lds
  s_add_u32 m0, s3, 2048
  s_nop 0
  buffer_load_dwordx4 v5, s[36:39], s73 offen offset:0 lds
  buffer_load_dwordx4 v5, s[36:39], s73 offen offset:1024 lds
  s_add_u32 s3, s75, s77
  s_add_u32 m0, s3, 0
  s_add_u32 s4, s74, 0
  buffer_load_dwordx4 v8, s[40:43], s4 offen lds
  s_add_u32 m0, s3, 1024
  s_nop 0
  buffer_load_dwordx4 v9, s[40:43], s4 offen lds
  s_add_u32 m0, s3, 8192
  s_add_u32 s4, s74, s78
  buffer_load_dwordx4 v8, s[40:43], s4 offen lds
  s_add_u32 m0, s3, 9216
  s_nop 0
  buffer_load_dwordx4 v9, s[40:43], s4 offen lds
  s_add_u32 m0, s3, 16384
  s_add_u32 s4, s4, 128
  buffer_load_dwordx4 v8, s[40:43], s4 offen lds
  s_add_u32 m0, s3, 17408
  s_nop 0
  buffer_load_dwordx4 v9, s[40:43], s4 offen lds
  s_add_u32 m0, s3, 24576
  s_nop 0
  buffer_load_dwordx4 v28, s[40:43], s74 offen lds
  s_add_u32 s101, s101, 1
  s_sub_u32 s73, s101, s100
  s_lshl_b32 s73, s73, 3
  s_lshr_b32 s73, 0xf0f02, s73
  s_and_b32 s73, s73, 255
  s_add_u32 s73, s73, s101
  s_and_b32 s73, s73, 15
  s_mul_i32 s74, s73, 458752
  s_lshl_b32 s73, s73, 11
  s_add_u32 s75, s75, 49152
  s_cmp_eq_u32 s75, 147456
  s_cselect_b32 s75, 0, s75
  s_buffer_load_dword s84, s[60:63], s98 offset:0
  s_buffer_load_dword s84, s[60:63], s98 offset:64
  s_buffer_load_dword s84, s[60:63], s98 offset:128
  s_buffer_load_dword s84, s[60:63], s98 offset:192
  s_add_u32 s98, s98, 256
  s_waitcnt vmcnt(11)
  s_barrier
  s_sub_u32 s79, s79, 1
  s_cmp_lg_u32 s79, 0
  s_cbranch_scc1 L_w1_ld1
  s_add_u32 s3, s75, s76
  s_add_u32 m0, s3, 0
  s_nop 0
  buffer_load_dwordx4 v4, s[36:39], s73 offen offset:0 lds
  buffer_load_dwordx4 v4, s[36:39], s73 offen offset:1024 lds
  s_add_u32 m0, s3, 2048
  s_nop 0
  buffer_load_dwordx4 v5, s[36:39], s73 offen offset:0 lds
  buffer_load_dwordx4 v5, s[36:39], s73 offen offset:1024 lds
  s_add_u32 s3, s75, s77
  s_add_u32 m0, s3, 0
  s_add_u32 s4, s74, 0
  buffer_load_dwordx4 v8, s[40:43], s4 offen lds
  s_add_u32 m0, s3, 1024
  s_nop 0
  buffer_load_dwordx4 v9, s[40:43], s4 offen lds
  s_add_u32 m0, s3, 8192
  s_add_u32 s4, s74, s78
  buffer_load_dwordx4 v8, s[40:43], s4 offen lds
  s_add_u32 m0, s3, 9216
  s_nop 0
  buffer_load_dwordx4 v9, s[40:43], s4 offen lds
  s_add_u32 m0, s3, 16384
  s_add_u32 s4, s4, 128
  buffer_load_dwordx4 v8, s[40:43], s4 offen lds
  s_add_u32 m0, s3, 17408
  s_nop 0
  buffer_load_dwordx4 v9, s[40:43], s4 offen lds
  s_add_u32 m0, s3, 24576
  s_nop 0
  buffer_load_dwordx4 v28, s[40:43], s74 offen lds
  s_add_u32 s101, s101, 1
  s_sub_u32 s73, s101, s100
  s_lshl_b32 s73, s73, 3
  s_lshr_b32 s73, 0xf0f02, s73
  s_and_b32 s73, s73, 255
  s_add_u32 s73, s73, s101
  s_and_b32 s73, s73, 15
  s_mul_i32 s74, s73, 458752
  s_lshl_b32 s73, s73, 11
  s_add_u32 s75, s75, 49152
  s_cmp_eq_u32 s75, 147456
  s_cselect_b32 s75, 0, s75
  s_buffer_load_dword s84, s[60:63], s98 offset:0
  s_buffer_load_dword s84, s[60:63], s98 offset:64
  s_buffer_load_dword s84, s[60:63], s98 offset:128
  s_buffer_load_dword s84, s[60:63], s98 offset:192
  s_add_u32 s98, s98, 256
  s_and_b32 s3, s70, 3
  s_lshl_b32 s4, s68, 7
  s_lshl_b32 s5, s3, 6
  s_add_u32 s5, s5, s4
  v_add_u32 v2, s5, v1
  s_sub_u32 s4, s4, 16
  v_and_b32 v3, 15, v1
  v_add_u32 v3, s4, v3
  v_max_i32 v3, 0, v3
  s_cmp_ge_u32 s3, 2
  s_cselect_b64 vcc, -1, 0
  v_cndmask_b32 v2, v2, v3, vcc
  v_lshlrev_b32 v2, 3, v2
  s_mov_b32 s3, 0
  buffer_load_dwordx2 v[32:33], v2, s[56:59], s3 offen
  s_add_u32 s3, s3, 16384
  buffer_load_dwordx2 v[34:35], v2, s[56:59], s3 offen
  s_add_u32 s3, s3, 16384
  buffer_load_dwordx2 v[36:37], v2, s[56:59], s3 offen
  s_add_u32 s3, s3, 16384
  buffer_load_dwordx2 v[38:39], v2, s[56:59], s3 offen
  s_add_u32 s3, s3, 16384
  buffer_load_dwordx2 v[40:41], v2, s[56:59], s3 offen
  s_add_u32 s3, s3, 16384
  buffer_load_dwordx2 v[42:43], v2, s[56:59], s3 offen
  s_add_u32 s3, s3, 16384
  buffer_load_dwordx2 v[44:45], v2, s[56:59], s3 offen
  s_add_u32 s3, s3, 16384
  buffer_load_dwordx2 v[46:47], v2, s[56:59], s3 offen
  s_add_u32 s3, s3, 16384
  buffer_load_dwordx2 v[48:49], v2, s[56:59], s3 offen
  s_add_u32 s3, s3, 16384
  buffer_load_dwordx2 v[50:51], v2, s[56:59], s3 offen
  s_add_u32 s3, s3, 16384
  buffer_load_dwordx2 v[52:53], v2, s[56:59], s3 offen
  s_add_u32 s3, s3, 16384
  buffer_load_dwordx2 v[54:55], v2, s[56:59], s3 offen
  s_add_u32 s3, s3, 16384
  buffer_load_dwordx2 v[56:57], v2, s[56:59], s3 offen
  s_add_u32 s3, s3, 16384
  buffer_load_dwordx2 v[58:59], v2, s[56:59], s3 offen
  s_add_u32 s3, s3, 16384
  buffer_load_dwordx2 v[60:61], v2, s[56:59], s3 offen
  s_add_u32 s3, s3, 16384
  buffer_load_dwordx2 v[62:63], v2, s[56:59], s3 offen
  s_lshl_b32 s4, s69, 7
  s_lshl_b32 s5, s70, 6
  s_add_u32 s4, s4, s5
  s_add_u32 s4, s4, 1216
  s_lshl_b32 s5, s69, 6
  s_cmp_eq_u32 s70, 4
  s_cselect_b32 s4, s5, s4
  s_lshr_b32 s5, s5, 1
  s_add_u32 s5, s5, 1024
  s_cmp_eq_u32 s70, 7
  s_cselect_b32 s4, s5, s4
  v_add_u32 v3, s4, v1
  v_lshlrev_b32 v2, 2, v3
  v_lshlrev_b32 v3, 1, v3
  s_mov_b32 s3, 0
  buffer_load_dword v64, v2, s[64:67], s3 offen
  s_add_u32 s3, s3, 16384
  buffer_load_dword v65, v2, s[64:67], s3 offen
  s_add_u32 s3, s3, 16384
  buffer_load_dword v66, v2, s[64:67], s3 offen
  s_add_u32 s3, s3, 16384
  buffer_load_dword v67, v2, s[64:67], s3 offen
  s_add_u32 s3, s3, 16384
  buffer_load_dword v68, v2, s[64:67], s3 offen
  s_add_u32 s3, s3, 16384
  buffer_load_dword v69, v2, s[64:67], s3 offen
  s_add_u32 s3, s3, 16384
  buffer_load_dword v70, v2, s[64:67], s3 offen
  s_add_u32 s3, s3, 16384
  buffer_load_dword v71, v2, s[64:67], s3 offen
  s_add_u32 s3, s3, 16384
  buffer_load_dword v72, v2, s[64:67], s3 offen
  s_add_u32 s3, s3, 16384
  buffer_load_dword v73, v2, s[64:67], s3 offen
  s_add_u32 s3, s3, 16384
  buffer_load_dword v74, v2, s[64:67], s3 offen
  s_add_u32 s3, s3, 16384
  buffer_load_dword v75, v2, s[64:67], s3 offen
  s_add_u32 s3, s3, 16384
  buffer_load_dword v76, v2, s[64:67], s3 offen
  s_add_u32 s3, s3, 16384
  buffer_load_dword v77, v2, s[64:67], s3 offen
  s_add_u32 s3, s3, 16384
  buffer_load_dword v78, v2, s[64:67], s3 offen
  s_add_u32 s3, s3, 16384
  buffer_load_dword v79, v2, s[64:67], s3 offen
  buffer_load_ushort v80, v3, s[52:55], 0 offen
  s_waitcnt vmcnt(44)
  s_barrier
  s_waitcnt vmcnt(33)
  s_barrier
  s_waitcnt vmcnt(0)
  v_add_f32 v32, v32, v34
  v_add_f32 v33, v33, v35
  v_add_f32 v48, v48, v50
  v_add_f32 v49, v49, v51
  v_add_f32 v32, v32, v36
  v_add_f32 v33, v33, v37
  v_add_f32 v48, v48, v52
  v_add_f32 v49, v49, v53
  v_add_f32 v32, v32, v38
  v_add_f32 v33, v33, v39
  v_add_f32 v48, v48, v54
  v_add_f32 v49, v49, v55
  v_add_f32 v32, v32, v40
  v_add_f32 v33, v33, v41
  v_add_f32 v48, v48, v56
  v_add_f32 v49, v49, v57
  v_add_f32 v32, v32, v42
  v_add_f32 v33, v33, v43
  v_add_f32 v48, v48, v58
  v_add_f32 v49, v49, v59
  v_add_f32 v32, v32, v44
  v_add_f32 v33, v33, v45
  v_add_f32 v48, v48, v60
  v_add_f32 v49, v49, v61
  v_add_f32 v32, v32, v46
  v_add_f32 v33, v33, v47
  v_add_f32 v48, v48, v62
  v_add_f32 v49, v49, v63
  v_add_f32 v32, v32, v48
  v_add_f32 v33, v33, v49
  v_mul_f32 v32, 0x3a800000, v32
  v_mul_f32 v33, 0x3a800000, v33
  v_fma_f32 v33, -v32, v32, v33
  v_max_f32 v33, 0, v33
  v_add_f32 v33, 0x3727c5ac, v33
  v_rsq_f32 v33, v33
  s_nop 0
  s_and_b32 s3, s70, 3
  s_lshl_b32 s5, s3, 6
  s_add_u32 s5, s5, 16
  v_add_u32 v2, s5, v1
  v_and_b32 v3, 15, v1
  s_cmp_ge_u32 s3, 2
  s_cselect_b64 vcc, -1, 0
  v_cndmask_b32 v2, v2, v3, vcc
  v_lshlrev_b32 v2, 2, v2
  v_add_u32 v2, 147456, v2
  ds_write2_b32 v2, v32, v33 offset0:0 offset1:160
  v_add_f32 v64, v64, v72
  v_add_f32 v65, v65, v73
  v_add_f32 v66, v66, v74
  v_add_f32 v67, v67, v75
  v_add_f32 v68, v68, v76
  v_add_f32 v69, v69, v77
  v_add_f32 v70, v70, v78
  v_add_f32 v71, v71, v79
  v_add_f32 v64, v64, v68
  v_add_f32 v65, v65, v69
  v_add_f32 v66, v66, v70
  v_add_f32 v67, v67, v71
  v_add_f32 v64, v64, v65
  v_add_f32 v66, v66, v67
  v_add_f32 v64, v64, v66
  v_lshlrev_b32 v80, 16, v80
  v_lshlrev_b32 v2, 2, v0
  v_add_u32 v2, 147712, v2
  ds_write_b32 v2, v64
  ds_write_b32 v2, v80 offset:1024
  s_waitcnt lgkmcnt(0)
  s_barrier
  s_lshl_b32 s87, s97, 12
  s_lshl_b32 s4, s68, 8
  s_add_u32 s87, s87, s4
  s_lshl_b32 s4, s69, 2
  s_add_u32 s87, s87, s4
  s_add_u32 s97, s97, 1
  s_branch L_w2_body
L_w1_end:
  s_endpgm
L_w1_compute:
  s_and_b32 s71, s70, 1
  s_lshr_b32 s72, s70, 1
  v_and_b32 v3, 15, v1
  v_lshrrev_b32 v2, 4, v1
  s_lshl_b32 s8, s71, 13
  v_lshl_add_u32 v4, v1, 4, s8
  v_bfe_u32 v13, v1, 2, 2
  v_lshl_add_u32 v13, v2, 3, v13
  v_lshlrev_b32 v13, 7, v13
  v_and_b32 v17, 3, v1
  v_lshl_add_u32 v13, v17, 3, v13
  v_bfe_u32 v17, v1, 3, 2
  v_lshl_add_u32 v13, v17, 5, v13
  s_lshl_b32 s9, s72, 6
  v_xor_b32 v13, s9, v13
  v_add_u32 v5, 16384, v13
  v_xor_b32 v6, 32, v5
  v_and_b32 v16, 1, v2
  v_lshrrev_b32 v17, 1, v2
  v_bfe_u32 v13, v1, 2, 2
  v_lshl_add_u32 v13, v16, 3, v13
  v_lshl_add_u32 v13, v17, 5, v13
  v_xor_b32 v14, s72, v16
  v_lshl_add_u32 v13, v13, 1, v14
  v_and_b32 v14, 3, v1
  v_lshl_add_u32 v13, v13, 2, v14
  v_lshlrev_b32 v13, 3, v13
  v_add_u32 v7, 40960, v13
  s_lshl_b32 s8, s68, 7
  s_lshl_b32 s9, s71, 6
  s_add_u32 s8, s8, s9
  s_mul_i32 s8, s8, 7168
  v_lshlrev_b32 v14, 8, v17
  v_lshl_add_u32 v14, v3, 4, v14
  v_add_u32 v14, s8, v14
  s_lshl_b32 s10, s69, 11
  s_lshl_b32 s9, s72, 10
  s_add_u32 s9, s9, s10
  v_lshl_add_u32 v12, v16, 9, v14
  v_add_u32 v12, s9, v12
  v_mul_u32_u24 v16, 114688, v16
  s_lshr_b32 s9, s9, 1
  v_add3_u32 v13, v16, v14, s9
  s_lshl_b32 s9, s71, 8
  s_add_u32 s9, s9, 147520
  v_lshl_add_u32 v14, v3, 2, s9
  s_lshl_b32 s9, s72, 7
  s_add_u32 s9, s9, 148736
  v_lshl_add_u32 v15, v2, 4, s9
  s_lshl_b32 s9, s72, 6
  s_add_u32 s9, s9, 148736
  v_lshl_add_u32 v16, v2, 4, s9
  v_mov_b32 v128, 0
  v_mov_b32 v129, 0
  v_mov_b32 v130, 0
  v_mov_b32 v131, 0
  v_mov_b32 v132, 0
  v_mov_b32 v133, 0
  v_mov_b32 v134, 0
  v_mov_b32 v135, 0
  v_mov_b32 v136, 0
  v_mov_b32 v137, 0
  v_mov_b32 v138, 0
  v_mov_b32 v139, 0
  v_mov_b32 v140, 0
  v_mov_b32 v141, 0
  v_mov_b32 v142, 0
  v_mov_b32 v143, 0
  v_mov_b32 v144, 0
  v_mov_b32 v145, 0
  v_mov_b32 v146, 0
  v_mov_b32 v147, 0
  v_mov_b32 v148, 0
  v_mov_b32 v149, 0
  v_mov_b32 v150, 0
  v_mov_b32 v151, 0
  v_mov_b32 v152, 0
  v_mov_b32 v153, 0
  v_mov_b32 v154, 0
  v_mov_b32 v155, 0
  v_mov_b32 v156, 0
  v_mov_b32 v157, 0
  v_mov_b32 v158, 0
  v_mov_b32 v159, 0
  v_mov_b32 v160, 0
  v_mov_b32 v161, 0
  v_mov_b32 v162, 0
  v_mov_b32 v163, 0
  v_mov_b32 v164, 0
  v_mov_b32 v165, 0
  v_mov_b32 v166, 0
  v_mov_b32 v167, 0
  v_mov_b32 v168, 0
  v_mov_b32 v169, 0
  v_mov_b32 v170, 0
  v_mov_b32 v171, 0
  v_mov_b32 v172, 0
  v_mov_b32 v173, 0
  v_mov_b32 v174, 0
  v_mov_b32 v175, 0
  v_mov_b32 v176, 0
  v_mov_b32 v177, 0
  v_mov_b32 v178, 0
  v_mov_b32 v179, 0
  v_mov_b32 v180, 0
  v_mov_b32 v181, 0
  v_mov_b32 v182, 0
  v_mov_b32 v183, 0
  v_mov_b32 v184, 0
  v_mov_b32 v185, 0
  v_mov_b32 v186, 0
  v_mov_b32 v187, 0
  v_mov_b32 v188, 0
  v_mov_b32 v189, 0
  v_mov_b32 v190, 0
  v_mov_b32 v191, 0
  v_mov_b32 v192, 0
  v_mov_b32 v193, 0
  v_mov_b32 v194, 0
  v_mov_b32 v195, 0
  v_mov_b32 v196, 0
  v_mov_b32 v197, 0
  v_mov_b32 v198, 0
  v_mov_b32 v199, 0
  v_mov_b32 v200, 0
  v_mov_b32 v201, 0
  v_mov_b32 v202, 0
  v_mov_b32 v203, 0
  v_mov_b32 v204, 0
  v_mov_b32 v205, 0
  v_mov_b32 v206, 0
  v_mov_b32 v207, 0
  v_mov_b32 v208, 0
  v_mov_b32 v209, 0
  v_mov_b32 v210, 0
  v_mov_b32 v211, 0
  v_mov_b32 v212, 0
  v_mov_b32 v213, 0
  v_mov_b32 v214, 0
  v_mov_b32 v215, 0
  v_mov_b32 v216, 0
  v_mov_b32 v217, 0
  v_mov_b32 v218, 0
  v_mov_b32 v219, 0
  v_mov_b32 v220, 0
  v_mov_b32 v221, 0
  v_mov_b32 v222, 0
  v_mov_b32 v223, 0
  v_mov_b32 v224, 0
  v_mov_b32 v225, 0
  v_mov_b32 v226, 0
  v_mov_b32 v227, 0
  v_mov_b32 v228, 0
  v_mov_b32 v229, 0
  v_mov_b32 v230, 0
  v_mov_b32 v231, 0
  v_mov_b32 v232, 0
  v_mov_b32 v233, 0
  v_mov_b32 v234, 0
  v_mov_b32 v235, 0
  v_mov_b32 v236, 0
  v_mov_b32 v237, 0
  v_mov_b32 v238, 0
  v_mov_b32 v239, 0
  s_waitcnt lgkmcnt(0)
  s_add_u32 s44, s34, 8388608
  s_addc_u32 s45, s35, 0
  s_and_b32 s45, s45, 0xffff
  s_mov_b32 s46, 14680064
  s_mov_b32 s47, 0x00020000
  s_cmp_lg_u32 s96, 0
  s_cbranch_scc1 L_pfc3_skip
  s_getpc_b64 s[4:5]
L_pfc3:
  s_lshl_b32 s3, s99, 2
  s_add_u32 s3, s3, s70
  s_mul_i32 s3, s3, 192
  s_min_u32 s3, s3, L_w2_c1-L_w2_c0-192
  s_add_i32 s3, s3, L_w2_c0-L_pfc3
  s_ashr_i32 s6, s3, 31
  s_add_u32 s4, s4, s3
  s_addc_u32 s5, s5, s6
  s_load_dword s36, s[4:5], 0
  s_load_dword s37, s[4:5], 64
  s_load_dword s38, s[4:5], 128
L_pfc3_skip:
  s_mov_b32 s75, 0
  v_add_u32_e64 v20, s75, v4
  v_add_u32_e64 v21, s75, v5
  v_add_u32_e64 v22, s75, v6
  v_add_u32_e64 v23, s75, v7
  s_add_u32 s75, s75, 49152
  s_cmp_eq_u32 s75, 147456
  s_cselect_b32 s75, 0, s75
  s_mov_b32 s79, 16
  s_barrier
  s_barrier
  ds_read_b128 v[32:35], v20 offset:0
  ds_read_b128 v[36:39], v20 offset:2048
  ds_read_b128 v[40:43], v20 offset:4096
  ds_read_b128 v[44:47], v20 offset:6144
  ds_read_b64_tr_b16 v[48:49], v21 offset:0
  ds_read_b64_tr_b16 v[50:51], v21 offset:512
  ds_read_b64_tr_b16 v[52:53], v22 offset:0
  ds_read_b64_tr_b16 v[54:55], v22 offset:512
  ds_read_b64_tr_b16 v[56:57], v21 offset:8192
  ds_read_b64_tr_b16 v[58:59], v21 offset:8704
  ds_read_b64_tr_b16 v[60:61], v22 offset:8192
  ds_read_b64_tr_b16 v[62:63], v22 offset:8704
  ds_read_b64_tr_b16 v[64:65], v21 offset:16384
  ds_read_b64_tr_b16 v[66:67], v21 offset:16896
  ds_read_b64_tr_b16 v[68:69], v22 offset:16384
  ds_read_b64_tr_b16 v[70:71], v22 offset:16896
  ds_read_b64_tr_b16 v[72:73], v23 offset:0
  ds_read_b64_tr_b16 v[74:75], v23 offset:256
  s_waitcnt lgkmcnt(0)
.p2align 3
L_w1_loop:
  v_mfma_f32_16x16x32_bf16 v[128:131], v[48:51], v[32:35], v[128:131]
  ds_read_b128 v[80:83], v20 offset:1024
  v_mfma_f32_16x16x32_bf16 v[132:135], v[48:51], v[36:39], v[132:135]
  ds_read_b128 v[84:87], v20 offset:3072
  v_mfma_f32_16x16x32_bf16 v[136:139], v[48:51], v[40:43], v[136:139]
  ds_read_b128 v[88:91], v20 offset:5120
  v_mfma_f32_16x16x32_bf16 v[140:143], v[48:51], v[44:47], v[140:143]
  ds_read_b128 v[92:95], v20 offset:7168
  v_mfma_f32_16x16x32_bf16 v[144:147], v[52:55], v[32:35], v[144:147]
  ds_read_b64_tr_b16 v[96:97], v21 offset:4096
  v_mfma_f32_16x16x32_bf16 v[148:151], v[52:55], v[36:39], v[148:151]
  ds_read_b64_tr_b16 v[98:99], v21 offset:4608
  v_mfma_f32_16x16x32_bf16 v[152:155], v[52:55], v[40:43], v[152:155]
  ds_read_b64_tr_b16 v[100:101], v22 offset:4096
  v_mfma_f32_16x16x32_bf16 v[156:159], v[52:55], v[44:47], v[156:159]
  ds_read_b64_tr_b16 v[102:103], v22 offset:4608
  v_mfma_f32_16x16x32_bf16 v[160:163], v[56:59], v[32:35], v[160:163]
  ds_read_b64_tr_b16 v[104:105], v21 offset:12288
  v_mfma_f32_16x16x32_bf16 v[164:167], v[56:59], v[36:39], v[164:167]
  ds_read_b64_tr_b16 v[106:107], v21 offset:12800
  v_mfma_f32_16x16x32_bf16 v[168:171], v[56:59], v[40:43], v[168:171]
  ds_read_b64_tr_b16 v[108:109], v22 offset:12288
  v_mfma_f32_16x16x32_bf16 v[172:175], v[56:59], v[44:47], v[172:175]
  ds_read_b64_tr_b16 v[110:111], v22 offset:12800
  v_mfma_f32_16x16x32_bf16 v[176:179], v[60:63], v[32:35], v[176:179]
  ds_read_b64_tr_b16 v[112:113], v21 offset:20480
  v_mfma_f32_16x16x32_bf16 v[180:183], v[60:63], v[36:39], v[180:183]
  ds_read_b64_tr_b16 v[114:115], v21 offset:20992
  v_mfma_f32_16x16x32_bf16 v[184:187], v[60:63], v[40:43], v[184:187]
  ds_read_b64_tr_b16 v[116:117], v22 offset:20480
  v_mfma_f32_16x16x32_bf16 v[188:191], v[60:63], v[44:47], v[188:191]
  ds_read_b64_tr_b16 v[118:119], v22 offset:20992
  v_mfma_f32_16x16x32_bf16 v[192:195], v[64:67], v[32:35], v[192:195]
  ds_read_b64_tr_b16 v[120:121], v23 offset:4096
  v_mfma_f32_16x16x32_bf16 v[196:199], v[64:67], v[36:39], v[196:199]
  ds_read_b64_tr_b16 v[122:123], v23 offset:4352
  v_mfma_f32_16x16x32_bf16 v[200:203], v[64:67], v[40:43], v[200:203]
  v_add_u32_e64 v20, s75, v4
  v_mfma_f32_16x16x32_bf16 v[204:207], v[64:67], v[44:47], v[204:207]
  v_add_u32_e64 v21, s75, v5
  v_mfma_f32_16x16x32_bf16 v[208:211], v[68:71], v[32:35], v[208:211]
  v_add_u32_e64 v22, s75, v6
  v_mfma_f32_16x16x32_bf16 v[212:215], v[68:71], v[36:39], v[212:215]
  v_add_u32_e64 v23, s75, v7
  v_mfma_f32_16x16x32_bf16 v[216:219], v[68:71], v[40:43], v[216:219]
  s_add_u32 s75, s75, 49152
  v_mfma_f32_16x16x32_bf16 v[220:223], v[68:71], v[44:47], v[220:223]
  s_cmp_eq_u32 s75, 147456
  v_mfma_f32_16x16x32_bf16 v[224:227], v[72:75], v[32:35], v[224:227]
  s_cselect_b32 s75, 0, s75
  s_sub_u32 s79, s79, 1
  v_mfma_f32_16x16x32_bf16 v[228:231], v[72:75], v[36:39], v[228:231]
  v_mfma_f32_16x16x32_bf16 v[232:235], v[72:75], v[40:43], v[232:235]
  v_mfma_f32_16x16x32_bf16 v[236:239], v[72:75], v[44:47], v[236:239]
  s_waitcnt lgkmcnt(0)
  s_barrier
  v_mfma_f32_16x16x32_bf16 v[128:131], v[96:99], v[80:83], v[128:131]
  ds_read_b128 v[32:35], v20 offset:0
  v_mfma_f32_16x16x32_bf16 v[132:135], v[96:99], v[84:87], v[132:135]
  ds_read_b128 v[36:39], v20 offset:2048
  v_mfma_f32_16x16x32_bf16 v[136:139], v[96:99], v[88:91], v[136:139]
  ds_read_b128 v[40:43], v20 offset:4096
  v_mfma_f32_16x16x32_bf16 v[140:143], v[96:99], v[92:95], v[140:143]
  ds_read_b128 v[44:47], v20 offset:6144
  v_mfma_f32_16x16x32_bf16 v[144:147], v[100:103], v[80:83], v[144:147]
  ds_read_b64_tr_b16 v[48:49], v21 offset:0
  v_mfma_f32_16x16x32_bf16 v[148:151], v[100:103], v[84:87], v[148:151]
  ds_read_b64_tr_b16 v[50:51], v21 offset:512
  v_mfma_f32_16x16x32_bf16 v[152:155], v[100:103], v[88:91], v[152:155]
  ds_read_b64_tr_b16 v[52:53], v22 offset:0
  v_mfma_f32_16x16x32_bf16 v[156:159], v[100:103], v[92:95], v[156:159]
  ds_read_b64_tr_b16 v[54:55], v22 offset:512
  v_mfma_f32_16x16x32_bf16 v[160:163], v[104:107], v[80:83], v[160:163]
  ds_read_b64_tr_b16 v[56:57], v21 offset:8192
  v_mfma_f32_16x16x32_bf16 v[164:167], v[104:107], v[84:87], v[164:167]
  ds_read_b64_tr_b16 v[58:59], v21 offset:8704
  v_mfma_f32_16x16x32_bf16 v[168:171], v[104:107], v[88:91], v[168:171]
  ds_read_b64_tr_b16 v[60:61], v22 offset:8192
  v_mfma_f32_16x16x32_bf16 v[172:175], v[104:107], v[92:95], v[172:175]
  ds_read_b64_tr_b16 v[62:63], v22 offset:8704
  v_mfma_f32_16x16x32_bf16 v[176:179], v[108:111], v[80:83], v[176:179]
  ds_read_b64_tr_b16 v[64:65], v21 offset:16384
  v_mfma_f32_16x16x32_bf16 v[180:183], v[108:111], v[84:87], v[180:183]
  ds_read_b64_tr_b16 v[66:67], v21 offset:16896
  v_mfma_f32_16x16x32_bf16 v[184:187], v[108:111], v[88:91], v[184:187]
  ds_read_b64_tr_b16 v[68:69], v22 offset:16384
  v_mfma_f32_16x16x32_bf16 v[188:191], v[108:111], v[92:95], v[188:191]
  ds_read_b64_tr_b16 v[70:71], v22 offset:16896
  v_mfma_f32_16x16x32_bf16 v[192:195], v[112:115], v[80:83], v[192:195]
  ds_read_b64_tr_b16 v[72:73], v23 offset:0
  v_mfma_f32_16x16x32_bf16 v[196:199], v[112:115], v[84:87], v[196:199]
  ds_read_b64_tr_b16 v[74:75], v23 offset:256
  v_mfma_f32_16x16x32_bf16 v[200:203], v[112:115], v[88:91], v[200:203]
  s_cmp_lg_u32 s79, 0
  s_nop 0
  v_mfma_f32_16x16x32_bf16 v[204:207], v[112:115], v[92:95], v[204:207]
  v_mfma_f32_16x16x32_bf16 v[208:211], v[116:119], v[80:83], v[208:211]
  v_mfma_f32_16x16x32_bf16 v[212:215], v[116:119], v[84:87], v[212:215]
  v_mfma_f32_16x16x32_bf16 v[216:219], v[116:119], v[88:91], v[216:219]
  v_mfma_f32_16x16x32_bf16 v[220:223], v[116:119], v[92:95], v[220:223]
  v_mfma_f32_16x16x32_bf16 v[224:227], v[120:123], v[80:83], v[224:227]
  v_mfma_f32_16x16x32_bf16 v[228:231], v[120:123], v[84:87], v[228:231]
  v_mfma_f32_16x16x32_bf16 v[232:235], v[120:123], v[88:91], v[232:235]
  v_mfma_f32_16x16x32_bf16 v[236:239], v[120:123], v[92:95], v[236:239]
  s_waitcnt lgkmcnt(0)
  s_cbranch_scc1 L_w1_loop
L_w1_exit:
  ds_read2_b32 v[88:89], v14 offset0:0 offset1:160
  ds_read2_b32 v[90:91], v14 offset0:16 offset1:176
  ds_read2_b32 v[92:93], v14 offset0:32 offset1:192
  ds_read2_b32 v[94:95], v14 offset0:48 offset1:208
  ds_read_b128 v[32:35], v15 offset:0
  ds_read_b128 v[60:63], v15 offset:1024
  ds_read_b128 v[36:39], v15 offset:64
  ds_read_b128 v[64:67], v15 offset:1088
  ds_read_b128 v[40:43], v15 offset:256
  ds_read_b128 v[68:71], v15 offset:1280
  ds_read_b128 v[44:47], v15 offset:320
  ds_read_b128 v[72:75], v15 offset:1344
  ds_read_b128 v[48:51], v15 offset:512
  ds_read_b128 v[76:79], v15 offset:1536
  ds_read_b128 v[52:55], v15 offset:576
  ds_read_b128 v[80:83], v15 offset:1600
  ds_read_b128 v[56:59], v16 offset:768
  ds_read_b128 v[84:87], v16 offset:1792
  v_mov_b32 v96, 0xc0135761
  v_mov_b32 v97, 0xbdd2d3e8
  v_mov_b32 v98, 1.0
  s_waitcnt lgkmcnt(0)
  v_mul_f32 v88, v88, v89
  v_mul_f32 v90, v90, v91
  v_mul_f32 v92, v92, v93
  v_mul_f32 v94, v94, v95
  v_pk_fma_f32 v[100:101], v[32:33], v[88:89], v[60:61] op_sel:[0,0,0] op_sel_hi:[1,0,1] neg_lo:[0,1,0] neg_hi:[0,1,0]
  v_pk_fma_f32 v[102:103], v[34:35], v[88:89], v[62:63] op_sel:[0,0,0] op_sel_hi:[1,0,1] neg_lo:[0,1,0] neg_hi:[0,1,0]
  v_pk_fma_f32 v[128:129], v[128:129], v[88:89], v[100:101] op_sel:[0,1,0] op_sel_hi:[1,1,1]
  v_pk_fma_f32 v[130:131], v[130:131], v[88:89], v[102:103] op_sel:[0,1,0] op_sel_hi:[1,1,1]
  v_pk_mul_f32 v[100:101], v[128:129], v[128:129]
  v_pk_mul_f32 v[102:103], v[130:131], v[130:131]
  v_pk_fma_f32 v[100:101], v[100:101], v[96:97], v[96:97] op_sel:[0,1,0] op_sel_hi:[1,1,0]
  v_pk_fma_f32 v[102:103], v[102:103], v[96:97], v[96:97] op_sel:[0,1,0] op_sel_hi:[1,1,0]
  v_pk_mul_f32 v[100:101], v[100:101], v[128:129]
  v_pk_mul_f32 v[102:103], v[102:103], v[130:131]
  v_exp_f32 v100, v100
  v_exp_f32 v101, v101
  v_exp_f32 v102, v102
  v_exp_f32 v103, v103
  v_pk_add_f32 v[100:101], v[100:101], v[98:99] op_sel_hi:[1,0]
  v_pk_add_f32 v[102:103], v[102:103], v[98:99] op_sel_hi:[1,0]
  v_rcp_f32 v100, v100
  v_rcp_f32 v101, v101
  v_rcp_f32 v102, v102
  v_rcp_f32 v103, v103
  v_pk_mul_f32 v[128:129], v[128:129], v[100:101]
  v_pk_mul_f32 v[130:131], v[130:131], v[102:103]
  v_cvt_pk_bf16_f32 v108, v128, v129
  v_cvt_pk_bf16_f32 v109, v130, v131
  v_pk_fma_f32 v[104:105], v[36:37], v[88:89], v[64:65] op_sel:[0,0,0] op_sel_hi:[1,0,1] neg_lo:[0,1,0] neg_hi:[0,1,0]
  v_pk_fma_f32 v[106:107], v[38:39], v[88:89], v[66:67] op_sel:[0,0,0] op_sel_hi:[1,0,1] neg_lo:[0,1,0] neg_hi:[0,1,0]
  v_pk_fma_f32 v[144:145], v[144:145], v[88:89], v[104:105] op_sel:[0,1,0] op_sel_hi:[1,1,1]
  v_pk_fma_f32 v[146:147], v[146:147], v[88:89], v[106:107] op_sel:[0,1,0] op_sel_hi:[1,1,1]
  v_pk_mul_f32 v[104:105], v[144:145], v[144:145]
  v_pk_mul_f32 v[106:107], v[146:147], v[146:147]
  v_pk_fma_f32 v[104:105], v[104:105], v[96:97], v[96:97] op_sel:[0,1,0] op_sel_hi:[1,1,0]
  v_pk_fma_f32 v[106:107], v[106:107], v[96:97], v[96:97] op_sel:[0,1,0] op_sel_hi:[1,1,0]
  v_pk_mul_f32 v[104:105], v[104:105], v[144:145]
  v_pk_mul_f32 v[106:107], v[106:107], v[146:147]
  v_exp_f32 v104, v104
  v_exp_f32 v105, v105
  v_exp_f32 v106, v106
  v_exp_f32 v107, v107
  v_pk_add_f32 v[104:105], v[104:105], v[98:99] op_sel_hi:[1,0]
  v_pk_add_f32 v[106:107], v[106:107], v[98:99] op_sel_hi:[1,0]
  v_rcp_f32 v104, v104
  v_rcp_f32 v105, v105
  v_rcp_f32 v106, v106
  v_rcp_f32 v107, v107
  v_pk_mul_f32 v[144:145], v[144:145], v[104:105]
  v_pk_mul_f32 v[146:147], v[146:147], v[106:107]
  v_cvt_pk_bf16_f32 v110, v144, v145
  v_cvt_pk_bf16_f32 v111, v146, v147
  s_mov_b32 s3, 0
  s_nop 0
  v_permlane16_swap_b32 v108, v110
  v_permlane16_swap_b32 v109, v111
  buffer_store_dwordx4 v[108:111], v12, s[44:47], s3 offen sc1
  v_pk_fma_f32 v[100:101], v[32:33], v[90:91], v[60:61] op_sel:[0,0,0] op_sel_hi:[1,0,1] neg_lo:[0,1,0] neg_hi:[0,1,0]
  v_pk_fma_f32 v[102:103], v[34:35], v[90:91], v[62:63] op_sel:[0,0,0] op_sel_hi:[1,0,1] neg_lo:[0,1,0] neg_hi:[0,1,0]
  v_pk_fma_f32 v[132:133], v[132:133], v[90:91], v[100:101] op_sel:[0,1,0] op_sel_hi:[1,1,1]
  v_pk_fma_f32 v[134:135], v[134:135], v[90:91], v[102:103] op_sel:[0,1,0] op_sel_hi:[1,1,1]
  v_pk_mul_f32 v[100:101], v[132:133], v[132:133]
  v_pk_mul_f32 v[102:103], v[134:135], v[134:135]
  v_pk_fma_f32 v[100:101], v[100:101], v[96:97], v[96:97] op_sel:[0,1,0] op_sel_hi:[1,1,0]
  v_pk_fma_f32 v[102:103], v[102:103], v[96:97], v[96:97] op_sel:[0,1,0] op_sel_hi:[1,1,0]
  v_pk_mul_f32 v[100:101], v[100:101], v[132:133]
  v_pk_mul_f32 v[102:103], v[102:103], v[134:135]
  v_exp_f32 v100, v100
  v_exp_f32 v101, v101
  v_exp_f32 v102, v102
  v_exp_f32 v103, v103
  v_pk_add_f32 v[100:101], v[100:101], v[98:99] op_sel_hi:[1,0]
  v_pk_add_f32 v[102:103], v[102:103], v[98:99] op_sel_hi:[1,0]
  v_rcp_f32 v100, v100
  v_rcp_f32 v101, v101
  v_rcp_f32 v102, v102
  v_rcp_f32 v103, v103
  v_pk_mul_f32 v[132:133], v[132:133], v[100:101]
  v_pk_mul_f32 v[134:135], v[134:135], v[102:103]
  v_cvt_pk_bf16_f32 v112, v132, v133
  v_cvt_pk_bf16_f32 v113, v134, v135
  v_pk_fma_f32 v[104:105], v[36:37], v[90:91], v[64:65] op_sel:[0,0,0] op_sel_hi:[1,0,1] neg_lo:[0,1,0] neg_hi:[0,1,0]
  v_pk_fma_f32 v[106:107], v[38:39], v[90:91], v[66:67] op_sel:[0,0,0] op_sel_hi:[1,0,1] neg_lo:[0,1,0] neg_hi:[0,1,0]
  v_pk_fma_f32 v[148:149], v[148:149], v[90:91], v[104:105] op_sel:[0,1,0] op_sel_hi:[1,1,1]
  v_pk_fma_f32 v[150:151], v[150:151], v[90:91], v[106:107] op_sel:[0,1,0] op_sel_hi:[1,1,1]
  v_pk_mul_f32 v[104:105], v[148:149], v[148:149]
  v_pk_mul_f32 v[106:107], v[150:151], v[150:151]
  v_pk_fma_f32 v[104:105], v[104:105], v[96:97], v[96:97] op_sel:[0,1,0] op_sel_hi:[1,1,0]
  v_pk_fma_f32 v[106:107], v[106:107], v[96:97], v[96:97] op_sel:[0,1,0] op_sel_hi:[1,1,0]
  v_pk_mul_f32 v[104:105], v[104:105], v[148:149]
  v_pk_mul_f32 v[106:107], v[106:107], v[150:151]
  v_exp_f32 v104, v104
  v_exp_f32 v105, v105
  v_exp_f32 v106, v106
  v_exp_f32 v107, v107
  v_pk_add_f32 v[104:105], v[104:105], v[98:99] op_sel_hi:[1,0]
  v_pk_add_f32 v[106:107], v[106:107], v[98:99] op_sel_hi:[1,0]
  v_rcp_f32 v104, v104
  v_rcp_f32 v105, v105
  v_rcp_f32 v106, v106
  v_rcp_f32 v107, v107
  v_pk_mul_f32 v[148:149], v[148:149], v[104:105]
  v_pk_mul_f32 v[150:151], v[150:151], v[106:107]
  v_cvt_pk_bf16_f32 v114, v148, v149
  v_cvt_pk_bf16_f32 v115, v150, v151
  s_mov_b32 s3, 114688
  s_nop 0
  v_permlane16_swap_b32 v112, v114
  v_permlane16_swap_b32 v113, v115
  buffer_store_dwordx4 v[112:115], v12, s[44:47], s3 offen sc1
  v_pk_fma_f32 v[100:101], v[32:33], v[92:93], v[60:61] op_sel:[0,0,0] op_sel_hi:[1,0,1] neg_lo:[0,1,0] neg_hi:[0,1,0]
  v_pk_fma_f32 v[102:103], v[34:35], v[92:93], v[62:63] op_sel:[0,0,0] op_sel_hi:[1,0,1] neg_lo:[0,1,0] neg_hi:[0,1,0]
  v_pk_fma_f32 v[136:137], v[136:137], v[92:93], v[100:101] op_sel:[0,1,0] op_sel_hi:[1,1,1]
  v_pk_fma_f32 v[138:139], v[138:139], v[92:93], v[102:103] op_sel:[0,1,0] op_sel_hi:[1,1,1]
  v_pk_mul_f32 v[100:101], v[136:137], v[136:137]
  v_pk_mul_f32 v[102:103], v[138:139], v[138:139]
  v_pk_fma_f32 v[100:101], v[100:101], v[96:97], v[96:97] op_sel:[0,1,0] op_sel_hi:[1,1,0]
  v_pk_fma_f32 v[102:103], v[102:103], v[96:97], v[96:97] op_sel:[0,1,0] op_sel_hi:[1,1,0]
  v_pk_mul_f32 v[100:101], v[100:101], v[136:137]
  v_pk_mul_f32 v[102:103], v[102:103], v[138:139]
  v_exp_f32 v100, v100
  v_exp_f32 v101, v101
  v_exp_f32 v102, v102
  v_exp_f32 v103, v103
  v_pk_add_f32 v[100:101], v[100:101], v[98:99] op_sel_hi:[1,0]
  v_pk_add_f32 v[102:103], v[102:103], v[98:99] op_sel_hi:[1,0]
  v_rcp_f32 v100, v100
  v_rcp_f32 v101, v101
  v_rcp_f32 v102, v102
  v_rcp_f32 v103, v103
  v_pk_mul_f32 v[136:137], v[136:137], v[100:101]
  v_pk_mul_f32 v[138:139], v[138:139], v[102:103]
  v_cvt_pk_bf16_f32 v116, v136, v137
  v_cvt_pk_bf16_f32 v117, v138, v139
  v_pk_fma_f32 v[104:105], v[36:37], v[92:93], v[64:65] op_sel:[0,0,0] op_sel_hi:[1,0,1] neg_lo:[0,1,0] neg_hi:[0,1,0]
  v_pk_fma_f32 v[106:107], v[38:39], v[92:93], v[66:67] op_sel:[0,0,0] op_sel_hi:[1,0,1] neg_lo:[0,1,0] neg_hi:[0,1,0]
  v_pk_fma_f32 v[152:153], v[152:153], v[92:93], v[104:105] op_sel:[0,1,0] op_sel_hi:[1,1,1]
  v_pk_fma_f32 v[154:155], v[154:155], v[92:93], v[106:107] op_sel:[0,1,0] op_sel_hi:[1,1,1]
  v_pk_mul_f32 v[104:105], v[152:153], v[152:153]
  v_pk_mul_f32 v[106:107], v[154:155], v[154:155]
  v_pk_fma_f32 v[104:105], v[104:105], v[96:97], v[96:97] op_sel:[0,1,0] op_sel_hi:[1,1,0]
  v_pk_fma_f32 v[106:107], v[106:107], v[96:97], v[96:97] op_sel:[0,1,0] op_sel_hi:[1,1,0]
  v_pk_mul_f32 v[104:105], v[104:105], v[152:153]
  v_pk_mul_f32 v[106:107], v[106:107], v[154:155]
  v_exp_f32 v104, v104
  v_exp_f32 v105, v105
  v_exp_f32 v106, v106
  v_exp_f32 v107, v107
  v_pk_add_f32 v[104:105], v[104:105], v[98:99] op_sel_hi:[1,0]
  v_pk_add_f32 v[106:107], v[106:107], v[98:99] op_sel_hi:[1,0]
  v_rcp_f32 v104, v104
  v_rcp_f32 v105, v105
  v_rcp_f32 v106, v106
  v_rcp_f32 v107, v107
  v_pk_mul_f32 v[152:153], v[152:153], v[104:105]
  v_pk_mul_f32 v[154:155], v[154:155], v[106:107]
  v_cvt_pk_bf16_f32 v118, v152, v153
  v_cvt_pk_bf16_f32 v119, v154, v155
  s_mov_b32 s3, 229376
  s_nop 0
  v_permlane16_swap_b32 v116, v118
  v_permlane16_swap_b32 v117, v119
  buffer_store_dwordx4 v[116:119], v12, s[44:47], s3 offen sc1
  v_pk_fma_f32 v[100:101], v[32:33], v[94:95], v[60:61] op_sel:[0,0,0] op_sel_hi:[1,0,1] neg_lo:[0,1,0] neg_hi:[0,1,0]
  v_pk_fma_f32 v[102:103], v[34:35], v[94:95], v[62:63] op_sel:[0,0,0] op_sel_hi:[1,0,1] neg_lo:[0,1,0] neg_hi:[0,1,0]
  v_pk_fma_f32 v[140:141], v[140:141], v[94:95], v[100:101] op_sel:[0,1,0] op_sel_hi:[1,1,1]
  v_pk_fma_f32 v[142:143], v[142:143], v[94:95], v[102:103] op_sel:[0,1,0] op_sel_hi:[1,1,1]
  v_pk_mul_f32 v[100:101], v[140:141], v[140:141]
  v_pk_mul_f32 v[102:103], v[142:143], v[142:143]
  v_pk_fma_f32 v[100:101], v[100:101], v[96:97], v[96:97] op_sel:[0,1,0] op_sel_hi:[1,1,0]
  v_pk_fma_f32 v[102:103], v[102:103], v[96:97], v[96:97] op_sel:[0,1,0] op_sel_hi:[1,1,0]
  v_pk_mul_f32 v[100:101], v[100:101], v[140:141]
  v_pk_mul_f32 v[102:103], v[102:103], v[142:143]
  v_exp_f32 v100, v100
  v_exp_f32 v101, v101
  v_exp_f32 v102, v102
  v_exp_f32 v103, v103
  v_pk_add_f32 v[100:101], v[100:101], v[98:99] op_sel_hi:[1,0]
  v_pk_add_f32 v[102:103], v[102:103], v[98:99] op_sel_hi:[1,0]
  v_rcp_f32 v100, v100
  v_rcp_f32 v101, v101
  v_rcp_f32 v102, v102
  v_rcp_f32 v103, v103
  v_pk_mul_f32 v[140:141], v[140:141], v[100:101]
  v_pk_mul_f32 v[142:143], v[142:143], v[102:103]
  v_cvt_pk_bf16_f32 v120, v140, v141
  v_cvt_pk_bf16_f32 v121, v142, v143
  v_pk_fma_f32 v[104:105], v[36:37], v[94:95], v[64:65] op_sel:[0,0,0] op_sel_hi:[1,0,1] neg_lo:[0,1,0] neg_hi:[0,1,0]
  v_pk_fma_f32 v[106:107], v[38:39], v[94:95], v[66:67] op_sel:[0,0,0] op_sel_hi:[1,0,1] neg_lo:[0,1,0] neg_hi:[0,1,0]
  v_pk_fma_f32 v[156:157], v[156:157], v[94:95], v[104:105] op_sel:[0,1,0] op_sel_hi:[1,1,1]
  v_pk_fma_f32 v[158:159], v[158:159], v[94:95], v[106:107] op_sel:[0,1,0] op_sel_hi:[1,1,1]
  v_pk_mul_f32 v[104:105], v[156:157], v[156:157]
  v_pk_mul_f32 v[106:107], v[158:159], v[158:159]
  v_pk_fma_f32 v[104:105], v[104:105], v[96:97], v[96:97] op_sel:[0,1,0] op_sel_hi:[1,1,0]
  v_pk_fma_f32 v[106:107], v[106:107], v[96:97], v[96:97] op_sel:[0,1,0] op_sel_hi:[1,1,0]
  v_pk_mul_f32 v[104:105], v[104:105], v[156:157]
  v_pk_mul_f32 v[106:107], v[106:107], v[158:159]
  v_exp_f32 v104, v104
  v_exp_f32 v105, v105
  v_exp_f32 v106, v106
  v_exp_f32 v107, v107
  v_pk_add_f32 v[104:105], v[104:105], v[98:99] op_sel_hi:[1,0]
  v_pk_add_f32 v[106:107], v[106:107], v[98:99] op_sel_hi:[1,0]
  v_rcp_f32 v104, v104
  v_rcp_f32 v105, v105
  v_rcp_f32 v106, v106
  v_rcp_f32 v107, v107
  v_pk_mul_f32 v[156:157], v[156:157], v[104:105]
  v_pk_mul_f32 v[158:159], v[158:159], v[106:107]
  v_cvt_pk_bf16_f32 v122, v156, v157
  v_cvt_pk_bf16_f32 v123, v158, v159
  s_mov_b32 s3, 344064
  s_nop 0
  v_permlane16_swap_b32 v120, v122
  v_permlane16_swap_b32 v121, v123
  buffer_store_dwordx4 v[120:123], v12, s[44:47], s3 offen sc1
  v_pk_fma_f32 v[100:101], v[56:57], v[88:89], v[84:85] op_sel:[0,0,0] op_sel_hi:[1,0,1] neg_lo:[0,1,0] neg_hi:[0,1,0]
  v_pk_fma_f32 v[102:103], v[58:59], v[88:89], v[86:87] op_sel:[0,0,0] op_sel_hi:[1,0,1] neg_lo:[0,1,0] neg_hi:[0,1,0]
  v_pk_fma_f32 v[224:225], v[224:225], v[88:89], v[100:101] op_sel:[0,1,0] op_sel_hi:[1,1,1]
  v_pk_fma_f32 v[226:227], v[226:227], v[88:89], v[102:103] op_sel:[0,1,0] op_sel_hi:[1,1,1]
  v_pk_mul_f32 v[100:101], v[224:225], v[224:225]
  v_pk_mul_f32 v[102:103], v[226:227], v[226:227]
  v_pk_fma_f32 v[100:101], v[100:101], v[96:97], v[96:97] op_sel:[0,1,0] op_sel_hi:[1,1,0]
  v_pk_fma_f32 v[102:103], v[102:103], v[96:97], v[96:97] op_sel:[0,1,0] op_sel_hi:[1,1,0]
  v_pk_mul_f32 v[100:101], v[100:101], v[224:225]
  v_pk_mul_f32 v[102:103], v[102:103], v[226:227]
  v_exp_f32 v100, v100
  v_exp_f32 v101, v101
  v_exp_f32 v102, v102
  v_exp_f32 v103, v103
  v_pk_add_f32 v[100:101], v[100:101], v[98:99] op_sel_hi:[1,0]
  v_pk_add_f32 v[102:103], v[102:103], v[98:99] op_sel_hi:[1,0]
  v_rcp_f32 v100, v100
  v_rcp_f32 v101, v101
  v_rcp_f32 v102, v102
  v_rcp_f32 v103, v103
  v_pk_mul_f32 v[224:225], v[224:225], v[100:101]
  v_pk_mul_f32 v[226:227], v[226:227], v[102:103]
  v_cvt_pk_bf16_f32 v108, v224, v225
  v_cvt_pk_bf16_f32 v109, v226, v227
  v_pk_fma_f32 v[100:101], v[56:57], v[90:91], v[84:85] op_sel:[0,0,0] op_sel_hi:[1,0,1] neg_lo:[0,1,0] neg_hi:[0,1,0]
  v_pk_fma_f32 v[102:103], v[58:59], v[90:91], v[86:87] op_sel:[0,0,0] op_sel_hi:[1,0,1] neg_lo:[0,1,0] neg_hi:[0,1,0]
  v_pk_fma_f32 v[228:229], v[228:229], v[90:91], v[100:101] op_sel:[0,1,0] op_sel_hi:[1,1,1]
  v_pk_fma_f32 v[230:231], v[230:231], v[90:91], v[102:103] op_sel:[0,1,0] op_sel_hi:[1,1,1]
  v_pk_mul_f32 v[100:101], v[228:229], v[228:229]
  v_pk_mul_f32 v[102:103], v[230:231], v[230:231]
  v_pk_fma_f32 v[100:101], v[100:101], v[96:97], v[96:97] op_sel:[0,1,0] op_sel_hi:[1,1,0]
  v_pk_fma_f32 v[102:103], v[102:103], v[96:97], v[96:97] op_sel:[0,1,0] op_sel_hi:[1,1,0]
  v_pk_mul_f32 v[100:101], v[100:101], v[228:229]
  v_pk_mul_f32 v[102:103], v[102:103], v[230:231]
  v_exp_f32 v100, v100
  v_exp_f32 v101, v101
  v_exp_f32 v102, v102
  v_exp_f32 v103, v103
  v_pk_add_f32 v[100:101], v[100:101], v[98:99] op_sel_hi:[1,0]
  v_pk_add_f32 v[102:103], v[102:103], v[98:99] op_sel_hi:[1,0]
  v_rcp_f32 v100, v100
  v_rcp_f32 v101, v101
  v_rcp_f32 v102, v102
  v_rcp_f32 v103, v103
  v_pk_mul_f32 v[228:229], v[228:229], v[100:101]
  v_pk_mul_f32 v[230:231], v[230:231], v[102:103]
  v_cvt_pk_bf16_f32 v110, v228, v229
  v_cvt_pk_bf16_f32 v111, v230, v231
  s_mov_b32 s3, 32768
  s_nop 0
  v_permlane16_swap_b32 v108, v110
  v_permlane16_swap_b32 v109, v111
  buffer_store_dwordx4 v[108:111], v13, s[44:47], s3 offen sc1
  v_pk_fma_f32 v[100:101], v[56:57], v[92:93], v[84:85] op_sel:[0,0,0] op_sel_hi:[1,0,1] neg_lo:[0,1,0] neg_hi:[0,1,0]
  v_pk_fma_f32 v[102:103], v[58:59], v[92:93], v[86:87] op_sel:[0,0,0] op_sel_hi:[1,0,1] neg_lo:[0,1,0] neg_hi:[0,1,0]
  v_pk_fma_f32 v[232:233], v[232:233], v[92:93], v[100:101] op_sel:[0,1,0] op_sel_hi:[1,1,1]
  v_pk_fma_f32 v[234:235], v[234:235], v[92:93], v[102:103] op_sel:[0,1,0] op_sel_hi:[1,1,1]
  v_pk_mul_f32 v[100:101], v[232:233], v[232:233]
  v_pk_mul_f32 v[102:103], v[234:235], v[234:235]
  v_pk_fma_f32 v[100:101], v[100:101], v[96:97], v[96:97] op_sel:[0,1,0] op_sel_hi:[1,1,0]
  v_pk_fma_f32 v[102:103], v[102:103], v[96:97], v[96:97] op_sel:[0,1,0] op_sel_hi:[1,1,0]
  v_pk_mul_f32 v[100:101], v[100:101], v[232:233]
  v_pk_mul_f32 v[102:103], v[102:103], v[234:235]
  v_exp_f32 v100, v100
  v_exp_f32 v101, v101
  v_exp_f32 v102, v102
  v_exp_f32 v103, v103
  v_pk_add_f32 v[100:101], v[100:101], v[98:99] op_sel_hi:[1,0]
  v_pk_add_f32 v[102:103], v[102:103], v[98:99] op_sel_hi:[1,0]
  v_rcp_f32 v100, v100
  v_rcp_f32 v101, v101
  v_rcp_f32 v102, v102
  v_rcp_f32 v103, v103
  v_pk_mul_f32 v[232:233], v[232:233], v[100:101]
  v_pk_mul_f32 v[234:235], v[234:235], v[102:103]
  v_cvt_pk_bf16_f32 v112, v232, v233
  v_cvt_pk_bf16_f32 v113, v234, v235
  v_pk_fma_f32 v[100:101], v[56:57], v[94:95], v[84:85] op_sel:[0,0,0] op_sel_hi:[1,0,1] neg_lo:[0,1,0] neg_hi:[0,1,0]
  v_pk_fma_f32 v[102:103], v[58:59], v[94:95], v[86:87] op_sel:[0,0,0] op_sel_hi:[1,0,1] neg_lo:[0,1,0] neg_hi:[0,1,0]
  v_pk_fma_f32 v[236:237], v[236:237], v[94:95], v[100:101] op_sel:[0,1,0] op_sel_hi:[1,1,1]
  v_pk_fma_f32 v[238:239], v[238:239], v[94:95], v[102:103] op_sel:[0,1,0] op_sel_hi:[1,1,1]
  v_pk_mul_f32 v[100:101], v[236:237], v[236:237]
  v_pk_mul_f32 v[102:103], v[238:239], v[238:239]
  v_pk_fma_f32 v[100:101], v[100:101], v[96:97], v[96:97] op_sel:[0,1,0] op_sel_hi:[1,1,0]
  v_pk_fma_f32 v[102:103], v[102:103], v[96:97], v[96:97] op_sel:[0,1,0] op_sel_hi:[1,1,0]
  v_pk_mul_f32 v[100:101], v[100:101], v[236:237]
  v_pk_mul_f32 v[102:103], v[102:103], v[238:239]
  v_exp_f32 v100, v100
  v_exp_f32 v101, v101
  v_exp_f32 v102, v102
  v_exp_f32 v103, v103
  v_pk_add_f32 v[100:101], v[100:101], v[98:99] op_sel_hi:[1,0]
  v_pk_add_f32 v[102:103], v[102:103], v[98:99] op_sel_hi:[1,0]
  v_rcp_f32 v100, v100
  v_rcp_f32 v101, v101
  v_rcp_f32 v102, v102
  v_rcp_f32 v103, v103
  v_pk_mul_f32 v[236:237], v[236:237], v[100:101]
  v_pk_mul_f32 v[238:239], v[238:239], v[102:103]
  v_cvt_pk_bf16_f32 v114, v236, v237
  v_cvt_pk_bf16_f32 v115, v238, v239
  s_mov_b32 s3, 262144
  s_nop 0
  v_permlane16_swap_b32 v112, v114
  v_permlane16_swap_b32 v113, v115
  buffer_store_dwordx4 v[112:115], v13, s[44:47], s3 offen sc1
  v_pk_fma_f32 v[100:101], v[40:41], v[88:89], v[68:69] op_sel:[0,0,0] op_sel_hi:[1,0,1] neg_lo:[0,1,0] neg_hi:[0,1,0]
  v_pk_fma_f32 v[102:103], v[42:43], v[88:89], v[70:71] op_sel:[0,0,0] op_sel_hi:[1,0,1] neg_lo:[0,1,0] neg_hi:[0,1,0]
  v_pk_fma_f32 v[160:161], v[160:161], v[88:89], v[100:101] op_sel:[0,1,0] op_sel_hi:[1,1,1]
  v_pk_fma_f32 v[162:163], v[162:163], v[88:89], v[102:103] op_sel:[0,1,0] op_sel_hi:[1,1,1]
  v_pk_mul_f32 v[100:101], v[160:161], v[160:161]
  v_pk_mul_f32 v[102:103], v[162:163], v[162:163]
  v_pk_fma_f32 v[100:101], v[100:101], v[96:97], v[96:97] op_sel:[0,1,0] op_sel_hi:[1,1,0]
  v_pk_fma_f32 v[102:103], v[102:103], v[96:97], v[96:97] op_sel:[0,1,0] op_sel_hi:[1,1,0]
  v_pk_mul_f32 v[100:101], v[100:101], v[160:161]
  v_pk_mul_f32 v[102:103], v[102:103], v[162:163]
  v_exp_f32 v100, v100
  v_exp_f32 v101, v101
  v_exp_f32 v102, v102
  v_exp_f32 v103, v103
  v_pk_add_f32 v[100:101], v[100:101], v[98:99] op_sel_hi:[1,0]
  v_pk_add_f32 v[102:103], v[102:103], v[98:99] op_sel_hi:[1,0]
  v_rcp_f32 v100, v100
  v_rcp_f32 v101, v101
  v_rcp_f32 v102, v102
  v_rcp_f32 v103, v103
  v_pk_mul_f32 v[160:161], v[160:161], v[100:101]
  v_pk_mul_f32 v[162:163], v[162:163], v[102:103]
  v_cvt_pk_bf16_f32 v116, v160, v161
  v_cvt_pk_bf16_f32 v117, v162, v163
  v_pk_fma_f32 v[104:105], v[44:45], v[88:89], v[72:73] op_sel:[0,0,0] op_sel_hi:[1,0,1] neg_lo:[0,1,0] neg_hi:[0,1,0]
  v_pk_fma_f32 v[106:107], v[46:47], v[88:89], v[74:75] op_sel:[0,0,0] op_sel_hi:[1,0,1] neg_lo:[0,1,0] neg_hi:[0,1,0]
  v_pk_fma_f32 v[176:177], v[176:177], v[88:89], v[104:105] op_sel:[0,1,0] op_sel_hi:[1,1,1]
  v_pk_fma_f32 v[178:179], v[178:179], v[88:89], v[106:107] op_sel:[0,1,0] op_sel_hi:[1,1,1]
  v_pk_mul_f32 v[104:105], v[176:177], v[176:177]
  v_pk_mul_f32 v[106:107], v[178:179], v[178:179]
  v_pk_fma_f32 v[104:105], v[104:105], v[96:97], v[96:97] op_sel:[0,1,0] op_sel_hi:[1,1,0]
  v_pk_fma_f32 v[106:107], v[106:107], v[96:97], v[96:97] op_sel:[0,1,0] op_sel_hi:[1,1,0]
  v_pk_mul_f32 v[104:105], v[104:105], v[176:177]
  v_pk_mul_f32 v[106:107], v[106:107], v[178:179]
  v_exp_f32 v104, v104
  v_exp_f32 v105, v105
  v_exp_f32 v106, v106
  v_exp_f32 v107, v107
  v_pk_add_f32 v[104:105], v[104:105], v[98:99] op_sel_hi:[1,0]
  v_pk_add_f32 v[106:107], v[106:107], v[98:99] op_sel_hi:[1,0]
  v_rcp_f32 v104, v104
  v_rcp_f32 v105, v105
  v_rcp_f32 v106, v106
  v_rcp_f32 v107, v107
  v_pk_mul_f32 v[176:177], v[176:177], v[104:105]
  v_pk_mul_f32 v[178:179], v[178:179], v[106:107]
  v_cvt_pk_bf16_f32 v118, v176, v177
  v_cvt_pk_bf16_f32 v119, v178, v179
  s_add_u32 s3, s10, 49152
  s_nop 0
  v_permlane16_swap_b32 v116, v118
  v_permlane16_swap_b32 v117, v119
  buffer_store_dwordx4 v[116:119], v12, s[44:47], s3 offen sc1
  v_pk_fma_f32 v[100:101], v[48:49], v[88:89], v[76:77] op_sel:[0,0,0] op_sel_hi:[1,0,1] neg_lo:[0,1,0] neg_hi:[0,1,0]
  v_pk_fma_f32 v[102:103], v[50:51], v[88:89], v[78:79] op_sel:[0,0,0] op_sel_hi:[1,0,1] neg_lo:[0,1,0] neg_hi:[0,1,0]
  v_pk_fma_f32 v[192:193], v[192:193], v[88:89], v[100:101] op_sel:[0,1,0] op_sel_hi:[1,1,1]
  v_pk_fma_f32 v[194:195], v[194:195], v[88:89], v[102:103] op_sel:[0,1,0] op_sel_hi:[1,1,1]
  v_pk_mul_f32 v[100:101], v[192:193], v[192:193]
  v_pk_mul_f32 v[102:103], v[194:195], v[194:195]
  v_pk_fma_f32 v[100:101], v[100:101], v[96:97], v[96:97] op_sel:[0,1,0] op_sel_hi:[1,1,0]
  v_pk_fma_f32 v[102:103], v[102:103], v[96:97], v[96:97] op_sel:[0,1,0] op_sel_hi:[1,1,0]
  v_pk_mul_f32 v[100:101], v[100:101], v[192:193]
  v_pk_mul_f32 v[102:103], v[102:103], v[194:195]
  v_exp_f32 v100, v100
  v_exp_f32 v101, v101
  v_exp_f32 v102, v102
  v_exp_f32 v103, v103
  v_pk_add_f32 v[100:101], v[100:101], v[98:99] op_sel_hi:[1,0]
  v_pk_add_f32 v[102:103], v[102:103], v[98:99] op_sel_hi:[1,0]
  v_rcp_f32 v100, v100
  v_rcp_f32 v101, v101
  v_rcp_f32 v102, v102
  v_rcp_f32 v103, v103
  v_pk_mul_f32 v[192:193], v[192:193], v[100:101]
  v_pk_mul_f32 v[194:195], v[194:195], v[102:103]
  v_cvt_pk_bf16_f32 v120, v192, v193
  v_cvt_pk_bf16_f32 v121, v194, v195
  v_pk_fma_f32 v[104:105], v[52:53], v[88:89], v[80:81] op_sel:[0,0,0] op_sel_hi:[1,0,1] neg_lo:[0,1,0] neg_hi:[0,1,0]
  v_pk_fma_f32 v[106:107], v[54:55], v[88:89], v[82:83] op_sel:[0,0,0] op_sel_hi:[1,0,1] neg_lo:[0,1,0] neg_hi:[0,1,0]
  v_pk_fma_f32 v[208:209], v[208:209], v[88:89], v[104:105] op_sel:[0,1,0] op_sel_hi:[1,1,1]
  v_pk_fma_f32 v[210:211], v[210:211], v[88:89], v[106:107] op_sel:[0,1,0] op_sel_hi:[1,1,1]
  v_pk_mul_f32 v[104:105], v[208:209], v[208:209]
  v_pk_mul_f32 v[106:107], v[210:211], v[210:211]
  v_pk_fma_f32 v[104:105], v[104:105], v[96:97], v[96:97] op_sel:[0,1,0] op_sel_hi:[1,1,0]
  v_pk_fma_f32 v[106:107], v[106:107], v[96:97], v[96:97] op_sel:[0,1,0] op_sel_hi:[1,1,0]
  v_pk_mul_f32 v[104:105], v[104:105], v[208:209]
  v_pk_mul_f32 v[106:107], v[106:107], v[210:211]
  v_exp_f32 v104, v104
  v_exp_f32 v105, v105
  v_exp_f32 v106, v106
  v_exp_f32 v107, v107
  v_pk_add_f32 v[104:105], v[104:105], v[98:99] op_sel_hi:[1,0]
  v_pk_add_f32 v[106:107], v[106:107], v[98:99] op_sel_hi:[1,0]
  v_rcp_f32 v104, v104
  v_rcp_f32 v105, v105
  v_rcp_f32 v106, v106
  v_rcp_f32 v107, v107
  v_pk_mul_f32 v[208:209], v[208:209], v[104:105]
  v_pk_mul_f32 v[210:211], v[210:211], v[106:107]
  v_cvt_pk_bf16_f32 v122, v208, v209
  v_cvt_pk_bf16_f32 v123, v210, v211
  s_add_u32 s3, s10, 51200
  s_nop 0
  v_permlane16_swap_b32 v120, v122
  v_permlane16_swap_b32 v121, v123
  buffer_store_dwordx4 v[120:123], v12, s[44:47], s3 offen sc1
  v_pk_fma_f32 v[100:101], v[40:41], v[90:91], v[68:69] op_sel:[0,0,0] op_sel_hi:[1,0,1] neg_lo:[0,1,0] neg_hi:[0,1,0]
  v_pk_fma_f32 v[102:103], v[42:43], v[90:91], v[70:71] op_sel:[0,0,0] op_sel_hi:[1,0,1] neg_lo:[0,1,0] neg_hi:[0,1,0]
  v_pk_fma_f32 v[164:165], v[164:165], v[90:91], v[100:101] op_sel:[0,1,0] op_sel_hi:[1,1,1]
  v_pk_fma_f32 v[166:167], v[166:167], v[90:91], v[102:103] op_sel:[0,1,0] op_sel_hi:[1,1,1]
  v_pk_mul_f32 v[100:101], v[164:165], v[164:165]
  v_pk_mul_f32 v[102:103], v[166:167], v[166:167]
  v_pk_fma_f32 v[100:101], v[100:101], v[96:97], v[96:97] op_sel:[0,1,0] op_sel_hi:[1,1,0]
  v_pk_fma_f32 v[102:103], v[102:103], v[96:97], v[96:97] op_sel:[0,1,0] op_sel_hi:[1,1,0]
  v_pk_mul_f32 v[100:101], v[100:101], v[164:165]
  v_pk_mul_f32 v[102:103], v[102:103], v[166:167]
  v_exp_f32 v100, v100
  v_exp_f32 v101, v101
  v_exp_f32 v102, v102
  v_exp_f32 v103, v103
  v_pk_add_f32 v[100:101], v[100:101], v[98:99] op_sel_hi:[1,0]
  v_pk_add_f32 v[102:103], v[102:103], v[98:99] op_sel_hi:[1,0]
  v_rcp_f32 v100, v100
  v_rcp_f32 v101, v101
  v_rcp_f32 v102, v102
  v_rcp_f32 v103, v103
  v_pk_mul_f32 v[164:165], v[164:165], v[100:101]
  v_pk_mul_f32 v[166:167], v[166:167], v[102:103]
  v_cvt_pk_bf16_f32 v108, v164, v165
  v_cvt_pk_bf16_f32 v109, v166, v167
  v_pk_fma_f32 v[104:105], v[44:45], v[90:91], v[72:73] op_sel:[0,0,0] op_sel_hi:[1,0,1] neg_lo:[0,1,0] neg_hi:[0,1,0]
  v_pk_fma_f32 v[106:107], v[46:47], v[90:91], v[74:75] op_sel:[0,0,0] op_sel_hi:[1,0,1] neg_lo:[0,1,0] neg_hi:[0,1,0]
  v_pk_fma_f32 v[180:181], v[180:181], v[90:91], v[104:105] op_sel:[0,1,0] op_sel_hi:[1,1,1]
  v_pk_fma_f32 v[182:183], v[182:183], v[90:91], v[106:107] op_sel:[0,1,0] op_sel_hi:[1,1,1]
  v_pk_mul_f32 v[104:105], v[180:181], v[180:181]
  v_pk_mul_f32 v[106:107], v[182:183], v[182:183]
  v_pk_fma_f32 v[104:105], v[104:105], v[96:97], v[96:97] op_sel:[0,1,0] op_sel_hi:[1,1,0]
  v_pk_fma_f32 v[106:107], v[106:107], v[96:97], v[96:97] op_sel:[0,1,0] op_sel_hi:[1,1,0]
  v_pk_mul_f32 v[104:105], v[104:105], v[180:181]
  v_pk_mul_f32 v[106:107], v[106:107], v[182:183]
  v_exp_f32 v104, v104
  v_exp_f32 v105, v105
  v_exp_f32 v106, v106
  v_exp_f32 v107, v107
  v_pk_add_f32 v[104:105], v[104:105], v[98:99] op_sel_hi:[1,0]
  v_pk_add_f32 v[106:107], v[106:107], v[98:99] op_sel_hi:[1,0]
  v_rcp_f32 v104, v104
  v_rcp_f32 v105, v105
  v_rcp_f32 v106, v106
  v_rcp_f32 v107, v107
  v_pk_mul_f32 v[180:181], v[180:181], v[104:105]
  v_pk_mul_f32 v[182:183], v[182:183], v[106:107]
  v_cvt_pk_bf16_f32 v110, v180, v181
  v_cvt_pk_bf16_f32 v111, v182, v183
  s_add_u32 s3, s10, 163840
  s_nop 0
  v_permlane16_swap_b32 v108, v110
  v_permlane16_swap_b32 v109, v111
  buffer_store_dwordx4 v[108:111], v12, s[44:47], s3 offen sc1
  v_pk_fma_f32 v[100:101], v[48:49], v[90:91], v[76:77] op_sel:[0,0,0] op_sel_hi:[1,0,1] neg_lo:[0,1,0] neg_hi:[0,1,0]
  v_pk_fma_f32 v[102:103], v[50:51], v[90:91], v[78:79] op_sel:[0,0,0] op_sel_hi:[1,0,1] neg_lo:[0,1,0] neg_hi:[0,1,0]
  v_pk_fma_f32 v[196:197], v[196:197], v[90:91], v[100:101] op_sel:[0,1,0] op_sel_hi:[1,1,1]
  v_pk_fma_f32 v[198:199], v[198:199], v[90:91], v[102:103] op_sel:[0,1,0] op_sel_hi:[1,1,1]
  v_pk_mul_f32 v[100:101], v[196:197], v[196:197]
  v_pk_mul_f32 v[102:103], v[198:199], v[198:199]
  v_pk_fma_f32 v[100:101], v[100:101], v[96:97], v[96:97] op_sel:[0,1,0] op_sel_hi:[1,1,0]
  v_pk_fma_f32 v[102:103], v[102:103], v[96:97], v[96:97] op_sel:[0,1,0] op_sel_hi:[1,1,0]
  v_pk_mul_f32 v[100:101], v[100:101], v[196:197]
  v_pk_mul_f32 v[102:103], v[102:103], v[198:199]
  v_exp_f32 v100, v100
  v_exp_f32 v101, v101
  v_exp_f32 v102, v102
  v_exp_f32 v103, v103
  v_pk_add_f32 v[100:101], v[100:101], v[98:99] op_sel_hi:[1,0]
  v_pk_add_f32 v[102:103], v[102:103], v[98:99] op_sel_hi:[1,0]
  v_rcp_f32 v100, v100
  v_rcp_f32 v101, v101
  v_rcp_f32 v102, v102
  v_rcp_f32 v103, v103
  v_pk_mul_f32 v[196:197], v[196:197], v[100:101]
  v_pk_mul_f32 v[198:199], v[198:199], v[102:103]
  v_cvt_pk_bf16_f32 v112, v196, v197
  v_cvt_pk_bf16_f32 v113, v198, v199
  v_pk_fma_f32 v[104:105], v[52:53], v[90:91], v[80:81] op_sel:[0,0,0] op_sel_hi:[1,0,1] neg_lo:[0,1,0] neg_hi:[0,1,0]
  v_pk_fma_f32 v[106:107], v[54:55], v[90:91], v[82:83] op_sel:[0,0,0] op_sel_hi:[1,0,1] neg_lo:[0,1,0] neg_hi:[0,1,0]
  v_pk_fma_f32 v[212:213], v[212:213], v[90:91], v[104:105] op_sel:[0,1,0] op_sel_hi:[1,1,1]
  v_pk_fma_f32 v[214:215], v[214:215], v[90:91], v[106:107] op_sel:[0,1,0] op_sel_hi:[1,1,1]
  v_pk_mul_f32 v[104:105], v[212:213], v[212:213]
  v_pk_mul_f32 v[106:107], v[214:215], v[214:215]
  v_pk_fma_f32 v[104:105], v[104:105], v[96:97], v[96:97] op_sel:[0,1,0] op_sel_hi:[1,1,0]
  v_pk_fma_f32 v[106:107], v[106:107], v[96:97], v[96:97] op_sel:[0,1,0] op_sel_hi:[1,1,0]
  v_pk_mul_f32 v[104:105], v[104:105], v[212:213]
  v_pk_mul_f32 v[106:107], v[106:107], v[214:215]
  v_exp_f32 v104, v104
  v_exp_f32 v105, v105
  v_exp_f32 v106, v106
  v_exp_f32 v107, v107
  v_pk_add_f32 v[104:105], v[104:105], v[98:99] op_sel_hi:[1,0]
  v_pk_add_f32 v[106:107], v[106:107], v[98:99] op_sel_hi:[1,0]
  v_rcp_f32 v104, v104
  v_rcp_f32 v105, v105
  v_rcp_f32 v106, v106
  v_rcp_f32 v107, v107
  v_pk_mul_f32 v[212:213], v[212:213], v[104:105]
  v_pk_mul_f32 v[214:215], v[214:215], v[106:107]
  v_cvt_pk_bf16_f32 v114, v212, v213
  v_cvt_pk_bf16_f32 v115, v214, v215
  s_add_u32 s3, s10, 165888
  s_nop 0
  v_permlane16_swap_b32 v112, v114
  v_permlane16_swap_b32 v113, v115
  buffer_store_dwordx4 v[112:115], v12, s[44:47], s3 offen sc1
  v_pk_fma_f32 v[100:101], v[40:41], v[92:93], v[68:69] op_sel:[0,0,0] op_sel_hi:[1,0,1] neg_lo:[0,1,0] neg_hi:[0,1,0]
  v_pk_fma_f32 v[102:103], v[42:43], v[92:93], v[70:71] op_sel:[0,0,0] op_sel_hi:[1,0,1] neg_lo:[0,1,0] neg_hi:[0,1,0]
  v_pk_fma_f32 v[168:169], v[168:169], v[92:93], v[100:101] op_sel:[0,1,0] op_sel_hi:[1,1,1]
  v_pk_fma_f32 v[170:171], v[170:171], v[92:93], v[102:103] op_sel:[0,1,0] op_sel_hi:[1,1,1]
  v_pk_mul_f32 v[100:101], v[168:169], v[168:169]
  v_pk_mul_f32 v[102:103], v[170:171], v[170:171]
  v_pk_fma_f32 v[100:101], v[100:101], v[96:97], v[96:97] op_sel:[0,1,0] op_sel_hi:[1,1,0]
  v_pk_fma_f32 v[102:103], v[102:103], v[96:97], v[96:97] op_sel:[0,1,0] op_sel_hi:[1,1,0]
  v_pk_mul_f32 v[100:101], v[100:101], v[168:169]
  v_pk_mul_f32 v[102:103], v[102:103], v[170:171]
  v_exp_f32 v100, v100
  v_exp_f32 v101, v101
  v_exp_f32 v102, v102
  v_exp_f32 v103, v103
  v_pk_add_f32 v[100:101], v[100:101], v[98:99] op_sel_hi:[1,0]
  v_pk_add_f32 v[102:103], v[102:103], v[98:99] op_sel_hi:[1,0]
  v_rcp_f32 v100, v100
  v_rcp_f32 v101, v101
  v_rcp_f32 v102, v102
  v_rcp_f32 v103, v103
  v_pk_mul_f32 v[168:169], v[168:169], v[100:101]
  v_pk_mul_f32 v[170:171], v[170:171], v[102:103]
  v_cvt_pk_bf16_f32 v116, v168, v169
  v_cvt_pk_bf16_f32 v117, v170, v171
  v_pk_fma_f32 v[104:105], v[44:45], v[92:93], v[72:73] op_sel:[0,0,0] op_sel_hi:[1,0,1] neg_lo:[0,1,0] neg_hi:[0,1,0]
  v_pk_fma_f32 v[106:107], v[46:47], v[92:93], v[74:75] op_sel:[0,0,0] op_sel_hi:[1,0,1] neg_lo:[0,1,0] neg_hi:[0,1,0]
  v_pk_fma_f32 v[184:185], v[184:185], v[92:93], v[104:105] op_sel:[0,1,0] op_sel_hi:[1,1,1]
  v_pk_fma_f32 v[186:187], v[186:187], v[92:93], v[106:107] op_sel:[0,1,0] op_sel_hi:[1,1,1]
  v_pk_mul_f32 v[104:105], v[184:185], v[184:185]
  v_pk_mul_f32 v[106:107], v[186:187], v[186:187]
  v_pk_fma_f32 v[104:105], v[104:105], v[96:97], v[96:97] op_sel:[0,1,0] op_sel_hi:[1,1,0]
  v_pk_fma_f32 v[106:107], v[106:107], v[96:97], v[96:97] op_sel:[0,1,0] op_sel_hi:[1,1,0]
  v_pk_mul_f32 v[104:105], v[104:105], v[184:185]
  v_pk_mul_f32 v[106:107], v[106:107], v[186:187]
  v_exp_f32 v104, v104
  v_exp_f32 v105, v105
  v_exp_f32 v106, v106
  v_exp_f32 v107, v107
  v_pk_add_f32 v[104:105], v[104:105], v[98:99] op_sel_hi:[1,0]
  v_pk_add_f32 v[106:107], v[106:107], v[98:99] op_sel_hi:[1,0]
  v_rcp_f32 v104, v104
  v_rcp_f32 v105, v105
  v_rcp_f32 v106, v106
  v_rcp_f32 v107, v107
  v_pk_mul_f32 v[184:185], v[184:185], v[104:105]
  v_pk_mul_f32 v[186:187], v[186:187], v[106:107]
  v_cvt_pk_bf16_f32 v118, v184, v185
  v_cvt_pk_bf16_f32 v119, v186, v187
  s_add_u32 s3, s10, 278528
  s_nop 0
  v_permlane16_swap_b32 v116, v118
  v_permlane16_swap_b32 v117, v119
  buffer_store_dwordx4 v[116:119], v12, s[44:47], s3 offen sc1
  v_pk_fma_f32 v[100:101], v[48:49], v[92:93], v[76:77] op_sel:[0,0,0] op_sel_hi:[1,0,1] neg_lo:[0,1,0] neg_hi:[0,1,0]
  v_pk_fma_f32 v[102:103], v[50:51], v[92:93], v[78:79] op_sel:[0,0,0] op_sel_hi:[1,0,1] neg_lo:[0,1,0] neg_hi:[0,1,0]
  v_pk_fma_f32 v[200:201], v[200:201], v[92:93], v[100:101] op_sel:[0,1,0] op_sel_hi:[1,1,1]
  v_pk_fma_f32 v[202:203], v[202:203], v[92:93], v[102:103] op_sel:[0,1,0] op_sel_hi:[1,1,1]
  v_pk_mul_f32 v[100:101], v[200:201], v[200:201]
  v_pk_mul_f32 v[102:103], v[202:203], v[202:203]
  v_pk_fma_f32 v[100:101], v[100:101], v[96:97], v[96:97] op_sel:[0,1,0] op_sel_hi:[1,1,0]
  v_pk_fma_f32 v[102:103], v[102:103], v[96:97], v[96:97] op_sel:[0,1,0] op_sel_hi:[1,1,0]
  v_pk_mul_f32 v[100:101], v[100:101], v[200:201]
  v_pk_mul_f32 v[102:103], v[102:103], v[202:203]
  v_exp_f32 v100, v100
  v_exp_f32 v101, v101
  v_exp_f32 v102, v102
  v_exp_f32 v103, v103
  v_pk_add_f32 v[100:101], v[100:101], v[98:99] op_sel_hi:[1,0]
  v_pk_add_f32 v[102:103], v[102:103], v[98:99] op_sel_hi:[1,0]
  v_rcp_f32 v100, v100
  v_rcp_f32 v101, v101
  v_rcp_f32 v102, v102
  v_rcp_f32 v103, v103
  v_pk_mul_f32 v[200:201], v[200:201], v[100:101]
  v_pk_mul_f32 v[202:203], v[202:203], v[102:103]
  v_cvt_pk_bf16_f32 v120, v200, v201
  v_cvt_pk_bf16_f32 v121, v202, v203
  v_pk_fma_f32 v[104:105], v[52:53], v[92:93], v[80:81] op_sel:[0,0,0] op_sel_hi:[1,0,1] neg_lo:[0,1,0] neg_hi:[0,1,0]
  v_pk_fma_f32 v[106:107], v[54:55], v[92:93], v[82:83] op_sel:[0,0,0] op_sel_hi:[1,0,1] neg_lo:[0,1,0] neg_hi:[0,1,0]
  v_pk_fma_f32 v[216:217], v[216:217], v[92:93], v[104:105] op_sel:[0,1,0] op_sel_hi:[1,1,1]
  v_pk_fma_f32 v[218:219], v[218:219], v[92:93], v[106:107] op_sel:[0,1,0] op_sel_hi:[1,1,1]
  v_pk_mul_f32 v[104:105], v[216:217], v[216:217]
  v_pk_mul_f32 v[106:107], v[218:219], v[218:219]
  v_pk_fma_f32 v[104:105], v[104:105], v[96:97], v[96:97] op_sel:[0,1,0] op_sel_hi:[1,1,0]
  v_pk_fma_f32 v[106:107], v[106:107], v[96:97], v[96:97] op_sel:[0,1,0] op_sel_hi:[1,1,0]
  v_pk_mul_f32 v[104:105], v[104:105], v[216:217]
  v_pk_mul_f32 v[106:107], v[106:107], v[218:219]
  v_exp_f32 v104, v104
  v_exp_f32 v105, v105
  v_exp_f32 v106, v106
  v_exp_f32 v107, v107
  v_pk_add_f32 v[104:105], v[104:105], v[98:99] op_sel_hi:[1,0]
  v_pk_add_f32 v[106:107], v[106:107], v[98:99] op_sel_hi:[1,0]
  v_rcp_f32 v104, v104
  v_rcp_f32 v105, v105
  v_rcp_f32 v106, v106
  v_rcp_f32 v107, v107
  v_pk_mul_f32 v[216:217], v[216:217], v[104:105]
  v_pk_mul_f32 v[218:219], v[218:219], v[106:107]
  v_cvt_pk_bf16_f32 v122, v216, v217
  v_cvt_pk_bf16_f32 v123, v218, v219
  s_add_u32 s3, s10, 280576
  s_nop 0
  v_permlane16_swap_b32 v120, v122
  v_permlane16_swap_b32 v121, v123
  buffer_store_dwordx4 v[120:123], v12, s[44:47], s3 offen sc1
  v_pk_fma_f32 v[100:101], v[40:41], v[94:95], v[68:69] op_sel:[0,0,0] op_sel_hi:[1,0,1] neg_lo:[0,1,0] neg_hi:[0,1,0]
  v_pk_fma_f32 v[102:103], v[42:43], v[94:95], v[70:71] op_sel:[0,0,0] op_sel_hi:[1,0,1] neg_lo:[0,1,0] neg_hi:[0,1,0]
  v_pk_fma_f32 v[172:173], v[172:173], v[94:95], v[100:101] op_sel:[0,1,0] op_sel_hi:[1,1,1]
  v_pk_fma_f32 v[174:175], v[174:175], v[94:95], v[102:103] op_sel:[0,1,0] op_sel_hi:[1,1,1]
  v_pk_mul_f32 v[100:101], v[172:173], v[172:173]
  v_pk_mul_f32 v[102:103], v[174:175], v[174:175]
  v_pk_fma_f32 v[100:101], v[100:101], v[96:97], v[96:97] op_sel:[0,1,0] op_sel_hi:[1,1,0]
  v_pk_fma_f32 v[102:103], v[102:103], v[96:97], v[96:97] op_sel:[0,1,0] op_sel_hi:[1,1,0]
  v_pk_mul_f32 v[100:101], v[100:101], v[172:173]
  v_pk_mul_f32 v[102:103], v[102:103], v[174:175]
  v_exp_f32 v100, v100
  v_exp_f32 v101, v101
  v_exp_f32 v102, v102
  v_exp_f32 v103, v103
  v_pk_add_f32 v[100:101], v[100:101], v[98:99] op_sel_hi:[1,0]
  v_pk_add_f32 v[102:103], v[102:103], v[98:99] op_sel_hi:[1,0]
  v_rcp_f32 v100, v100
  v_rcp_f32 v101, v101
  v_rcp_f32 v102, v102
  v_rcp_f32 v103, v103
  v_pk_mul_f32 v[172:173], v[172:173], v[100:101]
  v_pk_mul_f32 v[174:175], v[174:175], v[102:103]
  v_cvt_pk_bf16_f32 v108, v172, v173
  v_cvt_pk_bf16_f32 v109, v174, v175
  v_pk_fma_f32 v[104:105], v[44:45], v[94:95], v[72:73] op_sel:[0,0,0] op_sel_hi:[1,0,1] neg_lo:[0,1,0] neg_hi:[0,1,0]
  v_pk_fma_f32 v[106:107], v[46:47], v[94:95], v[74:75] op_sel:[0,0,0] op_sel_hi:[1,0,1] neg_lo:[0,1,0] neg_hi:[0,1,0]
  v_pk_fma_f32 v[188:189], v[188:189], v[94:95], v[104:105] op_sel:[0,1,0] op_sel_hi:[1,1,1]
  v_pk_fma_f32 v[190:191], v[190:191], v[94:95], v[106:107] op_sel:[0,1,0] op_sel_hi:[1,1,1]
  v_pk_mul_f32 v[104:105], v[188:189], v[188:189]
  v_pk_mul_f32 v[106:107], v[190:191], v[190:191]
  v_pk_fma_f32 v[104:105], v[104:105], v[96:97], v[96:97] op_sel:[0,1,0] op_sel_hi:[1,1,0]
  v_pk_fma_f32 v[106:107], v[106:107], v[96:97], v[96:97] op_sel:[0,1,0] op_sel_hi:[1,1,0]
  v_pk_mul_f32 v[104:105], v[104:105], v[188:189]
  v_pk_mul_f32 v[106:107], v[106:107], v[190:191]
  v_exp_f32 v104, v104
  v_exp_f32 v105, v105
  v_exp_f32 v106, v106
  v_exp_f32 v107, v107
  v_pk_add_f32 v[104:105], v[104:105], v[98:99] op_sel_hi:[1,0]
  v_pk_add_f32 v[106:107], v[106:107], v[98:99] op_sel_hi:[1,0]
  v_rcp_f32 v104, v104
  v_rcp_f32 v105, v105
  v_rcp_f32 v106, v106
  v_rcp_f32 v107, v107
  v_pk_mul_f32 v[188:189], v[188:189], v[104:105]
  v_pk_mul_f32 v[190:191], v[190:191], v[106:107]
  v_cvt_pk_bf16_f32 v110, v188, v189
  v_cvt_pk_bf16_f32 v111, v190, v191
  s_add_u32 s3, s10, 393216
  s_nop 0
  v_permlane16_swap_b32 v108, v110
  v_permlane16_swap_b32 v109, v111
  buffer_store_dwordx4 v[108:111], v12, s[44:47], s3 offen sc1
  v_pk_fma_f32 v[100:101], v[48:49], v[94:95], v[76:77] op_sel:[0,0,0] op_sel_hi:[1,0,1] neg_lo:[0,1,0] neg_hi:[0,1,0]
  v_pk_fma_f32 v[102:103], v[50:51], v[94:95], v[78:79] op_sel:[0,0,0] op_sel_hi:[1,0,1] neg_lo:[0,1,0] neg_hi:[0,1,0]
  v_pk_fma_f32 v[204:205], v[204:205], v[94:95], v[100:101] op_sel:[0,1,0] op_sel_hi:[1,1,1]
  v_pk_fma_f32 v[206:207], v[206:207], v[94:95], v[102:103] op_sel:[0,1,0] op_sel_hi:[1,1,1]
  v_pk_mul_f32 v[100:101], v[204:205], v[204:205]
  v_pk_mul_f32 v[102:103], v[206:207], v[206:207]
  v_pk_fma_f32 v[100:101], v[100:101], v[96:97], v[96:97] op_sel:[0,1,0] op_sel_hi:[1,1,0]
  v_pk_fma_f32 v[102:103], v[102:103], v[96:97], v[96:97] op_sel:[0,1,0] op_sel_hi:[1,1,0]
  v_pk_mul_f32 v[100:101], v[100:101], v[204:205]
  v_pk_mul_f32 v[102:103], v[102:103], v[206:207]
  v_exp_f32 v100, v100
  v_exp_f32 v101, v101
  v_exp_f32 v102, v102
  v_exp_f32 v103, v103
  v_pk_add_f32 v[100:101], v[100:101], v[98:99] op_sel_hi:[1,0]
  v_pk_add_f32 v[102:103], v[102:103], v[98:99] op_sel_hi:[1,0]
  v_rcp_f32 v100, v100
  v_rcp_f32 v101, v101
  v_rcp_f32 v102, v102
  v_rcp_f32 v103, v103
  v_pk_mul_f32 v[204:205], v[204:205], v[100:101]
  v_pk_mul_f32 v[206:207], v[206:207], v[102:103]
  v_cvt_pk_bf16_f32 v112, v204, v205
  v_cvt_pk_bf16_f32 v113, v206, v207
  v_pk_fma_f32 v[104:105], v[52:53], v[94:95], v[80:81] op_sel:[0,0,0] op_sel_hi:[1,0,1] neg_lo:[0,1,0] neg_hi:[0,1,0]
  v_pk_fma_f32 v[106:107], v[54:55], v[94:95], v[82:83] op_sel:[0,0,0] op_sel_hi:[1,0,1] neg_lo:[0,1,0] neg_hi:[0,1,0]
  v_pk_fma_f32 v[220:221], v[220:221], v[94:95], v[104:105] op_sel:[0,1,0] op_sel_hi:[1,1,1]
  v_pk_fma_f32 v[222:223], v[222:223], v[94:95], v[106:107] op_sel:[0,1,0] op_sel_hi:[1,1,1]
  v_pk_mul_f32 v[104:105], v[220:221], v[220:221]
  v_pk_mul_f32 v[106:107], v[222:223], v[222:223]
  v_pk_fma_f32 v[104:105], v[104:105], v[96:97], v[96:97] op_sel:[0,1,0] op_sel_hi:[1,1,0]
  v_pk_fma_f32 v[106:107], v[106:107], v[96:97], v[96:97] op_sel:[0,1,0] op_sel_hi:[1,1,0]
  v_pk_mul_f32 v[104:105], v[104:105], v[220:221]
  v_pk_mul_f32 v[106:107], v[106:107], v[222:223]
  v_exp_f32 v104, v104
  v_exp_f32 v105, v105
  v_exp_f32 v106, v106
  v_exp_f32 v107, v107
  v_pk_add_f32 v[104:105], v[104:105], v[98:99] op_sel_hi:[1,0]
  v_pk_add_f32 v[106:107], v[106:107], v[98:99] op_sel_hi:[1,0]
  v_rcp_f32 v104, v104
  v_rcp_f32 v105, v105
  v_rcp_f32 v106, v106
  v_rcp_f32 v107, v107
  v_pk_mul_f32 v[220:221], v[220:221], v[104:105]
  v_pk_mul_f32 v[222:223], v[222:223], v[106:107]
  v_cvt_pk_bf16_f32 v114, v220, v221
  v_cvt_pk_bf16_f32 v115, v222, v223
  s_add_u32 s3, s10, 395264
  s_nop 0
  v_permlane16_swap_b32 v112, v114
  v_permlane16_swap_b32 v113, v115
  buffer_store_dwordx4 v[112:115], v12, s[44:47], s3 offen sc1
  s_waitcnt vmcnt(0) lgkmcnt(0)
  s_barrier
  s_add_u32 s97, s97, 1
  s_branch L_w2_body
L_w1_c1:
L_w2_c0:
L_w2_body:
  s_cmp_ge_u32 s2, 256
  s_cbranch_scc1 L_w2_end
  v_lshrrev_b32 v2, 6, v0
  v_and_b32 v1, 63, v0
  v_readfirstlane_b32 s70, v2
  s_and_b32 s3, s2, 7
  s_lshr_b32 s99, s2, 3
  s_and_b32 s5, s3, 3
  s_lshl_b32 s5, s5, 2
  s_and_b32 s6, s99, 3
  s_add_u32 s68, s5, s6
  s_lshr_b32 s5, s3, 2
  s_lshr_b32 s78, s99, 2
  s_lshl1_add_u32 s69, s78, s5
  s_add_u32 s3, s68, s78
  s_lshl_b32 s3, s3, 3
  s_lshl_b32 s85, 0xffff02, s3
  s_sub_u32 s3, 0, s3
  s_lshr_b32 s3, 0xffff02, s3
  s_or_b32 s85, s85, s3
  s_cmp_lt_u32 s70, 4
  s_cbranch_scc1 L_w2_compute
L_w2_loader:
  v_and_b32 v2, 3, v1
  v_lshlrev_b32 v2, 3, v2
  v_bfe_i32 v16, s85, v2, 8
  s_and_b32 s3, s68, 3
  s_mul_i32 s4, s3, 4
  v_add3_u32 v3, v16, v1, s4
  v_subrev_u32 v3, 20, v3
  v_and_b32 v3, 15, v3
  v_add3_u32 v16, v16, v1, 20
  s_mul_i32 s3, s3, 1
  s_bitcmp1_b32 s69, 0
  s_cselect_b32 s4, 20, 0
  v_subrev_u32 v2, 20, v16
  v_min_u32 v16, v16, v2
  v_subrev_u32 v2, 20, v16
  v_min_u32 v16, v16, v2
  v_cmp_gt_u32 vcc, 4, v16
  v_add_u32 v2, s3, v16
  v_subrev_u32 v17, 4, v2
  v_min_u32 v2, v17, v2
  v_cndmask_b32 v16, v16, v2, vcc
  v_cmp_gt_u32 vcc, 20, v1
  v_add_u32 v16, s4, v16
  v_add_u32 v3, 40, v3
  v_cndmask_b32 v3, v3, v16, vcc
  v_lshlrev_b32 v16, 17, v3
  s_add_u32 s9, s70, s68
  s_and_b32 s9, s9, 3
  s_lshl_b32 s77, s9, 11
  v_and_b32 v10, 7, v1
  v_lshrrev_b32 v3, 3, v1
  s_lshl_b32 s10, s9, 4
  v_add_u32 v3, s10, v3
  v_mul_u32_u24 v3, 2048, v3
  v_lshrrev_b32 v2, 3, v1
  v_and_b32 v2, 2, v2
  v_xor_b32 v2, v2, v10
  s_lshl_b32 s10, s69, 7
  v_add_u32 v3, s10, v3
  v_lshl_add_u32 v8, v2, 4, v3
  v_xor_b32 v2, 4, v2
  v_add_u32 v3, 16384, v3
  v_lshl_add_u32 v9, v2, 4, v3
  s_mov_b32 s40, s28
  s_and_b32 s41, s29, 0xffff
  s_mov_b32 s42, 7340032
  s_mov_b32 s43, 0x00020000
  s_bitcmp1_b32 s69, 0
  s_mov_b32 s76, 128
  s_cselect_b32 s76, -128, s76
  v_readlane_b32 s74, v16, 0
  s_add_u32 m0, s77, 0
  s_add_u32 s4, s74, s76
  buffer_load_dwordx4 v8, s[40:43], s4 offen lds
  s_add_u32 m0, s77, 1024
  s_nop 0
  buffer_load_dwordx4 v9, s[40:43], s4 offen lds
  s_add_u32 m0, s77, 8192
  s_add_u32 s4, s74, 0
  buffer_load_dwordx4 v8, s[40:43], s4 offen lds
  s_add_u32 m0, s77, 9216
  s_nop 0
  buffer_load_dwordx4 v9, s[40:43], s4 offen lds
  v_readlane_b32 s74, v16, 1
  s_add_u32 m0, s77, 16384
  s_add_u32 s4, s74, s76
  buffer_load_dwordx4 v8, s[40:43], s4 offen lds
  s_add_u32 m0, s77, 17408
  s_nop 0
  buffer_load_dwordx4 v9, s[40:43], s4 offen lds
  s_add_u32 m0, s77, 24576
  s_add_u32 s4, s74, 0
  buffer_load_dwordx4 v8, s[40:43], s4 offen lds
  s_add_u32 m0, s77, 25600
  s_nop 0
  buffer_load_dwordx4 v9, s[40:43], s4 offen lds
  v_readlane_b32 s74, v16, 2
  s_add_u32 m0, s77, 32768
  s_add_u32 s4, s74, s76
  buffer_load_dwordx4 v8, s[40:43], s4 offen lds
  s_add_u32 m0, s77, 33792
  s_nop 0
  buffer_load_dwordx4 v9, s[40:43], s4 offen lds
  s_add_u32 m0, s77, 40960
  s_add_u32 s4, s74, 0
  buffer_load_dwordx4 v8, s[40:43], s4 offen lds
  s_add_u32 m0, s77, 41984
  s_nop 0
  buffer_load_dwordx4 v9, s[40:43], s4 offen lds
  v_readlane_b32 s74, v16, 3
  s_add_u32 m0, s77, 49152
  s_add_u32 s4, s74, s76
  buffer_load_dwordx4 v8, s[40:43], s4 offen lds
  s_add_u32 m0, s77, 50176
  s_nop 0
  buffer_load_dwordx4 v9, s[40:43], s4 offen lds
  s_add_u32 m0, s77, 57344
  s_add_u32 s4, s74, 0
  buffer_load_dwordx4 v8, s[40:43], s4 offen lds
  s_add_u32 m0, s77, 58368
  s_nop 0
  buffer_load_dwordx4 v9, s[40:43], s4 offen lds
  v_readlane_b32 s74, v16, 4
  s_add_u32 m0, s77, 65536
  s_add_u32 s4, s74, s76
  buffer_load_dwordx4 v8, s[40:43], s4 offen lds
  s_add_u32 m0, s77, 66560
  s_nop 0
  buffer_load_dwordx4 v9, s[40:43], s4 offen lds
  s_add_u32 m0, s77, 73728
  s_add_u32 s4, s74, 0
  buffer_load_dwordx4 v8, s[40:43], s4 offen lds
  s_add_u32 m0, s77, 74752
  s_nop 0
  buffer_load_dwordx4 v9, s[40:43], s4 offen lds
  s_add_u32 s44, s22, 24903680
  s_addc_u32 s45, s23, 0
  s_and_b32 s45, s45, 0xffff
  s_mov_b32 s46, 32768
  s_mov_b32 s47, 0x00020000
  s_lshl_b32 s3, s97, 12
  s_lshl_b32 s4, s68, 8
  s_add_u32 s3, s3, s4
  s_sub_u32 s3, s3, 4096
  v_and_b32 v2, 15, v1
  v_lshlrev_b32 v2, 2, v2
  v_mov_b32 v3, 1
  s_mov_b32 s79, 0x100000
  s_cmp_lg_u32 s70, 4
  s_barrier
  s_cbranch_scc1 L_w2_nofl
  s_mov_b64 exec, 1
  buffer_store_dword v3, off, s[44:47], s87 sc1
  s_mov_b64 exec, -1
L_w2_nofl:
  s_mov_b32 s5, s3
  v_readlane_b32 s74, v16, 5
  s_add_u32 m0, s77, 81920
  s_add_u32 s4, s74, s76
  buffer_load_dwordx4 v8, s[40:43], s4 offen lds
  s_add_u32 m0, s77, 82944
  s_nop 0
  buffer_load_dwordx4 v9, s[40:43], s4 offen lds
  s_add_u32 m0, s77, 90112
  s_add_u32 s4, s74, 0
  buffer_load_dwordx4 v8, s[40:43], s4 offen lds
  s_add_u32 m0, s77, 91136
  s_nop 0
  buffer_load_dwordx4 v9, s[40:43], s4 offen lds
  v_readlane_b32 s74, v16, 6
  s_add_u32 m0, s77, 98304
  s_add_u32 s4, s74, s76
  buffer_load_dwordx4 v8, s[40:43], s4 offen lds
  s_add_u32 m0, s77, 99328
  s_nop 0
  buffer_load_dwordx4 v9, s[40:43], s4 offen lds
  s_add_u32 m0, s77, 106496
  s_add_u32 s4, s74, 0
  buffer_load_dwordx4 v8, s[40:43], s4 offen lds
  s_add_u32 m0, s77, 107520
  s_nop 0
  buffer_load_dwordx4 v9, s[40:43], s4 offen lds
  v_readlane_b32 s74, v16, 7
  s_add_u32 m0, s77, 114688
  s_add_u32 s4, s74, s76
  buffer_load_dwordx4 v8, s[40:43], s4 offen lds
  s_add_u32 m0, s77, 115712
  s_nop 0
  buffer_load_dwordx4 v9, s[40:43], s4 offen lds
  s_add_u32 m0, s77, 122880
  s_add_u32 s4, s74, 0
  buffer_load_dwordx4 v8, s[40:43], s4 offen lds
  s_add_u32 m0, s77, 123904
  s_nop 0
  buffer_load_dwordx4 v9, s[40:43], s4 offen lds
  v_readlane_b32 s74, v16, 8
  s_add_u32 m0, s77, 131072
  s_add_u32 s4, s74, s76
  buffer_load_dwordx4 v8, s[40:43], s4 offen lds
  s_add_u32 m0, s77, 132096
  s_nop 0
  buffer_load_dwordx4 v9, s[40:43], s4 offen lds
  s_add_u32 m0, s77, 139264
  s_add_u32 s4, s74, 0
  buffer_load_dwordx4 v8, s[40:43], s4 offen lds
  s_add_u32 m0, s77, 140288
  s_nop 0
  buffer_load_dwordx4 v9, s[40:43], s4 offen lds
  v_readlane_b32 s74, v16, 9
  s_add_u32 m0, s77, 147456
  s_add_u32 s4, s74, s76
  buffer_load_dwordx4 v8, s[40:43], s4 offen lds
  s_add_u32 m0, s77, 148480
  s_nop 0
  buffer_load_dwordx4 v9, s[40:43], s4 offen lds
  s_add_u32 m0, s77, 155648
  s_add_u32 s4, s74, 0
  buffer_load_dwordx4 v8, s[40:43], s4 offen lds
  s_add_u32 m0, s77, 156672
  s_nop 0
  buffer_load_dwordx4 v9, s[40:43], s4 offen lds
  s_mov_b32 s3, s5
  s_cmp_lg_u32 s70, 4
  s_cbranch_scc1 L_w2_dep
L_w2_poll:
  buffer_load_dword v3, v2, s[44:47], s3 offen sc1
  s_sub_u32 s79, s79, 1
  s_cbranch_scc1 L_w2_dep
  s_waitcnt vmcnt(0)
  v_cmp_ne_u32 vcc, 1, v3
  s_cbranch_vccnz L_w2_poll
L_w2_dep:
  s_waitcnt vmcnt(30) lgkmcnt(0)
  s_barrier
  s_waitcnt vmcnt(22)
  s_barrier
  v_readlane_b32 s74, v16, 10
  s_add_u32 m0, s77, 0
  s_add_u32 s4, s74, s76
  buffer_load_dwordx4 v8, s[40:43], s4 offen lds
  s_add_u32 m0, s77, 1024
  s_nop 0
  buffer_load_dwordx4 v9, s[40:43], s4 offen lds
  s_waitcnt vmcnt(4)
  s_add_u32 m0, s77, 8192
  s_add_u32 s4, s74, 0
  buffer_load_dwordx4 v8, s[40:43], s4 offen lds
  s_add_u32 m0, s77, 9216
  s_nop 0
  buffer_load_dwordx4 v9, s[40:43], s4 offen lds
  s_waitcnt vmcnt(4)
  v_readlane_b32 s74, v16, 11
  s_add_u32 m0, s77, 16384
  s_add_u32 s4, s74, s76
  buffer_load_dwordx4 v8, s[40:43], s4 offen lds
  s_add_u32 m0, s77, 17408
  s_nop 0
  buffer_load_dwordx4 v9, s[40:43], s4 offen lds
  s_waitcnt vmcnt(4)
  s_add_u32 m0, s77, 24576
  s_add_u32 s4, s74, 0
  buffer_load_dwordx4 v8, s[40:43], s4 offen lds
  s_add_u32 m0, s77, 25600
  s_nop 0
  buffer_load_dwordx4 v9, s[40:43], s4 offen lds
  s_waitcnt vmcnt(22)
  s_barrier
  v_readlane_b32 s74, v16, 12
  s_add_u32 m0, s77, 32768
  s_add_u32 s4, s74, s76
  buffer_load_dwordx4 v8, s[40:43], s4 offen lds
  s_add_u32 m0, s77, 33792
  s_nop 0
  buffer_load_dwordx4 v9, s[40:43], s4 offen lds
  s_waitcnt vmcnt(4)
  s_add_u32 m0, s77, 40960
  s_add_u32 s4, s74, 0
  buffer_load_dwordx4 v8, s[40:43], s4 offen lds
  s_add_u32 m0, s77, 41984
  s_nop 0
  buffer_load_dwordx4 v9, s[40:43], s4 offen lds
  s_waitcnt vmcnt(4)
  v_readlane_b32 s74, v16, 13
  s_add_u32 m0, s77, 49152
  s_add_u32 s4, s74, s76
  buffer_load_dwordx4 v8, s[40:43], s4 offen lds
  s_add_u32 m0, s77, 50176
  s_nop 0
  buffer_load_dwordx4 v9, s[40:43], s4 offen lds
  s_waitcnt vmcnt(4)
  s_add_u32 m0, s77, 57344
  s_add_u32 s4, s74, 0
  buffer_load_dwordx4 v8, s[40:43], s4 offen lds
  s_add_u32 m0, s77, 58368
  s_nop 0
  buffer_load_dwordx4 v9, s[40:43], s4 offen lds
  s_waitcnt vmcnt(22)
  s_barrier
  v_readlane_b32 s74, v16, 14
  s_add_u32 m0, s77, 65536
  s_add_u32 s4, s74, s76
  buffer_load_dwordx4 v8, s[40:43], s4 offen lds
  s_add_u32 m0, s77, 66560
  s_nop 0
  buffer_load_dwordx4 v9, s[40:43], s4 offen lds
  s_waitcnt vmcnt(4)
  s_add_u32 m0, s77, 73728
  s_add_u32 s4, s74, 0
  buffer_load_dwordx4 v8, s[40:43], s4 offen lds
  s_add_u32 m0, s77, 74752
  s_nop 0
  buffer_load_dwordx4 v9, s[40:43], s4 offen lds
  s_waitcnt vmcnt(4)
  v_readlane_b32 s74, v16, 15
  s_add_u32 m0, s77, 81920
  s_add_u32 s4, s74, s76
  buffer_load_dwordx4 v8, s[40:43], s4 offen lds
  s_add_u32 m0, s77, 82944
  s_nop 0
  buffer_load_dwordx4 v9, s[40:43], s4 offen lds
  s_waitcnt vmcnt(4)
  s_add_u32 m0, s77, 90112
  s_add_u32 s4, s74, 0
  buffer_load_dwordx4 v8, s[40:43], s4 offen lds
  s_add_u32 m0, s77, 91136
  s_nop 0
  buffer_load_dwordx4 v9, s[40:43], s4 offen lds
  s_waitcnt vmcnt(22)
  s_barrier
  v_readlane_b32 s74, v16, 16
  s_add_u32 m0, s77, 98304
  s_add_u32 s4, s74, s76
  buffer_load_dwordx4 v8, s[40:43], s4 offen lds
  s_add_u32 m0, s77, 99328
  s_nop 0
  buffer_load_dwordx4 v9, s[40:43], s4 offen lds
  s_waitcnt vmcnt(4)
  s_add_u32 m0, s77, 106496
  s_add_u32 s4, s74, 0
  buffer_load_dwordx4 v8, s[40:43], s4 offen lds
  s_add_u32 m0, s77, 107520
  s_nop 0
  buffer_load_dwordx4 v9, s[40:43], s4 offen lds
  s_waitcnt vmcnt(4)
  v_readlane_b32 s74, v16, 17
  s_add_u32 m0, s77, 114688
  s_add_u32 s4, s74, s76
  buffer_load_dwordx4 v8, s[40:43], s4 offen lds
  s_add_u32 m0, s77, 115712
  s_nop 0
  buffer_load_dwordx4 v9, s[40:43], s4 offen lds
  s_waitcnt vmcnt(4)
  s_add_u32 m0, s77, 122880
  s_add_u32 s4, s74, 0
  buffer_load_dwordx4 v8, s[40:43], s4 offen lds
  s_add_u32 m0, s77, 123904
  s_nop 0
  buffer_load_dwordx4 v9, s[40:43], s4 offen lds
  s_waitcnt vmcnt(22)
  s_barrier
  v_readlane_b32 s74, v16, 18
  s_add_u32 m0, s77, 131072
  s_add_u32 s4, s74, s76
  buffer_load_dwordx4 v8, s[40:43], s4 offen lds
  s_add_u32 m0, s77, 132096
  s_nop 0
  buffer_load_dwordx4 v9, s[40:43], s4 offen lds
  s_waitcnt vmcnt(4)
  s_add_u32 m0, s77, 139264
  s_add_u32 s4, s74, 0
  buffer_load_dwordx4 v8, s[40:43], s4 offen lds
  s_add_u32 m0, s77, 140288
  s_nop 0
  buffer_load_dwordx4 v9, s[40:43], s4 offen lds
  s_waitcnt vmcnt(4)
  v_readlane_b32 s74, v16, 19
  s_add_u32 m0, s77, 147456
  s_add_u32 s4, s74, s76
  buffer_load_dwordx4 v8, s[40:43], s4 offen lds
  s_add_u32 m0, s77, 148480
  s_nop 0
  buffer_load_dwordx4 v9, s[40:43], s4 offen lds
  s_waitcnt vmcnt(4)
  s_add_u32 m0, s77, 155648
  s_add_u32 s4, s74, 0
  buffer_load_dwordx4 v8, s[40:43], s4 offen lds
  s_add_u32 m0, s77, 156672
  s_nop 0
  buffer_load_dwordx4 v9, s[40:43], s4 offen lds
  s_waitcnt vmcnt(22)
  s_barrier
  v_readlane_b32 s74, v16, 20
  s_add_u32 m0, s77, 0
  s_add_u32 s4, s74, 0
  buffer_load_dwordx4 v8, s[40:43], s4 offen lds
  s_add_u32 m0, s77, 1024
  s_nop 0
  buffer_load_dwordx4 v9, s[40:43], s4 offen lds
  s_waitcnt vmcnt(4)
  v_readlane_b32 s74, v16, 21
  s_add_u32 m0, s77, 8192
  s_add_u32 s4, s74, 0
  buffer_load_dwordx4 v8, s[40:43], s4 offen lds
  s_add_u32 m0, s77, 9216
  s_nop 0
  buffer_load_dwordx4 v9, s[40:43], s4 offen lds
  s_waitcnt vmcnt(4)
  v_readlane_b32 s74, v16, 22
  s_add_u32 m0, s77, 16384
  s_add_u32 s4, s74, 0
  buffer_load_dwordx4 v8, s[40:43], s4 offen lds
  s_add_u32 m0, s77, 17408
  s_nop 0
  buffer_load_dwordx4 v9, s[40:43], s4 offen lds
  s_waitcnt vmcnt(4)
  v_readlane_b32 s74, v16, 23
  s_add_u32 m0, s77, 24576
  s_add_u32 s4, s74, 0
  buffer_load_dwordx4 v8, s[40:43], s4 offen lds
  s_add_u32 m0, s77, 25600
  s_nop 0
  buffer_load_dwordx4 v9, s[40:43], s4 offen lds
  s_waitcnt vmcnt(22)
  s_barrier
  v_readlane_b32 s74, v16, 24
  s_add_u32 m0, s77, 32768
  s_add_u32 s4, s74, 0
  buffer_load_dwordx4 v8, s[40:43], s4 offen lds
  s_add_u32 m0, s77, 33792
  s_nop 0
  buffer_load_dwordx4 v9, s[40:43], s4 offen lds
  s_waitcnt vmcnt(4)
  v_readlane_b32 s74, v16, 25
  s_add_u32 m0, s77, 40960
  s_add_u32 s4, s74, 0
  buffer_load_dwordx4 v8, s[40:43], s4 offen lds
  s_add_u32 m0, s77, 41984
  s_nop 0
  buffer_load_dwordx4 v9, s[40:43], s4 offen lds
  s_waitcnt vmcnt(4)
  v_readlane_b32 s74, v16, 26
  s_add_u32 m0, s77, 49152
  s_add_u32 s4, s74, 0
  buffer_load_dwordx4 v8, s[40:43], s4 offen lds
  s_add_u32 m0, s77, 50176
  s_nop 0
  buffer_load_dwordx4 v9, s[40:43], s4 offen lds
  s_waitcnt vmcnt(4)
  v_readlane_b32 s74, v16, 27
  s_add_u32 m0, s77, 57344
  s_add_u32 s4, s74, 0
  buffer_load_dwordx4 v8, s[40:43], s4 offen lds
  s_add_u32 m0, s77, 58368
  s_nop 0
  buffer_load_dwordx4 v9, s[40:43], s4 offen lds
  s_waitcnt vmcnt(22)
  s_barrier
  v_readlane_b32 s74, v16, 28
  s_add_u32 m0, s77, 65536
  s_add_u32 s4, s74, 0
  buffer_load_dwordx4 v8, s[40:43], s4 offen lds
  s_add_u32 m0, s77, 66560
  s_nop 0
  buffer_load_dwordx4 v9, s[40:43], s4 offen lds
  s_waitcnt vmcnt(4)
  v_readlane_b32 s74, v16, 29
  s_add_u32 m0, s77, 73728
  s_add_u32 s4, s74, 0
  buffer_load_dwordx4 v8, s[40:43], s4 offen lds
  s_add_u32 m0, s77, 74752
  s_nop 0
  buffer_load_dwordx4 v9, s[40:43], s4 offen lds
  s_waitcnt vmcnt(4)
  v_readlane_b32 s74, v16, 30
  s_add_u32 m0, s77, 81920
  s_add_u32 s4, s74, 0
  buffer_load_dwordx4 v8, s[40:43], s4 offen lds
  s_add_u32 m0, s77, 82944
  s_nop 0
  buffer_load_dwordx4 v9, s[40:43], s4 offen lds
  s_waitcnt vmcnt(4)
  v_readlane_b32 s74, v16, 31
  s_add_u32 m0, s77, 90112
  s_add_u32 s4, s74, 0
  buffer_load_dwordx4 v8, s[40:43], s4 offen lds
  s_add_u32 m0, s77, 91136
  s_nop 0
  buffer_load_dwordx4 v9, s[40:43], s4 offen lds
  s_waitcnt vmcnt(22)
  s_barrier
  v_readlane_b32 s74, v16, 32
  s_add_u32 m0, s77, 98304
  s_add_u32 s4, s74, 0
  buffer_load_dwordx4 v8, s[40:43], s4 offen lds
  s_add_u32 m0, s77, 99328
  s_nop 0
  buffer_load_dwordx4 v9, s[40:43], s4 offen lds
  s_waitcnt vmcnt(4)
  v_readlane_b32 s74, v16, 33
  s_add_u32 m0, s77, 106496
  s_add_u32 s4, s74, 0
  buffer_load_dwordx4 v8, s[40:43], s4 offen lds
  s_add_u32 m0, s77, 107520
  s_nop 0
  buffer_load_dwordx4 v9, s[40:43], s4 offen lds
  s_waitcnt vmcnt(4)
  v_readlane_b32 s74, v16, 34
  s_add_u32 m0, s77, 114688
  s_add_u32 s4, s74, 0
  buffer_load_dwordx4 v8, s[40:43], s4 offen lds
  s_add_u32 m0, s77, 115712
  s_nop 0
  buffer_load_dwordx4 v9, s[40:43], s4 offen lds
  s_waitcnt vmcnt(4)
  v_readlane_b32 s74, v16, 35
  s_add_u32 m0, s77, 122880
  s_add_u32 s4, s74, 0
  buffer_load_dwordx4 v8, s[40:43], s4 offen lds
  s_add_u32 m0, s77, 123904
  s_nop 0
  buffer_load_dwordx4 v9, s[40:43], s4 offen lds
  s_add_u32 s60, s34, 25165824
  s_addc_u32 s61, s35, 0
  s_and_b32 s61, s61, 0xffff
  s_mov_b32 s62, 8388608
  s_mov_b32 s63, 0x00020000
  s_add_u32 s64, s22, 24903680
  s_addc_u32 s65, s23, 0
  s_and_b32 s65, s65, 0xffff
  s_mov_b32 s66, 262144
  s_mov_b32 s67, 0x00020000
  s_and_b32 s5, s70, 3
  s_lshl4_add_u32 s6, s68, s69
  s_lshl2_add_u32 s6, s6, s5
  s_mul_i32 s8, s6, 4096
  s_add_u32 s9, s8, 4096
  s_add_u32 s7, s96, 1
  s_lshl_b32 s7, s7, 10
  s_add_u32 s6, s6, s7
  s_lshl_b32 s6, s6, 6
  s_xor_b32 s7, s6, 256
  s_mul_i32 s5, s5, 4096
  s_add_u32 s5, s5, 131072
  v_lshlrev_b32 v3, 4, v1
  v_add_u32 v2, s5, v3
  v_mov_b32 v4, 1
  s_mov_b32 s79, 0x100000
  s_waitcnt vmcnt(26)
  s_barrier
  s_waitcnt vmcnt(0)
  s_barrier
  ds_read_b128 v[32:35], v2 offset:0
  ds_read_b128 v[36:39], v2 offset:1024
  ds_read_b128 v[40:43], v2 offset:2048
  ds_read_b128 v[44:47], v2 offset:3072
  s_waitcnt lgkmcnt(3)
  buffer_store_dwordx4 v[32:35], v3, s[60:63], s8 offen offset:0 sc1
  s_waitcnt lgkmcnt(2)
  buffer_store_dwordx4 v[36:39], v3, s[60:63], s8 offen offset:1024 sc1
  s_waitcnt lgkmcnt(1)
  buffer_store_dwordx4 v[40:43], v3, s[60:63], s8 offen offset:2048 sc1
  s_waitcnt lgkmcnt(0)
  buffer_store_dwordx4 v[44:47], v3, s[60:63], s8 offen offset:3072 sc1
  s_xor_b32 s8, s8, 16384
  s_xor_b32 s9, s9, 16384
  s_mov_b64 exec, 1
  s_waitcnt vmcnt(0)
  buffer_store_dword v4, off, s[64:67], s6 sc1
L_w2_xpoll:
  buffer_load_dword v5, off, s[64:67], s7 sc1
  s_sub_u32 s79, s79, 1
  s_cbranch_scc1 L_w2_xgo
  s_waitcnt vmcnt(0)
  v_cmp_ne_u32 vcc, 1, v5
  s_cbranch_vccnz L_w2_xpoll
L_w2_xgo:
  s_mov_b64 exec, -1
  s_mov_b32 m0, s5
  s_nop 0
  buffer_load_dwordx4 v3, s[60:63], s8 offen offset:0 lds
  buffer_load_dwordx4 v3, s[60:63], s8 offen offset:1024 lds
  buffer_load_dwordx4 v3, s[60:63], s8 offen offset:2048 lds
  buffer_load_dwordx4 v3, s[60:63], s8 offen offset:3072 lds
  s_waitcnt vmcnt(0)
  s_barrier
  s_cmp_eq_u32 s96, 1
  s_cbranch_scc1 L_w2_end
  s_lshl_b32 s87, s97, 12
  s_lshl_b32 s4, s68, 8
  s_add_u32 s87, s87, s4
  s_lshl_b32 s4, s69, 2
  s_add_u32 s87, s87, s4
  s_mov_b32 s96, 1
  s_add_u32 s12, s22, 33554432
  s_addc_u32 s13, s23, 0
  s_add_u32 s34, s22, 67108864
  s_addc_u32 s35, s23, 0
  s_add_u32 s97, s97, 1
  s_branch L_attn_body
L_w2_end:
  s_endpgm
L_w2_compute:
  v_and_b32 v2, 3, v1
  v_lshlrev_b32 v2, 3, v2
  v_bfe_i32 v15, s85, v2, 8
  s_and_b32 s3, s68, 3
  s_mul_i32 s4, s3, 4
  v_add3_u32 v3, v15, v1, s4
  v_subrev_u32 v3, 20, v3
  v_and_b32 v3, 15, v3
  v_add3_u32 v15, v15, v1, 20
  s_mul_i32 s3, s3, 1
  s_bitcmp1_b32 s69, 0
  s_cselect_b32 s4, 20, 0
  v_subrev_u32 v2, 20, v15
  v_min_u32 v15, v15, v2
  v_subrev_u32 v2, 20, v15
  v_min_u32 v15, v15, v2
  v_cmp_gt_u32 vcc, 4, v15
  v_add_u32 v2, s3, v15
  v_subrev_u32 v16, 4, v2
  v_min_u32 v2, v16, v2
  v_cndmask_b32 v15, v15, v2, vcc
  v_cmp_gt_u32 vcc, 20, v1
  v_add_u32 v15, s4, v15
  v_add_u32 v3, 40, v3
  v_cndmask_b32 v3, v3, v15, vcc
  v_lshlrev_b32 v15, 11, v3
  v_and_b32 v3, 15, v1
  v_lshrrev_b32 v2, 4, v1
  s_lshl_b32 s8, s68, 7
  s_lshl_b32 s9, s70, 5
  s_add_u32 s8, s8, s9
  s_mul_i32 s9, s8, 7168
  v_lshl_add_u32 v4, v1, 4, s9
  v_add_u32 v5, 114688, v4
  v_add_u32 v13, s8, v3
  s_lshl_b32 s10, s69, 7
  v_lshl_add_u32 v14, v2, 3, s10
  v_and_b32 v16, 1, v2
  v_lshrrev_b32 v17, 1, v2
  v_lshlrev_b32 v16, 5, v16
  v_lshl_add_u32 v16, v17, 4, v16
  v_add_u32 v16, s10, v16
  s_cmp_eq_u32 s96, 0
  s_cselect_b32 s7, 128, 0
  s_add_u32 s7, s7, 2048
  v_mad_u32_u24 v12, v13, s7, v16
  v_lshl_add_u32 v18, v17, 4, v13
  v_lshlrev_b32 v18, 3, v18
  v_and_b32 v16, 1, v2
  v_lshl_add_u32 v18, v16, 2, v18
  s_lshl_b32 s10, s69, 14
  v_add_u32 v18, s10, v18
  v_bfe_u32 v6, v1, 2, 2
  v_lshl_add_u32 v6, v2, 3, v6
  v_lshlrev_b32 v6, 7, v6
  v_and_b32 v17, 3, v1
  v_lshl_add_u32 v6, v17, 3, v6
  v_bfe_u32 v17, v1, 3, 2
  v_lshl_add_u32 v6, v17, 5, v6
  v_xor_b32 v7, 32, v6
  v_xor_b32 v8, 64, v6
  v_xor_b32 v9, 96, v6
  s_mov_b32 s11, 0xffff0000
  s_mov_b32 s52, s30
  s_and_b32 s53, s31, 0xffff
  s_mov_b32 s54, 2048
  s_mov_b32 s55, 0x00020000
  buffer_load_dwordx2 v[192:193], v14, s[52:55], 0 offen offset:0
  buffer_load_dwordx2 v[194:195], v14, s[52:55], 0 offen offset:32
  buffer_load_dwordx2 v[196:197], v14, s[52:55], 0 offen offset:64
  buffer_load_dwordx2 v[198:199], v14, s[52:55], 0 offen offset:96
  s_add_u32 s36, s34, 8388608
  s_addc_u32 s37, s35, 0
  s_and_b32 s37, s37, 0xffff
  s_mov_b32 s38, 14680064
  s_mov_b32 s39, 0x00020000
  s_mov_b32 s44, s32
  s_and_b32 s45, s33, 0xffff
  s_mov_b32 s46, 4194304
  s_mov_b32 s47, 0x00020000
  s_add_u32 s48, s22, 33554432
  s_addc_u32 s49, s23, 0
  s_and_b32 s49, s49, 0xffff
  s_mov_b32 s50, 4194304
  s_mov_b32 s51, 0x00020000
  s_cmp_eq_u32 s96, 0
  s_cselect_b64 s[44:45], s[48:49], s[44:45]
  s_lshl_b32 s46, s7, 11
  s_add_u32 s56, s34, 24379392
  s_addc_u32 s57, s35, 0
  s_and_b32 s57, s57, 0xffff
  s_mov_b32 s58, 262144
  s_mov_b32 s59, 0x00020000
  s_mul_i32 s3, s70, 4096
  s_add_u32 s3, s3, 131072
  v_lshl_add_u32 v19, v1, 4, s3
  v_mov_b32 v128, 0
  v_mov_b32 v129, 0
  v_mov_b32 v130, 0
  v_mov_b32 v131, 0
  v_mov_b32 v132, 0
  v_mov_b32 v133, 0
  v_mov_b32 v134, 0
  v_mov_b32 v135, 0
  v_mov_b32 v136, 0
  v_mov_b32 v137, 0
  v_mov_b32 v138, 0
  v_mov_b32 v139, 0
  v_mov_b32 v140, 0
  v_mov_b32 v141, 0
  v_mov_b32 v142, 0
  v_mov_b32 v143, 0
  v_mov_b32 v144, 0
  v_mov_b32 v145, 0
  v_mov_b32 v146, 0
  v_mov_b32 v147, 0
  v_mov_b32 v148, 0
  v_mov_b32 v149, 0
  v_mov_b32 v150, 0
  v_mov_b32 v151, 0
  v_mov_b32 v152, 0
  v_mov_b32 v153, 0
  v_mov_b32 v154, 0
  v_mov_b32 v155, 0
  v_mov_b32 v156, 0
  v_mov_b32 v157, 0
  v_mov_b32 v158, 0
  v_mov_b32 v159, 0
  v_add_u32 v26, 131072, v6
  v_add_u32 v27, 131072, v7
  v_add_u32 v28, 131072, v8
  v_add_u32 v29, 131072, v9
  v_add_u32 v20, 65536, v6
  v_add_u32 v21, 65536, v7
  v_add_u32 v22, 65536, v8
  v_add_u32 v23, 65536, v9
  v_readlane_b32 s48, v15, 0
  v_readlane_b32 s49, v15, 1
  v_readlane_b32 s50, v15, 2
  v_permlane16_swap_b32 v240, v242
  v_permlane16_swap_b32 v241, v243
  v_permlane16_swap_b32 v244, v246
  v_permlane16_swap_b32 v245, v247
  v_permlane16_swap_b32 v248, v250
  v_permlane16_swap_b32 v249, v251
  v_permlane16_swap_b32 v252, v254
  v_permlane16_swap_b32 v253, v255
  s_waitcnt lgkmcnt(0)
  s_barrier
  buffer_load_dwordx4 v[32:35], v4, s[36:39], s48 offen offset:0
  buffer_load_dwordx4 v[36:39], v5, s[36:39], s48 offen offset:0
  buffer_load_dwordx4 v[40:43], v4, s[36:39], s48 offen offset:1024
  buffer_load_dwordx4 v[44:47], v5, s[36:39], s48 offen offset:1024
  buffer_load_dwordx4 v[48:51], v4, s[36:39], s49 offen offset:0
  buffer_load_dwordx4 v[52:55], v5, s[36:39], s49 offen offset:0
  buffer_load_dwordx4 v[56:59], v4, s[36:39], s49 offen offset:1024
  buffer_load_dwordx4 v[60:63], v5, s[36:39], s49 offen offset:1024
  buffer_load_dwordx4 v[64:67], v4, s[36:39], s50 offen offset:0
  buffer_load_dwordx4 v[68:71], v5, s[36:39], s50 offen offset:0
  buffer_load_dwordx4 v[72:75], v4, s[36:39], s50 offen offset:1024
  buffer_load_dwordx4 v[76:79], v5, s[36:39], s50 offen offset:1024
  ds_read_b64_tr_b16 v[160:161], v6 offset:0
  ds_read_b64_tr_b16 v[162:163], v6 offset:512
  ds_read_b64_tr_b16 v[164:165], v7 offset:0
  ds_read_b64_tr_b16 v[166:167], v7 offset:512
  ds_read_b64_tr_b16 v[168:169], v8 offset:0
  ds_read_b64_tr_b16 v[170:171], v8 offset:512
  ds_read_b64_tr_b16 v[172:173], v9 offset:0
  ds_read_b64_tr_b16 v[174:175], v9 offset:512
  ds_read_b64_tr_b16 v[176:177], v6 offset:4096
  ds_read_b64_tr_b16 v[178:179], v6 offset:4608
  ds_read_b64_tr_b16 v[180:181], v7 offset:4096
  ds_read_b64_tr_b16 v[182:183], v7 offset:4608
  ds_read_b64_tr_b16 v[184:185], v8 offset:4096
  ds_read_b64_tr_b16 v[186:187], v8 offset:4608
  ds_read_b64_tr_b16 v[188:189], v9 offset:4096
  ds_read_b64_tr_b16 v[190:191], v9 offset:4608
  s_waitcnt vmcnt(12)
  v_lshlrev_b32 v216, 16, v192
  v_and_b32 v217, s11, v192
  v_lshlrev_b32 v218, 16, v193
  v_and_b32 v219, s11, v193
  v_lshlrev_b32 v96, 16, v240
  v_and_b32 v97, s11, v240
  v_pk_add_f32 v[96:97], v[96:97], v[216:217]
  v_lshlrev_b32 v98, 16, v241
  v_and_b32 v99, s11, v241
  v_pk_add_f32 v[98:99], v[98:99], v[218:219]
  v_lshlrev_b32 v100, 16, v248
  v_and_b32 v101, s11, v248
  v_pk_add_f32 v[100:101], v[100:101], v[216:217]
  v_lshlrev_b32 v102, 16, v249
  v_and_b32 v103, s11, v249
  v_pk_add_f32 v[102:103], v[102:103], v[218:219]
  v_lshlrev_b32 v216, 16, v194
  v_and_b32 v217, s11, v194
  v_lshlrev_b32 v218, 16, v195
  v_and_b32 v219, s11, v195
  v_lshlrev_b32 v104, 16, v242
  v_and_b32 v105, s11, v242
  v_pk_add_f32 v[104:105], v[104:105], v[216:217]
  v_lshlrev_b32 v106, 16, v243
  v_and_b32 v107, s11, v243
  v_pk_add_f32 v[106:107], v[106:107], v[218:219]
  v_lshlrev_b32 v108, 16, v250
  v_and_b32 v109, s11, v250
  v_pk_add_f32 v[108:109], v[108:109], v[216:217]
  v_lshlrev_b32 v110, 16, v251
  v_and_b32 v111, s11, v251
  v_pk_add_f32 v[110:111], v[110:111], v[218:219]
  v_lshlrev_b32 v216, 16, v196
  v_and_b32 v217, s11, v196
  v_lshlrev_b32 v218, 16, v197
  v_and_b32 v219, s11, v197
  v_lshlrev_b32 v112, 16, v244
  v_and_b32 v113, s11, v244
  v_pk_add_f32 v[112:113], v[112:113], v[216:217]
  v_lshlrev_b32 v114, 16, v245
  v_and_b32 v115, s11, v245
  v_pk_add_f32 v[114:115], v[114:115], v[218:219]
  v_lshlrev_b32 v116, 16, v252
  v_and_b32 v117, s11, v252
  v_pk_add_f32 v[116:117], v[116:117], v[216:217]
  v_lshlrev_b32 v118, 16, v253
  v_and_b32 v119, s11, v253
  v_pk_add_f32 v[118:119], v[118:119], v[218:219]
  v_lshlrev_b32 v216, 16, v198
  v_and_b32 v217, s11, v198
  v_lshlrev_b32 v218, 16, v199
  v_and_b32 v219, s11, v199
  v_lshlrev_b32 v120, 16, v246
  v_and_b32 v121, s11, v246
  v_pk_add_f32 v[120:121], v[120:121], v[216:217]
  v_lshlrev_b32 v122, 16, v247
  v_and_b32 v123, s11, v247
  v_pk_add_f32 v[122:123], v[122:123], v[218:219]
  v_lshlrev_b32 v124, 16, v254
  v_and_b32 v125, s11, v254
  v_pk_add_f32 v[124:125], v[124:125], v[216:217]
  v_lshlrev_b32 v126, 16, v255
  v_and_b32 v127, s11, v255
  v_pk_add_f32 v[126:127], v[126:127], v[218:219]
  s_waitcnt vmcnt(10) lgkmcnt(8)
  v_mfma_f32_16x16x32_bf16 v[128:131], v[160:163], v[32:35], v[128:131]
  ds_read_b64_tr_b16 v[192:193], v6 offset:8192
  v_readlane_b32 s51, v15, 3
  v_mfma_f32_16x16x32_bf16 v[132:135], v[160:163], v[36:39], v[132:135]
  ds_read_b64_tr_b16 v[194:195], v6 offset:8704
  v_mfma_f32_16x16x32_bf16 v[136:139], v[164:167], v[32:35], v[136:139]
  ds_read_b64_tr_b16 v[196:197], v7 offset:8192
  v_mfma_f32_16x16x32_bf16 v[140:143], v[164:167], v[36:39], v[140:143]
  ds_read_b64_tr_b16 v[198:199], v7 offset:8704
  buffer_load_dwordx4 v[80:83], v4, s[36:39], s51 offen offset:0
  v_mfma_f32_16x16x32_bf16 v[144:147], v[168:171], v[32:35], v[144:147]
  ds_read_b64_tr_b16 v[200:201], v8 offset:8192
  v_mfma_f32_16x16x32_bf16 v[148:151], v[168:171], v[36:39], v[148:151]
  ds_read_b64_tr_b16 v[202:203], v8 offset:8704
  v_mfma_f32_16x16x32_bf16 v[152:155], v[172:175], v[32:35], v[152:155]
  ds_read_b64_tr_b16 v[204:205], v9 offset:8192
  buffer_load_dwordx4 v[84:87], v5, s[36:39], s51 offen offset:0
  v_mfma_f32_16x16x32_bf16 v[156:159], v[172:175], v[36:39], v[156:159]
  ds_read_b64_tr_b16 v[206:207], v9 offset:8704
  s_waitcnt vmcnt(10) lgkmcnt(8)
  v_mfma_f32_16x16x32_bf16 v[128:131], v[176:179], v[40:43], v[128:131]
  ds_read_b64_tr_b16 v[208:209], v6 offset:12288
  v_mfma_f32_16x16x32_bf16 v[132:135], v[176:179], v[44:47], v[132:135]
  ds_read_b64_tr_b16 v[210:211], v6 offset:12800
  buffer_load_dwordx4 v[88:91], v4, s[36:39], s51 offen offset:1024
  v_mfma_f32_16x16x32_bf16 v[136:139], v[180:183], v[40:43], v[136:139]
  ds_read_b64_tr_b16 v[212:213], v7 offset:12288
  v_mfma_f32_16x16x32_bf16 v[140:143], v[180:183], v[44:47], v[140:143]
  ds_read_b64_tr_b16 v[214:215], v7 offset:12800
  v_mfma_f32_16x16x32_bf16 v[144:147], v[184:187], v[40:43], v[144:147]
  ds_read_b64_tr_b16 v[216:217], v8 offset:12288
  buffer_load_dwordx4 v[92:95], v5, s[36:39], s51 offen offset:1024
  v_mfma_f32_16x16x32_bf16 v[148:151], v[184:187], v[44:47], v[148:151]
  ds_read_b64_tr_b16 v[218:219], v8 offset:12800
  v_readlane_b32 s48, v15, 4
  v_mfma_f32_16x16x32_bf16 v[152:155], v[188:191], v[40:43], v[152:155]
  ds_read_b64_tr_b16 v[220:221], v9 offset:12288
  v_mfma_f32_16x16x32_bf16 v[156:159], v[188:191], v[44:47], v[156:159]
  ds_read_b64_tr_b16 v[222:223], v9 offset:12800
  s_waitcnt lgkmcnt(8)
  v_mfma_f32_16x16x32_bf16 v[96:99], v[192:195], v[32:35], v[96:99]
  ds_read_b64_tr_b16 v[160:161], v6 offset:16384
  buffer_load_dwordx4 v[224:227], v4, s[36:39], s48 offen offset:0
  v_mfma_f32_16x16x32_bf16 v[100:103], v[192:195], v[36:39], v[100:103]
  ds_read_b64_tr_b16 v[162:163], v6 offset:16896
  v_mfma_f32_16x16x32_bf16 v[104:107], v[196:199], v[32:35], v[104:107]
  ds_read_b64_tr_b16 v[164:165], v7 offset:16384
  v_mfma_f32_16x16x32_bf16 v[108:111], v[196:199], v[36:39], v[108:111]
  ds_read_b64_tr_b16 v[166:167], v7 offset:16896
  buffer_load_dwordx4 v[228:231], v5, s[36:39], s48 offen offset:0
  v_mfma_f32_16x16x32_bf16 v[112:115], v[200:203], v[32:35], v[112:115]
  ds_read_b64_tr_b16 v[168:169], v8 offset:16384
  v_mfma_f32_16x16x32_bf16 v[116:119], v[200:203], v[36:39], v[116:119]
  ds_read_b64_tr_b16 v[170:171], v8 offset:16896
  v_mfma_f32_16x16x32_bf16 v[120:123], v[204:207], v[32:35], v[120:123]
  ds_read_b64_tr_b16 v[172:173], v9 offset:16384
  buffer_load_dwordx4 v[232:235], v4, s[36:39], s48 offen offset:1024
  v_mfma_f32_16x16x32_bf16 v[124:127], v[204:207], v[36:39], v[124:127]
  ds_read_b64_tr_b16 v[174:175], v9 offset:16896
  s_waitcnt lgkmcnt(8)
  v_mfma_f32_16x16x32_bf16 v[96:99], v[208:211], v[40:43], v[96:99]
  ds_read_b64_tr_b16 v[176:177], v6 offset:20480
  v_mfma_f32_16x16x32_bf16 v[100:103], v[208:211], v[44:47], v[100:103]
  ds_read_b64_tr_b16 v[178:179], v6 offset:20992
  buffer_load_dwordx4 v[236:239], v5, s[36:39], s48 offen offset:1024
  v_mfma_f32_16x16x32_bf16 v[104:107], v[212:215], v[40:43], v[104:107]
  ds_read_b64_tr_b16 v[180:181], v7 offset:20480
  v_readlane_b32 s49, v15, 5
  v_mfma_f32_16x16x32_bf16 v[108:111], v[212:215], v[44:47], v[108:111]
  ds_read_b64_tr_b16 v[182:183], v7 offset:20992
  v_mfma_f32_16x16x32_bf16 v[112:115], v[216:219], v[40:43], v[112:115]
  ds_read_b64_tr_b16 v[184:185], v8 offset:20480
  v_mfma_f32_16x16x32_bf16 v[116:119], v[216:219], v[44:47], v[116:119]
  ds_read_b64_tr_b16 v[186:187], v8 offset:20992
  buffer_load_dwordx4 v[240:243], v4, s[36:39], s49 offen offset:0
  v_mfma_f32_16x16x32_bf16 v[120:123], v[220:223], v[40:43], v[120:123]
  ds_read_b64_tr_b16 v[188:189], v9 offset:20480
  v_mfma_f32_16x16x32_bf16 v[124:127], v[220:223], v[44:47], v[124:127]
  ds_read_b64_tr_b16 v[190:191], v9 offset:20992
  s_waitcnt vmcnt(15) lgkmcnt(8)
  v_mfma_f32_16x16x32_bf16 v[128:131], v[160:163], v[48:51], v[128:131]
  ds_read_b64_tr_b16 v[192:193], v6 offset:24576
  buffer_load_dwordx4 v[244:247], v5, s[36:39], s49 offen offset:0
  v_mfma_f32_16x16x32_bf16 v[132:135], v[160:163], v[52:55], v[132:135]
  ds_read_b64_tr_b16 v[194:195], v6 offset:25088
  v_mfma_f32_16x16x32_bf16 v[136:139], v[164:167], v[48:51], v[136:139]
  ds_read_b64_tr_b16 v[196:197], v7 offset:24576
  v_mfma_f32_16x16x32_bf16 v[140:143], v[164:167], v[52:55], v[140:143]
  ds_read_b64_tr_b16 v[198:199], v7 offset:25088
  buffer_load_dwordx4 v[248:251], v4, s[36:39], s49 offen offset:1024
  v_mfma_f32_16x16x32_bf16 v[144:147], v[168:171], v[48:51], v[144:147]
  ds_read_b64_tr_b16 v[200:201], v8 offset:24576
  v_mfma_f32_16x16x32_bf16 v[148:151], v[168:171], v[52:55], v[148:151]
  ds_read_b64_tr_b16 v[202:203], v8 offset:25088
  v_mfma_f32_16x16x32_bf16 v[152:155], v[172:175], v[48:51], v[152:155]
  ds_read_b64_tr_b16 v[204:205], v9 offset:24576
  buffer_load_dwordx4 v[252:255], v5, s[36:39], s49 offen offset:1024
  v_mfma_f32_16x16x32_bf16 v[156:159], v[172:175], v[52:55], v[156:159]
  ds_read_b64_tr_b16 v[206:207], v9 offset:25088
  s_waitcnt vmcnt(16) lgkmcnt(8)
  v_mfma_f32_16x16x32_bf16 v[128:131], v[176:179], v[56:59], v[128:131]
  ds_read_b64_tr_b16 v[208:209], v6 offset:28672
  v_readlane_b32 s50, v15, 6
  v_mfma_f32_16x16x32_bf16 v[132:135], v[176:179], v[60:63], v[132:135]
  ds_read_b64_tr_b16 v[210:211], v6 offset:29184
  v_mfma_f32_16x16x32_bf16 v[136:139], v[180:183], v[56:59], v[136:139]
  ds_read_b64_tr_b16 v[212:213], v7 offset:28672
  v_mfma_f32_16x16x32_bf16 v[140:143], v[180:183], v[60:63], v[140:143]
  ds_read_b64_tr_b16 v[214:215], v7 offset:29184
  buffer_load_dwordx4 v[32:35], v4, s[36:39], s50 offen offset:0
  v_mfma_f32_16x16x32_bf16 v[144:147], v[184:187], v[56:59], v[144:147]
  ds_read_b64_tr_b16 v[216:217], v8 offset:28672
  v_mfma_f32_16x16x32_bf16 v[148:151], v[184:187], v[60:63], v[148:151]
  ds_read_b64_tr_b16 v[218:219], v8 offset:29184
  v_mfma_f32_16x16x32_bf16 v[152:155], v[188:191], v[56:59], v[152:155]
  ds_read_b64_tr_b16 v[220:221], v9 offset:28672
  v_mfma_f32_16x16x32_bf16 v[156:159], v[188:191], v[60:63], v[156:159]
  ds_read_b64_tr_b16 v[222:223], v9 offset:29184
  s_waitcnt lgkmcnt(8)
  v_mfma_f32_16x16x32_bf16 v[96:99], v[192:195], v[48:51], v[96:99]
  ds_read_b64_tr_b16 v[160:161], v6 offset:32768
  v_mfma_f32_16x16x32_bf16 v[100:103], v[192:195], v[52:55], v[100:103]
  ds_read_b64_tr_b16 v[162:163], v6 offset:33280
  v_mfma_f32_16x16x32_bf16 v[104:107], v[196:199], v[48:51], v[104:107]
  ds_read_b64_tr_b16 v[164:165], v7 offset:32768
  buffer_load_dwordx4 v[36:39], v5, s[36:39], s50 offen offset:0
  v_mfma_f32_16x16x32_bf16 v[108:111], v[196:199], v[52:55], v[108:111]
  ds_read_b64_tr_b16 v[166:167], v7 offset:33280
  v_mfma_f32_16x16x32_bf16 v[112:115], v[200:203], v[48:51], v[112:115]
  ds_read_b64_tr_b16 v[168:169], v8 offset:32768
  v_mfma_f32_16x16x32_bf16 v[116:119], v[200:203], v[52:55], v[116:119]
  ds_read_b64_tr_b16 v[170:171], v8 offset:33280
  v_mfma_f32_16x16x32_bf16 v[120:123], v[204:207], v[48:51], v[120:123]
  ds_read_b64_tr_b16 v[172:173], v9 offset:32768
  v_mfma_f32_16x16x32_bf16 v[124:127], v[204:207], v[52:55], v[124:127]
  ds_read_b64_tr_b16 v[174:175], v9 offset:33280
  s_waitcnt lgkmcnt(8)
  s_barrier
  v_mfma_f32_16x16x32_bf16 v[96:99], v[208:211], v[56:59], v[96:99]
  ds_read_b64_tr_b16 v[176:177], v6 offset:36864
  v_mfma_f32_16x16x32_bf16 v[100:103], v[208:211], v[60:63], v[100:103]
  ds_read_b64_tr_b16 v[178:179], v6 offset:37376
  buffer_load_dwordx4 v[40:43], v4, s[36:39], s50 offen offset:1024
  v_mfma_f32_16x16x32_bf16 v[104:107], v[212:215], v[56:59], v[104:107]
  ds_read_b64_tr_b16 v[180:181], v7 offset:36864
  v_mfma_f32_16x16x32_bf16 v[108:111], v[212:215], v[60:63], v[108:111]
  ds_read_b64_tr_b16 v[182:183], v7 offset:37376
  v_mfma_f32_16x16x32_bf16 v[112:115], v[216:219], v[56:59], v[112:115]
  ds_read_b64_tr_b16 v[184:185], v8 offset:36864
  v_mfma_f32_16x16x32_bf16 v[116:119], v[216:219], v[60:63], v[116:119]
  ds_read_b64_tr_b16 v[186:187], v8 offset:37376
  v_mfma_f32_16x16x32_bf16 v[120:123], v[220:223], v[56:59], v[120:123]
  ds_read_b64_tr_b16 v[188:189], v9 offset:36864
  v_mfma_f32_16x16x32_bf16 v[124:127], v[220:223], v[60:63], v[124:127]
  ds_read_b64_tr_b16 v[190:191], v9 offset:37376
  s_waitcnt vmcnt(17) lgkmcnt(8)
  v_mfma_f32_16x16x32_bf16 v[128:131], v[160:163], v[64:67], v[128:131]
  ds_read_b64_tr_b16 v[192:193], v6 offset:40960
  buffer_load_dwordx4 v[44:47], v5, s[36:39], s50 offen offset:1024
  v_mfma_f32_16x16x32_bf16 v[132:135], v[160:163], v[68:71], v[132:135]
  ds_read_b64_tr_b16 v[194:195], v6 offset:41472
  v_mfma_f32_16x16x32_bf16 v[136:139], v[164:167], v[64:67], v[136:139]
  ds_read_b64_tr_b16 v[196:197], v7 offset:40960
  v_mfma_f32_16x16x32_bf16 v[140:143], v[164:167], v[68:71], v[140:143]
  ds_read_b64_tr_b16 v[198:199], v7 offset:41472
  v_mfma_f32_16x16x32_bf16 v[144:147], v[168:171], v[64:67], v[144:147]
  ds_read_b64_tr_b16 v[200:201], v8 offset:40960
  v_mfma_f32_16x16x32_bf16 v[148:151], v[168:171], v[68:71], v[148:151]
  ds_read_b64_tr_b16 v[202:203], v8 offset:41472
  v_readlane_b32 s51, v15, 7
  v_mfma_f32_16x16x32_bf16 v[152:155], v[172:175], v[64:67], v[152:155]
  ds_read_b64_tr_b16 v[204:205], v9 offset:40960
  v_mfma_f32_16x16x32_bf16 v[156:159], v[172:175], v[68:71], v[156:159]
  ds_read_b64_tr_b16 v[206:207], v9 offset:41472
  s_waitcnt vmcnt(16) lgkmcnt(8)
  v_mfma_f32_16x16x32_bf16 v[128:131], v[176:179], v[72:75], v[128:131]
  ds_read_b64_tr_b16 v[208:209], v6 offset:45056
  buffer_load_dwordx4 v[48:51], v4, s[36:39], s51 offen offset:0
  v_mfma_f32_16x16x32_bf16 v[132:135], v[176:179], v[76:79], v[132:135]
  ds_read_b64_tr_b16 v[210:211], v6 offset:45568
  v_mfma_f32_16x16x32_bf16 v[136:139], v[180:183], v[72:75], v[136:139]
  ds_read_b64_tr_b16 v[212:213], v7 offset:45056
  v_mfma_f32_16x16x32_bf16 v[140:143], v[180:183], v[76:79], v[140:143]
  ds_read_b64_tr_b16 v[214:215], v7 offset:45568
  v_mfma_f32_16x16x32_bf16 v[144:147], v[184:187], v[72:75], v[144:147]
  ds_read_b64_tr_b16 v[216:217], v8 offset:45056
  v_mfma_f32_16x16x32_bf16 v[148:151], v[184:187], v[76:79], v[148:151]
  ds_read_b64_tr_b16 v[218:219], v8 offset:45568
  v_mfma_f32_16x16x32_bf16 v[152:155], v[188:191], v[72:75], v[152:155]
  ds_read_b64_tr_b16 v[220:221], v9 offset:45056
  v_mfma_f32_16x16x32_bf16 v[156:159], v[188:191], v[76:79], v[156:159]
  ds_read_b64_tr_b16 v[222:223], v9 offset:45568
  s_waitcnt lgkmcnt(8)
  v_mfma_f32_16x16x32_bf16 v[96:99], v[192:195], v[64:67], v[96:99]
  ds_read_b64_tr_b16 v[160:161], v6 offset:49152
  buffer_load_dwordx4 v[52:55], v5, s[36:39], s51 offen offset:0
  v_mfma_f32_16x16x32_bf16 v[100:103], v[192:195], v[68:71], v[100:103]
  ds_read_b64_tr_b16 v[162:163], v6 offset:49664
  v_mfma_f32_16x16x32_bf16 v[104:107], v[196:199], v[64:67], v[104:107]
  ds_read_b64_tr_b16 v[164:165], v7 offset:49152
  v_mfma_f32_16x16x32_bf16 v[108:111], v[196:199], v[68:71], v[108:111]
  ds_read_b64_tr_b16 v[166:167], v7 offset:49664
  v_mfma_f32_16x16x32_bf16 v[112:115], v[200:203], v[64:67], v[112:115]
  ds_read_b64_tr_b16 v[168:169], v8 offset:49152
  v_mfma_f32_16x16x32_bf16 v[116:119], v[200:203], v[68:71], v[116:119]
  ds_read_b64_tr_b16 v[170:171], v8 offset:49664
  v_mfma_f32_16x16x32_bf16 v[120:123], v[204:207], v[64:67], v[120:123]
  ds_read_b64_tr_b16 v[172:173], v9 offset:49152
  v_mfma_f32_16x16x32_bf16 v[124:127], v[204:207], v[68:71], v[124:127]
  ds_read_b64_tr_b16 v[174:175], v9 offset:49664
  s_waitcnt lgkmcnt(8)
  v_mfma_f32_16x16x32_bf16 v[96:99], v[208:211], v[72:75], v[96:99]
  ds_read_b64_tr_b16 v[176:177], v6 offset:53248
  buffer_load_dwordx4 v[56:59], v4, s[36:39], s51 offen offset:1024
  v_mfma_f32_16x16x32_bf16 v[100:103], v[208:211], v[76:79], v[100:103]
  ds_read_b64_tr_b16 v[178:179], v6 offset:53760
  v_mfma_f32_16x16x32_bf16 v[104:107], v[212:215], v[72:75], v[104:107]
  ds_read_b64_tr_b16 v[180:181], v7 offset:53248
  v_mfma_f32_16x16x32_bf16 v[108:111], v[212:215], v[76:79], v[108:111]
  ds_read_b64_tr_b16 v[182:183], v7 offset:53760
  v_mfma_f32_16x16x32_bf16 v[112:115], v[216:219], v[72:75], v[112:115]
  ds_read_b64_tr_b16 v[184:185], v8 offset:53248
  v_mfma_f32_16x16x32_bf16 v[116:119], v[216:219], v[76:79], v[116:119]
  ds_read_b64_tr_b16 v[186:187], v8 offset:53760
  v_mfma_f32_16x16x32_bf16 v[120:123], v[220:223], v[72:75], v[120:123]
  ds_read_b64_tr_b16 v[188:189], v9 offset:53248
  v_mfma_f32_16x16x32_bf16 v[124:127], v[220:223], v[76:79], v[124:127]
  ds_read_b64_tr_b16 v[190:191], v9 offset:53760
  s_waitcnt vmcnt(17) lgkmcnt(8)
  v_mfma_f32_16x16x32_bf16 v[128:131], v[160:163], v[80:83], v[128:131]
  ds_read_b64_tr_b16 v[192:193], v6 offset:57344
  buffer_load_dwordx4 v[60:63], v5, s[36:39], s51 offen offset:1024
  v_mfma_f32_16x16x32_bf16 v[132:135], v[160:163], v[84:87], v[132:135]
  ds_read_b64_tr_b16 v[194:195], v6 offset:57856
  v_mfma_f32_16x16x32_bf16 v[136:139], v[164:167], v[80:83], v[136:139]
  ds_read_b64_tr_b16 v[196:197], v7 offset:57344
  v_mfma_f32_16x16x32_bf16 v[140:143], v[164:167], v[84:87], v[140:143]
  ds_read_b64_tr_b16 v[198:199], v7 offset:57856
  v_mfma_f32_16x16x32_bf16 v[144:147], v[168:171], v[80:83], v[144:147]
  ds_read_b64_tr_b16 v[200:201], v8 offset:57344
  v_mfma_f32_16x16x32_bf16 v[148:151], v[168:171], v[84:87], v[148:151]
  ds_read_b64_tr_b16 v[202:203], v8 offset:57856
  v_readlane_b32 s48, v15, 8
  v_mfma_f32_16x16x32_bf16 v[152:155], v[172:175], v[80:83], v[152:155]
  ds_read_b64_tr_b16 v[204:205], v9 offset:57344
  v_mfma_f32_16x16x32_bf16 v[156:159], v[172:175], v[84:87], v[156:159]
  ds_read_b64_tr_b16 v[206:207], v9 offset:57856
  s_waitcnt vmcnt(16) lgkmcnt(8)
  v_mfma_f32_16x16x32_bf16 v[128:131], v[176:179], v[88:91], v[128:131]
  ds_read_b64_tr_b16 v[208:209], v6 offset:61440
  buffer_load_dwordx4 v[64:67], v4, s[36:39], s48 offen offset:0
  v_mfma_f32_16x16x32_bf16 v[132:135], v[176:179], v[92:95], v[132:135]
  ds_read_b64_tr_b16 v[210:211], v6 offset:61952
  v_mfma_f32_16x16x32_bf16 v[136:139], v[180:183], v[88:91], v[136:139]
  ds_read_b64_tr_b16 v[212:213], v7 offset:61440
  v_mfma_f32_16x16x32_bf16 v[140:143], v[180:183], v[92:95], v[140:143]
  ds_read_b64_tr_b16 v[214:215], v7 offset:61952
  v_mfma_f32_16x16x32_bf16 v[144:147], v[184:187], v[88:91], v[144:147]
  ds_read_b64_tr_b16 v[216:217], v8 offset:61440
  v_mfma_f32_16x16x32_bf16 v[148:151], v[184:187], v[92:95], v[148:151]
  ds_read_b64_tr_b16 v[218:219], v8 offset:61952
  v_mfma_f32_16x16x32_bf16 v[152:155], v[188:191], v[88:91], v[152:155]
  ds_read_b64_tr_b16 v[220:221], v9 offset:61440
  v_mfma_f32_16x16x32_bf16 v[156:159], v[188:191], v[92:95], v[156:159]
  ds_read_b64_tr_b16 v[222:223], v9 offset:61952
  s_waitcnt lgkmcnt(8)
  v_mfma_f32_16x16x32_bf16 v[96:99], v[192:195], v[80:83], v[96:99]
  ds_read_b64_tr_b16 v[160:161], v20 offset:0
  buffer_load_dwordx4 v[68:71], v5, s[36:39], s48 offen offset:0
  v_mfma_f32_16x16x32_bf16 v[100:103], v[192:195], v[84:87], v[100:103]
  ds_read_b64_tr_b16 v[162:163], v20 offset:512
  v_mfma_f32_16x16x32_bf16 v[104:107], v[196:199], v[80:83], v[104:107]
  ds_read_b64_tr_b16 v[164:165], v21 offset:0
  v_mfma_f32_16x16x32_bf16 v[108:111], v[196:199], v[84:87], v[108:111]
  ds_read_b64_tr_b16 v[166:167], v21 offset:512
  v_mfma_f32_16x16x32_bf16 v[112:115], v[200:203], v[80:83], v[112:115]
  ds_read_b64_tr_b16 v[168:169], v22 offset:0
  v_mfma_f32_16x16x32_bf16 v[116:119], v[200:203], v[84:87], v[116:119]
  ds_read_b64_tr_b16 v[170:171], v22 offset:512
  v_mfma_f32_16x16x32_bf16 v[120:123], v[204:207], v[80:83], v[120:123]
  ds_read_b64_tr_b16 v[172:173], v23 offset:0
  v_mfma_f32_16x16x32_bf16 v[124:127], v[204:207], v[84:87], v[124:127]
  ds_read_b64_tr_b16 v[174:175], v23 offset:512
  s_waitcnt lgkmcnt(8)
  s_barrier
  v_mfma_f32_16x16x32_bf16 v[96:99], v[208:211], v[88:91], v[96:99]
  ds_read_b64_tr_b16 v[176:177], v20 offset:4096
  buffer_load_dwordx4 v[72:75], v4, s[36:39], s48 offen offset:1024
  v_mfma_f32_16x16x32_bf16 v[100:103], v[208:211], v[92:95], v[100:103]
  ds_read_b64_tr_b16 v[178:179], v20 offset:4608
  v_mfma_f32_16x16x32_bf16 v[104:107], v[212:215], v[88:91], v[104:107]
  ds_read_b64_tr_b16 v[180:181], v21 offset:4096
  v_mfma_f32_16x16x32_bf16 v[108:111], v[212:215], v[92:95], v[108:111]
  ds_read_b64_tr_b16 v[182:183], v21 offset:4608
  v_mfma_f32_16x16x32_bf16 v[112:115], v[216:219], v[88:91], v[112:115]
  ds_read_b64_tr_b16 v[184:185], v22 offset:4096
  v_mfma_f32_16x16x32_bf16 v[116:119], v[216:219], v[92:95], v[116:119]
  ds_read_b64_tr_b16 v[186:187], v22 offset:4608
  v_mfma_f32_16x16x32_bf16 v[120:123], v[220:223], v[88:91], v[120:123]
  ds_read_b64_tr_b16 v[188:189], v23 offset:4096
  v_mfma_f32_16x16x32_bf16 v[124:127], v[220:223], v[92:95], v[124:127]
  ds_read_b64_tr_b16 v[190:191], v23 offset:4608
  s_waitcnt vmcnt(17) lgkmcnt(8)
  v_mfma_f32_16x16x32_bf16 v[128:131], v[160:163], v[224:227], v[128:131]
  ds_read_b64_tr_b16 v[192:193], v20 offset:8192
  buffer_load_dwordx4 v[76:79], v5, s[36:39], s48 offen offset:1024
  v_mfma_f32_16x16x32_bf16 v[132:135], v[160:163], v[228:231], v[132:135]
  ds_read_b64_tr_b16 v[194:195], v20 offset:8704
  v_mfma_f32_16x16x32_bf16 v[136:139], v[164:167], v[224:227], v[136:139]
  ds_read_b64_tr_b16 v[196:197], v21 offset:8192
  v_mfma_f32_16x16x32_bf16 v[140:143], v[164:167], v[228:231], v[140:143]
  ds_read_b64_tr_b16 v[198:199], v21 offset:8704
  v_mfma_f32_16x16x32_bf16 v[144:147], v[168:171], v[224:227], v[144:147]
  ds_read_b64_tr_b16 v[200:201], v22 offset:8192
  v_mfma_f32_16x16x32_bf16 v[148:151], v[168:171], v[228:231], v[148:151]
  ds_read_b64_tr_b16 v[202:203], v22 offset:8704
  v_readlane_b32 s49, v15, 9
  v_mfma_f32_16x16x32_bf16 v[152:155], v[172:175], v[224:227], v[152:155]
  ds_read_b64_tr_b16 v[204:205], v23 offset:8192
  v_mfma_f32_16x16x32_bf16 v[156:159], v[172:175], v[228:231], v[156:159]
  ds_read_b64_tr_b16 v[206:207], v23 offset:8704
  s_waitcnt vmcnt(16) lgkmcnt(8)
  v_mfma_f32_16x16x32_bf16 v[128:131], v[176:179], v[232:235], v[128:131]
  ds_read_b64_tr_b16 v[208:209], v20 offset:12288
  buffer_load_dwordx4 v[80:83], v4, s[36:39], s49 offen offset:0
  v_mfma_f32_16x16x32_bf16 v[132:135], v[176:179], v[236:239], v[132:135]
  ds_read_b64_tr_b16 v[210:211], v20 offset:12800
  v_mfma_f32_16x16x32_bf16 v[136:139], v[180:183], v[232:235], v[136:139]
  ds_read_b64_tr_b16 v[212:213], v21 offset:12288
  v_mfma_f32_16x16x32_bf16 v[140:143], v[180:183], v[236:239], v[140:143]
  ds_read_b64_tr_b16 v[214:215], v21 offset:12800
  v_mfma_f32_16x16x32_bf16 v[144:147], v[184:187], v[232:235], v[144:147]
  ds_read_b64_tr_b16 v[216:217], v22 offset:12288
  v_mfma_f32_16x16x32_bf16 v[148:151], v[184:187], v[236:239], v[148:151]
  ds_read_b64_tr_b16 v[218:219], v22 offset:12800
  v_mfma_f32_16x16x32_bf16 v[152:155], v[188:191], v[232:235], v[152:155]
  ds_read_b64_tr_b16 v[220:221], v23 offset:12288
  v_mfma_f32_16x16x32_bf16 v[156:159], v[188:191], v[236:239], v[156:159]
  ds_read_b64_tr_b16 v[222:223], v23 offset:12800
  s_waitcnt lgkmcnt(8)
  v_mfma_f32_16x16x32_bf16 v[96:99], v[192:195], v[224:227], v[96:99]
  ds_read_b64_tr_b16 v[160:161], v20 offset:16384
  buffer_load_dwordx4 v[84:87], v5, s[36:39], s49 offen offset:0
  v_mfma_f32_16x16x32_bf16 v[100:103], v[192:195], v[228:231], v[100:103]
  ds_read_b64_tr_b16 v[162:163], v20 offset:16896
  v_mfma_f32_16x16x32_bf16 v[104:107], v[196:199], v[224:227], v[104:107]
  ds_read_b64_tr_b16 v[164:165], v21 offset:16384
  v_mfma_f32_16x16x32_bf16 v[108:111], v[196:199], v[228:231], v[108:111]
  ds_read_b64_tr_b16 v[166:167], v21 offset:16896
  v_mfma_f32_16x16x32_bf16 v[112:115], v[200:203], v[224:227], v[112:115]
  ds_read_b64_tr_b16 v[168:169], v22 offset:16384
  v_mfma_f32_16x16x32_bf16 v[116:119], v[200:203], v[228:231], v[116:119]
  ds_read_b64_tr_b16 v[170:171], v22 offset:16896
  v_mfma_f32_16x16x32_bf16 v[120:123], v[204:207], v[224:227], v[120:123]
  ds_read_b64_tr_b16 v[172:173], v23 offset:16384
  v_mfma_f32_16x16x32_bf16 v[124:127], v[204:207], v[228:231], v[124:127]
  ds_read_b64_tr_b16 v[174:175], v23 offset:16896
  s_waitcnt lgkmcnt(8)
  v_mfma_f32_16x16x32_bf16 v[96:99], v[208:211], v[232:235], v[96:99]
  ds_read_b64_tr_b16 v[176:177], v20 offset:20480
  buffer_load_dwordx4 v[88:91], v4, s[36:39], s49 offen offset:1024
  v_mfma_f32_16x16x32_bf16 v[100:103], v[208:211], v[236:239], v[100:103]
  ds_read_b64_tr_b16 v[178:179], v20 offset:20992
  v_mfma_f32_16x16x32_bf16 v[104:107], v[212:215], v[232:235], v[104:107]
  ds_read_b64_tr_b16 v[180:181], v21 offset:20480
  v_mfma_f32_16x16x32_bf16 v[108:111], v[212:215], v[236:239], v[108:111]
  ds_read_b64_tr_b16 v[182:183], v21 offset:20992
  v_mfma_f32_16x16x32_bf16 v[112:115], v[216:219], v[232:235], v[112:115]
  ds_read_b64_tr_b16 v[184:185], v22 offset:20480
  v_mfma_f32_16x16x32_bf16 v[116:119], v[216:219], v[236:239], v[116:119]
  ds_read_b64_tr_b16 v[186:187], v22 offset:20992
  v_mfma_f32_16x16x32_bf16 v[120:123], v[220:223], v[232:235], v[120:123]
  ds_read_b64_tr_b16 v[188:189], v23 offset:20480
  v_mfma_f32_16x16x32_bf16 v[124:127], v[220:223], v[236:239], v[124:127]
  ds_read_b64_tr_b16 v[190:191], v23 offset:20992
  s_waitcnt vmcnt(17) lgkmcnt(8)
  v_mfma_f32_16x16x32_bf16 v[128:131], v[160:163], v[240:243], v[128:131]
  ds_read_b64_tr_b16 v[192:193], v20 offset:24576
  buffer_load_dwordx4 v[92:95], v5, s[36:39], s49 offen offset:1024
  v_mfma_f32_16x16x32_bf16 v[132:135], v[160:163], v[244:247], v[132:135]
  ds_read_b64_tr_b16 v[194:195], v20 offset:25088
  v_mfma_f32_16x16x32_bf16 v[136:139], v[164:167], v[240:243], v[136:139]
  ds_read_b64_tr_b16 v[196:197], v21 offset:24576
  v_mfma_f32_16x16x32_bf16 v[140:143], v[164:167], v[244:247], v[140:143]
  ds_read_b64_tr_b16 v[198:199], v21 offset:25088
  v_mfma_f32_16x16x32_bf16 v[144:147], v[168:171], v[240:243], v[144:147]
  ds_read_b64_tr_b16 v[200:201], v22 offset:24576
  v_mfma_f32_16x16x32_bf16 v[148:151], v[168:171], v[244:247], v[148:151]
  ds_read_b64_tr_b16 v[202:203], v22 offset:25088
  v_readlane_b32 s50, v15, 10
  v_mfma_f32_16x16x32_bf16 v[152:155], v[172:175], v[240:243], v[152:155]
  ds_read_b64_tr_b16 v[204:205], v23 offset:24576
  v_mfma_f32_16x16x32_bf16 v[156:159], v[172:175], v[244:247], v[156:159]
  ds_read_b64_tr_b16 v[206:207], v23 offset:25088
  s_waitcnt vmcnt(16) lgkmcnt(8)
  v_mfma_f32_16x16x32_bf16 v[128:131], v[176:179], v[248:251], v[128:131]
  ds_read_b64_tr_b16 v[208:209], v20 offset:28672
  buffer_load_dwordx4 v[224:227], v4, s[36:39], s50 offen offset:0
  v_mfma_f32_16x16x32_bf16 v[132:135], v[176:179], v[252:255], v[132:135]
  ds_read_b64_tr_b16 v[210:211], v20 offset:29184
  v_mfma_f32_16x16x32_bf16 v[136:139], v[180:183], v[248:251], v[136:139]
  ds_read_b64_tr_b16 v[212:213], v21 offset:28672
  v_mfma_f32_16x16x32_bf16 v[140:143], v[180:183], v[252:255], v[140:143]
  ds_read_b64_tr_b16 v[214:215], v21 offset:29184
  v_mfma_f32_16x16x32_bf16 v[144:147], v[184:187], v[248:251], v[144:147]
  ds_read_b64_tr_b16 v[216:217], v22 offset:28672
  v_mfma_f32_16x16x32_bf16 v[148:151], v[184:187], v[252:255], v[148:151]
  ds_read_b64_tr_b16 v[218:219], v22 offset:29184
  v_mfma_f32_16x16x32_bf16 v[152:155], v[188:191], v[248:251], v[152:155]
  ds_read_b64_tr_b16 v[220:221], v23 offset:28672
  v_mfma_f32_16x16x32_bf16 v[156:159], v[188:191], v[252:255], v[156:159]
  ds_read_b64_tr_b16 v[222:223], v23 offset:29184
  s_waitcnt lgkmcnt(8)
  v_mfma_f32_16x16x32_bf16 v[96:99], v[192:195], v[240:243], v[96:99]
  ds_read_b64_tr_b16 v[160:161], v20 offset:32768
  buffer_load_dwordx4 v[228:231], v5, s[36:39], s50 offen offset:0
  v_mfma_f32_16x16x32_bf16 v[100:103], v[192:195], v[244:247], v[100:103]
  ds_read_b64_tr_b16 v[162:163], v20 offset:33280
  v_mfma_f32_16x16x32_bf16 v[104:107], v[196:199], v[240:243], v[104:107]
  ds_read_b64_tr_b16 v[164:165], v21 offset:32768
  v_mfma_f32_16x16x32_bf16 v[108:111], v[196:199], v[244:247], v[108:111]
  ds_read_b64_tr_b16 v[166:167], v21 offset:33280
  v_mfma_f32_16x16x32_bf16 v[112:115], v[200:203], v[240:243], v[112:115]
  ds_read_b64_tr_b16 v[168:169], v22 offset:32768
  v_mfma_f32_16x16x32_bf16 v[116:119], v[200:203], v[244:247], v[116:119]
  ds_read_b64_tr_b16 v[170:171], v22 offset:33280
  v_mfma_f32_16x16x32_bf16 v[120:123], v[204:207], v[240:243], v[120:123]
  ds_read_b64_tr_b16 v[172:173], v23 offset:32768
  v_mfma_f32_16x16x32_bf16 v[124:127], v[204:207], v[244:247], v[124:127]
  ds_read_b64_tr_b16 v[174:175], v23 offset:33280
  s_waitcnt lgkmcnt(8)
  s_barrier
  v_mfma_f32_16x16x32_bf16 v[96:99], v[208:211], v[248:251], v[96:99]
  ds_read_b64_tr_b16 v[176:177], v20 offset:36864
  buffer_load_dwordx4 v[232:235], v4, s[36:39], s50 offen offset:1024
  v_mfma_f32_16x16x32_bf16 v[100:103], v[208:211], v[252:255], v[100:103]
  ds_read_b64_tr_b16 v[178:179], v20 offset:37376
  v_mfma_f32_16x16x32_bf16 v[104:107], v[212:215], v[248:251], v[104:107]
  ds_read_b64_tr_b16 v[180:181], v21 offset:36864
  v_mfma_f32_16x16x32_bf16 v[108:111], v[212:215], v[252:255], v[108:111]
  ds_read_b64_tr_b16 v[182:183], v21 offset:37376
  v_mfma_f32_16x16x32_bf16 v[112:115], v[216:219], v[248:251], v[112:115]
  ds_read_b64_tr_b16 v[184:185], v22 offset:36864
  v_mfma_f32_16x16x32_bf16 v[116:119], v[216:219], v[252:255], v[116:119]
  ds_read_b64_tr_b16 v[186:187], v22 offset:37376
  v_mfma_f32_16x16x32_bf16 v[120:123], v[220:223], v[248:251], v[120:123]
  ds_read_b64_tr_b16 v[188:189], v23 offset:36864
  v_mfma_f32_16x16x32_bf16 v[124:127], v[220:223], v[252:255], v[124:127]
  ds_read_b64_tr_b16 v[190:191], v23 offset:37376
  s_waitcnt vmcnt(17) lgkmcnt(8)
  v_mfma_f32_16x16x32_bf16 v[128:131], v[160:163], v[32:35], v[128:131]
  ds_read_b64_tr_b16 v[192:193], v20 offset:40960
  buffer_load_dwordx4 v[236:239], v5, s[36:39], s50 offen offset:1024
  v_mfma_f32_16x16x32_bf16 v[132:135], v[160:163], v[36:39], v[132:135]
  ds_read_b64_tr_b16 v[194:195], v20 offset:41472
  v_mfma_f32_16x16x32_bf16 v[136:139], v[164:167], v[32:35], v[136:139]
  ds_read_b64_tr_b16 v[196:197], v21 offset:40960
  v_mfma_f32_16x16x32_bf16 v[140:143], v[164:167], v[36:39], v[140:143]
  ds_read_b64_tr_b16 v[198:199], v21 offset:41472
  v_mfma_f32_16x16x32_bf16 v[144:147], v[168:171], v[32:35], v[144:147]
  ds_read_b64_tr_b16 v[200:201], v22 offset:40960
  v_mfma_f32_16x16x32_bf16 v[148:151], v[168:171], v[36:39], v[148:151]
  ds_read_b64_tr_b16 v[202:203], v22 offset:41472
  v_readlane_b32 s51, v15, 11
  v_mfma_f32_16x16x32_bf16 v[152:155], v[172:175], v[32:35], v[152:155]
  ds_read_b64_tr_b16 v[204:205], v23 offset:40960
  v_mfma_f32_16x16x32_bf16 v[156:159], v[172:175], v[36:39], v[156:159]
  ds_read_b64_tr_b16 v[206:207], v23 offset:41472
  s_waitcnt vmcnt(16) lgkmcnt(8)
  v_mfma_f32_16x16x32_bf16 v[128:131], v[176:179], v[40:43], v[128:131]
  ds_read_b64_tr_b16 v[208:209], v20 offset:45056
  buffer_load_dwordx4 v[240:243], v4, s[36:39], s51 offen offset:0
  v_mfma_f32_16x16x32_bf16 v[132:135], v[176:179], v[44:47], v[132:135]
  ds_read_b64_tr_b16 v[210:211], v20 offset:45568
  v_mfma_f32_16x16x32_bf16 v[136:139], v[180:183], v[40:43], v[136:139]
  ds_read_b64_tr_b16 v[212:213], v21 offset:45056
  v_mfma_f32_16x16x32_bf16 v[140:143], v[180:183], v[44:47], v[140:143]
  ds_read_b64_tr_b16 v[214:215], v21 offset:45568
  v_mfma_f32_16x16x32_bf16 v[144:147], v[184:187], v[40:43], v[144:147]
  ds_read_b64_tr_b16 v[216:217], v22 offset:45056
  v_mfma_f32_16x16x32_bf16 v[148:151], v[184:187], v[44:47], v[148:151]
  ds_read_b64_tr_b16 v[218:219], v22 offset:45568
  v_mfma_f32_16x16x32_bf16 v[152:155], v[188:191], v[40:43], v[152:155]
  ds_read_b64_tr_b16 v[220:221], v23 offset:45056
  v_mfma_f32_16x16x32_bf16 v[156:159], v[188:191], v[44:47], v[156:159]
  ds_read_b64_tr_b16 v[222:223], v23 offset:45568
  s_waitcnt lgkmcnt(8)
  v_mfma_f32_16x16x32_bf16 v[96:99], v[192:195], v[32:35], v[96:99]
  ds_read_b64_tr_b16 v[160:161], v20 offset:49152
  buffer_load_dwordx4 v[244:247], v5, s[36:39], s51 offen offset:0
  v_mfma_f32_16x16x32_bf16 v[100:103], v[192:195], v[36:39], v[100:103]
  ds_read_b64_tr_b16 v[162:163], v20 offset:49664
  v_mfma_f32_16x16x32_bf16 v[104:107], v[196:199], v[32:35], v[104:107]
  ds_read_b64_tr_b16 v[164:165], v21 offset:49152
  v_mfma_f32_16x16x32_bf16 v[108:111], v[196:199], v[36:39], v[108:111]
  ds_read_b64_tr_b16 v[166:167], v21 offset:49664
  v_mfma_f32_16x16x32_bf16 v[112:115], v[200:203], v[32:35], v[112:115]
  ds_read_b64_tr_b16 v[168:169], v22 offset:49152
  v_mfma_f32_16x16x32_bf16 v[116:119], v[200:203], v[36:39], v[116:119]
  ds_read_b64_tr_b16 v[170:171], v22 offset:49664
  v_mfma_f32_16x16x32_bf16 v[120:123], v[204:207], v[32:35], v[120:123]
  ds_read_b64_tr_b16 v[172:173], v23 offset:49152
  v_mfma_f32_16x16x32_bf16 v[124:127], v[204:207], v[36:39], v[124:127]
  ds_read_b64_tr_b16 v[174:175], v23 offset:49664
  s_waitcnt lgkmcnt(8)
  v_mfma_f32_16x16x32_bf16 v[96:99], v[208:211], v[40:43], v[96:99]
  ds_read_b64_tr_b16 v[176:177], v20 offset:53248
  buffer_load_dwordx4 v[248:251], v4, s[36:39], s51 offen offset:1024
  v_mfma_f32_16x16x32_bf16 v[100:103], v[208:211], v[44:47], v[100:103]
  ds_read_b64_tr_b16 v[178:179], v20 offset:53760
  v_mfma_f32_16x16x32_bf16 v[104:107], v[212:215], v[40:43], v[104:107]
  ds_read_b64_tr_b16 v[180:181], v21 offset:53248
  v_mfma_f32_16x16x32_bf16 v[108:111], v[212:215], v[44:47], v[108:111]
  ds_read_b64_tr_b16 v[182:183], v21 offset:53760
  v_mfma_f32_16x16x32_bf16 v[112:115], v[216:219], v[40:43], v[112:115]
  ds_read_b64_tr_b16 v[184:185], v22 offset:53248
  v_mfma_f32_16x16x32_bf16 v[116:119], v[216:219], v[44:47], v[116:119]
  ds_read_b64_tr_b16 v[186:187], v22 offset:53760
  v_mfma_f32_16x16x32_bf16 v[120:123], v[220:223], v[40:43], v[120:123]
  ds_read_b64_tr_b16 v[188:189], v23 offset:53248
  v_mfma_f32_16x16x32_bf16 v[124:127], v[220:223], v[44:47], v[124:127]
  ds_read_b64_tr_b16 v[190:191], v23 offset:53760
  s_waitcnt vmcnt(17) lgkmcnt(8)
  v_mfma_f32_16x16x32_bf16 v[128:131], v[160:163], v[48:51], v[128:131]
  ds_read_b64_tr_b16 v[192:193], v20 offset:57344
  buffer_load_dwordx4 v[252:255], v5, s[36:39], s51 offen offset:1024
  v_mfma_f32_16x16x32_bf16 v[132:135], v[160:163], v[52:55], v[132:135]
  ds_read_b64_tr_b16 v[194:195], v20 offset:57856
  v_mfma_f32_16x16x32_bf16 v[136:139], v[164:167], v[48:51], v[136:139]
  ds_read_b64_tr_b16 v[196:197], v21 offset:57344
  v_mfma_f32_16x16x32_bf16 v[140:143], v[164:167], v[52:55], v[140:143]
  ds_read_b64_tr_b16 v[198:199], v21 offset:57856
  v_mfma_f32_16x16x32_bf16 v[144:147], v[168:171], v[48:51], v[144:147]
  ds_read_b64_tr_b16 v[200:201], v22 offset:57344
  v_mfma_f32_16x16x32_bf16 v[148:151], v[168:171], v[52:55], v[148:151]
  ds_read_b64_tr_b16 v[202:203], v22 offset:57856
  v_readlane_b32 s48, v15, 12
  v_mfma_f32_16x16x32_bf16 v[152:155], v[172:175], v[48:51], v[152:155]
  ds_read_b64_tr_b16 v[204:205], v23 offset:57344
  v_mfma_f32_16x16x32_bf16 v[156:159], v[172:175], v[52:55], v[156:159]
  ds_read_b64_tr_b16 v[206:207], v23 offset:57856
  s_waitcnt vmcnt(16) lgkmcnt(8)
  v_mfma_f32_16x16x32_bf16 v[128:131], v[176:179], v[56:59], v[128:131]
  ds_read_b64_tr_b16 v[208:209], v20 offset:61440
  buffer_load_dwordx4 v[32:35], v4, s[36:39], s48 offen offset:0
  v_mfma_f32_16x16x32_bf16 v[132:135], v[176:179], v[60:63], v[132:135]
  ds_read_b64_tr_b16 v[210:211], v20 offset:61952
  v_mfma_f32_16x16x32_bf16 v[136:139], v[180:183], v[56:59], v[136:139]
  ds_read_b64_tr_b16 v[212:213], v21 offset:61440
  v_mfma_f32_16x16x32_bf16 v[140:143], v[180:183], v[60:63], v[140:143]
  ds_read_b64_tr_b16 v[214:215], v21 offset:61952
  v_mfma_f32_16x16x32_bf16 v[144:147], v[184:187], v[56:59], v[144:147]
  ds_read_b64_tr_b16 v[216:217], v22 offset:61440
  v_mfma_f32_16x16x32_bf16 v[148:151], v[184:187], v[60:63], v[148:151]
  ds_read_b64_tr_b16 v[218:219], v22 offset:61952
  v_mfma_f32_16x16x32_bf16 v[152:155], v[188:191], v[56:59], v[152:155]
  ds_read_b64_tr_b16 v[220:221], v23 offset:61440
  v_mfma_f32_16x16x32_bf16 v[156:159], v[188:191], v[60:63], v[156:159]
  ds_read_b64_tr_b16 v[222:223], v23 offset:61952
  s_waitcnt lgkmcnt(8)
  v_mfma_f32_16x16x32_bf16 v[96:99], v[192:195], v[48:51], v[96:99]
  ds_read_b64_tr_b16 v[160:161], v26 offset:0
  buffer_load_dwordx4 v[36:39], v5, s[36:39], s48 offen offset:0
  v_mfma_f32_16x16x32_bf16 v[100:103], v[192:195], v[52:55], v[100:103]
  ds_read_b64_tr_b16 v[162:163], v26 offset:512
  v_mfma_f32_16x16x32_bf16 v[104:107], v[196:199], v[48:51], v[104:107]
  ds_read_b64_tr_b16 v[164:165], v27 offset:0
  v_mfma_f32_16x16x32_bf16 v[108:111], v[196:199], v[52:55], v[108:111]
  ds_read_b64_tr_b16 v[166:167], v27 offset:512
  v_mfma_f32_16x16x32_bf16 v[112:115], v[200:203], v[48:51], v[112:115]
  ds_read_b64_tr_b16 v[168:169], v28 offset:0
  v_mfma_f32_16x16x32_bf16 v[116:119], v[200:203], v[52:55], v[116:119]
  ds_read_b64_tr_b16 v[170:171], v28 offset:512
  v_mfma_f32_16x16x32_bf16 v[120:123], v[204:207], v[48:51], v[120:123]
  ds_read_b64_tr_b16 v[172:173], v29 offset:0
  v_mfma_f32_16x16x32_bf16 v[124:127], v[204:207], v[52:55], v[124:127]
  ds_read_b64_tr_b16 v[174:175], v29 offset:512
  s_waitcnt lgkmcnt(8)
  s_barrier
  v_mfma_f32_16x16x32_bf16 v[96:99], v[208:211], v[56:59], v[96:99]
  ds_read_b64_tr_b16 v[176:177], v26 offset:4096
  buffer_load_dwordx4 v[40:43], v4, s[36:39], s48 offen offset:1024
  v_mfma_f32_16x16x32_bf16 v[100:103], v[208:211], v[60:63], v[100:103]
  ds_read_b64_tr_b16 v[178:179], v26 offset:4608
  v_mfma_f32_16x16x32_bf16 v[104:107], v[212:215], v[56:59], v[104:107]
  ds_read_b64_tr_b16 v[180:181], v27 offset:4096
  v_mfma_f32_16x16x32_bf16 v[108:111], v[212:215], v[60:63], v[108:111]
  ds_read_b64_tr_b16 v[182:183], v27 offset:4608
  v_mfma_f32_16x16x32_bf16 v[112:115], v[216:219], v[56:59], v[112:115]
  ds_read_b64_tr_b16 v[184:185], v28 offset:4096
  v_mfma_f32_16x16x32_bf16 v[116:119], v[216:219], v[60:63], v[116:119]
  ds_read_b64_tr_b16 v[186:187], v28 offset:4608
  v_mfma_f32_16x16x32_bf16 v[120:123], v[220:223], v[56:59], v[120:123]
  ds_read_b64_tr_b16 v[188:189], v29 offset:4096
  v_mfma_f32_16x16x32_bf16 v[124:127], v[220:223], v[60:63], v[124:127]
  ds_read_b64_tr_b16 v[190:191], v29 offset:4608
  s_waitcnt vmcnt(17) lgkmcnt(8)
  v_mfma_f32_16x16x32_bf16 v[128:131], v[160:163], v[64:67], v[128:131]
  ds_read_b64_tr_b16 v[192:193], v26 offset:8192
  buffer_load_dwordx4 v[44:47], v5, s[36:39], s48 offen offset:1024
  v_mfma_f32_16x16x32_bf16 v[132:135], v[160:163], v[68:71], v[132:135]
  ds_read_b64_tr_b16 v[194:195], v26 offset:8704
  v_mfma_f32_16x16x32_bf16 v[136:139], v[164:167], v[64:67], v[136:139]
  ds_read_b64_tr_b16 v[196:197], v27 offset:8192
  v_mfma_f32_16x16x32_bf16 v[140:143], v[164:167], v[68:71], v[140:143]
  ds_read_b64_tr_b16 v[198:199], v27 offset:8704
  v_mfma_f32_16x16x32_bf16 v[144:147], v[168:171], v[64:67], v[144:147]
  ds_read_b64_tr_b16 v[200:201], v28 offset:8192
  v_mfma_f32_16x16x32_bf16 v[148:151], v[168:171], v[68:71], v[148:151]
  ds_read_b64_tr_b16 v[202:203], v28 offset:8704
  v_readlane_b32 s49, v15, 13
  v_mfma_f32_16x16x32_bf16 v[152:155], v[172:175], v[64:67], v[152:155]
  ds_read_b64_tr_b16 v[204:205], v29 offset:8192
  v_mfma_f32_16x16x32_bf16 v[156:159], v[172:175], v[68:71], v[156:159]
  ds_read_b64_tr_b16 v[206:207], v29 offset:8704
  s_waitcnt vmcnt(16) lgkmcnt(8)
  v_mfma_f32_16x16x32_bf16 v[128:131], v[176:179], v[72:75], v[128:131]
  ds_read_b64_tr_b16 v[208:209], v26 offset:12288
  buffer_load_dwordx4 v[48:51], v4, s[36:39], s49 offen offset:0
  v_mfma_f32_16x16x32_bf16 v[132:135], v[176:179], v[76:79], v[132:135]
  ds_read_b64_tr_b16 v[210:211], v26 offset:12800
  v_mfma_f32_16x16x32_bf16 v[136:139], v[180:183], v[72:75], v[136:139]
  ds_read_b64_tr_b16 v[212:213], v27 offset:12288
  v_mfma_f32_16x16x32_bf16 v[140:143], v[180:183], v[76:79], v[140:143]
  ds_read_b64_tr_b16 v[214:215], v27 offset:12800
  v_mfma_f32_16x16x32_bf16 v[144:147], v[184:187], v[72:75], v[144:147]
  ds_read_b64_tr_b16 v[216:217], v28 offset:12288
  v_mfma_f32_16x16x32_bf16 v[148:151], v[184:187], v[76:79], v[148:151]
  ds_read_b64_tr_b16 v[218:219], v28 offset:12800
  v_mfma_f32_16x16x32_bf16 v[152:155], v[188:191], v[72:75], v[152:155]
  ds_read_b64_tr_b16 v[220:221], v29 offset:12288
  v_mfma_f32_16x16x32_bf16 v[156:159], v[188:191], v[76:79], v[156:159]
  ds_read_b64_tr_b16 v[222:223], v29 offset:12800
  s_waitcnt lgkmcnt(8)
  v_mfma_f32_16x16x32_bf16 v[96:99], v[192:195], v[64:67], v[96:99]
  ds_read_b64_tr_b16 v[160:161], v26 offset:16384
  buffer_load_dwordx4 v[52:55], v5, s[36:39], s49 offen offset:0
  v_mfma_f32_16x16x32_bf16 v[100:103], v[192:195], v[68:71], v[100:103]
  ds_read_b64_tr_b16 v[162:163], v26 offset:16896
  v_mfma_f32_16x16x32_bf16 v[104:107], v[196:199], v[64:67], v[104:107]
  ds_read_b64_tr_b16 v[164:165], v27 offset:16384
  v_mfma_f32_16x16x32_bf16 v[108:111], v[196:199], v[68:71], v[108:111]
  ds_read_b64_tr_b16 v[166:167], v27 offset:16896
  v_mfma_f32_16x16x32_bf16 v[112:115], v[200:203], v[64:67], v[112:115]
  ds_read_b64_tr_b16 v[168:169], v28 offset:16384
  v_mfma_f32_16x16x32_bf16 v[116:119], v[200:203], v[68:71], v[116:119]
  ds_read_b64_tr_b16 v[170:171], v28 offset:16896
  v_mfma_f32_16x16x32_bf16 v[120:123], v[204:207], v[64:67], v[120:123]
  ds_read_b64_tr_b16 v[172:173], v29 offset:16384
  v_mfma_f32_16x16x32_bf16 v[124:127], v[204:207], v[68:71], v[124:127]
  ds_read_b64_tr_b16 v[174:175], v29 offset:16896
  s_waitcnt lgkmcnt(8)
  v_mfma_f32_16x16x32_bf16 v[96:99], v[208:211], v[72:75], v[96:99]
  ds_read_b64_tr_b16 v[176:177], v26 offset:20480
  buffer_load_dwordx4 v[56:59], v4, s[36:39], s49 offen offset:1024
  v_mfma_f32_16x16x32_bf16 v[100:103], v[208:211], v[76:79], v[100:103]
  ds_read_b64_tr_b16 v[178:179], v26 offset:20992
  v_mfma_f32_16x16x32_bf16 v[104:107], v[212:215], v[72:75], v[104:107]
  ds_read_b64_tr_b16 v[180:181], v27 offset:20480
  v_mfma_f32_16x16x32_bf16 v[108:111], v[212:215], v[76:79], v[108:111]
  ds_read_b64_tr_b16 v[182:183], v27 offset:20992
  v_mfma_f32_16x16x32_bf16 v[112:115], v[216:219], v[72:75], v[112:115]
  ds_read_b64_tr_b16 v[184:185], v28 offset:20480
  v_mfma_f32_16x16x32_bf16 v[116:119], v[216:219], v[76:79], v[116:119]
  ds_read_b64_tr_b16 v[186:187], v28 offset:20992
  v_mfma_f32_16x16x32_bf16 v[120:123], v[220:223], v[72:75], v[120:123]
  ds_read_b64_tr_b16 v[188:189], v29 offset:20480
  v_mfma_f32_16x16x32_bf16 v[124:127], v[220:223], v[76:79], v[124:127]
  ds_read_b64_tr_b16 v[190:191], v29 offset:20992
  s_waitcnt vmcnt(17) lgkmcnt(8)
  v_mfma_f32_16x16x32_bf16 v[128:131], v[160:163], v[80:83], v[128:131]
  ds_read_b64_tr_b16 v[192:193], v26 offset:24576
  buffer_load_dwordx4 v[60:63], v5, s[36:39], s49 offen offset:1024
  v_mfma_f32_16x16x32_bf16 v[132:135], v[160:163], v[84:87], v[132:135]
  ds_read_b64_tr_b16 v[194:195], v26 offset:25088
  v_mfma_f32_16x16x32_bf16 v[136:139], v[164:167], v[80:83], v[136:139]
  ds_read_b64_tr_b16 v[196:197], v27 offset:24576
  v_mfma_f32_16x16x32_bf16 v[140:143], v[164:167], v[84:87], v[140:143]
  ds_read_b64_tr_b16 v[198:199], v27 offset:25088
  v_mfma_f32_16x16x32_bf16 v[144:147], v[168:171], v[80:83], v[144:147]
  ds_read_b64_tr_b16 v[200:201], v28 offset:24576
  v_mfma_f32_16x16x32_bf16 v[148:151], v[168:171], v[84:87], v[148:151]
  ds_read_b64_tr_b16 v[202:203], v28 offset:25088
  v_readlane_b32 s50, v15, 14
  v_mfma_f32_16x16x32_bf16 v[152:155], v[172:175], v[80:83], v[152:155]
  ds_read_b64_tr_b16 v[204:205], v29 offset:24576
  v_mfma_f32_16x16x32_bf16 v[156:159], v[172:175], v[84:87], v[156:159]
  ds_read_b64_tr_b16 v[206:207], v29 offset:25088
  s_waitcnt vmcnt(16) lgkmcnt(8)
  v_mfma_f32_16x16x32_bf16 v[128:131], v[176:179], v[88:91], v[128:131]
  ds_read_b64_tr_b16 v[208:209], v26 offset:28672
  buffer_load_dwordx4 v[64:67], v4, s[36:39], s50 offen offset:0
  v_mfma_f32_16x16x32_bf16 v[132:135], v[176:179], v[92:95], v[132:135]
  ds_read_b64_tr_b16 v[210:211], v26 offset:29184
  v_mfma_f32_16x16x32_bf16 v[136:139], v[180:183], v[88:91], v[136:139]
  ds_read_b64_tr_b16 v[212:213], v27 offset:28672
  v_mfma_f32_16x16x32_bf16 v[140:143], v[180:183], v[92:95], v[140:143]
  ds_read_b64_tr_b16 v[214:215], v27 offset:29184
  v_mfma_f32_16x16x32_bf16 v[144:147], v[184:187], v[88:91], v[144:147]
  ds_read_b64_tr_b16 v[216:217], v28 offset:28672
  v_mfma_f32_16x16x32_bf16 v[148:151], v[184:187], v[92:95], v[148:151]
  ds_read_b64_tr_b16 v[218:219], v28 offset:29184
  v_mfma_f32_16x16x32_bf16 v[152:155], v[188:191], v[88:91], v[152:155]
  ds_read_b64_tr_b16 v[220:221], v29 offset:28672
  v_mfma_f32_16x16x32_bf16 v[156:159], v[188:191], v[92:95], v[156:159]
  ds_read_b64_tr_b16 v[222:223], v29 offset:29184
  s_waitcnt lgkmcnt(8)
  v_mfma_f32_16x16x32_bf16 v[96:99], v[192:195], v[80:83], v[96:99]
  ds_read_b64_tr_b16 v[160:161], v6 offset:0
  buffer_load_dwordx4 v[68:71], v5, s[36:39], s50 offen offset:0
  v_mfma_f32_16x16x32_bf16 v[100:103], v[192:195], v[84:87], v[100:103]
  ds_read_b64_tr_b16 v[162:163], v6 offset:512
  v_mfma_f32_16x16x32_bf16 v[104:107], v[196:199], v[80:83], v[104:107]
  ds_read_b64_tr_b16 v[164:165], v7 offset:0
  v_mfma_f32_16x16x32_bf16 v[108:111], v[196:199], v[84:87], v[108:111]
  ds_read_b64_tr_b16 v[166:167], v7 offset:512
  v_mfma_f32_16x16x32_bf16 v[112:115], v[200:203], v[80:83], v[112:115]
  ds_read_b64_tr_b16 v[168:169], v8 offset:0
  v_mfma_f32_16x16x32_bf16 v[116:119], v[200:203], v[84:87], v[116:119]
  ds_read_b64_tr_b16 v[170:171], v8 offset:512
  v_mfma_f32_16x16x32_bf16 v[120:123], v[204:207], v[80:83], v[120:123]
  ds_read_b64_tr_b16 v[172:173], v9 offset:0
  v_mfma_f32_16x16x32_bf16 v[124:127], v[204:207], v[84:87], v[124:127]
  ds_read_b64_tr_b16 v[174:175], v9 offset:512
  s_waitcnt lgkmcnt(8)
  s_barrier
  v_mfma_f32_16x16x32_bf16 v[96:99], v[208:211], v[88:91], v[96:99]
  ds_read_b64_tr_b16 v[176:177], v6 offset:4096
  buffer_load_dwordx4 v[72:75], v4, s[36:39], s50 offen offset:1024
  v_mfma_f32_16x16x32_bf16 v[100:103], v[208:211], v[92:95], v[100:103]
  ds_read_b64_tr_b16 v[178:179], v6 offset:4608
  v_mfma_f32_16x16x32_bf16 v[104:107], v[212:215], v[88:91], v[104:107]
  ds_read_b64_tr_b16 v[180:181], v7 offset:4096
  v_mfma_f32_16x16x32_bf16 v[108:111], v[212:215], v[92:95], v[108:111]
  ds_read_b64_tr_b16 v[182:183], v7 offset:4608
  v_mfma_f32_16x16x32_bf16 v[112:115], v[216:219], v[88:91], v[112:115]
  ds_read_b64_tr_b16 v[184:185], v8 offset:4096
  v_mfma_f32_16x16x32_bf16 v[116:119], v[216:219], v[92:95], v[116:119]
  ds_read_b64_tr_b16 v[186:187], v8 offset:4608
  v_mfma_f32_16x16x32_bf16 v[120:123], v[220:223], v[88:91], v[120:123]
  ds_read_b64_tr_b16 v[188:189], v9 offset:4096
  v_mfma_f32_16x16x32_bf16 v[124:127], v[220:223], v[92:95], v[124:127]
  ds_read_b64_tr_b16 v[190:191], v9 offset:4608
  s_waitcnt vmcnt(17) lgkmcnt(8)
  v_mfma_f32_16x16x32_bf16 v[128:131], v[160:163], v[224:227], v[128:131]
  ds_read_b64_tr_b16 v[192:193], v6 offset:8192
  buffer_load_dwordx4 v[76:79], v5, s[36:39], s50 offen offset:1024
  v_mfma_f32_16x16x32_bf16 v[132:135], v[160:163], v[228:231], v[132:135]
  ds_read_b64_tr_b16 v[194:195], v6 offset:8704
  v_mfma_f32_16x16x32_bf16 v[136:139], v[164:167], v[224:227], v[136:139]
  ds_read_b64_tr_b16 v[196:197], v7 offset:8192
  v_mfma_f32_16x16x32_bf16 v[140:143], v[164:167], v[228:231], v[140:143]
  ds_read_b64_tr_b16 v[198:199], v7 offset:8704
  v_mfma_f32_16x16x32_bf16 v[144:147], v[168:171], v[224:227], v[144:147]
  ds_read_b64_tr_b16 v[200:201], v8 offset:8192
  v_mfma_f32_16x16x32_bf16 v[148:151], v[168:171], v[228:231], v[148:151]
  ds_read_b64_tr_b16 v[202:203], v8 offset:8704
  v_readlane_b32 s51, v15, 15
  v_mfma_f32_16x16x32_bf16 v[152:155], v[172:175], v[224:227], v[152:155]
  ds_read_b64_tr_b16 v[204:205], v9 offset:8192
  v_mfma_f32_16x16x32_bf16 v[156:159], v[172:175], v[228:231], v[156:159]
  ds_read_b64_tr_b16 v[206:207], v9 offset:8704
  s_waitcnt vmcnt(16) lgkmcnt(8)
  v_mfma_f32_16x16x32_bf16 v[128:131], v[176:179], v[232:235], v[128:131]
  ds_read_b64_tr_b16 v[208:209], v6 offset:12288
  buffer_load_dwordx4 v[80:83], v4, s[36:39], s51 offen offset:0
  v_mfma_f32_16x16x32_bf16 v[132:135], v[176:179], v[236:239], v[132:135]
  ds_read_b64_tr_b16 v[210:211], v6 offset:12800
  v_mfma_f32_16x16x32_bf16 v[136:139], v[180:183], v[232:235], v[136:139]
  ds_read_b64_tr_b16 v[212:213], v7 offset:12288
  v_mfma_f32_16x16x32_bf16 v[140:143], v[180:183], v[236:239], v[140:143]
  ds_read_b64_tr_b16 v[214:215], v7 offset:12800
  v_mfma_f32_16x16x32_bf16 v[144:147], v[184:187], v[232:235], v[144:147]
  ds_read_b64_tr_b16 v[216:217], v8 offset:12288
  v_mfma_f32_16x16x32_bf16 v[148:151], v[184:187], v[236:239], v[148:151]
  ds_read_b64_tr_b16 v[218:219], v8 offset:12800
  v_mfma_f32_16x16x32_bf16 v[152:155], v[188:191], v[232:235], v[152:155]
  ds_read_b64_tr_b16 v[220:221], v9 offset:12288
  v_mfma_f32_16x16x32_bf16 v[156:159], v[188:191], v[236:239], v[156:159]
  ds_read_b64_tr_b16 v[222:223], v9 offset:12800
  s_waitcnt lgkmcnt(8)
  v_mfma_f32_16x16x32_bf16 v[96:99], v[192:195], v[224:227], v[96:99]
  ds_read_b64_tr_b16 v[160:161], v6 offset:16384
  buffer_load_dwordx4 v[84:87], v5, s[36:39], s51 offen offset:0
  v_mfma_f32_16x16x32_bf16 v[100:103], v[192:195], v[228:231], v[100:103]
  ds_read_b64_tr_b16 v[162:163], v6 offset:16896
  v_mfma_f32_16x16x32_bf16 v[104:107], v[196:199], v[224:227], v[104:107]
  ds_read_b64_tr_b16 v[164:165], v7 offset:16384
  v_mfma_f32_16x16x32_bf16 v[108:111], v[196:199], v[228:231], v[108:111]
  ds_read_b64_tr_b16 v[166:167], v7 offset:16896
  v_mfma_f32_16x16x32_bf16 v[112:115], v[200:203], v[224:227], v[112:115]
  ds_read_b64_tr_b16 v[168:169], v8 offset:16384
  v_mfma_f32_16x16x32_bf16 v[116:119], v[200:203], v[228:231], v[116:119]
  ds_read_b64_tr_b16 v[170:171], v8 offset:16896
  v_mfma_f32_16x16x32_bf16 v[120:123], v[204:207], v[224:227], v[120:123]
  ds_read_b64_tr_b16 v[172:173], v9 offset:16384
  v_mfma_f32_16x16x32_bf16 v[124:127], v[204:207], v[228:231], v[124:127]
  ds_read_b64_tr_b16 v[174:175], v9 offset:16896
  s_waitcnt lgkmcnt(8)
  v_mfma_f32_16x16x32_bf16 v[96:99], v[208:211], v[232:235], v[96:99]
  ds_read_b64_tr_b16 v[176:177], v6 offset:20480
  buffer_load_dwordx4 v[88:91], v4, s[36:39], s51 offen offset:1024
  v_mfma_f32_16x16x32_bf16 v[100:103], v[208:211], v[236:239], v[100:103]
  ds_read_b64_tr_b16 v[178:179], v6 offset:20992
  v_mfma_f32_16x16x32_bf16 v[104:107], v[212:215], v[232:235], v[104:107]
  ds_read_b64_tr_b16 v[180:181], v7 offset:20480
  v_mfma_f32_16x16x32_bf16 v[108:111], v[212:215], v[236:239], v[108:111]
  ds_read_b64_tr_b16 v[182:183], v7 offset:20992
  v_mfma_f32_16x16x32_bf16 v[112:115], v[216:219], v[232:235], v[112:115]
  ds_read_b64_tr_b16 v[184:185], v8 offset:20480
  v_mfma_f32_16x16x32_bf16 v[116:119], v[216:219], v[236:239], v[116:119]
  ds_read_b64_tr_b16 v[186:187], v8 offset:20992
  v_mfma_f32_16x16x32_bf16 v[120:123], v[220:223], v[232:235], v[120:123]
  ds_read_b64_tr_b16 v[188:189], v9 offset:20480
  v_mfma_f32_16x16x32_bf16 v[124:127], v[220:223], v[236:239], v[124:127]
  ds_read_b64_tr_b16 v[190:191], v9 offset:20992
  s_waitcnt vmcnt(17) lgkmcnt(8)
  v_mfma_f32_16x16x32_bf16 v[128:131], v[160:163], v[240:243], v[128:131]
  ds_read_b64_tr_b16 v[192:193], v6 offset:24576
  buffer_load_dwordx4 v[92:95], v5, s[36:39], s51 offen offset:1024
  v_mfma_f32_16x16x32_bf16 v[132:135], v[160:163], v[244:247], v[132:135]
  ds_read_b64_tr_b16 v[194:195], v6 offset:25088
  v_mfma_f32_16x16x32_bf16 v[136:139], v[164:167], v[240:243], v[136:139]
  ds_read_b64_tr_b16 v[196:197], v7 offset:24576
  v_mfma_f32_16x16x32_bf16 v[140:143], v[164:167], v[244:247], v[140:143]
  ds_read_b64_tr_b16 v[198:199], v7 offset:25088
  v_mfma_f32_16x16x32_bf16 v[144:147], v[168:171], v[240:243], v[144:147]
  ds_read_b64_tr_b16 v[200:201], v8 offset:24576
  v_mfma_f32_16x16x32_bf16 v[148:151], v[168:171], v[244:247], v[148:151]
  ds_read_b64_tr_b16 v[202:203], v8 offset:25088
  v_readlane_b32 s48, v15, 16
  v_mfma_f32_16x16x32_bf16 v[152:155], v[172:175], v[240:243], v[152:155]
  ds_read_b64_tr_b16 v[204:205], v9 offset:24576
  v_mfma_f32_16x16x32_bf16 v[156:159], v[172:175], v[244:247], v[156:159]
  ds_read_b64_tr_b16 v[206:207], v9 offset:25088
  s_waitcnt vmcnt(16) lgkmcnt(8)
  v_mfma_f32_16x16x32_bf16 v[128:131], v[176:179], v[248:251], v[128:131]
  ds_read_b64_tr_b16 v[208:209], v6 offset:28672
  buffer_load_dwordx4 v[224:227], v4, s[36:39], s48 offen offset:0
  v_mfma_f32_16x16x32_bf16 v[132:135], v[176:179], v[252:255], v[132:135]
  ds_read_b64_tr_b16 v[210:211], v6 offset:29184
  v_mfma_f32_16x16x32_bf16 v[136:139], v[180:183], v[248:251], v[136:139]
  ds_read_b64_tr_b16 v[212:213], v7 offset:28672
  v_mfma_f32_16x16x32_bf16 v[140:143], v[180:183], v[252:255], v[140:143]
  ds_read_b64_tr_b16 v[214:215], v7 offset:29184
  v_mfma_f32_16x16x32_bf16 v[144:147], v[184:187], v[248:251], v[144:147]
  ds_read_b64_tr_b16 v[216:217], v8 offset:28672
  v_mfma_f32_16x16x32_bf16 v[148:151], v[184:187], v[252:255], v[148:151]
  ds_read_b64_tr_b16 v[218:219], v8 offset:29184
  v_mfma_f32_16x16x32_bf16 v[152:155], v[188:191], v[248:251], v[152:155]
  ds_read_b64_tr_b16 v[220:221], v9 offset:28672
  v_mfma_f32_16x16x32_bf16 v[156:159], v[188:191], v[252:255], v[156:159]
  ds_read_b64_tr_b16 v[222:223], v9 offset:29184
  s_waitcnt lgkmcnt(8)
  v_mfma_f32_16x16x32_bf16 v[96:99], v[192:195], v[240:243], v[96:99]
  ds_read_b64_tr_b16 v[160:161], v6 offset:32768
  buffer_load_dwordx4 v[228:231], v5, s[36:39], s48 offen offset:0
  v_mfma_f32_16x16x32_bf16 v[100:103], v[192:195], v[244:247], v[100:103]
  ds_read_b64_tr_b16 v[162:163], v6 offset:33280
  v_mfma_f32_16x16x32_bf16 v[104:107], v[196:199], v[240:243], v[104:107]
  ds_read_b64_tr_b16 v[164:165], v7 offset:32768
  v_mfma_f32_16x16x32_bf16 v[108:111], v[196:199], v[244:247], v[108:111]
  ds_read_b64_tr_b16 v[166:167], v7 offset:33280
  v_mfma_f32_16x16x32_bf16 v[112:115], v[200:203], v[240:243], v[112:115]
  ds_read_b64_tr_b16 v[168:169], v8 offset:32768
  v_mfma_f32_16x16x32_bf16 v[116:119], v[200:203], v[244:247], v[116:119]
  ds_read_b64_tr_b16 v[170:171], v8 offset:33280
  v_mfma_f32_16x16x32_bf16 v[120:123], v[204:207], v[240:243], v[120:123]
  ds_read_b64_tr_b16 v[172:173], v9 offset:32768
  v_mfma_f32_16x16x32_bf16 v[124:127], v[204:207], v[244:247], v[124:127]
  ds_read_b64_tr_b16 v[174:175], v9 offset:33280
  s_waitcnt lgkmcnt(8)
  s_barrier
  v_mfma_f32_16x16x32_bf16 v[96:99], v[208:211], v[248:251], v[96:99]
  ds_read_b64_tr_b16 v[176:177], v6 offset:36864
  buffer_load_dwordx4 v[232:235], v4, s[36:39], s48 offen offset:1024
  v_mfma_f32_16x16x32_bf16 v[100:103], v[208:211], v[252:255], v[100:103]
  ds_read_b64_tr_b16 v[178:179], v6 offset:37376
  v_mfma_f32_16x16x32_bf16 v[104:107], v[212:215], v[248:251], v[104:107]
  ds_read_b64_tr_b16 v[180:181], v7 offset:36864
  v_mfma_f32_16x16x32_bf16 v[108:111], v[212:215], v[252:255], v[108:111]
  ds_read_b64_tr_b16 v[182:183], v7 offset:37376
  v_mfma_f32_16x16x32_bf16 v[112:115], v[216:219], v[248:251], v[112:115]
  ds_read_b64_tr_b16 v[184:185], v8 offset:36864
  v_mfma_f32_16x16x32_bf16 v[116:119], v[216:219], v[252:255], v[116:119]
  ds_read_b64_tr_b16 v[186:187], v8 offset:37376
  v_mfma_f32_16x16x32_bf16 v[120:123], v[220:223], v[248:251], v[120:123]
  ds_read_b64_tr_b16 v[188:189], v9 offset:36864
  v_mfma_f32_16x16x32_bf16 v[124:127], v[220:223], v[252:255], v[124:127]
  ds_read_b64_tr_b16 v[190:191], v9 offset:37376
  s_waitcnt vmcnt(17) lgkmcnt(8)
  v_mfma_f32_16x16x32_bf16 v[128:131], v[160:163], v[32:35], v[128:131]
  ds_read_b64_tr_b16 v[192:193], v6 offset:40960
  buffer_load_dwordx4 v[236:239], v5, s[36:39], s48 offen offset:1024
  v_mfma_f32_16x16x32_bf16 v[132:135], v[160:163], v[36:39], v[132:135]
  ds_read_b64_tr_b16 v[194:195], v6 offset:41472
  v_mfma_f32_16x16x32_bf16 v[136:139], v[164:167], v[32:35], v[136:139]
  ds_read_b64_tr_b16 v[196:197], v7 offset:40960
  v_mfma_f32_16x16x32_bf16 v[140:143], v[164:167], v[36:39], v[140:143]
  ds_read_b64_tr_b16 v[198:199], v7 offset:41472
  v_mfma_f32_16x16x32_bf16 v[144:147], v[168:171], v[32:35], v[144:147]
  ds_read_b64_tr_b16 v[200:201], v8 offset:40960
  v_mfma_f32_16x16x32_bf16 v[148:151], v[168:171], v[36:39], v[148:151]
  ds_read_b64_tr_b16 v[202:203], v8 offset:41472
  v_readlane_b32 s49, v15, 17
  v_mfma_f32_16x16x32_bf16 v[152:155], v[172:175], v[32:35], v[152:155]
  ds_read_b64_tr_b16 v[204:205], v9 offset:40960
  v_mfma_f32_16x16x32_bf16 v[156:159], v[172:175], v[36:39], v[156:159]
  ds_read_b64_tr_b16 v[206:207], v9 offset:41472
  s_waitcnt vmcnt(16) lgkmcnt(8)
  v_mfma_f32_16x16x32_bf16 v[128:131], v[176:179], v[40:43], v[128:131]
  ds_read_b64_tr_b16 v[208:209], v6 offset:45056
  buffer_load_dwordx4 v[240:243], v4, s[36:39], s49 offen offset:0
  v_mfma_f32_16x16x32_bf16 v[132:135], v[176:179], v[44:47], v[132:135]
  ds_read_b64_tr_b16 v[210:211], v6 offset:45568
  v_mfma_f32_16x16x32_bf16 v[136:139], v[180:183], v[40:43], v[136:139]
  ds_read_b64_tr_b16 v[212:213], v7 offset:45056
  v_mfma_f32_16x16x32_bf16 v[140:143], v[180:183], v[44:47], v[140:143]
  ds_read_b64_tr_b16 v[214:215], v7 offset:45568
  v_mfma_f32_16x16x32_bf16 v[144:147], v[184:187], v[40:43], v[144:147]
  ds_read_b64_tr_b16 v[216:217], v8 offset:45056
  v_mfma_f32_16x16x32_bf16 v[148:151], v[184:187], v[44:47], v[148:151]
  ds_read_b64_tr_b16 v[218:219], v8 offset:45568
  v_mfma_f32_16x16x32_bf16 v[152:155], v[188:191], v[40:43], v[152:155]
  ds_read_b64_tr_b16 v[220:221], v9 offset:45056
  v_mfma_f32_16x16x32_bf16 v[156:159], v[188:191], v[44:47], v[156:159]
  ds_read_b64_tr_b16 v[222:223], v9 offset:45568
  s_waitcnt lgkmcnt(8)
  v_mfma_f32_16x16x32_bf16 v[96:99], v[192:195], v[32:35], v[96:99]
  ds_read_b64_tr_b16 v[160:161], v6 offset:49152
  buffer_load_dwordx4 v[244:247], v5, s[36:39], s49 offen offset:0
  v_mfma_f32_16x16x32_bf16 v[100:103], v[192:195], v[36:39], v[100:103]
  ds_read_b64_tr_b16 v[162:163], v6 offset:49664
  v_mfma_f32_16x16x32_bf16 v[104:107], v[196:199], v[32:35], v[104:107]
  ds_read_b64_tr_b16 v[164:165], v7 offset:49152
  v_mfma_f32_16x16x32_bf16 v[108:111], v[196:199], v[36:39], v[108:111]
  ds_read_b64_tr_b16 v[166:167], v7 offset:49664
  v_mfma_f32_16x16x32_bf16 v[112:115], v[200:203], v[32:35], v[112:115]
  ds_read_b64_tr_b16 v[168:169], v8 offset:49152
  v_mfma_f32_16x16x32_bf16 v[116:119], v[200:203], v[36:39], v[116:119]
  ds_read_b64_tr_b16 v[170:171], v8 offset:49664
  v_mfma_f32_16x16x32_bf16 v[120:123], v[204:207], v[32:35], v[120:123]
  ds_read_b64_tr_b16 v[172:173], v9 offset:49152
  v_mfma_f32_16x16x32_bf16 v[124:127], v[204:207], v[36:39], v[124:127]
  ds_read_b64_tr_b16 v[174:175], v9 offset:49664
  s_waitcnt lgkmcnt(8)
  v_mfma_f32_16x16x32_bf16 v[96:99], v[208:211], v[40:43], v[96:99]
  ds_read_b64_tr_b16 v[176:177], v6 offset:53248
  buffer_load_dwordx4 v[248:251], v4, s[36:39], s49 offen offset:1024
  v_mfma_f32_16x16x32_bf16 v[100:103], v[208:211], v[44:47], v[100:103]
  ds_read_b64_tr_b16 v[178:179], v6 offset:53760
  v_mfma_f32_16x16x32_bf16 v[104:107], v[212:215], v[40:43], v[104:107]
  ds_read_b64_tr_b16 v[180:181], v7 offset:53248
  v_mfma_f32_16x16x32_bf16 v[108:111], v[212:215], v[44:47], v[108:111]
  ds_read_b64_tr_b16 v[182:183], v7 offset:53760
  v_mfma_f32_16x16x32_bf16 v[112:115], v[216:219], v[40:43], v[112:115]
  ds_read_b64_tr_b16 v[184:185], v8 offset:53248
  v_mfma_f32_16x16x32_bf16 v[116:119], v[216:219], v[44:47], v[116:119]
  ds_read_b64_tr_b16 v[186:187], v8 offset:53760
  v_mfma_f32_16x16x32_bf16 v[120:123], v[220:223], v[40:43], v[120:123]
  ds_read_b64_tr_b16 v[188:189], v9 offset:53248
  v_mfma_f32_16x16x32_bf16 v[124:127], v[220:223], v[44:47], v[124:127]
  ds_read_b64_tr_b16 v[190:191], v9 offset:53760
  s_waitcnt vmcnt(17) lgkmcnt(8)
  v_mfma_f32_16x16x32_bf16 v[128:131], v[160:163], v[48:51], v[128:131]
  ds_read_b64_tr_b16 v[192:193], v6 offset:57344
  buffer_load_dwordx4 v[252:255], v5, s[36:39], s49 offen offset:1024
  v_mfma_f32_16x16x32_bf16 v[132:135], v[160:163], v[52:55], v[132:135]
  ds_read_b64_tr_b16 v[194:195], v6 offset:57856
  v_mfma_f32_16x16x32_bf16 v[136:139], v[164:167], v[48:51], v[136:139]
  ds_read_b64_tr_b16 v[196:197], v7 offset:57344
  v_mfma_f32_16x16x32_bf16 v[140:143], v[164:167], v[52:55], v[140:143]
  ds_read_b64_tr_b16 v[198:199], v7 offset:57856
  v_mfma_f32_16x16x32_bf16 v[144:147], v[168:171], v[48:51], v[144:147]
  ds_read_b64_tr_b16 v[200:201], v8 offset:57344
  v_mfma_f32_16x16x32_bf16 v[148:151], v[168:171], v[52:55], v[148:151]
  ds_read_b64_tr_b16 v[202:203], v8 offset:57856
  v_readlane_b32 s50, v15, 18
  v_mfma_f32_16x16x32_bf16 v[152:155], v[172:175], v[48:51], v[152:155]
  ds_read_b64_tr_b16 v[204:205], v9 offset:57344
  v_mfma_f32_16x16x32_bf16 v[156:159], v[172:175], v[52:55], v[156:159]
  ds_read_b64_tr_b16 v[206:207], v9 offset:57856
  s_waitcnt vmcnt(16) lgkmcnt(8)
  v_mfma_f32_16x16x32_bf16 v[128:131], v[176:179], v[56:59], v[128:131]
  ds_read_b64_tr_b16 v[208:209], v6 offset:61440
  buffer_load_dwordx4 v[32:35], v4, s[36:39], s50 offen offset:0
  v_mfma_f32_16x16x32_bf16 v[132:135], v[176:179], v[60:63], v[132:135]
  ds_read_b64_tr_b16 v[210:211], v6 offset:61952
  v_mfma_f32_16x16x32_bf16 v[136:139], v[180:183], v[56:59], v[136:139]
  ds_read_b64_tr_b16 v[212:213], v7 offset:61440
  v_mfma_f32_16x16x32_bf16 v[140:143], v[180:183], v[60:63], v[140:143]
  ds_read_b64_tr_b16 v[214:215], v7 offset:61952
  v_mfma_f32_16x16x32_bf16 v[144:147], v[184:187], v[56:59], v[144:147]
  ds_read_b64_tr_b16 v[216:217], v8 offset:61440
  v_mfma_f32_16x16x32_bf16 v[148:151], v[184:187], v[60:63], v[148:151]
  ds_read_b64_tr_b16 v[218:219], v8 offset:61952
  v_mfma_f32_16x16x32_bf16 v[152:155], v[188:191], v[56:59], v[152:155]
  ds_read_b64_tr_b16 v[220:221], v9 offset:61440
  v_mfma_f32_16x16x32_bf16 v[156:159], v[188:191], v[60:63], v[156:159]
  ds_read_b64_tr_b16 v[222:223], v9 offset:61952
  s_waitcnt lgkmcnt(8)
  v_mfma_f32_16x16x32_bf16 v[96:99], v[192:195], v[48:51], v[96:99]
  ds_read_b64_tr_b16 v[160:161], v20 offset:0
  buffer_load_dwordx4 v[36:39], v5, s[36:39], s50 offen offset:0
  v_mfma_f32_16x16x32_bf16 v[100:103], v[192:195], v[52:55], v[100:103]
  ds_read_b64_tr_b16 v[162:163], v20 offset:512
  v_mfma_f32_16x16x32_bf16 v[104:107], v[196:199], v[48:51], v[104:107]
  ds_read_b64_tr_b16 v[164:165], v21 offset:0
  v_mfma_f32_16x16x32_bf16 v[108:111], v[196:199], v[52:55], v[108:111]
  ds_read_b64_tr_b16 v[166:167], v21 offset:512
  v_mfma_f32_16x16x32_bf16 v[112:115], v[200:203], v[48:51], v[112:115]
  ds_read_b64_tr_b16 v[168:169], v22 offset:0
  v_mfma_f32_16x16x32_bf16 v[116:119], v[200:203], v[52:55], v[116:119]
  ds_read_b64_tr_b16 v[170:171], v22 offset:512
  v_mfma_f32_16x16x32_bf16 v[120:123], v[204:207], v[48:51], v[120:123]
  ds_read_b64_tr_b16 v[172:173], v23 offset:0
  v_mfma_f32_16x16x32_bf16 v[124:127], v[204:207], v[52:55], v[124:127]
  ds_read_b64_tr_b16 v[174:175], v23 offset:512
  s_waitcnt lgkmcnt(8)
  s_barrier
  v_mfma_f32_16x16x32_bf16 v[96:99], v[208:211], v[56:59], v[96:99]
  ds_read_b64_tr_b16 v[176:177], v20 offset:4096
  buffer_load_dwordx4 v[40:43], v4, s[36:39], s50 offen offset:1024
  v_mfma_f32_16x16x32_bf16 v[100:103], v[208:211], v[60:63], v[100:103]
  ds_read_b64_tr_b16 v[178:179], v20 offset:4608
  v_mfma_f32_16x16x32_bf16 v[104:107], v[212:215], v[56:59], v[104:107]
  ds_read_b64_tr_b16 v[180:181], v21 offset:4096
  v_mfma_f32_16x16x32_bf16 v[108:111], v[212:215], v[60:63], v[108:111]
  ds_read_b64_tr_b16 v[182:183], v21 offset:4608
  v_mfma_f32_16x16x32_bf16 v[112:115], v[216:219], v[56:59], v[112:115]
  ds_read_b64_tr_b16 v[184:185], v22 offset:4096
  v_mfma_f32_16x16x32_bf16 v[116:119], v[216:219], v[60:63], v[116:119]
  ds_read_b64_tr_b16 v[186:187], v22 offset:4608
  v_mfma_f32_16x16x32_bf16 v[120:123], v[220:223], v[56:59], v[120:123]
  ds_read_b64_tr_b16 v[188:189], v23 offset:4096
  v_mfma_f32_16x16x32_bf16 v[124:127], v[220:223], v[60:63], v[124:127]
  ds_read_b64_tr_b16 v[190:191], v23 offset:4608
  s_waitcnt vmcnt(17) lgkmcnt(8)
  v_mfma_f32_16x16x32_bf16 v[128:131], v[160:163], v[64:67], v[128:131]
  ds_read_b64_tr_b16 v[192:193], v20 offset:8192
  buffer_load_dwordx4 v[44:47], v5, s[36:39], s50 offen offset:1024
  v_mfma_f32_16x16x32_bf16 v[132:135], v[160:163], v[68:71], v[132:135]
  ds_read_b64_tr_b16 v[194:195], v20 offset:8704
  v_mfma_f32_16x16x32_bf16 v[136:139], v[164:167], v[64:67], v[136:139]
  ds_read_b64_tr_b16 v[196:197], v21 offset:8192
  v_mfma_f32_16x16x32_bf16 v[140:143], v[164:167], v[68:71], v[140:143]
  ds_read_b64_tr_b16 v[198:199], v21 offset:8704
  v_mfma_f32_16x16x32_bf16 v[144:147], v[168:171], v[64:67], v[144:147]
  ds_read_b64_tr_b16 v[200:201], v22 offset:8192
  v_mfma_f32_16x16x32_bf16 v[148:151], v[168:171], v[68:71], v[148:151]
  ds_read_b64_tr_b16 v[202:203], v22 offset:8704
  v_readlane_b32 s51, v15, 19
  v_mfma_f32_16x16x32_bf16 v[152:155], v[172:175], v[64:67], v[152:155]
  ds_read_b64_tr_b16 v[204:205], v23 offset:8192
  v_mfma_f32_16x16x32_bf16 v[156:159], v[172:175], v[68:71], v[156:159]
  ds_read_b64_tr_b16 v[206:207], v23 offset:8704
  s_waitcnt vmcnt(16) lgkmcnt(8)
  v_mfma_f32_16x16x32_bf16 v[128:131], v[176:179], v[72:75], v[128:131]
  ds_read_b64_tr_b16 v[208:209], v20 offset:12288
  buffer_load_dwordx4 v[48:51], v4, s[36:39], s51 offen offset:0
  v_mfma_f32_16x16x32_bf16 v[132:135], v[176:179], v[76:79], v[132:135]
  ds_read_b64_tr_b16 v[210:211], v20 offset:12800
  v_mfma_f32_16x16x32_bf16 v[136:139], v[180:183], v[72:75], v[136:139]
  ds_read_b64_tr_b16 v[212:213], v21 offset:12288
  v_mfma_f32_16x16x32_bf16 v[140:143], v[180:183], v[76:79], v[140:143]
  ds_read_b64_tr_b16 v[214:215], v21 offset:12800
  v_mfma_f32_16x16x32_bf16 v[144:147], v[184:187], v[72:75], v[144:147]
  ds_read_b64_tr_b16 v[216:217], v22 offset:12288
  v_mfma_f32_16x16x32_bf16 v[148:151], v[184:187], v[76:79], v[148:151]
  ds_read_b64_tr_b16 v[218:219], v22 offset:12800
  v_mfma_f32_16x16x32_bf16 v[152:155], v[188:191], v[72:75], v[152:155]
  ds_read_b64_tr_b16 v[220:221], v23 offset:12288
  v_mfma_f32_16x16x32_bf16 v[156:159], v[188:191], v[76:79], v[156:159]
  ds_read_b64_tr_b16 v[222:223], v23 offset:12800
  s_waitcnt lgkmcnt(8)
  v_mfma_f32_16x16x32_bf16 v[96:99], v[192:195], v[64:67], v[96:99]
  ds_read_b64_tr_b16 v[160:161], v20 offset:16384
  buffer_load_dwordx4 v[52:55], v5, s[36:39], s51 offen offset:0
  v_mfma_f32_16x16x32_bf16 v[100:103], v[192:195], v[68:71], v[100:103]
  ds_read_b64_tr_b16 v[162:163], v20 offset:16896
  v_mfma_f32_16x16x32_bf16 v[104:107], v[196:199], v[64:67], v[104:107]
  ds_read_b64_tr_b16 v[164:165], v21 offset:16384
  v_mfma_f32_16x16x32_bf16 v[108:111], v[196:199], v[68:71], v[108:111]
  ds_read_b64_tr_b16 v[166:167], v21 offset:16896
  v_mfma_f32_16x16x32_bf16 v[112:115], v[200:203], v[64:67], v[112:115]
  ds_read_b64_tr_b16 v[168:169], v22 offset:16384
  v_mfma_f32_16x16x32_bf16 v[116:119], v[200:203], v[68:71], v[116:119]
  ds_read_b64_tr_b16 v[170:171], v22 offset:16896
  v_mfma_f32_16x16x32_bf16 v[120:123], v[204:207], v[64:67], v[120:123]
  ds_read_b64_tr_b16 v[172:173], v23 offset:16384
  v_mfma_f32_16x16x32_bf16 v[124:127], v[204:207], v[68:71], v[124:127]
  ds_read_b64_tr_b16 v[174:175], v23 offset:16896
  s_waitcnt lgkmcnt(8)
  v_mfma_f32_16x16x32_bf16 v[96:99], v[208:211], v[72:75], v[96:99]
  ds_read_b64_tr_b16 v[176:177], v20 offset:20480
  buffer_load_dwordx4 v[56:59], v4, s[36:39], s51 offen offset:1024
  v_mfma_f32_16x16x32_bf16 v[100:103], v[208:211], v[76:79], v[100:103]
  ds_read_b64_tr_b16 v[178:179], v20 offset:20992
  v_mfma_f32_16x16x32_bf16 v[104:107], v[212:215], v[72:75], v[104:107]
  ds_read_b64_tr_b16 v[180:181], v21 offset:20480
  v_mfma_f32_16x16x32_bf16 v[108:111], v[212:215], v[76:79], v[108:111]
  ds_read_b64_tr_b16 v[182:183], v21 offset:20992
  v_mfma_f32_16x16x32_bf16 v[112:115], v[216:219], v[72:75], v[112:115]
  ds_read_b64_tr_b16 v[184:185], v22 offset:20480
  v_mfma_f32_16x16x32_bf16 v[116:119], v[216:219], v[76:79], v[116:119]
  ds_read_b64_tr_b16 v[186:187], v22 offset:20992
  v_mfma_f32_16x16x32_bf16 v[120:123], v[220:223], v[72:75], v[120:123]
  ds_read_b64_tr_b16 v[188:189], v23 offset:20480
  v_mfma_f32_16x16x32_bf16 v[124:127], v[220:223], v[76:79], v[124:127]
  ds_read_b64_tr_b16 v[190:191], v23 offset:20992
  s_waitcnt vmcnt(17) lgkmcnt(8)
  v_mfma_f32_16x16x32_bf16 v[128:131], v[160:163], v[80:83], v[128:131]
  ds_read_b64_tr_b16 v[192:193], v20 offset:24576
  buffer_load_dwordx4 v[60:63], v5, s[36:39], s51 offen offset:1024
  v_mfma_f32_16x16x32_bf16 v[132:135], v[160:163], v[84:87], v[132:135]
  ds_read_b64_tr_b16 v[194:195], v20 offset:25088
  v_mfma_f32_16x16x32_bf16 v[136:139], v[164:167], v[80:83], v[136:139]
  ds_read_b64_tr_b16 v[196:197], v21 offset:24576
  v_mfma_f32_16x16x32_bf16 v[140:143], v[164:167], v[84:87], v[140:143]
  ds_read_b64_tr_b16 v[198:199], v21 offset:25088
  v_mfma_f32_16x16x32_bf16 v[144:147], v[168:171], v[80:83], v[144:147]
  ds_read_b64_tr_b16 v[200:201], v22 offset:24576
  v_mfma_f32_16x16x32_bf16 v[148:151], v[168:171], v[84:87], v[148:151]
  ds_read_b64_tr_b16 v[202:203], v22 offset:25088
  v_readlane_b32 s48, v15, 20
  v_mfma_f32_16x16x32_bf16 v[152:155], v[172:175], v[80:83], v[152:155]
  ds_read_b64_tr_b16 v[204:205], v23 offset:24576
  v_mfma_f32_16x16x32_bf16 v[156:159], v[172:175], v[84:87], v[156:159]
  ds_read_b64_tr_b16 v[206:207], v23 offset:25088
  s_waitcnt vmcnt(16) lgkmcnt(8)
  v_mfma_f32_16x16x32_bf16 v[128:131], v[176:179], v[88:91], v[128:131]
  ds_read_b64_tr_b16 v[208:209], v20 offset:28672
  buffer_load_dwordx4 v[64:67], v4, s[36:39], s48 offen offset:0
  v_mfma_f32_16x16x32_bf16 v[132:135], v[176:179], v[92:95], v[132:135]
  ds_read_b64_tr_b16 v[210:211], v20 offset:29184
  v_mfma_f32_16x16x32_bf16 v[136:139], v[180:183], v[88:91], v[136:139]
  ds_read_b64_tr_b16 v[212:213], v21 offset:28672
  v_mfma_f32_16x16x32_bf16 v[140:143], v[180:183], v[92:95], v[140:143]
  ds_read_b64_tr_b16 v[214:215], v21 offset:29184
  v_mfma_f32_16x16x32_bf16 v[144:147], v[184:187], v[88:91], v[144:147]
  ds_read_b64_tr_b16 v[216:217], v22 offset:28672
  v_mfma_f32_16x16x32_bf16 v[148:151], v[184:187], v[92:95], v[148:151]
  ds_read_b64_tr_b16 v[218:219], v22 offset:29184
  v_mfma_f32_16x16x32_bf16 v[152:155], v[188:191], v[88:91], v[152:155]
  ds_read_b64_tr_b16 v[220:221], v23 offset:28672
  v_mfma_f32_16x16x32_bf16 v[156:159], v[188:191], v[92:95], v[156:159]
  ds_read_b64_tr_b16 v[222:223], v23 offset:29184
  s_waitcnt lgkmcnt(8)
  v_mfma_f32_16x16x32_bf16 v[96:99], v[192:195], v[80:83], v[96:99]
  ds_read_b64_tr_b16 v[160:161], v20 offset:32768
  buffer_load_dwordx4 v[68:71], v5, s[36:39], s48 offen offset:0
  v_mfma_f32_16x16x32_bf16 v[100:103], v[192:195], v[84:87], v[100:103]
  ds_read_b64_tr_b16 v[162:163], v20 offset:33280
  v_mfma_f32_16x16x32_bf16 v[104:107], v[196:199], v[80:83], v[104:107]
  ds_read_b64_tr_b16 v[164:165], v21 offset:32768
  v_mfma_f32_16x16x32_bf16 v[108:111], v[196:199], v[84:87], v[108:111]
  ds_read_b64_tr_b16 v[166:167], v21 offset:33280
  v_mfma_f32_16x16x32_bf16 v[112:115], v[200:203], v[80:83], v[112:115]
  ds_read_b64_tr_b16 v[168:169], v22 offset:32768
  v_mfma_f32_16x16x32_bf16 v[116:119], v[200:203], v[84:87], v[116:119]
  ds_read_b64_tr_b16 v[170:171], v22 offset:33280
  v_mfma_f32_16x16x32_bf16 v[120:123], v[204:207], v[80:83], v[120:123]
  ds_read_b64_tr_b16 v[172:173], v23 offset:32768
  v_mfma_f32_16x16x32_bf16 v[124:127], v[204:207], v[84:87], v[124:127]
  ds_read_b64_tr_b16 v[174:175], v23 offset:33280
  s_waitcnt lgkmcnt(8)
  s_barrier
  v_mfma_f32_16x16x32_bf16 v[96:99], v[208:211], v[88:91], v[96:99]
  ds_read_b64_tr_b16 v[176:177], v20 offset:36864
  buffer_load_dwordx4 v[72:75], v4, s[36:39], s48 offen offset:1024
  v_mfma_f32_16x16x32_bf16 v[100:103], v[208:211], v[92:95], v[100:103]
  ds_read_b64_tr_b16 v[178:179], v20 offset:37376
  v_mfma_f32_16x16x32_bf16 v[104:107], v[212:215], v[88:91], v[104:107]
  ds_read_b64_tr_b16 v[180:181], v21 offset:36864
  v_mfma_f32_16x16x32_bf16 v[108:111], v[212:215], v[92:95], v[108:111]
  ds_read_b64_tr_b16 v[182:183], v21 offset:37376
  v_mfma_f32_16x16x32_bf16 v[112:115], v[216:219], v[88:91], v[112:115]
  ds_read_b64_tr_b16 v[184:185], v22 offset:36864
  v_mfma_f32_16x16x32_bf16 v[116:119], v[216:219], v[92:95], v[116:119]
  ds_read_b64_tr_b16 v[186:187], v22 offset:37376
  v_mfma_f32_16x16x32_bf16 v[120:123], v[220:223], v[88:91], v[120:123]
  ds_read_b64_tr_b16 v[188:189], v23 offset:36864
  v_mfma_f32_16x16x32_bf16 v[124:127], v[220:223], v[92:95], v[124:127]
  ds_read_b64_tr_b16 v[190:191], v23 offset:37376
  s_waitcnt vmcnt(17) lgkmcnt(8)
  v_mfma_f32_16x16x32_bf16 v[128:131], v[160:163], v[224:227], v[128:131]
  ds_read_b64_tr_b16 v[192:193], v20 offset:40960
  buffer_load_dwordx4 v[76:79], v5, s[36:39], s48 offen offset:1024
  v_mfma_f32_16x16x32_bf16 v[132:135], v[160:163], v[228:231], v[132:135]
  ds_read_b64_tr_b16 v[194:195], v20 offset:41472
  v_mfma_f32_16x16x32_bf16 v[136:139], v[164:167], v[224:227], v[136:139]
  ds_read_b64_tr_b16 v[196:197], v21 offset:40960
  v_mfma_f32_16x16x32_bf16 v[140:143], v[164:167], v[228:231], v[140:143]
  ds_read_b64_tr_b16 v[198:199], v21 offset:41472
  v_mfma_f32_16x16x32_bf16 v[144:147], v[168:171], v[224:227], v[144:147]
  ds_read_b64_tr_b16 v[200:201], v22 offset:40960
  v_mfma_f32_16x16x32_bf16 v[148:151], v[168:171], v[228:231], v[148:151]
  ds_read_b64_tr_b16 v[202:203], v22 offset:41472
  v_readlane_b32 s49, v15, 21
  v_mfma_f32_16x16x32_bf16 v[152:155], v[172:175], v[224:227], v[152:155]
  ds_read_b64_tr_b16 v[204:205], v23 offset:40960
  v_mfma_f32_16x16x32_bf16 v[156:159], v[172:175], v[228:231], v[156:159]
  ds_read_b64_tr_b16 v[206:207], v23 offset:41472
  s_waitcnt vmcnt(16) lgkmcnt(8)
  v_mfma_f32_16x16x32_bf16 v[128:131], v[176:179], v[232:235], v[128:131]
  ds_read_b64_tr_b16 v[208:209], v20 offset:45056
  buffer_load_dwordx4 v[80:83], v4, s[36:39], s49 offen offset:0
  v_mfma_f32_16x16x32_bf16 v[132:135], v[176:179], v[236:239], v[132:135]
  ds_read_b64_tr_b16 v[210:211], v20 offset:45568
  v_mfma_f32_16x16x32_bf16 v[136:139], v[180:183], v[232:235], v[136:139]
  ds_read_b64_tr_b16 v[212:213], v21 offset:45056
  v_mfma_f32_16x16x32_bf16 v[140:143], v[180:183], v[236:239], v[140:143]
  ds_read_b64_tr_b16 v[214:215], v21 offset:45568
  v_mfma_f32_16x16x32_bf16 v[144:147], v[184:187], v[232:235], v[144:147]
  ds_read_b64_tr_b16 v[216:217], v22 offset:45056
  v_mfma_f32_16x16x32_bf16 v[148:151], v[184:187], v[236:239], v[148:151]
  ds_read_b64_tr_b16 v[218:219], v22 offset:45568
  v_mfma_f32_16x16x32_bf16 v[152:155], v[188:191], v[232:235], v[152:155]
  ds_read_b64_tr_b16 v[220:221], v23 offset:45056
  v_mfma_f32_16x16x32_bf16 v[156:159], v[188:191], v[236:239], v[156:159]
  ds_read_b64_tr_b16 v[222:223], v23 offset:45568
  s_waitcnt lgkmcnt(8)
  v_mfma_f32_16x16x32_bf16 v[96:99], v[192:195], v[224:227], v[96:99]
  ds_read_b64_tr_b16 v[160:161], v20 offset:49152
  buffer_load_dwordx4 v[84:87], v5, s[36:39], s49 offen offset:0
  v_mfma_f32_16x16x32_bf16 v[100:103], v[192:195], v[228:231], v[100:103]
  ds_read_b64_tr_b16 v[162:163], v20 offset:49664
  v_mfma_f32_16x16x32_bf16 v[104:107], v[196:199], v[224:227], v[104:107]
  ds_read_b64_tr_b16 v[164:165], v21 offset:49152
  v_mfma_f32_16x16x32_bf16 v[108:111], v[196:199], v[228:231], v[108:111]
  ds_read_b64_tr_b16 v[166:167], v21 offset:49664
  v_mfma_f32_16x16x32_bf16 v[112:115], v[200:203], v[224:227], v[112:115]
  ds_read_b64_tr_b16 v[168:169], v22 offset:49152
  v_mfma_f32_16x16x32_bf16 v[116:119], v[200:203], v[228:231], v[116:119]
  ds_read_b64_tr_b16 v[170:171], v22 offset:49664
  v_mfma_f32_16x16x32_bf16 v[120:123], v[204:207], v[224:227], v[120:123]
  ds_read_b64_tr_b16 v[172:173], v23 offset:49152
  v_mfma_f32_16x16x32_bf16 v[124:127], v[204:207], v[228:231], v[124:127]
  ds_read_b64_tr_b16 v[174:175], v23 offset:49664
  s_waitcnt lgkmcnt(8)
  v_mfma_f32_16x16x32_bf16 v[96:99], v[208:211], v[232:235], v[96:99]
  ds_read_b64_tr_b16 v[176:177], v20 offset:53248
  buffer_load_dwordx4 v[88:91], v4, s[36:39], s49 offen offset:1024
  v_mfma_f32_16x16x32_bf16 v[100:103], v[208:211], v[236:239], v[100:103]
  ds_read_b64_tr_b16 v[178:179], v20 offset:53760
  v_mfma_f32_16x16x32_bf16 v[104:107], v[212:215], v[232:235], v[104:107]
  ds_read_b64_tr_b16 v[180:181], v21 offset:53248
  v_mfma_f32_16x16x32_bf16 v[108:111], v[212:215], v[236:239], v[108:111]
  ds_read_b64_tr_b16 v[182:183], v21 offset:53760
  v_mfma_f32_16x16x32_bf16 v[112:115], v[216:219], v[232:235], v[112:115]
  ds_read_b64_tr_b16 v[184:185], v22 offset:53248
  v_mfma_f32_16x16x32_bf16 v[116:119], v[216:219], v[236:239], v[116:119]
  ds_read_b64_tr_b16 v[186:187], v22 offset:53760
  v_mfma_f32_16x16x32_bf16 v[120:123], v[220:223], v[232:235], v[120:123]
  ds_read_b64_tr_b16 v[188:189], v23 offset:53248
  v_mfma_f32_16x16x32_bf16 v[124:127], v[220:223], v[236:239], v[124:127]
  ds_read_b64_tr_b16 v[190:191], v23 offset:53760
  s_waitcnt vmcnt(17) lgkmcnt(8)
  v_mfma_f32_16x16x32_bf16 v[128:131], v[160:163], v[240:243], v[128:131]
  ds_read_b64_tr_b16 v[192:193], v20 offset:57344
  buffer_load_dwordx4 v[92:95], v5, s[36:39], s49 offen offset:1024
  v_mfma_f32_16x16x32_bf16 v[132:135], v[160:163], v[244:247], v[132:135]
  ds_read_b64_tr_b16 v[194:195], v20 offset:57856
  v_mfma_f32_16x16x32_bf16 v[136:139], v[164:167], v[240:243], v[136:139]
  ds_read_b64_tr_b16 v[196:197], v21 offset:57344
  v_mfma_f32_16x16x32_bf16 v[140:143], v[164:167], v[244:247], v[140:143]
  ds_read_b64_tr_b16 v[198:199], v21 offset:57856
  v_mfma_f32_16x16x32_bf16 v[144:147], v[168:171], v[240:243], v[144:147]
  ds_read_b64_tr_b16 v[200:201], v22 offset:57344
  v_mfma_f32_16x16x32_bf16 v[148:151], v[168:171], v[244:247], v[148:151]
  ds_read_b64_tr_b16 v[202:203], v22 offset:57856
  v_readlane_b32 s50, v15, 22
  v_mfma_f32_16x16x32_bf16 v[152:155], v[172:175], v[240:243], v[152:155]
  ds_read_b64_tr_b16 v[204:205], v23 offset:57344
  v_mfma_f32_16x16x32_bf16 v[156:159], v[172:175], v[244:247], v[156:159]
  ds_read_b64_tr_b16 v[206:207], v23 offset:57856
  s_waitcnt vmcnt(16) lgkmcnt(8)
  v_mfma_f32_16x16x32_bf16 v[128:131], v[176:179], v[248:251], v[128:131]
  ds_read_b64_tr_b16 v[208:209], v20 offset:61440
  buffer_load_dwordx4 v[224:227], v4, s[36:39], s50 offen offset:0
  v_mfma_f32_16x16x32_bf16 v[132:135], v[176:179], v[252:255], v[132:135]
  ds_read_b64_tr_b16 v[210:211], v20 offset:61952
  v_mfma_f32_16x16x32_bf16 v[136:139], v[180:183], v[248:251], v[136:139]
  ds_read_b64_tr_b16 v[212:213], v21 offset:61440
  v_mfma_f32_16x16x32_bf16 v[140:143], v[180:183], v[252:255], v[140:143]
  ds_read_b64_tr_b16 v[214:215], v21 offset:61952
  v_mfma_f32_16x16x32_bf16 v[144:147], v[184:187], v[248:251], v[144:147]
  ds_read_b64_tr_b16 v[216:217], v22 offset:61440
  v_mfma_f32_16x16x32_bf16 v[148:151], v[184:187], v[252:255], v[148:151]
  ds_read_b64_tr_b16 v[218:219], v22 offset:61952
  v_mfma_f32_16x16x32_bf16 v[152:155], v[188:191], v[248:251], v[152:155]
  ds_read_b64_tr_b16 v[220:221], v23 offset:61440
  v_mfma_f32_16x16x32_bf16 v[156:159], v[188:191], v[252:255], v[156:159]
  ds_read_b64_tr_b16 v[222:223], v23 offset:61952
  s_waitcnt lgkmcnt(8)
  v_mfma_f32_16x16x32_bf16 v[96:99], v[192:195], v[240:243], v[96:99]
  ds_read_b64_tr_b16 v[160:161], v26 offset:0
  buffer_load_dwordx4 v[228:231], v5, s[36:39], s50 offen offset:0
  v_mfma_f32_16x16x32_bf16 v[100:103], v[192:195], v[244:247], v[100:103]
  ds_read_b64_tr_b16 v[162:163], v26 offset:512
  v_mfma_f32_16x16x32_bf16 v[104:107], v[196:199], v[240:243], v[104:107]
  ds_read_b64_tr_b16 v[164:165], v27 offset:0
  v_mfma_f32_16x16x32_bf16 v[108:111], v[196:199], v[244:247], v[108:111]
  ds_read_b64_tr_b16 v[166:167], v27 offset:512
  v_mfma_f32_16x16x32_bf16 v[112:115], v[200:203], v[240:243], v[112:115]
  ds_read_b64_tr_b16 v[168:169], v28 offset:0
  v_mfma_f32_16x16x32_bf16 v[116:119], v[200:203], v[244:247], v[116:119]
  ds_read_b64_tr_b16 v[170:171], v28 offset:512
  v_mfma_f32_16x16x32_bf16 v[120:123], v[204:207], v[240:243], v[120:123]
  ds_read_b64_tr_b16 v[172:173], v29 offset:0
  v_mfma_f32_16x16x32_bf16 v[124:127], v[204:207], v[244:247], v[124:127]
  ds_read_b64_tr_b16 v[174:175], v29 offset:512
  s_waitcnt lgkmcnt(8)
  s_barrier
  v_mfma_f32_16x16x32_bf16 v[96:99], v[208:211], v[248:251], v[96:99]
  ds_read_b64_tr_b16 v[176:177], v26 offset:4096
  buffer_load_dwordx4 v[232:235], v4, s[36:39], s50 offen offset:1024
  v_mfma_f32_16x16x32_bf16 v[100:103], v[208:211], v[252:255], v[100:103]
  ds_read_b64_tr_b16 v[178:179], v26 offset:4608
  v_mfma_f32_16x16x32_bf16 v[104:107], v[212:215], v[248:251], v[104:107]
  ds_read_b64_tr_b16 v[180:181], v27 offset:4096
  v_mfma_f32_16x16x32_bf16 v[108:111], v[212:215], v[252:255], v[108:111]
  ds_read_b64_tr_b16 v[182:183], v27 offset:4608
  v_mfma_f32_16x16x32_bf16 v[112:115], v[216:219], v[248:251], v[112:115]
  ds_read_b64_tr_b16 v[184:185], v28 offset:4096
  v_mfma_f32_16x16x32_bf16 v[116:119], v[216:219], v[252:255], v[116:119]
  ds_read_b64_tr_b16 v[186:187], v28 offset:4608
  v_mfma_f32_16x16x32_bf16 v[120:123], v[220:223], v[248:251], v[120:123]
  ds_read_b64_tr_b16 v[188:189], v29 offset:4096
  v_mfma_f32_16x16x32_bf16 v[124:127], v[220:223], v[252:255], v[124:127]
  ds_read_b64_tr_b16 v[190:191], v29 offset:4608
  s_waitcnt vmcnt(17) lgkmcnt(8)
  v_mfma_f32_16x16x32_bf16 v[128:131], v[160:163], v[32:35], v[128:131]
  ds_read_b64_tr_b16 v[192:193], v26 offset:8192
  buffer_load_dwordx4 v[236:239], v5, s[36:39], s50 offen offset:1024
  v_mfma_f32_16x16x32_bf16 v[132:135], v[160:163], v[36:39], v[132:135]
  ds_read_b64_tr_b16 v[194:195], v26 offset:8704
  v_mfma_f32_16x16x32_bf16 v[136:139], v[164:167], v[32:35], v[136:139]
  ds_read_b64_tr_b16 v[196:197], v27 offset:8192
  v_mfma_f32_16x16x32_bf16 v[140:143], v[164:167], v[36:39], v[140:143]
  ds_read_b64_tr_b16 v[198:199], v27 offset:8704
  v_mfma_f32_16x16x32_bf16 v[144:147], v[168:171], v[32:35], v[144:147]
  ds_read_b64_tr_b16 v[200:201], v28 offset:8192
  v_mfma_f32_16x16x32_bf16 v[148:151], v[168:171], v[36:39], v[148:151]
  ds_read_b64_tr_b16 v[202:203], v28 offset:8704
  v_readlane_b32 s51, v15, 23
  v_mfma_f32_16x16x32_bf16 v[152:155], v[172:175], v[32:35], v[152:155]
  ds_read_b64_tr_b16 v[204:205], v29 offset:8192
  v_mfma_f32_16x16x32_bf16 v[156:159], v[172:175], v[36:39], v[156:159]
  ds_read_b64_tr_b16 v[206:207], v29 offset:8704
  s_waitcnt vmcnt(16) lgkmcnt(8)
  v_mfma_f32_16x16x32_bf16 v[128:131], v[176:179], v[40:43], v[128:131]
  ds_read_b64_tr_b16 v[208:209], v26 offset:12288
  buffer_load_dwordx4 v[240:243], v4, s[36:39], s51 offen offset:0
  v_mfma_f32_16x16x32_bf16 v[132:135], v[176:179], v[44:47], v[132:135]
  ds_read_b64_tr_b16 v[210:211], v26 offset:12800
  v_mfma_f32_16x16x32_bf16 v[136:139], v[180:183], v[40:43], v[136:139]
  ds_read_b64_tr_b16 v[212:213], v27 offset:12288
  v_mfma_f32_16x16x32_bf16 v[140:143], v[180:183], v[44:47], v[140:143]
  ds_read_b64_tr_b16 v[214:215], v27 offset:12800
  v_mfma_f32_16x16x32_bf16 v[144:147], v[184:187], v[40:43], v[144:147]
  ds_read_b64_tr_b16 v[216:217], v28 offset:12288
  v_mfma_f32_16x16x32_bf16 v[148:151], v[184:187], v[44:47], v[148:151]
  ds_read_b64_tr_b16 v[218:219], v28 offset:12800
  v_mfma_f32_16x16x32_bf16 v[152:155], v[188:191], v[40:43], v[152:155]
  ds_read_b64_tr_b16 v[220:221], v29 offset:12288
  v_mfma_f32_16x16x32_bf16 v[156:159], v[188:191], v[44:47], v[156:159]
  ds_read_b64_tr_b16 v[222:223], v29 offset:12800
  s_waitcnt lgkmcnt(8)
  v_mfma_f32_16x16x32_bf16 v[96:99], v[192:195], v[32:35], v[96:99]
  ds_read_b64_tr_b16 v[160:161], v26 offset:16384
  buffer_load_dwordx4 v[244:247], v5, s[36:39], s51 offen offset:0
  v_mfma_f32_16x16x32_bf16 v[100:103], v[192:195], v[36:39], v[100:103]
  ds_read_b64_tr_b16 v[162:163], v26 offset:16896
  v_mfma_f32_16x16x32_bf16 v[104:107], v[196:199], v[32:35], v[104:107]
  ds_read_b64_tr_b16 v[164:165], v27 offset:16384
  v_mfma_f32_16x16x32_bf16 v[108:111], v[196:199], v[36:39], v[108:111]
  ds_read_b64_tr_b16 v[166:167], v27 offset:16896
  v_mfma_f32_16x16x32_bf16 v[112:115], v[200:203], v[32:35], v[112:115]
  ds_read_b64_tr_b16 v[168:169], v28 offset:16384
  v_mfma_f32_16x16x32_bf16 v[116:119], v[200:203], v[36:39], v[116:119]
  ds_read_b64_tr_b16 v[170:171], v28 offset:16896
  v_mfma_f32_16x16x32_bf16 v[120:123], v[204:207], v[32:35], v[120:123]
  ds_read_b64_tr_b16 v[172:173], v29 offset:16384
  v_mfma_f32_16x16x32_bf16 v[124:127], v[204:207], v[36:39], v[124:127]
  ds_read_b64_tr_b16 v[174:175], v29 offset:16896
  s_waitcnt lgkmcnt(8)
  v_mfma_f32_16x16x32_bf16 v[96:99], v[208:211], v[40:43], v[96:99]
  ds_read_b64_tr_b16 v[176:177], v26 offset:20480
  buffer_load_dwordx4 v[248:251], v4, s[36:39], s51 offen offset:1024
  v_mfma_f32_16x16x32_bf16 v[100:103], v[208:211], v[44:47], v[100:103]
  ds_read_b64_tr_b16 v[178:179], v26 offset:20992
  v_mfma_f32_16x16x32_bf16 v[104:107], v[212:215], v[40:43], v[104:107]
  ds_read_b64_tr_b16 v[180:181], v27 offset:20480
  v_mfma_f32_16x16x32_bf16 v[108:111], v[212:215], v[44:47], v[108:111]
  ds_read_b64_tr_b16 v[182:183], v27 offset:20992
  v_mfma_f32_16x16x32_bf16 v[112:115], v[216:219], v[40:43], v[112:115]
  ds_read_b64_tr_b16 v[184:185], v28 offset:20480
  v_mfma_f32_16x16x32_bf16 v[116:119], v[216:219], v[44:47], v[116:119]
  ds_read_b64_tr_b16 v[186:187], v28 offset:20992
  v_mfma_f32_16x16x32_bf16 v[120:123], v[220:223], v[40:43], v[120:123]
  ds_read_b64_tr_b16 v[188:189], v29 offset:20480
  v_mfma_f32_16x16x32_bf16 v[124:127], v[220:223], v[44:47], v[124:127]
  ds_read_b64_tr_b16 v[190:191], v29 offset:20992
  s_waitcnt vmcnt(17) lgkmcnt(8)
  v_mfma_f32_16x16x32_bf16 v[128:131], v[160:163], v[48:51], v[128:131]
  ds_read_b64_tr_b16 v[192:193], v26 offset:24576
  buffer_load_dwordx4 v[252:255], v5, s[36:39], s51 offen offset:1024
  v_mfma_f32_16x16x32_bf16 v[132:135], v[160:163], v[52:55], v[132:135]
  ds_read_b64_tr_b16 v[194:195], v26 offset:25088
  v_mfma_f32_16x16x32_bf16 v[136:139], v[164:167], v[48:51], v[136:139]
  ds_read_b64_tr_b16 v[196:197], v27 offset:24576
  v_mfma_f32_16x16x32_bf16 v[140:143], v[164:167], v[52:55], v[140:143]
  ds_read_b64_tr_b16 v[198:199], v27 offset:25088
  v_mfma_f32_16x16x32_bf16 v[144:147], v[168:171], v[48:51], v[144:147]
  ds_read_b64_tr_b16 v[200:201], v28 offset:24576
  v_mfma_f32_16x16x32_bf16 v[148:151], v[168:171], v[52:55], v[148:151]
  ds_read_b64_tr_b16 v[202:203], v28 offset:25088
  v_readlane_b32 s48, v15, 24
  v_mfma_f32_16x16x32_bf16 v[152:155], v[172:175], v[48:51], v[152:155]
  ds_read_b64_tr_b16 v[204:205], v29 offset:24576
  v_mfma_f32_16x16x32_bf16 v[156:159], v[172:175], v[52:55], v[156:159]
  ds_read_b64_tr_b16 v[206:207], v29 offset:25088
  s_waitcnt vmcnt(16) lgkmcnt(8)
  v_mfma_f32_16x16x32_bf16 v[128:131], v[176:179], v[56:59], v[128:131]
  ds_read_b64_tr_b16 v[208:209], v26 offset:28672
  buffer_load_dwordx4 v[32:35], v4, s[36:39], s48 offen offset:0
  v_mfma_f32_16x16x32_bf16 v[132:135], v[176:179], v[60:63], v[132:135]
  ds_read_b64_tr_b16 v[210:211], v26 offset:29184
  v_mfma_f32_16x16x32_bf16 v[136:139], v[180:183], v[56:59], v[136:139]
  ds_read_b64_tr_b16 v[212:213], v27 offset:28672
  v_mfma_f32_16x16x32_bf16 v[140:143], v[180:183], v[60:63], v[140:143]
  ds_read_b64_tr_b16 v[214:215], v27 offset:29184
  v_mfma_f32_16x16x32_bf16 v[144:147], v[184:187], v[56:59], v[144:147]
  ds_read_b64_tr_b16 v[216:217], v28 offset:28672
  v_mfma_f32_16x16x32_bf16 v[148:151], v[184:187], v[60:63], v[148:151]
  ds_read_b64_tr_b16 v[218:219], v28 offset:29184
  v_mfma_f32_16x16x32_bf16 v[152:155], v[188:191], v[56:59], v[152:155]
  ds_read_b64_tr_b16 v[220:221], v29 offset:28672
  v_mfma_f32_16x16x32_bf16 v[156:159], v[188:191], v[60:63], v[156:159]
  ds_read_b64_tr_b16 v[222:223], v29 offset:29184
  s_waitcnt lgkmcnt(8)
  v_mfma_f32_16x16x32_bf16 v[96:99], v[192:195], v[48:51], v[96:99]
  ds_read_b64_tr_b16 v[160:161], v6 offset:0
  buffer_load_dwordx4 v[36:39], v5, s[36:39], s48 offen offset:0
  v_mfma_f32_16x16x32_bf16 v[100:103], v[192:195], v[52:55], v[100:103]
  ds_read_b64_tr_b16 v[162:163], v6 offset:512
  v_mfma_f32_16x16x32_bf16 v[104:107], v[196:199], v[48:51], v[104:107]
  ds_read_b64_tr_b16 v[164:165], v7 offset:0
  v_cvt_pk_bf16_f32 v128, v128, v129
  v_mfma_f32_16x16x32_bf16 v[108:111], v[196:199], v[52:55], v[108:111]
  ds_read_b64_tr_b16 v[166:167], v7 offset:512
  v_cvt_pk_bf16_f32 v129, v130, v131
  v_mfma_f32_16x16x32_bf16 v[112:115], v[200:203], v[48:51], v[112:115]
  ds_read_b64_tr_b16 v[168:169], v8 offset:0
  v_cvt_pk_bf16_f32 v130, v132, v133
  v_mfma_f32_16x16x32_bf16 v[116:119], v[200:203], v[52:55], v[116:119]
  ds_read_b64_tr_b16 v[170:171], v8 offset:512
  v_cvt_pk_bf16_f32 v131, v134, v135
  v_mfma_f32_16x16x32_bf16 v[120:123], v[204:207], v[48:51], v[120:123]
  ds_read_b64_tr_b16 v[172:173], v9 offset:0
  v_cvt_pk_bf16_f32 v132, v136, v137
  v_mfma_f32_16x16x32_bf16 v[124:127], v[204:207], v[52:55], v[124:127]
  ds_read_b64_tr_b16 v[174:175], v9 offset:512
  s_waitcnt lgkmcnt(8)
  s_barrier
  v_mfma_f32_16x16x32_bf16 v[96:99], v[208:211], v[56:59], v[96:99]
  ds_read_b64_tr_b16 v[176:177], v6 offset:4096
  buffer_load_dwordx4 v[40:43], v4, s[36:39], s48 offen offset:1024
  v_mfma_f32_16x16x32_bf16 v[100:103], v[208:211], v[60:63], v[100:103]
  ds_read_b64_tr_b16 v[178:179], v6 offset:4608
  ds_write_b128 v19, v[128:131] offset:0
  v_mfma_f32_16x16x32_bf16 v[104:107], v[212:215], v[56:59], v[104:107]
  ds_read_b64_tr_b16 v[180:181], v7 offset:4096
  v_cvt_pk_bf16_f32 v133, v138, v139
  v_mfma_f32_16x16x32_bf16 v[108:111], v[212:215], v[60:63], v[108:111]
  ds_read_b64_tr_b16 v[182:183], v7 offset:4608
  v_cvt_pk_bf16_f32 v134, v140, v141
  v_mfma_f32_16x16x32_bf16 v[112:115], v[216:219], v[56:59], v[112:115]
  ds_read_b64_tr_b16 v[184:185], v8 offset:4096
  v_cvt_pk_bf16_f32 v135, v142, v143
  v_mfma_f32_16x16x32_bf16 v[116:119], v[216:219], v[60:63], v[116:119]
  ds_read_b64_tr_b16 v[186:187], v8 offset:4608
  ds_write_b128 v19, v[132:135] offset:1024
  v_mfma_f32_16x16x32_bf16 v[120:123], v[220:223], v[56:59], v[120:123]
  ds_read_b64_tr_b16 v[188:189], v9 offset:4096
  v_cvt_pk_bf16_f32 v136, v144, v145
  v_mfma_f32_16x16x32_bf16 v[124:127], v[220:223], v[60:63], v[124:127]
  ds_read_b64_tr_b16 v[190:191], v9 offset:4608
  s_waitcnt vmcnt(17) lgkmcnt(10)
  v_mfma_f32_16x16x32_bf16 v[96:99], v[160:163], v[64:67], v[96:99]
  ds_read_b64_tr_b16 v[192:193], v6 offset:8192
  buffer_load_dwordx4 v[44:47], v5, s[36:39], s48 offen offset:1024
  v_mfma_f32_16x16x32_bf16 v[100:103], v[160:163], v[68:71], v[100:103]
  ds_read_b64_tr_b16 v[194:195], v6 offset:8704
  v_cvt_pk_bf16_f32 v137, v146, v147
  v_mfma_f32_16x16x32_bf16 v[104:107], v[164:167], v[64:67], v[104:107]
  ds_read_b64_tr_b16 v[196:197], v7 offset:8192
  v_cvt_pk_bf16_f32 v138, v148, v149
  v_mfma_f32_16x16x32_bf16 v[108:111], v[164:167], v[68:71], v[108:111]
  ds_read_b64_tr_b16 v[198:199], v7 offset:8704
  v_cvt_pk_bf16_f32 v139, v150, v151
  v_mfma_f32_16x16x32_bf16 v[112:115], v[168:171], v[64:67], v[112:115]
  ds_read_b64_tr_b16 v[200:201], v8 offset:8192
  ds_write_b128 v19, v[136:139] offset:2048
  v_mfma_f32_16x16x32_bf16 v[116:119], v[168:171], v[68:71], v[116:119]
  ds_read_b64_tr_b16 v[202:203], v8 offset:8704
  v_readlane_b32 s49, v15, 25
  v_mfma_f32_16x16x32_bf16 v[120:123], v[172:175], v[64:67], v[120:123]
  ds_read_b64_tr_b16 v[204:205], v9 offset:8192
  v_cvt_pk_bf16_f32 v140, v152, v153
  v_mfma_f32_16x16x32_bf16 v[124:127], v[172:175], v[68:71], v[124:127]
  ds_read_b64_tr_b16 v[206:207], v9 offset:8704
  s_waitcnt vmcnt(16) lgkmcnt(9)
  v_mfma_f32_16x16x32_bf16 v[96:99], v[176:179], v[72:75], v[96:99]
  ds_read_b64_tr_b16 v[208:209], v6 offset:12288
  buffer_load_dwordx4 v[48:51], v4, s[36:39], s49 offen offset:0
  v_mfma_f32_16x16x32_bf16 v[100:103], v[176:179], v[76:79], v[100:103]
  ds_read_b64_tr_b16 v[210:211], v6 offset:12800
  v_cvt_pk_bf16_f32 v141, v154, v155
  v_mfma_f32_16x16x32_bf16 v[104:107], v[180:183], v[72:75], v[104:107]
  ds_read_b64_tr_b16 v[212:213], v7 offset:12288
  v_cvt_pk_bf16_f32 v142, v156, v157
  v_mfma_f32_16x16x32_bf16 v[108:111], v[180:183], v[76:79], v[108:111]
  ds_read_b64_tr_b16 v[214:215], v7 offset:12800
  buffer_load_dwordx4 v[52:55], v5, s[36:39], s49 offen offset:0
  v_mfma_f32_16x16x32_bf16 v[112:115], v[184:187], v[72:75], v[112:115]
  ds_read_b64_tr_b16 v[216:217], v8 offset:12288
  v_cvt_pk_bf16_f32 v143, v158, v159
  v_mfma_f32_16x16x32_bf16 v[116:119], v[184:187], v[76:79], v[116:119]
  ds_read_b64_tr_b16 v[218:219], v8 offset:12800
  ds_write_b128 v19, v[140:143] offset:3072
  v_mfma_f32_16x16x32_bf16 v[120:123], v[188:191], v[72:75], v[120:123]
  ds_read_b64_tr_b16 v[220:221], v9 offset:12288
  buffer_load_dwordx4 v[56:59], v4, s[36:39], s49 offen offset:1024
  v_mfma_f32_16x16x32_bf16 v[124:127], v[188:191], v[76:79], v[124:127]
  ds_read_b64_tr_b16 v[222:223], v9 offset:12800
  s_waitcnt vmcnt(17) lgkmcnt(9)
  v_mfma_f32_16x16x32_bf16 v[96:99], v[192:195], v[80:83], v[96:99]
  ds_read_b64_tr_b16 v[160:161], v6 offset:16384
  v_mfma_f32_16x16x32_bf16 v[100:103], v[192:195], v[84:87], v[100:103]
  ds_read_b64_tr_b16 v[162:163], v6 offset:16896
  buffer_load_dwordx4 v[60:63], v5, s[36:39], s49 offen offset:1024
  v_mfma_f32_16x16x32_bf16 v[104:107], v[196:199], v[80:83], v[104:107]
  ds_read_b64_tr_b16 v[164:165], v7 offset:16384
  v_readlane_b32 s50, v15, 26
  v_mfma_f32_16x16x32_bf16 v[108:111], v[196:199], v[84:87], v[108:111]
  ds_read_b64_tr_b16 v[166:167], v7 offset:16896
  v_mfma_f32_16x16x32_bf16 v[112:115], v[200:203], v[80:83], v[112:115]
  ds_read_b64_tr_b16 v[168:169], v8 offset:16384
  v_mfma_f32_16x16x32_bf16 v[116:119], v[200:203], v[84:87], v[116:119]
  ds_read_b64_tr_b16 v[170:171], v8 offset:16896
  buffer_load_dwordx4 v[64:67], v4, s[36:39], s50 offen offset:0
  v_mfma_f32_16x16x32_bf16 v[120:123], v[204:207], v[80:83], v[120:123]
  ds_read_b64_tr_b16 v[172:173], v9 offset:16384
  v_mfma_f32_16x16x32_bf16 v[124:127], v[204:207], v[84:87], v[124:127]
  ds_read_b64_tr_b16 v[174:175], v9 offset:16896
  s_waitcnt vmcnt(17) lgkmcnt(8)
  s_barrier
  v_mfma_f32_16x16x32_bf16 v[96:99], v[208:211], v[88:91], v[96:99]
  ds_read_b64_tr_b16 v[176:177], v6 offset:20480
  buffer_load_dwordx4 v[68:71], v5, s[36:39], s50 offen offset:0
  v_mfma_f32_16x16x32_bf16 v[100:103], v[208:211], v[92:95], v[100:103]
  ds_read_b64_tr_b16 v[178:179], v6 offset:20992
  v_mfma_f32_16x16x32_bf16 v[104:107], v[212:215], v[88:91], v[104:107]
  ds_read_b64_tr_b16 v[180:181], v7 offset:20480
  v_mfma_f32_16x16x32_bf16 v[108:111], v[212:215], v[92:95], v[108:111]
  ds_read_b64_tr_b16 v[182:183], v7 offset:20992
  buffer_load_dwordx4 v[72:75], v4, s[36:39], s50 offen offset:1024
  v_mfma_f32_16x16x32_bf16 v[112:115], v[216:219], v[88:91], v[112:115]
  ds_read_b64_tr_b16 v[184:185], v8 offset:20480
  v_mfma_f32_16x16x32_bf16 v[116:119], v[216:219], v[92:95], v[116:119]
  ds_read_b64_tr_b16 v[186:187], v8 offset:20992
  v_mfma_f32_16x16x32_bf16 v[120:123], v[220:223], v[88:91], v[120:123]
  ds_read_b64_tr_b16 v[188:189], v9 offset:20480
  buffer_load_dwordx4 v[76:79], v5, s[36:39], s50 offen offset:1024
  v_mfma_f32_16x16x32_bf16 v[124:127], v[220:223], v[92:95], v[124:127]
  ds_read_b64_tr_b16 v[190:191], v9 offset:20992
  s_waitcnt vmcnt(18) lgkmcnt(8)
  v_mfma_f32_16x16x32_bf16 v[96:99], v[160:163], v[224:227], v[96:99]
  ds_read_b64_tr_b16 v[192:193], v6 offset:24576
  v_readlane_b32 s51, v15, 27
  v_mfma_f32_16x16x32_bf16 v[100:103], v[160:163], v[228:231], v[100:103]
  ds_read_b64_tr_b16 v[194:195], v6 offset:25088
  v_mfma_f32_16x16x32_bf16 v[104:107], v[164:167], v[224:227], v[104:107]
  ds_read_b64_tr_b16 v[196:197], v7 offset:24576
  v_mfma_f32_16x16x32_bf16 v[108:111], v[164:167], v[228:231], v[108:111]
  ds_read_b64_tr_b16 v[198:199], v7 offset:25088
  buffer_load_dwordx4 v[80:83], v4, s[36:39], s51 offen offset:0
  v_mfma_f32_16x16x32_bf16 v[112:115], v[168:171], v[224:227], v[112:115]
  ds_read_b64_tr_b16 v[200:201], v8 offset:24576
  v_mfma_f32_16x16x32_bf16 v[116:119], v[168:171], v[228:231], v[116:119]
  ds_read_b64_tr_b16 v[202:203], v8 offset:25088
  v_mfma_f32_16x16x32_bf16 v[120:123], v[172:175], v[224:227], v[120:123]
  ds_read_b64_tr_b16 v[204:205], v9 offset:24576
  buffer_load_dwordx4 v[84:87], v5, s[36:39], s51 offen offset:0
  v_mfma_f32_16x16x32_bf16 v[124:127], v[172:175], v[228:231], v[124:127]
  ds_read_b64_tr_b16 v[206:207], v9 offset:25088
  s_waitcnt vmcnt(18) lgkmcnt(8)
  v_mfma_f32_16x16x32_bf16 v[96:99], v[176:179], v[232:235], v[96:99]
  ds_read_b64_tr_b16 v[208:209], v6 offset:28672
  v_mfma_f32_16x16x32_bf16 v[100:103], v[176:179], v[236:239], v[100:103]
  ds_read_b64_tr_b16 v[210:211], v6 offset:29184
  buffer_load_dwordx4 v[88:91], v4, s[36:39], s51 offen offset:1024
  v_mfma_f32_16x16x32_bf16 v[104:107], v[180:183], v[232:235], v[104:107]
  ds_read_b64_tr_b16 v[212:213], v7 offset:28672
  v_mfma_f32_16x16x32_bf16 v[108:111], v[180:183], v[236:239], v[108:111]
  ds_read_b64_tr_b16 v[214:215], v7 offset:29184
  v_mfma_f32_16x16x32_bf16 v[112:115], v[184:187], v[232:235], v[112:115]
  ds_read_b64_tr_b16 v[216:217], v8 offset:28672
  buffer_load_dwordx4 v[92:95], v5, s[36:39], s51 offen offset:1024
  v_mfma_f32_16x16x32_bf16 v[116:119], v[184:187], v[236:239], v[116:119]
  ds_read_b64_tr_b16 v[218:219], v8 offset:29184
  v_readlane_b32 s48, v15, 28
  v_mfma_f32_16x16x32_bf16 v[120:123], v[188:191], v[232:235], v[120:123]
  ds_read_b64_tr_b16 v[220:221], v9 offset:28672
  v_mfma_f32_16x16x32_bf16 v[124:127], v[188:191], v[236:239], v[124:127]
  ds_read_b64_tr_b16 v[222:223], v9 offset:29184
  s_waitcnt vmcnt(18) lgkmcnt(8)
  v_mfma_f32_16x16x32_bf16 v[96:99], v[192:195], v[240:243], v[96:99]
  ds_read_b64_tr_b16 v[160:161], v6 offset:32768
  buffer_load_dwordx4 v[224:227], v4, s[36:39], s48 offen offset:0
  v_mfma_f32_16x16x32_bf16 v[100:103], v[192:195], v[244:247], v[100:103]
  ds_read_b64_tr_b16 v[162:163], v6 offset:33280
  v_mfma_f32_16x16x32_bf16 v[104:107], v[196:199], v[240:243], v[104:107]
  ds_read_b64_tr_b16 v[164:165], v7 offset:32768
  v_mfma_f32_16x16x32_bf16 v[108:111], v[196:199], v[244:247], v[108:111]
  ds_read_b64_tr_b16 v[166:167], v7 offset:33280
  buffer_load_dwordx4 v[228:231], v5, s[36:39], s48 offen offset:0
  v_mfma_f32_16x16x32_bf16 v[112:115], v[200:203], v[240:243], v[112:115]
  ds_read_b64_tr_b16 v[168:169], v8 offset:32768
  v_mfma_f32_16x16x32_bf16 v[116:119], v[200:203], v[244:247], v[116:119]
  ds_read_b64_tr_b16 v[170:171], v8 offset:33280
  v_mfma_f32_16x16x32_bf16 v[120:123], v[204:207], v[240:243], v[120:123]
  ds_read_b64_tr_b16 v[172:173], v9 offset:32768
  buffer_load_dwordx4 v[232:235], v4, s[36:39], s48 offen offset:1024
  v_mfma_f32_16x16x32_bf16 v[124:127], v[204:207], v[244:247], v[124:127]
  ds_read_b64_tr_b16 v[174:175], v9 offset:33280
  s_waitcnt vmcnt(19) lgkmcnt(8)
  v_mfma_f32_16x16x32_bf16 v[96:99], v[208:211], v[248:251], v[96:99]
  ds_read_b64_tr_b16 v[176:177], v6 offset:36864
  v_mfma_f32_16x16x32_bf16 v[100:103], v[208:211], v[252:255], v[100:103]
  ds_read_b64_tr_b16 v[178:179], v6 offset:37376
  buffer_load_dwordx4 v[236:239], v5, s[36:39], s48 offen offset:1024
  v_mfma_f32_16x16x32_bf16 v[104:107], v[212:215], v[248:251], v[104:107]
  ds_read_b64_tr_b16 v[180:181], v7 offset:36864
  v_mfma_f32_16x16x32_bf16 v[108:111], v[212:215], v[252:255], v[108:111]
  ds_read_b64_tr_b16 v[182:183], v7 offset:37376
  v_mfma_f32_16x16x32_bf16 v[112:115], v[216:219], v[248:251], v[112:115]
  ds_read_b64_tr_b16 v[184:185], v8 offset:36864
  v_mfma_f32_16x16x32_bf16 v[116:119], v[216:219], v[252:255], v[116:119]
  ds_read_b64_tr_b16 v[186:187], v8 offset:37376
  v_readlane_b32 s49, v15, 29
  v_mfma_f32_16x16x32_bf16 v[120:123], v[220:223], v[248:251], v[120:123]
  ds_read_b64_tr_b16 v[188:189], v9 offset:36864
  v_mfma_f32_16x16x32_bf16 v[124:127], v[220:223], v[252:255], v[124:127]
  ds_read_b64_tr_b16 v[190:191], v9 offset:37376
  s_waitcnt vmcnt(18) lgkmcnt(8)
  v_mfma_f32_16x16x32_bf16 v[96:99], v[160:163], v[32:35], v[96:99]
  ds_read_b64_tr_b16 v[192:193], v6 offset:40960
  buffer_load_dwordx4 v[240:243], v4, s[36:39], s49 offen offset:0
  v_mfma_f32_16x16x32_bf16 v[100:103], v[160:163], v[36:39], v[100:103]
  ds_read_b64_tr_b16 v[194:195], v6 offset:41472
  v_mfma_f32_16x16x32_bf16 v[104:107], v[164:167], v[32:35], v[104:107]
  ds_read_b64_tr_b16 v[196:197], v7 offset:40960
  v_mfma_f32_16x16x32_bf16 v[108:111], v[164:167], v[36:39], v[108:111]
  ds_read_b64_tr_b16 v[198:199], v7 offset:41472
  buffer_load_dwordx4 v[244:247], v5, s[36:39], s49 offen offset:0
  v_mfma_f32_16x16x32_bf16 v[112:115], v[168:171], v[32:35], v[112:115]
  ds_read_b64_tr_b16 v[200:201], v8 offset:40960
  v_mfma_f32_16x16x32_bf16 v[116:119], v[168:171], v[36:39], v[116:119]
  ds_read_b64_tr_b16 v[202:203], v8 offset:41472
  v_mfma_f32_16x16x32_bf16 v[120:123], v[172:175], v[32:35], v[120:123]
  ds_read_b64_tr_b16 v[204:205], v9 offset:40960
  buffer_load_dwordx4 v[248:251], v4, s[36:39], s49 offen offset:1024
  v_mfma_f32_16x16x32_bf16 v[124:127], v[172:175], v[36:39], v[124:127]
  ds_read_b64_tr_b16 v[206:207], v9 offset:41472
  s_waitcnt vmcnt(19) lgkmcnt(8)
  v_mfma_f32_16x16x32_bf16 v[96:99], v[176:179], v[40:43], v[96:99]
  ds_read_b64_tr_b16 v[208:209], v6 offset:45056
  v_mfma_f32_16x16x32_bf16 v[100:103], v[176:179], v[44:47], v[100:103]
  ds_read_b64_tr_b16 v[210:211], v6 offset:45568
  buffer_load_dwordx4 v[252:255], v5, s[36:39], s49 offen offset:1024
  v_mfma_f32_16x16x32_bf16 v[104:107], v[180:183], v[40:43], v[104:107]
  ds_read_b64_tr_b16 v[212:213], v7 offset:45056
  v_mfma_f32_16x16x32_bf16 v[108:111], v[180:183], v[44:47], v[108:111]
  ds_read_b64_tr_b16 v[214:215], v7 offset:45568
  v_mfma_f32_16x16x32_bf16 v[112:115], v[184:187], v[40:43], v[112:115]
  ds_read_b64_tr_b16 v[216:217], v8 offset:45056
  v_mfma_f32_16x16x32_bf16 v[116:119], v[184:187], v[44:47], v[116:119]
  ds_read_b64_tr_b16 v[218:219], v8 offset:45568
  v_readlane_b32 s50, v15, 30
  v_mfma_f32_16x16x32_bf16 v[120:123], v[188:191], v[40:43], v[120:123]
  ds_read_b64_tr_b16 v[220:221], v9 offset:45056
  v_mfma_f32_16x16x32_bf16 v[124:127], v[188:191], v[44:47], v[124:127]
  ds_read_b64_tr_b16 v[222:223], v9 offset:45568
  s_waitcnt vmcnt(18) lgkmcnt(8)
  v_mfma_f32_16x16x32_bf16 v[96:99], v[192:195], v[48:51], v[96:99]
  ds_read_b64_tr_b16 v[160:161], v6 offset:49152
  buffer_load_dwordx4 v[32:35], v4, s[36:39], s50 offen offset:0
  v_mfma_f32_16x16x32_bf16 v[100:103], v[192:195], v[52:55], v[100:103]
  ds_read_b64_tr_b16 v[162:163], v6 offset:49664
  v_mfma_f32_16x16x32_bf16 v[104:107], v[196:199], v[48:51], v[104:107]
  ds_read_b64_tr_b16 v[164:165], v7 offset:49152
  v_mfma_f32_16x16x32_bf16 v[108:111], v[196:199], v[52:55], v[108:111]
  ds_read_b64_tr_b16 v[166:167], v7 offset:49664
  buffer_load_dwordx4 v[36:39], v5, s[36:39], s50 offen offset:0
  v_mfma_f32_16x16x32_bf16 v[112:115], v[200:203], v[48:51], v[112:115]
  ds_read_b64_tr_b16 v[168:169], v8 offset:49152
  v_mfma_f32_16x16x32_bf16 v[116:119], v[200:203], v[52:55], v[116:119]
  ds_read_b64_tr_b16 v[170:171], v8 offset:49664
  v_mfma_f32_16x16x32_bf16 v[120:123], v[204:207], v[48:51], v[120:123]
  ds_read_b64_tr_b16 v[172:173], v9 offset:49152
  buffer_load_dwordx4 v[40:43], v4, s[36:39], s50 offen offset:1024
  v_mfma_f32_16x16x32_bf16 v[124:127], v[204:207], v[52:55], v[124:127]
  ds_read_b64_tr_b16 v[174:175], v9 offset:49664
  s_waitcnt vmcnt(19) lgkmcnt(8)
  v_mfma_f32_16x16x32_bf16 v[96:99], v[208:211], v[56:59], v[96:99]
  ds_read_b64_tr_b16 v[176:177], v6 offset:53248
  v_mfma_f32_16x16x32_bf16 v[100:103], v[208:211], v[60:63], v[100:103]
  ds_read_b64_tr_b16 v[178:179], v6 offset:53760
  buffer_load_dwordx4 v[44:47], v5, s[36:39], s50 offen offset:1024
  v_mfma_f32_16x16x32_bf16 v[104:107], v[212:215], v[56:59], v[104:107]
  ds_read_b64_tr_b16 v[180:181], v7 offset:53248
  v_mfma_f32_16x16x32_bf16 v[108:111], v[212:215], v[60:63], v[108:111]
  ds_read_b64_tr_b16 v[182:183], v7 offset:53760
  v_mfma_f32_16x16x32_bf16 v[112:115], v[216:219], v[56:59], v[112:115]
  ds_read_b64_tr_b16 v[184:185], v8 offset:53248
  v_mfma_f32_16x16x32_bf16 v[116:119], v[216:219], v[60:63], v[116:119]
  ds_read_b64_tr_b16 v[186:187], v8 offset:53760
  v_readlane_b32 s51, v15, 31
  v_mfma_f32_16x16x32_bf16 v[120:123], v[220:223], v[56:59], v[120:123]
  ds_read_b64_tr_b16 v[188:189], v9 offset:53248
  v_mfma_f32_16x16x32_bf16 v[124:127], v[220:223], v[60:63], v[124:127]
  ds_read_b64_tr_b16 v[190:191], v9 offset:53760
  s_waitcnt vmcnt(18) lgkmcnt(8)
  v_mfma_f32_16x16x32_bf16 v[96:99], v[160:163], v[64:67], v[96:99]
  ds_read_b64_tr_b16 v[192:193], v6 offset:57344
  buffer_load_dwordx4 v[48:51], v4, s[36:39], s51 offen offset:0
  v_mfma_f32_16x16x32_bf16 v[100:103], v[160:163], v[68:71], v[100:103]
  ds_read_b64_tr_b16 v[194:195], v6 offset:57856
  v_mfma_f32_16x16x32_bf16 v[104:107], v[164:167], v[64:67], v[104:107]
  ds_read_b64_tr_b16 v[196:197], v7 offset:57344
  v_mfma_f32_16x16x32_bf16 v[108:111], v[164:167], v[68:71], v[108:111]
  ds_read_b64_tr_b16 v[198:199], v7 offset:57856
  buffer_load_dwordx4 v[52:55], v5, s[36:39], s51 offen offset:0
  v_mfma_f32_16x16x32_bf16 v[112:115], v[168:171], v[64:67], v[112:115]
  ds_read_b64_tr_b16 v[200:201], v8 offset:57344
  v_mfma_f32_16x16x32_bf16 v[116:119], v[168:171], v[68:71], v[116:119]
  ds_read_b64_tr_b16 v[202:203], v8 offset:57856
  v_mfma_f32_16x16x32_bf16 v[120:123], v[172:175], v[64:67], v[120:123]
  ds_read_b64_tr_b16 v[204:205], v9 offset:57344
  buffer_load_dwordx4 v[56:59], v4, s[36:39], s51 offen offset:1024
  v_mfma_f32_16x16x32_bf16 v[124:127], v[172:175], v[68:71], v[124:127]
  ds_read_b64_tr_b16 v[206:207], v9 offset:57856
  s_waitcnt vmcnt(19) lgkmcnt(8)
  v_mfma_f32_16x16x32_bf16 v[96:99], v[176:179], v[72:75], v[96:99]
  ds_read_b64_tr_b16 v[208:209], v6 offset:61440
  v_mfma_f32_16x16x32_bf16 v[100:103], v[176:179], v[76:79], v[100:103]
  ds_read_b64_tr_b16 v[210:211], v6 offset:61952
  buffer_load_dwordx4 v[60:63], v5, s[36:39], s51 offen offset:1024
  v_mfma_f32_16x16x32_bf16 v[104:107], v[180:183], v[72:75], v[104:107]
  ds_read_b64_tr_b16 v[212:213], v7 offset:61440
  v_mfma_f32_16x16x32_bf16 v[108:111], v[180:183], v[76:79], v[108:111]
  ds_read_b64_tr_b16 v[214:215], v7 offset:61952
  v_mfma_f32_16x16x32_bf16 v[112:115], v[184:187], v[72:75], v[112:115]
  ds_read_b64_tr_b16 v[216:217], v8 offset:61440
  v_mfma_f32_16x16x32_bf16 v[116:119], v[184:187], v[76:79], v[116:119]
  ds_read_b64_tr_b16 v[218:219], v8 offset:61952
  v_readlane_b32 s48, v15, 32
  v_mfma_f32_16x16x32_bf16 v[120:123], v[188:191], v[72:75], v[120:123]
  ds_read_b64_tr_b16 v[220:221], v9 offset:61440
  v_mfma_f32_16x16x32_bf16 v[124:127], v[188:191], v[76:79], v[124:127]
  ds_read_b64_tr_b16 v[222:223], v9 offset:61952
  s_waitcnt vmcnt(18) lgkmcnt(8)
  v_mfma_f32_16x16x32_bf16 v[96:99], v[192:195], v[80:83], v[96:99]
  ds_read_b64_tr_b16 v[160:161], v20 offset:0
  buffer_load_dwordx4 v[64:67], v4, s[36:39], s48 offen offset:0
  v_mfma_f32_16x16x32_bf16 v[100:103], v[192:195], v[84:87], v[100:103]
  ds_read_b64_tr_b16 v[162:163], v20 offset:512
  v_mfma_f32_16x16x32_bf16 v[104:107], v[196:199], v[80:83], v[104:107]
  ds_read_b64_tr_b16 v[164:165], v21 offset:0
  v_mfma_f32_16x16x32_bf16 v[108:111], v[196:199], v[84:87], v[108:111]
  ds_read_b64_tr_b16 v[166:167], v21 offset:512
  buffer_load_dwordx4 v[68:71], v5, s[36:39], s48 offen offset:0
  v_mfma_f32_16x16x32_bf16 v[112:115], v[200:203], v[80:83], v[112:115]
  ds_read_b64_tr_b16 v[168:169], v22 offset:0
  v_mfma_f32_16x16x32_bf16 v[116:119], v[200:203], v[84:87], v[116:119]
  ds_read_b64_tr_b16 v[170:171], v22 offset:512
  v_mfma_f32_16x16x32_bf16 v[120:123], v[204:207], v[80:83], v[120:123]
  ds_read_b64_tr_b16 v[172:173], v23 offset:0
  buffer_load_dwordx4 v[72:75], v4, s[36:39], s48 offen offset:1024
  v_mfma_f32_16x16x32_bf16 v[124:127], v[204:207], v[84:87], v[124:127]
  ds_read_b64_tr_b16 v[174:175], v23 offset:512
  s_waitcnt vmcnt(19) lgkmcnt(8)
  v_mfma_f32_16x16x32_bf16 v[96:99], v[208:211], v[88:91], v[96:99]
  ds_read_b64_tr_b16 v[176:177], v20 offset:4096
  v_mfma_f32_16x16x32_bf16 v[100:103], v[208:211], v[92:95], v[100:103]
  ds_read_b64_tr_b16 v[178:179], v20 offset:4608
  buffer_load_dwordx4 v[76:79], v5, s[36:39], s48 offen offset:1024
  v_mfma_f32_16x16x32_bf16 v[104:107], v[212:215], v[88:91], v[104:107]
  ds_read_b64_tr_b16 v[180:181], v21 offset:4096
  v_mfma_f32_16x16x32_bf16 v[108:111], v[212:215], v[92:95], v[108:111]
  ds_read_b64_tr_b16 v[182:183], v21 offset:4608
  v_mfma_f32_16x16x32_bf16 v[112:115], v[216:219], v[88:91], v[112:115]
  ds_read_b64_tr_b16 v[184:185], v22 offset:4096
  v_mfma_f32_16x16x32_bf16 v[116:119], v[216:219], v[92:95], v[116:119]
  ds_read_b64_tr_b16 v[186:187], v22 offset:4608
  v_readlane_b32 s49, v15, 33
  v_mfma_f32_16x16x32_bf16 v[120:123], v[220:223], v[88:91], v[120:123]
  ds_read_b64_tr_b16 v[188:189], v23 offset:4096
  v_mfma_f32_16x16x32_bf16 v[124:127], v[220:223], v[92:95], v[124:127]
  ds_read_b64_tr_b16 v[190:191], v23 offset:4608
  s_waitcnt vmcnt(18) lgkmcnt(8)
  v_mfma_f32_16x16x32_bf16 v[96:99], v[160:163], v[224:227], v[96:99]
  ds_read_b64_tr_b16 v[192:193], v20 offset:8192
  buffer_load_dwordx4 v[80:83], v4, s[36:39], s49 offen offset:0
  v_mfma_f32_16x16x32_bf16 v[100:103], v[160:163], v[228:231], v[100:103]
  ds_read_b64_tr_b16 v[194:195], v20 offset:8704
  v_mfma_f32_16x16x32_bf16 v[104:107], v[164:167], v[224:227], v[104:107]
  ds_read_b64_tr_b16 v[196:197], v21 offset:8192
  v_mfma_f32_16x16x32_bf16 v[108:111], v[164:167], v[228:231], v[108:111]
  ds_read_b64_tr_b16 v[198:199], v21 offset:8704
  buffer_load_dwordx4 v[84:87], v5, s[36:39], s49 offen offset:0
  v_mfma_f32_16x16x32_bf16 v[112:115], v[168:171], v[224:227], v[112:115]
  ds_read_b64_tr_b16 v[200:201], v22 offset:8192
  v_mfma_f32_16x16x32_bf16 v[116:119], v[168:171], v[228:231], v[116:119]
  ds_read_b64_tr_b16 v[202:203], v22 offset:8704
  v_mfma_f32_16x16x32_bf16 v[120:123], v[172:175], v[224:227], v[120:123]
  ds_read_b64_tr_b16 v[204:205], v23 offset:8192
  buffer_load_dwordx4 v[88:91], v4, s[36:39], s49 offen offset:1024
  v_mfma_f32_16x16x32_bf16 v[124:127], v[172:175], v[228:231], v[124:127]
  ds_read_b64_tr_b16 v[206:207], v23 offset:8704
  s_waitcnt vmcnt(19) lgkmcnt(8)
  v_mfma_f32_16x16x32_bf16 v[96:99], v[176:179], v[232:235], v[96:99]
  ds_read_b64_tr_b16 v[208:209], v20 offset:12288
  v_mfma_f32_16x16x32_bf16 v[100:103], v[176:179], v[236:239], v[100:103]
  ds_read_b64_tr_b16 v[210:211], v20 offset:12800
  buffer_load_dwordx4 v[92:95], v5, s[36:39], s49 offen offset:1024
  v_mfma_f32_16x16x32_bf16 v[104:107], v[180:183], v[232:235], v[104:107]
  ds_read_b64_tr_b16 v[212:213], v21 offset:12288
  v_mfma_f32_16x16x32_bf16 v[108:111], v[180:183], v[236:239], v[108:111]
  ds_read_b64_tr_b16 v[214:215], v21 offset:12800
  v_mfma_f32_16x16x32_bf16 v[112:115], v[184:187], v[232:235], v[112:115]
  ds_read_b64_tr_b16 v[216:217], v22 offset:12288
  v_mfma_f32_16x16x32_bf16 v[116:119], v[184:187], v[236:239], v[116:119]
  ds_read_b64_tr_b16 v[218:219], v22 offset:12800
  v_readlane_b32 s50, v15, 34
  v_mfma_f32_16x16x32_bf16 v[120:123], v[188:191], v[232:235], v[120:123]
  ds_read_b64_tr_b16 v[220:221], v23 offset:12288
  v_mfma_f32_16x16x32_bf16 v[124:127], v[188:191], v[236:239], v[124:127]
  ds_read_b64_tr_b16 v[222:223], v23 offset:12800
  s_waitcnt vmcnt(18) lgkmcnt(8)
  v_mfma_f32_16x16x32_bf16 v[96:99], v[192:195], v[240:243], v[96:99]
  ds_read_b64_tr_b16 v[160:161], v20 offset:16384
  buffer_load_dwordx4 v[224:227], v4, s[36:39], s50 offen offset:0
  v_mfma_f32_16x16x32_bf16 v[100:103], v[192:195], v[244:247], v[100:103]
  ds_read_b64_tr_b16 v[162:163], v20 offset:16896
  v_mfma_f32_16x16x32_bf16 v[104:107], v[196:199], v[240:243], v[104:107]
  ds_read_b64_tr_b16 v[164:165], v21 offset:16384
  v_mfma_f32_16x16x32_bf16 v[108:111], v[196:199], v[244:247], v[108:111]
  ds_read_b64_tr_b16 v[166:167], v21 offset:16896
  buffer_load_dwordx4 v[228:231], v5, s[36:39], s50 offen offset:0
  v_mfma_f32_16x16x32_bf16 v[112:115], v[200:203], v[240:243], v[112:115]
  ds_read_b64_tr_b16 v[168:169], v22 offset:16384
  v_mfma_f32_16x16x32_bf16 v[116:119], v[200:203], v[244:247], v[116:119]
  ds_read_b64_tr_b16 v[170:171], v22 offset:16896
  v_mfma_f32_16x16x32_bf16 v[120:123], v[204:207], v[240:243], v[120:123]
  ds_read_b64_tr_b16 v[172:173], v23 offset:16384
  buffer_load_dwordx4 v[232:235], v4, s[36:39], s50 offen offset:1024
  v_mfma_f32_16x16x32_bf16 v[124:127], v[204:207], v[244:247], v[124:127]
  ds_read_b64_tr_b16 v[174:175], v23 offset:16896
  s_waitcnt vmcnt(19) lgkmcnt(8)
  v_mfma_f32_16x16x32_bf16 v[96:99], v[208:211], v[248:251], v[96:99]
  ds_read_b64_tr_b16 v[176:177], v20 offset:20480
  v_mfma_f32_16x16x32_bf16 v[100:103], v[208:211], v[252:255], v[100:103]
  ds_read_b64_tr_b16 v[178:179], v20 offset:20992
  buffer_load_dwordx4 v[236:239], v5, s[36:39], s50 offen offset:1024
  v_mfma_f32_16x16x32_bf16 v[104:107], v[212:215], v[248:251], v[104:107]
  ds_read_b64_tr_b16 v[180:181], v21 offset:20480
  v_mfma_f32_16x16x32_bf16 v[108:111], v[212:215], v[252:255], v[108:111]
  ds_read_b64_tr_b16 v[182:183], v21 offset:20992
  v_mfma_f32_16x16x32_bf16 v[112:115], v[216:219], v[248:251], v[112:115]
  ds_read_b64_tr_b16 v[184:185], v22 offset:20480
  v_mfma_f32_16x16x32_bf16 v[116:119], v[216:219], v[252:255], v[116:119]
  ds_read_b64_tr_b16 v[186:187], v22 offset:20992
  v_readlane_b32 s51, v15, 35
  v_mfma_f32_16x16x32_bf16 v[120:123], v[220:223], v[248:251], v[120:123]
  ds_read_b64_tr_b16 v[188:189], v23 offset:20480
  v_mfma_f32_16x16x32_bf16 v[124:127], v[220:223], v[252:255], v[124:127]
  ds_read_b64_tr_b16 v[190:191], v23 offset:20992
  s_waitcnt vmcnt(18) lgkmcnt(8)
  v_mfma_f32_16x16x32_bf16 v[96:99], v[160:163], v[32:35], v[96:99]
  ds_read_b64_tr_b16 v[192:193], v20 offset:24576
  buffer_load_dwordx4 v[240:243], v4, s[36:39], s51 offen offset:0
  v_mfma_f32_16x16x32_bf16 v[100:103], v[160:163], v[36:39], v[100:103]
  ds_read_b64_tr_b16 v[194:195], v20 offset:25088
  v_mfma_f32_16x16x32_bf16 v[104:107], v[164:167], v[32:35], v[104:107]
  ds_read_b64_tr_b16 v[196:197], v21 offset:24576
  v_mfma_f32_16x16x32_bf16 v[108:111], v[164:167], v[36:39], v[108:111]
  ds_read_b64_tr_b16 v[198:199], v21 offset:25088
  buffer_load_dwordx4 v[244:247], v5, s[36:39], s51 offen offset:0
  v_mfma_f32_16x16x32_bf16 v[112:115], v[168:171], v[32:35], v[112:115]
  ds_read_b64_tr_b16 v[200:201], v22 offset:24576
  v_mfma_f32_16x16x32_bf16 v[116:119], v[168:171], v[36:39], v[116:119]
  ds_read_b64_tr_b16 v[202:203], v22 offset:25088
  v_mfma_f32_16x16x32_bf16 v[120:123], v[172:175], v[32:35], v[120:123]
  ds_read_b64_tr_b16 v[204:205], v23 offset:24576
  buffer_load_dwordx4 v[248:251], v4, s[36:39], s51 offen offset:1024
  v_mfma_f32_16x16x32_bf16 v[124:127], v[172:175], v[36:39], v[124:127]
  ds_read_b64_tr_b16 v[206:207], v23 offset:25088
  s_waitcnt vmcnt(19) lgkmcnt(8)
  v_mfma_f32_16x16x32_bf16 v[96:99], v[176:179], v[40:43], v[96:99]
  ds_read_b64_tr_b16 v[208:209], v20 offset:28672
  v_mfma_f32_16x16x32_bf16 v[100:103], v[176:179], v[44:47], v[100:103]
  ds_read_b64_tr_b16 v[210:211], v20 offset:29184
  buffer_load_dwordx4 v[252:255], v5, s[36:39], s51 offen offset:1024
  v_mfma_f32_16x16x32_bf16 v[104:107], v[180:183], v[40:43], v[104:107]
  ds_read_b64_tr_b16 v[212:213], v21 offset:28672
  v_mfma_f32_16x16x32_bf16 v[108:111], v[180:183], v[44:47], v[108:111]
  ds_read_b64_tr_b16 v[214:215], v21 offset:29184
  v_mfma_f32_16x16x32_bf16 v[112:115], v[184:187], v[40:43], v[112:115]
  ds_read_b64_tr_b16 v[216:217], v22 offset:28672
  v_mfma_f32_16x16x32_bf16 v[116:119], v[184:187], v[44:47], v[116:119]
  ds_read_b64_tr_b16 v[218:219], v22 offset:29184
  v_mfma_f32_16x16x32_bf16 v[120:123], v[188:191], v[40:43], v[120:123]
  ds_read_b64_tr_b16 v[220:221], v23 offset:28672
  v_mfma_f32_16x16x32_bf16 v[124:127], v[188:191], v[44:47], v[124:127]
  ds_read_b64_tr_b16 v[222:223], v23 offset:29184
  s_waitcnt vmcnt(18) lgkmcnt(8)
  v_mfma_f32_16x16x32_bf16 v[96:99], v[192:195], v[48:51], v[96:99]
  ds_read_b64_tr_b16 v[160:161], v20 offset:32768
  v_mfma_f32_16x16x32_bf16 v[100:103], v[192:195], v[52:55], v[100:103]
  ds_read_b64_tr_b16 v[162:163], v20 offset:33280
  v_mfma_f32_16x16x32_bf16 v[104:107], v[196:199], v[48:51], v[104:107]
  ds_read_b64_tr_b16 v[164:165], v21 offset:32768
  v_mfma_f32_16x16x32_bf16 v[108:111], v[196:199], v[52:55], v[108:111]
  ds_read_b64_tr_b16 v[166:167], v21 offset:33280
  v_mfma_f32_16x16x32_bf16 v[112:115], v[200:203], v[48:51], v[112:115]
  ds_read_b64_tr_b16 v[168:169], v22 offset:32768
  v_mfma_f32_16x16x32_bf16 v[116:119], v[200:203], v[52:55], v[116:119]
  ds_read_b64_tr_b16 v[170:171], v22 offset:33280
  v_mfma_f32_16x16x32_bf16 v[120:123], v[204:207], v[48:51], v[120:123]
  ds_read_b64_tr_b16 v[172:173], v23 offset:32768
  v_mfma_f32_16x16x32_bf16 v[124:127], v[204:207], v[52:55], v[124:127]
  ds_read_b64_tr_b16 v[174:175], v23 offset:33280
  s_waitcnt vmcnt(16) lgkmcnt(8)
  v_mfma_f32_16x16x32_bf16 v[96:99], v[208:211], v[56:59], v[96:99]
  ds_read_b64_tr_b16 v[176:177], v20 offset:36864
  v_mfma_f32_16x16x32_bf16 v[100:103], v[208:211], v[60:63], v[100:103]
  ds_read_b64_tr_b16 v[178:179], v20 offset:37376
  v_mfma_f32_16x16x32_bf16 v[104:107], v[212:215], v[56:59], v[104:107]
  ds_read_b64_tr_b16 v[180:181], v21 offset:36864
  v_mfma_f32_16x16x32_bf16 v[108:111], v[212:215], v[60:63], v[108:111]
  ds_read_b64_tr_b16 v[182:183], v21 offset:37376
  v_mfma_f32_16x16x32_bf16 v[112:115], v[216:219], v[56:59], v[112:115]
  ds_read_b64_tr_b16 v[184:185], v22 offset:36864
  v_mfma_f32_16x16x32_bf16 v[116:119], v[216:219], v[60:63], v[116:119]
  ds_read_b64_tr_b16 v[186:187], v22 offset:37376
  v_mfma_f32_16x16x32_bf16 v[120:123], v[220:223], v[56:59], v[120:123]
  ds_read_b64_tr_b16 v[188:189], v23 offset:36864
  v_mfma_f32_16x16x32_bf16 v[124:127], v[220:223], v[60:63], v[124:127]
  ds_read_b64_tr_b16 v[190:191], v23 offset:37376
  s_waitcnt vmcnt(14) lgkmcnt(8)
  v_mfma_f32_16x16x32_bf16 v[96:99], v[160:163], v[64:67], v[96:99]
  ds_read_b64_tr_b16 v[192:193], v20 offset:40960
  v_mfma_f32_16x16x32_bf16 v[100:103], v[160:163], v[68:71], v[100:103]
  ds_read_b64_tr_b16 v[194:195], v20 offset:41472
  v_mfma_f32_16x16x32_bf16 v[104:107], v[164:167], v[64:67], v[104:107]
  ds_read_b64_tr_b16 v[196:197], v21 offset:40960
  v_mfma_f32_16x16x32_bf16 v[108:111], v[164:167], v[68:71], v[108:111]
  ds_read_b64_tr_b16 v[198:199], v21 offset:41472
  v_mfma_f32_16x16x32_bf16 v[112:115], v[168:171], v[64:67], v[112:115]
  ds_read_b64_tr_b16 v[200:201], v22 offset:40960
  v_mfma_f32_16x16x32_bf16 v[116:119], v[168:171], v[68:71], v[116:119]
  ds_read_b64_tr_b16 v[202:203], v22 offset:41472
  v_mfma_f32_16x16x32_bf16 v[120:123], v[172:175], v[64:67], v[120:123]
  ds_read_b64_tr_b16 v[204:205], v23 offset:40960
  v_mfma_f32_16x16x32_bf16 v[124:127], v[172:175], v[68:71], v[124:127]
  ds_read_b64_tr_b16 v[206:207], v23 offset:41472
  s_waitcnt vmcnt(12) lgkmcnt(8)
  v_mfma_f32_16x16x32_bf16 v[96:99], v[176:179], v[72:75], v[96:99]
  ds_read_b64_tr_b16 v[208:209], v20 offset:45056
  v_mfma_f32_16x16x32_bf16 v[100:103], v[176:179], v[76:79], v[100:103]
  ds_read_b64_tr_b16 v[210:211], v20 offset:45568
  v_mfma_f32_16x16x32_bf16 v[104:107], v[180:183], v[72:75], v[104:107]
  ds_read_b64_tr_b16 v[212:213], v21 offset:45056
  v_mfma_f32_16x16x32_bf16 v[108:111], v[180:183], v[76:79], v[108:111]
  ds_read_b64_tr_b16 v[214:215], v21 offset:45568
  v_mfma_f32_16x16x32_bf16 v[112:115], v[184:187], v[72:75], v[112:115]
  ds_read_b64_tr_b16 v[216:217], v22 offset:45056
  v_mfma_f32_16x16x32_bf16 v[116:119], v[184:187], v[76:79], v[116:119]
  ds_read_b64_tr_b16 v[218:219], v22 offset:45568
  v_mfma_f32_16x16x32_bf16 v[120:123], v[188:191], v[72:75], v[120:123]
  ds_read_b64_tr_b16 v[220:221], v23 offset:45056
  v_mfma_f32_16x16x32_bf16 v[124:127], v[188:191], v[76:79], v[124:127]
  ds_read_b64_tr_b16 v[222:223], v23 offset:45568
  s_waitcnt vmcnt(10) lgkmcnt(8)
  v_mfma_f32_16x16x32_bf16 v[96:99], v[192:195], v[80:83], v[96:99]
  ds_read_b64_tr_b16 v[160:161], v20 offset:49152
  v_mfma_f32_16x16x32_bf16 v[100:103], v[192:195], v[84:87], v[100:103]
  ds_read_b64_tr_b16 v[162:163], v20 offset:49664
  v_mfma_f32_16x16x32_bf16 v[104:107], v[196:199], v[80:83], v[104:107]
  ds_read_b64_tr_b16 v[164:165], v21 offset:49152
  v_mfma_f32_16x16x32_bf16 v[108:111], v[196:199], v[84:87], v[108:111]
  ds_read_b64_tr_b16 v[166:167], v21 offset:49664
  v_mfma_f32_16x16x32_bf16 v[112:115], v[200:203], v[80:83], v[112:115]
  ds_read_b64_tr_b16 v[168:169], v22 offset:49152
  v_mfma_f32_16x16x32_bf16 v[116:119], v[200:203], v[84:87], v[116:119]
  ds_read_b64_tr_b16 v[170:171], v22 offset:49664
  v_mfma_f32_16x16x32_bf16 v[120:123], v[204:207], v[80:83], v[120:123]
  ds_read_b64_tr_b16 v[172:173], v23 offset:49152
  v_mfma_f32_16x16x32_bf16 v[124:127], v[204:207], v[84:87], v[124:127]
  ds_read_b64_tr_b16 v[174:175], v23 offset:49664
  s_waitcnt vmcnt(8) lgkmcnt(8)
  v_mfma_f32_16x16x32_bf16 v[96:99], v[208:211], v[88:91], v[96:99]
  ds_read_b64_tr_b16 v[176:177], v20 offset:53248
  v_mfma_f32_16x16x32_bf16 v[100:103], v[208:211], v[92:95], v[100:103]
  ds_read_b64_tr_b16 v[178:179], v20 offset:53760
  v_mfma_f32_16x16x32_bf16 v[104:107], v[212:215], v[88:91], v[104:107]
  ds_read_b64_tr_b16 v[180:181], v21 offset:53248
  v_mfma_f32_16x16x32_bf16 v[108:111], v[212:215], v[92:95], v[108:111]
  ds_read_b64_tr_b16 v[182:183], v21 offset:53760
  v_mfma_f32_16x16x32_bf16 v[112:115], v[216:219], v[88:91], v[112:115]
  ds_read_b64_tr_b16 v[184:185], v22 offset:53248
  v_mfma_f32_16x16x32_bf16 v[116:119], v[216:219], v[92:95], v[116:119]
  ds_read_b64_tr_b16 v[186:187], v22 offset:53760
  v_mfma_f32_16x16x32_bf16 v[120:123], v[220:223], v[88:91], v[120:123]
  ds_read_b64_tr_b16 v[188:189], v23 offset:53248
  v_mfma_f32_16x16x32_bf16 v[124:127], v[220:223], v[92:95], v[124:127]
  ds_read_b64_tr_b16 v[190:191], v23 offset:53760
  s_waitcnt vmcnt(6) lgkmcnt(8)
  v_mfma_f32_16x16x32_bf16 v[96:99], v[160:163], v[224:227], v[96:99]
  ds_read_b64_tr_b16 v[192:193], v20 offset:57344
  v_mfma_f32_16x16x32_bf16 v[100:103], v[160:163], v[228:231], v[100:103]
  ds_read_b64_tr_b16 v[194:195], v20 offset:57856
  v_mfma_f32_16x16x32_bf16 v[104:107], v[164:167], v[224:227], v[104:107]
  ds_read_b64_tr_b16 v[196:197], v21 offset:57344
  v_mfma_f32_16x16x32_bf16 v[108:111], v[164:167], v[228:231], v[108:111]
  ds_read_b64_tr_b16 v[198:199], v21 offset:57856
  v_mfma_f32_16x16x32_bf16 v[112:115], v[168:171], v[224:227], v[112:115]
  ds_read_b64_tr_b16 v[200:201], v22 offset:57344
  v_mfma_f32_16x16x32_bf16 v[116:119], v[168:171], v[228:231], v[116:119]
  ds_read_b64_tr_b16 v[202:203], v22 offset:57856
  v_mfma_f32_16x16x32_bf16 v[120:123], v[172:175], v[224:227], v[120:123]
  ds_read_b64_tr_b16 v[204:205], v23 offset:57344
  v_mfma_f32_16x16x32_bf16 v[124:127], v[172:175], v[228:231], v[124:127]
  ds_read_b64_tr_b16 v[206:207], v23 offset:57856
  s_waitcnt vmcnt(4) lgkmcnt(8)
  s_barrier
  v_mfma_f32_16x16x32_bf16 v[96:99], v[176:179], v[232:235], v[96:99]
  ds_read_b64_tr_b16 v[208:209], v20 offset:61440
  ds_read_b128 v[144:147], v19 offset:0
  v_mfma_f32_16x16x32_bf16 v[100:103], v[176:179], v[236:239], v[100:103]
  ds_read_b64_tr_b16 v[210:211], v20 offset:61952
  ds_read_b128 v[148:151], v19 offset:1024
  v_mfma_f32_16x16x32_bf16 v[104:107], v[180:183], v[232:235], v[104:107]
  ds_read_b64_tr_b16 v[212:213], v21 offset:61440
  ds_read_b128 v[152:155], v19 offset:2048
  v_mfma_f32_16x16x32_bf16 v[108:111], v[180:183], v[236:239], v[108:111]
  ds_read_b64_tr_b16 v[214:215], v21 offset:61952
  ds_read_b128 v[156:159], v19 offset:3072
  v_mfma_f32_16x16x32_bf16 v[112:115], v[184:187], v[232:235], v[112:115]
  ds_read_b64_tr_b16 v[216:217], v22 offset:61440
  v_mfma_f32_16x16x32_bf16 v[116:119], v[184:187], v[236:239], v[116:119]
  ds_read_b64_tr_b16 v[218:219], v22 offset:61952
  v_mfma_f32_16x16x32_bf16 v[120:123], v[188:191], v[232:235], v[120:123]
  ds_read_b64_tr_b16 v[220:221], v23 offset:61440
  v_mfma_f32_16x16x32_bf16 v[124:127], v[188:191], v[236:239], v[124:127]
  ds_read_b64_tr_b16 v[222:223], v23 offset:61952
  s_waitcnt vmcnt(2) lgkmcnt(12)
  v_mfma_f32_16x16x32_bf16 v[96:99], v[192:195], v[240:243], v[96:99]
  v_mov_b32 v20, 0
  v_mov_b32 v21, 0
  v_mfma_f32_16x16x32_bf16 v[100:103], v[192:195], v[244:247], v[100:103]
  v_mov_b32 v22, 0
  v_mov_b32 v23, 0
  v_mfma_f32_16x16x32_bf16 v[104:107], v[196:199], v[240:243], v[104:107]
  s_waitcnt lgkmcnt(4)
  v_lshlrev_b32 v128, 16, v144
  v_and_b32 v129, s11, v144
  v_mfma_f32_16x16x32_bf16 v[108:111], v[196:199], v[244:247], v[108:111]
  v_lshlrev_b32 v130, 16, v145
  v_and_b32 v131, s11, v145
  v_lshlrev_b32 v132, 16, v146
  v_mfma_f32_16x16x32_bf16 v[112:115], v[200:203], v[240:243], v[112:115]
  v_and_b32 v133, s11, v146
  v_lshlrev_b32 v134, 16, v147
  v_and_b32 v135, s11, v147
  v_mfma_f32_16x16x32_bf16 v[116:119], v[200:203], v[244:247], v[116:119]
  v_lshlrev_b32 v136, 16, v148
  v_and_b32 v137, s11, v148
  v_lshlrev_b32 v138, 16, v149
  v_mfma_f32_16x16x32_bf16 v[120:123], v[204:207], v[240:243], v[120:123]
  v_and_b32 v139, s11, v149
  v_lshlrev_b32 v140, 16, v150
  v_and_b32 v141, s11, v150
  v_mfma_f32_16x16x32_bf16 v[124:127], v[204:207], v[244:247], v[124:127]
  s_waitcnt vmcnt(0) lgkmcnt(0)
  v_lshlrev_b32 v142, 16, v151
  v_and_b32 v143, s11, v151
  v_mfma_f32_16x16x32_bf16 v[96:99], v[208:211], v[248:251], v[96:99]
  v_lshlrev_b32 v144, 16, v152
  v_and_b32 v145, s11, v152
  v_lshlrev_b32 v146, 16, v153
  v_mfma_f32_16x16x32_bf16 v[100:103], v[208:211], v[252:255], v[100:103]
  v_and_b32 v147, s11, v153
  v_lshlrev_b32 v148, 16, v154
  v_and_b32 v149, s11, v154
  v_mfma_f32_16x16x32_bf16 v[104:107], v[212:215], v[248:251], v[104:107]
  v_lshlrev_b32 v150, 16, v155
  v_and_b32 v151, s11, v155
  v_lshlrev_b32 v152, 16, v156
  v_mfma_f32_16x16x32_bf16 v[108:111], v[212:215], v[252:255], v[108:111]
  v_and_b32 v153, s11, v156
  v_lshlrev_b32 v154, 16, v157
  v_and_b32 v155, s11, v157
  v_mfma_f32_16x16x32_bf16 v[112:115], v[216:219], v[248:251], v[112:115]
  v_lshlrev_b32 v156, 16, v158
  v_and_b32 v157, s11, v158
  v_lshlrev_b32 v158, 16, v159
  v_mfma_f32_16x16x32_bf16 v[116:119], v[216:219], v[252:255], v[116:119]
  v_and_b32 v159, s11, v159
  v_mfma_f32_16x16x32_bf16 v[120:123], v[220:223], v[248:251], v[120:123]
  v_mfma_f32_16x16x32_bf16 v[124:127], v[220:223], v[252:255], v[124:127]
  s_lshl_b32 s3, s7, 4
  s_mov_b32 s10, 0x3f803f80
  s_nop 4
  v_pk_add_f32 v[96:97], v[96:97], v[128:129]
  v_pk_add_f32 v[98:99], v[98:99], v[130:131]
  v_cvt_pk_bf16_f32 v240, v96, v97
  v_cvt_pk_bf16_f32 v241, v98, v99
  v_pk_add_f32 v[104:105], v[104:105], v[136:137]
  v_pk_add_f32 v[106:107], v[106:107], v[138:139]
  v_cvt_pk_bf16_f32 v242, v104, v105
  v_cvt_pk_bf16_f32 v243, v106, v107
  s_nop 1
  v_permlane16_swap_b32 v240, v242
  v_permlane16_swap_b32 v241, v243
  buffer_store_dwordx4 v[240:243], v12, s[44:47], 0 offen offset:0 sc1
  v_pk_add_f32 v[112:113], v[112:113], v[144:145]
  v_pk_add_f32 v[114:115], v[114:115], v[146:147]
  v_cvt_pk_bf16_f32 v244, v112, v113
  v_cvt_pk_bf16_f32 v245, v114, v115
  v_pk_add_f32 v[120:121], v[120:121], v[152:153]
  v_pk_add_f32 v[122:123], v[122:123], v[154:155]
  v_cvt_pk_bf16_f32 v246, v120, v121
  v_cvt_pk_bf16_f32 v247, v122, v123
  s_nop 1
  v_permlane16_swap_b32 v244, v246
  v_permlane16_swap_b32 v245, v247
  buffer_store_dwordx4 v[244:247], v12, s[44:47], 0 offen offset:64 sc1
  v_pk_add_f32 v[100:101], v[100:101], v[132:133]
  v_pk_add_f32 v[102:103], v[102:103], v[134:135]
  v_cvt_pk_bf16_f32 v248, v100, v101
  v_cvt_pk_bf16_f32 v249, v102, v103
  v_pk_add_f32 v[108:109], v[108:109], v[140:141]
  v_pk_add_f32 v[110:111], v[110:111], v[142:143]
  v_cvt_pk_bf16_f32 v250, v108, v109
  v_cvt_pk_bf16_f32 v251, v110, v111
  s_nop 1
  v_permlane16_swap_b32 v248, v250
  v_permlane16_swap_b32 v249, v251
  buffer_store_dwordx4 v[248:251], v12, s[44:47], s3 offen offset:0 sc1
  v_pk_add_f32 v[116:117], v[116:117], v[148:149]
  v_pk_add_f32 v[118:119], v[118:119], v[150:151]
  v_cvt_pk_bf16_f32 v252, v116, v117
  v_cvt_pk_bf16_f32 v253, v118, v119
  v_pk_add_f32 v[124:125], v[124:125], v[156:157]
  v_pk_add_f32 v[126:127], v[126:127], v[158:159]
  v_cvt_pk_bf16_f32 v254, v124, v125
  v_cvt_pk_bf16_f32 v255, v126, v127
  s_nop 1
  v_permlane16_swap_b32 v252, v254
  v_permlane16_swap_b32 v253, v255
  buffer_store_dwordx4 v[252:255], v12, s[44:47], s3 offen offset:64 sc1
  v_dot2_f32_bf16 v20, v240, s10, v20
  v_dot2_f32_bf16 v22, v240, v240, v22
  v_dot2_f32_bf16 v20, v241, s10, v20
  v_dot2_f32_bf16 v22, v241, v241, v22
  v_dot2_f32_bf16 v20, v242, s10, v20
  v_dot2_f32_bf16 v22, v242, v242, v22
  v_dot2_f32_bf16 v20, v243, s10, v20
  v_dot2_f32_bf16 v22, v243, v243, v22
  v_dot2_f32_bf16 v20, v244, s10, v20
  v_dot2_f32_bf16 v22, v244, v244, v22
  v_dot2_f32_bf16 v20, v245, s10, v20
  v_dot2_f32_bf16 v22, v245, v245, v22
  v_dot2_f32_bf16 v20, v246, s10, v20
  v_dot2_f32_bf16 v22, v246, v246, v22
  v_dot2_f32_bf16 v20, v247, s10, v20
  v_dot2_f32_bf16 v22, v247, v247, v22
  v_dot2_f32_bf16 v21, v248, s10, v21
  v_dot2_f32_bf16 v23, v248, v248, v23
  v_dot2_f32_bf16 v21, v249, s10, v21
  v_dot2_f32_bf16 v23, v249, v249, v23
  v_dot2_f32_bf16 v21, v250, s10, v21
  v_dot2_f32_bf16 v23, v250, v250, v23
  v_dot2_f32_bf16 v21, v251, s10, v21
  v_dot2_f32_bf16 v23, v251, v251, v23
  v_dot2_f32_bf16 v21, v252, s10, v21
  v_dot2_f32_bf16 v23, v252, v252, v23
  v_dot2_f32_bf16 v21, v253, s10, v21
  v_dot2_f32_bf16 v23, v253, v253, v23
  v_dot2_f32_bf16 v21, v254, s10, v21
  v_dot2_f32_bf16 v23, v254, v254, v23
  v_dot2_f32_bf16 v21, v255, s10, v21
  v_dot2_f32_bf16 v23, v255, v255, v23
  s_nop 2
  v_permlane32_swap_b32 v20, v21
  v_permlane32_swap_b32 v22, v23
  v_add_f32 v20, v20, v21
  v_add_f32 v22, v22, v23
  s_nop 1
  v_permlane16_swap_b32 v20, v22
  v_add_f32 v20, v20, v22
  buffer_store_dword v20, v18, s[56:59], 0 offen sc1
  s_cmp_eq_u32 s96, 1
  s_cbranch_scc1 L_w2_end
  s_waitcnt vmcnt(0) lgkmcnt(0)
  s_barrier
  s_mov_b32 s96, 1
  s_add_u32 s12, s22, 33554432
  s_addc_u32 s13, s23, 0
  s_add_u32 s34, s22, 67108864
  s_addc_u32 s35, s23, 0
  s_add_u32 s97, s97, 1
  s_branch L_attn_body
L_w2_c1:
```

```asm
; @launch grid=(256,1,1) block=(512,1,1) lds=163840
.amdgcn_target "amdgcn-amd-amdhsa--gfx950"
L_attn_c0:
.text
.globl interleave_layers__sliding_local_dilated__dense_activation_gelu__prompt_kernel
.p2align 8
.type interleave_layers__sliding_local_dilated__dense_activation_gelu__prompt_kernel,@function
interleave_layers__sliding_local_dilated__dense_activation_gelu__prompt_kernel:
  s_load_dwordx4 s[16:19], s[0:1], 0
  s_load_dwordx2 s[20:21], s[0:1], 16
  s_load_dwordx2 s[22:23], s[0:1], 80
  s_load_dwordx8 s[24:31], s[0:1], 32
  s_load_dwordx2 s[32:33], s[0:1], 64
  s_load_dwordx2 s[34:35], s[0:1], 80
  s_load_dwordx2 s[12:13], s[0:1], 0
  s_mov_b32 s96, 0
  s_mov_b32 s97, 0
L_attn_body:
  s_cmp_ge_u32 s2, 256
  s_cbranch_scc1 L_attn_end
  v_lshrrev_b32 v2, 6, v0
  v_and_b32 v1, 63, v0
  v_readfirstlane_b32 s70, v2
  s_and_b32 s3, s2, 7
  s_lshr_b32 s99, s2, 3
  s_and_b32 s5, s3, 1
  s_lshl_b32 s5, s5, 3
  s_and_b32 s6, s99, 7
  s_add_u32 s68, s5, s6
  s_lshr_b32 s5, s3, 1
  s_lshl_b32 s5, s5, 2
  s_lshr_b32 s6, s99, 3
  s_add_u32 s69, s5, s6
  s_cmp_lt_u32 s70, 4
  s_cbranch_scc1 L_attn_compute
L_attn_loader:
  s_add_u32 s8, s70, s69
  s_and_b32 s8, s8, 3
  s_add_u32 s9, s70, s68
  s_and_b32 s9, s9, 3
  s_lshl_b32 s76, s8, 12
  s_lshl_b32 s77, s9, 11
  s_add_u32 s77, s77, 16384
  s_lshl_b32 s11, s68, 7
  v_and_b32 v10, 7, v1
  v_lshrrev_b32 v3, 3, v1
  s_lshr_b32 s10, s76, 7
  s_lshl_b32 s3, s68, 7
  s_add_u32 s10, s10, s3
  v_add_u32 v3, s10, v3
  s_cmp_eq_u32 s96, 1
  s_cselect_b32 s5, 128, 0
  s_add_u32 s5, s5, 2048
  s_lshl_b32 s6, s5, 3
  v_mul_u32_u24 v3, s5, v3
  v_lshrrev_b32 v2, 4, v1
  v_xor_b32 v4, v2, v10
  v_lshl_add_u32 v4, v4, 4, v3
  v_add_u32 v3, s6, v3
  v_add_u32 v5, 4, v2
  v_xor_b32 v5, v5, v10
  v_lshl_add_u32 v5, v5, 4, v3
  v_add_u32 v3, s6, v3
  v_xor_b32 v6, v2, v10
  v_lshl_add_u32 v6, v6, 4, v3
  v_add_u32 v3, s6, v3
  v_add_u32 v7, 4, v2
  v_xor_b32 v7, v7, v10
  v_lshl_add_u32 v7, v7, 4, v3
  v_lshrrev_b32 v3, 3, v1
  s_lshl_b32 s10, s9, 4
  v_add_u32 v3, s10, v3
  v_mul_u32_u24 v3, 6144, v3
  v_lshrrev_b32 v2, 3, v1
  v_and_b32 v2, 2, v2
  v_xor_b32 v2, v2, v10
  s_mul_i32 s10, s69, 128
  v_add_u32 v3, s10, v3
  v_lshl_add_u32 v8, v2, 4, v3
  v_xor_b32 v2, 4, v2
  v_add_u32 v3, 49152, v3
  v_lshl_add_u32 v9, v2, 4, v3
  s_and_b32 s10, s70, 3
  s_lshl_b32 s78, s10, 9
  s_add_u32 s78, s78, 40960
  s_lshl_b32 s14, s10, 2
  s_add_u32 s14, s14, s11
  s_sub_u32 s14, s14, 16
  v_lshrrev_b32 v3, 3, v1
  v_add_u32 v3, s14, v3
  v_max_i32 v3, 0, v3
  v_mul_u32_u24 v3, s5, v3
  s_lshl_b32 s14, s10, 1
  v_lshrrev_b32 v2, 4, v1
  v_add_u32 v2, s14, v2
  v_and_b32 v2, 7, v2
  v_xor_b32 v2, v2, v10
  v_lshl_add_u32 v28, v2, 4, v3
  s_cmp_eq_u32 s10, 0
  s_cselect_b32 s14, 0xffffff00, -1
  s_mov_b32 s15, 0
  s_mov_b32 s75, 0
  s_add_u32 s100, s68, s69
  s_mov_b32 s101, -1
  s_add_u32 s101, s101, 1
  s_sub_u32 s73, s101, s100
  s_lshl_b32 s73, s73, 3
  s_lshr_b32 s73, 0xf0f02, s73
  s_and_b32 s73, s73, 255
  s_add_u32 s73, s73, s101
  s_and_b32 s73, s73, 15
  s_mul_i32 s74, s73, 393216
  s_lshl_b32 s73, s73, 7
  s_waitcnt lgkmcnt(0)
  s_mov_b32 s36, s12
  s_and_b32 s37, s13, 0xffff
  s_mov_b32 s38, 4194304
  s_mov_b32 s39, 0x00020000
  s_cmp_eq_u32 s96, 1
  s_cselect_b32 s38, 128, 0
  s_add_u32 s38, s38, 2048
  s_lshl_b32 s38, s38, 11
  s_mov_b32 s40, s18
  s_and_b32 s41, s19, 0xffff
  s_mov_b32 s42, 6291456
  s_mov_b32 s43, 0x00020000
  s_cmp_lg_u32 s96, 0
  s_cbranch_scc1 L_attn_ld1
  s_mov_b32 s48, s28
  s_and_b32 s49, s29, 0xffff
  s_mov_b32 s50, 7340032
  s_mov_b32 s51, 0x00020000
  s_cmp_eq_u32 s96, 0
  s_cselect_b32 s50, s50, 0
  s_and_b32 s3, s70, 3
  s_lshl_b32 s4, s2, 2
  s_add_u32 s3, s3, s4
  s_mul_i32 s98, s3, 3584
  s_add_u32 s98, s98, 0
  s_add_u32 s3, s75, s76
  s_add_u32 m0, s3, 0
  s_nop 0
  buffer_load_dwordx4 v4, s[36:39], s73 offen lds
  s_add_u32 m0, s3, 1024
  s_nop 0
  buffer_load_dwordx4 v5, s[36:39], s73 offen lds
  s_add_u32 m0, s3, 2048
  s_nop 0
  buffer_load_dwordx4 v6, s[36:39], s73 offen lds
  s_add_u32 m0, s3, 3072
  s_nop 0
  buffer_load_dwordx4 v7, s[36:39], s73 offen lds
  s_add_u32 m0, s78, s75
  s_mov_b64 exec, s[14:15]
  buffer_load_dwordx4 v28, s[36:39], s73 offen lds
  s_mov_b64 exec, -1
  s_add_u32 s3, s75, s77
  s_add_u32 m0, s3, 0
  s_add_u32 s4, s74, 0
  buffer_load_dwordx4 v8, s[40:43], s4 offen lds
  s_add_u32 m0, s3, 1024
  s_nop 0
  buffer_load_dwordx4 v9, s[40:43], s4 offen lds
  s_add_u32 m0, s3, 8192
  s_add_u32 s4, s74, 2048
  buffer_load_dwordx4 v8, s[40:43], s4 offen lds
  s_add_u32 m0, s3, 9216
  s_nop 0
  buffer_load_dwordx4 v9, s[40:43], s4 offen lds
  s_add_u32 m0, s3, 16384
  s_add_u32 s4, s74, 4096
  buffer_load_dwordx4 v8, s[40:43], s4 offen lds
  s_add_u32 m0, s3, 17408
  s_nop 0
  buffer_load_dwordx4 v9, s[40:43], s4 offen lds
  s_add_u32 s101, s101, 1
  s_sub_u32 s73, s101, s100
  s_lshl_b32 s73, s73, 3
  s_lshr_b32 s73, 0xf0f02, s73
  s_and_b32 s73, s73, 255
  s_add_u32 s73, s73, s101
  s_and_b32 s73, s73, 15
  s_mul_i32 s74, s73, 393216
  s_lshl_b32 s73, s73, 7
  s_add_u32 s75, s75, 43008
  s_cmp_eq_u32 s75, 129024
  s_cselect_b32 s75, 0, s75
  s_add_u32 s3, s75, s76
  s_add_u32 m0, s3, 0
  s_nop 0
  buffer_load_dwordx4 v4, s[36:39], s73 offen lds
  s_add_u32 m0, s3, 1024
  s_nop 0
  buffer_load_dwordx4 v5, s[36:39], s73 offen lds
  s_add_u32 m0, s3, 2048
  s_nop 0
  buffer_load_dwordx4 v6, s[36:39], s73 offen lds
  s_add_u32 m0, s3, 3072
  s_nop 0
  buffer_load_dwordx4 v7, s[36:39], s73 offen lds
  s_add_u32 m0, s78, s75
  s_mov_b64 exec, s[14:15]
  buffer_load_dwordx4 v28, s[36:39], s73 offen lds
  s_mov_b64 exec, -1
  s_add_u32 s3, s75, s77
  s_add_u32 m0, s3, 0
  s_add_u32 s4, s74, 0
  buffer_load_dwordx4 v8, s[40:43], s4 offen lds
  s_add_u32 m0, s3, 1024
  s_nop 0
  buffer_load_dwordx4 v9, s[40:43], s4 offen lds
  s_add_u32 m0, s3, 8192
  s_add_u32 s4, s74, 2048
  buffer_load_dwordx4 v8, s[40:43], s4 offen lds
  s_add_u32 m0, s3, 9216
  s_nop 0
  buffer_load_dwordx4 v9, s[40:43], s4 offen lds
  s_add_u32 m0, s3, 16384
  s_add_u32 s4, s74, 4096
  buffer_load_dwordx4 v8, s[40:43], s4 offen lds
  s_add_u32 m0, s3, 17408
  s_nop 0
  buffer_load_dwordx4 v9, s[40:43], s4 offen lds
  s_add_u32 s101, s101, 1
  s_sub_u32 s73, s101, s100
  s_lshl_b32 s73, s73, 3
  s_lshr_b32 s73, 0xf0f02, s73
  s_and_b32 s73, s73, 255
  s_add_u32 s73, s73, s101
  s_and_b32 s73, s73, 15
  s_mul_i32 s74, s73, 393216
  s_lshl_b32 s73, s73, 7
  s_add_u32 s75, s75, 43008
  s_cmp_eq_u32 s75, 129024
  s_cselect_b32 s75, 0, s75
  s_and_b32 s3, s70, 3
  s_lshl_b32 s4, s2, 2
  s_add_u32 s3, s3, s4
  s_sub_u32 s4, 384, s40
  s_and_b32 s4, s4, 0x380
  s_mul_i32 s5, s3, 6144
  s_add_u32 s5, s5, s4
  s_buffer_load_dword s84, s[40:43], s5 offset:0
  s_buffer_load_dword s84, s[40:43], s5 offset:64
  s_buffer_load_dword s84, s[40:43], s5 offset:1024
  s_buffer_load_dword s84, s[40:43], s5 offset:1088
  s_buffer_load_dword s84, s[40:43], s5 offset:2048
  s_buffer_load_dword s84, s[40:43], s5 offset:2112
  s_buffer_load_dword s84, s[40:43], s5 offset:3072
  s_buffer_load_dword s84, s[40:43], s5 offset:3136
  s_buffer_load_dword s84, s[40:43], s5 offset:4096
  s_buffer_load_dword s84, s[40:43], s5 offset:4160
  s_buffer_load_dword s84, s[40:43], s5 offset:5120
  s_buffer_load_dword s84, s[40:43], s5 offset:5184
  s_waitcnt vmcnt(11)
  s_barrier
  s_mov_b32 s79, 13
L_attn0_ld1:
  s_add_u32 s3, s75, s76
  s_add_u32 m0, s3, 0
  s_nop 0
  buffer_load_dwordx4 v4, s[36:39], s73 offen lds
  s_add_u32 m0, s3, 1024
  s_nop 0
  buffer_load_dwordx4 v5, s[36:39], s73 offen lds
  s_add_u32 m0, s3, 2048
  s_nop 0
  buffer_load_dwordx4 v6, s[36:39], s73 offen lds
  s_add_u32 m0, s3, 3072
  s_nop 0
  buffer_load_dwordx4 v7, s[36:39], s73 offen lds
  s_add_u32 m0, s78, s75
  s_mov_b64 exec, s[14:15]
  buffer_load_dwordx4 v28, s[36:39], s73 offen lds
  s_mov_b64 exec, -1
  s_add_u32 s3, s75, s77
  s_add_u32 m0, s3, 0
  s_add_u32 s4, s74, 0
  buffer_load_dwordx4 v8, s[40:43], s4 offen lds
  s_add_u32 m0, s3, 1024
  s_nop 0
  buffer_load_dwordx4 v9, s[40:43], s4 offen lds
  s_add_u32 m0, s3, 8192
  s_add_u32 s4, s74, 2048
  buffer_load_dwordx4 v8, s[40:43], s4 offen lds
  s_add_u32 m0, s3, 9216
  s_nop 0
  buffer_load_dwordx4 v9, s[40:43], s4 offen lds
  s_add_u32 m0, s3, 16384
  s_add_u32 s4, s74, 4096
  buffer_load_dwordx4 v8, s[40:43], s4 offen lds
  s_add_u32 m0, s3, 17408
  s_nop 0
  buffer_load_dwordx4 v9, s[40:43], s4 offen lds
  s_add_u32 s101, s101, 1
  s_sub_u32 s73, s101, s100
  s_lshl_b32 s73, s73, 3
  s_lshr_b32 s73, 0xf0f02, s73
  s_and_b32 s73, s73, 255
  s_add_u32 s73, s73, s101
  s_and_b32 s73, s73, 15
  s_mul_i32 s74, s73, 393216
  s_lshl_b32 s73, s73, 7
  s_add_u32 s75, s75, 43008
  s_cmp_eq_u32 s75, 129024
  s_cselect_b32 s75, 0, s75
  s_buffer_load_dword s84, s[48:51], s98 offset:0
  s_buffer_load_dword s84, s[48:51], s98 offset:64
  s_buffer_load_dword s84, s[48:51], s98 offset:128
  s_buffer_load_dword s84, s[48:51], s98 offset:192
  s_add_u32 s98, s98, 256
  s_waitcnt vmcnt(11)
  s_barrier
  s_sub_u32 s79, s79, 1
  s_cmp_lg_u32 s79, 0
  s_cbranch_scc1 L_attn0_ld1
  s_add_u32 s3, s75, s76
  s_add_u32 m0, s3, 0
  s_nop 0
  buffer_load_dwordx4 v4, s[36:39], s73 offen lds
  s_add_u32 m0, s3, 1024
  s_nop 0
  buffer_load_dwordx4 v5, s[36:39], s73 offen lds
  s_add_u32 m0, s3, 2048
  s_nop 0
  buffer_load_dwordx4 v6, s[36:39], s73 offen lds
  s_add_u32 m0, s3, 3072
  s_nop 0
  buffer_load_dwordx4 v7, s[36:39], s73 offen lds
  s_add_u32 m0, s78, s75
  s_mov_b64 exec, s[14:15]
  buffer_load_dwordx4 v28, s[36:39], s73 offen lds
  s_mov_b64 exec, -1
  s_add_u32 s3, s75, s77
  s_add_u32 m0, s3, 0
  s_add_u32 s4, s74, 0
  buffer_load_dwordx4 v8, s[40:43], s4 offen lds
  s_add_u32 m0, s3, 1024
  s_nop 0
  buffer_load_dwordx4 v9, s[40:43], s4 offen lds
  s_add_u32 m0, s3, 8192
  s_add_u32 s4, s74, 2048
  buffer_load_dwordx4 v8, s[40:43], s4 offen lds
  s_add_u32 m0, s3, 9216
  s_nop 0
  buffer_load_dwordx4 v9, s[40:43], s4 offen lds
  s_add_u32 m0, s3, 16384
  s_add_u32 s4, s74, 4096
  buffer_load_dwordx4 v8, s[40:43], s4 offen lds
  s_add_u32 m0, s3, 17408
  s_nop 0
  buffer_load_dwordx4 v9, s[40:43], s4 offen lds
  s_add_u32 s101, s101, 1
  s_sub_u32 s73, s101, s100
  s_lshl_b32 s73, s73, 3
  s_lshr_b32 s73, 0xf0f02, s73
  s_and_b32 s73, s73, 255
  s_add_u32 s73, s73, s101
  s_and_b32 s73, s73, 15
  s_mul_i32 s74, s73, 393216
  s_lshl_b32 s73, s73, 7
  s_add_u32 s75, s75, 43008
  s_cmp_eq_u32 s75, 129024
  s_cselect_b32 s75, 0, s75
  s_buffer_load_dword s84, s[48:51], s98 offset:0
  s_buffer_load_dword s84, s[48:51], s98 offset:64
  s_buffer_load_dword s84, s[48:51], s98 offset:128
  s_buffer_load_dword s84, s[48:51], s98 offset:192
  s_add_u32 s98, s98, 256
  s_mov_b32 s64, s24
  s_and_b32 s65, s25, 0xffff
  s_mov_b32 s66, 7340032
  s_mov_b32 s67, 0x00020000
  s_min_u32 s3, s2, 223
  s_mul_i32 s4, s3, 4682
  s_lshr_b32 s4, s4, 16
  s_mul_i32 s5, s4, 14
  s_sub_u32 s3, s3, s5
  s_lshl_b32 s3, s3, 2
  s_and_b32 s5, s70, 3
  s_add_u32 s3, s3, s5
  s_mul_i32 s5, s4, 458752
  s_lshl_b32 s8, s3, 7
  s_add_u32 s5, s5, s8
  s_lshl_b32 s9, s4, 14
  s_lshl_b32 s8, s3, 8
  s_add_u32 s94, s9, s8
  v_lshrrev_b32 v2, 3, v1
  v_mul_u32_u24 v2, 7168, v2
  v_and_b32 v3, 7, v1
  v_lshl_add_u32 v2, v3, 4, v2
  buffer_load_dwordx4 v[64:67], v2, s[64:67], s5 offen
  s_add_u32 s5, s5, 57344
  buffer_load_dwordx4 v[68:71], v2, s[64:67], s5 offen
  s_add_u32 s5, s5, 57344
  buffer_load_dwordx4 v[72:75], v2, s[64:67], s5 offen
  s_add_u32 s5, s5, 57344
  buffer_load_dwordx4 v[76:79], v2, s[64:67], s5 offen
  s_add_u32 s5, s5, 57344
  buffer_load_dwordx4 v[80:83], v2, s[64:67], s5 offen
  s_add_u32 s5, s5, 57344
  buffer_load_dwordx4 v[84:87], v2, s[64:67], s5 offen
  s_add_u32 s5, s5, 57344
  buffer_load_dwordx4 v[88:91], v2, s[64:67], s5 offen
  s_add_u32 s5, s5, 57344
  buffer_load_dwordx4 v[92:95], v2, s[64:67], s5 offen
  s_mov_b32 s60, s20
  s_and_b32 s61, s21, 0xffff
  s_mov_b32 s62, 2097152
  s_mov_b32 s63, 0x00020000
  s_and_b32 s3, s70, 3
  s_mul_i32 s3, s3, 8
  s_mul_i32 s4, s99, 32
  s_add_u32 s3, s3, s4
  v_lshrrev_b32 v2, 3, v1
  v_add_u32 v2, s3, v2
  v_mul_u32_u24 v2, 2048, v2
  v_and_b32 v3, 7, v1
  v_lshl_add_u32 v2, v3, 8, v2
  s_and_b32 s3, s2, 7
  s_lshr_b32 s3, s3, 2
  s_mul_i32 s3, s3, 128
  buffer_load_dword v96, v2, s[60:63], s3 offen
  s_waitcnt vmcnt(20)
  s_barrier
  s_waitcnt vmcnt(9)
  s_barrier
  s_barrier
  s_barrier
  s_barrier
  s_branch L_attn_ldend
L_attn_ld1:
  s_add_u32 s56, s22, 24379392
  s_addc_u32 s57, s23, 0
  s_and_b32 s57, s57, 0xffff
  s_mov_b32 s58, 262144
  s_mov_b32 s59, 0x00020000
  s_mov_b32 s75, 86016
  s_add_u32 s44, s22, 41943040
  s_addc_u32 s45, s23, 0
  s_and_b32 s45, s45, 0xffff
  s_mov_b32 s46, 524288
  s_mov_b32 s47, 0x00020000
  s_lshl4_add_u32 s3, s97, s68
  s_and_b32 s4, s69, 15
  s_lshl4_add_u32 s3, s3, s4
  s_lshl_b32 s3, s3, 7
  s_sub_u32 s3, s3, 32768
  v_lshlrev_b32 v11, 7, v1
  s_cmp_eq_u32 s68, 0
  s_cselect_b32 s4, 15, 31
  v_and_b32 v2, 16, v1
  v_lshl_add_u32 v11, v2, 2, v11
  v_and_b32 v2, s4, v1
  v_lshlrev_b32 v2, 2, v2
  v_mov_b32 v3, 1
  s_mov_b32 s79, 0x100000
  s_cmp_lg_u32 s70, 4
  s_barrier
  s_cbranch_scc1 L_attn_nofl
  s_mov_b32 exec_lo, 0xffffffff
  s_mov_b32 exec_hi, 0
  buffer_store_dword v3, v11, s[44:47], s87 offen sc1
  s_mov_b64 exec, -1
L_attn_nofl:
  s_mov_b32 s5, s3
  s_mov_b32 s88, s73
  s_add_u32 m0, s77, 0
  s_add_u32 s4, s74, 0
  buffer_load_dwordx4 v8, s[40:43], s4 offen lds
  s_add_u32 m0, s77, 1024
  s_nop 0
  buffer_load_dwordx4 v9, s[40:43], s4 offen lds
  s_add_u32 m0, s77, 8192
  s_add_u32 s4, s74, 2048
  buffer_load_dwordx4 v8, s[40:43], s4 offen lds
  s_add_u32 m0, s77, 9216
  s_nop 0
  buffer_load_dwordx4 v9, s[40:43], s4 offen lds
  s_add_u32 m0, s77, 16384
  s_add_u32 s4, s74, 4096
  buffer_load_dwordx4 v8, s[40:43], s4 offen lds
  s_add_u32 m0, s77, 17408
  s_nop 0
  buffer_load_dwordx4 v9, s[40:43], s4 offen lds
  s_add_u32 s101, s101, 1
  s_sub_u32 s73, s101, s100
  s_lshl_b32 s73, s73, 3
  s_lshr_b32 s73, 0xf0f02, s73
  s_and_b32 s73, s73, 255
  s_add_u32 s73, s73, s101
  s_and_b32 s73, s73, 15
  s_mul_i32 s74, s73, 393216
  s_lshl_b32 s73, s73, 7
  s_mov_b32 s89, s73
  s_add_u32 m0, s77, 43008
  s_add_u32 s4, s74, 0
  buffer_load_dwordx4 v8, s[40:43], s4 offen lds
  s_add_u32 m0, s77, 44032
  s_nop 0
  buffer_load_dwordx4 v9, s[40:43], s4 offen lds
  s_add_u32 m0, s77, 51200
  s_add_u32 s4, s74, 2048
  buffer_load_dwordx4 v8, s[40:43], s4 offen lds
  s_add_u32 m0, s77, 52224
  s_nop 0
  buffer_load_dwordx4 v9, s[40:43], s4 offen lds
  s_add_u32 m0, s77, 59392
  s_add_u32 s4, s74, 4096
  buffer_load_dwordx4 v8, s[40:43], s4 offen lds
  s_add_u32 m0, s77, 60416
  s_nop 0
  buffer_load_dwordx4 v9, s[40:43], s4 offen lds
  s_add_u32 s101, s101, 1
  s_sub_u32 s73, s101, s100
  s_lshl_b32 s73, s73, 3
  s_lshr_b32 s73, 0xf0f02, s73
  s_and_b32 s73, s73, 255
  s_add_u32 s73, s73, s101
  s_and_b32 s73, s73, 15
  s_mul_i32 s74, s73, 393216
  s_lshl_b32 s73, s73, 7
  s_mov_b32 s3, s5
  s_cmp_lg_u32 s70, 4
  s_cbranch_scc1 L_attn_dep
L_attn_poll:
  buffer_load_dword v3, v2, s[44:47], s3 offen sc1
  s_sub_u32 s79, s79, 1
  s_cbranch_scc1 L_attn_dep
  s_waitcnt vmcnt(0)
  v_cmp_ne_u32 vcc, 1, v3
  s_cbranch_vccnz L_attn_poll
L_attn_dep:
  s_barrier
  s_add_u32 m0, s76, 0
  s_nop 0
  buffer_load_dwordx4 v4, s[36:39], s88 offen lds
  s_add_u32 m0, s76, 1024
  s_nop 0
  buffer_load_dwordx4 v5, s[36:39], s88 offen lds
  s_add_u32 m0, s76, 2048
  s_nop 0
  buffer_load_dwordx4 v6, s[36:39], s88 offen lds
  s_add_u32 m0, s76, 3072
  s_nop 0
  buffer_load_dwordx4 v7, s[36:39], s88 offen lds
  s_add_u32 m0, s78, 0
  s_mov_b64 exec, s[14:15]
  buffer_load_dwordx4 v28, s[36:39], s88 offen lds
  s_mov_b64 exec, -1
  s_add_u32 m0, s76, 43008
  s_nop 0
  buffer_load_dwordx4 v4, s[36:39], s89 offen lds
  s_add_u32 m0, s76, 44032
  s_nop 0
  buffer_load_dwordx4 v5, s[36:39], s89 offen lds
  s_add_u32 m0, s76, 45056
  s_nop 0
  buffer_load_dwordx4 v6, s[36:39], s89 offen lds
  s_add_u32 m0, s76, 46080
  s_nop 0
  buffer_load_dwordx4 v7, s[36:39], s89 offen lds
  s_add_u32 m0, s78, 43008
  s_mov_b64 exec, s[14:15]
  buffer_load_dwordx4 v28, s[36:39], s89 offen lds
  s_mov_b64 exec, -1
  s_waitcnt vmcnt(5)
  s_barrier
  s_mov_b32 s79, 13
L_attn1_ld1:
  s_add_u32 s3, s75, s76
  s_add_u32 m0, s3, 0
  s_nop 0
  buffer_load_dwordx4 v4, s[36:39], s73 offen lds
  s_add_u32 m0, s3, 1024
  s_nop 0
  buffer_load_dwordx4 v5, s[36:39], s73 offen lds
  s_add_u32 m0, s3, 2048
  s_nop 0
  buffer_load_dwordx4 v6, s[36:39], s73 offen lds
  s_add_u32 m0, s3, 3072
  s_nop 0
  buffer_load_dwordx4 v7, s[36:39], s73 offen lds
  s_add_u32 m0, s78, s75
  s_mov_b64 exec, s[14:15]
  buffer_load_dwordx4 v28, s[36:39], s73 offen lds
  s_mov_b64 exec, -1
  s_add_u32 s3, s75, s77
  s_add_u32 m0, s3, 0
  s_add_u32 s4, s74, 0
  buffer_load_dwordx4 v8, s[40:43], s4 offen lds
  s_add_u32 m0, s3, 1024
  s_nop 0
  buffer_load_dwordx4 v9, s[40:43], s4 offen lds
  s_add_u32 m0, s3, 8192
  s_add_u32 s4, s74, 2048
  buffer_load_dwordx4 v8, s[40:43], s4 offen lds
  s_add_u32 m0, s3, 9216
  s_nop 0
  buffer_load_dwordx4 v9, s[40:43], s4 offen lds
  s_add_u32 m0, s3, 16384
  s_add_u32 s4, s74, 4096
  buffer_load_dwordx4 v8, s[40:43], s4 offen lds
  s_add_u32 m0, s3, 17408
  s_nop 0
  buffer_load_dwordx4 v9, s[40:43], s4 offen lds
  s_add_u32 s101, s101, 1
  s_sub_u32 s73, s101, s100
  s_lshl_b32 s73, s73, 3
  s_lshr_b32 s73, 0xf0f02, s73
  s_and_b32 s73, s73, 255
  s_add_u32 s73, s73, s101
  s_and_b32 s73, s73, 15
  s_mul_i32 s74, s73, 393216
  s_lshl_b32 s73, s73, 7
  s_add_u32 s75, s75, 43008
  s_cmp_eq_u32 s75, 129024
  s_cselect_b32 s75, 0, s75
  s_waitcnt vmcnt(11)
  s_barrier
  s_sub_u32 s79, s79, 1
  s_cmp_lg_u32 s79, 0
  s_cbranch_scc1 L_attn1_ld1
  s_add_u32 s3, s75, s76
  s_add_u32 m0, s3, 0
  s_nop 0
  buffer_load_dwordx4 v4, s[36:39], s73 offen lds
  s_add_u32 m0, s3, 1024
  s_nop 0
  buffer_load_dwordx4 v5, s[36:39], s73 offen lds
  s_add_u32 m0, s3, 2048
  s_nop 0
  buffer_load_dwordx4 v6, s[36:39], s73 offen lds
  s_add_u32 m0, s3, 3072
  s_nop 0
  buffer_load_dwordx4 v7, s[36:39], s73 offen lds
  s_add_u32 m0, s78, s75
  s_mov_b64 exec, s[14:15]
  buffer_load_dwordx4 v28, s[36:39], s73 offen lds
  s_mov_b64 exec, -1
  s_add_u32 s3, s75, s77
  s_add_u32 m0, s3, 0
  s_add_u32 s4, s74, 0
  buffer_load_dwordx4 v8, s[40:43], s4 offen lds
  s_add_u32 m0, s3, 1024
  s_nop 0
  buffer_load_dwordx4 v9, s[40:43], s4 offen lds
  s_add_u32 m0, s3, 8192
  s_add_u32 s4, s74, 2048
  buffer_load_dwordx4 v8, s[40:43], s4 offen lds
  s_add_u32 m0, s3, 9216
  s_nop 0
  buffer_load_dwordx4 v9, s[40:43], s4 offen lds
  s_add_u32 m0, s3, 16384
  s_add_u32 s4, s74, 4096
  buffer_load_dwordx4 v8, s[40:43], s4 offen lds
  s_add_u32 m0, s3, 17408
  s_nop 0
  buffer_load_dwordx4 v9, s[40:43], s4 offen lds
  s_add_u32 s101, s101, 1
  s_sub_u32 s73, s101, s100
  s_lshl_b32 s73, s73, 3
  s_lshr_b32 s73, 0xf0f02, s73
  s_and_b32 s73, s73, 255
  s_add_u32 s73, s73, s101
  s_and_b32 s73, s73, 15
  s_mul_i32 s74, s73, 393216
  s_lshl_b32 s73, s73, 7
  s_add_u32 s75, s75, 43008
  s_cmp_eq_u32 s75, 129024
  s_cselect_b32 s75, 0, s75
  s_and_b32 s3, s70, 3
  s_lshl_b32 s4, s68, 7
  s_lshl_b32 s5, s3, 6
  s_add_u32 s5, s5, s4
  v_add_u32 v2, s5, v1
  s_sub_u32 s4, s4, 16
  v_and_b32 v3, 15, v1
  v_add_u32 v3, s4, v3
  v_max_i32 v3, 0, v3
  s_cmp_ge_u32 s3, 2
  s_cselect_b64 vcc, -1, 0
  v_cndmask_b32 v2, v2, v3, vcc
  v_lshlrev_b32 v2, 3, v2
  s_mov_b32 s3, 0
  buffer_load_dwordx2 v[32:33], v2, s[56:59], s3 offen
  s_add_u32 s3, s3, 16384
  buffer_load_dwordx2 v[34:35], v2, s[56:59], s3 offen
  s_add_u32 s3, s3, 16384
  buffer_load_dwordx2 v[36:37], v2, s[56:59], s3 offen
  s_add_u32 s3, s3, 16384
  buffer_load_dwordx2 v[38:39], v2, s[56:59], s3 offen
  s_add_u32 s3, s3, 16384
  buffer_load_dwordx2 v[40:41], v2, s[56:59], s3 offen
  s_add_u32 s3, s3, 16384
  buffer_load_dwordx2 v[42:43], v2, s[56:59], s3 offen
  s_add_u32 s3, s3, 16384
  buffer_load_dwordx2 v[44:45], v2, s[56:59], s3 offen
  s_add_u32 s3, s3, 16384
  buffer_load_dwordx2 v[46:47], v2, s[56:59], s3 offen
  s_add_u32 s3, s3, 16384
  buffer_load_dwordx2 v[48:49], v2, s[56:59], s3 offen
  s_add_u32 s3, s3, 16384
  buffer_load_dwordx2 v[50:51], v2, s[56:59], s3 offen
  s_add_u32 s3, s3, 16384
  buffer_load_dwordx2 v[52:53], v2, s[56:59], s3 offen
  s_add_u32 s3, s3, 16384
  buffer_load_dwordx2 v[54:55], v2, s[56:59], s3 offen
  s_add_u32 s3, s3, 16384
  buffer_load_dwordx2 v[56:57], v2, s[56:59], s3 offen
  s_add_u32 s3, s3, 16384
  buffer_load_dwordx2 v[58:59], v2, s[56:59], s3 offen
  s_add_u32 s3, s3, 16384
  buffer_load_dwordx2 v[60:61], v2, s[56:59], s3 offen
  s_add_u32 s3, s3, 16384
  buffer_load_dwordx2 v[62:63], v2, s[56:59], s3 offen
  s_mov_b32 s60, s20
  s_and_b32 s61, s21, 0xffff
  s_mov_b32 s62, 2097152
  s_mov_b32 s63, 0x00020000
  s_and_b32 s3, s70, 3
  s_mul_i32 s3, s3, 8
  s_mul_i32 s4, s99, 32
  s_add_u32 s3, s3, s4
  v_lshrrev_b32 v2, 3, v1
  v_add_u32 v2, s3, v2
  v_mul_u32_u24 v2, 2048, v2
  v_and_b32 v3, 7, v1
  v_lshl_add_u32 v2, v3, 8, v2
  s_and_b32 s3, s2, 7
  s_lshr_b32 s3, s3, 2
  s_mul_i32 s3, s3, 128
  buffer_load_dword v96, v2, s[60:63], s3 offen
  s_waitcnt vmcnt(28)
  s_barrier
  s_waitcnt vmcnt(17)
  s_barrier
  s_waitcnt vmcnt(1)
  v_add_f32 v32, v32, v34
  v_add_f32 v33, v33, v35
  v_add_f32 v48, v48, v50
  v_add_f32 v49, v49, v51
  v_add_f32 v32, v32, v36
  v_add_f32 v33, v33, v37
  v_add_f32 v48, v48, v52
  v_add_f32 v49, v49, v53
  v_add_f32 v32, v32, v38
  v_add_f32 v33, v33, v39
  v_add_f32 v48, v48, v54
  v_add_f32 v49, v49, v55
  v_add_f32 v32, v32, v40
  v_add_f32 v33, v33, v41
  v_add_f32 v48, v48, v56
  v_add_f32 v49, v49, v57
  v_add_f32 v32, v32, v42
  v_add_f32 v33, v33, v43
  v_add_f32 v48, v48, v58
  v_add_f32 v49, v49, v59
  v_add_f32 v32, v32, v44
  v_add_f32 v33, v33, v45
  v_add_f32 v48, v48, v60
  v_add_f32 v49, v49, v61
  v_add_f32 v32, v32, v46
  v_add_f32 v33, v33, v47
  v_add_f32 v48, v48, v62
  v_add_f32 v49, v49, v63
  v_add_f32 v32, v32, v48
  v_add_f32 v33, v33, v49
  v_mul_f32 v32, 0x3a800000, v32
  v_mul_f32 v33, 0x3a800000, v33
  v_fma_f32 v33, -v32, v32, v33
  v_max_f32 v33, 0, v33
  v_add_f32 v33, 0x3727c5ac, v33
  v_rsq_f32 v33, v33
  s_nop 0
  s_and_b32 s3, s70, 3
  s_lshl_b32 s5, s3, 6
  s_add_u32 s5, s5, 16
  v_add_u32 v2, s5, v1
  v_and_b32 v3, 15, v1
  s_cmp_ge_u32 s3, 2
  s_cselect_b64 vcc, -1, 0
  v_cndmask_b32 v2, v2, v3, vcc
  v_lshlrev_b32 v2, 2, v2
  v_add_u32 v2, 129024, v2
  ds_write2_b32 v2, v32, v33 offset0:0 offset1:160
  s_waitcnt lgkmcnt(0)
  s_barrier
  s_barrier
L_attn_ldend:
  s_lshl_b32 s87, s97, 15
  s_lshl_b32 s4, s68, 11
  s_add_u32 s87, s87, s4
  s_lshl_b32 s4, s69, 2
  s_add_u32 s87, s87, s4
  s_add_u32 s97, s97, 1
  s_branch L_wo_body
L_attn_end:
  s_endpgm
L_attn_compute:
  s_and_b32 s71, s70, 1
  s_lshr_b32 s72, s70, 1
  v_and_b32 v3, 31, v1
  v_lshlrev_b32 v3, 2, v3
  v_add_u32 v3, 40960, v3
  v_mov_b32 v236, 0x3f803f80
  v_mov_b32 v237, 0x3f803f80
  v_mov_b32 v238, 0x3f803f80
  v_mov_b32 v239, 0x3f803f80
  ds_write_b32 v3, v236
  ds_write_b32 v3, v236 offset:43008
  v_add_u32 v3, 86016, v3
  ds_write_b32 v3, v236
  v_and_b32 v3, 15, v1
  v_lshrrev_b32 v2, 4, v1
  v_lshrrev_b32 v33, 1, v3
  s_lshl_b32 s8, s71, 13
  v_xor_b32 v4, v2, v33
  v_lshlrev_b32 v4, 4, v4
  v_lshl_add_u32 v4, v3, 7, v4
  v_add_u32 v8, 40960, v4
  v_add_u32 v4, s8, v4
  v_add_u32 v5, 4, v2
  v_xor_b32 v5, v5, v33
  v_lshlrev_b32 v5, 4, v5
  v_lshl_add_u32 v5, v3, 7, v5
  v_add_u32 v9, 40960, v5
  v_add_u32 v5, s8, v5
  v_bfe_u32 v34, v1, 2, 2
  v_lshl_add_u32 v34, v2, 3, v34
  v_lshlrev_b32 v34, 7, v34
  v_and_b32 v33, 3, v1
  v_lshl_add_u32 v34, v33, 3, v34
  v_bfe_u32 v33, v1, 3, 2
  v_lshl_add_u32 v34, v33, 5, v34
  v_and_b32 v35, 1, v2
  v_xor_b32 v35, s71, v35
  s_lshl_b32 s8, s70, 5
  v_xor_b32 v34, s8, v34
  v_add_u32 v6, 16384, v34
  v_xor_b32 v7, 32, v6
  s_lshl_b32 s8, s68, 7
  s_lshl_b32 s9, s71, 6
  s_add_u32 s8, s8, s9
  s_add_u32 s10, s8, s69
  s_lshl_b32 s10, s10, 11
  s_lshl_b32 s11, s72, 10
  s_add_u32 s10, s10, s11
  v_lshl_add_u32 v33, v3, 4, s10
  v_lshl_add_u32 v33, v35, 9, v33
  v_lshrrev_b32 v34, 1, v2
  v_lshl_add_u32 v31, v34, 8, v33
  s_mul_i32 s10, s72, 14336
  s_add_u32 s10, s10, 1024
  s_lshl_b32 s11, s71, 10
  s_add_u32 s4, s10, s11
  s_sub_u32 s5, s10, s11
  s_mul_i32 s6, s71, 6144
  v_lshl_add_u32 v16, v1, 4, s4
  v_add_u32 v17, s6, v16
  v_lshl_add_u32 v18, v1, 4, s5
  v_add_u32 v18, s6, v18
  v_lshl_add_u32 v19, v2, 8, s4
  v_lshl_add_u32 v20, v2, 8, s5
  v_lshl_add_u32 v21, v3, 4, s4
  v_lshl_add_u32 v22, v3, 4, s5
  s_lshl_b32 s10, s71, 8
  s_add_u32 s10, s10, 129024
  v_lshl_add_u32 v23, v3, 2, s10
  v_lshl_add_u32 v24, v2, 4, s10
  v_and_b32 v33, 1, v3
  v_cmp_eq_u32 s[48:49], 1, v33
  v_lshl_add_u32 v34, v2, 2, v33
  v_add_u32 v35, 2, v34
  v_cmp_gt_u32 s[50:51], v34, v3
  v_cmp_gt_u32 s[52:53], v35, v3
  v_mov_b32 v36, 0xffff
  v_mov_b32 v37, 0xffff0000
  v_cndmask_b32 v36, v36, v37, s[48:49]
  s_add_u32 s10, s10, 704
  v_lshl_add_u32 v34, v34, 2, s10
  v_lshl_add_u32 v35, v35, 2, s10
  v_subrev_u32 v38, 64, v34
  v_subrev_u32 v39, 64, v35
  v_cndmask_b32 v25, v34, v38, s[50:51]
  v_cndmask_b32 v26, v35, v39, s[52:53]
  v_cndmask_b32 v27, 0, v36, s[50:51]
  v_cndmask_b32 v29, 0, v36, s[52:53]
  v_xor_b32 v28, v27, v36
  v_xor_b32 v30, v29, v36
  s_cmp_eq_u32 s8, 0
  s_cselect_b64 s[54:55], s[50:51], 0
  s_cselect_b64 s[14:15], s[52:53], 0
  v_mov_b32 v120, 0
  v_mov_b32 v121, 0
  v_mov_b32 v122, 0
  v_mov_b32 v123, 0
  v_mov_b32 v124, 0
  v_mov_b32 v125, 0
  v_mov_b32 v126, 0
  v_mov_b32 v127, 0
  v_mov_b32 v128, 0
  v_mov_b32 v129, 0
  v_mov_b32 v130, 0
  v_mov_b32 v131, 0
  v_mov_b32 v132, 0
  v_mov_b32 v133, 0
  v_mov_b32 v134, 0
  v_mov_b32 v135, 0
  v_mov_b32 v136, 0
  v_mov_b32 v137, 0
  v_mov_b32 v138, 0
  v_mov_b32 v139, 0
  v_mov_b32 v140, 0
  v_mov_b32 v141, 0
  v_mov_b32 v142, 0
  v_mov_b32 v143, 0
  v_mov_b32 v144, 0
  v_mov_b32 v145, 0
  v_mov_b32 v146, 0
  v_mov_b32 v147, 0
  v_mov_b32 v148, 0
  v_mov_b32 v149, 0
  v_mov_b32 v150, 0
  v_mov_b32 v151, 0
  v_mov_b32 v152, 0
  v_mov_b32 v153, 0
  v_mov_b32 v154, 0
  v_mov_b32 v155, 0
  v_mov_b32 v156, 0
  v_mov_b32 v157, 0
  v_mov_b32 v158, 0
  v_mov_b32 v159, 0
  v_mov_b32 v160, 0
  v_mov_b32 v161, 0
  v_mov_b32 v162, 0
  v_mov_b32 v163, 0
  v_mov_b32 v164, 0
  v_mov_b32 v165, 0
  v_mov_b32 v166, 0
  v_mov_b32 v167, 0
  v_mov_b32 v168, 0
  v_mov_b32 v169, 0
  v_mov_b32 v170, 0
  v_mov_b32 v171, 0
  v_mov_b32 v172, 0
  v_mov_b32 v173, 0
  v_mov_b32 v174, 0
  v_mov_b32 v175, 0
  v_mov_b32 v176, 0
  v_mov_b32 v177, 0
  v_mov_b32 v178, 0
  v_mov_b32 v179, 0
  v_mov_b32 v180, 0
  v_mov_b32 v181, 0
  v_mov_b32 v182, 0
  v_mov_b32 v183, 0
  v_mov_b32 v184, 0
  v_mov_b32 v185, 0
  v_mov_b32 v186, 0
  v_mov_b32 v187, 0
  v_mov_b32 v188, 0
  v_mov_b32 v189, 0
  v_mov_b32 v190, 0
  v_mov_b32 v191, 0
  v_mov_b32 v192, 0
  v_mov_b32 v193, 0
  v_mov_b32 v194, 0
  v_mov_b32 v195, 0
  v_mov_b32 v196, 0
  v_mov_b32 v197, 0
  v_mov_b32 v198, 0
  v_mov_b32 v199, 0
  v_mov_b32 v200, 0
  v_mov_b32 v201, 0
  v_mov_b32 v202, 0
  v_mov_b32 v203, 0
  v_mov_b32 v204, 0
  v_mov_b32 v205, 0
  v_mov_b32 v206, 0
  v_mov_b32 v207, 0
  v_mov_b32 v208, 0
  v_mov_b32 v209, 0
  v_mov_b32 v210, 0
  v_mov_b32 v211, 0
  v_mov_b32 v212, 0
  v_mov_b32 v213, 0
  v_mov_b32 v214, 0
  v_mov_b32 v215, 0
  v_mov_b32 v216, 0
  v_mov_b32 v217, 0
  v_mov_b32 v218, 0
  v_mov_b32 v219, 0
  v_mov_b32 v220, 0
  v_mov_b32 v221, 0
  v_mov_b32 v222, 0
  v_mov_b32 v223, 0
  v_mov_b32 v224, 0
  v_mov_b32 v225, 0
  v_mov_b32 v226, 0
  v_mov_b32 v227, 0
  v_mov_b32 v228, 0
  v_mov_b32 v229, 0
  v_mov_b32 v230, 0
  v_mov_b32 v231, 0
  v_mov_b32 v232, 0
  v_mov_b32 v233, 0
  v_mov_b32 v234, 0
  v_mov_b32 v235, 0
  s_waitcnt lgkmcnt(0)
  s_mov_b32 s44, s34
  s_and_b32 s45, s35, 0xffff
  s_mov_b32 s46, 4194304
  s_mov_b32 s47, 0x00020000
  s_load_dwordx2 s[64:65], s[0:1], 72
  s_or_b32 s3, s96, s70
  s_cbranch_scc1 L_clr_skip0
  s_add_u32 s60, s22, 41943040
  s_addc_u32 s61, s23, 0
  s_and_b32 s61, s61, 0xffff
  s_mov_b32 s62, 524288
  s_mov_b32 s63, 0x00020000
  s_lshl_b32 s3, s2, 11
  v_lshlrev_b32 v2, 4, v1
  buffer_store_dwordx4 v[128:131], v2, s[60:63], s3 offen sc1
  buffer_store_dwordx4 v[128:131], v2, s[60:63], s3 offen offset:1024 sc1
L_clr_skip0:
  s_cmp_lg_u32 s96, 0
  s_cbranch_scc1 L_pfc1_skip
  s_getpc_b64 s[4:5]
L_pfc1:
  s_lshl_b32 s3, s99, 2
  s_add_u32 s3, s3, s70
  s_mul_i32 s3, s3, 256
  s_min_u32 s3, s3, L_w2_c1-L_attn_c0-256
  s_add_i32 s3, s3, L_attn_c0-L_pfc1
  s_ashr_i32 s6, s3, 31
  s_add_u32 s4, s4, s3
  s_addc_u32 s5, s5, s6
  s_load_dword s36, s[4:5], 0
  s_load_dword s37, s[4:5], 64
  s_load_dword s38, s[4:5], 128
  s_load_dword s39, s[4:5], 192
L_pfc1_skip:
  s_mov_b32 s75, 0
  v_add_u32_e64 v10, s75, v4
  v_add_u32_e64 v11, s75, v5
  v_add_u32_e64 v12, s75, v6
  v_add_u32_e64 v13, s75, v7
  v_add_u32_e64 v14, s75, v8
  v_add_u32_e64 v15, s75, v9
  s_add_u32 s75, s75, 43008
  s_cmp_eq_u32 s75, 129024
  s_cselect_b32 s75, 0, s75
  s_mov_b32 s79, 16
  s_cmp_eq_u32 s96, 0
  s_cbranch_scc1 L_attn_nog
  s_barrier
L_attn_nog:
  s_barrier
  ds_read_b128 v[32:35], v10 offset:0
  ds_read_b128 v[36:39], v10 offset:2048
  ds_read_b128 v[40:43], v10 offset:4096
  ds_read_b128 v[44:47], v10 offset:6144
  ds_read_b128 v[48:51], v14
  ds_read_b64_tr_b16 v[52:53], v12 offset:0
  ds_read_b64_tr_b16 v[54:55], v12 offset:512
  ds_read_b64_tr_b16 v[56:57], v13 offset:0
  ds_read_b64_tr_b16 v[58:59], v13 offset:512
  ds_read_b64_tr_b16 v[60:61], v12 offset:8192
  ds_read_b64_tr_b16 v[62:63], v12 offset:8704
  ds_read_b64_tr_b16 v[64:65], v13 offset:8192
  ds_read_b64_tr_b16 v[66:67], v13 offset:8704
  ds_read_b64_tr_b16 v[68:69], v12 offset:16384
  ds_read_b64_tr_b16 v[70:71], v12 offset:16896
  ds_read_b64_tr_b16 v[72:73], v13 offset:16384
  ds_read_b64_tr_b16 v[74:75], v13 offset:16896
  s_waitcnt lgkmcnt(0)
  s_cmp_lg_u32 s96, 0
  s_cbranch_scc1 L_attn_loop
  v_mov_b32 v240, 0
  v_mov_b32 v241, 0
  v_mov_b32 v242, 0
  v_mov_b32 v243, 0
  v_mov_b32 v244, 0
  v_mov_b32 v245, 0
  v_mov_b32 v246, 0
  v_mov_b32 v247, 0
  v_mov_b32 v248, 0
  v_mov_b32 v249, 0
  v_mov_b32 v250, 0
  v_mov_b32 v251, 0
  v_mov_b32 v252, 0
  v_mov_b32 v253, 0
  v_mov_b32 v254, 0
  v_mov_b32 v255, 0
  s_cmp_lg_u32 s72, 0
  s_cbranch_scc1 L_attn_loopb
  s_or_b32 s3, s96, s70
  s_cbranch_scc1 L_clr_skip1
  v_mov_b32 v3, 1
  s_and_b32 s65, s65, 0xffff
  s_mov_b32 s66, 256
  s_mov_b32 s67, 0x00020000
  s_mov_b64 exec, 1
  s_waitcnt vmcnt(0)
  buffer_store_byte v3, off, s[64:67], s2 sc1
  s_mov_b64 exec, -1
L_clr_skip1:
.p2align 3
L_attn_loopa:
  v_mfma_f32_16x16x32_bf16 v[240:243], v[236:239], v[32:35], v[240:243]
  ds_read_b128 v[76:79], v11 offset:0
  v_mfma_f32_16x16x32_bf16 v[244:247], v[32:35], v[32:35], v[244:247]
  ds_read_b128 v[80:83], v11 offset:2048
  v_mfma_f32_16x16x32_bf16 v[248:251], v[236:239], v[36:39], v[248:251]
  ds_read_b128 v[84:87], v11 offset:4096
  v_mfma_f32_16x16x32_bf16 v[252:255], v[36:39], v[36:39], v[252:255]
  ds_read_b128 v[88:91], v11 offset:6144
  v_mfma_f32_16x16x32_bf16 v[120:123], v[236:239], v[48:51], v[120:123]
  ds_read_b128 v[92:95], v15
  v_mfma_f32_16x16x32_bf16 v[124:127], v[48:51], v[48:51], v[124:127]
  ds_read_b64_tr_b16 v[96:97], v12 offset:4096
  v_mfma_f32_16x16x32_bf16 v[128:131], v[52:55], v[32:35], v[128:131]
  ds_read_b64_tr_b16 v[98:99], v12 offset:4608
  v_mfma_f32_16x16x32_bf16 v[132:135], v[52:55], v[36:39], v[132:135]
  ds_read_b64_tr_b16 v[100:101], v13 offset:4096
  v_mfma_f32_16x16x32_bf16 v[136:139], v[52:55], v[40:43], v[136:139]
  ds_read_b64_tr_b16 v[102:103], v13 offset:4608
  v_mfma_f32_16x16x32_bf16 v[140:143], v[52:55], v[44:47], v[140:143]
  ds_read_b64_tr_b16 v[104:105], v12 offset:12288
  v_mfma_f32_16x16x32_bf16 v[224:227], v[52:55], v[48:51], v[224:227]
  ds_read_b64_tr_b16 v[106:107], v12 offset:12800
  v_mfma_f32_16x16x32_bf16 v[144:147], v[56:59], v[32:35], v[144:147]
  ds_read_b64_tr_b16 v[108:109], v13 offset:12288
  v_mfma_f32_16x16x32_bf16 v[148:151], v[56:59], v[36:39], v[148:151]
  ds_read_b64_tr_b16 v[110:111], v13 offset:12800
  v_mfma_f32_16x16x32_bf16 v[152:155], v[56:59], v[40:43], v[152:155]
  ds_read_b64_tr_b16 v[112:113], v12 offset:20480
  v_mfma_f32_16x16x32_bf16 v[156:159], v[56:59], v[44:47], v[156:159]
  ds_read_b64_tr_b16 v[114:115], v12 offset:20992
  v_mfma_f32_16x16x32_bf16 v[160:163], v[60:63], v[32:35], v[160:163]
  ds_read_b64_tr_b16 v[116:117], v13 offset:20480
  v_mfma_f32_16x16x32_bf16 v[164:167], v[60:63], v[36:39], v[164:167]
  ds_read_b64_tr_b16 v[118:119], v13 offset:20992
  v_mfma_f32_16x16x32_bf16 v[168:171], v[60:63], v[40:43], v[168:171]
  v_add_u32_e64 v10, s75, v4
  v_mfma_f32_16x16x32_bf16 v[172:175], v[60:63], v[44:47], v[172:175]
  v_add_u32_e64 v11, s75, v5
  v_mfma_f32_16x16x32_bf16 v[228:231], v[60:63], v[48:51], v[228:231]
  v_add_u32_e64 v12, s75, v6
  v_mfma_f32_16x16x32_bf16 v[176:179], v[64:67], v[32:35], v[176:179]
  v_add_u32_e64 v13, s75, v7
  v_mfma_f32_16x16x32_bf16 v[180:183], v[64:67], v[36:39], v[180:183]
  v_add_u32_e64 v14, s75, v8
  v_mfma_f32_16x16x32_bf16 v[184:187], v[64:67], v[40:43], v[184:187]
  v_add_u32_e64 v15, s75, v9
  v_mfma_f32_16x16x32_bf16 v[188:191], v[64:67], v[44:47], v[188:191]
  s_add_u32 s75, s75, 43008
  v_mfma_f32_16x16x32_bf16 v[192:195], v[32:35], v[68:71], v[192:195]
  s_cmp_eq_u32 s75, 129024
  v_mfma_f32_16x16x32_bf16 v[196:199], v[36:39], v[68:71], v[196:199]
  s_cselect_b32 s75, 0, s75
  s_sub_u32 s79, s79, 1
  v_mfma_f32_16x16x32_bf16 v[200:203], v[40:43], v[68:71], v[200:203]
  v_mfma_f32_16x16x32_bf16 v[204:207], v[44:47], v[68:71], v[204:207]
  v_mfma_f32_16x16x32_bf16 v[232:235], v[48:51], v[68:71], v[232:235]
  v_mfma_f32_16x16x32_bf16 v[208:211], v[32:35], v[72:75], v[208:211]
  v_mfma_f32_16x16x32_bf16 v[212:215], v[36:39], v[72:75], v[212:215]
  v_mfma_f32_16x16x32_bf16 v[216:219], v[40:43], v[72:75], v[216:219]
  v_mfma_f32_16x16x32_bf16 v[220:223], v[44:47], v[72:75], v[220:223]
  s_waitcnt lgkmcnt(0)
  s_barrier
  v_mfma_f32_16x16x32_bf16 v[240:243], v[236:239], v[76:79], v[240:243]
  ds_read_b128 v[32:35], v10 offset:0
  v_mfma_f32_16x16x32_bf16 v[244:247], v[76:79], v[76:79], v[244:247]
  ds_read_b128 v[36:39], v10 offset:2048
  v_mfma_f32_16x16x32_bf16 v[248:251], v[236:239], v[80:83], v[248:251]
  ds_read_b128 v[40:43], v10 offset:4096
  v_mfma_f32_16x16x32_bf16 v[252:255], v[80:83], v[80:83], v[252:255]
  ds_read_b128 v[44:47], v10 offset:6144
  v_mfma_f32_16x16x32_bf16 v[120:123], v[236:239], v[92:95], v[120:123]
  ds_read_b128 v[48:51], v14
  v_mfma_f32_16x16x32_bf16 v[124:127], v[92:95], v[92:95], v[124:127]
  ds_read_b64_tr_b16 v[52:53], v12 offset:0
  v_mfma_f32_16x16x32_bf16 v[128:131], v[96:99], v[76:79], v[128:131]
  ds_read_b64_tr_b16 v[54:55], v12 offset:512
  v_mfma_f32_16x16x32_bf16 v[132:135], v[96:99], v[80:83], v[132:135]
  ds_read_b64_tr_b16 v[56:57], v13 offset:0
  v_mfma_f32_16x16x32_bf16 v[136:139], v[96:99], v[84:87], v[136:139]
  ds_read_b64_tr_b16 v[58:59], v13 offset:512
  v_mfma_f32_16x16x32_bf16 v[140:143], v[96:99], v[88:91], v[140:143]
  ds_read_b64_tr_b16 v[60:61], v12 offset:8192
  v_mfma_f32_16x16x32_bf16 v[224:227], v[96:99], v[92:95], v[224:227]
  ds_read_b64_tr_b16 v[62:63], v12 offset:8704
  v_mfma_f32_16x16x32_bf16 v[144:147], v[100:103], v[76:79], v[144:147]
  ds_read_b64_tr_b16 v[64:65], v13 offset:8192
  v_mfma_f32_16x16x32_bf16 v[148:151], v[100:103], v[80:83], v[148:151]
  ds_read_b64_tr_b16 v[66:67], v13 offset:8704
  v_mfma_f32_16x16x32_bf16 v[152:155], v[100:103], v[84:87], v[152:155]
  ds_read_b64_tr_b16 v[68:69], v12 offset:16384
  v_mfma_f32_16x16x32_bf16 v[156:159], v[100:103], v[88:91], v[156:159]
  ds_read_b64_tr_b16 v[70:71], v12 offset:16896
  v_mfma_f32_16x16x32_bf16 v[160:163], v[104:107], v[76:79], v[160:163]
  ds_read_b64_tr_b16 v[72:73], v13 offset:16384
  v_mfma_f32_16x16x32_bf16 v[164:167], v[104:107], v[80:83], v[164:167]
  ds_read_b64_tr_b16 v[74:75], v13 offset:16896
  v_mfma_f32_16x16x32_bf16 v[168:171], v[104:107], v[84:87], v[168:171]
  s_cmp_lg_u32 s79, 0
  s_nop 0
  v_mfma_f32_16x16x32_bf16 v[172:175], v[104:107], v[88:91], v[172:175]
  v_mfma_f32_16x16x32_bf16 v[228:231], v[104:107], v[92:95], v[228:231]
  v_mfma_f32_16x16x32_bf16 v[176:179], v[108:111], v[76:79], v[176:179]
  v_mfma_f32_16x16x32_bf16 v[180:183], v[108:111], v[80:83], v[180:183]
  v_mfma_f32_16x16x32_bf16 v[184:187], v[108:111], v[84:87], v[184:187]
  v_mfma_f32_16x16x32_bf16 v[188:191], v[108:111], v[88:91], v[188:191]
  v_mfma_f32_16x16x32_bf16 v[192:195], v[76:79], v[112:115], v[192:195]
  v_mfma_f32_16x16x32_bf16 v[196:199], v[80:83], v[112:115], v[196:199]
  v_mfma_f32_16x16x32_bf16 v[200:203], v[84:87], v[112:115], v[200:203]
  v_mfma_f32_16x16x32_bf16 v[204:207], v[88:91], v[112:115], v[204:207]
  v_mfma_f32_16x16x32_bf16 v[232:235], v[92:95], v[112:115], v[232:235]
  v_mfma_f32_16x16x32_bf16 v[208:211], v[76:79], v[116:119], v[208:211]
  v_mfma_f32_16x16x32_bf16 v[212:215], v[80:83], v[116:119], v[212:215]
  v_mfma_f32_16x16x32_bf16 v[216:219], v[84:87], v[116:119], v[216:219]
  v_mfma_f32_16x16x32_bf16 v[220:223], v[88:91], v[116:119], v[220:223]
  s_waitcnt lgkmcnt(0)
  s_cbranch_scc1 L_attn_loopa
  s_branch L_attn_post
.p2align 3
L_attn_loopb:
  v_mfma_f32_16x16x32_bf16 v[240:243], v[236:239], v[40:43], v[240:243]
  ds_read_b128 v[76:79], v11 offset:0
  v_mfma_f32_16x16x32_bf16 v[244:247], v[40:43], v[40:43], v[244:247]
  ds_read_b128 v[80:83], v11 offset:2048
  v_mfma_f32_16x16x32_bf16 v[248:251], v[236:239], v[44:47], v[248:251]
  ds_read_b128 v[84:87], v11 offset:4096
  v_mfma_f32_16x16x32_bf16 v[252:255], v[44:47], v[44:47], v[252:255]
  ds_read_b128 v[88:91], v11 offset:6144
  v_mfma_f32_16x16x32_bf16 v[128:131], v[52:55], v[32:35], v[128:131]
  ds_read_b128 v[92:95], v15
  v_mfma_f32_16x16x32_bf16 v[132:135], v[52:55], v[36:39], v[132:135]
  ds_read_b64_tr_b16 v[96:97], v12 offset:4096
  v_mfma_f32_16x16x32_bf16 v[136:139], v[52:55], v[40:43], v[136:139]
  ds_read_b64_tr_b16 v[98:99], v12 offset:4608
  v_mfma_f32_16x16x32_bf16 v[140:143], v[52:55], v[44:47], v[140:143]
  ds_read_b64_tr_b16 v[100:101], v13 offset:4096
  v_mfma_f32_16x16x32_bf16 v[224:227], v[52:55], v[48:51], v[224:227]
  ds_read_b64_tr_b16 v[102:103], v13 offset:4608
  v_mfma_f32_16x16x32_bf16 v[144:147], v[56:59], v[32:35], v[144:147]
  ds_read_b64_tr_b16 v[104:105], v12 offset:12288
  v_mfma_f32_16x16x32_bf16 v[148:151], v[56:59], v[36:39], v[148:151]
  ds_read_b64_tr_b16 v[106:107], v12 offset:12800
  v_mfma_f32_16x16x32_bf16 v[152:155], v[56:59], v[40:43], v[152:155]
  ds_read_b64_tr_b16 v[108:109], v13 offset:12288
  v_mfma_f32_16x16x32_bf16 v[156:159], v[56:59], v[44:47], v[156:159]
  ds_read_b64_tr_b16 v[110:111], v13 offset:12800
  v_mfma_f32_16x16x32_bf16 v[160:163], v[60:63], v[32:35], v[160:163]
  ds_read_b64_tr_b16 v[112:113], v12 offset:20480
  v_mfma_f32_16x16x32_bf16 v[164:167], v[60:63], v[36:39], v[164:167]
  ds_read_b64_tr_b16 v[114:115], v12 offset:20992
  v_mfma_f32_16x16x32_bf16 v[168:171], v[60:63], v[40:43], v[168:171]
  ds_read_b64_tr_b16 v[116:117], v13 offset:20480
  v_mfma_f32_16x16x32_bf16 v[172:175], v[60:63], v[44:47], v[172:175]
  ds_read_b64_tr_b16 v[118:119], v13 offset:20992
  v_mfma_f32_16x16x32_bf16 v[228:231], v[60:63], v[48:51], v[228:231]
  v_add_u32_e64 v10, s75, v4
  v_mfma_f32_16x16x32_bf16 v[176:179], v[64:67], v[32:35], v[176:179]
  v_add_u32_e64 v11, s75, v5
  v_mfma_f32_16x16x32_bf16 v[180:183], v[64:67], v[36:39], v[180:183]
  v_add_u32_e64 v12, s75, v6
  v_mfma_f32_16x16x32_bf16 v[184:187], v[64:67], v[40:43], v[184:187]
  v_add_u32_e64 v13, s75, v7
  v_mfma_f32_16x16x32_bf16 v[188:191], v[64:67], v[44:47], v[188:191]
  v_add_u32_e64 v14, s75, v8
  v_mfma_f32_16x16x32_bf16 v[192:195], v[32:35], v[68:71], v[192:195]
  v_add_u32_e64 v15, s75, v9
  v_mfma_f32_16x16x32_bf16 v[196:199], v[36:39], v[68:71], v[196:199]
  s_add_u32 s75, s75, 43008
  v_mfma_f32_16x16x32_bf16 v[200:203], v[40:43], v[68:71], v[200:203]
  s_cmp_eq_u32 s75, 129024
  v_mfma_f32_16x16x32_bf16 v[204:207], v[44:47], v[68:71], v[204:207]
  s_cselect_b32 s75, 0, s75
  s_sub_u32 s79, s79, 1
  v_mfma_f32_16x16x32_bf16 v[232:235], v[48:51], v[68:71], v[232:235]
  v_mfma_f32_16x16x32_bf16 v[208:211], v[32:35], v[72:75], v[208:211]
  v_mfma_f32_16x16x32_bf16 v[212:215], v[36:39], v[72:75], v[212:215]
  v_mfma_f32_16x16x32_bf16 v[216:219], v[40:43], v[72:75], v[216:219]
  v_mfma_f32_16x16x32_bf16 v[220:223], v[44:47], v[72:75], v[220:223]
  s_waitcnt lgkmcnt(0)
  s_barrier
  v_mfma_f32_16x16x32_bf16 v[240:243], v[236:239], v[84:87], v[240:243]
  ds_read_b128 v[32:35], v10 offset:0
  v_mfma_f32_16x16x32_bf16 v[244:247], v[84:87], v[84:87], v[244:247]
  ds_read_b128 v[36:39], v10 offset:2048
  v_mfma_f32_16x16x32_bf16 v[248:251], v[236:239], v[88:91], v[248:251]
  ds_read_b128 v[40:43], v10 offset:4096
  v_mfma_f32_16x16x32_bf16 v[252:255], v[88:91], v[88:91], v[252:255]
  ds_read_b128 v[44:47], v10 offset:6144
  v_mfma_f32_16x16x32_bf16 v[128:131], v[96:99], v[76:79], v[128:131]
  ds_read_b128 v[48:51], v14
  v_mfma_f32_16x16x32_bf16 v[132:135], v[96:99], v[80:83], v[132:135]
  ds_read_b64_tr_b16 v[52:53], v12 offset:0
  v_mfma_f32_16x16x32_bf16 v[136:139], v[96:99], v[84:87], v[136:139]
  ds_read_b64_tr_b16 v[54:55], v12 offset:512
  v_mfma_f32_16x16x32_bf16 v[140:143], v[96:99], v[88:91], v[140:143]
  ds_read_b64_tr_b16 v[56:57], v13 offset:0
  v_mfma_f32_16x16x32_bf16 v[224:227], v[96:99], v[92:95], v[224:227]
  ds_read_b64_tr_b16 v[58:59], v13 offset:512
  v_mfma_f32_16x16x32_bf16 v[144:147], v[100:103], v[76:79], v[144:147]
  ds_read_b64_tr_b16 v[60:61], v12 offset:8192
  v_mfma_f32_16x16x32_bf16 v[148:151], v[100:103], v[80:83], v[148:151]
  ds_read_b64_tr_b16 v[62:63], v12 offset:8704
  v_mfma_f32_16x16x32_bf16 v[152:155], v[100:103], v[84:87], v[152:155]
  ds_read_b64_tr_b16 v[64:65], v13 offset:8192
  v_mfma_f32_16x16x32_bf16 v[156:159], v[100:103], v[88:91], v[156:159]
  ds_read_b64_tr_b16 v[66:67], v13 offset:8704
  v_mfma_f32_16x16x32_bf16 v[160:163], v[104:107], v[76:79], v[160:163]
  ds_read_b64_tr_b16 v[68:69], v12 offset:16384
  v_mfma_f32_16x16x32_bf16 v[164:167], v[104:107], v[80:83], v[164:167]
  ds_read_b64_tr_b16 v[70:71], v12 offset:16896
  v_mfma_f32_16x16x32_bf16 v[168:171], v[104:107], v[84:87], v[168:171]
  ds_read_b64_tr_b16 v[72:73], v13 offset:16384
  v_mfma_f32_16x16x32_bf16 v[172:175], v[104:107], v[88:91], v[172:175]
  ds_read_b64_tr_b16 v[74:75], v13 offset:16896
  v_mfma_f32_16x16x32_bf16 v[228:231], v[104:107], v[92:95], v[228:231]
  s_cmp_lg_u32 s79, 0
  s_nop 0
  v_mfma_f32_16x16x32_bf16 v[176:179], v[108:111], v[76:79], v[176:179]
  v_mfma_f32_16x16x32_bf16 v[180:183], v[108:111], v[80:83], v[180:183]
  v_mfma_f32_16x16x32_bf16 v[184:187], v[108:111], v[84:87], v[184:187]
  v_mfma_f32_16x16x32_bf16 v[188:191], v[108:111], v[88:91], v[188:191]
  v_mfma_f32_16x16x32_bf16 v[192:195], v[76:79], v[112:115], v[192:195]
  v_mfma_f32_16x16x32_bf16 v[196:199], v[80:83], v[112:115], v[196:199]
  v_mfma_f32_16x16x32_bf16 v[200:203], v[84:87], v[112:115], v[200:203]
  v_mfma_f32_16x16x32_bf16 v[204:207], v[88:91], v[112:115], v[204:207]
  v_mfma_f32_16x16x32_bf16 v[232:235], v[92:95], v[112:115], v[232:235]
  v_mfma_f32_16x16x32_bf16 v[208:211], v[76:79], v[116:119], v[208:211]
  v_mfma_f32_16x16x32_bf16 v[212:215], v[80:83], v[116:119], v[212:215]
  v_mfma_f32_16x16x32_bf16 v[216:219], v[84:87], v[116:119], v[216:219]
  v_mfma_f32_16x16x32_bf16 v[220:223], v[88:91], v[116:119], v[220:223]
  s_waitcnt lgkmcnt(0)
  s_cbranch_scc1 L_attn_loopb
L_attn_post:
  v_and_b32 v32, 3, v1
  v_cmp_eq_u32 s[4:5], 1, v32
  v_cmp_eq_u32 s[6:7], 2, v32
  v_cmp_eq_u32 s[8:9], 3, v32
  v_bfe_u32 v33, v1, 2, 2
  v_lshrrev_b32 v34, 4, v1
  v_cmp_eq_u32 s[10:11], v33, v34
  s_lshl_b32 s3, s72, 7
  v_add_u32 v35, s3, v23
  v_and_b32 v36, 15, v1
  s_cmp_eq_u32 s70, 0
  s_cselect_b32 s3, 0, 576
  s_add_u32 s3, s3, 129024
  v_lshl_add_u32 v36, v36, 2, s3
  v_cndmask_b32 v241, v244, v245, s[4:5]
  v_cndmask_b32 v249, v252, v253, s[4:5]
  v_cndmask_b32 v121, v124, v125, s[4:5]
  v_cndmask_b32 v241, v241, v246, s[6:7]
  v_cndmask_b32 v249, v249, v254, s[6:7]
  v_cndmask_b32 v121, v121, v126, s[6:7]
  v_cndmask_b32 v241, v241, v247, s[8:9]
  v_cndmask_b32 v249, v249, v255, s[8:9]
  v_cndmask_b32 v121, v121, v127, s[8:9]
  v_mul_f32 v240, 0x3a800000, v240
  v_mul_f32 v241, 0x3a800000, v241
  v_fma_f32 v241, -v240, v240, v241
  v_max_f32 v241, 0, v241
  v_add_f32 v241, 0x3727c5ac, v241
  v_rsq_f32 v241, v241
  s_nop 0
  v_mul_f32 v248, 0x3a800000, v248
  v_mul_f32 v249, 0x3a800000, v249
  v_fma_f32 v249, -v248, v248, v249
  v_max_f32 v249, 0, v249
  v_add_f32 v249, 0x3727c5ac, v249
  v_rsq_f32 v249, v249
  s_nop 0
  v_mul_f32 v120, 0x3a800000, v120
  v_mul_f32 v121, 0x3a800000, v121
  v_fma_f32 v121, -v120, v120, v121
  v_max_f32 v121, 0, v121
  v_add_f32 v121, 0x3727c5ac, v121
  v_rsq_f32 v121, v121
  s_nop 0
  s_mov_b64 exec, s[10:11]
  ds_write2_b32 v35, v240, v241 offset0:16 offset1:176
  ds_write2_b32 v35, v248, v249 offset0:32 offset1:192
  ds_write2_b32 v36, v120, v121 offset0:0 offset1:160
  s_mov_b64 exec, -1
  s_mov_b32 s36, s16
  s_and_b32 s37, s17, 0xffff
  s_mov_b32 s38, 4194304
  s_mov_b32 s39, 0x00020000
  s_and_b32 s3, s2, 3
  s_and_b32 s4, s99, 3
  s_lshl2_add_u32 s3, s3, s4
  s_lshl2_add_u32 s3, s3, s70
  s_lshl_b32 s3, s3, 16
  s_bfe_u32 s4, s2, 0x10002
  s_lshr_b32 s5, s99, 2
  s_lshl1_add_u32 s4, s5, s4
  s_lshl_b32 s4, s4, 7
  s_add_u32 s3, s3, s4
  s_add_u32 s4, s3, 32768
  v_and_b32 v32, 15, v1
  v_lshlrev_b32 v33, 1, v1
  v_and_b32 v33, 32, v33
  v_lshl_add_u32 v32, v32, 11, v33
  v_lshrrev_b32 v33, 1, v1
  v_and_b32 v33, 16, v33
  v_add_u32 v32, v32, v33
  s_waitcnt lgkmcnt(0)
  buffer_load_dwordx4 v[240:243], v32, s[36:39], s3 offen offset:0
  buffer_load_dwordx4 v[244:247], v32, s[36:39], s3 offen offset:64
  buffer_load_dwordx4 v[248:251], v32, s[36:39], s4 offen offset:0
  buffer_load_dwordx4 v[252:255], v32, s[36:39], s4 offen offset:64
  s_barrier
  s_branch L_attn_exit
.p2align 3
L_attn_loop:
  v_mfma_f32_16x16x32_bf16 v[128:131], v[52:55], v[32:35], v[128:131]
  ds_read_b128 v[76:79], v11 offset:0
  v_mfma_f32_16x16x32_bf16 v[132:135], v[52:55], v[36:39], v[132:135]
  ds_read_b128 v[80:83], v11 offset:2048
  v_mfma_f32_16x16x32_bf16 v[136:139], v[52:55], v[40:43], v[136:139]
  ds_read_b128 v[84:87], v11 offset:4096
  v_mfma_f32_16x16x32_bf16 v[140:143], v[52:55], v[44:47], v[140:143]
  ds_read_b128 v[88:91], v11 offset:6144
  v_mfma_f32_16x16x32_bf16 v[224:227], v[52:55], v[48:51], v[224:227]
  ds_read_b128 v[92:95], v15
  v_mfma_f32_16x16x32_bf16 v[144:147], v[56:59], v[32:35], v[144:147]
  ds_read_b64_tr_b16 v[96:97], v12 offset:4096
  v_mfma_f32_16x16x32_bf16 v[148:151], v[56:59], v[36:39], v[148:151]
  ds_read_b64_tr_b16 v[98:99], v12 offset:4608
  v_mfma_f32_16x16x32_bf16 v[152:155], v[56:59], v[40:43], v[152:155]
  ds_read_b64_tr_b16 v[100:101], v13 offset:4096
  v_mfma_f32_16x16x32_bf16 v[156:159], v[56:59], v[44:47], v[156:159]
  ds_read_b64_tr_b16 v[102:103], v13 offset:4608
  v_mfma_f32_16x16x32_bf16 v[160:163], v[60:63], v[32:35], v[160:163]
  ds_read_b64_tr_b16 v[104:105], v12 offset:12288
  v_mfma_f32_16x16x32_bf16 v[164:167], v[60:63], v[36:39], v[164:167]
  ds_read_b64_tr_b16 v[106:107], v12 offset:12800
  v_mfma_f32_16x16x32_bf16 v[168:171], v[60:63], v[40:43], v[168:171]
  ds_read_b64_tr_b16 v[108:109], v13 offset:12288
  v_mfma_f32_16x16x32_bf16 v[172:175], v[60:63], v[44:47], v[172:175]
  ds_read_b64_tr_b16 v[110:111], v13 offset:12800
  v_mfma_f32_16x16x32_bf16 v[228:231], v[60:63], v[48:51], v[228:231]
  ds_read_b64_tr_b16 v[112:113], v12 offset:20480
  v_mfma_f32_16x16x32_bf16 v[176:179], v[64:67], v[32:35], v[176:179]
  ds_read_b64_tr_b16 v[114:115], v12 offset:20992
  v_mfma_f32_16x16x32_bf16 v[180:183], v[64:67], v[36:39], v[180:183]
  ds_read_b64_tr_b16 v[116:117], v13 offset:20480
  v_mfma_f32_16x16x32_bf16 v[184:187], v[64:67], v[40:43], v[184:187]
  ds_read_b64_tr_b16 v[118:119], v13 offset:20992
  v_mfma_f32_16x16x32_bf16 v[188:191], v[64:67], v[44:47], v[188:191]
  v_add_u32_e64 v10, s75, v4
  v_mfma_f32_16x16x32_bf16 v[192:195], v[32:35], v[68:71], v[192:195]
  v_add_u32_e64 v11, s75, v5
  v_mfma_f32_16x16x32_bf16 v[196:199], v[36:39], v[68:71], v[196:199]
  v_add_u32_e64 v12, s75, v6
  v_mfma_f32_16x16x32_bf16 v[200:203], v[40:43], v[68:71], v[200:203]
  v_add_u32_e64 v13, s75, v7
  v_mfma_f32_16x16x32_bf16 v[204:207], v[44:47], v[68:71], v[204:207]
  v_add_u32_e64 v14, s75, v8
  v_mfma_f32_16x16x32_bf16 v[232:235], v[48:51], v[68:71], v[232:235]
  v_add_u32_e64 v15, s75, v9
  v_mfma_f32_16x16x32_bf16 v[208:211], v[32:35], v[72:75], v[208:211]
  s_add_u32 s75, s75, 43008
  v_mfma_f32_16x16x32_bf16 v[212:215], v[36:39], v[72:75], v[212:215]
  s_cmp_eq_u32 s75, 129024
  v_mfma_f32_16x16x32_bf16 v[216:219], v[40:43], v[72:75], v[216:219]
  s_cselect_b32 s75, 0, s75
  s_sub_u32 s79, s79, 1
  v_mfma_f32_16x16x32_bf16 v[220:223], v[44:47], v[72:75], v[220:223]
  s_waitcnt lgkmcnt(0)
  s_barrier
  v_mfma_f32_16x16x32_bf16 v[128:131], v[96:99], v[76:79], v[128:131]
  ds_read_b128 v[32:35], v10 offset:0
  v_mfma_f32_16x16x32_bf16 v[132:135], v[96:99], v[80:83], v[132:135]
  ds_read_b128 v[36:39], v10 offset:2048
  v_mfma_f32_16x16x32_bf16 v[136:139], v[96:99], v[84:87], v[136:139]
  ds_read_b128 v[40:43], v10 offset:4096
  v_mfma_f32_16x16x32_bf16 v[140:143], v[96:99], v[88:91], v[140:143]
  ds_read_b128 v[44:47], v10 offset:6144
  v_mfma_f32_16x16x32_bf16 v[224:227], v[96:99], v[92:95], v[224:227]
  ds_read_b128 v[48:51], v14
  v_mfma_f32_16x16x32_bf16 v[144:147], v[100:103], v[76:79], v[144:147]
  ds_read_b64_tr_b16 v[52:53], v12 offset:0
  v_mfma_f32_16x16x32_bf16 v[148:151], v[100:103], v[80:83], v[148:151]
  ds_read_b64_tr_b16 v[54:55], v12 offset:512
  v_mfma_f32_16x16x32_bf16 v[152:155], v[100:103], v[84:87], v[152:155]
  ds_read_b64_tr_b16 v[56:57], v13 offset:0
  v_mfma_f32_16x16x32_bf16 v[156:159], v[100:103], v[88:91], v[156:159]
  ds_read_b64_tr_b16 v[58:59], v13 offset:512
  v_mfma_f32_16x16x32_bf16 v[160:163], v[104:107], v[76:79], v[160:163]
  ds_read_b64_tr_b16 v[60:61], v12 offset:8192
  v_mfma_f32_16x16x32_bf16 v[164:167], v[104:107], v[80:83], v[164:167]
  ds_read_b64_tr_b16 v[62:63], v12 offset:8704
  v_mfma_f32_16x16x32_bf16 v[168:171], v[104:107], v[84:87], v[168:171]
  ds_read_b64_tr_b16 v[64:65], v13 offset:8192
  v_mfma_f32_16x16x32_bf16 v[172:175], v[104:107], v[88:91], v[172:175]
  ds_read_b64_tr_b16 v[66:67], v13 offset:8704
  v_mfma_f32_16x16x32_bf16 v[228:231], v[104:107], v[92:95], v[228:231]
  ds_read_b64_tr_b16 v[68:69], v12 offset:16384
  v_mfma_f32_16x16x32_bf16 v[176:179], v[108:111], v[76:79], v[176:179]
  ds_read_b64_tr_b16 v[70:71], v12 offset:16896
  v_mfma_f32_16x16x32_bf16 v[180:183], v[108:111], v[80:83], v[180:183]
  ds_read_b64_tr_b16 v[72:73], v13 offset:16384
  v_mfma_f32_16x16x32_bf16 v[184:187], v[108:111], v[84:87], v[184:187]
  ds_read_b64_tr_b16 v[74:75], v13 offset:16896
  v_mfma_f32_16x16x32_bf16 v[188:191], v[108:111], v[88:91], v[188:191]
  s_cmp_lg_u32 s79, 0
  s_nop 0
  v_mfma_f32_16x16x32_bf16 v[192:195], v[76:79], v[112:115], v[192:195]
  v_mfma_f32_16x16x32_bf16 v[196:199], v[80:83], v[112:115], v[196:199]
  v_mfma_f32_16x16x32_bf16 v[200:203], v[84:87], v[112:115], v[200:203]
  v_mfma_f32_16x16x32_bf16 v[204:207], v[88:91], v[112:115], v[204:207]
  v_mfma_f32_16x16x32_bf16 v[232:235], v[92:95], v[112:115], v[232:235]
  v_mfma_f32_16x16x32_bf16 v[208:211], v[76:79], v[116:119], v[208:211]
  v_mfma_f32_16x16x32_bf16 v[212:215], v[80:83], v[116:119], v[212:215]
  v_mfma_f32_16x16x32_bf16 v[216:219], v[84:87], v[116:119], v[216:219]
  v_mfma_f32_16x16x32_bf16 v[220:223], v[88:91], v[116:119], v[220:223]
  s_waitcnt lgkmcnt(0)
  s_cbranch_scc1 L_attn_loop
L_attn_exit:
  ds_read2_b32 v[66:67], v23 offset0:0 offset1:160
  ds_read2_b32 v[68:69], v23 offset0:16 offset1:176
  ds_read2_b32 v[70:71], v23 offset0:32 offset1:192
  ds_read2_b32 v[72:73], v23 offset0:48 offset1:208
  ds_read2_b32 v[74:75], v23 offset0:64 offset1:224
  ds_read2_b32 v[76:77], v25 offset0:0 offset1:16
  ds_read2_b32 v[80:81], v26 offset0:0 offset1:16
  ds_read2_b32 v[78:79], v25 offset0:32 offset1:48
  ds_read2_b32 v[82:83], v26 offset0:32 offset1:48
  ds_write_b128 v16, v[224:227] offset:0
  ds_write_b128 v16, v[228:231] offset:2048
  ds_write_b128 v16, v[232:235] offset:4096
  s_cmp_eq_u32 s71, 1
  s_cbranch_scc1 L_attn_nop3
  ds_write_b128 v16, v[172:175] offset:8192
  ds_write_b128 v16, v[188:191] offset:9216
  ds_write_b128 v16, v[204:207] offset:10240
  ds_write_b128 v16, v[220:223] offset:11264
L_attn_nop3:
  ds_read_b128 v[84:87], v24 offset:0
  ds_read_b128 v[104:107], v24 offset:640
  ds_read_b128 v[88:91], v24 offset:64
  ds_read_b128 v[108:111], v24 offset:704
  ds_read_b128 v[92:95], v24 offset:128
  ds_read_b128 v[112:115], v24 offset:768
  ds_read_b128 v[96:99], v24 offset:192
  ds_read_b128 v[116:119], v24 offset:832
  ds_read_b128 v[100:103], v24 offset:256
  ds_read_b128 v[120:123], v24 offset:896
  s_waitcnt lgkmcnt(10)
  s_barrier
  ds_read_b128 v[48:51], v19 offset:0
  ds_read_b128 v[52:55], v20 offset:1024
  ds_read_b128 v[56:59], v19 offset:2048
  ds_read_b128 v[60:63], v20 offset:3072
  ds_read_b32 v64, v21 offset:4096
  ds_read_b32 v65, v22 offset:5120
  ds_read_b128 v[32:35], v17 offset:2048
  ds_read_b128 v[36:39], v18 offset:3072
  ds_read_b128 v[40:43], v17 offset:4096
  ds_read_b128 v[44:47], v18 offset:5120
  v_mul_f32 v69, 0x3e8293ee, v69
  v_mul_f32 v71, 0x3e8293ee, v71
  v_mul_f32 v73, 0x3e8293ee, v73
  v_mul_f32 v75, 0x3e8293ee, v75
  v_mul_f32 v76, v76, v69
  v_mul_f32 v80, v80, v69
  v_mul_f32 v77, v77, v71
  v_mul_f32 v81, v81, v71
  v_mul_f32 v78, v78, v73
  v_mul_f32 v82, v82, v73
  v_mul_f32 v79, v79, v75
  v_mul_f32 v83, v83, v75
  s_waitcnt lgkmcnt(6)
  v_pk_fma_f32 v[128:129], v[48:49], v[68:69], v[128:129] op_sel:[0,0,0] op_sel_hi:[1,0,1] neg_lo:[0,1,0] neg_hi:[0,1,0]
  v_pk_fma_f32 v[130:131], v[50:51], v[68:69], v[130:131] op_sel:[0,0,0] op_sel_hi:[1,0,1] neg_lo:[0,1,0] neg_hi:[0,1,0]
  v_pk_fma_f32 v[144:145], v[52:53], v[68:69], v[144:145] op_sel:[0,0,0] op_sel_hi:[1,0,1] neg_lo:[0,1,0] neg_hi:[0,1,0]
  v_pk_fma_f32 v[146:147], v[54:55], v[68:69], v[146:147] op_sel:[0,0,0] op_sel_hi:[1,0,1] neg_lo:[0,1,0] neg_hi:[0,1,0]
  v_cvt_pk_bf16_f32 v128, v128, v129
  v_cvt_pk_bf16_f32 v129, v130, v131
  v_cvt_pk_bf16_f32 v130, v144, v145
  v_cvt_pk_bf16_f32 v131, v146, v147
  v_pk_fma_f32 v[160:161], v[56:57], v[68:69], v[160:161] op_sel:[0,0,0] op_sel_hi:[1,0,1] neg_lo:[0,1,0] neg_hi:[0,1,0]
  v_pk_fma_f32 v[162:163], v[58:59], v[68:69], v[162:163] op_sel:[0,0,0] op_sel_hi:[1,0,1] neg_lo:[0,1,0] neg_hi:[0,1,0]
  v_pk_fma_f32 v[176:177], v[60:61], v[68:69], v[176:177] op_sel:[0,0,0] op_sel_hi:[1,0,1] neg_lo:[0,1,0] neg_hi:[0,1,0]
  v_pk_fma_f32 v[178:179], v[62:63], v[68:69], v[178:179] op_sel:[0,0,0] op_sel_hi:[1,0,1] neg_lo:[0,1,0] neg_hi:[0,1,0]
  v_cvt_pk_bf16_f32 v160, v160, v161
  v_cvt_pk_bf16_f32 v161, v162, v163
  v_cvt_pk_bf16_f32 v162, v176, v177
  v_cvt_pk_bf16_f32 v163, v178, v179
  v_pk_fma_f32 v[132:133], v[48:49], v[70:71], v[132:133] op_sel:[0,0,0] op_sel_hi:[1,0,1] neg_lo:[0,1,0] neg_hi:[0,1,0]
  v_pk_fma_f32 v[134:135], v[50:51], v[70:71], v[134:135] op_sel:[0,0,0] op_sel_hi:[1,0,1] neg_lo:[0,1,0] neg_hi:[0,1,0]
  v_pk_fma_f32 v[148:149], v[52:53], v[70:71], v[148:149] op_sel:[0,0,0] op_sel_hi:[1,0,1] neg_lo:[0,1,0] neg_hi:[0,1,0]
  v_pk_fma_f32 v[150:151], v[54:55], v[70:71], v[150:151] op_sel:[0,0,0] op_sel_hi:[1,0,1] neg_lo:[0,1,0] neg_hi:[0,1,0]
  v_cvt_pk_bf16_f32 v132, v132, v133
  v_cvt_pk_bf16_f32 v133, v134, v135
  v_cvt_pk_bf16_f32 v134, v148, v149
  v_cvt_pk_bf16_f32 v135, v150, v151
  v_pk_fma_f32 v[164:165], v[56:57], v[70:71], v[164:165] op_sel:[0,0,0] op_sel_hi:[1,0,1] neg_lo:[0,1,0] neg_hi:[0,1,0]
  v_pk_fma_f32 v[166:167], v[58:59], v[70:71], v[166:167] op_sel:[0,0,0] op_sel_hi:[1,0,1] neg_lo:[0,1,0] neg_hi:[0,1,0]
  v_pk_fma_f32 v[180:181], v[60:61], v[70:71], v[180:181] op_sel:[0,0,0] op_sel_hi:[1,0,1] neg_lo:[0,1,0] neg_hi:[0,1,0]
  v_pk_fma_f32 v[182:183], v[62:63], v[70:71], v[182:183] op_sel:[0,0,0] op_sel_hi:[1,0,1] neg_lo:[0,1,0] neg_hi:[0,1,0]
  v_cvt_pk_bf16_f32 v164, v164, v165
  v_cvt_pk_bf16_f32 v165, v166, v167
  v_cvt_pk_bf16_f32 v166, v180, v181
  v_cvt_pk_bf16_f32 v167, v182, v183
  v_mfma_f32_16x16x32_bf16 v[144:147], v[160:163], v[128:131], 0
  v_pk_fma_f32 v[136:137], v[48:49], v[72:73], v[136:137] op_sel:[0,0,0] op_sel_hi:[1,0,1] neg_lo:[0,1,0] neg_hi:[0,1,0]
  v_pk_fma_f32 v[138:139], v[50:51], v[72:73], v[138:139] op_sel:[0,0,0] op_sel_hi:[1,0,1] neg_lo:[0,1,0] neg_hi:[0,1,0]
  v_pk_fma_f32 v[152:153], v[52:53], v[72:73], v[152:153] op_sel:[0,0,0] op_sel_hi:[1,0,1] neg_lo:[0,1,0] neg_hi:[0,1,0]
  v_pk_fma_f32 v[154:155], v[54:55], v[72:73], v[154:155] op_sel:[0,0,0] op_sel_hi:[1,0,1] neg_lo:[0,1,0] neg_hi:[0,1,0]
  v_cvt_pk_bf16_f32 v136, v136, v137
  v_cvt_pk_bf16_f32 v137, v138, v139
  v_cvt_pk_bf16_f32 v138, v152, v153
  v_cvt_pk_bf16_f32 v139, v154, v155
  v_pk_fma_f32 v[168:169], v[56:57], v[72:73], v[168:169] op_sel:[0,0,0] op_sel_hi:[1,0,1] neg_lo:[0,1,0] neg_hi:[0,1,0]
  v_pk_fma_f32 v[170:171], v[58:59], v[72:73], v[170:171] op_sel:[0,0,0] op_sel_hi:[1,0,1] neg_lo:[0,1,0] neg_hi:[0,1,0]
  v_pk_fma_f32 v[184:185], v[60:61], v[72:73], v[184:185] op_sel:[0,0,0] op_sel_hi:[1,0,1] neg_lo:[0,1,0] neg_hi:[0,1,0]
  v_pk_fma_f32 v[186:187], v[62:63], v[72:73], v[186:187] op_sel:[0,0,0] op_sel_hi:[1,0,1] neg_lo:[0,1,0] neg_hi:[0,1,0]
  v_cvt_pk_bf16_f32 v168, v168, v169
  v_cvt_pk_bf16_f32 v169, v170, v171
  v_cvt_pk_bf16_f32 v170, v184, v185
  v_cvt_pk_bf16_f32 v171, v186, v187
  v_mfma_f32_16x16x32_bf16 v[148:151], v[164:167], v[132:135], 0
  v_mfma_f32_16x16x32_bf16 v[180:183], v[160:163], v[132:135], 0
  v_pk_fma_f32 v[140:141], v[48:49], v[74:75], v[140:141] op_sel:[0,0,0] op_sel_hi:[1,0,1] neg_lo:[0,1,0] neg_hi:[0,1,0]
  v_pk_fma_f32 v[142:143], v[50:51], v[74:75], v[142:143] op_sel:[0,0,0] op_sel_hi:[1,0,1] neg_lo:[0,1,0] neg_hi:[0,1,0]
  v_pk_fma_f32 v[156:157], v[52:53], v[74:75], v[156:157] op_sel:[0,0,0] op_sel_hi:[1,0,1] neg_lo:[0,1,0] neg_hi:[0,1,0]
  v_pk_fma_f32 v[158:159], v[54:55], v[74:75], v[158:159] op_sel:[0,0,0] op_sel_hi:[1,0,1] neg_lo:[0,1,0] neg_hi:[0,1,0]
  v_cvt_pk_bf16_f32 v140, v140, v141
  v_cvt_pk_bf16_f32 v141, v142, v143
  v_cvt_pk_bf16_f32 v142, v156, v157
  v_cvt_pk_bf16_f32 v143, v158, v159
  v_pk_fma_f32 v[172:173], v[56:57], v[74:75], v[172:173] op_sel:[0,0,0] op_sel_hi:[1,0,1] neg_lo:[0,1,0] neg_hi:[0,1,0]
  v_pk_fma_f32 v[174:175], v[58:59], v[74:75], v[174:175] op_sel:[0,0,0] op_sel_hi:[1,0,1] neg_lo:[0,1,0] neg_hi:[0,1,0]
  v_pk_fma_f32 v[188:189], v[60:61], v[74:75], v[188:189] op_sel:[0,0,0] op_sel_hi:[1,0,1] neg_lo:[0,1,0] neg_hi:[0,1,0]
  v_pk_fma_f32 v[190:191], v[62:63], v[74:75], v[190:191] op_sel:[0,0,0] op_sel_hi:[1,0,1] neg_lo:[0,1,0] neg_hi:[0,1,0]
  v_cvt_pk_bf16_f32 v172, v172, v173
  v_cvt_pk_bf16_f32 v173, v174, v175
  v_cvt_pk_bf16_f32 v174, v188, v189
  v_cvt_pk_bf16_f32 v175, v190, v191
  s_waitcnt lgkmcnt(0)
  v_pk_fma_f32 v[32:33], v[56:57], v[66:67], v[32:33] op_sel:[0,0,0] op_sel_hi:[1,0,1] neg_lo:[0,1,0] neg_hi:[0,1,0]
  v_pk_fma_f32 v[34:35], v[58:59], v[66:67], v[34:35] op_sel:[0,0,0] op_sel_hi:[1,0,1] neg_lo:[0,1,0] neg_hi:[0,1,0]
  v_pk_fma_f32 v[36:37], v[60:61], v[66:67], v[36:37] op_sel:[0,0,0] op_sel_hi:[1,0,1] neg_lo:[0,1,0] neg_hi:[0,1,0]
  v_pk_fma_f32 v[38:39], v[62:63], v[66:67], v[38:39] op_sel:[0,0,0] op_sel_hi:[1,0,1] neg_lo:[0,1,0] neg_hi:[0,1,0]
  v_cvt_pk_bf16_f32 v32, v32, v33
  v_cvt_pk_bf16_f32 v33, v34, v35
  v_cvt_pk_bf16_f32 v34, v36, v37
  v_cvt_pk_bf16_f32 v35, v38, v39
  v_mfma_f32_16x16x32_bf16 v[152:155], v[168:171], v[136:139], 0
  v_mfma_f32_16x16x32_bf16 v[184:187], v[164:167], v[136:139], 0
  v_mfma_f32_16x16x32_bf16 v[156:159], v[172:175], v[140:143], 0
  v_mfma_f32_16x16x32_bf16 v[188:191], v[168:171], v[140:143], 0
  v_mfma_f32_16x16x32_bf16 v[176:179], v[32:35], v[128:131], 0
  v_pk_fma_f32 v[40:41], v[84:85], v[64:65], v[40:41] op_sel:[0,0,0] op_sel_hi:[1,0,1] neg_lo:[1,0,0] neg_hi:[1,0,0]
  v_pk_fma_f32 v[42:43], v[86:87], v[64:65], v[42:43] op_sel:[0,0,0] op_sel_hi:[1,0,1] neg_lo:[1,0,0] neg_hi:[1,0,0]
  v_pk_mul_f32 v[40:41], v[40:41], v[104:105]
  v_pk_mul_f32 v[42:43], v[42:43], v[106:107]
  v_cvt_pk_bf16_f32 v4, v40, v41
  v_cvt_pk_bf16_f32 v5, v42, v43
  v_pk_fma_f32 v[192:193], v[88:89], v[64:65], v[192:193] op_sel:[0,0,0] op_sel_hi:[1,0,1] neg_lo:[1,0,0] neg_hi:[1,0,0]
  v_pk_fma_f32 v[194:195], v[90:91], v[64:65], v[194:195] op_sel:[0,0,0] op_sel_hi:[1,0,1] neg_lo:[1,0,0] neg_hi:[1,0,0]
  v_pk_mul_f32 v[192:193], v[192:193], v[108:109]
  v_pk_mul_f32 v[194:195], v[194:195], v[110:111]
  v_cvt_pk_bf16_f32 v6, v192, v193
  v_cvt_pk_bf16_f32 v7, v194, v195
  v_pk_fma_f32 v[196:197], v[92:93], v[64:65], v[196:197] op_sel:[0,0,0] op_sel_hi:[1,0,1] neg_lo:[1,0,0] neg_hi:[1,0,0]
  v_pk_fma_f32 v[198:199], v[94:95], v[64:65], v[198:199] op_sel:[0,0,0] op_sel_hi:[1,0,1] neg_lo:[1,0,0] neg_hi:[1,0,0]
  v_pk_mul_f32 v[196:197], v[196:197], v[112:113]
  v_pk_mul_f32 v[198:199], v[198:199], v[114:115]
  v_cvt_pk_bf16_f32 v8, v196, v197
  v_cvt_pk_bf16_f32 v9, v198, v199
  v_pk_fma_f32 v[200:201], v[96:97], v[64:65], v[200:201] op_sel:[0,0,0] op_sel_hi:[1,0,1] neg_lo:[1,0,0] neg_hi:[1,0,0]
  v_pk_fma_f32 v[202:203], v[98:99], v[64:65], v[202:203] op_sel:[0,0,0] op_sel_hi:[1,0,1] neg_lo:[1,0,0] neg_hi:[1,0,0]
  v_pk_mul_f32 v[200:201], v[200:201], v[116:117]
  v_pk_mul_f32 v[202:203], v[202:203], v[118:119]
  v_cvt_pk_bf16_f32 v10, v200, v201
  v_cvt_pk_bf16_f32 v11, v202, v203
  v_pk_fma_f32 v[204:205], v[100:101], v[64:65], v[204:205] op_sel:[0,0,0] op_sel_hi:[1,0,1] neg_lo:[1,0,0] neg_hi:[1,0,0]
  v_pk_fma_f32 v[206:207], v[102:103], v[64:65], v[206:207] op_sel:[0,0,0] op_sel_hi:[1,0,1] neg_lo:[1,0,0] neg_hi:[1,0,0]
  v_pk_mul_f32 v[204:205], v[204:205], v[120:121]
  v_pk_mul_f32 v[206:207], v[206:207], v[122:123]
  v_cvt_pk_bf16_f32 v12, v204, v205
  v_cvt_pk_bf16_f32 v13, v206, v207
  v_pk_fma_f32 v[44:45], v[84:85], v[64:65], v[44:45] op_sel:[0,1,0] op_sel_hi:[1,1,1] neg_lo:[1,0,0] neg_hi:[1,0,0]
  v_pk_fma_f32 v[46:47], v[86:87], v[64:65], v[46:47] op_sel:[0,1,0] op_sel_hi:[1,1,1] neg_lo:[1,0,0] neg_hi:[1,0,0]
  v_pk_mul_f32 v[44:45], v[44:45], v[104:105]
  v_pk_mul_f32 v[46:47], v[46:47], v[106:107]
  v_cvt_pk_bf16_f32 v224, v44, v45
  v_cvt_pk_bf16_f32 v225, v46, v47
  v_pk_fma_f32 v[208:209], v[88:89], v[64:65], v[208:209] op_sel:[0,1,0] op_sel_hi:[1,1,1] neg_lo:[1,0,0] neg_hi:[1,0,0]
  v_pk_fma_f32 v[210:211], v[90:91], v[64:65], v[210:211] op_sel:[0,1,0] op_sel_hi:[1,1,1] neg_lo:[1,0,0] neg_hi:[1,0,0]
  v_pk_mul_f32 v[208:209], v[208:209], v[108:109]
  v_pk_mul_f32 v[210:211], v[210:211], v[110:111]
  v_cvt_pk_bf16_f32 v226, v208, v209
  v_cvt_pk_bf16_f32 v227, v210, v211
  v_pk_fma_f32 v[212:213], v[92:93], v[64:65], v[212:213] op_sel:[0,1,0] op_sel_hi:[1,1,1] neg_lo:[1,0,0] neg_hi:[1,0,0]
  v_pk_fma_f32 v[214:215], v[94:95], v[64:65], v[214:215] op_sel:[0,1,0] op_sel_hi:[1,1,1] neg_lo:[1,0,0] neg_hi:[1,0,0]
  v_pk_mul_f32 v[212:213], v[212:213], v[112:113]
  v_pk_mul_f32 v[214:215], v[214:215], v[114:115]
  v_cvt_pk_bf16_f32 v228, v212, v213
  v_cvt_pk_bf16_f32 v229, v214, v215
  v_pk_fma_f32 v[216:217], v[96:97], v[64:65], v[216:217] op_sel:[0,1,0] op_sel_hi:[1,1,1] neg_lo:[1,0,0] neg_hi:[1,0,0]
  v_pk_fma_f32 v[218:219], v[98:99], v[64:65], v[218:219] op_sel:[0,1,0] op_sel_hi:[1,1,1] neg_lo:[1,0,0] neg_hi:[1,0,0]
  v_pk_mul_f32 v[216:217], v[216:217], v[116:117]
  v_pk_mul_f32 v[218:219], v[218:219], v[118:119]
  v_cvt_pk_bf16_f32 v230, v216, v217
  v_cvt_pk_bf16_f32 v231, v218, v219
  v_pk_fma_f32 v[220:221], v[100:101], v[64:65], v[220:221] op_sel:[0,1,0] op_sel_hi:[1,1,1] neg_lo:[1,0,0] neg_hi:[1,0,0]
  v_pk_fma_f32 v[222:223], v[102:103], v[64:65], v[222:223] op_sel:[0,1,0] op_sel_hi:[1,1,1] neg_lo:[1,0,0] neg_hi:[1,0,0]
  v_pk_mul_f32 v[220:221], v[220:221], v[120:121]
  v_pk_mul_f32 v[222:223], v[222:223], v[122:123]
  v_cvt_pk_bf16_f32 v232, v220, v221
  v_cvt_pk_bf16_f32 v233, v222, v223
  v_cndmask_b32 v148, v148, v149, s[48:49]
  v_cndmask_b32 v180, v180, v181, s[48:49]
  v_cndmask_b32 v150, v150, v151, s[48:49]
  v_cndmask_b32 v182, v182, v183, s[48:49]
  v_cndmask_b32 v36, v148, v180, s[50:51]
  v_cndmask_b32 v37, v150, v182, s[52:53]
  v_mul_f32 v36, v36, v77
  v_mul_f32 v37, v37, v81
  v_cndmask_b32 v152, v152, v153, s[48:49]
  v_cndmask_b32 v184, v184, v185, s[48:49]
  v_cndmask_b32 v154, v154, v155, s[48:49]
  v_cndmask_b32 v186, v186, v187, s[48:49]
  v_cndmask_b32 v40, v152, v184, s[50:51]
  v_cndmask_b32 v41, v154, v186, s[52:53]
  v_mul_f32 v40, v40, v78
  v_mul_f32 v41, v41, v82
  v_cndmask_b32 v156, v156, v157, s[48:49]
  v_cndmask_b32 v188, v188, v189, s[48:49]
  v_cndmask_b32 v158, v158, v159, s[48:49]
  v_cndmask_b32 v190, v190, v191, s[48:49]
  v_cndmask_b32 v44, v156, v188, s[50:51]
  v_cndmask_b32 v45, v158, v190, s[52:53]
  v_mul_f32 v44, v44, v79
  v_mul_f32 v45, v45, v83
  v_cndmask_b32 v144, v144, v145, s[48:49]
  v_cndmask_b32 v176, v176, v177, s[48:49]
  v_cndmask_b32 v146, v146, v147, s[48:49]
  v_cndmask_b32 v178, v178, v179, s[48:49]
  v_cndmask_b32 v32, v144, v176, s[50:51]
  v_cndmask_b32 v33, v146, v178, s[52:53]
  v_mul_f32 v32, v32, v76
  v_mul_f32 v33, v33, v80
  v_mov_b32 v48, 0xceabfb8f
  v_cndmask_b32 v32, v32, v48, s[54:55]
  v_cndmask_b32 v33, v33, v48, s[14:15]
  v_max_f32 v34, v32, v33
  v_max_f32 v38, v36, v37
  v_max_f32 v42, v40, v41
  v_max_f32 v46, v44, v45
  v_mov_b32 v35, v34
  v_mov_b32 v39, v38
  v_mov_b32 v43, v42
  v_mov_b32 v47, v46
  v_permlane32_swap_b32 v34, v35
  v_permlane32_swap_b32 v38, v39
  v_permlane32_swap_b32 v42, v43
  v_permlane32_swap_b32 v46, v47
  v_max_f32 v34, v34, v35
  v_max_f32 v38, v38, v39
  v_max_f32 v42, v42, v43
  v_max_f32 v46, v46, v47
  v_mov_b32 v35, v34
  v_mov_b32 v39, v38
  v_mov_b32 v43, v42
  v_mov_b32 v47, v46
  v_permlane16_swap_b32 v34, v35
  v_permlane16_swap_b32 v38, v39
  v_permlane16_swap_b32 v42, v43
  v_permlane16_swap_b32 v46, v47
  v_max_f32 v34, v34, v35
  v_max_f32 v38, v38, v39
  v_max_f32 v42, v42, v43
  v_max_f32 v46, v46, v47
  v_sub_f32 v32, v32, v34
  v_sub_f32 v33, v33, v34
  v_sub_f32 v36, v36, v38
  v_sub_f32 v37, v37, v38
  v_sub_f32 v40, v40, v42
  v_sub_f32 v41, v41, v42
  v_sub_f32 v44, v44, v46
  v_sub_f32 v45, v45, v46
  v_exp_f32 v32, v32
  v_exp_f32 v33, v33
  v_exp_f32 v36, v36
  v_exp_f32 v37, v37
  v_exp_f32 v40, v40
  v_exp_f32 v41, v41
  v_exp_f32 v44, v44
  v_exp_f32 v45, v45
  v_cvt_pk_bf16_f32 v32, v32, v32
  v_cvt_pk_bf16_f32 v33, v33, v33
  v_and_b32 v128, v32, v27
  v_and_b32 v129, v33, v29
  v_and_b32 v130, v32, v28
  v_and_b32 v131, v33, v30
  v_cvt_pk_bf16_f32 v36, v36, v36
  v_cvt_pk_bf16_f32 v37, v37, v37
  v_and_b32 v132, v36, v27
  v_and_b32 v133, v37, v29
  v_and_b32 v134, v36, v28
  v_and_b32 v135, v37, v30
  v_mfma_f32_16x16x32_bf16 v[144:147], v[236:239], v[128:131], 0
  v_mfma_f32_16x16x32_bf16 v[192:195], v[4:7], v[128:131], 0
  v_mfma_f32_16x16x32_bf16 v[208:211], v[224:227], v[128:131], 0
  v_cvt_pk_bf16_f32 v40, v40, v40
  v_cvt_pk_bf16_f32 v41, v41, v41
  v_and_b32 v136, v40, v27
  v_and_b32 v137, v41, v29
  v_and_b32 v138, v40, v28
  v_and_b32 v139, v41, v30
  v_mfma_f32_16x16x32_bf16 v[148:151], v[236:239], v[132:135], 0
  v_mfma_f32_16x16x32_bf16 v[196:199], v[6:9], v[132:135], 0
  v_mfma_f32_16x16x32_bf16 v[212:215], v[226:229], v[132:135], 0
  v_cvt_pk_bf16_f32 v44, v44, v44
  v_cvt_pk_bf16_f32 v45, v45, v45
  v_and_b32 v140, v44, v27
  v_and_b32 v141, v45, v29
  v_and_b32 v142, v44, v28
  v_and_b32 v143, v45, v30
  v_mfma_f32_16x16x32_bf16 v[152:155], v[236:239], v[136:139], 0
  v_mfma_f32_16x16x32_bf16 v[200:203], v[8:11], v[136:139], 0
  v_mfma_f32_16x16x32_bf16 v[216:219], v[228:231], v[136:139], 0
  v_mfma_f32_16x16x32_bf16 v[156:159], v[236:239], v[140:143], 0
  v_mfma_f32_16x16x32_bf16 v[204:207], v[10:13], v[140:143], 0
  v_mfma_f32_16x16x32_bf16 v[220:223], v[230:233], v[140:143], 0
  v_rcp_f32 v144, v144
  s_mov_b32 s3, 0
  v_pk_mul_f32 v[192:193], v[192:193], v[144:145] op_sel_hi:[1,0]
  v_pk_mul_f32 v[194:195], v[194:195], v[144:145] op_sel_hi:[1,0]
  v_pk_mul_f32 v[208:209], v[208:209], v[144:145] op_sel_hi:[1,0]
  v_pk_mul_f32 v[210:211], v[210:211], v[144:145] op_sel_hi:[1,0]
  v_cvt_pk_bf16_f32 v48, v192, v193
  v_cvt_pk_bf16_f32 v49, v194, v195
  v_cvt_pk_bf16_f32 v50, v208, v209
  v_cvt_pk_bf16_f32 v51, v210, v211
  s_nop 1
  v_permlane16_swap_b32 v48, v50
  v_permlane16_swap_b32 v49, v51
  buffer_store_dwordx4 v[48:51], v31, s[44:47], s3 offen sc1
  v_rcp_f32 v148, v148
  s_mov_b32 s3, 32768
  v_pk_mul_f32 v[196:197], v[196:197], v[148:149] op_sel_hi:[1,0]
  v_pk_mul_f32 v[198:199], v[198:199], v[148:149] op_sel_hi:[1,0]
  v_pk_mul_f32 v[212:213], v[212:213], v[148:149] op_sel_hi:[1,0]
  v_pk_mul_f32 v[214:215], v[214:215], v[148:149] op_sel_hi:[1,0]
  v_cvt_pk_bf16_f32 v52, v196, v197
  v_cvt_pk_bf16_f32 v53, v198, v199
  v_cvt_pk_bf16_f32 v54, v212, v213
  v_cvt_pk_bf16_f32 v55, v214, v215
  s_nop 1
  v_permlane16_swap_b32 v52, v54
  v_permlane16_swap_b32 v53, v55
  buffer_store_dwordx4 v[52:55], v31, s[44:47], s3 offen sc1
  v_rcp_f32 v152, v152
  s_mov_b32 s3, 65536
  v_pk_mul_f32 v[200:201], v[200:201], v[152:153] op_sel_hi:[1,0]
  v_pk_mul_f32 v[202:203], v[202:203], v[152:153] op_sel_hi:[1,0]
  v_pk_mul_f32 v[216:217], v[216:217], v[152:153] op_sel_hi:[1,0]
  v_pk_mul_f32 v[218:219], v[218:219], v[152:153] op_sel_hi:[1,0]
  v_cvt_pk_bf16_f32 v56, v200, v201
  v_cvt_pk_bf16_f32 v57, v202, v203
  v_cvt_pk_bf16_f32 v58, v216, v217
  v_cvt_pk_bf16_f32 v59, v218, v219
  s_nop 1
  v_permlane16_swap_b32 v56, v58
  v_permlane16_swap_b32 v57, v59
  buffer_store_dwordx4 v[56:59], v31, s[44:47], s3 offen sc1
  v_rcp_f32 v156, v156
  s_mov_b32 s3, 98304
  v_pk_mul_f32 v[204:205], v[204:205], v[156:157] op_sel_hi:[1,0]
  v_pk_mul_f32 v[206:207], v[206:207], v[156:157] op_sel_hi:[1,0]
  v_pk_mul_f32 v[220:221], v[220:221], v[156:157] op_sel_hi:[1,0]
  v_pk_mul_f32 v[222:223], v[222:223], v[156:157] op_sel_hi:[1,0]
  v_cvt_pk_bf16_f32 v60, v204, v205
  v_cvt_pk_bf16_f32 v61, v206, v207
  v_cvt_pk_bf16_f32 v62, v220, v221
  v_cvt_pk_bf16_f32 v63, v222, v223
  s_nop 1
  v_permlane16_swap_b32 v60, v62
  v_permlane16_swap_b32 v61, v63
  buffer_store_dwordx4 v[60:63], v31, s[44:47], s3 offen sc1
  s_waitcnt vmcnt(0) lgkmcnt(0)
  s_barrier
  s_add_u32 s97, s97, 1
  s_branch L_wo_body
.section .rodata,"a"
.p2align 6
.amdhsa_kernel interleave_layers__sliding_local_dilated__dense_activation_gelu__prompt_kernel
  .amdhsa_next_free_vgpr 256
  .amdhsa_next_free_sgpr 102
  .amdhsa_accum_offset 256
  .amdhsa_group_segment_fixed_size 0
  .amdhsa_kernarg_size 88
  .amdhsa_user_sgpr_count 2
  .amdhsa_user_sgpr_kernarg_segment_ptr 1
  .amdhsa_system_sgpr_workgroup_id_x 1
  .amdhsa_float_denorm_mode_32 3
  .amdhsa_float_denorm_mode_16_64 3
.end_amdhsa_kernel
.text
L_attn_c1:
L_wo_c0:
L_wo_body:
  s_cmp_ge_u32 s2, 256
  s_cbranch_scc1 L_wo_end
  v_lshrrev_b32 v2, 6, v0
  v_and_b32 v1, 63, v0
  v_readfirstlane_b32 s70, v2
  s_and_b32 s3, s2, 7
  s_lshr_b32 s99, s2, 3
  s_and_b32 s5, s3, 3
  s_lshl_b32 s5, s5, 2
  s_and_b32 s6, s99, 3
  s_add_u32 s68, s5, s6
  s_lshr_b32 s5, s3, 2
  s_lshr_b32 s78, s99, 2
  s_lshl1_add_u32 s69, s78, s5
  s_add_u32 s3, s68, s78
  s_lshl_b32 s3, s3, 3
  s_lshl_b32 s85, 0xffff02, s3
  s_sub_u32 s3, 0, s3
  s_lshr_b32 s3, 0xffff02, s3
  s_or_b32 s85, s85, s3
  s_cmp_lt_u32 s70, 4
  s_cbranch_scc1 L_wo_compute
L_wo_loader:
  v_and_b32 v2, 3, v1
  v_lshlrev_b32 v2, 3, v2
  v_bfe_i32 v16, s85, v2, 8
  s_and_b32 s3, s68, 3
  s_mul_i32 s4, s3, 4
  v_add3_u32 v3, v16, v1, s4
  v_and_b32 v3, 15, v3
  v_lshlrev_b32 v16, 17, v3
  s_add_u32 s9, s70, s68
  s_and_b32 s9, s9, 3
  s_lshl_b32 s77, s9, 11
  v_and_b32 v10, 7, v1
  v_lshrrev_b32 v3, 3, v1
  s_lshl_b32 s10, s9, 4
  v_add_u32 v3, s10, v3
  v_mul_u32_u24 v3, 2048, v3
  v_lshrrev_b32 v2, 3, v1
  v_and_b32 v2, 2, v2
  v_xor_b32 v2, v2, v10
  s_lshl_b32 s10, s69, 7
  v_add_u32 v3, s10, v3
  v_lshl_add_u32 v8, v2, 4, v3
  v_xor_b32 v2, 4, v2
  v_add_u32 v3, 16384, v3
  v_lshl_add_u32 v9, v2, 4, v3
  s_mov_b32 s40, s20
  s_and_b32 s41, s21, 0xffff
  s_mov_b32 s42, 2097152
  s_mov_b32 s43, 0x00020000
  s_add_u32 s3, s96, s70
  s_cmp_lg_u32 s3, 4
  s_cbranch_scc1 L_wo_chk
  s_load_dwordx2 s[64:65], s[0:1], 72
  s_mov_b32 s79, 0x100000
  s_waitcnt lgkmcnt(0)
  s_and_b32 s65, s65, 0xffff
  s_mov_b32 s66, 256
  s_mov_b32 s67, 0x00020000
  v_lshlrev_b32 v2, 2, v1
L_wo_chkl:
  buffer_load_dword v12, v2, s[64:67], 0 offen sc1
  s_sub_u32 s79, s79, 1
  s_cbranch_scc1 L_wo_chk
  s_waitcnt vmcnt(0)
  v_cmp_ne_u32 vcc, 0x01010101, v12
  s_cbranch_vccnz L_wo_chkl
L_wo_chk:
  v_readlane_b32 s74, v16, 0
  s_add_u32 m0, s77, 131072
  s_add_u32 s4, s74, 0
  buffer_load_dwordx4 v8, s[40:43], s4 offen lds
  s_add_u32 m0, s77, 132096
  s_nop 0
  buffer_load_dwordx4 v9, s[40:43], s4 offen lds
  v_readlane_b32 s74, v16, 1
  s_add_u32 m0, s77, 139264
  s_add_u32 s4, s74, 0
  buffer_load_dwordx4 v8, s[40:43], s4 offen lds
  s_add_u32 m0, s77, 140288
  s_nop 0
  buffer_load_dwordx4 v9, s[40:43], s4 offen lds
  v_readlane_b32 s74, v16, 2
  s_add_u32 m0, s77, 147456
  s_add_u32 s4, s74, 0
  buffer_load_dwordx4 v8, s[40:43], s4 offen lds
  s_add_u32 m0, s77, 148480
  s_nop 0
  buffer_load_dwordx4 v9, s[40:43], s4 offen lds
  v_readlane_b32 s74, v16, 3
  s_add_u32 m0, s77, 155648
  s_add_u32 s4, s74, 0
  buffer_load_dwordx4 v8, s[40:43], s4 offen lds
  s_add_u32 m0, s77, 156672
  s_nop 0
  buffer_load_dwordx4 v9, s[40:43], s4 offen lds
  v_readlane_b32 s74, v16, 4
  s_add_u32 m0, s77, 28672
  s_add_u32 s4, s74, 0
  buffer_load_dwordx4 v8, s[40:43], s4 offen lds
  s_add_u32 m0, s77, 29696
  s_nop 0
  buffer_load_dwordx4 v9, s[40:43], s4 offen lds
  v_readlane_b32 s74, v16, 5
  s_add_u32 m0, s77, 36864
  s_add_u32 s4, s74, 0
  buffer_load_dwordx4 v8, s[40:43], s4 offen lds
  s_add_u32 m0, s77, 37888
  s_nop 0
  buffer_load_dwordx4 v9, s[40:43], s4 offen lds
  s_add_u32 s44, s22, 41943040
  s_addc_u32 s45, s23, 0
  s_and_b32 s45, s45, 0xffff
  s_mov_b32 s46, 524288
  s_mov_b32 s47, 0x00020000
  s_cmp_lg_u32 s96, 0
  s_cbranch_scc1 L_wo_nofirst
  s_waitcnt vmcnt(12)
  s_mov_b32 s7, 0xffff0000
  v_lshlrev_b32 v32, 16, v64
  v_and_b32 v33, s7, v64
  v_lshlrev_b32 v34, 16, v65
  v_and_b32 v35, s7, v65
  v_lshlrev_b32 v36, 16, v66
  v_and_b32 v37, s7, v66
  v_lshlrev_b32 v38, 16, v67
  v_and_b32 v39, s7, v67
  v_lshlrev_b32 v40, 16, v68
  v_and_b32 v41, s7, v68
  v_pk_add_f32 v[32:33], v[32:33], v[40:41]
  v_lshlrev_b32 v40, 16, v69
  v_and_b32 v41, s7, v69
  v_pk_add_f32 v[34:35], v[34:35], v[40:41]
  v_lshlrev_b32 v40, 16, v70
  v_and_b32 v41, s7, v70
  v_pk_add_f32 v[36:37], v[36:37], v[40:41]
  v_lshlrev_b32 v40, 16, v71
  v_and_b32 v41, s7, v71
  v_pk_add_f32 v[38:39], v[38:39], v[40:41]
  v_lshlrev_b32 v40, 16, v72
  v_and_b32 v41, s7, v72
  v_pk_add_f32 v[32:33], v[32:33], v[40:41]
  v_lshlrev_b32 v40, 16, v73
  v_and_b32 v41, s7, v73
  v_pk_add_f32 v[34:35], v[34:35], v[40:41]
  v_lshlrev_b32 v40, 16, v74
  v_and_b32 v41, s7, v74
  v_pk_add_f32 v[36:37], v[36:37], v[40:41]
  v_lshlrev_b32 v40, 16, v75
  v_and_b32 v41, s7, v75
  v_pk_add_f32 v[38:39], v[38:39], v[40:41]
  v_lshlrev_b32 v40, 16, v76
  v_and_b32 v41, s7, v76
  v_pk_add_f32 v[32:33], v[32:33], v[40:41]
  v_lshlrev_b32 v40, 16, v77
  v_and_b32 v41, s7, v77
  v_pk_add_f32 v[34:35], v[34:35], v[40:41]
  v_lshlrev_b32 v40, 16, v78
  v_and_b32 v41, s7, v78
  v_pk_add_f32 v[36:37], v[36:37], v[40:41]
  v_lshlrev_b32 v40, 16, v79
  v_and_b32 v41, s7, v79
  v_pk_add_f32 v[38:39], v[38:39], v[40:41]
  v_lshlrev_b32 v40, 16, v80
  v_and_b32 v41, s7, v80
  v_pk_add_f32 v[32:33], v[32:33], v[40:41]
  v_lshlrev_b32 v40, 16, v81
  v_and_b32 v41, s7, v81
  v_pk_add_f32 v[34:35], v[34:35], v[40:41]
  v_lshlrev_b32 v40, 16, v82
  v_and_b32 v41, s7, v82
  v_pk_add_f32 v[36:37], v[36:37], v[40:41]
  v_lshlrev_b32 v40, 16, v83
  v_and_b32 v41, s7, v83
  v_pk_add_f32 v[38:39], v[38:39], v[40:41]
  v_lshlrev_b32 v40, 16, v84
  v_and_b32 v41, s7, v84
  v_pk_add_f32 v[32:33], v[32:33], v[40:41]
  v_lshlrev_b32 v40, 16, v85
  v_and_b32 v41, s7, v85
  v_pk_add_f32 v[34:35], v[34:35], v[40:41]
  v_lshlrev_b32 v40, 16, v86
  v_and_b32 v41, s7, v86
  v_pk_add_f32 v[36:37], v[36:37], v[40:41]
  v_lshlrev_b32 v40, 16, v87
  v_and_b32 v41, s7, v87
  v_pk_add_f32 v[38:39], v[38:39], v[40:41]
  v_lshlrev_b32 v40, 16, v88
  v_and_b32 v41, s7, v88
  v_pk_add_f32 v[32:33], v[32:33], v[40:41]
  v_lshlrev_b32 v40, 16, v89
  v_and_b32 v41, s7, v89
  v_pk_add_f32 v[34:35], v[34:35], v[40:41]
  v_lshlrev_b32 v40, 16, v90
  v_and_b32 v41, s7, v90
  v_pk_add_f32 v[36:37], v[36:37], v[40:41]
  v_lshlrev_b32 v40, 16, v91
  v_and_b32 v41, s7, v91
  v_pk_add_f32 v[38:39], v[38:39], v[40:41]
  v_lshlrev_b32 v40, 16, v92
  v_and_b32 v41, s7, v92
  v_pk_add_f32 v[32:33], v[32:33], v[40:41]
  v_lshlrev_b32 v40, 16, v93
  v_and_b32 v41, s7, v93
  v_pk_add_f32 v[34:35], v[34:35], v[40:41]
  v_lshlrev_b32 v40, 16, v94
  v_and_b32 v41, s7, v94
  v_pk_add_f32 v[36:37], v[36:37], v[40:41]
  v_lshlrev_b32 v40, 16, v95
  v_and_b32 v41, s7, v95
  v_pk_add_f32 v[38:39], v[38:39], v[40:41]
  s_add_u32 s52, s22, 24641536
  s_addc_u32 s53, s23, 0
  s_and_b32 s53, s53, 0xffff
  s_mov_b32 s54, 262144
  s_mov_b32 s55, 0x00020000
  v_permlane32_swap_b32 v32, v36
  v_permlane32_swap_b32 v33, v37
  v_permlane32_swap_b32 v34, v38
  v_permlane32_swap_b32 v35, v39
  v_add_f32 v32, v32, v36
  v_add_f32 v33, v33, v37
  v_add_f32 v34, v34, v38
  v_add_f32 v35, v35, v39
  v_and_b32 v2, 7, v1
  v_lshlrev_b32 v2, 5, v2
  v_permlane16_swap_b32 v32, v34
  v_permlane16_swap_b32 v33, v35
  v_add_f32 v32, v32, v34
  v_add_f32 v33, v33, v35
  v_lshrrev_b32 v3, 4, v1
  v_lshl_add_u32 v2, v3, 3, v2
  v_add_f32_dpp v32, v32, v32 row_ror:8 row_mask:0xf bank_mask:0xf
  v_add_f32_dpp v33, v33, v33 row_ror:8 row_mask:0xf bank_mask:0xf
  buffer_store_dwordx2 v[32:33], v2, s[52:55], s94 offen sc1
  s_waitcnt vmcnt(0)
L_wo_nofirst:
  s_lshl4_add_u32 s3, s97, s68
  s_and_b32 s4, s69, 15
  s_lshl4_add_u32 s3, s3, s4
  s_lshl_b32 s3, s3, 7
  s_sub_u32 s3, s3, 32768
  v_lshlrev_b32 v11, 7, v1
  v_and_b32 v2, 15, v1
  v_lshlrev_b32 v2, 2, v2
  v_mov_b32 v3, 1
  s_mov_b32 s79, 0x100000
  s_cmp_lg_u32 s70, 4
  s_barrier
  s_cbranch_scc1 L_wo_nofl
  s_mov_b32 exec_lo, 0xffff
  s_mov_b32 exec_hi, 0
  buffer_store_dword v3, v11, s[44:47], s87 offen sc1
  s_mov_b64 exec, -1
L_wo_nofl:
  s_mov_b32 s5, s3
  v_readlane_b32 s74, v16, 6
  s_add_u32 m0, s77, 45056
  s_add_u32 s4, s74, 0
  buffer_load_dwordx4 v8, s[40:43], s4 offen lds
  s_add_u32 m0, s77, 46080
  s_nop 0
  buffer_load_dwordx4 v9, s[40:43], s4 offen lds
  v_readlane_b32 s74, v16, 7
  s_add_u32 m0, s77, 53248
  s_add_u32 s4, s74, 0
  buffer_load_dwordx4 v8, s[40:43], s4 offen lds
  s_add_u32 m0, s77, 54272
  s_nop 0
  buffer_load_dwordx4 v9, s[40:43], s4 offen lds
  v_readlane_b32 s74, v16, 8
  s_add_u32 m0, s77, 61440
  s_add_u32 s4, s74, 0
  buffer_load_dwordx4 v8, s[40:43], s4 offen lds
  s_add_u32 m0, s77, 62464
  s_nop 0
  buffer_load_dwordx4 v9, s[40:43], s4 offen lds
  v_readlane_b32 s74, v16, 9
  s_add_u32 m0, s77, 69632
  s_add_u32 s4, s74, 0
  buffer_load_dwordx4 v8, s[40:43], s4 offen lds
  s_add_u32 m0, s77, 70656
  s_nop 0
  buffer_load_dwordx4 v9, s[40:43], s4 offen lds
  v_readlane_b32 s74, v16, 10
  s_add_u32 m0, s77, 77824
  s_add_u32 s4, s74, 0
  buffer_load_dwordx4 v8, s[40:43], s4 offen lds
  s_add_u32 m0, s77, 78848
  s_nop 0
  buffer_load_dwordx4 v9, s[40:43], s4 offen lds
  v_readlane_b32 s74, v16, 11
  s_add_u32 m0, s77, 86016
  s_add_u32 s4, s74, 0
  buffer_load_dwordx4 v8, s[40:43], s4 offen lds
  s_add_u32 m0, s77, 87040
  s_nop 0
  buffer_load_dwordx4 v9, s[40:43], s4 offen lds
  v_readlane_b32 s74, v16, 12
  s_add_u32 m0, s77, 94208
  s_add_u32 s4, s74, 0
  buffer_load_dwordx4 v8, s[40:43], s4 offen lds
  s_add_u32 m0, s77, 95232
  s_nop 0
  buffer_load_dwordx4 v9, s[40:43], s4 offen lds
  v_readlane_b32 s74, v16, 13
  s_add_u32 m0, s77, 102400
  s_add_u32 s4, s74, 0
  buffer_load_dwordx4 v8, s[40:43], s4 offen lds
  s_add_u32 m0, s77, 103424
  s_nop 0
  buffer_load_dwordx4 v9, s[40:43], s4 offen lds
  v_readlane_b32 s74, v16, 14
  s_add_u32 m0, s77, 110592
  s_add_u32 s4, s74, 0
  buffer_load_dwordx4 v8, s[40:43], s4 offen lds
  s_add_u32 m0, s77, 111616
  s_nop 0
  buffer_load_dwordx4 v9, s[40:43], s4 offen lds
  v_readlane_b32 s74, v16, 15
  s_add_u32 m0, s77, 118784
  s_add_u32 s4, s74, 0
  buffer_load_dwordx4 v8, s[40:43], s4 offen lds
  s_add_u32 m0, s77, 119808
  s_nop 0
  buffer_load_dwordx4 v9, s[40:43], s4 offen lds
  s_mov_b32 s3, s5
  s_cmp_lg_u32 s70, 4
  s_cbranch_scc1 L_wo_dep
L_wo_poll:
  buffer_load_dword v3, v2, s[44:47], s3 offen sc1
  s_sub_u32 s79, s79, 1
  s_cbranch_scc1 L_wo_dep
  s_waitcnt vmcnt(0)
  v_cmp_ne_u32 vcc, 1, v3
  s_cbranch_vccnz L_wo_poll
L_wo_dep:
  s_waitcnt vmcnt(22) lgkmcnt(0)
  s_barrier
  s_waitcnt vmcnt(14)
  s_barrier
  s_waitcnt vmcnt(6)
  s_barrier
  s_waitcnt vmcnt(0)
  s_barrier
  s_waitcnt vmcnt(0)
  s_barrier
  s_lshl_b32 s87, s97, 15
  s_lshl_b32 s4, s68, 11
  s_add_u32 s87, s87, s4
  s_lshl_b32 s4, s69, 2
  s_add_u32 s87, s87, s4
  s_add_u32 s97, s97, 1
  s_branch L_w1_body
L_wo_end:
  s_endpgm
L_wo_compute:
  v_and_b32 v2, 3, v1
  v_lshlrev_b32 v2, 3, v2
  v_bfe_i32 v15, s85, v2, 8
  s_and_b32 s3, s68, 3
  s_mul_i32 s4, s3, 4
  v_add3_u32 v3, v15, v1, s4
  v_and_b32 v3, 15, v3
  v_lshlrev_b32 v15, 11, v3
  v_and_b32 v3, 15, v1
  v_lshrrev_b32 v2, 4, v1
  s_lshl_b32 s8, s68, 7
  s_lshl_b32 s9, s70, 5
  s_add_u32 s8, s8, s9
  s_mul_i32 s9, s8, 2048
  v_lshl_add_u32 v4, v1, 4, s9
  v_add_u32 v5, 32768, v4
  v_add_u32 v13, s8, v3
  s_lshl_b32 s10, s69, 7
  v_lshl_add_u32 v14, v2, 3, s10
  v_and_b32 v16, 1, v2
  v_lshrrev_b32 v17, 1, v2
  v_lshl_add_u32 v16, v16, 1, v17
  v_lshlrev_b32 v16, 8, v16
  v_lshl_add_u32 v16, v3, 4, v16
  s_add_u32 s9, s8, s69
  s_lshl_b32 s9, s9, 11
  v_add_u32 v12, s9, v16
  v_lshl_add_u32 v18, v17, 4, v13
  v_lshlrev_b32 v18, 3, v18
  v_and_b32 v16, 1, v2
  v_lshl_add_u32 v18, v16, 2, v18
  s_lshl_b32 s10, s69, 14
  v_add_u32 v18, s10, v18
  v_bfe_u32 v6, v1, 2, 2
  v_lshl_add_u32 v6, v2, 3, v6
  v_lshlrev_b32 v6, 7, v6
  v_and_b32 v17, 3, v1
  v_lshl_add_u32 v6, v17, 3, v6
  v_bfe_u32 v17, v1, 3, 2
  v_lshl_add_u32 v6, v17, 5, v6
  v_xor_b32 v7, 32, v6
  v_xor_b32 v8, 64, v6
  v_xor_b32 v9, 96, v6
  s_mov_b32 s11, 0xffff0000
  s_mov_b32 s36, s34
  s_and_b32 s37, s35, 0xffff
  s_mov_b32 s38, 4194304
  s_mov_b32 s39, 0x00020000
  s_add_u32 s44, s34, 4194304
  s_addc_u32 s45, s35, 0
  s_and_b32 s45, s45, 0xffff
  s_mov_b32 s46, 4194304
  s_mov_b32 s47, 0x00020000
  s_add_u32 s56, s34, 24117248
  s_addc_u32 s57, s35, 0
  s_and_b32 s57, s57, 0xffff
  s_mov_b32 s58, 262144
  s_mov_b32 s59, 0x00020000
  s_cmp_lg_u32 s96, 0
  s_cbranch_scc1 L_pfc2_skip
  s_getpc_b64 s[4:5]
L_pfc2:
  s_lshl_b32 s3, s99, 2
  s_add_u32 s3, s3, s70
  s_mul_i32 s3, s3, 128
  s_min_u32 s3, s3, L_w1_c1-L_w1_c0-128
  s_add_i32 s3, s3, L_w1_c0-L_pfc2
  s_ashr_i32 s6, s3, 31
  s_add_u32 s4, s4, s3
  s_addc_u32 s5, s5, s6
  s_load_dword s40, s[4:5], 0
  s_load_dword s41, s[4:5], 64
L_pfc2_skip:
  v_add_u32 v26, 155648, v6
  v_add_u32 v27, 155648, v7
  v_add_u32 v28, 155648, v8
  v_add_u32 v29, 155648, v9
  v_add_u32 v20, 94208, v6
  v_add_u32 v21, 94208, v7
  v_add_u32 v22, 94208, v8
  v_add_u32 v23, 94208, v9
  v_add_u32 v6, 28672, v6
  v_add_u32 v7, 28672, v7
  v_add_u32 v8, 28672, v8
  v_add_u32 v9, 28672, v9
  v_readlane_b32 s48, v15, 0
  v_readlane_b32 s49, v15, 1
  v_readlane_b32 s50, v15, 2
  v_permlane16_swap_b32 v240, v242
  v_permlane16_swap_b32 v241, v243
  v_permlane16_swap_b32 v244, v246
  v_permlane16_swap_b32 v245, v247
  v_permlane16_swap_b32 v248, v250
  v_permlane16_swap_b32 v249, v251
  v_permlane16_swap_b32 v252, v254
  v_permlane16_swap_b32 v253, v255
  s_waitcnt lgkmcnt(0)
  s_barrier
  buffer_load_dwordx4 v[32:35], v4, s[36:39], s48 offen offset:0
  buffer_load_dwordx4 v[36:39], v5, s[36:39], s48 offen offset:0
  buffer_load_dwordx4 v[40:43], v4, s[36:39], s48 offen offset:1024
  buffer_load_dwordx4 v[44:47], v5, s[36:39], s48 offen offset:1024
  buffer_load_dwordx4 v[48:51], v4, s[36:39], s49 offen offset:0
  buffer_load_dwordx4 v[52:55], v5, s[36:39], s49 offen offset:0
  buffer_load_dwordx4 v[56:59], v4, s[36:39], s49 offen offset:1024
  buffer_load_dwordx4 v[60:63], v5, s[36:39], s49 offen offset:1024
  buffer_load_dwordx4 v[64:67], v4, s[36:39], s50 offen offset:0
  buffer_load_dwordx4 v[68:71], v5, s[36:39], s50 offen offset:0
  buffer_load_dwordx4 v[72:75], v4, s[36:39], s50 offen offset:1024
  buffer_load_dwordx4 v[76:79], v5, s[36:39], s50 offen offset:1024
  ds_read_b64_tr_b16 v[160:161], v20 offset:36864
  ds_read_b64_tr_b16 v[162:163], v20 offset:37376
  ds_read_b64_tr_b16 v[164:165], v21 offset:36864
  ds_read_b64_tr_b16 v[166:167], v21 offset:37376
  ds_read_b64_tr_b16 v[168:169], v22 offset:36864
  ds_read_b64_tr_b16 v[170:171], v22 offset:37376
  ds_read_b64_tr_b16 v[172:173], v23 offset:36864
  ds_read_b64_tr_b16 v[174:175], v23 offset:37376
  ds_read_b64_tr_b16 v[176:177], v20 offset:40960
  ds_read_b64_tr_b16 v[178:179], v20 offset:41472
  ds_read_b64_tr_b16 v[180:181], v21 offset:40960
  ds_read_b64_tr_b16 v[182:183], v21 offset:41472
  ds_read_b64_tr_b16 v[184:185], v22 offset:40960
  ds_read_b64_tr_b16 v[186:187], v22 offset:41472
  ds_read_b64_tr_b16 v[188:189], v23 offset:40960
  ds_read_b64_tr_b16 v[190:191], v23 offset:41472
  v_lshlrev_b32 v96, 16, v240
  v_and_b32 v97, s11, v240
  v_lshlrev_b32 v98, 16, v241
  v_and_b32 v99, s11, v241
  v_lshlrev_b32 v100, 16, v248
  v_and_b32 v101, s11, v248
  v_lshlrev_b32 v102, 16, v249
  v_and_b32 v103, s11, v249
  v_lshlrev_b32 v104, 16, v242
  v_and_b32 v105, s11, v242
  v_lshlrev_b32 v106, 16, v243
  v_and_b32 v107, s11, v243
  v_lshlrev_b32 v108, 16, v250
  v_and_b32 v109, s11, v250
  v_lshlrev_b32 v110, 16, v251
  v_and_b32 v111, s11, v251
  v_lshlrev_b32 v112, 16, v244
  v_and_b32 v113, s11, v244
  v_lshlrev_b32 v114, 16, v245
  v_and_b32 v115, s11, v245
  v_lshlrev_b32 v116, 16, v252
  v_and_b32 v117, s11, v252
  v_lshlrev_b32 v118, 16, v253
  v_and_b32 v119, s11, v253
  v_lshlrev_b32 v120, 16, v246
  v_and_b32 v121, s11, v246
  v_lshlrev_b32 v122, 16, v247
  v_and_b32 v123, s11, v247
  v_lshlrev_b32 v124, 16, v254
  v_and_b32 v125, s11, v254
  v_lshlrev_b32 v126, 16, v255
  v_and_b32 v127, s11, v255
  s_waitcnt vmcnt(10) lgkmcnt(8)
  v_mfma_f32_16x16x32_bf16 v[96:99], v[160:163], v[32:35], v[96:99]
  ds_read_b64_tr_b16 v[192:193], v20 offset:45056
  v_readlane_b32 s51, v15, 3
  v_mfma_f32_16x16x32_bf16 v[100:103], v[160:163], v[36:39], v[100:103]
  ds_read_b64_tr_b16 v[194:195], v20 offset:45568
  v_mfma_f32_16x16x32_bf16 v[104:107], v[164:167], v[32:35], v[104:107]
  ds_read_b64_tr_b16 v[196:197], v21 offset:45056
  v_mfma_f32_16x16x32_bf16 v[108:111], v[164:167], v[36:39], v[108:111]
  ds_read_b64_tr_b16 v[198:199], v21 offset:45568
  buffer_load_dwordx4 v[80:83], v4, s[36:39], s51 offen offset:0
  v_mfma_f32_16x16x32_bf16 v[112:115], v[168:171], v[32:35], v[112:115]
  ds_read_b64_tr_b16 v[200:201], v22 offset:45056
  v_mfma_f32_16x16x32_bf16 v[116:119], v[168:171], v[36:39], v[116:119]
  ds_read_b64_tr_b16 v[202:203], v22 offset:45568
  v_mfma_f32_16x16x32_bf16 v[120:123], v[172:175], v[32:35], v[120:123]
  ds_read_b64_tr_b16 v[204:205], v23 offset:45056
  buffer_load_dwordx4 v[84:87], v5, s[36:39], s51 offen offset:0
  v_mfma_f32_16x16x32_bf16 v[124:127], v[172:175], v[36:39], v[124:127]
  ds_read_b64_tr_b16 v[206:207], v23 offset:45568
  s_waitcnt vmcnt(10) lgkmcnt(8)
  v_mfma_f32_16x16x32_bf16 v[96:99], v[176:179], v[40:43], v[96:99]
  ds_read_b64_tr_b16 v[208:209], v20 offset:49152
  v_mfma_f32_16x16x32_bf16 v[100:103], v[176:179], v[44:47], v[100:103]
  ds_read_b64_tr_b16 v[210:211], v20 offset:49664
  buffer_load_dwordx4 v[88:91], v4, s[36:39], s51 offen offset:1024
  v_mfma_f32_16x16x32_bf16 v[104:107], v[180:183], v[40:43], v[104:107]
  ds_read_b64_tr_b16 v[212:213], v21 offset:49152
  v_mfma_f32_16x16x32_bf16 v[108:111], v[180:183], v[44:47], v[108:111]
  ds_read_b64_tr_b16 v[214:215], v21 offset:49664
  v_mfma_f32_16x16x32_bf16 v[112:115], v[184:187], v[40:43], v[112:115]
  ds_read_b64_tr_b16 v[216:217], v22 offset:49152
  buffer_load_dwordx4 v[92:95], v5, s[36:39], s51 offen offset:1024
  v_mfma_f32_16x16x32_bf16 v[116:119], v[184:187], v[44:47], v[116:119]
  ds_read_b64_tr_b16 v[218:219], v22 offset:49664
  v_readlane_b32 s48, v15, 4
  v_mfma_f32_16x16x32_bf16 v[120:123], v[188:191], v[40:43], v[120:123]
  ds_read_b64_tr_b16 v[220:221], v23 offset:49152
  v_mfma_f32_16x16x32_bf16 v[124:127], v[188:191], v[44:47], v[124:127]
  ds_read_b64_tr_b16 v[222:223], v23 offset:49664
  s_waitcnt vmcnt(10) lgkmcnt(8)
  v_mfma_f32_16x16x32_bf16 v[96:99], v[192:195], v[48:51], v[96:99]
  ds_read_b64_tr_b16 v[160:161], v20 offset:53248
  buffer_load_dwordx4 v[32:35], v4, s[36:39], s48 offen offset:0
  v_mfma_f32_16x16x32_bf16 v[100:103], v[192:195], v[52:55], v[100:103]
  ds_read_b64_tr_b16 v[162:163], v20 offset:53760
  v_mfma_f32_16x16x32_bf16 v[104:107], v[196:199], v[48:51], v[104:107]
  ds_read_b64_tr_b16 v[164:165], v21 offset:53248
  v_mfma_f32_16x16x32_bf16 v[108:111], v[196:199], v[52:55], v[108:111]
  ds_read_b64_tr_b16 v[166:167], v21 offset:53760
  buffer_load_dwordx4 v[36:39], v5, s[36:39], s48 offen offset:0
  v_mfma_f32_16x16x32_bf16 v[112:115], v[200:203], v[48:51], v[112:115]
  ds_read_b64_tr_b16 v[168:169], v22 offset:53248
  v_mfma_f32_16x16x32_bf16 v[116:119], v[200:203], v[52:55], v[116:119]
  ds_read_b64_tr_b16 v[170:171], v22 offset:53760
  v_mfma_f32_16x16x32_bf16 v[120:123], v[204:207], v[48:51], v[120:123]
  ds_read_b64_tr_b16 v[172:173], v23 offset:53248
  buffer_load_dwordx4 v[40:43], v4, s[36:39], s48 offen offset:1024
  v_mfma_f32_16x16x32_bf16 v[124:127], v[204:207], v[52:55], v[124:127]
  ds_read_b64_tr_b16 v[174:175], v23 offset:53760
  s_waitcnt vmcnt(11) lgkmcnt(8)
  v_mfma_f32_16x16x32_bf16 v[96:99], v[208:211], v[56:59], v[96:99]
  ds_read_b64_tr_b16 v[176:177], v20 offset:57344
  v_mfma_f32_16x16x32_bf16 v[100:103], v[208:211], v[60:63], v[100:103]
  ds_read_b64_tr_b16 v[178:179], v20 offset:57856
  buffer_load_dwordx4 v[44:47], v5, s[36:39], s48 offen offset:1024
  v_mfma_f32_16x16x32_bf16 v[104:107], v[212:215], v[56:59], v[104:107]
  ds_read_b64_tr_b16 v[180:181], v21 offset:57344
  v_mfma_f32_16x16x32_bf16 v[108:111], v[212:215], v[60:63], v[108:111]
  ds_read_b64_tr_b16 v[182:183], v21 offset:57856
  v_mfma_f32_16x16x32_bf16 v[112:115], v[216:219], v[56:59], v[112:115]
  ds_read_b64_tr_b16 v[184:185], v22 offset:57344
  v_mfma_f32_16x16x32_bf16 v[116:119], v[216:219], v[60:63], v[116:119]
  ds_read_b64_tr_b16 v[186:187], v22 offset:57856
  v_readlane_b32 s49, v15, 5
  v_mfma_f32_16x16x32_bf16 v[120:123], v[220:223], v[56:59], v[120:123]
  ds_read_b64_tr_b16 v[188:189], v23 offset:57344
  v_mfma_f32_16x16x32_bf16 v[124:127], v[220:223], v[60:63], v[124:127]
  ds_read_b64_tr_b16 v[190:191], v23 offset:57856
  s_waitcnt vmcnt(10) lgkmcnt(8)
  v_mfma_f32_16x16x32_bf16 v[96:99], v[160:163], v[64:67], v[96:99]
  ds_read_b64_tr_b16 v[192:193], v26 offset:0
  buffer_load_dwordx4 v[48:51], v4, s[36:39], s49 offen offset:0
  v_mfma_f32_16x16x32_bf16 v[100:103], v[160:163], v[68:71], v[100:103]
  ds_read_b64_tr_b16 v[194:195], v26 offset:512
  v_mfma_f32_16x16x32_bf16 v[104:107], v[164:167], v[64:67], v[104:107]
  ds_read_b64_tr_b16 v[196:197], v27 offset:0
  v_mfma_f32_16x16x32_bf16 v[108:111], v[164:167], v[68:71], v[108:111]
  ds_read_b64_tr_b16 v[198:199], v27 offset:512
  buffer_load_dwordx4 v[52:55], v5, s[36:39], s49 offen offset:0
  v_mfma_f32_16x16x32_bf16 v[112:115], v[168:171], v[64:67], v[112:115]
  ds_read_b64_tr_b16 v[200:201], v28 offset:0
  v_mfma_f32_16x16x32_bf16 v[116:119], v[168:171], v[68:71], v[116:119]
  ds_read_b64_tr_b16 v[202:203], v28 offset:512
  v_mfma_f32_16x16x32_bf16 v[120:123], v[172:175], v[64:67], v[120:123]
  ds_read_b64_tr_b16 v[204:205], v29 offset:0
  buffer_load_dwordx4 v[56:59], v4, s[36:39], s49 offen offset:1024
  v_mfma_f32_16x16x32_bf16 v[124:127], v[172:175], v[68:71], v[124:127]
  ds_read_b64_tr_b16 v[206:207], v29 offset:512
  s_waitcnt vmcnt(11) lgkmcnt(8)
  v_mfma_f32_16x16x32_bf16 v[96:99], v[176:179], v[72:75], v[96:99]
  ds_read_b64_tr_b16 v[208:209], v26 offset:4096
  v_mfma_f32_16x16x32_bf16 v[100:103], v[176:179], v[76:79], v[100:103]
  ds_read_b64_tr_b16 v[210:211], v26 offset:4608
  buffer_load_dwordx4 v[60:63], v5, s[36:39], s49 offen offset:1024
  v_mfma_f32_16x16x32_bf16 v[104:107], v[180:183], v[72:75], v[104:107]
  ds_read_b64_tr_b16 v[212:213], v27 offset:4096
  v_mfma_f32_16x16x32_bf16 v[108:111], v[180:183], v[76:79], v[108:111]
  ds_read_b64_tr_b16 v[214:215], v27 offset:4608
  v_mfma_f32_16x16x32_bf16 v[112:115], v[184:187], v[72:75], v[112:115]
  ds_read_b64_tr_b16 v[216:217], v28 offset:4096
  v_mfma_f32_16x16x32_bf16 v[116:119], v[184:187], v[76:79], v[116:119]
  ds_read_b64_tr_b16 v[218:219], v28 offset:4608
  v_readlane_b32 s50, v15, 6
  v_mfma_f32_16x16x32_bf16 v[120:123], v[188:191], v[72:75], v[120:123]
  ds_read_b64_tr_b16 v[220:221], v29 offset:4096
  v_mfma_f32_16x16x32_bf16 v[124:127], v[188:191], v[76:79], v[124:127]
  ds_read_b64_tr_b16 v[222:223], v29 offset:4608
  s_waitcnt vmcnt(10) lgkmcnt(8)
  v_mfma_f32_16x16x32_bf16 v[96:99], v[192:195], v[80:83], v[96:99]
  ds_read_b64_tr_b16 v[160:161], v6 offset:0
  buffer_load_dwordx4 v[64:67], v4, s[36:39], s50 offen offset:0
  v_mfma_f32_16x16x32_bf16 v[100:103], v[192:195], v[84:87], v[100:103]
  ds_read_b64_tr_b16 v[162:163], v6 offset:512
  v_mfma_f32_16x16x32_bf16 v[104:107], v[196:199], v[80:83], v[104:107]
  ds_read_b64_tr_b16 v[164:165], v7 offset:0
  v_mfma_f32_16x16x32_bf16 v[108:111], v[196:199], v[84:87], v[108:111]
  ds_read_b64_tr_b16 v[166:167], v7 offset:512
  buffer_load_dwordx4 v[68:71], v5, s[36:39], s50 offen offset:0
  v_mfma_f32_16x16x32_bf16 v[112:115], v[200:203], v[80:83], v[112:115]
  ds_read_b64_tr_b16 v[168:169], v8 offset:0
  v_mfma_f32_16x16x32_bf16 v[116:119], v[200:203], v[84:87], v[116:119]
  ds_read_b64_tr_b16 v[170:171], v8 offset:512
  v_mfma_f32_16x16x32_bf16 v[120:123], v[204:207], v[80:83], v[120:123]
  ds_read_b64_tr_b16 v[172:173], v9 offset:0
  buffer_load_dwordx4 v[72:75], v4, s[36:39], s50 offen offset:1024
  v_mfma_f32_16x16x32_bf16 v[124:127], v[204:207], v[84:87], v[124:127]
  ds_read_b64_tr_b16 v[174:175], v9 offset:512
  s_waitcnt vmcnt(11) lgkmcnt(8)
  s_barrier
  v_mfma_f32_16x16x32_bf16 v[96:99], v[208:211], v[88:91], v[96:99]
  ds_read_b64_tr_b16 v[176:177], v6 offset:4096
  v_mfma_f32_16x16x32_bf16 v[100:103], v[208:211], v[92:95], v[100:103]
  ds_read_b64_tr_b16 v[178:179], v6 offset:4608
  buffer_load_dwordx4 v[76:79], v5, s[36:39], s50 offen offset:1024
  v_mfma_f32_16x16x32_bf16 v[104:107], v[212:215], v[88:91], v[104:107]
  ds_read_b64_tr_b16 v[180:181], v7 offset:4096
  v_mfma_f32_16x16x32_bf16 v[108:111], v[212:215], v[92:95], v[108:111]
  ds_read_b64_tr_b16 v[182:183], v7 offset:4608
  v_mfma_f32_16x16x32_bf16 v[112:115], v[216:219], v[88:91], v[112:115]
  ds_read_b64_tr_b16 v[184:185], v8 offset:4096
  v_mfma_f32_16x16x32_bf16 v[116:119], v[216:219], v[92:95], v[116:119]
  ds_read_b64_tr_b16 v[186:187], v8 offset:4608
  v_readlane_b32 s51, v15, 7
  v_mfma_f32_16x16x32_bf16 v[120:123], v[220:223], v[88:91], v[120:123]
  ds_read_b64_tr_b16 v[188:189], v9 offset:4096
  v_mfma_f32_16x16x32_bf16 v[124:127], v[220:223], v[92:95], v[124:127]
  ds_read_b64_tr_b16 v[190:191], v9 offset:4608
  s_waitcnt vmcnt(10) lgkmcnt(8)
  v_mfma_f32_16x16x32_bf16 v[96:99], v[160:163], v[32:35], v[96:99]
  ds_read_b64_tr_b16 v[192:193], v6 offset:8192
  buffer_load_dwordx4 v[80:83], v4, s[36:39], s51 offen offset:0
  v_mfma_f32_16x16x32_bf16 v[100:103], v[160:163], v[36:39], v[100:103]
  ds_read_b64_tr_b16 v[194:195], v6 offset:8704
  v_mfma_f32_16x16x32_bf16 v[104:107], v[164:167], v[32:35], v[104:107]
  ds_read_b64_tr_b16 v[196:197], v7 offset:8192
  v_mfma_f32_16x16x32_bf16 v[108:111], v[164:167], v[36:39], v[108:111]
  ds_read_b64_tr_b16 v[198:199], v7 offset:8704
  buffer_load_dwordx4 v[84:87], v5, s[36:39], s51 offen offset:0
  v_mfma_f32_16x16x32_bf16 v[112:115], v[168:171], v[32:35], v[112:115]
  ds_read_b64_tr_b16 v[200:201], v8 offset:8192
  v_mfma_f32_16x16x32_bf16 v[116:119], v[168:171], v[36:39], v[116:119]
  ds_read_b64_tr_b16 v[202:203], v8 offset:8704
  v_mfma_f32_16x16x32_bf16 v[120:123], v[172:175], v[32:35], v[120:123]
  ds_read_b64_tr_b16 v[204:205], v9 offset:8192
  buffer_load_dwordx4 v[88:91], v4, s[36:39], s51 offen offset:1024
  v_mfma_f32_16x16x32_bf16 v[124:127], v[172:175], v[36:39], v[124:127]
  ds_read_b64_tr_b16 v[206:207], v9 offset:8704
  s_waitcnt vmcnt(11) lgkmcnt(8)
  v_mfma_f32_16x16x32_bf16 v[96:99], v[176:179], v[40:43], v[96:99]
  ds_read_b64_tr_b16 v[208:209], v6 offset:12288
  v_mfma_f32_16x16x32_bf16 v[100:103], v[176:179], v[44:47], v[100:103]
  ds_read_b64_tr_b16 v[210:211], v6 offset:12800
  buffer_load_dwordx4 v[92:95], v5, s[36:39], s51 offen offset:1024
  v_mfma_f32_16x16x32_bf16 v[104:107], v[180:183], v[40:43], v[104:107]
  ds_read_b64_tr_b16 v[212:213], v7 offset:12288
  v_mfma_f32_16x16x32_bf16 v[108:111], v[180:183], v[44:47], v[108:111]
  ds_read_b64_tr_b16 v[214:215], v7 offset:12800
  v_mfma_f32_16x16x32_bf16 v[112:115], v[184:187], v[40:43], v[112:115]
  ds_read_b64_tr_b16 v[216:217], v8 offset:12288
  v_mfma_f32_16x16x32_bf16 v[116:119], v[184:187], v[44:47], v[116:119]
  ds_read_b64_tr_b16 v[218:219], v8 offset:12800
  v_readlane_b32 s48, v15, 8
  v_mfma_f32_16x16x32_bf16 v[120:123], v[188:191], v[40:43], v[120:123]
  ds_read_b64_tr_b16 v[220:221], v9 offset:12288
  v_mfma_f32_16x16x32_bf16 v[124:127], v[188:191], v[44:47], v[124:127]
  ds_read_b64_tr_b16 v[222:223], v9 offset:12800
  s_waitcnt vmcnt(10) lgkmcnt(8)
  v_mfma_f32_16x16x32_bf16 v[96:99], v[192:195], v[48:51], v[96:99]
  ds_read_b64_tr_b16 v[160:161], v6 offset:16384
  buffer_load_dwordx4 v[32:35], v4, s[36:39], s48 offen offset:0
  v_mfma_f32_16x16x32_bf16 v[100:103], v[192:195], v[52:55], v[100:103]
  ds_read_b64_tr_b16 v[162:163], v6 offset:16896
  v_mfma_f32_16x16x32_bf16 v[104:107], v[196:199], v[48:51], v[104:107]
  ds_read_b64_tr_b16 v[164:165], v7 offset:16384
  v_mfma_f32_16x16x32_bf16 v[108:111], v[196:199], v[52:55], v[108:111]
  ds_read_b64_tr_b16 v[166:167], v7 offset:16896
  buffer_load_dwordx4 v[36:39], v5, s[36:39], s48 offen offset:0
  v_mfma_f32_16x16x32_bf16 v[112:115], v[200:203], v[48:51], v[112:115]
  ds_read_b64_tr_b16 v[168:169], v8 offset:16384
  v_mfma_f32_16x16x32_bf16 v[116:119], v[200:203], v[52:55], v[116:119]
  ds_read_b64_tr_b16 v[170:171], v8 offset:16896
  v_mfma_f32_16x16x32_bf16 v[120:123], v[204:207], v[48:51], v[120:123]
  ds_read_b64_tr_b16 v[172:173], v9 offset:16384
  buffer_load_dwordx4 v[40:43], v4, s[36:39], s48 offen offset:1024
  v_mfma_f32_16x16x32_bf16 v[124:127], v[204:207], v[52:55], v[124:127]
  ds_read_b64_tr_b16 v[174:175], v9 offset:16896
  s_waitcnt vmcnt(11) lgkmcnt(8)
  v_mfma_f32_16x16x32_bf16 v[96:99], v[208:211], v[56:59], v[96:99]
  ds_read_b64_tr_b16 v[176:177], v6 offset:20480
  v_mfma_f32_16x16x32_bf16 v[100:103], v[208:211], v[60:63], v[100:103]
  ds_read_b64_tr_b16 v[178:179], v6 offset:20992
  buffer_load_dwordx4 v[44:47], v5, s[36:39], s48 offen offset:1024
  v_mfma_f32_16x16x32_bf16 v[104:107], v[212:215], v[56:59], v[104:107]
  ds_read_b64_tr_b16 v[180:181], v7 offset:20480
  v_mfma_f32_16x16x32_bf16 v[108:111], v[212:215], v[60:63], v[108:111]
  ds_read_b64_tr_b16 v[182:183], v7 offset:20992
  v_mfma_f32_16x16x32_bf16 v[112:115], v[216:219], v[56:59], v[112:115]
  ds_read_b64_tr_b16 v[184:185], v8 offset:20480
  v_mfma_f32_16x16x32_bf16 v[116:119], v[216:219], v[60:63], v[116:119]
  ds_read_b64_tr_b16 v[186:187], v8 offset:20992
  v_readlane_b32 s49, v15, 9
  v_mfma_f32_16x16x32_bf16 v[120:123], v[220:223], v[56:59], v[120:123]
  ds_read_b64_tr_b16 v[188:189], v9 offset:20480
  v_mfma_f32_16x16x32_bf16 v[124:127], v[220:223], v[60:63], v[124:127]
  ds_read_b64_tr_b16 v[190:191], v9 offset:20992
  s_waitcnt vmcnt(10) lgkmcnt(8)
  v_mfma_f32_16x16x32_bf16 v[96:99], v[160:163], v[64:67], v[96:99]
  ds_read_b64_tr_b16 v[192:193], v6 offset:24576
  buffer_load_dwordx4 v[48:51], v4, s[36:39], s49 offen offset:0
  v_mfma_f32_16x16x32_bf16 v[100:103], v[160:163], v[68:71], v[100:103]
  ds_read_b64_tr_b16 v[194:195], v6 offset:25088
  v_mfma_f32_16x16x32_bf16 v[104:107], v[164:167], v[64:67], v[104:107]
  ds_read_b64_tr_b16 v[196:197], v7 offset:24576
  v_mfma_f32_16x16x32_bf16 v[108:111], v[164:167], v[68:71], v[108:111]
  ds_read_b64_tr_b16 v[198:199], v7 offset:25088
  buffer_load_dwordx4 v[52:55], v5, s[36:39], s49 offen offset:0
  v_mfma_f32_16x16x32_bf16 v[112:115], v[168:171], v[64:67], v[112:115]
  ds_read_b64_tr_b16 v[200:201], v8 offset:24576
  v_mfma_f32_16x16x32_bf16 v[116:119], v[168:171], v[68:71], v[116:119]
  ds_read_b64_tr_b16 v[202:203], v8 offset:25088
  v_mfma_f32_16x16x32_bf16 v[120:123], v[172:175], v[64:67], v[120:123]
  ds_read_b64_tr_b16 v[204:205], v9 offset:24576
  buffer_load_dwordx4 v[56:59], v4, s[36:39], s49 offen offset:1024
  v_mfma_f32_16x16x32_bf16 v[124:127], v[172:175], v[68:71], v[124:127]
  ds_read_b64_tr_b16 v[206:207], v9 offset:25088
  s_waitcnt vmcnt(11) lgkmcnt(8)
  v_mfma_f32_16x16x32_bf16 v[96:99], v[176:179], v[72:75], v[96:99]
  ds_read_b64_tr_b16 v[208:209], v6 offset:28672
  v_mfma_f32_16x16x32_bf16 v[100:103], v[176:179], v[76:79], v[100:103]
  ds_read_b64_tr_b16 v[210:211], v6 offset:29184
  buffer_load_dwordx4 v[60:63], v5, s[36:39], s49 offen offset:1024
  v_mfma_f32_16x16x32_bf16 v[104:107], v[180:183], v[72:75], v[104:107]
  ds_read_b64_tr_b16 v[212:213], v7 offset:28672
  v_mfma_f32_16x16x32_bf16 v[108:111], v[180:183], v[76:79], v[108:111]
  ds_read_b64_tr_b16 v[214:215], v7 offset:29184
  v_mfma_f32_16x16x32_bf16 v[112:115], v[184:187], v[72:75], v[112:115]
  ds_read_b64_tr_b16 v[216:217], v8 offset:28672
  v_mfma_f32_16x16x32_bf16 v[116:119], v[184:187], v[76:79], v[116:119]
  ds_read_b64_tr_b16 v[218:219], v8 offset:29184
  v_readlane_b32 s50, v15, 10
  v_mfma_f32_16x16x32_bf16 v[120:123], v[188:191], v[72:75], v[120:123]
  ds_read_b64_tr_b16 v[220:221], v9 offset:28672
  v_mfma_f32_16x16x32_bf16 v[124:127], v[188:191], v[76:79], v[124:127]
  ds_read_b64_tr_b16 v[222:223], v9 offset:29184
  s_waitcnt vmcnt(10) lgkmcnt(8)
  v_mfma_f32_16x16x32_bf16 v[96:99], v[192:195], v[80:83], v[96:99]
  ds_read_b64_tr_b16 v[160:161], v6 offset:32768
  buffer_load_dwordx4 v[64:67], v4, s[36:39], s50 offen offset:0
  v_mfma_f32_16x16x32_bf16 v[100:103], v[192:195], v[84:87], v[100:103]
  ds_read_b64_tr_b16 v[162:163], v6 offset:33280
  v_mfma_f32_16x16x32_bf16 v[104:107], v[196:199], v[80:83], v[104:107]
  ds_read_b64_tr_b16 v[164:165], v7 offset:32768
  v_mfma_f32_16x16x32_bf16 v[108:111], v[196:199], v[84:87], v[108:111]
  ds_read_b64_tr_b16 v[166:167], v7 offset:33280
  buffer_load_dwordx4 v[68:71], v5, s[36:39], s50 offen offset:0
  v_mfma_f32_16x16x32_bf16 v[112:115], v[200:203], v[80:83], v[112:115]
  ds_read_b64_tr_b16 v[168:169], v8 offset:32768
  v_mfma_f32_16x16x32_bf16 v[116:119], v[200:203], v[84:87], v[116:119]
  ds_read_b64_tr_b16 v[170:171], v8 offset:33280
  v_mfma_f32_16x16x32_bf16 v[120:123], v[204:207], v[80:83], v[120:123]
  ds_read_b64_tr_b16 v[172:173], v9 offset:32768
  buffer_load_dwordx4 v[72:75], v4, s[36:39], s50 offen offset:1024
  v_mfma_f32_16x16x32_bf16 v[124:127], v[204:207], v[84:87], v[124:127]
  ds_read_b64_tr_b16 v[174:175], v9 offset:33280
  s_waitcnt vmcnt(11) lgkmcnt(8)
  s_barrier
  v_mfma_f32_16x16x32_bf16 v[96:99], v[208:211], v[88:91], v[96:99]
  ds_read_b64_tr_b16 v[176:177], v6 offset:36864
  v_mfma_f32_16x16x32_bf16 v[100:103], v[208:211], v[92:95], v[100:103]
  ds_read_b64_tr_b16 v[178:179], v6 offset:37376
  buffer_load_dwordx4 v[76:79], v5, s[36:39], s50 offen offset:1024
  v_mfma_f32_16x16x32_bf16 v[104:107], v[212:215], v[88:91], v[104:107]
  ds_read_b64_tr_b16 v[180:181], v7 offset:36864
  v_mfma_f32_16x16x32_bf16 v[108:111], v[212:215], v[92:95], v[108:111]
  ds_read_b64_tr_b16 v[182:183], v7 offset:37376
  v_mfma_f32_16x16x32_bf16 v[112:115], v[216:219], v[88:91], v[112:115]
  ds_read_b64_tr_b16 v[184:185], v8 offset:36864
  v_mfma_f32_16x16x32_bf16 v[116:119], v[216:219], v[92:95], v[116:119]
  ds_read_b64_tr_b16 v[186:187], v8 offset:37376
  v_readlane_b32 s51, v15, 11
  v_mfma_f32_16x16x32_bf16 v[120:123], v[220:223], v[88:91], v[120:123]
  ds_read_b64_tr_b16 v[188:189], v9 offset:36864
  v_mfma_f32_16x16x32_bf16 v[124:127], v[220:223], v[92:95], v[124:127]
  ds_read_b64_tr_b16 v[190:191], v9 offset:37376
  s_waitcnt vmcnt(10) lgkmcnt(8)
  v_mfma_f32_16x16x32_bf16 v[96:99], v[160:163], v[32:35], v[96:99]
  ds_read_b64_tr_b16 v[192:193], v6 offset:40960
  buffer_load_dwordx4 v[80:83], v4, s[36:39], s51 offen offset:0
  v_mfma_f32_16x16x32_bf16 v[100:103], v[160:163], v[36:39], v[100:103]
  ds_read_b64_tr_b16 v[194:195], v6 offset:41472
  v_mfma_f32_16x16x32_bf16 v[104:107], v[164:167], v[32:35], v[104:107]
  ds_read_b64_tr_b16 v[196:197], v7 offset:40960
  v_mfma_f32_16x16x32_bf16 v[108:111], v[164:167], v[36:39], v[108:111]
  ds_read_b64_tr_b16 v[198:199], v7 offset:41472
  buffer_load_dwordx4 v[84:87], v5, s[36:39], s51 offen offset:0
  v_mfma_f32_16x16x32_bf16 v[112:115], v[168:171], v[32:35], v[112:115]
  ds_read_b64_tr_b16 v[200:201], v8 offset:40960
  v_mfma_f32_16x16x32_bf16 v[116:119], v[168:171], v[36:39], v[116:119]
  ds_read_b64_tr_b16 v[202:203], v8 offset:41472
  v_mfma_f32_16x16x32_bf16 v[120:123], v[172:175], v[32:35], v[120:123]
  ds_read_b64_tr_b16 v[204:205], v9 offset:40960
  buffer_load_dwordx4 v[88:91], v4, s[36:39], s51 offen offset:1024
  v_mfma_f32_16x16x32_bf16 v[124:127], v[172:175], v[36:39], v[124:127]
  ds_read_b64_tr_b16 v[206:207], v9 offset:41472
  s_waitcnt vmcnt(11) lgkmcnt(8)
  v_mfma_f32_16x16x32_bf16 v[96:99], v[176:179], v[40:43], v[96:99]
  ds_read_b64_tr_b16 v[208:209], v6 offset:45056
  v_mfma_f32_16x16x32_bf16 v[100:103], v[176:179], v[44:47], v[100:103]
  ds_read_b64_tr_b16 v[210:211], v6 offset:45568
  buffer_load_dwordx4 v[92:95], v5, s[36:39], s51 offen offset:1024
  v_mfma_f32_16x16x32_bf16 v[104:107], v[180:183], v[40:43], v[104:107]
  ds_read_b64_tr_b16 v[212:213], v7 offset:45056
  v_mfma_f32_16x16x32_bf16 v[108:111], v[180:183], v[44:47], v[108:111]
  ds_read_b64_tr_b16 v[214:215], v7 offset:45568
  v_mfma_f32_16x16x32_bf16 v[112:115], v[184:187], v[40:43], v[112:115]
  ds_read_b64_tr_b16 v[216:217], v8 offset:45056
  v_mfma_f32_16x16x32_bf16 v[116:119], v[184:187], v[44:47], v[116:119]
  ds_read_b64_tr_b16 v[218:219], v8 offset:45568
  v_readlane_b32 s48, v15, 12
  v_mfma_f32_16x16x32_bf16 v[120:123], v[188:191], v[40:43], v[120:123]
  ds_read_b64_tr_b16 v[220:221], v9 offset:45056
  v_mfma_f32_16x16x32_bf16 v[124:127], v[188:191], v[44:47], v[124:127]
  ds_read_b64_tr_b16 v[222:223], v9 offset:45568
  s_waitcnt vmcnt(10) lgkmcnt(8)
  v_mfma_f32_16x16x32_bf16 v[96:99], v[192:195], v[48:51], v[96:99]
  ds_read_b64_tr_b16 v[160:161], v6 offset:49152
  buffer_load_dwordx4 v[32:35], v4, s[36:39], s48 offen offset:0
  v_mfma_f32_16x16x32_bf16 v[100:103], v[192:195], v[52:55], v[100:103]
  ds_read_b64_tr_b16 v[162:163], v6 offset:49664
  v_mfma_f32_16x16x32_bf16 v[104:107], v[196:199], v[48:51], v[104:107]
  ds_read_b64_tr_b16 v[164:165], v7 offset:49152
  v_mfma_f32_16x16x32_bf16 v[108:111], v[196:199], v[52:55], v[108:111]
  ds_read_b64_tr_b16 v[166:167], v7 offset:49664
  buffer_load_dwordx4 v[36:39], v5, s[36:39], s48 offen offset:0
  v_mfma_f32_16x16x32_bf16 v[112:115], v[200:203], v[48:51], v[112:115]
  ds_read_b64_tr_b16 v[168:169], v8 offset:49152
  v_mfma_f32_16x16x32_bf16 v[116:119], v[200:203], v[52:55], v[116:119]
  ds_read_b64_tr_b16 v[170:171], v8 offset:49664
  v_mfma_f32_16x16x32_bf16 v[120:123], v[204:207], v[48:51], v[120:123]
  ds_read_b64_tr_b16 v[172:173], v9 offset:49152
  buffer_load_dwordx4 v[40:43], v4, s[36:39], s48 offen offset:1024
  v_mfma_f32_16x16x32_bf16 v[124:127], v[204:207], v[52:55], v[124:127]
  ds_read_b64_tr_b16 v[174:175], v9 offset:49664
  s_waitcnt vmcnt(11) lgkmcnt(8)
  v_mfma_f32_16x16x32_bf16 v[96:99], v[208:211], v[56:59], v[96:99]
  ds_read_b64_tr_b16 v[176:177], v6 offset:53248
  v_mfma_f32_16x16x32_bf16 v[100:103], v[208:211], v[60:63], v[100:103]
  ds_read_b64_tr_b16 v[178:179], v6 offset:53760
  buffer_load_dwordx4 v[44:47], v5, s[36:39], s48 offen offset:1024
  v_mfma_f32_16x16x32_bf16 v[104:107], v[212:215], v[56:59], v[104:107]
  ds_read_b64_tr_b16 v[180:181], v7 offset:53248
  v_mfma_f32_16x16x32_bf16 v[108:111], v[212:215], v[60:63], v[108:111]
  ds_read_b64_tr_b16 v[182:183], v7 offset:53760
  v_mfma_f32_16x16x32_bf16 v[112:115], v[216:219], v[56:59], v[112:115]
  ds_read_b64_tr_b16 v[184:185], v8 offset:53248
  v_mfma_f32_16x16x32_bf16 v[116:119], v[216:219], v[60:63], v[116:119]
  ds_read_b64_tr_b16 v[186:187], v8 offset:53760
  v_readlane_b32 s49, v15, 13
  v_mfma_f32_16x16x32_bf16 v[120:123], v[220:223], v[56:59], v[120:123]
  ds_read_b64_tr_b16 v[188:189], v9 offset:53248
  v_mfma_f32_16x16x32_bf16 v[124:127], v[220:223], v[60:63], v[124:127]
  ds_read_b64_tr_b16 v[190:191], v9 offset:53760
  s_waitcnt vmcnt(10) lgkmcnt(8)
  v_mfma_f32_16x16x32_bf16 v[96:99], v[160:163], v[64:67], v[96:99]
  ds_read_b64_tr_b16 v[192:193], v6 offset:57344
  buffer_load_dwordx4 v[48:51], v4, s[36:39], s49 offen offset:0
  v_mfma_f32_16x16x32_bf16 v[100:103], v[160:163], v[68:71], v[100:103]
  ds_read_b64_tr_b16 v[194:195], v6 offset:57856
  v_mfma_f32_16x16x32_bf16 v[104:107], v[164:167], v[64:67], v[104:107]
  ds_read_b64_tr_b16 v[196:197], v7 offset:57344
  v_mfma_f32_16x16x32_bf16 v[108:111], v[164:167], v[68:71], v[108:111]
  ds_read_b64_tr_b16 v[198:199], v7 offset:57856
  buffer_load_dwordx4 v[52:55], v5, s[36:39], s49 offen offset:0
  v_mfma_f32_16x16x32_bf16 v[112:115], v[168:171], v[64:67], v[112:115]
  ds_read_b64_tr_b16 v[200:201], v8 offset:57344
  v_mfma_f32_16x16x32_bf16 v[116:119], v[168:171], v[68:71], v[116:119]
  ds_read_b64_tr_b16 v[202:203], v8 offset:57856
  v_mfma_f32_16x16x32_bf16 v[120:123], v[172:175], v[64:67], v[120:123]
  ds_read_b64_tr_b16 v[204:205], v9 offset:57344
  buffer_load_dwordx4 v[56:59], v4, s[36:39], s49 offen offset:1024
  v_mfma_f32_16x16x32_bf16 v[124:127], v[172:175], v[68:71], v[124:127]
  ds_read_b64_tr_b16 v[206:207], v9 offset:57856
  s_waitcnt vmcnt(11) lgkmcnt(8)
  v_mfma_f32_16x16x32_bf16 v[96:99], v[176:179], v[72:75], v[96:99]
  ds_read_b64_tr_b16 v[208:209], v6 offset:61440
  v_mfma_f32_16x16x32_bf16 v[100:103], v[176:179], v[76:79], v[100:103]
  ds_read_b64_tr_b16 v[210:211], v6 offset:61952
  buffer_load_dwordx4 v[60:63], v5, s[36:39], s49 offen offset:1024
  v_mfma_f32_16x16x32_bf16 v[104:107], v[180:183], v[72:75], v[104:107]
  ds_read_b64_tr_b16 v[212:213], v7 offset:61440
  v_mfma_f32_16x16x32_bf16 v[108:111], v[180:183], v[76:79], v[108:111]
  ds_read_b64_tr_b16 v[214:215], v7 offset:61952
  v_mfma_f32_16x16x32_bf16 v[112:115], v[184:187], v[72:75], v[112:115]
  ds_read_b64_tr_b16 v[216:217], v8 offset:61440
  v_mfma_f32_16x16x32_bf16 v[116:119], v[184:187], v[76:79], v[116:119]
  ds_read_b64_tr_b16 v[218:219], v8 offset:61952
  v_readlane_b32 s50, v15, 14
  v_mfma_f32_16x16x32_bf16 v[120:123], v[188:191], v[72:75], v[120:123]
  ds_read_b64_tr_b16 v[220:221], v9 offset:61440
  v_mfma_f32_16x16x32_bf16 v[124:127], v[188:191], v[76:79], v[124:127]
  ds_read_b64_tr_b16 v[222:223], v9 offset:61952
  s_waitcnt vmcnt(10) lgkmcnt(8)
  v_mfma_f32_16x16x32_bf16 v[96:99], v[192:195], v[80:83], v[96:99]
  ds_read_b64_tr_b16 v[160:161], v20 offset:0
  buffer_load_dwordx4 v[64:67], v4, s[36:39], s50 offen offset:0
  v_mfma_f32_16x16x32_bf16 v[100:103], v[192:195], v[84:87], v[100:103]
  ds_read_b64_tr_b16 v[162:163], v20 offset:512
  v_mfma_f32_16x16x32_bf16 v[104:107], v[196:199], v[80:83], v[104:107]
  ds_read_b64_tr_b16 v[164:165], v21 offset:0
  v_mfma_f32_16x16x32_bf16 v[108:111], v[196:199], v[84:87], v[108:111]
  ds_read_b64_tr_b16 v[166:167], v21 offset:512
  buffer_load_dwordx4 v[68:71], v5, s[36:39], s50 offen offset:0
  v_mfma_f32_16x16x32_bf16 v[112:115], v[200:203], v[80:83], v[112:115]
  ds_read_b64_tr_b16 v[168:169], v22 offset:0
  v_mfma_f32_16x16x32_bf16 v[116:119], v[200:203], v[84:87], v[116:119]
  ds_read_b64_tr_b16 v[170:171], v22 offset:512
  v_mfma_f32_16x16x32_bf16 v[120:123], v[204:207], v[80:83], v[120:123]
  ds_read_b64_tr_b16 v[172:173], v23 offset:0
  buffer_load_dwordx4 v[72:75], v4, s[36:39], s50 offen offset:1024
  v_mfma_f32_16x16x32_bf16 v[124:127], v[204:207], v[84:87], v[124:127]
  ds_read_b64_tr_b16 v[174:175], v23 offset:512
  s_waitcnt vmcnt(11) lgkmcnt(8)
  s_barrier
  v_mfma_f32_16x16x32_bf16 v[96:99], v[208:211], v[88:91], v[96:99]
  ds_read_b64_tr_b16 v[176:177], v20 offset:4096
  v_mfma_f32_16x16x32_bf16 v[100:103], v[208:211], v[92:95], v[100:103]
  ds_read_b64_tr_b16 v[178:179], v20 offset:4608
  buffer_load_dwordx4 v[76:79], v5, s[36:39], s50 offen offset:1024
  v_mfma_f32_16x16x32_bf16 v[104:107], v[212:215], v[88:91], v[104:107]
  ds_read_b64_tr_b16 v[180:181], v21 offset:4096
  v_mfma_f32_16x16x32_bf16 v[108:111], v[212:215], v[92:95], v[108:111]
  ds_read_b64_tr_b16 v[182:183], v21 offset:4608
  v_mfma_f32_16x16x32_bf16 v[112:115], v[216:219], v[88:91], v[112:115]
  ds_read_b64_tr_b16 v[184:185], v22 offset:4096
  v_mfma_f32_16x16x32_bf16 v[116:119], v[216:219], v[92:95], v[116:119]
  ds_read_b64_tr_b16 v[186:187], v22 offset:4608
  v_readlane_b32 s51, v15, 15
  v_mfma_f32_16x16x32_bf16 v[120:123], v[220:223], v[88:91], v[120:123]
  ds_read_b64_tr_b16 v[188:189], v23 offset:4096
  v_mfma_f32_16x16x32_bf16 v[124:127], v[220:223], v[92:95], v[124:127]
  ds_read_b64_tr_b16 v[190:191], v23 offset:4608
  s_waitcnt vmcnt(10) lgkmcnt(8)
  v_mfma_f32_16x16x32_bf16 v[96:99], v[160:163], v[32:35], v[96:99]
  ds_read_b64_tr_b16 v[192:193], v20 offset:8192
  buffer_load_dwordx4 v[80:83], v4, s[36:39], s51 offen offset:0
  v_mfma_f32_16x16x32_bf16 v[100:103], v[160:163], v[36:39], v[100:103]
  ds_read_b64_tr_b16 v[194:195], v20 offset:8704
  v_mfma_f32_16x16x32_bf16 v[104:107], v[164:167], v[32:35], v[104:107]
  ds_read_b64_tr_b16 v[196:197], v21 offset:8192
  v_mfma_f32_16x16x32_bf16 v[108:111], v[164:167], v[36:39], v[108:111]
  ds_read_b64_tr_b16 v[198:199], v21 offset:8704
  buffer_load_dwordx4 v[84:87], v5, s[36:39], s51 offen offset:0
  v_mfma_f32_16x16x32_bf16 v[112:115], v[168:171], v[32:35], v[112:115]
  ds_read_b64_tr_b16 v[200:201], v22 offset:8192
  v_mfma_f32_16x16x32_bf16 v[116:119], v[168:171], v[36:39], v[116:119]
  ds_read_b64_tr_b16 v[202:203], v22 offset:8704
  v_mfma_f32_16x16x32_bf16 v[120:123], v[172:175], v[32:35], v[120:123]
  ds_read_b64_tr_b16 v[204:205], v23 offset:8192
  buffer_load_dwordx4 v[88:91], v4, s[36:39], s51 offen offset:1024
  v_mfma_f32_16x16x32_bf16 v[124:127], v[172:175], v[36:39], v[124:127]
  ds_read_b64_tr_b16 v[206:207], v23 offset:8704
  s_waitcnt vmcnt(11) lgkmcnt(8)
  v_mfma_f32_16x16x32_bf16 v[96:99], v[176:179], v[40:43], v[96:99]
  ds_read_b64_tr_b16 v[208:209], v20 offset:12288
  v_mfma_f32_16x16x32_bf16 v[100:103], v[176:179], v[44:47], v[100:103]
  ds_read_b64_tr_b16 v[210:211], v20 offset:12800
  buffer_load_dwordx4 v[92:95], v5, s[36:39], s51 offen offset:1024
  v_mfma_f32_16x16x32_bf16 v[104:107], v[180:183], v[40:43], v[104:107]
  ds_read_b64_tr_b16 v[212:213], v21 offset:12288
  v_mfma_f32_16x16x32_bf16 v[108:111], v[180:183], v[44:47], v[108:111]
  ds_read_b64_tr_b16 v[214:215], v21 offset:12800
  v_mfma_f32_16x16x32_bf16 v[112:115], v[184:187], v[40:43], v[112:115]
  ds_read_b64_tr_b16 v[216:217], v22 offset:12288
  v_mfma_f32_16x16x32_bf16 v[116:119], v[184:187], v[44:47], v[116:119]
  ds_read_b64_tr_b16 v[218:219], v22 offset:12800
  v_mfma_f32_16x16x32_bf16 v[120:123], v[188:191], v[40:43], v[120:123]
  ds_read_b64_tr_b16 v[220:221], v23 offset:12288
  v_mfma_f32_16x16x32_bf16 v[124:127], v[188:191], v[44:47], v[124:127]
  ds_read_b64_tr_b16 v[222:223], v23 offset:12800
  s_waitcnt vmcnt(10) lgkmcnt(8)
  v_mfma_f32_16x16x32_bf16 v[96:99], v[192:195], v[48:51], v[96:99]
  ds_read_b64_tr_b16 v[160:161], v20 offset:16384
  v_mfma_f32_16x16x32_bf16 v[100:103], v[192:195], v[52:55], v[100:103]
  ds_read_b64_tr_b16 v[162:163], v20 offset:16896
  v_mfma_f32_16x16x32_bf16 v[104:107], v[196:199], v[48:51], v[104:107]
  ds_read_b64_tr_b16 v[164:165], v21 offset:16384
  v_mfma_f32_16x16x32_bf16 v[108:111], v[196:199], v[52:55], v[108:111]
  ds_read_b64_tr_b16 v[166:167], v21 offset:16896
  v_mfma_f32_16x16x32_bf16 v[112:115], v[200:203], v[48:51], v[112:115]
  ds_read_b64_tr_b16 v[168:169], v22 offset:16384
  v_mfma_f32_16x16x32_bf16 v[116:119], v[200:203], v[52:55], v[116:119]
  ds_read_b64_tr_b16 v[170:171], v22 offset:16896
  v_mfma_f32_16x16x32_bf16 v[120:123], v[204:207], v[48:51], v[120:123]
  ds_read_b64_tr_b16 v[172:173], v23 offset:16384
  v_mfma_f32_16x16x32_bf16 v[124:127], v[204:207], v[52:55], v[124:127]
  ds_read_b64_tr_b16 v[174:175], v23 offset:16896
  s_waitcnt vmcnt(8) lgkmcnt(8)
  v_mfma_f32_16x16x32_bf16 v[96:99], v[208:211], v[56:59], v[96:99]
  ds_read_b64_tr_b16 v[176:177], v20 offset:20480
  v_mfma_f32_16x16x32_bf16 v[100:103], v[208:211], v[60:63], v[100:103]
  ds_read_b64_tr_b16 v[178:179], v20 offset:20992
  v_mfma_f32_16x16x32_bf16 v[104:107], v[212:215], v[56:59], v[104:107]
  ds_read_b64_tr_b16 v[180:181], v21 offset:20480
  v_mfma_f32_16x16x32_bf16 v[108:111], v[212:215], v[60:63], v[108:111]
  ds_read_b64_tr_b16 v[182:183], v21 offset:20992
  v_mfma_f32_16x16x32_bf16 v[112:115], v[216:219], v[56:59], v[112:115]
  ds_read_b64_tr_b16 v[184:185], v22 offset:20480
  v_mfma_f32_16x16x32_bf16 v[116:119], v[216:219], v[60:63], v[116:119]
  ds_read_b64_tr_b16 v[186:187], v22 offset:20992
  v_mfma_f32_16x16x32_bf16 v[120:123], v[220:223], v[56:59], v[120:123]
  ds_read_b64_tr_b16 v[188:189], v23 offset:20480
  v_mfma_f32_16x16x32_bf16 v[124:127], v[220:223], v[60:63], v[124:127]
  ds_read_b64_tr_b16 v[190:191], v23 offset:20992
  s_waitcnt vmcnt(6) lgkmcnt(8)
  v_mfma_f32_16x16x32_bf16 v[96:99], v[160:163], v[64:67], v[96:99]
  ds_read_b64_tr_b16 v[192:193], v20 offset:24576
  v_mfma_f32_16x16x32_bf16 v[100:103], v[160:163], v[68:71], v[100:103]
  ds_read_b64_tr_b16 v[194:195], v20 offset:25088
  v_mfma_f32_16x16x32_bf16 v[104:107], v[164:167], v[64:67], v[104:107]
  ds_read_b64_tr_b16 v[196:197], v21 offset:24576
  v_mfma_f32_16x16x32_bf16 v[108:111], v[164:167], v[68:71], v[108:111]
  ds_read_b64_tr_b16 v[198:199], v21 offset:25088
  v_mfma_f32_16x16x32_bf16 v[112:115], v[168:171], v[64:67], v[112:115]
  ds_read_b64_tr_b16 v[200:201], v22 offset:24576
  v_mfma_f32_16x16x32_bf16 v[116:119], v[168:171], v[68:71], v[116:119]
  ds_read_b64_tr_b16 v[202:203], v22 offset:25088
  v_mfma_f32_16x16x32_bf16 v[120:123], v[172:175], v[64:67], v[120:123]
  ds_read_b64_tr_b16 v[204:205], v23 offset:24576
  v_mfma_f32_16x16x32_bf16 v[124:127], v[172:175], v[68:71], v[124:127]
  ds_read_b64_tr_b16 v[206:207], v23 offset:25088
  s_waitcnt vmcnt(4) lgkmcnt(8)
  v_mfma_f32_16x16x32_bf16 v[96:99], v[176:179], v[72:75], v[96:99]
  ds_read_b64_tr_b16 v[208:209], v20 offset:28672
  v_mfma_f32_16x16x32_bf16 v[100:103], v[176:179], v[76:79], v[100:103]
  ds_read_b64_tr_b16 v[210:211], v20 offset:29184
  v_mfma_f32_16x16x32_bf16 v[104:107], v[180:183], v[72:75], v[104:107]
  ds_read_b64_tr_b16 v[212:213], v21 offset:28672
  v_mfma_f32_16x16x32_bf16 v[108:111], v[180:183], v[76:79], v[108:111]
  ds_read_b64_tr_b16 v[214:215], v21 offset:29184
  v_mfma_f32_16x16x32_bf16 v[112:115], v[184:187], v[72:75], v[112:115]
  ds_read_b64_tr_b16 v[216:217], v22 offset:28672
  v_mfma_f32_16x16x32_bf16 v[116:119], v[184:187], v[76:79], v[116:119]
  ds_read_b64_tr_b16 v[218:219], v22 offset:29184
  v_mfma_f32_16x16x32_bf16 v[120:123], v[188:191], v[72:75], v[120:123]
  ds_read_b64_tr_b16 v[220:221], v23 offset:28672
  v_mfma_f32_16x16x32_bf16 v[124:127], v[188:191], v[76:79], v[124:127]
  ds_read_b64_tr_b16 v[222:223], v23 offset:29184
  s_waitcnt vmcnt(2) lgkmcnt(8)
  v_mfma_f32_16x16x32_bf16 v[96:99], v[192:195], v[80:83], v[96:99]
  v_mov_b32 v20, 0
  v_mov_b32 v21, 0
  v_mfma_f32_16x16x32_bf16 v[100:103], v[192:195], v[84:87], v[100:103]
  v_mov_b32 v22, 0
  v_mov_b32 v23, 0
  v_mfma_f32_16x16x32_bf16 v[104:107], v[196:199], v[80:83], v[104:107]
  v_mfma_f32_16x16x32_bf16 v[108:111], v[196:199], v[84:87], v[108:111]
  v_mfma_f32_16x16x32_bf16 v[112:115], v[200:203], v[80:83], v[112:115]
  v_mfma_f32_16x16x32_bf16 v[116:119], v[200:203], v[84:87], v[116:119]
  v_mfma_f32_16x16x32_bf16 v[120:123], v[204:207], v[80:83], v[120:123]
  v_mfma_f32_16x16x32_bf16 v[124:127], v[204:207], v[84:87], v[124:127]
  s_waitcnt vmcnt(0) lgkmcnt(0)
  s_barrier
  v_mfma_f32_16x16x32_bf16 v[96:99], v[208:211], v[88:91], v[96:99]
  v_mfma_f32_16x16x32_bf16 v[100:103], v[208:211], v[92:95], v[100:103]
  v_mfma_f32_16x16x32_bf16 v[104:107], v[212:215], v[88:91], v[104:107]
  v_mfma_f32_16x16x32_bf16 v[108:111], v[212:215], v[92:95], v[108:111]
  v_mfma_f32_16x16x32_bf16 v[112:115], v[216:219], v[88:91], v[112:115]
  v_mfma_f32_16x16x32_bf16 v[116:119], v[216:219], v[92:95], v[116:119]
  v_mfma_f32_16x16x32_bf16 v[120:123], v[220:223], v[88:91], v[120:123]
  v_mfma_f32_16x16x32_bf16 v[124:127], v[220:223], v[92:95], v[124:127]
  s_mov_b32 s3, 32768
  s_mov_b32 s10, 0x3f803f80
  s_nop 4
  v_cvt_pk_bf16_f32 v240, v96, v97
  v_cvt_pk_bf16_f32 v241, v98, v99
  v_cvt_pk_bf16_f32 v242, v104, v105
  v_cvt_pk_bf16_f32 v243, v106, v107
  s_nop 1
  v_permlane16_swap_b32 v240, v242
  v_permlane16_swap_b32 v241, v243
  buffer_store_dwordx4 v[240:243], v12, s[44:47], 0 offen offset:0 sc1
  v_cvt_pk_bf16_f32 v244, v112, v113
  v_cvt_pk_bf16_f32 v245, v114, v115
  v_cvt_pk_bf16_f32 v246, v120, v121
  v_cvt_pk_bf16_f32 v247, v122, v123
  s_nop 1
  v_permlane16_swap_b32 v244, v246
  v_permlane16_swap_b32 v245, v247
  buffer_store_dwordx4 v[244:247], v12, s[44:47], 0 offen offset:1024 sc1
  v_cvt_pk_bf16_f32 v248, v100, v101
  v_cvt_pk_bf16_f32 v249, v102, v103
  v_cvt_pk_bf16_f32 v250, v108, v109
  v_cvt_pk_bf16_f32 v251, v110, v111
  s_nop 1
  v_permlane16_swap_b32 v248, v250
  v_permlane16_swap_b32 v249, v251
  buffer_store_dwordx4 v[248:251], v12, s[44:47], s3 offen offset:0 sc1
  v_cvt_pk_bf16_f32 v252, v116, v117
  v_cvt_pk_bf16_f32 v253, v118, v119
  v_cvt_pk_bf16_f32 v254, v124, v125
  v_cvt_pk_bf16_f32 v255, v126, v127
  s_nop 1
  v_permlane16_swap_b32 v252, v254
  v_permlane16_swap_b32 v253, v255
  buffer_store_dwordx4 v[252:255], v12, s[44:47], s3 offen offset:1024 sc1
  v_dot2_f32_bf16 v20, v240, s10, v20
  v_dot2_f32_bf16 v22, v240, v240, v22
  v_dot2_f32_bf16 v20, v241, s10, v20
  v_dot2_f32_bf16 v22, v241, v241, v22
  v_dot2_f32_bf16 v20, v242, s10, v20
  v_dot2_f32_bf16 v22, v242, v242, v22
  v_dot2_f32_bf16 v20, v243, s10, v20
  v_dot2_f32_bf16 v22, v243, v243, v22
  v_dot2_f32_bf16 v20, v244, s10, v20
  v_dot2_f32_bf16 v22, v244, v244, v22
  v_dot2_f32_bf16 v20, v245, s10, v20
  v_dot2_f32_bf16 v22, v245, v245, v22
  v_dot2_f32_bf16 v20, v246, s10, v20
  v_dot2_f32_bf16 v22, v246, v246, v22
  v_dot2_f32_bf16 v20, v247, s10, v20
  v_dot2_f32_bf16 v22, v247, v247, v22
  v_dot2_f32_bf16 v21, v248, s10, v21
  v_dot2_f32_bf16 v23, v248, v248, v23
  v_dot2_f32_bf16 v21, v249, s10, v21
  v_dot2_f32_bf16 v23, v249, v249, v23
  v_dot2_f32_bf16 v21, v250, s10, v21
  v_dot2_f32_bf16 v23, v250, v250, v23
  v_dot2_f32_bf16 v21, v251, s10, v21
  v_dot2_f32_bf16 v23, v251, v251, v23
  v_dot2_f32_bf16 v21, v252, s10, v21
  v_dot2_f32_bf16 v23, v252, v252, v23
  v_dot2_f32_bf16 v21, v253, s10, v21
  v_dot2_f32_bf16 v23, v253, v253, v23
  v_dot2_f32_bf16 v21, v254, s10, v21
  v_dot2_f32_bf16 v23, v254, v254, v23
  v_dot2_f32_bf16 v21, v255, s10, v21
  v_dot2_f32_bf16 v23, v255, v255, v23
  s_nop 2
  v_permlane32_swap_b32 v20, v21
  v_permlane32_swap_b32 v22, v23
  v_add_f32 v20, v20, v21
  v_add_f32 v22, v22, v23
  s_nop 1
  v_permlane16_swap_b32 v20, v22
  v_add_f32 v20, v20, v22
  buffer_store_dword v20, v18, s[56:59], 0 offen sc1
  s_waitcnt vmcnt(0) lgkmcnt(0)
  s_barrier
  s_add_u32 s97, s97, 1
  s_branch L_w1_body
L_wo_c1:
L_w1_c0:
L_w1_body:
  s_cmp_ge_u32 s2, 256
  s_cbranch_scc1 L_w1_end
  v_lshrrev_b32 v2, 6, v0
  v_and_b32 v1, 63, v0
  v_readfirstlane_b32 s70, v2
  s_and_b32 s3, s2, 7
  s_lshr_b32 s99, s2, 3
  s_and_b32 s5, s3, 1
  s_lshl_b32 s5, s5, 3
  s_and_b32 s6, s99, 7
  s_add_u32 s68, s5, s6
  s_lshr_b32 s5, s3, 1
  s_lshl_b32 s5, s5, 2
  s_lshr_b32 s6, s99, 3
  s_add_u32 s69, s5, s6
  s_cmp_lt_u32 s70, 4
  s_cbranch_scc1 L_w1_compute
L_w1_loader:
  s_add_u32 s8, s70, s69
  s_and_b32 s8, s8, 3
  s_add_u32 s9, s70, s68
  s_and_b32 s9, s9, 3
  s_lshl_b32 s76, s8, 12
  s_lshl_b32 s77, s9, 11
  s_add_u32 s77, s77, 16384
  s_lshl_b32 s11, s68, 7
  v_and_b32 v10, 7, v1
  s_lshr_b32 s10, s76, 11
  s_lshl_b32 s3, s68, 3
  s_add_u32 s10, s10, s3
  s_mul_i32 s10, s10, 32768
  v_lshl_add_u32 v4, v1, 4, s10
  v_add_u32 v5, 32768, v4
  v_lshrrev_b32 v3, 3, v1
  s_lshl_b32 s10, s9, 4
  v_add_u32 v3, s10, v3
  v_mul_u32_u24 v3, 7168, v3
  v_lshrrev_b32 v2, 3, v1
  v_and_b32 v2, 2, v2
  v_xor_b32 v2, v2, v10
  s_mul_i32 s10, s69, 128
  v_add_u32 v3, s10, v3
  v_lshl_add_u32 v8, v2, 4, v3
  v_xor_b32 v2, 4, v2
  v_add_u32 v3, 57344, v3
  v_lshl_add_u32 v9, v2, 4, v3
  v_lshrrev_b32 v3, 2, v1
  s_lshl_b32 s10, s9, 4
  v_add_u32 v3, s10, v3
  v_mul_u32_u24 v3, 7168, v3
  v_lshrrev_b32 v2, 4, v1
  v_and_b32 v2, 2, v2
  v_xor_b32 v2, v2, v1
  v_and_b32 v2, 3, v2
  s_lshl_b32 s10, s69, 6
  s_add_u32 s10, s10, 2048
  v_add_u32 v3, s10, v3
  v_lshl_add_u32 v28, v2, 4, v3
  s_lshl_b32 s78, s69, 7
  s_add_u32 s78, s78, 3072
  s_mov_b32 s75, 0
  s_add_u32 s100, s68, s69
  s_mov_b32 s101, -1
  s_add_u32 s101, s101, 1
  s_sub_u32 s73, s101, s100
  s_lshl_b32 s73, s73, 3
  s_lshr_b32 s73, 0xf0f02, s73
  s_and_b32 s73, s73, 255
  s_add_u32 s73, s73, s101
  s_and_b32 s73, s73, 15
  s_mul_i32 s74, s73, 458752
  s_lshl_b32 s73, s73, 11
  s_waitcnt lgkmcnt(0)
  s_add_u32 s36, s34, 4194304
  s_addc_u32 s37, s35, 0
  s_and_b32 s37, s37, 0xffff
  s_mov_b32 s38, 4194304
  s_mov_b32 s39, 0x00020000
  s_mov_b32 s40, s24
  s_and_b32 s41, s25, 0xffff
  s_mov_b32 s42, 7340032
  s_mov_b32 s43, 0x00020000
  s_add_u32 s56, s34, 24117248
  s_addc_u32 s57, s35, 0
  s_and_b32 s57, s57, 0xffff
  s_mov_b32 s58, 262144
  s_mov_b32 s59, 0x00020000
  s_add_u32 s64, s22, 24641536
  s_addc_u32 s65, s23, 0
  s_and_b32 s65, s65, 0xffff
  s_mov_b32 s66, 262144
  s_mov_b32 s67, 0x00020000
  s_mov_b32 s52, s26
  s_and_b32 s53, s27, 0xffff
  s_mov_b32 s54, 7168
  s_mov_b32 s55, 0x00020000
  s_mov_b32 s60, s28
  s_and_b32 s61, s29, 0xffff
  s_mov_b32 s62, 7340032
  s_mov_b32 s63, 0x00020000
  s_cmp_eq_u32 s96, 0
  s_cselect_b32 s62, s62, 0
  s_and_b32 s3, s70, 3
  s_lshl_b32 s4, s2, 2
  s_add_u32 s3, s3, s4
  s_mul_i32 s98, s3, 3584
  s_add_u32 s98, s98, 3670016
  s_add_u32 s3, s96, s70
  s_cmp_lg_u32 s3, 4
  s_cbranch_scc1 L_w1_chk
  s_add_u32 s44, s22, 41943040
  s_addc_u32 s45, s23, 0
  s_and_b32 s45, s45, 0xffff
  s_mov_b32 s46, 524288
  s_mov_b32 s47, 0x00020000
  s_mov_b32 s79, 0x100000
  v_lshrrev_b32 v2, 2, v1
  v_and_b32 v3, 3, v1
  v_lshlrev_b32 v2, 11, v2
  v_lshl_add_u32 v2, v3, 4, v2
  s_and_b32 s3, s69, 15
  s_lshl_b32 s3, s3, 7
L_w1_chkl:
  buffer_load_dwordx4 v[12:15], v2, s[44:47], s3 offen sc1
  s_sub_u32 s79, s79, 1
  s_cbranch_scc1 L_w1_chk
  s_waitcnt vmcnt(0)
  v_and_b32 v12, v12, v13
  v_and_b32 v14, v14, v15
  v_and_b32 v12, v12, v14
  v_cmp_ne_u32 vcc, 1, v12
  s_cbranch_vccnz L_w1_chkl
L_w1_chk:
  s_mov_b32 s75, 98304
  s_add_u32 s44, s22, 41943040
  s_addc_u32 s45, s23, 0
  s_and_b32 s45, s45, 0xffff
  s_mov_b32 s46, 524288
  s_mov_b32 s47, 0x00020000
  s_lshl4_add_u32 s3, s97, s68
  s_and_b32 s4, s69, 15
  s_lshl4_add_u32 s3, s3, s4
  s_lshl_b32 s3, s3, 7
  s_sub_u32 s3, s3, 32768
  v_lshlrev_b32 v11, 7, v1
  v_and_b32 v2, 15, v1
  v_lshlrev_b32 v2, 2, v2
  v_mov_b32 v3, 1
  s_mov_b32 s79, 0x100000
  s_cmp_lg_u32 s70, 4
  s_barrier
  s_cbranch_scc1 L_w1_nofl
  s_mov_b32 exec_lo, 0xffff
  s_mov_b32 exec_hi, 0
  buffer_store_dword v3, v11, s[44:47], s87 offen sc1
  s_mov_b64 exec, -1
L_w1_nofl:
  s_mov_b32 s5, s3
  s_mov_b32 s88, s73
  s_add_u32 m0, s77, 0
  s_add_u32 s4, s74, 0
  buffer_load_dwordx4 v8, s[40:43], s4 offen lds
  s_add_u32 m0, s77, 1024
  s_nop 0
  buffer_load_dwordx4 v9, s[40:43], s4 offen lds
  s_add_u32 m0, s77, 8192
  s_add_u32 s4, s74, s78
  buffer_load_dwordx4 v8, s[40:43], s4 offen lds
  s_add_u32 m0, s77, 9216
  s_nop 0
  buffer_load_dwordx4 v9, s[40:43], s4 offen lds
  s_add_u32 m0, s77, 16384
  s_add_u32 s4, s4, 128
  buffer_load_dwordx4 v8, s[40:43], s4 offen lds
  s_add_u32 m0, s77, 17408
  s_nop 0
  buffer_load_dwordx4 v9, s[40:43], s4 offen lds
  s_add_u32 m0, s77, 24576
  s_nop 0
  buffer_load_dwordx4 v28, s[40:43], s74 offen lds
  s_add_u32 s101, s101, 1
  s_sub_u32 s73, s101, s100
  s_lshl_b32 s73, s73, 3
  s_lshr_b32 s73, 0xf0f02, s73
  s_and_b32 s73, s73, 255
  s_add_u32 s73, s73, s101
  s_and_b32 s73, s73, 15
  s_mul_i32 s74, s73, 458752
  s_lshl_b32 s73, s73, 11
  s_mov_b32 s89, s73
  s_add_u32 m0, s77, 49152
  s_add_u32 s4, s74, 0
  buffer_load_dwordx4 v8, s[40:43], s4 offen lds
  s_add_u32 m0, s77, 50176
  s_nop 0
  buffer_load_dwordx4 v9, s[40:43], s4 offen lds
  s_add_u32 m0, s77, 57344
  s_add_u32 s4, s74, s78
  buffer_load_dwordx4 v8, s[40:43], s4 offen lds
  s_add_u32 m0, s77, 58368
  s_nop 0
  buffer_load_dwordx4 v9, s[40:43], s4 offen lds
  s_add_u32 m0, s77, 65536
  s_add_u32 s4, s4, 128
  buffer_load_dwordx4 v8, s[40:43], s4 offen lds
  s_add_u32 m0, s77, 66560
  s_nop 0
  buffer_load_dwordx4 v9, s[40:43], s4 offen lds
  s_add_u32 m0, s77, 73728
  s_nop 0
  buffer_load_dwordx4 v28, s[40:43], s74 offen lds
  s_add_u32 s101, s101, 1
  s_sub_u32 s73, s101, s100
  s_lshl_b32 s73, s73, 3
  s_lshr_b32 s73, 0xf0f02, s73
  s_and_b32 s73, s73, 255
  s_add_u32 s73, s73, s101
  s_and_b32 s73, s73, 15
  s_mul_i32 s74, s73, 458752
  s_lshl_b32 s73, s73, 11
  s_mov_b32 s3, s5
  s_cmp_lg_u32 s70, 4
  s_cbranch_scc1 L_w1_dep
L_w1_poll:
  buffer_load_dword v3, v2, s[44:47], s3 offen sc1
  s_sub_u32 s79, s79, 1
  s_cbranch_scc1 L_w1_dep
  s_waitcnt vmcnt(0)
  v_cmp_ne_u32 vcc, 1, v3
  s_cbranch_vccnz L_w1_poll
L_w1_dep:
  s_barrier
  s_add_u32 m0, s76, 0
  s_nop 0
  buffer_load_dwordx4 v4, s[36:39], s88 offen offset:0 lds
  buffer_load_dwordx4 v4, s[36:39], s88 offen offset:1024 lds
  s_add_u32 m0, s76, 2048
  s_nop 0
  buffer_load_dwordx4 v5, s[36:39], s88 offen offset:0 lds
  buffer_load_dwordx4 v5, s[36:39], s88 offen offset:1024 lds
  s_add_u32 m0, s76, 49152
  s_nop 0
  buffer_load_dwordx4 v4, s[36:39], s89 offen offset:0 lds
  buffer_load_dwordx4 v4, s[36:39], s89 offen offset:1024 lds
  s_add_u32 m0, s76, 51200
  s_nop 0
  buffer_load_dwordx4 v5, s[36:39], s89 offen offset:0 lds
  buffer_load_dwordx4 v5, s[36:39], s89 offen offset:1024 lds
  s_waitcnt vmcnt(4)
  s_barrier
  s_mov_b32 s79, 13
L_w1_ld1:
  s_add_u32 s3, s75, s76
  s_add_u32 m0, s3, 0
  s_nop 0
  buffer_load_dwordx4 v4, s[36:39], s73 offen offset:0 lds
  buffer_load_dwordx4 v4, s[36:39], s73 offen offset:1024 lds
  s_add_u32 m0, s3, 2048
  s_nop 0
  buffer_load_dwordx4 v5, s[36:39], s73 offen offset:0 lds
  buffer_load_dwordx4 v5, s[36:39], s73 offen offset:1024 lds
  s_add_u32 s3, s75, s77
  s_add_u32 m0, s3, 0
  s_add_u32 s4, s74, 0
  buffer_load_dwordx4 v8, s[40:43], s4 offen lds
  s_add_u32 m0, s3, 1024
  s_nop 0
  buffer_load_dwordx4 v9, s[40:43], s4 offen lds
  s_add_u32 m0, s3, 8192
  s_add_u32 s4, s74, s78
  buffer_load_dwordx4 v8, s[40:43], s4 offen lds
  s_add_u32 m0, s3, 9216
  s_nop 0
  buffer_load_dwordx4 v9, s[40:43], s4 offen lds
  s_add_u32 m0, s3, 16384
  s_add_u32 s4, s4, 128
  buffer_load_dwordx4 v8, s[40:43], s4 offen lds
  s_add_u32 m0, s3, 17408
  s_nop 0
  buffer_load_dwordx4 v9, s[40:43], s4 offen lds
  s_add_u32 m0, s3, 24576
  s_nop 0
  buffer_load_dwordx4 v28, s[40:43], s74 offen lds
  s_add_u32 s101, s101, 1
  s_sub_u32 s73, s101, s100
  s_lshl_b32 s73, s73, 3
  s_lshr_b32 s73, 0xf0f02, s73
  s_and_b32 s73, s73, 255
  s_add_u32 s73, s73, s101
  s_and_b32 s73, s73, 15
  s_mul_i32 s74, s73, 458752
  s_lshl_b32 s73, s73, 11
  s_add_u32 s75, s75, 49152
  s_cmp_eq_u32 s75, 147456
  s_cselect_b32 s75, 0, s75
  s_buffer_load_dword s84, s[60:63], s98 offset:0
  s_buffer_load_dword s84, s[60:63], s98 offset:64
  s_buffer_load_dword s84, s[60:63], s98 offset:128
  s_buffer_load_dword s84, s[60:63], s98 offset:192
  s_add_u32 s98, s98, 256
  s_waitcnt vmcnt(11)
  s_barrier
  s_sub_u32 s79, s79, 1
  s_cmp_lg_u32 s79, 0
  s_cbranch_scc1 L_w1_ld1
  s_add_u32 s3, s75, s76
  s_add_u32 m0, s3, 0
  s_nop 0
  buffer_load_dwordx4 v4, s[36:39], s73 offen offset:0 lds
  buffer_load_dwordx4 v4, s[36:39], s73 offen offset:1024 lds
  s_add_u32 m0, s3, 2048
  s_nop 0
  buffer_load_dwordx4 v5, s[36:39], s73 offen offset:0 lds
  buffer_load_dwordx4 v5, s[36:39], s73 offen offset:1024 lds
  s_add_u32 s3, s75, s77
  s_add_u32 m0, s3, 0
  s_add_u32 s4, s74, 0
  buffer_load_dwordx4 v8, s[40:43], s4 offen lds
  s_add_u32 m0, s3, 1024
  s_nop 0
  buffer_load_dwordx4 v9, s[40:43], s4 offen lds
  s_add_u32 m0, s3, 8192
  s_add_u32 s4, s74, s78
  buffer_load_dwordx4 v8, s[40:43], s4 offen lds
  s_add_u32 m0, s3, 9216
  s_nop 0
  buffer_load_dwordx4 v9, s[40:43], s4 offen lds
  s_add_u32 m0, s3, 16384
  s_add_u32 s4, s4, 128
  buffer_load_dwordx4 v8, s[40:43], s4 offen lds
  s_add_u32 m0, s3, 17408
  s_nop 0
  buffer_load_dwordx4 v9, s[40:43], s4 offen lds
  s_add_u32 m0, s3, 24576
  s_nop 0
  buffer_load_dwordx4 v28, s[40:43], s74 offen lds
  s_add_u32 s101, s101, 1
  s_sub_u32 s73, s101, s100
  s_lshl_b32 s73, s73, 3
  s_lshr_b32 s73, 0xf0f02, s73
  s_and_b32 s73, s73, 255
  s_add_u32 s73, s73, s101
  s_and_b32 s73, s73, 15
  s_mul_i32 s74, s73, 458752
  s_lshl_b32 s73, s73, 11
  s_add_u32 s75, s75, 49152
  s_cmp_eq_u32 s75, 147456
  s_cselect_b32 s75, 0, s75
  s_buffer_load_dword s84, s[60:63], s98 offset:0
  s_buffer_load_dword s84, s[60:63], s98 offset:64
  s_buffer_load_dword s84, s[60:63], s98 offset:128
  s_buffer_load_dword s84, s[60:63], s98 offset:192
  s_add_u32 s98, s98, 256
  s_and_b32 s3, s70, 3
  s_lshl_b32 s4, s68, 7
  s_lshl_b32 s5, s3, 6
  s_add_u32 s5, s5, s4
  v_add_u32 v2, s5, v1
  s_sub_u32 s4, s4, 16
  v_and_b32 v3, 15, v1
  v_add_u32 v3, s4, v3
  v_max_i32 v3, 0, v3
  s_cmp_ge_u32 s3, 2
  s_cselect_b64 vcc, -1, 0
  v_cndmask_b32 v2, v2, v3, vcc
  v_lshlrev_b32 v2, 3, v2
  s_mov_b32 s3, 0
  buffer_load_dwordx2 v[32:33], v2, s[56:59], s3 offen
  s_add_u32 s3, s3, 16384
  buffer_load_dwordx2 v[34:35], v2, s[56:59], s3 offen
  s_add_u32 s3, s3, 16384
  buffer_load_dwordx2 v[36:37], v2, s[56:59], s3 offen
  s_add_u32 s3, s3, 16384
  buffer_load_dwordx2 v[38:39], v2, s[56:59], s3 offen
  s_add_u32 s3, s3, 16384
  buffer_load_dwordx2 v[40:41], v2, s[56:59], s3 offen
  s_add_u32 s3, s3, 16384
  buffer_load_dwordx2 v[42:43], v2, s[56:59], s3 offen
  s_add_u32 s3, s3, 16384
  buffer_load_dwordx2 v[44:45], v2, s[56:59], s3 offen
  s_add_u32 s3, s3, 16384
  buffer_load_dwordx2 v[46:47], v2, s[56:59], s3 offen
  s_add_u32 s3, s3, 16384
  buffer_load_dwordx2 v[48:49], v2, s[56:59], s3 offen
  s_add_u32 s3, s3, 16384
  buffer_load_dwordx2 v[50:51], v2, s[56:59], s3 offen
  s_add_u32 s3, s3, 16384
  buffer_load_dwordx2 v[52:53], v2, s[56:59], s3 offen
  s_add_u32 s3, s3, 16384
  buffer_load_dwordx2 v[54:55], v2, s[56:59], s3 offen
  s_add_u32 s3, s3, 16384
  buffer_load_dwordx2 v[56:57], v2, s[56:59], s3 offen
  s_add_u32 s3, s3, 16384
  buffer_load_dwordx2 v[58:59], v2, s[56:59], s3 offen
  s_add_u32 s3, s3, 16384
  buffer_load_dwordx2 v[60:61], v2, s[56:59], s3 offen
  s_add_u32 s3, s3, 16384
  buffer_load_dwordx2 v[62:63], v2, s[56:59], s3 offen
  s_lshl_b32 s4, s69, 7
  s_lshl_b32 s5, s70, 6
  s_add_u32 s4, s4, s5
  s_add_u32 s4, s4, 1216
  s_lshl_b32 s5, s69, 6
  s_cmp_eq_u32 s70, 4
  s_cselect_b32 s4, s5, s4
  s_lshr_b32 s5, s5, 1
  s_add_u32 s5, s5, 1024
  s_cmp_eq_u32 s70, 7
  s_cselect_b32 s4, s5, s4
  v_add_u32 v3, s4, v1
  v_lshlrev_b32 v2, 2, v3
  v_lshlrev_b32 v3, 1, v3
  s_mov_b32 s3, 0
  buffer_load_dword v64, v2, s[64:67], s3 offen
  s_add_u32 s3, s3, 16384
  buffer_load_dword v65, v2, s[64:67], s3 offen
  s_add_u32 s3, s3, 16384
  buffer_load_dword v66, v2, s[64:67], s3 offen
  s_add_u32 s3, s3, 16384
  buffer_load_dword v67, v2, s[64:67], s3 offen
  s_add_u32 s3, s3, 16384
  buffer_load_dword v68, v2, s[64:67], s3 offen
  s_add_u32 s3, s3, 16384
  buffer_load_dword v69, v2, s[64:67], s3 offen
  s_add_u32 s3, s3, 16384
  buffer_load_dword v70, v2, s[64:67], s3 offen
  s_add_u32 s3, s3, 16384
  buffer_load_dword v71, v2, s[64:67], s3 offen
  s_add_u32 s3, s3, 16384
  buffer_load_dword v72, v2, s[64:67], s3 offen
  s_add_u32 s3, s3, 16384
  buffer_load_dword v73, v2, s[64:67], s3 offen
  s_add_u32 s3, s3, 16384
  buffer_load_dword v74, v2, s[64:67], s3 offen
  s_add_u32 s3, s3, 16384
  buffer_load_dword v75, v2, s[64:67], s3 offen
  s_add_u32 s3, s3, 16384
  buffer_load_dword v76, v2, s[64:67], s3 offen
  s_add_u32 s3, s3, 16384
  buffer_load_dword v77, v2, s[64:67], s3 offen
  s_add_u32 s3, s3, 16384
  buffer_load_dword v78, v2, s[64:67], s3 offen
  s_add_u32 s3, s3, 16384
  buffer_load_dword v79, v2, s[64:67], s3 offen
  buffer_load_ushort v80, v3, s[52:55], 0 offen
  s_waitcnt vmcnt(44)
  s_barrier
  s_waitcnt vmcnt(33)
  s_barrier
  s_waitcnt vmcnt(0)
  v_add_f32 v32, v32, v34
  v_add_f32 v33, v33, v35
  v_add_f32 v48, v48, v50
  v_add_f32 v49, v49, v51
  v_add_f32 v32, v32, v36
  v_add_f32 v33, v33, v37
  v_add_f32 v48, v48, v52
  v_add_f32 v49, v49, v53
  v_add_f32 v32, v32, v38
  v_add_f32 v33, v33, v39
  v_add_f32 v48, v48, v54
  v_add_f32 v49, v49, v55
  v_add_f32 v32, v32, v40
  v_add_f32 v33, v33, v41
  v_add_f32 v48, v48, v56
  v_add_f32 v49, v49, v57
  v_add_f32 v32, v32, v42
  v_add_f32 v33, v33, v43
  v_add_f32 v48, v48, v58
  v_add_f32 v49, v49, v59
  v_add_f32 v32, v32, v44
  v_add_f32 v33, v33, v45
  v_add_f32 v48, v48, v60
  v_add_f32 v49, v49, v61
  v_add_f32 v32, v32, v46
  v_add_f32 v33, v33, v47
  v_add_f32 v48, v48, v62
  v_add_f32 v49, v49, v63
  v_add_f32 v32, v32, v48
  v_add_f32 v33, v33, v49
  v_mul_f32 v32, 0x3a800000, v32
  v_mul_f32 v33, 0x3a800000, v33
  v_fma_f32 v33, -v32, v32, v33
  v_max_f32 v33, 0, v33
  v_add_f32 v33, 0x3727c5ac, v33
  v_rsq_f32 v33, v33
  s_nop 0
  s_and_b32 s3, s70, 3
  s_lshl_b32 s5, s3, 6
  s_add_u32 s5, s5, 16
  v_add_u32 v2, s5, v1
  v_and_b32 v3, 15, v1
  s_cmp_ge_u32 s3, 2
  s_cselect_b64 vcc, -1, 0
  v_cndmask_b32 v2, v2, v3, vcc
  v_lshlrev_b32 v2, 2, v2
  v_add_u32 v2, 147456, v2
  ds_write2_b32 v2, v32, v33 offset0:0 offset1:160
  v_add_f32 v64, v64, v72
  v_add_f32 v65, v65, v73
  v_add_f32 v66, v66, v74
  v_add_f32 v67, v67, v75
  v_add_f32 v68, v68, v76
  v_add_f32 v69, v69, v77
  v_add_f32 v70, v70, v78
  v_add_f32 v71, v71, v79
  v_add_f32 v64, v64, v68
  v_add_f32 v65, v65, v69
  v_add_f32 v66, v66, v70
  v_add_f32 v67, v67, v71
  v_add_f32 v64, v64, v65
  v_add_f32 v66, v66, v67
  v_add_f32 v64, v64, v66
  v_lshlrev_b32 v80, 16, v80
  v_lshlrev_b32 v2, 2, v0
  v_add_u32 v2, 147712, v2
  ds_write_b32 v2, v64
  ds_write_b32 v2, v80 offset:1024
  s_waitcnt lgkmcnt(0)
  s_barrier
  s_lshl_b32 s87, s97, 15
  s_lshl_b32 s4, s68, 11
  s_add_u32 s87, s87, s4
  s_lshl_b32 s4, s69, 2
  s_add_u32 s87, s87, s4
  s_add_u32 s97, s97, 1
  s_branch L_w2_body
L_w1_end:
  s_endpgm
L_w1_compute:
  s_and_b32 s71, s70, 1
  s_lshr_b32 s72, s70, 1
  v_and_b32 v3, 15, v1
  v_lshrrev_b32 v2, 4, v1
  s_lshl_b32 s8, s71, 13
  v_lshl_add_u32 v4, v1, 4, s8
  v_bfe_u32 v13, v1, 2, 2
  v_lshl_add_u32 v13, v2, 3, v13
  v_lshlrev_b32 v13, 7, v13
  v_and_b32 v17, 3, v1
  v_lshl_add_u32 v13, v17, 3, v13
  v_bfe_u32 v17, v1, 3, 2
  v_lshl_add_u32 v13, v17, 5, v13
  s_lshl_b32 s9, s72, 6
  v_xor_b32 v13, s9, v13
  v_add_u32 v5, 16384, v13
  v_xor_b32 v6, 32, v5
  v_and_b32 v16, 1, v2
  v_lshrrev_b32 v17, 1, v2
  v_bfe_u32 v13, v1, 2, 2
  v_lshl_add_u32 v13, v16, 3, v13
  v_lshl_add_u32 v13, v17, 5, v13
  v_xor_b32 v14, s72, v16
  v_lshl_add_u32 v13, v13, 1, v14
  v_and_b32 v14, 3, v1
  v_lshl_add_u32 v13, v13, 2, v14
  v_lshlrev_b32 v13, 3, v13
  v_add_u32 v7, 40960, v13
  s_lshl_b32 s8, s68, 7
  s_lshl_b32 s9, s71, 6
  s_add_u32 s8, s8, s9
  s_mul_i32 s8, s8, 7168
  v_lshlrev_b32 v14, 8, v17
  v_lshl_add_u32 v14, v3, 4, v14
  v_add_u32 v14, s8, v14
  s_lshl_b32 s10, s69, 11
  s_lshl_b32 s9, s72, 10
  s_add_u32 s9, s9, s10
  v_lshl_add_u32 v12, v16, 9, v14
  v_add_u32 v12, s9, v12
  v_mul_u32_u24 v16, 114688, v16
  s_lshr_b32 s9, s9, 1
  v_add3_u32 v13, v16, v14, s9
  s_lshl_b32 s9, s71, 8
  s_add_u32 s9, s9, 147520
  v_lshl_add_u32 v14, v3, 2, s9
  s_lshl_b32 s9, s72, 7
  s_add_u32 s9, s9, 148736
  v_lshl_add_u32 v15, v2, 4, s9
  s_lshl_b32 s9, s72, 6
  s_add_u32 s9, s9, 148736
  v_lshl_add_u32 v16, v2, 4, s9
  v_mov_b32 v128, 0
  v_mov_b32 v129, 0
  v_mov_b32 v130, 0
  v_mov_b32 v131, 0
  v_mov_b32 v132, 0
  v_mov_b32 v133, 0
  v_mov_b32 v134, 0
  v_mov_b32 v135, 0
  v_mov_b32 v136, 0
  v_mov_b32 v137, 0
  v_mov_b32 v138, 0
  v_mov_b32 v139, 0
  v_mov_b32 v140, 0
  v_mov_b32 v141, 0
  v_mov_b32 v142, 0
  v_mov_b32 v143, 0
  v_mov_b32 v144, 0
  v_mov_b32 v145, 0
  v_mov_b32 v146, 0
  v_mov_b32 v147, 0
  v_mov_b32 v148, 0
  v_mov_b32 v149, 0
  v_mov_b32 v150, 0
  v_mov_b32 v151, 0
  v_mov_b32 v152, 0
  v_mov_b32 v153, 0
  v_mov_b32 v154, 0
  v_mov_b32 v155, 0
  v_mov_b32 v156, 0
  v_mov_b32 v157, 0
  v_mov_b32 v158, 0
  v_mov_b32 v159, 0
  v_mov_b32 v160, 0
  v_mov_b32 v161, 0
  v_mov_b32 v162, 0
  v_mov_b32 v163, 0
  v_mov_b32 v164, 0
  v_mov_b32 v165, 0
  v_mov_b32 v166, 0
  v_mov_b32 v167, 0
  v_mov_b32 v168, 0
  v_mov_b32 v169, 0
  v_mov_b32 v170, 0
  v_mov_b32 v171, 0
  v_mov_b32 v172, 0
  v_mov_b32 v173, 0
  v_mov_b32 v174, 0
  v_mov_b32 v175, 0
  v_mov_b32 v176, 0
  v_mov_b32 v177, 0
  v_mov_b32 v178, 0
  v_mov_b32 v179, 0
  v_mov_b32 v180, 0
  v_mov_b32 v181, 0
  v_mov_b32 v182, 0
  v_mov_b32 v183, 0
  v_mov_b32 v184, 0
  v_mov_b32 v185, 0
  v_mov_b32 v186, 0
  v_mov_b32 v187, 0
  v_mov_b32 v188, 0
  v_mov_b32 v189, 0
  v_mov_b32 v190, 0
  v_mov_b32 v191, 0
  v_mov_b32 v192, 0
  v_mov_b32 v193, 0
  v_mov_b32 v194, 0
  v_mov_b32 v195, 0
  v_mov_b32 v196, 0
  v_mov_b32 v197, 0
  v_mov_b32 v198, 0
  v_mov_b32 v199, 0
  v_mov_b32 v200, 0
  v_mov_b32 v201, 0
  v_mov_b32 v202, 0
  v_mov_b32 v203, 0
  v_mov_b32 v204, 0
  v_mov_b32 v205, 0
  v_mov_b32 v206, 0
  v_mov_b32 v207, 0
  v_mov_b32 v208, 0
  v_mov_b32 v209, 0
  v_mov_b32 v210, 0
  v_mov_b32 v211, 0
  v_mov_b32 v212, 0
  v_mov_b32 v213, 0
  v_mov_b32 v214, 0
  v_mov_b32 v215, 0
  v_mov_b32 v216, 0
  v_mov_b32 v217, 0
  v_mov_b32 v218, 0
  v_mov_b32 v219, 0
  v_mov_b32 v220, 0
  v_mov_b32 v221, 0
  v_mov_b32 v222, 0
  v_mov_b32 v223, 0
  v_mov_b32 v224, 0
  v_mov_b32 v225, 0
  v_mov_b32 v226, 0
  v_mov_b32 v227, 0
  v_mov_b32 v228, 0
  v_mov_b32 v229, 0
  v_mov_b32 v230, 0
  v_mov_b32 v231, 0
  v_mov_b32 v232, 0
  v_mov_b32 v233, 0
  v_mov_b32 v234, 0
  v_mov_b32 v235, 0
  v_mov_b32 v236, 0
  v_mov_b32 v237, 0
  v_mov_b32 v238, 0
  v_mov_b32 v239, 0
  s_waitcnt lgkmcnt(0)
  s_add_u32 s44, s34, 8388608
  s_addc_u32 s45, s35, 0
  s_and_b32 s45, s45, 0xffff
  s_mov_b32 s46, 14680064
  s_mov_b32 s47, 0x00020000
  s_cmp_lg_u32 s96, 0
  s_cbranch_scc1 L_pfc3_skip
  s_getpc_b64 s[4:5]
L_pfc3:
  s_lshl_b32 s3, s99, 2
  s_add_u32 s3, s3, s70
  s_mul_i32 s3, s3, 192
  s_min_u32 s3, s3, L_w2_c1-L_w2_c0-192
  s_add_i32 s3, s3, L_w2_c0-L_pfc3
  s_ashr_i32 s6, s3, 31
  s_add_u32 s4, s4, s3
  s_addc_u32 s5, s5, s6
  s_load_dword s36, s[4:5], 0
  s_load_dword s37, s[4:5], 64
  s_load_dword s38, s[4:5], 128
L_pfc3_skip:
  s_mov_b32 s75, 0
  v_add_u32_e64 v20, s75, v4
  v_add_u32_e64 v21, s75, v5
  v_add_u32_e64 v22, s75, v6
  v_add_u32_e64 v23, s75, v7
  s_add_u32 s75, s75, 49152
  s_cmp_eq_u32 s75, 147456
  s_cselect_b32 s75, 0, s75
  s_mov_b32 s79, 16
  s_barrier
  s_barrier
  ds_read_b128 v[32:35], v20 offset:0
  ds_read_b128 v[36:39], v20 offset:2048
  ds_read_b128 v[40:43], v20 offset:4096
  ds_read_b128 v[44:47], v20 offset:6144
  ds_read_b64_tr_b16 v[48:49], v21 offset:0
  ds_read_b64_tr_b16 v[50:51], v21 offset:512
  ds_read_b64_tr_b16 v[52:53], v22 offset:0
  ds_read_b64_tr_b16 v[54:55], v22 offset:512
  ds_read_b64_tr_b16 v[56:57], v21 offset:8192
  ds_read_b64_tr_b16 v[58:59], v21 offset:8704
  ds_read_b64_tr_b16 v[60:61], v22 offset:8192
  ds_read_b64_tr_b16 v[62:63], v22 offset:8704
  ds_read_b64_tr_b16 v[64:65], v21 offset:16384
  ds_read_b64_tr_b16 v[66:67], v21 offset:16896
  ds_read_b64_tr_b16 v[68:69], v22 offset:16384
  ds_read_b64_tr_b16 v[70:71], v22 offset:16896
  ds_read_b64_tr_b16 v[72:73], v23 offset:0
  ds_read_b64_tr_b16 v[74:75], v23 offset:256
  s_waitcnt lgkmcnt(0)
.p2align 3
L_w1_loop:
  v_mfma_f32_16x16x32_bf16 v[128:131], v[48:51], v[32:35], v[128:131]
  ds_read_b128 v[80:83], v20 offset:1024
  v_mfma_f32_16x16x32_bf16 v[132:135], v[48:51], v[36:39], v[132:135]
  ds_read_b128 v[84:87], v20 offset:3072
  v_mfma_f32_16x16x32_bf16 v[136:139], v[48:51], v[40:43], v[136:139]
  ds_read_b128 v[88:91], v20 offset:5120
  v_mfma_f32_16x16x32_bf16 v[140:143], v[48:51], v[44:47], v[140:143]
  ds_read_b128 v[92:95], v20 offset:7168
  v_mfma_f32_16x16x32_bf16 v[144:147], v[52:55], v[32:35], v[144:147]
  ds_read_b64_tr_b16 v[96:97], v21 offset:4096
  v_mfma_f32_16x16x32_bf16 v[148:151], v[52:55], v[36:39], v[148:151]
  ds_read_b64_tr_b16 v[98:99], v21 offset:4608
  v_mfma_f32_16x16x32_bf16 v[152:155], v[52:55], v[40:43], v[152:155]
  ds_read_b64_tr_b16 v[100:101], v22 offset:4096
  v_mfma_f32_16x16x32_bf16 v[156:159], v[52:55], v[44:47], v[156:159]
  ds_read_b64_tr_b16 v[102:103], v22 offset:4608
  v_mfma_f32_16x16x32_bf16 v[160:163], v[56:59], v[32:35], v[160:163]
  ds_read_b64_tr_b16 v[104:105], v21 offset:12288
  v_mfma_f32_16x16x32_bf16 v[164:167], v[56:59], v[36:39], v[164:167]
  ds_read_b64_tr_b16 v[106:107], v21 offset:12800
  v_mfma_f32_16x16x32_bf16 v[168:171], v[56:59], v[40:43], v[168:171]
  ds_read_b64_tr_b16 v[108:109], v22 offset:12288
  v_mfma_f32_16x16x32_bf16 v[172:175], v[56:59], v[44:47], v[172:175]
  ds_read_b64_tr_b16 v[110:111], v22 offset:12800
  v_mfma_f32_16x16x32_bf16 v[176:179], v[60:63], v[32:35], v[176:179]
  ds_read_b64_tr_b16 v[112:113], v21 offset:20480
  v_mfma_f32_16x16x32_bf16 v[180:183], v[60:63], v[36:39], v[180:183]
  ds_read_b64_tr_b16 v[114:115], v21 offset:20992
  v_mfma_f32_16x16x32_bf16 v[184:187], v[60:63], v[40:43], v[184:187]
  ds_read_b64_tr_b16 v[116:117], v22 offset:20480
  v_mfma_f32_16x16x32_bf16 v[188:191], v[60:63], v[44:47], v[188:191]
  ds_read_b64_tr_b16 v[118:119], v22 offset:20992
  v_mfma_f32_16x16x32_bf16 v[192:195], v[64:67], v[32:35], v[192:195]
  ds_read_b64_tr_b16 v[120:121], v23 offset:4096
  v_mfma_f32_16x16x32_bf16 v[196:199], v[64:67], v[36:39], v[196:199]
  ds_read_b64_tr_b16 v[122:123], v23 offset:4352
  v_mfma_f32_16x16x32_bf16 v[200:203], v[64:67], v[40:43], v[200:203]
  v_add_u32_e64 v20, s75, v4
  v_mfma_f32_16x16x32_bf16 v[204:207], v[64:67], v[44:47], v[204:207]
  v_add_u32_e64 v21, s75, v5
  v_mfma_f32_16x16x32_bf16 v[208:211], v[68:71], v[32:35], v[208:211]
  v_add_u32_e64 v22, s75, v6
  v_mfma_f32_16x16x32_bf16 v[212:215], v[68:71], v[36:39], v[212:215]
  v_add_u32_e64 v23, s75, v7
  v_mfma_f32_16x16x32_bf16 v[216:219], v[68:71], v[40:43], v[216:219]
  s_add_u32 s75, s75, 49152
  v_mfma_f32_16x16x32_bf16 v[220:223], v[68:71], v[44:47], v[220:223]
  s_cmp_eq_u32 s75, 147456
  v_mfma_f32_16x16x32_bf16 v[224:227], v[72:75], v[32:35], v[224:227]
  s_cselect_b32 s75, 0, s75
  s_sub_u32 s79, s79, 1
  v_mfma_f32_16x16x32_bf16 v[228:231], v[72:75], v[36:39], v[228:231]
  v_mfma_f32_16x16x32_bf16 v[232:235], v[72:75], v[40:43], v[232:235]
  v_mfma_f32_16x16x32_bf16 v[236:239], v[72:75], v[44:47], v[236:239]
  s_waitcnt lgkmcnt(0)
  s_barrier
  v_mfma_f32_16x16x32_bf16 v[128:131], v[96:99], v[80:83], v[128:131]
  ds_read_b128 v[32:35], v20 offset:0
  v_mfma_f32_16x16x32_bf16 v[132:135], v[96:99], v[84:87], v[132:135]
  ds_read_b128 v[36:39], v20 offset:2048
  v_mfma_f32_16x16x32_bf16 v[136:139], v[96:99], v[88:91], v[136:139]
  ds_read_b128 v[40:43], v20 offset:4096
  v_mfma_f32_16x16x32_bf16 v[140:143], v[96:99], v[92:95], v[140:143]
  ds_read_b128 v[44:47], v20 offset:6144
  v_mfma_f32_16x16x32_bf16 v[144:147], v[100:103], v[80:83], v[144:147]
  ds_read_b64_tr_b16 v[48:49], v21 offset:0
  v_mfma_f32_16x16x32_bf16 v[148:151], v[100:103], v[84:87], v[148:151]
  ds_read_b64_tr_b16 v[50:51], v21 offset:512
  v_mfma_f32_16x16x32_bf16 v[152:155], v[100:103], v[88:91], v[152:155]
  ds_read_b64_tr_b16 v[52:53], v22 offset:0
  v_mfma_f32_16x16x32_bf16 v[156:159], v[100:103], v[92:95], v[156:159]
  ds_read_b64_tr_b16 v[54:55], v22 offset:512
  v_mfma_f32_16x16x32_bf16 v[160:163], v[104:107], v[80:83], v[160:163]
  ds_read_b64_tr_b16 v[56:57], v21 offset:8192
  v_mfma_f32_16x16x32_bf16 v[164:167], v[104:107], v[84:87], v[164:167]
  ds_read_b64_tr_b16 v[58:59], v21 offset:8704
  v_mfma_f32_16x16x32_bf16 v[168:171], v[104:107], v[88:91], v[168:171]
  ds_read_b64_tr_b16 v[60:61], v22 offset:8192
  v_mfma_f32_16x16x32_bf16 v[172:175], v[104:107], v[92:95], v[172:175]
  ds_read_b64_tr_b16 v[62:63], v22 offset:8704
  v_mfma_f32_16x16x32_bf16 v[176:179], v[108:111], v[80:83], v[176:179]
  ds_read_b64_tr_b16 v[64:65], v21 offset:16384
  v_mfma_f32_16x16x32_bf16 v[180:183], v[108:111], v[84:87], v[180:183]
  ds_read_b64_tr_b16 v[66:67], v21 offset:16896
  v_mfma_f32_16x16x32_bf16 v[184:187], v[108:111], v[88:91], v[184:187]
  ds_read_b64_tr_b16 v[68:69], v22 offset:16384
  v_mfma_f32_16x16x32_bf16 v[188:191], v[108:111], v[92:95], v[188:191]
  ds_read_b64_tr_b16 v[70:71], v22 offset:16896
  v_mfma_f32_16x16x32_bf16 v[192:195], v[112:115], v[80:83], v[192:195]
  ds_read_b64_tr_b16 v[72:73], v23 offset:0
  v_mfma_f32_16x16x32_bf16 v[196:199], v[112:115], v[84:87], v[196:199]
  ds_read_b64_tr_b16 v[74:75], v23 offset:256
  v_mfma_f32_16x16x32_bf16 v[200:203], v[112:115], v[88:91], v[200:203]
  s_cmp_lg_u32 s79, 0
  s_nop 0
  v_mfma_f32_16x16x32_bf16 v[204:207], v[112:115], v[92:95], v[204:207]
  v_mfma_f32_16x16x32_bf16 v[208:211], v[116:119], v[80:83], v[208:211]
  v_mfma_f32_16x16x32_bf16 v[212:215], v[116:119], v[84:87], v[212:215]
  v_mfma_f32_16x16x32_bf16 v[216:219], v[116:119], v[88:91], v[216:219]
  v_mfma_f32_16x16x32_bf16 v[220:223], v[116:119], v[92:95], v[220:223]
  v_mfma_f32_16x16x32_bf16 v[224:227], v[120:123], v[80:83], v[224:227]
  v_mfma_f32_16x16x32_bf16 v[228:231], v[120:123], v[84:87], v[228:231]
  v_mfma_f32_16x16x32_bf16 v[232:235], v[120:123], v[88:91], v[232:235]
  v_mfma_f32_16x16x32_bf16 v[236:239], v[120:123], v[92:95], v[236:239]
  s_waitcnt lgkmcnt(0)
  s_cbranch_scc1 L_w1_loop
L_w1_exit:
  ds_read2_b32 v[88:89], v14 offset0:0 offset1:160
  ds_read2_b32 v[90:91], v14 offset0:16 offset1:176
  ds_read2_b32 v[92:93], v14 offset0:32 offset1:192
  ds_read2_b32 v[94:95], v14 offset0:48 offset1:208
  ds_read_b128 v[32:35], v15 offset:0
  ds_read_b128 v[60:63], v15 offset:1024
  ds_read_b128 v[36:39], v15 offset:64
  ds_read_b128 v[64:67], v15 offset:1088
  ds_read_b128 v[40:43], v15 offset:256
  ds_read_b128 v[68:71], v15 offset:1280
  ds_read_b128 v[44:47], v15 offset:320
  ds_read_b128 v[72:75], v15 offset:1344
  ds_read_b128 v[48:51], v15 offset:512
  ds_read_b128 v[76:79], v15 offset:1536
  ds_read_b128 v[52:55], v15 offset:576
  ds_read_b128 v[80:83], v15 offset:1600
  ds_read_b128 v[56:59], v16 offset:768
  ds_read_b128 v[84:87], v16 offset:1792
  v_mov_b32 v96, 0xc0135761
  v_mov_b32 v97, 0xbdd2d3e8
  v_mov_b32 v98, 1.0
  s_waitcnt lgkmcnt(0)
  v_mul_f32 v88, v88, v89
  v_mul_f32 v90, v90, v91
  v_mul_f32 v92, v92, v93
  v_mul_f32 v94, v94, v95
  v_pk_fma_f32 v[100:101], v[32:33], v[88:89], v[60:61] op_sel:[0,0,0] op_sel_hi:[1,0,1] neg_lo:[0,1,0] neg_hi:[0,1,0]
  v_pk_fma_f32 v[102:103], v[34:35], v[88:89], v[62:63] op_sel:[0,0,0] op_sel_hi:[1,0,1] neg_lo:[0,1,0] neg_hi:[0,1,0]
  v_pk_fma_f32 v[128:129], v[128:129], v[88:89], v[100:101] op_sel:[0,1,0] op_sel_hi:[1,1,1]
  v_pk_fma_f32 v[130:131], v[130:131], v[88:89], v[102:103] op_sel:[0,1,0] op_sel_hi:[1,1,1]
  v_pk_mul_f32 v[100:101], v[128:129], v[128:129]
  v_pk_mul_f32 v[102:103], v[130:131], v[130:131]
  v_pk_fma_f32 v[100:101], v[100:101], v[96:97], v[96:97] op_sel:[0,1,0] op_sel_hi:[1,1,0]
  v_pk_fma_f32 v[102:103], v[102:103], v[96:97], v[96:97] op_sel:[0,1,0] op_sel_hi:[1,1,0]
  v_pk_mul_f32 v[100:101], v[100:101], v[128:129]
  v_pk_mul_f32 v[102:103], v[102:103], v[130:131]
  v_exp_f32 v100, v100
  v_exp_f32 v101, v101
  v_exp_f32 v102, v102
  v_exp_f32 v103, v103
  v_pk_add_f32 v[100:101], v[100:101], v[98:99] op_sel_hi:[1,0]
  v_pk_add_f32 v[102:103], v[102:103], v[98:99] op_sel_hi:[1,0]
  v_rcp_f32 v100, v100
  v_rcp_f32 v101, v101
  v_rcp_f32 v102, v102
  v_rcp_f32 v103, v103
  v_pk_mul_f32 v[128:129], v[128:129], v[100:101]
  v_pk_mul_f32 v[130:131], v[130:131], v[102:103]
  v_cvt_pk_bf16_f32 v108, v128, v129
  v_cvt_pk_bf16_f32 v109, v130, v131
  v_pk_fma_f32 v[104:105], v[36:37], v[88:89], v[64:65] op_sel:[0,0,0] op_sel_hi:[1,0,1] neg_lo:[0,1,0] neg_hi:[0,1,0]
  v_pk_fma_f32 v[106:107], v[38:39], v[88:89], v[66:67] op_sel:[0,0,0] op_sel_hi:[1,0,1] neg_lo:[0,1,0] neg_hi:[0,1,0]
  v_pk_fma_f32 v[144:145], v[144:145], v[88:89], v[104:105] op_sel:[0,1,0] op_sel_hi:[1,1,1]
  v_pk_fma_f32 v[146:147], v[146:147], v[88:89], v[106:107] op_sel:[0,1,0] op_sel_hi:[1,1,1]
  v_pk_mul_f32 v[104:105], v[144:145], v[144:145]
  v_pk_mul_f32 v[106:107], v[146:147], v[146:147]
  v_pk_fma_f32 v[104:105], v[104:105], v[96:97], v[96:97] op_sel:[0,1,0] op_sel_hi:[1,1,0]
  v_pk_fma_f32 v[106:107], v[106:107], v[96:97], v[96:97] op_sel:[0,1,0] op_sel_hi:[1,1,0]
  v_pk_mul_f32 v[104:105], v[104:105], v[144:145]
  v_pk_mul_f32 v[106:107], v[106:107], v[146:147]
  v_exp_f32 v104, v104
  v_exp_f32 v105, v105
  v_exp_f32 v106, v106
  v_exp_f32 v107, v107
  v_pk_add_f32 v[104:105], v[104:105], v[98:99] op_sel_hi:[1,0]
  v_pk_add_f32 v[106:107], v[106:107], v[98:99] op_sel_hi:[1,0]
  v_rcp_f32 v104, v104
  v_rcp_f32 v105, v105
  v_rcp_f32 v106, v106
  v_rcp_f32 v107, v107
  v_pk_mul_f32 v[144:145], v[144:145], v[104:105]
  v_pk_mul_f32 v[146:147], v[146:147], v[106:107]
  v_cvt_pk_bf16_f32 v110, v144, v145
  v_cvt_pk_bf16_f32 v111, v146, v147
  s_mov_b32 s3, 0
  s_nop 0
  v_permlane16_swap_b32 v108, v110
  v_permlane16_swap_b32 v109, v111
  buffer_store_dwordx4 v[108:111], v12, s[44:47], s3 offen sc1
  v_pk_fma_f32 v[100:101], v[32:33], v[90:91], v[60:61] op_sel:[0,0,0] op_sel_hi:[1,0,1] neg_lo:[0,1,0] neg_hi:[0,1,0]
  v_pk_fma_f32 v[102:103], v[34:35], v[90:91], v[62:63] op_sel:[0,0,0] op_sel_hi:[1,0,1] neg_lo:[0,1,0] neg_hi:[0,1,0]
  v_pk_fma_f32 v[132:133], v[132:133], v[90:91], v[100:101] op_sel:[0,1,0] op_sel_hi:[1,1,1]
  v_pk_fma_f32 v[134:135], v[134:135], v[90:91], v[102:103] op_sel:[0,1,0] op_sel_hi:[1,1,1]
  v_pk_mul_f32 v[100:101], v[132:133], v[132:133]
  v_pk_mul_f32 v[102:103], v[134:135], v[134:135]
  v_pk_fma_f32 v[100:101], v[100:101], v[96:97], v[96:97] op_sel:[0,1,0] op_sel_hi:[1,1,0]
  v_pk_fma_f32 v[102:103], v[102:103], v[96:97], v[96:97] op_sel:[0,1,0] op_sel_hi:[1,1,0]
  v_pk_mul_f32 v[100:101], v[100:101], v[132:133]
  v_pk_mul_f32 v[102:103], v[102:103], v[134:135]
  v_exp_f32 v100, v100
  v_exp_f32 v101, v101
  v_exp_f32 v102, v102
  v_exp_f32 v103, v103
  v_pk_add_f32 v[100:101], v[100:101], v[98:99] op_sel_hi:[1,0]
  v_pk_add_f32 v[102:103], v[102:103], v[98:99] op_sel_hi:[1,0]
  v_rcp_f32 v100, v100
  v_rcp_f32 v101, v101
  v_rcp_f32 v102, v102
  v_rcp_f32 v103, v103
  v_pk_mul_f32 v[132:133], v[132:133], v[100:101]
  v_pk_mul_f32 v[134:135], v[134:135], v[102:103]
  v_cvt_pk_bf16_f32 v112, v132, v133
  v_cvt_pk_bf16_f32 v113, v134, v135
  v_pk_fma_f32 v[104:105], v[36:37], v[90:91], v[64:65] op_sel:[0,0,0] op_sel_hi:[1,0,1] neg_lo:[0,1,0] neg_hi:[0,1,0]
  v_pk_fma_f32 v[106:107], v[38:39], v[90:91], v[66:67] op_sel:[0,0,0] op_sel_hi:[1,0,1] neg_lo:[0,1,0] neg_hi:[0,1,0]
  v_pk_fma_f32 v[148:149], v[148:149], v[90:91], v[104:105] op_sel:[0,1,0] op_sel_hi:[1,1,1]
  v_pk_fma_f32 v[150:151], v[150:151], v[90:91], v[106:107] op_sel:[0,1,0] op_sel_hi:[1,1,1]
  v_pk_mul_f32 v[104:105], v[148:149], v[148:149]
  v_pk_mul_f32 v[106:107], v[150:151], v[150:151]
  v_pk_fma_f32 v[104:105], v[104:105], v[96:97], v[96:97] op_sel:[0,1,0] op_sel_hi:[1,1,0]
  v_pk_fma_f32 v[106:107], v[106:107], v[96:97], v[96:97] op_sel:[0,1,0] op_sel_hi:[1,1,0]
  v_pk_mul_f32 v[104:105], v[104:105], v[148:149]
  v_pk_mul_f32 v[106:107], v[106:107], v[150:151]
  v_exp_f32 v104, v104
  v_exp_f32 v105, v105
  v_exp_f32 v106, v106
  v_exp_f32 v107, v107
  v_pk_add_f32 v[104:105], v[104:105], v[98:99] op_sel_hi:[1,0]
  v_pk_add_f32 v[106:107], v[106:107], v[98:99] op_sel_hi:[1,0]
  v_rcp_f32 v104, v104
  v_rcp_f32 v105, v105
  v_rcp_f32 v106, v106
  v_rcp_f32 v107, v107
  v_pk_mul_f32 v[148:149], v[148:149], v[104:105]
  v_pk_mul_f32 v[150:151], v[150:151], v[106:107]
  v_cvt_pk_bf16_f32 v114, v148, v149
  v_cvt_pk_bf16_f32 v115, v150, v151
  s_mov_b32 s3, 114688
  s_nop 0
  v_permlane16_swap_b32 v112, v114
  v_permlane16_swap_b32 v113, v115
  buffer_store_dwordx4 v[112:115], v12, s[44:47], s3 offen sc1
  v_pk_fma_f32 v[100:101], v[32:33], v[92:93], v[60:61] op_sel:[0,0,0] op_sel_hi:[1,0,1] neg_lo:[0,1,0] neg_hi:[0,1,0]
  v_pk_fma_f32 v[102:103], v[34:35], v[92:93], v[62:63] op_sel:[0,0,0] op_sel_hi:[1,0,1] neg_lo:[0,1,0] neg_hi:[0,1,0]
  v_pk_fma_f32 v[136:137], v[136:137], v[92:93], v[100:101] op_sel:[0,1,0] op_sel_hi:[1,1,1]
  v_pk_fma_f32 v[138:139], v[138:139], v[92:93], v[102:103] op_sel:[0,1,0] op_sel_hi:[1,1,1]
  v_pk_mul_f32 v[100:101], v[136:137], v[136:137]
  v_pk_mul_f32 v[102:103], v[138:139], v[138:139]
  v_pk_fma_f32 v[100:101], v[100:101], v[96:97], v[96:97] op_sel:[0,1,0] op_sel_hi:[1,1,0]
  v_pk_fma_f32 v[102:103], v[102:103], v[96:97], v[96:97] op_sel:[0,1,0] op_sel_hi:[1,1,0]
  v_pk_mul_f32 v[100:101], v[100:101], v[136:137]
  v_pk_mul_f32 v[102:103], v[102:103], v[138:139]
  v_exp_f32 v100, v100
  v_exp_f32 v101, v101
  v_exp_f32 v102, v102
  v_exp_f32 v103, v103
  v_pk_add_f32 v[100:101], v[100:101], v[98:99] op_sel_hi:[1,0]
  v_pk_add_f32 v[102:103], v[102:103], v[98:99] op_sel_hi:[1,0]
  v_rcp_f32 v100, v100
  v_rcp_f32 v101, v101
  v_rcp_f32 v102, v102
  v_rcp_f32 v103, v103
  v_pk_mul_f32 v[136:137], v[136:137], v[100:101]
  v_pk_mul_f32 v[138:139], v[138:139], v[102:103]
  v_cvt_pk_bf16_f32 v116, v136, v137
  v_cvt_pk_bf16_f32 v117, v138, v139
  v_pk_fma_f32 v[104:105], v[36:37], v[92:93], v[64:65] op_sel:[0,0,0] op_sel_hi:[1,0,1] neg_lo:[0,1,0] neg_hi:[0,1,0]
  v_pk_fma_f32 v[106:107], v[38:39], v[92:93], v[66:67] op_sel:[0,0,0] op_sel_hi:[1,0,1] neg_lo:[0,1,0] neg_hi:[0,1,0]
  v_pk_fma_f32 v[152:153], v[152:153], v[92:93], v[104:105] op_sel:[0,1,0] op_sel_hi:[1,1,1]
  v_pk_fma_f32 v[154:155], v[154:155], v[92:93], v[106:107] op_sel:[0,1,0] op_sel_hi:[1,1,1]
  v_pk_mul_f32 v[104:105], v[152:153], v[152:153]
  v_pk_mul_f32 v[106:107], v[154:155], v[154:155]
  v_pk_fma_f32 v[104:105], v[104:105], v[96:97], v[96:97] op_sel:[0,1,0] op_sel_hi:[1,1,0]
  v_pk_fma_f32 v[106:107], v[106:107], v[96:97], v[96:97] op_sel:[0,1,0] op_sel_hi:[1,1,0]
  v_pk_mul_f32 v[104:105], v[104:105], v[152:153]
  v_pk_mul_f32 v[106:107], v[106:107], v[154:155]
  v_exp_f32 v104, v104
  v_exp_f32 v105, v105
  v_exp_f32 v106, v106
  v_exp_f32 v107, v107
  v_pk_add_f32 v[104:105], v[104:105], v[98:99] op_sel_hi:[1,0]
  v_pk_add_f32 v[106:107], v[106:107], v[98:99] op_sel_hi:[1,0]
  v_rcp_f32 v104, v104
  v_rcp_f32 v105, v105
  v_rcp_f32 v106, v106
  v_rcp_f32 v107, v107
  v_pk_mul_f32 v[152:153], v[152:153], v[104:105]
  v_pk_mul_f32 v[154:155], v[154:155], v[106:107]
  v_cvt_pk_bf16_f32 v118, v152, v153
  v_cvt_pk_bf16_f32 v119, v154, v155
  s_mov_b32 s3, 229376
  s_nop 0
  v_permlane16_swap_b32 v116, v118
  v_permlane16_swap_b32 v117, v119
  buffer_store_dwordx4 v[116:119], v12, s[44:47], s3 offen sc1
  v_pk_fma_f32 v[100:101], v[32:33], v[94:95], v[60:61] op_sel:[0,0,0] op_sel_hi:[1,0,1] neg_lo:[0,1,0] neg_hi:[0,1,0]
  v_pk_fma_f32 v[102:103], v[34:35], v[94:95], v[62:63] op_sel:[0,0,0] op_sel_hi:[1,0,1] neg_lo:[0,1,0] neg_hi:[0,1,0]
  v_pk_fma_f32 v[140:141], v[140:141], v[94:95], v[100:101] op_sel:[0,1,0] op_sel_hi:[1,1,1]
  v_pk_fma_f32 v[142:143], v[142:143], v[94:95], v[102:103] op_sel:[0,1,0] op_sel_hi:[1,1,1]
  v_pk_mul_f32 v[100:101], v[140:141], v[140:141]
  v_pk_mul_f32 v[102:103], v[142:143], v[142:143]
  v_pk_fma_f32 v[100:101], v[100:101], v[96:97], v[96:97] op_sel:[0,1,0] op_sel_hi:[1,1,0]
  v_pk_fma_f32 v[102:103], v[102:103], v[96:97], v[96:97] op_sel:[0,1,0] op_sel_hi:[1,1,0]
  v_pk_mul_f32 v[100:101], v[100:101], v[140:141]
  v_pk_mul_f32 v[102:103], v[102:103], v[142:143]
  v_exp_f32 v100, v100
  v_exp_f32 v101, v101
  v_exp_f32 v102, v102
  v_exp_f32 v103, v103
  v_pk_add_f32 v[100:101], v[100:101], v[98:99] op_sel_hi:[1,0]
  v_pk_add_f32 v[102:103], v[102:103], v[98:99] op_sel_hi:[1,0]
  v_rcp_f32 v100, v100
  v_rcp_f32 v101, v101
  v_rcp_f32 v102, v102
  v_rcp_f32 v103, v103
  v_pk_mul_f32 v[140:141], v[140:141], v[100:101]
  v_pk_mul_f32 v[142:143], v[142:143], v[102:103]
  v_cvt_pk_bf16_f32 v120, v140, v141
  v_cvt_pk_bf16_f32 v121, v142, v143
  v_pk_fma_f32 v[104:105], v[36:37], v[94:95], v[64:65] op_sel:[0,0,0] op_sel_hi:[1,0,1] neg_lo:[0,1,0] neg_hi:[0,1,0]
  v_pk_fma_f32 v[106:107], v[38:39], v[94:95], v[66:67] op_sel:[0,0,0] op_sel_hi:[1,0,1] neg_lo:[0,1,0] neg_hi:[0,1,0]
  v_pk_fma_f32 v[156:157], v[156:157], v[94:95], v[104:105] op_sel:[0,1,0] op_sel_hi:[1,1,1]
  v_pk_fma_f32 v[158:159], v[158:159], v[94:95], v[106:107] op_sel:[0,1,0] op_sel_hi:[1,1,1]
  v_pk_mul_f32 v[104:105], v[156:157], v[156:157]
  v_pk_mul_f32 v[106:107], v[158:159], v[158:159]
  v_pk_fma_f32 v[104:105], v[104:105], v[96:97], v[96:97] op_sel:[0,1,0] op_sel_hi:[1,1,0]
  v_pk_fma_f32 v[106:107], v[106:107], v[96:97], v[96:97] op_sel:[0,1,0] op_sel_hi:[1,1,0]
  v_pk_mul_f32 v[104:105], v[104:105], v[156:157]
  v_pk_mul_f32 v[106:107], v[106:107], v[158:159]
  v_exp_f32 v104, v104
  v_exp_f32 v105, v105
  v_exp_f32 v106, v106
  v_exp_f32 v107, v107
  v_pk_add_f32 v[104:105], v[104:105], v[98:99] op_sel_hi:[1,0]
  v_pk_add_f32 v[106:107], v[106:107], v[98:99] op_sel_hi:[1,0]
  v_rcp_f32 v104, v104
  v_rcp_f32 v105, v105
  v_rcp_f32 v106, v106
  v_rcp_f32 v107, v107
  v_pk_mul_f32 v[156:157], v[156:157], v[104:105]
  v_pk_mul_f32 v[158:159], v[158:159], v[106:107]
  v_cvt_pk_bf16_f32 v122, v156, v157
  v_cvt_pk_bf16_f32 v123, v158, v159
  s_mov_b32 s3, 344064
  s_nop 0
  v_permlane16_swap_b32 v120, v122
  v_permlane16_swap_b32 v121, v123
  buffer_store_dwordx4 v[120:123], v12, s[44:47], s3 offen sc1
  v_pk_fma_f32 v[100:101], v[56:57], v[88:89], v[84:85] op_sel:[0,0,0] op_sel_hi:[1,0,1] neg_lo:[0,1,0] neg_hi:[0,1,0]
  v_pk_fma_f32 v[102:103], v[58:59], v[88:89], v[86:87] op_sel:[0,0,0] op_sel_hi:[1,0,1] neg_lo:[0,1,0] neg_hi:[0,1,0]
  v_pk_fma_f32 v[224:225], v[224:225], v[88:89], v[100:101] op_sel:[0,1,0] op_sel_hi:[1,1,1]
  v_pk_fma_f32 v[226:227], v[226:227], v[88:89], v[102:103] op_sel:[0,1,0] op_sel_hi:[1,1,1]
  v_pk_mul_f32 v[100:101], v[224:225], v[224:225]
  v_pk_mul_f32 v[102:103], v[226:227], v[226:227]
  v_pk_fma_f32 v[100:101], v[100:101], v[96:97], v[96:97] op_sel:[0,1,0] op_sel_hi:[1,1,0]
  v_pk_fma_f32 v[102:103], v[102:103], v[96:97], v[96:97] op_sel:[0,1,0] op_sel_hi:[1,1,0]
  v_pk_mul_f32 v[100:101], v[100:101], v[224:225]
  v_pk_mul_f32 v[102:103], v[102:103], v[226:227]
  v_exp_f32 v100, v100
  v_exp_f32 v101, v101
  v_exp_f32 v102, v102
  v_exp_f32 v103, v103
  v_pk_add_f32 v[100:101], v[100:101], v[98:99] op_sel_hi:[1,0]
  v_pk_add_f32 v[102:103], v[102:103], v[98:99] op_sel_hi:[1,0]
  v_rcp_f32 v100, v100
  v_rcp_f32 v101, v101
  v_rcp_f32 v102, v102
  v_rcp_f32 v103, v103
  v_pk_mul_f32 v[224:225], v[224:225], v[100:101]
  v_pk_mul_f32 v[226:227], v[226:227], v[102:103]
  v_cvt_pk_bf16_f32 v108, v224, v225
  v_cvt_pk_bf16_f32 v109, v226, v227
  v_pk_fma_f32 v[100:101], v[56:57], v[90:91], v[84:85] op_sel:[0,0,0] op_sel_hi:[1,0,1] neg_lo:[0,1,0] neg_hi:[0,1,0]
  v_pk_fma_f32 v[102:103], v[58:59], v[90:91], v[86:87] op_sel:[0,0,0] op_sel_hi:[1,0,1] neg_lo:[0,1,0] neg_hi:[0,1,0]
  v_pk_fma_f32 v[228:229], v[228:229], v[90:91], v[100:101] op_sel:[0,1,0] op_sel_hi:[1,1,1]
  v_pk_fma_f32 v[230:231], v[230:231], v[90:91], v[102:103] op_sel:[0,1,0] op_sel_hi:[1,1,1]
  v_pk_mul_f32 v[100:101], v[228:229], v[228:229]
  v_pk_mul_f32 v[102:103], v[230:231], v[230:231]
  v_pk_fma_f32 v[100:101], v[100:101], v[96:97], v[96:97] op_sel:[0,1,0] op_sel_hi:[1,1,0]
  v_pk_fma_f32 v[102:103], v[102:103], v[96:97], v[96:97] op_sel:[0,1,0] op_sel_hi:[1,1,0]
  v_pk_mul_f32 v[100:101], v[100:101], v[228:229]
  v_pk_mul_f32 v[102:103], v[102:103], v[230:231]
  v_exp_f32 v100, v100
  v_exp_f32 v101, v101
  v_exp_f32 v102, v102
  v_exp_f32 v103, v103
  v_pk_add_f32 v[100:101], v[100:101], v[98:99] op_sel_hi:[1,0]
  v_pk_add_f32 v[102:103], v[102:103], v[98:99] op_sel_hi:[1,0]
  v_rcp_f32 v100, v100
  v_rcp_f32 v101, v101
  v_rcp_f32 v102, v102
  v_rcp_f32 v103, v103
  v_pk_mul_f32 v[228:229], v[228:229], v[100:101]
  v_pk_mul_f32 v[230:231], v[230:231], v[102:103]
  v_cvt_pk_bf16_f32 v110, v228, v229
  v_cvt_pk_bf16_f32 v111, v230, v231
  s_mov_b32 s3, 32768
  s_nop 0
  v_permlane16_swap_b32 v108, v110
  v_permlane16_swap_b32 v109, v111
  buffer_store_dwordx4 v[108:111], v13, s[44:47], s3 offen sc1
  v_pk_fma_f32 v[100:101], v[56:57], v[92:93], v[84:85] op_sel:[0,0,0] op_sel_hi:[1,0,1] neg_lo:[0,1,0] neg_hi:[0,1,0]
  v_pk_fma_f32 v[102:103], v[58:59], v[92:93], v[86:87] op_sel:[0,0,0] op_sel_hi:[1,0,1] neg_lo:[0,1,0] neg_hi:[0,1,0]
  v_pk_fma_f32 v[232:233], v[232:233], v[92:93], v[100:101] op_sel:[0,1,0] op_sel_hi:[1,1,1]
  v_pk_fma_f32 v[234:235], v[234:235], v[92:93], v[102:103] op_sel:[0,1,0] op_sel_hi:[1,1,1]
  v_pk_mul_f32 v[100:101], v[232:233], v[232:233]
  v_pk_mul_f32 v[102:103], v[234:235], v[234:235]
  v_pk_fma_f32 v[100:101], v[100:101], v[96:97], v[96:97] op_sel:[0,1,0] op_sel_hi:[1,1,0]
  v_pk_fma_f32 v[102:103], v[102:103], v[96:97], v[96:97] op_sel:[0,1,0] op_sel_hi:[1,1,0]
  v_pk_mul_f32 v[100:101], v[100:101], v[232:233]
  v_pk_mul_f32 v[102:103], v[102:103], v[234:235]
  v_exp_f32 v100, v100
  v_exp_f32 v101, v101
  v_exp_f32 v102, v102
  v_exp_f32 v103, v103
  v_pk_add_f32 v[100:101], v[100:101], v[98:99] op_sel_hi:[1,0]
  v_pk_add_f32 v[102:103], v[102:103], v[98:99] op_sel_hi:[1,0]
  v_rcp_f32 v100, v100
  v_rcp_f32 v101, v101
  v_rcp_f32 v102, v102
  v_rcp_f32 v103, v103
  v_pk_mul_f32 v[232:233], v[232:233], v[100:101]
  v_pk_mul_f32 v[234:235], v[234:235], v[102:103]
  v_cvt_pk_bf16_f32 v112, v232, v233
  v_cvt_pk_bf16_f32 v113, v234, v235
  v_pk_fma_f32 v[100:101], v[56:57], v[94:95], v[84:85] op_sel:[0,0,0] op_sel_hi:[1,0,1] neg_lo:[0,1,0] neg_hi:[0,1,0]
  v_pk_fma_f32 v[102:103], v[58:59], v[94:95], v[86:87] op_sel:[0,0,0] op_sel_hi:[1,0,1] neg_lo:[0,1,0] neg_hi:[0,1,0]
  v_pk_fma_f32 v[236:237], v[236:237], v[94:95], v[100:101] op_sel:[0,1,0] op_sel_hi:[1,1,1]
  v_pk_fma_f32 v[238:239], v[238:239], v[94:95], v[102:103] op_sel:[0,1,0] op_sel_hi:[1,1,1]
  v_pk_mul_f32 v[100:101], v[236:237], v[236:237]
  v_pk_mul_f32 v[102:103], v[238:239], v[238:239]
  v_pk_fma_f32 v[100:101], v[100:101], v[96:97], v[96:97] op_sel:[0,1,0] op_sel_hi:[1,1,0]
  v_pk_fma_f32 v[102:103], v[102:103], v[96:97], v[96:97] op_sel:[0,1,0] op_sel_hi:[1,1,0]
  v_pk_mul_f32 v[100:101], v[100:101], v[236:237]
  v_pk_mul_f32 v[102:103], v[102:103], v[238:239]
  v_exp_f32 v100, v100
  v_exp_f32 v101, v101
  v_exp_f32 v102, v102
  v_exp_f32 v103, v103
  v_pk_add_f32 v[100:101], v[100:101], v[98:99] op_sel_hi:[1,0]
  v_pk_add_f32 v[102:103], v[102:103], v[98:99] op_sel_hi:[1,0]
  v_rcp_f32 v100, v100
  v_rcp_f32 v101, v101
  v_rcp_f32 v102, v102
  v_rcp_f32 v103, v103
  v_pk_mul_f32 v[236:237], v[236:237], v[100:101]
  v_pk_mul_f32 v[238:239], v[238:239], v[102:103]
  v_cvt_pk_bf16_f32 v114, v236, v237
  v_cvt_pk_bf16_f32 v115, v238, v239
  s_mov_b32 s3, 262144
  s_nop 0
  v_permlane16_swap_b32 v112, v114
  v_permlane16_swap_b32 v113, v115
  buffer_store_dwordx4 v[112:115], v13, s[44:47], s3 offen sc1
  v_pk_fma_f32 v[100:101], v[40:41], v[88:89], v[68:69] op_sel:[0,0,0] op_sel_hi:[1,0,1] neg_lo:[0,1,0] neg_hi:[0,1,0]
  v_pk_fma_f32 v[102:103], v[42:43], v[88:89], v[70:71] op_sel:[0,0,0] op_sel_hi:[1,0,1] neg_lo:[0,1,0] neg_hi:[0,1,0]
  v_pk_fma_f32 v[160:161], v[160:161], v[88:89], v[100:101] op_sel:[0,1,0] op_sel_hi:[1,1,1]
  v_pk_fma_f32 v[162:163], v[162:163], v[88:89], v[102:103] op_sel:[0,1,0] op_sel_hi:[1,1,1]
  v_pk_mul_f32 v[100:101], v[160:161], v[160:161]
  v_pk_mul_f32 v[102:103], v[162:163], v[162:163]
  v_pk_fma_f32 v[100:101], v[100:101], v[96:97], v[96:97] op_sel:[0,1,0] op_sel_hi:[1,1,0]
  v_pk_fma_f32 v[102:103], v[102:103], v[96:97], v[96:97] op_sel:[0,1,0] op_sel_hi:[1,1,0]
  v_pk_mul_f32 v[100:101], v[100:101], v[160:161]
  v_pk_mul_f32 v[102:103], v[102:103], v[162:163]
  v_exp_f32 v100, v100
  v_exp_f32 v101, v101
  v_exp_f32 v102, v102
  v_exp_f32 v103, v103
  v_pk_add_f32 v[100:101], v[100:101], v[98:99] op_sel_hi:[1,0]
  v_pk_add_f32 v[102:103], v[102:103], v[98:99] op_sel_hi:[1,0]
  v_rcp_f32 v100, v100
  v_rcp_f32 v101, v101
  v_rcp_f32 v102, v102
  v_rcp_f32 v103, v103
  v_pk_mul_f32 v[160:161], v[160:161], v[100:101]
  v_pk_mul_f32 v[162:163], v[162:163], v[102:103]
  v_cvt_pk_bf16_f32 v116, v160, v161
  v_cvt_pk_bf16_f32 v117, v162, v163
  v_pk_fma_f32 v[104:105], v[44:45], v[88:89], v[72:73] op_sel:[0,0,0] op_sel_hi:[1,0,1] neg_lo:[0,1,0] neg_hi:[0,1,0]
  v_pk_fma_f32 v[106:107], v[46:47], v[88:89], v[74:75] op_sel:[0,0,0] op_sel_hi:[1,0,1] neg_lo:[0,1,0] neg_hi:[0,1,0]
  v_pk_fma_f32 v[176:177], v[176:177], v[88:89], v[104:105] op_sel:[0,1,0] op_sel_hi:[1,1,1]
  v_pk_fma_f32 v[178:179], v[178:179], v[88:89], v[106:107] op_sel:[0,1,0] op_sel_hi:[1,1,1]
  v_pk_mul_f32 v[104:105], v[176:177], v[176:177]
  v_pk_mul_f32 v[106:107], v[178:179], v[178:179]
  v_pk_fma_f32 v[104:105], v[104:105], v[96:97], v[96:97] op_sel:[0,1,0] op_sel_hi:[1,1,0]
  v_pk_fma_f32 v[106:107], v[106:107], v[96:97], v[96:97] op_sel:[0,1,0] op_sel_hi:[1,1,0]
  v_pk_mul_f32 v[104:105], v[104:105], v[176:177]
  v_pk_mul_f32 v[106:107], v[106:107], v[178:179]
  v_exp_f32 v104, v104
  v_exp_f32 v105, v105
  v_exp_f32 v106, v106
  v_exp_f32 v107, v107
  v_pk_add_f32 v[104:105], v[104:105], v[98:99] op_sel_hi:[1,0]
  v_pk_add_f32 v[106:107], v[106:107], v[98:99] op_sel_hi:[1,0]
  v_rcp_f32 v104, v104
  v_rcp_f32 v105, v105
  v_rcp_f32 v106, v106
  v_rcp_f32 v107, v107
  v_pk_mul_f32 v[176:177], v[176:177], v[104:105]
  v_pk_mul_f32 v[178:179], v[178:179], v[106:107]
  v_cvt_pk_bf16_f32 v118, v176, v177
  v_cvt_pk_bf16_f32 v119, v178, v179
  s_add_u32 s3, s10, 49152
  s_nop 0
  v_permlane16_swap_b32 v116, v118
  v_permlane16_swap_b32 v117, v119
  buffer_store_dwordx4 v[116:119], v12, s[44:47], s3 offen sc1
  v_pk_fma_f32 v[100:101], v[48:49], v[88:89], v[76:77] op_sel:[0,0,0] op_sel_hi:[1,0,1] neg_lo:[0,1,0] neg_hi:[0,1,0]
  v_pk_fma_f32 v[102:103], v[50:51], v[88:89], v[78:79] op_sel:[0,0,0] op_sel_hi:[1,0,1] neg_lo:[0,1,0] neg_hi:[0,1,0]
  v_pk_fma_f32 v[192:193], v[192:193], v[88:89], v[100:101] op_sel:[0,1,0] op_sel_hi:[1,1,1]
  v_pk_fma_f32 v[194:195], v[194:195], v[88:89], v[102:103] op_sel:[0,1,0] op_sel_hi:[1,1,1]
  v_pk_mul_f32 v[100:101], v[192:193], v[192:193]
  v_pk_mul_f32 v[102:103], v[194:195], v[194:195]
  v_pk_fma_f32 v[100:101], v[100:101], v[96:97], v[96:97] op_sel:[0,1,0] op_sel_hi:[1,1,0]
  v_pk_fma_f32 v[102:103], v[102:103], v[96:97], v[96:97] op_sel:[0,1,0] op_sel_hi:[1,1,0]
  v_pk_mul_f32 v[100:101], v[100:101], v[192:193]
  v_pk_mul_f32 v[102:103], v[102:103], v[194:195]
  v_exp_f32 v100, v100
  v_exp_f32 v101, v101
  v_exp_f32 v102, v102
  v_exp_f32 v103, v103
  v_pk_add_f32 v[100:101], v[100:101], v[98:99] op_sel_hi:[1,0]
  v_pk_add_f32 v[102:103], v[102:103], v[98:99] op_sel_hi:[1,0]
  v_rcp_f32 v100, v100
  v_rcp_f32 v101, v101
  v_rcp_f32 v102, v102
  v_rcp_f32 v103, v103
  v_pk_mul_f32 v[192:193], v[192:193], v[100:101]
  v_pk_mul_f32 v[194:195], v[194:195], v[102:103]
  v_cvt_pk_bf16_f32 v120, v192, v193
  v_cvt_pk_bf16_f32 v121, v194, v195
  v_pk_fma_f32 v[104:105], v[52:53], v[88:89], v[80:81] op_sel:[0,0,0] op_sel_hi:[1,0,1] neg_lo:[0,1,0] neg_hi:[0,1,0]
  v_pk_fma_f32 v[106:107], v[54:55], v[88:89], v[82:83] op_sel:[0,0,0] op_sel_hi:[1,0,1] neg_lo:[0,1,0] neg_hi:[0,1,0]
  v_pk_fma_f32 v[208:209], v[208:209], v[88:89], v[104:105] op_sel:[0,1,0] op_sel_hi:[1,1,1]
  v_pk_fma_f32 v[210:211], v[210:211], v[88:89], v[106:107] op_sel:[0,1,0] op_sel_hi:[1,1,1]
  v_pk_mul_f32 v[104:105], v[208:209], v[208:209]
  v_pk_mul_f32 v[106:107], v[210:211], v[210:211]
  v_pk_fma_f32 v[104:105], v[104:105], v[96:97], v[96:97] op_sel:[0,1,0] op_sel_hi:[1,1,0]
  v_pk_fma_f32 v[106:107], v[106:107], v[96:97], v[96:97] op_sel:[0,1,0] op_sel_hi:[1,1,0]
  v_pk_mul_f32 v[104:105], v[104:105], v[208:209]
  v_pk_mul_f32 v[106:107], v[106:107], v[210:211]
  v_exp_f32 v104, v104
  v_exp_f32 v105, v105
  v_exp_f32 v106, v106
  v_exp_f32 v107, v107
  v_pk_add_f32 v[104:105], v[104:105], v[98:99] op_sel_hi:[1,0]
  v_pk_add_f32 v[106:107], v[106:107], v[98:99] op_sel_hi:[1,0]
  v_rcp_f32 v104, v104
  v_rcp_f32 v105, v105
  v_rcp_f32 v106, v106
  v_rcp_f32 v107, v107
  v_pk_mul_f32 v[208:209], v[208:209], v[104:105]
  v_pk_mul_f32 v[210:211], v[210:211], v[106:107]
  v_cvt_pk_bf16_f32 v122, v208, v209
  v_cvt_pk_bf16_f32 v123, v210, v211
  s_add_u32 s3, s10, 51200
  s_nop 0
  v_permlane16_swap_b32 v120, v122
  v_permlane16_swap_b32 v121, v123
  buffer_store_dwordx4 v[120:123], v12, s[44:47], s3 offen sc1
  v_pk_fma_f32 v[100:101], v[40:41], v[90:91], v[68:69] op_sel:[0,0,0] op_sel_hi:[1,0,1] neg_lo:[0,1,0] neg_hi:[0,1,0]
  v_pk_fma_f32 v[102:103], v[42:43], v[90:91], v[70:71] op_sel:[0,0,0] op_sel_hi:[1,0,1] neg_lo:[0,1,0] neg_hi:[0,1,0]
  v_pk_fma_f32 v[164:165], v[164:165], v[90:91], v[100:101] op_sel:[0,1,0] op_sel_hi:[1,1,1]
  v_pk_fma_f32 v[166:167], v[166:167], v[90:91], v[102:103] op_sel:[0,1,0] op_sel_hi:[1,1,1]
  v_pk_mul_f32 v[100:101], v[164:165], v[164:165]
  v_pk_mul_f32 v[102:103], v[166:167], v[166:167]
  v_pk_fma_f32 v[100:101], v[100:101], v[96:97], v[96:97] op_sel:[0,1,0] op_sel_hi:[1,1,0]
  v_pk_fma_f32 v[102:103], v[102:103], v[96:97], v[96:97] op_sel:[0,1,0] op_sel_hi:[1,1,0]
  v_pk_mul_f32 v[100:101], v[100:101], v[164:165]
  v_pk_mul_f32 v[102:103], v[102:103], v[166:167]
  v_exp_f32 v100, v100
  v_exp_f32 v101, v101
  v_exp_f32 v102, v102
  v_exp_f32 v103, v103
  v_pk_add_f32 v[100:101], v[100:101], v[98:99] op_sel_hi:[1,0]
  v_pk_add_f32 v[102:103], v[102:103], v[98:99] op_sel_hi:[1,0]
  v_rcp_f32 v100, v100
  v_rcp_f32 v101, v101
  v_rcp_f32 v102, v102
  v_rcp_f32 v103, v103
  v_pk_mul_f32 v[164:165], v[164:165], v[100:101]
  v_pk_mul_f32 v[166:167], v[166:167], v[102:103]
  v_cvt_pk_bf16_f32 v108, v164, v165
  v_cvt_pk_bf16_f32 v109, v166, v167
  v_pk_fma_f32 v[104:105], v[44:45], v[90:91], v[72:73] op_sel:[0,0,0] op_sel_hi:[1,0,1] neg_lo:[0,1,0] neg_hi:[0,1,0]
  v_pk_fma_f32 v[106:107], v[46:47], v[90:91], v[74:75] op_sel:[0,0,0] op_sel_hi:[1,0,1] neg_lo:[0,1,0] neg_hi:[0,1,0]
  v_pk_fma_f32 v[180:181], v[180:181], v[90:91], v[104:105] op_sel:[0,1,0] op_sel_hi:[1,1,1]
  v_pk_fma_f32 v[182:183], v[182:183], v[90:91], v[106:107] op_sel:[0,1,0] op_sel_hi:[1,1,1]
  v_pk_mul_f32 v[104:105], v[180:181], v[180:181]
  v_pk_mul_f32 v[106:107], v[182:183], v[182:183]
  v_pk_fma_f32 v[104:105], v[104:105], v[96:97], v[96:97] op_sel:[0,1,0] op_sel_hi:[1,1,0]
  v_pk_fma_f32 v[106:107], v[106:107], v[96:97], v[96:97] op_sel:[0,1,0] op_sel_hi:[1,1,0]
  v_pk_mul_f32 v[104:105], v[104:105], v[180:181]
  v_pk_mul_f32 v[106:107], v[106:107], v[182:183]
  v_exp_f32 v104, v104
  v_exp_f32 v105, v105
  v_exp_f32 v106, v106
  v_exp_f32 v107, v107
  v_pk_add_f32 v[104:105], v[104:105], v[98:99] op_sel_hi:[1,0]
  v_pk_add_f32 v[106:107], v[106:107], v[98:99] op_sel_hi:[1,0]
  v_rcp_f32 v104, v104
  v_rcp_f32 v105, v105
  v_rcp_f32 v106, v106
  v_rcp_f32 v107, v107
  v_pk_mul_f32 v[180:181], v[180:181], v[104:105]
  v_pk_mul_f32 v[182:183], v[182:183], v[106:107]
  v_cvt_pk_bf16_f32 v110, v180, v181
  v_cvt_pk_bf16_f32 v111, v182, v183
  s_add_u32 s3, s10, 163840
  s_nop 0
  v_permlane16_swap_b32 v108, v110
  v_permlane16_swap_b32 v109, v111
  buffer_store_dwordx4 v[108:111], v12, s[44:47], s3 offen sc1
  v_pk_fma_f32 v[100:101], v[48:49], v[90:91], v[76:77] op_sel:[0,0,0] op_sel_hi:[1,0,1] neg_lo:[0,1,0] neg_hi:[0,1,0]
  v_pk_fma_f32 v[102:103], v[50:51], v[90:91], v[78:79] op_sel:[0,0,0] op_sel_hi:[1,0,1] neg_lo:[0,1,0] neg_hi:[0,1,0]
  v_pk_fma_f32 v[196:197], v[196:197], v[90:91], v[100:101] op_sel:[0,1,0] op_sel_hi:[1,1,1]
  v_pk_fma_f32 v[198:199], v[198:199], v[90:91], v[102:103] op_sel:[0,1,0] op_sel_hi:[1,1,1]
  v_pk_mul_f32 v[100:101], v[196:197], v[196:197]
  v_pk_mul_f32 v[102:103], v[198:199], v[198:199]
  v_pk_fma_f32 v[100:101], v[100:101], v[96:97], v[96:97] op_sel:[0,1,0] op_sel_hi:[1,1,0]
  v_pk_fma_f32 v[102:103], v[102:103], v[96:97], v[96:97] op_sel:[0,1,0] op_sel_hi:[1,1,0]
  v_pk_mul_f32 v[100:101], v[100:101], v[196:197]
  v_pk_mul_f32 v[102:103], v[102:103], v[198:199]
  v_exp_f32 v100, v100
  v_exp_f32 v101, v101
  v_exp_f32 v102, v102
  v_exp_f32 v103, v103
  v_pk_add_f32 v[100:101], v[100:101], v[98:99] op_sel_hi:[1,0]
  v_pk_add_f32 v[102:103], v[102:103], v[98:99] op_sel_hi:[1,0]
  v_rcp_f32 v100, v100
  v_rcp_f32 v101, v101
  v_rcp_f32 v102, v102
  v_rcp_f32 v103, v103
  v_pk_mul_f32 v[196:197], v[196:197], v[100:101]
  v_pk_mul_f32 v[198:199], v[198:199], v[102:103]
  v_cvt_pk_bf16_f32 v112, v196, v197
  v_cvt_pk_bf16_f32 v113, v198, v199
  v_pk_fma_f32 v[104:105], v[52:53], v[90:91], v[80:81] op_sel:[0,0,0] op_sel_hi:[1,0,1] neg_lo:[0,1,0] neg_hi:[0,1,0]
  v_pk_fma_f32 v[106:107], v[54:55], v[90:91], v[82:83] op_sel:[0,0,0] op_sel_hi:[1,0,1] neg_lo:[0,1,0] neg_hi:[0,1,0]
  v_pk_fma_f32 v[212:213], v[212:213], v[90:91], v[104:105] op_sel:[0,1,0] op_sel_hi:[1,1,1]
  v_pk_fma_f32 v[214:215], v[214:215], v[90:91], v[106:107] op_sel:[0,1,0] op_sel_hi:[1,1,1]
  v_pk_mul_f32 v[104:105], v[212:213], v[212:213]
  v_pk_mul_f32 v[106:107], v[214:215], v[214:215]
  v_pk_fma_f32 v[104:105], v[104:105], v[96:97], v[96:97] op_sel:[0,1,0] op_sel_hi:[1,1,0]
  v_pk_fma_f32 v[106:107], v[106:107], v[96:97], v[96:97] op_sel:[0,1,0] op_sel_hi:[1,1,0]
  v_pk_mul_f32 v[104:105], v[104:105], v[212:213]
  v_pk_mul_f32 v[106:107], v[106:107], v[214:215]
  v_exp_f32 v104, v104
  v_exp_f32 v105, v105
  v_exp_f32 v106, v106
  v_exp_f32 v107, v107
  v_pk_add_f32 v[104:105], v[104:105], v[98:99] op_sel_hi:[1,0]
  v_pk_add_f32 v[106:107], v[106:107], v[98:99] op_sel_hi:[1,0]
  v_rcp_f32 v104, v104
  v_rcp_f32 v105, v105
  v_rcp_f32 v106, v106
  v_rcp_f32 v107, v107
  v_pk_mul_f32 v[212:213], v[212:213], v[104:105]
  v_pk_mul_f32 v[214:215], v[214:215], v[106:107]
  v_cvt_pk_bf16_f32 v114, v212, v213
  v_cvt_pk_bf16_f32 v115, v214, v215
  s_add_u32 s3, s10, 165888
  s_nop 0
  v_permlane16_swap_b32 v112, v114
  v_permlane16_swap_b32 v113, v115
  buffer_store_dwordx4 v[112:115], v12, s[44:47], s3 offen sc1
  v_pk_fma_f32 v[100:101], v[40:41], v[92:93], v[68:69] op_sel:[0,0,0] op_sel_hi:[1,0,1] neg_lo:[0,1,0] neg_hi:[0,1,0]
  v_pk_fma_f32 v[102:103], v[42:43], v[92:93], v[70:71] op_sel:[0,0,0] op_sel_hi:[1,0,1] neg_lo:[0,1,0] neg_hi:[0,1,0]
  v_pk_fma_f32 v[168:169], v[168:169], v[92:93], v[100:101] op_sel:[0,1,0] op_sel_hi:[1,1,1]
  v_pk_fma_f32 v[170:171], v[170:171], v[92:93], v[102:103] op_sel:[0,1,0] op_sel_hi:[1,1,1]
  v_pk_mul_f32 v[100:101], v[168:169], v[168:169]
  v_pk_mul_f32 v[102:103], v[170:171], v[170:171]
  v_pk_fma_f32 v[100:101], v[100:101], v[96:97], v[96:97] op_sel:[0,1,0] op_sel_hi:[1,1,0]
  v_pk_fma_f32 v[102:103], v[102:103], v[96:97], v[96:97] op_sel:[0,1,0] op_sel_hi:[1,1,0]
  v_pk_mul_f32 v[100:101], v[100:101], v[168:169]
  v_pk_mul_f32 v[102:103], v[102:103], v[170:171]
  v_exp_f32 v100, v100
  v_exp_f32 v101, v101
  v_exp_f32 v102, v102
  v_exp_f32 v103, v103
  v_pk_add_f32 v[100:101], v[100:101], v[98:99] op_sel_hi:[1,0]
  v_pk_add_f32 v[102:103], v[102:103], v[98:99] op_sel_hi:[1,0]
  v_rcp_f32 v100, v100
  v_rcp_f32 v101, v101
  v_rcp_f32 v102, v102
  v_rcp_f32 v103, v103
  v_pk_mul_f32 v[168:169], v[168:169], v[100:101]
  v_pk_mul_f32 v[170:171], v[170:171], v[102:103]
  v_cvt_pk_bf16_f32 v116, v168, v169
  v_cvt_pk_bf16_f32 v117, v170, v171
  v_pk_fma_f32 v[104:105], v[44:45], v[92:93], v[72:73] op_sel:[0,0,0] op_sel_hi:[1,0,1] neg_lo:[0,1,0] neg_hi:[0,1,0]
  v_pk_fma_f32 v[106:107], v[46:47], v[92:93], v[74:75] op_sel:[0,0,0] op_sel_hi:[1,0,1] neg_lo:[0,1,0] neg_hi:[0,1,0]
  v_pk_fma_f32 v[184:185], v[184:185], v[92:93], v[104:105] op_sel:[0,1,0] op_sel_hi:[1,1,1]
  v_pk_fma_f32 v[186:187], v[186:187], v[92:93], v[106:107] op_sel:[0,1,0] op_sel_hi:[1,1,1]
  v_pk_mul_f32 v[104:105], v[184:185], v[184:185]
  v_pk_mul_f32 v[106:107], v[186:187], v[186:187]
  v_pk_fma_f32 v[104:105], v[104:105], v[96:97], v[96:97] op_sel:[0,1,0] op_sel_hi:[1,1,0]
  v_pk_fma_f32 v[106:107], v[106:107], v[96:97], v[96:97] op_sel:[0,1,0] op_sel_hi:[1,1,0]
  v_pk_mul_f32 v[104:105], v[104:105], v[184:185]
  v_pk_mul_f32 v[106:107], v[106:107], v[186:187]
  v_exp_f32 v104, v104
  v_exp_f32 v105, v105
  v_exp_f32 v106, v106
  v_exp_f32 v107, v107
  v_pk_add_f32 v[104:105], v[104:105], v[98:99] op_sel_hi:[1,0]
  v_pk_add_f32 v[106:107], v[106:107], v[98:99] op_sel_hi:[1,0]
  v_rcp_f32 v104, v104
  v_rcp_f32 v105, v105
  v_rcp_f32 v106, v106
  v_rcp_f32 v107, v107
  v_pk_mul_f32 v[184:185], v[184:185], v[104:105]
  v_pk_mul_f32 v[186:187], v[186:187], v[106:107]
  v_cvt_pk_bf16_f32 v118, v184, v185
  v_cvt_pk_bf16_f32 v119, v186, v187
  s_add_u32 s3, s10, 278528
  s_nop 0
  v_permlane16_swap_b32 v116, v118
  v_permlane16_swap_b32 v117, v119
  buffer_store_dwordx4 v[116:119], v12, s[44:47], s3 offen sc1
  v_pk_fma_f32 v[100:101], v[48:49], v[92:93], v[76:77] op_sel:[0,0,0] op_sel_hi:[1,0,1] neg_lo:[0,1,0] neg_hi:[0,1,0]
  v_pk_fma_f32 v[102:103], v[50:51], v[92:93], v[78:79] op_sel:[0,0,0] op_sel_hi:[1,0,1] neg_lo:[0,1,0] neg_hi:[0,1,0]
  v_pk_fma_f32 v[200:201], v[200:201], v[92:93], v[100:101] op_sel:[0,1,0] op_sel_hi:[1,1,1]
  v_pk_fma_f32 v[202:203], v[202:203], v[92:93], v[102:103] op_sel:[0,1,0] op_sel_hi:[1,1,1]
  v_pk_mul_f32 v[100:101], v[200:201], v[200:201]
  v_pk_mul_f32 v[102:103], v[202:203], v[202:203]
  v_pk_fma_f32 v[100:101], v[100:101], v[96:97], v[96:97] op_sel:[0,1,0] op_sel_hi:[1,1,0]
  v_pk_fma_f32 v[102:103], v[102:103], v[96:97], v[96:97] op_sel:[0,1,0] op_sel_hi:[1,1,0]
  v_pk_mul_f32 v[100:101], v[100:101], v[200:201]
  v_pk_mul_f32 v[102:103], v[102:103], v[202:203]
  v_exp_f32 v100, v100
  v_exp_f32 v101, v101
  v_exp_f32 v102, v102
  v_exp_f32 v103, v103
  v_pk_add_f32 v[100:101], v[100:101], v[98:99] op_sel_hi:[1,0]
  v_pk_add_f32 v[102:103], v[102:103], v[98:99] op_sel_hi:[1,0]
  v_rcp_f32 v100, v100
  v_rcp_f32 v101, v101
  v_rcp_f32 v102, v102
  v_rcp_f32 v103, v103
  v_pk_mul_f32 v[200:201], v[200:201], v[100:101]
  v_pk_mul_f32 v[202:203], v[202:203], v[102:103]
  v_cvt_pk_bf16_f32 v120, v200, v201
  v_cvt_pk_bf16_f32 v121, v202, v203
  v_pk_fma_f32 v[104:105], v[52:53], v[92:93], v[80:81] op_sel:[0,0,0] op_sel_hi:[1,0,1] neg_lo:[0,1,0] neg_hi:[0,1,0]
  v_pk_fma_f32 v[106:107], v[54:55], v[92:93], v[82:83] op_sel:[0,0,0] op_sel_hi:[1,0,1] neg_lo:[0,1,0] neg_hi:[0,1,0]
  v_pk_fma_f32 v[216:217], v[216:217], v[92:93], v[104:105] op_sel:[0,1,0] op_sel_hi:[1,1,1]
  v_pk_fma_f32 v[218:219], v[218:219], v[92:93], v[106:107] op_sel:[0,1,0] op_sel_hi:[1,1,1]
  v_pk_mul_f32 v[104:105], v[216:217], v[216:217]
  v_pk_mul_f32 v[106:107], v[218:219], v[218:219]
  v_pk_fma_f32 v[104:105], v[104:105], v[96:97], v[96:97] op_sel:[0,1,0] op_sel_hi:[1,1,0]
  v_pk_fma_f32 v[106:107], v[106:107], v[96:97], v[96:97] op_sel:[0,1,0] op_sel_hi:[1,1,0]
  v_pk_mul_f32 v[104:105], v[104:105], v[216:217]
  v_pk_mul_f32 v[106:107], v[106:107], v[218:219]
  v_exp_f32 v104, v104
  v_exp_f32 v105, v105
  v_exp_f32 v106, v106
  v_exp_f32 v107, v107
  v_pk_add_f32 v[104:105], v[104:105], v[98:99] op_sel_hi:[1,0]
  v_pk_add_f32 v[106:107], v[106:107], v[98:99] op_sel_hi:[1,0]
  v_rcp_f32 v104, v104
  v_rcp_f32 v105, v105
  v_rcp_f32 v106, v106
  v_rcp_f32 v107, v107
  v_pk_mul_f32 v[216:217], v[216:217], v[104:105]
  v_pk_mul_f32 v[218:219], v[218:219], v[106:107]
  v_cvt_pk_bf16_f32 v122, v216, v217
  v_cvt_pk_bf16_f32 v123, v218, v219
  s_add_u32 s3, s10, 280576
  s_nop 0
  v_permlane16_swap_b32 v120, v122
  v_permlane16_swap_b32 v121, v123
  buffer_store_dwordx4 v[120:123], v12, s[44:47], s3 offen sc1
  v_pk_fma_f32 v[100:101], v[40:41], v[94:95], v[68:69] op_sel:[0,0,0] op_sel_hi:[1,0,1] neg_lo:[0,1,0] neg_hi:[0,1,0]
  v_pk_fma_f32 v[102:103], v[42:43], v[94:95], v[70:71] op_sel:[0,0,0] op_sel_hi:[1,0,1] neg_lo:[0,1,0] neg_hi:[0,1,0]
  v_pk_fma_f32 v[172:173], v[172:173], v[94:95], v[100:101] op_sel:[0,1,0] op_sel_hi:[1,1,1]
  v_pk_fma_f32 v[174:175], v[174:175], v[94:95], v[102:103] op_sel:[0,1,0] op_sel_hi:[1,1,1]
  v_pk_mul_f32 v[100:101], v[172:173], v[172:173]
  v_pk_mul_f32 v[102:103], v[174:175], v[174:175]
  v_pk_fma_f32 v[100:101], v[100:101], v[96:97], v[96:97] op_sel:[0,1,0] op_sel_hi:[1,1,0]
  v_pk_fma_f32 v[102:103], v[102:103], v[96:97], v[96:97] op_sel:[0,1,0] op_sel_hi:[1,1,0]
  v_pk_mul_f32 v[100:101], v[100:101], v[172:173]
  v_pk_mul_f32 v[102:103], v[102:103], v[174:175]
  v_exp_f32 v100, v100
  v_exp_f32 v101, v101
  v_exp_f32 v102, v102
  v_exp_f32 v103, v103
  v_pk_add_f32 v[100:101], v[100:101], v[98:99] op_sel_hi:[1,0]
  v_pk_add_f32 v[102:103], v[102:103], v[98:99] op_sel_hi:[1,0]
  v_rcp_f32 v100, v100
  v_rcp_f32 v101, v101
  v_rcp_f32 v102, v102
  v_rcp_f32 v103, v103
  v_pk_mul_f32 v[172:173], v[172:173], v[100:101]
  v_pk_mul_f32 v[174:175], v[174:175], v[102:103]
  v_cvt_pk_bf16_f32 v108, v172, v173
  v_cvt_pk_bf16_f32 v109, v174, v175
  v_pk_fma_f32 v[104:105], v[44:45], v[94:95], v[72:73] op_sel:[0,0,0] op_sel_hi:[1,0,1] neg_lo:[0,1,0] neg_hi:[0,1,0]
  v_pk_fma_f32 v[106:107], v[46:47], v[94:95], v[74:75] op_sel:[0,0,0] op_sel_hi:[1,0,1] neg_lo:[0,1,0] neg_hi:[0,1,0]
  v_pk_fma_f32 v[188:189], v[188:189], v[94:95], v[104:105] op_sel:[0,1,0] op_sel_hi:[1,1,1]
  v_pk_fma_f32 v[190:191], v[190:191], v[94:95], v[106:107] op_sel:[0,1,0] op_sel_hi:[1,1,1]
  v_pk_mul_f32 v[104:105], v[188:189], v[188:189]
  v_pk_mul_f32 v[106:107], v[190:191], v[190:191]
  v_pk_fma_f32 v[104:105], v[104:105], v[96:97], v[96:97] op_sel:[0,1,0] op_sel_hi:[1,1,0]
  v_pk_fma_f32 v[106:107], v[106:107], v[96:97], v[96:97] op_sel:[0,1,0] op_sel_hi:[1,1,0]
  v_pk_mul_f32 v[104:105], v[104:105], v[188:189]
  v_pk_mul_f32 v[106:107], v[106:107], v[190:191]
  v_exp_f32 v104, v104
  v_exp_f32 v105, v105
  v_exp_f32 v106, v106
  v_exp_f32 v107, v107
  v_pk_add_f32 v[104:105], v[104:105], v[98:99] op_sel_hi:[1,0]
  v_pk_add_f32 v[106:107], v[106:107], v[98:99] op_sel_hi:[1,0]
  v_rcp_f32 v104, v104
  v_rcp_f32 v105, v105
  v_rcp_f32 v106, v106
  v_rcp_f32 v107, v107
  v_pk_mul_f32 v[188:189], v[188:189], v[104:105]
  v_pk_mul_f32 v[190:191], v[190:191], v[106:107]
  v_cvt_pk_bf16_f32 v110, v188, v189
  v_cvt_pk_bf16_f32 v111, v190, v191
  s_add_u32 s3, s10, 393216
  s_nop 0
  v_permlane16_swap_b32 v108, v110
  v_permlane16_swap_b32 v109, v111
  buffer_store_dwordx4 v[108:111], v12, s[44:47], s3 offen sc1
  v_pk_fma_f32 v[100:101], v[48:49], v[94:95], v[76:77] op_sel:[0,0,0] op_sel_hi:[1,0,1] neg_lo:[0,1,0] neg_hi:[0,1,0]
  v_pk_fma_f32 v[102:103], v[50:51], v[94:95], v[78:79] op_sel:[0,0,0] op_sel_hi:[1,0,1] neg_lo:[0,1,0] neg_hi:[0,1,0]
  v_pk_fma_f32 v[204:205], v[204:205], v[94:95], v[100:101] op_sel:[0,1,0] op_sel_hi:[1,1,1]
  v_pk_fma_f32 v[206:207], v[206:207], v[94:95], v[102:103] op_sel:[0,1,0] op_sel_hi:[1,1,1]
  v_pk_mul_f32 v[100:101], v[204:205], v[204:205]
  v_pk_mul_f32 v[102:103], v[206:207], v[206:207]
  v_pk_fma_f32 v[100:101], v[100:101], v[96:97], v[96:97] op_sel:[0,1,0] op_sel_hi:[1,1,0]
  v_pk_fma_f32 v[102:103], v[102:103], v[96:97], v[96:97] op_sel:[0,1,0] op_sel_hi:[1,1,0]
  v_pk_mul_f32 v[100:101], v[100:101], v[204:205]
  v_pk_mul_f32 v[102:103], v[102:103], v[206:207]
  v_exp_f32 v100, v100
  v_exp_f32 v101, v101
  v_exp_f32 v102, v102
  v_exp_f32 v103, v103
  v_pk_add_f32 v[100:101], v[100:101], v[98:99] op_sel_hi:[1,0]
  v_pk_add_f32 v[102:103], v[102:103], v[98:99] op_sel_hi:[1,0]
  v_rcp_f32 v100, v100
  v_rcp_f32 v101, v101
  v_rcp_f32 v102, v102
  v_rcp_f32 v103, v103
  v_pk_mul_f32 v[204:205], v[204:205], v[100:101]
  v_pk_mul_f32 v[206:207], v[206:207], v[102:103]
  v_cvt_pk_bf16_f32 v112, v204, v205
  v_cvt_pk_bf16_f32 v113, v206, v207
  v_pk_fma_f32 v[104:105], v[52:53], v[94:95], v[80:81] op_sel:[0,0,0] op_sel_hi:[1,0,1] neg_lo:[0,1,0] neg_hi:[0,1,0]
  v_pk_fma_f32 v[106:107], v[54:55], v[94:95], v[82:83] op_sel:[0,0,0] op_sel_hi:[1,0,1] neg_lo:[0,1,0] neg_hi:[0,1,0]
  v_pk_fma_f32 v[220:221], v[220:221], v[94:95], v[104:105] op_sel:[0,1,0] op_sel_hi:[1,1,1]
  v_pk_fma_f32 v[222:223], v[222:223], v[94:95], v[106:107] op_sel:[0,1,0] op_sel_hi:[1,1,1]
  v_pk_mul_f32 v[104:105], v[220:221], v[220:221]
  v_pk_mul_f32 v[106:107], v[222:223], v[222:223]
  v_pk_fma_f32 v[104:105], v[104:105], v[96:97], v[96:97] op_sel:[0,1,0] op_sel_hi:[1,1,0]
  v_pk_fma_f32 v[106:107], v[106:107], v[96:97], v[96:97] op_sel:[0,1,0] op_sel_hi:[1,1,0]
  v_pk_mul_f32 v[104:105], v[104:105], v[220:221]
  v_pk_mul_f32 v[106:107], v[106:107], v[222:223]
  v_exp_f32 v104, v104
  v_exp_f32 v105, v105
  v_exp_f32 v106, v106
  v_exp_f32 v107, v107
  v_pk_add_f32 v[104:105], v[104:105], v[98:99] op_sel_hi:[1,0]
  v_pk_add_f32 v[106:107], v[106:107], v[98:99] op_sel_hi:[1,0]
  v_rcp_f32 v104, v104
  v_rcp_f32 v105, v105
  v_rcp_f32 v106, v106
  v_rcp_f32 v107, v107
  v_pk_mul_f32 v[220:221], v[220:221], v[104:105]
  v_pk_mul_f32 v[222:223], v[222:223], v[106:107]
  v_cvt_pk_bf16_f32 v114, v220, v221
  v_cvt_pk_bf16_f32 v115, v222, v223
  s_add_u32 s3, s10, 395264
  s_nop 0
  v_permlane16_swap_b32 v112, v114
  v_permlane16_swap_b32 v113, v115
  buffer_store_dwordx4 v[112:115], v12, s[44:47], s3 offen sc1
  s_waitcnt vmcnt(0) lgkmcnt(0)
  s_barrier
  s_add_u32 s97, s97, 1
  s_branch L_w2_body
L_w1_c1:
L_w2_c0:
L_w2_body:
  s_cmp_ge_u32 s2, 256
  s_cbranch_scc1 L_w2_end
  v_lshrrev_b32 v2, 6, v0
  v_and_b32 v1, 63, v0
  v_readfirstlane_b32 s70, v2
  s_and_b32 s3, s2, 7
  s_lshr_b32 s99, s2, 3
  s_and_b32 s5, s3, 3
  s_lshl_b32 s5, s5, 2
  s_and_b32 s6, s99, 3
  s_add_u32 s68, s5, s6
  s_lshr_b32 s5, s3, 2
  s_lshr_b32 s78, s99, 2
  s_lshl1_add_u32 s69, s78, s5
  s_add_u32 s3, s68, s78
  s_lshl_b32 s3, s3, 3
  s_lshl_b32 s85, 0xffff02, s3
  s_sub_u32 s3, 0, s3
  s_lshr_b32 s3, 0xffff02, s3
  s_or_b32 s85, s85, s3
  s_cmp_lt_u32 s70, 4
  s_cbranch_scc1 L_w2_compute
L_w2_loader:
  v_and_b32 v2, 3, v1
  v_lshlrev_b32 v2, 3, v2
  v_bfe_i32 v16, s85, v2, 8
  s_and_b32 s3, s68, 3
  s_mul_i32 s4, s3, 4
  v_add3_u32 v3, v16, v1, s4
  v_subrev_u32 v3, 20, v3
  v_and_b32 v3, 15, v3
  v_add3_u32 v16, v16, v1, 20
  s_mul_i32 s3, s3, 1
  s_bitcmp1_b32 s69, 0
  s_cselect_b32 s4, 20, 0
  v_subrev_u32 v2, 20, v16
  v_min_u32 v16, v16, v2
  v_subrev_u32 v2, 20, v16
  v_min_u32 v16, v16, v2
  v_cmp_gt_u32 vcc, 4, v16
  v_add_u32 v2, s3, v16
  v_subrev_u32 v17, 4, v2
  v_min_u32 v2, v17, v2
  v_cndmask_b32 v16, v16, v2, vcc
  v_cmp_gt_u32 vcc, 20, v1
  v_add_u32 v16, s4, v16
  v_add_u32 v3, 40, v3
  v_cndmask_b32 v3, v3, v16, vcc
  v_lshlrev_b32 v16, 17, v3
  s_add_u32 s9, s70, s68
  s_and_b32 s9, s9, 3
  s_lshl_b32 s77, s9, 11
  v_and_b32 v10, 7, v1
  v_lshrrev_b32 v3, 3, v1
  s_lshl_b32 s10, s9, 4
  v_add_u32 v3, s10, v3
  v_mul_u32_u24 v3, 2048, v3
  v_lshrrev_b32 v2, 3, v1
  v_and_b32 v2, 2, v2
  v_xor_b32 v2, v2, v10
  s_lshl_b32 s10, s69, 7
  v_add_u32 v3, s10, v3
  v_lshl_add_u32 v8, v2, 4, v3
  v_xor_b32 v2, 4, v2
  v_add_u32 v3, 16384, v3
  v_lshl_add_u32 v9, v2, 4, v3
  s_mov_b32 s40, s28
  s_and_b32 s41, s29, 0xffff
  s_mov_b32 s42, 7340032
  s_mov_b32 s43, 0x00020000
  s_bitcmp1_b32 s69, 0
  s_mov_b32 s76, 128
  s_cselect_b32 s76, -128, s76
  v_readlane_b32 s74, v16, 0
  s_add_u32 m0, s77, 0
  s_add_u32 s4, s74, s76
  buffer_load_dwordx4 v8, s[40:43], s4 offen lds
  s_add_u32 m0, s77, 1024
  s_nop 0
  buffer_load_dwordx4 v9, s[40:43], s4 offen lds
  s_add_u32 m0, s77, 8192
  s_add_u32 s4, s74, 0
  buffer_load_dwordx4 v8, s[40:43], s4 offen lds
  s_add_u32 m0, s77, 9216
  s_nop 0
  buffer_load_dwordx4 v9, s[40:43], s4 offen lds
  v_readlane_b32 s74, v16, 1
  s_add_u32 m0, s77, 16384
  s_add_u32 s4, s74, s76
  buffer_load_dwordx4 v8, s[40:43], s4 offen lds
  s_add_u32 m0, s77, 17408
  s_nop 0
  buffer_load_dwordx4 v9, s[40:43], s4 offen lds
  s_add_u32 m0, s77, 24576
  s_add_u32 s4, s74, 0
  buffer_load_dwordx4 v8, s[40:43], s4 offen lds
  s_add_u32 m0, s77, 25600
  s_nop 0
  buffer_load_dwordx4 v9, s[40:43], s4 offen lds
  v_readlane_b32 s74, v16, 2
  s_add_u32 m0, s77, 32768
  s_add_u32 s4, s74, s76
  buffer_load_dwordx4 v8, s[40:43], s4 offen lds
  s_add_u32 m0, s77, 33792
  s_nop 0
  buffer_load_dwordx4 v9, s[40:43], s4 offen lds
  s_add_u32 m0, s77, 40960
  s_add_u32 s4, s74, 0
  buffer_load_dwordx4 v8, s[40:43], s4 offen lds
  s_add_u32 m0, s77, 41984
  s_nop 0
  buffer_load_dwordx4 v9, s[40:43], s4 offen lds
  v_readlane_b32 s74, v16, 3
  s_add_u32 m0, s77, 49152
  s_add_u32 s4, s74, s76
  buffer_load_dwordx4 v8, s[40:43], s4 offen lds
  s_add_u32 m0, s77, 50176
  s_nop 0
  buffer_load_dwordx4 v9, s[40:43], s4 offen lds
  s_add_u32 m0, s77, 57344
  s_add_u32 s4, s74, 0
  buffer_load_dwordx4 v8, s[40:43], s4 offen lds
  s_add_u32 m0, s77, 58368
  s_nop 0
  buffer_load_dwordx4 v9, s[40:43], s4 offen lds
  v_readlane_b32 s74, v16, 4
  s_add_u32 m0, s77, 65536
  s_add_u32 s4, s74, s76
  buffer_load_dwordx4 v8, s[40:43], s4 offen lds
  s_add_u32 m0, s77, 66560
  s_nop 0
  buffer_load_dwordx4 v9, s[40:43], s4 offen lds
  s_add_u32 m0, s77, 73728
  s_add_u32 s4, s74, 0
  buffer_load_dwordx4 v8, s[40:43], s4 offen lds
  s_add_u32 m0, s77, 74752
  s_nop 0
  buffer_load_dwordx4 v9, s[40:43], s4 offen lds
  s_add_u32 s44, s22, 41943040
  s_addc_u32 s45, s23, 0
  s_and_b32 s45, s45, 0xffff
  s_mov_b32 s46, 524288
  s_mov_b32 s47, 0x00020000
  s_lshl4_add_u32 s3, s97, s68
  s_and_b32 s4, s69, 15
  s_lshl4_add_u32 s3, s3, s4
  s_lshl_b32 s3, s3, 7
  s_sub_u32 s3, s3, 32768
  v_lshlrev_b32 v11, 7, v1
  v_and_b32 v2, 15, v1
  v_lshlrev_b32 v2, 2, v2
  v_mov_b32 v3, 1
  s_mov_b32 s79, 0x100000
  s_cmp_lg_u32 s70, 4
  s_barrier
  s_cbranch_scc1 L_w2_nofl
  s_mov_b32 exec_lo, 0xffff
  s_mov_b32 exec_hi, 0
  buffer_store_dword v3, v11, s[44:47], s87 offen sc1
  s_mov_b64 exec, -1
L_w2_nofl:
  s_mov_b32 s5, s3
  v_readlane_b32 s74, v16, 5
  s_add_u32 m0, s77, 81920
  s_add_u32 s4, s74, s76
  buffer_load_dwordx4 v8, s[40:43], s4 offen lds
  s_add_u32 m0, s77, 82944
  s_nop 0
  buffer_load_dwordx4 v9, s[40:43], s4 offen lds
  s_add_u32 m0, s77, 90112
  s_add_u32 s4, s74, 0
  buffer_load_dwordx4 v8, s[40:43], s4 offen lds
  s_add_u32 m0, s77, 91136
  s_nop 0
  buffer_load_dwordx4 v9, s[40:43], s4 offen lds
  v_readlane_b32 s74, v16, 6
  s_add_u32 m0, s77, 98304
  s_add_u32 s4, s74, s76
  buffer_load_dwordx4 v8, s[40:43], s4 offen lds
  s_add_u32 m0, s77, 99328
  s_nop 0
  buffer_load_dwordx4 v9, s[40:43], s4 offen lds
  s_add_u32 m0, s77, 106496
  s_add_u32 s4, s74, 0
  buffer_load_dwordx4 v8, s[40:43], s4 offen lds
  s_add_u32 m0, s77, 107520
  s_nop 0
  buffer_load_dwordx4 v9, s[40:43], s4 offen lds
  v_readlane_b32 s74, v16, 7
  s_add_u32 m0, s77, 114688
  s_add_u32 s4, s74, s76
  buffer_load_dwordx4 v8, s[40:43], s4 offen lds
  s_add_u32 m0, s77, 115712
  s_nop 0
  buffer_load_dwordx4 v9, s[40:43], s4 offen lds
  s_add_u32 m0, s77, 122880
  s_add_u32 s4, s74, 0
  buffer_load_dwordx4 v8, s[40:43], s4 offen lds
  s_add_u32 m0, s77, 123904
  s_nop 0
  buffer_load_dwordx4 v9, s[40:43], s4 offen lds
  v_readlane_b32 s74, v16, 8
  s_add_u32 m0, s77, 131072
  s_add_u32 s4, s74, s76
  buffer_load_dwordx4 v8, s[40:43], s4 offen lds
  s_add_u32 m0, s77, 132096
  s_nop 0
  buffer_load_dwordx4 v9, s[40:43], s4 offen lds
  s_add_u32 m0, s77, 139264
  s_add_u32 s4, s74, 0
  buffer_load_dwordx4 v8, s[40:43], s4 offen lds
  s_add_u32 m0, s77, 140288
  s_nop 0
  buffer_load_dwordx4 v9, s[40:43], s4 offen lds
  v_readlane_b32 s74, v16, 9
  s_add_u32 m0, s77, 147456
  s_add_u32 s4, s74, s76
  buffer_load_dwordx4 v8, s[40:43], s4 offen lds
  s_add_u32 m0, s77, 148480
  s_nop 0
  buffer_load_dwordx4 v9, s[40:43], s4 offen lds
  s_add_u32 m0, s77, 155648
  s_add_u32 s4, s74, 0
  buffer_load_dwordx4 v8, s[40:43], s4 offen lds
  s_add_u32 m0, s77, 156672
  s_nop 0
  buffer_load_dwordx4 v9, s[40:43], s4 offen lds
  s_mov_b32 s3, s5
  s_cmp_lg_u32 s70, 4
  s_cbranch_scc1 L_w2_dep
L_w2_poll:
  buffer_load_dword v3, v2, s[44:47], s3 offen sc1
  s_sub_u32 s79, s79, 1
  s_cbranch_scc1 L_w2_dep
  s_waitcnt vmcnt(0)
  v_cmp_ne_u32 vcc, 1, v3
  s_cbranch_vccnz L_w2_poll
L_w2_dep:
  s_waitcnt vmcnt(30) lgkmcnt(0)
  s_barrier
  s_waitcnt vmcnt(22)
  s_barrier
  v_readlane_b32 s74, v16, 10
  s_add_u32 m0, s77, 0
  s_add_u32 s4, s74, s76
  buffer_load_dwordx4 v8, s[40:43], s4 offen lds
  s_add_u32 m0, s77, 1024
  s_nop 0
  buffer_load_dwordx4 v9, s[40:43], s4 offen lds
  s_waitcnt vmcnt(4)
  s_add_u32 m0, s77, 8192
  s_add_u32 s4, s74, 0
  buffer_load_dwordx4 v8, s[40:43], s4 offen lds
  s_add_u32 m0, s77, 9216
  s_nop 0
  buffer_load_dwordx4 v9, s[40:43], s4 offen lds
  s_waitcnt vmcnt(4)
  v_readlane_b32 s74, v16, 11
  s_add_u32 m0, s77, 16384
  s_add_u32 s4, s74, s76
  buffer_load_dwordx4 v8, s[40:43], s4 offen lds
  s_add_u32 m0, s77, 17408
  s_nop 0
  buffer_load_dwordx4 v9, s[40:43], s4 offen lds
  s_waitcnt vmcnt(4)
  s_add_u32 m0, s77, 24576
  s_add_u32 s4, s74, 0
  buffer_load_dwordx4 v8, s[40:43], s4 offen lds
  s_add_u32 m0, s77, 25600
  s_nop 0
  buffer_load_dwordx4 v9, s[40:43], s4 offen lds
  s_waitcnt vmcnt(22)
  s_barrier
  v_readlane_b32 s74, v16, 12
  s_add_u32 m0, s77, 32768
  s_add_u32 s4, s74, s76
  buffer_load_dwordx4 v8, s[40:43], s4 offen lds
  s_add_u32 m0, s77, 33792
  s_nop 0
  buffer_load_dwordx4 v9, s[40:43], s4 offen lds
  s_waitcnt vmcnt(4)
  s_add_u32 m0, s77, 40960
  s_add_u32 s4, s74, 0
  buffer_load_dwordx4 v8, s[40:43], s4 offen lds
  s_add_u32 m0, s77, 41984
  s_nop 0
  buffer_load_dwordx4 v9, s[40:43], s4 offen lds
  s_waitcnt vmcnt(4)
  v_readlane_b32 s74, v16, 13
  s_add_u32 m0, s77, 49152
  s_add_u32 s4, s74, s76
  buffer_load_dwordx4 v8, s[40:43], s4 offen lds
  s_add_u32 m0, s77, 50176
  s_nop 0
  buffer_load_dwordx4 v9, s[40:43], s4 offen lds
  s_waitcnt vmcnt(4)
  s_add_u32 m0, s77, 57344
  s_add_u32 s4, s74, 0
  buffer_load_dwordx4 v8, s[40:43], s4 offen lds
  s_add_u32 m0, s77, 58368
  s_nop 0
  buffer_load_dwordx4 v9, s[40:43], s4 offen lds
  s_waitcnt vmcnt(22)
  s_barrier
  v_readlane_b32 s74, v16, 14
  s_add_u32 m0, s77, 65536
  s_add_u32 s4, s74, s76
  buffer_load_dwordx4 v8, s[40:43], s4 offen lds
  s_add_u32 m0, s77, 66560
  s_nop 0
  buffer_load_dwordx4 v9, s[40:43], s4 offen lds
  s_waitcnt vmcnt(4)
  s_add_u32 m0, s77, 73728
  s_add_u32 s4, s74, 0
  buffer_load_dwordx4 v8, s[40:43], s4 offen lds
  s_add_u32 m0, s77, 74752
  s_nop 0
  buffer_load_dwordx4 v9, s[40:43], s4 offen lds
  s_waitcnt vmcnt(4)
  v_readlane_b32 s74, v16, 15
  s_add_u32 m0, s77, 81920
  s_add_u32 s4, s74, s76
  buffer_load_dwordx4 v8, s[40:43], s4 offen lds
  s_add_u32 m0, s77, 82944
  s_nop 0
  buffer_load_dwordx4 v9, s[40:43], s4 offen lds
  s_waitcnt vmcnt(4)
  s_add_u32 m0, s77, 90112
  s_add_u32 s4, s74, 0
  buffer_load_dwordx4 v8, s[40:43], s4 offen lds
  s_add_u32 m0, s77, 91136
  s_nop 0
  buffer_load_dwordx4 v9, s[40:43], s4 offen lds
  s_waitcnt vmcnt(22)
  s_barrier
  v_readlane_b32 s74, v16, 16
  s_add_u32 m0, s77, 98304
  s_add_u32 s4, s74, s76
  buffer_load_dwordx4 v8, s[40:43], s4 offen lds
  s_add_u32 m0, s77, 99328
  s_nop 0
  buffer_load_dwordx4 v9, s[40:43], s4 offen lds
  s_waitcnt vmcnt(4)
  s_add_u32 m0, s77, 106496
  s_add_u32 s4, s74, 0
  buffer_load_dwordx4 v8, s[40:43], s4 offen lds
  s_add_u32 m0, s77, 107520
  s_nop 0
  buffer_load_dwordx4 v9, s[40:43], s4 offen lds
  s_waitcnt vmcnt(4)
  v_readlane_b32 s74, v16, 17
  s_add_u32 m0, s77, 114688
  s_add_u32 s4, s74, s76
  buffer_load_dwordx4 v8, s[40:43], s4 offen lds
  s_add_u32 m0, s77, 115712
  s_nop 0
  buffer_load_dwordx4 v9, s[40:43], s4 offen lds
  s_waitcnt vmcnt(4)
  s_add_u32 m0, s77, 122880
  s_add_u32 s4, s74, 0
  buffer_load_dwordx4 v8, s[40:43], s4 offen lds
  s_add_u32 m0, s77, 123904
  s_nop 0
  buffer_load_dwordx4 v9, s[40:43], s4 offen lds
  s_waitcnt vmcnt(22)
  s_barrier
  v_readlane_b32 s74, v16, 18
  s_add_u32 m0, s77, 131072
  s_add_u32 s4, s74, s76
  buffer_load_dwordx4 v8, s[40:43], s4 offen lds
  s_add_u32 m0, s77, 132096
  s_nop 0
  buffer_load_dwordx4 v9, s[40:43], s4 offen lds
  s_waitcnt vmcnt(4)
  s_add_u32 m0, s77, 139264
  s_add_u32 s4, s74, 0
  buffer_load_dwordx4 v8, s[40:43], s4 offen lds
  s_add_u32 m0, s77, 140288
  s_nop 0
  buffer_load_dwordx4 v9, s[40:43], s4 offen lds
  s_waitcnt vmcnt(4)
  v_readlane_b32 s74, v16, 19
  s_add_u32 m0, s77, 147456
  s_add_u32 s4, s74, s76
  buffer_load_dwordx4 v8, s[40:43], s4 offen lds
  s_add_u32 m0, s77, 148480
  s_nop 0
  buffer_load_dwordx4 v9, s[40:43], s4 offen lds
  s_waitcnt vmcnt(4)
  s_add_u32 m0, s77, 155648
  s_add_u32 s4, s74, 0
  buffer_load_dwordx4 v8, s[40:43], s4 offen lds
  s_add_u32 m0, s77, 156672
  s_nop 0
  buffer_load_dwordx4 v9, s[40:43], s4 offen lds
  s_waitcnt vmcnt(22)
  s_barrier
  v_readlane_b32 s74, v16, 20
  s_add_u32 m0, s77, 0
  s_add_u32 s4, s74, 0
  buffer_load_dwordx4 v8, s[40:43], s4 offen lds
  s_add_u32 m0, s77, 1024
  s_nop 0
  buffer_load_dwordx4 v9, s[40:43], s4 offen lds
  s_waitcnt vmcnt(4)
  v_readlane_b32 s74, v16, 21
  s_add_u32 m0, s77, 8192
  s_add_u32 s4, s74, 0
  buffer_load_dwordx4 v8, s[40:43], s4 offen lds
  s_add_u32 m0, s77, 9216
  s_nop 0
  buffer_load_dwordx4 v9, s[40:43], s4 offen lds
  s_waitcnt vmcnt(4)
  v_readlane_b32 s74, v16, 22
  s_add_u32 m0, s77, 16384
  s_add_u32 s4, s74, 0
  buffer_load_dwordx4 v8, s[40:43], s4 offen lds
  s_add_u32 m0, s77, 17408
  s_nop 0
  buffer_load_dwordx4 v9, s[40:43], s4 offen lds
  s_waitcnt vmcnt(4)
  v_readlane_b32 s74, v16, 23
  s_add_u32 m0, s77, 24576
  s_add_u32 s4, s74, 0
  buffer_load_dwordx4 v8, s[40:43], s4 offen lds
  s_add_u32 m0, s77, 25600
  s_nop 0
  buffer_load_dwordx4 v9, s[40:43], s4 offen lds
  s_waitcnt vmcnt(22)
  s_barrier
  v_readlane_b32 s74, v16, 24
  s_add_u32 m0, s77, 32768
  s_add_u32 s4, s74, 0
  buffer_load_dwordx4 v8, s[40:43], s4 offen lds
  s_add_u32 m0, s77, 33792
  s_nop 0
  buffer_load_dwordx4 v9, s[40:43], s4 offen lds
  s_waitcnt vmcnt(4)
  v_readlane_b32 s74, v16, 25
  s_add_u32 m0, s77, 40960
  s_add_u32 s4, s74, 0
  buffer_load_dwordx4 v8, s[40:43], s4 offen lds
  s_add_u32 m0, s77, 41984
  s_nop 0
  buffer_load_dwordx4 v9, s[40:43], s4 offen lds
  s_waitcnt vmcnt(4)
  v_readlane_b32 s74, v16, 26
  s_add_u32 m0, s77, 49152
  s_add_u32 s4, s74, 0
  buffer_load_dwordx4 v8, s[40:43], s4 offen lds
  s_add_u32 m0, s77, 50176
  s_nop 0
  buffer_load_dwordx4 v9, s[40:43], s4 offen lds
  s_waitcnt vmcnt(4)
  v_readlane_b32 s74, v16, 27
  s_add_u32 m0, s77, 57344
  s_add_u32 s4, s74, 0
  buffer_load_dwordx4 v8, s[40:43], s4 offen lds
  s_add_u32 m0, s77, 58368
  s_nop 0
  buffer_load_dwordx4 v9, s[40:43], s4 offen lds
  s_waitcnt vmcnt(22)
  s_barrier
  v_readlane_b32 s74, v16, 28
  s_add_u32 m0, s77, 65536
  s_add_u32 s4, s74, 0
  buffer_load_dwordx4 v8, s[40:43], s4 offen lds
  s_add_u32 m0, s77, 66560
  s_nop 0
  buffer_load_dwordx4 v9, s[40:43], s4 offen lds
  s_waitcnt vmcnt(4)
  v_readlane_b32 s74, v16, 29
  s_add_u32 m0, s77, 73728
  s_add_u32 s4, s74, 0
  buffer_load_dwordx4 v8, s[40:43], s4 offen lds
  s_add_u32 m0, s77, 74752
  s_nop 0
  buffer_load_dwordx4 v9, s[40:43], s4 offen lds
  s_waitcnt vmcnt(4)
  v_readlane_b32 s74, v16, 30
  s_add_u32 m0, s77, 81920
  s_add_u32 s4, s74, 0
  buffer_load_dwordx4 v8, s[40:43], s4 offen lds
  s_add_u32 m0, s77, 82944
  s_nop 0
  buffer_load_dwordx4 v9, s[40:43], s4 offen lds
  s_waitcnt vmcnt(4)
  v_readlane_b32 s74, v16, 31
  s_add_u32 m0, s77, 90112
  s_add_u32 s4, s74, 0
  buffer_load_dwordx4 v8, s[40:43], s4 offen lds
  s_add_u32 m0, s77, 91136
  s_nop 0
  buffer_load_dwordx4 v9, s[40:43], s4 offen lds
  s_waitcnt vmcnt(22)
  s_barrier
  v_readlane_b32 s74, v16, 32
  s_add_u32 m0, s77, 98304
  s_add_u32 s4, s74, 0
  buffer_load_dwordx4 v8, s[40:43], s4 offen lds
  s_add_u32 m0, s77, 99328
  s_nop 0
  buffer_load_dwordx4 v9, s[40:43], s4 offen lds
  s_waitcnt vmcnt(4)
  v_readlane_b32 s74, v16, 33
  s_add_u32 m0, s77, 106496
  s_add_u32 s4, s74, 0
  buffer_load_dwordx4 v8, s[40:43], s4 offen lds
  s_add_u32 m0, s77, 107520
  s_nop 0
  buffer_load_dwordx4 v9, s[40:43], s4 offen lds
  s_waitcnt vmcnt(4)
  v_readlane_b32 s74, v16, 34
  s_add_u32 m0, s77, 114688
  s_add_u32 s4, s74, 0
  buffer_load_dwordx4 v8, s[40:43], s4 offen lds
  s_add_u32 m0, s77, 115712
  s_nop 0
  buffer_load_dwordx4 v9, s[40:43], s4 offen lds
  s_waitcnt vmcnt(4)
  v_readlane_b32 s74, v16, 35
  s_add_u32 m0, s77, 122880
  s_add_u32 s4, s74, 0
  buffer_load_dwordx4 v8, s[40:43], s4 offen lds
  s_add_u32 m0, s77, 123904
  s_nop 0
  buffer_load_dwordx4 v9, s[40:43], s4 offen lds
  s_add_u32 s60, s34, 25165824
  s_addc_u32 s61, s35, 0
  s_and_b32 s61, s61, 0xffff
  s_mov_b32 s62, 8388608
  s_mov_b32 s63, 0x00020000
  s_add_u32 s64, s22, 41943040
  s_addc_u32 s65, s23, 0
  s_and_b32 s65, s65, 0xffff
  s_mov_b32 s66, 524288
  s_mov_b32 s67, 0x00020000
  s_and_b32 s5, s70, 3
  s_lshl4_add_u32 s6, s68, s69
  s_lshl2_add_u32 s6, s6, s5
  s_mul_i32 s8, s6, 4096
  s_add_u32 s9, s8, 4096
  s_add_u32 s7, s96, 4
  s_lshl_b32 s7, s7, 10
  s_add_u32 s6, s6, s7
  s_lshl_b32 s6, s6, 6
  s_xor_b32 s7, s6, 256
  s_mul_i32 s5, s5, 4096
  s_add_u32 s5, s5, 131072
  v_lshlrev_b32 v3, 4, v1
  v_add_u32 v2, s5, v3
  v_mov_b32 v4, 1
  s_mov_b32 s79, 0x100000
  s_waitcnt vmcnt(26)
  s_barrier
  s_waitcnt vmcnt(0)
  s_barrier
  ds_read_b128 v[32:35], v2 offset:0
  ds_read_b128 v[36:39], v2 offset:1024
  ds_read_b128 v[40:43], v2 offset:2048
  ds_read_b128 v[44:47], v2 offset:3072
  s_waitcnt lgkmcnt(3)
  buffer_store_dwordx4 v[32:35], v3, s[60:63], s8 offen offset:0 sc1
  s_waitcnt lgkmcnt(2)
  buffer_store_dwordx4 v[36:39], v3, s[60:63], s8 offen offset:1024 sc1
  s_waitcnt lgkmcnt(1)
  buffer_store_dwordx4 v[40:43], v3, s[60:63], s8 offen offset:2048 sc1
  s_waitcnt lgkmcnt(0)
  buffer_store_dwordx4 v[44:47], v3, s[60:63], s8 offen offset:3072 sc1
  s_xor_b32 s8, s8, 16384
  s_xor_b32 s9, s9, 16384
  s_mov_b64 exec, 1
  s_waitcnt vmcnt(0)
  buffer_store_dword v4, off, s[64:67], s6 sc1
L_w2_xpoll:
  buffer_load_dword v5, off, s[64:67], s7 sc1
  s_sub_u32 s79, s79, 1
  s_cbranch_scc1 L_w2_xgo
  s_waitcnt vmcnt(0)
  v_cmp_ne_u32 vcc, 1, v5
  s_cbranch_vccnz L_w2_xpoll
L_w2_xgo:
  s_mov_b64 exec, -1
  s_mov_b32 m0, s5
  s_nop 0
  buffer_load_dwordx4 v3, s[60:63], s8 offen offset:0 lds
  buffer_load_dwordx4 v3, s[60:63], s8 offen offset:1024 lds
  buffer_load_dwordx4 v3, s[60:63], s8 offen offset:2048 lds
  buffer_load_dwordx4 v3, s[60:63], s8 offen offset:3072 lds
  s_waitcnt vmcnt(0)
  s_barrier
  s_cmp_eq_u32 s96, 1
  s_cbranch_scc1 L_w2_end
  s_lshl_b32 s87, s97, 15
  s_lshl_b32 s4, s68, 11
  s_add_u32 s87, s87, s4
  s_lshl_b32 s4, s69, 2
  s_add_u32 s87, s87, s4
  s_mov_b32 s96, 1
  s_add_u32 s12, s22, 33554432
  s_addc_u32 s13, s23, 0
  s_add_u32 s34, s22, 67108864
  s_addc_u32 s35, s23, 0
  s_add_u32 s97, s97, 1
  s_branch L_attn_body
L_w2_end:
  s_endpgm
L_w2_compute:
  v_and_b32 v2, 3, v1
  v_lshlrev_b32 v2, 3, v2
  v_bfe_i32 v15, s85, v2, 8
  s_and_b32 s3, s68, 3
  s_mul_i32 s4, s3, 4
  v_add3_u32 v3, v15, v1, s4
  v_subrev_u32 v3, 20, v3
  v_and_b32 v3, 15, v3
  v_add3_u32 v15, v15, v1, 20
  s_mul_i32 s3, s3, 1
  s_bitcmp1_b32 s69, 0
  s_cselect_b32 s4, 20, 0
  v_subrev_u32 v2, 20, v15
  v_min_u32 v15, v15, v2
  v_subrev_u32 v2, 20, v15
  v_min_u32 v15, v15, v2
  v_cmp_gt_u32 vcc, 4, v15
  v_add_u32 v2, s3, v15
  v_subrev_u32 v16, 4, v2
  v_min_u32 v2, v16, v2
  v_cndmask_b32 v15, v15, v2, vcc
  v_cmp_gt_u32 vcc, 20, v1
  v_add_u32 v15, s4, v15
  v_add_u32 v3, 40, v3
  v_cndmask_b32 v3, v3, v15, vcc
  v_lshlrev_b32 v15, 11, v3
  v_and_b32 v3, 15, v1
  v_lshrrev_b32 v2, 4, v1
  s_lshl_b32 s8, s68, 7
  s_lshl_b32 s9, s70, 5
  s_add_u32 s8, s8, s9
  s_mul_i32 s9, s8, 7168
  v_lshl_add_u32 v4, v1, 4, s9
  v_add_u32 v5, 114688, v4
  v_add_u32 v13, s8, v3
  s_lshl_b32 s10, s69, 7
  v_lshl_add_u32 v14, v2, 3, s10
  v_and_b32 v16, 1, v2
  v_lshrrev_b32 v17, 1, v2
  v_lshlrev_b32 v16, 5, v16
  v_lshl_add_u32 v16, v17, 4, v16
  v_add_u32 v16, s10, v16
  s_cmp_eq_u32 s96, 0
  s_cselect_b32 s7, 128, 0
  s_add_u32 s7, s7, 2048
  v_mad_u32_u24 v12, v13, s7, v16
  v_lshl_add_u32 v18, v17, 4, v13
  v_lshlrev_b32 v18, 3, v18
  v_and_b32 v16, 1, v2
  v_lshl_add_u32 v18, v16, 2, v18
  s_lshl_b32 s10, s69, 14
  v_add_u32 v18, s10, v18
  v_bfe_u32 v6, v1, 2, 2
  v_lshl_add_u32 v6, v2, 3, v6
  v_lshlrev_b32 v6, 7, v6
  v_and_b32 v17, 3, v1
  v_lshl_add_u32 v6, v17, 3, v6
  v_bfe_u32 v17, v1, 3, 2
  v_lshl_add_u32 v6, v17, 5, v6
  v_xor_b32 v7, 32, v6
  v_xor_b32 v8, 64, v6
  v_xor_b32 v9, 96, v6
  s_mov_b32 s11, 0xffff0000
  s_mov_b32 s52, s30
  s_and_b32 s53, s31, 0xffff
  s_mov_b32 s54, 2048
  s_mov_b32 s55, 0x00020000
  buffer_load_dwordx2 v[192:193], v14, s[52:55], 0 offen offset:0
  buffer_load_dwordx2 v[194:195], v14, s[52:55], 0 offen offset:32
  buffer_load_dwordx2 v[196:197], v14, s[52:55], 0 offen offset:64
  buffer_load_dwordx2 v[198:199], v14, s[52:55], 0 offen offset:96
  s_add_u32 s36, s34, 8388608
  s_addc_u32 s37, s35, 0
  s_and_b32 s37, s37, 0xffff
  s_mov_b32 s38, 14680064
  s_mov_b32 s39, 0x00020000
  s_mov_b32 s44, s32
  s_and_b32 s45, s33, 0xffff
  s_mov_b32 s46, 4194304
  s_mov_b32 s47, 0x00020000
  s_add_u32 s48, s22, 33554432
  s_addc_u32 s49, s23, 0
  s_and_b32 s49, s49, 0xffff
  s_mov_b32 s50, 4194304
  s_mov_b32 s51, 0x00020000
  s_cmp_eq_u32 s96, 0
  s_cselect_b64 s[44:45], s[48:49], s[44:45]
  s_lshl_b32 s46, s7, 11
  s_add_u32 s56, s34, 24379392
  s_addc_u32 s57, s35, 0
  s_and_b32 s57, s57, 0xffff
  s_mov_b32 s58, 262144
  s_mov_b32 s59, 0x00020000
  s_mul_i32 s3, s70, 4096
  s_add_u32 s3, s3, 131072
  v_lshl_add_u32 v19, v1, 4, s3
  v_mov_b32 v128, 0
  v_mov_b32 v129, 0
  v_mov_b32 v130, 0
  v_mov_b32 v131, 0
  v_mov_b32 v132, 0
  v_mov_b32 v133, 0
  v_mov_b32 v134, 0
  v_mov_b32 v135, 0
  v_mov_b32 v136, 0
  v_mov_b32 v137, 0
  v_mov_b32 v138, 0
  v_mov_b32 v139, 0
  v_mov_b32 v140, 0
  v_mov_b32 v141, 0
  v_mov_b32 v142, 0
  v_mov_b32 v143, 0
  v_mov_b32 v144, 0
  v_mov_b32 v145, 0
  v_mov_b32 v146, 0
  v_mov_b32 v147, 0
  v_mov_b32 v148, 0
  v_mov_b32 v149, 0
  v_mov_b32 v150, 0
  v_mov_b32 v151, 0
  v_mov_b32 v152, 0
  v_mov_b32 v153, 0
  v_mov_b32 v154, 0
  v_mov_b32 v155, 0
  v_mov_b32 v156, 0
  v_mov_b32 v157, 0
  v_mov_b32 v158, 0
  v_mov_b32 v159, 0
  v_add_u32 v26, 131072, v6
  v_add_u32 v27, 131072, v7
  v_add_u32 v28, 131072, v8
  v_add_u32 v29, 131072, v9
  v_add_u32 v20, 65536, v6
  v_add_u32 v21, 65536, v7
  v_add_u32 v22, 65536, v8
  v_add_u32 v23, 65536, v9
  v_readlane_b32 s48, v15, 0
  v_readlane_b32 s49, v15, 1
  v_readlane_b32 s50, v15, 2
  v_permlane16_swap_b32 v240, v242
  v_permlane16_swap_b32 v241, v243
  v_permlane16_swap_b32 v244, v246
  v_permlane16_swap_b32 v245, v247
  v_permlane16_swap_b32 v248, v250
  v_permlane16_swap_b32 v249, v251
  v_permlane16_swap_b32 v252, v254
  v_permlane16_swap_b32 v253, v255
  s_waitcnt lgkmcnt(0)
  s_barrier
  buffer_load_dwordx4 v[32:35], v4, s[36:39], s48 offen offset:0
  buffer_load_dwordx4 v[36:39], v5, s[36:39], s48 offen offset:0
  buffer_load_dwordx4 v[40:43], v4, s[36:39], s48 offen offset:1024
  buffer_load_dwordx4 v[44:47], v5, s[36:39], s48 offen offset:1024
  buffer_load_dwordx4 v[48:51], v4, s[36:39], s49 offen offset:0
  buffer_load_dwordx4 v[52:55], v5, s[36:39], s49 offen offset:0
  buffer_load_dwordx4 v[56:59], v4, s[36:39], s49 offen offset:1024
  buffer_load_dwordx4 v[60:63], v5, s[36:39], s49 offen offset:1024
  buffer_load_dwordx4 v[64:67], v4, s[36:39], s50 offen offset:0
  buffer_load_dwordx4 v[68:71], v5, s[36:39], s50 offen offset:0
  buffer_load_dwordx4 v[72:75], v4, s[36:39], s50 offen offset:1024
  buffer_load_dwordx4 v[76:79], v5, s[36:39], s50 offen offset:1024
  ds_read_b64_tr_b16 v[160:161], v6 offset:0
  ds_read_b64_tr_b16 v[162:163], v6 offset:512
  ds_read_b64_tr_b16 v[164:165], v7 offset:0
  ds_read_b64_tr_b16 v[166:167], v7 offset:512
  ds_read_b64_tr_b16 v[168:169], v8 offset:0
  ds_read_b64_tr_b16 v[170:171], v8 offset:512
  ds_read_b64_tr_b16 v[172:173], v9 offset:0
  ds_read_b64_tr_b16 v[174:175], v9 offset:512
  ds_read_b64_tr_b16 v[176:177], v6 offset:4096
  ds_read_b64_tr_b16 v[178:179], v6 offset:4608
  ds_read_b64_tr_b16 v[180:181], v7 offset:4096
  ds_read_b64_tr_b16 v[182:183], v7 offset:4608
  ds_read_b64_tr_b16 v[184:185], v8 offset:4096
  ds_read_b64_tr_b16 v[186:187], v8 offset:4608
  ds_read_b64_tr_b16 v[188:189], v9 offset:4096
  ds_read_b64_tr_b16 v[190:191], v9 offset:4608
  s_waitcnt vmcnt(12)
  v_lshlrev_b32 v216, 16, v192
  v_and_b32 v217, s11, v192
  v_lshlrev_b32 v218, 16, v193
  v_and_b32 v219, s11, v193
  v_lshlrev_b32 v96, 16, v240
  v_and_b32 v97, s11, v240
  v_pk_add_f32 v[96:97], v[96:97], v[216:217]
  v_lshlrev_b32 v98, 16, v241
  v_and_b32 v99, s11, v241
  v_pk_add_f32 v[98:99], v[98:99], v[218:219]
  v_lshlrev_b32 v100, 16, v248
  v_and_b32 v101, s11, v248
  v_pk_add_f32 v[100:101], v[100:101], v[216:217]
  v_lshlrev_b32 v102, 16, v249
  v_and_b32 v103, s11, v249
  v_pk_add_f32 v[102:103], v[102:103], v[218:219]
  v_lshlrev_b32 v216, 16, v194
  v_and_b32 v217, s11, v194
  v_lshlrev_b32 v218, 16, v195
  v_and_b32 v219, s11, v195
  v_lshlrev_b32 v104, 16, v242
  v_and_b32 v105, s11, v242
  v_pk_add_f32 v[104:105], v[104:105], v[216:217]
  v_lshlrev_b32 v106, 16, v243
  v_and_b32 v107, s11, v243
  v_pk_add_f32 v[106:107], v[106:107], v[218:219]
  v_lshlrev_b32 v108, 16, v250
  v_and_b32 v109, s11, v250
  v_pk_add_f32 v[108:109], v[108:109], v[216:217]
  v_lshlrev_b32 v110, 16, v251
  v_and_b32 v111, s11, v251
  v_pk_add_f32 v[110:111], v[110:111], v[218:219]
  v_lshlrev_b32 v216, 16, v196
  v_and_b32 v217, s11, v196
  v_lshlrev_b32 v218, 16, v197
  v_and_b32 v219, s11, v197
  v_lshlrev_b32 v112, 16, v244
  v_and_b32 v113, s11, v244
  v_pk_add_f32 v[112:113], v[112:113], v[216:217]
  v_lshlrev_b32 v114, 16, v245
  v_and_b32 v115, s11, v245
  v_pk_add_f32 v[114:115], v[114:115], v[218:219]
  v_lshlrev_b32 v116, 16, v252
  v_and_b32 v117, s11, v252
  v_pk_add_f32 v[116:117], v[116:117], v[216:217]
  v_lshlrev_b32 v118, 16, v253
  v_and_b32 v119, s11, v253
  v_pk_add_f32 v[118:119], v[118:119], v[218:219]
  v_lshlrev_b32 v216, 16, v198
  v_and_b32 v217, s11, v198
  v_lshlrev_b32 v218, 16, v199
  v_and_b32 v219, s11, v199
  v_lshlrev_b32 v120, 16, v246
  v_and_b32 v121, s11, v246
  v_pk_add_f32 v[120:121], v[120:121], v[216:217]
  v_lshlrev_b32 v122, 16, v247
  v_and_b32 v123, s11, v247
  v_pk_add_f32 v[122:123], v[122:123], v[218:219]
  v_lshlrev_b32 v124, 16, v254
  v_and_b32 v125, s11, v254
  v_pk_add_f32 v[124:125], v[124:125], v[216:217]
  v_lshlrev_b32 v126, 16, v255
  v_and_b32 v127, s11, v255
  v_pk_add_f32 v[126:127], v[126:127], v[218:219]
  s_waitcnt vmcnt(10) lgkmcnt(8)
  v_mfma_f32_16x16x32_bf16 v[128:131], v[160:163], v[32:35], v[128:131]
  ds_read_b64_tr_b16 v[192:193], v6 offset:8192
  v_readlane_b32 s51, v15, 3
  v_mfma_f32_16x16x32_bf16 v[132:135], v[160:163], v[36:39], v[132:135]
  ds_read_b64_tr_b16 v[194:195], v6 offset:8704
  v_mfma_f32_16x16x32_bf16 v[136:139], v[164:167], v[32:35], v[136:139]
  ds_read_b64_tr_b16 v[196:197], v7 offset:8192
  v_mfma_f32_16x16x32_bf16 v[140:143], v[164:167], v[36:39], v[140:143]
  ds_read_b64_tr_b16 v[198:199], v7 offset:8704
  buffer_load_dwordx4 v[80:83], v4, s[36:39], s51 offen offset:0
  v_mfma_f32_16x16x32_bf16 v[144:147], v[168:171], v[32:35], v[144:147]
  ds_read_b64_tr_b16 v[200:201], v8 offset:8192
  v_mfma_f32_16x16x32_bf16 v[148:151], v[168:171], v[36:39], v[148:151]
  ds_read_b64_tr_b16 v[202:203], v8 offset:8704
  v_mfma_f32_16x16x32_bf16 v[152:155], v[172:175], v[32:35], v[152:155]
  ds_read_b64_tr_b16 v[204:205], v9 offset:8192
  buffer_load_dwordx4 v[84:87], v5, s[36:39], s51 offen offset:0
  v_mfma_f32_16x16x32_bf16 v[156:159], v[172:175], v[36:39], v[156:159]
  ds_read_b64_tr_b16 v[206:207], v9 offset:8704
  s_waitcnt vmcnt(10) lgkmcnt(8)
  v_mfma_f32_16x16x32_bf16 v[128:131], v[176:179], v[40:43], v[128:131]
  ds_read_b64_tr_b16 v[208:209], v6 offset:12288
  v_mfma_f32_16x16x32_bf16 v[132:135], v[176:179], v[44:47], v[132:135]
  ds_read_b64_tr_b16 v[210:211], v6 offset:12800
  buffer_load_dwordx4 v[88:91], v4, s[36:39], s51 offen offset:1024
  v_mfma_f32_16x16x32_bf16 v[136:139], v[180:183], v[40:43], v[136:139]
  ds_read_b64_tr_b16 v[212:213], v7 offset:12288
  v_mfma_f32_16x16x32_bf16 v[140:143], v[180:183], v[44:47], v[140:143]
  ds_read_b64_tr_b16 v[214:215], v7 offset:12800
  v_mfma_f32_16x16x32_bf16 v[144:147], v[184:187], v[40:43], v[144:147]
  ds_read_b64_tr_b16 v[216:217], v8 offset:12288
  buffer_load_dwordx4 v[92:95], v5, s[36:39], s51 offen offset:1024
  v_mfma_f32_16x16x32_bf16 v[148:151], v[184:187], v[44:47], v[148:151]
  ds_read_b64_tr_b16 v[218:219], v8 offset:12800
  v_readlane_b32 s48, v15, 4
  v_mfma_f32_16x16x32_bf16 v[152:155], v[188:191], v[40:43], v[152:155]
  ds_read_b64_tr_b16 v[220:221], v9 offset:12288
  v_mfma_f32_16x16x32_bf16 v[156:159], v[188:191], v[44:47], v[156:159]
  ds_read_b64_tr_b16 v[222:223], v9 offset:12800
  s_waitcnt lgkmcnt(8)
  v_mfma_f32_16x16x32_bf16 v[96:99], v[192:195], v[32:35], v[96:99]
  ds_read_b64_tr_b16 v[160:161], v6 offset:16384
  buffer_load_dwordx4 v[224:227], v4, s[36:39], s48 offen offset:0
  v_mfma_f32_16x16x32_bf16 v[100:103], v[192:195], v[36:39], v[100:103]
  ds_read_b64_tr_b16 v[162:163], v6 offset:16896
  v_mfma_f32_16x16x32_bf16 v[104:107], v[196:199], v[32:35], v[104:107]
  ds_read_b64_tr_b16 v[164:165], v7 offset:16384
  v_mfma_f32_16x16x32_bf16 v[108:111], v[196:199], v[36:39], v[108:111]
  ds_read_b64_tr_b16 v[166:167], v7 offset:16896
  buffer_load_dwordx4 v[228:231], v5, s[36:39], s48 offen offset:0
  v_mfma_f32_16x16x32_bf16 v[112:115], v[200:203], v[32:35], v[112:115]
  ds_read_b64_tr_b16 v[168:169], v8 offset:16384
  v_mfma_f32_16x16x32_bf16 v[116:119], v[200:203], v[36:39], v[116:119]
  ds_read_b64_tr_b16 v[170:171], v8 offset:16896
  v_mfma_f32_16x16x32_bf16 v[120:123], v[204:207], v[32:35], v[120:123]
  ds_read_b64_tr_b16 v[172:173], v9 offset:16384
  buffer_load_dwordx4 v[232:235], v4, s[36:39], s48 offen offset:1024
  v_mfma_f32_16x16x32_bf16 v[124:127], v[204:207], v[36:39], v[124:127]
  ds_read_b64_tr_b16 v[174:175], v9 offset:16896
  s_waitcnt lgkmcnt(8)
  v_mfma_f32_16x16x32_bf16 v[96:99], v[208:211], v[40:43], v[96:99]
  ds_read_b64_tr_b16 v[176:177], v6 offset:20480
  v_mfma_f32_16x16x32_bf16 v[100:103], v[208:211], v[44:47], v[100:103]
  ds_read_b64_tr_b16 v[178:179], v6 offset:20992
  buffer_load_dwordx4 v[236:239], v5, s[36:39], s48 offen offset:1024
  v_mfma_f32_16x16x32_bf16 v[104:107], v[212:215], v[40:43], v[104:107]
  ds_read_b64_tr_b16 v[180:181], v7 offset:20480
  v_readlane_b32 s49, v15, 5
  v_mfma_f32_16x16x32_bf16 v[108:111], v[212:215], v[44:47], v[108:111]
  ds_read_b64_tr_b16 v[182:183], v7 offset:20992
  v_mfma_f32_16x16x32_bf16 v[112:115], v[216:219], v[40:43], v[112:115]
  ds_read_b64_tr_b16 v[184:185], v8 offset:20480
  v_mfma_f32_16x16x32_bf16 v[116:119], v[216:219], v[44:47], v[116:119]
  ds_read_b64_tr_b16 v[186:187], v8 offset:20992
  buffer_load_dwordx4 v[240:243], v4, s[36:39], s49 offen offset:0
  v_mfma_f32_16x16x32_bf16 v[120:123], v[220:223], v[40:43], v[120:123]
  ds_read_b64_tr_b16 v[188:189], v9 offset:20480
  v_mfma_f32_16x16x32_bf16 v[124:127], v[220:223], v[44:47], v[124:127]
  ds_read_b64_tr_b16 v[190:191], v9 offset:20992
  s_waitcnt vmcnt(15) lgkmcnt(8)
  v_mfma_f32_16x16x32_bf16 v[128:131], v[160:163], v[48:51], v[128:131]
  ds_read_b64_tr_b16 v[192:193], v6 offset:24576
  buffer_load_dwordx4 v[244:247], v5, s[36:39], s49 offen offset:0
  v_mfma_f32_16x16x32_bf16 v[132:135], v[160:163], v[52:55], v[132:135]
  ds_read_b64_tr_b16 v[194:195], v6 offset:25088
  v_mfma_f32_16x16x32_bf16 v[136:139], v[164:167], v[48:51], v[136:139]
  ds_read_b64_tr_b16 v[196:197], v7 offset:24576
  v_mfma_f32_16x16x32_bf16 v[140:143], v[164:167], v[52:55], v[140:143]
  ds_read_b64_tr_b16 v[198:199], v7 offset:25088
  buffer_load_dwordx4 v[248:251], v4, s[36:39], s49 offen offset:1024
  v_mfma_f32_16x16x32_bf16 v[144:147], v[168:171], v[48:51], v[144:147]
  ds_read_b64_tr_b16 v[200:201], v8 offset:24576
  v_mfma_f32_16x16x32_bf16 v[148:151], v[168:171], v[52:55], v[148:151]
  ds_read_b64_tr_b16 v[202:203], v8 offset:25088
  v_mfma_f32_16x16x32_bf16 v[152:155], v[172:175], v[48:51], v[152:155]
  ds_read_b64_tr_b16 v[204:205], v9 offset:24576
  buffer_load_dwordx4 v[252:255], v5, s[36:39], s49 offen offset:1024
  v_mfma_f32_16x16x32_bf16 v[156:159], v[172:175], v[52:55], v[156:159]
  ds_read_b64_tr_b16 v[206:207], v9 offset:25088
  s_waitcnt vmcnt(16) lgkmcnt(8)
  v_mfma_f32_16x16x32_bf16 v[128:131], v[176:179], v[56:59], v[128:131]
  ds_read_b64_tr_b16 v[208:209], v6 offset:28672
  v_readlane_b32 s50, v15, 6
  v_mfma_f32_16x16x32_bf16 v[132:135], v[176:179], v[60:63], v[132:135]
  ds_read_b64_tr_b16 v[210:211], v6 offset:29184
  v_mfma_f32_16x16x32_bf16 v[136:139], v[180:183], v[56:59], v[136:139]
  ds_read_b64_tr_b16 v[212:213], v7 offset:28672
  v_mfma_f32_16x16x32_bf16 v[140:143], v[180:183], v[60:63], v[140:143]
  ds_read_b64_tr_b16 v[214:215], v7 offset:29184
  buffer_load_dwordx4 v[32:35], v4, s[36:39], s50 offen offset:0
  v_mfma_f32_16x16x32_bf16 v[144:147], v[184:187], v[56:59], v[144:147]
  ds_read_b64_tr_b16 v[216:217], v8 offset:28672
  v_mfma_f32_16x16x32_bf16 v[148:151], v[184:187], v[60:63], v[148:151]
  ds_read_b64_tr_b16 v[218:219], v8 offset:29184
  v_mfma_f32_16x16x32_bf16 v[152:155], v[188:191], v[56:59], v[152:155]
  ds_read_b64_tr_b16 v[220:221], v9 offset:28672
  v_mfma_f32_16x16x32_bf16 v[156:159], v[188:191], v[60:63], v[156:159]
  ds_read_b64_tr_b16 v[222:223], v9 offset:29184
  s_waitcnt lgkmcnt(8)
  v_mfma_f32_16x16x32_bf16 v[96:99], v[192:195], v[48:51], v[96:99]
  ds_read_b64_tr_b16 v[160:161], v6 offset:32768
  v_mfma_f32_16x16x32_bf16 v[100:103], v[192:195], v[52:55], v[100:103]
  ds_read_b64_tr_b16 v[162:163], v6 offset:33280
  v_mfma_f32_16x16x32_bf16 v[104:107], v[196:199], v[48:51], v[104:107]
  ds_read_b64_tr_b16 v[164:165], v7 offset:32768
  buffer_load_dwordx4 v[36:39], v5, s[36:39], s50 offen offset:0
  v_mfma_f32_16x16x32_bf16 v[108:111], v[196:199], v[52:55], v[108:111]
  ds_read_b64_tr_b16 v[166:167], v7 offset:33280
  v_mfma_f32_16x16x32_bf16 v[112:115], v[200:203], v[48:51], v[112:115]
  ds_read_b64_tr_b16 v[168:169], v8 offset:32768
  v_mfma_f32_16x16x32_bf16 v[116:119], v[200:203], v[52:55], v[116:119]
  ds_read_b64_tr_b16 v[170:171], v8 offset:33280
  v_mfma_f32_16x16x32_bf16 v[120:123], v[204:207], v[48:51], v[120:123]
  ds_read_b64_tr_b16 v[172:173], v9 offset:32768
  v_mfma_f32_16x16x32_bf16 v[124:127], v[204:207], v[52:55], v[124:127]
  ds_read_b64_tr_b16 v[174:175], v9 offset:33280
  s_waitcnt lgkmcnt(8)
  s_barrier
  v_mfma_f32_16x16x32_bf16 v[96:99], v[208:211], v[56:59], v[96:99]
  ds_read_b64_tr_b16 v[176:177], v6 offset:36864
  v_mfma_f32_16x16x32_bf16 v[100:103], v[208:211], v[60:63], v[100:103]
  ds_read_b64_tr_b16 v[178:179], v6 offset:37376
  buffer_load_dwordx4 v[40:43], v4, s[36:39], s50 offen offset:1024
  v_mfma_f32_16x16x32_bf16 v[104:107], v[212:215], v[56:59], v[104:107]
  ds_read_b64_tr_b16 v[180:181], v7 offset:36864
  v_mfma_f32_16x16x32_bf16 v[108:111], v[212:215], v[60:63], v[108:111]
  ds_read_b64_tr_b16 v[182:183], v7 offset:37376
  v_mfma_f32_16x16x32_bf16 v[112:115], v[216:219], v[56:59], v[112:115]
  ds_read_b64_tr_b16 v[184:185], v8 offset:36864
  v_mfma_f32_16x16x32_bf16 v[116:119], v[216:219], v[60:63], v[116:119]
  ds_read_b64_tr_b16 v[186:187], v8 offset:37376
  v_mfma_f32_16x16x32_bf16 v[120:123], v[220:223], v[56:59], v[120:123]
  ds_read_b64_tr_b16 v[188:189], v9 offset:36864
  v_mfma_f32_16x16x32_bf16 v[124:127], v[220:223], v[60:63], v[124:127]
  ds_read_b64_tr_b16 v[190:191], v9 offset:37376
  s_waitcnt vmcnt(17) lgkmcnt(8)
  v_mfma_f32_16x16x32_bf16 v[128:131], v[160:163], v[64:67], v[128:131]
  ds_read_b64_tr_b16 v[192:193], v6 offset:40960
  buffer_load_dwordx4 v[44:47], v5, s[36:39], s50 offen offset:1024
  v_mfma_f32_16x16x32_bf16 v[132:135], v[160:163], v[68:71], v[132:135]
  ds_read_b64_tr_b16 v[194:195], v6 offset:41472
  v_mfma_f32_16x16x32_bf16 v[136:139], v[164:167], v[64:67], v[136:139]
  ds_read_b64_tr_b16 v[196:197], v7 offset:40960
  v_mfma_f32_16x16x32_bf16 v[140:143], v[164:167], v[68:71], v[140:143]
  ds_read_b64_tr_b16 v[198:199], v7 offset:41472
  v_mfma_f32_16x16x32_bf16 v[144:147], v[168:171], v[64:67], v[144:147]
  ds_read_b64_tr_b16 v[200:201], v8 offset:40960
  v_mfma_f32_16x16x32_bf16 v[148:151], v[168:171], v[68:71], v[148:151]
  ds_read_b64_tr_b16 v[202:203], v8 offset:41472
  v_readlane_b32 s51, v15, 7
  v_mfma_f32_16x16x32_bf16 v[152:155], v[172:175], v[64:67], v[152:155]
  ds_read_b64_tr_b16 v[204:205], v9 offset:40960
  v_mfma_f32_16x16x32_bf16 v[156:159], v[172:175], v[68:71], v[156:159]
  ds_read_b64_tr_b16 v[206:207], v9 offset:41472
  s_waitcnt vmcnt(16) lgkmcnt(8)
  v_mfma_f32_16x16x32_bf16 v[128:131], v[176:179], v[72:75], v[128:131]
  ds_read_b64_tr_b16 v[208:209], v6 offset:45056
  buffer_load_dwordx4 v[48:51], v4, s[36:39], s51 offen offset:0
  v_mfma_f32_16x16x32_bf16 v[132:135], v[176:179], v[76:79], v[132:135]
  ds_read_b64_tr_b16 v[210:211], v6 offset:45568
  v_mfma_f32_16x16x32_bf16 v[136:139], v[180:183], v[72:75], v[136:139]
  ds_read_b64_tr_b16 v[212:213], v7 offset:45056
  v_mfma_f32_16x16x32_bf16 v[140:143], v[180:183], v[76:79], v[140:143]
  ds_read_b64_tr_b16 v[214:215], v7 offset:45568
  v_mfma_f32_16x16x32_bf16 v[144:147], v[184:187], v[72:75], v[144:147]
  ds_read_b64_tr_b16 v[216:217], v8 offset:45056
  v_mfma_f32_16x16x32_bf16 v[148:151], v[184:187], v[76:79], v[148:151]
  ds_read_b64_tr_b16 v[218:219], v8 offset:45568
  v_mfma_f32_16x16x32_bf16 v[152:155], v[188:191], v[72:75], v[152:155]
  ds_read_b64_tr_b16 v[220:221], v9 offset:45056
  v_mfma_f32_16x16x32_bf16 v[156:159], v[188:191], v[76:79], v[156:159]
  ds_read_b64_tr_b16 v[222:223], v9 offset:45568
  s_waitcnt lgkmcnt(8)
  v_mfma_f32_16x16x32_bf16 v[96:99], v[192:195], v[64:67], v[96:99]
  ds_read_b64_tr_b16 v[160:161], v6 offset:49152
  buffer_load_dwordx4 v[52:55], v5, s[36:39], s51 offen offset:0
  v_mfma_f32_16x16x32_bf16 v[100:103], v[192:195], v[68:71], v[100:103]
  ds_read_b64_tr_b16 v[162:163], v6 offset:49664
  v_mfma_f32_16x16x32_bf16 v[104:107], v[196:199], v[64:67], v[104:107]
  ds_read_b64_tr_b16 v[164:165], v7 offset:49152
  v_mfma_f32_16x16x32_bf16 v[108:111], v[196:199], v[68:71], v[108:111]
  ds_read_b64_tr_b16 v[166:167], v7 offset:49664
  v_mfma_f32_16x16x32_bf16 v[112:115], v[200:203], v[64:67], v[112:115]
  ds_read_b64_tr_b16 v[168:169], v8 offset:49152
  v_mfma_f32_16x16x32_bf16 v[116:119], v[200:203], v[68:71], v[116:119]
  ds_read_b64_tr_b16 v[170:171], v8 offset:49664
  v_mfma_f32_16x16x32_bf16 v[120:123], v[204:207], v[64:67], v[120:123]
  ds_read_b64_tr_b16 v[172:173], v9 offset:49152
  v_mfma_f32_16x16x32_bf16 v[124:127], v[204:207], v[68:71], v[124:127]
  ds_read_b64_tr_b16 v[174:175], v9 offset:49664
  s_waitcnt lgkmcnt(8)
  v_mfma_f32_16x16x32_bf16 v[96:99], v[208:211], v[72:75], v[96:99]
  ds_read_b64_tr_b16 v[176:177], v6 offset:53248
  buffer_load_dwordx4 v[56:59], v4, s[36:39], s51 offen offset:1024
  v_mfma_f32_16x16x32_bf16 v[100:103], v[208:211], v[76:79], v[100:103]
  ds_read_b64_tr_b16 v[178:179], v6 offset:53760
  v_mfma_f32_16x16x32_bf16 v[104:107], v[212:215], v[72:75], v[104:107]
  ds_read_b64_tr_b16 v[180:181], v7 offset:53248
  v_mfma_f32_16x16x32_bf16 v[108:111], v[212:215], v[76:79], v[108:111]
  ds_read_b64_tr_b16 v[182:183], v7 offset:53760
  v_mfma_f32_16x16x32_bf16 v[112:115], v[216:219], v[72:75], v[112:115]
  ds_read_b64_tr_b16 v[184:185], v8 offset:53248
  v_mfma_f32_16x16x32_bf16 v[116:119], v[216:219], v[76:79], v[116:119]
  ds_read_b64_tr_b16 v[186:187], v8 offset:53760
  v_mfma_f32_16x16x32_bf16 v[120:123], v[220:223], v[72:75], v[120:123]
  ds_read_b64_tr_b16 v[188:189], v9 offset:53248
  v_mfma_f32_16x16x32_bf16 v[124:127], v[220:223], v[76:79], v[124:127]
  ds_read_b64_tr_b16 v[190:191], v9 offset:53760
  s_waitcnt vmcnt(17) lgkmcnt(8)
  v_mfma_f32_16x16x32_bf16 v[128:131], v[160:163], v[80:83], v[128:131]
  ds_read_b64_tr_b16 v[192:193], v6 offset:57344
  buffer_load_dwordx4 v[60:63], v5, s[36:39], s51 offen offset:1024
  v_mfma_f32_16x16x32_bf16 v[132:135], v[160:163], v[84:87], v[132:135]
  ds_read_b64_tr_b16 v[194:195], v6 offset:57856
  v_mfma_f32_16x16x32_bf16 v[136:139], v[164:167], v[80:83], v[136:139]
  ds_read_b64_tr_b16 v[196:197], v7 offset:57344
  v_mfma_f32_16x16x32_bf16 v[140:143], v[164:167], v[84:87], v[140:143]
  ds_read_b64_tr_b16 v[198:199], v7 offset:57856
  v_mfma_f32_16x16x32_bf16 v[144:147], v[168:171], v[80:83], v[144:147]
  ds_read_b64_tr_b16 v[200:201], v8 offset:57344
  v_mfma_f32_16x16x32_bf16 v[148:151], v[168:171], v[84:87], v[148:151]
  ds_read_b64_tr_b16 v[202:203], v8 offset:57856
  v_readlane_b32 s48, v15, 8
  v_mfma_f32_16x16x32_bf16 v[152:155], v[172:175], v[80:83], v[152:155]
  ds_read_b64_tr_b16 v[204:205], v9 offset:57344
  v_mfma_f32_16x16x32_bf16 v[156:159], v[172:175], v[84:87], v[156:159]
  ds_read_b64_tr_b16 v[206:207], v9 offset:57856
  s_waitcnt vmcnt(16) lgkmcnt(8)
  v_mfma_f32_16x16x32_bf16 v[128:131], v[176:179], v[88:91], v[128:131]
  ds_read_b64_tr_b16 v[208:209], v6 offset:61440
  buffer_load_dwordx4 v[64:67], v4, s[36:39], s48 offen offset:0
  v_mfma_f32_16x16x32_bf16 v[132:135], v[176:179], v[92:95], v[132:135]
  ds_read_b64_tr_b16 v[210:211], v6 offset:61952
  v_mfma_f32_16x16x32_bf16 v[136:139], v[180:183], v[88:91], v[136:139]
  ds_read_b64_tr_b16 v[212:213], v7 offset:61440
  v_mfma_f32_16x16x32_bf16 v[140:143], v[180:183], v[92:95], v[140:143]
  ds_read_b64_tr_b16 v[214:215], v7 offset:61952
  v_mfma_f32_16x16x32_bf16 v[144:147], v[184:187], v[88:91], v[144:147]
  ds_read_b64_tr_b16 v[216:217], v8 offset:61440
  v_mfma_f32_16x16x32_bf16 v[148:151], v[184:187], v[92:95], v[148:151]
  ds_read_b64_tr_b16 v[218:219], v8 offset:61952
  v_mfma_f32_16x16x32_bf16 v[152:155], v[188:191], v[88:91], v[152:155]
  ds_read_b64_tr_b16 v[220:221], v9 offset:61440
  v_mfma_f32_16x16x32_bf16 v[156:159], v[188:191], v[92:95], v[156:159]
  ds_read_b64_tr_b16 v[222:223], v9 offset:61952
  s_waitcnt lgkmcnt(8)
  v_mfma_f32_16x16x32_bf16 v[96:99], v[192:195], v[80:83], v[96:99]
  ds_read_b64_tr_b16 v[160:161], v20 offset:0
  buffer_load_dwordx4 v[68:71], v5, s[36:39], s48 offen offset:0
  v_mfma_f32_16x16x32_bf16 v[100:103], v[192:195], v[84:87], v[100:103]
  ds_read_b64_tr_b16 v[162:163], v20 offset:512
  v_mfma_f32_16x16x32_bf16 v[104:107], v[196:199], v[80:83], v[104:107]
  ds_read_b64_tr_b16 v[164:165], v21 offset:0
  v_mfma_f32_16x16x32_bf16 v[108:111], v[196:199], v[84:87], v[108:111]
  ds_read_b64_tr_b16 v[166:167], v21 offset:512
  v_mfma_f32_16x16x32_bf16 v[112:115], v[200:203], v[80:83], v[112:115]
  ds_read_b64_tr_b16 v[168:169], v22 offset:0
  v_mfma_f32_16x16x32_bf16 v[116:119], v[200:203], v[84:87], v[116:119]
  ds_read_b64_tr_b16 v[170:171], v22 offset:512
  v_mfma_f32_16x16x32_bf16 v[120:123], v[204:207], v[80:83], v[120:123]
  ds_read_b64_tr_b16 v[172:173], v23 offset:0
  v_mfma_f32_16x16x32_bf16 v[124:127], v[204:207], v[84:87], v[124:127]
  ds_read_b64_tr_b16 v[174:175], v23 offset:512
  s_waitcnt lgkmcnt(8)
  s_barrier
  v_mfma_f32_16x16x32_bf16 v[96:99], v[208:211], v[88:91], v[96:99]
  ds_read_b64_tr_b16 v[176:177], v20 offset:4096
  buffer_load_dwordx4 v[72:75], v4, s[36:39], s48 offen offset:1024
  v_mfma_f32_16x16x32_bf16 v[100:103], v[208:211], v[92:95], v[100:103]
  ds_read_b64_tr_b16 v[178:179], v20 offset:4608
  v_mfma_f32_16x16x32_bf16 v[104:107], v[212:215], v[88:91], v[104:107]
  ds_read_b64_tr_b16 v[180:181], v21 offset:4096
  v_mfma_f32_16x16x32_bf16 v[108:111], v[212:215], v[92:95], v[108:111]
  ds_read_b64_tr_b16 v[182:183], v21 offset:4608
  v_mfma_f32_16x16x32_bf16 v[112:115], v[216:219], v[88:91], v[112:115]
  ds_read_b64_tr_b16 v[184:185], v22 offset:4096
  v_mfma_f32_16x16x32_bf16 v[116:119], v[216:219], v[92:95], v[116:119]
  ds_read_b64_tr_b16 v[186:187], v22 offset:4608
  v_mfma_f32_16x16x32_bf16 v[120:123], v[220:223], v[88:91], v[120:123]
  ds_read_b64_tr_b16 v[188:189], v23 offset:4096
  v_mfma_f32_16x16x32_bf16 v[124:127], v[220:223], v[92:95], v[124:127]
  ds_read_b64_tr_b16 v[190:191], v23 offset:4608
  s_waitcnt vmcnt(17) lgkmcnt(8)
  v_mfma_f32_16x16x32_bf16 v[128:131], v[160:163], v[224:227], v[128:131]
  ds_read_b64_tr_b16 v[192:193], v20 offset:8192
  buffer_load_dwordx4 v[76:79], v5, s[36:39], s48 offen offset:1024
  v_mfma_f32_16x16x32_bf16 v[132:135], v[160:163], v[228:231], v[132:135]
  ds_read_b64_tr_b16 v[194:195], v20 offset:8704
  v_mfma_f32_16x16x32_bf16 v[136:139], v[164:167], v[224:227], v[136:139]
  ds_read_b64_tr_b16 v[196:197], v21 offset:8192
  v_mfma_f32_16x16x32_bf16 v[140:143], v[164:167], v[228:231], v[140:143]
  ds_read_b64_tr_b16 v[198:199], v21 offset:8704
  v_mfma_f32_16x16x32_bf16 v[144:147], v[168:171], v[224:227], v[144:147]
  ds_read_b64_tr_b16 v[200:201], v22 offset:8192
  v_mfma_f32_16x16x32_bf16 v[148:151], v[168:171], v[228:231], v[148:151]
  ds_read_b64_tr_b16 v[202:203], v22 offset:8704
  v_readlane_b32 s49, v15, 9
  v_mfma_f32_16x16x32_bf16 v[152:155], v[172:175], v[224:227], v[152:155]
  ds_read_b64_tr_b16 v[204:205], v23 offset:8192
  v_mfma_f32_16x16x32_bf16 v[156:159], v[172:175], v[228:231], v[156:159]
  ds_read_b64_tr_b16 v[206:207], v23 offset:8704
  s_waitcnt vmcnt(16) lgkmcnt(8)
  v_mfma_f32_16x16x32_bf16 v[128:131], v[176:179], v[232:235], v[128:131]
  ds_read_b64_tr_b16 v[208:209], v20 offset:12288
  buffer_load_dwordx4 v[80:83], v4, s[36:39], s49 offen offset:0
  v_mfma_f32_16x16x32_bf16 v[132:135], v[176:179], v[236:239], v[132:135]
  ds_read_b64_tr_b16 v[210:211], v20 offset:12800
  v_mfma_f32_16x16x32_bf16 v[136:139], v[180:183], v[232:235], v[136:139]
  ds_read_b64_tr_b16 v[212:213], v21 offset:12288
  v_mfma_f32_16x16x32_bf16 v[140:143], v[180:183], v[236:239], v[140:143]
  ds_read_b64_tr_b16 v[214:215], v21 offset:12800
  v_mfma_f32_16x16x32_bf16 v[144:147], v[184:187], v[232:235], v[144:147]
  ds_read_b64_tr_b16 v[216:217], v22 offset:12288
  v_mfma_f32_16x16x32_bf16 v[148:151], v[184:187], v[236:239], v[148:151]
  ds_read_b64_tr_b16 v[218:219], v22 offset:12800
  v_mfma_f32_16x16x32_bf16 v[152:155], v[188:191], v[232:235], v[152:155]
  ds_read_b64_tr_b16 v[220:221], v23 offset:12288
  v_mfma_f32_16x16x32_bf16 v[156:159], v[188:191], v[236:239], v[156:159]
  ds_read_b64_tr_b16 v[222:223], v23 offset:12800
  s_waitcnt lgkmcnt(8)
  v_mfma_f32_16x16x32_bf16 v[96:99], v[192:195], v[224:227], v[96:99]
  ds_read_b64_tr_b16 v[160:161], v20 offset:16384
  buffer_load_dwordx4 v[84:87], v5, s[36:39], s49 offen offset:0
  v_mfma_f32_16x16x32_bf16 v[100:103], v[192:195], v[228:231], v[100:103]
  ds_read_b64_tr_b16 v[162:163], v20 offset:16896
  v_mfma_f32_16x16x32_bf16 v[104:107], v[196:199], v[224:227], v[104:107]
  ds_read_b64_tr_b16 v[164:165], v21 offset:16384
  v_mfma_f32_16x16x32_bf16 v[108:111], v[196:199], v[228:231], v[108:111]
  ds_read_b64_tr_b16 v[166:167], v21 offset:16896
  v_mfma_f32_16x16x32_bf16 v[112:115], v[200:203], v[224:227], v[112:115]
  ds_read_b64_tr_b16 v[168:169], v22 offset:16384
  v_mfma_f32_16x16x32_bf16 v[116:119], v[200:203], v[228:231], v[116:119]
  ds_read_b64_tr_b16 v[170:171], v22 offset:16896
  v_mfma_f32_16x16x32_bf16 v[120:123], v[204:207], v[224:227], v[120:123]
  ds_read_b64_tr_b16 v[172:173], v23 offset:16384
  v_mfma_f32_16x16x32_bf16 v[124:127], v[204:207], v[228:231], v[124:127]
  ds_read_b64_tr_b16 v[174:175], v23 offset:16896
  s_waitcnt lgkmcnt(8)
  v_mfma_f32_16x16x32_bf16 v[96:99], v[208:211], v[232:235], v[96:99]
  ds_read_b64_tr_b16 v[176:177], v20 offset:20480
  buffer_load_dwordx4 v[88:91], v4, s[36:39], s49 offen offset:1024
  v_mfma_f32_16x16x32_bf16 v[100:103], v[208:211], v[236:239], v[100:103]
  ds_read_b64_tr_b16 v[178:179], v20 offset:20992
  v_mfma_f32_16x16x32_bf16 v[104:107], v[212:215], v[232:235], v[104:107]
  ds_read_b64_tr_b16 v[180:181], v21 offset:20480
  v_mfma_f32_16x16x32_bf16 v[108:111], v[212:215], v[236:239], v[108:111]
  ds_read_b64_tr_b16 v[182:183], v21 offset:20992
  v_mfma_f32_16x16x32_bf16 v[112:115], v[216:219], v[232:235], v[112:115]
  ds_read_b64_tr_b16 v[184:185], v22 offset:20480
  v_mfma_f32_16x16x32_bf16 v[116:119], v[216:219], v[236:239], v[116:119]
  ds_read_b64_tr_b16 v[186:187], v22 offset:20992
  v_mfma_f32_16x16x32_bf16 v[120:123], v[220:223], v[232:235], v[120:123]
  ds_read_b64_tr_b16 v[188:189], v23 offset:20480
  v_mfma_f32_16x16x32_bf16 v[124:127], v[220:223], v[236:239], v[124:127]
  ds_read_b64_tr_b16 v[190:191], v23 offset:20992
  s_waitcnt vmcnt(17) lgkmcnt(8)
  v_mfma_f32_16x16x32_bf16 v[128:131], v[160:163], v[240:243], v[128:131]
  ds_read_b64_tr_b16 v[192:193], v20 offset:24576
  buffer_load_dwordx4 v[92:95], v5, s[36:39], s49 offen offset:1024
  v_mfma_f32_16x16x32_bf16 v[132:135], v[160:163], v[244:247], v[132:135]
  ds_read_b64_tr_b16 v[194:195], v20 offset:25088
  v_mfma_f32_16x16x32_bf16 v[136:139], v[164:167], v[240:243], v[136:139]
  ds_read_b64_tr_b16 v[196:197], v21 offset:24576
  v_mfma_f32_16x16x32_bf16 v[140:143], v[164:167], v[244:247], v[140:143]
  ds_read_b64_tr_b16 v[198:199], v21 offset:25088
  v_mfma_f32_16x16x32_bf16 v[144:147], v[168:171], v[240:243], v[144:147]
  ds_read_b64_tr_b16 v[200:201], v22 offset:24576
  v_mfma_f32_16x16x32_bf16 v[148:151], v[168:171], v[244:247], v[148:151]
  ds_read_b64_tr_b16 v[202:203], v22 offset:25088
  v_readlane_b32 s50, v15, 10
  v_mfma_f32_16x16x32_bf16 v[152:155], v[172:175], v[240:243], v[152:155]
  ds_read_b64_tr_b16 v[204:205], v23 offset:24576
  v_mfma_f32_16x16x32_bf16 v[156:159], v[172:175], v[244:247], v[156:159]
  ds_read_b64_tr_b16 v[206:207], v23 offset:25088
  s_waitcnt vmcnt(16) lgkmcnt(8)
  v_mfma_f32_16x16x32_bf16 v[128:131], v[176:179], v[248:251], v[128:131]
  ds_read_b64_tr_b16 v[208:209], v20 offset:28672
  buffer_load_dwordx4 v[224:227], v4, s[36:39], s50 offen offset:0
  v_mfma_f32_16x16x32_bf16 v[132:135], v[176:179], v[252:255], v[132:135]
  ds_read_b64_tr_b16 v[210:211], v20 offset:29184
  v_mfma_f32_16x16x32_bf16 v[136:139], v[180:183], v[248:251], v[136:139]
  ds_read_b64_tr_b16 v[212:213], v21 offset:28672
  v_mfma_f32_16x16x32_bf16 v[140:143], v[180:183], v[252:255], v[140:143]
  ds_read_b64_tr_b16 v[214:215], v21 offset:29184
  v_mfma_f32_16x16x32_bf16 v[144:147], v[184:187], v[248:251], v[144:147]
  ds_read_b64_tr_b16 v[216:217], v22 offset:28672
  v_mfma_f32_16x16x32_bf16 v[148:151], v[184:187], v[252:255], v[148:151]
  ds_read_b64_tr_b16 v[218:219], v22 offset:29184
  v_mfma_f32_16x16x32_bf16 v[152:155], v[188:191], v[248:251], v[152:155]
  ds_read_b64_tr_b16 v[220:221], v23 offset:28672
  v_mfma_f32_16x16x32_bf16 v[156:159], v[188:191], v[252:255], v[156:159]
  ds_read_b64_tr_b16 v[222:223], v23 offset:29184
  s_waitcnt lgkmcnt(8)
  v_mfma_f32_16x16x32_bf16 v[96:99], v[192:195], v[240:243], v[96:99]
  ds_read_b64_tr_b16 v[160:161], v20 offset:32768
  buffer_load_dwordx4 v[228:231], v5, s[36:39], s50 offen offset:0
  v_mfma_f32_16x16x32_bf16 v[100:103], v[192:195], v[244:247], v[100:103]
  ds_read_b64_tr_b16 v[162:163], v20 offset:33280
  v_mfma_f32_16x16x32_bf16 v[104:107], v[196:199], v[240:243], v[104:107]
  ds_read_b64_tr_b16 v[164:165], v21 offset:32768
  v_mfma_f32_16x16x32_bf16 v[108:111], v[196:199], v[244:247], v[108:111]
  ds_read_b64_tr_b16 v[166:167], v21 offset:33280
  v_mfma_f32_16x16x32_bf16 v[112:115], v[200:203], v[240:243], v[112:115]
  ds_read_b64_tr_b16 v[168:169], v22 offset:32768
  v_mfma_f32_16x16x32_bf16 v[116:119], v[200:203], v[244:247], v[116:119]
  ds_read_b64_tr_b16 v[170:171], v22 offset:33280
  v_mfma_f32_16x16x32_bf16 v[120:123], v[204:207], v[240:243], v[120:123]
  ds_read_b64_tr_b16 v[172:173], v23 offset:32768
  v_mfma_f32_16x16x32_bf16 v[124:127], v[204:207], v[244:247], v[124:127]
  ds_read_b64_tr_b16 v[174:175], v23 offset:33280
  s_waitcnt lgkmcnt(8)
  s_barrier
  v_mfma_f32_16x16x32_bf16 v[96:99], v[208:211], v[248:251], v[96:99]
  ds_read_b64_tr_b16 v[176:177], v20 offset:36864
  buffer_load_dwordx4 v[232:235], v4, s[36:39], s50 offen offset:1024
  v_mfma_f32_16x16x32_bf16 v[100:103], v[208:211], v[252:255], v[100:103]
  ds_read_b64_tr_b16 v[178:179], v20 offset:37376
  v_mfma_f32_16x16x32_bf16 v[104:107], v[212:215], v[248:251], v[104:107]
  ds_read_b64_tr_b16 v[180:181], v21 offset:36864
  v_mfma_f32_16x16x32_bf16 v[108:111], v[212:215], v[252:255], v[108:111]
  ds_read_b64_tr_b16 v[182:183], v21 offset:37376
  v_mfma_f32_16x16x32_bf16 v[112:115], v[216:219], v[248:251], v[112:115]
  ds_read_b64_tr_b16 v[184:185], v22 offset:36864
  v_mfma_f32_16x16x32_bf16 v[116:119], v[216:219], v[252:255], v[116:119]
  ds_read_b64_tr_b16 v[186:187], v22 offset:37376
  v_mfma_f32_16x16x32_bf16 v[120:123], v[220:223], v[248:251], v[120:123]
  ds_read_b64_tr_b16 v[188:189], v23 offset:36864
  v_mfma_f32_16x16x32_bf16 v[124:127], v[220:223], v[252:255], v[124:127]
  ds_read_b64_tr_b16 v[190:191], v23 offset:37376
  s_waitcnt vmcnt(17) lgkmcnt(8)
  v_mfma_f32_16x16x32_bf16 v[128:131], v[160:163], v[32:35], v[128:131]
  ds_read_b64_tr_b16 v[192:193], v20 offset:40960
  buffer_load_dwordx4 v[236:239], v5, s[36:39], s50 offen offset:1024
  v_mfma_f32_16x16x32_bf16 v[132:135], v[160:163], v[36:39], v[132:135]
  ds_read_b64_tr_b16 v[194:195], v20 offset:41472
  v_mfma_f32_16x16x32_bf16 v[136:139], v[164:167], v[32:35], v[136:139]
  ds_read_b64_tr_b16 v[196:197], v21 offset:40960
  v_mfma_f32_16x16x32_bf16 v[140:143], v[164:167], v[36:39], v[140:143]
  ds_read_b64_tr_b16 v[198:199], v21 offset:41472
  v_mfma_f32_16x16x32_bf16 v[144:147], v[168:171], v[32:35], v[144:147]
  ds_read_b64_tr_b16 v[200:201], v22 offset:40960
  v_mfma_f32_16x16x32_bf16 v[148:151], v[168:171], v[36:39], v[148:151]
  ds_read_b64_tr_b16 v[202:203], v22 offset:41472
  v_readlane_b32 s51, v15, 11
  v_mfma_f32_16x16x32_bf16 v[152:155], v[172:175], v[32:35], v[152:155]
  ds_read_b64_tr_b16 v[204:205], v23 offset:40960
  v_mfma_f32_16x16x32_bf16 v[156:159], v[172:175], v[36:39], v[156:159]
  ds_read_b64_tr_b16 v[206:207], v23 offset:41472
  s_waitcnt vmcnt(16) lgkmcnt(8)
  v_mfma_f32_16x16x32_bf16 v[128:131], v[176:179], v[40:43], v[128:131]
  ds_read_b64_tr_b16 v[208:209], v20 offset:45056
  buffer_load_dwordx4 v[240:243], v4, s[36:39], s51 offen offset:0
  v_mfma_f32_16x16x32_bf16 v[132:135], v[176:179], v[44:47], v[132:135]
  ds_read_b64_tr_b16 v[210:211], v20 offset:45568
  v_mfma_f32_16x16x32_bf16 v[136:139], v[180:183], v[40:43], v[136:139]
  ds_read_b64_tr_b16 v[212:213], v21 offset:45056
  v_mfma_f32_16x16x32_bf16 v[140:143], v[180:183], v[44:47], v[140:143]
  ds_read_b64_tr_b16 v[214:215], v21 offset:45568
  v_mfma_f32_16x16x32_bf16 v[144:147], v[184:187], v[40:43], v[144:147]
  ds_read_b64_tr_b16 v[216:217], v22 offset:45056
  v_mfma_f32_16x16x32_bf16 v[148:151], v[184:187], v[44:47], v[148:151]
  ds_read_b64_tr_b16 v[218:219], v22 offset:45568
  v_mfma_f32_16x16x32_bf16 v[152:155], v[188:191], v[40:43], v[152:155]
  ds_read_b64_tr_b16 v[220:221], v23 offset:45056
  v_mfma_f32_16x16x32_bf16 v[156:159], v[188:191], v[44:47], v[156:159]
  ds_read_b64_tr_b16 v[222:223], v23 offset:45568
  s_waitcnt lgkmcnt(8)
  v_mfma_f32_16x16x32_bf16 v[96:99], v[192:195], v[32:35], v[96:99]
  ds_read_b64_tr_b16 v[160:161], v20 offset:49152
  buffer_load_dwordx4 v[244:247], v5, s[36:39], s51 offen offset:0
  v_mfma_f32_16x16x32_bf16 v[100:103], v[192:195], v[36:39], v[100:103]
  ds_read_b64_tr_b16 v[162:163], v20 offset:49664
  v_mfma_f32_16x16x32_bf16 v[104:107], v[196:199], v[32:35], v[104:107]
  ds_read_b64_tr_b16 v[164:165], v21 offset:49152
  v_mfma_f32_16x16x32_bf16 v[108:111], v[196:199], v[36:39], v[108:111]
  ds_read_b64_tr_b16 v[166:167], v21 offset:49664
  v_mfma_f32_16x16x32_bf16 v[112:115], v[200:203], v[32:35], v[112:115]
  ds_read_b64_tr_b16 v[168:169], v22 offset:49152
  v_mfma_f32_16x16x32_bf16 v[116:119], v[200:203], v[36:39], v[116:119]
  ds_read_b64_tr_b16 v[170:171], v22 offset:49664
  v_mfma_f32_16x16x32_bf16 v[120:123], v[204:207], v[32:35], v[120:123]
  ds_read_b64_tr_b16 v[172:173], v23 offset:49152
  v_mfma_f32_16x16x32_bf16 v[124:127], v[204:207], v[36:39], v[124:127]
  ds_read_b64_tr_b16 v[174:175], v23 offset:49664
  s_waitcnt lgkmcnt(8)
  v_mfma_f32_16x16x32_bf16 v[96:99], v[208:211], v[40:43], v[96:99]
  ds_read_b64_tr_b16 v[176:177], v20 offset:53248
  buffer_load_dwordx4 v[248:251], v4, s[36:39], s51 offen offset:1024
  v_mfma_f32_16x16x32_bf16 v[100:103], v[208:211], v[44:47], v[100:103]
  ds_read_b64_tr_b16 v[178:179], v20 offset:53760
  v_mfma_f32_16x16x32_bf16 v[104:107], v[212:215], v[40:43], v[104:107]
  ds_read_b64_tr_b16 v[180:181], v21 offset:53248
  v_mfma_f32_16x16x32_bf16 v[108:111], v[212:215], v[44:47], v[108:111]
  ds_read_b64_tr_b16 v[182:183], v21 offset:53760
  v_mfma_f32_16x16x32_bf16 v[112:115], v[216:219], v[40:43], v[112:115]
  ds_read_b64_tr_b16 v[184:185], v22 offset:53248
  v_mfma_f32_16x16x32_bf16 v[116:119], v[216:219], v[44:47], v[116:119]
  ds_read_b64_tr_b16 v[186:187], v22 offset:53760
  v_mfma_f32_16x16x32_bf16 v[120:123], v[220:223], v[40:43], v[120:123]
  ds_read_b64_tr_b16 v[188:189], v23 offset:53248
  v_mfma_f32_16x16x32_bf16 v[124:127], v[220:223], v[44:47], v[124:127]
  ds_read_b64_tr_b16 v[190:191], v23 offset:53760
  s_waitcnt vmcnt(17) lgkmcnt(8)
  v_mfma_f32_16x16x32_bf16 v[128:131], v[160:163], v[48:51], v[128:131]
  ds_read_b64_tr_b16 v[192:193], v20 offset:57344
  buffer_load_dwordx4 v[252:255], v5, s[36:39], s51 offen offset:1024
  v_mfma_f32_16x16x32_bf16 v[132:135], v[160:163], v[52:55], v[132:135]
  ds_read_b64_tr_b16 v[194:195], v20 offset:57856
  v_mfma_f32_16x16x32_bf16 v[136:139], v[164:167], v[48:51], v[136:139]
  ds_read_b64_tr_b16 v[196:197], v21 offset:57344
  v_mfma_f32_16x16x32_bf16 v[140:143], v[164:167], v[52:55], v[140:143]
  ds_read_b64_tr_b16 v[198:199], v21 offset:57856
  v_mfma_f32_16x16x32_bf16 v[144:147], v[168:171], v[48:51], v[144:147]
  ds_read_b64_tr_b16 v[200:201], v22 offset:57344
  v_mfma_f32_16x16x32_bf16 v[148:151], v[168:171], v[52:55], v[148:151]
  ds_read_b64_tr_b16 v[202:203], v22 offset:57856
  v_readlane_b32 s48, v15, 12
  v_mfma_f32_16x16x32_bf16 v[152:155], v[172:175], v[48:51], v[152:155]
  ds_read_b64_tr_b16 v[204:205], v23 offset:57344
  v_mfma_f32_16x16x32_bf16 v[156:159], v[172:175], v[52:55], v[156:159]
  ds_read_b64_tr_b16 v[206:207], v23 offset:57856
  s_waitcnt vmcnt(16) lgkmcnt(8)
  v_mfma_f32_16x16x32_bf16 v[128:131], v[176:179], v[56:59], v[128:131]
  ds_read_b64_tr_b16 v[208:209], v20 offset:61440
  buffer_load_dwordx4 v[32:35], v4, s[36:39], s48 offen offset:0
  v_mfma_f32_16x16x32_bf16 v[132:135], v[176:179], v[60:63], v[132:135]
  ds_read_b64_tr_b16 v[210:211], v20 offset:61952
  v_mfma_f32_16x16x32_bf16 v[136:139], v[180:183], v[56:59], v[136:139]
  ds_read_b64_tr_b16 v[212:213], v21 offset:61440
  v_mfma_f32_16x16x32_bf16 v[140:143], v[180:183], v[60:63], v[140:143]
  ds_read_b64_tr_b16 v[214:215], v21 offset:61952
  v_mfma_f32_16x16x32_bf16 v[144:147], v[184:187], v[56:59], v[144:147]
  ds_read_b64_tr_b16 v[216:217], v22 offset:61440
  v_mfma_f32_16x16x32_bf16 v[148:151], v[184:187], v[60:63], v[148:151]
  ds_read_b64_tr_b16 v[218:219], v22 offset:61952
  v_mfma_f32_16x16x32_bf16 v[152:155], v[188:191], v[56:59], v[152:155]
  ds_read_b64_tr_b16 v[220:221], v23 offset:61440
  v_mfma_f32_16x16x32_bf16 v[156:159], v[188:191], v[60:63], v[156:159]
  ds_read_b64_tr_b16 v[222:223], v23 offset:61952
  s_waitcnt lgkmcnt(8)
  v_mfma_f32_16x16x32_bf16 v[96:99], v[192:195], v[48:51], v[96:99]
  ds_read_b64_tr_b16 v[160:161], v26 offset:0
  buffer_load_dwordx4 v[36:39], v5, s[36:39], s48 offen offset:0
  v_mfma_f32_16x16x32_bf16 v[100:103], v[192:195], v[52:55], v[100:103]
  ds_read_b64_tr_b16 v[162:163], v26 offset:512
  v_mfma_f32_16x16x32_bf16 v[104:107], v[196:199], v[48:51], v[104:107]
  ds_read_b64_tr_b16 v[164:165], v27 offset:0
  v_mfma_f32_16x16x32_bf16 v[108:111], v[196:199], v[52:55], v[108:111]
  ds_read_b64_tr_b16 v[166:167], v27 offset:512
  v_mfma_f32_16x16x32_bf16 v[112:115], v[200:203], v[48:51], v[112:115]
  ds_read_b64_tr_b16 v[168:169], v28 offset:0
  v_mfma_f32_16x16x32_bf16 v[116:119], v[200:203], v[52:55], v[116:119]
  ds_read_b64_tr_b16 v[170:171], v28 offset:512
  v_mfma_f32_16x16x32_bf16 v[120:123], v[204:207], v[48:51], v[120:123]
  ds_read_b64_tr_b16 v[172:173], v29 offset:0
  v_mfma_f32_16x16x32_bf16 v[124:127], v[204:207], v[52:55], v[124:127]
  ds_read_b64_tr_b16 v[174:175], v29 offset:512
  s_waitcnt lgkmcnt(8)
  s_barrier
  v_mfma_f32_16x16x32_bf16 v[96:99], v[208:211], v[56:59], v[96:99]
  ds_read_b64_tr_b16 v[176:177], v26 offset:4096
  buffer_load_dwordx4 v[40:43], v4, s[36:39], s48 offen offset:1024
  v_mfma_f32_16x16x32_bf16 v[100:103], v[208:211], v[60:63], v[100:103]
  ds_read_b64_tr_b16 v[178:179], v26 offset:4608
  v_mfma_f32_16x16x32_bf16 v[104:107], v[212:215], v[56:59], v[104:107]
  ds_read_b64_tr_b16 v[180:181], v27 offset:4096
  v_mfma_f32_16x16x32_bf16 v[108:111], v[212:215], v[60:63], v[108:111]
  ds_read_b64_tr_b16 v[182:183], v27 offset:4608
  v_mfma_f32_16x16x32_bf16 v[112:115], v[216:219], v[56:59], v[112:115]
  ds_read_b64_tr_b16 v[184:185], v28 offset:4096
  v_mfma_f32_16x16x32_bf16 v[116:119], v[216:219], v[60:63], v[116:119]
  ds_read_b64_tr_b16 v[186:187], v28 offset:4608
  v_mfma_f32_16x16x32_bf16 v[120:123], v[220:223], v[56:59], v[120:123]
  ds_read_b64_tr_b16 v[188:189], v29 offset:4096
  v_mfma_f32_16x16x32_bf16 v[124:127], v[220:223], v[60:63], v[124:127]
  ds_read_b64_tr_b16 v[190:191], v29 offset:4608
  s_waitcnt vmcnt(17) lgkmcnt(8)
  v_mfma_f32_16x16x32_bf16 v[128:131], v[160:163], v[64:67], v[128:131]
  ds_read_b64_tr_b16 v[192:193], v26 offset:8192
  buffer_load_dwordx4 v[44:47], v5, s[36:39], s48 offen offset:1024
  v_mfma_f32_16x16x32_bf16 v[132:135], v[160:163], v[68:71], v[132:135]
  ds_read_b64_tr_b16 v[194:195], v26 offset:8704
  v_mfma_f32_16x16x32_bf16 v[136:139], v[164:167], v[64:67], v[136:139]
  ds_read_b64_tr_b16 v[196:197], v27 offset:8192
  v_mfma_f32_16x16x32_bf16 v[140:143], v[164:167], v[68:71], v[140:143]
  ds_read_b64_tr_b16 v[198:199], v27 offset:8704
  v_mfma_f32_16x16x32_bf16 v[144:147], v[168:171], v[64:67], v[144:147]
  ds_read_b64_tr_b16 v[200:201], v28 offset:8192
  v_mfma_f32_16x16x32_bf16 v[148:151], v[168:171], v[68:71], v[148:151]
  ds_read_b64_tr_b16 v[202:203], v28 offset:8704
  v_readlane_b32 s49, v15, 13
  v_mfma_f32_16x16x32_bf16 v[152:155], v[172:175], v[64:67], v[152:155]
  ds_read_b64_tr_b16 v[204:205], v29 offset:8192
  v_mfma_f32_16x16x32_bf16 v[156:159], v[172:175], v[68:71], v[156:159]
  ds_read_b64_tr_b16 v[206:207], v29 offset:8704
  s_waitcnt vmcnt(16) lgkmcnt(8)
  v_mfma_f32_16x16x32_bf16 v[128:131], v[176:179], v[72:75], v[128:131]
  ds_read_b64_tr_b16 v[208:209], v26 offset:12288
  buffer_load_dwordx4 v[48:51], v4, s[36:39], s49 offen offset:0
  v_mfma_f32_16x16x32_bf16 v[132:135], v[176:179], v[76:79], v[132:135]
  ds_read_b64_tr_b16 v[210:211], v26 offset:12800
  v_mfma_f32_16x16x32_bf16 v[136:139], v[180:183], v[72:75], v[136:139]
  ds_read_b64_tr_b16 v[212:213], v27 offset:12288
  v_mfma_f32_16x16x32_bf16 v[140:143], v[180:183], v[76:79], v[140:143]
  ds_read_b64_tr_b16 v[214:215], v27 offset:12800
  v_mfma_f32_16x16x32_bf16 v[144:147], v[184:187], v[72:75], v[144:147]
  ds_read_b64_tr_b16 v[216:217], v28 offset:12288
  v_mfma_f32_16x16x32_bf16 v[148:151], v[184:187], v[76:79], v[148:151]
  ds_read_b64_tr_b16 v[218:219], v28 offset:12800
  v_mfma_f32_16x16x32_bf16 v[152:155], v[188:191], v[72:75], v[152:155]
  ds_read_b64_tr_b16 v[220:221], v29 offset:12288
  v_mfma_f32_16x16x32_bf16 v[156:159], v[188:191], v[76:79], v[156:159]
  ds_read_b64_tr_b16 v[222:223], v29 offset:12800
  s_waitcnt lgkmcnt(8)
  v_mfma_f32_16x16x32_bf16 v[96:99], v[192:195], v[64:67], v[96:99]
  ds_read_b64_tr_b16 v[160:161], v26 offset:16384
  buffer_load_dwordx4 v[52:55], v5, s[36:39], s49 offen offset:0
  v_mfma_f32_16x16x32_bf16 v[100:103], v[192:195], v[68:71], v[100:103]
  ds_read_b64_tr_b16 v[162:163], v26 offset:16896
  v_mfma_f32_16x16x32_bf16 v[104:107], v[196:199], v[64:67], v[104:107]
  ds_read_b64_tr_b16 v[164:165], v27 offset:16384
  v_mfma_f32_16x16x32_bf16 v[108:111], v[196:199], v[68:71], v[108:111]
  ds_read_b64_tr_b16 v[166:167], v27 offset:16896
  v_mfma_f32_16x16x32_bf16 v[112:115], v[200:203], v[64:67], v[112:115]
  ds_read_b64_tr_b16 v[168:169], v28 offset:16384
  v_mfma_f32_16x16x32_bf16 v[116:119], v[200:203], v[68:71], v[116:119]
  ds_read_b64_tr_b16 v[170:171], v28 offset:16896
  v_mfma_f32_16x16x32_bf16 v[120:123], v[204:207], v[64:67], v[120:123]
  ds_read_b64_tr_b16 v[172:173], v29 offset:16384
  v_mfma_f32_16x16x32_bf16 v[124:127], v[204:207], v[68:71], v[124:127]
  ds_read_b64_tr_b16 v[174:175], v29 offset:16896
  s_waitcnt lgkmcnt(8)
  v_mfma_f32_16x16x32_bf16 v[96:99], v[208:211], v[72:75], v[96:99]
  ds_read_b64_tr_b16 v[176:177], v26 offset:20480
  buffer_load_dwordx4 v[56:59], v4, s[36:39], s49 offen offset:1024
  v_mfma_f32_16x16x32_bf16 v[100:103], v[208:211], v[76:79], v[100:103]
  ds_read_b64_tr_b16 v[178:179], v26 offset:20992
  v_mfma_f32_16x16x32_bf16 v[104:107], v[212:215], v[72:75], v[104:107]
  ds_read_b64_tr_b16 v[180:181], v27 offset:20480
  v_mfma_f32_16x16x32_bf16 v[108:111], v[212:215], v[76:79], v[108:111]
  ds_read_b64_tr_b16 v[182:183], v27 offset:20992
  v_mfma_f32_16x16x32_bf16 v[112:115], v[216:219], v[72:75], v[112:115]
  ds_read_b64_tr_b16 v[184:185], v28 offset:20480
  v_mfma_f32_16x16x32_bf16 v[116:119], v[216:219], v[76:79], v[116:119]
  ds_read_b64_tr_b16 v[186:187], v28 offset:20992
  v_mfma_f32_16x16x32_bf16 v[120:123], v[220:223], v[72:75], v[120:123]
  ds_read_b64_tr_b16 v[188:189], v29 offset:20480
  v_mfma_f32_16x16x32_bf16 v[124:127], v[220:223], v[76:79], v[124:127]
  ds_read_b64_tr_b16 v[190:191], v29 offset:20992
  s_waitcnt vmcnt(17) lgkmcnt(8)
  v_mfma_f32_16x16x32_bf16 v[128:131], v[160:163], v[80:83], v[128:131]
  ds_read_b64_tr_b16 v[192:193], v26 offset:24576
  buffer_load_dwordx4 v[60:63], v5, s[36:39], s49 offen offset:1024
  v_mfma_f32_16x16x32_bf16 v[132:135], v[160:163], v[84:87], v[132:135]
  ds_read_b64_tr_b16 v[194:195], v26 offset:25088
  v_mfma_f32_16x16x32_bf16 v[136:139], v[164:167], v[80:83], v[136:139]
  ds_read_b64_tr_b16 v[196:197], v27 offset:24576
  v_mfma_f32_16x16x32_bf16 v[140:143], v[164:167], v[84:87], v[140:143]
  ds_read_b64_tr_b16 v[198:199], v27 offset:25088
  v_mfma_f32_16x16x32_bf16 v[144:147], v[168:171], v[80:83], v[144:147]
  ds_read_b64_tr_b16 v[200:201], v28 offset:24576
  v_mfma_f32_16x16x32_bf16 v[148:151], v[168:171], v[84:87], v[148:151]
  ds_read_b64_tr_b16 v[202:203], v28 offset:25088
  v_readlane_b32 s50, v15, 14
  v_mfma_f32_16x16x32_bf16 v[152:155], v[172:175], v[80:83], v[152:155]
  ds_read_b64_tr_b16 v[204:205], v29 offset:24576
  v_mfma_f32_16x16x32_bf16 v[156:159], v[172:175], v[84:87], v[156:159]
  ds_read_b64_tr_b16 v[206:207], v29 offset:25088
  s_waitcnt vmcnt(16) lgkmcnt(8)
  v_mfma_f32_16x16x32_bf16 v[128:131], v[176:179], v[88:91], v[128:131]
  ds_read_b64_tr_b16 v[208:209], v26 offset:28672
  buffer_load_dwordx4 v[64:67], v4, s[36:39], s50 offen offset:0
  v_mfma_f32_16x16x32_bf16 v[132:135], v[176:179], v[92:95], v[132:135]
  ds_read_b64_tr_b16 v[210:211], v26 offset:29184
  v_mfma_f32_16x16x32_bf16 v[136:139], v[180:183], v[88:91], v[136:139]
  ds_read_b64_tr_b16 v[212:213], v27 offset:28672
  v_mfma_f32_16x16x32_bf16 v[140:143], v[180:183], v[92:95], v[140:143]
  ds_read_b64_tr_b16 v[214:215], v27 offset:29184
  v_mfma_f32_16x16x32_bf16 v[144:147], v[184:187], v[88:91], v[144:147]
  ds_read_b64_tr_b16 v[216:217], v28 offset:28672
  v_mfma_f32_16x16x32_bf16 v[148:151], v[184:187], v[92:95], v[148:151]
  ds_read_b64_tr_b16 v[218:219], v28 offset:29184
  v_mfma_f32_16x16x32_bf16 v[152:155], v[188:191], v[88:91], v[152:155]
  ds_read_b64_tr_b16 v[220:221], v29 offset:28672
  v_mfma_f32_16x16x32_bf16 v[156:159], v[188:191], v[92:95], v[156:159]
  ds_read_b64_tr_b16 v[222:223], v29 offset:29184
  s_waitcnt lgkmcnt(8)
  v_mfma_f32_16x16x32_bf16 v[96:99], v[192:195], v[80:83], v[96:99]
  ds_read_b64_tr_b16 v[160:161], v6 offset:0
  buffer_load_dwordx4 v[68:71], v5, s[36:39], s50 offen offset:0
  v_mfma_f32_16x16x32_bf16 v[100:103], v[192:195], v[84:87], v[100:103]
  ds_read_b64_tr_b16 v[162:163], v6 offset:512
  v_mfma_f32_16x16x32_bf16 v[104:107], v[196:199], v[80:83], v[104:107]
  ds_read_b64_tr_b16 v[164:165], v7 offset:0
  v_mfma_f32_16x16x32_bf16 v[108:111], v[196:199], v[84:87], v[108:111]
  ds_read_b64_tr_b16 v[166:167], v7 offset:512
  v_mfma_f32_16x16x32_bf16 v[112:115], v[200:203], v[80:83], v[112:115]
  ds_read_b64_tr_b16 v[168:169], v8 offset:0
  v_mfma_f32_16x16x32_bf16 v[116:119], v[200:203], v[84:87], v[116:119]
  ds_read_b64_tr_b16 v[170:171], v8 offset:512
  v_mfma_f32_16x16x32_bf16 v[120:123], v[204:207], v[80:83], v[120:123]
  ds_read_b64_tr_b16 v[172:173], v9 offset:0
  v_mfma_f32_16x16x32_bf16 v[124:127], v[204:207], v[84:87], v[124:127]
  ds_read_b64_tr_b16 v[174:175], v9 offset:512
  s_waitcnt lgkmcnt(8)
  s_barrier
  v_mfma_f32_16x16x32_bf16 v[96:99], v[208:211], v[88:91], v[96:99]
  ds_read_b64_tr_b16 v[176:177], v6 offset:4096
  buffer_load_dwordx4 v[72:75], v4, s[36:39], s50 offen offset:1024
  v_mfma_f32_16x16x32_bf16 v[100:103], v[208:211], v[92:95], v[100:103]
  ds_read_b64_tr_b16 v[178:179], v6 offset:4608
  v_mfma_f32_16x16x32_bf16 v[104:107], v[212:215], v[88:91], v[104:107]
  ds_read_b64_tr_b16 v[180:181], v7 offset:4096
  v_mfma_f32_16x16x32_bf16 v[108:111], v[212:215], v[92:95], v[108:111]
  ds_read_b64_tr_b16 v[182:183], v7 offset:4608
  v_mfma_f32_16x16x32_bf16 v[112:115], v[216:219], v[88:91], v[112:115]
  ds_read_b64_tr_b16 v[184:185], v8 offset:4096
  v_mfma_f32_16x16x32_bf16 v[116:119], v[216:219], v[92:95], v[116:119]
  ds_read_b64_tr_b16 v[186:187], v8 offset:4608
  v_mfma_f32_16x16x32_bf16 v[120:123], v[220:223], v[88:91], v[120:123]
  ds_read_b64_tr_b16 v[188:189], v9 offset:4096
  v_mfma_f32_16x16x32_bf16 v[124:127], v[220:223], v[92:95], v[124:127]
  ds_read_b64_tr_b16 v[190:191], v9 offset:4608
  s_waitcnt vmcnt(17) lgkmcnt(8)
  v_mfma_f32_16x16x32_bf16 v[128:131], v[160:163], v[224:227], v[128:131]
  ds_read_b64_tr_b16 v[192:193], v6 offset:8192
  buffer_load_dwordx4 v[76:79], v5, s[36:39], s50 offen offset:1024
  v_mfma_f32_16x16x32_bf16 v[132:135], v[160:163], v[228:231], v[132:135]
  ds_read_b64_tr_b16 v[194:195], v6 offset:8704
  v_mfma_f32_16x16x32_bf16 v[136:139], v[164:167], v[224:227], v[136:139]
  ds_read_b64_tr_b16 v[196:197], v7 offset:8192
  v_mfma_f32_16x16x32_bf16 v[140:143], v[164:167], v[228:231], v[140:143]
  ds_read_b64_tr_b16 v[198:199], v7 offset:8704
  v_mfma_f32_16x16x32_bf16 v[144:147], v[168:171], v[224:227], v[144:147]
  ds_read_b64_tr_b16 v[200:201], v8 offset:8192
  v_mfma_f32_16x16x32_bf16 v[148:151], v[168:171], v[228:231], v[148:151]
  ds_read_b64_tr_b16 v[202:203], v8 offset:8704
  v_readlane_b32 s51, v15, 15
  v_mfma_f32_16x16x32_bf16 v[152:155], v[172:175], v[224:227], v[152:155]
  ds_read_b64_tr_b16 v[204:205], v9 offset:8192
  v_mfma_f32_16x16x32_bf16 v[156:159], v[172:175], v[228:231], v[156:159]
  ds_read_b64_tr_b16 v[206:207], v9 offset:8704
  s_waitcnt vmcnt(16) lgkmcnt(8)
  v_mfma_f32_16x16x32_bf16 v[128:131], v[176:179], v[232:235], v[128:131]
  ds_read_b64_tr_b16 v[208:209], v6 offset:12288
  buffer_load_dwordx4 v[80:83], v4, s[36:39], s51 offen offset:0
  v_mfma_f32_16x16x32_bf16 v[132:135], v[176:179], v[236:239], v[132:135]
  ds_read_b64_tr_b16 v[210:211], v6 offset:12800
  v_mfma_f32_16x16x32_bf16 v[136:139], v[180:183], v[232:235], v[136:139]
  ds_read_b64_tr_b16 v[212:213], v7 offset:12288
  v_mfma_f32_16x16x32_bf16 v[140:143], v[180:183], v[236:239], v[140:143]
  ds_read_b64_tr_b16 v[214:215], v7 offset:12800
  v_mfma_f32_16x16x32_bf16 v[144:147], v[184:187], v[232:235], v[144:147]
  ds_read_b64_tr_b16 v[216:217], v8 offset:12288
  v_mfma_f32_16x16x32_bf16 v[148:151], v[184:187], v[236:239], v[148:151]
  ds_read_b64_tr_b16 v[218:219], v8 offset:12800
  v_mfma_f32_16x16x32_bf16 v[152:155], v[188:191], v[232:235], v[152:155]
  ds_read_b64_tr_b16 v[220:221], v9 offset:12288
  v_mfma_f32_16x16x32_bf16 v[156:159], v[188:191], v[236:239], v[156:159]
  ds_read_b64_tr_b16 v[222:223], v9 offset:12800
  s_waitcnt lgkmcnt(8)
  v_mfma_f32_16x16x32_bf16 v[96:99], v[192:195], v[224:227], v[96:99]
  ds_read_b64_tr_b16 v[160:161], v6 offset:16384
  buffer_load_dwordx4 v[84:87], v5, s[36:39], s51 offen offset:0
  v_mfma_f32_16x16x32_bf16 v[100:103], v[192:195], v[228:231], v[100:103]
  ds_read_b64_tr_b16 v[162:163], v6 offset:16896
  v_mfma_f32_16x16x32_bf16 v[104:107], v[196:199], v[224:227], v[104:107]
  ds_read_b64_tr_b16 v[164:165], v7 offset:16384
  v_mfma_f32_16x16x32_bf16 v[108:111], v[196:199], v[228:231], v[108:111]
  ds_read_b64_tr_b16 v[166:167], v7 offset:16896
  v_mfma_f32_16x16x32_bf16 v[112:115], v[200:203], v[224:227], v[112:115]
  ds_read_b64_tr_b16 v[168:169], v8 offset:16384
  v_mfma_f32_16x16x32_bf16 v[116:119], v[200:203], v[228:231], v[116:119]
  ds_read_b64_tr_b16 v[170:171], v8 offset:16896
  v_mfma_f32_16x16x32_bf16 v[120:123], v[204:207], v[224:227], v[120:123]
  ds_read_b64_tr_b16 v[172:173], v9 offset:16384
  v_mfma_f32_16x16x32_bf16 v[124:127], v[204:207], v[228:231], v[124:127]
  ds_read_b64_tr_b16 v[174:175], v9 offset:16896
  s_waitcnt lgkmcnt(8)
  v_mfma_f32_16x16x32_bf16 v[96:99], v[208:211], v[232:235], v[96:99]
  ds_read_b64_tr_b16 v[176:177], v6 offset:20480
  buffer_load_dwordx4 v[88:91], v4, s[36:39], s51 offen offset:1024
  v_mfma_f32_16x16x32_bf16 v[100:103], v[208:211], v[236:239], v[100:103]
  ds_read_b64_tr_b16 v[178:179], v6 offset:20992
  v_mfma_f32_16x16x32_bf16 v[104:107], v[212:215], v[232:235], v[104:107]
  ds_read_b64_tr_b16 v[180:181], v7 offset:20480
  v_mfma_f32_16x16x32_bf16 v[108:111], v[212:215], v[236:239], v[108:111]
  ds_read_b64_tr_b16 v[182:183], v7 offset:20992
  v_mfma_f32_16x16x32_bf16 v[112:115], v[216:219], v[232:235], v[112:115]
  ds_read_b64_tr_b16 v[184:185], v8 offset:20480
  v_mfma_f32_16x16x32_bf16 v[116:119], v[216:219], v[236:239], v[116:119]
  ds_read_b64_tr_b16 v[186:187], v8 offset:20992
  v_mfma_f32_16x16x32_bf16 v[120:123], v[220:223], v[232:235], v[120:123]
  ds_read_b64_tr_b16 v[188:189], v9 offset:20480
  v_mfma_f32_16x16x32_bf16 v[124:127], v[220:223], v[236:239], v[124:127]
  ds_read_b64_tr_b16 v[190:191], v9 offset:20992
  s_waitcnt vmcnt(17) lgkmcnt(8)
  v_mfma_f32_16x16x32_bf16 v[128:131], v[160:163], v[240:243], v[128:131]
  ds_read_b64_tr_b16 v[192:193], v6 offset:24576
  buffer_load_dwordx4 v[92:95], v5, s[36:39], s51 offen offset:1024
  v_mfma_f32_16x16x32_bf16 v[132:135], v[160:163], v[244:247], v[132:135]
  ds_read_b64_tr_b16 v[194:195], v6 offset:25088
  v_mfma_f32_16x16x32_bf16 v[136:139], v[164:167], v[240:243], v[136:139]
  ds_read_b64_tr_b16 v[196:197], v7 offset:24576
  v_mfma_f32_16x16x32_bf16 v[140:143], v[164:167], v[244:247], v[140:143]
  ds_read_b64_tr_b16 v[198:199], v7 offset:25088
  v_mfma_f32_16x16x32_bf16 v[144:147], v[168:171], v[240:243], v[144:147]
  ds_read_b64_tr_b16 v[200:201], v8 offset:24576
  v_mfma_f32_16x16x32_bf16 v[148:151], v[168:171], v[244:247], v[148:151]
  ds_read_b64_tr_b16 v[202:203], v8 offset:25088
  v_readlane_b32 s48, v15, 16
  v_mfma_f32_16x16x32_bf16 v[152:155], v[172:175], v[240:243], v[152:155]
  ds_read_b64_tr_b16 v[204:205], v9 offset:24576
  v_mfma_f32_16x16x32_bf16 v[156:159], v[172:175], v[244:247], v[156:159]
  ds_read_b64_tr_b16 v[206:207], v9 offset:25088
  s_waitcnt vmcnt(16) lgkmcnt(8)
  v_mfma_f32_16x16x32_bf16 v[128:131], v[176:179], v[248:251], v[128:131]
  ds_read_b64_tr_b16 v[208:209], v6 offset:28672
  buffer_load_dwordx4 v[224:227], v4, s[36:39], s48 offen offset:0
  v_mfma_f32_16x16x32_bf16 v[132:135], v[176:179], v[252:255], v[132:135]
  ds_read_b64_tr_b16 v[210:211], v6 offset:29184
  v_mfma_f32_16x16x32_bf16 v[136:139], v[180:183], v[248:251], v[136:139]
  ds_read_b64_tr_b16 v[212:213], v7 offset:28672
  v_mfma_f32_16x16x32_bf16 v[140:143], v[180:183], v[252:255], v[140:143]
  ds_read_b64_tr_b16 v[214:215], v7 offset:29184
  v_mfma_f32_16x16x32_bf16 v[144:147], v[184:187], v[248:251], v[144:147]
  ds_read_b64_tr_b16 v[216:217], v8 offset:28672
  v_mfma_f32_16x16x32_bf16 v[148:151], v[184:187], v[252:255], v[148:151]
  ds_read_b64_tr_b16 v[218:219], v8 offset:29184
  v_mfma_f32_16x16x32_bf16 v[152:155], v[188:191], v[248:251], v[152:155]
  ds_read_b64_tr_b16 v[220:221], v9 offset:28672
  v_mfma_f32_16x16x32_bf16 v[156:159], v[188:191], v[252:255], v[156:159]
  ds_read_b64_tr_b16 v[222:223], v9 offset:29184
  s_waitcnt lgkmcnt(8)
  v_mfma_f32_16x16x32_bf16 v[96:99], v[192:195], v[240:243], v[96:99]
  ds_read_b64_tr_b16 v[160:161], v6 offset:32768
  buffer_load_dwordx4 v[228:231], v5, s[36:39], s48 offen offset:0
  v_mfma_f32_16x16x32_bf16 v[100:103], v[192:195], v[244:247], v[100:103]
  ds_read_b64_tr_b16 v[162:163], v6 offset:33280
  v_mfma_f32_16x16x32_bf16 v[104:107], v[196:199], v[240:243], v[104:107]
  ds_read_b64_tr_b16 v[164:165], v7 offset:32768
  v_mfma_f32_16x16x32_bf16 v[108:111], v[196:199], v[244:247], v[108:111]
  ds_read_b64_tr_b16 v[166:167], v7 offset:33280
  v_mfma_f32_16x16x32_bf16 v[112:115], v[200:203], v[240:243], v[112:115]
  ds_read_b64_tr_b16 v[168:169], v8 offset:32768
  v_mfma_f32_16x16x32_bf16 v[116:119], v[200:203], v[244:247], v[116:119]
  ds_read_b64_tr_b16 v[170:171], v8 offset:33280
  v_mfma_f32_16x16x32_bf16 v[120:123], v[204:207], v[240:243], v[120:123]
  ds_read_b64_tr_b16 v[172:173], v9 offset:32768
  v_mfma_f32_16x16x32_bf16 v[124:127], v[204:207], v[244:247], v[124:127]
  ds_read_b64_tr_b16 v[174:175], v9 offset:33280
  s_waitcnt lgkmcnt(8)
  s_barrier
  v_mfma_f32_16x16x32_bf16 v[96:99], v[208:211], v[248:251], v[96:99]
  ds_read_b64_tr_b16 v[176:177], v6 offset:36864
  buffer_load_dwordx4 v[232:235], v4, s[36:39], s48 offen offset:1024
  v_mfma_f32_16x16x32_bf16 v[100:103], v[208:211], v[252:255], v[100:103]
  ds_read_b64_tr_b16 v[178:179], v6 offset:37376
  v_mfma_f32_16x16x32_bf16 v[104:107], v[212:215], v[248:251], v[104:107]
  ds_read_b64_tr_b16 v[180:181], v7 offset:36864
  v_mfma_f32_16x16x32_bf16 v[108:111], v[212:215], v[252:255], v[108:111]
  ds_read_b64_tr_b16 v[182:183], v7 offset:37376
  v_mfma_f32_16x16x32_bf16 v[112:115], v[216:219], v[248:251], v[112:115]
  ds_read_b64_tr_b16 v[184:185], v8 offset:36864
  v_mfma_f32_16x16x32_bf16 v[116:119], v[216:219], v[252:255], v[116:119]
  ds_read_b64_tr_b16 v[186:187], v8 offset:37376
  v_mfma_f32_16x16x32_bf16 v[120:123], v[220:223], v[248:251], v[120:123]
  ds_read_b64_tr_b16 v[188:189], v9 offset:36864
  v_mfma_f32_16x16x32_bf16 v[124:127], v[220:223], v[252:255], v[124:127]
  ds_read_b64_tr_b16 v[190:191], v9 offset:37376
  s_waitcnt vmcnt(17) lgkmcnt(8)
  v_mfma_f32_16x16x32_bf16 v[128:131], v[160:163], v[32:35], v[128:131]
  ds_read_b64_tr_b16 v[192:193], v6 offset:40960
  buffer_load_dwordx4 v[236:239], v5, s[36:39], s48 offen offset:1024
  v_mfma_f32_16x16x32_bf16 v[132:135], v[160:163], v[36:39], v[132:135]
  ds_read_b64_tr_b16 v[194:195], v6 offset:41472
  v_mfma_f32_16x16x32_bf16 v[136:139], v[164:167], v[32:35], v[136:139]
  ds_read_b64_tr_b16 v[196:197], v7 offset:40960
  v_mfma_f32_16x16x32_bf16 v[140:143], v[164:167], v[36:39], v[140:143]
  ds_read_b64_tr_b16 v[198:199], v7 offset:41472
  v_mfma_f32_16x16x32_bf16 v[144:147], v[168:171], v[32:35], v[144:147]
  ds_read_b64_tr_b16 v[200:201], v8 offset:40960
  v_mfma_f32_16x16x32_bf16 v[148:151], v[168:171], v[36:39], v[148:151]
  ds_read_b64_tr_b16 v[202:203], v8 offset:41472
  v_readlane_b32 s49, v15, 17
  v_mfma_f32_16x16x32_bf16 v[152:155], v[172:175], v[32:35], v[152:155]
  ds_read_b64_tr_b16 v[204:205], v9 offset:40960
  v_mfma_f32_16x16x32_bf16 v[156:159], v[172:175], v[36:39], v[156:159]
  ds_read_b64_tr_b16 v[206:207], v9 offset:41472
  s_waitcnt vmcnt(16) lgkmcnt(8)
  v_mfma_f32_16x16x32_bf16 v[128:131], v[176:179], v[40:43], v[128:131]
  ds_read_b64_tr_b16 v[208:209], v6 offset:45056
  buffer_load_dwordx4 v[240:243], v4, s[36:39], s49 offen offset:0
  v_mfma_f32_16x16x32_bf16 v[132:135], v[176:179], v[44:47], v[132:135]
  ds_read_b64_tr_b16 v[210:211], v6 offset:45568
  v_mfma_f32_16x16x32_bf16 v[136:139], v[180:183], v[40:43], v[136:139]
  ds_read_b64_tr_b16 v[212:213], v7 offset:45056
  v_mfma_f32_16x16x32_bf16 v[140:143], v[180:183], v[44:47], v[140:143]
  ds_read_b64_tr_b16 v[214:215], v7 offset:45568
  v_mfma_f32_16x16x32_bf16 v[144:147], v[184:187], v[40:43], v[144:147]
  ds_read_b64_tr_b16 v[216:217], v8 offset:45056
  v_mfma_f32_16x16x32_bf16 v[148:151], v[184:187], v[44:47], v[148:151]
  ds_read_b64_tr_b16 v[218:219], v8 offset:45568
  v_mfma_f32_16x16x32_bf16 v[152:155], v[188:191], v[40:43], v[152:155]
  ds_read_b64_tr_b16 v[220:221], v9 offset:45056
  v_mfma_f32_16x16x32_bf16 v[156:159], v[188:191], v[44:47], v[156:159]
  ds_read_b64_tr_b16 v[222:223], v9 offset:45568
  s_waitcnt lgkmcnt(8)
  v_mfma_f32_16x16x32_bf16 v[96:99], v[192:195], v[32:35], v[96:99]
  ds_read_b64_tr_b16 v[160:161], v6 offset:49152
  buffer_load_dwordx4 v[244:247], v5, s[36:39], s49 offen offset:0
  v_mfma_f32_16x16x32_bf16 v[100:103], v[192:195], v[36:39], v[100:103]
  ds_read_b64_tr_b16 v[162:163], v6 offset:49664
  v_mfma_f32_16x16x32_bf16 v[104:107], v[196:199], v[32:35], v[104:107]
  ds_read_b64_tr_b16 v[164:165], v7 offset:49152
  v_mfma_f32_16x16x32_bf16 v[108:111], v[196:199], v[36:39], v[108:111]
  ds_read_b64_tr_b16 v[166:167], v7 offset:49664
  v_mfma_f32_16x16x32_bf16 v[112:115], v[200:203], v[32:35], v[112:115]
  ds_read_b64_tr_b16 v[168:169], v8 offset:49152
  v_mfma_f32_16x16x32_bf16 v[116:119], v[200:203], v[36:39], v[116:119]
  ds_read_b64_tr_b16 v[170:171], v8 offset:49664
  v_mfma_f32_16x16x32_bf16 v[120:123], v[204:207], v[32:35], v[120:123]
  ds_read_b64_tr_b16 v[172:173], v9 offset:49152
  v_mfma_f32_16x16x32_bf16 v[124:127], v[204:207], v[36:39], v[124:127]
  ds_read_b64_tr_b16 v[174:175], v9 offset:49664
  s_waitcnt lgkmcnt(8)
  v_mfma_f32_16x16x32_bf16 v[96:99], v[208:211], v[40:43], v[96:99]
  ds_read_b64_tr_b16 v[176:177], v6 offset:53248
  buffer_load_dwordx4 v[248:251], v4, s[36:39], s49 offen offset:1024
  v_mfma_f32_16x16x32_bf16 v[100:103], v[208:211], v[44:47], v[100:103]
  ds_read_b64_tr_b16 v[178:179], v6 offset:53760
  v_mfma_f32_16x16x32_bf16 v[104:107], v[212:215], v[40:43], v[104:107]
  ds_read_b64_tr_b16 v[180:181], v7 offset:53248
  v_mfma_f32_16x16x32_bf16 v[108:111], v[212:215], v[44:47], v[108:111]
  ds_read_b64_tr_b16 v[182:183], v7 offset:53760
  v_mfma_f32_16x16x32_bf16 v[112:115], v[216:219], v[40:43], v[112:115]
  ds_read_b64_tr_b16 v[184:185], v8 offset:53248
  v_mfma_f32_16x16x32_bf16 v[116:119], v[216:219], v[44:47], v[116:119]
  ds_read_b64_tr_b16 v[186:187], v8 offset:53760
  v_mfma_f32_16x16x32_bf16 v[120:123], v[220:223], v[40:43], v[120:123]
  ds_read_b64_tr_b16 v[188:189], v9 offset:53248
  v_mfma_f32_16x16x32_bf16 v[124:127], v[220:223], v[44:47], v[124:127]
  ds_read_b64_tr_b16 v[190:191], v9 offset:53760
  s_waitcnt vmcnt(17) lgkmcnt(8)
  v_mfma_f32_16x16x32_bf16 v[128:131], v[160:163], v[48:51], v[128:131]
  ds_read_b64_tr_b16 v[192:193], v6 offset:57344
  buffer_load_dwordx4 v[252:255], v5, s[36:39], s49 offen offset:1024
  v_mfma_f32_16x16x32_bf16 v[132:135], v[160:163], v[52:55], v[132:135]
  ds_read_b64_tr_b16 v[194:195], v6 offset:57856
  v_mfma_f32_16x16x32_bf16 v[136:139], v[164:167], v[48:51], v[136:139]
  ds_read_b64_tr_b16 v[196:197], v7 offset:57344
  v_mfma_f32_16x16x32_bf16 v[140:143], v[164:167], v[52:55], v[140:143]
  ds_read_b64_tr_b16 v[198:199], v7 offset:57856
  v_mfma_f32_16x16x32_bf16 v[144:147], v[168:171], v[48:51], v[144:147]
  ds_read_b64_tr_b16 v[200:201], v8 offset:57344
  v_mfma_f32_16x16x32_bf16 v[148:151], v[168:171], v[52:55], v[148:151]
  ds_read_b64_tr_b16 v[202:203], v8 offset:57856
  v_readlane_b32 s50, v15, 18
  v_mfma_f32_16x16x32_bf16 v[152:155], v[172:175], v[48:51], v[152:155]
  ds_read_b64_tr_b16 v[204:205], v9 offset:57344
  v_mfma_f32_16x16x32_bf16 v[156:159], v[172:175], v[52:55], v[156:159]
  ds_read_b64_tr_b16 v[206:207], v9 offset:57856
  s_waitcnt vmcnt(16) lgkmcnt(8)
  v_mfma_f32_16x16x32_bf16 v[128:131], v[176:179], v[56:59], v[128:131]
  ds_read_b64_tr_b16 v[208:209], v6 offset:61440
  buffer_load_dwordx4 v[32:35], v4, s[36:39], s50 offen offset:0
  v_mfma_f32_16x16x32_bf16 v[132:135], v[176:179], v[60:63], v[132:135]
  ds_read_b64_tr_b16 v[210:211], v6 offset:61952
  v_mfma_f32_16x16x32_bf16 v[136:139], v[180:183], v[56:59], v[136:139]
  ds_read_b64_tr_b16 v[212:213], v7 offset:61440
  v_mfma_f32_16x16x32_bf16 v[140:143], v[180:183], v[60:63], v[140:143]
  ds_read_b64_tr_b16 v[214:215], v7 offset:61952
  v_mfma_f32_16x16x32_bf16 v[144:147], v[184:187], v[56:59], v[144:147]
  ds_read_b64_tr_b16 v[216:217], v8 offset:61440
  v_mfma_f32_16x16x32_bf16 v[148:151], v[184:187], v[60:63], v[148:151]
  ds_read_b64_tr_b16 v[218:219], v8 offset:61952
  v_mfma_f32_16x16x32_bf16 v[152:155], v[188:191], v[56:59], v[152:155]
  ds_read_b64_tr_b16 v[220:221], v9 offset:61440
  v_mfma_f32_16x16x32_bf16 v[156:159], v[188:191], v[60:63], v[156:159]
  ds_read_b64_tr_b16 v[222:223], v9 offset:61952
  s_waitcnt lgkmcnt(8)
  v_mfma_f32_16x16x32_bf16 v[96:99], v[192:195], v[48:51], v[96:99]
  ds_read_b64_tr_b16 v[160:161], v20 offset:0
  buffer_load_dwordx4 v[36:39], v5, s[36:39], s50 offen offset:0
  v_mfma_f32_16x16x32_bf16 v[100:103], v[192:195], v[52:55], v[100:103]
  ds_read_b64_tr_b16 v[162:163], v20 offset:512
  v_mfma_f32_16x16x32_bf16 v[104:107], v[196:199], v[48:51], v[104:107]
  ds_read_b64_tr_b16 v[164:165], v21 offset:0
  v_mfma_f32_16x16x32_bf16 v[108:111], v[196:199], v[52:55], v[108:111]
  ds_read_b64_tr_b16 v[166:167], v21 offset:512
  v_mfma_f32_16x16x32_bf16 v[112:115], v[200:203], v[48:51], v[112:115]
  ds_read_b64_tr_b16 v[168:169], v22 offset:0
  v_mfma_f32_16x16x32_bf16 v[116:119], v[200:203], v[52:55], v[116:119]
  ds_read_b64_tr_b16 v[170:171], v22 offset:512
  v_mfma_f32_16x16x32_bf16 v[120:123], v[204:207], v[48:51], v[120:123]
  ds_read_b64_tr_b16 v[172:173], v23 offset:0
  v_mfma_f32_16x16x32_bf16 v[124:127], v[204:207], v[52:55], v[124:127]
  ds_read_b64_tr_b16 v[174:175], v23 offset:512
  s_waitcnt lgkmcnt(8)
  s_barrier
  v_mfma_f32_16x16x32_bf16 v[96:99], v[208:211], v[56:59], v[96:99]
  ds_read_b64_tr_b16 v[176:177], v20 offset:4096
  buffer_load_dwordx4 v[40:43], v4, s[36:39], s50 offen offset:1024
  v_mfma_f32_16x16x32_bf16 v[100:103], v[208:211], v[60:63], v[100:103]
  ds_read_b64_tr_b16 v[178:179], v20 offset:4608
  v_mfma_f32_16x16x32_bf16 v[104:107], v[212:215], v[56:59], v[104:107]
  ds_read_b64_tr_b16 v[180:181], v21 offset:4096
  v_mfma_f32_16x16x32_bf16 v[108:111], v[212:215], v[60:63], v[108:111]
  ds_read_b64_tr_b16 v[182:183], v21 offset:4608
  v_mfma_f32_16x16x32_bf16 v[112:115], v[216:219], v[56:59], v[112:115]
  ds_read_b64_tr_b16 v[184:185], v22 offset:4096
  v_mfma_f32_16x16x32_bf16 v[116:119], v[216:219], v[60:63], v[116:119]
  ds_read_b64_tr_b16 v[186:187], v22 offset:4608
  v_mfma_f32_16x16x32_bf16 v[120:123], v[220:223], v[56:59], v[120:123]
  ds_read_b64_tr_b16 v[188:189], v23 offset:4096
  v_mfma_f32_16x16x32_bf16 v[124:127], v[220:223], v[60:63], v[124:127]
  ds_read_b64_tr_b16 v[190:191], v23 offset:4608
  s_waitcnt vmcnt(17) lgkmcnt(8)
  v_mfma_f32_16x16x32_bf16 v[128:131], v[160:163], v[64:67], v[128:131]
  ds_read_b64_tr_b16 v[192:193], v20 offset:8192
  buffer_load_dwordx4 v[44:47], v5, s[36:39], s50 offen offset:1024
  v_mfma_f32_16x16x32_bf16 v[132:135], v[160:163], v[68:71], v[132:135]
  ds_read_b64_tr_b16 v[194:195], v20 offset:8704
  v_mfma_f32_16x16x32_bf16 v[136:139], v[164:167], v[64:67], v[136:139]
  ds_read_b64_tr_b16 v[196:197], v21 offset:8192
  v_mfma_f32_16x16x32_bf16 v[140:143], v[164:167], v[68:71], v[140:143]
  ds_read_b64_tr_b16 v[198:199], v21 offset:8704
  v_mfma_f32_16x16x32_bf16 v[144:147], v[168:171], v[64:67], v[144:147]
  ds_read_b64_tr_b16 v[200:201], v22 offset:8192
  v_mfma_f32_16x16x32_bf16 v[148:151], v[168:171], v[68:71], v[148:151]
  ds_read_b64_tr_b16 v[202:203], v22 offset:8704
  v_readlane_b32 s51, v15, 19
  v_mfma_f32_16x16x32_bf16 v[152:155], v[172:175], v[64:67], v[152:155]
  ds_read_b64_tr_b16 v[204:205], v23 offset:8192
  v_mfma_f32_16x16x32_bf16 v[156:159], v[172:175], v[68:71], v[156:159]
  ds_read_b64_tr_b16 v[206:207], v23 offset:8704
  s_waitcnt vmcnt(16) lgkmcnt(8)
  v_mfma_f32_16x16x32_bf16 v[128:131], v[176:179], v[72:75], v[128:131]
  ds_read_b64_tr_b16 v[208:209], v20 offset:12288
  buffer_load_dwordx4 v[48:51], v4, s[36:39], s51 offen offset:0
  v_mfma_f32_16x16x32_bf16 v[132:135], v[176:179], v[76:79], v[132:135]
  ds_read_b64_tr_b16 v[210:211], v20 offset:12800
  v_mfma_f32_16x16x32_bf16 v[136:139], v[180:183], v[72:75], v[136:139]
  ds_read_b64_tr_b16 v[212:213], v21 offset:12288
  v_mfma_f32_16x16x32_bf16 v[140:143], v[180:183], v[76:79], v[140:143]
  ds_read_b64_tr_b16 v[214:215], v21 offset:12800
  v_mfma_f32_16x16x32_bf16 v[144:147], v[184:187], v[72:75], v[144:147]
  ds_read_b64_tr_b16 v[216:217], v22 offset:12288
  v_mfma_f32_16x16x32_bf16 v[148:151], v[184:187], v[76:79], v[148:151]
  ds_read_b64_tr_b16 v[218:219], v22 offset:12800
  v_mfma_f32_16x16x32_bf16 v[152:155], v[188:191], v[72:75], v[152:155]
  ds_read_b64_tr_b16 v[220:221], v23 offset:12288
  v_mfma_f32_16x16x32_bf16 v[156:159], v[188:191], v[76:79], v[156:159]
  ds_read_b64_tr_b16 v[222:223], v23 offset:12800
  s_waitcnt lgkmcnt(8)
  v_mfma_f32_16x16x32_bf16 v[96:99], v[192:195], v[64:67], v[96:99]
  ds_read_b64_tr_b16 v[160:161], v20 offset:16384
  buffer_load_dwordx4 v[52:55], v5, s[36:39], s51 offen offset:0
  v_mfma_f32_16x16x32_bf16 v[100:103], v[192:195], v[68:71], v[100:103]
  ds_read_b64_tr_b16 v[162:163], v20 offset:16896
  v_mfma_f32_16x16x32_bf16 v[104:107], v[196:199], v[64:67], v[104:107]
  ds_read_b64_tr_b16 v[164:165], v21 offset:16384
  v_mfma_f32_16x16x32_bf16 v[108:111], v[196:199], v[68:71], v[108:111]
  ds_read_b64_tr_b16 v[166:167], v21 offset:16896
  v_mfma_f32_16x16x32_bf16 v[112:115], v[200:203], v[64:67], v[112:115]
  ds_read_b64_tr_b16 v[168:169], v22 offset:16384
  v_mfma_f32_16x16x32_bf16 v[116:119], v[200:203], v[68:71], v[116:119]
  ds_read_b64_tr_b16 v[170:171], v22 offset:16896
  v_mfma_f32_16x16x32_bf16 v[120:123], v[204:207], v[64:67], v[120:123]
  ds_read_b64_tr_b16 v[172:173], v23 offset:16384
  v_mfma_f32_16x16x32_bf16 v[124:127], v[204:207], v[68:71], v[124:127]
  ds_read_b64_tr_b16 v[174:175], v23 offset:16896
  s_waitcnt lgkmcnt(8)
  v_mfma_f32_16x16x32_bf16 v[96:99], v[208:211], v[72:75], v[96:99]
  ds_read_b64_tr_b16 v[176:177], v20 offset:20480
  buffer_load_dwordx4 v[56:59], v4, s[36:39], s51 offen offset:1024
  v_mfma_f32_16x16x32_bf16 v[100:103], v[208:211], v[76:79], v[100:103]
  ds_read_b64_tr_b16 v[178:179], v20 offset:20992
  v_mfma_f32_16x16x32_bf16 v[104:107], v[212:215], v[72:75], v[104:107]
  ds_read_b64_tr_b16 v[180:181], v21 offset:20480
  v_mfma_f32_16x16x32_bf16 v[108:111], v[212:215], v[76:79], v[108:111]
  ds_read_b64_tr_b16 v[182:183], v21 offset:20992
  v_mfma_f32_16x16x32_bf16 v[112:115], v[216:219], v[72:75], v[112:115]
  ds_read_b64_tr_b16 v[184:185], v22 offset:20480
  v_mfma_f32_16x16x32_bf16 v[116:119], v[216:219], v[76:79], v[116:119]
  ds_read_b64_tr_b16 v[186:187], v22 offset:20992
  v_mfma_f32_16x16x32_bf16 v[120:123], v[220:223], v[72:75], v[120:123]
  ds_read_b64_tr_b16 v[188:189], v23 offset:20480
  v_mfma_f32_16x16x32_bf16 v[124:127], v[220:223], v[76:79], v[124:127]
  ds_read_b64_tr_b16 v[190:191], v23 offset:20992
  s_waitcnt vmcnt(17) lgkmcnt(8)
  v_mfma_f32_16x16x32_bf16 v[128:131], v[160:163], v[80:83], v[128:131]
  ds_read_b64_tr_b16 v[192:193], v20 offset:24576
  buffer_load_dwordx4 v[60:63], v5, s[36:39], s51 offen offset:1024
  v_mfma_f32_16x16x32_bf16 v[132:135], v[160:163], v[84:87], v[132:135]
  ds_read_b64_tr_b16 v[194:195], v20 offset:25088
  v_mfma_f32_16x16x32_bf16 v[136:139], v[164:167], v[80:83], v[136:139]
  ds_read_b64_tr_b16 v[196:197], v21 offset:24576
  v_mfma_f32_16x16x32_bf16 v[140:143], v[164:167], v[84:87], v[140:143]
  ds_read_b64_tr_b16 v[198:199], v21 offset:25088
  v_mfma_f32_16x16x32_bf16 v[144:147], v[168:171], v[80:83], v[144:147]
  ds_read_b64_tr_b16 v[200:201], v22 offset:24576
  v_mfma_f32_16x16x32_bf16 v[148:151], v[168:171], v[84:87], v[148:151]
  ds_read_b64_tr_b16 v[202:203], v22 offset:25088
  v_readlane_b32 s48, v15, 20
  v_mfma_f32_16x16x32_bf16 v[152:155], v[172:175], v[80:83], v[152:155]
  ds_read_b64_tr_b16 v[204:205], v23 offset:24576
  v_mfma_f32_16x16x32_bf16 v[156:159], v[172:175], v[84:87], v[156:159]
  ds_read_b64_tr_b16 v[206:207], v23 offset:25088
  s_waitcnt vmcnt(16) lgkmcnt(8)
  v_mfma_f32_16x16x32_bf16 v[128:131], v[176:179], v[88:91], v[128:131]
  ds_read_b64_tr_b16 v[208:209], v20 offset:28672
  buffer_load_dwordx4 v[64:67], v4, s[36:39], s48 offen offset:0
  v_mfma_f32_16x16x32_bf16 v[132:135], v[176:179], v[92:95], v[132:135]
  ds_read_b64_tr_b16 v[210:211], v20 offset:29184
  v_mfma_f32_16x16x32_bf16 v[136:139], v[180:183], v[88:91], v[136:139]
  ds_read_b64_tr_b16 v[212:213], v21 offset:28672
  v_mfma_f32_16x16x32_bf16 v[140:143], v[180:183], v[92:95], v[140:143]
  ds_read_b64_tr_b16 v[214:215], v21 offset:29184
  v_mfma_f32_16x16x32_bf16 v[144:147], v[184:187], v[88:91], v[144:147]
  ds_read_b64_tr_b16 v[216:217], v22 offset:28672
  v_mfma_f32_16x16x32_bf16 v[148:151], v[184:187], v[92:95], v[148:151]
  ds_read_b64_tr_b16 v[218:219], v22 offset:29184
  v_mfma_f32_16x16x32_bf16 v[152:155], v[188:191], v[88:91], v[152:155]
  ds_read_b64_tr_b16 v[220:221], v23 offset:28672
  v_mfma_f32_16x16x32_bf16 v[156:159], v[188:191], v[92:95], v[156:159]
  ds_read_b64_tr_b16 v[222:223], v23 offset:29184
  s_waitcnt lgkmcnt(8)
  v_mfma_f32_16x16x32_bf16 v[96:99], v[192:195], v[80:83], v[96:99]
  ds_read_b64_tr_b16 v[160:161], v20 offset:32768
  buffer_load_dwordx4 v[68:71], v5, s[36:39], s48 offen offset:0
  v_mfma_f32_16x16x32_bf16 v[100:103], v[192:195], v[84:87], v[100:103]
  ds_read_b64_tr_b16 v[162:163], v20 offset:33280
  v_mfma_f32_16x16x32_bf16 v[104:107], v[196:199], v[80:83], v[104:107]
  ds_read_b64_tr_b16 v[164:165], v21 offset:32768
  v_mfma_f32_16x16x32_bf16 v[108:111], v[196:199], v[84:87], v[108:111]
  ds_read_b64_tr_b16 v[166:167], v21 offset:33280
  v_mfma_f32_16x16x32_bf16 v[112:115], v[200:203], v[80:83], v[112:115]
  ds_read_b64_tr_b16 v[168:169], v22 offset:32768
  v_mfma_f32_16x16x32_bf16 v[116:119], v[200:203], v[84:87], v[116:119]
  ds_read_b64_tr_b16 v[170:171], v22 offset:33280
  v_mfma_f32_16x16x32_bf16 v[120:123], v[204:207], v[80:83], v[120:123]
  ds_read_b64_tr_b16 v[172:173], v23 offset:32768
  v_mfma_f32_16x16x32_bf16 v[124:127], v[204:207], v[84:87], v[124:127]
  ds_read_b64_tr_b16 v[174:175], v23 offset:33280
  s_waitcnt lgkmcnt(8)
  s_barrier
  v_mfma_f32_16x16x32_bf16 v[96:99], v[208:211], v[88:91], v[96:99]
  ds_read_b64_tr_b16 v[176:177], v20 offset:36864
  buffer_load_dwordx4 v[72:75], v4, s[36:39], s48 offen offset:1024
  v_mfma_f32_16x16x32_bf16 v[100:103], v[208:211], v[92:95], v[100:103]
  ds_read_b64_tr_b16 v[178:179], v20 offset:37376
  v_mfma_f32_16x16x32_bf16 v[104:107], v[212:215], v[88:91], v[104:107]
  ds_read_b64_tr_b16 v[180:181], v21 offset:36864
  v_mfma_f32_16x16x32_bf16 v[108:111], v[212:215], v[92:95], v[108:111]
  ds_read_b64_tr_b16 v[182:183], v21 offset:37376
  v_mfma_f32_16x16x32_bf16 v[112:115], v[216:219], v[88:91], v[112:115]
  ds_read_b64_tr_b16 v[184:185], v22 offset:36864
  v_mfma_f32_16x16x32_bf16 v[116:119], v[216:219], v[92:95], v[116:119]
  ds_read_b64_tr_b16 v[186:187], v22 offset:37376
  v_mfma_f32_16x16x32_bf16 v[120:123], v[220:223], v[88:91], v[120:123]
  ds_read_b64_tr_b16 v[188:189], v23 offset:36864
  v_mfma_f32_16x16x32_bf16 v[124:127], v[220:223], v[92:95], v[124:127]
  ds_read_b64_tr_b16 v[190:191], v23 offset:37376
  s_waitcnt vmcnt(17) lgkmcnt(8)
  v_mfma_f32_16x16x32_bf16 v[128:131], v[160:163], v[224:227], v[128:131]
  ds_read_b64_tr_b16 v[192:193], v20 offset:40960
  buffer_load_dwordx4 v[76:79], v5, s[36:39], s48 offen offset:1024
  v_mfma_f32_16x16x32_bf16 v[132:135], v[160:163], v[228:231], v[132:135]
  ds_read_b64_tr_b16 v[194:195], v20 offset:41472
  v_mfma_f32_16x16x32_bf16 v[136:139], v[164:167], v[224:227], v[136:139]
  ds_read_b64_tr_b16 v[196:197], v21 offset:40960
  v_mfma_f32_16x16x32_bf16 v[140:143], v[164:167], v[228:231], v[140:143]
  ds_read_b64_tr_b16 v[198:199], v21 offset:41472
  v_mfma_f32_16x16x32_bf16 v[144:147], v[168:171], v[224:227], v[144:147]
  ds_read_b64_tr_b16 v[200:201], v22 offset:40960
  v_mfma_f32_16x16x32_bf16 v[148:151], v[168:171], v[228:231], v[148:151]
  ds_read_b64_tr_b16 v[202:203], v22 offset:41472
  v_readlane_b32 s49, v15, 21
  v_mfma_f32_16x16x32_bf16 v[152:155], v[172:175], v[224:227], v[152:155]
  ds_read_b64_tr_b16 v[204:205], v23 offset:40960
  v_mfma_f32_16x16x32_bf16 v[156:159], v[172:175], v[228:231], v[156:159]
  ds_read_b64_tr_b16 v[206:207], v23 offset:41472
  s_waitcnt vmcnt(16) lgkmcnt(8)
  v_mfma_f32_16x16x32_bf16 v[128:131], v[176:179], v[232:235], v[128:131]
  ds_read_b64_tr_b16 v[208:209], v20 offset:45056
  buffer_load_dwordx4 v[80:83], v4, s[36:39], s49 offen offset:0
  v_mfma_f32_16x16x32_bf16 v[132:135], v[176:179], v[236:239], v[132:135]
  ds_read_b64_tr_b16 v[210:211], v20 offset:45568
  v_mfma_f32_16x16x32_bf16 v[136:139], v[180:183], v[232:235], v[136:139]
  ds_read_b64_tr_b16 v[212:213], v21 offset:45056
  v_mfma_f32_16x16x32_bf16 v[140:143], v[180:183], v[236:239], v[140:143]
  ds_read_b64_tr_b16 v[214:215], v21 offset:45568
  v_mfma_f32_16x16x32_bf16 v[144:147], v[184:187], v[232:235], v[144:147]
  ds_read_b64_tr_b16 v[216:217], v22 offset:45056
  v_mfma_f32_16x16x32_bf16 v[148:151], v[184:187], v[236:239], v[148:151]
  ds_read_b64_tr_b16 v[218:219], v22 offset:45568
  v_mfma_f32_16x16x32_bf16 v[152:155], v[188:191], v[232:235], v[152:155]
  ds_read_b64_tr_b16 v[220:221], v23 offset:45056
  v_mfma_f32_16x16x32_bf16 v[156:159], v[188:191], v[236:239], v[156:159]
  ds_read_b64_tr_b16 v[222:223], v23 offset:45568
  s_waitcnt lgkmcnt(8)
  v_mfma_f32_16x16x32_bf16 v[96:99], v[192:195], v[224:227], v[96:99]
  ds_read_b64_tr_b16 v[160:161], v20 offset:49152
  buffer_load_dwordx4 v[84:87], v5, s[36:39], s49 offen offset:0
  v_mfma_f32_16x16x32_bf16 v[100:103], v[192:195], v[228:231], v[100:103]
  ds_read_b64_tr_b16 v[162:163], v20 offset:49664
  v_mfma_f32_16x16x32_bf16 v[104:107], v[196:199], v[224:227], v[104:107]
  ds_read_b64_tr_b16 v[164:165], v21 offset:49152
  v_mfma_f32_16x16x32_bf16 v[108:111], v[196:199], v[228:231], v[108:111]
  ds_read_b64_tr_b16 v[166:167], v21 offset:49664
  v_mfma_f32_16x16x32_bf16 v[112:115], v[200:203], v[224:227], v[112:115]
  ds_read_b64_tr_b16 v[168:169], v22 offset:49152
  v_mfma_f32_16x16x32_bf16 v[116:119], v[200:203], v[228:231], v[116:119]
  ds_read_b64_tr_b16 v[170:171], v22 offset:49664
  v_mfma_f32_16x16x32_bf16 v[120:123], v[204:207], v[224:227], v[120:123]
  ds_read_b64_tr_b16 v[172:173], v23 offset:49152
  v_mfma_f32_16x16x32_bf16 v[124:127], v[204:207], v[228:231], v[124:127]
  ds_read_b64_tr_b16 v[174:175], v23 offset:49664
  s_waitcnt lgkmcnt(8)
  v_mfma_f32_16x16x32_bf16 v[96:99], v[208:211], v[232:235], v[96:99]
  ds_read_b64_tr_b16 v[176:177], v20 offset:53248
  buffer_load_dwordx4 v[88:91], v4, s[36:39], s49 offen offset:1024
  v_mfma_f32_16x16x32_bf16 v[100:103], v[208:211], v[236:239], v[100:103]
  ds_read_b64_tr_b16 v[178:179], v20 offset:53760
  v_mfma_f32_16x16x32_bf16 v[104:107], v[212:215], v[232:235], v[104:107]
  ds_read_b64_tr_b16 v[180:181], v21 offset:53248
  v_mfma_f32_16x16x32_bf16 v[108:111], v[212:215], v[236:239], v[108:111]
  ds_read_b64_tr_b16 v[182:183], v21 offset:53760
  v_mfma_f32_16x16x32_bf16 v[112:115], v[216:219], v[232:235], v[112:115]
  ds_read_b64_tr_b16 v[184:185], v22 offset:53248
  v_mfma_f32_16x16x32_bf16 v[116:119], v[216:219], v[236:239], v[116:119]
  ds_read_b64_tr_b16 v[186:187], v22 offset:53760
  v_mfma_f32_16x16x32_bf16 v[120:123], v[220:223], v[232:235], v[120:123]
  ds_read_b64_tr_b16 v[188:189], v23 offset:53248
  v_mfma_f32_16x16x32_bf16 v[124:127], v[220:223], v[236:239], v[124:127]
  ds_read_b64_tr_b16 v[190:191], v23 offset:53760
  s_waitcnt vmcnt(17) lgkmcnt(8)
  v_mfma_f32_16x16x32_bf16 v[128:131], v[160:163], v[240:243], v[128:131]
  ds_read_b64_tr_b16 v[192:193], v20 offset:57344
  buffer_load_dwordx4 v[92:95], v5, s[36:39], s49 offen offset:1024
  v_mfma_f32_16x16x32_bf16 v[132:135], v[160:163], v[244:247], v[132:135]
  ds_read_b64_tr_b16 v[194:195], v20 offset:57856
  v_mfma_f32_16x16x32_bf16 v[136:139], v[164:167], v[240:243], v[136:139]
  ds_read_b64_tr_b16 v[196:197], v21 offset:57344
  v_mfma_f32_16x16x32_bf16 v[140:143], v[164:167], v[244:247], v[140:143]
  ds_read_b64_tr_b16 v[198:199], v21 offset:57856
  v_mfma_f32_16x16x32_bf16 v[144:147], v[168:171], v[240:243], v[144:147]
  ds_read_b64_tr_b16 v[200:201], v22 offset:57344
  v_mfma_f32_16x16x32_bf16 v[148:151], v[168:171], v[244:247], v[148:151]
  ds_read_b64_tr_b16 v[202:203], v22 offset:57856
  v_readlane_b32 s50, v15, 22
  v_mfma_f32_16x16x32_bf16 v[152:155], v[172:175], v[240:243], v[152:155]
  ds_read_b64_tr_b16 v[204:205], v23 offset:57344
  v_mfma_f32_16x16x32_bf16 v[156:159], v[172:175], v[244:247], v[156:159]
  ds_read_b64_tr_b16 v[206:207], v23 offset:57856
  s_waitcnt vmcnt(16) lgkmcnt(8)
  v_mfma_f32_16x16x32_bf16 v[128:131], v[176:179], v[248:251], v[128:131]
  ds_read_b64_tr_b16 v[208:209], v20 offset:61440
  buffer_load_dwordx4 v[224:227], v4, s[36:39], s50 offen offset:0
  v_mfma_f32_16x16x32_bf16 v[132:135], v[176:179], v[252:255], v[132:135]
  ds_read_b64_tr_b16 v[210:211], v20 offset:61952
  v_mfma_f32_16x16x32_bf16 v[136:139], v[180:183], v[248:251], v[136:139]
  ds_read_b64_tr_b16 v[212:213], v21 offset:61440
  v_mfma_f32_16x16x32_bf16 v[140:143], v[180:183], v[252:255], v[140:143]
  ds_read_b64_tr_b16 v[214:215], v21 offset:61952
  v_mfma_f32_16x16x32_bf16 v[144:147], v[184:187], v[248:251], v[144:147]
  ds_read_b64_tr_b16 v[216:217], v22 offset:61440
  v_mfma_f32_16x16x32_bf16 v[148:151], v[184:187], v[252:255], v[148:151]
  ds_read_b64_tr_b16 v[218:219], v22 offset:61952
  v_mfma_f32_16x16x32_bf16 v[152:155], v[188:191], v[248:251], v[152:155]
  ds_read_b64_tr_b16 v[220:221], v23 offset:61440
  v_mfma_f32_16x16x32_bf16 v[156:159], v[188:191], v[252:255], v[156:159]
  ds_read_b64_tr_b16 v[222:223], v23 offset:61952
  s_waitcnt lgkmcnt(8)
  v_mfma_f32_16x16x32_bf16 v[96:99], v[192:195], v[240:243], v[96:99]
  ds_read_b64_tr_b16 v[160:161], v26 offset:0
  buffer_load_dwordx4 v[228:231], v5, s[36:39], s50 offen offset:0
  v_mfma_f32_16x16x32_bf16 v[100:103], v[192:195], v[244:247], v[100:103]
  ds_read_b64_tr_b16 v[162:163], v26 offset:512
  v_mfma_f32_16x16x32_bf16 v[104:107], v[196:199], v[240:243], v[104:107]
  ds_read_b64_tr_b16 v[164:165], v27 offset:0
  v_mfma_f32_16x16x32_bf16 v[108:111], v[196:199], v[244:247], v[108:111]
  ds_read_b64_tr_b16 v[166:167], v27 offset:512
  v_mfma_f32_16x16x32_bf16 v[112:115], v[200:203], v[240:243], v[112:115]
  ds_read_b64_tr_b16 v[168:169], v28 offset:0
  v_mfma_f32_16x16x32_bf16 v[116:119], v[200:203], v[244:247], v[116:119]
  ds_read_b64_tr_b16 v[170:171], v28 offset:512
  v_mfma_f32_16x16x32_bf16 v[120:123], v[204:207], v[240:243], v[120:123]
  ds_read_b64_tr_b16 v[172:173], v29 offset:0
  v_mfma_f32_16x16x32_bf16 v[124:127], v[204:207], v[244:247], v[124:127]
  ds_read_b64_tr_b16 v[174:175], v29 offset:512
  s_waitcnt lgkmcnt(8)
  s_barrier
  v_mfma_f32_16x16x32_bf16 v[96:99], v[208:211], v[248:251], v[96:99]
  ds_read_b64_tr_b16 v[176:177], v26 offset:4096
  buffer_load_dwordx4 v[232:235], v4, s[36:39], s50 offen offset:1024
  v_mfma_f32_16x16x32_bf16 v[100:103], v[208:211], v[252:255], v[100:103]
  ds_read_b64_tr_b16 v[178:179], v26 offset:4608
  v_mfma_f32_16x16x32_bf16 v[104:107], v[212:215], v[248:251], v[104:107]
  ds_read_b64_tr_b16 v[180:181], v27 offset:4096
  v_mfma_f32_16x16x32_bf16 v[108:111], v[212:215], v[252:255], v[108:111]
  ds_read_b64_tr_b16 v[182:183], v27 offset:4608
  v_mfma_f32_16x16x32_bf16 v[112:115], v[216:219], v[248:251], v[112:115]
  ds_read_b64_tr_b16 v[184:185], v28 offset:4096
  v_mfma_f32_16x16x32_bf16 v[116:119], v[216:219], v[252:255], v[116:119]
  ds_read_b64_tr_b16 v[186:187], v28 offset:4608
  v_mfma_f32_16x16x32_bf16 v[120:123], v[220:223], v[248:251], v[120:123]
  ds_read_b64_tr_b16 v[188:189], v29 offset:4096
  v_mfma_f32_16x16x32_bf16 v[124:127], v[220:223], v[252:255], v[124:127]
  ds_read_b64_tr_b16 v[190:191], v29 offset:4608
  s_waitcnt vmcnt(17) lgkmcnt(8)
  v_mfma_f32_16x16x32_bf16 v[128:131], v[160:163], v[32:35], v[128:131]
  ds_read_b64_tr_b16 v[192:193], v26 offset:8192
  buffer_load_dwordx4 v[236:239], v5, s[36:39], s50 offen offset:1024
  v_mfma_f32_16x16x32_bf16 v[132:135], v[160:163], v[36:39], v[132:135]
  ds_read_b64_tr_b16 v[194:195], v26 offset:8704
  v_mfma_f32_16x16x32_bf16 v[136:139], v[164:167], v[32:35], v[136:139]
  ds_read_b64_tr_b16 v[196:197], v27 offset:8192
  v_mfma_f32_16x16x32_bf16 v[140:143], v[164:167], v[36:39], v[140:143]
  ds_read_b64_tr_b16 v[198:199], v27 offset:8704
  v_mfma_f32_16x16x32_bf16 v[144:147], v[168:171], v[32:35], v[144:147]
  ds_read_b64_tr_b16 v[200:201], v28 offset:8192
  v_mfma_f32_16x16x32_bf16 v[148:151], v[168:171], v[36:39], v[148:151]
  ds_read_b64_tr_b16 v[202:203], v28 offset:8704
  v_readlane_b32 s51, v15, 23
  v_mfma_f32_16x16x32_bf16 v[152:155], v[172:175], v[32:35], v[152:155]
  ds_read_b64_tr_b16 v[204:205], v29 offset:8192
  v_mfma_f32_16x16x32_bf16 v[156:159], v[172:175], v[36:39], v[156:159]
  ds_read_b64_tr_b16 v[206:207], v29 offset:8704
  s_waitcnt vmcnt(16) lgkmcnt(8)
  v_mfma_f32_16x16x32_bf16 v[128:131], v[176:179], v[40:43], v[128:131]
  ds_read_b64_tr_b16 v[208:209], v26 offset:12288
  buffer_load_dwordx4 v[240:243], v4, s[36:39], s51 offen offset:0
  v_mfma_f32_16x16x32_bf16 v[132:135], v[176:179], v[44:47], v[132:135]
  ds_read_b64_tr_b16 v[210:211], v26 offset:12800
  v_mfma_f32_16x16x32_bf16 v[136:139], v[180:183], v[40:43], v[136:139]
  ds_read_b64_tr_b16 v[212:213], v27 offset:12288
  v_mfma_f32_16x16x32_bf16 v[140:143], v[180:183], v[44:47], v[140:143]
  ds_read_b64_tr_b16 v[214:215], v27 offset:12800
  v_mfma_f32_16x16x32_bf16 v[144:147], v[184:187], v[40:43], v[144:147]
  ds_read_b64_tr_b16 v[216:217], v28 offset:12288
  v_mfma_f32_16x16x32_bf16 v[148:151], v[184:187], v[44:47], v[148:151]
  ds_read_b64_tr_b16 v[218:219], v28 offset:12800
  v_mfma_f32_16x16x32_bf16 v[152:155], v[188:191], v[40:43], v[152:155]
  ds_read_b64_tr_b16 v[220:221], v29 offset:12288
  v_mfma_f32_16x16x32_bf16 v[156:159], v[188:191], v[44:47], v[156:159]
  ds_read_b64_tr_b16 v[222:223], v29 offset:12800
  s_waitcnt lgkmcnt(8)
  v_mfma_f32_16x16x32_bf16 v[96:99], v[192:195], v[32:35], v[96:99]
  ds_read_b64_tr_b16 v[160:161], v26 offset:16384
  buffer_load_dwordx4 v[244:247], v5, s[36:39], s51 offen offset:0
  v_mfma_f32_16x16x32_bf16 v[100:103], v[192:195], v[36:39], v[100:103]
  ds_read_b64_tr_b16 v[162:163], v26 offset:16896
  v_mfma_f32_16x16x32_bf16 v[104:107], v[196:199], v[32:35], v[104:107]
  ds_read_b64_tr_b16 v[164:165], v27 offset:16384
  v_mfma_f32_16x16x32_bf16 v[108:111], v[196:199], v[36:39], v[108:111]
  ds_read_b64_tr_b16 v[166:167], v27 offset:16896
  v_mfma_f32_16x16x32_bf16 v[112:115], v[200:203], v[32:35], v[112:115]
  ds_read_b64_tr_b16 v[168:169], v28 offset:16384
  v_mfma_f32_16x16x32_bf16 v[116:119], v[200:203], v[36:39], v[116:119]
  ds_read_b64_tr_b16 v[170:171], v28 offset:16896
  v_mfma_f32_16x16x32_bf16 v[120:123], v[204:207], v[32:35], v[120:123]
  ds_read_b64_tr_b16 v[172:173], v29 offset:16384
  v_mfma_f32_16x16x32_bf16 v[124:127], v[204:207], v[36:39], v[124:127]
  ds_read_b64_tr_b16 v[174:175], v29 offset:16896
  s_waitcnt lgkmcnt(8)
  v_mfma_f32_16x16x32_bf16 v[96:99], v[208:211], v[40:43], v[96:99]
  ds_read_b64_tr_b16 v[176:177], v26 offset:20480
  buffer_load_dwordx4 v[248:251], v4, s[36:39], s51 offen offset:1024
  v_mfma_f32_16x16x32_bf16 v[100:103], v[208:211], v[44:47], v[100:103]
  ds_read_b64_tr_b16 v[178:179], v26 offset:20992
  v_mfma_f32_16x16x32_bf16 v[104:107], v[212:215], v[40:43], v[104:107]
  ds_read_b64_tr_b16 v[180:181], v27 offset:20480
  v_mfma_f32_16x16x32_bf16 v[108:111], v[212:215], v[44:47], v[108:111]
  ds_read_b64_tr_b16 v[182:183], v27 offset:20992
  v_mfma_f32_16x16x32_bf16 v[112:115], v[216:219], v[40:43], v[112:115]
  ds_read_b64_tr_b16 v[184:185], v28 offset:20480
  v_mfma_f32_16x16x32_bf16 v[116:119], v[216:219], v[44:47], v[116:119]
  ds_read_b64_tr_b16 v[186:187], v28 offset:20992
  v_mfma_f32_16x16x32_bf16 v[120:123], v[220:223], v[40:43], v[120:123]
  ds_read_b64_tr_b16 v[188:189], v29 offset:20480
  v_mfma_f32_16x16x32_bf16 v[124:127], v[220:223], v[44:47], v[124:127]
  ds_read_b64_tr_b16 v[190:191], v29 offset:20992
  s_waitcnt vmcnt(17) lgkmcnt(8)
  v_mfma_f32_16x16x32_bf16 v[128:131], v[160:163], v[48:51], v[128:131]
  ds_read_b64_tr_b16 v[192:193], v26 offset:24576
  buffer_load_dwordx4 v[252:255], v5, s[36:39], s51 offen offset:1024
  v_mfma_f32_16x16x32_bf16 v[132:135], v[160:163], v[52:55], v[132:135]
  ds_read_b64_tr_b16 v[194:195], v26 offset:25088
  v_mfma_f32_16x16x32_bf16 v[136:139], v[164:167], v[48:51], v[136:139]
  ds_read_b64_tr_b16 v[196:197], v27 offset:24576
  v_mfma_f32_16x16x32_bf16 v[140:143], v[164:167], v[52:55], v[140:143]
  ds_read_b64_tr_b16 v[198:199], v27 offset:25088
  v_mfma_f32_16x16x32_bf16 v[144:147], v[168:171], v[48:51], v[144:147]
  ds_read_b64_tr_b16 v[200:201], v28 offset:24576
  v_mfma_f32_16x16x32_bf16 v[148:151], v[168:171], v[52:55], v[148:151]
  ds_read_b64_tr_b16 v[202:203], v28 offset:25088
  v_readlane_b32 s48, v15, 24
  v_mfma_f32_16x16x32_bf16 v[152:155], v[172:175], v[48:51], v[152:155]
  ds_read_b64_tr_b16 v[204:205], v29 offset:24576
  v_mfma_f32_16x16x32_bf16 v[156:159], v[172:175], v[52:55], v[156:159]
  ds_read_b64_tr_b16 v[206:207], v29 offset:25088
  s_waitcnt vmcnt(16) lgkmcnt(8)
  v_mfma_f32_16x16x32_bf16 v[128:131], v[176:179], v[56:59], v[128:131]
  ds_read_b64_tr_b16 v[208:209], v26 offset:28672
  buffer_load_dwordx4 v[32:35], v4, s[36:39], s48 offen offset:0
  v_mfma_f32_16x16x32_bf16 v[132:135], v[176:179], v[60:63], v[132:135]
  ds_read_b64_tr_b16 v[210:211], v26 offset:29184
  v_mfma_f32_16x16x32_bf16 v[136:139], v[180:183], v[56:59], v[136:139]
  ds_read_b64_tr_b16 v[212:213], v27 offset:28672
  v_mfma_f32_16x16x32_bf16 v[140:143], v[180:183], v[60:63], v[140:143]
  ds_read_b64_tr_b16 v[214:215], v27 offset:29184
  v_mfma_f32_16x16x32_bf16 v[144:147], v[184:187], v[56:59], v[144:147]
  ds_read_b64_tr_b16 v[216:217], v28 offset:28672
  v_mfma_f32_16x16x32_bf16 v[148:151], v[184:187], v[60:63], v[148:151]
  ds_read_b64_tr_b16 v[218:219], v28 offset:29184
  v_mfma_f32_16x16x32_bf16 v[152:155], v[188:191], v[56:59], v[152:155]
  ds_read_b64_tr_b16 v[220:221], v29 offset:28672
  v_mfma_f32_16x16x32_bf16 v[156:159], v[188:191], v[60:63], v[156:159]
  ds_read_b64_tr_b16 v[222:223], v29 offset:29184
  s_waitcnt lgkmcnt(8)
  v_mfma_f32_16x16x32_bf16 v[96:99], v[192:195], v[48:51], v[96:99]
  ds_read_b64_tr_b16 v[160:161], v6 offset:0
  buffer_load_dwordx4 v[36:39], v5, s[36:39], s48 offen offset:0
  v_mfma_f32_16x16x32_bf16 v[100:103], v[192:195], v[52:55], v[100:103]
  ds_read_b64_tr_b16 v[162:163], v6 offset:512
  v_mfma_f32_16x16x32_bf16 v[104:107], v[196:199], v[48:51], v[104:107]
  ds_read_b64_tr_b16 v[164:165], v7 offset:0
  v_cvt_pk_bf16_f32 v128, v128, v129
  v_mfma_f32_16x16x32_bf16 v[108:111], v[196:199], v[52:55], v[108:111]
  ds_read_b64_tr_b16 v[166:167], v7 offset:512
  v_cvt_pk_bf16_f32 v129, v130, v131
  v_mfma_f32_16x16x32_bf16 v[112:115], v[200:203], v[48:51], v[112:115]
  ds_read_b64_tr_b16 v[168:169], v8 offset:0
  v_cvt_pk_bf16_f32 v130, v132, v133
  v_mfma_f32_16x16x32_bf16 v[116:119], v[200:203], v[52:55], v[116:119]
  ds_read_b64_tr_b16 v[170:171], v8 offset:512
  v_cvt_pk_bf16_f32 v131, v134, v135
  v_mfma_f32_16x16x32_bf16 v[120:123], v[204:207], v[48:51], v[120:123]
  ds_read_b64_tr_b16 v[172:173], v9 offset:0
  v_cvt_pk_bf16_f32 v132, v136, v137
  v_mfma_f32_16x16x32_bf16 v[124:127], v[204:207], v[52:55], v[124:127]
  ds_read_b64_tr_b16 v[174:175], v9 offset:512
  s_waitcnt lgkmcnt(8)
  s_barrier
  v_mfma_f32_16x16x32_bf16 v[96:99], v[208:211], v[56:59], v[96:99]
  ds_read_b64_tr_b16 v[176:177], v6 offset:4096
  buffer_load_dwordx4 v[40:43], v4, s[36:39], s48 offen offset:1024
  v_mfma_f32_16x16x32_bf16 v[100:103], v[208:211], v[60:63], v[100:103]
  ds_read_b64_tr_b16 v[178:179], v6 offset:4608
  ds_write_b128 v19, v[128:131] offset:0
  v_mfma_f32_16x16x32_bf16 v[104:107], v[212:215], v[56:59], v[104:107]
  ds_read_b64_tr_b16 v[180:181], v7 offset:4096
  v_cvt_pk_bf16_f32 v133, v138, v139
  v_mfma_f32_16x16x32_bf16 v[108:111], v[212:215], v[60:63], v[108:111]
  ds_read_b64_tr_b16 v[182:183], v7 offset:4608
  v_cvt_pk_bf16_f32 v134, v140, v141
  v_mfma_f32_16x16x32_bf16 v[112:115], v[216:219], v[56:59], v[112:115]
  ds_read_b64_tr_b16 v[184:185], v8 offset:4096
  v_cvt_pk_bf16_f32 v135, v142, v143
  v_mfma_f32_16x16x32_bf16 v[116:119], v[216:219], v[60:63], v[116:119]
  ds_read_b64_tr_b16 v[186:187], v8 offset:4608
  ds_write_b128 v19, v[132:135] offset:1024
  v_mfma_f32_16x16x32_bf16 v[120:123], v[220:223], v[56:59], v[120:123]
  ds_read_b64_tr_b16 v[188:189], v9 offset:4096
  v_cvt_pk_bf16_f32 v136, v144, v145
  v_mfma_f32_16x16x32_bf16 v[124:127], v[220:223], v[60:63], v[124:127]
  ds_read_b64_tr_b16 v[190:191], v9 offset:4608
  s_waitcnt vmcnt(17) lgkmcnt(10)
  v_mfma_f32_16x16x32_bf16 v[96:99], v[160:163], v[64:67], v[96:99]
  ds_read_b64_tr_b16 v[192:193], v6 offset:8192
  buffer_load_dwordx4 v[44:47], v5, s[36:39], s48 offen offset:1024
  v_mfma_f32_16x16x32_bf16 v[100:103], v[160:163], v[68:71], v[100:103]
  ds_read_b64_tr_b16 v[194:195], v6 offset:8704
  v_cvt_pk_bf16_f32 v137, v146, v147
  v_mfma_f32_16x16x32_bf16 v[104:107], v[164:167], v[64:67], v[104:107]
  ds_read_b64_tr_b16 v[196:197], v7 offset:8192
  v_cvt_pk_bf16_f32 v138, v148, v149
  v_mfma_f32_16x16x32_bf16 v[108:111], v[164:167], v[68:71], v[108:111]
  ds_read_b64_tr_b16 v[198:199], v7 offset:8704
  v_cvt_pk_bf16_f32 v139, v150, v151
  v_mfma_f32_16x16x32_bf16 v[112:115], v[168:171], v[64:67], v[112:115]
  ds_read_b64_tr_b16 v[200:201], v8 offset:8192
  ds_write_b128 v19, v[136:139] offset:2048
  v_mfma_f32_16x16x32_bf16 v[116:119], v[168:171], v[68:71], v[116:119]
  ds_read_b64_tr_b16 v[202:203], v8 offset:8704
  v_readlane_b32 s49, v15, 25
  v_mfma_f32_16x16x32_bf16 v[120:123], v[172:175], v[64:67], v[120:123]
  ds_read_b64_tr_b16 v[204:205], v9 offset:8192
  v_cvt_pk_bf16_f32 v140, v152, v153
  v_mfma_f32_16x16x32_bf16 v[124:127], v[172:175], v[68:71], v[124:127]
  ds_read_b64_tr_b16 v[206:207], v9 offset:8704
  s_waitcnt vmcnt(16) lgkmcnt(9)
  v_mfma_f32_16x16x32_bf16 v[96:99], v[176:179], v[72:75], v[96:99]
  ds_read_b64_tr_b16 v[208:209], v6 offset:12288
  buffer_load_dwordx4 v[48:51], v4, s[36:39], s49 offen offset:0
  v_mfma_f32_16x16x32_bf16 v[100:103], v[176:179], v[76:79], v[100:103]
  ds_read_b64_tr_b16 v[210:211], v6 offset:12800
  v_cvt_pk_bf16_f32 v141, v154, v155
  v_mfma_f32_16x16x32_bf16 v[104:107], v[180:183], v[72:75], v[104:107]
  ds_read_b64_tr_b16 v[212:213], v7 offset:12288
  v_cvt_pk_bf16_f32 v142, v156, v157
  v_mfma_f32_16x16x32_bf16 v[108:111], v[180:183], v[76:79], v[108:111]
  ds_read_b64_tr_b16 v[214:215], v7 offset:12800
  buffer_load_dwordx4 v[52:55], v5, s[36:39], s49 offen offset:0
  v_mfma_f32_16x16x32_bf16 v[112:115], v[184:187], v[72:75], v[112:115]
  ds_read_b64_tr_b16 v[216:217], v8 offset:12288
  v_cvt_pk_bf16_f32 v143, v158, v159
  v_mfma_f32_16x16x32_bf16 v[116:119], v[184:187], v[76:79], v[116:119]
  ds_read_b64_tr_b16 v[218:219], v8 offset:12800
  ds_write_b128 v19, v[140:143] offset:3072
  v_mfma_f32_16x16x32_bf16 v[120:123], v[188:191], v[72:75], v[120:123]
  ds_read_b64_tr_b16 v[220:221], v9 offset:12288
  buffer_load_dwordx4 v[56:59], v4, s[36:39], s49 offen offset:1024
  v_mfma_f32_16x16x32_bf16 v[124:127], v[188:191], v[76:79], v[124:127]
  ds_read_b64_tr_b16 v[222:223], v9 offset:12800
  s_waitcnt vmcnt(17) lgkmcnt(9)
  v_mfma_f32_16x16x32_bf16 v[96:99], v[192:195], v[80:83], v[96:99]
  ds_read_b64_tr_b16 v[160:161], v6 offset:16384
  v_mfma_f32_16x16x32_bf16 v[100:103], v[192:195], v[84:87], v[100:103]
  ds_read_b64_tr_b16 v[162:163], v6 offset:16896
  buffer_load_dwordx4 v[60:63], v5, s[36:39], s49 offen offset:1024
  v_mfma_f32_16x16x32_bf16 v[104:107], v[196:199], v[80:83], v[104:107]
  ds_read_b64_tr_b16 v[164:165], v7 offset:16384
  v_readlane_b32 s50, v15, 26
  v_mfma_f32_16x16x32_bf16 v[108:111], v[196:199], v[84:87], v[108:111]
  ds_read_b64_tr_b16 v[166:167], v7 offset:16896
  v_mfma_f32_16x16x32_bf16 v[112:115], v[200:203], v[80:83], v[112:115]
  ds_read_b64_tr_b16 v[168:169], v8 offset:16384
  v_mfma_f32_16x16x32_bf16 v[116:119], v[200:203], v[84:87], v[116:119]
  ds_read_b64_tr_b16 v[170:171], v8 offset:16896
  buffer_load_dwordx4 v[64:67], v4, s[36:39], s50 offen offset:0
  v_mfma_f32_16x16x32_bf16 v[120:123], v[204:207], v[80:83], v[120:123]
  ds_read_b64_tr_b16 v[172:173], v9 offset:16384
  v_mfma_f32_16x16x32_bf16 v[124:127], v[204:207], v[84:87], v[124:127]
  ds_read_b64_tr_b16 v[174:175], v9 offset:16896
  s_waitcnt vmcnt(17) lgkmcnt(8)
  s_barrier
  v_mfma_f32_16x16x32_bf16 v[96:99], v[208:211], v[88:91], v[96:99]
  ds_read_b64_tr_b16 v[176:177], v6 offset:20480
  buffer_load_dwordx4 v[68:71], v5, s[36:39], s50 offen offset:0
  v_mfma_f32_16x16x32_bf16 v[100:103], v[208:211], v[92:95], v[100:103]
  ds_read_b64_tr_b16 v[178:179], v6 offset:20992
  v_mfma_f32_16x16x32_bf16 v[104:107], v[212:215], v[88:91], v[104:107]
  ds_read_b64_tr_b16 v[180:181], v7 offset:20480
  v_mfma_f32_16x16x32_bf16 v[108:111], v[212:215], v[92:95], v[108:111]
  ds_read_b64_tr_b16 v[182:183], v7 offset:20992
  buffer_load_dwordx4 v[72:75], v4, s[36:39], s50 offen offset:1024
  v_mfma_f32_16x16x32_bf16 v[112:115], v[216:219], v[88:91], v[112:115]
  ds_read_b64_tr_b16 v[184:185], v8 offset:20480
  v_mfma_f32_16x16x32_bf16 v[116:119], v[216:219], v[92:95], v[116:119]
  ds_read_b64_tr_b16 v[186:187], v8 offset:20992
  v_mfma_f32_16x16x32_bf16 v[120:123], v[220:223], v[88:91], v[120:123]
  ds_read_b64_tr_b16 v[188:189], v9 offset:20480
  buffer_load_dwordx4 v[76:79], v5, s[36:39], s50 offen offset:1024
  v_mfma_f32_16x16x32_bf16 v[124:127], v[220:223], v[92:95], v[124:127]
  ds_read_b64_tr_b16 v[190:191], v9 offset:20992
  s_waitcnt vmcnt(18) lgkmcnt(8)
  v_mfma_f32_16x16x32_bf16 v[96:99], v[160:163], v[224:227], v[96:99]
  ds_read_b64_tr_b16 v[192:193], v6 offset:24576
  v_readlane_b32 s51, v15, 27
  v_mfma_f32_16x16x32_bf16 v[100:103], v[160:163], v[228:231], v[100:103]
  ds_read_b64_tr_b16 v[194:195], v6 offset:25088
  v_mfma_f32_16x16x32_bf16 v[104:107], v[164:167], v[224:227], v[104:107]
  ds_read_b64_tr_b16 v[196:197], v7 offset:24576
  v_mfma_f32_16x16x32_bf16 v[108:111], v[164:167], v[228:231], v[108:111]
  ds_read_b64_tr_b16 v[198:199], v7 offset:25088
  buffer_load_dwordx4 v[80:83], v4, s[36:39], s51 offen offset:0
  v_mfma_f32_16x16x32_bf16 v[112:115], v[168:171], v[224:227], v[112:115]
  ds_read_b64_tr_b16 v[200:201], v8 offset:24576
  v_mfma_f32_16x16x32_bf16 v[116:119], v[168:171], v[228:231], v[116:119]
  ds_read_b64_tr_b16 v[202:203], v8 offset:25088
  v_mfma_f32_16x16x32_bf16 v[120:123], v[172:175], v[224:227], v[120:123]
  ds_read_b64_tr_b16 v[204:205], v9 offset:24576
  buffer_load_dwordx4 v[84:87], v5, s[36:39], s51 offen offset:0
  v_mfma_f32_16x16x32_bf16 v[124:127], v[172:175], v[228:231], v[124:127]
  ds_read_b64_tr_b16 v[206:207], v9 offset:25088
  s_waitcnt vmcnt(18) lgkmcnt(8)
  v_mfma_f32_16x16x32_bf16 v[96:99], v[176:179], v[232:235], v[96:99]
  ds_read_b64_tr_b16 v[208:209], v6 offset:28672
  v_mfma_f32_16x16x32_bf16 v[100:103], v[176:179], v[236:239], v[100:103]
  ds_read_b64_tr_b16 v[210:211], v6 offset:29184
  buffer_load_dwordx4 v[88:91], v4, s[36:39], s51 offen offset:1024
  v_mfma_f32_16x16x32_bf16 v[104:107], v[180:183], v[232:235], v[104:107]
  ds_read_b64_tr_b16 v[212:213], v7 offset:28672
  v_mfma_f32_16x16x32_bf16 v[108:111], v[180:183], v[236:239], v[108:111]
  ds_read_b64_tr_b16 v[214:215], v7 offset:29184
  v_mfma_f32_16x16x32_bf16 v[112:115], v[184:187], v[232:235], v[112:115]
  ds_read_b64_tr_b16 v[216:217], v8 offset:28672
  buffer_load_dwordx4 v[92:95], v5, s[36:39], s51 offen offset:1024
  v_mfma_f32_16x16x32_bf16 v[116:119], v[184:187], v[236:239], v[116:119]
  ds_read_b64_tr_b16 v[218:219], v8 offset:29184
  v_readlane_b32 s48, v15, 28
  v_mfma_f32_16x16x32_bf16 v[120:123], v[188:191], v[232:235], v[120:123]
  ds_read_b64_tr_b16 v[220:221], v9 offset:28672
  v_mfma_f32_16x16x32_bf16 v[124:127], v[188:191], v[236:239], v[124:127]
  ds_read_b64_tr_b16 v[222:223], v9 offset:29184
  s_waitcnt vmcnt(18) lgkmcnt(8)
  v_mfma_f32_16x16x32_bf16 v[96:99], v[192:195], v[240:243], v[96:99]
  ds_read_b64_tr_b16 v[160:161], v6 offset:32768
  buffer_load_dwordx4 v[224:227], v4, s[36:39], s48 offen offset:0
  v_mfma_f32_16x16x32_bf16 v[100:103], v[192:195], v[244:247], v[100:103]
  ds_read_b64_tr_b16 v[162:163], v6 offset:33280
  v_mfma_f32_16x16x32_bf16 v[104:107], v[196:199], v[240:243], v[104:107]
  ds_read_b64_tr_b16 v[164:165], v7 offset:32768
  v_mfma_f32_16x16x32_bf16 v[108:111], v[196:199], v[244:247], v[108:111]
  ds_read_b64_tr_b16 v[166:167], v7 offset:33280
  buffer_load_dwordx4 v[228:231], v5, s[36:39], s48 offen offset:0
  v_mfma_f32_16x16x32_bf16 v[112:115], v[200:203], v[240:243], v[112:115]
  ds_read_b64_tr_b16 v[168:169], v8 offset:32768
  v_mfma_f32_16x16x32_bf16 v[116:119], v[200:203], v[244:247], v[116:119]
  ds_read_b64_tr_b16 v[170:171], v8 offset:33280
  v_mfma_f32_16x16x32_bf16 v[120:123], v[204:207], v[240:243], v[120:123]
  ds_read_b64_tr_b16 v[172:173], v9 offset:32768
  buffer_load_dwordx4 v[232:235], v4, s[36:39], s48 offen offset:1024
  v_mfma_f32_16x16x32_bf16 v[124:127], v[204:207], v[244:247], v[124:127]
  ds_read_b64_tr_b16 v[174:175], v9 offset:33280
  s_waitcnt vmcnt(19) lgkmcnt(8)
  v_mfma_f32_16x16x32_bf16 v[96:99], v[208:211], v[248:251], v[96:99]
  ds_read_b64_tr_b16 v[176:177], v6 offset:36864
  v_mfma_f32_16x16x32_bf16 v[100:103], v[208:211], v[252:255], v[100:103]
  ds_read_b64_tr_b16 v[178:179], v6 offset:37376
  buffer_load_dwordx4 v[236:239], v5, s[36:39], s48 offen offset:1024
  v_mfma_f32_16x16x32_bf16 v[104:107], v[212:215], v[248:251], v[104:107]
  ds_read_b64_tr_b16 v[180:181], v7 offset:36864
  v_mfma_f32_16x16x32_bf16 v[108:111], v[212:215], v[252:255], v[108:111]
  ds_read_b64_tr_b16 v[182:183], v7 offset:37376
  v_mfma_f32_16x16x32_bf16 v[112:115], v[216:219], v[248:251], v[112:115]
  ds_read_b64_tr_b16 v[184:185], v8 offset:36864
  v_mfma_f32_16x16x32_bf16 v[116:119], v[216:219], v[252:255], v[116:119]
  ds_read_b64_tr_b16 v[186:187], v8 offset:37376
  v_readlane_b32 s49, v15, 29
  v_mfma_f32_16x16x32_bf16 v[120:123], v[220:223], v[248:251], v[120:123]
  ds_read_b64_tr_b16 v[188:189], v9 offset:36864
  v_mfma_f32_16x16x32_bf16 v[124:127], v[220:223], v[252:255], v[124:127]
  ds_read_b64_tr_b16 v[190:191], v9 offset:37376
  s_waitcnt vmcnt(18) lgkmcnt(8)
  v_mfma_f32_16x16x32_bf16 v[96:99], v[160:163], v[32:35], v[96:99]
  ds_read_b64_tr_b16 v[192:193], v6 offset:40960
  buffer_load_dwordx4 v[240:243], v4, s[36:39], s49 offen offset:0
  v_mfma_f32_16x16x32_bf16 v[100:103], v[160:163], v[36:39], v[100:103]
  ds_read_b64_tr_b16 v[194:195], v6 offset:41472
  v_mfma_f32_16x16x32_bf16 v[104:107], v[164:167], v[32:35], v[104:107]
  ds_read_b64_tr_b16 v[196:197], v7 offset:40960
  v_mfma_f32_16x16x32_bf16 v[108:111], v[164:167], v[36:39], v[108:111]
  ds_read_b64_tr_b16 v[198:199], v7 offset:41472
  buffer_load_dwordx4 v[244:247], v5, s[36:39], s49 offen offset:0
  v_mfma_f32_16x16x32_bf16 v[112:115], v[168:171], v[32:35], v[112:115]
  ds_read_b64_tr_b16 v[200:201], v8 offset:40960
  v_mfma_f32_16x16x32_bf16 v[116:119], v[168:171], v[36:39], v[116:119]
  ds_read_b64_tr_b16 v[202:203], v8 offset:41472
  v_mfma_f32_16x16x32_bf16 v[120:123], v[172:175], v[32:35], v[120:123]
  ds_read_b64_tr_b16 v[204:205], v9 offset:40960
  buffer_load_dwordx4 v[248:251], v4, s[36:39], s49 offen offset:1024
  v_mfma_f32_16x16x32_bf16 v[124:127], v[172:175], v[36:39], v[124:127]
  ds_read_b64_tr_b16 v[206:207], v9 offset:41472
  s_waitcnt vmcnt(19) lgkmcnt(8)
  v_mfma_f32_16x16x32_bf16 v[96:99], v[176:179], v[40:43], v[96:99]
  ds_read_b64_tr_b16 v[208:209], v6 offset:45056
  v_mfma_f32_16x16x32_bf16 v[100:103], v[176:179], v[44:47], v[100:103]
  ds_read_b64_tr_b16 v[210:211], v6 offset:45568
  buffer_load_dwordx4 v[252:255], v5, s[36:39], s49 offen offset:1024
  v_mfma_f32_16x16x32_bf16 v[104:107], v[180:183], v[40:43], v[104:107]
  ds_read_b64_tr_b16 v[212:213], v7 offset:45056
  v_mfma_f32_16x16x32_bf16 v[108:111], v[180:183], v[44:47], v[108:111]
  ds_read_b64_tr_b16 v[214:215], v7 offset:45568
  v_mfma_f32_16x16x32_bf16 v[112:115], v[184:187], v[40:43], v[112:115]
  ds_read_b64_tr_b16 v[216:217], v8 offset:45056
  v_mfma_f32_16x16x32_bf16 v[116:119], v[184:187], v[44:47], v[116:119]
  ds_read_b64_tr_b16 v[218:219], v8 offset:45568
  v_readlane_b32 s50, v15, 30
  v_mfma_f32_16x16x32_bf16 v[120:123], v[188:191], v[40:43], v[120:123]
  ds_read_b64_tr_b16 v[220:221], v9 offset:45056
  v_mfma_f32_16x16x32_bf16 v[124:127], v[188:191], v[44:47], v[124:127]
  ds_read_b64_tr_b16 v[222:223], v9 offset:45568
  s_waitcnt vmcnt(18) lgkmcnt(8)
  v_mfma_f32_16x16x32_bf16 v[96:99], v[192:195], v[48:51], v[96:99]
  ds_read_b64_tr_b16 v[160:161], v6 offset:49152
  buffer_load_dwordx4 v[32:35], v4, s[36:39], s50 offen offset:0
  v_mfma_f32_16x16x32_bf16 v[100:103], v[192:195], v[52:55], v[100:103]
  ds_read_b64_tr_b16 v[162:163], v6 offset:49664
  v_mfma_f32_16x16x32_bf16 v[104:107], v[196:199], v[48:51], v[104:107]
  ds_read_b64_tr_b16 v[164:165], v7 offset:49152
  v_mfma_f32_16x16x32_bf16 v[108:111], v[196:199], v[52:55], v[108:111]
  ds_read_b64_tr_b16 v[166:167], v7 offset:49664
  buffer_load_dwordx4 v[36:39], v5, s[36:39], s50 offen offset:0
  v_mfma_f32_16x16x32_bf16 v[112:115], v[200:203], v[48:51], v[112:115]
  ds_read_b64_tr_b16 v[168:169], v8 offset:49152
  v_mfma_f32_16x16x32_bf16 v[116:119], v[200:203], v[52:55], v[116:119]
  ds_read_b64_tr_b16 v[170:171], v8 offset:49664
  v_mfma_f32_16x16x32_bf16 v[120:123], v[204:207], v[48:51], v[120:123]
  ds_read_b64_tr_b16 v[172:173], v9 offset:49152
  buffer_load_dwordx4 v[40:43], v4, s[36:39], s50 offen offset:1024
  v_mfma_f32_16x16x32_bf16 v[124:127], v[204:207], v[52:55], v[124:127]
  ds_read_b64_tr_b16 v[174:175], v9 offset:49664
  s_waitcnt vmcnt(19) lgkmcnt(8)
  v_mfma_f32_16x16x32_bf16 v[96:99], v[208:211], v[56:59], v[96:99]
  ds_read_b64_tr_b16 v[176:177], v6 offset:53248
  v_mfma_f32_16x16x32_bf16 v[100:103], v[208:211], v[60:63], v[100:103]
  ds_read_b64_tr_b16 v[178:179], v6 offset:53760
  buffer_load_dwordx4 v[44:47], v5, s[36:39], s50 offen offset:1024
  v_mfma_f32_16x16x32_bf16 v[104:107], v[212:215], v[56:59], v[104:107]
  ds_read_b64_tr_b16 v[180:181], v7 offset:53248
  v_mfma_f32_16x16x32_bf16 v[108:111], v[212:215], v[60:63], v[108:111]
  ds_read_b64_tr_b16 v[182:183], v7 offset:53760
  v_mfma_f32_16x16x32_bf16 v[112:115], v[216:219], v[56:59], v[112:115]
  ds_read_b64_tr_b16 v[184:185], v8 offset:53248
  v_mfma_f32_16x16x32_bf16 v[116:119], v[216:219], v[60:63], v[116:119]
  ds_read_b64_tr_b16 v[186:187], v8 offset:53760
  v_readlane_b32 s51, v15, 31
  v_mfma_f32_16x16x32_bf16 v[120:123], v[220:223], v[56:59], v[120:123]
  ds_read_b64_tr_b16 v[188:189], v9 offset:53248
  v_mfma_f32_16x16x32_bf16 v[124:127], v[220:223], v[60:63], v[124:127]
  ds_read_b64_tr_b16 v[190:191], v9 offset:53760
  s_waitcnt vmcnt(18) lgkmcnt(8)
  v_mfma_f32_16x16x32_bf16 v[96:99], v[160:163], v[64:67], v[96:99]
  ds_read_b64_tr_b16 v[192:193], v6 offset:57344
  buffer_load_dwordx4 v[48:51], v4, s[36:39], s51 offen offset:0
  v_mfma_f32_16x16x32_bf16 v[100:103], v[160:163], v[68:71], v[100:103]
  ds_read_b64_tr_b16 v[194:195], v6 offset:57856
  v_mfma_f32_16x16x32_bf16 v[104:107], v[164:167], v[64:67], v[104:107]
  ds_read_b64_tr_b16 v[196:197], v7 offset:57344
  v_mfma_f32_16x16x32_bf16 v[108:111], v[164:167], v[68:71], v[108:111]
  ds_read_b64_tr_b16 v[198:199], v7 offset:57856
  buffer_load_dwordx4 v[52:55], v5, s[36:39], s51 offen offset:0
  v_mfma_f32_16x16x32_bf16 v[112:115], v[168:171], v[64:67], v[112:115]
  ds_read_b64_tr_b16 v[200:201], v8 offset:57344
  v_mfma_f32_16x16x32_bf16 v[116:119], v[168:171], v[68:71], v[116:119]
  ds_read_b64_tr_b16 v[202:203], v8 offset:57856
  v_mfma_f32_16x16x32_bf16 v[120:123], v[172:175], v[64:67], v[120:123]
  ds_read_b64_tr_b16 v[204:205], v9 offset:57344
  buffer_load_dwordx4 v[56:59], v4, s[36:39], s51 offen offset:1024
  v_mfma_f32_16x16x32_bf16 v[124:127], v[172:175], v[68:71], v[124:127]
  ds_read_b64_tr_b16 v[206:207], v9 offset:57856
  s_waitcnt vmcnt(19) lgkmcnt(8)
  v_mfma_f32_16x16x32_bf16 v[96:99], v[176:179], v[72:75], v[96:99]
  ds_read_b64_tr_b16 v[208:209], v6 offset:61440
  v_mfma_f32_16x16x32_bf16 v[100:103], v[176:179], v[76:79], v[100:103]
  ds_read_b64_tr_b16 v[210:211], v6 offset:61952
  buffer_load_dwordx4 v[60:63], v5, s[36:39], s51 offen offset:1024
  v_mfma_f32_16x16x32_bf16 v[104:107], v[180:183], v[72:75], v[104:107]
  ds_read_b64_tr_b16 v[212:213], v7 offset:61440
  v_mfma_f32_16x16x32_bf16 v[108:111], v[180:183], v[76:79], v[108:111]
  ds_read_b64_tr_b16 v[214:215], v7 offset:61952
  v_mfma_f32_16x16x32_bf16 v[112:115], v[184:187], v[72:75], v[112:115]
  ds_read_b64_tr_b16 v[216:217], v8 offset:61440
  v_mfma_f32_16x16x32_bf16 v[116:119], v[184:187], v[76:79], v[116:119]
  ds_read_b64_tr_b16 v[218:219], v8 offset:61952
  v_readlane_b32 s48, v15, 32
  v_mfma_f32_16x16x32_bf16 v[120:123], v[188:191], v[72:75], v[120:123]
  ds_read_b64_tr_b16 v[220:221], v9 offset:61440
  v_mfma_f32_16x16x32_bf16 v[124:127], v[188:191], v[76:79], v[124:127]
  ds_read_b64_tr_b16 v[222:223], v9 offset:61952
  s_waitcnt vmcnt(18) lgkmcnt(8)
  v_mfma_f32_16x16x32_bf16 v[96:99], v[192:195], v[80:83], v[96:99]
  ds_read_b64_tr_b16 v[160:161], v20 offset:0
  buffer_load_dwordx4 v[64:67], v4, s[36:39], s48 offen offset:0
  v_mfma_f32_16x16x32_bf16 v[100:103], v[192:195], v[84:87], v[100:103]
  ds_read_b64_tr_b16 v[162:163], v20 offset:512
  v_mfma_f32_16x16x32_bf16 v[104:107], v[196:199], v[80:83], v[104:107]
  ds_read_b64_tr_b16 v[164:165], v21 offset:0
  v_mfma_f32_16x16x32_bf16 v[108:111], v[196:199], v[84:87], v[108:111]
  ds_read_b64_tr_b16 v[166:167], v21 offset:512
  buffer_load_dwordx4 v[68:71], v5, s[36:39], s48 offen offset:0
  v_mfma_f32_16x16x32_bf16 v[112:115], v[200:203], v[80:83], v[112:115]
  ds_read_b64_tr_b16 v[168:169], v22 offset:0
  v_mfma_f32_16x16x32_bf16 v[116:119], v[200:203], v[84:87], v[116:119]
  ds_read_b64_tr_b16 v[170:171], v22 offset:512
  v_mfma_f32_16x16x32_bf16 v[120:123], v[204:207], v[80:83], v[120:123]
  ds_read_b64_tr_b16 v[172:173], v23 offset:0
  buffer_load_dwordx4 v[72:75], v4, s[36:39], s48 offen offset:1024
  v_mfma_f32_16x16x32_bf16 v[124:127], v[204:207], v[84:87], v[124:127]
  ds_read_b64_tr_b16 v[174:175], v23 offset:512
  s_waitcnt vmcnt(19) lgkmcnt(8)
  v_mfma_f32_16x16x32_bf16 v[96:99], v[208:211], v[88:91], v[96:99]
  ds_read_b64_tr_b16 v[176:177], v20 offset:4096
  v_mfma_f32_16x16x32_bf16 v[100:103], v[208:211], v[92:95], v[100:103]
  ds_read_b64_tr_b16 v[178:179], v20 offset:4608
  buffer_load_dwordx4 v[76:79], v5, s[36:39], s48 offen offset:1024
  v_mfma_f32_16x16x32_bf16 v[104:107], v[212:215], v[88:91], v[104:107]
  ds_read_b64_tr_b16 v[180:181], v21 offset:4096
  v_mfma_f32_16x16x32_bf16 v[108:111], v[212:215], v[92:95], v[108:111]
  ds_read_b64_tr_b16 v[182:183], v21 offset:4608
  v_mfma_f32_16x16x32_bf16 v[112:115], v[216:219], v[88:91], v[112:115]
  ds_read_b64_tr_b16 v[184:185], v22 offset:4096
  v_mfma_f32_16x16x32_bf16 v[116:119], v[216:219], v[92:95], v[116:119]
  ds_read_b64_tr_b16 v[186:187], v22 offset:4608
  v_readlane_b32 s49, v15, 33
  v_mfma_f32_16x16x32_bf16 v[120:123], v[220:223], v[88:91], v[120:123]
  ds_read_b64_tr_b16 v[188:189], v23 offset:4096
  v_mfma_f32_16x16x32_bf16 v[124:127], v[220:223], v[92:95], v[124:127]
  ds_read_b64_tr_b16 v[190:191], v23 offset:4608
  s_waitcnt vmcnt(18) lgkmcnt(8)
  v_mfma_f32_16x16x32_bf16 v[96:99], v[160:163], v[224:227], v[96:99]
  ds_read_b64_tr_b16 v[192:193], v20 offset:8192
  buffer_load_dwordx4 v[80:83], v4, s[36:39], s49 offen offset:0
  v_mfma_f32_16x16x32_bf16 v[100:103], v[160:163], v[228:231], v[100:103]
  ds_read_b64_tr_b16 v[194:195], v20 offset:8704
  v_mfma_f32_16x16x32_bf16 v[104:107], v[164:167], v[224:227], v[104:107]
  ds_read_b64_tr_b16 v[196:197], v21 offset:8192
  v_mfma_f32_16x16x32_bf16 v[108:111], v[164:167], v[228:231], v[108:111]
  ds_read_b64_tr_b16 v[198:199], v21 offset:8704
  buffer_load_dwordx4 v[84:87], v5, s[36:39], s49 offen offset:0
  v_mfma_f32_16x16x32_bf16 v[112:115], v[168:171], v[224:227], v[112:115]
  ds_read_b64_tr_b16 v[200:201], v22 offset:8192
  v_mfma_f32_16x16x32_bf16 v[116:119], v[168:171], v[228:231], v[116:119]
  ds_read_b64_tr_b16 v[202:203], v22 offset:8704
  v_mfma_f32_16x16x32_bf16 v[120:123], v[172:175], v[224:227], v[120:123]
  ds_read_b64_tr_b16 v[204:205], v23 offset:8192
  buffer_load_dwordx4 v[88:91], v4, s[36:39], s49 offen offset:1024
  v_mfma_f32_16x16x32_bf16 v[124:127], v[172:175], v[228:231], v[124:127]
  ds_read_b64_tr_b16 v[206:207], v23 offset:8704
  s_waitcnt vmcnt(19) lgkmcnt(8)
  v_mfma_f32_16x16x32_bf16 v[96:99], v[176:179], v[232:235], v[96:99]
  ds_read_b64_tr_b16 v[208:209], v20 offset:12288
  v_mfma_f32_16x16x32_bf16 v[100:103], v[176:179], v[236:239], v[100:103]
  ds_read_b64_tr_b16 v[210:211], v20 offset:12800
  buffer_load_dwordx4 v[92:95], v5, s[36:39], s49 offen offset:1024
  v_mfma_f32_16x16x32_bf16 v[104:107], v[180:183], v[232:235], v[104:107]
  ds_read_b64_tr_b16 v[212:213], v21 offset:12288
  v_mfma_f32_16x16x32_bf16 v[108:111], v[180:183], v[236:239], v[108:111]
  ds_read_b64_tr_b16 v[214:215], v21 offset:12800
  v_mfma_f32_16x16x32_bf16 v[112:115], v[184:187], v[232:235], v[112:115]
  ds_read_b64_tr_b16 v[216:217], v22 offset:12288
  v_mfma_f32_16x16x32_bf16 v[116:119], v[184:187], v[236:239], v[116:119]
  ds_read_b64_tr_b16 v[218:219], v22 offset:12800
  v_readlane_b32 s50, v15, 34
  v_mfma_f32_16x16x32_bf16 v[120:123], v[188:191], v[232:235], v[120:123]
  ds_read_b64_tr_b16 v[220:221], v23 offset:12288
  v_mfma_f32_16x16x32_bf16 v[124:127], v[188:191], v[236:239], v[124:127]
  ds_read_b64_tr_b16 v[222:223], v23 offset:12800
  s_waitcnt vmcnt(18) lgkmcnt(8)
  v_mfma_f32_16x16x32_bf16 v[96:99], v[192:195], v[240:243], v[96:99]
  ds_read_b64_tr_b16 v[160:161], v20 offset:16384
  buffer_load_dwordx4 v[224:227], v4, s[36:39], s50 offen offset:0
  v_mfma_f32_16x16x32_bf16 v[100:103], v[192:195], v[244:247], v[100:103]
  ds_read_b64_tr_b16 v[162:163], v20 offset:16896
  v_mfma_f32_16x16x32_bf16 v[104:107], v[196:199], v[240:243], v[104:107]
  ds_read_b64_tr_b16 v[164:165], v21 offset:16384
  v_mfma_f32_16x16x32_bf16 v[108:111], v[196:199], v[244:247], v[108:111]
  ds_read_b64_tr_b16 v[166:167], v21 offset:16896
  buffer_load_dwordx4 v[228:231], v5, s[36:39], s50 offen offset:0
  v_mfma_f32_16x16x32_bf16 v[112:115], v[200:203], v[240:243], v[112:115]
  ds_read_b64_tr_b16 v[168:169], v22 offset:16384
  v_mfma_f32_16x16x32_bf16 v[116:119], v[200:203], v[244:247], v[116:119]
  ds_read_b64_tr_b16 v[170:171], v22 offset:16896
  v_mfma_f32_16x16x32_bf16 v[120:123], v[204:207], v[240:243], v[120:123]
  ds_read_b64_tr_b16 v[172:173], v23 offset:16384
  buffer_load_dwordx4 v[232:235], v4, s[36:39], s50 offen offset:1024
  v_mfma_f32_16x16x32_bf16 v[124:127], v[204:207], v[244:247], v[124:127]
  ds_read_b64_tr_b16 v[174:175], v23 offset:16896
  s_waitcnt vmcnt(19) lgkmcnt(8)
  v_mfma_f32_16x16x32_bf16 v[96:99], v[208:211], v[248:251], v[96:99]
  ds_read_b64_tr_b16 v[176:177], v20 offset:20480
  v_mfma_f32_16x16x32_bf16 v[100:103], v[208:211], v[252:255], v[100:103]
  ds_read_b64_tr_b16 v[178:179], v20 offset:20992
  buffer_load_dwordx4 v[236:239], v5, s[36:39], s50 offen offset:1024
  v_mfma_f32_16x16x32_bf16 v[104:107], v[212:215], v[248:251], v[104:107]
  ds_read_b64_tr_b16 v[180:181], v21 offset:20480
  v_mfma_f32_16x16x32_bf16 v[108:111], v[212:215], v[252:255], v[108:111]
  ds_read_b64_tr_b16 v[182:183], v21 offset:20992
  v_mfma_f32_16x16x32_bf16 v[112:115], v[216:219], v[248:251], v[112:115]
  ds_read_b64_tr_b16 v[184:185], v22 offset:20480
  v_mfma_f32_16x16x32_bf16 v[116:119], v[216:219], v[252:255], v[116:119]
  ds_read_b64_tr_b16 v[186:187], v22 offset:20992
  v_readlane_b32 s51, v15, 35
  v_mfma_f32_16x16x32_bf16 v[120:123], v[220:223], v[248:251], v[120:123]
  ds_read_b64_tr_b16 v[188:189], v23 offset:20480
  v_mfma_f32_16x16x32_bf16 v[124:127], v[220:223], v[252:255], v[124:127]
  ds_read_b64_tr_b16 v[190:191], v23 offset:20992
  s_waitcnt vmcnt(18) lgkmcnt(8)
  v_mfma_f32_16x16x32_bf16 v[96:99], v[160:163], v[32:35], v[96:99]
  ds_read_b64_tr_b16 v[192:193], v20 offset:24576
  buffer_load_dwordx4 v[240:243], v4, s[36:39], s51 offen offset:0
  v_mfma_f32_16x16x32_bf16 v[100:103], v[160:163], v[36:39], v[100:103]
  ds_read_b64_tr_b16 v[194:195], v20 offset:25088
  v_mfma_f32_16x16x32_bf16 v[104:107], v[164:167], v[32:35], v[104:107]
  ds_read_b64_tr_b16 v[196:197], v21 offset:24576
  v_mfma_f32_16x16x32_bf16 v[108:111], v[164:167], v[36:39], v[108:111]
  ds_read_b64_tr_b16 v[198:199], v21 offset:25088
  buffer_load_dwordx4 v[244:247], v5, s[36:39], s51 offen offset:0
  v_mfma_f32_16x16x32_bf16 v[112:115], v[168:171], v[32:35], v[112:115]
  ds_read_b64_tr_b16 v[200:201], v22 offset:24576
  v_mfma_f32_16x16x32_bf16 v[116:119], v[168:171], v[36:39], v[116:119]
  ds_read_b64_tr_b16 v[202:203], v22 offset:25088
  v_mfma_f32_16x16x32_bf16 v[120:123], v[172:175], v[32:35], v[120:123]
  ds_read_b64_tr_b16 v[204:205], v23 offset:24576
  buffer_load_dwordx4 v[248:251], v4, s[36:39], s51 offen offset:1024
  v_mfma_f32_16x16x32_bf16 v[124:127], v[172:175], v[36:39], v[124:127]
  ds_read_b64_tr_b16 v[206:207], v23 offset:25088
  s_waitcnt vmcnt(19) lgkmcnt(8)
  v_mfma_f32_16x16x32_bf16 v[96:99], v[176:179], v[40:43], v[96:99]
  ds_read_b64_tr_b16 v[208:209], v20 offset:28672
  v_mfma_f32_16x16x32_bf16 v[100:103], v[176:179], v[44:47], v[100:103]
  ds_read_b64_tr_b16 v[210:211], v20 offset:29184
  buffer_load_dwordx4 v[252:255], v5, s[36:39], s51 offen offset:1024
  v_mfma_f32_16x16x32_bf16 v[104:107], v[180:183], v[40:43], v[104:107]
  ds_read_b64_tr_b16 v[212:213], v21 offset:28672
  v_mfma_f32_16x16x32_bf16 v[108:111], v[180:183], v[44:47], v[108:111]
  ds_read_b64_tr_b16 v[214:215], v21 offset:29184
  v_mfma_f32_16x16x32_bf16 v[112:115], v[184:187], v[40:43], v[112:115]
  ds_read_b64_tr_b16 v[216:217], v22 offset:28672
  v_mfma_f32_16x16x32_bf16 v[116:119], v[184:187], v[44:47], v[116:119]
  ds_read_b64_tr_b16 v[218:219], v22 offset:29184
  v_mfma_f32_16x16x32_bf16 v[120:123], v[188:191], v[40:43], v[120:123]
  ds_read_b64_tr_b16 v[220:221], v23 offset:28672
  v_mfma_f32_16x16x32_bf16 v[124:127], v[188:191], v[44:47], v[124:127]
  ds_read_b64_tr_b16 v[222:223], v23 offset:29184
  s_waitcnt vmcnt(18) lgkmcnt(8)
  v_mfma_f32_16x16x32_bf16 v[96:99], v[192:195], v[48:51], v[96:99]
  ds_read_b64_tr_b16 v[160:161], v20 offset:32768
  v_mfma_f32_16x16x32_bf16 v[100:103], v[192:195], v[52:55], v[100:103]
  ds_read_b64_tr_b16 v[162:163], v20 offset:33280
  v_mfma_f32_16x16x32_bf16 v[104:107], v[196:199], v[48:51], v[104:107]
  ds_read_b64_tr_b16 v[164:165], v21 offset:32768
  v_mfma_f32_16x16x32_bf16 v[108:111], v[196:199], v[52:55], v[108:111]
  ds_read_b64_tr_b16 v[166:167], v21 offset:33280
  v_mfma_f32_16x16x32_bf16 v[112:115], v[200:203], v[48:51], v[112:115]
  ds_read_b64_tr_b16 v[168:169], v22 offset:32768
  v_mfma_f32_16x16x32_bf16 v[116:119], v[200:203], v[52:55], v[116:119]
  ds_read_b64_tr_b16 v[170:171], v22 offset:33280
  v_mfma_f32_16x16x32_bf16 v[120:123], v[204:207], v[48:51], v[120:123]
  ds_read_b64_tr_b16 v[172:173], v23 offset:32768
  v_mfma_f32_16x16x32_bf16 v[124:127], v[204:207], v[52:55], v[124:127]
  ds_read_b64_tr_b16 v[174:175], v23 offset:33280
  s_waitcnt vmcnt(16) lgkmcnt(8)
  v_mfma_f32_16x16x32_bf16 v[96:99], v[208:211], v[56:59], v[96:99]
  ds_read_b64_tr_b16 v[176:177], v20 offset:36864
  v_mfma_f32_16x16x32_bf16 v[100:103], v[208:211], v[60:63], v[100:103]
  ds_read_b64_tr_b16 v[178:179], v20 offset:37376
  v_mfma_f32_16x16x32_bf16 v[104:107], v[212:215], v[56:59], v[104:107]
  ds_read_b64_tr_b16 v[180:181], v21 offset:36864
  v_mfma_f32_16x16x32_bf16 v[108:111], v[212:215], v[60:63], v[108:111]
  ds_read_b64_tr_b16 v[182:183], v21 offset:37376
  v_mfma_f32_16x16x32_bf16 v[112:115], v[216:219], v[56:59], v[112:115]
  ds_read_b64_tr_b16 v[184:185], v22 offset:36864
  v_mfma_f32_16x16x32_bf16 v[116:119], v[216:219], v[60:63], v[116:119]
  ds_read_b64_tr_b16 v[186:187], v22 offset:37376
  v_mfma_f32_16x16x32_bf16 v[120:123], v[220:223], v[56:59], v[120:123]
  ds_read_b64_tr_b16 v[188:189], v23 offset:36864
  v_mfma_f32_16x16x32_bf16 v[124:127], v[220:223], v[60:63], v[124:127]
  ds_read_b64_tr_b16 v[190:191], v23 offset:37376
  s_waitcnt vmcnt(14) lgkmcnt(8)
  v_mfma_f32_16x16x32_bf16 v[96:99], v[160:163], v[64:67], v[96:99]
  ds_read_b64_tr_b16 v[192:193], v20 offset:40960
  v_mfma_f32_16x16x32_bf16 v[100:103], v[160:163], v[68:71], v[100:103]
  ds_read_b64_tr_b16 v[194:195], v20 offset:41472
  v_mfma_f32_16x16x32_bf16 v[104:107], v[164:167], v[64:67], v[104:107]
  ds_read_b64_tr_b16 v[196:197], v21 offset:40960
  v_mfma_f32_16x16x32_bf16 v[108:111], v[164:167], v[68:71], v[108:111]
  ds_read_b64_tr_b16 v[198:199], v21 offset:41472
  v_mfma_f32_16x16x32_bf16 v[112:115], v[168:171], v[64:67], v[112:115]
  ds_read_b64_tr_b16 v[200:201], v22 offset:40960
  v_mfma_f32_16x16x32_bf16 v[116:119], v[168:171], v[68:71], v[116:119]
  ds_read_b64_tr_b16 v[202:203], v22 offset:41472
  v_mfma_f32_16x16x32_bf16 v[120:123], v[172:175], v[64:67], v[120:123]
  ds_read_b64_tr_b16 v[204:205], v23 offset:40960
  v_mfma_f32_16x16x32_bf16 v[124:127], v[172:175], v[68:71], v[124:127]
  ds_read_b64_tr_b16 v[206:207], v23 offset:41472
  s_waitcnt vmcnt(12) lgkmcnt(8)
  v_mfma_f32_16x16x32_bf16 v[96:99], v[176:179], v[72:75], v[96:99]
  ds_read_b64_tr_b16 v[208:209], v20 offset:45056
  v_mfma_f32_16x16x32_bf16 v[100:103], v[176:179], v[76:79], v[100:103]
  ds_read_b64_tr_b16 v[210:211], v20 offset:45568
  v_mfma_f32_16x16x32_bf16 v[104:107], v[180:183], v[72:75], v[104:107]
  ds_read_b64_tr_b16 v[212:213], v21 offset:45056
  v_mfma_f32_16x16x32_bf16 v[108:111], v[180:183], v[76:79], v[108:111]
  ds_read_b64_tr_b16 v[214:215], v21 offset:45568
  v_mfma_f32_16x16x32_bf16 v[112:115], v[184:187], v[72:75], v[112:115]
  ds_read_b64_tr_b16 v[216:217], v22 offset:45056
  v_mfma_f32_16x16x32_bf16 v[116:119], v[184:187], v[76:79], v[116:119]
  ds_read_b64_tr_b16 v[218:219], v22 offset:45568
  v_mfma_f32_16x16x32_bf16 v[120:123], v[188:191], v[72:75], v[120:123]
  ds_read_b64_tr_b16 v[220:221], v23 offset:45056
  v_mfma_f32_16x16x32_bf16 v[124:127], v[188:191], v[76:79], v[124:127]
  ds_read_b64_tr_b16 v[222:223], v23 offset:45568
  s_waitcnt vmcnt(10) lgkmcnt(8)
  v_mfma_f32_16x16x32_bf16 v[96:99], v[192:195], v[80:83], v[96:99]
  ds_read_b64_tr_b16 v[160:161], v20 offset:49152
  v_mfma_f32_16x16x32_bf16 v[100:103], v[192:195], v[84:87], v[100:103]
  ds_read_b64_tr_b16 v[162:163], v20 offset:49664
  v_mfma_f32_16x16x32_bf16 v[104:107], v[196:199], v[80:83], v[104:107]
  ds_read_b64_tr_b16 v[164:165], v21 offset:49152
  v_mfma_f32_16x16x32_bf16 v[108:111], v[196:199], v[84:87], v[108:111]
  ds_read_b64_tr_b16 v[166:167], v21 offset:49664
  v_mfma_f32_16x16x32_bf16 v[112:115], v[200:203], v[80:83], v[112:115]
  ds_read_b64_tr_b16 v[168:169], v22 offset:49152
  v_mfma_f32_16x16x32_bf16 v[116:119], v[200:203], v[84:87], v[116:119]
  ds_read_b64_tr_b16 v[170:171], v22 offset:49664
  v_mfma_f32_16x16x32_bf16 v[120:123], v[204:207], v[80:83], v[120:123]
  ds_read_b64_tr_b16 v[172:173], v23 offset:49152
  v_mfma_f32_16x16x32_bf16 v[124:127], v[204:207], v[84:87], v[124:127]
  ds_read_b64_tr_b16 v[174:175], v23 offset:49664
  s_waitcnt vmcnt(8) lgkmcnt(8)
  v_mfma_f32_16x16x32_bf16 v[96:99], v[208:211], v[88:91], v[96:99]
  ds_read_b64_tr_b16 v[176:177], v20 offset:53248
  v_mfma_f32_16x16x32_bf16 v[100:103], v[208:211], v[92:95], v[100:103]
  ds_read_b64_tr_b16 v[178:179], v20 offset:53760
  v_mfma_f32_16x16x32_bf16 v[104:107], v[212:215], v[88:91], v[104:107]
  ds_read_b64_tr_b16 v[180:181], v21 offset:53248
  v_mfma_f32_16x16x32_bf16 v[108:111], v[212:215], v[92:95], v[108:111]
  ds_read_b64_tr_b16 v[182:183], v21 offset:53760
  v_mfma_f32_16x16x32_bf16 v[112:115], v[216:219], v[88:91], v[112:115]
  ds_read_b64_tr_b16 v[184:185], v22 offset:53248
  v_mfma_f32_16x16x32_bf16 v[116:119], v[216:219], v[92:95], v[116:119]
  ds_read_b64_tr_b16 v[186:187], v22 offset:53760
  v_mfma_f32_16x16x32_bf16 v[120:123], v[220:223], v[88:91], v[120:123]
  ds_read_b64_tr_b16 v[188:189], v23 offset:53248
  v_mfma_f32_16x16x32_bf16 v[124:127], v[220:223], v[92:95], v[124:127]
  ds_read_b64_tr_b16 v[190:191], v23 offset:53760
  s_waitcnt vmcnt(6) lgkmcnt(8)
  v_mfma_f32_16x16x32_bf16 v[96:99], v[160:163], v[224:227], v[96:99]
  ds_read_b64_tr_b16 v[192:193], v20 offset:57344
  v_mfma_f32_16x16x32_bf16 v[100:103], v[160:163], v[228:231], v[100:103]
  ds_read_b64_tr_b16 v[194:195], v20 offset:57856
  v_mfma_f32_16x16x32_bf16 v[104:107], v[164:167], v[224:227], v[104:107]
  ds_read_b64_tr_b16 v[196:197], v21 offset:57344
  v_mfma_f32_16x16x32_bf16 v[108:111], v[164:167], v[228:231], v[108:111]
  ds_read_b64_tr_b16 v[198:199], v21 offset:57856
  v_mfma_f32_16x16x32_bf16 v[112:115], v[168:171], v[224:227], v[112:115]
  ds_read_b64_tr_b16 v[200:201], v22 offset:57344
  v_mfma_f32_16x16x32_bf16 v[116:119], v[168:171], v[228:231], v[116:119]
  ds_read_b64_tr_b16 v[202:203], v22 offset:57856
  v_mfma_f32_16x16x32_bf16 v[120:123], v[172:175], v[224:227], v[120:123]
  ds_read_b64_tr_b16 v[204:205], v23 offset:57344
  v_mfma_f32_16x16x32_bf16 v[124:127], v[172:175], v[228:231], v[124:127]
  ds_read_b64_tr_b16 v[206:207], v23 offset:57856
  s_waitcnt vmcnt(4) lgkmcnt(8)
  s_barrier
  v_mfma_f32_16x16x32_bf16 v[96:99], v[176:179], v[232:235], v[96:99]
  ds_read_b64_tr_b16 v[208:209], v20 offset:61440
  ds_read_b128 v[144:147], v19 offset:0
  v_mfma_f32_16x16x32_bf16 v[100:103], v[176:179], v[236:239], v[100:103]
  ds_read_b64_tr_b16 v[210:211], v20 offset:61952
  ds_read_b128 v[148:151], v19 offset:1024
  v_mfma_f32_16x16x32_bf16 v[104:107], v[180:183], v[232:235], v[104:107]
  ds_read_b64_tr_b16 v[212:213], v21 offset:61440
  ds_read_b128 v[152:155], v19 offset:2048
  v_mfma_f32_16x16x32_bf16 v[108:111], v[180:183], v[236:239], v[108:111]
  ds_read_b64_tr_b16 v[214:215], v21 offset:61952
  ds_read_b128 v[156:159], v19 offset:3072
  v_mfma_f32_16x16x32_bf16 v[112:115], v[184:187], v[232:235], v[112:115]
  ds_read_b64_tr_b16 v[216:217], v22 offset:61440
  v_mfma_f32_16x16x32_bf16 v[116:119], v[184:187], v[236:239], v[116:119]
  ds_read_b64_tr_b16 v[218:219], v22 offset:61952
  v_mfma_f32_16x16x32_bf16 v[120:123], v[188:191], v[232:235], v[120:123]
  ds_read_b64_tr_b16 v[220:221], v23 offset:61440
  v_mfma_f32_16x16x32_bf16 v[124:127], v[188:191], v[236:239], v[124:127]
  ds_read_b64_tr_b16 v[222:223], v23 offset:61952
  s_waitcnt vmcnt(2) lgkmcnt(12)
  v_mfma_f32_16x16x32_bf16 v[96:99], v[192:195], v[240:243], v[96:99]
  v_mov_b32 v20, 0
  v_mov_b32 v21, 0
  v_mfma_f32_16x16x32_bf16 v[100:103], v[192:195], v[244:247], v[100:103]
  v_mov_b32 v22, 0
  v_mov_b32 v23, 0
  v_mfma_f32_16x16x32_bf16 v[104:107], v[196:199], v[240:243], v[104:107]
  s_waitcnt lgkmcnt(4)
  v_lshlrev_b32 v128, 16, v144
  v_and_b32 v129, s11, v144
  v_mfma_f32_16x16x32_bf16 v[108:111], v[196:199], v[244:247], v[108:111]
  v_lshlrev_b32 v130, 16, v145
  v_and_b32 v131, s11, v145
  v_lshlrev_b32 v132, 16, v146
  v_mfma_f32_16x16x32_bf16 v[112:115], v[200:203], v[240:243], v[112:115]
  v_and_b32 v133, s11, v146
  v_lshlrev_b32 v134, 16, v147
  v_and_b32 v135, s11, v147
  v_mfma_f32_16x16x32_bf16 v[116:119], v[200:203], v[244:247], v[116:119]
  v_lshlrev_b32 v136, 16, v148
  v_and_b32 v137, s11, v148
  v_lshlrev_b32 v138, 16, v149
  v_mfma_f32_16x16x32_bf16 v[120:123], v[204:207], v[240:243], v[120:123]
  v_and_b32 v139, s11, v149
  v_lshlrev_b32 v140, 16, v150
  v_and_b32 v141, s11, v150
  v_mfma_f32_16x16x32_bf16 v[124:127], v[204:207], v[244:247], v[124:127]
  s_waitcnt vmcnt(0) lgkmcnt(0)
  v_lshlrev_b32 v142, 16, v151
  v_and_b32 v143, s11, v151
  v_mfma_f32_16x16x32_bf16 v[96:99], v[208:211], v[248:251], v[96:99]
  v_lshlrev_b32 v144, 16, v152
  v_and_b32 v145, s11, v152
  v_lshlrev_b32 v146, 16, v153
  v_mfma_f32_16x16x32_bf16 v[100:103], v[208:211], v[252:255], v[100:103]
  v_and_b32 v147, s11, v153
  v_lshlrev_b32 v148, 16, v154
  v_and_b32 v149, s11, v154
  v_mfma_f32_16x16x32_bf16 v[104:107], v[212:215], v[248:251], v[104:107]
  v_lshlrev_b32 v150, 16, v155
  v_and_b32 v151, s11, v155
  v_lshlrev_b32 v152, 16, v156
  v_mfma_f32_16x16x32_bf16 v[108:111], v[212:215], v[252:255], v[108:111]
  v_and_b32 v153, s11, v156
  v_lshlrev_b32 v154, 16, v157
  v_and_b32 v155, s11, v157
  v_mfma_f32_16x16x32_bf16 v[112:115], v[216:219], v[248:251], v[112:115]
  v_lshlrev_b32 v156, 16, v158
  v_and_b32 v157, s11, v158
  v_lshlrev_b32 v158, 16, v159
  v_mfma_f32_16x16x32_bf16 v[116:119], v[216:219], v[252:255], v[116:119]
  v_and_b32 v159, s11, v159
  v_mfma_f32_16x16x32_bf16 v[120:123], v[220:223], v[248:251], v[120:123]
  v_mfma_f32_16x16x32_bf16 v[124:127], v[220:223], v[252:255], v[124:127]
  s_lshl_b32 s3, s7, 4
  s_mov_b32 s10, 0x3f803f80
  s_nop 4
  v_pk_add_f32 v[96:97], v[96:97], v[128:129]
  v_pk_add_f32 v[98:99], v[98:99], v[130:131]
  v_cvt_pk_bf16_f32 v240, v96, v97
  v_cvt_pk_bf16_f32 v241, v98, v99
  v_pk_add_f32 v[104:105], v[104:105], v[136:137]
  v_pk_add_f32 v[106:107], v[106:107], v[138:139]
  v_cvt_pk_bf16_f32 v242, v104, v105
  v_cvt_pk_bf16_f32 v243, v106, v107
  s_nop 1
  v_permlane16_swap_b32 v240, v242
  v_permlane16_swap_b32 v241, v243
  buffer_store_dwordx4 v[240:243], v12, s[44:47], 0 offen offset:0 sc1
  v_pk_add_f32 v[112:113], v[112:113], v[144:145]
  v_pk_add_f32 v[114:115], v[114:115], v[146:147]
  v_cvt_pk_bf16_f32 v244, v112, v113
  v_cvt_pk_bf16_f32 v245, v114, v115
  v_pk_add_f32 v[120:121], v[120:121], v[152:153]
  v_pk_add_f32 v[122:123], v[122:123], v[154:155]
  v_cvt_pk_bf16_f32 v246, v120, v121
  v_cvt_pk_bf16_f32 v247, v122, v123
  s_nop 1
  v_permlane16_swap_b32 v244, v246
  v_permlane16_swap_b32 v245, v247
  buffer_store_dwordx4 v[244:247], v12, s[44:47], 0 offen offset:64 sc1
  v_pk_add_f32 v[100:101], v[100:101], v[132:133]
  v_pk_add_f32 v[102:103], v[102:103], v[134:135]
  v_cvt_pk_bf16_f32 v248, v100, v101
  v_cvt_pk_bf16_f32 v249, v102, v103
  v_pk_add_f32 v[108:109], v[108:109], v[140:141]
  v_pk_add_f32 v[110:111], v[110:111], v[142:143]
  v_cvt_pk_bf16_f32 v250, v108, v109
  v_cvt_pk_bf16_f32 v251, v110, v111
  s_nop 1
  v_permlane16_swap_b32 v248, v250
  v_permlane16_swap_b32 v249, v251
  buffer_store_dwordx4 v[248:251], v12, s[44:47], s3 offen offset:0 sc1
  v_pk_add_f32 v[116:117], v[116:117], v[148:149]
  v_pk_add_f32 v[118:119], v[118:119], v[150:151]
  v_cvt_pk_bf16_f32 v252, v116, v117
  v_cvt_pk_bf16_f32 v253, v118, v119
  v_pk_add_f32 v[124:125], v[124:125], v[156:157]
  v_pk_add_f32 v[126:127], v[126:127], v[158:159]
  v_cvt_pk_bf16_f32 v254, v124, v125
  v_cvt_pk_bf16_f32 v255, v126, v127
  s_nop 1
  v_permlane16_swap_b32 v252, v254
  v_permlane16_swap_b32 v253, v255
  buffer_store_dwordx4 v[252:255], v12, s[44:47], s3 offen offset:64 sc1
  v_dot2_f32_bf16 v20, v240, s10, v20
  v_dot2_f32_bf16 v22, v240, v240, v22
  v_dot2_f32_bf16 v20, v241, s10, v20
  v_dot2_f32_bf16 v22, v241, v241, v22
  v_dot2_f32_bf16 v20, v242, s10, v20
  v_dot2_f32_bf16 v22, v242, v242, v22
  v_dot2_f32_bf16 v20, v243, s10, v20
  v_dot2_f32_bf16 v22, v243, v243, v22
  v_dot2_f32_bf16 v20, v244, s10, v20
  v_dot2_f32_bf16 v22, v244, v244, v22
  v_dot2_f32_bf16 v20, v245, s10, v20
  v_dot2_f32_bf16 v22, v245, v245, v22
  v_dot2_f32_bf16 v20, v246, s10, v20
  v_dot2_f32_bf16 v22, v246, v246, v22
  v_dot2_f32_bf16 v20, v247, s10, v20
  v_dot2_f32_bf16 v22, v247, v247, v22
  v_dot2_f32_bf16 v21, v248, s10, v21
  v_dot2_f32_bf16 v23, v248, v248, v23
  v_dot2_f32_bf16 v21, v249, s10, v21
  v_dot2_f32_bf16 v23, v249, v249, v23
  v_dot2_f32_bf16 v21, v250, s10, v21
  v_dot2_f32_bf16 v23, v250, v250, v23
  v_dot2_f32_bf16 v21, v251, s10, v21
  v_dot2_f32_bf16 v23, v251, v251, v23
  v_dot2_f32_bf16 v21, v252, s10, v21
  v_dot2_f32_bf16 v23, v252, v252, v23
  v_dot2_f32_bf16 v21, v253, s10, v21
  v_dot2_f32_bf16 v23, v253, v253, v23
  v_dot2_f32_bf16 v21, v254, s10, v21
  v_dot2_f32_bf16 v23, v254, v254, v23
  v_dot2_f32_bf16 v21, v255, s10, v21
  v_dot2_f32_bf16 v23, v255, v255, v23
  s_nop 2
  v_permlane32_swap_b32 v20, v21
  v_permlane32_swap_b32 v22, v23
  v_add_f32 v20, v20, v21
  v_add_f32 v22, v22, v23
  s_nop 1
  v_permlane16_swap_b32 v20, v22
  v_add_f32 v20, v20, v22
  buffer_store_dword v20, v18, s[56:59], 0 offen sc1
  s_cmp_eq_u32 s96, 1
  s_cbranch_scc1 L_w2_end
  s_waitcnt vmcnt(0) lgkmcnt(0)
  s_barrier
  s_mov_b32 s96, 1
  s_add_u32 s12, s22, 33554432
  s_addc_u32 s13, s23, 0
  s_add_u32 s34, s22, 67108864
  s_addc_u32 s35, s23, 0
  s_add_u32 s97, s97, 1
  s_branch L_attn_body
L_w2_c1:
```

```asm
; @launch grid=(256,1,1) block=(512,1,1) lds=163840
.amdgcn_target "amdgcn-amd-amdhsa--gfx950"
L_attn_c0:
.text
.globl interleave_layers__sliding_local_dilated__dense_activation_gelu__prompt_kernel
.p2align 8
.type interleave_layers__sliding_local_dilated__dense_activation_gelu__prompt_kernel,@function
interleave_layers__sliding_local_dilated__dense_activation_gelu__prompt_kernel:
  s_load_dwordx4 s[16:19], s[0:1], 0
  s_load_dwordx2 s[20:21], s[0:1], 16
  s_load_dwordx2 s[22:23], s[0:1], 80
  s_load_dwordx8 s[24:31], s[0:1], 32
  s_load_dwordx2 s[32:33], s[0:1], 64
  s_load_dwordx2 s[34:35], s[0:1], 80
  s_load_dwordx2 s[12:13], s[0:1], 0
  s_mov_b32 s96, 0
  s_mov_b32 s97, 0
L_attn_body:
  s_cmp_ge_u32 s2, 256
  s_cbranch_scc1 L_attn_end
  v_lshrrev_b32 v2, 6, v0
  v_and_b32 v1, 63, v0
  v_readfirstlane_b32 s70, v2
  s_and_b32 s3, s2, 7
  s_lshr_b32 s99, s2, 3
  s_and_b32 s5, s3, 1
  s_lshl_b32 s5, s5, 3
  s_and_b32 s6, s99, 7
  s_add_u32 s68, s5, s6
  s_lshr_b32 s5, s3, 1
  s_lshl_b32 s5, s5, 2
  s_lshr_b32 s6, s99, 3
  s_add_u32 s69, s5, s6
  s_cmp_lt_u32 s70, 4
  s_cbranch_scc1 L_attn_compute
L_attn_loader:
  s_add_u32 s8, s70, s69
  s_and_b32 s8, s8, 3
  s_add_u32 s9, s70, s68
  s_and_b32 s9, s9, 3
  s_lshl_b32 s76, s8, 12
  s_lshl_b32 s77, s9, 11
  s_add_u32 s77, s77, 16384
  s_lshl_b32 s11, s68, 7
  v_and_b32 v10, 7, v1
  v_lshrrev_b32 v3, 3, v1
  s_lshr_b32 s10, s76, 7
  s_lshl_b32 s3, s68, 7
  s_add_u32 s10, s10, s3
  v_add_u32 v3, s10, v3
  s_cmp_eq_u32 s96, 1
  s_cselect_b32 s5, 128, 0
  s_add_u32 s5, s5, 2048
  s_lshl_b32 s6, s5, 3
  v_mul_u32_u24 v3, s5, v3
  v_lshrrev_b32 v2, 4, v1
  v_xor_b32 v4, v2, v10
  v_lshl_add_u32 v4, v4, 4, v3
  v_add_u32 v3, s6, v3
  v_add_u32 v5, 4, v2
  v_xor_b32 v5, v5, v10
  v_lshl_add_u32 v5, v5, 4, v3
  v_add_u32 v3, s6, v3
  v_xor_b32 v6, v2, v10
  v_lshl_add_u32 v6, v6, 4, v3
  v_add_u32 v3, s6, v3
  v_add_u32 v7, 4, v2
  v_xor_b32 v7, v7, v10
  v_lshl_add_u32 v7, v7, 4, v3
  v_lshrrev_b32 v3, 3, v1
  s_lshl_b32 s10, s9, 4
  v_add_u32 v3, s10, v3
  v_mul_u32_u24 v3, 6144, v3
  v_lshrrev_b32 v2, 3, v1
  v_and_b32 v2, 2, v2
  v_xor_b32 v2, v2, v10
  s_mul_i32 s10, s69, 128
  v_add_u32 v3, s10, v3
  v_lshl_add_u32 v8, v2, 4, v3
  v_xor_b32 v2, 4, v2
  v_add_u32 v3, 49152, v3
  v_lshl_add_u32 v9, v2, 4, v3
  s_and_b32 s10, s70, 3
  s_lshl_b32 s78, s10, 9
  s_add_u32 s78, s78, 40960
  s_lshl_b32 s14, s10, 2
  s_add_u32 s14, s14, s11
  s_sub_u32 s14, s14, 16
  v_lshrrev_b32 v3, 3, v1
  v_add_u32 v3, s14, v3
  v_max_i32 v3, 0, v3
  v_mul_u32_u24 v3, s5, v3
  s_lshl_b32 s14, s10, 1
  v_lshrrev_b32 v2, 4, v1
  v_add_u32 v2, s14, v2
  v_and_b32 v2, 7, v2
  v_xor_b32 v2, v2, v10
  v_lshl_add_u32 v28, v2, 4, v3
  s_cmp_eq_u32 s10, 0
  s_cselect_b32 s14, 0xffffff00, -1
  s_mov_b32 s15, 0
  s_mov_b32 s75, 0
  s_add_u32 s100, s68, s69
  s_mov_b32 s101, -1
  s_add_u32 s101, s101, 1
  s_sub_u32 s73, s101, s100
  s_lshl_b32 s73, s73, 3
  s_lshr_b32 s73, 0xf0f02, s73
  s_and_b32 s73, s73, 255
  s_add_u32 s73, s73, s101
  s_and_b32 s73, s73, 15
  s_mul_i32 s74, s73, 393216
  s_lshl_b32 s73, s73, 7
  s_waitcnt lgkmcnt(0)
  s_mov_b32 s36, s12
  s_and_b32 s37, s13, 0xffff
  s_mov_b32 s38, 4194304
  s_mov_b32 s39, 0x00020000
  s_cmp_eq_u32 s96, 1
  s_cselect_b32 s38, 128, 0
  s_add_u32 s38, s38, 2048
  s_lshl_b32 s38, s38, 11
  s_mov_b32 s40, s18
  s_and_b32 s41, s19, 0xffff
  s_mov_b32 s42, 6291456
  s_mov_b32 s43, 0x00020000
  s_cmp_lg_u32 s96, 0
  s_cbranch_scc1 L_attn_ld1
  s_mov_b32 s48, s28
  s_and_b32 s49, s29, 0xffff
  s_mov_b32 s50, 7340032
  s_mov_b32 s51, 0x00020000
  s_cmp_eq_u32 s96, 0
  s_cselect_b32 s50, s50, 0
  s_and_b32 s3, s70, 3
  s_lshl_b32 s4, s2, 2
  s_add_u32 s3, s3, s4
  s_mul_i32 s98, s3, 3584
  s_add_u32 s98, s98, 0
  s_add_u32 s3, s75, s76
  s_add_u32 m0, s3, 0
  s_nop 0
  buffer_load_dwordx4 v4, s[36:39], s73 offen lds
  s_add_u32 m0, s3, 1024
  s_nop 0
  buffer_load_dwordx4 v5, s[36:39], s73 offen lds
  s_add_u32 m0, s3, 2048
  s_nop 0
  buffer_load_dwordx4 v6, s[36:39], s73 offen lds
  s_add_u32 m0, s3, 3072
  s_nop 0
  buffer_load_dwordx4 v7, s[36:39], s73 offen lds
  s_add_u32 m0, s78, s75
  s_mov_b64 exec, s[14:15]
  buffer_load_dwordx4 v28, s[36:39], s73 offen lds
  s_mov_b64 exec, -1
  s_add_u32 s3, s75, s77
  s_add_u32 m0, s3, 0
  s_add_u32 s4, s74, 0
  buffer_load_dwordx4 v8, s[40:43], s4 offen lds
  s_add_u32 m0, s3, 1024
  s_nop 0
  buffer_load_dwordx4 v9, s[40:43], s4 offen lds
  s_add_u32 m0, s3, 8192
  s_add_u32 s4, s74, 2048
  buffer_load_dwordx4 v8, s[40:43], s4 offen lds
  s_add_u32 m0, s3, 9216
  s_nop 0
  buffer_load_dwordx4 v9, s[40:43], s4 offen lds
  s_add_u32 m0, s3, 16384
  s_add_u32 s4, s74, 4096
  buffer_load_dwordx4 v8, s[40:43], s4 offen lds
  s_add_u32 m0, s3, 17408
  s_nop 0
  buffer_load_dwordx4 v9, s[40:43], s4 offen lds
  s_add_u32 s101, s101, 1
  s_sub_u32 s73, s101, s100
  s_lshl_b32 s73, s73, 3
  s_lshr_b32 s73, 0xf0f02, s73
  s_and_b32 s73, s73, 255
  s_add_u32 s73, s73, s101
  s_and_b32 s73, s73, 15
  s_mul_i32 s74, s73, 393216
  s_lshl_b32 s73, s73, 7
  s_add_u32 s75, s75, 43008
  s_cmp_eq_u32 s75, 129024
  s_cselect_b32 s75, 0, s75
  s_add_u32 s3, s75, s76
  s_add_u32 m0, s3, 0
  s_nop 0
  buffer_load_dwordx4 v4, s[36:39], s73 offen lds
  s_add_u32 m0, s3, 1024
  s_nop 0
  buffer_load_dwordx4 v5, s[36:39], s73 offen lds
  s_add_u32 m0, s3, 2048
  s_nop 0
  buffer_load_dwordx4 v6, s[36:39], s73 offen lds
  s_add_u32 m0, s3, 3072
  s_nop 0
  buffer_load_dwordx4 v7, s[36:39], s73 offen lds
  s_add_u32 m0, s78, s75
  s_mov_b64 exec, s[14:15]
  buffer_load_dwordx4 v28, s[36:39], s73 offen lds
  s_mov_b64 exec, -1
  s_add_u32 s3, s75, s77
  s_add_u32 m0, s3, 0
  s_add_u32 s4, s74, 0
  buffer_load_dwordx4 v8, s[40:43], s4 offen lds
  s_add_u32 m0, s3, 1024
  s_nop 0
  buffer_load_dwordx4 v9, s[40:43], s4 offen lds
  s_add_u32 m0, s3, 8192
  s_add_u32 s4, s74, 2048
  buffer_load_dwordx4 v8, s[40:43], s4 offen lds
  s_add_u32 m0, s3, 9216
  s_nop 0
  buffer_load_dwordx4 v9, s[40:43], s4 offen lds
  s_add_u32 m0, s3, 16384
  s_add_u32 s4, s74, 4096
  buffer_load_dwordx4 v8, s[40:43], s4 offen lds
  s_add_u32 m0, s3, 17408
  s_nop 0
  buffer_load_dwordx4 v9, s[40:43], s4 offen lds
  s_add_u32 s101, s101, 1
  s_sub_u32 s73, s101, s100
  s_lshl_b32 s73, s73, 3
  s_lshr_b32 s73, 0xf0f02, s73
  s_and_b32 s73, s73, 255
  s_add_u32 s73, s73, s101
  s_and_b32 s73, s73, 15
  s_mul_i32 s74, s73, 393216
  s_lshl_b32 s73, s73, 7
  s_add_u32 s75, s75, 43008
  s_cmp_eq_u32 s75, 129024
  s_cselect_b32 s75, 0, s75
  s_and_b32 s3, s70, 3
  s_lshl_b32 s4, s2, 2
  s_add_u32 s3, s3, s4
  s_sub_u32 s4, 384, s40
  s_and_b32 s4, s4, 0x380
  s_mul_i32 s5, s3, 6144
  s_add_u32 s5, s5, s4
  s_buffer_load_dword s84, s[40:43], s5 offset:0
  s_buffer_load_dword s84, s[40:43], s5 offset:64
  s_buffer_load_dword s84, s[40:43], s5 offset:1024
  s_buffer_load_dword s84, s[40:43], s5 offset:1088
  s_buffer_load_dword s84, s[40:43], s5 offset:2048
  s_buffer_load_dword s84, s[40:43], s5 offset:2112
  s_buffer_load_dword s84, s[40:43], s5 offset:3072
  s_buffer_load_dword s84, s[40:43], s5 offset:3136
  s_buffer_load_dword s84, s[40:43], s5 offset:4096
  s_buffer_load_dword s84, s[40:43], s5 offset:4160
  s_buffer_load_dword s84, s[40:43], s5 offset:5120
  s_buffer_load_dword s84, s[40:43], s5 offset:5184
  s_waitcnt vmcnt(11)
  s_barrier
  s_mov_b32 s79, 13
L_attn0_ld1:
  s_add_u32 s3, s75, s76
  s_add_u32 m0, s3, 0
  s_nop 0
  buffer_load_dwordx4 v4, s[36:39], s73 offen lds
  s_add_u32 m0, s3, 1024
  s_nop 0
  buffer_load_dwordx4 v5, s[36:39], s73 offen lds
  s_add_u32 m0, s3, 2048
  s_nop 0
  buffer_load_dwordx4 v6, s[36:39], s73 offen lds
  s_add_u32 m0, s3, 3072
  s_nop 0
  buffer_load_dwordx4 v7, s[36:39], s73 offen lds
  s_add_u32 m0, s78, s75
  s_mov_b64 exec, s[14:15]
  buffer_load_dwordx4 v28, s[36:39], s73 offen lds
  s_mov_b64 exec, -1
  s_add_u32 s3, s75, s77
  s_add_u32 m0, s3, 0
  s_add_u32 s4, s74, 0
  buffer_load_dwordx4 v8, s[40:43], s4 offen lds
  s_add_u32 m0, s3, 1024
  s_nop 0
  buffer_load_dwordx4 v9, s[40:43], s4 offen lds
  s_add_u32 m0, s3, 8192
  s_add_u32 s4, s74, 2048
  buffer_load_dwordx4 v8, s[40:43], s4 offen lds
  s_add_u32 m0, s3, 9216
  s_nop 0
  buffer_load_dwordx4 v9, s[40:43], s4 offen lds
  s_add_u32 m0, s3, 16384
  s_add_u32 s4, s74, 4096
  buffer_load_dwordx4 v8, s[40:43], s4 offen lds
  s_add_u32 m0, s3, 17408
  s_nop 0
  buffer_load_dwordx4 v9, s[40:43], s4 offen lds
  s_add_u32 s101, s101, 1
  s_sub_u32 s73, s101, s100
  s_lshl_b32 s73, s73, 3
  s_lshr_b32 s73, 0xf0f02, s73
  s_and_b32 s73, s73, 255
  s_add_u32 s73, s73, s101
  s_and_b32 s73, s73, 15
  s_mul_i32 s74, s73, 393216
  s_lshl_b32 s73, s73, 7
  s_add_u32 s75, s75, 43008
  s_cmp_eq_u32 s75, 129024
  s_cselect_b32 s75, 0, s75
  s_buffer_load_dword s84, s[48:51], s98 offset:0
  s_buffer_load_dword s84, s[48:51], s98 offset:64
  s_buffer_load_dword s84, s[48:51], s98 offset:128
  s_buffer_load_dword s84, s[48:51], s98 offset:192
  s_add_u32 s98, s98, 256
  s_waitcnt vmcnt(11)
  s_barrier
  s_sub_u32 s79, s79, 1
  s_cmp_lg_u32 s79, 0
  s_cbranch_scc1 L_attn0_ld1
  s_add_u32 s3, s75, s76
  s_add_u32 m0, s3, 0
  s_nop 0
  buffer_load_dwordx4 v4, s[36:39], s73 offen lds
  s_add_u32 m0, s3, 1024
  s_nop 0
  buffer_load_dwordx4 v5, s[36:39], s73 offen lds
  s_add_u32 m0, s3, 2048
  s_nop 0
  buffer_load_dwordx4 v6, s[36:39], s73 offen lds
  s_add_u32 m0, s3, 3072
  s_nop 0
  buffer_load_dwordx4 v7, s[36:39], s73 offen lds
  s_add_u32 m0, s78, s75
  s_mov_b64 exec, s[14:15]
  buffer_load_dwordx4 v28, s[36:39], s73 offen lds
  s_mov_b64 exec, -1
  s_add_u32 s3, s75, s77
  s_add_u32 m0, s3, 0
  s_add_u32 s4, s74, 0
  buffer_load_dwordx4 v8, s[40:43], s4 offen lds
  s_add_u32 m0, s3, 1024
  s_nop 0
  buffer_load_dwordx4 v9, s[40:43], s4 offen lds
  s_add_u32 m0, s3, 8192
  s_add_u32 s4, s74, 2048
  buffer_load_dwordx4 v8, s[40:43], s4 offen lds
  s_add_u32 m0, s3, 9216
  s_nop 0
  buffer_load_dwordx4 v9, s[40:43], s4 offen lds
  s_add_u32 m0, s3, 16384
  s_add_u32 s4, s74, 4096
  buffer_load_dwordx4 v8, s[40:43], s4 offen lds
  s_add_u32 m0, s3, 17408
  s_nop 0
  buffer_load_dwordx4 v9, s[40:43], s4 offen lds
  s_add_u32 s101, s101, 1
  s_sub_u32 s73, s101, s100
  s_lshl_b32 s73, s73, 3
  s_lshr_b32 s73, 0xf0f02, s73
  s_and_b32 s73, s73, 255
  s_add_u32 s73, s73, s101
  s_and_b32 s73, s73, 15
  s_mul_i32 s74, s73, 393216
  s_lshl_b32 s73, s73, 7
  s_add_u32 s75, s75, 43008
  s_cmp_eq_u32 s75, 129024
  s_cselect_b32 s75, 0, s75
  s_buffer_load_dword s84, s[48:51], s98 offset:0
  s_buffer_load_dword s84, s[48:51], s98 offset:64
  s_buffer_load_dword s84, s[48:51], s98 offset:128
  s_buffer_load_dword s84, s[48:51], s98 offset:192
  s_add_u32 s98, s98, 256
  s_mov_b32 s64, s24
  s_and_b32 s65, s25, 0xffff
  s_mov_b32 s66, 7340032
  s_mov_b32 s67, 0x00020000
  s_min_u32 s3, s2, 223
  s_mul_i32 s4, s3, 4682
  s_lshr_b32 s4, s4, 16
  s_mul_i32 s5, s4, 14
  s_sub_u32 s3, s3, s5
  s_lshl_b32 s3, s3, 2
  s_and_b32 s5, s70, 3
  s_add_u32 s3, s3, s5
  s_mul_i32 s5, s4, 458752
  s_lshl_b32 s8, s3, 7
  s_add_u32 s5, s5, s8
  s_lshl_b32 s9, s4, 14
  s_lshl_b32 s8, s3, 8
  s_add_u32 s94, s9, s8
  v_lshrrev_b32 v2, 3, v1
  v_mul_u32_u24 v2, 7168, v2
  v_and_b32 v3, 7, v1
  v_lshl_add_u32 v2, v3, 4, v2
  buffer_load_dwordx4 v[64:67], v2, s[64:67], s5 offen
  s_add_u32 s5, s5, 57344
  buffer_load_dwordx4 v[68:71], v2, s[64:67], s5 offen
  s_add_u32 s5, s5, 57344
  buffer_load_dwordx4 v[72:75], v2, s[64:67], s5 offen
  s_add_u32 s5, s5, 57344
  buffer_load_dwordx4 v[76:79], v2, s[64:67], s5 offen
  s_add_u32 s5, s5, 57344
  buffer_load_dwordx4 v[80:83], v2, s[64:67], s5 offen
  s_add_u32 s5, s5, 57344
  buffer_load_dwordx4 v[84:87], v2, s[64:67], s5 offen
  s_add_u32 s5, s5, 57344
  buffer_load_dwordx4 v[88:91], v2, s[64:67], s5 offen
  s_add_u32 s5, s5, 57344
  buffer_load_dwordx4 v[92:95], v2, s[64:67], s5 offen
  s_mov_b32 s60, s20
  s_and_b32 s61, s21, 0xffff
  s_mov_b32 s62, 2097152
  s_mov_b32 s63, 0x00020000
  s_and_b32 s3, s70, 3
  s_mul_i32 s3, s3, 8
  s_mul_i32 s4, s99, 32
  s_add_u32 s3, s3, s4
  v_lshrrev_b32 v2, 3, v1
  v_add_u32 v2, s3, v2
  v_mul_u32_u24 v2, 2048, v2
  v_and_b32 v3, 7, v1
  v_lshl_add_u32 v2, v3, 8, v2
  s_and_b32 s3, s2, 7
  s_lshr_b32 s3, s3, 2
  s_mul_i32 s3, s3, 128
  buffer_load_dword v96, v2, s[60:63], s3 offen
  s_waitcnt vmcnt(20)
  s_barrier
  s_waitcnt vmcnt(9)
  s_barrier
  s_barrier
  s_barrier
  s_barrier
  s_branch L_attn_ldend
L_attn_ld1:
  s_add_u32 s56, s22, 24379392
  s_addc_u32 s57, s23, 0
  s_and_b32 s57, s57, 0xffff
  s_mov_b32 s58, 262144
  s_mov_b32 s59, 0x00020000
  s_mov_b32 s75, 86016
  s_add_u32 s44, s22, 41943040
  s_addc_u32 s45, s23, 0
  s_and_b32 s45, s45, 0xffff
  s_mov_b32 s46, 524288
  s_mov_b32 s47, 0x00020000
  s_lshl4_add_u32 s3, s97, s68
  s_and_b32 s4, s69, 15
  s_lshl4_add_u32 s3, s3, s4
  s_lshl_b32 s3, s3, 7
  s_sub_u32 s3, s3, 32768
  v_lshlrev_b32 v11, 7, v1
  s_cmp_eq_u32 s68, 0
  s_cselect_b32 s4, 15, 31
  v_and_b32 v2, 16, v1
  v_lshl_add_u32 v11, v2, 2, v11
  v_and_b32 v2, s4, v1
  v_lshlrev_b32 v2, 2, v2
  v_mov_b32 v3, 1
  s_mov_b32 s79, 0x100000
  s_cmp_lg_u32 s70, 4
  s_barrier
  s_cbranch_scc1 L_attn_nofl
  s_mov_b32 exec_lo, 0xffffffff
  s_mov_b32 exec_hi, 0
  buffer_store_dword v3, v11, s[44:47], s87 offen sc1
  s_mov_b64 exec, -1
L_attn_nofl:
  s_mov_b32 s5, s3
  s_mov_b32 s88, s73
  s_add_u32 m0, s77, 0
  s_add_u32 s4, s74, 0
  buffer_load_dwordx4 v8, s[40:43], s4 offen lds
  s_add_u32 m0, s77, 1024
  s_nop 0
  buffer_load_dwordx4 v9, s[40:43], s4 offen lds
  s_add_u32 m0, s77, 8192
  s_add_u32 s4, s74, 2048
  buffer_load_dwordx4 v8, s[40:43], s4 offen lds
  s_add_u32 m0, s77, 9216
  s_nop 0
  buffer_load_dwordx4 v9, s[40:43], s4 offen lds
  s_add_u32 m0, s77, 16384
  s_add_u32 s4, s74, 4096
  buffer_load_dwordx4 v8, s[40:43], s4 offen lds
  s_add_u32 m0, s77, 17408
  s_nop 0
  buffer_load_dwordx4 v9, s[40:43], s4 offen lds
  s_add_u32 s101, s101, 1
  s_sub_u32 s73, s101, s100
  s_lshl_b32 s73, s73, 3
  s_lshr_b32 s73, 0xf0f02, s73
  s_and_b32 s73, s73, 255
  s_add_u32 s73, s73, s101
  s_and_b32 s73, s73, 15
  s_mul_i32 s74, s73, 393216
  s_lshl_b32 s73, s73, 7
  s_mov_b32 s89, s73
  s_add_u32 m0, s77, 43008
  s_add_u32 s4, s74, 0
  buffer_load_dwordx4 v8, s[40:43], s4 offen lds
  s_add_u32 m0, s77, 44032
  s_nop 0
  buffer_load_dwordx4 v9, s[40:43], s4 offen lds
  s_add_u32 m0, s77, 51200
  s_add_u32 s4, s74, 2048
  buffer_load_dwordx4 v8, s[40:43], s4 offen lds
  s_add_u32 m0, s77, 52224
  s_nop 0
  buffer_load_dwordx4 v9, s[40:43], s4 offen lds
  s_add_u32 m0, s77, 59392
  s_add_u32 s4, s74, 4096
  buffer_load_dwordx4 v8, s[40:43], s4 offen lds
  s_add_u32 m0, s77, 60416
  s_nop 0
  buffer_load_dwordx4 v9, s[40:43], s4 offen lds
  s_add_u32 s101, s101, 1
  s_sub_u32 s73, s101, s100
  s_lshl_b32 s73, s73, 3
  s_lshr_b32 s73, 0xf0f02, s73
  s_and_b32 s73, s73, 255
  s_add_u32 s73, s73, s101
  s_and_b32 s73, s73, 15
  s_mul_i32 s74, s73, 393216
  s_lshl_b32 s73, s73, 7
  s_mov_b32 s3, s5
  s_cmp_lg_u32 s70, 4
  s_cbranch_scc1 L_attn_dep
L_attn_poll:
  buffer_load_dword v3, v2, s[44:47], s3 offen sc1
  s_sub_u32 s79, s79, 1
  s_cbranch_scc1 L_attn_dep
  s_waitcnt vmcnt(0)
  v_cmp_ne_u32 vcc, 1, v3
  s_cbranch_vccnz L_attn_poll
L_attn_dep:
  s_barrier
  s_add_u32 m0, s76, 0
  s_nop 0
  buffer_load_dwordx4 v4, s[36:39], s88 offen lds
  s_add_u32 m0, s76, 1024
  s_nop 0
  buffer_load_dwordx4 v5, s[36:39], s88 offen lds
  s_add_u32 m0, s76, 2048
  s_nop 0
  buffer_load_dwordx4 v6, s[36:39], s88 offen lds
  s_add_u32 m0, s76, 3072
  s_nop 0
  buffer_load_dwordx4 v7, s[36:39], s88 offen lds
  s_add_u32 m0, s78, 0
  s_mov_b64 exec, s[14:15]
  buffer_load_dwordx4 v28, s[36:39], s88 offen lds
  s_mov_b64 exec, -1
  s_add_u32 m0, s76, 43008
  s_nop 0
  buffer_load_dwordx4 v4, s[36:39], s89 offen lds
  s_add_u32 m0, s76, 44032
  s_nop 0
  buffer_load_dwordx4 v5, s[36:39], s89 offen lds
  s_add_u32 m0, s76, 45056
  s_nop 0
  buffer_load_dwordx4 v6, s[36:39], s89 offen lds
  s_add_u32 m0, s76, 46080
  s_nop 0
  buffer_load_dwordx4 v7, s[36:39], s89 offen lds
  s_add_u32 m0, s78, 43008
  s_mov_b64 exec, s[14:15]
  buffer_load_dwordx4 v28, s[36:39], s89 offen lds
  s_mov_b64 exec, -1
  s_waitcnt vmcnt(5)
  s_barrier
  s_mov_b32 s79, 13
L_attn1_ld1:
  s_add_u32 s3, s75, s76
  s_add_u32 m0, s3, 0
  s_nop 0
  buffer_load_dwordx4 v4, s[36:39], s73 offen lds
  s_add_u32 m0, s3, 1024
  s_nop 0
  buffer_load_dwordx4 v5, s[36:39], s73 offen lds
  s_add_u32 m0, s3, 2048
  s_nop 0
  buffer_load_dwordx4 v6, s[36:39], s73 offen lds
  s_add_u32 m0, s3, 3072
  s_nop 0
  buffer_load_dwordx4 v7, s[36:39], s73 offen lds
  s_add_u32 m0, s78, s75
  s_mov_b64 exec, s[14:15]
  buffer_load_dwordx4 v28, s[36:39], s73 offen lds
  s_mov_b64 exec, -1
  s_add_u32 s3, s75, s77
  s_add_u32 m0, s3, 0
  s_add_u32 s4, s74, 0
  buffer_load_dwordx4 v8, s[40:43], s4 offen lds
  s_add_u32 m0, s3, 1024
  s_nop 0
  buffer_load_dwordx4 v9, s[40:43], s4 offen lds
  s_add_u32 m0, s3, 8192
  s_add_u32 s4, s74, 2048
  buffer_load_dwordx4 v8, s[40:43], s4 offen lds
  s_add_u32 m0, s3, 9216
  s_nop 0
  buffer_load_dwordx4 v9, s[40:43], s4 offen lds
  s_add_u32 m0, s3, 16384
  s_add_u32 s4, s74, 4096
  buffer_load_dwordx4 v8, s[40:43], s4 offen lds
  s_add_u32 m0, s3, 17408
  s_nop 0
  buffer_load_dwordx4 v9, s[40:43], s4 offen lds
  s_add_u32 s101, s101, 1
  s_sub_u32 s73, s101, s100
  s_lshl_b32 s73, s73, 3
  s_lshr_b32 s73, 0xf0f02, s73
  s_and_b32 s73, s73, 255
  s_add_u32 s73, s73, s101
  s_and_b32 s73, s73, 15
  s_mul_i32 s74, s73, 393216
  s_lshl_b32 s73, s73, 7
  s_add_u32 s75, s75, 43008
  s_cmp_eq_u32 s75, 129024
  s_cselect_b32 s75, 0, s75
  s_waitcnt vmcnt(11)
  s_barrier
  s_sub_u32 s79, s79, 1
  s_cmp_lg_u32 s79, 0
  s_cbranch_scc1 L_attn1_ld1
  s_add_u32 s3, s75, s76
  s_add_u32 m0, s3, 0
  s_nop 0
  buffer_load_dwordx4 v4, s[36:39], s73 offen lds
  s_add_u32 m0, s3, 1024
  s_nop 0
  buffer_load_dwordx4 v5, s[36:39], s73 offen lds
  s_add_u32 m0, s3, 2048
  s_nop 0
  buffer_load_dwordx4 v6, s[36:39], s73 offen lds
  s_add_u32 m0, s3, 3072
  s_nop 0
  buffer_load_dwordx4 v7, s[36:39], s73 offen lds
  s_add_u32 m0, s78, s75
  s_mov_b64 exec, s[14:15]
  buffer_load_dwordx4 v28, s[36:39], s73 offen lds
  s_mov_b64 exec, -1
  s_add_u32 s3, s75, s77
  s_add_u32 m0, s3, 0
  s_add_u32 s4, s74, 0
  buffer_load_dwordx4 v8, s[40:43], s4 offen lds
  s_add_u32 m0, s3, 1024
  s_nop 0
  buffer_load_dwordx4 v9, s[40:43], s4 offen lds
  s_add_u32 m0, s3, 8192
  s_add_u32 s4, s74, 2048
  buffer_load_dwordx4 v8, s[40:43], s4 offen lds
  s_add_u32 m0, s3, 9216
  s_nop 0
  buffer_load_dwordx4 v9, s[40:43], s4 offen lds
  s_add_u32 m0, s3, 16384
  s_add_u32 s4, s74, 4096
  buffer_load_dwordx4 v8, s[40:43], s4 offen lds
  s_add_u32 m0, s3, 17408
  s_nop 0
  buffer_load_dwordx4 v9, s[40:43], s4 offen lds
  s_add_u32 s101, s101, 1
  s_sub_u32 s73, s101, s100
  s_lshl_b32 s73, s73, 3
  s_lshr_b32 s73, 0xf0f02, s73
  s_and_b32 s73, s73, 255
  s_add_u32 s73, s73, s101
  s_and_b32 s73, s73, 15
  s_mul_i32 s74, s73, 393216
  s_lshl_b32 s73, s73, 7
  s_add_u32 s75, s75, 43008
  s_cmp_eq_u32 s75, 129024
  s_cselect_b32 s75, 0, s75
  s_and_b32 s3, s70, 3
  s_lshl_b32 s4, s68, 7
  s_lshl_b32 s5, s3, 6
  s_add_u32 s5, s5, s4
  v_add_u32 v2, s5, v1
  s_sub_u32 s4, s4, 16
  v_and_b32 v3, 15, v1
  v_add_u32 v3, s4, v3
  v_max_i32 v3, 0, v3
  s_cmp_ge_u32 s3, 2
  s_cselect_b64 vcc, -1, 0
  v_cndmask_b32 v2, v2, v3, vcc
  v_lshlrev_b32 v2, 3, v2
  s_mov_b32 s3, 0
  buffer_load_dwordx2 v[32:33], v2, s[56:59], s3 offen
  s_add_u32 s3, s3, 16384
  buffer_load_dwordx2 v[34:35], v2, s[56:59], s3 offen
  s_add_u32 s3, s3, 16384
  buffer_load_dwordx2 v[36:37], v2, s[56:59], s3 offen
  s_add_u32 s3, s3, 16384
  buffer_load_dwordx2 v[38:39], v2, s[56:59], s3 offen
  s_add_u32 s3, s3, 16384
  buffer_load_dwordx2 v[40:41], v2, s[56:59], s3 offen
  s_add_u32 s3, s3, 16384
  buffer_load_dwordx2 v[42:43], v2, s[56:59], s3 offen
  s_add_u32 s3, s3, 16384
  buffer_load_dwordx2 v[44:45], v2, s[56:59], s3 offen
  s_add_u32 s3, s3, 16384
  buffer_load_dwordx2 v[46:47], v2, s[56:59], s3 offen
  s_add_u32 s3, s3, 16384
  buffer_load_dwordx2 v[48:49], v2, s[56:59], s3 offen
  s_add_u32 s3, s3, 16384
  buffer_load_dwordx2 v[50:51], v2, s[56:59], s3 offen
  s_add_u32 s3, s3, 16384
  buffer_load_dwordx2 v[52:53], v2, s[56:59], s3 offen
  s_add_u32 s3, s3, 16384
  buffer_load_dwordx2 v[54:55], v2, s[56:59], s3 offen
  s_add_u32 s3, s3, 16384
  buffer_load_dwordx2 v[56:57], v2, s[56:59], s3 offen
  s_add_u32 s3, s3, 16384
  buffer_load_dwordx2 v[58:59], v2, s[56:59], s3 offen
  s_add_u32 s3, s3, 16384
  buffer_load_dwordx2 v[60:61], v2, s[56:59], s3 offen
  s_add_u32 s3, s3, 16384
  buffer_load_dwordx2 v[62:63], v2, s[56:59], s3 offen
  s_mov_b32 s60, s20
  s_and_b32 s61, s21, 0xffff
  s_mov_b32 s62, 2097152
  s_mov_b32 s63, 0x00020000
  s_and_b32 s3, s70, 3
  s_mul_i32 s3, s3, 8
  s_mul_i32 s4, s99, 32
  s_add_u32 s3, s3, s4
  v_lshrrev_b32 v2, 3, v1
  v_add_u32 v2, s3, v2
  v_mul_u32_u24 v2, 2048, v2
  v_and_b32 v3, 7, v1
  v_lshl_add_u32 v2, v3, 8, v2
  s_and_b32 s3, s2, 7
  s_lshr_b32 s3, s3, 2
  s_mul_i32 s3, s3, 128
  buffer_load_dword v96, v2, s[60:63], s3 offen
  s_waitcnt vmcnt(28)
  s_barrier
  s_waitcnt vmcnt(17)
  s_barrier
  s_waitcnt vmcnt(1)
  v_add_f32 v32, v32, v34
  v_add_f32 v33, v33, v35
  v_add_f32 v48, v48, v50
  v_add_f32 v49, v49, v51
  v_add_f32 v32, v32, v36
  v_add_f32 v33, v33, v37
  v_add_f32 v48, v48, v52
  v_add_f32 v49, v49, v53
  v_add_f32 v32, v32, v38
  v_add_f32 v33, v33, v39
  v_add_f32 v48, v48, v54
  v_add_f32 v49, v49, v55
  v_add_f32 v32, v32, v40
  v_add_f32 v33, v33, v41
  v_add_f32 v48, v48, v56
  v_add_f32 v49, v49, v57
  v_add_f32 v32, v32, v42
  v_add_f32 v33, v33, v43
  v_add_f32 v48, v48, v58
  v_add_f32 v49, v49, v59
  v_add_f32 v32, v32, v44
  v_add_f32 v33, v33, v45
  v_add_f32 v48, v48, v60
  v_add_f32 v49, v49, v61
  v_add_f32 v32, v32, v46
  v_add_f32 v33, v33, v47
  v_add_f32 v48, v48, v62
  v_add_f32 v49, v49, v63
  v_add_f32 v32, v32, v48
  v_add_f32 v33, v33, v49
  v_mul_f32 v32, 0x3a800000, v32
  v_mul_f32 v33, 0x3a800000, v33
  v_fma_f32 v33, -v32, v32, v33
  v_max_f32 v33, 0, v33
  v_add_f32 v33, 0x3727c5ac, v33
  v_rsq_f32 v33, v33
  s_nop 0
  s_and_b32 s3, s70, 3
  s_lshl_b32 s5, s3, 6
  s_add_u32 s5, s5, 16
  v_add_u32 v2, s5, v1
  v_and_b32 v3, 15, v1
  s_cmp_ge_u32 s3, 2
  s_cselect_b64 vcc, -1, 0
  v_cndmask_b32 v2, v2, v3, vcc
  v_lshlrev_b32 v2, 2, v2
  v_add_u32 v2, 129024, v2
  ds_write2_b32 v2, v32, v33 offset0:0 offset1:160
  s_waitcnt lgkmcnt(0)
  s_barrier
  s_barrier
L_attn_ldend:
  s_lshl_b32 s87, s97, 15
  s_lshl_b32 s4, s68, 11
  s_add_u32 s87, s87, s4
  s_lshl_b32 s4, s69, 2
  s_add_u32 s87, s87, s4
  s_add_u32 s97, s97, 1
  s_branch L_wo_body
L_attn_end:
  s_endpgm
L_attn_compute:
  s_and_b32 s71, s70, 1
  s_lshr_b32 s72, s70, 1
  v_and_b32 v3, 31, v1
  v_lshlrev_b32 v3, 2, v3
  v_add_u32 v3, 40960, v3
  v_mov_b32 v236, 0x3f803f80
  v_mov_b32 v237, 0x3f803f80
  v_mov_b32 v238, 0x3f803f80
  v_mov_b32 v239, 0x3f803f80
  ds_write_b32 v3, v236
  ds_write_b32 v3, v236 offset:43008
  v_add_u32 v3, 86016, v3
  ds_write_b32 v3, v236
  v_and_b32 v3, 15, v1
  v_lshrrev_b32 v2, 4, v1
  v_lshrrev_b32 v33, 1, v3
  s_lshl_b32 s8, s71, 13
  v_xor_b32 v4, v2, v33
  v_lshlrev_b32 v4, 4, v4
  v_lshl_add_u32 v4, v3, 7, v4
  v_add_u32 v8, 40960, v4
  v_add_u32 v4, s8, v4
  v_add_u32 v5, 4, v2
  v_xor_b32 v5, v5, v33
  v_lshlrev_b32 v5, 4, v5
  v_lshl_add_u32 v5, v3, 7, v5
  v_add_u32 v9, 40960, v5
  v_add_u32 v5, s8, v5
  v_bfe_u32 v34, v1, 2, 2
  v_lshl_add_u32 v34, v2, 3, v34
  v_lshlrev_b32 v34, 7, v34
  v_and_b32 v33, 3, v1
  v_lshl_add_u32 v34, v33, 3, v34
  v_bfe_u32 v33, v1, 3, 2
  v_lshl_add_u32 v34, v33, 5, v34
  v_and_b32 v35, 1, v2
  v_xor_b32 v35, s71, v35
  s_lshl_b32 s8, s70, 5
  v_xor_b32 v34, s8, v34
  v_add_u32 v6, 16384, v34
  v_xor_b32 v7, 32, v6
  s_lshl_b32 s8, s68, 7
  s_lshl_b32 s9, s71, 6
  s_add_u32 s8, s8, s9
  s_add_u32 s10, s8, s69
  s_lshl_b32 s10, s10, 11
  s_lshl_b32 s11, s72, 10
  s_add_u32 s10, s10, s11
  v_lshl_add_u32 v33, v3, 4, s10
  v_lshl_add_u32 v33, v35, 9, v33
  v_lshrrev_b32 v34, 1, v2
  v_lshl_add_u32 v31, v34, 8, v33
  s_mul_i32 s10, s72, 14336
  s_add_u32 s10, s10, 1024
  s_lshl_b32 s11, s71, 10
  s_add_u32 s4, s10, s11
  s_sub_u32 s5, s10, s11
  s_mul_i32 s6, s71, 6144
  v_lshl_add_u32 v16, v1, 4, s4
  v_add_u32 v17, s6, v16
  v_lshl_add_u32 v18, v1, 4, s5
  v_add_u32 v18, s6, v18
  v_lshl_add_u32 v19, v2, 8, s4
  v_lshl_add_u32 v20, v2, 8, s5
  v_lshl_add_u32 v21, v3, 4, s4
  v_lshl_add_u32 v22, v3, 4, s5
  s_lshl_b32 s10, s71, 8
  s_add_u32 s10, s10, 129024
  v_lshl_add_u32 v23, v3, 2, s10
  v_lshl_add_u32 v24, v2, 4, s10
  v_and_b32 v33, 1, v3
  v_cmp_eq_u32 s[48:49], 1, v33
  v_lshl_add_u32 v34, v2, 2, v33
  v_add_u32 v35, 2, v34
  v_cmp_gt_u32 s[50:51], v34, v3
  v_cmp_gt_u32 s[52:53], v35, v3
  v_mov_b32 v36, 0xffff
  v_mov_b32 v37, 0xffff0000
  v_cndmask_b32 v36, v36, v37, s[48:49]
  s_add_u32 s10, s10, 704
  v_lshl_add_u32 v34, v34, 2, s10
  v_lshl_add_u32 v35, v35, 2, s10
  v_subrev_u32 v38, 64, v34
  v_subrev_u32 v39, 64, v35
  v_cndmask_b32 v25, v34, v38, s[50:51]
  v_cndmask_b32 v26, v35, v39, s[52:53]
  v_cndmask_b32 v27, 0, v36, s[50:51]
  v_cndmask_b32 v29, 0, v36, s[52:53]
  v_xor_b32 v28, v27, v36
  v_xor_b32 v30, v29, v36
  s_cmp_eq_u32 s8, 0
  s_cselect_b64 s[54:55], s[50:51], 0
  s_cselect_b64 s[14:15], s[52:53], 0
  v_mov_b32 v120, 0
  v_mov_b32 v121, 0
  v_mov_b32 v122, 0
  v_mov_b32 v123, 0
  v_mov_b32 v124, 0
  v_mov_b32 v125, 0
  v_mov_b32 v126, 0
  v_mov_b32 v127, 0
  v_mov_b32 v128, 0
  v_mov_b32 v129, 0
  v_mov_b32 v130, 0
  v_mov_b32 v131, 0
  v_mov_b32 v132, 0
  v_mov_b32 v133, 0
  v_mov_b32 v134, 0
  v_mov_b32 v135, 0
  v_mov_b32 v136, 0
  v_mov_b32 v137, 0
  v_mov_b32 v138, 0
  v_mov_b32 v139, 0
  v_mov_b32 v140, 0
  v_mov_b32 v141, 0
  v_mov_b32 v142, 0
  v_mov_b32 v143, 0
  v_mov_b32 v144, 0
  v_mov_b32 v145, 0
  v_mov_b32 v146, 0
  v_mov_b32 v147, 0
  v_mov_b32 v148, 0
  v_mov_b32 v149, 0
  v_mov_b32 v150, 0
  v_mov_b32 v151, 0
  v_mov_b32 v152, 0
  v_mov_b32 v153, 0
  v_mov_b32 v154, 0
  v_mov_b32 v155, 0
  v_mov_b32 v156, 0
  v_mov_b32 v157, 0
  v_mov_b32 v158, 0
  v_mov_b32 v159, 0
  v_mov_b32 v160, 0
  v_mov_b32 v161, 0
  v_mov_b32 v162, 0
  v_mov_b32 v163, 0
  v_mov_b32 v164, 0
  v_mov_b32 v165, 0
  v_mov_b32 v166, 0
  v_mov_b32 v167, 0
  v_mov_b32 v168, 0
  v_mov_b32 v169, 0
  v_mov_b32 v170, 0
  v_mov_b32 v171, 0
  v_mov_b32 v172, 0
  v_mov_b32 v173, 0
  v_mov_b32 v174, 0
  v_mov_b32 v175, 0
  v_mov_b32 v176, 0
  v_mov_b32 v177, 0
  v_mov_b32 v178, 0
  v_mov_b32 v179, 0
  v_mov_b32 v180, 0
  v_mov_b32 v181, 0
  v_mov_b32 v182, 0
  v_mov_b32 v183, 0
  v_mov_b32 v184, 0
  v_mov_b32 v185, 0
  v_mov_b32 v186, 0
  v_mov_b32 v187, 0
  v_mov_b32 v188, 0
  v_mov_b32 v189, 0
  v_mov_b32 v190, 0
  v_mov_b32 v191, 0
  v_mov_b32 v192, 0
  v_mov_b32 v193, 0
  v_mov_b32 v194, 0
  v_mov_b32 v195, 0
  v_mov_b32 v196, 0
  v_mov_b32 v197, 0
  v_mov_b32 v198, 0
  v_mov_b32 v199, 0
  v_mov_b32 v200, 0
  v_mov_b32 v201, 0
  v_mov_b32 v202, 0
  v_mov_b32 v203, 0
  v_mov_b32 v204, 0
  v_mov_b32 v205, 0
  v_mov_b32 v206, 0
  v_mov_b32 v207, 0
  v_mov_b32 v208, 0
  v_mov_b32 v209, 0
  v_mov_b32 v210, 0
  v_mov_b32 v211, 0
  v_mov_b32 v212, 0
  v_mov_b32 v213, 0
  v_mov_b32 v214, 0
  v_mov_b32 v215, 0
  v_mov_b32 v216, 0
  v_mov_b32 v217, 0
  v_mov_b32 v218, 0
  v_mov_b32 v219, 0
  v_mov_b32 v220, 0
  v_mov_b32 v221, 0
  v_mov_b32 v222, 0
  v_mov_b32 v223, 0
  v_mov_b32 v224, 0
  v_mov_b32 v225, 0
  v_mov_b32 v226, 0
  v_mov_b32 v227, 0
  v_mov_b32 v228, 0
  v_mov_b32 v229, 0
  v_mov_b32 v230, 0
  v_mov_b32 v231, 0
  v_mov_b32 v232, 0
  v_mov_b32 v233, 0
  v_mov_b32 v234, 0
  v_mov_b32 v235, 0
  s_waitcnt lgkmcnt(0)
  s_mov_b32 s44, s34
  s_and_b32 s45, s35, 0xffff
  s_mov_b32 s46, 4194304
  s_mov_b32 s47, 0x00020000
  s_load_dwordx2 s[64:65], s[0:1], 72
  s_or_b32 s3, s96, s70
  s_cbranch_scc1 L_clr_skip0
  s_add_u32 s60, s22, 41943040
  s_addc_u32 s61, s23, 0
  s_and_b32 s61, s61, 0xffff
  s_mov_b32 s62, 524288
  s_mov_b32 s63, 0x00020000
  s_lshl_b32 s3, s2, 11
  v_lshlrev_b32 v2, 4, v1
  buffer_store_dwordx4 v[128:131], v2, s[60:63], s3 offen sc1
  buffer_store_dwordx4 v[128:131], v2, s[60:63], s3 offen offset:1024 sc1
L_clr_skip0:
  s_cmp_lg_u32 s96, 0
  s_cbranch_scc1 L_pfc1_skip
  s_getpc_b64 s[4:5]
L_pfc1:
  s_lshl_b32 s3, s99, 2
  s_add_u32 s3, s3, s70
  s_mul_i32 s3, s3, 256
  s_min_u32 s3, s3, L_w2_c1-L_attn_c0-256
  s_add_i32 s3, s3, L_attn_c0-L_pfc1
  s_ashr_i32 s6, s3, 31
  s_add_u32 s4, s4, s3
  s_addc_u32 s5, s5, s6
  s_load_dword s36, s[4:5], 0
  s_load_dword s37, s[4:5], 64
  s_load_dword s38, s[4:5], 128
  s_load_dword s39, s[4:5], 192
L_pfc1_skip:
  s_mov_b32 s75, 0
  v_add_u32_e64 v10, s75, v4
  v_add_u32_e64 v11, s75, v5
  v_add_u32_e64 v12, s75, v6
  v_add_u32_e64 v13, s75, v7
  v_add_u32_e64 v14, s75, v8
  v_add_u32_e64 v15, s75, v9
  s_add_u32 s75, s75, 43008
  s_cmp_eq_u32 s75, 129024
  s_cselect_b32 s75, 0, s75
  s_mov_b32 s79, 16
  s_cmp_eq_u32 s96, 0
  s_cbranch_scc1 L_attn_nog
  s_barrier
L_attn_nog:
  s_barrier
  ds_read_b128 v[32:35], v10 offset:0
  ds_read_b128 v[36:39], v10 offset:2048
  ds_read_b128 v[40:43], v10 offset:4096
  ds_read_b128 v[44:47], v10 offset:6144
  ds_read_b128 v[48:51], v14
  ds_read_b64_tr_b16 v[52:53], v12 offset:0
  ds_read_b64_tr_b16 v[54:55], v12 offset:512
  ds_read_b64_tr_b16 v[56:57], v13 offset:0
  ds_read_b64_tr_b16 v[58:59], v13 offset:512
  ds_read_b64_tr_b16 v[60:61], v12 offset:8192
  ds_read_b64_tr_b16 v[62:63], v12 offset:8704
  ds_read_b64_tr_b16 v[64:65], v13 offset:8192
  ds_read_b64_tr_b16 v[66:67], v13 offset:8704
  ds_read_b64_tr_b16 v[68:69], v12 offset:16384
  ds_read_b64_tr_b16 v[70:71], v12 offset:16896
  ds_read_b64_tr_b16 v[72:73], v13 offset:16384
  ds_read_b64_tr_b16 v[74:75], v13 offset:16896
  s_waitcnt lgkmcnt(0)
  s_cmp_lg_u32 s96, 0
  s_cbranch_scc1 L_attn_loop
  v_mov_b32 v240, 0
  v_mov_b32 v241, 0
  v_mov_b32 v242, 0
  v_mov_b32 v243, 0
  v_mov_b32 v244, 0
  v_mov_b32 v245, 0
  v_mov_b32 v246, 0
  v_mov_b32 v247, 0
  v_mov_b32 v248, 0
  v_mov_b32 v249, 0
  v_mov_b32 v250, 0
  v_mov_b32 v251, 0
  v_mov_b32 v252, 0
  v_mov_b32 v253, 0
  v_mov_b32 v254, 0
  v_mov_b32 v255, 0
  s_cmp_lg_u32 s72, 0
  s_cbranch_scc1 L_attn_loopb
  s_or_b32 s3, s96, s70
  s_cbranch_scc1 L_clr_skip1
  v_mov_b32 v3, 1
  s_and_b32 s65, s65, 0xffff
  s_mov_b32 s66, 256
  s_mov_b32 s67, 0x00020000
  s_mov_b64 exec, 1
  s_waitcnt vmcnt(0)
  buffer_store_byte v3, off, s[64:67], s2 sc1
  s_mov_b64 exec, -1
L_clr_skip1:
.p2align 3
L_attn_loopa:
  v_mfma_f32_16x16x32_bf16 v[240:243], v[236:239], v[32:35], v[240:243]
  ds_read_b128 v[76:79], v11 offset:0
  v_mfma_f32_16x16x32_bf16 v[244:247], v[32:35], v[32:35], v[244:247]
  ds_read_b128 v[80:83], v11 offset:2048
  v_mfma_f32_16x16x32_bf16 v[248:251], v[236:239], v[36:39], v[248:251]
  ds_read_b128 v[84:87], v11 offset:4096
  v_mfma_f32_16x16x32_bf16 v[252:255], v[36:39], v[36:39], v[252:255]
  ds_read_b128 v[88:91], v11 offset:6144
  v_mfma_f32_16x16x32_bf16 v[120:123], v[236:239], v[48:51], v[120:123]
  ds_read_b128 v[92:95], v15
  v_mfma_f32_16x16x32_bf16 v[124:127], v[48:51], v[48:51], v[124:127]
  ds_read_b64_tr_b16 v[96:97], v12 offset:4096
  v_mfma_f32_16x16x32_bf16 v[128:131], v[52:55], v[32:35], v[128:131]
  ds_read_b64_tr_b16 v[98:99], v12 offset:4608
  v_mfma_f32_16x16x32_bf16 v[132:135], v[52:55], v[36:39], v[132:135]
  ds_read_b64_tr_b16 v[100:101], v13 offset:4096
  v_mfma_f32_16x16x32_bf16 v[136:139], v[52:55], v[40:43], v[136:139]
  ds_read_b64_tr_b16 v[102:103], v13 offset:4608
  v_mfma_f32_16x16x32_bf16 v[140:143], v[52:55], v[44:47], v[140:143]
  ds_read_b64_tr_b16 v[104:105], v12 offset:12288
  v_mfma_f32_16x16x32_bf16 v[224:227], v[52:55], v[48:51], v[224:227]
  ds_read_b64_tr_b16 v[106:107], v12 offset:12800
  v_mfma_f32_16x16x32_bf16 v[156:159], v[56:59], v[44:47], v[156:159]
  ds_read_b64_tr_b16 v[108:109], v13 offset:12288
  v_mfma_f32_16x16x32_bf16 v[152:155], v[56:59], v[40:43], v[152:155]
  ds_read_b64_tr_b16 v[110:111], v13 offset:12800
  v_mfma_f32_16x16x32_bf16 v[148:151], v[56:59], v[36:39], v[148:151]
  ds_read_b64_tr_b16 v[112:113], v12 offset:20480
  v_mfma_f32_16x16x32_bf16 v[144:147], v[56:59], v[32:35], v[144:147]
  ds_read_b64_tr_b16 v[114:115], v12 offset:20992
  v_mfma_f32_16x16x32_bf16 v[160:163], v[60:63], v[32:35], v[160:163]
  ds_read_b64_tr_b16 v[116:117], v13 offset:20480
  v_mfma_f32_16x16x32_bf16 v[164:167], v[60:63], v[36:39], v[164:167]
  ds_read_b64_tr_b16 v[118:119], v13 offset:20992
  v_mfma_f32_16x16x32_bf16 v[168:171], v[60:63], v[40:43], v[168:171]
  v_add_u32_e64 v10, s75, v4
  v_mfma_f32_16x16x32_bf16 v[172:175], v[60:63], v[44:47], v[172:175]
  v_add_u32_e64 v11, s75, v5
  v_mfma_f32_16x16x32_bf16 v[228:231], v[60:63], v[48:51], v[228:231]
  v_add_u32_e64 v12, s75, v6
  v_mfma_f32_16x16x32_bf16 v[188:191], v[64:67], v[44:47], v[188:191]
  v_add_u32_e64 v13, s75, v7
  v_mfma_f32_16x16x32_bf16 v[184:187], v[64:67], v[40:43], v[184:187]
  v_add_u32_e64 v14, s75, v8
  v_mfma_f32_16x16x32_bf16 v[180:183], v[64:67], v[36:39], v[180:183]
  v_add_u32_e64 v15, s75, v9
  v_mfma_f32_16x16x32_bf16 v[176:179], v[64:67], v[32:35], v[176:179]
  s_add_u32 s75, s75, 43008
  v_mfma_f32_16x16x32_bf16 v[192:195], v[32:35], v[68:71], v[192:195]
  s_cmp_eq_u32 s75, 129024
  v_mfma_f32_16x16x32_bf16 v[196:199], v[36:39], v[68:71], v[196:199]
  s_cselect_b32 s75, 0, s75
  s_sub_u32 s79, s79, 1
  v_mfma_f32_16x16x32_bf16 v[200:203], v[40:43], v[68:71], v[200:203]
  v_mfma_f32_16x16x32_bf16 v[204:207], v[44:47], v[68:71], v[204:207]
  v_mfma_f32_16x16x32_bf16 v[232:235], v[48:51], v[68:71], v[232:235]
  v_mfma_f32_16x16x32_bf16 v[220:223], v[44:47], v[72:75], v[220:223]
  v_mfma_f32_16x16x32_bf16 v[216:219], v[40:43], v[72:75], v[216:219]
  v_mfma_f32_16x16x32_bf16 v[212:215], v[36:39], v[72:75], v[212:215]
  v_mfma_f32_16x16x32_bf16 v[208:211], v[32:35], v[72:75], v[208:211]
  s_waitcnt lgkmcnt(0)
  s_barrier
  v_mfma_f32_16x16x32_bf16 v[240:243], v[236:239], v[76:79], v[240:243]
  ds_read_b128 v[32:35], v10 offset:0
  v_mfma_f32_16x16x32_bf16 v[244:247], v[76:79], v[76:79], v[244:247]
  ds_read_b128 v[36:39], v10 offset:2048
  v_mfma_f32_16x16x32_bf16 v[248:251], v[236:239], v[80:83], v[248:251]
  ds_read_b128 v[40:43], v10 offset:4096
  v_mfma_f32_16x16x32_bf16 v[252:255], v[80:83], v[80:83], v[252:255]
  ds_read_b128 v[44:47], v10 offset:6144
  v_mfma_f32_16x16x32_bf16 v[120:123], v[236:239], v[92:95], v[120:123]
  ds_read_b128 v[48:51], v14
  v_mfma_f32_16x16x32_bf16 v[124:127], v[92:95], v[92:95], v[124:127]
  ds_read_b64_tr_b16 v[52:53], v12 offset:0
  v_mfma_f32_16x16x32_bf16 v[128:131], v[96:99], v[76:79], v[128:131]
  ds_read_b64_tr_b16 v[54:55], v12 offset:512
  v_mfma_f32_16x16x32_bf16 v[132:135], v[96:99], v[80:83], v[132:135]
  ds_read_b64_tr_b16 v[56:57], v13 offset:0
  v_mfma_f32_16x16x32_bf16 v[136:139], v[96:99], v[84:87], v[136:139]
  ds_read_b64_tr_b16 v[58:59], v13 offset:512
  v_mfma_f32_16x16x32_bf16 v[140:143], v[96:99], v[88:91], v[140:143]
  ds_read_b64_tr_b16 v[60:61], v12 offset:8192
  v_mfma_f32_16x16x32_bf16 v[224:227], v[96:99], v[92:95], v[224:227]
  ds_read_b64_tr_b16 v[62:63], v12 offset:8704
  v_mfma_f32_16x16x32_bf16 v[156:159], v[100:103], v[88:91], v[156:159]
  ds_read_b64_tr_b16 v[64:65], v13 offset:8192
  v_mfma_f32_16x16x32_bf16 v[152:155], v[100:103], v[84:87], v[152:155]
  ds_read_b64_tr_b16 v[66:67], v13 offset:8704
  v_mfma_f32_16x16x32_bf16 v[148:151], v[100:103], v[80:83], v[148:151]
  ds_read_b64_tr_b16 v[68:69], v12 offset:16384
  v_mfma_f32_16x16x32_bf16 v[144:147], v[100:103], v[76:79], v[144:147]
  ds_read_b64_tr_b16 v[70:71], v12 offset:16896
  v_mfma_f32_16x16x32_bf16 v[160:163], v[104:107], v[76:79], v[160:163]
  ds_read_b64_tr_b16 v[72:73], v13 offset:16384
  v_mfma_f32_16x16x32_bf16 v[164:167], v[104:107], v[80:83], v[164:167]
  ds_read_b64_tr_b16 v[74:75], v13 offset:16896
  v_mfma_f32_16x16x32_bf16 v[168:171], v[104:107], v[84:87], v[168:171]
  s_cmp_lg_u32 s79, 0
  s_nop 0
  v_mfma_f32_16x16x32_bf16 v[172:175], v[104:107], v[88:91], v[172:175]
  v_mfma_f32_16x16x32_bf16 v[228:231], v[104:107], v[92:95], v[228:231]
  v_mfma_f32_16x16x32_bf16 v[188:191], v[108:111], v[88:91], v[188:191]
  v_mfma_f32_16x16x32_bf16 v[184:187], v[108:111], v[84:87], v[184:187]
  v_mfma_f32_16x16x32_bf16 v[180:183], v[108:111], v[80:83], v[180:183]
  v_mfma_f32_16x16x32_bf16 v[176:179], v[108:111], v[76:79], v[176:179]
  v_mfma_f32_16x16x32_bf16 v[192:195], v[76:79], v[112:115], v[192:195]
  v_mfma_f32_16x16x32_bf16 v[196:199], v[80:83], v[112:115], v[196:199]
  v_mfma_f32_16x16x32_bf16 v[200:203], v[84:87], v[112:115], v[200:203]
  v_mfma_f32_16x16x32_bf16 v[204:207], v[88:91], v[112:115], v[204:207]
  v_mfma_f32_16x16x32_bf16 v[232:235], v[92:95], v[112:115], v[232:235]
  v_mfma_f32_16x16x32_bf16 v[220:223], v[88:91], v[116:119], v[220:223]
  v_mfma_f32_16x16x32_bf16 v[216:219], v[84:87], v[116:119], v[216:219]
  v_mfma_f32_16x16x32_bf16 v[212:215], v[80:83], v[116:119], v[212:215]
  v_mfma_f32_16x16x32_bf16 v[208:211], v[76:79], v[116:119], v[208:211]
  s_waitcnt lgkmcnt(0)
  s_cbranch_scc1 L_attn_loopa
  s_branch L_attn_post
.p2align 3
L_attn_loopb:
  v_mfma_f32_16x16x32_bf16 v[240:243], v[236:239], v[40:43], v[240:243]
  ds_read_b128 v[76:79], v11 offset:0
  v_mfma_f32_16x16x32_bf16 v[244:247], v[40:43], v[40:43], v[244:247]
  ds_read_b128 v[80:83], v11 offset:2048
  v_mfma_f32_16x16x32_bf16 v[248:251], v[236:239], v[44:47], v[248:251]
  ds_read_b128 v[84:87], v11 offset:4096
  v_mfma_f32_16x16x32_bf16 v[252:255], v[44:47], v[44:47], v[252:255]
  ds_read_b128 v[88:91], v11 offset:6144
  v_mfma_f32_16x16x32_bf16 v[128:131], v[52:55], v[32:35], v[128:131]
  ds_read_b128 v[92:95], v15
  v_mfma_f32_16x16x32_bf16 v[132:135], v[52:55], v[36:39], v[132:135]
  ds_read_b64_tr_b16 v[96:97], v12 offset:4096
  v_mfma_f32_16x16x32_bf16 v[136:139], v[52:55], v[40:43], v[136:139]
  ds_read_b64_tr_b16 v[98:99], v12 offset:4608
  v_mfma_f32_16x16x32_bf16 v[140:143], v[52:55], v[44:47], v[140:143]
  ds_read_b64_tr_b16 v[100:101], v13 offset:4096
  v_mfma_f32_16x16x32_bf16 v[224:227], v[52:55], v[48:51], v[224:227]
  ds_read_b64_tr_b16 v[102:103], v13 offset:4608
  v_mfma_f32_16x16x32_bf16 v[156:159], v[56:59], v[44:47], v[156:159]
  ds_read_b64_tr_b16 v[104:105], v12 offset:12288
  v_mfma_f32_16x16x32_bf16 v[152:155], v[56:59], v[40:43], v[152:155]
  ds_read_b64_tr_b16 v[106:107], v12 offset:12800
  v_mfma_f32_16x16x32_bf16 v[148:151], v[56:59], v[36:39], v[148:151]
  ds_read_b64_tr_b16 v[108:109], v13 offset:12288
  v_mfma_f32_16x16x32_bf16 v[144:147], v[56:59], v[32:35], v[144:147]
  ds_read_b64_tr_b16 v[110:111], v13 offset:12800
  v_mfma_f32_16x16x32_bf16 v[160:163], v[60:63], v[32:35], v[160:163]
  ds_read_b64_tr_b16 v[112:113], v12 offset:20480
  v_mfma_f32_16x16x32_bf16 v[164:167], v[60:63], v[36:39], v[164:167]
  ds_read_b64_tr_b16 v[114:115], v12 offset:20992
  v_mfma_f32_16x16x32_bf16 v[168:171], v[60:63], v[40:43], v[168:171]
  ds_read_b64_tr_b16 v[116:117], v13 offset:20480
  v_mfma_f32_16x16x32_bf16 v[172:175], v[60:63], v[44:47], v[172:175]
  ds_read_b64_tr_b16 v[118:119], v13 offset:20992
  v_mfma_f32_16x16x32_bf16 v[228:231], v[60:63], v[48:51], v[228:231]
  v_add_u32_e64 v10, s75, v4
  v_mfma_f32_16x16x32_bf16 v[188:191], v[64:67], v[44:47], v[188:191]
  v_add_u32_e64 v11, s75, v5
  v_mfma_f32_16x16x32_bf16 v[184:187], v[64:67], v[40:43], v[184:187]
  v_add_u32_e64 v12, s75, v6
  v_mfma_f32_16x16x32_bf16 v[180:183], v[64:67], v[36:39], v[180:183]
  v_add_u32_e64 v13, s75, v7
  v_mfma_f32_16x16x32_bf16 v[176:179], v[64:67], v[32:35], v[176:179]
  v_add_u32_e64 v14, s75, v8
  v_mfma_f32_16x16x32_bf16 v[192:195], v[32:35], v[68:71], v[192:195]
  v_add_u32_e64 v15, s75, v9
  v_mfma_f32_16x16x32_bf16 v[196:199], v[36:39], v[68:71], v[196:199]
  s_add_u32 s75, s75, 43008
  v_mfma_f32_16x16x32_bf16 v[200:203], v[40:43], v[68:71], v[200:203]
  s_cmp_eq_u32 s75, 129024
  v_mfma_f32_16x16x32_bf16 v[204:207], v[44:47], v[68:71], v[204:207]
  s_cselect_b32 s75, 0, s75
  s_sub_u32 s79, s79, 1
  v_mfma_f32_16x16x32_bf16 v[232:235], v[48:51], v[68:71], v[232:235]
  v_mfma_f32_16x16x32_bf16 v[220:223], v[44:47], v[72:75], v[220:223]
  v_mfma_f32_16x16x32_bf16 v[216:219], v[40:43], v[72:75], v[216:219]
  v_mfma_f32_16x16x32_bf16 v[212:215], v[36:39], v[72:75], v[212:215]
  v_mfma_f32_16x16x32_bf16 v[208:211], v[32:35], v[72:75], v[208:211]
  s_waitcnt lgkmcnt(0)
  s_barrier
  v_mfma_f32_16x16x32_bf16 v[240:243], v[236:239], v[84:87], v[240:243]
  ds_read_b128 v[32:35], v10 offset:0
  v_mfma_f32_16x16x32_bf16 v[244:247], v[84:87], v[84:87], v[244:247]
  ds_read_b128 v[36:39], v10 offset:2048
  v_mfma_f32_16x16x32_bf16 v[248:251], v[236:239], v[88:91], v[248:251]
  ds_read_b128 v[40:43], v10 offset:4096
  v_mfma_f32_16x16x32_bf16 v[252:255], v[88:91], v[88:91], v[252:255]
  ds_read_b128 v[44:47], v10 offset:6144
  v_mfma_f32_16x16x32_bf16 v[128:131], v[96:99], v[76:79], v[128:131]
  ds_read_b128 v[48:51], v14
  v_mfma_f32_16x16x32_bf16 v[132:135], v[96:99], v[80:83], v[132:135]
  ds_read_b64_tr_b16 v[52:53], v12 offset:0
  v_mfma_f32_16x16x32_bf16 v[136:139], v[96:99], v[84:87], v[136:139]
  ds_read_b64_tr_b16 v[54:55], v12 offset:512
  v_mfma_f32_16x16x32_bf16 v[140:143], v[96:99], v[88:91], v[140:143]
  ds_read_b64_tr_b16 v[56:57], v13 offset:0
  v_mfma_f32_16x16x32_bf16 v[224:227], v[96:99], v[92:95], v[224:227]
  ds_read_b64_tr_b16 v[58:59], v13 offset:512
  v_mfma_f32_16x16x32_bf16 v[156:159], v[100:103], v[88:91], v[156:159]
  ds_read_b64_tr_b16 v[60:61], v12 offset:8192
  v_mfma_f32_16x16x32_bf16 v[152:155], v[100:103], v[84:87], v[152:155]
  ds_read_b64_tr_b16 v[62:63], v12 offset:8704
  v_mfma_f32_16x16x32_bf16 v[148:151], v[100:103], v[80:83], v[148:151]
  ds_read_b64_tr_b16 v[64:65], v13 offset:8192
  v_mfma_f32_16x16x32_bf16 v[144:147], v[100:103], v[76:79], v[144:147]
  ds_read_b64_tr_b16 v[66:67], v13 offset:8704
  v_mfma_f32_16x16x32_bf16 v[160:163], v[104:107], v[76:79], v[160:163]
  ds_read_b64_tr_b16 v[68:69], v12 offset:16384
  v_mfma_f32_16x16x32_bf16 v[164:167], v[104:107], v[80:83], v[164:167]
  ds_read_b64_tr_b16 v[70:71], v12 offset:16896
  v_mfma_f32_16x16x32_bf16 v[168:171], v[104:107], v[84:87], v[168:171]
  ds_read_b64_tr_b16 v[72:73], v13 offset:16384
  v_mfma_f32_16x16x32_bf16 v[172:175], v[104:107], v[88:91], v[172:175]
  ds_read_b64_tr_b16 v[74:75], v13 offset:16896
  v_mfma_f32_16x16x32_bf16 v[228:231], v[104:107], v[92:95], v[228:231]
  s_cmp_lg_u32 s79, 0
  s_nop 0
  v_mfma_f32_16x16x32_bf16 v[188:191], v[108:111], v[88:91], v[188:191]
  v_mfma_f32_16x16x32_bf16 v[184:187], v[108:111], v[84:87], v[184:187]
  v_mfma_f32_16x16x32_bf16 v[180:183], v[108:111], v[80:83], v[180:183]
  v_mfma_f32_16x16x32_bf16 v[176:179], v[108:111], v[76:79], v[176:179]
  v_mfma_f32_16x16x32_bf16 v[192:195], v[76:79], v[112:115], v[192:195]
  v_mfma_f32_16x16x32_bf16 v[196:199], v[80:83], v[112:115], v[196:199]
  v_mfma_f32_16x16x32_bf16 v[200:203], v[84:87], v[112:115], v[200:203]
  v_mfma_f32_16x16x32_bf16 v[204:207], v[88:91], v[112:115], v[204:207]
  v_mfma_f32_16x16x32_bf16 v[232:235], v[92:95], v[112:115], v[232:235]
  v_mfma_f32_16x16x32_bf16 v[220:223], v[88:91], v[116:119], v[220:223]
  v_mfma_f32_16x16x32_bf16 v[216:219], v[84:87], v[116:119], v[216:219]
  v_mfma_f32_16x16x32_bf16 v[212:215], v[80:83], v[116:119], v[212:215]
  v_mfma_f32_16x16x32_bf16 v[208:211], v[76:79], v[116:119], v[208:211]
  s_waitcnt lgkmcnt(0)
  s_cbranch_scc1 L_attn_loopb
L_attn_post:
  v_and_b32 v32, 3, v1
  v_cmp_eq_u32 s[4:5], 1, v32
  v_cmp_eq_u32 s[6:7], 2, v32
  v_cmp_eq_u32 s[8:9], 3, v32
  v_bfe_u32 v33, v1, 2, 2
  v_lshrrev_b32 v34, 4, v1
  v_cmp_eq_u32 s[10:11], v33, v34
  s_lshl_b32 s3, s72, 7
  v_add_u32 v35, s3, v23
  v_and_b32 v36, 15, v1
  s_cmp_eq_u32 s70, 0
  s_cselect_b32 s3, 0, 576
  s_add_u32 s3, s3, 129024
  v_lshl_add_u32 v36, v36, 2, s3
  v_cndmask_b32 v241, v244, v245, s[4:5]
  v_cndmask_b32 v249, v252, v253, s[4:5]
  v_cndmask_b32 v121, v124, v125, s[4:5]
  v_cndmask_b32 v241, v241, v246, s[6:7]
  v_cndmask_b32 v249, v249, v254, s[6:7]
  v_cndmask_b32 v121, v121, v126, s[6:7]
  v_cndmask_b32 v241, v241, v247, s[8:9]
  v_cndmask_b32 v249, v249, v255, s[8:9]
  v_cndmask_b32 v121, v121, v127, s[8:9]
  v_mul_f32 v240, 0x3a800000, v240
  v_mul_f32 v241, 0x3a800000, v241
  v_fma_f32 v241, -v240, v240, v241
  v_max_f32 v241, 0, v241
  v_add_f32 v241, 0x3727c5ac, v241
  v_rsq_f32 v241, v241
  s_nop 0
  v_mul_f32 v248, 0x3a800000, v248
  v_mul_f32 v249, 0x3a800000, v249
  v_fma_f32 v249, -v248, v248, v249
  v_max_f32 v249, 0, v249
  v_add_f32 v249, 0x3727c5ac, v249
  v_rsq_f32 v249, v249
  s_nop 0
  v_mul_f32 v120, 0x3a800000, v120
  v_mul_f32 v121, 0x3a800000, v121
  v_fma_f32 v121, -v120, v120, v121
  v_max_f32 v121, 0, v121
  v_add_f32 v121, 0x3727c5ac, v121
  v_rsq_f32 v121, v121
  s_nop 0
  s_mov_b64 exec, s[10:11]
  ds_write2_b32 v35, v240, v241 offset0:16 offset1:176
  ds_write2_b32 v35, v248, v249 offset0:32 offset1:192
  ds_write2_b32 v36, v120, v121 offset0:0 offset1:160
  s_mov_b64 exec, -1
  s_mov_b32 s36, s16
  s_and_b32 s37, s17, 0xffff
  s_mov_b32 s38, 4194304
  s_mov_b32 s39, 0x00020000
  s_and_b32 s3, s2, 3
  s_and_b32 s4, s99, 3
  s_lshl2_add_u32 s3, s3, s4
  s_lshl2_add_u32 s3, s3, s70
  s_lshl_b32 s3, s3, 16
  s_bfe_u32 s4, s2, 0x10002
  s_lshr_b32 s5, s99, 2
  s_lshl1_add_u32 s4, s5, s4
  s_lshl_b32 s4, s4, 7
  s_add_u32 s3, s3, s4
  s_add_u32 s4, s3, 32768
  v_and_b32 v32, 15, v1
  v_lshlrev_b32 v33, 1, v1
  v_and_b32 v33, 32, v33
  v_lshl_add_u32 v32, v32, 11, v33
  v_lshrrev_b32 v33, 1, v1
  v_and_b32 v33, 16, v33
  v_add_u32 v32, v32, v33
  s_waitcnt lgkmcnt(0)
  buffer_load_dwordx4 v[240:243], v32, s[36:39], s3 offen offset:0
  buffer_load_dwordx4 v[244:247], v32, s[36:39], s3 offen offset:64
  buffer_load_dwordx4 v[248:251], v32, s[36:39], s4 offen offset:0
  buffer_load_dwordx4 v[252:255], v32, s[36:39], s4 offen offset:64
  s_barrier
  s_branch L_attn_exit
.p2align 3
L_attn_loop:
  v_mfma_f32_16x16x32_bf16 v[128:131], v[52:55], v[32:35], v[128:131]
  ds_read_b128 v[76:79], v11 offset:0
  v_mfma_f32_16x16x32_bf16 v[132:135], v[52:55], v[36:39], v[132:135]
  ds_read_b128 v[80:83], v11 offset:2048
  v_mfma_f32_16x16x32_bf16 v[136:139], v[52:55], v[40:43], v[136:139]
  ds_read_b128 v[84:87], v11 offset:4096
  v_mfma_f32_16x16x32_bf16 v[140:143], v[52:55], v[44:47], v[140:143]
  ds_read_b128 v[88:91], v11 offset:6144
  v_mfma_f32_16x16x32_bf16 v[224:227], v[52:55], v[48:51], v[224:227]
  ds_read_b128 v[92:95], v15
  v_mfma_f32_16x16x32_bf16 v[156:159], v[56:59], v[44:47], v[156:159]
  ds_read_b64_tr_b16 v[96:97], v12 offset:4096
  v_mfma_f32_16x16x32_bf16 v[152:155], v[56:59], v[40:43], v[152:155]
  ds_read_b64_tr_b16 v[98:99], v12 offset:4608
  v_mfma_f32_16x16x32_bf16 v[148:151], v[56:59], v[36:39], v[148:151]
  ds_read_b64_tr_b16 v[100:101], v13 offset:4096
  v_mfma_f32_16x16x32_bf16 v[144:147], v[56:59], v[32:35], v[144:147]
  ds_read_b64_tr_b16 v[102:103], v13 offset:4608
  v_mfma_f32_16x16x32_bf16 v[160:163], v[60:63], v[32:35], v[160:163]
  ds_read_b64_tr_b16 v[104:105], v12 offset:12288
  v_mfma_f32_16x16x32_bf16 v[164:167], v[60:63], v[36:39], v[164:167]
  ds_read_b64_tr_b16 v[106:107], v12 offset:12800
  v_mfma_f32_16x16x32_bf16 v[168:171], v[60:63], v[40:43], v[168:171]
  ds_read_b64_tr_b16 v[108:109], v13 offset:12288
  v_mfma_f32_16x16x32_bf16 v[172:175], v[60:63], v[44:47], v[172:175]
  ds_read_b64_tr_b16 v[110:111], v13 offset:12800
  v_mfma_f32_16x16x32_bf16 v[228:231], v[60:63], v[48:51], v[228:231]
  ds_read_b64_tr_b16 v[112:113], v12 offset:20480
  v_mfma_f32_16x16x32_bf16 v[188:191], v[64:67], v[44:47], v[188:191]
  ds_read_b64_tr_b16 v[114:115], v12 offset:20992
  v_mfma_f32_16x16x32_bf16 v[184:187], v[64:67], v[40:43], v[184:187]
  ds_read_b64_tr_b16 v[116:117], v13 offset:20480
  v_mfma_f32_16x16x32_bf16 v[180:183], v[64:67], v[36:39], v[180:183]
  ds_read_b64_tr_b16 v[118:119], v13 offset:20992
  v_mfma_f32_16x16x32_bf16 v[176:179], v[64:67], v[32:35], v[176:179]
  v_add_u32_e64 v10, s75, v4
  v_mfma_f32_16x16x32_bf16 v[192:195], v[32:35], v[68:71], v[192:195]
  v_add_u32_e64 v11, s75, v5
  v_mfma_f32_16x16x32_bf16 v[196:199], v[36:39], v[68:71], v[196:199]
  v_add_u32_e64 v12, s75, v6
  v_mfma_f32_16x16x32_bf16 v[200:203], v[40:43], v[68:71], v[200:203]
  v_add_u32_e64 v13, s75, v7
  v_mfma_f32_16x16x32_bf16 v[204:207], v[44:47], v[68:71], v[204:207]
  v_add_u32_e64 v14, s75, v8
  v_mfma_f32_16x16x32_bf16 v[232:235], v[48:51], v[68:71], v[232:235]
  v_add_u32_e64 v15, s75, v9
  v_mfma_f32_16x16x32_bf16 v[220:223], v[44:47], v[72:75], v[220:223]
  s_add_u32 s75, s75, 43008
  v_mfma_f32_16x16x32_bf16 v[216:219], v[40:43], v[72:75], v[216:219]
  s_cmp_eq_u32 s75, 129024
  v_mfma_f32_16x16x32_bf16 v[212:215], v[36:39], v[72:75], v[212:215]
  s_cselect_b32 s75, 0, s75
  s_sub_u32 s79, s79, 1
  v_mfma_f32_16x16x32_bf16 v[208:211], v[32:35], v[72:75], v[208:211]
  s_waitcnt lgkmcnt(0)
  s_barrier
  v_mfma_f32_16x16x32_bf16 v[128:131], v[96:99], v[76:79], v[128:131]
  ds_read_b128 v[32:35], v10 offset:0
  v_mfma_f32_16x16x32_bf16 v[132:135], v[96:99], v[80:83], v[132:135]
  ds_read_b128 v[36:39], v10 offset:2048
  v_mfma_f32_16x16x32_bf16 v[136:139], v[96:99], v[84:87], v[136:139]
  ds_read_b128 v[40:43], v10 offset:4096
  v_mfma_f32_16x16x32_bf16 v[140:143], v[96:99], v[88:91], v[140:143]
  ds_read_b128 v[44:47], v10 offset:6144
  v_mfma_f32_16x16x32_bf16 v[224:227], v[96:99], v[92:95], v[224:227]
  ds_read_b128 v[48:51], v14
  v_mfma_f32_16x16x32_bf16 v[156:159], v[100:103], v[88:91], v[156:159]
  ds_read_b64_tr_b16 v[52:53], v12 offset:0
  v_mfma_f32_16x16x32_bf16 v[152:155], v[100:103], v[84:87], v[152:155]
  ds_read_b64_tr_b16 v[54:55], v12 offset:512
  v_mfma_f32_16x16x32_bf16 v[148:151], v[100:103], v[80:83], v[148:151]
  ds_read_b64_tr_b16 v[56:57], v13 offset:0
  v_mfma_f32_16x16x32_bf16 v[144:147], v[100:103], v[76:79], v[144:147]
  ds_read_b64_tr_b16 v[58:59], v13 offset:512
  v_mfma_f32_16x16x32_bf16 v[160:163], v[104:107], v[76:79], v[160:163]
  ds_read_b64_tr_b16 v[60:61], v12 offset:8192
  v_mfma_f32_16x16x32_bf16 v[164:167], v[104:107], v[80:83], v[164:167]
  ds_read_b64_tr_b16 v[62:63], v12 offset:8704
  v_mfma_f32_16x16x32_bf16 v[168:171], v[104:107], v[84:87], v[168:171]
  ds_read_b64_tr_b16 v[64:65], v13 offset:8192
  v_mfma_f32_16x16x32_bf16 v[172:175], v[104:107], v[88:91], v[172:175]
  ds_read_b64_tr_b16 v[66:67], v13 offset:8704
  v_mfma_f32_16x16x32_bf16 v[228:231], v[104:107], v[92:95], v[228:231]
  ds_read_b64_tr_b16 v[68:69], v12 offset:16384
  v_mfma_f32_16x16x32_bf16 v[188:191], v[108:111], v[88:91], v[188:191]
  ds_read_b64_tr_b16 v[70:71], v12 offset:16896
  v_mfma_f32_16x16x32_bf16 v[184:187], v[108:111], v[84:87], v[184:187]
  ds_read_b64_tr_b16 v[72:73], v13 offset:16384
  v_mfma_f32_16x16x32_bf16 v[180:183], v[108:111], v[80:83], v[180:183]
  ds_read_b64_tr_b16 v[74:75], v13 offset:16896
  v_mfma_f32_16x16x32_bf16 v[176:179], v[108:111], v[76:79], v[176:179]
  s_cmp_lg_u32 s79, 0
  s_nop 0
  v_mfma_f32_16x16x32_bf16 v[192:195], v[76:79], v[112:115], v[192:195]
  v_mfma_f32_16x16x32_bf16 v[196:199], v[80:83], v[112:115], v[196:199]
  v_mfma_f32_16x16x32_bf16 v[200:203], v[84:87], v[112:115], v[200:203]
  v_mfma_f32_16x16x32_bf16 v[204:207], v[88:91], v[112:115], v[204:207]
  v_mfma_f32_16x16x32_bf16 v[232:235], v[92:95], v[112:115], v[232:235]
  v_mfma_f32_16x16x32_bf16 v[220:223], v[88:91], v[116:119], v[220:223]
  v_mfma_f32_16x16x32_bf16 v[216:219], v[84:87], v[116:119], v[216:219]
  v_mfma_f32_16x16x32_bf16 v[212:215], v[80:83], v[116:119], v[212:215]
  v_mfma_f32_16x16x32_bf16 v[208:211], v[76:79], v[116:119], v[208:211]
  s_waitcnt lgkmcnt(0)
  s_cbranch_scc1 L_attn_loop
L_attn_exit:
  ds_read2_b32 v[66:67], v23 offset0:0 offset1:160
  ds_read2_b32 v[68:69], v23 offset0:16 offset1:176
  ds_read2_b32 v[70:71], v23 offset0:32 offset1:192
  ds_read2_b32 v[72:73], v23 offset0:48 offset1:208
  ds_read2_b32 v[74:75], v23 offset0:64 offset1:224
  ds_read2_b32 v[76:77], v25 offset0:0 offset1:16
  ds_read2_b32 v[80:81], v26 offset0:0 offset1:16
  ds_read2_b32 v[78:79], v25 offset0:32 offset1:48
  ds_read2_b32 v[82:83], v26 offset0:32 offset1:48
  ds_write_b128 v16, v[224:227] offset:0
  ds_write_b128 v16, v[228:231] offset:2048
  ds_write_b128 v16, v[232:235] offset:4096
  s_cmp_eq_u32 s71, 1
  s_cbranch_scc1 L_attn_nop3
  ds_write_b128 v16, v[172:175] offset:8192
  ds_write_b128 v16, v[188:191] offset:9216
  ds_write_b128 v16, v[204:207] offset:10240
  ds_write_b128 v16, v[220:223] offset:11264
L_attn_nop3:
  ds_read_b128 v[84:87], v24 offset:0
  ds_read_b128 v[104:107], v24 offset:640
  ds_read_b128 v[88:91], v24 offset:64
  ds_read_b128 v[108:111], v24 offset:704
  ds_read_b128 v[92:95], v24 offset:128
  ds_read_b128 v[112:115], v24 offset:768
  ds_read_b128 v[96:99], v24 offset:192
  ds_read_b128 v[116:119], v24 offset:832
  ds_read_b128 v[100:103], v24 offset:256
  ds_read_b128 v[120:123], v24 offset:896
  s_waitcnt lgkmcnt(10)
  s_barrier
  ds_read_b128 v[48:51], v19 offset:0
  ds_read_b128 v[52:55], v20 offset:1024
  ds_read_b128 v[56:59], v19 offset:2048
  ds_read_b128 v[60:63], v20 offset:3072
  ds_read_b32 v64, v21 offset:4096
  ds_read_b32 v65, v22 offset:5120
  ds_read_b128 v[32:35], v17 offset:2048
  ds_read_b128 v[36:39], v18 offset:3072
  ds_read_b128 v[40:43], v17 offset:4096
  ds_read_b128 v[44:47], v18 offset:5120
  v_mul_f32 v69, 0x3e8293ee, v69
  v_mul_f32 v71, 0x3e8293ee, v71
  v_mul_f32 v73, 0x3e8293ee, v73
  v_mul_f32 v75, 0x3e8293ee, v75
  v_mul_f32 v76, v76, v69
  v_mul_f32 v80, v80, v69
  v_mul_f32 v77, v77, v71
  v_mul_f32 v81, v81, v71
  v_mul_f32 v78, v78, v73
  v_mul_f32 v82, v82, v73
  v_mul_f32 v79, v79, v75
  v_mul_f32 v83, v83, v75
  s_waitcnt lgkmcnt(6)
  v_pk_fma_f32 v[128:129], v[48:49], v[68:69], v[128:129] op_sel:[0,0,0] op_sel_hi:[1,0,1] neg_lo:[0,1,0] neg_hi:[0,1,0]
  v_pk_fma_f32 v[130:131], v[50:51], v[68:69], v[130:131] op_sel:[0,0,0] op_sel_hi:[1,0,1] neg_lo:[0,1,0] neg_hi:[0,1,0]
  v_pk_fma_f32 v[144:145], v[52:53], v[68:69], v[144:145] op_sel:[0,0,0] op_sel_hi:[1,0,1] neg_lo:[0,1,0] neg_hi:[0,1,0]
  v_pk_fma_f32 v[146:147], v[54:55], v[68:69], v[146:147] op_sel:[0,0,0] op_sel_hi:[1,0,1] neg_lo:[0,1,0] neg_hi:[0,1,0]
  v_cvt_pk_bf16_f32 v128, v128, v129
  v_cvt_pk_bf16_f32 v129, v130, v131
  v_cvt_pk_bf16_f32 v130, v144, v145
  v_cvt_pk_bf16_f32 v131, v146, v147
  v_pk_fma_f32 v[160:161], v[56:57], v[68:69], v[160:161] op_sel:[0,0,0] op_sel_hi:[1,0,1] neg_lo:[0,1,0] neg_hi:[0,1,0]
  v_pk_fma_f32 v[162:163], v[58:59], v[68:69], v[162:163] op_sel:[0,0,0] op_sel_hi:[1,0,1] neg_lo:[0,1,0] neg_hi:[0,1,0]
  v_pk_fma_f32 v[176:177], v[60:61], v[68:69], v[176:177] op_sel:[0,0,0] op_sel_hi:[1,0,1] neg_lo:[0,1,0] neg_hi:[0,1,0]
  v_pk_fma_f32 v[178:179], v[62:63], v[68:69], v[178:179] op_sel:[0,0,0] op_sel_hi:[1,0,1] neg_lo:[0,1,0] neg_hi:[0,1,0]
  v_cvt_pk_bf16_f32 v160, v160, v161
  v_cvt_pk_bf16_f32 v161, v162, v163
  v_cvt_pk_bf16_f32 v162, v176, v177
  v_cvt_pk_bf16_f32 v163, v178, v179
  v_pk_fma_f32 v[132:133], v[48:49], v[70:71], v[132:133] op_sel:[0,0,0] op_sel_hi:[1,0,1] neg_lo:[0,1,0] neg_hi:[0,1,0]
  v_pk_fma_f32 v[134:135], v[50:51], v[70:71], v[134:135] op_sel:[0,0,0] op_sel_hi:[1,0,1] neg_lo:[0,1,0] neg_hi:[0,1,0]
  v_pk_fma_f32 v[148:149], v[52:53], v[70:71], v[148:149] op_sel:[0,0,0] op_sel_hi:[1,0,1] neg_lo:[0,1,0] neg_hi:[0,1,0]
  v_pk_fma_f32 v[150:151], v[54:55], v[70:71], v[150:151] op_sel:[0,0,0] op_sel_hi:[1,0,1] neg_lo:[0,1,0] neg_hi:[0,1,0]
  v_cvt_pk_bf16_f32 v132, v132, v133
  v_cvt_pk_bf16_f32 v133, v134, v135
  v_cvt_pk_bf16_f32 v134, v148, v149
  v_cvt_pk_bf16_f32 v135, v150, v151
  v_pk_fma_f32 v[164:165], v[56:57], v[70:71], v[164:165] op_sel:[0,0,0] op_sel_hi:[1,0,1] neg_lo:[0,1,0] neg_hi:[0,1,0]
  v_pk_fma_f32 v[166:167], v[58:59], v[70:71], v[166:167] op_sel:[0,0,0] op_sel_hi:[1,0,1] neg_lo:[0,1,0] neg_hi:[0,1,0]
  v_pk_fma_f32 v[180:181], v[60:61], v[70:71], v[180:181] op_sel:[0,0,0] op_sel_hi:[1,0,1] neg_lo:[0,1,0] neg_hi:[0,1,0]
  v_pk_fma_f32 v[182:183], v[62:63], v[70:71], v[182:183] op_sel:[0,0,0] op_sel_hi:[1,0,1] neg_lo:[0,1,0] neg_hi:[0,1,0]
  v_cvt_pk_bf16_f32 v164, v164, v165
  v_cvt_pk_bf16_f32 v165, v166, v167
  v_cvt_pk_bf16_f32 v166, v180, v181
  v_cvt_pk_bf16_f32 v167, v182, v183
  v_mfma_f32_16x16x32_bf16 v[144:147], v[160:163], v[128:131], 0
  v_pk_fma_f32 v[136:137], v[48:49], v[72:73], v[136:137] op_sel:[0,0,0] op_sel_hi:[1,0,1] neg_lo:[0,1,0] neg_hi:[0,1,0]
  v_pk_fma_f32 v[138:139], v[50:51], v[72:73], v[138:139] op_sel:[0,0,0] op_sel_hi:[1,0,1] neg_lo:[0,1,0] neg_hi:[0,1,0]
  v_pk_fma_f32 v[152:153], v[52:53], v[72:73], v[152:153] op_sel:[0,0,0] op_sel_hi:[1,0,1] neg_lo:[0,1,0] neg_hi:[0,1,0]
  v_pk_fma_f32 v[154:155], v[54:55], v[72:73], v[154:155] op_sel:[0,0,0] op_sel_hi:[1,0,1] neg_lo:[0,1,0] neg_hi:[0,1,0]
  v_cvt_pk_bf16_f32 v136, v136, v137
  v_cvt_pk_bf16_f32 v137, v138, v139
  v_cvt_pk_bf16_f32 v138, v152, v153
  v_cvt_pk_bf16_f32 v139, v154, v155
  v_pk_fma_f32 v[168:169], v[56:57], v[72:73], v[168:169] op_sel:[0,0,0] op_sel_hi:[1,0,1] neg_lo:[0,1,0] neg_hi:[0,1,0]
  v_pk_fma_f32 v[170:171], v[58:59], v[72:73], v[170:171] op_sel:[0,0,0] op_sel_hi:[1,0,1] neg_lo:[0,1,0] neg_hi:[0,1,0]
  v_pk_fma_f32 v[184:185], v[60:61], v[72:73], v[184:185] op_sel:[0,0,0] op_sel_hi:[1,0,1] neg_lo:[0,1,0] neg_hi:[0,1,0]
  v_pk_fma_f32 v[186:187], v[62:63], v[72:73], v[186:187] op_sel:[0,0,0] op_sel_hi:[1,0,1] neg_lo:[0,1,0] neg_hi:[0,1,0]
  v_cvt_pk_bf16_f32 v168, v168, v169
  v_cvt_pk_bf16_f32 v169, v170, v171
  v_cvt_pk_bf16_f32 v170, v184, v185
  v_cvt_pk_bf16_f32 v171, v186, v187
  v_mfma_f32_16x16x32_bf16 v[148:151], v[164:167], v[132:135], 0
  v_mfma_f32_16x16x32_bf16 v[180:183], v[160:163], v[132:135], 0
  v_pk_fma_f32 v[140:141], v[48:49], v[74:75], v[140:141] op_sel:[0,0,0] op_sel_hi:[1,0,1] neg_lo:[0,1,0] neg_hi:[0,1,0]
  v_pk_fma_f32 v[142:143], v[50:51], v[74:75], v[142:143] op_sel:[0,0,0] op_sel_hi:[1,0,1] neg_lo:[0,1,0] neg_hi:[0,1,0]
  v_pk_fma_f32 v[156:157], v[52:53], v[74:75], v[156:157] op_sel:[0,0,0] op_sel_hi:[1,0,1] neg_lo:[0,1,0] neg_hi:[0,1,0]
  v_pk_fma_f32 v[158:159], v[54:55], v[74:75], v[158:159] op_sel:[0,0,0] op_sel_hi:[1,0,1] neg_lo:[0,1,0] neg_hi:[0,1,0]
  v_cvt_pk_bf16_f32 v140, v140, v141
  v_cvt_pk_bf16_f32 v141, v142, v143
  v_cvt_pk_bf16_f32 v142, v156, v157
  v_cvt_pk_bf16_f32 v143, v158, v159
  v_pk_fma_f32 v[172:173], v[56:57], v[74:75], v[172:173] op_sel:[0,0,0] op_sel_hi:[1,0,1] neg_lo:[0,1,0] neg_hi:[0,1,0]
  v_pk_fma_f32 v[174:175], v[58:59], v[74:75], v[174:175] op_sel:[0,0,0] op_sel_hi:[1,0,1] neg_lo:[0,1,0] neg_hi:[0,1,0]
  v_pk_fma_f32 v[188:189], v[60:61], v[74:75], v[188:189] op_sel:[0,0,0] op_sel_hi:[1,0,1] neg_lo:[0,1,0] neg_hi:[0,1,0]
  v_pk_fma_f32 v[190:191], v[62:63], v[74:75], v[190:191] op_sel:[0,0,0] op_sel_hi:[1,0,1] neg_lo:[0,1,0] neg_hi:[0,1,0]
  v_cvt_pk_bf16_f32 v172, v172, v173
  v_cvt_pk_bf16_f32 v173, v174, v175
  v_cvt_pk_bf16_f32 v174, v188, v189
  v_cvt_pk_bf16_f32 v175, v190, v191
  s_waitcnt lgkmcnt(0)
  v_pk_fma_f32 v[32:33], v[56:57], v[66:67], v[32:33] op_sel:[0,0,0] op_sel_hi:[1,0,1] neg_lo:[0,1,0] neg_hi:[0,1,0]
  v_pk_fma_f32 v[34:35], v[58:59], v[66:67], v[34:35] op_sel:[0,0,0] op_sel_hi:[1,0,1] neg_lo:[0,1,0] neg_hi:[0,1,0]
  v_pk_fma_f32 v[36:37], v[60:61], v[66:67], v[36:37] op_sel:[0,0,0] op_sel_hi:[1,0,1] neg_lo:[0,1,0] neg_hi:[0,1,0]
  v_pk_fma_f32 v[38:39], v[62:63], v[66:67], v[38:39] op_sel:[0,0,0] op_sel_hi:[1,0,1] neg_lo:[0,1,0] neg_hi:[0,1,0]
  v_cvt_pk_bf16_f32 v32, v32, v33
  v_cvt_pk_bf16_f32 v33, v34, v35
  v_cvt_pk_bf16_f32 v34, v36, v37
  v_cvt_pk_bf16_f32 v35, v38, v39
  v_mfma_f32_16x16x32_bf16 v[152:155], v[168:171], v[136:139], 0
  v_mfma_f32_16x16x32_bf16 v[184:187], v[164:167], v[136:139], 0
  v_mfma_f32_16x16x32_bf16 v[156:159], v[172:175], v[140:143], 0
  v_mfma_f32_16x16x32_bf16 v[188:191], v[168:171], v[140:143], 0
  v_mfma_f32_16x16x32_bf16 v[176:179], v[32:35], v[128:131], 0
  v_pk_fma_f32 v[40:41], v[84:85], v[64:65], v[40:41] op_sel:[0,0,0] op_sel_hi:[1,0,1] neg_lo:[1,0,0] neg_hi:[1,0,0]
  v_pk_fma_f32 v[42:43], v[86:87], v[64:65], v[42:43] op_sel:[0,0,0] op_sel_hi:[1,0,1] neg_lo:[1,0,0] neg_hi:[1,0,0]
  v_pk_mul_f32 v[40:41], v[40:41], v[104:105]
  v_pk_mul_f32 v[42:43], v[42:43], v[106:107]
  v_cvt_pk_bf16_f32 v4, v40, v41
  v_cvt_pk_bf16_f32 v5, v42, v43
  v_pk_fma_f32 v[192:193], v[88:89], v[64:65], v[192:193] op_sel:[0,0,0] op_sel_hi:[1,0,1] neg_lo:[1,0,0] neg_hi:[1,0,0]
  v_pk_fma_f32 v[194:195], v[90:91], v[64:65], v[194:195] op_sel:[0,0,0] op_sel_hi:[1,0,1] neg_lo:[1,0,0] neg_hi:[1,0,0]
  v_pk_mul_f32 v[192:193], v[192:193], v[108:109]
  v_pk_mul_f32 v[194:195], v[194:195], v[110:111]
  v_cvt_pk_bf16_f32 v6, v192, v193
  v_cvt_pk_bf16_f32 v7, v194, v195
  v_pk_fma_f32 v[196:197], v[92:93], v[64:65], v[196:197] op_sel:[0,0,0] op_sel_hi:[1,0,1] neg_lo:[1,0,0] neg_hi:[1,0,0]
  v_pk_fma_f32 v[198:199], v[94:95], v[64:65], v[198:199] op_sel:[0,0,0] op_sel_hi:[1,0,1] neg_lo:[1,0,0] neg_hi:[1,0,0]
  v_pk_mul_f32 v[196:197], v[196:197], v[112:113]
  v_pk_mul_f32 v[198:199], v[198:199], v[114:115]
  v_cvt_pk_bf16_f32 v8, v196, v197
  v_cvt_pk_bf16_f32 v9, v198, v199
  v_pk_fma_f32 v[200:201], v[96:97], v[64:65], v[200:201] op_sel:[0,0,0] op_sel_hi:[1,0,1] neg_lo:[1,0,0] neg_hi:[1,0,0]
  v_pk_fma_f32 v[202:203], v[98:99], v[64:65], v[202:203] op_sel:[0,0,0] op_sel_hi:[1,0,1] neg_lo:[1,0,0] neg_hi:[1,0,0]
  v_pk_mul_f32 v[200:201], v[200:201], v[116:117]
  v_pk_mul_f32 v[202:203], v[202:203], v[118:119]
  v_cvt_pk_bf16_f32 v10, v200, v201
  v_cvt_pk_bf16_f32 v11, v202, v203
  v_pk_fma_f32 v[204:205], v[100:101], v[64:65], v[204:205] op_sel:[0,0,0] op_sel_hi:[1,0,1] neg_lo:[1,0,0] neg_hi:[1,0,0]
  v_pk_fma_f32 v[206:207], v[102:103], v[64:65], v[206:207] op_sel:[0,0,0] op_sel_hi:[1,0,1] neg_lo:[1,0,0] neg_hi:[1,0,0]
  v_pk_mul_f32 v[204:205], v[204:205], v[120:121]
  v_pk_mul_f32 v[206:207], v[206:207], v[122:123]
  v_cvt_pk_bf16_f32 v12, v204, v205
  v_cvt_pk_bf16_f32 v13, v206, v207
  v_pk_fma_f32 v[44:45], v[84:85], v[64:65], v[44:45] op_sel:[0,1,0] op_sel_hi:[1,1,1] neg_lo:[1,0,0] neg_hi:[1,0,0]
  v_pk_fma_f32 v[46:47], v[86:87], v[64:65], v[46:47] op_sel:[0,1,0] op_sel_hi:[1,1,1] neg_lo:[1,0,0] neg_hi:[1,0,0]
  v_pk_mul_f32 v[44:45], v[44:45], v[104:105]
  v_pk_mul_f32 v[46:47], v[46:47], v[106:107]
  v_cvt_pk_bf16_f32 v224, v44, v45
  v_cvt_pk_bf16_f32 v225, v46, v47
  v_pk_fma_f32 v[208:209], v[88:89], v[64:65], v[208:209] op_sel:[0,1,0] op_sel_hi:[1,1,1] neg_lo:[1,0,0] neg_hi:[1,0,0]
  v_pk_fma_f32 v[210:211], v[90:91], v[64:65], v[210:211] op_sel:[0,1,0] op_sel_hi:[1,1,1] neg_lo:[1,0,0] neg_hi:[1,0,0]
  v_pk_mul_f32 v[208:209], v[208:209], v[108:109]
  v_pk_mul_f32 v[210:211], v[210:211], v[110:111]
  v_cvt_pk_bf16_f32 v226, v208, v209
  v_cvt_pk_bf16_f32 v227, v210, v211
  v_pk_fma_f32 v[212:213], v[92:93], v[64:65], v[212:213] op_sel:[0,1,0] op_sel_hi:[1,1,1] neg_lo:[1,0,0] neg_hi:[1,0,0]
  v_pk_fma_f32 v[214:215], v[94:95], v[64:65], v[214:215] op_sel:[0,1,0] op_sel_hi:[1,1,1] neg_lo:[1,0,0] neg_hi:[1,0,0]
  v_pk_mul_f32 v[212:213], v[212:213], v[112:113]
  v_pk_mul_f32 v[214:215], v[214:215], v[114:115]
  v_cvt_pk_bf16_f32 v228, v212, v213
  v_cvt_pk_bf16_f32 v229, v214, v215
  v_pk_fma_f32 v[216:217], v[96:97], v[64:65], v[216:217] op_sel:[0,1,0] op_sel_hi:[1,1,1] neg_lo:[1,0,0] neg_hi:[1,0,0]
  v_pk_fma_f32 v[218:219], v[98:99], v[64:65], v[218:219] op_sel:[0,1,0] op_sel_hi:[1,1,1] neg_lo:[1,0,0] neg_hi:[1,0,0]
  v_pk_mul_f32 v[216:217], v[216:217], v[116:117]
  v_pk_mul_f32 v[218:219], v[218:219], v[118:119]
  v_cvt_pk_bf16_f32 v230, v216, v217
  v_cvt_pk_bf16_f32 v231, v218, v219
  v_pk_fma_f32 v[220:221], v[100:101], v[64:65], v[220:221] op_sel:[0,1,0] op_sel_hi:[1,1,1] neg_lo:[1,0,0] neg_hi:[1,0,0]
  v_pk_fma_f32 v[222:223], v[102:103], v[64:65], v[222:223] op_sel:[0,1,0] op_sel_hi:[1,1,1] neg_lo:[1,0,0] neg_hi:[1,0,0]
  v_pk_mul_f32 v[220:221], v[220:221], v[120:121]
  v_pk_mul_f32 v[222:223], v[222:223], v[122:123]
  v_cvt_pk_bf16_f32 v232, v220, v221
  v_cvt_pk_bf16_f32 v233, v222, v223
  v_cndmask_b32 v148, v148, v149, s[48:49]
  v_cndmask_b32 v180, v180, v181, s[48:49]
  v_cndmask_b32 v150, v150, v151, s[48:49]
  v_cndmask_b32 v182, v182, v183, s[48:49]
  v_cndmask_b32 v36, v148, v180, s[50:51]
  v_cndmask_b32 v37, v150, v182, s[52:53]
  v_mul_f32 v36, v36, v77
  v_mul_f32 v37, v37, v81
  v_cndmask_b32 v152, v152, v153, s[48:49]
  v_cndmask_b32 v184, v184, v185, s[48:49]
  v_cndmask_b32 v154, v154, v155, s[48:49]
  v_cndmask_b32 v186, v186, v187, s[48:49]
  v_cndmask_b32 v40, v152, v184, s[50:51]
  v_cndmask_b32 v41, v154, v186, s[52:53]
  v_mul_f32 v40, v40, v78
  v_mul_f32 v41, v41, v82
  v_cndmask_b32 v156, v156, v157, s[48:49]
  v_cndmask_b32 v188, v188, v189, s[48:49]
  v_cndmask_b32 v158, v158, v159, s[48:49]
  v_cndmask_b32 v190, v190, v191, s[48:49]
  v_cndmask_b32 v44, v156, v188, s[50:51]
  v_cndmask_b32 v45, v158, v190, s[52:53]
  v_mul_f32 v44, v44, v79
  v_mul_f32 v45, v45, v83
  v_cndmask_b32 v144, v144, v145, s[48:49]
  v_cndmask_b32 v176, v176, v177, s[48:49]
  v_cndmask_b32 v146, v146, v147, s[48:49]
  v_cndmask_b32 v178, v178, v179, s[48:49]
  v_cndmask_b32 v32, v144, v176, s[50:51]
  v_cndmask_b32 v33, v146, v178, s[52:53]
  v_mul_f32 v32, v32, v76
  v_mul_f32 v33, v33, v80
  v_mov_b32 v48, 0xceabfb8f
  v_cndmask_b32 v32, v32, v48, s[54:55]
  v_cndmask_b32 v33, v33, v48, s[14:15]
  v_max_f32 v34, v32, v33
  v_max_f32 v38, v36, v37
  v_max_f32 v42, v40, v41
  v_max_f32 v46, v44, v45
  v_mov_b32 v35, v34
  v_mov_b32 v39, v38
  v_mov_b32 v43, v42
  v_mov_b32 v47, v46
  v_permlane32_swap_b32 v34, v35
  v_permlane32_swap_b32 v38, v39
  v_permlane32_swap_b32 v42, v43
  v_permlane32_swap_b32 v46, v47
  v_max_f32 v34, v34, v35
  v_max_f32 v38, v38, v39
  v_max_f32 v42, v42, v43
  v_max_f32 v46, v46, v47
  v_mov_b32 v35, v34
  v_mov_b32 v39, v38
  v_mov_b32 v43, v42
  v_mov_b32 v47, v46
  v_permlane16_swap_b32 v34, v35
  v_permlane16_swap_b32 v38, v39
  v_permlane16_swap_b32 v42, v43
  v_permlane16_swap_b32 v46, v47
  v_max_f32 v34, v34, v35
  v_max_f32 v38, v38, v39
  v_max_f32 v42, v42, v43
  v_max_f32 v46, v46, v47
  v_sub_f32 v32, v32, v34
  v_sub_f32 v33, v33, v34
  v_sub_f32 v36, v36, v38
  v_sub_f32 v37, v37, v38
  v_sub_f32 v40, v40, v42
  v_sub_f32 v41, v41, v42
  v_sub_f32 v44, v44, v46
  v_sub_f32 v45, v45, v46
  v_exp_f32 v32, v32
  v_exp_f32 v33, v33
  v_exp_f32 v36, v36
  v_exp_f32 v37, v37
  v_exp_f32 v40, v40
  v_exp_f32 v41, v41
  v_exp_f32 v44, v44
  v_exp_f32 v45, v45
  v_cvt_pk_bf16_f32 v32, v32, v32
  v_cvt_pk_bf16_f32 v33, v33, v33
  v_and_b32 v128, v32, v27
  v_and_b32 v129, v33, v29
  v_and_b32 v130, v32, v28
  v_and_b32 v131, v33, v30
  v_cvt_pk_bf16_f32 v36, v36, v36
  v_cvt_pk_bf16_f32 v37, v37, v37
  v_and_b32 v132, v36, v27
  v_and_b32 v133, v37, v29
  v_and_b32 v134, v36, v28
  v_and_b32 v135, v37, v30
  v_mfma_f32_16x16x32_bf16 v[144:147], v[236:239], v[128:131], 0
  v_mfma_f32_16x16x32_bf16 v[192:195], v[4:7], v[128:131], 0
  v_mfma_f32_16x16x32_bf16 v[208:211], v[224:227], v[128:131], 0
  v_cvt_pk_bf16_f32 v40, v40, v40
  v_cvt_pk_bf16_f32 v41, v41, v41
  v_and_b32 v136, v40, v27
  v_and_b32 v137, v41, v29
  v_and_b32 v138, v40, v28
  v_and_b32 v139, v41, v30
  v_mfma_f32_16x16x32_bf16 v[148:151], v[236:239], v[132:135], 0
  v_mfma_f32_16x16x32_bf16 v[196:199], v[6:9], v[132:135], 0
  v_mfma_f32_16x16x32_bf16 v[212:215], v[226:229], v[132:135], 0
  v_cvt_pk_bf16_f32 v44, v44, v44
  v_cvt_pk_bf16_f32 v45, v45, v45
  v_and_b32 v140, v44, v27
  v_and_b32 v141, v45, v29
  v_and_b32 v142, v44, v28
  v_and_b32 v143, v45, v30
  v_mfma_f32_16x16x32_bf16 v[152:155], v[236:239], v[136:139], 0
  v_mfma_f32_16x16x32_bf16 v[200:203], v[8:11], v[136:139], 0
  v_mfma_f32_16x16x32_bf16 v[216:219], v[228:231], v[136:139], 0
  v_mfma_f32_16x16x32_bf16 v[156:159], v[236:239], v[140:143], 0
  v_mfma_f32_16x16x32_bf16 v[204:207], v[10:13], v[140:143], 0
  v_mfma_f32_16x16x32_bf16 v[220:223], v[230:233], v[140:143], 0
  v_rcp_f32 v144, v144
  s_mov_b32 s3, 0
  v_pk_mul_f32 v[192:193], v[192:193], v[144:145] op_sel_hi:[1,0]
  v_pk_mul_f32 v[194:195], v[194:195], v[144:145] op_sel_hi:[1,0]
  v_pk_mul_f32 v[208:209], v[208:209], v[144:145] op_sel_hi:[1,0]
  v_pk_mul_f32 v[210:211], v[210:211], v[144:145] op_sel_hi:[1,0]
  v_cvt_pk_bf16_f32 v48, v192, v193
  v_cvt_pk_bf16_f32 v49, v194, v195
  v_cvt_pk_bf16_f32 v50, v208, v209
  v_cvt_pk_bf16_f32 v51, v210, v211
  s_nop 1
  v_permlane16_swap_b32 v48, v50
  v_permlane16_swap_b32 v49, v51
  buffer_store_dwordx4 v[48:51], v31, s[44:47], s3 offen sc1
  v_rcp_f32 v148, v148
  s_mov_b32 s3, 32768
  v_pk_mul_f32 v[196:197], v[196:197], v[148:149] op_sel_hi:[1,0]
  v_pk_mul_f32 v[198:199], v[198:199], v[148:149] op_sel_hi:[1,0]
  v_pk_mul_f32 v[212:213], v[212:213], v[148:149] op_sel_hi:[1,0]
  v_pk_mul_f32 v[214:215], v[214:215], v[148:149] op_sel_hi:[1,0]
  v_cvt_pk_bf16_f32 v52, v196, v197
  v_cvt_pk_bf16_f32 v53, v198, v199
  v_cvt_pk_bf16_f32 v54, v212, v213
  v_cvt_pk_bf16_f32 v55, v214, v215
  s_nop 1
  v_permlane16_swap_b32 v52, v54
  v_permlane16_swap_b32 v53, v55
  buffer_store_dwordx4 v[52:55], v31, s[44:47], s3 offen sc1
  v_rcp_f32 v152, v152
  s_mov_b32 s3, 65536
  v_pk_mul_f32 v[200:201], v[200:201], v[152:153] op_sel_hi:[1,0]
  v_pk_mul_f32 v[202:203], v[202:203], v[152:153] op_sel_hi:[1,0]
  v_pk_mul_f32 v[216:217], v[216:217], v[152:153] op_sel_hi:[1,0]
  v_pk_mul_f32 v[218:219], v[218:219], v[152:153] op_sel_hi:[1,0]
  v_cvt_pk_bf16_f32 v56, v200, v201
  v_cvt_pk_bf16_f32 v57, v202, v203
  v_cvt_pk_bf16_f32 v58, v216, v217
  v_cvt_pk_bf16_f32 v59, v218, v219
  s_nop 1
  v_permlane16_swap_b32 v56, v58
  v_permlane16_swap_b32 v57, v59
  buffer_store_dwordx4 v[56:59], v31, s[44:47], s3 offen sc1
  v_rcp_f32 v156, v156
  s_mov_b32 s3, 98304
  v_pk_mul_f32 v[204:205], v[204:205], v[156:157] op_sel_hi:[1,0]
  v_pk_mul_f32 v[206:207], v[206:207], v[156:157] op_sel_hi:[1,0]
  v_pk_mul_f32 v[220:221], v[220:221], v[156:157] op_sel_hi:[1,0]
  v_pk_mul_f32 v[222:223], v[222:223], v[156:157] op_sel_hi:[1,0]
  v_cvt_pk_bf16_f32 v60, v204, v205
  v_cvt_pk_bf16_f32 v61, v206, v207
  v_cvt_pk_bf16_f32 v62, v220, v221
  v_cvt_pk_bf16_f32 v63, v222, v223
  s_nop 1
  v_permlane16_swap_b32 v60, v62
  v_permlane16_swap_b32 v61, v63
  buffer_store_dwordx4 v[60:63], v31, s[44:47], s3 offen sc1
  s_waitcnt vmcnt(0) lgkmcnt(0)
  s_barrier
  s_add_u32 s97, s97, 1
  s_branch L_wo_body
.section .rodata,"a"
.p2align 6
.amdhsa_kernel interleave_layers__sliding_local_dilated__dense_activation_gelu__prompt_kernel
  .amdhsa_next_free_vgpr 256
  .amdhsa_next_free_sgpr 102
  .amdhsa_accum_offset 256
  .amdhsa_group_segment_fixed_size 0
  .amdhsa_kernarg_size 88
  .amdhsa_user_sgpr_count 2
  .amdhsa_user_sgpr_kernarg_segment_ptr 1
  .amdhsa_system_sgpr_workgroup_id_x 1
  .amdhsa_float_denorm_mode_32 3
  .amdhsa_float_denorm_mode_16_64 3
.end_amdhsa_kernel
.text
L_attn_c1:
L_wo_c0:
L_wo_body:
  s_cmp_ge_u32 s2, 256
  s_cbranch_scc1 L_wo_end
  v_lshrrev_b32 v2, 6, v0
  v_and_b32 v1, 63, v0
  v_readfirstlane_b32 s70, v2
  s_and_b32 s3, s2, 7
  s_lshr_b32 s99, s2, 3
  s_and_b32 s5, s3, 3
  s_lshl_b32 s5, s5, 2
  s_and_b32 s6, s99, 3
  s_add_u32 s68, s5, s6
  s_lshr_b32 s5, s3, 2
  s_lshr_b32 s78, s99, 2
  s_lshl1_add_u32 s69, s78, s5
  s_add_u32 s3, s68, s78
  s_lshl_b32 s3, s3, 3
  s_lshl_b32 s85, 0xffff02, s3
  s_sub_u32 s3, 0, s3
  s_lshr_b32 s3, 0xffff02, s3
  s_or_b32 s85, s85, s3
  s_cmp_lt_u32 s70, 4
  s_cbranch_scc1 L_wo_compute
L_wo_loader:
  s_add_u32 s3, s96, s70
  s_cmp_lg_u32 s3, 4
  s_cbranch_scc1 L_wo_chk0
  s_load_dwordx2 s[64:65], s[0:1], 72
  s_waitcnt lgkmcnt(0)
  s_and_b32 s65, s65, 0xffff
  s_mov_b32 s66, 256
  s_mov_b32 s67, 0x00020000
  v_lshlrev_b32 v17, 2, v1
  buffer_load_dword v12, v17, s[64:67], 0 offen sc1
L_wo_chk0:
  s_cmp_lg_u32 s96, 0
  s_cbranch_scc1 L_wo_nofirst
  s_waitcnt vmcnt(1)
  s_mov_b32 s7, 0xffff0000
  v_lshlrev_b32 v32, 16, v64
  v_and_b32 v33, s7, v64
  v_lshlrev_b32 v34, 16, v65
  v_and_b32 v35, s7, v65
  v_lshlrev_b32 v36, 16, v66
  v_and_b32 v37, s7, v66
  v_lshlrev_b32 v38, 16, v67
  v_and_b32 v39, s7, v67
  v_lshlrev_b32 v40, 16, v68
  v_and_b32 v41, s7, v68
  v_pk_add_f32 v[32:33], v[32:33], v[40:41]
  v_lshlrev_b32 v40, 16, v69
  v_and_b32 v41, s7, v69
  v_pk_add_f32 v[34:35], v[34:35], v[40:41]
  v_lshlrev_b32 v40, 16, v70
  v_and_b32 v41, s7, v70
  v_pk_add_f32 v[36:37], v[36:37], v[40:41]
  v_lshlrev_b32 v40, 16, v71
  v_and_b32 v41, s7, v71
  v_pk_add_f32 v[38:39], v[38:39], v[40:41]
  v_lshlrev_b32 v40, 16, v72
  v_and_b32 v41, s7, v72
  v_pk_add_f32 v[32:33], v[32:33], v[40:41]
  v_lshlrev_b32 v40, 16, v73
  v_and_b32 v41, s7, v73
  v_pk_add_f32 v[34:35], v[34:35], v[40:41]
  v_lshlrev_b32 v40, 16, v74
  v_and_b32 v41, s7, v74
  v_pk_add_f32 v[36:37], v[36:37], v[40:41]
  v_lshlrev_b32 v40, 16, v75
  v_and_b32 v41, s7, v75
  v_pk_add_f32 v[38:39], v[38:39], v[40:41]
  v_lshlrev_b32 v40, 16, v76
  v_and_b32 v41, s7, v76
  v_pk_add_f32 v[32:33], v[32:33], v[40:41]
  v_lshlrev_b32 v40, 16, v77
  v_and_b32 v41, s7, v77
  v_pk_add_f32 v[34:35], v[34:35], v[40:41]
  v_lshlrev_b32 v40, 16, v78
  v_and_b32 v41, s7, v78
  v_pk_add_f32 v[36:37], v[36:37], v[40:41]
  v_lshlrev_b32 v40, 16, v79
  v_and_b32 v41, s7, v79
  v_pk_add_f32 v[38:39], v[38:39], v[40:41]
  v_lshlrev_b32 v40, 16, v80
  v_and_b32 v41, s7, v80
  v_pk_add_f32 v[32:33], v[32:33], v[40:41]
  v_lshlrev_b32 v40, 16, v81
  v_and_b32 v41, s7, v81
  v_pk_add_f32 v[34:35], v[34:35], v[40:41]
  v_lshlrev_b32 v40, 16, v82
  v_and_b32 v41, s7, v82
  v_pk_add_f32 v[36:37], v[36:37], v[40:41]
  v_lshlrev_b32 v40, 16, v83
  v_and_b32 v41, s7, v83
  v_pk_add_f32 v[38:39], v[38:39], v[40:41]
  v_lshlrev_b32 v40, 16, v84
  v_and_b32 v41, s7, v84
  v_pk_add_f32 v[32:33], v[32:33], v[40:41]
  v_lshlrev_b32 v40, 16, v85
  v_and_b32 v41, s7, v85
  v_pk_add_f32 v[34:35], v[34:35], v[40:41]
  v_lshlrev_b32 v40, 16, v86
  v_and_b32 v41, s7, v86
  v_pk_add_f32 v[36:37], v[36:37], v[40:41]
  v_lshlrev_b32 v40, 16, v87
  v_and_b32 v41, s7, v87
  v_pk_add_f32 v[38:39], v[38:39], v[40:41]
  v_lshlrev_b32 v40, 16, v88
  v_and_b32 v41, s7, v88
  v_pk_add_f32 v[32:33], v[32:33], v[40:41]
  v_lshlrev_b32 v40, 16, v89
  v_and_b32 v41, s7, v89
  v_pk_add_f32 v[34:35], v[34:35], v[40:41]
  v_lshlrev_b32 v40, 16, v90
  v_and_b32 v41, s7, v90
  v_pk_add_f32 v[36:37], v[36:37], v[40:41]
  v_lshlrev_b32 v40, 16, v91
  v_and_b32 v41, s7, v91
  v_pk_add_f32 v[38:39], v[38:39], v[40:41]
  v_lshlrev_b32 v40, 16, v92
  v_and_b32 v41, s7, v92
  v_pk_add_f32 v[32:33], v[32:33], v[40:41]
  v_lshlrev_b32 v40, 16, v93
  v_and_b32 v41, s7, v93
  v_pk_add_f32 v[34:35], v[34:35], v[40:41]
  v_lshlrev_b32 v40, 16, v94
  v_and_b32 v41, s7, v94
  v_pk_add_f32 v[36:37], v[36:37], v[40:41]
  v_lshlrev_b32 v40, 16, v95
  v_and_b32 v41, s7, v95
  v_pk_add_f32 v[38:39], v[38:39], v[40:41]
  s_add_u32 s52, s22, 24641536
  s_addc_u32 s53, s23, 0
  s_and_b32 s53, s53, 0xffff
  s_mov_b32 s54, 262144
  s_mov_b32 s55, 0x00020000
  v_permlane32_swap_b32 v32, v36
  v_permlane32_swap_b32 v33, v37
  v_permlane32_swap_b32 v34, v38
  v_permlane32_swap_b32 v35, v39
  v_add_f32 v32, v32, v36
  v_add_f32 v33, v33, v37
  v_add_f32 v34, v34, v38
  v_add_f32 v35, v35, v39
  v_and_b32 v2, 7, v1
  v_lshlrev_b32 v2, 5, v2
  v_permlane16_swap_b32 v32, v34
  v_permlane16_swap_b32 v33, v35
  v_add_f32 v32, v32, v34
  v_add_f32 v33, v33, v35
  v_lshrrev_b32 v3, 4, v1
  v_lshl_add_u32 v2, v3, 3, v2
  v_add_f32_dpp v32, v32, v32 row_ror:8 row_mask:0xf bank_mask:0xf
  v_add_f32_dpp v33, v33, v33 row_ror:8 row_mask:0xf bank_mask:0xf
  buffer_store_dwordx2 v[32:33], v2, s[52:55], s94 offen sc1
L_wo_nofirst:
  v_and_b32 v2, 3, v1
  v_lshlrev_b32 v2, 3, v2
  v_bfe_i32 v16, s85, v2, 8
  s_and_b32 s3, s68, 3
  s_mul_i32 s4, s3, 4
  v_add3_u32 v3, v16, v1, s4
  v_and_b32 v3, 15, v3
  v_lshlrev_b32 v16, 17, v3
  s_add_u32 s9, s70, s68
  s_and_b32 s9, s9, 3
  s_lshl_b32 s77, s9, 11
  v_and_b32 v10, 7, v1
  v_lshrrev_b32 v3, 3, v1
  s_lshl_b32 s10, s9, 4
  v_add_u32 v3, s10, v3
  v_mul_u32_u24 v3, 2048, v3
  v_lshrrev_b32 v2, 3, v1
  v_and_b32 v2, 2, v2
  v_xor_b32 v2, v2, v10
  s_lshl_b32 s10, s69, 7
  v_add_u32 v3, s10, v3
  v_lshl_add_u32 v8, v2, 4, v3
  v_xor_b32 v2, 4, v2
  v_add_u32 v3, 16384, v3
  v_lshl_add_u32 v9, v2, 4, v3
  s_mov_b32 s40, s20
  s_and_b32 s41, s21, 0xffff
  s_mov_b32 s42, 2097152
  s_mov_b32 s43, 0x00020000
  v_readlane_b32 s74, v16, 0
  s_add_u32 m0, s77, 131072
  s_add_u32 s4, s74, 0
  buffer_load_dwordx4 v8, s[40:43], s4 offen lds
  s_add_u32 m0, s77, 132096
  s_nop 0
  buffer_load_dwordx4 v9, s[40:43], s4 offen lds
  v_readlane_b32 s74, v16, 1
  s_add_u32 m0, s77, 139264
  s_add_u32 s4, s74, 0
  buffer_load_dwordx4 v8, s[40:43], s4 offen lds
  s_add_u32 m0, s77, 140288
  s_nop 0
  buffer_load_dwordx4 v9, s[40:43], s4 offen lds
  v_readlane_b32 s74, v16, 2
  s_add_u32 m0, s77, 147456
  s_add_u32 s4, s74, 0
  buffer_load_dwordx4 v8, s[40:43], s4 offen lds
  s_add_u32 m0, s77, 148480
  s_nop 0
  buffer_load_dwordx4 v9, s[40:43], s4 offen lds
  v_readlane_b32 s74, v16, 3
  s_add_u32 m0, s77, 155648
  s_add_u32 s4, s74, 0
  buffer_load_dwordx4 v8, s[40:43], s4 offen lds
  s_add_u32 m0, s77, 156672
  s_nop 0
  buffer_load_dwordx4 v9, s[40:43], s4 offen lds
  v_readlane_b32 s74, v16, 4
  s_add_u32 m0, s77, 28672
  s_add_u32 s4, s74, 0
  buffer_load_dwordx4 v8, s[40:43], s4 offen lds
  s_add_u32 m0, s77, 29696
  s_nop 0
  buffer_load_dwordx4 v9, s[40:43], s4 offen lds
  v_readlane_b32 s74, v16, 5
  s_add_u32 m0, s77, 36864
  s_add_u32 s4, s74, 0
  buffer_load_dwordx4 v8, s[40:43], s4 offen lds
  s_add_u32 m0, s77, 37888
  s_nop 0
  buffer_load_dwordx4 v9, s[40:43], s4 offen lds
  s_waitcnt vmcnt(12)
  s_add_u32 s3, s96, s70
  s_cmp_lg_u32 s3, 4
  s_cbranch_scc1 L_wo_chk1
  v_cmp_ne_u32 vcc, 0x01010101, v12
  s_cbranch_vccz L_wo_chk1
  s_load_dwordx2 s[64:65], s[0:1], 72
  s_waitcnt lgkmcnt(0)
  s_and_b32 s65, s65, 0xffff
  s_mov_b32 s66, 256
  s_mov_b32 s67, 0x00020000
  v_lshlrev_b32 v17, 2, v1
  s_mov_b32 s79, 0x100000
L_wo_chkl:
  buffer_load_dword v12, v17, s[64:67], 0 offen sc1
  s_sub_u32 s79, s79, 1
  s_cbranch_scc1 L_wo_chk1
  s_waitcnt vmcnt(0)
  v_cmp_ne_u32 vcc, 0x01010101, v12
  s_cbranch_vccnz L_wo_chkl
L_wo_chk1:
  s_add_u32 s44, s22, 41943040
  s_addc_u32 s45, s23, 0
  s_and_b32 s45, s45, 0xffff
  s_mov_b32 s46, 524288
  s_mov_b32 s47, 0x00020000
  s_lshl4_add_u32 s3, s97, s68
  s_and_b32 s4, s69, 15
  s_lshl4_add_u32 s3, s3, s4
  s_lshl_b32 s3, s3, 7
  s_sub_u32 s3, s3, 32768
  v_lshlrev_b32 v11, 7, v1
  v_and_b32 v2, 15, v1
  v_lshlrev_b32 v2, 2, v2
  v_mov_b32 v3, 1
  s_mov_b32 s79, 0x100000
  s_cmp_lg_u32 s70, 4
  s_barrier
  s_cbranch_scc1 L_wo_nofl
  s_mov_b32 exec_lo, 0xffff
  s_mov_b32 exec_hi, 0
  buffer_store_dword v3, v11, s[44:47], s87 offen sc1
  s_mov_b64 exec, -1
L_wo_nofl:
  s_mov_b32 s5, s3
  v_readlane_b32 s74, v16, 6
  s_add_u32 m0, s77, 45056
  s_add_u32 s4, s74, 0
  buffer_load_dwordx4 v8, s[40:43], s4 offen lds
  s_add_u32 m0, s77, 46080
  s_nop 0
  buffer_load_dwordx4 v9, s[40:43], s4 offen lds
  v_readlane_b32 s74, v16, 7
  s_add_u32 m0, s77, 53248
  s_add_u32 s4, s74, 0
  buffer_load_dwordx4 v8, s[40:43], s4 offen lds
  s_add_u32 m0, s77, 54272
  s_nop 0
  buffer_load_dwordx4 v9, s[40:43], s4 offen lds
  v_readlane_b32 s74, v16, 8
  s_add_u32 m0, s77, 61440
  s_add_u32 s4, s74, 0
  buffer_load_dwordx4 v8, s[40:43], s4 offen lds
  s_add_u32 m0, s77, 62464
  s_nop 0
  buffer_load_dwordx4 v9, s[40:43], s4 offen lds
  v_readlane_b32 s74, v16, 9
  s_add_u32 m0, s77, 69632
  s_add_u32 s4, s74, 0
  buffer_load_dwordx4 v8, s[40:43], s4 offen lds
  s_add_u32 m0, s77, 70656
  s_nop 0
  buffer_load_dwordx4 v9, s[40:43], s4 offen lds
  v_readlane_b32 s74, v16, 10
  s_add_u32 m0, s77, 77824
  s_add_u32 s4, s74, 0
  buffer_load_dwordx4 v8, s[40:43], s4 offen lds
  s_add_u32 m0, s77, 78848
  s_nop 0
  buffer_load_dwordx4 v9, s[40:43], s4 offen lds
  v_readlane_b32 s74, v16, 11
  s_add_u32 m0, s77, 86016
  s_add_u32 s4, s74, 0
  buffer_load_dwordx4 v8, s[40:43], s4 offen lds
  s_add_u32 m0, s77, 87040
  s_nop 0
  buffer_load_dwordx4 v9, s[40:43], s4 offen lds
  v_readlane_b32 s74, v16, 12
  s_add_u32 m0, s77, 94208
  s_add_u32 s4, s74, 0
  buffer_load_dwordx4 v8, s[40:43], s4 offen lds
  s_add_u32 m0, s77, 95232
  s_nop 0
  buffer_load_dwordx4 v9, s[40:43], s4 offen lds
  v_readlane_b32 s74, v16, 13
  s_add_u32 m0, s77, 102400
  s_add_u32 s4, s74, 0
  buffer_load_dwordx4 v8, s[40:43], s4 offen lds
  s_add_u32 m0, s77, 103424
  s_nop 0
  buffer_load_dwordx4 v9, s[40:43], s4 offen lds
  v_readlane_b32 s74, v16, 14
  s_add_u32 m0, s77, 110592
  s_add_u32 s4, s74, 0
  buffer_load_dwordx4 v8, s[40:43], s4 offen lds
  s_add_u32 m0, s77, 111616
  s_nop 0
  buffer_load_dwordx4 v9, s[40:43], s4 offen lds
  v_readlane_b32 s74, v16, 15
  s_add_u32 m0, s77, 118784
  s_add_u32 s4, s74, 0
  buffer_load_dwordx4 v8, s[40:43], s4 offen lds
  s_add_u32 m0, s77, 119808
  s_nop 0
  buffer_load_dwordx4 v9, s[40:43], s4 offen lds
  s_mov_b32 s3, s5
  s_cmp_lg_u32 s70, 4
  s_cbranch_scc1 L_wo_dep
L_wo_poll:
  buffer_load_dword v3, v2, s[44:47], s3 offen sc1
  s_sub_u32 s79, s79, 1
  s_cbranch_scc1 L_wo_dep
  s_waitcnt vmcnt(0)
  v_cmp_ne_u32 vcc, 1, v3
  s_cbranch_vccnz L_wo_poll
L_wo_dep:
  s_waitcnt vmcnt(22) lgkmcnt(0)
  s_barrier
  s_waitcnt vmcnt(14)
  s_barrier
  s_waitcnt vmcnt(6)
  s_barrier
  s_waitcnt vmcnt(0)
  s_barrier
  s_waitcnt vmcnt(0)
  s_barrier
  s_lshl_b32 s87, s97, 15
  s_lshl_b32 s4, s68, 11
  s_add_u32 s87, s87, s4
  s_lshl_b32 s4, s69, 2
  s_add_u32 s87, s87, s4
  s_add_u32 s97, s97, 1
  s_branch L_w1_body
L_wo_end:
  s_endpgm
L_wo_compute:
  v_and_b32 v2, 3, v1
  v_lshlrev_b32 v2, 3, v2
  v_bfe_i32 v15, s85, v2, 8
  s_and_b32 s3, s68, 3
  s_mul_i32 s4, s3, 4
  v_add3_u32 v3, v15, v1, s4
  v_and_b32 v3, 15, v3
  v_lshlrev_b32 v15, 11, v3
  v_and_b32 v3, 15, v1
  v_lshrrev_b32 v2, 4, v1
  s_lshl_b32 s8, s68, 7
  s_lshl_b32 s9, s70, 5
  s_add_u32 s8, s8, s9
  s_mul_i32 s9, s8, 2048
  v_lshl_add_u32 v4, v1, 4, s9
  v_add_u32 v5, 32768, v4
  v_add_u32 v13, s8, v3
  s_lshl_b32 s10, s69, 7
  v_lshl_add_u32 v14, v2, 3, s10
  v_and_b32 v16, 1, v2
  v_lshrrev_b32 v17, 1, v2
  v_lshl_add_u32 v16, v16, 1, v17
  v_lshlrev_b32 v16, 8, v16
  v_lshl_add_u32 v16, v3, 4, v16
  s_add_u32 s9, s8, s69
  s_lshl_b32 s9, s9, 11
  v_add_u32 v12, s9, v16
  v_lshl_add_u32 v18, v17, 4, v13
  v_lshlrev_b32 v18, 3, v18
  v_and_b32 v16, 1, v2
  v_lshl_add_u32 v18, v16, 2, v18
  s_lshl_b32 s10, s69, 14
  v_add_u32 v18, s10, v18
  v_bfe_u32 v6, v1, 2, 2
  v_lshl_add_u32 v6, v2, 3, v6
  v_lshlrev_b32 v6, 7, v6
  v_and_b32 v17, 3, v1
  v_lshl_add_u32 v6, v17, 3, v6
  v_bfe_u32 v17, v1, 3, 2
  v_lshl_add_u32 v6, v17, 5, v6
  v_xor_b32 v7, 32, v6
  v_xor_b32 v8, 64, v6
  v_xor_b32 v9, 96, v6
  s_mov_b32 s11, 0xffff0000
  s_mov_b32 s36, s34
  s_and_b32 s37, s35, 0xffff
  s_mov_b32 s38, 4194304
  s_mov_b32 s39, 0x00020000
  s_add_u32 s44, s34, 4194304
  s_addc_u32 s45, s35, 0
  s_and_b32 s45, s45, 0xffff
  s_mov_b32 s46, 4194304
  s_mov_b32 s47, 0x00020000
  s_add_u32 s56, s34, 24117248
  s_addc_u32 s57, s35, 0
  s_and_b32 s57, s57, 0xffff
  s_mov_b32 s58, 262144
  s_mov_b32 s59, 0x00020000
  s_cmp_lg_u32 s96, 0
  s_cbranch_scc1 L_pfc2_skip
  s_getpc_b64 s[4:5]
L_pfc2:
  s_lshl_b32 s3, s99, 2
  s_add_u32 s3, s3, s70
  s_mul_i32 s3, s3, 128
  s_min_u32 s3, s3, L_w1_c1-L_w1_c0-128
  s_add_i32 s3, s3, L_w1_c0-L_pfc2
  s_ashr_i32 s6, s3, 31
  s_add_u32 s4, s4, s3
  s_addc_u32 s5, s5, s6
  s_load_dword s40, s[4:5], 0
  s_load_dword s41, s[4:5], 64
L_pfc2_skip:
  v_add_u32 v26, 155648, v6
  v_add_u32 v27, 155648, v7
  v_add_u32 v28, 155648, v8
  v_add_u32 v29, 155648, v9
  v_add_u32 v20, 94208, v6
  v_add_u32 v21, 94208, v7
  v_add_u32 v22, 94208, v8
  v_add_u32 v23, 94208, v9
  v_add_u32 v6, 28672, v6
  v_add_u32 v7, 28672, v7
  v_add_u32 v8, 28672, v8
  v_add_u32 v9, 28672, v9
  v_readlane_b32 s48, v15, 0
  v_readlane_b32 s49, v15, 1
  v_readlane_b32 s50, v15, 2
  v_permlane16_swap_b32 v240, v242
  v_permlane16_swap_b32 v241, v243
  v_permlane16_swap_b32 v244, v246
  v_permlane16_swap_b32 v245, v247
  v_permlane16_swap_b32 v248, v250
  v_permlane16_swap_b32 v249, v251
  v_permlane16_swap_b32 v252, v254
  v_permlane16_swap_b32 v253, v255
  s_waitcnt lgkmcnt(0)
  s_barrier
  buffer_load_dwordx4 v[32:35], v4, s[36:39], s48 offen offset:0
  buffer_load_dwordx4 v[36:39], v5, s[36:39], s48 offen offset:0
  buffer_load_dwordx4 v[40:43], v4, s[36:39], s48 offen offset:1024
  buffer_load_dwordx4 v[44:47], v5, s[36:39], s48 offen offset:1024
  buffer_load_dwordx4 v[48:51], v4, s[36:39], s49 offen offset:0
  buffer_load_dwordx4 v[52:55], v5, s[36:39], s49 offen offset:0
  buffer_load_dwordx4 v[56:59], v4, s[36:39], s49 offen offset:1024
  buffer_load_dwordx4 v[60:63], v5, s[36:39], s49 offen offset:1024
  buffer_load_dwordx4 v[64:67], v4, s[36:39], s50 offen offset:0
  buffer_load_dwordx4 v[68:71], v5, s[36:39], s50 offen offset:0
  buffer_load_dwordx4 v[72:75], v4, s[36:39], s50 offen offset:1024
  buffer_load_dwordx4 v[76:79], v5, s[36:39], s50 offen offset:1024
  ds_read_b64_tr_b16 v[160:161], v20 offset:36864
  ds_read_b64_tr_b16 v[162:163], v20 offset:37376
  ds_read_b64_tr_b16 v[164:165], v21 offset:36864
  ds_read_b64_tr_b16 v[166:167], v21 offset:37376
  ds_read_b64_tr_b16 v[168:169], v22 offset:36864
  ds_read_b64_tr_b16 v[170:171], v22 offset:37376
  ds_read_b64_tr_b16 v[172:173], v23 offset:36864
  ds_read_b64_tr_b16 v[174:175], v23 offset:37376
  ds_read_b64_tr_b16 v[176:177], v20 offset:40960
  ds_read_b64_tr_b16 v[178:179], v20 offset:41472
  ds_read_b64_tr_b16 v[180:181], v21 offset:40960
  ds_read_b64_tr_b16 v[182:183], v21 offset:41472
  ds_read_b64_tr_b16 v[184:185], v22 offset:40960
  ds_read_b64_tr_b16 v[186:187], v22 offset:41472
  ds_read_b64_tr_b16 v[188:189], v23 offset:40960
  ds_read_b64_tr_b16 v[190:191], v23 offset:41472
  v_lshlrev_b32 v96, 16, v240
  v_and_b32 v97, s11, v240
  v_lshlrev_b32 v98, 16, v241
  v_and_b32 v99, s11, v241
  v_lshlrev_b32 v100, 16, v248
  v_and_b32 v101, s11, v248
  v_lshlrev_b32 v102, 16, v249
  v_and_b32 v103, s11, v249
  v_lshlrev_b32 v104, 16, v242
  v_and_b32 v105, s11, v242
  v_lshlrev_b32 v106, 16, v243
  v_and_b32 v107, s11, v243
  v_lshlrev_b32 v108, 16, v250
  v_and_b32 v109, s11, v250
  v_lshlrev_b32 v110, 16, v251
  v_and_b32 v111, s11, v251
  v_lshlrev_b32 v112, 16, v244
  v_and_b32 v113, s11, v244
  v_lshlrev_b32 v114, 16, v245
  v_and_b32 v115, s11, v245
  v_lshlrev_b32 v116, 16, v252
  v_and_b32 v117, s11, v252
  v_lshlrev_b32 v118, 16, v253
  v_and_b32 v119, s11, v253
  v_lshlrev_b32 v120, 16, v246
  v_and_b32 v121, s11, v246
  v_lshlrev_b32 v122, 16, v247
  v_and_b32 v123, s11, v247
  v_lshlrev_b32 v124, 16, v254
  v_and_b32 v125, s11, v254
  v_lshlrev_b32 v126, 16, v255
  v_and_b32 v127, s11, v255
  s_waitcnt vmcnt(10) lgkmcnt(8)
  v_mfma_f32_16x16x32_bf16 v[96:99], v[160:163], v[32:35], v[96:99]
  ds_read_b64_tr_b16 v[192:193], v20 offset:45056
  v_readlane_b32 s51, v15, 3
  v_mfma_f32_16x16x32_bf16 v[100:103], v[160:163], v[36:39], v[100:103]
  ds_read_b64_tr_b16 v[194:195], v20 offset:45568
  v_mfma_f32_16x16x32_bf16 v[108:111], v[164:167], v[36:39], v[108:111]
  ds_read_b64_tr_b16 v[196:197], v21 offset:45056
  v_mfma_f32_16x16x32_bf16 v[104:107], v[164:167], v[32:35], v[104:107]
  ds_read_b64_tr_b16 v[198:199], v21 offset:45568
  buffer_load_dwordx4 v[80:83], v4, s[36:39], s51 offen offset:0
  v_mfma_f32_16x16x32_bf16 v[112:115], v[168:171], v[32:35], v[112:115]
  ds_read_b64_tr_b16 v[200:201], v22 offset:45056
  v_mfma_f32_16x16x32_bf16 v[116:119], v[168:171], v[36:39], v[116:119]
  ds_read_b64_tr_b16 v[202:203], v22 offset:45568
  v_mfma_f32_16x16x32_bf16 v[124:127], v[172:175], v[36:39], v[124:127]
  ds_read_b64_tr_b16 v[204:205], v23 offset:45056
  buffer_load_dwordx4 v[84:87], v5, s[36:39], s51 offen offset:0
  v_mfma_f32_16x16x32_bf16 v[120:123], v[172:175], v[32:35], v[120:123]
  ds_read_b64_tr_b16 v[206:207], v23 offset:45568
  s_waitcnt vmcnt(10) lgkmcnt(8)
  v_mfma_f32_16x16x32_bf16 v[96:99], v[176:179], v[40:43], v[96:99]
  ds_read_b64_tr_b16 v[208:209], v20 offset:49152
  v_mfma_f32_16x16x32_bf16 v[100:103], v[176:179], v[44:47], v[100:103]
  ds_read_b64_tr_b16 v[210:211], v20 offset:49664
  buffer_load_dwordx4 v[88:91], v4, s[36:39], s51 offen offset:1024
  v_mfma_f32_16x16x32_bf16 v[108:111], v[180:183], v[44:47], v[108:111]
  ds_read_b64_tr_b16 v[212:213], v21 offset:49152
  v_mfma_f32_16x16x32_bf16 v[104:107], v[180:183], v[40:43], v[104:107]
  ds_read_b64_tr_b16 v[214:215], v21 offset:49664
  v_mfma_f32_16x16x32_bf16 v[112:115], v[184:187], v[40:43], v[112:115]
  ds_read_b64_tr_b16 v[216:217], v22 offset:49152
  buffer_load_dwordx4 v[92:95], v5, s[36:39], s51 offen offset:1024
  v_mfma_f32_16x16x32_bf16 v[116:119], v[184:187], v[44:47], v[116:119]
  ds_read_b64_tr_b16 v[218:219], v22 offset:49664
  v_readlane_b32 s48, v15, 4
  v_mfma_f32_16x16x32_bf16 v[124:127], v[188:191], v[44:47], v[124:127]
  ds_read_b64_tr_b16 v[220:221], v23 offset:49152
  v_mfma_f32_16x16x32_bf16 v[120:123], v[188:191], v[40:43], v[120:123]
  ds_read_b64_tr_b16 v[222:223], v23 offset:49664
  s_waitcnt vmcnt(10) lgkmcnt(8)
  v_mfma_f32_16x16x32_bf16 v[96:99], v[192:195], v[48:51], v[96:99]
  ds_read_b64_tr_b16 v[160:161], v20 offset:53248
  buffer_load_dwordx4 v[32:35], v4, s[36:39], s48 offen offset:0
  v_mfma_f32_16x16x32_bf16 v[100:103], v[192:195], v[52:55], v[100:103]
  ds_read_b64_tr_b16 v[162:163], v20 offset:53760
  v_mfma_f32_16x16x32_bf16 v[108:111], v[196:199], v[52:55], v[108:111]
  ds_read_b64_tr_b16 v[164:165], v21 offset:53248
  v_mfma_f32_16x16x32_bf16 v[104:107], v[196:199], v[48:51], v[104:107]
  ds_read_b64_tr_b16 v[166:167], v21 offset:53760
  buffer_load_dwordx4 v[36:39], v5, s[36:39], s48 offen offset:0
  v_mfma_f32_16x16x32_bf16 v[112:115], v[200:203], v[48:51], v[112:115]
  ds_read_b64_tr_b16 v[168:169], v22 offset:53248
  v_mfma_f32_16x16x32_bf16 v[116:119], v[200:203], v[52:55], v[116:119]
  ds_read_b64_tr_b16 v[170:171], v22 offset:53760
  v_mfma_f32_16x16x32_bf16 v[124:127], v[204:207], v[52:55], v[124:127]
  ds_read_b64_tr_b16 v[172:173], v23 offset:53248
  buffer_load_dwordx4 v[40:43], v4, s[36:39], s48 offen offset:1024
  v_mfma_f32_16x16x32_bf16 v[120:123], v[204:207], v[48:51], v[120:123]
  ds_read_b64_tr_b16 v[174:175], v23 offset:53760
  s_waitcnt vmcnt(11) lgkmcnt(8)
  v_mfma_f32_16x16x32_bf16 v[96:99], v[208:211], v[56:59], v[96:99]
  ds_read_b64_tr_b16 v[176:177], v20 offset:57344
  v_mfma_f32_16x16x32_bf16 v[100:103], v[208:211], v[60:63], v[100:103]
  ds_read_b64_tr_b16 v[178:179], v20 offset:57856
  buffer_load_dwordx4 v[44:47], v5, s[36:39], s48 offen offset:1024
  v_mfma_f32_16x16x32_bf16 v[108:111], v[212:215], v[60:63], v[108:111]
  ds_read_b64_tr_b16 v[180:181], v21 offset:57344
  v_mfma_f32_16x16x32_bf16 v[104:107], v[212:215], v[56:59], v[104:107]
  ds_read_b64_tr_b16 v[182:183], v21 offset:57856
  v_mfma_f32_16x16x32_bf16 v[112:115], v[216:219], v[56:59], v[112:115]
  ds_read_b64_tr_b16 v[184:185], v22 offset:57344
  v_mfma_f32_16x16x32_bf16 v[116:119], v[216:219], v[60:63], v[116:119]
  ds_read_b64_tr_b16 v[186:187], v22 offset:57856
  v_readlane_b32 s49, v15, 5
  v_mfma_f32_16x16x32_bf16 v[124:127], v[220:223], v[60:63], v[124:127]
  ds_read_b64_tr_b16 v[188:189], v23 offset:57344
  v_mfma_f32_16x16x32_bf16 v[120:123], v[220:223], v[56:59], v[120:123]
  ds_read_b64_tr_b16 v[190:191], v23 offset:57856
  s_waitcnt vmcnt(10) lgkmcnt(8)
  v_mfma_f32_16x16x32_bf16 v[96:99], v[160:163], v[64:67], v[96:99]
  ds_read_b64_tr_b16 v[192:193], v26 offset:0
  buffer_load_dwordx4 v[48:51], v4, s[36:39], s49 offen offset:0
  v_mfma_f32_16x16x32_bf16 v[100:103], v[160:163], v[68:71], v[100:103]
  ds_read_b64_tr_b16 v[194:195], v26 offset:512
  v_mfma_f32_16x16x32_bf16 v[108:111], v[164:167], v[68:71], v[108:111]
  ds_read_b64_tr_b16 v[196:197], v27 offset:0
  v_mfma_f32_16x16x32_bf16 v[104:107], v[164:167], v[64:67], v[104:107]
  ds_read_b64_tr_b16 v[198:199], v27 offset:512
  buffer_load_dwordx4 v[52:55], v5, s[36:39], s49 offen offset:0
  v_mfma_f32_16x16x32_bf16 v[112:115], v[168:171], v[64:67], v[112:115]
  ds_read_b64_tr_b16 v[200:201], v28 offset:0
  v_mfma_f32_16x16x32_bf16 v[116:119], v[168:171], v[68:71], v[116:119]
  ds_read_b64_tr_b16 v[202:203], v28 offset:512
  v_mfma_f32_16x16x32_bf16 v[124:127], v[172:175], v[68:71], v[124:127]
  ds_read_b64_tr_b16 v[204:205], v29 offset:0
  buffer_load_dwordx4 v[56:59], v4, s[36:39], s49 offen offset:1024
  v_mfma_f32_16x16x32_bf16 v[120:123], v[172:175], v[64:67], v[120:123]
  ds_read_b64_tr_b16 v[206:207], v29 offset:512
  s_waitcnt vmcnt(11) lgkmcnt(8)
  v_mfma_f32_16x16x32_bf16 v[96:99], v[176:179], v[72:75], v[96:99]
  ds_read_b64_tr_b16 v[208:209], v26 offset:4096
  v_mfma_f32_16x16x32_bf16 v[100:103], v[176:179], v[76:79], v[100:103]
  ds_read_b64_tr_b16 v[210:211], v26 offset:4608
  buffer_load_dwordx4 v[60:63], v5, s[36:39], s49 offen offset:1024
  v_mfma_f32_16x16x32_bf16 v[108:111], v[180:183], v[76:79], v[108:111]
  ds_read_b64_tr_b16 v[212:213], v27 offset:4096
  v_mfma_f32_16x16x32_bf16 v[104:107], v[180:183], v[72:75], v[104:107]
  ds_read_b64_tr_b16 v[214:215], v27 offset:4608
  v_mfma_f32_16x16x32_bf16 v[112:115], v[184:187], v[72:75], v[112:115]
  ds_read_b64_tr_b16 v[216:217], v28 offset:4096
  v_mfma_f32_16x16x32_bf16 v[116:119], v[184:187], v[76:79], v[116:119]
  ds_read_b64_tr_b16 v[218:219], v28 offset:4608
  v_readlane_b32 s50, v15, 6
  v_mfma_f32_16x16x32_bf16 v[124:127], v[188:191], v[76:79], v[124:127]
  ds_read_b64_tr_b16 v[220:221], v29 offset:4096
  v_mfma_f32_16x16x32_bf16 v[120:123], v[188:191], v[72:75], v[120:123]
  ds_read_b64_tr_b16 v[222:223], v29 offset:4608
  s_waitcnt vmcnt(10) lgkmcnt(8)
  v_mfma_f32_16x16x32_bf16 v[96:99], v[192:195], v[80:83], v[96:99]
  ds_read_b64_tr_b16 v[160:161], v6 offset:0
  buffer_load_dwordx4 v[64:67], v4, s[36:39], s50 offen offset:0
  v_mfma_f32_16x16x32_bf16 v[100:103], v[192:195], v[84:87], v[100:103]
  ds_read_b64_tr_b16 v[162:163], v6 offset:512
  v_mfma_f32_16x16x32_bf16 v[108:111], v[196:199], v[84:87], v[108:111]
  ds_read_b64_tr_b16 v[164:165], v7 offset:0
  v_mfma_f32_16x16x32_bf16 v[104:107], v[196:199], v[80:83], v[104:107]
  ds_read_b64_tr_b16 v[166:167], v7 offset:512
  buffer_load_dwordx4 v[68:71], v5, s[36:39], s50 offen offset:0
  v_mfma_f32_16x16x32_bf16 v[112:115], v[200:203], v[80:83], v[112:115]
  ds_read_b64_tr_b16 v[168:169], v8 offset:0
  v_mfma_f32_16x16x32_bf16 v[116:119], v[200:203], v[84:87], v[116:119]
  ds_read_b64_tr_b16 v[170:171], v8 offset:512
  v_mfma_f32_16x16x32_bf16 v[124:127], v[204:207], v[84:87], v[124:127]
  ds_read_b64_tr_b16 v[172:173], v9 offset:0
  buffer_load_dwordx4 v[72:75], v4, s[36:39], s50 offen offset:1024
  v_mfma_f32_16x16x32_bf16 v[120:123], v[204:207], v[80:83], v[120:123]
  ds_read_b64_tr_b16 v[174:175], v9 offset:512
  s_waitcnt vmcnt(11) lgkmcnt(8)
  s_barrier
  v_mfma_f32_16x16x32_bf16 v[96:99], v[208:211], v[88:91], v[96:99]
  ds_read_b64_tr_b16 v[176:177], v6 offset:4096
  v_mfma_f32_16x16x32_bf16 v[100:103], v[208:211], v[92:95], v[100:103]
  ds_read_b64_tr_b16 v[178:179], v6 offset:4608
  buffer_load_dwordx4 v[76:79], v5, s[36:39], s50 offen offset:1024
  v_mfma_f32_16x16x32_bf16 v[108:111], v[212:215], v[92:95], v[108:111]
  ds_read_b64_tr_b16 v[180:181], v7 offset:4096
  v_mfma_f32_16x16x32_bf16 v[104:107], v[212:215], v[88:91], v[104:107]
  ds_read_b64_tr_b16 v[182:183], v7 offset:4608
  v_mfma_f32_16x16x32_bf16 v[112:115], v[216:219], v[88:91], v[112:115]
  ds_read_b64_tr_b16 v[184:185], v8 offset:4096
  v_mfma_f32_16x16x32_bf16 v[116:119], v[216:219], v[92:95], v[116:119]
  ds_read_b64_tr_b16 v[186:187], v8 offset:4608
  v_readlane_b32 s51, v15, 7
  v_mfma_f32_16x16x32_bf16 v[124:127], v[220:223], v[92:95], v[124:127]
  ds_read_b64_tr_b16 v[188:189], v9 offset:4096
  v_mfma_f32_16x16x32_bf16 v[120:123], v[220:223], v[88:91], v[120:123]
  ds_read_b64_tr_b16 v[190:191], v9 offset:4608
  s_waitcnt vmcnt(10) lgkmcnt(8)
  v_mfma_f32_16x16x32_bf16 v[96:99], v[160:163], v[32:35], v[96:99]
  ds_read_b64_tr_b16 v[192:193], v6 offset:8192
  buffer_load_dwordx4 v[80:83], v4, s[36:39], s51 offen offset:0
  v_mfma_f32_16x16x32_bf16 v[100:103], v[160:163], v[36:39], v[100:103]
  ds_read_b64_tr_b16 v[194:195], v6 offset:8704
  v_mfma_f32_16x16x32_bf16 v[108:111], v[164:167], v[36:39], v[108:111]
  ds_read_b64_tr_b16 v[196:197], v7 offset:8192
  v_mfma_f32_16x16x32_bf16 v[104:107], v[164:167], v[32:35], v[104:107]
  ds_read_b64_tr_b16 v[198:199], v7 offset:8704
  buffer_load_dwordx4 v[84:87], v5, s[36:39], s51 offen offset:0
  v_mfma_f32_16x16x32_bf16 v[112:115], v[168:171], v[32:35], v[112:115]
  ds_read_b64_tr_b16 v[200:201], v8 offset:8192
  v_mfma_f32_16x16x32_bf16 v[116:119], v[168:171], v[36:39], v[116:119]
  ds_read_b64_tr_b16 v[202:203], v8 offset:8704
  v_mfma_f32_16x16x32_bf16 v[124:127], v[172:175], v[36:39], v[124:127]
  ds_read_b64_tr_b16 v[204:205], v9 offset:8192
  buffer_load_dwordx4 v[88:91], v4, s[36:39], s51 offen offset:1024
  v_mfma_f32_16x16x32_bf16 v[120:123], v[172:175], v[32:35], v[120:123]
  ds_read_b64_tr_b16 v[206:207], v9 offset:8704
  s_waitcnt vmcnt(11) lgkmcnt(8)
  v_mfma_f32_16x16x32_bf16 v[96:99], v[176:179], v[40:43], v[96:99]
  ds_read_b64_tr_b16 v[208:209], v6 offset:12288
  v_mfma_f32_16x16x32_bf16 v[100:103], v[176:179], v[44:47], v[100:103]
  ds_read_b64_tr_b16 v[210:211], v6 offset:12800
  buffer_load_dwordx4 v[92:95], v5, s[36:39], s51 offen offset:1024
  v_mfma_f32_16x16x32_bf16 v[108:111], v[180:183], v[44:47], v[108:111]
  ds_read_b64_tr_b16 v[212:213], v7 offset:12288
  v_mfma_f32_16x16x32_bf16 v[104:107], v[180:183], v[40:43], v[104:107]
  ds_read_b64_tr_b16 v[214:215], v7 offset:12800
  v_mfma_f32_16x16x32_bf16 v[112:115], v[184:187], v[40:43], v[112:115]
  ds_read_b64_tr_b16 v[216:217], v8 offset:12288
  v_mfma_f32_16x16x32_bf16 v[116:119], v[184:187], v[44:47], v[116:119]
  ds_read_b64_tr_b16 v[218:219], v8 offset:12800
  v_readlane_b32 s48, v15, 8
  v_mfma_f32_16x16x32_bf16 v[124:127], v[188:191], v[44:47], v[124:127]
  ds_read_b64_tr_b16 v[220:221], v9 offset:12288
  v_mfma_f32_16x16x32_bf16 v[120:123], v[188:191], v[40:43], v[120:123]
  ds_read_b64_tr_b16 v[222:223], v9 offset:12800
  s_waitcnt vmcnt(10) lgkmcnt(8)
  v_mfma_f32_16x16x32_bf16 v[96:99], v[192:195], v[48:51], v[96:99]
  ds_read_b64_tr_b16 v[160:161], v6 offset:16384
  buffer_load_dwordx4 v[32:35], v4, s[36:39], s48 offen offset:0
  v_mfma_f32_16x16x32_bf16 v[100:103], v[192:195], v[52:55], v[100:103]
  ds_read_b64_tr_b16 v[162:163], v6 offset:16896
  v_mfma_f32_16x16x32_bf16 v[108:111], v[196:199], v[52:55], v[108:111]
  ds_read_b64_tr_b16 v[164:165], v7 offset:16384
  v_mfma_f32_16x16x32_bf16 v[104:107], v[196:199], v[48:51], v[104:107]
  ds_read_b64_tr_b16 v[166:167], v7 offset:16896
  buffer_load_dwordx4 v[36:39], v5, s[36:39], s48 offen offset:0
  v_mfma_f32_16x16x32_bf16 v[112:115], v[200:203], v[48:51], v[112:115]
  ds_read_b64_tr_b16 v[168:169], v8 offset:16384
  v_mfma_f32_16x16x32_bf16 v[116:119], v[200:203], v[52:55], v[116:119]
  ds_read_b64_tr_b16 v[170:171], v8 offset:16896
  v_mfma_f32_16x16x32_bf16 v[124:127], v[204:207], v[52:55], v[124:127]
  ds_read_b64_tr_b16 v[172:173], v9 offset:16384
  buffer_load_dwordx4 v[40:43], v4, s[36:39], s48 offen offset:1024
  v_mfma_f32_16x16x32_bf16 v[120:123], v[204:207], v[48:51], v[120:123]
  ds_read_b64_tr_b16 v[174:175], v9 offset:16896
  s_waitcnt vmcnt(11) lgkmcnt(8)
  v_mfma_f32_16x16x32_bf16 v[96:99], v[208:211], v[56:59], v[96:99]
  ds_read_b64_tr_b16 v[176:177], v6 offset:20480
  v_mfma_f32_16x16x32_bf16 v[100:103], v[208:211], v[60:63], v[100:103]
  ds_read_b64_tr_b16 v[178:179], v6 offset:20992
  buffer_load_dwordx4 v[44:47], v5, s[36:39], s48 offen offset:1024
  v_mfma_f32_16x16x32_bf16 v[108:111], v[212:215], v[60:63], v[108:111]
  ds_read_b64_tr_b16 v[180:181], v7 offset:20480
  v_mfma_f32_16x16x32_bf16 v[104:107], v[212:215], v[56:59], v[104:107]
  ds_read_b64_tr_b16 v[182:183], v7 offset:20992
  v_mfma_f32_16x16x32_bf16 v[112:115], v[216:219], v[56:59], v[112:115]
  ds_read_b64_tr_b16 v[184:185], v8 offset:20480
  v_mfma_f32_16x16x32_bf16 v[116:119], v[216:219], v[60:63], v[116:119]
  ds_read_b64_tr_b16 v[186:187], v8 offset:20992
  v_readlane_b32 s49, v15, 9
  v_mfma_f32_16x16x32_bf16 v[124:127], v[220:223], v[60:63], v[124:127]
  ds_read_b64_tr_b16 v[188:189], v9 offset:20480
  v_mfma_f32_16x16x32_bf16 v[120:123], v[220:223], v[56:59], v[120:123]
  ds_read_b64_tr_b16 v[190:191], v9 offset:20992
  s_waitcnt vmcnt(10) lgkmcnt(8)
  v_mfma_f32_16x16x32_bf16 v[96:99], v[160:163], v[64:67], v[96:99]
  ds_read_b64_tr_b16 v[192:193], v6 offset:24576
  buffer_load_dwordx4 v[48:51], v4, s[36:39], s49 offen offset:0
  v_mfma_f32_16x16x32_bf16 v[100:103], v[160:163], v[68:71], v[100:103]
  ds_read_b64_tr_b16 v[194:195], v6 offset:25088
  v_mfma_f32_16x16x32_bf16 v[108:111], v[164:167], v[68:71], v[108:111]
  ds_read_b64_tr_b16 v[196:197], v7 offset:24576
  v_mfma_f32_16x16x32_bf16 v[104:107], v[164:167], v[64:67], v[104:107]
  ds_read_b64_tr_b16 v[198:199], v7 offset:25088
  buffer_load_dwordx4 v[52:55], v5, s[36:39], s49 offen offset:0
  v_mfma_f32_16x16x32_bf16 v[112:115], v[168:171], v[64:67], v[112:115]
  ds_read_b64_tr_b16 v[200:201], v8 offset:24576
  v_mfma_f32_16x16x32_bf16 v[116:119], v[168:171], v[68:71], v[116:119]
  ds_read_b64_tr_b16 v[202:203], v8 offset:25088
  v_mfma_f32_16x16x32_bf16 v[124:127], v[172:175], v[68:71], v[124:127]
  ds_read_b64_tr_b16 v[204:205], v9 offset:24576
  buffer_load_dwordx4 v[56:59], v4, s[36:39], s49 offen offset:1024
  v_mfma_f32_16x16x32_bf16 v[120:123], v[172:175], v[64:67], v[120:123]
  ds_read_b64_tr_b16 v[206:207], v9 offset:25088
  s_waitcnt vmcnt(11) lgkmcnt(8)
  v_mfma_f32_16x16x32_bf16 v[96:99], v[176:179], v[72:75], v[96:99]
  ds_read_b64_tr_b16 v[208:209], v6 offset:28672
  v_mfma_f32_16x16x32_bf16 v[100:103], v[176:179], v[76:79], v[100:103]
  ds_read_b64_tr_b16 v[210:211], v6 offset:29184
  buffer_load_dwordx4 v[60:63], v5, s[36:39], s49 offen offset:1024
  v_mfma_f32_16x16x32_bf16 v[108:111], v[180:183], v[76:79], v[108:111]
  ds_read_b64_tr_b16 v[212:213], v7 offset:28672
  v_mfma_f32_16x16x32_bf16 v[104:107], v[180:183], v[72:75], v[104:107]
  ds_read_b64_tr_b16 v[214:215], v7 offset:29184
  v_mfma_f32_16x16x32_bf16 v[112:115], v[184:187], v[72:75], v[112:115]
  ds_read_b64_tr_b16 v[216:217], v8 offset:28672
  v_mfma_f32_16x16x32_bf16 v[116:119], v[184:187], v[76:79], v[116:119]
  ds_read_b64_tr_b16 v[218:219], v8 offset:29184
  v_readlane_b32 s50, v15, 10
  v_mfma_f32_16x16x32_bf16 v[124:127], v[188:191], v[76:79], v[124:127]
  ds_read_b64_tr_b16 v[220:221], v9 offset:28672
  v_mfma_f32_16x16x32_bf16 v[120:123], v[188:191], v[72:75], v[120:123]
  ds_read_b64_tr_b16 v[222:223], v9 offset:29184
  s_waitcnt vmcnt(10) lgkmcnt(8)
  v_mfma_f32_16x16x32_bf16 v[96:99], v[192:195], v[80:83], v[96:99]
  ds_read_b64_tr_b16 v[160:161], v6 offset:32768
  buffer_load_dwordx4 v[64:67], v4, s[36:39], s50 offen offset:0
  v_mfma_f32_16x16x32_bf16 v[100:103], v[192:195], v[84:87], v[100:103]
  ds_read_b64_tr_b16 v[162:163], v6 offset:33280
  v_mfma_f32_16x16x32_bf16 v[108:111], v[196:199], v[84:87], v[108:111]
  ds_read_b64_tr_b16 v[164:165], v7 offset:32768
  v_mfma_f32_16x16x32_bf16 v[104:107], v[196:199], v[80:83], v[104:107]
  ds_read_b64_tr_b16 v[166:167], v7 offset:33280
  buffer_load_dwordx4 v[68:71], v5, s[36:39], s50 offen offset:0
  v_mfma_f32_16x16x32_bf16 v[112:115], v[200:203], v[80:83], v[112:115]
  ds_read_b64_tr_b16 v[168:169], v8 offset:32768
  v_mfma_f32_16x16x32_bf16 v[116:119], v[200:203], v[84:87], v[116:119]
  ds_read_b64_tr_b16 v[170:171], v8 offset:33280
  v_mfma_f32_16x16x32_bf16 v[124:127], v[204:207], v[84:87], v[124:127]
  ds_read_b64_tr_b16 v[172:173], v9 offset:32768
  buffer_load_dwordx4 v[72:75], v4, s[36:39], s50 offen offset:1024
  v_mfma_f32_16x16x32_bf16 v[120:123], v[204:207], v[80:83], v[120:123]
  ds_read_b64_tr_b16 v[174:175], v9 offset:33280
  s_waitcnt vmcnt(11) lgkmcnt(8)
  s_barrier
  v_mfma_f32_16x16x32_bf16 v[96:99], v[208:211], v[88:91], v[96:99]
  ds_read_b64_tr_b16 v[176:177], v6 offset:36864
  v_mfma_f32_16x16x32_bf16 v[100:103], v[208:211], v[92:95], v[100:103]
  ds_read_b64_tr_b16 v[178:179], v6 offset:37376
  buffer_load_dwordx4 v[76:79], v5, s[36:39], s50 offen offset:1024
  v_mfma_f32_16x16x32_bf16 v[108:111], v[212:215], v[92:95], v[108:111]
  ds_read_b64_tr_b16 v[180:181], v7 offset:36864
  v_mfma_f32_16x16x32_bf16 v[104:107], v[212:215], v[88:91], v[104:107]
  ds_read_b64_tr_b16 v[182:183], v7 offset:37376
  v_mfma_f32_16x16x32_bf16 v[112:115], v[216:219], v[88:91], v[112:115]
  ds_read_b64_tr_b16 v[184:185], v8 offset:36864
  v_mfma_f32_16x16x32_bf16 v[116:119], v[216:219], v[92:95], v[116:119]
  ds_read_b64_tr_b16 v[186:187], v8 offset:37376
  v_readlane_b32 s51, v15, 11
  v_mfma_f32_16x16x32_bf16 v[124:127], v[220:223], v[92:95], v[124:127]
  ds_read_b64_tr_b16 v[188:189], v9 offset:36864
  v_mfma_f32_16x16x32_bf16 v[120:123], v[220:223], v[88:91], v[120:123]
  ds_read_b64_tr_b16 v[190:191], v9 offset:37376
  s_waitcnt vmcnt(10) lgkmcnt(8)
  v_mfma_f32_16x16x32_bf16 v[96:99], v[160:163], v[32:35], v[96:99]
  ds_read_b64_tr_b16 v[192:193], v6 offset:40960
  buffer_load_dwordx4 v[80:83], v4, s[36:39], s51 offen offset:0
  v_mfma_f32_16x16x32_bf16 v[100:103], v[160:163], v[36:39], v[100:103]
  ds_read_b64_tr_b16 v[194:195], v6 offset:41472
  v_mfma_f32_16x16x32_bf16 v[108:111], v[164:167], v[36:39], v[108:111]
  ds_read_b64_tr_b16 v[196:197], v7 offset:40960
  v_mfma_f32_16x16x32_bf16 v[104:107], v[164:167], v[32:35], v[104:107]
  ds_read_b64_tr_b16 v[198:199], v7 offset:41472
  buffer_load_dwordx4 v[84:87], v5, s[36:39], s51 offen offset:0
  v_mfma_f32_16x16x32_bf16 v[112:115], v[168:171], v[32:35], v[112:115]
  ds_read_b64_tr_b16 v[200:201], v8 offset:40960
  v_mfma_f32_16x16x32_bf16 v[116:119], v[168:171], v[36:39], v[116:119]
  ds_read_b64_tr_b16 v[202:203], v8 offset:41472
  v_mfma_f32_16x16x32_bf16 v[124:127], v[172:175], v[36:39], v[124:127]
  ds_read_b64_tr_b16 v[204:205], v9 offset:40960
  buffer_load_dwordx4 v[88:91], v4, s[36:39], s51 offen offset:1024
  v_mfma_f32_16x16x32_bf16 v[120:123], v[172:175], v[32:35], v[120:123]
  ds_read_b64_tr_b16 v[206:207], v9 offset:41472
  s_waitcnt vmcnt(11) lgkmcnt(8)
  v_mfma_f32_16x16x32_bf16 v[96:99], v[176:179], v[40:43], v[96:99]
  ds_read_b64_tr_b16 v[208:209], v6 offset:45056
  v_mfma_f32_16x16x32_bf16 v[100:103], v[176:179], v[44:47], v[100:103]
  ds_read_b64_tr_b16 v[210:211], v6 offset:45568
  buffer_load_dwordx4 v[92:95], v5, s[36:39], s51 offen offset:1024
  v_mfma_f32_16x16x32_bf16 v[108:111], v[180:183], v[44:47], v[108:111]
  ds_read_b64_tr_b16 v[212:213], v7 offset:45056
  v_mfma_f32_16x16x32_bf16 v[104:107], v[180:183], v[40:43], v[104:107]
  ds_read_b64_tr_b16 v[214:215], v7 offset:45568
  v_mfma_f32_16x16x32_bf16 v[112:115], v[184:187], v[40:43], v[112:115]
  ds_read_b64_tr_b16 v[216:217], v8 offset:45056
  v_mfma_f32_16x16x32_bf16 v[116:119], v[184:187], v[44:47], v[116:119]
  ds_read_b64_tr_b16 v[218:219], v8 offset:45568
  v_readlane_b32 s48, v15, 12
  v_mfma_f32_16x16x32_bf16 v[124:127], v[188:191], v[44:47], v[124:127]
  ds_read_b64_tr_b16 v[220:221], v9 offset:45056
  v_mfma_f32_16x16x32_bf16 v[120:123], v[188:191], v[40:43], v[120:123]
  ds_read_b64_tr_b16 v[222:223], v9 offset:45568
  s_waitcnt vmcnt(10) lgkmcnt(8)
  v_mfma_f32_16x16x32_bf16 v[96:99], v[192:195], v[48:51], v[96:99]
  ds_read_b64_tr_b16 v[160:161], v6 offset:49152
  buffer_load_dwordx4 v[32:35], v4, s[36:39], s48 offen offset:0
  v_mfma_f32_16x16x32_bf16 v[100:103], v[192:195], v[52:55], v[100:103]
  ds_read_b64_tr_b16 v[162:163], v6 offset:49664
  v_mfma_f32_16x16x32_bf16 v[108:111], v[196:199], v[52:55], v[108:111]
  ds_read_b64_tr_b16 v[164:165], v7 offset:49152
  v_mfma_f32_16x16x32_bf16 v[104:107], v[196:199], v[48:51], v[104:107]
  ds_read_b64_tr_b16 v[166:167], v7 offset:49664
  buffer_load_dwordx4 v[36:39], v5, s[36:39], s48 offen offset:0
  v_mfma_f32_16x16x32_bf16 v[112:115], v[200:203], v[48:51], v[112:115]
  ds_read_b64_tr_b16 v[168:169], v8 offset:49152
  v_mfma_f32_16x16x32_bf16 v[116:119], v[200:203], v[52:55], v[116:119]
  ds_read_b64_tr_b16 v[170:171], v8 offset:49664
  v_mfma_f32_16x16x32_bf16 v[124:127], v[204:207], v[52:55], v[124:127]
  ds_read_b64_tr_b16 v[172:173], v9 offset:49152
  buffer_load_dwordx4 v[40:43], v4, s[36:39], s48 offen offset:1024
  v_mfma_f32_16x16x32_bf16 v[120:123], v[204:207], v[48:51], v[120:123]
  ds_read_b64_tr_b16 v[174:175], v9 offset:49664
  s_waitcnt vmcnt(11) lgkmcnt(8)
  v_mfma_f32_16x16x32_bf16 v[96:99], v[208:211], v[56:59], v[96:99]
  ds_read_b64_tr_b16 v[176:177], v6 offset:53248
  v_mfma_f32_16x16x32_bf16 v[100:103], v[208:211], v[60:63], v[100:103]
  ds_read_b64_tr_b16 v[178:179], v6 offset:53760
  buffer_load_dwordx4 v[44:47], v5, s[36:39], s48 offen offset:1024
  v_mfma_f32_16x16x32_bf16 v[108:111], v[212:215], v[60:63], v[108:111]
  ds_read_b64_tr_b16 v[180:181], v7 offset:53248
  v_mfma_f32_16x16x32_bf16 v[104:107], v[212:215], v[56:59], v[104:107]
  ds_read_b64_tr_b16 v[182:183], v7 offset:53760
  v_mfma_f32_16x16x32_bf16 v[112:115], v[216:219], v[56:59], v[112:115]
  ds_read_b64_tr_b16 v[184:185], v8 offset:53248
  v_mfma_f32_16x16x32_bf16 v[116:119], v[216:219], v[60:63], v[116:119]
  ds_read_b64_tr_b16 v[186:187], v8 offset:53760
  v_readlane_b32 s49, v15, 13
  v_mfma_f32_16x16x32_bf16 v[124:127], v[220:223], v[60:63], v[124:127]
  ds_read_b64_tr_b16 v[188:189], v9 offset:53248
  v_mfma_f32_16x16x32_bf16 v[120:123], v[220:223], v[56:59], v[120:123]
  ds_read_b64_tr_b16 v[190:191], v9 offset:53760
  s_waitcnt vmcnt(10) lgkmcnt(8)
  v_mfma_f32_16x16x32_bf16 v[96:99], v[160:163], v[64:67], v[96:99]
  ds_read_b64_tr_b16 v[192:193], v6 offset:57344
  buffer_load_dwordx4 v[48:51], v4, s[36:39], s49 offen offset:0
  v_mfma_f32_16x16x32_bf16 v[100:103], v[160:163], v[68:71], v[100:103]
  ds_read_b64_tr_b16 v[194:195], v6 offset:57856
  v_mfma_f32_16x16x32_bf16 v[108:111], v[164:167], v[68:71], v[108:111]
  ds_read_b64_tr_b16 v[196:197], v7 offset:57344
  v_mfma_f32_16x16x32_bf16 v[104:107], v[164:167], v[64:67], v[104:107]
  ds_read_b64_tr_b16 v[198:199], v7 offset:57856
  buffer_load_dwordx4 v[52:55], v5, s[36:39], s49 offen offset:0
  v_mfma_f32_16x16x32_bf16 v[112:115], v[168:171], v[64:67], v[112:115]
  ds_read_b64_tr_b16 v[200:201], v8 offset:57344
  v_mfma_f32_16x16x32_bf16 v[116:119], v[168:171], v[68:71], v[116:119]
  ds_read_b64_tr_b16 v[202:203], v8 offset:57856
  v_mfma_f32_16x16x32_bf16 v[124:127], v[172:175], v[68:71], v[124:127]
  ds_read_b64_tr_b16 v[204:205], v9 offset:57344
  buffer_load_dwordx4 v[56:59], v4, s[36:39], s49 offen offset:1024
  v_mfma_f32_16x16x32_bf16 v[120:123], v[172:175], v[64:67], v[120:123]
  ds_read_b64_tr_b16 v[206:207], v9 offset:57856
  s_waitcnt vmcnt(11) lgkmcnt(8)
  v_mfma_f32_16x16x32_bf16 v[96:99], v[176:179], v[72:75], v[96:99]
  ds_read_b64_tr_b16 v[208:209], v6 offset:61440
  v_mfma_f32_16x16x32_bf16 v[100:103], v[176:179], v[76:79], v[100:103]
  ds_read_b64_tr_b16 v[210:211], v6 offset:61952
  buffer_load_dwordx4 v[60:63], v5, s[36:39], s49 offen offset:1024
  v_mfma_f32_16x16x32_bf16 v[108:111], v[180:183], v[76:79], v[108:111]
  ds_read_b64_tr_b16 v[212:213], v7 offset:61440
  v_mfma_f32_16x16x32_bf16 v[104:107], v[180:183], v[72:75], v[104:107]
  ds_read_b64_tr_b16 v[214:215], v7 offset:61952
  v_mfma_f32_16x16x32_bf16 v[112:115], v[184:187], v[72:75], v[112:115]
  ds_read_b64_tr_b16 v[216:217], v8 offset:61440
  v_mfma_f32_16x16x32_bf16 v[116:119], v[184:187], v[76:79], v[116:119]
  ds_read_b64_tr_b16 v[218:219], v8 offset:61952
  v_readlane_b32 s50, v15, 14
  v_mfma_f32_16x16x32_bf16 v[124:127], v[188:191], v[76:79], v[124:127]
  ds_read_b64_tr_b16 v[220:221], v9 offset:61440
  v_mfma_f32_16x16x32_bf16 v[120:123], v[188:191], v[72:75], v[120:123]
  ds_read_b64_tr_b16 v[222:223], v9 offset:61952
  s_waitcnt vmcnt(10) lgkmcnt(8)
  v_mfma_f32_16x16x32_bf16 v[96:99], v[192:195], v[80:83], v[96:99]
  ds_read_b64_tr_b16 v[160:161], v20 offset:0
  buffer_load_dwordx4 v[64:67], v4, s[36:39], s50 offen offset:0
  v_mfma_f32_16x16x32_bf16 v[100:103], v[192:195], v[84:87], v[100:103]
  ds_read_b64_tr_b16 v[162:163], v20 offset:512
  v_mfma_f32_16x16x32_bf16 v[108:111], v[196:199], v[84:87], v[108:111]
  ds_read_b64_tr_b16 v[164:165], v21 offset:0
  v_mfma_f32_16x16x32_bf16 v[104:107], v[196:199], v[80:83], v[104:107]
  ds_read_b64_tr_b16 v[166:167], v21 offset:512
  buffer_load_dwordx4 v[68:71], v5, s[36:39], s50 offen offset:0
  v_mfma_f32_16x16x32_bf16 v[112:115], v[200:203], v[80:83], v[112:115]
  ds_read_b64_tr_b16 v[168:169], v22 offset:0
  v_mfma_f32_16x16x32_bf16 v[116:119], v[200:203], v[84:87], v[116:119]
  ds_read_b64_tr_b16 v[170:171], v22 offset:512
  v_mfma_f32_16x16x32_bf16 v[124:127], v[204:207], v[84:87], v[124:127]
  ds_read_b64_tr_b16 v[172:173], v23 offset:0
  buffer_load_dwordx4 v[72:75], v4, s[36:39], s50 offen offset:1024
  v_mfma_f32_16x16x32_bf16 v[120:123], v[204:207], v[80:83], v[120:123]
  ds_read_b64_tr_b16 v[174:175], v23 offset:512
  s_waitcnt vmcnt(11) lgkmcnt(8)
  s_barrier
  v_mfma_f32_16x16x32_bf16 v[96:99], v[208:211], v[88:91], v[96:99]
  ds_read_b64_tr_b16 v[176:177], v20 offset:4096
  v_mfma_f32_16x16x32_bf16 v[100:103], v[208:211], v[92:95], v[100:103]
  ds_read_b64_tr_b16 v[178:179], v20 offset:4608
  buffer_load_dwordx4 v[76:79], v5, s[36:39], s50 offen offset:1024
  v_mfma_f32_16x16x32_bf16 v[108:111], v[212:215], v[92:95], v[108:111]
  ds_read_b64_tr_b16 v[180:181], v21 offset:4096
  v_mfma_f32_16x16x32_bf16 v[104:107], v[212:215], v[88:91], v[104:107]
  ds_read_b64_tr_b16 v[182:183], v21 offset:4608
  v_mfma_f32_16x16x32_bf16 v[112:115], v[216:219], v[88:91], v[112:115]
  ds_read_b64_tr_b16 v[184:185], v22 offset:4096
  v_mfma_f32_16x16x32_bf16 v[116:119], v[216:219], v[92:95], v[116:119]
  ds_read_b64_tr_b16 v[186:187], v22 offset:4608
  v_readlane_b32 s51, v15, 15
  v_mfma_f32_16x16x32_bf16 v[124:127], v[220:223], v[92:95], v[124:127]
  ds_read_b64_tr_b16 v[188:189], v23 offset:4096
  v_mfma_f32_16x16x32_bf16 v[120:123], v[220:223], v[88:91], v[120:123]
  ds_read_b64_tr_b16 v[190:191], v23 offset:4608
  s_waitcnt vmcnt(10) lgkmcnt(8)
  v_mfma_f32_16x16x32_bf16 v[96:99], v[160:163], v[32:35], v[96:99]
  ds_read_b64_tr_b16 v[192:193], v20 offset:8192
  buffer_load_dwordx4 v[80:83], v4, s[36:39], s51 offen offset:0
  v_mfma_f32_16x16x32_bf16 v[100:103], v[160:163], v[36:39], v[100:103]
  ds_read_b64_tr_b16 v[194:195], v20 offset:8704
  v_mfma_f32_16x16x32_bf16 v[108:111], v[164:167], v[36:39], v[108:111]
  ds_read_b64_tr_b16 v[196:197], v21 offset:8192
  v_mfma_f32_16x16x32_bf16 v[104:107], v[164:167], v[32:35], v[104:107]
  ds_read_b64_tr_b16 v[198:199], v21 offset:8704
  buffer_load_dwordx4 v[84:87], v5, s[36:39], s51 offen offset:0
  v_mfma_f32_16x16x32_bf16 v[112:115], v[168:171], v[32:35], v[112:115]
  ds_read_b64_tr_b16 v[200:201], v22 offset:8192
  v_mfma_f32_16x16x32_bf16 v[116:119], v[168:171], v[36:39], v[116:119]
  ds_read_b64_tr_b16 v[202:203], v22 offset:8704
  v_mfma_f32_16x16x32_bf16 v[124:127], v[172:175], v[36:39], v[124:127]
  ds_read_b64_tr_b16 v[204:205], v23 offset:8192
  buffer_load_dwordx4 v[88:91], v4, s[36:39], s51 offen offset:1024
  v_mfma_f32_16x16x32_bf16 v[120:123], v[172:175], v[32:35], v[120:123]
  ds_read_b64_tr_b16 v[206:207], v23 offset:8704
  s_waitcnt vmcnt(11) lgkmcnt(8)
  v_mfma_f32_16x16x32_bf16 v[96:99], v[176:179], v[40:43], v[96:99]
  ds_read_b64_tr_b16 v[208:209], v20 offset:12288
  v_mfma_f32_16x16x32_bf16 v[100:103], v[176:179], v[44:47], v[100:103]
  ds_read_b64_tr_b16 v[210:211], v20 offset:12800
  buffer_load_dwordx4 v[92:95], v5, s[36:39], s51 offen offset:1024
  v_mfma_f32_16x16x32_bf16 v[108:111], v[180:183], v[44:47], v[108:111]
  ds_read_b64_tr_b16 v[212:213], v21 offset:12288
  v_mfma_f32_16x16x32_bf16 v[104:107], v[180:183], v[40:43], v[104:107]
  ds_read_b64_tr_b16 v[214:215], v21 offset:12800
  v_mfma_f32_16x16x32_bf16 v[112:115], v[184:187], v[40:43], v[112:115]
  ds_read_b64_tr_b16 v[216:217], v22 offset:12288
  v_mfma_f32_16x16x32_bf16 v[116:119], v[184:187], v[44:47], v[116:119]
  ds_read_b64_tr_b16 v[218:219], v22 offset:12800
  v_mfma_f32_16x16x32_bf16 v[124:127], v[188:191], v[44:47], v[124:127]
  ds_read_b64_tr_b16 v[220:221], v23 offset:12288
  v_mfma_f32_16x16x32_bf16 v[120:123], v[188:191], v[40:43], v[120:123]
  ds_read_b64_tr_b16 v[222:223], v23 offset:12800
  s_waitcnt vmcnt(10) lgkmcnt(8)
  v_mfma_f32_16x16x32_bf16 v[96:99], v[192:195], v[48:51], v[96:99]
  ds_read_b64_tr_b16 v[160:161], v20 offset:16384
  v_mfma_f32_16x16x32_bf16 v[100:103], v[192:195], v[52:55], v[100:103]
  ds_read_b64_tr_b16 v[162:163], v20 offset:16896
  v_mfma_f32_16x16x32_bf16 v[108:111], v[196:199], v[52:55], v[108:111]
  ds_read_b64_tr_b16 v[164:165], v21 offset:16384
  v_mfma_f32_16x16x32_bf16 v[104:107], v[196:199], v[48:51], v[104:107]
  ds_read_b64_tr_b16 v[166:167], v21 offset:16896
  v_mfma_f32_16x16x32_bf16 v[112:115], v[200:203], v[48:51], v[112:115]
  ds_read_b64_tr_b16 v[168:169], v22 offset:16384
  v_mfma_f32_16x16x32_bf16 v[116:119], v[200:203], v[52:55], v[116:119]
  ds_read_b64_tr_b16 v[170:171], v22 offset:16896
  v_mfma_f32_16x16x32_bf16 v[124:127], v[204:207], v[52:55], v[124:127]
  ds_read_b64_tr_b16 v[172:173], v23 offset:16384
  v_mfma_f32_16x16x32_bf16 v[120:123], v[204:207], v[48:51], v[120:123]
  ds_read_b64_tr_b16 v[174:175], v23 offset:16896
  s_waitcnt vmcnt(8) lgkmcnt(8)
  v_mfma_f32_16x16x32_bf16 v[96:99], v[208:211], v[56:59], v[96:99]
  ds_read_b64_tr_b16 v[176:177], v20 offset:20480
  v_mfma_f32_16x16x32_bf16 v[100:103], v[208:211], v[60:63], v[100:103]
  ds_read_b64_tr_b16 v[178:179], v20 offset:20992
  v_mfma_f32_16x16x32_bf16 v[108:111], v[212:215], v[60:63], v[108:111]
  ds_read_b64_tr_b16 v[180:181], v21 offset:20480
  v_mfma_f32_16x16x32_bf16 v[104:107], v[212:215], v[56:59], v[104:107]
  ds_read_b64_tr_b16 v[182:183], v21 offset:20992
  v_mfma_f32_16x16x32_bf16 v[112:115], v[216:219], v[56:59], v[112:115]
  ds_read_b64_tr_b16 v[184:185], v22 offset:20480
  v_mfma_f32_16x16x32_bf16 v[116:119], v[216:219], v[60:63], v[116:119]
  ds_read_b64_tr_b16 v[186:187], v22 offset:20992
  v_mfma_f32_16x16x32_bf16 v[124:127], v[220:223], v[60:63], v[124:127]
  ds_read_b64_tr_b16 v[188:189], v23 offset:20480
  v_mfma_f32_16x16x32_bf16 v[120:123], v[220:223], v[56:59], v[120:123]
  ds_read_b64_tr_b16 v[190:191], v23 offset:20992
  s_waitcnt vmcnt(6) lgkmcnt(8)
  v_mfma_f32_16x16x32_bf16 v[96:99], v[160:163], v[64:67], v[96:99]
  ds_read_b64_tr_b16 v[192:193], v20 offset:24576
  v_mfma_f32_16x16x32_bf16 v[100:103], v[160:163], v[68:71], v[100:103]
  ds_read_b64_tr_b16 v[194:195], v20 offset:25088
  v_mfma_f32_16x16x32_bf16 v[108:111], v[164:167], v[68:71], v[108:111]
  ds_read_b64_tr_b16 v[196:197], v21 offset:24576
  v_mfma_f32_16x16x32_bf16 v[104:107], v[164:167], v[64:67], v[104:107]
  ds_read_b64_tr_b16 v[198:199], v21 offset:25088
  v_mfma_f32_16x16x32_bf16 v[112:115], v[168:171], v[64:67], v[112:115]
  ds_read_b64_tr_b16 v[200:201], v22 offset:24576
  v_mfma_f32_16x16x32_bf16 v[116:119], v[168:171], v[68:71], v[116:119]
  ds_read_b64_tr_b16 v[202:203], v22 offset:25088
  v_mfma_f32_16x16x32_bf16 v[124:127], v[172:175], v[68:71], v[124:127]
  ds_read_b64_tr_b16 v[204:205], v23 offset:24576
  v_mfma_f32_16x16x32_bf16 v[120:123], v[172:175], v[64:67], v[120:123]
  ds_read_b64_tr_b16 v[206:207], v23 offset:25088
  s_waitcnt vmcnt(4) lgkmcnt(8)
  v_mfma_f32_16x16x32_bf16 v[96:99], v[176:179], v[72:75], v[96:99]
  ds_read_b64_tr_b16 v[208:209], v20 offset:28672
  v_mfma_f32_16x16x32_bf16 v[100:103], v[176:179], v[76:79], v[100:103]
  ds_read_b64_tr_b16 v[210:211], v20 offset:29184
  v_mfma_f32_16x16x32_bf16 v[108:111], v[180:183], v[76:79], v[108:111]
  ds_read_b64_tr_b16 v[212:213], v21 offset:28672
  v_mfma_f32_16x16x32_bf16 v[104:107], v[180:183], v[72:75], v[104:107]
  ds_read_b64_tr_b16 v[214:215], v21 offset:29184
  v_mfma_f32_16x16x32_bf16 v[112:115], v[184:187], v[72:75], v[112:115]
  ds_read_b64_tr_b16 v[216:217], v22 offset:28672
  v_mfma_f32_16x16x32_bf16 v[116:119], v[184:187], v[76:79], v[116:119]
  ds_read_b64_tr_b16 v[218:219], v22 offset:29184
  v_mfma_f32_16x16x32_bf16 v[124:127], v[188:191], v[76:79], v[124:127]
  ds_read_b64_tr_b16 v[220:221], v23 offset:28672
  v_mfma_f32_16x16x32_bf16 v[120:123], v[188:191], v[72:75], v[120:123]
  ds_read_b64_tr_b16 v[222:223], v23 offset:29184
  s_waitcnt vmcnt(2) lgkmcnt(8)
  v_mfma_f32_16x16x32_bf16 v[96:99], v[192:195], v[80:83], v[96:99]
  v_mov_b32 v20, 0
  v_mov_b32 v21, 0
  v_mfma_f32_16x16x32_bf16 v[100:103], v[192:195], v[84:87], v[100:103]
  v_mov_b32 v22, 0
  v_mov_b32 v23, 0
  v_mfma_f32_16x16x32_bf16 v[108:111], v[196:199], v[84:87], v[108:111]
  v_mfma_f32_16x16x32_bf16 v[104:107], v[196:199], v[80:83], v[104:107]
  v_mfma_f32_16x16x32_bf16 v[112:115], v[200:203], v[80:83], v[112:115]
  v_mfma_f32_16x16x32_bf16 v[116:119], v[200:203], v[84:87], v[116:119]
  v_mfma_f32_16x16x32_bf16 v[124:127], v[204:207], v[84:87], v[124:127]
  v_mfma_f32_16x16x32_bf16 v[120:123], v[204:207], v[80:83], v[120:123]
  s_waitcnt vmcnt(0) lgkmcnt(0)
  s_barrier
  v_mfma_f32_16x16x32_bf16 v[96:99], v[208:211], v[88:91], v[96:99]
  v_mfma_f32_16x16x32_bf16 v[100:103], v[208:211], v[92:95], v[100:103]
  v_mfma_f32_16x16x32_bf16 v[108:111], v[212:215], v[92:95], v[108:111]
  v_mfma_f32_16x16x32_bf16 v[104:107], v[212:215], v[88:91], v[104:107]
  v_mfma_f32_16x16x32_bf16 v[112:115], v[216:219], v[88:91], v[112:115]
  v_mfma_f32_16x16x32_bf16 v[116:119], v[216:219], v[92:95], v[116:119]
  v_mfma_f32_16x16x32_bf16 v[124:127], v[220:223], v[92:95], v[124:127]
  v_mfma_f32_16x16x32_bf16 v[120:123], v[220:223], v[88:91], v[120:123]
  s_mov_b32 s3, 32768
  s_mov_b32 s10, 0x3f803f80
  s_nop 4
  v_cvt_pk_bf16_f32 v240, v96, v97
  v_cvt_pk_bf16_f32 v241, v98, v99
  v_cvt_pk_bf16_f32 v242, v104, v105
  v_cvt_pk_bf16_f32 v243, v106, v107
  s_nop 1
  v_permlane16_swap_b32 v240, v242
  v_permlane16_swap_b32 v241, v243
  buffer_store_dwordx4 v[240:243], v12, s[44:47], 0 offen offset:0 sc1
  v_cvt_pk_bf16_f32 v244, v112, v113
  v_cvt_pk_bf16_f32 v245, v114, v115
  v_cvt_pk_bf16_f32 v246, v120, v121
  v_cvt_pk_bf16_f32 v247, v122, v123
  s_nop 1
  v_permlane16_swap_b32 v244, v246
  v_permlane16_swap_b32 v245, v247
  buffer_store_dwordx4 v[244:247], v12, s[44:47], 0 offen offset:1024 sc1
  v_cvt_pk_bf16_f32 v248, v100, v101
  v_cvt_pk_bf16_f32 v249, v102, v103
  v_cvt_pk_bf16_f32 v250, v108, v109
  v_cvt_pk_bf16_f32 v251, v110, v111
  s_nop 1
  v_permlane16_swap_b32 v248, v250
  v_permlane16_swap_b32 v249, v251
  buffer_store_dwordx4 v[248:251], v12, s[44:47], s3 offen offset:0 sc1
  v_cvt_pk_bf16_f32 v252, v116, v117
  v_cvt_pk_bf16_f32 v253, v118, v119
  v_cvt_pk_bf16_f32 v254, v124, v125
  v_cvt_pk_bf16_f32 v255, v126, v127
  s_nop 1
  v_permlane16_swap_b32 v252, v254
  v_permlane16_swap_b32 v253, v255
  buffer_store_dwordx4 v[252:255], v12, s[44:47], s3 offen offset:1024 sc1
  v_dot2_f32_bf16 v20, v240, s10, v20
  v_dot2_f32_bf16 v22, v240, v240, v22
  v_dot2_f32_bf16 v20, v241, s10, v20
  v_dot2_f32_bf16 v22, v241, v241, v22
  v_dot2_f32_bf16 v20, v242, s10, v20
  v_dot2_f32_bf16 v22, v242, v242, v22
  v_dot2_f32_bf16 v20, v243, s10, v20
  v_dot2_f32_bf16 v22, v243, v243, v22
  v_dot2_f32_bf16 v20, v244, s10, v20
  v_dot2_f32_bf16 v22, v244, v244, v22
  v_dot2_f32_bf16 v20, v245, s10, v20
  v_dot2_f32_bf16 v22, v245, v245, v22
  v_dot2_f32_bf16 v20, v246, s10, v20
  v_dot2_f32_bf16 v22, v246, v246, v22
  v_dot2_f32_bf16 v20, v247, s10, v20
  v_dot2_f32_bf16 v22, v247, v247, v22
  v_dot2_f32_bf16 v21, v248, s10, v21
  v_dot2_f32_bf16 v23, v248, v248, v23
  v_dot2_f32_bf16 v21, v249, s10, v21
  v_dot2_f32_bf16 v23, v249, v249, v23
  v_dot2_f32_bf16 v21, v250, s10, v21
  v_dot2_f32_bf16 v23, v250, v250, v23
  v_dot2_f32_bf16 v21, v251, s10, v21
  v_dot2_f32_bf16 v23, v251, v251, v23
  v_dot2_f32_bf16 v21, v252, s10, v21
  v_dot2_f32_bf16 v23, v252, v252, v23
  v_dot2_f32_bf16 v21, v253, s10, v21
  v_dot2_f32_bf16 v23, v253, v253, v23
  v_dot2_f32_bf16 v21, v254, s10, v21
  v_dot2_f32_bf16 v23, v254, v254, v23
  v_dot2_f32_bf16 v21, v255, s10, v21
  v_dot2_f32_bf16 v23, v255, v255, v23
  s_nop 2
  v_permlane32_swap_b32 v20, v21
  v_permlane32_swap_b32 v22, v23
  v_add_f32 v20, v20, v21
  v_add_f32 v22, v22, v23
  s_nop 1
  v_permlane16_swap_b32 v20, v22
  v_add_f32 v20, v20, v22
  buffer_store_dword v20, v18, s[56:59], 0 offen sc1
  s_waitcnt vmcnt(0) lgkmcnt(0)
  s_barrier
  s_add_u32 s97, s97, 1
  s_branch L_w1_body
L_wo_c1:
L_w1_c0:
L_w1_body:
  s_cmp_ge_u32 s2, 256
  s_cbranch_scc1 L_w1_end
  v_lshrrev_b32 v2, 6, v0
  v_and_b32 v1, 63, v0
  v_readfirstlane_b32 s70, v2
  s_and_b32 s3, s2, 7
  s_lshr_b32 s99, s2, 3
  s_and_b32 s5, s3, 1
  s_lshl_b32 s5, s5, 3
  s_and_b32 s6, s99, 7
  s_add_u32 s68, s5, s6
  s_lshr_b32 s5, s3, 1
  s_lshl_b32 s5, s5, 2
  s_lshr_b32 s6, s99, 3
  s_add_u32 s69, s5, s6
  s_cmp_lt_u32 s70, 4
  s_cbranch_scc1 L_w1_compute
L_w1_loader:
  s_add_u32 s8, s70, s69
  s_and_b32 s8, s8, 3
  s_add_u32 s9, s70, s68
  s_and_b32 s9, s9, 3
  s_lshl_b32 s76, s8, 12
  s_lshl_b32 s77, s9, 11
  s_add_u32 s77, s77, 16384
  s_lshl_b32 s11, s68, 7
  v_and_b32 v10, 7, v1
  s_lshr_b32 s10, s76, 11
  s_lshl_b32 s3, s68, 3
  s_add_u32 s10, s10, s3
  s_mul_i32 s10, s10, 32768
  v_lshl_add_u32 v4, v1, 4, s10
  v_add_u32 v5, 32768, v4
  v_lshrrev_b32 v3, 3, v1
  s_lshl_b32 s10, s9, 4
  v_add_u32 v3, s10, v3
  v_mul_u32_u24 v3, 7168, v3
  v_lshrrev_b32 v2, 3, v1
  v_and_b32 v2, 2, v2
  v_xor_b32 v2, v2, v10
  s_mul_i32 s10, s69, 128
  v_add_u32 v3, s10, v3
  v_lshl_add_u32 v8, v2, 4, v3
  v_xor_b32 v2, 4, v2
  v_add_u32 v3, 57344, v3
  v_lshl_add_u32 v9, v2, 4, v3
  v_lshrrev_b32 v3, 2, v1
  s_lshl_b32 s10, s9, 4
  v_add_u32 v3, s10, v3
  v_mul_u32_u24 v3, 7168, v3
  v_lshrrev_b32 v2, 4, v1
  v_and_b32 v2, 2, v2
  v_xor_b32 v2, v2, v1
  v_and_b32 v2, 3, v2
  s_lshl_b32 s10, s69, 6
  s_add_u32 s10, s10, 2048
  v_add_u32 v3, s10, v3
  v_lshl_add_u32 v28, v2, 4, v3
  s_lshl_b32 s78, s69, 7
  s_add_u32 s78, s78, 3072
  s_mov_b32 s75, 0
  s_add_u32 s100, s68, s69
  s_mov_b32 s101, -1
  s_add_u32 s101, s101, 1
  s_sub_u32 s73, s101, s100
  s_lshl_b32 s73, s73, 3
  s_lshr_b32 s73, 0xf0f02, s73
  s_and_b32 s73, s73, 255
  s_add_u32 s73, s73, s101
  s_and_b32 s73, s73, 15
  s_mul_i32 s74, s73, 458752
  s_lshl_b32 s73, s73, 11
  s_waitcnt lgkmcnt(0)
  s_add_u32 s36, s34, 4194304
  s_addc_u32 s37, s35, 0
  s_and_b32 s37, s37, 0xffff
  s_mov_b32 s38, 4194304
  s_mov_b32 s39, 0x00020000
  s_mov_b32 s40, s24
  s_and_b32 s41, s25, 0xffff
  s_mov_b32 s42, 7340032
  s_mov_b32 s43, 0x00020000
  s_add_u32 s56, s34, 24117248
  s_addc_u32 s57, s35, 0
  s_and_b32 s57, s57, 0xffff
  s_mov_b32 s58, 262144
  s_mov_b32 s59, 0x00020000
  s_add_u32 s64, s22, 24641536
  s_addc_u32 s65, s23, 0
  s_and_b32 s65, s65, 0xffff
  s_mov_b32 s66, 262144
  s_mov_b32 s67, 0x00020000
  s_mov_b32 s52, s26
  s_and_b32 s53, s27, 0xffff
  s_mov_b32 s54, 7168
  s_mov_b32 s55, 0x00020000
  s_mov_b32 s60, s28
  s_and_b32 s61, s29, 0xffff
  s_mov_b32 s62, 7340032
  s_mov_b32 s63, 0x00020000
  s_cmp_eq_u32 s96, 0
  s_cselect_b32 s62, s62, 0
  s_and_b32 s3, s70, 3
  s_lshl_b32 s4, s2, 2
  s_add_u32 s3, s3, s4
  s_mul_i32 s98, s3, 3584
  s_add_u32 s98, s98, 3670016
  s_add_u32 s3, s96, s70
  s_cmp_lg_u32 s3, 4
  s_cbranch_scc1 L_w1_chkNone
  s_add_u32 s44, s22, 41943040
  s_addc_u32 s45, s23, 0
  s_and_b32 s45, s45, 0xffff
  s_mov_b32 s46, 524288
  s_mov_b32 s47, 0x00020000
  v_lshrrev_b32 v2, 2, v1
  v_and_b32 v3, 3, v1
  v_lshlrev_b32 v2, 11, v2
  v_lshl_add_u32 v17, v3, 4, v2
  s_and_b32 s3, s69, 15
  s_lshl_b32 s3, s3, 7
  s_mov_b32 s79, 0x100000
L_w1_chkl:
  buffer_load_dwordx4 v[12:15], v17, s[44:47], s3 offen sc1
  s_sub_u32 s79, s79, 1
  s_cbranch_scc1 L_w1_chkNone
  s_waitcnt vmcnt(0)
  v_and_b32 v12, v12, v13
  v_and_b32 v14, v14, v15
  v_and_b32 v12, v12, v14
  v_cmp_ne_u32 vcc, 1, v12
  s_cbranch_vccnz L_w1_chkl
L_w1_chkNone:
  s_mov_b32 s75, 98304
  s_add_u32 s44, s22, 41943040
  s_addc_u32 s45, s23, 0
  s_and_b32 s45, s45, 0xffff
  s_mov_b32 s46, 524288
  s_mov_b32 s47, 0x00020000
  s_lshl4_add_u32 s3, s97, s68
  s_and_b32 s4, s69, 15
  s_lshl4_add_u32 s3, s3, s4
  s_lshl_b32 s3, s3, 7
  s_sub_u32 s3, s3, 32768
  v_lshlrev_b32 v11, 7, v1
  v_and_b32 v2, 15, v1
  v_lshlrev_b32 v2, 2, v2
  v_mov_b32 v3, 1
  s_mov_b32 s79, 0x100000
  s_cmp_lg_u32 s70, 4
  s_barrier
  s_cbranch_scc1 L_w1_nofl
  s_mov_b32 exec_lo, 0xffff
  s_mov_b32 exec_hi, 0
  buffer_store_dword v3, v11, s[44:47], s87 offen sc1
  s_mov_b64 exec, -1
L_w1_nofl:
  s_mov_b32 s5, s3
  s_mov_b32 s88, s73
  s_add_u32 m0, s77, 0
  s_add_u32 s4, s74, 0
  buffer_load_dwordx4 v8, s[40:43], s4 offen lds
  s_add_u32 m0, s77, 1024
  s_nop 0
  buffer_load_dwordx4 v9, s[40:43], s4 offen lds
  s_add_u32 m0, s77, 8192
  s_add_u32 s4, s74, s78
  buffer_load_dwordx4 v8, s[40:43], s4 offen lds
  s_add_u32 m0, s77, 9216
  s_nop 0
  buffer_load_dwordx4 v9, s[40:43], s4 offen lds
  s_add_u32 m0, s77, 16384
  s_add_u32 s4, s4, 128
  buffer_load_dwordx4 v8, s[40:43], s4 offen lds
  s_add_u32 m0, s77, 17408
  s_nop 0
  buffer_load_dwordx4 v9, s[40:43], s4 offen lds
  s_add_u32 m0, s77, 24576
  s_nop 0
  buffer_load_dwordx4 v28, s[40:43], s74 offen lds
  s_add_u32 s101, s101, 1
  s_sub_u32 s73, s101, s100
  s_lshl_b32 s73, s73, 3
  s_lshr_b32 s73, 0xf0f02, s73
  s_and_b32 s73, s73, 255
  s_add_u32 s73, s73, s101
  s_and_b32 s73, s73, 15
  s_mul_i32 s74, s73, 458752
  s_lshl_b32 s73, s73, 11
  s_mov_b32 s89, s73
  s_add_u32 m0, s77, 49152
  s_add_u32 s4, s74, 0
  buffer_load_dwordx4 v8, s[40:43], s4 offen lds
  s_add_u32 m0, s77, 50176
  s_nop 0
  buffer_load_dwordx4 v9, s[40:43], s4 offen lds
  s_add_u32 m0, s77, 57344
  s_add_u32 s4, s74, s78
  buffer_load_dwordx4 v8, s[40:43], s4 offen lds
  s_add_u32 m0, s77, 58368
  s_nop 0
  buffer_load_dwordx4 v9, s[40:43], s4 offen lds
  s_add_u32 m0, s77, 65536
  s_add_u32 s4, s4, 128
  buffer_load_dwordx4 v8, s[40:43], s4 offen lds
  s_add_u32 m0, s77, 66560
  s_nop 0
  buffer_load_dwordx4 v9, s[40:43], s4 offen lds
  s_add_u32 m0, s77, 73728
  s_nop 0
  buffer_load_dwordx4 v28, s[40:43], s74 offen lds
  s_add_u32 s101, s101, 1
  s_sub_u32 s73, s101, s100
  s_lshl_b32 s73, s73, 3
  s_lshr_b32 s73, 0xf0f02, s73
  s_and_b32 s73, s73, 255
  s_add_u32 s73, s73, s101
  s_and_b32 s73, s73, 15
  s_mul_i32 s74, s73, 458752
  s_lshl_b32 s73, s73, 11
  s_mov_b32 s3, s5
  s_cmp_lg_u32 s70, 4
  s_cbranch_scc1 L_w1_dep
L_w1_poll:
  buffer_load_dword v3, v2, s[44:47], s3 offen sc1
  s_sub_u32 s79, s79, 1
  s_cbranch_scc1 L_w1_dep
  s_waitcnt vmcnt(0)
  v_cmp_ne_u32 vcc, 1, v3
  s_cbranch_vccnz L_w1_poll
L_w1_dep:
  s_barrier
  s_add_u32 m0, s76, 0
  s_nop 0
  buffer_load_dwordx4 v4, s[36:39], s88 offen offset:0 lds
  buffer_load_dwordx4 v4, s[36:39], s88 offen offset:1024 lds
  s_add_u32 m0, s76, 2048
  s_nop 0
  buffer_load_dwordx4 v5, s[36:39], s88 offen offset:0 lds
  buffer_load_dwordx4 v5, s[36:39], s88 offen offset:1024 lds
  s_add_u32 m0, s76, 49152
  s_nop 0
  buffer_load_dwordx4 v4, s[36:39], s89 offen offset:0 lds
  buffer_load_dwordx4 v4, s[36:39], s89 offen offset:1024 lds
  s_add_u32 m0, s76, 51200
  s_nop 0
  buffer_load_dwordx4 v5, s[36:39], s89 offen offset:0 lds
  buffer_load_dwordx4 v5, s[36:39], s89 offen offset:1024 lds
  s_waitcnt vmcnt(4)
  s_barrier
  s_mov_b32 s79, 13
L_w1_ld1:
  s_add_u32 s3, s75, s76
  s_add_u32 m0, s3, 0
  s_nop 0
  buffer_load_dwordx4 v4, s[36:39], s73 offen offset:0 lds
  buffer_load_dwordx4 v4, s[36:39], s73 offen offset:1024 lds
  s_add_u32 m0, s3, 2048
  s_nop 0
  buffer_load_dwordx4 v5, s[36:39], s73 offen offset:0 lds
  buffer_load_dwordx4 v5, s[36:39], s73 offen offset:1024 lds
  s_add_u32 s3, s75, s77
  s_add_u32 m0, s3, 0
  s_add_u32 s4, s74, 0
  buffer_load_dwordx4 v8, s[40:43], s4 offen lds
  s_add_u32 m0, s3, 1024
  s_nop 0
  buffer_load_dwordx4 v9, s[40:43], s4 offen lds
  s_add_u32 m0, s3, 8192
  s_add_u32 s4, s74, s78
  buffer_load_dwordx4 v8, s[40:43], s4 offen lds
  s_add_u32 m0, s3, 9216
  s_nop 0
  buffer_load_dwordx4 v9, s[40:43], s4 offen lds
  s_add_u32 m0, s3, 16384
  s_add_u32 s4, s4, 128
  buffer_load_dwordx4 v8, s[40:43], s4 offen lds
  s_add_u32 m0, s3, 17408
  s_nop 0
  buffer_load_dwordx4 v9, s[40:43], s4 offen lds
  s_add_u32 m0, s3, 24576
  s_nop 0
  buffer_load_dwordx4 v28, s[40:43], s74 offen lds
  s_add_u32 s101, s101, 1
  s_sub_u32 s73, s101, s100
  s_lshl_b32 s73, s73, 3
  s_lshr_b32 s73, 0xf0f02, s73
  s_and_b32 s73, s73, 255
  s_add_u32 s73, s73, s101
  s_and_b32 s73, s73, 15
  s_mul_i32 s74, s73, 458752
  s_lshl_b32 s73, s73, 11
  s_add_u32 s75, s75, 49152
  s_cmp_eq_u32 s75, 147456
  s_cselect_b32 s75, 0, s75
  s_buffer_load_dword s84, s[60:63], s98 offset:0
  s_buffer_load_dword s84, s[60:63], s98 offset:64
  s_buffer_load_dword s84, s[60:63], s98 offset:128
  s_buffer_load_dword s84, s[60:63], s98 offset:192
  s_add_u32 s98, s98, 256
  s_waitcnt vmcnt(11)
  s_barrier
  s_sub_u32 s79, s79, 1
  s_cmp_lg_u32 s79, 0
  s_cbranch_scc1 L_w1_ld1
  s_add_u32 s3, s75, s76
  s_add_u32 m0, s3, 0
  s_nop 0
  buffer_load_dwordx4 v4, s[36:39], s73 offen offset:0 lds
  buffer_load_dwordx4 v4, s[36:39], s73 offen offset:1024 lds
  s_add_u32 m0, s3, 2048
  s_nop 0
  buffer_load_dwordx4 v5, s[36:39], s73 offen offset:0 lds
  buffer_load_dwordx4 v5, s[36:39], s73 offen offset:1024 lds
  s_add_u32 s3, s75, s77
  s_add_u32 m0, s3, 0
  s_add_u32 s4, s74, 0
  buffer_load_dwordx4 v8, s[40:43], s4 offen lds
  s_add_u32 m0, s3, 1024
  s_nop 0
  buffer_load_dwordx4 v9, s[40:43], s4 offen lds
  s_add_u32 m0, s3, 8192
  s_add_u32 s4, s74, s78
  buffer_load_dwordx4 v8, s[40:43], s4 offen lds
  s_add_u32 m0, s3, 9216
  s_nop 0
  buffer_load_dwordx4 v9, s[40:43], s4 offen lds
  s_add_u32 m0, s3, 16384
  s_add_u32 s4, s4, 128
  buffer_load_dwordx4 v8, s[40:43], s4 offen lds
  s_add_u32 m0, s3, 17408
  s_nop 0
  buffer_load_dwordx4 v9, s[40:43], s4 offen lds
  s_add_u32 m0, s3, 24576
  s_nop 0
  buffer_load_dwordx4 v28, s[40:43], s74 offen lds
  s_add_u32 s101, s101, 1
  s_sub_u32 s73, s101, s100
  s_lshl_b32 s73, s73, 3
  s_lshr_b32 s73, 0xf0f02, s73
  s_and_b32 s73, s73, 255
  s_add_u32 s73, s73, s101
  s_and_b32 s73, s73, 15
  s_mul_i32 s74, s73, 458752
  s_lshl_b32 s73, s73, 11
  s_add_u32 s75, s75, 49152
  s_cmp_eq_u32 s75, 147456
  s_cselect_b32 s75, 0, s75
  s_buffer_load_dword s84, s[60:63], s98 offset:0
  s_buffer_load_dword s84, s[60:63], s98 offset:64
  s_buffer_load_dword s84, s[60:63], s98 offset:128
  s_buffer_load_dword s84, s[60:63], s98 offset:192
  s_add_u32 s98, s98, 256
  s_and_b32 s3, s70, 3
  s_lshl_b32 s4, s68, 7
  s_lshl_b32 s5, s3, 6
  s_add_u32 s5, s5, s4
  v_add_u32 v2, s5, v1
  s_sub_u32 s4, s4, 16
  v_and_b32 v3, 15, v1
  v_add_u32 v3, s4, v3
  v_max_i32 v3, 0, v3
  s_cmp_ge_u32 s3, 2
  s_cselect_b64 vcc, -1, 0
  v_cndmask_b32 v2, v2, v3, vcc
  v_lshlrev_b32 v2, 3, v2
  s_mov_b32 s3, 0
  buffer_load_dwordx2 v[32:33], v2, s[56:59], s3 offen
  s_add_u32 s3, s3, 16384
  buffer_load_dwordx2 v[34:35], v2, s[56:59], s3 offen
  s_add_u32 s3, s3, 16384
  buffer_load_dwordx2 v[36:37], v2, s[56:59], s3 offen
  s_add_u32 s3, s3, 16384
  buffer_load_dwordx2 v[38:39], v2, s[56:59], s3 offen
  s_add_u32 s3, s3, 16384
  buffer_load_dwordx2 v[40:41], v2, s[56:59], s3 offen
  s_add_u32 s3, s3, 16384
  buffer_load_dwordx2 v[42:43], v2, s[56:59], s3 offen
  s_add_u32 s3, s3, 16384
  buffer_load_dwordx2 v[44:45], v2, s[56:59], s3 offen
  s_add_u32 s3, s3, 16384
  buffer_load_dwordx2 v[46:47], v2, s[56:59], s3 offen
  s_add_u32 s3, s3, 16384
  buffer_load_dwordx2 v[48:49], v2, s[56:59], s3 offen
  s_add_u32 s3, s3, 16384
  buffer_load_dwordx2 v[50:51], v2, s[56:59], s3 offen
  s_add_u32 s3, s3, 16384
  buffer_load_dwordx2 v[52:53], v2, s[56:59], s3 offen
  s_add_u32 s3, s3, 16384
  buffer_load_dwordx2 v[54:55], v2, s[56:59], s3 offen
  s_add_u32 s3, s3, 16384
  buffer_load_dwordx2 v[56:57], v2, s[56:59], s3 offen
  s_add_u32 s3, s3, 16384
  buffer_load_dwordx2 v[58:59], v2, s[56:59], s3 offen
  s_add_u32 s3, s3, 16384
  buffer_load_dwordx2 v[60:61], v2, s[56:59], s3 offen
  s_add_u32 s3, s3, 16384
  buffer_load_dwordx2 v[62:63], v2, s[56:59], s3 offen
  s_lshl_b32 s4, s69, 7
  s_lshl_b32 s5, s70, 6
  s_add_u32 s4, s4, s5
  s_add_u32 s4, s4, 1216
  s_lshl_b32 s5, s69, 6
  s_cmp_eq_u32 s70, 4
  s_cselect_b32 s4, s5, s4
  s_lshr_b32 s5, s5, 1
  s_add_u32 s5, s5, 1024
  s_cmp_eq_u32 s70, 7
  s_cselect_b32 s4, s5, s4
  v_add_u32 v3, s4, v1
  v_lshlrev_b32 v2, 2, v3
  v_lshlrev_b32 v3, 1, v3
  s_mov_b32 s3, 0
  buffer_load_dword v64, v2, s[64:67], s3 offen
  s_add_u32 s3, s3, 16384
  buffer_load_dword v65, v2, s[64:67], s3 offen
  s_add_u32 s3, s3, 16384
  buffer_load_dword v66, v2, s[64:67], s3 offen
  s_add_u32 s3, s3, 16384
  buffer_load_dword v67, v2, s[64:67], s3 offen
  s_add_u32 s3, s3, 16384
  buffer_load_dword v68, v2, s[64:67], s3 offen
  s_add_u32 s3, s3, 16384
  buffer_load_dword v69, v2, s[64:67], s3 offen
  s_add_u32 s3, s3, 16384
  buffer_load_dword v70, v2, s[64:67], s3 offen
  s_add_u32 s3, s3, 16384
  buffer_load_dword v71, v2, s[64:67], s3 offen
  s_add_u32 s3, s3, 16384
  buffer_load_dword v72, v2, s[64:67], s3 offen
  s_add_u32 s3, s3, 16384
  buffer_load_dword v73, v2, s[64:67], s3 offen
  s_add_u32 s3, s3, 16384
  buffer_load_dword v74, v2, s[64:67], s3 offen
  s_add_u32 s3, s3, 16384
  buffer_load_dword v75, v2, s[64:67], s3 offen
  s_add_u32 s3, s3, 16384
  buffer_load_dword v76, v2, s[64:67], s3 offen
  s_add_u32 s3, s3, 16384
  buffer_load_dword v77, v2, s[64:67], s3 offen
  s_add_u32 s3, s3, 16384
  buffer_load_dword v78, v2, s[64:67], s3 offen
  s_add_u32 s3, s3, 16384
  buffer_load_dword v79, v2, s[64:67], s3 offen
  buffer_load_ushort v80, v3, s[52:55], 0 offen
  s_waitcnt vmcnt(44)
  s_barrier
  s_waitcnt vmcnt(33)
  s_barrier
  s_waitcnt vmcnt(0)
  v_add_f32 v32, v32, v34
  v_add_f32 v33, v33, v35
  v_add_f32 v48, v48, v50
  v_add_f32 v49, v49, v51
  v_add_f32 v32, v32, v36
  v_add_f32 v33, v33, v37
  v_add_f32 v48, v48, v52
  v_add_f32 v49, v49, v53
  v_add_f32 v32, v32, v38
  v_add_f32 v33, v33, v39
  v_add_f32 v48, v48, v54
  v_add_f32 v49, v49, v55
  v_add_f32 v32, v32, v40
  v_add_f32 v33, v33, v41
  v_add_f32 v48, v48, v56
  v_add_f32 v49, v49, v57
  v_add_f32 v32, v32, v42
  v_add_f32 v33, v33, v43
  v_add_f32 v48, v48, v58
  v_add_f32 v49, v49, v59
  v_add_f32 v32, v32, v44
  v_add_f32 v33, v33, v45
  v_add_f32 v48, v48, v60
  v_add_f32 v49, v49, v61
  v_add_f32 v32, v32, v46
  v_add_f32 v33, v33, v47
  v_add_f32 v48, v48, v62
  v_add_f32 v49, v49, v63
  v_add_f32 v32, v32, v48
  v_add_f32 v33, v33, v49
  v_mul_f32 v32, 0x3a800000, v32
  v_mul_f32 v33, 0x3a800000, v33
  v_fma_f32 v33, -v32, v32, v33
  v_max_f32 v33, 0, v33
  v_add_f32 v33, 0x3727c5ac, v33
  v_rsq_f32 v33, v33
  s_nop 0
  s_and_b32 s3, s70, 3
  s_lshl_b32 s5, s3, 6
  s_add_u32 s5, s5, 16
  v_add_u32 v2, s5, v1
  v_and_b32 v3, 15, v1
  s_cmp_ge_u32 s3, 2
  s_cselect_b64 vcc, -1, 0
  v_cndmask_b32 v2, v2, v3, vcc
  v_lshlrev_b32 v2, 2, v2
  v_add_u32 v2, 147456, v2
  ds_write2_b32 v2, v32, v33 offset0:0 offset1:160
  v_add_f32 v64, v64, v72
  v_add_f32 v65, v65, v73
  v_add_f32 v66, v66, v74
  v_add_f32 v67, v67, v75
  v_add_f32 v68, v68, v76
  v_add_f32 v69, v69, v77
  v_add_f32 v70, v70, v78
  v_add_f32 v71, v71, v79
  v_add_f32 v64, v64, v68
  v_add_f32 v65, v65, v69
  v_add_f32 v66, v66, v70
  v_add_f32 v67, v67, v71
  v_add_f32 v64, v64, v65
  v_add_f32 v66, v66, v67
  v_add_f32 v64, v64, v66
  v_lshlrev_b32 v80, 16, v80
  v_lshlrev_b32 v2, 2, v0
  v_add_u32 v2, 147712, v2
  ds_write_b32 v2, v64
  ds_write_b32 v2, v80 offset:1024
  s_waitcnt lgkmcnt(0)
  s_barrier
  s_lshl_b32 s87, s97, 15
  s_lshl_b32 s4, s68, 11
  s_add_u32 s87, s87, s4
  s_lshl_b32 s4, s69, 2
  s_add_u32 s87, s87, s4
  s_add_u32 s97, s97, 1
  s_branch L_w2_body
L_w1_end:
  s_endpgm
L_w1_compute:
  s_and_b32 s71, s70, 1
  s_lshr_b32 s72, s70, 1
  v_and_b32 v3, 15, v1
  v_lshrrev_b32 v2, 4, v1
  s_lshl_b32 s8, s71, 13
  v_lshl_add_u32 v4, v1, 4, s8
  v_bfe_u32 v13, v1, 2, 2
  v_lshl_add_u32 v13, v2, 3, v13
  v_lshlrev_b32 v13, 7, v13
  v_and_b32 v17, 3, v1
  v_lshl_add_u32 v13, v17, 3, v13
  v_bfe_u32 v17, v1, 3, 2
  v_lshl_add_u32 v13, v17, 5, v13
  s_lshl_b32 s9, s72, 6
  v_xor_b32 v13, s9, v13
  v_add_u32 v5, 16384, v13
  v_xor_b32 v6, 32, v5
  v_and_b32 v16, 1, v2
  v_lshrrev_b32 v17, 1, v2
  v_bfe_u32 v13, v1, 2, 2
  v_lshl_add_u32 v13, v16, 3, v13
  v_lshl_add_u32 v13, v17, 5, v13
  v_xor_b32 v14, s72, v16
  v_lshl_add_u32 v13, v13, 1, v14
  v_and_b32 v14, 3, v1
  v_lshl_add_u32 v13, v13, 2, v14
  v_lshlrev_b32 v13, 3, v13
  v_add_u32 v7, 40960, v13
  s_lshl_b32 s8, s68, 7
  s_lshl_b32 s9, s71, 6
  s_add_u32 s8, s8, s9
  s_mul_i32 s8, s8, 7168
  v_lshlrev_b32 v14, 8, v17
  v_lshl_add_u32 v14, v3, 4, v14
  v_add_u32 v14, s8, v14
  s_lshl_b32 s10, s69, 11
  s_lshl_b32 s9, s72, 10
  s_add_u32 s9, s9, s10
  v_lshl_add_u32 v12, v16, 9, v14
  v_add_u32 v12, s9, v12
  v_mul_u32_u24 v16, 114688, v16
  s_lshr_b32 s9, s9, 1
  v_add3_u32 v13, v16, v14, s9
  s_lshl_b32 s9, s71, 8
  s_add_u32 s9, s9, 147520
  v_lshl_add_u32 v14, v3, 2, s9
  s_lshl_b32 s9, s72, 7
  s_add_u32 s9, s9, 148736
  v_lshl_add_u32 v15, v2, 4, s9
  s_lshl_b32 s9, s72, 6
  s_add_u32 s9, s9, 148736
  v_lshl_add_u32 v16, v2, 4, s9
  v_mov_b32 v128, 0
  v_mov_b32 v129, 0
  v_mov_b32 v130, 0
  v_mov_b32 v131, 0
  v_mov_b32 v132, 0
  v_mov_b32 v133, 0
  v_mov_b32 v134, 0
  v_mov_b32 v135, 0
  v_mov_b32 v136, 0
  v_mov_b32 v137, 0
  v_mov_b32 v138, 0
  v_mov_b32 v139, 0
  v_mov_b32 v140, 0
  v_mov_b32 v141, 0
  v_mov_b32 v142, 0
  v_mov_b32 v143, 0
  v_mov_b32 v144, 0
  v_mov_b32 v145, 0
  v_mov_b32 v146, 0
  v_mov_b32 v147, 0
  v_mov_b32 v148, 0
  v_mov_b32 v149, 0
  v_mov_b32 v150, 0
  v_mov_b32 v151, 0
  v_mov_b32 v152, 0
  v_mov_b32 v153, 0
  v_mov_b32 v154, 0
  v_mov_b32 v155, 0
  v_mov_b32 v156, 0
  v_mov_b32 v157, 0
  v_mov_b32 v158, 0
  v_mov_b32 v159, 0
  v_mov_b32 v160, 0
  v_mov_b32 v161, 0
  v_mov_b32 v162, 0
  v_mov_b32 v163, 0
  v_mov_b32 v164, 0
  v_mov_b32 v165, 0
  v_mov_b32 v166, 0
  v_mov_b32 v167, 0
  v_mov_b32 v168, 0
  v_mov_b32 v169, 0
  v_mov_b32 v170, 0
  v_mov_b32 v171, 0
  v_mov_b32 v172, 0
  v_mov_b32 v173, 0
  v_mov_b32 v174, 0
  v_mov_b32 v175, 0
  v_mov_b32 v176, 0
  v_mov_b32 v177, 0
  v_mov_b32 v178, 0
  v_mov_b32 v179, 0
  v_mov_b32 v180, 0
  v_mov_b32 v181, 0
  v_mov_b32 v182, 0
  v_mov_b32 v183, 0
  v_mov_b32 v184, 0
  v_mov_b32 v185, 0
  v_mov_b32 v186, 0
  v_mov_b32 v187, 0
  v_mov_b32 v188, 0
  v_mov_b32 v189, 0
  v_mov_b32 v190, 0
  v_mov_b32 v191, 0
  v_mov_b32 v192, 0
  v_mov_b32 v193, 0
  v_mov_b32 v194, 0
  v_mov_b32 v195, 0
  v_mov_b32 v196, 0
  v_mov_b32 v197, 0
  v_mov_b32 v198, 0
  v_mov_b32 v199, 0
  v_mov_b32 v200, 0
  v_mov_b32 v201, 0
  v_mov_b32 v202, 0
  v_mov_b32 v203, 0
  v_mov_b32 v204, 0
  v_mov_b32 v205, 0
  v_mov_b32 v206, 0
  v_mov_b32 v207, 0
  v_mov_b32 v208, 0
  v_mov_b32 v209, 0
  v_mov_b32 v210, 0
  v_mov_b32 v211, 0
  v_mov_b32 v212, 0
  v_mov_b32 v213, 0
  v_mov_b32 v214, 0
  v_mov_b32 v215, 0
  v_mov_b32 v216, 0
  v_mov_b32 v217, 0
  v_mov_b32 v218, 0
  v_mov_b32 v219, 0
  v_mov_b32 v220, 0
  v_mov_b32 v221, 0
  v_mov_b32 v222, 0
  v_mov_b32 v223, 0
  v_mov_b32 v224, 0
  v_mov_b32 v225, 0
  v_mov_b32 v226, 0
  v_mov_b32 v227, 0
  v_mov_b32 v228, 0
  v_mov_b32 v229, 0
  v_mov_b32 v230, 0
  v_mov_b32 v231, 0
  v_mov_b32 v232, 0
  v_mov_b32 v233, 0
  v_mov_b32 v234, 0
  v_mov_b32 v235, 0
  v_mov_b32 v236, 0
  v_mov_b32 v237, 0
  v_mov_b32 v238, 0
  v_mov_b32 v239, 0
  s_waitcnt lgkmcnt(0)
  s_add_u32 s44, s34, 8388608
  s_addc_u32 s45, s35, 0
  s_and_b32 s45, s45, 0xffff
  s_mov_b32 s46, 14680064
  s_mov_b32 s47, 0x00020000
  s_cmp_lg_u32 s96, 0
  s_cbranch_scc1 L_pfc3_skip
  s_getpc_b64 s[4:5]
L_pfc3:
  s_lshl_b32 s3, s99, 2
  s_add_u32 s3, s3, s70
  s_mul_i32 s3, s3, 192
  s_min_u32 s3, s3, L_w2_c1-L_w2_c0-192
  s_add_i32 s3, s3, L_w2_c0-L_pfc3
  s_ashr_i32 s6, s3, 31
  s_add_u32 s4, s4, s3
  s_addc_u32 s5, s5, s6
  s_load_dword s36, s[4:5], 0
  s_load_dword s37, s[4:5], 64
  s_load_dword s38, s[4:5], 128
L_pfc3_skip:
  s_mov_b32 s75, 0
  v_add_u32_e64 v20, s75, v4
  v_add_u32_e64 v21, s75, v5
  v_add_u32_e64 v22, s75, v6
  v_add_u32_e64 v23, s75, v7
  s_add_u32 s75, s75, 49152
  s_cmp_eq_u32 s75, 147456
  s_cselect_b32 s75, 0, s75
  s_mov_b32 s79, 16
  s_barrier
  s_barrier
  ds_read_b128 v[32:35], v20 offset:0
  ds_read_b128 v[36:39], v20 offset:2048
  ds_read_b128 v[40:43], v20 offset:4096
  ds_read_b128 v[44:47], v20 offset:6144
  ds_read_b64_tr_b16 v[48:49], v21 offset:0
  ds_read_b64_tr_b16 v[50:51], v21 offset:512
  ds_read_b64_tr_b16 v[52:53], v22 offset:0
  ds_read_b64_tr_b16 v[54:55], v22 offset:512
  ds_read_b64_tr_b16 v[56:57], v21 offset:8192
  ds_read_b64_tr_b16 v[58:59], v21 offset:8704
  ds_read_b64_tr_b16 v[60:61], v22 offset:8192
  ds_read_b64_tr_b16 v[62:63], v22 offset:8704
  ds_read_b64_tr_b16 v[64:65], v21 offset:16384
  ds_read_b64_tr_b16 v[66:67], v21 offset:16896
  ds_read_b64_tr_b16 v[68:69], v22 offset:16384
  ds_read_b64_tr_b16 v[70:71], v22 offset:16896
  ds_read_b64_tr_b16 v[72:73], v23 offset:0
  ds_read_b64_tr_b16 v[74:75], v23 offset:256
  s_waitcnt lgkmcnt(0)
.p2align 3
L_w1_loop:
  v_mfma_f32_16x16x32_bf16 v[128:131], v[48:51], v[32:35], v[128:131]
  ds_read_b128 v[80:83], v20 offset:1024
  v_mfma_f32_16x16x32_bf16 v[132:135], v[48:51], v[36:39], v[132:135]
  ds_read_b128 v[84:87], v20 offset:3072
  v_mfma_f32_16x16x32_bf16 v[136:139], v[48:51], v[40:43], v[136:139]
  ds_read_b128 v[88:91], v20 offset:5120
  v_mfma_f32_16x16x32_bf16 v[140:143], v[48:51], v[44:47], v[140:143]
  ds_read_b128 v[92:95], v20 offset:7168
  v_mfma_f32_16x16x32_bf16 v[156:159], v[52:55], v[44:47], v[156:159]
  ds_read_b64_tr_b16 v[96:97], v21 offset:4096
  v_mfma_f32_16x16x32_bf16 v[152:155], v[52:55], v[40:43], v[152:155]
  ds_read_b64_tr_b16 v[98:99], v21 offset:4608
  v_mfma_f32_16x16x32_bf16 v[148:151], v[52:55], v[36:39], v[148:151]
  ds_read_b64_tr_b16 v[100:101], v22 offset:4096
  v_mfma_f32_16x16x32_bf16 v[144:147], v[52:55], v[32:35], v[144:147]
  ds_read_b64_tr_b16 v[102:103], v22 offset:4608
  v_mfma_f32_16x16x32_bf16 v[160:163], v[56:59], v[32:35], v[160:163]
  ds_read_b64_tr_b16 v[104:105], v21 offset:12288
  v_mfma_f32_16x16x32_bf16 v[164:167], v[56:59], v[36:39], v[164:167]
  ds_read_b64_tr_b16 v[106:107], v21 offset:12800
  v_mfma_f32_16x16x32_bf16 v[168:171], v[56:59], v[40:43], v[168:171]
  ds_read_b64_tr_b16 v[108:109], v22 offset:12288
  v_mfma_f32_16x16x32_bf16 v[172:175], v[56:59], v[44:47], v[172:175]
  ds_read_b64_tr_b16 v[110:111], v22 offset:12800
  v_mfma_f32_16x16x32_bf16 v[188:191], v[60:63], v[44:47], v[188:191]
  ds_read_b64_tr_b16 v[112:113], v21 offset:20480
  v_mfma_f32_16x16x32_bf16 v[184:187], v[60:63], v[40:43], v[184:187]
  ds_read_b64_tr_b16 v[114:115], v21 offset:20992
  v_mfma_f32_16x16x32_bf16 v[180:183], v[60:63], v[36:39], v[180:183]
  ds_read_b64_tr_b16 v[116:117], v22 offset:20480
  v_mfma_f32_16x16x32_bf16 v[176:179], v[60:63], v[32:35], v[176:179]
  ds_read_b64_tr_b16 v[118:119], v22 offset:20992
  v_mfma_f32_16x16x32_bf16 v[192:195], v[64:67], v[32:35], v[192:195]
  ds_read_b64_tr_b16 v[120:121], v23 offset:4096
  v_mfma_f32_16x16x32_bf16 v[196:199], v[64:67], v[36:39], v[196:199]
  ds_read_b64_tr_b16 v[122:123], v23 offset:4352
  v_mfma_f32_16x16x32_bf16 v[200:203], v[64:67], v[40:43], v[200:203]
  v_add_u32_e64 v20, s75, v4
  v_mfma_f32_16x16x32_bf16 v[204:207], v[64:67], v[44:47], v[204:207]
  v_add_u32_e64 v21, s75, v5
  v_mfma_f32_16x16x32_bf16 v[220:223], v[68:71], v[44:47], v[220:223]
  v_add_u32_e64 v22, s75, v6
  v_mfma_f32_16x16x32_bf16 v[216:219], v[68:71], v[40:43], v[216:219]
  v_add_u32_e64 v23, s75, v7
  v_mfma_f32_16x16x32_bf16 v[212:215], v[68:71], v[36:39], v[212:215]
  s_add_u32 s75, s75, 49152
  v_mfma_f32_16x16x32_bf16 v[208:211], v[68:71], v[32:35], v[208:211]
  s_cmp_eq_u32 s75, 147456
  v_mfma_f32_16x16x32_bf16 v[224:227], v[72:75], v[32:35], v[224:227]
  s_cselect_b32 s75, 0, s75
  s_sub_u32 s79, s79, 1
  v_mfma_f32_16x16x32_bf16 v[228:231], v[72:75], v[36:39], v[228:231]
  v_mfma_f32_16x16x32_bf16 v[232:235], v[72:75], v[40:43], v[232:235]
  v_mfma_f32_16x16x32_bf16 v[236:239], v[72:75], v[44:47], v[236:239]
  s_waitcnt lgkmcnt(0)
  s_barrier
  v_mfma_f32_16x16x32_bf16 v[128:131], v[96:99], v[80:83], v[128:131]
  ds_read_b128 v[32:35], v20 offset:0
  v_mfma_f32_16x16x32_bf16 v[132:135], v[96:99], v[84:87], v[132:135]
  ds_read_b128 v[36:39], v20 offset:2048
  v_mfma_f32_16x16x32_bf16 v[136:139], v[96:99], v[88:91], v[136:139]
  ds_read_b128 v[40:43], v20 offset:4096
  v_mfma_f32_16x16x32_bf16 v[140:143], v[96:99], v[92:95], v[140:143]
  ds_read_b128 v[44:47], v20 offset:6144
  v_mfma_f32_16x16x32_bf16 v[156:159], v[100:103], v[92:95], v[156:159]
  ds_read_b64_tr_b16 v[48:49], v21 offset:0
  v_mfma_f32_16x16x32_bf16 v[152:155], v[100:103], v[88:91], v[152:155]
  ds_read_b64_tr_b16 v[50:51], v21 offset:512
  v_mfma_f32_16x16x32_bf16 v[148:151], v[100:103], v[84:87], v[148:151]
  ds_read_b64_tr_b16 v[52:53], v22 offset:0
  v_mfma_f32_16x16x32_bf16 v[144:147], v[100:103], v[80:83], v[144:147]
  ds_read_b64_tr_b16 v[54:55], v22 offset:512
  v_mfma_f32_16x16x32_bf16 v[160:163], v[104:107], v[80:83], v[160:163]
  ds_read_b64_tr_b16 v[56:57], v21 offset:8192
  v_mfma_f32_16x16x32_bf16 v[164:167], v[104:107], v[84:87], v[164:167]
  ds_read_b64_tr_b16 v[58:59], v21 offset:8704
  v_mfma_f32_16x16x32_bf16 v[168:171], v[104:107], v[88:91], v[168:171]
  ds_read_b64_tr_b16 v[60:61], v22 offset:8192
  v_mfma_f32_16x16x32_bf16 v[172:175], v[104:107], v[92:95], v[172:175]
  ds_read_b64_tr_b16 v[62:63], v22 offset:8704
  v_mfma_f32_16x16x32_bf16 v[188:191], v[108:111], v[92:95], v[188:191]
  ds_read_b64_tr_b16 v[64:65], v21 offset:16384
  v_mfma_f32_16x16x32_bf16 v[184:187], v[108:111], v[88:91], v[184:187]
  ds_read_b64_tr_b16 v[66:67], v21 offset:16896
  v_mfma_f32_16x16x32_bf16 v[180:183], v[108:111], v[84:87], v[180:183]
  ds_read_b64_tr_b16 v[68:69], v22 offset:16384
  v_mfma_f32_16x16x32_bf16 v[176:179], v[108:111], v[80:83], v[176:179]
  ds_read_b64_tr_b16 v[70:71], v22 offset:16896
  v_mfma_f32_16x16x32_bf16 v[192:195], v[112:115], v[80:83], v[192:195]
  ds_read_b64_tr_b16 v[72:73], v23 offset:0
  v_mfma_f32_16x16x32_bf16 v[196:199], v[112:115], v[84:87], v[196:199]
  ds_read_b64_tr_b16 v[74:75], v23 offset:256
  v_mfma_f32_16x16x32_bf16 v[200:203], v[112:115], v[88:91], v[200:203]
  s_cmp_lg_u32 s79, 0
  s_nop 0
  v_mfma_f32_16x16x32_bf16 v[204:207], v[112:115], v[92:95], v[204:207]
  v_mfma_f32_16x16x32_bf16 v[220:223], v[116:119], v[92:95], v[220:223]
  v_mfma_f32_16x16x32_bf16 v[216:219], v[116:119], v[88:91], v[216:219]
  v_mfma_f32_16x16x32_bf16 v[212:215], v[116:119], v[84:87], v[212:215]
  v_mfma_f32_16x16x32_bf16 v[208:211], v[116:119], v[80:83], v[208:211]
  v_mfma_f32_16x16x32_bf16 v[224:227], v[120:123], v[80:83], v[224:227]
  v_mfma_f32_16x16x32_bf16 v[228:231], v[120:123], v[84:87], v[228:231]
  v_mfma_f32_16x16x32_bf16 v[232:235], v[120:123], v[88:91], v[232:235]
  v_mfma_f32_16x16x32_bf16 v[236:239], v[120:123], v[92:95], v[236:239]
  s_waitcnt lgkmcnt(0)
  s_cbranch_scc1 L_w1_loop
L_w1_exit:
  ds_read2_b32 v[88:89], v14 offset0:0 offset1:160
  ds_read2_b32 v[90:91], v14 offset0:16 offset1:176
  ds_read2_b32 v[92:93], v14 offset0:32 offset1:192
  ds_read2_b32 v[94:95], v14 offset0:48 offset1:208
  ds_read_b128 v[32:35], v15 offset:0
  ds_read_b128 v[60:63], v15 offset:1024
  ds_read_b128 v[36:39], v15 offset:64
  ds_read_b128 v[64:67], v15 offset:1088
  ds_read_b128 v[40:43], v15 offset:256
  ds_read_b128 v[68:71], v15 offset:1280
  ds_read_b128 v[44:47], v15 offset:320
  ds_read_b128 v[72:75], v15 offset:1344
  ds_read_b128 v[48:51], v15 offset:512
  ds_read_b128 v[76:79], v15 offset:1536
  ds_read_b128 v[52:55], v15 offset:576
  ds_read_b128 v[80:83], v15 offset:1600
  ds_read_b128 v[56:59], v16 offset:768
  ds_read_b128 v[84:87], v16 offset:1792
  v_mov_b32 v96, 0xc0135761
  v_mov_b32 v97, 0xbdd2d3e8
  v_mov_b32 v98, 1.0
  s_waitcnt lgkmcnt(0)
  v_mul_f32 v88, v88, v89
  v_mul_f32 v90, v90, v91
  v_mul_f32 v92, v92, v93
  v_mul_f32 v94, v94, v95
  v_pk_fma_f32 v[100:101], v[32:33], v[88:89], v[60:61] op_sel:[0,0,0] op_sel_hi:[1,0,1] neg_lo:[0,1,0] neg_hi:[0,1,0]
  v_pk_fma_f32 v[102:103], v[34:35], v[88:89], v[62:63] op_sel:[0,0,0] op_sel_hi:[1,0,1] neg_lo:[0,1,0] neg_hi:[0,1,0]
  v_pk_fma_f32 v[128:129], v[128:129], v[88:89], v[100:101] op_sel:[0,1,0] op_sel_hi:[1,1,1]
  v_pk_fma_f32 v[130:131], v[130:131], v[88:89], v[102:103] op_sel:[0,1,0] op_sel_hi:[1,1,1]
  v_pk_mul_f32 v[100:101], v[128:129], v[128:129]
  v_pk_mul_f32 v[102:103], v[130:131], v[130:131]
  v_pk_fma_f32 v[100:101], v[100:101], v[96:97], v[96:97] op_sel:[0,1,0] op_sel_hi:[1,1,0]
  v_pk_fma_f32 v[102:103], v[102:103], v[96:97], v[96:97] op_sel:[0,1,0] op_sel_hi:[1,1,0]
  v_pk_mul_f32 v[100:101], v[100:101], v[128:129]
  v_pk_mul_f32 v[102:103], v[102:103], v[130:131]
  v_exp_f32 v100, v100
  v_exp_f32 v101, v101
  v_exp_f32 v102, v102
  v_exp_f32 v103, v103
  v_pk_add_f32 v[100:101], v[100:101], v[98:99] op_sel_hi:[1,0]
  v_pk_add_f32 v[102:103], v[102:103], v[98:99] op_sel_hi:[1,0]
  v_rcp_f32 v100, v100
  v_rcp_f32 v101, v101
  v_rcp_f32 v102, v102
  v_rcp_f32 v103, v103
  v_pk_mul_f32 v[128:129], v[128:129], v[100:101]
  v_pk_mul_f32 v[130:131], v[130:131], v[102:103]
  v_cvt_pk_bf16_f32 v108, v128, v129
  v_cvt_pk_bf16_f32 v109, v130, v131
  v_pk_fma_f32 v[104:105], v[36:37], v[88:89], v[64:65] op_sel:[0,0,0] op_sel_hi:[1,0,1] neg_lo:[0,1,0] neg_hi:[0,1,0]
  v_pk_fma_f32 v[106:107], v[38:39], v[88:89], v[66:67] op_sel:[0,0,0] op_sel_hi:[1,0,1] neg_lo:[0,1,0] neg_hi:[0,1,0]
  v_pk_fma_f32 v[144:145], v[144:145], v[88:89], v[104:105] op_sel:[0,1,0] op_sel_hi:[1,1,1]
  v_pk_fma_f32 v[146:147], v[146:147], v[88:89], v[106:107] op_sel:[0,1,0] op_sel_hi:[1,1,1]
  v_pk_mul_f32 v[104:105], v[144:145], v[144:145]
  v_pk_mul_f32 v[106:107], v[146:147], v[146:147]
  v_pk_fma_f32 v[104:105], v[104:105], v[96:97], v[96:97] op_sel:[0,1,0] op_sel_hi:[1,1,0]
  v_pk_fma_f32 v[106:107], v[106:107], v[96:97], v[96:97] op_sel:[0,1,0] op_sel_hi:[1,1,0]
  v_pk_mul_f32 v[104:105], v[104:105], v[144:145]
  v_pk_mul_f32 v[106:107], v[106:107], v[146:147]
  v_exp_f32 v104, v104
  v_exp_f32 v105, v105
  v_exp_f32 v106, v106
  v_exp_f32 v107, v107
  v_pk_add_f32 v[104:105], v[104:105], v[98:99] op_sel_hi:[1,0]
  v_pk_add_f32 v[106:107], v[106:107], v[98:99] op_sel_hi:[1,0]
  v_rcp_f32 v104, v104
  v_rcp_f32 v105, v105
  v_rcp_f32 v106, v106
  v_rcp_f32 v107, v107
  v_pk_mul_f32 v[144:145], v[144:145], v[104:105]
  v_pk_mul_f32 v[146:147], v[146:147], v[106:107]
  v_cvt_pk_bf16_f32 v110, v144, v145
  v_cvt_pk_bf16_f32 v111, v146, v147
  s_mov_b32 s3, 0
  s_nop 0
  v_permlane16_swap_b32 v108, v110
  v_permlane16_swap_b32 v109, v111
  buffer_store_dwordx4 v[108:111], v12, s[44:47], s3 offen sc1
  v_pk_fma_f32 v[100:101], v[32:33], v[90:91], v[60:61] op_sel:[0,0,0] op_sel_hi:[1,0,1] neg_lo:[0,1,0] neg_hi:[0,1,0]
  v_pk_fma_f32 v[102:103], v[34:35], v[90:91], v[62:63] op_sel:[0,0,0] op_sel_hi:[1,0,1] neg_lo:[0,1,0] neg_hi:[0,1,0]
  v_pk_fma_f32 v[132:133], v[132:133], v[90:91], v[100:101] op_sel:[0,1,0] op_sel_hi:[1,1,1]
  v_pk_fma_f32 v[134:135], v[134:135], v[90:91], v[102:103] op_sel:[0,1,0] op_sel_hi:[1,1,1]
  v_pk_mul_f32 v[100:101], v[132:133], v[132:133]
  v_pk_mul_f32 v[102:103], v[134:135], v[134:135]
  v_pk_fma_f32 v[100:101], v[100:101], v[96:97], v[96:97] op_sel:[0,1,0] op_sel_hi:[1,1,0]
  v_pk_fma_f32 v[102:103], v[102:103], v[96:97], v[96:97] op_sel:[0,1,0] op_sel_hi:[1,1,0]
  v_pk_mul_f32 v[100:101], v[100:101], v[132:133]
  v_pk_mul_f32 v[102:103], v[102:103], v[134:135]
  v_exp_f32 v100, v100
  v_exp_f32 v101, v101
  v_exp_f32 v102, v102
  v_exp_f32 v103, v103
  v_pk_add_f32 v[100:101], v[100:101], v[98:99] op_sel_hi:[1,0]
  v_pk_add_f32 v[102:103], v[102:103], v[98:99] op_sel_hi:[1,0]
  v_rcp_f32 v100, v100
  v_rcp_f32 v101, v101
  v_rcp_f32 v102, v102
  v_rcp_f32 v103, v103
  v_pk_mul_f32 v[132:133], v[132:133], v[100:101]
  v_pk_mul_f32 v[134:135], v[134:135], v[102:103]
  v_cvt_pk_bf16_f32 v112, v132, v133
  v_cvt_pk_bf16_f32 v113, v134, v135
  v_pk_fma_f32 v[104:105], v[36:37], v[90:91], v[64:65] op_sel:[0,0,0] op_sel_hi:[1,0,1] neg_lo:[0,1,0] neg_hi:[0,1,0]
  v_pk_fma_f32 v[106:107], v[38:39], v[90:91], v[66:67] op_sel:[0,0,0] op_sel_hi:[1,0,1] neg_lo:[0,1,0] neg_hi:[0,1,0]
  v_pk_fma_f32 v[148:149], v[148:149], v[90:91], v[104:105] op_sel:[0,1,0] op_sel_hi:[1,1,1]
  v_pk_fma_f32 v[150:151], v[150:151], v[90:91], v[106:107] op_sel:[0,1,0] op_sel_hi:[1,1,1]
  v_pk_mul_f32 v[104:105], v[148:149], v[148:149]
  v_pk_mul_f32 v[106:107], v[150:151], v[150:151]
  v_pk_fma_f32 v[104:105], v[104:105], v[96:97], v[96:97] op_sel:[0,1,0] op_sel_hi:[1,1,0]
  v_pk_fma_f32 v[106:107], v[106:107], v[96:97], v[96:97] op_sel:[0,1,0] op_sel_hi:[1,1,0]
  v_pk_mul_f32 v[104:105], v[104:105], v[148:149]
  v_pk_mul_f32 v[106:107], v[106:107], v[150:151]
  v_exp_f32 v104, v104
  v_exp_f32 v105, v105
  v_exp_f32 v106, v106
  v_exp_f32 v107, v107
  v_pk_add_f32 v[104:105], v[104:105], v[98:99] op_sel_hi:[1,0]
  v_pk_add_f32 v[106:107], v[106:107], v[98:99] op_sel_hi:[1,0]
  v_rcp_f32 v104, v104
  v_rcp_f32 v105, v105
  v_rcp_f32 v106, v106
  v_rcp_f32 v107, v107
  v_pk_mul_f32 v[148:149], v[148:149], v[104:105]
  v_pk_mul_f32 v[150:151], v[150:151], v[106:107]
  v_cvt_pk_bf16_f32 v114, v148, v149
  v_cvt_pk_bf16_f32 v115, v150, v151
  s_mov_b32 s3, 114688
  s_nop 0
  v_permlane16_swap_b32 v112, v114
  v_permlane16_swap_b32 v113, v115
  buffer_store_dwordx4 v[112:115], v12, s[44:47], s3 offen sc1
  v_pk_fma_f32 v[100:101], v[32:33], v[92:93], v[60:61] op_sel:[0,0,0] op_sel_hi:[1,0,1] neg_lo:[0,1,0] neg_hi:[0,1,0]
  v_pk_fma_f32 v[102:103], v[34:35], v[92:93], v[62:63] op_sel:[0,0,0] op_sel_hi:[1,0,1] neg_lo:[0,1,0] neg_hi:[0,1,0]
  v_pk_fma_f32 v[136:137], v[136:137], v[92:93], v[100:101] op_sel:[0,1,0] op_sel_hi:[1,1,1]
  v_pk_fma_f32 v[138:139], v[138:139], v[92:93], v[102:103] op_sel:[0,1,0] op_sel_hi:[1,1,1]
  v_pk_mul_f32 v[100:101], v[136:137], v[136:137]
  v_pk_mul_f32 v[102:103], v[138:139], v[138:139]
  v_pk_fma_f32 v[100:101], v[100:101], v[96:97], v[96:97] op_sel:[0,1,0] op_sel_hi:[1,1,0]
  v_pk_fma_f32 v[102:103], v[102:103], v[96:97], v[96:97] op_sel:[0,1,0] op_sel_hi:[1,1,0]
  v_pk_mul_f32 v[100:101], v[100:101], v[136:137]
  v_pk_mul_f32 v[102:103], v[102:103], v[138:139]
  v_exp_f32 v100, v100
  v_exp_f32 v101, v101
  v_exp_f32 v102, v102
  v_exp_f32 v103, v103
  v_pk_add_f32 v[100:101], v[100:101], v[98:99] op_sel_hi:[1,0]
  v_pk_add_f32 v[102:103], v[102:103], v[98:99] op_sel_hi:[1,0]
  v_rcp_f32 v100, v100
  v_rcp_f32 v101, v101
  v_rcp_f32 v102, v102
  v_rcp_f32 v103, v103
  v_pk_mul_f32 v[136:137], v[136:137], v[100:101]
  v_pk_mul_f32 v[138:139], v[138:139], v[102:103]
  v_cvt_pk_bf16_f32 v116, v136, v137
  v_cvt_pk_bf16_f32 v117, v138, v139
  v_pk_fma_f32 v[104:105], v[36:37], v[92:93], v[64:65] op_sel:[0,0,0] op_sel_hi:[1,0,1] neg_lo:[0,1,0] neg_hi:[0,1,0]
  v_pk_fma_f32 v[106:107], v[38:39], v[92:93], v[66:67] op_sel:[0,0,0] op_sel_hi:[1,0,1] neg_lo:[0,1,0] neg_hi:[0,1,0]
  v_pk_fma_f32 v[152:153], v[152:153], v[92:93], v[104:105] op_sel:[0,1,0] op_sel_hi:[1,1,1]
  v_pk_fma_f32 v[154:155], v[154:155], v[92:93], v[106:107] op_sel:[0,1,0] op_sel_hi:[1,1,1]
  v_pk_mul_f32 v[104:105], v[152:153], v[152:153]
  v_pk_mul_f32 v[106:107], v[154:155], v[154:155]
  v_pk_fma_f32 v[104:105], v[104:105], v[96:97], v[96:97] op_sel:[0,1,0] op_sel_hi:[1,1,0]
  v_pk_fma_f32 v[106:107], v[106:107], v[96:97], v[96:97] op_sel:[0,1,0] op_sel_hi:[1,1,0]
  v_pk_mul_f32 v[104:105], v[104:105], v[152:153]
  v_pk_mul_f32 v[106:107], v[106:107], v[154:155]
  v_exp_f32 v104, v104
  v_exp_f32 v105, v105
  v_exp_f32 v106, v106
  v_exp_f32 v107, v107
  v_pk_add_f32 v[104:105], v[104:105], v[98:99] op_sel_hi:[1,0]
  v_pk_add_f32 v[106:107], v[106:107], v[98:99] op_sel_hi:[1,0]
  v_rcp_f32 v104, v104
  v_rcp_f32 v105, v105
  v_rcp_f32 v106, v106
  v_rcp_f32 v107, v107
  v_pk_mul_f32 v[152:153], v[152:153], v[104:105]
  v_pk_mul_f32 v[154:155], v[154:155], v[106:107]
  v_cvt_pk_bf16_f32 v118, v152, v153
  v_cvt_pk_bf16_f32 v119, v154, v155
  s_mov_b32 s3, 229376
  s_nop 0
  v_permlane16_swap_b32 v116, v118
  v_permlane16_swap_b32 v117, v119
  buffer_store_dwordx4 v[116:119], v12, s[44:47], s3 offen sc1
  v_pk_fma_f32 v[100:101], v[32:33], v[94:95], v[60:61] op_sel:[0,0,0] op_sel_hi:[1,0,1] neg_lo:[0,1,0] neg_hi:[0,1,0]
  v_pk_fma_f32 v[102:103], v[34:35], v[94:95], v[62:63] op_sel:[0,0,0] op_sel_hi:[1,0,1] neg_lo:[0,1,0] neg_hi:[0,1,0]
  v_pk_fma_f32 v[140:141], v[140:141], v[94:95], v[100:101] op_sel:[0,1,0] op_sel_hi:[1,1,1]
  v_pk_fma_f32 v[142:143], v[142:143], v[94:95], v[102:103] op_sel:[0,1,0] op_sel_hi:[1,1,1]
  v_pk_mul_f32 v[100:101], v[140:141], v[140:141]
  v_pk_mul_f32 v[102:103], v[142:143], v[142:143]
  v_pk_fma_f32 v[100:101], v[100:101], v[96:97], v[96:97] op_sel:[0,1,0] op_sel_hi:[1,1,0]
  v_pk_fma_f32 v[102:103], v[102:103], v[96:97], v[96:97] op_sel:[0,1,0] op_sel_hi:[1,1,0]
  v_pk_mul_f32 v[100:101], v[100:101], v[140:141]
  v_pk_mul_f32 v[102:103], v[102:103], v[142:143]
  v_exp_f32 v100, v100
  v_exp_f32 v101, v101
  v_exp_f32 v102, v102
  v_exp_f32 v103, v103
  v_pk_add_f32 v[100:101], v[100:101], v[98:99] op_sel_hi:[1,0]
  v_pk_add_f32 v[102:103], v[102:103], v[98:99] op_sel_hi:[1,0]
  v_rcp_f32 v100, v100
  v_rcp_f32 v101, v101
  v_rcp_f32 v102, v102
  v_rcp_f32 v103, v103
  v_pk_mul_f32 v[140:141], v[140:141], v[100:101]
  v_pk_mul_f32 v[142:143], v[142:143], v[102:103]
  v_cvt_pk_bf16_f32 v120, v140, v141
  v_cvt_pk_bf16_f32 v121, v142, v143
  v_pk_fma_f32 v[104:105], v[36:37], v[94:95], v[64:65] op_sel:[0,0,0] op_sel_hi:[1,0,1] neg_lo:[0,1,0] neg_hi:[0,1,0]
  v_pk_fma_f32 v[106:107], v[38:39], v[94:95], v[66:67] op_sel:[0,0,0] op_sel_hi:[1,0,1] neg_lo:[0,1,0] neg_hi:[0,1,0]
  v_pk_fma_f32 v[156:157], v[156:157], v[94:95], v[104:105] op_sel:[0,1,0] op_sel_hi:[1,1,1]
  v_pk_fma_f32 v[158:159], v[158:159], v[94:95], v[106:107] op_sel:[0,1,0] op_sel_hi:[1,1,1]
  v_pk_mul_f32 v[104:105], v[156:157], v[156:157]
  v_pk_mul_f32 v[106:107], v[158:159], v[158:159]
  v_pk_fma_f32 v[104:105], v[104:105], v[96:97], v[96:97] op_sel:[0,1,0] op_sel_hi:[1,1,0]
  v_pk_fma_f32 v[106:107], v[106:107], v[96:97], v[96:97] op_sel:[0,1,0] op_sel_hi:[1,1,0]
  v_pk_mul_f32 v[104:105], v[104:105], v[156:157]
  v_pk_mul_f32 v[106:107], v[106:107], v[158:159]
  v_exp_f32 v104, v104
  v_exp_f32 v105, v105
  v_exp_f32 v106, v106
  v_exp_f32 v107, v107
  v_pk_add_f32 v[104:105], v[104:105], v[98:99] op_sel_hi:[1,0]
  v_pk_add_f32 v[106:107], v[106:107], v[98:99] op_sel_hi:[1,0]
  v_rcp_f32 v104, v104
  v_rcp_f32 v105, v105
  v_rcp_f32 v106, v106
  v_rcp_f32 v107, v107
  v_pk_mul_f32 v[156:157], v[156:157], v[104:105]
  v_pk_mul_f32 v[158:159], v[158:159], v[106:107]
  v_cvt_pk_bf16_f32 v122, v156, v157
  v_cvt_pk_bf16_f32 v123, v158, v159
  s_mov_b32 s3, 344064
  s_nop 0
  v_permlane16_swap_b32 v120, v122
  v_permlane16_swap_b32 v121, v123
  buffer_store_dwordx4 v[120:123], v12, s[44:47], s3 offen sc1
  v_pk_fma_f32 v[100:101], v[56:57], v[88:89], v[84:85] op_sel:[0,0,0] op_sel_hi:[1,0,1] neg_lo:[0,1,0] neg_hi:[0,1,0]
  v_pk_fma_f32 v[102:103], v[58:59], v[88:89], v[86:87] op_sel:[0,0,0] op_sel_hi:[1,0,1] neg_lo:[0,1,0] neg_hi:[0,1,0]
  v_pk_fma_f32 v[224:225], v[224:225], v[88:89], v[100:101] op_sel:[0,1,0] op_sel_hi:[1,1,1]
  v_pk_fma_f32 v[226:227], v[226:227], v[88:89], v[102:103] op_sel:[0,1,0] op_sel_hi:[1,1,1]
  v_pk_mul_f32 v[100:101], v[224:225], v[224:225]
  v_pk_mul_f32 v[102:103], v[226:227], v[226:227]
  v_pk_fma_f32 v[100:101], v[100:101], v[96:97], v[96:97] op_sel:[0,1,0] op_sel_hi:[1,1,0]
  v_pk_fma_f32 v[102:103], v[102:103], v[96:97], v[96:97] op_sel:[0,1,0] op_sel_hi:[1,1,0]
  v_pk_mul_f32 v[100:101], v[100:101], v[224:225]
  v_pk_mul_f32 v[102:103], v[102:103], v[226:227]
  v_exp_f32 v100, v100
  v_exp_f32 v101, v101
  v_exp_f32 v102, v102
  v_exp_f32 v103, v103
  v_pk_add_f32 v[100:101], v[100:101], v[98:99] op_sel_hi:[1,0]
  v_pk_add_f32 v[102:103], v[102:103], v[98:99] op_sel_hi:[1,0]
  v_rcp_f32 v100, v100
  v_rcp_f32 v101, v101
  v_rcp_f32 v102, v102
  v_rcp_f32 v103, v103
  v_pk_mul_f32 v[224:225], v[224:225], v[100:101]
  v_pk_mul_f32 v[226:227], v[226:227], v[102:103]
  v_cvt_pk_bf16_f32 v108, v224, v225
  v_cvt_pk_bf16_f32 v109, v226, v227
  v_pk_fma_f32 v[100:101], v[56:57], v[90:91], v[84:85] op_sel:[0,0,0] op_sel_hi:[1,0,1] neg_lo:[0,1,0] neg_hi:[0,1,0]
  v_pk_fma_f32 v[102:103], v[58:59], v[90:91], v[86:87] op_sel:[0,0,0] op_sel_hi:[1,0,1] neg_lo:[0,1,0] neg_hi:[0,1,0]
  v_pk_fma_f32 v[228:229], v[228:229], v[90:91], v[100:101] op_sel:[0,1,0] op_sel_hi:[1,1,1]
  v_pk_fma_f32 v[230:231], v[230:231], v[90:91], v[102:103] op_sel:[0,1,0] op_sel_hi:[1,1,1]
  v_pk_mul_f32 v[100:101], v[228:229], v[228:229]
  v_pk_mul_f32 v[102:103], v[230:231], v[230:231]
  v_pk_fma_f32 v[100:101], v[100:101], v[96:97], v[96:97] op_sel:[0,1,0] op_sel_hi:[1,1,0]
  v_pk_fma_f32 v[102:103], v[102:103], v[96:97], v[96:97] op_sel:[0,1,0] op_sel_hi:[1,1,0]
  v_pk_mul_f32 v[100:101], v[100:101], v[228:229]
  v_pk_mul_f32 v[102:103], v[102:103], v[230:231]
  v_exp_f32 v100, v100
  v_exp_f32 v101, v101
  v_exp_f32 v102, v102
  v_exp_f32 v103, v103
  v_pk_add_f32 v[100:101], v[100:101], v[98:99] op_sel_hi:[1,0]
  v_pk_add_f32 v[102:103], v[102:103], v[98:99] op_sel_hi:[1,0]
  v_rcp_f32 v100, v100
  v_rcp_f32 v101, v101
  v_rcp_f32 v102, v102
  v_rcp_f32 v103, v103
  v_pk_mul_f32 v[228:229], v[228:229], v[100:101]
  v_pk_mul_f32 v[230:231], v[230:231], v[102:103]
  v_cvt_pk_bf16_f32 v110, v228, v229
  v_cvt_pk_bf16_f32 v111, v230, v231
  s_mov_b32 s3, 32768
  s_nop 0
  v_permlane16_swap_b32 v108, v110
  v_permlane16_swap_b32 v109, v111
  buffer_store_dwordx4 v[108:111], v13, s[44:47], s3 offen sc1
  v_pk_fma_f32 v[100:101], v[56:57], v[92:93], v[84:85] op_sel:[0,0,0] op_sel_hi:[1,0,1] neg_lo:[0,1,0] neg_hi:[0,1,0]
  v_pk_fma_f32 v[102:103], v[58:59], v[92:93], v[86:87] op_sel:[0,0,0] op_sel_hi:[1,0,1] neg_lo:[0,1,0] neg_hi:[0,1,0]
  v_pk_fma_f32 v[232:233], v[232:233], v[92:93], v[100:101] op_sel:[0,1,0] op_sel_hi:[1,1,1]
  v_pk_fma_f32 v[234:235], v[234:235], v[92:93], v[102:103] op_sel:[0,1,0] op_sel_hi:[1,1,1]
  v_pk_mul_f32 v[100:101], v[232:233], v[232:233]
  v_pk_mul_f32 v[102:103], v[234:235], v[234:235]
  v_pk_fma_f32 v[100:101], v[100:101], v[96:97], v[96:97] op_sel:[0,1,0] op_sel_hi:[1,1,0]
  v_pk_fma_f32 v[102:103], v[102:103], v[96:97], v[96:97] op_sel:[0,1,0] op_sel_hi:[1,1,0]
  v_pk_mul_f32 v[100:101], v[100:101], v[232:233]
  v_pk_mul_f32 v[102:103], v[102:103], v[234:235]
  v_exp_f32 v100, v100
  v_exp_f32 v101, v101
  v_exp_f32 v102, v102
  v_exp_f32 v103, v103
  v_pk_add_f32 v[100:101], v[100:101], v[98:99] op_sel_hi:[1,0]
  v_pk_add_f32 v[102:103], v[102:103], v[98:99] op_sel_hi:[1,0]
  v_rcp_f32 v100, v100
  v_rcp_f32 v101, v101
  v_rcp_f32 v102, v102
  v_rcp_f32 v103, v103
  v_pk_mul_f32 v[232:233], v[232:233], v[100:101]
  v_pk_mul_f32 v[234:235], v[234:235], v[102:103]
  v_cvt_pk_bf16_f32 v112, v232, v233
  v_cvt_pk_bf16_f32 v113, v234, v235
  v_pk_fma_f32 v[100:101], v[56:57], v[94:95], v[84:85] op_sel:[0,0,0] op_sel_hi:[1,0,1] neg_lo:[0,1,0] neg_hi:[0,1,0]
  v_pk_fma_f32 v[102:103], v[58:59], v[94:95], v[86:87] op_sel:[0,0,0] op_sel_hi:[1,0,1] neg_lo:[0,1,0] neg_hi:[0,1,0]
  v_pk_fma_f32 v[236:237], v[236:237], v[94:95], v[100:101] op_sel:[0,1,0] op_sel_hi:[1,1,1]
  v_pk_fma_f32 v[238:239], v[238:239], v[94:95], v[102:103] op_sel:[0,1,0] op_sel_hi:[1,1,1]
  v_pk_mul_f32 v[100:101], v[236:237], v[236:237]
  v_pk_mul_f32 v[102:103], v[238:239], v[238:239]
  v_pk_fma_f32 v[100:101], v[100:101], v[96:97], v[96:97] op_sel:[0,1,0] op_sel_hi:[1,1,0]
  v_pk_fma_f32 v[102:103], v[102:103], v[96:97], v[96:97] op_sel:[0,1,0] op_sel_hi:[1,1,0]
  v_pk_mul_f32 v[100:101], v[100:101], v[236:237]
  v_pk_mul_f32 v[102:103], v[102:103], v[238:239]
  v_exp_f32 v100, v100
  v_exp_f32 v101, v101
  v_exp_f32 v102, v102
  v_exp_f32 v103, v103
  v_pk_add_f32 v[100:101], v[100:101], v[98:99] op_sel_hi:[1,0]
  v_pk_add_f32 v[102:103], v[102:103], v[98:99] op_sel_hi:[1,0]
  v_rcp_f32 v100, v100
  v_rcp_f32 v101, v101
  v_rcp_f32 v102, v102
  v_rcp_f32 v103, v103
  v_pk_mul_f32 v[236:237], v[236:237], v[100:101]
  v_pk_mul_f32 v[238:239], v[238:239], v[102:103]
  v_cvt_pk_bf16_f32 v114, v236, v237
  v_cvt_pk_bf16_f32 v115, v238, v239
  s_mov_b32 s3, 262144
  s_nop 0
  v_permlane16_swap_b32 v112, v114
  v_permlane16_swap_b32 v113, v115
  buffer_store_dwordx4 v[112:115], v13, s[44:47], s3 offen sc1
  v_pk_fma_f32 v[100:101], v[40:41], v[88:89], v[68:69] op_sel:[0,0,0] op_sel_hi:[1,0,1] neg_lo:[0,1,0] neg_hi:[0,1,0]
  v_pk_fma_f32 v[102:103], v[42:43], v[88:89], v[70:71] op_sel:[0,0,0] op_sel_hi:[1,0,1] neg_lo:[0,1,0] neg_hi:[0,1,0]
  v_pk_fma_f32 v[160:161], v[160:161], v[88:89], v[100:101] op_sel:[0,1,0] op_sel_hi:[1,1,1]
  v_pk_fma_f32 v[162:163], v[162:163], v[88:89], v[102:103] op_sel:[0,1,0] op_sel_hi:[1,1,1]
  v_pk_mul_f32 v[100:101], v[160:161], v[160:161]
  v_pk_mul_f32 v[102:103], v[162:163], v[162:163]
  v_pk_fma_f32 v[100:101], v[100:101], v[96:97], v[96:97] op_sel:[0,1,0] op_sel_hi:[1,1,0]
  v_pk_fma_f32 v[102:103], v[102:103], v[96:97], v[96:97] op_sel:[0,1,0] op_sel_hi:[1,1,0]
  v_pk_mul_f32 v[100:101], v[100:101], v[160:161]
  v_pk_mul_f32 v[102:103], v[102:103], v[162:163]
  v_exp_f32 v100, v100
  v_exp_f32 v101, v101
  v_exp_f32 v102, v102
  v_exp_f32 v103, v103
  v_pk_add_f32 v[100:101], v[100:101], v[98:99] op_sel_hi:[1,0]
  v_pk_add_f32 v[102:103], v[102:103], v[98:99] op_sel_hi:[1,0]
  v_rcp_f32 v100, v100
  v_rcp_f32 v101, v101
  v_rcp_f32 v102, v102
  v_rcp_f32 v103, v103
  v_pk_mul_f32 v[160:161], v[160:161], v[100:101]
  v_pk_mul_f32 v[162:163], v[162:163], v[102:103]
  v_cvt_pk_bf16_f32 v116, v160, v161
  v_cvt_pk_bf16_f32 v117, v162, v163
  v_pk_fma_f32 v[104:105], v[44:45], v[88:89], v[72:73] op_sel:[0,0,0] op_sel_hi:[1,0,1] neg_lo:[0,1,0] neg_hi:[0,1,0]
  v_pk_fma_f32 v[106:107], v[46:47], v[88:89], v[74:75] op_sel:[0,0,0] op_sel_hi:[1,0,1] neg_lo:[0,1,0] neg_hi:[0,1,0]
  v_pk_fma_f32 v[176:177], v[176:177], v[88:89], v[104:105] op_sel:[0,1,0] op_sel_hi:[1,1,1]
  v_pk_fma_f32 v[178:179], v[178:179], v[88:89], v[106:107] op_sel:[0,1,0] op_sel_hi:[1,1,1]
  v_pk_mul_f32 v[104:105], v[176:177], v[176:177]
  v_pk_mul_f32 v[106:107], v[178:179], v[178:179]
  v_pk_fma_f32 v[104:105], v[104:105], v[96:97], v[96:97] op_sel:[0,1,0] op_sel_hi:[1,1,0]
  v_pk_fma_f32 v[106:107], v[106:107], v[96:97], v[96:97] op_sel:[0,1,0] op_sel_hi:[1,1,0]
  v_pk_mul_f32 v[104:105], v[104:105], v[176:177]
  v_pk_mul_f32 v[106:107], v[106:107], v[178:179]
  v_exp_f32 v104, v104
  v_exp_f32 v105, v105
  v_exp_f32 v106, v106
  v_exp_f32 v107, v107
  v_pk_add_f32 v[104:105], v[104:105], v[98:99] op_sel_hi:[1,0]
  v_pk_add_f32 v[106:107], v[106:107], v[98:99] op_sel_hi:[1,0]
  v_rcp_f32 v104, v104
  v_rcp_f32 v105, v105
  v_rcp_f32 v106, v106
  v_rcp_f32 v107, v107
  v_pk_mul_f32 v[176:177], v[176:177], v[104:105]
  v_pk_mul_f32 v[178:179], v[178:179], v[106:107]
  v_cvt_pk_bf16_f32 v118, v176, v177
  v_cvt_pk_bf16_f32 v119, v178, v179
  s_add_u32 s3, s10, 49152
  s_nop 0
  v_permlane16_swap_b32 v116, v118
  v_permlane16_swap_b32 v117, v119
  buffer_store_dwordx4 v[116:119], v12, s[44:47], s3 offen sc1
  v_pk_fma_f32 v[100:101], v[48:49], v[88:89], v[76:77] op_sel:[0,0,0] op_sel_hi:[1,0,1] neg_lo:[0,1,0] neg_hi:[0,1,0]
  v_pk_fma_f32 v[102:103], v[50:51], v[88:89], v[78:79] op_sel:[0,0,0] op_sel_hi:[1,0,1] neg_lo:[0,1,0] neg_hi:[0,1,0]
  v_pk_fma_f32 v[192:193], v[192:193], v[88:89], v[100:101] op_sel:[0,1,0] op_sel_hi:[1,1,1]
  v_pk_fma_f32 v[194:195], v[194:195], v[88:89], v[102:103] op_sel:[0,1,0] op_sel_hi:[1,1,1]
  v_pk_mul_f32 v[100:101], v[192:193], v[192:193]
  v_pk_mul_f32 v[102:103], v[194:195], v[194:195]
  v_pk_fma_f32 v[100:101], v[100:101], v[96:97], v[96:97] op_sel:[0,1,0] op_sel_hi:[1,1,0]
  v_pk_fma_f32 v[102:103], v[102:103], v[96:97], v[96:97] op_sel:[0,1,0] op_sel_hi:[1,1,0]
  v_pk_mul_f32 v[100:101], v[100:101], v[192:193]
  v_pk_mul_f32 v[102:103], v[102:103], v[194:195]
  v_exp_f32 v100, v100
  v_exp_f32 v101, v101
  v_exp_f32 v102, v102
  v_exp_f32 v103, v103
  v_pk_add_f32 v[100:101], v[100:101], v[98:99] op_sel_hi:[1,0]
  v_pk_add_f32 v[102:103], v[102:103], v[98:99] op_sel_hi:[1,0]
  v_rcp_f32 v100, v100
  v_rcp_f32 v101, v101
  v_rcp_f32 v102, v102
  v_rcp_f32 v103, v103
  v_pk_mul_f32 v[192:193], v[192:193], v[100:101]
  v_pk_mul_f32 v[194:195], v[194:195], v[102:103]
  v_cvt_pk_bf16_f32 v120, v192, v193
  v_cvt_pk_bf16_f32 v121, v194, v195
  v_pk_fma_f32 v[104:105], v[52:53], v[88:89], v[80:81] op_sel:[0,0,0] op_sel_hi:[1,0,1] neg_lo:[0,1,0] neg_hi:[0,1,0]
  v_pk_fma_f32 v[106:107], v[54:55], v[88:89], v[82:83] op_sel:[0,0,0] op_sel_hi:[1,0,1] neg_lo:[0,1,0] neg_hi:[0,1,0]
  v_pk_fma_f32 v[208:209], v[208:209], v[88:89], v[104:105] op_sel:[0,1,0] op_sel_hi:[1,1,1]
  v_pk_fma_f32 v[210:211], v[210:211], v[88:89], v[106:107] op_sel:[0,1,0] op_sel_hi:[1,1,1]
  v_pk_mul_f32 v[104:105], v[208:209], v[208:209]
  v_pk_mul_f32 v[106:107], v[210:211], v[210:211]
  v_pk_fma_f32 v[104:105], v[104:105], v[96:97], v[96:97] op_sel:[0,1,0] op_sel_hi:[1,1,0]
  v_pk_fma_f32 v[106:107], v[106:107], v[96:97], v[96:97] op_sel:[0,1,0] op_sel_hi:[1,1,0]
  v_pk_mul_f32 v[104:105], v[104:105], v[208:209]
  v_pk_mul_f32 v[106:107], v[106:107], v[210:211]
  v_exp_f32 v104, v104
  v_exp_f32 v105, v105
  v_exp_f32 v106, v106
  v_exp_f32 v107, v107
  v_pk_add_f32 v[104:105], v[104:105], v[98:99] op_sel_hi:[1,0]
  v_pk_add_f32 v[106:107], v[106:107], v[98:99] op_sel_hi:[1,0]
  v_rcp_f32 v104, v104
  v_rcp_f32 v105, v105
  v_rcp_f32 v106, v106
  v_rcp_f32 v107, v107
  v_pk_mul_f32 v[208:209], v[208:209], v[104:105]
  v_pk_mul_f32 v[210:211], v[210:211], v[106:107]
  v_cvt_pk_bf16_f32 v122, v208, v209
  v_cvt_pk_bf16_f32 v123, v210, v211
  s_add_u32 s3, s10, 51200
  s_nop 0
  v_permlane16_swap_b32 v120, v122
  v_permlane16_swap_b32 v121, v123
  buffer_store_dwordx4 v[120:123], v12, s[44:47], s3 offen sc1
  v_pk_fma_f32 v[100:101], v[40:41], v[90:91], v[68:69] op_sel:[0,0,0] op_sel_hi:[1,0,1] neg_lo:[0,1,0] neg_hi:[0,1,0]
  v_pk_fma_f32 v[102:103], v[42:43], v[90:91], v[70:71] op_sel:[0,0,0] op_sel_hi:[1,0,1] neg_lo:[0,1,0] neg_hi:[0,1,0]
  v_pk_fma_f32 v[164:165], v[164:165], v[90:91], v[100:101] op_sel:[0,1,0] op_sel_hi:[1,1,1]
  v_pk_fma_f32 v[166:167], v[166:167], v[90:91], v[102:103] op_sel:[0,1,0] op_sel_hi:[1,1,1]
  v_pk_mul_f32 v[100:101], v[164:165], v[164:165]
  v_pk_mul_f32 v[102:103], v[166:167], v[166:167]
  v_pk_fma_f32 v[100:101], v[100:101], v[96:97], v[96:97] op_sel:[0,1,0] op_sel_hi:[1,1,0]
  v_pk_fma_f32 v[102:103], v[102:103], v[96:97], v[96:97] op_sel:[0,1,0] op_sel_hi:[1,1,0]
  v_pk_mul_f32 v[100:101], v[100:101], v[164:165]
  v_pk_mul_f32 v[102:103], v[102:103], v[166:167]
  v_exp_f32 v100, v100
  v_exp_f32 v101, v101
  v_exp_f32 v102, v102
  v_exp_f32 v103, v103
  v_pk_add_f32 v[100:101], v[100:101], v[98:99] op_sel_hi:[1,0]
  v_pk_add_f32 v[102:103], v[102:103], v[98:99] op_sel_hi:[1,0]
  v_rcp_f32 v100, v100
  v_rcp_f32 v101, v101
  v_rcp_f32 v102, v102
  v_rcp_f32 v103, v103
  v_pk_mul_f32 v[164:165], v[164:165], v[100:101]
  v_pk_mul_f32 v[166:167], v[166:167], v[102:103]
  v_cvt_pk_bf16_f32 v108, v164, v165
  v_cvt_pk_bf16_f32 v109, v166, v167
  v_pk_fma_f32 v[104:105], v[44:45], v[90:91], v[72:73] op_sel:[0,0,0] op_sel_hi:[1,0,1] neg_lo:[0,1,0] neg_hi:[0,1,0]
  v_pk_fma_f32 v[106:107], v[46:47], v[90:91], v[74:75] op_sel:[0,0,0] op_sel_hi:[1,0,1] neg_lo:[0,1,0] neg_hi:[0,1,0]
  v_pk_fma_f32 v[180:181], v[180:181], v[90:91], v[104:105] op_sel:[0,1,0] op_sel_hi:[1,1,1]
  v_pk_fma_f32 v[182:183], v[182:183], v[90:91], v[106:107] op_sel:[0,1,0] op_sel_hi:[1,1,1]
  v_pk_mul_f32 v[104:105], v[180:181], v[180:181]
  v_pk_mul_f32 v[106:107], v[182:183], v[182:183]
  v_pk_fma_f32 v[104:105], v[104:105], v[96:97], v[96:97] op_sel:[0,1,0] op_sel_hi:[1,1,0]
  v_pk_fma_f32 v[106:107], v[106:107], v[96:97], v[96:97] op_sel:[0,1,0] op_sel_hi:[1,1,0]
  v_pk_mul_f32 v[104:105], v[104:105], v[180:181]
  v_pk_mul_f32 v[106:107], v[106:107], v[182:183]
  v_exp_f32 v104, v104
  v_exp_f32 v105, v105
  v_exp_f32 v106, v106
  v_exp_f32 v107, v107
  v_pk_add_f32 v[104:105], v[104:105], v[98:99] op_sel_hi:[1,0]
  v_pk_add_f32 v[106:107], v[106:107], v[98:99] op_sel_hi:[1,0]
  v_rcp_f32 v104, v104
  v_rcp_f32 v105, v105
  v_rcp_f32 v106, v106
  v_rcp_f32 v107, v107
  v_pk_mul_f32 v[180:181], v[180:181], v[104:105]
  v_pk_mul_f32 v[182:183], v[182:183], v[106:107]
  v_cvt_pk_bf16_f32 v110, v180, v181
  v_cvt_pk_bf16_f32 v111, v182, v183
  s_add_u32 s3, s10, 163840
  s_nop 0
  v_permlane16_swap_b32 v108, v110
  v_permlane16_swap_b32 v109, v111
  buffer_store_dwordx4 v[108:111], v12, s[44:47], s3 offen sc1
  v_pk_fma_f32 v[100:101], v[48:49], v[90:91], v[76:77] op_sel:[0,0,0] op_sel_hi:[1,0,1] neg_lo:[0,1,0] neg_hi:[0,1,0]
  v_pk_fma_f32 v[102:103], v[50:51], v[90:91], v[78:79] op_sel:[0,0,0] op_sel_hi:[1,0,1] neg_lo:[0,1,0] neg_hi:[0,1,0]
  v_pk_fma_f32 v[196:197], v[196:197], v[90:91], v[100:101] op_sel:[0,1,0] op_sel_hi:[1,1,1]
  v_pk_fma_f32 v[198:199], v[198:199], v[90:91], v[102:103] op_sel:[0,1,0] op_sel_hi:[1,1,1]
  v_pk_mul_f32 v[100:101], v[196:197], v[196:197]
  v_pk_mul_f32 v[102:103], v[198:199], v[198:199]
  v_pk_fma_f32 v[100:101], v[100:101], v[96:97], v[96:97] op_sel:[0,1,0] op_sel_hi:[1,1,0]
  v_pk_fma_f32 v[102:103], v[102:103], v[96:97], v[96:97] op_sel:[0,1,0] op_sel_hi:[1,1,0]
  v_pk_mul_f32 v[100:101], v[100:101], v[196:197]
  v_pk_mul_f32 v[102:103], v[102:103], v[198:199]
  v_exp_f32 v100, v100
  v_exp_f32 v101, v101
  v_exp_f32 v102, v102
  v_exp_f32 v103, v103
  v_pk_add_f32 v[100:101], v[100:101], v[98:99] op_sel_hi:[1,0]
  v_pk_add_f32 v[102:103], v[102:103], v[98:99] op_sel_hi:[1,0]
  v_rcp_f32 v100, v100
  v_rcp_f32 v101, v101
  v_rcp_f32 v102, v102
  v_rcp_f32 v103, v103
  v_pk_mul_f32 v[196:197], v[196:197], v[100:101]
  v_pk_mul_f32 v[198:199], v[198:199], v[102:103]
  v_cvt_pk_bf16_f32 v112, v196, v197
  v_cvt_pk_bf16_f32 v113, v198, v199
  v_pk_fma_f32 v[104:105], v[52:53], v[90:91], v[80:81] op_sel:[0,0,0] op_sel_hi:[1,0,1] neg_lo:[0,1,0] neg_hi:[0,1,0]
  v_pk_fma_f32 v[106:107], v[54:55], v[90:91], v[82:83] op_sel:[0,0,0] op_sel_hi:[1,0,1] neg_lo:[0,1,0] neg_hi:[0,1,0]
  v_pk_fma_f32 v[212:213], v[212:213], v[90:91], v[104:105] op_sel:[0,1,0] op_sel_hi:[1,1,1]
  v_pk_fma_f32 v[214:215], v[214:215], v[90:91], v[106:107] op_sel:[0,1,0] op_sel_hi:[1,1,1]
  v_pk_mul_f32 v[104:105], v[212:213], v[212:213]
  v_pk_mul_f32 v[106:107], v[214:215], v[214:215]
  v_pk_fma_f32 v[104:105], v[104:105], v[96:97], v[96:97] op_sel:[0,1,0] op_sel_hi:[1,1,0]
  v_pk_fma_f32 v[106:107], v[106:107], v[96:97], v[96:97] op_sel:[0,1,0] op_sel_hi:[1,1,0]
  v_pk_mul_f32 v[104:105], v[104:105], v[212:213]
  v_pk_mul_f32 v[106:107], v[106:107], v[214:215]
  v_exp_f32 v104, v104
  v_exp_f32 v105, v105
  v_exp_f32 v106, v106
  v_exp_f32 v107, v107
  v_pk_add_f32 v[104:105], v[104:105], v[98:99] op_sel_hi:[1,0]
  v_pk_add_f32 v[106:107], v[106:107], v[98:99] op_sel_hi:[1,0]
  v_rcp_f32 v104, v104
  v_rcp_f32 v105, v105
  v_rcp_f32 v106, v106
  v_rcp_f32 v107, v107
  v_pk_mul_f32 v[212:213], v[212:213], v[104:105]
  v_pk_mul_f32 v[214:215], v[214:215], v[106:107]
  v_cvt_pk_bf16_f32 v114, v212, v213
  v_cvt_pk_bf16_f32 v115, v214, v215
  s_add_u32 s3, s10, 165888
  s_nop 0
  v_permlane16_swap_b32 v112, v114
  v_permlane16_swap_b32 v113, v115
  buffer_store_dwordx4 v[112:115], v12, s[44:47], s3 offen sc1
  v_pk_fma_f32 v[100:101], v[40:41], v[92:93], v[68:69] op_sel:[0,0,0] op_sel_hi:[1,0,1] neg_lo:[0,1,0] neg_hi:[0,1,0]
  v_pk_fma_f32 v[102:103], v[42:43], v[92:93], v[70:71] op_sel:[0,0,0] op_sel_hi:[1,0,1] neg_lo:[0,1,0] neg_hi:[0,1,0]
  v_pk_fma_f32 v[168:169], v[168:169], v[92:93], v[100:101] op_sel:[0,1,0] op_sel_hi:[1,1,1]
  v_pk_fma_f32 v[170:171], v[170:171], v[92:93], v[102:103] op_sel:[0,1,0] op_sel_hi:[1,1,1]
  v_pk_mul_f32 v[100:101], v[168:169], v[168:169]
  v_pk_mul_f32 v[102:103], v[170:171], v[170:171]
  v_pk_fma_f32 v[100:101], v[100:101], v[96:97], v[96:97] op_sel:[0,1,0] op_sel_hi:[1,1,0]
  v_pk_fma_f32 v[102:103], v[102:103], v[96:97], v[96:97] op_sel:[0,1,0] op_sel_hi:[1,1,0]
  v_pk_mul_f32 v[100:101], v[100:101], v[168:169]
  v_pk_mul_f32 v[102:103], v[102:103], v[170:171]
  v_exp_f32 v100, v100
  v_exp_f32 v101, v101
  v_exp_f32 v102, v102
  v_exp_f32 v103, v103
  v_pk_add_f32 v[100:101], v[100:101], v[98:99] op_sel_hi:[1,0]
  v_pk_add_f32 v[102:103], v[102:103], v[98:99] op_sel_hi:[1,0]
  v_rcp_f32 v100, v100
  v_rcp_f32 v101, v101
  v_rcp_f32 v102, v102
  v_rcp_f32 v103, v103
  v_pk_mul_f32 v[168:169], v[168:169], v[100:101]
  v_pk_mul_f32 v[170:171], v[170:171], v[102:103]
  v_cvt_pk_bf16_f32 v116, v168, v169
  v_cvt_pk_bf16_f32 v117, v170, v171
  v_pk_fma_f32 v[104:105], v[44:45], v[92:93], v[72:73] op_sel:[0,0,0] op_sel_hi:[1,0,1] neg_lo:[0,1,0] neg_hi:[0,1,0]
  v_pk_fma_f32 v[106:107], v[46:47], v[92:93], v[74:75] op_sel:[0,0,0] op_sel_hi:[1,0,1] neg_lo:[0,1,0] neg_hi:[0,1,0]
  v_pk_fma_f32 v[184:185], v[184:185], v[92:93], v[104:105] op_sel:[0,1,0] op_sel_hi:[1,1,1]
  v_pk_fma_f32 v[186:187], v[186:187], v[92:93], v[106:107] op_sel:[0,1,0] op_sel_hi:[1,1,1]
  v_pk_mul_f32 v[104:105], v[184:185], v[184:185]
  v_pk_mul_f32 v[106:107], v[186:187], v[186:187]
  v_pk_fma_f32 v[104:105], v[104:105], v[96:97], v[96:97] op_sel:[0,1,0] op_sel_hi:[1,1,0]
  v_pk_fma_f32 v[106:107], v[106:107], v[96:97], v[96:97] op_sel:[0,1,0] op_sel_hi:[1,1,0]
  v_pk_mul_f32 v[104:105], v[104:105], v[184:185]
  v_pk_mul_f32 v[106:107], v[106:107], v[186:187]
  v_exp_f32 v104, v104
  v_exp_f32 v105, v105
  v_exp_f32 v106, v106
  v_exp_f32 v107, v107
  v_pk_add_f32 v[104:105], v[104:105], v[98:99] op_sel_hi:[1,0]
  v_pk_add_f32 v[106:107], v[106:107], v[98:99] op_sel_hi:[1,0]
  v_rcp_f32 v104, v104
  v_rcp_f32 v105, v105
  v_rcp_f32 v106, v106
  v_rcp_f32 v107, v107
  v_pk_mul_f32 v[184:185], v[184:185], v[104:105]
  v_pk_mul_f32 v[186:187], v[186:187], v[106:107]
  v_cvt_pk_bf16_f32 v118, v184, v185
  v_cvt_pk_bf16_f32 v119, v186, v187
  s_add_u32 s3, s10, 278528
  s_nop 0
  v_permlane16_swap_b32 v116, v118
  v_permlane16_swap_b32 v117, v119
  buffer_store_dwordx4 v[116:119], v12, s[44:47], s3 offen sc1
  v_pk_fma_f32 v[100:101], v[48:49], v[92:93], v[76:77] op_sel:[0,0,0] op_sel_hi:[1,0,1] neg_lo:[0,1,0] neg_hi:[0,1,0]
  v_pk_fma_f32 v[102:103], v[50:51], v[92:93], v[78:79] op_sel:[0,0,0] op_sel_hi:[1,0,1] neg_lo:[0,1,0] neg_hi:[0,1,0]
  v_pk_fma_f32 v[200:201], v[200:201], v[92:93], v[100:101] op_sel:[0,1,0] op_sel_hi:[1,1,1]
  v_pk_fma_f32 v[202:203], v[202:203], v[92:93], v[102:103] op_sel:[0,1,0] op_sel_hi:[1,1,1]
  v_pk_mul_f32 v[100:101], v[200:201], v[200:201]
  v_pk_mul_f32 v[102:103], v[202:203], v[202:203]
  v_pk_fma_f32 v[100:101], v[100:101], v[96:97], v[96:97] op_sel:[0,1,0] op_sel_hi:[1,1,0]
  v_pk_fma_f32 v[102:103], v[102:103], v[96:97], v[96:97] op_sel:[0,1,0] op_sel_hi:[1,1,0]
  v_pk_mul_f32 v[100:101], v[100:101], v[200:201]
  v_pk_mul_f32 v[102:103], v[102:103], v[202:203]
  v_exp_f32 v100, v100
  v_exp_f32 v101, v101
  v_exp_f32 v102, v102
  v_exp_f32 v103, v103
  v_pk_add_f32 v[100:101], v[100:101], v[98:99] op_sel_hi:[1,0]
  v_pk_add_f32 v[102:103], v[102:103], v[98:99] op_sel_hi:[1,0]
  v_rcp_f32 v100, v100
  v_rcp_f32 v101, v101
  v_rcp_f32 v102, v102
  v_rcp_f32 v103, v103
  v_pk_mul_f32 v[200:201], v[200:201], v[100:101]
  v_pk_mul_f32 v[202:203], v[202:203], v[102:103]
  v_cvt_pk_bf16_f32 v120, v200, v201
  v_cvt_pk_bf16_f32 v121, v202, v203
  v_pk_fma_f32 v[104:105], v[52:53], v[92:93], v[80:81] op_sel:[0,0,0] op_sel_hi:[1,0,1] neg_lo:[0,1,0] neg_hi:[0,1,0]
  v_pk_fma_f32 v[106:107], v[54:55], v[92:93], v[82:83] op_sel:[0,0,0] op_sel_hi:[1,0,1] neg_lo:[0,1,0] neg_hi:[0,1,0]
  v_pk_fma_f32 v[216:217], v[216:217], v[92:93], v[104:105] op_sel:[0,1,0] op_sel_hi:[1,1,1]
  v_pk_fma_f32 v[218:219], v[218:219], v[92:93], v[106:107] op_sel:[0,1,0] op_sel_hi:[1,1,1]
  v_pk_mul_f32 v[104:105], v[216:217], v[216:217]
  v_pk_mul_f32 v[106:107], v[218:219], v[218:219]
  v_pk_fma_f32 v[104:105], v[104:105], v[96:97], v[96:97] op_sel:[0,1,0] op_sel_hi:[1,1,0]
  v_pk_fma_f32 v[106:107], v[106:107], v[96:97], v[96:97] op_sel:[0,1,0] op_sel_hi:[1,1,0]
  v_pk_mul_f32 v[104:105], v[104:105], v[216:217]
  v_pk_mul_f32 v[106:107], v[106:107], v[218:219]
  v_exp_f32 v104, v104
  v_exp_f32 v105, v105
  v_exp_f32 v106, v106
  v_exp_f32 v107, v107
  v_pk_add_f32 v[104:105], v[104:105], v[98:99] op_sel_hi:[1,0]
  v_pk_add_f32 v[106:107], v[106:107], v[98:99] op_sel_hi:[1,0]
  v_rcp_f32 v104, v104
  v_rcp_f32 v105, v105
  v_rcp_f32 v106, v106
  v_rcp_f32 v107, v107
  v_pk_mul_f32 v[216:217], v[216:217], v[104:105]
  v_pk_mul_f32 v[218:219], v[218:219], v[106:107]
  v_cvt_pk_bf16_f32 v122, v216, v217
  v_cvt_pk_bf16_f32 v123, v218, v219
  s_add_u32 s3, s10, 280576
  s_nop 0
  v_permlane16_swap_b32 v120, v122
  v_permlane16_swap_b32 v121, v123
  buffer_store_dwordx4 v[120:123], v12, s[44:47], s3 offen sc1
  v_pk_fma_f32 v[100:101], v[40:41], v[94:95], v[68:69] op_sel:[0,0,0] op_sel_hi:[1,0,1] neg_lo:[0,1,0] neg_hi:[0,1,0]
  v_pk_fma_f32 v[102:103], v[42:43], v[94:95], v[70:71] op_sel:[0,0,0] op_sel_hi:[1,0,1] neg_lo:[0,1,0] neg_hi:[0,1,0]
  v_pk_fma_f32 v[172:173], v[172:173], v[94:95], v[100:101] op_sel:[0,1,0] op_sel_hi:[1,1,1]
  v_pk_fma_f32 v[174:175], v[174:175], v[94:95], v[102:103] op_sel:[0,1,0] op_sel_hi:[1,1,1]
  v_pk_mul_f32 v[100:101], v[172:173], v[172:173]
  v_pk_mul_f32 v[102:103], v[174:175], v[174:175]
  v_pk_fma_f32 v[100:101], v[100:101], v[96:97], v[96:97] op_sel:[0,1,0] op_sel_hi:[1,1,0]
  v_pk_fma_f32 v[102:103], v[102:103], v[96:97], v[96:97] op_sel:[0,1,0] op_sel_hi:[1,1,0]
  v_pk_mul_f32 v[100:101], v[100:101], v[172:173]
  v_pk_mul_f32 v[102:103], v[102:103], v[174:175]
  v_exp_f32 v100, v100
  v_exp_f32 v101, v101
  v_exp_f32 v102, v102
  v_exp_f32 v103, v103
  v_pk_add_f32 v[100:101], v[100:101], v[98:99] op_sel_hi:[1,0]
  v_pk_add_f32 v[102:103], v[102:103], v[98:99] op_sel_hi:[1,0]
  v_rcp_f32 v100, v100
  v_rcp_f32 v101, v101
  v_rcp_f32 v102, v102
  v_rcp_f32 v103, v103
  v_pk_mul_f32 v[172:173], v[172:173], v[100:101]
  v_pk_mul_f32 v[174:175], v[174:175], v[102:103]
  v_cvt_pk_bf16_f32 v108, v172, v173
  v_cvt_pk_bf16_f32 v109, v174, v175
  v_pk_fma_f32 v[104:105], v[44:45], v[94:95], v[72:73] op_sel:[0,0,0] op_sel_hi:[1,0,1] neg_lo:[0,1,0] neg_hi:[0,1,0]
  v_pk_fma_f32 v[106:107], v[46:47], v[94:95], v[74:75] op_sel:[0,0,0] op_sel_hi:[1,0,1] neg_lo:[0,1,0] neg_hi:[0,1,0]
  v_pk_fma_f32 v[188:189], v[188:189], v[94:95], v[104:105] op_sel:[0,1,0] op_sel_hi:[1,1,1]
  v_pk_fma_f32 v[190:191], v[190:191], v[94:95], v[106:107] op_sel:[0,1,0] op_sel_hi:[1,1,1]
  v_pk_mul_f32 v[104:105], v[188:189], v[188:189]
  v_pk_mul_f32 v[106:107], v[190:191], v[190:191]
  v_pk_fma_f32 v[104:105], v[104:105], v[96:97], v[96:97] op_sel:[0,1,0] op_sel_hi:[1,1,0]
  v_pk_fma_f32 v[106:107], v[106:107], v[96:97], v[96:97] op_sel:[0,1,0] op_sel_hi:[1,1,0]
  v_pk_mul_f32 v[104:105], v[104:105], v[188:189]
  v_pk_mul_f32 v[106:107], v[106:107], v[190:191]
  v_exp_f32 v104, v104
  v_exp_f32 v105, v105
  v_exp_f32 v106, v106
  v_exp_f32 v107, v107
  v_pk_add_f32 v[104:105], v[104:105], v[98:99] op_sel_hi:[1,0]
  v_pk_add_f32 v[106:107], v[106:107], v[98:99] op_sel_hi:[1,0]
  v_rcp_f32 v104, v104
  v_rcp_f32 v105, v105
  v_rcp_f32 v106, v106
  v_rcp_f32 v107, v107
  v_pk_mul_f32 v[188:189], v[188:189], v[104:105]
  v_pk_mul_f32 v[190:191], v[190:191], v[106:107]
  v_cvt_pk_bf16_f32 v110, v188, v189
  v_cvt_pk_bf16_f32 v111, v190, v191
  s_add_u32 s3, s10, 393216
  s_nop 0
  v_permlane16_swap_b32 v108, v110
  v_permlane16_swap_b32 v109, v111
  buffer_store_dwordx4 v[108:111], v12, s[44:47], s3 offen sc1
  v_pk_fma_f32 v[100:101], v[48:49], v[94:95], v[76:77] op_sel:[0,0,0] op_sel_hi:[1,0,1] neg_lo:[0,1,0] neg_hi:[0,1,0]
  v_pk_fma_f32 v[102:103], v[50:51], v[94:95], v[78:79] op_sel:[0,0,0] op_sel_hi:[1,0,1] neg_lo:[0,1,0] neg_hi:[0,1,0]
  v_pk_fma_f32 v[204:205], v[204:205], v[94:95], v[100:101] op_sel:[0,1,0] op_sel_hi:[1,1,1]
  v_pk_fma_f32 v[206:207], v[206:207], v[94:95], v[102:103] op_sel:[0,1,0] op_sel_hi:[1,1,1]
  v_pk_mul_f32 v[100:101], v[204:205], v[204:205]
  v_pk_mul_f32 v[102:103], v[206:207], v[206:207]
  v_pk_fma_f32 v[100:101], v[100:101], v[96:97], v[96:97] op_sel:[0,1,0] op_sel_hi:[1,1,0]
  v_pk_fma_f32 v[102:103], v[102:103], v[96:97], v[96:97] op_sel:[0,1,0] op_sel_hi:[1,1,0]
  v_pk_mul_f32 v[100:101], v[100:101], v[204:205]
  v_pk_mul_f32 v[102:103], v[102:103], v[206:207]
  v_exp_f32 v100, v100
  v_exp_f32 v101, v101
  v_exp_f32 v102, v102
  v_exp_f32 v103, v103
  v_pk_add_f32 v[100:101], v[100:101], v[98:99] op_sel_hi:[1,0]
  v_pk_add_f32 v[102:103], v[102:103], v[98:99] op_sel_hi:[1,0]
  v_rcp_f32 v100, v100
  v_rcp_f32 v101, v101
  v_rcp_f32 v102, v102
  v_rcp_f32 v103, v103
  v_pk_mul_f32 v[204:205], v[204:205], v[100:101]
  v_pk_mul_f32 v[206:207], v[206:207], v[102:103]
  v_cvt_pk_bf16_f32 v112, v204, v205
  v_cvt_pk_bf16_f32 v113, v206, v207
  v_pk_fma_f32 v[104:105], v[52:53], v[94:95], v[80:81] op_sel:[0,0,0] op_sel_hi:[1,0,1] neg_lo:[0,1,0] neg_hi:[0,1,0]
  v_pk_fma_f32 v[106:107], v[54:55], v[94:95], v[82:83] op_sel:[0,0,0] op_sel_hi:[1,0,1] neg_lo:[0,1,0] neg_hi:[0,1,0]
  v_pk_fma_f32 v[220:221], v[220:221], v[94:95], v[104:105] op_sel:[0,1,0] op_sel_hi:[1,1,1]
  v_pk_fma_f32 v[222:223], v[222:223], v[94:95], v[106:107] op_sel:[0,1,0] op_sel_hi:[1,1,1]
  v_pk_mul_f32 v[104:105], v[220:221], v[220:221]
  v_pk_mul_f32 v[106:107], v[222:223], v[222:223]
  v_pk_fma_f32 v[104:105], v[104:105], v[96:97], v[96:97] op_sel:[0,1,0] op_sel_hi:[1,1,0]
  v_pk_fma_f32 v[106:107], v[106:107], v[96:97], v[96:97] op_sel:[0,1,0] op_sel_hi:[1,1,0]
  v_pk_mul_f32 v[104:105], v[104:105], v[220:221]
  v_pk_mul_f32 v[106:107], v[106:107], v[222:223]
  v_exp_f32 v104, v104
  v_exp_f32 v105, v105
  v_exp_f32 v106, v106
  v_exp_f32 v107, v107
  v_pk_add_f32 v[104:105], v[104:105], v[98:99] op_sel_hi:[1,0]
  v_pk_add_f32 v[106:107], v[106:107], v[98:99] op_sel_hi:[1,0]
  v_rcp_f32 v104, v104
  v_rcp_f32 v105, v105
  v_rcp_f32 v106, v106
  v_rcp_f32 v107, v107
  v_pk_mul_f32 v[220:221], v[220:221], v[104:105]
  v_pk_mul_f32 v[222:223], v[222:223], v[106:107]
  v_cvt_pk_bf16_f32 v114, v220, v221
  v_cvt_pk_bf16_f32 v115, v222, v223
  s_add_u32 s3, s10, 395264
  s_nop 0
  v_permlane16_swap_b32 v112, v114
  v_permlane16_swap_b32 v113, v115
  buffer_store_dwordx4 v[112:115], v12, s[44:47], s3 offen sc1
  s_waitcnt vmcnt(0) lgkmcnt(0)
  s_barrier
  s_add_u32 s97, s97, 1
  s_branch L_w2_body
L_w1_c1:
L_w2_c0:
L_w2_body:
  s_cmp_ge_u32 s2, 256
  s_cbranch_scc1 L_w2_end
  v_lshrrev_b32 v2, 6, v0
  v_and_b32 v1, 63, v0
  v_readfirstlane_b32 s70, v2
  s_and_b32 s3, s2, 7
  s_lshr_b32 s99, s2, 3
  s_and_b32 s5, s3, 3
  s_lshl_b32 s5, s5, 2
  s_and_b32 s6, s99, 3
  s_add_u32 s68, s5, s6
  s_lshr_b32 s5, s3, 2
  s_lshr_b32 s78, s99, 2
  s_lshl1_add_u32 s69, s78, s5
  s_add_u32 s3, s68, s78
  s_lshl_b32 s3, s3, 3
  s_lshl_b32 s85, 0xffff02, s3
  s_sub_u32 s3, 0, s3
  s_lshr_b32 s3, 0xffff02, s3
  s_or_b32 s85, s85, s3
  s_cmp_lt_u32 s70, 4
  s_cbranch_scc1 L_w2_compute
L_w2_loader:
  v_and_b32 v2, 3, v1
  v_lshlrev_b32 v2, 3, v2
  v_bfe_i32 v16, s85, v2, 8
  s_and_b32 s3, s68, 3
  s_mul_i32 s4, s3, 4
  v_add3_u32 v3, v16, v1, s4
  v_subrev_u32 v3, 20, v3
  v_and_b32 v3, 15, v3
  v_add3_u32 v16, v16, v1, 20
  s_mul_i32 s3, s3, 1
  s_bitcmp1_b32 s69, 0
  s_cselect_b32 s4, 20, 0
  v_subrev_u32 v2, 20, v16
  v_min_u32 v16, v16, v2
  v_subrev_u32 v2, 20, v16
  v_min_u32 v16, v16, v2
  v_cmp_gt_u32 vcc, 4, v16
  v_add_u32 v2, s3, v16
  v_subrev_u32 v17, 4, v2
  v_min_u32 v2, v17, v2
  v_cndmask_b32 v16, v16, v2, vcc
  v_cmp_gt_u32 vcc, 20, v1
  v_add_u32 v16, s4, v16
  v_add_u32 v3, 40, v3
  v_cndmask_b32 v3, v3, v16, vcc
  v_lshlrev_b32 v16, 17, v3
  s_add_u32 s9, s70, s68
  s_and_b32 s9, s9, 3
  s_lshl_b32 s77, s9, 11
  v_and_b32 v10, 7, v1
  v_lshrrev_b32 v3, 3, v1
  s_lshl_b32 s10, s9, 4
  v_add_u32 v3, s10, v3
  v_mul_u32_u24 v3, 2048, v3
  v_lshrrev_b32 v2, 3, v1
  v_and_b32 v2, 2, v2
  v_xor_b32 v2, v2, v10
  s_lshl_b32 s10, s69, 7
  v_add_u32 v3, s10, v3
  v_lshl_add_u32 v8, v2, 4, v3
  v_xor_b32 v2, 4, v2
  v_add_u32 v3, 16384, v3
  v_lshl_add_u32 v9, v2, 4, v3
  s_mov_b32 s40, s28
  s_and_b32 s41, s29, 0xffff
  s_mov_b32 s42, 7340032
  s_mov_b32 s43, 0x00020000
  s_bitcmp1_b32 s69, 0
  s_mov_b32 s76, 128
  s_cselect_b32 s76, -128, s76
  v_readlane_b32 s74, v16, 0
  s_add_u32 m0, s77, 0
  s_add_u32 s4, s74, s76
  buffer_load_dwordx4 v8, s[40:43], s4 offen lds
  s_add_u32 m0, s77, 1024
  s_nop 0
  buffer_load_dwordx4 v9, s[40:43], s4 offen lds
  s_add_u32 m0, s77, 8192
  s_add_u32 s4, s74, 0
  buffer_load_dwordx4 v8, s[40:43], s4 offen lds
  s_add_u32 m0, s77, 9216
  s_nop 0
  buffer_load_dwordx4 v9, s[40:43], s4 offen lds
  v_readlane_b32 s74, v16, 1
  s_add_u32 m0, s77, 16384
  s_add_u32 s4, s74, s76
  buffer_load_dwordx4 v8, s[40:43], s4 offen lds
  s_add_u32 m0, s77, 17408
  s_nop 0
  buffer_load_dwordx4 v9, s[40:43], s4 offen lds
  s_add_u32 m0, s77, 24576
  s_add_u32 s4, s74, 0
  buffer_load_dwordx4 v8, s[40:43], s4 offen lds
  s_add_u32 m0, s77, 25600
  s_nop 0
  buffer_load_dwordx4 v9, s[40:43], s4 offen lds
  v_readlane_b32 s74, v16, 2
  s_add_u32 m0, s77, 32768
  s_add_u32 s4, s74, s76
  buffer_load_dwordx4 v8, s[40:43], s4 offen lds
  s_add_u32 m0, s77, 33792
  s_nop 0
  buffer_load_dwordx4 v9, s[40:43], s4 offen lds
  s_add_u32 m0, s77, 40960
  s_add_u32 s4, s74, 0
  buffer_load_dwordx4 v8, s[40:43], s4 offen lds
  s_add_u32 m0, s77, 41984
  s_nop 0
  buffer_load_dwordx4 v9, s[40:43], s4 offen lds
  v_readlane_b32 s74, v16, 3
  s_add_u32 m0, s77, 49152
  s_add_u32 s4, s74, s76
  buffer_load_dwordx4 v8, s[40:43], s4 offen lds
  s_add_u32 m0, s77, 50176
  s_nop 0
  buffer_load_dwordx4 v9, s[40:43], s4 offen lds
  s_add_u32 m0, s77, 57344
  s_add_u32 s4, s74, 0
  buffer_load_dwordx4 v8, s[40:43], s4 offen lds
  s_add_u32 m0, s77, 58368
  s_nop 0
  buffer_load_dwordx4 v9, s[40:43], s4 offen lds
  v_readlane_b32 s74, v16, 4
  s_add_u32 m0, s77, 65536
  s_add_u32 s4, s74, s76
  buffer_load_dwordx4 v8, s[40:43], s4 offen lds
  s_add_u32 m0, s77, 66560
  s_nop 0
  buffer_load_dwordx4 v9, s[40:43], s4 offen lds
  s_add_u32 m0, s77, 73728
  s_add_u32 s4, s74, 0
  buffer_load_dwordx4 v8, s[40:43], s4 offen lds
  s_add_u32 m0, s77, 74752
  s_nop 0
  buffer_load_dwordx4 v9, s[40:43], s4 offen lds
  s_add_u32 s44, s22, 41943040
  s_addc_u32 s45, s23, 0
  s_and_b32 s45, s45, 0xffff
  s_mov_b32 s46, 524288
  s_mov_b32 s47, 0x00020000
  s_lshl4_add_u32 s3, s97, s68
  s_and_b32 s4, s69, 15
  s_lshl4_add_u32 s3, s3, s4
  s_lshl_b32 s3, s3, 7
  s_sub_u32 s3, s3, 32768
  v_lshlrev_b32 v11, 7, v1
  v_and_b32 v2, 15, v1
  v_lshlrev_b32 v2, 2, v2
  v_mov_b32 v3, 1
  s_mov_b32 s79, 0x100000
  s_cmp_lg_u32 s70, 4
  s_barrier
  s_cbranch_scc1 L_w2_nofl
  s_mov_b32 exec_lo, 0xffff
  s_mov_b32 exec_hi, 0
  buffer_store_dword v3, v11, s[44:47], s87 offen sc1
  s_mov_b64 exec, -1
L_w2_nofl:
  s_mov_b32 s5, s3
  v_readlane_b32 s74, v16, 5
  s_add_u32 m0, s77, 81920
  s_add_u32 s4, s74, s76
  buffer_load_dwordx4 v8, s[40:43], s4 offen lds
  s_add_u32 m0, s77, 82944
  s_nop 0
  buffer_load_dwordx4 v9, s[40:43], s4 offen lds
  s_add_u32 m0, s77, 90112
  s_add_u32 s4, s74, 0
  buffer_load_dwordx4 v8, s[40:43], s4 offen lds
  s_add_u32 m0, s77, 91136
  s_nop 0
  buffer_load_dwordx4 v9, s[40:43], s4 offen lds
  v_readlane_b32 s74, v16, 6
  s_add_u32 m0, s77, 98304
  s_add_u32 s4, s74, s76
  buffer_load_dwordx4 v8, s[40:43], s4 offen lds
  s_add_u32 m0, s77, 99328
  s_nop 0
  buffer_load_dwordx4 v9, s[40:43], s4 offen lds
  s_add_u32 m0, s77, 106496
  s_add_u32 s4, s74, 0
  buffer_load_dwordx4 v8, s[40:43], s4 offen lds
  s_add_u32 m0, s77, 107520
  s_nop 0
  buffer_load_dwordx4 v9, s[40:43], s4 offen lds
  v_readlane_b32 s74, v16, 7
  s_add_u32 m0, s77, 114688
  s_add_u32 s4, s74, s76
  buffer_load_dwordx4 v8, s[40:43], s4 offen lds
  s_add_u32 m0, s77, 115712
  s_nop 0
  buffer_load_dwordx4 v9, s[40:43], s4 offen lds
  s_add_u32 m0, s77, 122880
  s_add_u32 s4, s74, 0
  buffer_load_dwordx4 v8, s[40:43], s4 offen lds
  s_add_u32 m0, s77, 123904
  s_nop 0
  buffer_load_dwordx4 v9, s[40:43], s4 offen lds
  v_readlane_b32 s74, v16, 8
  s_add_u32 m0, s77, 131072
  s_add_u32 s4, s74, s76
  buffer_load_dwordx4 v8, s[40:43], s4 offen lds
  s_add_u32 m0, s77, 132096
  s_nop 0
  buffer_load_dwordx4 v9, s[40:43], s4 offen lds
  s_add_u32 m0, s77, 139264
  s_add_u32 s4, s74, 0
  buffer_load_dwordx4 v8, s[40:43], s4 offen lds
  s_add_u32 m0, s77, 140288
  s_nop 0
  buffer_load_dwordx4 v9, s[40:43], s4 offen lds
  v_readlane_b32 s74, v16, 9
  s_add_u32 m0, s77, 147456
  s_add_u32 s4, s74, s76
  buffer_load_dwordx4 v8, s[40:43], s4 offen lds
  s_add_u32 m0, s77, 148480
  s_nop 0
  buffer_load_dwordx4 v9, s[40:43], s4 offen lds
  s_add_u32 m0, s77, 155648
  s_add_u32 s4, s74, 0
  buffer_load_dwordx4 v8, s[40:43], s4 offen lds
  s_add_u32 m0, s77, 156672
  s_nop 0
  buffer_load_dwordx4 v9, s[40:43], s4 offen lds
  s_mov_b32 s3, s5
  s_cmp_lg_u32 s70, 4
  s_cbranch_scc1 L_w2_dep
L_w2_poll:
  buffer_load_dword v3, v2, s[44:47], s3 offen sc1
  s_sub_u32 s79, s79, 1
  s_cbranch_scc1 L_w2_dep
  s_waitcnt vmcnt(0)
  v_cmp_ne_u32 vcc, 1, v3
  s_cbranch_vccnz L_w2_poll
L_w2_dep:
  s_waitcnt vmcnt(30) lgkmcnt(0)
  s_barrier
  s_waitcnt vmcnt(22)
  s_barrier
  v_readlane_b32 s74, v16, 10
  s_add_u32 m0, s77, 0
  s_add_u32 s4, s74, s76
  buffer_load_dwordx4 v8, s[40:43], s4 offen lds
  s_add_u32 m0, s77, 1024
  s_nop 0
  buffer_load_dwordx4 v9, s[40:43], s4 offen lds
  s_waitcnt vmcnt(4)
  s_add_u32 m0, s77, 8192
  s_add_u32 s4, s74, 0
  buffer_load_dwordx4 v8, s[40:43], s4 offen lds
  s_add_u32 m0, s77, 9216
  s_nop 0
  buffer_load_dwordx4 v9, s[40:43], s4 offen lds
  s_waitcnt vmcnt(4)
  v_readlane_b32 s74, v16, 11
  s_add_u32 m0, s77, 16384
  s_add_u32 s4, s74, s76
  buffer_load_dwordx4 v8, s[40:43], s4 offen lds
  s_add_u32 m0, s77, 17408
  s_nop 0
  buffer_load_dwordx4 v9, s[40:43], s4 offen lds
  s_waitcnt vmcnt(4)
  s_add_u32 m0, s77, 24576
  s_add_u32 s4, s74, 0
  buffer_load_dwordx4 v8, s[40:43], s4 offen lds
  s_add_u32 m0, s77, 25600
  s_nop 0
  buffer_load_dwordx4 v9, s[40:43], s4 offen lds
  s_waitcnt vmcnt(22)
  s_barrier
  v_readlane_b32 s74, v16, 12
  s_add_u32 m0, s77, 32768
  s_add_u32 s4, s74, s76
  buffer_load_dwordx4 v8, s[40:43], s4 offen lds
  s_add_u32 m0, s77, 33792
  s_nop 0
  buffer_load_dwordx4 v9, s[40:43], s4 offen lds
  s_waitcnt vmcnt(4)
  s_add_u32 m0, s77, 40960
  s_add_u32 s4, s74, 0
  buffer_load_dwordx4 v8, s[40:43], s4 offen lds
  s_add_u32 m0, s77, 41984
  s_nop 0
  buffer_load_dwordx4 v9, s[40:43], s4 offen lds
  s_waitcnt vmcnt(4)
  v_readlane_b32 s74, v16, 13
  s_add_u32 m0, s77, 49152
  s_add_u32 s4, s74, s76
  buffer_load_dwordx4 v8, s[40:43], s4 offen lds
  s_add_u32 m0, s77, 50176
  s_nop 0
  buffer_load_dwordx4 v9, s[40:43], s4 offen lds
  s_waitcnt vmcnt(4)
  s_add_u32 m0, s77, 57344
  s_add_u32 s4, s74, 0
  buffer_load_dwordx4 v8, s[40:43], s4 offen lds
  s_add_u32 m0, s77, 58368
  s_nop 0
  buffer_load_dwordx4 v9, s[40:43], s4 offen lds
  s_waitcnt vmcnt(22)
  s_barrier
  v_readlane_b32 s74, v16, 14
  s_add_u32 m0, s77, 65536
  s_add_u32 s4, s74, s76
  buffer_load_dwordx4 v8, s[40:43], s4 offen lds
  s_add_u32 m0, s77, 66560
  s_nop 0
  buffer_load_dwordx4 v9, s[40:43], s4 offen lds
  s_waitcnt vmcnt(4)
  s_add_u32 m0, s77, 73728
  s_add_u32 s4, s74, 0
  buffer_load_dwordx4 v8, s[40:43], s4 offen lds
  s_add_u32 m0, s77, 74752
  s_nop 0
  buffer_load_dwordx4 v9, s[40:43], s4 offen lds
  s_waitcnt vmcnt(4)
  v_readlane_b32 s74, v16, 15
  s_add_u32 m0, s77, 81920
  s_add_u32 s4, s74, s76
  buffer_load_dwordx4 v8, s[40:43], s4 offen lds
  s_add_u32 m0, s77, 82944
  s_nop 0
  buffer_load_dwordx4 v9, s[40:43], s4 offen lds
  s_waitcnt vmcnt(4)
  s_add_u32 m0, s77, 90112
  s_add_u32 s4, s74, 0
  buffer_load_dwordx4 v8, s[40:43], s4 offen lds
  s_add_u32 m0, s77, 91136
  s_nop 0
  buffer_load_dwordx4 v9, s[40:43], s4 offen lds
  s_waitcnt vmcnt(22)
  s_barrier
  v_readlane_b32 s74, v16, 16
  s_add_u32 m0, s77, 98304
  s_add_u32 s4, s74, s76
  buffer_load_dwordx4 v8, s[40:43], s4 offen lds
  s_add_u32 m0, s77, 99328
  s_nop 0
  buffer_load_dwordx4 v9, s[40:43], s4 offen lds
  s_waitcnt vmcnt(4)
  s_add_u32 m0, s77, 106496
  s_add_u32 s4, s74, 0
  buffer_load_dwordx4 v8, s[40:43], s4 offen lds
  s_add_u32 m0, s77, 107520
  s_nop 0
  buffer_load_dwordx4 v9, s[40:43], s4 offen lds
  s_waitcnt vmcnt(4)
  v_readlane_b32 s74, v16, 17
  s_add_u32 m0, s77, 114688
  s_add_u32 s4, s74, s76
  buffer_load_dwordx4 v8, s[40:43], s4 offen lds
  s_add_u32 m0, s77, 115712
  s_nop 0
  buffer_load_dwordx4 v9, s[40:43], s4 offen lds
  s_waitcnt vmcnt(4)
  s_add_u32 m0, s77, 122880
  s_add_u32 s4, s74, 0
  buffer_load_dwordx4 v8, s[40:43], s4 offen lds
  s_add_u32 m0, s77, 123904
  s_nop 0
  buffer_load_dwordx4 v9, s[40:43], s4 offen lds
  s_waitcnt vmcnt(22)
  s_barrier
  v_readlane_b32 s74, v16, 18
  s_add_u32 m0, s77, 131072
  s_add_u32 s4, s74, s76
  buffer_load_dwordx4 v8, s[40:43], s4 offen lds
  s_add_u32 m0, s77, 132096
  s_nop 0
  buffer_load_dwordx4 v9, s[40:43], s4 offen lds
  s_waitcnt vmcnt(4)
  s_add_u32 m0, s77, 139264
  s_add_u32 s4, s74, 0
  buffer_load_dwordx4 v8, s[40:43], s4 offen lds
  s_add_u32 m0, s77, 140288
  s_nop 0
  buffer_load_dwordx4 v9, s[40:43], s4 offen lds
  s_waitcnt vmcnt(4)
  v_readlane_b32 s74, v16, 19
  s_add_u32 m0, s77, 147456
  s_add_u32 s4, s74, s76
  buffer_load_dwordx4 v8, s[40:43], s4 offen lds
  s_add_u32 m0, s77, 148480
  s_nop 0
  buffer_load_dwordx4 v9, s[40:43], s4 offen lds
  s_waitcnt vmcnt(4)
  s_add_u32 m0, s77, 155648
  s_add_u32 s4, s74, 0
  buffer_load_dwordx4 v8, s[40:43], s4 offen lds
  s_add_u32 m0, s77, 156672
  s_nop 0
  buffer_load_dwordx4 v9, s[40:43], s4 offen lds
  s_waitcnt vmcnt(22)
  s_barrier
  v_readlane_b32 s74, v16, 20
  s_add_u32 m0, s77, 0
  s_add_u32 s4, s74, 0
  buffer_load_dwordx4 v8, s[40:43], s4 offen lds
  s_add_u32 m0, s77, 1024
  s_nop 0
  buffer_load_dwordx4 v9, s[40:43], s4 offen lds
  s_waitcnt vmcnt(4)
  v_readlane_b32 s74, v16, 21
  s_add_u32 m0, s77, 8192
  s_add_u32 s4, s74, 0
  buffer_load_dwordx4 v8, s[40:43], s4 offen lds
  s_add_u32 m0, s77, 9216
  s_nop 0
  buffer_load_dwordx4 v9, s[40:43], s4 offen lds
  s_waitcnt vmcnt(4)
  v_readlane_b32 s74, v16, 22
  s_add_u32 m0, s77, 16384
  s_add_u32 s4, s74, 0
  buffer_load_dwordx4 v8, s[40:43], s4 offen lds
  s_add_u32 m0, s77, 17408
  s_nop 0
  buffer_load_dwordx4 v9, s[40:43], s4 offen lds
  s_waitcnt vmcnt(4)
  v_readlane_b32 s74, v16, 23
  s_add_u32 m0, s77, 24576
  s_add_u32 s4, s74, 0
  buffer_load_dwordx4 v8, s[40:43], s4 offen lds
  s_add_u32 m0, s77, 25600
  s_nop 0
  buffer_load_dwordx4 v9, s[40:43], s4 offen lds
  s_waitcnt vmcnt(22)
  s_barrier
  v_readlane_b32 s74, v16, 24
  s_add_u32 m0, s77, 32768
  s_add_u32 s4, s74, 0
  buffer_load_dwordx4 v8, s[40:43], s4 offen lds
  s_add_u32 m0, s77, 33792
  s_nop 0
  buffer_load_dwordx4 v9, s[40:43], s4 offen lds
  s_waitcnt vmcnt(4)
  v_readlane_b32 s74, v16, 25
  s_add_u32 m0, s77, 40960
  s_add_u32 s4, s74, 0
  buffer_load_dwordx4 v8, s[40:43], s4 offen lds
  s_add_u32 m0, s77, 41984
  s_nop 0
  buffer_load_dwordx4 v9, s[40:43], s4 offen lds
  s_waitcnt vmcnt(4)
  v_readlane_b32 s74, v16, 26
  s_add_u32 m0, s77, 49152
  s_add_u32 s4, s74, 0
  buffer_load_dwordx4 v8, s[40:43], s4 offen lds
  s_add_u32 m0, s77, 50176
  s_nop 0
  buffer_load_dwordx4 v9, s[40:43], s4 offen lds
  s_waitcnt vmcnt(4)
  v_readlane_b32 s74, v16, 27
  s_add_u32 m0, s77, 57344
  s_add_u32 s4, s74, 0
  buffer_load_dwordx4 v8, s[40:43], s4 offen lds
  s_add_u32 m0, s77, 58368
  s_nop 0
  buffer_load_dwordx4 v9, s[40:43], s4 offen lds
  s_waitcnt vmcnt(22)
  s_barrier
  v_readlane_b32 s74, v16, 28
  s_add_u32 m0, s77, 65536
  s_add_u32 s4, s74, 0
  buffer_load_dwordx4 v8, s[40:43], s4 offen lds
  s_add_u32 m0, s77, 66560
  s_nop 0
  buffer_load_dwordx4 v9, s[40:43], s4 offen lds
  s_waitcnt vmcnt(4)
  v_readlane_b32 s74, v16, 29
  s_add_u32 m0, s77, 73728
  s_add_u32 s4, s74, 0
  buffer_load_dwordx4 v8, s[40:43], s4 offen lds
  s_add_u32 m0, s77, 74752
  s_nop 0
  buffer_load_dwordx4 v9, s[40:43], s4 offen lds
  s_waitcnt vmcnt(4)
  v_readlane_b32 s74, v16, 30
  s_add_u32 m0, s77, 81920
  s_add_u32 s4, s74, 0
  buffer_load_dwordx4 v8, s[40:43], s4 offen lds
  s_add_u32 m0, s77, 82944
  s_nop 0
  buffer_load_dwordx4 v9, s[40:43], s4 offen lds
  s_waitcnt vmcnt(4)
  v_readlane_b32 s74, v16, 31
  s_add_u32 m0, s77, 90112
  s_add_u32 s4, s74, 0
  buffer_load_dwordx4 v8, s[40:43], s4 offen lds
  s_add_u32 m0, s77, 91136
  s_nop 0
  buffer_load_dwordx4 v9, s[40:43], s4 offen lds
  s_waitcnt vmcnt(22)
  s_barrier
  v_readlane_b32 s74, v16, 32
  s_add_u32 m0, s77, 98304
  s_add_u32 s4, s74, 0
  buffer_load_dwordx4 v8, s[40:43], s4 offen lds
  s_add_u32 m0, s77, 99328
  s_nop 0
  buffer_load_dwordx4 v9, s[40:43], s4 offen lds
  s_waitcnt vmcnt(4)
  v_readlane_b32 s74, v16, 33
  s_add_u32 m0, s77, 106496
  s_add_u32 s4, s74, 0
  buffer_load_dwordx4 v8, s[40:43], s4 offen lds
  s_add_u32 m0, s77, 107520
  s_nop 0
  buffer_load_dwordx4 v9, s[40:43], s4 offen lds
  s_waitcnt vmcnt(4)
  v_readlane_b32 s74, v16, 34
  s_add_u32 m0, s77, 114688
  s_add_u32 s4, s74, 0
  buffer_load_dwordx4 v8, s[40:43], s4 offen lds
  s_add_u32 m0, s77, 115712
  s_nop 0
  buffer_load_dwordx4 v9, s[40:43], s4 offen lds
  s_waitcnt vmcnt(4)
  v_readlane_b32 s74, v16, 35
  s_add_u32 m0, s77, 122880
  s_add_u32 s4, s74, 0
  buffer_load_dwordx4 v8, s[40:43], s4 offen lds
  s_add_u32 m0, s77, 123904
  s_nop 0
  buffer_load_dwordx4 v9, s[40:43], s4 offen lds
  s_add_u32 s60, s34, 25165824
  s_addc_u32 s61, s35, 0
  s_and_b32 s61, s61, 0xffff
  s_mov_b32 s62, 8388608
  s_mov_b32 s63, 0x00020000
  s_add_u32 s64, s22, 41943040
  s_addc_u32 s65, s23, 0
  s_and_b32 s65, s65, 0xffff
  s_mov_b32 s66, 524288
  s_mov_b32 s67, 0x00020000
  s_and_b32 s5, s70, 3
  s_lshl4_add_u32 s6, s68, s69
  s_lshl2_add_u32 s6, s6, s5
  s_mul_i32 s8, s6, 4096
  s_add_u32 s9, s8, 4096
  s_add_u32 s7, s96, 4
  s_lshl_b32 s7, s7, 10
  s_add_u32 s6, s6, s7
  s_lshl_b32 s6, s6, 6
  s_xor_b32 s7, s6, 256
  s_mul_i32 s5, s5, 4096
  s_add_u32 s5, s5, 131072
  v_lshlrev_b32 v3, 4, v1
  v_add_u32 v2, s5, v3
  v_mov_b32 v4, 1
  s_mov_b32 s79, 0x100000
  s_waitcnt vmcnt(26)
  s_barrier
  s_waitcnt vmcnt(0) lgkmcnt(0)
  s_barrier
  ds_read_b128 v[32:35], v2 offset:0
  ds_read_b128 v[36:39], v2 offset:1024
  ds_read_b128 v[40:43], v2 offset:2048
  ds_read_b128 v[44:47], v2 offset:3072
  s_waitcnt lgkmcnt(3)
  buffer_store_dwordx4 v[32:35], v3, s[60:63], s8 offen offset:0 sc1
  s_waitcnt lgkmcnt(2)
  buffer_store_dwordx4 v[36:39], v3, s[60:63], s8 offen offset:1024 sc1
  s_waitcnt lgkmcnt(1)
  buffer_store_dwordx4 v[40:43], v3, s[60:63], s8 offen offset:2048 sc1
  s_waitcnt lgkmcnt(0)
  buffer_store_dwordx4 v[44:47], v3, s[60:63], s8 offen offset:3072 sc1
  s_xor_b32 s8, s8, 16384
  s_xor_b32 s9, s9, 16384
  s_mov_b64 exec, 1
  s_waitcnt vmcnt(0)
  buffer_store_dword v4, off, s[64:67], s6 sc1
L_w2_xpoll:
  buffer_load_dword v5, off, s[64:67], s7 sc1
  s_sub_u32 s79, s79, 1
  s_cbranch_scc1 L_w2_xgo
  s_waitcnt vmcnt(0)
  v_cmp_ne_u32 vcc, 1, v5
  s_cbranch_vccnz L_w2_xpoll
L_w2_xgo:
  s_mov_b64 exec, -1
  s_mov_b32 m0, s5
  s_nop 0
  buffer_load_dwordx4 v3, s[60:63], s8 offen offset:0 lds
  buffer_load_dwordx4 v3, s[60:63], s8 offen offset:1024 lds
  buffer_load_dwordx4 v3, s[60:63], s8 offen offset:2048 lds
  buffer_load_dwordx4 v3, s[60:63], s8 offen offset:3072 lds
  s_waitcnt vmcnt(0)
  s_barrier
  s_cmp_eq_u32 s96, 1
  s_cbranch_scc1 L_w2_end
  s_lshl_b32 s87, s97, 15
  s_lshl_b32 s4, s68, 11
  s_add_u32 s87, s87, s4
  s_lshl_b32 s4, s69, 2
  s_add_u32 s87, s87, s4
  s_mov_b32 s96, 1
  s_add_u32 s12, s22, 33554432
  s_addc_u32 s13, s23, 0
  s_add_u32 s34, s22, 67108864
  s_addc_u32 s35, s23, 0
  s_add_u32 s97, s97, 1
  s_branch L_attn_body
L_w2_end:
  s_endpgm
L_w2_compute:
  v_and_b32 v2, 3, v1
  v_lshlrev_b32 v2, 3, v2
  v_bfe_i32 v15, s85, v2, 8
  s_and_b32 s3, s68, 3
  s_mul_i32 s4, s3, 4
  v_add3_u32 v3, v15, v1, s4
  v_subrev_u32 v3, 20, v3
  v_and_b32 v3, 15, v3
  v_add3_u32 v15, v15, v1, 20
  s_mul_i32 s3, s3, 1
  s_bitcmp1_b32 s69, 0
  s_cselect_b32 s4, 20, 0
  v_subrev_u32 v2, 20, v15
  v_min_u32 v15, v15, v2
  v_subrev_u32 v2, 20, v15
  v_min_u32 v15, v15, v2
  v_cmp_gt_u32 vcc, 4, v15
  v_add_u32 v2, s3, v15
  v_subrev_u32 v16, 4, v2
  v_min_u32 v2, v16, v2
  v_cndmask_b32 v15, v15, v2, vcc
  v_cmp_gt_u32 vcc, 20, v1
  v_add_u32 v15, s4, v15
  v_add_u32 v3, 40, v3
  v_cndmask_b32 v3, v3, v15, vcc
  v_lshlrev_b32 v15, 11, v3
  v_and_b32 v3, 15, v1
  v_lshrrev_b32 v2, 4, v1
  s_lshl_b32 s8, s68, 7
  s_lshl_b32 s9, s70, 5
  s_add_u32 s8, s8, s9
  s_mul_i32 s9, s8, 7168
  v_lshl_add_u32 v4, v1, 4, s9
  v_add_u32 v5, 114688, v4
  v_add_u32 v13, s8, v3
  s_lshl_b32 s10, s69, 7
  v_lshl_add_u32 v14, v2, 3, s10
  v_and_b32 v16, 1, v2
  v_lshrrev_b32 v17, 1, v2
  v_lshlrev_b32 v16, 5, v16
  v_lshl_add_u32 v16, v17, 4, v16
  v_add_u32 v16, s10, v16
  s_cmp_eq_u32 s96, 0
  s_cselect_b32 s7, 128, 0
  s_add_u32 s7, s7, 2048
  v_mad_u32_u24 v12, v13, s7, v16
  v_lshl_add_u32 v18, v17, 4, v13
  v_lshlrev_b32 v18, 3, v18
  v_and_b32 v16, 1, v2
  v_lshl_add_u32 v18, v16, 2, v18
  s_lshl_b32 s10, s69, 14
  v_add_u32 v18, s10, v18
  v_bfe_u32 v6, v1, 2, 2
  v_lshl_add_u32 v6, v2, 3, v6
  v_lshlrev_b32 v6, 7, v6
  v_and_b32 v17, 3, v1
  v_lshl_add_u32 v6, v17, 3, v6
  v_bfe_u32 v17, v1, 3, 2
  v_lshl_add_u32 v6, v17, 5, v6
  v_xor_b32 v7, 32, v6
  v_xor_b32 v8, 64, v6
  v_xor_b32 v9, 96, v6
  s_mov_b32 s11, 0xffff0000
  s_mov_b32 s52, s30
  s_and_b32 s53, s31, 0xffff
  s_mov_b32 s54, 2048
  s_mov_b32 s55, 0x00020000
  buffer_load_dwordx2 v[192:193], v14, s[52:55], 0 offen offset:0
  buffer_load_dwordx2 v[194:195], v14, s[52:55], 0 offen offset:32
  buffer_load_dwordx2 v[196:197], v14, s[52:55], 0 offen offset:64
  buffer_load_dwordx2 v[198:199], v14, s[52:55], 0 offen offset:96
  s_add_u32 s36, s34, 8388608
  s_addc_u32 s37, s35, 0
  s_and_b32 s37, s37, 0xffff
  s_mov_b32 s38, 14680064
  s_mov_b32 s39, 0x00020000
  s_mov_b32 s44, s32
  s_and_b32 s45, s33, 0xffff
  s_mov_b32 s46, 4194304
  s_mov_b32 s47, 0x00020000
  s_add_u32 s48, s22, 33554432
  s_addc_u32 s49, s23, 0
  s_and_b32 s49, s49, 0xffff
  s_mov_b32 s50, 4194304
  s_mov_b32 s51, 0x00020000
  s_cmp_eq_u32 s96, 0
  s_cselect_b64 s[44:45], s[48:49], s[44:45]
  s_lshl_b32 s46, s7, 11
  s_add_u32 s56, s34, 24379392
  s_addc_u32 s57, s35, 0
  s_and_b32 s57, s57, 0xffff
  s_mov_b32 s58, 262144
  s_mov_b32 s59, 0x00020000
  s_mul_i32 s3, s70, 4096
  s_add_u32 s3, s3, 131072
  v_lshl_add_u32 v19, v1, 4, s3
  v_mov_b32 v128, 0
  v_mov_b32 v129, 0
  v_mov_b32 v130, 0
  v_mov_b32 v131, 0
  v_mov_b32 v132, 0
  v_mov_b32 v133, 0
  v_mov_b32 v134, 0
  v_mov_b32 v135, 0
  v_mov_b32 v136, 0
  v_mov_b32 v137, 0
  v_mov_b32 v138, 0
  v_mov_b32 v139, 0
  v_mov_b32 v140, 0
  v_mov_b32 v141, 0
  v_mov_b32 v142, 0
  v_mov_b32 v143, 0
  v_mov_b32 v144, 0
  v_mov_b32 v145, 0
  v_mov_b32 v146, 0
  v_mov_b32 v147, 0
  v_mov_b32 v148, 0
  v_mov_b32 v149, 0
  v_mov_b32 v150, 0
  v_mov_b32 v151, 0
  v_mov_b32 v152, 0
  v_mov_b32 v153, 0
  v_mov_b32 v154, 0
  v_mov_b32 v155, 0
  v_mov_b32 v156, 0
  v_mov_b32 v157, 0
  v_mov_b32 v158, 0
  v_mov_b32 v159, 0
  v_add_u32 v26, 131072, v6
  v_add_u32 v27, 131072, v7
  v_add_u32 v28, 131072, v8
  v_add_u32 v29, 131072, v9
  v_add_u32 v20, 65536, v6
  v_add_u32 v21, 65536, v7
  v_add_u32 v22, 65536, v8
  v_add_u32 v23, 65536, v9
  v_readlane_b32 s48, v15, 0
  v_readlane_b32 s49, v15, 1
  v_readlane_b32 s50, v15, 2
  v_permlane16_swap_b32 v240, v242
  v_permlane16_swap_b32 v241, v243
  v_permlane16_swap_b32 v244, v246
  v_permlane16_swap_b32 v245, v247
  v_permlane16_swap_b32 v248, v250
  v_permlane16_swap_b32 v249, v251
  v_permlane16_swap_b32 v252, v254
  v_permlane16_swap_b32 v253, v255
  s_waitcnt lgkmcnt(0)
  s_barrier
  buffer_load_dwordx4 v[32:35], v4, s[36:39], s48 offen offset:0
  buffer_load_dwordx4 v[36:39], v5, s[36:39], s48 offen offset:0
  buffer_load_dwordx4 v[40:43], v4, s[36:39], s48 offen offset:1024
  buffer_load_dwordx4 v[44:47], v5, s[36:39], s48 offen offset:1024
  buffer_load_dwordx4 v[48:51], v4, s[36:39], s49 offen offset:0
  buffer_load_dwordx4 v[52:55], v5, s[36:39], s49 offen offset:0
  buffer_load_dwordx4 v[56:59], v4, s[36:39], s49 offen offset:1024
  buffer_load_dwordx4 v[60:63], v5, s[36:39], s49 offen offset:1024
  buffer_load_dwordx4 v[64:67], v4, s[36:39], s50 offen offset:0
  buffer_load_dwordx4 v[68:71], v5, s[36:39], s50 offen offset:0
  buffer_load_dwordx4 v[72:75], v4, s[36:39], s50 offen offset:1024
  buffer_load_dwordx4 v[76:79], v5, s[36:39], s50 offen offset:1024
  ds_read_b64_tr_b16 v[160:161], v6 offset:0
  ds_read_b64_tr_b16 v[162:163], v6 offset:512
  ds_read_b64_tr_b16 v[164:165], v7 offset:0
  ds_read_b64_tr_b16 v[166:167], v7 offset:512
  ds_read_b64_tr_b16 v[168:169], v8 offset:0
  ds_read_b64_tr_b16 v[170:171], v8 offset:512
  ds_read_b64_tr_b16 v[172:173], v9 offset:0
  ds_read_b64_tr_b16 v[174:175], v9 offset:512
  ds_read_b64_tr_b16 v[176:177], v6 offset:4096
  ds_read_b64_tr_b16 v[178:179], v6 offset:4608
  ds_read_b64_tr_b16 v[180:181], v7 offset:4096
  ds_read_b64_tr_b16 v[182:183], v7 offset:4608
  ds_read_b64_tr_b16 v[184:185], v8 offset:4096
  ds_read_b64_tr_b16 v[186:187], v8 offset:4608
  ds_read_b64_tr_b16 v[188:189], v9 offset:4096
  ds_read_b64_tr_b16 v[190:191], v9 offset:4608
  s_waitcnt vmcnt(12)
  v_lshlrev_b32 v216, 16, v192
  v_and_b32 v217, s11, v192
  v_lshlrev_b32 v218, 16, v193
  v_and_b32 v219, s11, v193
  v_lshlrev_b32 v96, 16, v240
  v_and_b32 v97, s11, v240
  v_pk_add_f32 v[96:97], v[96:97], v[216:217]
  v_lshlrev_b32 v98, 16, v241
  v_and_b32 v99, s11, v241
  v_pk_add_f32 v[98:99], v[98:99], v[218:219]
  v_lshlrev_b32 v100, 16, v248
  v_and_b32 v101, s11, v248
  v_pk_add_f32 v[100:101], v[100:101], v[216:217]
  v_lshlrev_b32 v102, 16, v249
  v_and_b32 v103, s11, v249
  v_pk_add_f32 v[102:103], v[102:103], v[218:219]
  v_lshlrev_b32 v216, 16, v194
  v_and_b32 v217, s11, v194
  v_lshlrev_b32 v218, 16, v195
  v_and_b32 v219, s11, v195
  v_lshlrev_b32 v104, 16, v242
  v_and_b32 v105, s11, v242
  v_pk_add_f32 v[104:105], v[104:105], v[216:217]
  v_lshlrev_b32 v106, 16, v243
  v_and_b32 v107, s11, v243
  v_pk_add_f32 v[106:107], v[106:107], v[218:219]
  v_lshlrev_b32 v108, 16, v250
  v_and_b32 v109, s11, v250
  v_pk_add_f32 v[108:109], v[108:109], v[216:217]
  v_lshlrev_b32 v110, 16, v251
  v_and_b32 v111, s11, v251
  v_pk_add_f32 v[110:111], v[110:111], v[218:219]
  v_lshlrev_b32 v216, 16, v196
  v_and_b32 v217, s11, v196
  v_lshlrev_b32 v218, 16, v197
  v_and_b32 v219, s11, v197
  v_lshlrev_b32 v112, 16, v244
  v_and_b32 v113, s11, v244
  v_pk_add_f32 v[112:113], v[112:113], v[216:217]
  v_lshlrev_b32 v114, 16, v245
  v_and_b32 v115, s11, v245
  v_pk_add_f32 v[114:115], v[114:115], v[218:219]
  v_lshlrev_b32 v116, 16, v252
  v_and_b32 v117, s11, v252
  v_pk_add_f32 v[116:117], v[116:117], v[216:217]
  v_lshlrev_b32 v118, 16, v253
  v_and_b32 v119, s11, v253
  v_pk_add_f32 v[118:119], v[118:119], v[218:219]
  v_lshlrev_b32 v216, 16, v198
  v_and_b32 v217, s11, v198
  v_lshlrev_b32 v218, 16, v199
  v_and_b32 v219, s11, v199
  v_lshlrev_b32 v120, 16, v246
  v_and_b32 v121, s11, v246
  v_pk_add_f32 v[120:121], v[120:121], v[216:217]
  v_lshlrev_b32 v122, 16, v247
  v_and_b32 v123, s11, v247
  v_pk_add_f32 v[122:123], v[122:123], v[218:219]
  v_lshlrev_b32 v124, 16, v254
  v_and_b32 v125, s11, v254
  v_pk_add_f32 v[124:125], v[124:125], v[216:217]
  v_lshlrev_b32 v126, 16, v255
  v_and_b32 v127, s11, v255
  v_pk_add_f32 v[126:127], v[126:127], v[218:219]
  s_waitcnt vmcnt(10) lgkmcnt(8)
  v_mfma_f32_16x16x32_bf16 v[128:131], v[160:163], v[32:35], v[128:131]
  ds_read_b64_tr_b16 v[192:193], v6 offset:8192
  v_readlane_b32 s51, v15, 3
  v_mfma_f32_16x16x32_bf16 v[132:135], v[160:163], v[36:39], v[132:135]
  ds_read_b64_tr_b16 v[194:195], v6 offset:8704
  v_mfma_f32_16x16x32_bf16 v[140:143], v[164:167], v[36:39], v[140:143]
  ds_read_b64_tr_b16 v[196:197], v7 offset:8192
  v_mfma_f32_16x16x32_bf16 v[136:139], v[164:167], v[32:35], v[136:139]
  ds_read_b64_tr_b16 v[198:199], v7 offset:8704
  buffer_load_dwordx4 v[80:83], v4, s[36:39], s51 offen offset:0
  v_mfma_f32_16x16x32_bf16 v[144:147], v[168:171], v[32:35], v[144:147]
  ds_read_b64_tr_b16 v[200:201], v8 offset:8192
  v_mfma_f32_16x16x32_bf16 v[148:151], v[168:171], v[36:39], v[148:151]
  ds_read_b64_tr_b16 v[202:203], v8 offset:8704
  v_mfma_f32_16x16x32_bf16 v[156:159], v[172:175], v[36:39], v[156:159]
  ds_read_b64_tr_b16 v[204:205], v9 offset:8192
  buffer_load_dwordx4 v[84:87], v5, s[36:39], s51 offen offset:0
  v_mfma_f32_16x16x32_bf16 v[152:155], v[172:175], v[32:35], v[152:155]
  ds_read_b64_tr_b16 v[206:207], v9 offset:8704
  s_waitcnt vmcnt(10) lgkmcnt(8)
  v_mfma_f32_16x16x32_bf16 v[128:131], v[176:179], v[40:43], v[128:131]
  ds_read_b64_tr_b16 v[208:209], v6 offset:12288
  v_mfma_f32_16x16x32_bf16 v[132:135], v[176:179], v[44:47], v[132:135]
  ds_read_b64_tr_b16 v[210:211], v6 offset:12800
  buffer_load_dwordx4 v[88:91], v4, s[36:39], s51 offen offset:1024
  v_mfma_f32_16x16x32_bf16 v[140:143], v[180:183], v[44:47], v[140:143]
  ds_read_b64_tr_b16 v[212:213], v7 offset:12288
  v_mfma_f32_16x16x32_bf16 v[136:139], v[180:183], v[40:43], v[136:139]
  ds_read_b64_tr_b16 v[214:215], v7 offset:12800
  v_mfma_f32_16x16x32_bf16 v[144:147], v[184:187], v[40:43], v[144:147]
  ds_read_b64_tr_b16 v[216:217], v8 offset:12288
  buffer_load_dwordx4 v[92:95], v5, s[36:39], s51 offen offset:1024
  v_mfma_f32_16x16x32_bf16 v[148:151], v[184:187], v[44:47], v[148:151]
  ds_read_b64_tr_b16 v[218:219], v8 offset:12800
  v_readlane_b32 s48, v15, 4
  v_mfma_f32_16x16x32_bf16 v[156:159], v[188:191], v[44:47], v[156:159]
  ds_read_b64_tr_b16 v[220:221], v9 offset:12288
  v_mfma_f32_16x16x32_bf16 v[152:155], v[188:191], v[40:43], v[152:155]
  ds_read_b64_tr_b16 v[222:223], v9 offset:12800
  s_waitcnt lgkmcnt(8)
  v_mfma_f32_16x16x32_bf16 v[96:99], v[192:195], v[32:35], v[96:99]
  ds_read_b64_tr_b16 v[160:161], v6 offset:16384
  buffer_load_dwordx4 v[224:227], v4, s[36:39], s48 offen offset:0
  v_mfma_f32_16x16x32_bf16 v[100:103], v[192:195], v[36:39], v[100:103]
  ds_read_b64_tr_b16 v[162:163], v6 offset:16896
  v_mfma_f32_16x16x32_bf16 v[108:111], v[196:199], v[36:39], v[108:111]
  ds_read_b64_tr_b16 v[164:165], v7 offset:16384
  v_mfma_f32_16x16x32_bf16 v[104:107], v[196:199], v[32:35], v[104:107]
  ds_read_b64_tr_b16 v[166:167], v7 offset:16896
  buffer_load_dwordx4 v[228:231], v5, s[36:39], s48 offen offset:0
  v_mfma_f32_16x16x32_bf16 v[112:115], v[200:203], v[32:35], v[112:115]
  ds_read_b64_tr_b16 v[168:169], v8 offset:16384
  v_mfma_f32_16x16x32_bf16 v[116:119], v[200:203], v[36:39], v[116:119]
  ds_read_b64_tr_b16 v[170:171], v8 offset:16896
  v_mfma_f32_16x16x32_bf16 v[124:127], v[204:207], v[36:39], v[124:127]
  ds_read_b64_tr_b16 v[172:173], v9 offset:16384
  buffer_load_dwordx4 v[232:235], v4, s[36:39], s48 offen offset:1024
  v_mfma_f32_16x16x32_bf16 v[120:123], v[204:207], v[32:35], v[120:123]
  ds_read_b64_tr_b16 v[174:175], v9 offset:16896
  s_waitcnt lgkmcnt(8)
  v_mfma_f32_16x16x32_bf16 v[96:99], v[208:211], v[40:43], v[96:99]
  ds_read_b64_tr_b16 v[176:177], v6 offset:20480
  v_mfma_f32_16x16x32_bf16 v[100:103], v[208:211], v[44:47], v[100:103]
  ds_read_b64_tr_b16 v[178:179], v6 offset:20992
  buffer_load_dwordx4 v[236:239], v5, s[36:39], s48 offen offset:1024
  v_mfma_f32_16x16x32_bf16 v[108:111], v[212:215], v[44:47], v[108:111]
  ds_read_b64_tr_b16 v[180:181], v7 offset:20480
  v_readlane_b32 s49, v15, 5
  v_mfma_f32_16x16x32_bf16 v[104:107], v[212:215], v[40:43], v[104:107]
  ds_read_b64_tr_b16 v[182:183], v7 offset:20992
  v_mfma_f32_16x16x32_bf16 v[112:115], v[216:219], v[40:43], v[112:115]
  ds_read_b64_tr_b16 v[184:185], v8 offset:20480
  v_mfma_f32_16x16x32_bf16 v[116:119], v[216:219], v[44:47], v[116:119]
  ds_read_b64_tr_b16 v[186:187], v8 offset:20992
  buffer_load_dwordx4 v[240:243], v4, s[36:39], s49 offen offset:0
  v_mfma_f32_16x16x32_bf16 v[124:127], v[220:223], v[44:47], v[124:127]
  ds_read_b64_tr_b16 v[188:189], v9 offset:20480
  v_mfma_f32_16x16x32_bf16 v[120:123], v[220:223], v[40:43], v[120:123]
  ds_read_b64_tr_b16 v[190:191], v9 offset:20992
  s_waitcnt vmcnt(15) lgkmcnt(8)
  v_mfma_f32_16x16x32_bf16 v[128:131], v[160:163], v[48:51], v[128:131]
  ds_read_b64_tr_b16 v[192:193], v6 offset:24576
  buffer_load_dwordx4 v[244:247], v5, s[36:39], s49 offen offset:0
  v_mfma_f32_16x16x32_bf16 v[132:135], v[160:163], v[52:55], v[132:135]
  ds_read_b64_tr_b16 v[194:195], v6 offset:25088
  v_mfma_f32_16x16x32_bf16 v[140:143], v[164:167], v[52:55], v[140:143]
  ds_read_b64_tr_b16 v[196:197], v7 offset:24576
  v_mfma_f32_16x16x32_bf16 v[136:139], v[164:167], v[48:51], v[136:139]
  ds_read_b64_tr_b16 v[198:199], v7 offset:25088
  buffer_load_dwordx4 v[248:251], v4, s[36:39], s49 offen offset:1024
  v_mfma_f32_16x16x32_bf16 v[144:147], v[168:171], v[48:51], v[144:147]
  ds_read_b64_tr_b16 v[200:201], v8 offset:24576
  v_mfma_f32_16x16x32_bf16 v[148:151], v[168:171], v[52:55], v[148:151]
  ds_read_b64_tr_b16 v[202:203], v8 offset:25088
  v_mfma_f32_16x16x32_bf16 v[156:159], v[172:175], v[52:55], v[156:159]
  ds_read_b64_tr_b16 v[204:205], v9 offset:24576
  buffer_load_dwordx4 v[252:255], v5, s[36:39], s49 offen offset:1024
  v_mfma_f32_16x16x32_bf16 v[152:155], v[172:175], v[48:51], v[152:155]
  ds_read_b64_tr_b16 v[206:207], v9 offset:25088
  s_waitcnt vmcnt(16) lgkmcnt(8)
  v_mfma_f32_16x16x32_bf16 v[128:131], v[176:179], v[56:59], v[128:131]
  ds_read_b64_tr_b16 v[208:209], v6 offset:28672
  v_readlane_b32 s50, v15, 6
  v_mfma_f32_16x16x32_bf16 v[132:135], v[176:179], v[60:63], v[132:135]
  ds_read_b64_tr_b16 v[210:211], v6 offset:29184
  v_mfma_f32_16x16x32_bf16 v[140:143], v[180:183], v[60:63], v[140:143]
  ds_read_b64_tr_b16 v[212:213], v7 offset:28672
  v_mfma_f32_16x16x32_bf16 v[136:139], v[180:183], v[56:59], v[136:139]
  ds_read_b64_tr_b16 v[214:215], v7 offset:29184
  buffer_load_dwordx4 v[32:35], v4, s[36:39], s50 offen offset:0
  v_mfma_f32_16x16x32_bf16 v[144:147], v[184:187], v[56:59], v[144:147]
  ds_read_b64_tr_b16 v[216:217], v8 offset:28672
  v_mfma_f32_16x16x32_bf16 v[148:151], v[184:187], v[60:63], v[148:151]
  ds_read_b64_tr_b16 v[218:219], v8 offset:29184
  v_mfma_f32_16x16x32_bf16 v[156:159], v[188:191], v[60:63], v[156:159]
  ds_read_b64_tr_b16 v[220:221], v9 offset:28672
  v_mfma_f32_16x16x32_bf16 v[152:155], v[188:191], v[56:59], v[152:155]
  ds_read_b64_tr_b16 v[222:223], v9 offset:29184
  s_waitcnt lgkmcnt(8)
  v_mfma_f32_16x16x32_bf16 v[96:99], v[192:195], v[48:51], v[96:99]
  ds_read_b64_tr_b16 v[160:161], v6 offset:32768
  v_mfma_f32_16x16x32_bf16 v[100:103], v[192:195], v[52:55], v[100:103]
  ds_read_b64_tr_b16 v[162:163], v6 offset:33280
  v_mfma_f32_16x16x32_bf16 v[108:111], v[196:199], v[52:55], v[108:111]
  ds_read_b64_tr_b16 v[164:165], v7 offset:32768
  buffer_load_dwordx4 v[36:39], v5, s[36:39], s50 offen offset:0
  v_mfma_f32_16x16x32_bf16 v[104:107], v[196:199], v[48:51], v[104:107]
  ds_read_b64_tr_b16 v[166:167], v7 offset:33280
  v_mfma_f32_16x16x32_bf16 v[112:115], v[200:203], v[48:51], v[112:115]
  ds_read_b64_tr_b16 v[168:169], v8 offset:32768
  v_mfma_f32_16x16x32_bf16 v[116:119], v[200:203], v[52:55], v[116:119]
  ds_read_b64_tr_b16 v[170:171], v8 offset:33280
  v_mfma_f32_16x16x32_bf16 v[124:127], v[204:207], v[52:55], v[124:127]
  ds_read_b64_tr_b16 v[172:173], v9 offset:32768
  v_mfma_f32_16x16x32_bf16 v[120:123], v[204:207], v[48:51], v[120:123]
  ds_read_b64_tr_b16 v[174:175], v9 offset:33280
  s_waitcnt lgkmcnt(8)
  s_barrier
  v_mfma_f32_16x16x32_bf16 v[96:99], v[208:211], v[56:59], v[96:99]
  ds_read_b64_tr_b16 v[176:177], v6 offset:36864
  v_mfma_f32_16x16x32_bf16 v[100:103], v[208:211], v[60:63], v[100:103]
  ds_read_b64_tr_b16 v[178:179], v6 offset:37376
  buffer_load_dwordx4 v[40:43], v4, s[36:39], s50 offen offset:1024
  v_mfma_f32_16x16x32_bf16 v[108:111], v[212:215], v[60:63], v[108:111]
  ds_read_b64_tr_b16 v[180:181], v7 offset:36864
  v_mfma_f32_16x16x32_bf16 v[104:107], v[212:215], v[56:59], v[104:107]
  ds_read_b64_tr_b16 v[182:183], v7 offset:37376
  v_mfma_f32_16x16x32_bf16 v[112:115], v[216:219], v[56:59], v[112:115]
  ds_read_b64_tr_b16 v[184:185], v8 offset:36864
  v_mfma_f32_16x16x32_bf16 v[116:119], v[216:219], v[60:63], v[116:119]
  ds_read_b64_tr_b16 v[186:187], v8 offset:37376
  v_mfma_f32_16x16x32_bf16 v[124:127], v[220:223], v[60:63], v[124:127]
  ds_read_b64_tr_b16 v[188:189], v9 offset:36864
  v_mfma_f32_16x16x32_bf16 v[120:123], v[220:223], v[56:59], v[120:123]
  ds_read_b64_tr_b16 v[190:191], v9 offset:37376
  s_waitcnt vmcnt(17) lgkmcnt(8)
  v_mfma_f32_16x16x32_bf16 v[128:131], v[160:163], v[64:67], v[128:131]
  ds_read_b64_tr_b16 v[192:193], v6 offset:40960
  buffer_load_dwordx4 v[44:47], v5, s[36:39], s50 offen offset:1024
  v_mfma_f32_16x16x32_bf16 v[132:135], v[160:163], v[68:71], v[132:135]
  ds_read_b64_tr_b16 v[194:195], v6 offset:41472
  v_mfma_f32_16x16x32_bf16 v[140:143], v[164:167], v[68:71], v[140:143]
  ds_read_b64_tr_b16 v[196:197], v7 offset:40960
  v_mfma_f32_16x16x32_bf16 v[136:139], v[164:167], v[64:67], v[136:139]
  ds_read_b64_tr_b16 v[198:199], v7 offset:41472
  v_mfma_f32_16x16x32_bf16 v[144:147], v[168:171], v[64:67], v[144:147]
  ds_read_b64_tr_b16 v[200:201], v8 offset:40960
  v_mfma_f32_16x16x32_bf16 v[148:151], v[168:171], v[68:71], v[148:151]
  ds_read_b64_tr_b16 v[202:203], v8 offset:41472
  v_readlane_b32 s51, v15, 7
  v_mfma_f32_16x16x32_bf16 v[156:159], v[172:175], v[68:71], v[156:159]
  ds_read_b64_tr_b16 v[204:205], v9 offset:40960
  v_mfma_f32_16x16x32_bf16 v[152:155], v[172:175], v[64:67], v[152:155]
  ds_read_b64_tr_b16 v[206:207], v9 offset:41472
  s_waitcnt vmcnt(16) lgkmcnt(8)
  v_mfma_f32_16x16x32_bf16 v[128:131], v[176:179], v[72:75], v[128:131]
  ds_read_b64_tr_b16 v[208:209], v6 offset:45056
  buffer_load_dwordx4 v[48:51], v4, s[36:39], s51 offen offset:0
  v_mfma_f32_16x16x32_bf16 v[132:135], v[176:179], v[76:79], v[132:135]
  ds_read_b64_tr_b16 v[210:211], v6 offset:45568
  v_mfma_f32_16x16x32_bf16 v[140:143], v[180:183], v[76:79], v[140:143]
  ds_read_b64_tr_b16 v[212:213], v7 offset:45056
  v_mfma_f32_16x16x32_bf16 v[136:139], v[180:183], v[72:75], v[136:139]
  ds_read_b64_tr_b16 v[214:215], v7 offset:45568
  v_mfma_f32_16x16x32_bf16 v[144:147], v[184:187], v[72:75], v[144:147]
  ds_read_b64_tr_b16 v[216:217], v8 offset:45056
  v_mfma_f32_16x16x32_bf16 v[148:151], v[184:187], v[76:79], v[148:151]
  ds_read_b64_tr_b16 v[218:219], v8 offset:45568
  v_mfma_f32_16x16x32_bf16 v[156:159], v[188:191], v[76:79], v[156:159]
  ds_read_b64_tr_b16 v[220:221], v9 offset:45056
  v_mfma_f32_16x16x32_bf16 v[152:155], v[188:191], v[72:75], v[152:155]
  ds_read_b64_tr_b16 v[222:223], v9 offset:45568
  s_waitcnt lgkmcnt(8)
  v_mfma_f32_16x16x32_bf16 v[96:99], v[192:195], v[64:67], v[96:99]
  ds_read_b64_tr_b16 v[160:161], v6 offset:49152
  buffer_load_dwordx4 v[52:55], v5, s[36:39], s51 offen offset:0
  v_mfma_f32_16x16x32_bf16 v[100:103], v[192:195], v[68:71], v[100:103]
  ds_read_b64_tr_b16 v[162:163], v6 offset:49664
  v_mfma_f32_16x16x32_bf16 v[108:111], v[196:199], v[68:71], v[108:111]
  ds_read_b64_tr_b16 v[164:165], v7 offset:49152
  v_mfma_f32_16x16x32_bf16 v[104:107], v[196:199], v[64:67], v[104:107]
  ds_read_b64_tr_b16 v[166:167], v7 offset:49664
  v_mfma_f32_16x16x32_bf16 v[112:115], v[200:203], v[64:67], v[112:115]
  ds_read_b64_tr_b16 v[168:169], v8 offset:49152
  v_mfma_f32_16x16x32_bf16 v[116:119], v[200:203], v[68:71], v[116:119]
  ds_read_b64_tr_b16 v[170:171], v8 offset:49664
  v_mfma_f32_16x16x32_bf16 v[124:127], v[204:207], v[68:71], v[124:127]
  ds_read_b64_tr_b16 v[172:173], v9 offset:49152
  v_mfma_f32_16x16x32_bf16 v[120:123], v[204:207], v[64:67], v[120:123]
  ds_read_b64_tr_b16 v[174:175], v9 offset:49664
  s_waitcnt lgkmcnt(8)
  v_mfma_f32_16x16x32_bf16 v[96:99], v[208:211], v[72:75], v[96:99]
  ds_read_b64_tr_b16 v[176:177], v6 offset:53248
  buffer_load_dwordx4 v[56:59], v4, s[36:39], s51 offen offset:1024
  v_mfma_f32_16x16x32_bf16 v[100:103], v[208:211], v[76:79], v[100:103]
  ds_read_b64_tr_b16 v[178:179], v6 offset:53760
  v_mfma_f32_16x16x32_bf16 v[108:111], v[212:215], v[76:79], v[108:111]
  ds_read_b64_tr_b16 v[180:181], v7 offset:53248
  v_mfma_f32_16x16x32_bf16 v[104:107], v[212:215], v[72:75], v[104:107]
  ds_read_b64_tr_b16 v[182:183], v7 offset:53760
  v_mfma_f32_16x16x32_bf16 v[112:115], v[216:219], v[72:75], v[112:115]
  ds_read_b64_tr_b16 v[184:185], v8 offset:53248
  v_mfma_f32_16x16x32_bf16 v[116:119], v[216:219], v[76:79], v[116:119]
  ds_read_b64_tr_b16 v[186:187], v8 offset:53760
  v_mfma_f32_16x16x32_bf16 v[124:127], v[220:223], v[76:79], v[124:127]
  ds_read_b64_tr_b16 v[188:189], v9 offset:53248
  v_mfma_f32_16x16x32_bf16 v[120:123], v[220:223], v[72:75], v[120:123]
  ds_read_b64_tr_b16 v[190:191], v9 offset:53760
  s_waitcnt vmcnt(17) lgkmcnt(8)
  v_mfma_f32_16x16x32_bf16 v[128:131], v[160:163], v[80:83], v[128:131]
  ds_read_b64_tr_b16 v[192:193], v6 offset:57344
  buffer_load_dwordx4 v[60:63], v5, s[36:39], s51 offen offset:1024
  v_mfma_f32_16x16x32_bf16 v[132:135], v[160:163], v[84:87], v[132:135]
  ds_read_b64_tr_b16 v[194:195], v6 offset:57856
  v_mfma_f32_16x16x32_bf16 v[140:143], v[164:167], v[84:87], v[140:143]
  ds_read_b64_tr_b16 v[196:197], v7 offset:57344
  v_mfma_f32_16x16x32_bf16 v[136:139], v[164:167], v[80:83], v[136:139]
  ds_read_b64_tr_b16 v[198:199], v7 offset:57856
  v_mfma_f32_16x16x32_bf16 v[144:147], v[168:171], v[80:83], v[144:147]
  ds_read_b64_tr_b16 v[200:201], v8 offset:57344
  v_mfma_f32_16x16x32_bf16 v[148:151], v[168:171], v[84:87], v[148:151]
  ds_read_b64_tr_b16 v[202:203], v8 offset:57856
  v_readlane_b32 s48, v15, 8
  v_mfma_f32_16x16x32_bf16 v[156:159], v[172:175], v[84:87], v[156:159]
  ds_read_b64_tr_b16 v[204:205], v9 offset:57344
  v_mfma_f32_16x16x32_bf16 v[152:155], v[172:175], v[80:83], v[152:155]
  ds_read_b64_tr_b16 v[206:207], v9 offset:57856
  s_waitcnt vmcnt(16) lgkmcnt(8)
  v_mfma_f32_16x16x32_bf16 v[128:131], v[176:179], v[88:91], v[128:131]
  ds_read_b64_tr_b16 v[208:209], v6 offset:61440
  buffer_load_dwordx4 v[64:67], v4, s[36:39], s48 offen offset:0
  v_mfma_f32_16x16x32_bf16 v[132:135], v[176:179], v[92:95], v[132:135]
  ds_read_b64_tr_b16 v[210:211], v6 offset:61952
  v_mfma_f32_16x16x32_bf16 v[140:143], v[180:183], v[92:95], v[140:143]
  ds_read_b64_tr_b16 v[212:213], v7 offset:61440
  v_mfma_f32_16x16x32_bf16 v[136:139], v[180:183], v[88:91], v[136:139]
  ds_read_b64_tr_b16 v[214:215], v7 offset:61952
  v_mfma_f32_16x16x32_bf16 v[144:147], v[184:187], v[88:91], v[144:147]
  ds_read_b64_tr_b16 v[216:217], v8 offset:61440
  v_mfma_f32_16x16x32_bf16 v[148:151], v[184:187], v[92:95], v[148:151]
  ds_read_b64_tr_b16 v[218:219], v8 offset:61952
  v_mfma_f32_16x16x32_bf16 v[156:159], v[188:191], v[92:95], v[156:159]
  ds_read_b64_tr_b16 v[220:221], v9 offset:61440
  v_mfma_f32_16x16x32_bf16 v[152:155], v[188:191], v[88:91], v[152:155]
  ds_read_b64_tr_b16 v[222:223], v9 offset:61952
  s_waitcnt lgkmcnt(8)
  v_mfma_f32_16x16x32_bf16 v[96:99], v[192:195], v[80:83], v[96:99]
  ds_read_b64_tr_b16 v[160:161], v20 offset:0
  buffer_load_dwordx4 v[68:71], v5, s[36:39], s48 offen offset:0
  v_mfma_f32_16x16x32_bf16 v[100:103], v[192:195], v[84:87], v[100:103]
  ds_read_b64_tr_b16 v[162:163], v20 offset:512
  v_mfma_f32_16x16x32_bf16 v[108:111], v[196:199], v[84:87], v[108:111]
  ds_read_b64_tr_b16 v[164:165], v21 offset:0
  v_mfma_f32_16x16x32_bf16 v[104:107], v[196:199], v[80:83], v[104:107]
  ds_read_b64_tr_b16 v[166:167], v21 offset:512
  v_mfma_f32_16x16x32_bf16 v[112:115], v[200:203], v[80:83], v[112:115]
  ds_read_b64_tr_b16 v[168:169], v22 offset:0
  v_mfma_f32_16x16x32_bf16 v[116:119], v[200:203], v[84:87], v[116:119]
  ds_read_b64_tr_b16 v[170:171], v22 offset:512
  v_mfma_f32_16x16x32_bf16 v[124:127], v[204:207], v[84:87], v[124:127]
  ds_read_b64_tr_b16 v[172:173], v23 offset:0
  v_mfma_f32_16x16x32_bf16 v[120:123], v[204:207], v[80:83], v[120:123]
  ds_read_b64_tr_b16 v[174:175], v23 offset:512
  s_waitcnt lgkmcnt(8)
  s_barrier
  v_mfma_f32_16x16x32_bf16 v[96:99], v[208:211], v[88:91], v[96:99]
  ds_read_b64_tr_b16 v[176:177], v20 offset:4096
  buffer_load_dwordx4 v[72:75], v4, s[36:39], s48 offen offset:1024
  v_mfma_f32_16x16x32_bf16 v[100:103], v[208:211], v[92:95], v[100:103]
  ds_read_b64_tr_b16 v[178:179], v20 offset:4608
  v_mfma_f32_16x16x32_bf16 v[108:111], v[212:215], v[92:95], v[108:111]
  ds_read_b64_tr_b16 v[180:181], v21 offset:4096
  v_mfma_f32_16x16x32_bf16 v[104:107], v[212:215], v[88:91], v[104:107]
  ds_read_b64_tr_b16 v[182:183], v21 offset:4608
  v_mfma_f32_16x16x32_bf16 v[112:115], v[216:219], v[88:91], v[112:115]
  ds_read_b64_tr_b16 v[184:185], v22 offset:4096
  v_mfma_f32_16x16x32_bf16 v[116:119], v[216:219], v[92:95], v[116:119]
  ds_read_b64_tr_b16 v[186:187], v22 offset:4608
  v_mfma_f32_16x16x32_bf16 v[124:127], v[220:223], v[92:95], v[124:127]
  ds_read_b64_tr_b16 v[188:189], v23 offset:4096
  v_mfma_f32_16x16x32_bf16 v[120:123], v[220:223], v[88:91], v[120:123]
  ds_read_b64_tr_b16 v[190:191], v23 offset:4608
  s_waitcnt vmcnt(17) lgkmcnt(8)
  v_mfma_f32_16x16x32_bf16 v[128:131], v[160:163], v[224:227], v[128:131]
  ds_read_b64_tr_b16 v[192:193], v20 offset:8192
  buffer_load_dwordx4 v[76:79], v5, s[36:39], s48 offen offset:1024
  v_mfma_f32_16x16x32_bf16 v[132:135], v[160:163], v[228:231], v[132:135]
  ds_read_b64_tr_b16 v[194:195], v20 offset:8704
  v_mfma_f32_16x16x32_bf16 v[140:143], v[164:167], v[228:231], v[140:143]
  ds_read_b64_tr_b16 v[196:197], v21 offset:8192
  v_mfma_f32_16x16x32_bf16 v[136:139], v[164:167], v[224:227], v[136:139]
  ds_read_b64_tr_b16 v[198:199], v21 offset:8704
  v_mfma_f32_16x16x32_bf16 v[144:147], v[168:171], v[224:227], v[144:147]
  ds_read_b64_tr_b16 v[200:201], v22 offset:8192
  v_mfma_f32_16x16x32_bf16 v[148:151], v[168:171], v[228:231], v[148:151]
  ds_read_b64_tr_b16 v[202:203], v22 offset:8704
  v_readlane_b32 s49, v15, 9
  v_mfma_f32_16x16x32_bf16 v[156:159], v[172:175], v[228:231], v[156:159]
  ds_read_b64_tr_b16 v[204:205], v23 offset:8192
  v_mfma_f32_16x16x32_bf16 v[152:155], v[172:175], v[224:227], v[152:155]
  ds_read_b64_tr_b16 v[206:207], v23 offset:8704
  s_waitcnt vmcnt(16) lgkmcnt(8)
  v_mfma_f32_16x16x32_bf16 v[128:131], v[176:179], v[232:235], v[128:131]
  ds_read_b64_tr_b16 v[208:209], v20 offset:12288
  buffer_load_dwordx4 v[80:83], v4, s[36:39], s49 offen offset:0
  v_mfma_f32_16x16x32_bf16 v[132:135], v[176:179], v[236:239], v[132:135]
  ds_read_b64_tr_b16 v[210:211], v20 offset:12800
  v_mfma_f32_16x16x32_bf16 v[140:143], v[180:183], v[236:239], v[140:143]
  ds_read_b64_tr_b16 v[212:213], v21 offset:12288
  v_mfma_f32_16x16x32_bf16 v[136:139], v[180:183], v[232:235], v[136:139]
  ds_read_b64_tr_b16 v[214:215], v21 offset:12800
  v_mfma_f32_16x16x32_bf16 v[144:147], v[184:187], v[232:235], v[144:147]
  ds_read_b64_tr_b16 v[216:217], v22 offset:12288
  v_mfma_f32_16x16x32_bf16 v[148:151], v[184:187], v[236:239], v[148:151]
  ds_read_b64_tr_b16 v[218:219], v22 offset:12800
  v_mfma_f32_16x16x32_bf16 v[156:159], v[188:191], v[236:239], v[156:159]
  ds_read_b64_tr_b16 v[220:221], v23 offset:12288
  v_mfma_f32_16x16x32_bf16 v[152:155], v[188:191], v[232:235], v[152:155]
  ds_read_b64_tr_b16 v[222:223], v23 offset:12800
  s_waitcnt lgkmcnt(8)
  v_mfma_f32_16x16x32_bf16 v[96:99], v[192:195], v[224:227], v[96:99]
  ds_read_b64_tr_b16 v[160:161], v20 offset:16384
  buffer_load_dwordx4 v[84:87], v5, s[36:39], s49 offen offset:0
  v_mfma_f32_16x16x32_bf16 v[100:103], v[192:195], v[228:231], v[100:103]
  ds_read_b64_tr_b16 v[162:163], v20 offset:16896
  v_mfma_f32_16x16x32_bf16 v[108:111], v[196:199], v[228:231], v[108:111]
  ds_read_b64_tr_b16 v[164:165], v21 offset:16384
  v_mfma_f32_16x16x32_bf16 v[104:107], v[196:199], v[224:227], v[104:107]
  ds_read_b64_tr_b16 v[166:167], v21 offset:16896
  v_mfma_f32_16x16x32_bf16 v[112:115], v[200:203], v[224:227], v[112:115]
  ds_read_b64_tr_b16 v[168:169], v22 offset:16384
  v_mfma_f32_16x16x32_bf16 v[116:119], v[200:203], v[228:231], v[116:119]
  ds_read_b64_tr_b16 v[170:171], v22 offset:16896
  v_mfma_f32_16x16x32_bf16 v[124:127], v[204:207], v[228:231], v[124:127]
  ds_read_b64_tr_b16 v[172:173], v23 offset:16384
  v_mfma_f32_16x16x32_bf16 v[120:123], v[204:207], v[224:227], v[120:123]
  ds_read_b64_tr_b16 v[174:175], v23 offset:16896
  s_waitcnt lgkmcnt(8)
  v_mfma_f32_16x16x32_bf16 v[96:99], v[208:211], v[232:235], v[96:99]
  ds_read_b64_tr_b16 v[176:177], v20 offset:20480
  buffer_load_dwordx4 v[88:91], v4, s[36:39], s49 offen offset:1024
  v_mfma_f32_16x16x32_bf16 v[100:103], v[208:211], v[236:239], v[100:103]
  ds_read_b64_tr_b16 v[178:179], v20 offset:20992
  v_mfma_f32_16x16x32_bf16 v[108:111], v[212:215], v[236:239], v[108:111]
  ds_read_b64_tr_b16 v[180:181], v21 offset:20480
  v_mfma_f32_16x16x32_bf16 v[104:107], v[212:215], v[232:235], v[104:107]
  ds_read_b64_tr_b16 v[182:183], v21 offset:20992
  v_mfma_f32_16x16x32_bf16 v[112:115], v[216:219], v[232:235], v[112:115]
  ds_read_b64_tr_b16 v[184:185], v22 offset:20480
  v_mfma_f32_16x16x32_bf16 v[116:119], v[216:219], v[236:239], v[116:119]
  ds_read_b64_tr_b16 v[186:187], v22 offset:20992
  v_mfma_f32_16x16x32_bf16 v[124:127], v[220:223], v[236:239], v[124:127]
  ds_read_b64_tr_b16 v[188:189], v23 offset:20480
  v_mfma_f32_16x16x32_bf16 v[120:123], v[220:223], v[232:235], v[120:123]
  ds_read_b64_tr_b16 v[190:191], v23 offset:20992
  s_waitcnt vmcnt(17) lgkmcnt(8)
  v_mfma_f32_16x16x32_bf16 v[128:131], v[160:163], v[240:243], v[128:131]
  ds_read_b64_tr_b16 v[192:193], v20 offset:24576
  buffer_load_dwordx4 v[92:95], v5, s[36:39], s49 offen offset:1024
  v_mfma_f32_16x16x32_bf16 v[132:135], v[160:163], v[244:247], v[132:135]
  ds_read_b64_tr_b16 v[194:195], v20 offset:25088
  v_mfma_f32_16x16x32_bf16 v[140:143], v[164:167], v[244:247], v[140:143]
  ds_read_b64_tr_b16 v[196:197], v21 offset:24576
  v_mfma_f32_16x16x32_bf16 v[136:139], v[164:167], v[240:243], v[136:139]
  ds_read_b64_tr_b16 v[198:199], v21 offset:25088
  v_mfma_f32_16x16x32_bf16 v[144:147], v[168:171], v[240:243], v[144:147]
  ds_read_b64_tr_b16 v[200:201], v22 offset:24576
  v_mfma_f32_16x16x32_bf16 v[148:151], v[168:171], v[244:247], v[148:151]
  ds_read_b64_tr_b16 v[202:203], v22 offset:25088
  v_readlane_b32 s50, v15, 10
  v_mfma_f32_16x16x32_bf16 v[156:159], v[172:175], v[244:247], v[156:159]
  ds_read_b64_tr_b16 v[204:205], v23 offset:24576
  v_mfma_f32_16x16x32_bf16 v[152:155], v[172:175], v[240:243], v[152:155]
  ds_read_b64_tr_b16 v[206:207], v23 offset:25088
  s_waitcnt vmcnt(16) lgkmcnt(8)
  v_mfma_f32_16x16x32_bf16 v[128:131], v[176:179], v[248:251], v[128:131]
  ds_read_b64_tr_b16 v[208:209], v20 offset:28672
  buffer_load_dwordx4 v[224:227], v4, s[36:39], s50 offen offset:0
  v_mfma_f32_16x16x32_bf16 v[132:135], v[176:179], v[252:255], v[132:135]
  ds_read_b64_tr_b16 v[210:211], v20 offset:29184
  v_mfma_f32_16x16x32_bf16 v[140:143], v[180:183], v[252:255], v[140:143]
  ds_read_b64_tr_b16 v[212:213], v21 offset:28672
  v_mfma_f32_16x16x32_bf16 v[136:139], v[180:183], v[248:251], v[136:139]
  ds_read_b64_tr_b16 v[214:215], v21 offset:29184
  v_mfma_f32_16x16x32_bf16 v[144:147], v[184:187], v[248:251], v[144:147]
  ds_read_b64_tr_b16 v[216:217], v22 offset:28672
  v_mfma_f32_16x16x32_bf16 v[148:151], v[184:187], v[252:255], v[148:151]
  ds_read_b64_tr_b16 v[218:219], v22 offset:29184
  v_mfma_f32_16x16x32_bf16 v[156:159], v[188:191], v[252:255], v[156:159]
  ds_read_b64_tr_b16 v[220:221], v23 offset:28672
  v_mfma_f32_16x16x32_bf16 v[152:155], v[188:191], v[248:251], v[152:155]
  ds_read_b64_tr_b16 v[222:223], v23 offset:29184
  s_waitcnt lgkmcnt(8)
  v_mfma_f32_16x16x32_bf16 v[96:99], v[192:195], v[240:243], v[96:99]
  ds_read_b64_tr_b16 v[160:161], v20 offset:32768
  buffer_load_dwordx4 v[228:231], v5, s[36:39], s50 offen offset:0
  v_mfma_f32_16x16x32_bf16 v[100:103], v[192:195], v[244:247], v[100:103]
  ds_read_b64_tr_b16 v[162:163], v20 offset:33280
  v_mfma_f32_16x16x32_bf16 v[108:111], v[196:199], v[244:247], v[108:111]
  ds_read_b64_tr_b16 v[164:165], v21 offset:32768
  v_mfma_f32_16x16x32_bf16 v[104:107], v[196:199], v[240:243], v[104:107]
  ds_read_b64_tr_b16 v[166:167], v21 offset:33280
  v_mfma_f32_16x16x32_bf16 v[112:115], v[200:203], v[240:243], v[112:115]
  ds_read_b64_tr_b16 v[168:169], v22 offset:32768
  v_mfma_f32_16x16x32_bf16 v[116:119], v[200:203], v[244:247], v[116:119]
  ds_read_b64_tr_b16 v[170:171], v22 offset:33280
  v_mfma_f32_16x16x32_bf16 v[124:127], v[204:207], v[244:247], v[124:127]
  ds_read_b64_tr_b16 v[172:173], v23 offset:32768
  v_mfma_f32_16x16x32_bf16 v[120:123], v[204:207], v[240:243], v[120:123]
  ds_read_b64_tr_b16 v[174:175], v23 offset:33280
  s_waitcnt lgkmcnt(8)
  s_barrier
  v_mfma_f32_16x16x32_bf16 v[96:99], v[208:211], v[248:251], v[96:99]
  ds_read_b64_tr_b16 v[176:177], v20 offset:36864
  buffer_load_dwordx4 v[232:235], v4, s[36:39], s50 offen offset:1024
  v_mfma_f32_16x16x32_bf16 v[100:103], v[208:211], v[252:255], v[100:103]
  ds_read_b64_tr_b16 v[178:179], v20 offset:37376
  v_mfma_f32_16x16x32_bf16 v[108:111], v[212:215], v[252:255], v[108:111]
  ds_read_b64_tr_b16 v[180:181], v21 offset:36864
  v_mfma_f32_16x16x32_bf16 v[104:107], v[212:215], v[248:251], v[104:107]
  ds_read_b64_tr_b16 v[182:183], v21 offset:37376
  v_mfma_f32_16x16x32_bf16 v[112:115], v[216:219], v[248:251], v[112:115]
  ds_read_b64_tr_b16 v[184:185], v22 offset:36864
  v_mfma_f32_16x16x32_bf16 v[116:119], v[216:219], v[252:255], v[116:119]
  ds_read_b64_tr_b16 v[186:187], v22 offset:37376
  v_mfma_f32_16x16x32_bf16 v[124:127], v[220:223], v[252:255], v[124:127]
  ds_read_b64_tr_b16 v[188:189], v23 offset:36864
  v_mfma_f32_16x16x32_bf16 v[120:123], v[220:223], v[248:251], v[120:123]
  ds_read_b64_tr_b16 v[190:191], v23 offset:37376
  s_waitcnt vmcnt(17) lgkmcnt(8)
  v_mfma_f32_16x16x32_bf16 v[128:131], v[160:163], v[32:35], v[128:131]
  ds_read_b64_tr_b16 v[192:193], v20 offset:40960
  buffer_load_dwordx4 v[236:239], v5, s[36:39], s50 offen offset:1024
  v_mfma_f32_16x16x32_bf16 v[132:135], v[160:163], v[36:39], v[132:135]
  ds_read_b64_tr_b16 v[194:195], v20 offset:41472
  v_mfma_f32_16x16x32_bf16 v[140:143], v[164:167], v[36:39], v[140:143]
  ds_read_b64_tr_b16 v[196:197], v21 offset:40960
  v_mfma_f32_16x16x32_bf16 v[136:139], v[164:167], v[32:35], v[136:139]
  ds_read_b64_tr_b16 v[198:199], v21 offset:41472
  v_mfma_f32_16x16x32_bf16 v[144:147], v[168:171], v[32:35], v[144:147]
  ds_read_b64_tr_b16 v[200:201], v22 offset:40960
  v_mfma_f32_16x16x32_bf16 v[148:151], v[168:171], v[36:39], v[148:151]
  ds_read_b64_tr_b16 v[202:203], v22 offset:41472
  v_readlane_b32 s51, v15, 11
  v_mfma_f32_16x16x32_bf16 v[156:159], v[172:175], v[36:39], v[156:159]
  ds_read_b64_tr_b16 v[204:205], v23 offset:40960
  v_mfma_f32_16x16x32_bf16 v[152:155], v[172:175], v[32:35], v[152:155]
  ds_read_b64_tr_b16 v[206:207], v23 offset:41472
  s_waitcnt vmcnt(16) lgkmcnt(8)
  v_mfma_f32_16x16x32_bf16 v[128:131], v[176:179], v[40:43], v[128:131]
  ds_read_b64_tr_b16 v[208:209], v20 offset:45056
  buffer_load_dwordx4 v[240:243], v4, s[36:39], s51 offen offset:0
  v_mfma_f32_16x16x32_bf16 v[132:135], v[176:179], v[44:47], v[132:135]
  ds_read_b64_tr_b16 v[210:211], v20 offset:45568
  v_mfma_f32_16x16x32_bf16 v[140:143], v[180:183], v[44:47], v[140:143]
  ds_read_b64_tr_b16 v[212:213], v21 offset:45056
  v_mfma_f32_16x16x32_bf16 v[136:139], v[180:183], v[40:43], v[136:139]
  ds_read_b64_tr_b16 v[214:215], v21 offset:45568
  v_mfma_f32_16x16x32_bf16 v[144:147], v[184:187], v[40:43], v[144:147]
  ds_read_b64_tr_b16 v[216:217], v22 offset:45056
  v_mfma_f32_16x16x32_bf16 v[148:151], v[184:187], v[44:47], v[148:151]
  ds_read_b64_tr_b16 v[218:219], v22 offset:45568
  v_mfma_f32_16x16x32_bf16 v[156:159], v[188:191], v[44:47], v[156:159]
  ds_read_b64_tr_b16 v[220:221], v23 offset:45056
  v_mfma_f32_16x16x32_bf16 v[152:155], v[188:191], v[40:43], v[152:155]
  ds_read_b64_tr_b16 v[222:223], v23 offset:45568
  s_waitcnt lgkmcnt(8)
  v_mfma_f32_16x16x32_bf16 v[96:99], v[192:195], v[32:35], v[96:99]
  ds_read_b64_tr_b16 v[160:161], v20 offset:49152
  buffer_load_dwordx4 v[244:247], v5, s[36:39], s51 offen offset:0
  v_mfma_f32_16x16x32_bf16 v[100:103], v[192:195], v[36:39], v[100:103]
  ds_read_b64_tr_b16 v[162:163], v20 offset:49664
  v_mfma_f32_16x16x32_bf16 v[108:111], v[196:199], v[36:39], v[108:111]
  ds_read_b64_tr_b16 v[164:165], v21 offset:49152
  v_mfma_f32_16x16x32_bf16 v[104:107], v[196:199], v[32:35], v[104:107]
  ds_read_b64_tr_b16 v[166:167], v21 offset:49664
  v_mfma_f32_16x16x32_bf16 v[112:115], v[200:203], v[32:35], v[112:115]
  ds_read_b64_tr_b16 v[168:169], v22 offset:49152
  v_mfma_f32_16x16x32_bf16 v[116:119], v[200:203], v[36:39], v[116:119]
  ds_read_b64_tr_b16 v[170:171], v22 offset:49664
  v_mfma_f32_16x16x32_bf16 v[124:127], v[204:207], v[36:39], v[124:127]
  ds_read_b64_tr_b16 v[172:173], v23 offset:49152
  v_mfma_f32_16x16x32_bf16 v[120:123], v[204:207], v[32:35], v[120:123]
  ds_read_b64_tr_b16 v[174:175], v23 offset:49664
  s_waitcnt lgkmcnt(8)
  v_mfma_f32_16x16x32_bf16 v[96:99], v[208:211], v[40:43], v[96:99]
  ds_read_b64_tr_b16 v[176:177], v20 offset:53248
  buffer_load_dwordx4 v[248:251], v4, s[36:39], s51 offen offset:1024
  v_mfma_f32_16x16x32_bf16 v[100:103], v[208:211], v[44:47], v[100:103]
  ds_read_b64_tr_b16 v[178:179], v20 offset:53760
  v_mfma_f32_16x16x32_bf16 v[108:111], v[212:215], v[44:47], v[108:111]
  ds_read_b64_tr_b16 v[180:181], v21 offset:53248
  v_mfma_f32_16x16x32_bf16 v[104:107], v[212:215], v[40:43], v[104:107]
  ds_read_b64_tr_b16 v[182:183], v21 offset:53760
  v_mfma_f32_16x16x32_bf16 v[112:115], v[216:219], v[40:43], v[112:115]
  ds_read_b64_tr_b16 v[184:185], v22 offset:53248
  v_mfma_f32_16x16x32_bf16 v[116:119], v[216:219], v[44:47], v[116:119]
  ds_read_b64_tr_b16 v[186:187], v22 offset:53760
  v_mfma_f32_16x16x32_bf16 v[124:127], v[220:223], v[44:47], v[124:127]
  ds_read_b64_tr_b16 v[188:189], v23 offset:53248
  v_mfma_f32_16x16x32_bf16 v[120:123], v[220:223], v[40:43], v[120:123]
  ds_read_b64_tr_b16 v[190:191], v23 offset:53760
  s_waitcnt vmcnt(17) lgkmcnt(8)
  v_mfma_f32_16x16x32_bf16 v[128:131], v[160:163], v[48:51], v[128:131]
  ds_read_b64_tr_b16 v[192:193], v20 offset:57344
  buffer_load_dwordx4 v[252:255], v5, s[36:39], s51 offen offset:1024
  v_mfma_f32_16x16x32_bf16 v[132:135], v[160:163], v[52:55], v[132:135]
  ds_read_b64_tr_b16 v[194:195], v20 offset:57856
  v_mfma_f32_16x16x32_bf16 v[140:143], v[164:167], v[52:55], v[140:143]
  ds_read_b64_tr_b16 v[196:197], v21 offset:57344
  v_mfma_f32_16x16x32_bf16 v[136:139], v[164:167], v[48:51], v[136:139]
  ds_read_b64_tr_b16 v[198:199], v21 offset:57856
  v_mfma_f32_16x16x32_bf16 v[144:147], v[168:171], v[48:51], v[144:147]
  ds_read_b64_tr_b16 v[200:201], v22 offset:57344
  v_mfma_f32_16x16x32_bf16 v[148:151], v[168:171], v[52:55], v[148:151]
  ds_read_b64_tr_b16 v[202:203], v22 offset:57856
  v_readlane_b32 s48, v15, 12
  v_mfma_f32_16x16x32_bf16 v[156:159], v[172:175], v[52:55], v[156:159]
  ds_read_b64_tr_b16 v[204:205], v23 offset:57344
  v_mfma_f32_16x16x32_bf16 v[152:155], v[172:175], v[48:51], v[152:155]
  ds_read_b64_tr_b16 v[206:207], v23 offset:57856
  s_waitcnt vmcnt(16) lgkmcnt(8)
  v_mfma_f32_16x16x32_bf16 v[128:131], v[176:179], v[56:59], v[128:131]
  ds_read_b64_tr_b16 v[208:209], v20 offset:61440
  buffer_load_dwordx4 v[32:35], v4, s[36:39], s48 offen offset:0
  v_mfma_f32_16x16x32_bf16 v[132:135], v[176:179], v[60:63], v[132:135]
  ds_read_b64_tr_b16 v[210:211], v20 offset:61952
  v_mfma_f32_16x16x32_bf16 v[140:143], v[180:183], v[60:63], v[140:143]
  ds_read_b64_tr_b16 v[212:213], v21 offset:61440
  v_mfma_f32_16x16x32_bf16 v[136:139], v[180:183], v[56:59], v[136:139]
  ds_read_b64_tr_b16 v[214:215], v21 offset:61952
  v_mfma_f32_16x16x32_bf16 v[144:147], v[184:187], v[56:59], v[144:147]
  ds_read_b64_tr_b16 v[216:217], v22 offset:61440
  v_mfma_f32_16x16x32_bf16 v[148:151], v[184:187], v[60:63], v[148:151]
  ds_read_b64_tr_b16 v[218:219], v22 offset:61952
  v_mfma_f32_16x16x32_bf16 v[156:159], v[188:191], v[60:63], v[156:159]
  ds_read_b64_tr_b16 v[220:221], v23 offset:61440
  v_mfma_f32_16x16x32_bf16 v[152:155], v[188:191], v[56:59], v[152:155]
  ds_read_b64_tr_b16 v[222:223], v23 offset:61952
  s_waitcnt lgkmcnt(8)
  v_mfma_f32_16x16x32_bf16 v[96:99], v[192:195], v[48:51], v[96:99]
  ds_read_b64_tr_b16 v[160:161], v26 offset:0
  buffer_load_dwordx4 v[36:39], v5, s[36:39], s48 offen offset:0
  v_mfma_f32_16x16x32_bf16 v[100:103], v[192:195], v[52:55], v[100:103]
  ds_read_b64_tr_b16 v[162:163], v26 offset:512
  v_mfma_f32_16x16x32_bf16 v[108:111], v[196:199], v[52:55], v[108:111]
  ds_read_b64_tr_b16 v[164:165], v27 offset:0
  v_mfma_f32_16x16x32_bf16 v[104:107], v[196:199], v[48:51], v[104:107]
  ds_read_b64_tr_b16 v[166:167], v27 offset:512
  v_mfma_f32_16x16x32_bf16 v[112:115], v[200:203], v[48:51], v[112:115]
  ds_read_b64_tr_b16 v[168:169], v28 offset:0
  v_mfma_f32_16x16x32_bf16 v[116:119], v[200:203], v[52:55], v[116:119]
  ds_read_b64_tr_b16 v[170:171], v28 offset:512
  v_mfma_f32_16x16x32_bf16 v[124:127], v[204:207], v[52:55], v[124:127]
  ds_read_b64_tr_b16 v[172:173], v29 offset:0
  v_mfma_f32_16x16x32_bf16 v[120:123], v[204:207], v[48:51], v[120:123]
  ds_read_b64_tr_b16 v[174:175], v29 offset:512
  s_waitcnt lgkmcnt(8)
  s_barrier
  v_mfma_f32_16x16x32_bf16 v[96:99], v[208:211], v[56:59], v[96:99]
  ds_read_b64_tr_b16 v[176:177], v26 offset:4096
  buffer_load_dwordx4 v[40:43], v4, s[36:39], s48 offen offset:1024
  v_mfma_f32_16x16x32_bf16 v[100:103], v[208:211], v[60:63], v[100:103]
  ds_read_b64_tr_b16 v[178:179], v26 offset:4608
  v_mfma_f32_16x16x32_bf16 v[108:111], v[212:215], v[60:63], v[108:111]
  ds_read_b64_tr_b16 v[180:181], v27 offset:4096
  v_mfma_f32_16x16x32_bf16 v[104:107], v[212:215], v[56:59], v[104:107]
  ds_read_b64_tr_b16 v[182:183], v27 offset:4608
  v_mfma_f32_16x16x32_bf16 v[112:115], v[216:219], v[56:59], v[112:115]
  ds_read_b64_tr_b16 v[184:185], v28 offset:4096
  v_mfma_f32_16x16x32_bf16 v[116:119], v[216:219], v[60:63], v[116:119]
  ds_read_b64_tr_b16 v[186:187], v28 offset:4608
  v_mfma_f32_16x16x32_bf16 v[124:127], v[220:223], v[60:63], v[124:127]
  ds_read_b64_tr_b16 v[188:189], v29 offset:4096
  v_mfma_f32_16x16x32_bf16 v[120:123], v[220:223], v[56:59], v[120:123]
  ds_read_b64_tr_b16 v[190:191], v29 offset:4608
  s_waitcnt vmcnt(17) lgkmcnt(8)
  v_mfma_f32_16x16x32_bf16 v[128:131], v[160:163], v[64:67], v[128:131]
  ds_read_b64_tr_b16 v[192:193], v26 offset:8192
  buffer_load_dwordx4 v[44:47], v5, s[36:39], s48 offen offset:1024
  v_mfma_f32_16x16x32_bf16 v[132:135], v[160:163], v[68:71], v[132:135]
  ds_read_b64_tr_b16 v[194:195], v26 offset:8704
  v_mfma_f32_16x16x32_bf16 v[140:143], v[164:167], v[68:71], v[140:143]
  ds_read_b64_tr_b16 v[196:197], v27 offset:8192
  v_mfma_f32_16x16x32_bf16 v[136:139], v[164:167], v[64:67], v[136:139]
  ds_read_b64_tr_b16 v[198:199], v27 offset:8704
  v_mfma_f32_16x16x32_bf16 v[144:147], v[168:171], v[64:67], v[144:147]
  ds_read_b64_tr_b16 v[200:201], v28 offset:8192
  v_mfma_f32_16x16x32_bf16 v[148:151], v[168:171], v[68:71], v[148:151]
  ds_read_b64_tr_b16 v[202:203], v28 offset:8704
  v_readlane_b32 s49, v15, 13
  v_mfma_f32_16x16x32_bf16 v[156:159], v[172:175], v[68:71], v[156:159]
  ds_read_b64_tr_b16 v[204:205], v29 offset:8192
  v_mfma_f32_16x16x32_bf16 v[152:155], v[172:175], v[64:67], v[152:155]
  ds_read_b64_tr_b16 v[206:207], v29 offset:8704
  s_waitcnt vmcnt(16) lgkmcnt(8)
  v_mfma_f32_16x16x32_bf16 v[128:131], v[176:179], v[72:75], v[128:131]
  ds_read_b64_tr_b16 v[208:209], v26 offset:12288
  buffer_load_dwordx4 v[48:51], v4, s[36:39], s49 offen offset:0
  v_mfma_f32_16x16x32_bf16 v[132:135], v[176:179], v[76:79], v[132:135]
  ds_read_b64_tr_b16 v[210:211], v26 offset:12800
  v_mfma_f32_16x16x32_bf16 v[140:143], v[180:183], v[76:79], v[140:143]
  ds_read_b64_tr_b16 v[212:213], v27 offset:12288
  v_mfma_f32_16x16x32_bf16 v[136:139], v[180:183], v[72:75], v[136:139]
  ds_read_b64_tr_b16 v[214:215], v27 offset:12800
  v_mfma_f32_16x16x32_bf16 v[144:147], v[184:187], v[72:75], v[144:147]
  ds_read_b64_tr_b16 v[216:217], v28 offset:12288
  v_mfma_f32_16x16x32_bf16 v[148:151], v[184:187], v[76:79], v[148:151]
  ds_read_b64_tr_b16 v[218:219], v28 offset:12800
  v_mfma_f32_16x16x32_bf16 v[156:159], v[188:191], v[76:79], v[156:159]
  ds_read_b64_tr_b16 v[220:221], v29 offset:12288
  v_mfma_f32_16x16x32_bf16 v[152:155], v[188:191], v[72:75], v[152:155]
  ds_read_b64_tr_b16 v[222:223], v29 offset:12800
  s_waitcnt lgkmcnt(8)
  v_mfma_f32_16x16x32_bf16 v[96:99], v[192:195], v[64:67], v[96:99]
  ds_read_b64_tr_b16 v[160:161], v26 offset:16384
  buffer_load_dwordx4 v[52:55], v5, s[36:39], s49 offen offset:0
  v_mfma_f32_16x16x32_bf16 v[100:103], v[192:195], v[68:71], v[100:103]
  ds_read_b64_tr_b16 v[162:163], v26 offset:16896
  v_mfma_f32_16x16x32_bf16 v[108:111], v[196:199], v[68:71], v[108:111]
  ds_read_b64_tr_b16 v[164:165], v27 offset:16384
  v_mfma_f32_16x16x32_bf16 v[104:107], v[196:199], v[64:67], v[104:107]
  ds_read_b64_tr_b16 v[166:167], v27 offset:16896
  v_mfma_f32_16x16x32_bf16 v[112:115], v[200:203], v[64:67], v[112:115]
  ds_read_b64_tr_b16 v[168:169], v28 offset:16384
  v_mfma_f32_16x16x32_bf16 v[116:119], v[200:203], v[68:71], v[116:119]
  ds_read_b64_tr_b16 v[170:171], v28 offset:16896
  v_mfma_f32_16x16x32_bf16 v[124:127], v[204:207], v[68:71], v[124:127]
  ds_read_b64_tr_b16 v[172:173], v29 offset:16384
  v_mfma_f32_16x16x32_bf16 v[120:123], v[204:207], v[64:67], v[120:123]
  ds_read_b64_tr_b16 v[174:175], v29 offset:16896
  s_waitcnt lgkmcnt(8)
  v_mfma_f32_16x16x32_bf16 v[96:99], v[208:211], v[72:75], v[96:99]
  ds_read_b64_tr_b16 v[176:177], v26 offset:20480
  buffer_load_dwordx4 v[56:59], v4, s[36:39], s49 offen offset:1024
  v_mfma_f32_16x16x32_bf16 v[100:103], v[208:211], v[76:79], v[100:103]
  ds_read_b64_tr_b16 v[178:179], v26 offset:20992
  v_mfma_f32_16x16x32_bf16 v[108:111], v[212:215], v[76:79], v[108:111]
  ds_read_b64_tr_b16 v[180:181], v27 offset:20480
  v_mfma_f32_16x16x32_bf16 v[104:107], v[212:215], v[72:75], v[104:107]
  ds_read_b64_tr_b16 v[182:183], v27 offset:20992
  v_mfma_f32_16x16x32_bf16 v[112:115], v[216:219], v[72:75], v[112:115]
  ds_read_b64_tr_b16 v[184:185], v28 offset:20480
  v_mfma_f32_16x16x32_bf16 v[116:119], v[216:219], v[76:79], v[116:119]
  ds_read_b64_tr_b16 v[186:187], v28 offset:20992
  v_mfma_f32_16x16x32_bf16 v[124:127], v[220:223], v[76:79], v[124:127]
  ds_read_b64_tr_b16 v[188:189], v29 offset:20480
  v_mfma_f32_16x16x32_bf16 v[120:123], v[220:223], v[72:75], v[120:123]
  ds_read_b64_tr_b16 v[190:191], v29 offset:20992
  s_waitcnt vmcnt(17) lgkmcnt(8)
  v_mfma_f32_16x16x32_bf16 v[128:131], v[160:163], v[80:83], v[128:131]
  ds_read_b64_tr_b16 v[192:193], v26 offset:24576
  buffer_load_dwordx4 v[60:63], v5, s[36:39], s49 offen offset:1024
  v_mfma_f32_16x16x32_bf16 v[132:135], v[160:163], v[84:87], v[132:135]
  ds_read_b64_tr_b16 v[194:195], v26 offset:25088
  v_mfma_f32_16x16x32_bf16 v[140:143], v[164:167], v[84:87], v[140:143]
  ds_read_b64_tr_b16 v[196:197], v27 offset:24576
  v_mfma_f32_16x16x32_bf16 v[136:139], v[164:167], v[80:83], v[136:139]
  ds_read_b64_tr_b16 v[198:199], v27 offset:25088
  v_mfma_f32_16x16x32_bf16 v[144:147], v[168:171], v[80:83], v[144:147]
  ds_read_b64_tr_b16 v[200:201], v28 offset:24576
  v_mfma_f32_16x16x32_bf16 v[148:151], v[168:171], v[84:87], v[148:151]
  ds_read_b64_tr_b16 v[202:203], v28 offset:25088
  v_readlane_b32 s50, v15, 14
  v_mfma_f32_16x16x32_bf16 v[156:159], v[172:175], v[84:87], v[156:159]
  ds_read_b64_tr_b16 v[204:205], v29 offset:24576
  v_mfma_f32_16x16x32_bf16 v[152:155], v[172:175], v[80:83], v[152:155]
  ds_read_b64_tr_b16 v[206:207], v29 offset:25088
  s_waitcnt vmcnt(16) lgkmcnt(8)
  v_mfma_f32_16x16x32_bf16 v[128:131], v[176:179], v[88:91], v[128:131]
  ds_read_b64_tr_b16 v[208:209], v26 offset:28672
  buffer_load_dwordx4 v[64:67], v4, s[36:39], s50 offen offset:0
  v_mfma_f32_16x16x32_bf16 v[132:135], v[176:179], v[92:95], v[132:135]
  ds_read_b64_tr_b16 v[210:211], v26 offset:29184
  v_mfma_f32_16x16x32_bf16 v[140:143], v[180:183], v[92:95], v[140:143]
  ds_read_b64_tr_b16 v[212:213], v27 offset:28672
  v_mfma_f32_16x16x32_bf16 v[136:139], v[180:183], v[88:91], v[136:139]
  ds_read_b64_tr_b16 v[214:215], v27 offset:29184
  v_mfma_f32_16x16x32_bf16 v[144:147], v[184:187], v[88:91], v[144:147]
  ds_read_b64_tr_b16 v[216:217], v28 offset:28672
  v_mfma_f32_16x16x32_bf16 v[148:151], v[184:187], v[92:95], v[148:151]
  ds_read_b64_tr_b16 v[218:219], v28 offset:29184
  v_mfma_f32_16x16x32_bf16 v[156:159], v[188:191], v[92:95], v[156:159]
  ds_read_b64_tr_b16 v[220:221], v29 offset:28672
  v_mfma_f32_16x16x32_bf16 v[152:155], v[188:191], v[88:91], v[152:155]
  ds_read_b64_tr_b16 v[222:223], v29 offset:29184
  s_waitcnt lgkmcnt(8)
  v_mfma_f32_16x16x32_bf16 v[96:99], v[192:195], v[80:83], v[96:99]
  ds_read_b64_tr_b16 v[160:161], v6 offset:0
  buffer_load_dwordx4 v[68:71], v5, s[36:39], s50 offen offset:0
  v_mfma_f32_16x16x32_bf16 v[100:103], v[192:195], v[84:87], v[100:103]
  ds_read_b64_tr_b16 v[162:163], v6 offset:512
  v_mfma_f32_16x16x32_bf16 v[108:111], v[196:199], v[84:87], v[108:111]
  ds_read_b64_tr_b16 v[164:165], v7 offset:0
  v_mfma_f32_16x16x32_bf16 v[104:107], v[196:199], v[80:83], v[104:107]
  ds_read_b64_tr_b16 v[166:167], v7 offset:512
  v_mfma_f32_16x16x32_bf16 v[112:115], v[200:203], v[80:83], v[112:115]
  ds_read_b64_tr_b16 v[168:169], v8 offset:0
  v_mfma_f32_16x16x32_bf16 v[116:119], v[200:203], v[84:87], v[116:119]
  ds_read_b64_tr_b16 v[170:171], v8 offset:512
  v_mfma_f32_16x16x32_bf16 v[124:127], v[204:207], v[84:87], v[124:127]
  ds_read_b64_tr_b16 v[172:173], v9 offset:0
  v_mfma_f32_16x16x32_bf16 v[120:123], v[204:207], v[80:83], v[120:123]
  ds_read_b64_tr_b16 v[174:175], v9 offset:512
  s_waitcnt lgkmcnt(8)
  s_barrier
  v_mfma_f32_16x16x32_bf16 v[96:99], v[208:211], v[88:91], v[96:99]
  ds_read_b64_tr_b16 v[176:177], v6 offset:4096
  buffer_load_dwordx4 v[72:75], v4, s[36:39], s50 offen offset:1024
  v_mfma_f32_16x16x32_bf16 v[100:103], v[208:211], v[92:95], v[100:103]
  ds_read_b64_tr_b16 v[178:179], v6 offset:4608
  v_mfma_f32_16x16x32_bf16 v[108:111], v[212:215], v[92:95], v[108:111]
  ds_read_b64_tr_b16 v[180:181], v7 offset:4096
  v_mfma_f32_16x16x32_bf16 v[104:107], v[212:215], v[88:91], v[104:107]
  ds_read_b64_tr_b16 v[182:183], v7 offset:4608
  v_mfma_f32_16x16x32_bf16 v[112:115], v[216:219], v[88:91], v[112:115]
  ds_read_b64_tr_b16 v[184:185], v8 offset:4096
  v_mfma_f32_16x16x32_bf16 v[116:119], v[216:219], v[92:95], v[116:119]
  ds_read_b64_tr_b16 v[186:187], v8 offset:4608
  v_mfma_f32_16x16x32_bf16 v[124:127], v[220:223], v[92:95], v[124:127]
  ds_read_b64_tr_b16 v[188:189], v9 offset:4096
  v_mfma_f32_16x16x32_bf16 v[120:123], v[220:223], v[88:91], v[120:123]
  ds_read_b64_tr_b16 v[190:191], v9 offset:4608
  s_waitcnt vmcnt(17) lgkmcnt(8)
  v_mfma_f32_16x16x32_bf16 v[128:131], v[160:163], v[224:227], v[128:131]
  ds_read_b64_tr_b16 v[192:193], v6 offset:8192
  buffer_load_dwordx4 v[76:79], v5, s[36:39], s50 offen offset:1024
  v_mfma_f32_16x16x32_bf16 v[132:135], v[160:163], v[228:231], v[132:135]
  ds_read_b64_tr_b16 v[194:195], v6 offset:8704
  v_mfma_f32_16x16x32_bf16 v[140:143], v[164:167], v[228:231], v[140:143]
  ds_read_b64_tr_b16 v[196:197], v7 offset:8192
  v_mfma_f32_16x16x32_bf16 v[136:139], v[164:167], v[224:227], v[136:139]
  ds_read_b64_tr_b16 v[198:199], v7 offset:8704
  v_mfma_f32_16x16x32_bf16 v[144:147], v[168:171], v[224:227], v[144:147]
  ds_read_b64_tr_b16 v[200:201], v8 offset:8192
  v_mfma_f32_16x16x32_bf16 v[148:151], v[168:171], v[228:231], v[148:151]
  ds_read_b64_tr_b16 v[202:203], v8 offset:8704
  v_readlane_b32 s51, v15, 15
  v_mfma_f32_16x16x32_bf16 v[156:159], v[172:175], v[228:231], v[156:159]
  ds_read_b64_tr_b16 v[204:205], v9 offset:8192
  v_mfma_f32_16x16x32_bf16 v[152:155], v[172:175], v[224:227], v[152:155]
  ds_read_b64_tr_b16 v[206:207], v9 offset:8704
  s_waitcnt vmcnt(16) lgkmcnt(8)
  v_mfma_f32_16x16x32_bf16 v[128:131], v[176:179], v[232:235], v[128:131]
  ds_read_b64_tr_b16 v[208:209], v6 offset:12288
  buffer_load_dwordx4 v[80:83], v4, s[36:39], s51 offen offset:0
  v_mfma_f32_16x16x32_bf16 v[132:135], v[176:179], v[236:239], v[132:135]
  ds_read_b64_tr_b16 v[210:211], v6 offset:12800
  v_mfma_f32_16x16x32_bf16 v[140:143], v[180:183], v[236:239], v[140:143]
  ds_read_b64_tr_b16 v[212:213], v7 offset:12288
  v_mfma_f32_16x16x32_bf16 v[136:139], v[180:183], v[232:235], v[136:139]
  ds_read_b64_tr_b16 v[214:215], v7 offset:12800
  v_mfma_f32_16x16x32_bf16 v[144:147], v[184:187], v[232:235], v[144:147]
  ds_read_b64_tr_b16 v[216:217], v8 offset:12288
  v_mfma_f32_16x16x32_bf16 v[148:151], v[184:187], v[236:239], v[148:151]
  ds_read_b64_tr_b16 v[218:219], v8 offset:12800
  v_mfma_f32_16x16x32_bf16 v[156:159], v[188:191], v[236:239], v[156:159]
  ds_read_b64_tr_b16 v[220:221], v9 offset:12288
  v_mfma_f32_16x16x32_bf16 v[152:155], v[188:191], v[232:235], v[152:155]
  ds_read_b64_tr_b16 v[222:223], v9 offset:12800
  s_waitcnt lgkmcnt(8)
  v_mfma_f32_16x16x32_bf16 v[96:99], v[192:195], v[224:227], v[96:99]
  ds_read_b64_tr_b16 v[160:161], v6 offset:16384
  buffer_load_dwordx4 v[84:87], v5, s[36:39], s51 offen offset:0
  v_mfma_f32_16x16x32_bf16 v[100:103], v[192:195], v[228:231], v[100:103]
  ds_read_b64_tr_b16 v[162:163], v6 offset:16896
  v_mfma_f32_16x16x32_bf16 v[108:111], v[196:199], v[228:231], v[108:111]
  ds_read_b64_tr_b16 v[164:165], v7 offset:16384
  v_mfma_f32_16x16x32_bf16 v[104:107], v[196:199], v[224:227], v[104:107]
  ds_read_b64_tr_b16 v[166:167], v7 offset:16896
  v_mfma_f32_16x16x32_bf16 v[112:115], v[200:203], v[224:227], v[112:115]
  ds_read_b64_tr_b16 v[168:169], v8 offset:16384
  v_mfma_f32_16x16x32_bf16 v[116:119], v[200:203], v[228:231], v[116:119]
  ds_read_b64_tr_b16 v[170:171], v8 offset:16896
  v_mfma_f32_16x16x32_bf16 v[124:127], v[204:207], v[228:231], v[124:127]
  ds_read_b64_tr_b16 v[172:173], v9 offset:16384
  v_mfma_f32_16x16x32_bf16 v[120:123], v[204:207], v[224:227], v[120:123]
  ds_read_b64_tr_b16 v[174:175], v9 offset:16896
  s_waitcnt lgkmcnt(8)
  v_mfma_f32_16x16x32_bf16 v[96:99], v[208:211], v[232:235], v[96:99]
  ds_read_b64_tr_b16 v[176:177], v6 offset:20480
  buffer_load_dwordx4 v[88:91], v4, s[36:39], s51 offen offset:1024
  v_mfma_f32_16x16x32_bf16 v[100:103], v[208:211], v[236:239], v[100:103]
  ds_read_b64_tr_b16 v[178:179], v6 offset:20992
  v_mfma_f32_16x16x32_bf16 v[108:111], v[212:215], v[236:239], v[108:111]
  ds_read_b64_tr_b16 v[180:181], v7 offset:20480
  v_mfma_f32_16x16x32_bf16 v[104:107], v[212:215], v[232:235], v[104:107]
  ds_read_b64_tr_b16 v[182:183], v7 offset:20992
  v_mfma_f32_16x16x32_bf16 v[112:115], v[216:219], v[232:235], v[112:115]
  ds_read_b64_tr_b16 v[184:185], v8 offset:20480
  v_mfma_f32_16x16x32_bf16 v[116:119], v[216:219], v[236:239], v[116:119]
  ds_read_b64_tr_b16 v[186:187], v8 offset:20992
  v_mfma_f32_16x16x32_bf16 v[124:127], v[220:223], v[236:239], v[124:127]
  ds_read_b64_tr_b16 v[188:189], v9 offset:20480
  v_mfma_f32_16x16x32_bf16 v[120:123], v[220:223], v[232:235], v[120:123]
  ds_read_b64_tr_b16 v[190:191], v9 offset:20992
  s_waitcnt vmcnt(17) lgkmcnt(8)
  v_mfma_f32_16x16x32_bf16 v[128:131], v[160:163], v[240:243], v[128:131]
  ds_read_b64_tr_b16 v[192:193], v6 offset:24576
  buffer_load_dwordx4 v[92:95], v5, s[36:39], s51 offen offset:1024
  v_mfma_f32_16x16x32_bf16 v[132:135], v[160:163], v[244:247], v[132:135]
  ds_read_b64_tr_b16 v[194:195], v6 offset:25088
  v_mfma_f32_16x16x32_bf16 v[140:143], v[164:167], v[244:247], v[140:143]
  ds_read_b64_tr_b16 v[196:197], v7 offset:24576
  v_mfma_f32_16x16x32_bf16 v[136:139], v[164:167], v[240:243], v[136:139]
  ds_read_b64_tr_b16 v[198:199], v7 offset:25088
  v_mfma_f32_16x16x32_bf16 v[144:147], v[168:171], v[240:243], v[144:147]
  ds_read_b64_tr_b16 v[200:201], v8 offset:24576
  v_mfma_f32_16x16x32_bf16 v[148:151], v[168:171], v[244:247], v[148:151]
  ds_read_b64_tr_b16 v[202:203], v8 offset:25088
  v_readlane_b32 s48, v15, 16
  v_mfma_f32_16x16x32_bf16 v[156:159], v[172:175], v[244:247], v[156:159]
  ds_read_b64_tr_b16 v[204:205], v9 offset:24576
  v_mfma_f32_16x16x32_bf16 v[152:155], v[172:175], v[240:243], v[152:155]
  ds_read_b64_tr_b16 v[206:207], v9 offset:25088
  s_waitcnt vmcnt(16) lgkmcnt(8)
  v_mfma_f32_16x16x32_bf16 v[128:131], v[176:179], v[248:251], v[128:131]
  ds_read_b64_tr_b16 v[208:209], v6 offset:28672
  buffer_load_dwordx4 v[224:227], v4, s[36:39], s48 offen offset:0
  v_mfma_f32_16x16x32_bf16 v[132:135], v[176:179], v[252:255], v[132:135]
  ds_read_b64_tr_b16 v[210:211], v6 offset:29184
  v_mfma_f32_16x16x32_bf16 v[140:143], v[180:183], v[252:255], v[140:143]
  ds_read_b64_tr_b16 v[212:213], v7 offset:28672
  v_mfma_f32_16x16x32_bf16 v[136:139], v[180:183], v[248:251], v[136:139]
  ds_read_b64_tr_b16 v[214:215], v7 offset:29184
  v_mfma_f32_16x16x32_bf16 v[144:147], v[184:187], v[248:251], v[144:147]
  ds_read_b64_tr_b16 v[216:217], v8 offset:28672
  v_mfma_f32_16x16x32_bf16 v[148:151], v[184:187], v[252:255], v[148:151]
  ds_read_b64_tr_b16 v[218:219], v8 offset:29184
  v_mfma_f32_16x16x32_bf16 v[156:159], v[188:191], v[252:255], v[156:159]
  ds_read_b64_tr_b16 v[220:221], v9 offset:28672
  v_mfma_f32_16x16x32_bf16 v[152:155], v[188:191], v[248:251], v[152:155]
  ds_read_b64_tr_b16 v[222:223], v9 offset:29184
  s_waitcnt lgkmcnt(8)
  v_mfma_f32_16x16x32_bf16 v[96:99], v[192:195], v[240:243], v[96:99]
  ds_read_b64_tr_b16 v[160:161], v6 offset:32768
  buffer_load_dwordx4 v[228:231], v5, s[36:39], s48 offen offset:0
  v_mfma_f32_16x16x32_bf16 v[100:103], v[192:195], v[244:247], v[100:103]
  ds_read_b64_tr_b16 v[162:163], v6 offset:33280
  v_mfma_f32_16x16x32_bf16 v[108:111], v[196:199], v[244:247], v[108:111]
  ds_read_b64_tr_b16 v[164:165], v7 offset:32768
  v_mfma_f32_16x16x32_bf16 v[104:107], v[196:199], v[240:243], v[104:107]
  ds_read_b64_tr_b16 v[166:167], v7 offset:33280
  v_mfma_f32_16x16x32_bf16 v[112:115], v[200:203], v[240:243], v[112:115]
  ds_read_b64_tr_b16 v[168:169], v8 offset:32768
  v_mfma_f32_16x16x32_bf16 v[116:119], v[200:203], v[244:247], v[116:119]
  ds_read_b64_tr_b16 v[170:171], v8 offset:33280
  v_mfma_f32_16x16x32_bf16 v[124:127], v[204:207], v[244:247], v[124:127]
  ds_read_b64_tr_b16 v[172:173], v9 offset:32768
  v_mfma_f32_16x16x32_bf16 v[120:123], v[204:207], v[240:243], v[120:123]
  ds_read_b64_tr_b16 v[174:175], v9 offset:33280
  s_waitcnt lgkmcnt(8)
  s_barrier
  v_mfma_f32_16x16x32_bf16 v[96:99], v[208:211], v[248:251], v[96:99]
  ds_read_b64_tr_b16 v[176:177], v6 offset:36864
  buffer_load_dwordx4 v[232:235], v4, s[36:39], s48 offen offset:1024
  v_mfma_f32_16x16x32_bf16 v[100:103], v[208:211], v[252:255], v[100:103]
  ds_read_b64_tr_b16 v[178:179], v6 offset:37376
  v_mfma_f32_16x16x32_bf16 v[108:111], v[212:215], v[252:255], v[108:111]
  ds_read_b64_tr_b16 v[180:181], v7 offset:36864
  v_mfma_f32_16x16x32_bf16 v[104:107], v[212:215], v[248:251], v[104:107]
  ds_read_b64_tr_b16 v[182:183], v7 offset:37376
  v_mfma_f32_16x16x32_bf16 v[112:115], v[216:219], v[248:251], v[112:115]
  ds_read_b64_tr_b16 v[184:185], v8 offset:36864
  v_mfma_f32_16x16x32_bf16 v[116:119], v[216:219], v[252:255], v[116:119]
  ds_read_b64_tr_b16 v[186:187], v8 offset:37376
  v_mfma_f32_16x16x32_bf16 v[124:127], v[220:223], v[252:255], v[124:127]
  ds_read_b64_tr_b16 v[188:189], v9 offset:36864
  v_mfma_f32_16x16x32_bf16 v[120:123], v[220:223], v[248:251], v[120:123]
  ds_read_b64_tr_b16 v[190:191], v9 offset:37376
  s_waitcnt vmcnt(17) lgkmcnt(8)
  v_mfma_f32_16x16x32_bf16 v[128:131], v[160:163], v[32:35], v[128:131]
  ds_read_b64_tr_b16 v[192:193], v6 offset:40960
  buffer_load_dwordx4 v[236:239], v5, s[36:39], s48 offen offset:1024
  v_mfma_f32_16x16x32_bf16 v[132:135], v[160:163], v[36:39], v[132:135]
  ds_read_b64_tr_b16 v[194:195], v6 offset:41472
  v_mfma_f32_16x16x32_bf16 v[140:143], v[164:167], v[36:39], v[140:143]
  ds_read_b64_tr_b16 v[196:197], v7 offset:40960
  v_mfma_f32_16x16x32_bf16 v[136:139], v[164:167], v[32:35], v[136:139]
  ds_read_b64_tr_b16 v[198:199], v7 offset:41472
  v_mfma_f32_16x16x32_bf16 v[144:147], v[168:171], v[32:35], v[144:147]
  ds_read_b64_tr_b16 v[200:201], v8 offset:40960
  v_mfma_f32_16x16x32_bf16 v[148:151], v[168:171], v[36:39], v[148:151]
  ds_read_b64_tr_b16 v[202:203], v8 offset:41472
  v_readlane_b32 s49, v15, 17
  v_mfma_f32_16x16x32_bf16 v[156:159], v[172:175], v[36:39], v[156:159]
  ds_read_b64_tr_b16 v[204:205], v9 offset:40960
  v_mfma_f32_16x16x32_bf16 v[152:155], v[172:175], v[32:35], v[152:155]
  ds_read_b64_tr_b16 v[206:207], v9 offset:41472
  s_waitcnt vmcnt(16) lgkmcnt(8)
  v_mfma_f32_16x16x32_bf16 v[128:131], v[176:179], v[40:43], v[128:131]
  ds_read_b64_tr_b16 v[208:209], v6 offset:45056
  buffer_load_dwordx4 v[240:243], v4, s[36:39], s49 offen offset:0
  v_mfma_f32_16x16x32_bf16 v[132:135], v[176:179], v[44:47], v[132:135]
  ds_read_b64_tr_b16 v[210:211], v6 offset:45568
  v_mfma_f32_16x16x32_bf16 v[140:143], v[180:183], v[44:47], v[140:143]
  ds_read_b64_tr_b16 v[212:213], v7 offset:45056
  v_mfma_f32_16x16x32_bf16 v[136:139], v[180:183], v[40:43], v[136:139]
  ds_read_b64_tr_b16 v[214:215], v7 offset:45568
  v_mfma_f32_16x16x32_bf16 v[144:147], v[184:187], v[40:43], v[144:147]
  ds_read_b64_tr_b16 v[216:217], v8 offset:45056
  v_mfma_f32_16x16x32_bf16 v[148:151], v[184:187], v[44:47], v[148:151]
  ds_read_b64_tr_b16 v[218:219], v8 offset:45568
  v_mfma_f32_16x16x32_bf16 v[156:159], v[188:191], v[44:47], v[156:159]
  ds_read_b64_tr_b16 v[220:221], v9 offset:45056
  v_mfma_f32_16x16x32_bf16 v[152:155], v[188:191], v[40:43], v[152:155]
  ds_read_b64_tr_b16 v[222:223], v9 offset:45568
  s_waitcnt lgkmcnt(8)
  v_mfma_f32_16x16x32_bf16 v[96:99], v[192:195], v[32:35], v[96:99]
  ds_read_b64_tr_b16 v[160:161], v6 offset:49152
  buffer_load_dwordx4 v[244:247], v5, s[36:39], s49 offen offset:0
  v_mfma_f32_16x16x32_bf16 v[100:103], v[192:195], v[36:39], v[100:103]
  ds_read_b64_tr_b16 v[162:163], v6 offset:49664
  v_mfma_f32_16x16x32_bf16 v[108:111], v[196:199], v[36:39], v[108:111]
  ds_read_b64_tr_b16 v[164:165], v7 offset:49152
  v_mfma_f32_16x16x32_bf16 v[104:107], v[196:199], v[32:35], v[104:107]
  ds_read_b64_tr_b16 v[166:167], v7 offset:49664
  v_mfma_f32_16x16x32_bf16 v[112:115], v[200:203], v[32:35], v[112:115]
  ds_read_b64_tr_b16 v[168:169], v8 offset:49152
  v_mfma_f32_16x16x32_bf16 v[116:119], v[200:203], v[36:39], v[116:119]
  ds_read_b64_tr_b16 v[170:171], v8 offset:49664
  v_mfma_f32_16x16x32_bf16 v[124:127], v[204:207], v[36:39], v[124:127]
  ds_read_b64_tr_b16 v[172:173], v9 offset:49152
  v_mfma_f32_16x16x32_bf16 v[120:123], v[204:207], v[32:35], v[120:123]
  ds_read_b64_tr_b16 v[174:175], v9 offset:49664
  s_waitcnt lgkmcnt(8)
  v_mfma_f32_16x16x32_bf16 v[96:99], v[208:211], v[40:43], v[96:99]
  ds_read_b64_tr_b16 v[176:177], v6 offset:53248
  buffer_load_dwordx4 v[248:251], v4, s[36:39], s49 offen offset:1024
  v_mfma_f32_16x16x32_bf16 v[100:103], v[208:211], v[44:47], v[100:103]
  ds_read_b64_tr_b16 v[178:179], v6 offset:53760
  v_mfma_f32_16x16x32_bf16 v[108:111], v[212:215], v[44:47], v[108:111]
  ds_read_b64_tr_b16 v[180:181], v7 offset:53248
  v_mfma_f32_16x16x32_bf16 v[104:107], v[212:215], v[40:43], v[104:107]
  ds_read_b64_tr_b16 v[182:183], v7 offset:53760
  v_mfma_f32_16x16x32_bf16 v[112:115], v[216:219], v[40:43], v[112:115]
  ds_read_b64_tr_b16 v[184:185], v8 offset:53248
  v_mfma_f32_16x16x32_bf16 v[116:119], v[216:219], v[44:47], v[116:119]
  ds_read_b64_tr_b16 v[186:187], v8 offset:53760
  v_mfma_f32_16x16x32_bf16 v[124:127], v[220:223], v[44:47], v[124:127]
  ds_read_b64_tr_b16 v[188:189], v9 offset:53248
  v_mfma_f32_16x16x32_bf16 v[120:123], v[220:223], v[40:43], v[120:123]
  ds_read_b64_tr_b16 v[190:191], v9 offset:53760
  s_waitcnt vmcnt(17) lgkmcnt(8)
  v_mfma_f32_16x16x32_bf16 v[128:131], v[160:163], v[48:51], v[128:131]
  ds_read_b64_tr_b16 v[192:193], v6 offset:57344
  buffer_load_dwordx4 v[252:255], v5, s[36:39], s49 offen offset:1024
  v_mfma_f32_16x16x32_bf16 v[132:135], v[160:163], v[52:55], v[132:135]
  ds_read_b64_tr_b16 v[194:195], v6 offset:57856
  v_mfma_f32_16x16x32_bf16 v[140:143], v[164:167], v[52:55], v[140:143]
  ds_read_b64_tr_b16 v[196:197], v7 offset:57344
  v_mfma_f32_16x16x32_bf16 v[136:139], v[164:167], v[48:51], v[136:139]
  ds_read_b64_tr_b16 v[198:199], v7 offset:57856
  v_mfma_f32_16x16x32_bf16 v[144:147], v[168:171], v[48:51], v[144:147]
  ds_read_b64_tr_b16 v[200:201], v8 offset:57344
  v_mfma_f32_16x16x32_bf16 v[148:151], v[168:171], v[52:55], v[148:151]
  ds_read_b64_tr_b16 v[202:203], v8 offset:57856
  v_readlane_b32 s50, v15, 18
  v_mfma_f32_16x16x32_bf16 v[156:159], v[172:175], v[52:55], v[156:159]
  ds_read_b64_tr_b16 v[204:205], v9 offset:57344
  v_mfma_f32_16x16x32_bf16 v[152:155], v[172:175], v[48:51], v[152:155]
  ds_read_b64_tr_b16 v[206:207], v9 offset:57856
  s_waitcnt vmcnt(16) lgkmcnt(8)
  v_mfma_f32_16x16x32_bf16 v[128:131], v[176:179], v[56:59], v[128:131]
  ds_read_b64_tr_b16 v[208:209], v6 offset:61440
  buffer_load_dwordx4 v[32:35], v4, s[36:39], s50 offen offset:0
  v_mfma_f32_16x16x32_bf16 v[132:135], v[176:179], v[60:63], v[132:135]
  ds_read_b64_tr_b16 v[210:211], v6 offset:61952
  v_mfma_f32_16x16x32_bf16 v[140:143], v[180:183], v[60:63], v[140:143]
  ds_read_b64_tr_b16 v[212:213], v7 offset:61440
  v_mfma_f32_16x16x32_bf16 v[136:139], v[180:183], v[56:59], v[136:139]
  ds_read_b64_tr_b16 v[214:215], v7 offset:61952
  v_mfma_f32_16x16x32_bf16 v[144:147], v[184:187], v[56:59], v[144:147]
  ds_read_b64_tr_b16 v[216:217], v8 offset:61440
  v_mfma_f32_16x16x32_bf16 v[148:151], v[184:187], v[60:63], v[148:151]
  ds_read_b64_tr_b16 v[218:219], v8 offset:61952
  v_mfma_f32_16x16x32_bf16 v[156:159], v[188:191], v[60:63], v[156:159]
  ds_read_b64_tr_b16 v[220:221], v9 offset:61440
  v_mfma_f32_16x16x32_bf16 v[152:155], v[188:191], v[56:59], v[152:155]
  ds_read_b64_tr_b16 v[222:223], v9 offset:61952
  s_waitcnt lgkmcnt(8)
  v_mfma_f32_16x16x32_bf16 v[96:99], v[192:195], v[48:51], v[96:99]
  ds_read_b64_tr_b16 v[160:161], v20 offset:0
  buffer_load_dwordx4 v[36:39], v5, s[36:39], s50 offen offset:0
  v_mfma_f32_16x16x32_bf16 v[100:103], v[192:195], v[52:55], v[100:103]
  ds_read_b64_tr_b16 v[162:163], v20 offset:512
  v_mfma_f32_16x16x32_bf16 v[108:111], v[196:199], v[52:55], v[108:111]
  ds_read_b64_tr_b16 v[164:165], v21 offset:0
  v_mfma_f32_16x16x32_bf16 v[104:107], v[196:199], v[48:51], v[104:107]
  ds_read_b64_tr_b16 v[166:167], v21 offset:512
  v_mfma_f32_16x16x32_bf16 v[112:115], v[200:203], v[48:51], v[112:115]
  ds_read_b64_tr_b16 v[168:169], v22 offset:0
  v_mfma_f32_16x16x32_bf16 v[116:119], v[200:203], v[52:55], v[116:119]
  ds_read_b64_tr_b16 v[170:171], v22 offset:512
  v_mfma_f32_16x16x32_bf16 v[124:127], v[204:207], v[52:55], v[124:127]
  ds_read_b64_tr_b16 v[172:173], v23 offset:0
  v_mfma_f32_16x16x32_bf16 v[120:123], v[204:207], v[48:51], v[120:123]
  ds_read_b64_tr_b16 v[174:175], v23 offset:512
  s_waitcnt lgkmcnt(8)
  s_barrier
  v_mfma_f32_16x16x32_bf16 v[96:99], v[208:211], v[56:59], v[96:99]
  ds_read_b64_tr_b16 v[176:177], v20 offset:4096
  buffer_load_dwordx4 v[40:43], v4, s[36:39], s50 offen offset:1024
  v_mfma_f32_16x16x32_bf16 v[100:103], v[208:211], v[60:63], v[100:103]
  ds_read_b64_tr_b16 v[178:179], v20 offset:4608
  v_mfma_f32_16x16x32_bf16 v[108:111], v[212:215], v[60:63], v[108:111]
  ds_read_b64_tr_b16 v[180:181], v21 offset:4096
  v_mfma_f32_16x16x32_bf16 v[104:107], v[212:215], v[56:59], v[104:107]
  ds_read_b64_tr_b16 v[182:183], v21 offset:4608
  v_mfma_f32_16x16x32_bf16 v[112:115], v[216:219], v[56:59], v[112:115]
  ds_read_b64_tr_b16 v[184:185], v22 offset:4096
  v_mfma_f32_16x16x32_bf16 v[116:119], v[216:219], v[60:63], v[116:119]
  ds_read_b64_tr_b16 v[186:187], v22 offset:4608
  v_mfma_f32_16x16x32_bf16 v[124:127], v[220:223], v[60:63], v[124:127]
  ds_read_b64_tr_b16 v[188:189], v23 offset:4096
  v_mfma_f32_16x16x32_bf16 v[120:123], v[220:223], v[56:59], v[120:123]
  ds_read_b64_tr_b16 v[190:191], v23 offset:4608
  s_waitcnt vmcnt(17) lgkmcnt(8)
  v_mfma_f32_16x16x32_bf16 v[128:131], v[160:163], v[64:67], v[128:131]
  ds_read_b64_tr_b16 v[192:193], v20 offset:8192
  buffer_load_dwordx4 v[44:47], v5, s[36:39], s50 offen offset:1024
  v_mfma_f32_16x16x32_bf16 v[132:135], v[160:163], v[68:71], v[132:135]
  ds_read_b64_tr_b16 v[194:195], v20 offset:8704
  v_mfma_f32_16x16x32_bf16 v[140:143], v[164:167], v[68:71], v[140:143]
  ds_read_b64_tr_b16 v[196:197], v21 offset:8192
  v_mfma_f32_16x16x32_bf16 v[136:139], v[164:167], v[64:67], v[136:139]
  ds_read_b64_tr_b16 v[198:199], v21 offset:8704
  v_mfma_f32_16x16x32_bf16 v[144:147], v[168:171], v[64:67], v[144:147]
  ds_read_b64_tr_b16 v[200:201], v22 offset:8192
  v_mfma_f32_16x16x32_bf16 v[148:151], v[168:171], v[68:71], v[148:151]
  ds_read_b64_tr_b16 v[202:203], v22 offset:8704
  v_readlane_b32 s51, v15, 19
  v_mfma_f32_16x16x32_bf16 v[156:159], v[172:175], v[68:71], v[156:159]
  ds_read_b64_tr_b16 v[204:205], v23 offset:8192
  v_mfma_f32_16x16x32_bf16 v[152:155], v[172:175], v[64:67], v[152:155]
  ds_read_b64_tr_b16 v[206:207], v23 offset:8704
  s_waitcnt vmcnt(16) lgkmcnt(8)
  v_mfma_f32_16x16x32_bf16 v[128:131], v[176:179], v[72:75], v[128:131]
  ds_read_b64_tr_b16 v[208:209], v20 offset:12288
  buffer_load_dwordx4 v[48:51], v4, s[36:39], s51 offen offset:0
  v_mfma_f32_16x16x32_bf16 v[132:135], v[176:179], v[76:79], v[132:135]
  ds_read_b64_tr_b16 v[210:211], v20 offset:12800
  v_mfma_f32_16x16x32_bf16 v[140:143], v[180:183], v[76:79], v[140:143]
  ds_read_b64_tr_b16 v[212:213], v21 offset:12288
  v_mfma_f32_16x16x32_bf16 v[136:139], v[180:183], v[72:75], v[136:139]
  ds_read_b64_tr_b16 v[214:215], v21 offset:12800
  v_mfma_f32_16x16x32_bf16 v[144:147], v[184:187], v[72:75], v[144:147]
  ds_read_b64_tr_b16 v[216:217], v22 offset:12288
  v_mfma_f32_16x16x32_bf16 v[148:151], v[184:187], v[76:79], v[148:151]
  ds_read_b64_tr_b16 v[218:219], v22 offset:12800
  v_mfma_f32_16x16x32_bf16 v[156:159], v[188:191], v[76:79], v[156:159]
  ds_read_b64_tr_b16 v[220:221], v23 offset:12288
  v_mfma_f32_16x16x32_bf16 v[152:155], v[188:191], v[72:75], v[152:155]
  ds_read_b64_tr_b16 v[222:223], v23 offset:12800
  s_waitcnt lgkmcnt(8)
  v_mfma_f32_16x16x32_bf16 v[96:99], v[192:195], v[64:67], v[96:99]
  ds_read_b64_tr_b16 v[160:161], v20 offset:16384
  buffer_load_dwordx4 v[52:55], v5, s[36:39], s51 offen offset:0
  v_mfma_f32_16x16x32_bf16 v[100:103], v[192:195], v[68:71], v[100:103]
  ds_read_b64_tr_b16 v[162:163], v20 offset:16896
  v_mfma_f32_16x16x32_bf16 v[108:111], v[196:199], v[68:71], v[108:111]
  ds_read_b64_tr_b16 v[164:165], v21 offset:16384
  v_mfma_f32_16x16x32_bf16 v[104:107], v[196:199], v[64:67], v[104:107]
  ds_read_b64_tr_b16 v[166:167], v21 offset:16896
  v_mfma_f32_16x16x32_bf16 v[112:115], v[200:203], v[64:67], v[112:115]
  ds_read_b64_tr_b16 v[168:169], v22 offset:16384
  v_mfma_f32_16x16x32_bf16 v[116:119], v[200:203], v[68:71], v[116:119]
  ds_read_b64_tr_b16 v[170:171], v22 offset:16896
  v_mfma_f32_16x16x32_bf16 v[124:127], v[204:207], v[68:71], v[124:127]
  ds_read_b64_tr_b16 v[172:173], v23 offset:16384
  v_mfma_f32_16x16x32_bf16 v[120:123], v[204:207], v[64:67], v[120:123]
  ds_read_b64_tr_b16 v[174:175], v23 offset:16896
  s_waitcnt lgkmcnt(8)
  v_mfma_f32_16x16x32_bf16 v[96:99], v[208:211], v[72:75], v[96:99]
  ds_read_b64_tr_b16 v[176:177], v20 offset:20480
  buffer_load_dwordx4 v[56:59], v4, s[36:39], s51 offen offset:1024
  v_mfma_f32_16x16x32_bf16 v[100:103], v[208:211], v[76:79], v[100:103]
  ds_read_b64_tr_b16 v[178:179], v20 offset:20992
  v_mfma_f32_16x16x32_bf16 v[108:111], v[212:215], v[76:79], v[108:111]
  ds_read_b64_tr_b16 v[180:181], v21 offset:20480
  v_mfma_f32_16x16x32_bf16 v[104:107], v[212:215], v[72:75], v[104:107]
  ds_read_b64_tr_b16 v[182:183], v21 offset:20992
  v_mfma_f32_16x16x32_bf16 v[112:115], v[216:219], v[72:75], v[112:115]
  ds_read_b64_tr_b16 v[184:185], v22 offset:20480
  v_mfma_f32_16x16x32_bf16 v[116:119], v[216:219], v[76:79], v[116:119]
  ds_read_b64_tr_b16 v[186:187], v22 offset:20992
  v_mfma_f32_16x16x32_bf16 v[124:127], v[220:223], v[76:79], v[124:127]
  ds_read_b64_tr_b16 v[188:189], v23 offset:20480
  v_mfma_f32_16x16x32_bf16 v[120:123], v[220:223], v[72:75], v[120:123]
  ds_read_b64_tr_b16 v[190:191], v23 offset:20992
  s_waitcnt vmcnt(17) lgkmcnt(8)
  v_mfma_f32_16x16x32_bf16 v[128:131], v[160:163], v[80:83], v[128:131]
  ds_read_b64_tr_b16 v[192:193], v20 offset:24576
  buffer_load_dwordx4 v[60:63], v5, s[36:39], s51 offen offset:1024
  v_mfma_f32_16x16x32_bf16 v[132:135], v[160:163], v[84:87], v[132:135]
  ds_read_b64_tr_b16 v[194:195], v20 offset:25088
  v_mfma_f32_16x16x32_bf16 v[140:143], v[164:167], v[84:87], v[140:143]
  ds_read_b64_tr_b16 v[196:197], v21 offset:24576
  v_mfma_f32_16x16x32_bf16 v[136:139], v[164:167], v[80:83], v[136:139]
  ds_read_b64_tr_b16 v[198:199], v21 offset:25088
  v_mfma_f32_16x16x32_bf16 v[144:147], v[168:171], v[80:83], v[144:147]
  ds_read_b64_tr_b16 v[200:201], v22 offset:24576
  v_mfma_f32_16x16x32_bf16 v[148:151], v[168:171], v[84:87], v[148:151]
  ds_read_b64_tr_b16 v[202:203], v22 offset:25088
  v_readlane_b32 s48, v15, 20
  v_mfma_f32_16x16x32_bf16 v[156:159], v[172:175], v[84:87], v[156:159]
  ds_read_b64_tr_b16 v[204:205], v23 offset:24576
  v_mfma_f32_16x16x32_bf16 v[152:155], v[172:175], v[80:83], v[152:155]
  ds_read_b64_tr_b16 v[206:207], v23 offset:25088
  s_waitcnt vmcnt(16) lgkmcnt(8)
  v_mfma_f32_16x16x32_bf16 v[128:131], v[176:179], v[88:91], v[128:131]
  ds_read_b64_tr_b16 v[208:209], v20 offset:28672
  buffer_load_dwordx4 v[64:67], v4, s[36:39], s48 offen offset:0
  v_mfma_f32_16x16x32_bf16 v[132:135], v[176:179], v[92:95], v[132:135]
  ds_read_b64_tr_b16 v[210:211], v20 offset:29184
  v_mfma_f32_16x16x32_bf16 v[140:143], v[180:183], v[92:95], v[140:143]
  ds_read_b64_tr_b16 v[212:213], v21 offset:28672
  v_mfma_f32_16x16x32_bf16 v[136:139], v[180:183], v[88:91], v[136:139]
  ds_read_b64_tr_b16 v[214:215], v21 offset:29184
  v_mfma_f32_16x16x32_bf16 v[144:147], v[184:187], v[88:91], v[144:147]
  ds_read_b64_tr_b16 v[216:217], v22 offset:28672
  v_mfma_f32_16x16x32_bf16 v[148:151], v[184:187], v[92:95], v[148:151]
  ds_read_b64_tr_b16 v[218:219], v22 offset:29184
  v_mfma_f32_16x16x32_bf16 v[156:159], v[188:191], v[92:95], v[156:159]
  ds_read_b64_tr_b16 v[220:221], v23 offset:28672
  v_mfma_f32_16x16x32_bf16 v[152:155], v[188:191], v[88:91], v[152:155]
  ds_read_b64_tr_b16 v[222:223], v23 offset:29184
  s_waitcnt lgkmcnt(8)
  v_mfma_f32_16x16x32_bf16 v[96:99], v[192:195], v[80:83], v[96:99]
  ds_read_b64_tr_b16 v[160:161], v20 offset:32768
  buffer_load_dwordx4 v[68:71], v5, s[36:39], s48 offen offset:0
  v_mfma_f32_16x16x32_bf16 v[100:103], v[192:195], v[84:87], v[100:103]
  ds_read_b64_tr_b16 v[162:163], v20 offset:33280
  v_mfma_f32_16x16x32_bf16 v[108:111], v[196:199], v[84:87], v[108:111]
  ds_read_b64_tr_b16 v[164:165], v21 offset:32768
  v_mfma_f32_16x16x32_bf16 v[104:107], v[196:199], v[80:83], v[104:107]
  ds_read_b64_tr_b16 v[166:167], v21 offset:33280
  v_mfma_f32_16x16x32_bf16 v[112:115], v[200:203], v[80:83], v[112:115]
  ds_read_b64_tr_b16 v[168:169], v22 offset:32768
  v_mfma_f32_16x16x32_bf16 v[116:119], v[200:203], v[84:87], v[116:119]
  ds_read_b64_tr_b16 v[170:171], v22 offset:33280
  v_mfma_f32_16x16x32_bf16 v[124:127], v[204:207], v[84:87], v[124:127]
  ds_read_b64_tr_b16 v[172:173], v23 offset:32768
  v_mfma_f32_16x16x32_bf16 v[120:123], v[204:207], v[80:83], v[120:123]
  ds_read_b64_tr_b16 v[174:175], v23 offset:33280
  s_waitcnt lgkmcnt(8)
  s_barrier
  v_mfma_f32_16x16x32_bf16 v[96:99], v[208:211], v[88:91], v[96:99]
  ds_read_b64_tr_b16 v[176:177], v20 offset:36864
  buffer_load_dwordx4 v[72:75], v4, s[36:39], s48 offen offset:1024
  v_mfma_f32_16x16x32_bf16 v[100:103], v[208:211], v[92:95], v[100:103]
  ds_read_b64_tr_b16 v[178:179], v20 offset:37376
  v_mfma_f32_16x16x32_bf16 v[108:111], v[212:215], v[92:95], v[108:111]
  ds_read_b64_tr_b16 v[180:181], v21 offset:36864
  v_mfma_f32_16x16x32_bf16 v[104:107], v[212:215], v[88:91], v[104:107]
  ds_read_b64_tr_b16 v[182:183], v21 offset:37376
  v_mfma_f32_16x16x32_bf16 v[112:115], v[216:219], v[88:91], v[112:115]
  ds_read_b64_tr_b16 v[184:185], v22 offset:36864
  v_mfma_f32_16x16x32_bf16 v[116:119], v[216:219], v[92:95], v[116:119]
  ds_read_b64_tr_b16 v[186:187], v22 offset:37376
  v_mfma_f32_16x16x32_bf16 v[124:127], v[220:223], v[92:95], v[124:127]
  ds_read_b64_tr_b16 v[188:189], v23 offset:36864
  v_mfma_f32_16x16x32_bf16 v[120:123], v[220:223], v[88:91], v[120:123]
  ds_read_b64_tr_b16 v[190:191], v23 offset:37376
  s_waitcnt vmcnt(17) lgkmcnt(8)
  v_mfma_f32_16x16x32_bf16 v[128:131], v[160:163], v[224:227], v[128:131]
  ds_read_b64_tr_b16 v[192:193], v20 offset:40960
  buffer_load_dwordx4 v[76:79], v5, s[36:39], s48 offen offset:1024
  v_mfma_f32_16x16x32_bf16 v[132:135], v[160:163], v[228:231], v[132:135]
  ds_read_b64_tr_b16 v[194:195], v20 offset:41472
  v_mfma_f32_16x16x32_bf16 v[140:143], v[164:167], v[228:231], v[140:143]
  ds_read_b64_tr_b16 v[196:197], v21 offset:40960
  v_mfma_f32_16x16x32_bf16 v[136:139], v[164:167], v[224:227], v[136:139]
  ds_read_b64_tr_b16 v[198:199], v21 offset:41472
  v_mfma_f32_16x16x32_bf16 v[144:147], v[168:171], v[224:227], v[144:147]
  ds_read_b64_tr_b16 v[200:201], v22 offset:40960
  v_mfma_f32_16x16x32_bf16 v[148:151], v[168:171], v[228:231], v[148:151]
  ds_read_b64_tr_b16 v[202:203], v22 offset:41472
  v_readlane_b32 s49, v15, 21
  v_mfma_f32_16x16x32_bf16 v[156:159], v[172:175], v[228:231], v[156:159]
  ds_read_b64_tr_b16 v[204:205], v23 offset:40960
  v_mfma_f32_16x16x32_bf16 v[152:155], v[172:175], v[224:227], v[152:155]
  ds_read_b64_tr_b16 v[206:207], v23 offset:41472
  s_waitcnt vmcnt(16) lgkmcnt(8)
  v_mfma_f32_16x16x32_bf16 v[128:131], v[176:179], v[232:235], v[128:131]
  ds_read_b64_tr_b16 v[208:209], v20 offset:45056
  buffer_load_dwordx4 v[80:83], v4, s[36:39], s49 offen offset:0
  v_mfma_f32_16x16x32_bf16 v[132:135], v[176:179], v[236:239], v[132:135]
  ds_read_b64_tr_b16 v[210:211], v20 offset:45568
  v_mfma_f32_16x16x32_bf16 v[140:143], v[180:183], v[236:239], v[140:143]
  ds_read_b64_tr_b16 v[212:213], v21 offset:45056
  v_mfma_f32_16x16x32_bf16 v[136:139], v[180:183], v[232:235], v[136:139]
  ds_read_b64_tr_b16 v[214:215], v21 offset:45568
  v_mfma_f32_16x16x32_bf16 v[144:147], v[184:187], v[232:235], v[144:147]
  ds_read_b64_tr_b16 v[216:217], v22 offset:45056
  v_mfma_f32_16x16x32_bf16 v[148:151], v[184:187], v[236:239], v[148:151]
  ds_read_b64_tr_b16 v[218:219], v22 offset:45568
  v_mfma_f32_16x16x32_bf16 v[156:159], v[188:191], v[236:239], v[156:159]
  ds_read_b64_tr_b16 v[220:221], v23 offset:45056
  v_mfma_f32_16x16x32_bf16 v[152:155], v[188:191], v[232:235], v[152:155]
  ds_read_b64_tr_b16 v[222:223], v23 offset:45568
  s_waitcnt lgkmcnt(8)
  v_mfma_f32_16x16x32_bf16 v[96:99], v[192:195], v[224:227], v[96:99]
  ds_read_b64_tr_b16 v[160:161], v20 offset:49152
  buffer_load_dwordx4 v[84:87], v5, s[36:39], s49 offen offset:0
  v_mfma_f32_16x16x32_bf16 v[100:103], v[192:195], v[228:231], v[100:103]
  ds_read_b64_tr_b16 v[162:163], v20 offset:49664
  v_mfma_f32_16x16x32_bf16 v[108:111], v[196:199], v[228:231], v[108:111]
  ds_read_b64_tr_b16 v[164:165], v21 offset:49152
  v_mfma_f32_16x16x32_bf16 v[104:107], v[196:199], v[224:227], v[104:107]
  ds_read_b64_tr_b16 v[166:167], v21 offset:49664
  v_mfma_f32_16x16x32_bf16 v[112:115], v[200:203], v[224:227], v[112:115]
  ds_read_b64_tr_b16 v[168:169], v22 offset:49152
  v_mfma_f32_16x16x32_bf16 v[116:119], v[200:203], v[228:231], v[116:119]
  ds_read_b64_tr_b16 v[170:171], v22 offset:49664
  v_mfma_f32_16x16x32_bf16 v[124:127], v[204:207], v[228:231], v[124:127]
  ds_read_b64_tr_b16 v[172:173], v23 offset:49152
  v_mfma_f32_16x16x32_bf16 v[120:123], v[204:207], v[224:227], v[120:123]
  ds_read_b64_tr_b16 v[174:175], v23 offset:49664
  s_waitcnt lgkmcnt(8)
  v_mfma_f32_16x16x32_bf16 v[96:99], v[208:211], v[232:235], v[96:99]
  ds_read_b64_tr_b16 v[176:177], v20 offset:53248
  buffer_load_dwordx4 v[88:91], v4, s[36:39], s49 offen offset:1024
  v_mfma_f32_16x16x32_bf16 v[100:103], v[208:211], v[236:239], v[100:103]
  ds_read_b64_tr_b16 v[178:179], v20 offset:53760
  v_mfma_f32_16x16x32_bf16 v[108:111], v[212:215], v[236:239], v[108:111]
  ds_read_b64_tr_b16 v[180:181], v21 offset:53248
  v_mfma_f32_16x16x32_bf16 v[104:107], v[212:215], v[232:235], v[104:107]
  ds_read_b64_tr_b16 v[182:183], v21 offset:53760
  v_mfma_f32_16x16x32_bf16 v[112:115], v[216:219], v[232:235], v[112:115]
  ds_read_b64_tr_b16 v[184:185], v22 offset:53248
  v_mfma_f32_16x16x32_bf16 v[116:119], v[216:219], v[236:239], v[116:119]
  ds_read_b64_tr_b16 v[186:187], v22 offset:53760
  v_mfma_f32_16x16x32_bf16 v[124:127], v[220:223], v[236:239], v[124:127]
  ds_read_b64_tr_b16 v[188:189], v23 offset:53248
  v_mfma_f32_16x16x32_bf16 v[120:123], v[220:223], v[232:235], v[120:123]
  ds_read_b64_tr_b16 v[190:191], v23 offset:53760
  s_waitcnt vmcnt(17) lgkmcnt(8)
  v_mfma_f32_16x16x32_bf16 v[128:131], v[160:163], v[240:243], v[128:131]
  ds_read_b64_tr_b16 v[192:193], v20 offset:57344
  buffer_load_dwordx4 v[92:95], v5, s[36:39], s49 offen offset:1024
  v_mfma_f32_16x16x32_bf16 v[132:135], v[160:163], v[244:247], v[132:135]
  ds_read_b64_tr_b16 v[194:195], v20 offset:57856
  v_mfma_f32_16x16x32_bf16 v[140:143], v[164:167], v[244:247], v[140:143]
  ds_read_b64_tr_b16 v[196:197], v21 offset:57344
  v_mfma_f32_16x16x32_bf16 v[136:139], v[164:167], v[240:243], v[136:139]
  ds_read_b64_tr_b16 v[198:199], v21 offset:57856
  v_mfma_f32_16x16x32_bf16 v[144:147], v[168:171], v[240:243], v[144:147]
  ds_read_b64_tr_b16 v[200:201], v22 offset:57344
  v_mfma_f32_16x16x32_bf16 v[148:151], v[168:171], v[244:247], v[148:151]
  ds_read_b64_tr_b16 v[202:203], v22 offset:57856
  v_readlane_b32 s50, v15, 22
  v_mfma_f32_16x16x32_bf16 v[156:159], v[172:175], v[244:247], v[156:159]
  ds_read_b64_tr_b16 v[204:205], v23 offset:57344
  v_mfma_f32_16x16x32_bf16 v[152:155], v[172:175], v[240:243], v[152:155]
  ds_read_b64_tr_b16 v[206:207], v23 offset:57856
  s_waitcnt vmcnt(16) lgkmcnt(8)
  v_mfma_f32_16x16x32_bf16 v[128:131], v[176:179], v[248:251], v[128:131]
  ds_read_b64_tr_b16 v[208:209], v20 offset:61440
  buffer_load_dwordx4 v[224:227], v4, s[36:39], s50 offen offset:0
  v_mfma_f32_16x16x32_bf16 v[132:135], v[176:179], v[252:255], v[132:135]
  ds_read_b64_tr_b16 v[210:211], v20 offset:61952
  v_mfma_f32_16x16x32_bf16 v[140:143], v[180:183], v[252:255], v[140:143]
  ds_read_b64_tr_b16 v[212:213], v21 offset:61440
  v_mfma_f32_16x16x32_bf16 v[136:139], v[180:183], v[248:251], v[136:139]
  ds_read_b64_tr_b16 v[214:215], v21 offset:61952
  v_mfma_f32_16x16x32_bf16 v[144:147], v[184:187], v[248:251], v[144:147]
  ds_read_b64_tr_b16 v[216:217], v22 offset:61440
  v_mfma_f32_16x16x32_bf16 v[148:151], v[184:187], v[252:255], v[148:151]
  ds_read_b64_tr_b16 v[218:219], v22 offset:61952
  v_mfma_f32_16x16x32_bf16 v[156:159], v[188:191], v[252:255], v[156:159]
  ds_read_b64_tr_b16 v[220:221], v23 offset:61440
  v_mfma_f32_16x16x32_bf16 v[152:155], v[188:191], v[248:251], v[152:155]
  ds_read_b64_tr_b16 v[222:223], v23 offset:61952
  s_waitcnt lgkmcnt(8)
  v_mfma_f32_16x16x32_bf16 v[96:99], v[192:195], v[240:243], v[96:99]
  ds_read_b64_tr_b16 v[160:161], v26 offset:0
  buffer_load_dwordx4 v[228:231], v5, s[36:39], s50 offen offset:0
  v_mfma_f32_16x16x32_bf16 v[100:103], v[192:195], v[244:247], v[100:103]
  ds_read_b64_tr_b16 v[162:163], v26 offset:512
  v_mfma_f32_16x16x32_bf16 v[108:111], v[196:199], v[244:247], v[108:111]
  ds_read_b64_tr_b16 v[164:165], v27 offset:0
  v_mfma_f32_16x16x32_bf16 v[104:107], v[196:199], v[240:243], v[104:107]
  ds_read_b64_tr_b16 v[166:167], v27 offset:512
  v_mfma_f32_16x16x32_bf16 v[112:115], v[200:203], v[240:243], v[112:115]
  ds_read_b64_tr_b16 v[168:169], v28 offset:0
  v_mfma_f32_16x16x32_bf16 v[116:119], v[200:203], v[244:247], v[116:119]
  ds_read_b64_tr_b16 v[170:171], v28 offset:512
  v_mfma_f32_16x16x32_bf16 v[124:127], v[204:207], v[244:247], v[124:127]
  ds_read_b64_tr_b16 v[172:173], v29 offset:0
  v_mfma_f32_16x16x32_bf16 v[120:123], v[204:207], v[240:243], v[120:123]
  ds_read_b64_tr_b16 v[174:175], v29 offset:512
  s_waitcnt lgkmcnt(8)
  s_barrier
  v_mfma_f32_16x16x32_bf16 v[96:99], v[208:211], v[248:251], v[96:99]
  ds_read_b64_tr_b16 v[176:177], v26 offset:4096
  buffer_load_dwordx4 v[232:235], v4, s[36:39], s50 offen offset:1024
  v_mfma_f32_16x16x32_bf16 v[100:103], v[208:211], v[252:255], v[100:103]
  ds_read_b64_tr_b16 v[178:179], v26 offset:4608
  v_mfma_f32_16x16x32_bf16 v[108:111], v[212:215], v[252:255], v[108:111]
  ds_read_b64_tr_b16 v[180:181], v27 offset:4096
  v_mfma_f32_16x16x32_bf16 v[104:107], v[212:215], v[248:251], v[104:107]
  ds_read_b64_tr_b16 v[182:183], v27 offset:4608
  v_mfma_f32_16x16x32_bf16 v[112:115], v[216:219], v[248:251], v[112:115]
  ds_read_b64_tr_b16 v[184:185], v28 offset:4096
  v_mfma_f32_16x16x32_bf16 v[116:119], v[216:219], v[252:255], v[116:119]
  ds_read_b64_tr_b16 v[186:187], v28 offset:4608
  v_mfma_f32_16x16x32_bf16 v[124:127], v[220:223], v[252:255], v[124:127]
  ds_read_b64_tr_b16 v[188:189], v29 offset:4096
  v_mfma_f32_16x16x32_bf16 v[120:123], v[220:223], v[248:251], v[120:123]
  ds_read_b64_tr_b16 v[190:191], v29 offset:4608
  s_waitcnt vmcnt(17) lgkmcnt(8)
  v_mfma_f32_16x16x32_bf16 v[128:131], v[160:163], v[32:35], v[128:131]
  ds_read_b64_tr_b16 v[192:193], v26 offset:8192
  buffer_load_dwordx4 v[236:239], v5, s[36:39], s50 offen offset:1024
  v_mfma_f32_16x16x32_bf16 v[132:135], v[160:163], v[36:39], v[132:135]
  ds_read_b64_tr_b16 v[194:195], v26 offset:8704
  v_mfma_f32_16x16x32_bf16 v[140:143], v[164:167], v[36:39], v[140:143]
  ds_read_b64_tr_b16 v[196:197], v27 offset:8192
  v_mfma_f32_16x16x32_bf16 v[136:139], v[164:167], v[32:35], v[136:139]
  ds_read_b64_tr_b16 v[198:199], v27 offset:8704
  v_mfma_f32_16x16x32_bf16 v[144:147], v[168:171], v[32:35], v[144:147]
  ds_read_b64_tr_b16 v[200:201], v28 offset:8192
  v_mfma_f32_16x16x32_bf16 v[148:151], v[168:171], v[36:39], v[148:151]
  ds_read_b64_tr_b16 v[202:203], v28 offset:8704
  v_readlane_b32 s51, v15, 23
  v_mfma_f32_16x16x32_bf16 v[156:159], v[172:175], v[36:39], v[156:159]
  ds_read_b64_tr_b16 v[204:205], v29 offset:8192
  v_mfma_f32_16x16x32_bf16 v[152:155], v[172:175], v[32:35], v[152:155]
  ds_read_b64_tr_b16 v[206:207], v29 offset:8704
  s_waitcnt vmcnt(16) lgkmcnt(8)
  v_mfma_f32_16x16x32_bf16 v[128:131], v[176:179], v[40:43], v[128:131]
  ds_read_b64_tr_b16 v[208:209], v26 offset:12288
  buffer_load_dwordx4 v[240:243], v4, s[36:39], s51 offen offset:0
  v_mfma_f32_16x16x32_bf16 v[132:135], v[176:179], v[44:47], v[132:135]
  ds_read_b64_tr_b16 v[210:211], v26 offset:12800
  v_mfma_f32_16x16x32_bf16 v[140:143], v[180:183], v[44:47], v[140:143]
  ds_read_b64_tr_b16 v[212:213], v27 offset:12288
  v_mfma_f32_16x16x32_bf16 v[136:139], v[180:183], v[40:43], v[136:139]
  ds_read_b64_tr_b16 v[214:215], v27 offset:12800
  v_mfma_f32_16x16x32_bf16 v[144:147], v[184:187], v[40:43], v[144:147]
  ds_read_b64_tr_b16 v[216:217], v28 offset:12288
  v_mfma_f32_16x16x32_bf16 v[148:151], v[184:187], v[44:47], v[148:151]
  ds_read_b64_tr_b16 v[218:219], v28 offset:12800
  v_mfma_f32_16x16x32_bf16 v[156:159], v[188:191], v[44:47], v[156:159]
  ds_read_b64_tr_b16 v[220:221], v29 offset:12288
  v_mfma_f32_16x16x32_bf16 v[152:155], v[188:191], v[40:43], v[152:155]
  ds_read_b64_tr_b16 v[222:223], v29 offset:12800
  s_waitcnt lgkmcnt(8)
  v_mfma_f32_16x16x32_bf16 v[96:99], v[192:195], v[32:35], v[96:99]
  ds_read_b64_tr_b16 v[160:161], v26 offset:16384
  buffer_load_dwordx4 v[244:247], v5, s[36:39], s51 offen offset:0
  v_mfma_f32_16x16x32_bf16 v[100:103], v[192:195], v[36:39], v[100:103]
  ds_read_b64_tr_b16 v[162:163], v26 offset:16896
  v_mfma_f32_16x16x32_bf16 v[108:111], v[196:199], v[36:39], v[108:111]
  ds_read_b64_tr_b16 v[164:165], v27 offset:16384
  v_mfma_f32_16x16x32_bf16 v[104:107], v[196:199], v[32:35], v[104:107]
  ds_read_b64_tr_b16 v[166:167], v27 offset:16896
  v_mfma_f32_16x16x32_bf16 v[112:115], v[200:203], v[32:35], v[112:115]
  ds_read_b64_tr_b16 v[168:169], v28 offset:16384
  v_mfma_f32_16x16x32_bf16 v[116:119], v[200:203], v[36:39], v[116:119]
  ds_read_b64_tr_b16 v[170:171], v28 offset:16896
  v_mfma_f32_16x16x32_bf16 v[124:127], v[204:207], v[36:39], v[124:127]
  ds_read_b64_tr_b16 v[172:173], v29 offset:16384
  v_mfma_f32_16x16x32_bf16 v[120:123], v[204:207], v[32:35], v[120:123]
  ds_read_b64_tr_b16 v[174:175], v29 offset:16896
  s_waitcnt lgkmcnt(8)
  v_mfma_f32_16x16x32_bf16 v[96:99], v[208:211], v[40:43], v[96:99]
  ds_read_b64_tr_b16 v[176:177], v26 offset:20480
  buffer_load_dwordx4 v[248:251], v4, s[36:39], s51 offen offset:1024
  v_mfma_f32_16x16x32_bf16 v[100:103], v[208:211], v[44:47], v[100:103]
  ds_read_b64_tr_b16 v[178:179], v26 offset:20992
  v_mfma_f32_16x16x32_bf16 v[108:111], v[212:215], v[44:47], v[108:111]
  ds_read_b64_tr_b16 v[180:181], v27 offset:20480
  v_mfma_f32_16x16x32_bf16 v[104:107], v[212:215], v[40:43], v[104:107]
  ds_read_b64_tr_b16 v[182:183], v27 offset:20992
  v_mfma_f32_16x16x32_bf16 v[112:115], v[216:219], v[40:43], v[112:115]
  ds_read_b64_tr_b16 v[184:185], v28 offset:20480
  v_mfma_f32_16x16x32_bf16 v[116:119], v[216:219], v[44:47], v[116:119]
  ds_read_b64_tr_b16 v[186:187], v28 offset:20992
  v_mfma_f32_16x16x32_bf16 v[124:127], v[220:223], v[44:47], v[124:127]
  ds_read_b64_tr_b16 v[188:189], v29 offset:20480
  v_mfma_f32_16x16x32_bf16 v[120:123], v[220:223], v[40:43], v[120:123]
  ds_read_b64_tr_b16 v[190:191], v29 offset:20992
  s_waitcnt vmcnt(17) lgkmcnt(8)
  v_mfma_f32_16x16x32_bf16 v[128:131], v[160:163], v[48:51], v[128:131]
  ds_read_b64_tr_b16 v[192:193], v26 offset:24576
  buffer_load_dwordx4 v[252:255], v5, s[36:39], s51 offen offset:1024
  v_mfma_f32_16x16x32_bf16 v[132:135], v[160:163], v[52:55], v[132:135]
  ds_read_b64_tr_b16 v[194:195], v26 offset:25088
  v_mfma_f32_16x16x32_bf16 v[140:143], v[164:167], v[52:55], v[140:143]
  ds_read_b64_tr_b16 v[196:197], v27 offset:24576
  v_mfma_f32_16x16x32_bf16 v[136:139], v[164:167], v[48:51], v[136:139]
  ds_read_b64_tr_b16 v[198:199], v27 offset:25088
  v_mfma_f32_16x16x32_bf16 v[144:147], v[168:171], v[48:51], v[144:147]
  ds_read_b64_tr_b16 v[200:201], v28 offset:24576
  v_mfma_f32_16x16x32_bf16 v[148:151], v[168:171], v[52:55], v[148:151]
  ds_read_b64_tr_b16 v[202:203], v28 offset:25088
  v_readlane_b32 s48, v15, 24
  v_mfma_f32_16x16x32_bf16 v[156:159], v[172:175], v[52:55], v[156:159]
  ds_read_b64_tr_b16 v[204:205], v29 offset:24576
  v_mfma_f32_16x16x32_bf16 v[152:155], v[172:175], v[48:51], v[152:155]
  ds_read_b64_tr_b16 v[206:207], v29 offset:25088
  s_waitcnt vmcnt(16) lgkmcnt(8)
  v_mfma_f32_16x16x32_bf16 v[128:131], v[176:179], v[56:59], v[128:131]
  ds_read_b64_tr_b16 v[208:209], v26 offset:28672
  buffer_load_dwordx4 v[32:35], v4, s[36:39], s48 offen offset:0
  v_mfma_f32_16x16x32_bf16 v[132:135], v[176:179], v[60:63], v[132:135]
  ds_read_b64_tr_b16 v[210:211], v26 offset:29184
  v_mfma_f32_16x16x32_bf16 v[140:143], v[180:183], v[60:63], v[140:143]
  ds_read_b64_tr_b16 v[212:213], v27 offset:28672
  v_mfma_f32_16x16x32_bf16 v[136:139], v[180:183], v[56:59], v[136:139]
  ds_read_b64_tr_b16 v[214:215], v27 offset:29184
  v_mfma_f32_16x16x32_bf16 v[144:147], v[184:187], v[56:59], v[144:147]
  ds_read_b64_tr_b16 v[216:217], v28 offset:28672
  v_mfma_f32_16x16x32_bf16 v[148:151], v[184:187], v[60:63], v[148:151]
  ds_read_b64_tr_b16 v[218:219], v28 offset:29184
  v_mfma_f32_16x16x32_bf16 v[156:159], v[188:191], v[60:63], v[156:159]
  ds_read_b64_tr_b16 v[220:221], v29 offset:28672
  v_mfma_f32_16x16x32_bf16 v[152:155], v[188:191], v[56:59], v[152:155]
  ds_read_b64_tr_b16 v[222:223], v29 offset:29184
  s_waitcnt lgkmcnt(8)
  v_mfma_f32_16x16x32_bf16 v[96:99], v[192:195], v[48:51], v[96:99]
  ds_read_b64_tr_b16 v[160:161], v6 offset:0
  buffer_load_dwordx4 v[36:39], v5, s[36:39], s48 offen offset:0
  v_mfma_f32_16x16x32_bf16 v[100:103], v[192:195], v[52:55], v[100:103]
  ds_read_b64_tr_b16 v[162:163], v6 offset:512
  v_mfma_f32_16x16x32_bf16 v[108:111], v[196:199], v[52:55], v[108:111]
  ds_read_b64_tr_b16 v[164:165], v7 offset:0
  v_cvt_pk_bf16_f32 v128, v128, v129
  v_mfma_f32_16x16x32_bf16 v[104:107], v[196:199], v[48:51], v[104:107]
  ds_read_b64_tr_b16 v[166:167], v7 offset:512
  v_cvt_pk_bf16_f32 v129, v130, v131
  v_mfma_f32_16x16x32_bf16 v[112:115], v[200:203], v[48:51], v[112:115]
  ds_read_b64_tr_b16 v[168:169], v8 offset:0
  v_cvt_pk_bf16_f32 v130, v132, v133
  v_mfma_f32_16x16x32_bf16 v[116:119], v[200:203], v[52:55], v[116:119]
  ds_read_b64_tr_b16 v[170:171], v8 offset:512
  v_cvt_pk_bf16_f32 v131, v134, v135
  v_mfma_f32_16x16x32_bf16 v[124:127], v[204:207], v[52:55], v[124:127]
  ds_read_b64_tr_b16 v[172:173], v9 offset:0
  v_cvt_pk_bf16_f32 v132, v136, v137
  v_mfma_f32_16x16x32_bf16 v[120:123], v[204:207], v[48:51], v[120:123]
  ds_read_b64_tr_b16 v[174:175], v9 offset:512
  s_waitcnt lgkmcnt(8)
  s_barrier
  v_mfma_f32_16x16x32_bf16 v[96:99], v[208:211], v[56:59], v[96:99]
  ds_read_b64_tr_b16 v[176:177], v6 offset:4096
  buffer_load_dwordx4 v[40:43], v4, s[36:39], s48 offen offset:1024
  v_mfma_f32_16x16x32_bf16 v[100:103], v[208:211], v[60:63], v[100:103]
  ds_read_b64_tr_b16 v[178:179], v6 offset:4608
  ds_write_b128 v19, v[128:131] offset:0
  v_mfma_f32_16x16x32_bf16 v[108:111], v[212:215], v[60:63], v[108:111]
  ds_read_b64_tr_b16 v[180:181], v7 offset:4096
  v_cvt_pk_bf16_f32 v133, v138, v139
  v_mfma_f32_16x16x32_bf16 v[104:107], v[212:215], v[56:59], v[104:107]
  ds_read_b64_tr_b16 v[182:183], v7 offset:4608
  v_cvt_pk_bf16_f32 v134, v140, v141
  v_mfma_f32_16x16x32_bf16 v[112:115], v[216:219], v[56:59], v[112:115]
  ds_read_b64_tr_b16 v[184:185], v8 offset:4096
  v_cvt_pk_bf16_f32 v135, v142, v143
  v_mfma_f32_16x16x32_bf16 v[116:119], v[216:219], v[60:63], v[116:119]
  ds_read_b64_tr_b16 v[186:187], v8 offset:4608
  ds_write_b128 v19, v[132:135] offset:1024
  v_mfma_f32_16x16x32_bf16 v[124:127], v[220:223], v[60:63], v[124:127]
  ds_read_b64_tr_b16 v[188:189], v9 offset:4096
  v_cvt_pk_bf16_f32 v136, v144, v145
  v_mfma_f32_16x16x32_bf16 v[120:123], v[220:223], v[56:59], v[120:123]
  ds_read_b64_tr_b16 v[190:191], v9 offset:4608
  s_waitcnt vmcnt(17) lgkmcnt(10)
  v_mfma_f32_16x16x32_bf16 v[96:99], v[160:163], v[64:67], v[96:99]
  ds_read_b64_tr_b16 v[192:193], v6 offset:8192
  buffer_load_dwordx4 v[44:47], v5, s[36:39], s48 offen offset:1024
  v_mfma_f32_16x16x32_bf16 v[100:103], v[160:163], v[68:71], v[100:103]
  ds_read_b64_tr_b16 v[194:195], v6 offset:8704
  v_cvt_pk_bf16_f32 v137, v146, v147
  v_mfma_f32_16x16x32_bf16 v[108:111], v[164:167], v[68:71], v[108:111]
  ds_read_b64_tr_b16 v[196:197], v7 offset:8192
  v_cvt_pk_bf16_f32 v138, v148, v149
  v_mfma_f32_16x16x32_bf16 v[104:107], v[164:167], v[64:67], v[104:107]
  ds_read_b64_tr_b16 v[198:199], v7 offset:8704
  v_cvt_pk_bf16_f32 v139, v150, v151
  v_mfma_f32_16x16x32_bf16 v[112:115], v[168:171], v[64:67], v[112:115]
  ds_read_b64_tr_b16 v[200:201], v8 offset:8192
  ds_write_b128 v19, v[136:139] offset:2048
  v_mfma_f32_16x16x32_bf16 v[116:119], v[168:171], v[68:71], v[116:119]
  ds_read_b64_tr_b16 v[202:203], v8 offset:8704
  v_readlane_b32 s49, v15, 25
  v_mfma_f32_16x16x32_bf16 v[124:127], v[172:175], v[68:71], v[124:127]
  ds_read_b64_tr_b16 v[204:205], v9 offset:8192
  v_cvt_pk_bf16_f32 v140, v152, v153
  v_mfma_f32_16x16x32_bf16 v[120:123], v[172:175], v[64:67], v[120:123]
  ds_read_b64_tr_b16 v[206:207], v9 offset:8704
  s_waitcnt vmcnt(16) lgkmcnt(9)
  v_mfma_f32_16x16x32_bf16 v[96:99], v[176:179], v[72:75], v[96:99]
  ds_read_b64_tr_b16 v[208:209], v6 offset:12288
  buffer_load_dwordx4 v[48:51], v4, s[36:39], s49 offen offset:0
  v_mfma_f32_16x16x32_bf16 v[100:103], v[176:179], v[76:79], v[100:103]
  ds_read_b64_tr_b16 v[210:211], v6 offset:12800
  v_cvt_pk_bf16_f32 v141, v154, v155
  v_mfma_f32_16x16x32_bf16 v[108:111], v[180:183], v[76:79], v[108:111]
  ds_read_b64_tr_b16 v[212:213], v7 offset:12288
  v_cvt_pk_bf16_f32 v142, v156, v157
  v_mfma_f32_16x16x32_bf16 v[104:107], v[180:183], v[72:75], v[104:107]
  ds_read_b64_tr_b16 v[214:215], v7 offset:12800
  buffer_load_dwordx4 v[52:55], v5, s[36:39], s49 offen offset:0
  v_mfma_f32_16x16x32_bf16 v[112:115], v[184:187], v[72:75], v[112:115]
  ds_read_b64_tr_b16 v[216:217], v8 offset:12288
  v_cvt_pk_bf16_f32 v143, v158, v159
  v_mfma_f32_16x16x32_bf16 v[116:119], v[184:187], v[76:79], v[116:119]
  ds_read_b64_tr_b16 v[218:219], v8 offset:12800
  ds_write_b128 v19, v[140:143] offset:3072
  v_mfma_f32_16x16x32_bf16 v[124:127], v[188:191], v[76:79], v[124:127]
  ds_read_b64_tr_b16 v[220:221], v9 offset:12288
  buffer_load_dwordx4 v[56:59], v4, s[36:39], s49 offen offset:1024
  v_mfma_f32_16x16x32_bf16 v[120:123], v[188:191], v[72:75], v[120:123]
  ds_read_b64_tr_b16 v[222:223], v9 offset:12800
  s_waitcnt vmcnt(17) lgkmcnt(9)
  v_mfma_f32_16x16x32_bf16 v[96:99], v[192:195], v[80:83], v[96:99]
  ds_read_b64_tr_b16 v[160:161], v6 offset:16384
  v_mfma_f32_16x16x32_bf16 v[100:103], v[192:195], v[84:87], v[100:103]
  ds_read_b64_tr_b16 v[162:163], v6 offset:16896
  buffer_load_dwordx4 v[60:63], v5, s[36:39], s49 offen offset:1024
  v_mfma_f32_16x16x32_bf16 v[108:111], v[196:199], v[84:87], v[108:111]
  ds_read_b64_tr_b16 v[164:165], v7 offset:16384
  v_readlane_b32 s50, v15, 26
  v_mfma_f32_16x16x32_bf16 v[104:107], v[196:199], v[80:83], v[104:107]
  ds_read_b64_tr_b16 v[166:167], v7 offset:16896
  v_mfma_f32_16x16x32_bf16 v[112:115], v[200:203], v[80:83], v[112:115]
  ds_read_b64_tr_b16 v[168:169], v8 offset:16384
  v_mfma_f32_16x16x32_bf16 v[116:119], v[200:203], v[84:87], v[116:119]
  ds_read_b64_tr_b16 v[170:171], v8 offset:16896
  buffer_load_dwordx4 v[64:67], v4, s[36:39], s50 offen offset:0
  v_mfma_f32_16x16x32_bf16 v[124:127], v[204:207], v[84:87], v[124:127]
  ds_read_b64_tr_b16 v[172:173], v9 offset:16384
  v_mfma_f32_16x16x32_bf16 v[120:123], v[204:207], v[80:83], v[120:123]
  ds_read_b64_tr_b16 v[174:175], v9 offset:16896
  s_waitcnt vmcnt(17) lgkmcnt(8)
  s_barrier
  v_mfma_f32_16x16x32_bf16 v[96:99], v[208:211], v[88:91], v[96:99]
  ds_read_b64_tr_b16 v[176:177], v6 offset:20480
  buffer_load_dwordx4 v[68:71], v5, s[36:39], s50 offen offset:0
  v_mfma_f32_16x16x32_bf16 v[100:103], v[208:211], v[92:95], v[100:103]
  ds_read_b64_tr_b16 v[178:179], v6 offset:20992
  v_mfma_f32_16x16x32_bf16 v[108:111], v[212:215], v[92:95], v[108:111]
  ds_read_b64_tr_b16 v[180:181], v7 offset:20480
  v_mfma_f32_16x16x32_bf16 v[104:107], v[212:215], v[88:91], v[104:107]
  ds_read_b64_tr_b16 v[182:183], v7 offset:20992
  buffer_load_dwordx4 v[72:75], v4, s[36:39], s50 offen offset:1024
  v_mfma_f32_16x16x32_bf16 v[112:115], v[216:219], v[88:91], v[112:115]
  ds_read_b64_tr_b16 v[184:185], v8 offset:20480
  v_mfma_f32_16x16x32_bf16 v[116:119], v[216:219], v[92:95], v[116:119]
  ds_read_b64_tr_b16 v[186:187], v8 offset:20992
  v_mfma_f32_16x16x32_bf16 v[124:127], v[220:223], v[92:95], v[124:127]
  ds_read_b64_tr_b16 v[188:189], v9 offset:20480
  buffer_load_dwordx4 v[76:79], v5, s[36:39], s50 offen offset:1024
  v_mfma_f32_16x16x32_bf16 v[120:123], v[220:223], v[88:91], v[120:123]
  ds_read_b64_tr_b16 v[190:191], v9 offset:20992
  s_waitcnt vmcnt(18) lgkmcnt(8)
  v_mfma_f32_16x16x32_bf16 v[96:99], v[160:163], v[224:227], v[96:99]
  ds_read_b64_tr_b16 v[192:193], v6 offset:24576
  v_readlane_b32 s51, v15, 27
  v_mfma_f32_16x16x32_bf16 v[100:103], v[160:163], v[228:231], v[100:103]
  ds_read_b64_tr_b16 v[194:195], v6 offset:25088
  v_mfma_f32_16x16x32_bf16 v[108:111], v[164:167], v[228:231], v[108:111]
  ds_read_b64_tr_b16 v[196:197], v7 offset:24576
  v_mfma_f32_16x16x32_bf16 v[104:107], v[164:167], v[224:227], v[104:107]
  ds_read_b64_tr_b16 v[198:199], v7 offset:25088
  buffer_load_dwordx4 v[80:83], v4, s[36:39], s51 offen offset:0
  v_mfma_f32_16x16x32_bf16 v[112:115], v[168:171], v[224:227], v[112:115]
  ds_read_b64_tr_b16 v[200:201], v8 offset:24576
  v_mfma_f32_16x16x32_bf16 v[116:119], v[168:171], v[228:231], v[116:119]
  ds_read_b64_tr_b16 v[202:203], v8 offset:25088
  v_mfma_f32_16x16x32_bf16 v[124:127], v[172:175], v[228:231], v[124:127]
  ds_read_b64_tr_b16 v[204:205], v9 offset:24576
  buffer_load_dwordx4 v[84:87], v5, s[36:39], s51 offen offset:0
  v_mfma_f32_16x16x32_bf16 v[120:123], v[172:175], v[224:227], v[120:123]
  ds_read_b64_tr_b16 v[206:207], v9 offset:25088
  s_waitcnt vmcnt(18) lgkmcnt(8)
  v_mfma_f32_16x16x32_bf16 v[96:99], v[176:179], v[232:235], v[96:99]
  ds_read_b64_tr_b16 v[208:209], v6 offset:28672
  v_mfma_f32_16x16x32_bf16 v[100:103], v[176:179], v[236:239], v[100:103]
  ds_read_b64_tr_b16 v[210:211], v6 offset:29184
  buffer_load_dwordx4 v[88:91], v4, s[36:39], s51 offen offset:1024
  v_mfma_f32_16x16x32_bf16 v[108:111], v[180:183], v[236:239], v[108:111]
  ds_read_b64_tr_b16 v[212:213], v7 offset:28672
  v_mfma_f32_16x16x32_bf16 v[104:107], v[180:183], v[232:235], v[104:107]
  ds_read_b64_tr_b16 v[214:215], v7 offset:29184
  v_mfma_f32_16x16x32_bf16 v[112:115], v[184:187], v[232:235], v[112:115]
  ds_read_b64_tr_b16 v[216:217], v8 offset:28672
  buffer_load_dwordx4 v[92:95], v5, s[36:39], s51 offen offset:1024
  v_mfma_f32_16x16x32_bf16 v[116:119], v[184:187], v[236:239], v[116:119]
  ds_read_b64_tr_b16 v[218:219], v8 offset:29184
  v_readlane_b32 s48, v15, 28
  v_mfma_f32_16x16x32_bf16 v[124:127], v[188:191], v[236:239], v[124:127]
  ds_read_b64_tr_b16 v[220:221], v9 offset:28672
  v_mfma_f32_16x16x32_bf16 v[120:123], v[188:191], v[232:235], v[120:123]
  ds_read_b64_tr_b16 v[222:223], v9 offset:29184
  s_waitcnt vmcnt(18) lgkmcnt(8)
  v_mfma_f32_16x16x32_bf16 v[96:99], v[192:195], v[240:243], v[96:99]
  ds_read_b64_tr_b16 v[160:161], v6 offset:32768
  buffer_load_dwordx4 v[224:227], v4, s[36:39], s48 offen offset:0
  v_mfma_f32_16x16x32_bf16 v[100:103], v[192:195], v[244:247], v[100:103]
  ds_read_b64_tr_b16 v[162:163], v6 offset:33280
  v_mfma_f32_16x16x32_bf16 v[108:111], v[196:199], v[244:247], v[108:111]
  ds_read_b64_tr_b16 v[164:165], v7 offset:32768
  v_mfma_f32_16x16x32_bf16 v[104:107], v[196:199], v[240:243], v[104:107]
  ds_read_b64_tr_b16 v[166:167], v7 offset:33280
  buffer_load_dwordx4 v[228:231], v5, s[36:39], s48 offen offset:0
  v_mfma_f32_16x16x32_bf16 v[112:115], v[200:203], v[240:243], v[112:115]
  ds_read_b64_tr_b16 v[168:169], v8 offset:32768
  v_mfma_f32_16x16x32_bf16 v[116:119], v[200:203], v[244:247], v[116:119]
  ds_read_b64_tr_b16 v[170:171], v8 offset:33280
  v_mfma_f32_16x16x32_bf16 v[124:127], v[204:207], v[244:247], v[124:127]
  ds_read_b64_tr_b16 v[172:173], v9 offset:32768
  buffer_load_dwordx4 v[232:235], v4, s[36:39], s48 offen offset:1024
  v_mfma_f32_16x16x32_bf16 v[120:123], v[204:207], v[240:243], v[120:123]
  ds_read_b64_tr_b16 v[174:175], v9 offset:33280
  s_waitcnt vmcnt(19) lgkmcnt(8)
  v_mfma_f32_16x16x32_bf16 v[96:99], v[208:211], v[248:251], v[96:99]
  ds_read_b64_tr_b16 v[176:177], v6 offset:36864
  v_mfma_f32_16x16x32_bf16 v[100:103], v[208:211], v[252:255], v[100:103]
  ds_read_b64_tr_b16 v[178:179], v6 offset:37376
  buffer_load_dwordx4 v[236:239], v5, s[36:39], s48 offen offset:1024
  v_mfma_f32_16x16x32_bf16 v[108:111], v[212:215], v[252:255], v[108:111]
  ds_read_b64_tr_b16 v[180:181], v7 offset:36864
  v_mfma_f32_16x16x32_bf16 v[104:107], v[212:215], v[248:251], v[104:107]
  ds_read_b64_tr_b16 v[182:183], v7 offset:37376
  v_mfma_f32_16x16x32_bf16 v[112:115], v[216:219], v[248:251], v[112:115]
  ds_read_b64_tr_b16 v[184:185], v8 offset:36864
  v_mfma_f32_16x16x32_bf16 v[116:119], v[216:219], v[252:255], v[116:119]
  ds_read_b64_tr_b16 v[186:187], v8 offset:37376
  v_readlane_b32 s49, v15, 29
  v_mfma_f32_16x16x32_bf16 v[124:127], v[220:223], v[252:255], v[124:127]
  ds_read_b64_tr_b16 v[188:189], v9 offset:36864
  v_mfma_f32_16x16x32_bf16 v[120:123], v[220:223], v[248:251], v[120:123]
  ds_read_b64_tr_b16 v[190:191], v9 offset:37376
  s_waitcnt vmcnt(18) lgkmcnt(8)
  v_mfma_f32_16x16x32_bf16 v[96:99], v[160:163], v[32:35], v[96:99]
  ds_read_b64_tr_b16 v[192:193], v6 offset:40960
  buffer_load_dwordx4 v[240:243], v4, s[36:39], s49 offen offset:0
  v_mfma_f32_16x16x32_bf16 v[100:103], v[160:163], v[36:39], v[100:103]
  ds_read_b64_tr_b16 v[194:195], v6 offset:41472
  v_mfma_f32_16x16x32_bf16 v[108:111], v[164:167], v[36:39], v[108:111]
  ds_read_b64_tr_b16 v[196:197], v7 offset:40960
  v_mfma_f32_16x16x32_bf16 v[104:107], v[164:167], v[32:35], v[104:107]
  ds_read_b64_tr_b16 v[198:199], v7 offset:41472
  buffer_load_dwordx4 v[244:247], v5, s[36:39], s49 offen offset:0
  v_mfma_f32_16x16x32_bf16 v[112:115], v[168:171], v[32:35], v[112:115]
  ds_read_b64_tr_b16 v[200:201], v8 offset:40960
  v_mfma_f32_16x16x32_bf16 v[116:119], v[168:171], v[36:39], v[116:119]
  ds_read_b64_tr_b16 v[202:203], v8 offset:41472
  v_mfma_f32_16x16x32_bf16 v[124:127], v[172:175], v[36:39], v[124:127]
  ds_read_b64_tr_b16 v[204:205], v9 offset:40960
  buffer_load_dwordx4 v[248:251], v4, s[36:39], s49 offen offset:1024
  v_mfma_f32_16x16x32_bf16 v[120:123], v[172:175], v[32:35], v[120:123]
  ds_read_b64_tr_b16 v[206:207], v9 offset:41472
  s_waitcnt vmcnt(19) lgkmcnt(8)
  v_mfma_f32_16x16x32_bf16 v[96:99], v[176:179], v[40:43], v[96:99]
  ds_read_b64_tr_b16 v[208:209], v6 offset:45056
  v_mfma_f32_16x16x32_bf16 v[100:103], v[176:179], v[44:47], v[100:103]
  ds_read_b64_tr_b16 v[210:211], v6 offset:45568
  buffer_load_dwordx4 v[252:255], v5, s[36:39], s49 offen offset:1024
  v_mfma_f32_16x16x32_bf16 v[108:111], v[180:183], v[44:47], v[108:111]
  ds_read_b64_tr_b16 v[212:213], v7 offset:45056
  v_mfma_f32_16x16x32_bf16 v[104:107], v[180:183], v[40:43], v[104:107]
  ds_read_b64_tr_b16 v[214:215], v7 offset:45568
  v_mfma_f32_16x16x32_bf16 v[112:115], v[184:187], v[40:43], v[112:115]
  ds_read_b64_tr_b16 v[216:217], v8 offset:45056
  v_mfma_f32_16x16x32_bf16 v[116:119], v[184:187], v[44:47], v[116:119]
  ds_read_b64_tr_b16 v[218:219], v8 offset:45568
  v_readlane_b32 s50, v15, 30
  v_mfma_f32_16x16x32_bf16 v[124:127], v[188:191], v[44:47], v[124:127]
  ds_read_b64_tr_b16 v[220:221], v9 offset:45056
  v_mfma_f32_16x16x32_bf16 v[120:123], v[188:191], v[40:43], v[120:123]
  ds_read_b64_tr_b16 v[222:223], v9 offset:45568
  s_waitcnt vmcnt(18) lgkmcnt(8)
  v_mfma_f32_16x16x32_bf16 v[96:99], v[192:195], v[48:51], v[96:99]
  ds_read_b64_tr_b16 v[160:161], v6 offset:49152
  buffer_load_dwordx4 v[32:35], v4, s[36:39], s50 offen offset:0
  v_mfma_f32_16x16x32_bf16 v[100:103], v[192:195], v[52:55], v[100:103]
  ds_read_b64_tr_b16 v[162:163], v6 offset:49664
  v_mfma_f32_16x16x32_bf16 v[108:111], v[196:199], v[52:55], v[108:111]
  ds_read_b64_tr_b16 v[164:165], v7 offset:49152
  v_mfma_f32_16x16x32_bf16 v[104:107], v[196:199], v[48:51], v[104:107]
  ds_read_b64_tr_b16 v[166:167], v7 offset:49664
  buffer_load_dwordx4 v[36:39], v5, s[36:39], s50 offen offset:0
  v_mfma_f32_16x16x32_bf16 v[112:115], v[200:203], v[48:51], v[112:115]
  ds_read_b64_tr_b16 v[168:169], v8 offset:49152
  v_mfma_f32_16x16x32_bf16 v[116:119], v[200:203], v[52:55], v[116:119]
  ds_read_b64_tr_b16 v[170:171], v8 offset:49664
  v_mfma_f32_16x16x32_bf16 v[124:127], v[204:207], v[52:55], v[124:127]
  ds_read_b64_tr_b16 v[172:173], v9 offset:49152
  buffer_load_dwordx4 v[40:43], v4, s[36:39], s50 offen offset:1024
  v_mfma_f32_16x16x32_bf16 v[120:123], v[204:207], v[48:51], v[120:123]
  ds_read_b64_tr_b16 v[174:175], v9 offset:49664
  s_waitcnt vmcnt(19) lgkmcnt(8)
  v_mfma_f32_16x16x32_bf16 v[96:99], v[208:211], v[56:59], v[96:99]
  ds_read_b64_tr_b16 v[176:177], v6 offset:53248
  v_mfma_f32_16x16x32_bf16 v[100:103], v[208:211], v[60:63], v[100:103]
  ds_read_b64_tr_b16 v[178:179], v6 offset:53760
  buffer_load_dwordx4 v[44:47], v5, s[36:39], s50 offen offset:1024
  v_mfma_f32_16x16x32_bf16 v[108:111], v[212:215], v[60:63], v[108:111]
  ds_read_b64_tr_b16 v[180:181], v7 offset:53248
  v_mfma_f32_16x16x32_bf16 v[104:107], v[212:215], v[56:59], v[104:107]
  ds_read_b64_tr_b16 v[182:183], v7 offset:53760
  v_mfma_f32_16x16x32_bf16 v[112:115], v[216:219], v[56:59], v[112:115]
  ds_read_b64_tr_b16 v[184:185], v8 offset:53248
  v_mfma_f32_16x16x32_bf16 v[116:119], v[216:219], v[60:63], v[116:119]
  ds_read_b64_tr_b16 v[186:187], v8 offset:53760
  v_readlane_b32 s51, v15, 31
  v_mfma_f32_16x16x32_bf16 v[124:127], v[220:223], v[60:63], v[124:127]
  ds_read_b64_tr_b16 v[188:189], v9 offset:53248
  v_mfma_f32_16x16x32_bf16 v[120:123], v[220:223], v[56:59], v[120:123]
  ds_read_b64_tr_b16 v[190:191], v9 offset:53760
  s_waitcnt vmcnt(18) lgkmcnt(8)
  v_mfma_f32_16x16x32_bf16 v[96:99], v[160:163], v[64:67], v[96:99]
  ds_read_b64_tr_b16 v[192:193], v6 offset:57344
  buffer_load_dwordx4 v[48:51], v4, s[36:39], s51 offen offset:0
  v_mfma_f32_16x16x32_bf16 v[100:103], v[160:163], v[68:71], v[100:103]
  ds_read_b64_tr_b16 v[194:195], v6 offset:57856
  v_mfma_f32_16x16x32_bf16 v[108:111], v[164:167], v[68:71], v[108:111]
  ds_read_b64_tr_b16 v[196:197], v7 offset:57344
  v_mfma_f32_16x16x32_bf16 v[104:107], v[164:167], v[64:67], v[104:107]
  ds_read_b64_tr_b16 v[198:199], v7 offset:57856
  buffer_load_dwordx4 v[52:55], v5, s[36:39], s51 offen offset:0
  v_mfma_f32_16x16x32_bf16 v[112:115], v[168:171], v[64:67], v[112:115]
  ds_read_b64_tr_b16 v[200:201], v8 offset:57344
  v_mfma_f32_16x16x32_bf16 v[116:119], v[168:171], v[68:71], v[116:119]
  ds_read_b64_tr_b16 v[202:203], v8 offset:57856
  v_mfma_f32_16x16x32_bf16 v[124:127], v[172:175], v[68:71], v[124:127]
  ds_read_b64_tr_b16 v[204:205], v9 offset:57344
  buffer_load_dwordx4 v[56:59], v4, s[36:39], s51 offen offset:1024
  v_mfma_f32_16x16x32_bf16 v[120:123], v[172:175], v[64:67], v[120:123]
  ds_read_b64_tr_b16 v[206:207], v9 offset:57856
  s_waitcnt vmcnt(19) lgkmcnt(8)
  v_mfma_f32_16x16x32_bf16 v[96:99], v[176:179], v[72:75], v[96:99]
  ds_read_b64_tr_b16 v[208:209], v6 offset:61440
  v_mfma_f32_16x16x32_bf16 v[100:103], v[176:179], v[76:79], v[100:103]
  ds_read_b64_tr_b16 v[210:211], v6 offset:61952
  buffer_load_dwordx4 v[60:63], v5, s[36:39], s51 offen offset:1024
  v_mfma_f32_16x16x32_bf16 v[108:111], v[180:183], v[76:79], v[108:111]
  ds_read_b64_tr_b16 v[212:213], v7 offset:61440
  v_mfma_f32_16x16x32_bf16 v[104:107], v[180:183], v[72:75], v[104:107]
  ds_read_b64_tr_b16 v[214:215], v7 offset:61952
  v_mfma_f32_16x16x32_bf16 v[112:115], v[184:187], v[72:75], v[112:115]
  ds_read_b64_tr_b16 v[216:217], v8 offset:61440
  v_mfma_f32_16x16x32_bf16 v[116:119], v[184:187], v[76:79], v[116:119]
  ds_read_b64_tr_b16 v[218:219], v8 offset:61952
  v_readlane_b32 s48, v15, 32
  v_mfma_f32_16x16x32_bf16 v[124:127], v[188:191], v[76:79], v[124:127]
  ds_read_b64_tr_b16 v[220:221], v9 offset:61440
  v_mfma_f32_16x16x32_bf16 v[120:123], v[188:191], v[72:75], v[120:123]
  ds_read_b64_tr_b16 v[222:223], v9 offset:61952
  s_waitcnt vmcnt(18) lgkmcnt(8)
  v_mfma_f32_16x16x32_bf16 v[96:99], v[192:195], v[80:83], v[96:99]
  ds_read_b64_tr_b16 v[160:161], v20 offset:0
  buffer_load_dwordx4 v[64:67], v4, s[36:39], s48 offen offset:0
  v_mfma_f32_16x16x32_bf16 v[100:103], v[192:195], v[84:87], v[100:103]
  ds_read_b64_tr_b16 v[162:163], v20 offset:512
  v_mfma_f32_16x16x32_bf16 v[108:111], v[196:199], v[84:87], v[108:111]
  ds_read_b64_tr_b16 v[164:165], v21 offset:0
  v_mfma_f32_16x16x32_bf16 v[104:107], v[196:199], v[80:83], v[104:107]
  ds_read_b64_tr_b16 v[166:167], v21 offset:512
  buffer_load_dwordx4 v[68:71], v5, s[36:39], s48 offen offset:0
  v_mfma_f32_16x16x32_bf16 v[112:115], v[200:203], v[80:83], v[112:115]
  ds_read_b64_tr_b16 v[168:169], v22 offset:0
  v_mfma_f32_16x16x32_bf16 v[116:119], v[200:203], v[84:87], v[116:119]
  ds_read_b64_tr_b16 v[170:171], v22 offset:512
  v_mfma_f32_16x16x32_bf16 v[124:127], v[204:207], v[84:87], v[124:127]
  ds_read_b64_tr_b16 v[172:173], v23 offset:0
  buffer_load_dwordx4 v[72:75], v4, s[36:39], s48 offen offset:1024
  v_mfma_f32_16x16x32_bf16 v[120:123], v[204:207], v[80:83], v[120:123]
  ds_read_b64_tr_b16 v[174:175], v23 offset:512
  s_waitcnt vmcnt(19) lgkmcnt(8)
  v_mfma_f32_16x16x32_bf16 v[96:99], v[208:211], v[88:91], v[96:99]
  ds_read_b64_tr_b16 v[176:177], v20 offset:4096
  v_mfma_f32_16x16x32_bf16 v[100:103], v[208:211], v[92:95], v[100:103]
  ds_read_b64_tr_b16 v[178:179], v20 offset:4608
  buffer_load_dwordx4 v[76:79], v5, s[36:39], s48 offen offset:1024
  v_mfma_f32_16x16x32_bf16 v[108:111], v[212:215], v[92:95], v[108:111]
  ds_read_b64_tr_b16 v[180:181], v21 offset:4096
  v_mfma_f32_16x16x32_bf16 v[104:107], v[212:215], v[88:91], v[104:107]
  ds_read_b64_tr_b16 v[182:183], v21 offset:4608
  v_mfma_f32_16x16x32_bf16 v[112:115], v[216:219], v[88:91], v[112:115]
  ds_read_b64_tr_b16 v[184:185], v22 offset:4096
  v_mfma_f32_16x16x32_bf16 v[116:119], v[216:219], v[92:95], v[116:119]
  ds_read_b64_tr_b16 v[186:187], v22 offset:4608
  v_readlane_b32 s49, v15, 33
  v_mfma_f32_16x16x32_bf16 v[124:127], v[220:223], v[92:95], v[124:127]
  ds_read_b64_tr_b16 v[188:189], v23 offset:4096
  v_mfma_f32_16x16x32_bf16 v[120:123], v[220:223], v[88:91], v[120:123]
  ds_read_b64_tr_b16 v[190:191], v23 offset:4608
  s_waitcnt vmcnt(18) lgkmcnt(8)
  v_mfma_f32_16x16x32_bf16 v[96:99], v[160:163], v[224:227], v[96:99]
  ds_read_b64_tr_b16 v[192:193], v20 offset:8192
  buffer_load_dwordx4 v[80:83], v4, s[36:39], s49 offen offset:0
  v_mfma_f32_16x16x32_bf16 v[100:103], v[160:163], v[228:231], v[100:103]
  ds_read_b64_tr_b16 v[194:195], v20 offset:8704
  v_mfma_f32_16x16x32_bf16 v[108:111], v[164:167], v[228:231], v[108:111]
  ds_read_b64_tr_b16 v[196:197], v21 offset:8192
  v_mfma_f32_16x16x32_bf16 v[104:107], v[164:167], v[224:227], v[104:107]
  ds_read_b64_tr_b16 v[198:199], v21 offset:8704
  buffer_load_dwordx4 v[84:87], v5, s[36:39], s49 offen offset:0
  v_mfma_f32_16x16x32_bf16 v[112:115], v[168:171], v[224:227], v[112:115]
  ds_read_b64_tr_b16 v[200:201], v22 offset:8192
  v_mfma_f32_16x16x32_bf16 v[116:119], v[168:171], v[228:231], v[116:119]
  ds_read_b64_tr_b16 v[202:203], v22 offset:8704
  v_mfma_f32_16x16x32_bf16 v[124:127], v[172:175], v[228:231], v[124:127]
  ds_read_b64_tr_b16 v[204:205], v23 offset:8192
  buffer_load_dwordx4 v[88:91], v4, s[36:39], s49 offen offset:1024
  v_mfma_f32_16x16x32_bf16 v[120:123], v[172:175], v[224:227], v[120:123]
  ds_read_b64_tr_b16 v[206:207], v23 offset:8704
  s_waitcnt vmcnt(19) lgkmcnt(8)
  v_mfma_f32_16x16x32_bf16 v[96:99], v[176:179], v[232:235], v[96:99]
  ds_read_b64_tr_b16 v[208:209], v20 offset:12288
  v_mfma_f32_16x16x32_bf16 v[100:103], v[176:179], v[236:239], v[100:103]
  ds_read_b64_tr_b16 v[210:211], v20 offset:12800
  buffer_load_dwordx4 v[92:95], v5, s[36:39], s49 offen offset:1024
  v_mfma_f32_16x16x32_bf16 v[108:111], v[180:183], v[236:239], v[108:111]
  ds_read_b64_tr_b16 v[212:213], v21 offset:12288
  v_mfma_f32_16x16x32_bf16 v[104:107], v[180:183], v[232:235], v[104:107]
  ds_read_b64_tr_b16 v[214:215], v21 offset:12800
  v_mfma_f32_16x16x32_bf16 v[112:115], v[184:187], v[232:235], v[112:115]
  ds_read_b64_tr_b16 v[216:217], v22 offset:12288
  v_mfma_f32_16x16x32_bf16 v[116:119], v[184:187], v[236:239], v[116:119]
  ds_read_b64_tr_b16 v[218:219], v22 offset:12800
  v_readlane_b32 s50, v15, 34
  v_mfma_f32_16x16x32_bf16 v[124:127], v[188:191], v[236:239], v[124:127]
  ds_read_b64_tr_b16 v[220:221], v23 offset:12288
  v_mfma_f32_16x16x32_bf16 v[120:123], v[188:191], v[232:235], v[120:123]
  ds_read_b64_tr_b16 v[222:223], v23 offset:12800
  s_waitcnt vmcnt(18) lgkmcnt(8)
  v_mfma_f32_16x16x32_bf16 v[96:99], v[192:195], v[240:243], v[96:99]
  ds_read_b64_tr_b16 v[160:161], v20 offset:16384
  buffer_load_dwordx4 v[224:227], v4, s[36:39], s50 offen offset:0
  v_mfma_f32_16x16x32_bf16 v[100:103], v[192:195], v[244:247], v[100:103]
  ds_read_b64_tr_b16 v[162:163], v20 offset:16896
  v_mfma_f32_16x16x32_bf16 v[108:111], v[196:199], v[244:247], v[108:111]
  ds_read_b64_tr_b16 v[164:165], v21 offset:16384
  v_mfma_f32_16x16x32_bf16 v[104:107], v[196:199], v[240:243], v[104:107]
  ds_read_b64_tr_b16 v[166:167], v21 offset:16896
  buffer_load_dwordx4 v[228:231], v5, s[36:39], s50 offen offset:0
  v_mfma_f32_16x16x32_bf16 v[112:115], v[200:203], v[240:243], v[112:115]
  ds_read_b64_tr_b16 v[168:169], v22 offset:16384
  v_mfma_f32_16x16x32_bf16 v[116:119], v[200:203], v[244:247], v[116:119]
  ds_read_b64_tr_b16 v[170:171], v22 offset:16896
  v_mfma_f32_16x16x32_bf16 v[124:127], v[204:207], v[244:247], v[124:127]
  ds_read_b64_tr_b16 v[172:173], v23 offset:16384
  buffer_load_dwordx4 v[232:235], v4, s[36:39], s50 offen offset:1024
  v_mfma_f32_16x16x32_bf16 v[120:123], v[204:207], v[240:243], v[120:123]
  ds_read_b64_tr_b16 v[174:175], v23 offset:16896
  s_waitcnt vmcnt(19) lgkmcnt(8)
  v_mfma_f32_16x16x32_bf16 v[96:99], v[208:211], v[248:251], v[96:99]
  ds_read_b64_tr_b16 v[176:177], v20 offset:20480
  v_mfma_f32_16x16x32_bf16 v[100:103], v[208:211], v[252:255], v[100:103]
  ds_read_b64_tr_b16 v[178:179], v20 offset:20992
  buffer_load_dwordx4 v[236:239], v5, s[36:39], s50 offen offset:1024
  v_mfma_f32_16x16x32_bf16 v[108:111], v[212:215], v[252:255], v[108:111]
  ds_read_b64_tr_b16 v[180:181], v21 offset:20480
  v_mfma_f32_16x16x32_bf16 v[104:107], v[212:215], v[248:251], v[104:107]
  ds_read_b64_tr_b16 v[182:183], v21 offset:20992
  v_mfma_f32_16x16x32_bf16 v[112:115], v[216:219], v[248:251], v[112:115]
  ds_read_b64_tr_b16 v[184:185], v22 offset:20480
  v_mfma_f32_16x16x32_bf16 v[116:119], v[216:219], v[252:255], v[116:119]
  ds_read_b64_tr_b16 v[186:187], v22 offset:20992
  v_readlane_b32 s51, v15, 35
  v_mfma_f32_16x16x32_bf16 v[124:127], v[220:223], v[252:255], v[124:127]
  ds_read_b64_tr_b16 v[188:189], v23 offset:20480
  v_mfma_f32_16x16x32_bf16 v[120:123], v[220:223], v[248:251], v[120:123]
  ds_read_b64_tr_b16 v[190:191], v23 offset:20992
  s_waitcnt vmcnt(18) lgkmcnt(8)
  v_mfma_f32_16x16x32_bf16 v[96:99], v[160:163], v[32:35], v[96:99]
  ds_read_b64_tr_b16 v[192:193], v20 offset:24576
  buffer_load_dwordx4 v[240:243], v4, s[36:39], s51 offen offset:0
  v_mfma_f32_16x16x32_bf16 v[100:103], v[160:163], v[36:39], v[100:103]
  ds_read_b64_tr_b16 v[194:195], v20 offset:25088
  v_mfma_f32_16x16x32_bf16 v[108:111], v[164:167], v[36:39], v[108:111]
  ds_read_b64_tr_b16 v[196:197], v21 offset:24576
  v_mfma_f32_16x16x32_bf16 v[104:107], v[164:167], v[32:35], v[104:107]
  ds_read_b64_tr_b16 v[198:199], v21 offset:25088
  buffer_load_dwordx4 v[244:247], v5, s[36:39], s51 offen offset:0
  v_mfma_f32_16x16x32_bf16 v[112:115], v[168:171], v[32:35], v[112:115]
  ds_read_b64_tr_b16 v[200:201], v22 offset:24576
  v_mfma_f32_16x16x32_bf16 v[116:119], v[168:171], v[36:39], v[116:119]
  ds_read_b64_tr_b16 v[202:203], v22 offset:25088
  v_mfma_f32_16x16x32_bf16 v[124:127], v[172:175], v[36:39], v[124:127]
  ds_read_b64_tr_b16 v[204:205], v23 offset:24576
  buffer_load_dwordx4 v[248:251], v4, s[36:39], s51 offen offset:1024
  v_mfma_f32_16x16x32_bf16 v[120:123], v[172:175], v[32:35], v[120:123]
  ds_read_b64_tr_b16 v[206:207], v23 offset:25088
  s_waitcnt vmcnt(19) lgkmcnt(8)
  v_mfma_f32_16x16x32_bf16 v[96:99], v[176:179], v[40:43], v[96:99]
  ds_read_b64_tr_b16 v[208:209], v20 offset:28672
  v_mfma_f32_16x16x32_bf16 v[100:103], v[176:179], v[44:47], v[100:103]
  ds_read_b64_tr_b16 v[210:211], v20 offset:29184
  buffer_load_dwordx4 v[252:255], v5, s[36:39], s51 offen offset:1024
  v_mfma_f32_16x16x32_bf16 v[108:111], v[180:183], v[44:47], v[108:111]
  ds_read_b64_tr_b16 v[212:213], v21 offset:28672
  v_mfma_f32_16x16x32_bf16 v[104:107], v[180:183], v[40:43], v[104:107]
  ds_read_b64_tr_b16 v[214:215], v21 offset:29184
  v_mfma_f32_16x16x32_bf16 v[112:115], v[184:187], v[40:43], v[112:115]
  ds_read_b64_tr_b16 v[216:217], v22 offset:28672
  v_mfma_f32_16x16x32_bf16 v[116:119], v[184:187], v[44:47], v[116:119]
  ds_read_b64_tr_b16 v[218:219], v22 offset:29184
  v_mfma_f32_16x16x32_bf16 v[124:127], v[188:191], v[44:47], v[124:127]
  ds_read_b64_tr_b16 v[220:221], v23 offset:28672
  v_mfma_f32_16x16x32_bf16 v[120:123], v[188:191], v[40:43], v[120:123]
  ds_read_b64_tr_b16 v[222:223], v23 offset:29184
  s_waitcnt vmcnt(18) lgkmcnt(8)
  v_mfma_f32_16x16x32_bf16 v[96:99], v[192:195], v[48:51], v[96:99]
  ds_read_b64_tr_b16 v[160:161], v20 offset:32768
  v_mfma_f32_16x16x32_bf16 v[100:103], v[192:195], v[52:55], v[100:103]
  ds_read_b64_tr_b16 v[162:163], v20 offset:33280
  v_mfma_f32_16x16x32_bf16 v[108:111], v[196:199], v[52:55], v[108:111]
  ds_read_b64_tr_b16 v[164:165], v21 offset:32768
  v_mfma_f32_16x16x32_bf16 v[104:107], v[196:199], v[48:51], v[104:107]
  ds_read_b64_tr_b16 v[166:167], v21 offset:33280
  v_mfma_f32_16x16x32_bf16 v[112:115], v[200:203], v[48:51], v[112:115]
  ds_read_b64_tr_b16 v[168:169], v22 offset:32768
  v_mfma_f32_16x16x32_bf16 v[116:119], v[200:203], v[52:55], v[116:119]
  ds_read_b64_tr_b16 v[170:171], v22 offset:33280
  v_mfma_f32_16x16x32_bf16 v[124:127], v[204:207], v[52:55], v[124:127]
  ds_read_b64_tr_b16 v[172:173], v23 offset:32768
  v_mfma_f32_16x16x32_bf16 v[120:123], v[204:207], v[48:51], v[120:123]
  ds_read_b64_tr_b16 v[174:175], v23 offset:33280
  s_waitcnt vmcnt(16) lgkmcnt(8)
  v_mfma_f32_16x16x32_bf16 v[96:99], v[208:211], v[56:59], v[96:99]
  ds_read_b64_tr_b16 v[176:177], v20 offset:36864
  v_mfma_f32_16x16x32_bf16 v[100:103], v[208:211], v[60:63], v[100:103]
  ds_read_b64_tr_b16 v[178:179], v20 offset:37376
  v_mfma_f32_16x16x32_bf16 v[108:111], v[212:215], v[60:63], v[108:111]
  ds_read_b64_tr_b16 v[180:181], v21 offset:36864
  v_mfma_f32_16x16x32_bf16 v[104:107], v[212:215], v[56:59], v[104:107]
  ds_read_b64_tr_b16 v[182:183], v21 offset:37376
  v_mfma_f32_16x16x32_bf16 v[112:115], v[216:219], v[56:59], v[112:115]
  ds_read_b64_tr_b16 v[184:185], v22 offset:36864
  v_mfma_f32_16x16x32_bf16 v[116:119], v[216:219], v[60:63], v[116:119]
  ds_read_b64_tr_b16 v[186:187], v22 offset:37376
  v_mfma_f32_16x16x32_bf16 v[124:127], v[220:223], v[60:63], v[124:127]
  ds_read_b64_tr_b16 v[188:189], v23 offset:36864
  v_mfma_f32_16x16x32_bf16 v[120:123], v[220:223], v[56:59], v[120:123]
  ds_read_b64_tr_b16 v[190:191], v23 offset:37376
  s_waitcnt vmcnt(14) lgkmcnt(8)
  v_mfma_f32_16x16x32_bf16 v[96:99], v[160:163], v[64:67], v[96:99]
  ds_read_b64_tr_b16 v[192:193], v20 offset:40960
  v_mfma_f32_16x16x32_bf16 v[100:103], v[160:163], v[68:71], v[100:103]
  ds_read_b64_tr_b16 v[194:195], v20 offset:41472
  v_mfma_f32_16x16x32_bf16 v[108:111], v[164:167], v[68:71], v[108:111]
  ds_read_b64_tr_b16 v[196:197], v21 offset:40960
  v_mfma_f32_16x16x32_bf16 v[104:107], v[164:167], v[64:67], v[104:107]
  ds_read_b64_tr_b16 v[198:199], v21 offset:41472
  v_mfma_f32_16x16x32_bf16 v[112:115], v[168:171], v[64:67], v[112:115]
  ds_read_b64_tr_b16 v[200:201], v22 offset:40960
  v_mfma_f32_16x16x32_bf16 v[116:119], v[168:171], v[68:71], v[116:119]
  ds_read_b64_tr_b16 v[202:203], v22 offset:41472
  v_mfma_f32_16x16x32_bf16 v[124:127], v[172:175], v[68:71], v[124:127]
  ds_read_b64_tr_b16 v[204:205], v23 offset:40960
  v_mfma_f32_16x16x32_bf16 v[120:123], v[172:175], v[64:67], v[120:123]
  ds_read_b64_tr_b16 v[206:207], v23 offset:41472
  s_waitcnt vmcnt(12) lgkmcnt(8)
  v_mfma_f32_16x16x32_bf16 v[96:99], v[176:179], v[72:75], v[96:99]
  ds_read_b64_tr_b16 v[208:209], v20 offset:45056
  v_mfma_f32_16x16x32_bf16 v[100:103], v[176:179], v[76:79], v[100:103]
  ds_read_b64_tr_b16 v[210:211], v20 offset:45568
  v_mfma_f32_16x16x32_bf16 v[108:111], v[180:183], v[76:79], v[108:111]
  ds_read_b64_tr_b16 v[212:213], v21 offset:45056
  v_mfma_f32_16x16x32_bf16 v[104:107], v[180:183], v[72:75], v[104:107]
  ds_read_b64_tr_b16 v[214:215], v21 offset:45568
  v_mfma_f32_16x16x32_bf16 v[112:115], v[184:187], v[72:75], v[112:115]
  ds_read_b64_tr_b16 v[216:217], v22 offset:45056
  v_mfma_f32_16x16x32_bf16 v[116:119], v[184:187], v[76:79], v[116:119]
  ds_read_b64_tr_b16 v[218:219], v22 offset:45568
  v_mfma_f32_16x16x32_bf16 v[124:127], v[188:191], v[76:79], v[124:127]
  ds_read_b64_tr_b16 v[220:221], v23 offset:45056
  v_mfma_f32_16x16x32_bf16 v[120:123], v[188:191], v[72:75], v[120:123]
  ds_read_b64_tr_b16 v[222:223], v23 offset:45568
  s_waitcnt vmcnt(10) lgkmcnt(8)
  v_mfma_f32_16x16x32_bf16 v[96:99], v[192:195], v[80:83], v[96:99]
  ds_read_b64_tr_b16 v[160:161], v20 offset:49152
  v_mfma_f32_16x16x32_bf16 v[100:103], v[192:195], v[84:87], v[100:103]
  ds_read_b64_tr_b16 v[162:163], v20 offset:49664
  v_mfma_f32_16x16x32_bf16 v[108:111], v[196:199], v[84:87], v[108:111]
  ds_read_b64_tr_b16 v[164:165], v21 offset:49152
  v_mfma_f32_16x16x32_bf16 v[104:107], v[196:199], v[80:83], v[104:107]
  ds_read_b64_tr_b16 v[166:167], v21 offset:49664
  v_mfma_f32_16x16x32_bf16 v[112:115], v[200:203], v[80:83], v[112:115]
  ds_read_b64_tr_b16 v[168:169], v22 offset:49152
  v_mfma_f32_16x16x32_bf16 v[116:119], v[200:203], v[84:87], v[116:119]
  ds_read_b64_tr_b16 v[170:171], v22 offset:49664
  v_mfma_f32_16x16x32_bf16 v[124:127], v[204:207], v[84:87], v[124:127]
  ds_read_b64_tr_b16 v[172:173], v23 offset:49152
  v_mfma_f32_16x16x32_bf16 v[120:123], v[204:207], v[80:83], v[120:123]
  ds_read_b64_tr_b16 v[174:175], v23 offset:49664
  s_waitcnt vmcnt(8) lgkmcnt(8)
  v_mfma_f32_16x16x32_bf16 v[96:99], v[208:211], v[88:91], v[96:99]
  ds_read_b64_tr_b16 v[176:177], v20 offset:53248
  v_mfma_f32_16x16x32_bf16 v[100:103], v[208:211], v[92:95], v[100:103]
  ds_read_b64_tr_b16 v[178:179], v20 offset:53760
  v_mfma_f32_16x16x32_bf16 v[108:111], v[212:215], v[92:95], v[108:111]
  ds_read_b64_tr_b16 v[180:181], v21 offset:53248
  v_mfma_f32_16x16x32_bf16 v[104:107], v[212:215], v[88:91], v[104:107]
  ds_read_b64_tr_b16 v[182:183], v21 offset:53760
  v_mfma_f32_16x16x32_bf16 v[112:115], v[216:219], v[88:91], v[112:115]
  ds_read_b64_tr_b16 v[184:185], v22 offset:53248
  v_mfma_f32_16x16x32_bf16 v[116:119], v[216:219], v[92:95], v[116:119]
  ds_read_b64_tr_b16 v[186:187], v22 offset:53760
  v_mfma_f32_16x16x32_bf16 v[124:127], v[220:223], v[92:95], v[124:127]
  ds_read_b64_tr_b16 v[188:189], v23 offset:53248
  v_mfma_f32_16x16x32_bf16 v[120:123], v[220:223], v[88:91], v[120:123]
  ds_read_b64_tr_b16 v[190:191], v23 offset:53760
  s_waitcnt vmcnt(6) lgkmcnt(8)
  v_mfma_f32_16x16x32_bf16 v[96:99], v[160:163], v[224:227], v[96:99]
  ds_read_b64_tr_b16 v[192:193], v20 offset:57344
  v_mfma_f32_16x16x32_bf16 v[100:103], v[160:163], v[228:231], v[100:103]
  ds_read_b64_tr_b16 v[194:195], v20 offset:57856
  v_mfma_f32_16x16x32_bf16 v[108:111], v[164:167], v[228:231], v[108:111]
  ds_read_b64_tr_b16 v[196:197], v21 offset:57344
  v_mfma_f32_16x16x32_bf16 v[104:107], v[164:167], v[224:227], v[104:107]
  ds_read_b64_tr_b16 v[198:199], v21 offset:57856
  v_mfma_f32_16x16x32_bf16 v[112:115], v[168:171], v[224:227], v[112:115]
  ds_read_b64_tr_b16 v[200:201], v22 offset:57344
  v_mfma_f32_16x16x32_bf16 v[116:119], v[168:171], v[228:231], v[116:119]
  ds_read_b64_tr_b16 v[202:203], v22 offset:57856
  v_mfma_f32_16x16x32_bf16 v[124:127], v[172:175], v[228:231], v[124:127]
  ds_read_b64_tr_b16 v[204:205], v23 offset:57344
  v_mfma_f32_16x16x32_bf16 v[120:123], v[172:175], v[224:227], v[120:123]
  ds_read_b64_tr_b16 v[206:207], v23 offset:57856
  s_waitcnt vmcnt(4) lgkmcnt(8)
  s_barrier
  v_mfma_f32_16x16x32_bf16 v[96:99], v[176:179], v[232:235], v[96:99]
  ds_read_b64_tr_b16 v[208:209], v20 offset:61440
  ds_read_b128 v[144:147], v19 offset:0
  v_mfma_f32_16x16x32_bf16 v[100:103], v[176:179], v[236:239], v[100:103]
  ds_read_b64_tr_b16 v[210:211], v20 offset:61952
  ds_read_b128 v[148:151], v19 offset:1024
  v_mfma_f32_16x16x32_bf16 v[108:111], v[180:183], v[236:239], v[108:111]
  ds_read_b64_tr_b16 v[212:213], v21 offset:61440
  ds_read_b128 v[152:155], v19 offset:2048
  v_mfma_f32_16x16x32_bf16 v[104:107], v[180:183], v[232:235], v[104:107]
  ds_read_b64_tr_b16 v[214:215], v21 offset:61952
  ds_read_b128 v[156:159], v19 offset:3072
  v_mfma_f32_16x16x32_bf16 v[112:115], v[184:187], v[232:235], v[112:115]
  ds_read_b64_tr_b16 v[216:217], v22 offset:61440
  v_mfma_f32_16x16x32_bf16 v[116:119], v[184:187], v[236:239], v[116:119]
  ds_read_b64_tr_b16 v[218:219], v22 offset:61952
  v_mfma_f32_16x16x32_bf16 v[124:127], v[188:191], v[236:239], v[124:127]
  ds_read_b64_tr_b16 v[220:221], v23 offset:61440
  v_mfma_f32_16x16x32_bf16 v[120:123], v[188:191], v[232:235], v[120:123]
  ds_read_b64_tr_b16 v[222:223], v23 offset:61952
  s_waitcnt vmcnt(2) lgkmcnt(12)
  v_mfma_f32_16x16x32_bf16 v[96:99], v[192:195], v[240:243], v[96:99]
  v_mov_b32 v20, 0
  v_mov_b32 v21, 0
  v_mfma_f32_16x16x32_bf16 v[100:103], v[192:195], v[244:247], v[100:103]
  v_mov_b32 v22, 0
  v_mov_b32 v23, 0
  v_mfma_f32_16x16x32_bf16 v[108:111], v[196:199], v[244:247], v[108:111]
  s_waitcnt lgkmcnt(4)
  v_lshlrev_b32 v128, 16, v144
  v_and_b32 v129, s11, v144
  v_mfma_f32_16x16x32_bf16 v[104:107], v[196:199], v[240:243], v[104:107]
  v_lshlrev_b32 v130, 16, v145
  v_and_b32 v131, s11, v145
  v_lshlrev_b32 v132, 16, v146
  v_mfma_f32_16x16x32_bf16 v[112:115], v[200:203], v[240:243], v[112:115]
  v_and_b32 v133, s11, v146
  v_lshlrev_b32 v134, 16, v147
  v_and_b32 v135, s11, v147
  v_mfma_f32_16x16x32_bf16 v[116:119], v[200:203], v[244:247], v[116:119]
  v_lshlrev_b32 v136, 16, v148
  v_and_b32 v137, s11, v148
  v_lshlrev_b32 v138, 16, v149
  v_mfma_f32_16x16x32_bf16 v[124:127], v[204:207], v[244:247], v[124:127]
  v_and_b32 v139, s11, v149
  v_lshlrev_b32 v140, 16, v150
  v_and_b32 v141, s11, v150
  v_mfma_f32_16x16x32_bf16 v[120:123], v[204:207], v[240:243], v[120:123]
  s_waitcnt vmcnt(0) lgkmcnt(0)
  v_lshlrev_b32 v142, 16, v151
  v_and_b32 v143, s11, v151
  v_mfma_f32_16x16x32_bf16 v[96:99], v[208:211], v[248:251], v[96:99]
  v_lshlrev_b32 v144, 16, v152
  v_and_b32 v145, s11, v152
  v_lshlrev_b32 v146, 16, v153
  v_mfma_f32_16x16x32_bf16 v[100:103], v[208:211], v[252:255], v[100:103]
  v_and_b32 v147, s11, v153
  v_lshlrev_b32 v148, 16, v154
  v_and_b32 v149, s11, v154
  v_mfma_f32_16x16x32_bf16 v[108:111], v[212:215], v[252:255], v[108:111]
  v_lshlrev_b32 v150, 16, v155
  v_and_b32 v151, s11, v155
  v_lshlrev_b32 v152, 16, v156
  v_mfma_f32_16x16x32_bf16 v[104:107], v[212:215], v[248:251], v[104:107]
  v_and_b32 v153, s11, v156
  v_lshlrev_b32 v154, 16, v157
  v_and_b32 v155, s11, v157
  v_mfma_f32_16x16x32_bf16 v[112:115], v[216:219], v[248:251], v[112:115]
  v_lshlrev_b32 v156, 16, v158
  v_and_b32 v157, s11, v158
  v_lshlrev_b32 v158, 16, v159
  v_mfma_f32_16x16x32_bf16 v[116:119], v[216:219], v[252:255], v[116:119]
  v_and_b32 v159, s11, v159
  v_mfma_f32_16x16x32_bf16 v[124:127], v[220:223], v[252:255], v[124:127]
  v_mfma_f32_16x16x32_bf16 v[120:123], v[220:223], v[248:251], v[120:123]
  s_lshl_b32 s3, s7, 4
  s_mov_b32 s10, 0x3f803f80
  s_nop 4
  v_pk_add_f32 v[96:97], v[96:97], v[128:129]
  v_pk_add_f32 v[98:99], v[98:99], v[130:131]
  v_cvt_pk_bf16_f32 v240, v96, v97
  v_cvt_pk_bf16_f32 v241, v98, v99
  v_pk_add_f32 v[104:105], v[104:105], v[136:137]
  v_pk_add_f32 v[106:107], v[106:107], v[138:139]
  v_cvt_pk_bf16_f32 v242, v104, v105
  v_cvt_pk_bf16_f32 v243, v106, v107
  s_nop 1
  v_permlane16_swap_b32 v240, v242
  v_permlane16_swap_b32 v241, v243
  buffer_store_dwordx4 v[240:243], v12, s[44:47], 0 offen offset:0 sc1
  v_pk_add_f32 v[112:113], v[112:113], v[144:145]
  v_pk_add_f32 v[114:115], v[114:115], v[146:147]
  v_cvt_pk_bf16_f32 v244, v112, v113
  v_cvt_pk_bf16_f32 v245, v114, v115
  v_pk_add_f32 v[120:121], v[120:121], v[152:153]
  v_pk_add_f32 v[122:123], v[122:123], v[154:155]
  v_cvt_pk_bf16_f32 v246, v120, v121
  v_cvt_pk_bf16_f32 v247, v122, v123
  s_nop 1
  v_permlane16_swap_b32 v244, v246
  v_permlane16_swap_b32 v245, v247
  buffer_store_dwordx4 v[244:247], v12, s[44:47], 0 offen offset:64 sc1
  v_pk_add_f32 v[100:101], v[100:101], v[132:133]
  v_pk_add_f32 v[102:103], v[102:103], v[134:135]
  v_cvt_pk_bf16_f32 v248, v100, v101
  v_cvt_pk_bf16_f32 v249, v102, v103
  v_pk_add_f32 v[108:109], v[108:109], v[140:141]
  v_pk_add_f32 v[110:111], v[110:111], v[142:143]
  v_cvt_pk_bf16_f32 v250, v108, v109
  v_cvt_pk_bf16_f32 v251, v110, v111
  s_nop 1
  v_permlane16_swap_b32 v248, v250
  v_permlane16_swap_b32 v249, v251
  buffer_store_dwordx4 v[248:251], v12, s[44:47], s3 offen offset:0 sc1
  v_pk_add_f32 v[116:117], v[116:117], v[148:149]
  v_pk_add_f32 v[118:119], v[118:119], v[150:151]
  v_cvt_pk_bf16_f32 v252, v116, v117
  v_cvt_pk_bf16_f32 v253, v118, v119
  v_pk_add_f32 v[124:125], v[124:125], v[156:157]
  v_pk_add_f32 v[126:127], v[126:127], v[158:159]
  v_cvt_pk_bf16_f32 v254, v124, v125
  v_cvt_pk_bf16_f32 v255, v126, v127
  s_nop 1
  v_permlane16_swap_b32 v252, v254
  v_permlane16_swap_b32 v253, v255
  buffer_store_dwordx4 v[252:255], v12, s[44:47], s3 offen offset:64 sc1
  v_dot2_f32_bf16 v20, v240, s10, v20
  v_dot2_f32_bf16 v22, v240, v240, v22
  v_dot2_f32_bf16 v20, v241, s10, v20
  v_dot2_f32_bf16 v22, v241, v241, v22
  v_dot2_f32_bf16 v20, v242, s10, v20
  v_dot2_f32_bf16 v22, v242, v242, v22
  v_dot2_f32_bf16 v20, v243, s10, v20
  v_dot2_f32_bf16 v22, v243, v243, v22
  v_dot2_f32_bf16 v20, v244, s10, v20
  v_dot2_f32_bf16 v22, v244, v244, v22
  v_dot2_f32_bf16 v20, v245, s10, v20
  v_dot2_f32_bf16 v22, v245, v245, v22
  v_dot2_f32_bf16 v20, v246, s10, v20
  v_dot2_f32_bf16 v22, v246, v246, v22
  v_dot2_f32_bf16 v20, v247, s10, v20
  v_dot2_f32_bf16 v22, v247, v247, v22
  v_dot2_f32_bf16 v21, v248, s10, v21
  v_dot2_f32_bf16 v23, v248, v248, v23
  v_dot2_f32_bf16 v21, v249, s10, v21
  v_dot2_f32_bf16 v23, v249, v249, v23
  v_dot2_f32_bf16 v21, v250, s10, v21
  v_dot2_f32_bf16 v23, v250, v250, v23
  v_dot2_f32_bf16 v21, v251, s10, v21
  v_dot2_f32_bf16 v23, v251, v251, v23
  v_dot2_f32_bf16 v21, v252, s10, v21
  v_dot2_f32_bf16 v23, v252, v252, v23
  v_dot2_f32_bf16 v21, v253, s10, v21
  v_dot2_f32_bf16 v23, v253, v253, v23
  v_dot2_f32_bf16 v21, v254, s10, v21
  v_dot2_f32_bf16 v23, v254, v254, v23
  v_dot2_f32_bf16 v21, v255, s10, v21
  v_dot2_f32_bf16 v23, v255, v255, v23
  s_nop 2
  v_permlane32_swap_b32 v20, v21
  v_permlane32_swap_b32 v22, v23
  v_add_f32 v20, v20, v21
  v_add_f32 v22, v22, v23
  s_nop 1
  v_permlane16_swap_b32 v20, v22
  v_add_f32 v20, v20, v22
  buffer_store_dword v20, v18, s[56:59], 0 offen sc1
  s_cmp_eq_u32 s96, 1
  s_cbranch_scc1 L_w2_end
  s_waitcnt vmcnt(0) lgkmcnt(0)
  s_barrier
  s_mov_b32 s96, 1
  s_add_u32 s12, s22, 33554432
  s_addc_u32 s13, s23, 0
  s_add_u32 s34, s22, 67108864
  s_addc_u32 s35, s23, 0
  s_add_u32 s97, s97, 1
  s_branch L_attn_body
L_w2_c1:
```

```asm
; @launch grid=(256,1,1) block=(512,1,1) lds=163840
.amdgcn_target "amdgcn-amd-amdhsa--gfx950"
L_attn_c0:
.text
.globl interleave_layers__sliding_local_dilated__dense_activation_gelu__prompt_kernel
.p2align 8
.type interleave_layers__sliding_local_dilated__dense_activation_gelu__prompt_kernel,@function
interleave_layers__sliding_local_dilated__dense_activation_gelu__prompt_kernel:
  s_load_dwordx4 s[16:19], s[0:1], 0
  s_load_dwordx2 s[20:21], s[0:1], 16
  s_load_dwordx2 s[22:23], s[0:1], 80
  s_load_dwordx8 s[24:31], s[0:1], 32
  s_load_dwordx2 s[32:33], s[0:1], 64
  s_load_dwordx2 s[34:35], s[0:1], 80
  s_load_dwordx2 s[12:13], s[0:1], 0
  s_mov_b32 s96, 0
  s_mov_b32 s97, 0
L_attn_body:
  s_cmp_ge_u32 s2, 256
  s_cbranch_scc1 L_attn_end
  v_lshrrev_b32 v2, 6, v0
  v_and_b32 v1, 63, v0
  v_readfirstlane_b32 s70, v2
  s_and_b32 s3, s2, 7
  s_lshr_b32 s99, s2, 3
  s_and_b32 s5, s3, 1
  s_lshl_b32 s5, s5, 3
  s_and_b32 s6, s99, 7
  s_add_u32 s68, s5, s6
  s_lshr_b32 s5, s3, 1
  s_lshl_b32 s5, s5, 2
  s_lshr_b32 s6, s99, 3
  s_add_u32 s69, s5, s6
  s_cmp_lt_u32 s70, 4
  s_cbranch_scc1 L_attn_compute
L_attn_loader:
  s_add_u32 s8, s70, s69
  s_and_b32 s8, s8, 3
  s_add_u32 s9, s70, s68
  s_and_b32 s9, s9, 3
  s_lshl_b32 s76, s8, 12
  s_lshl_b32 s77, s9, 11
  s_add_u32 s77, s77, 16384
  s_lshl_b32 s11, s68, 7
  v_and_b32 v10, 7, v1
  v_lshrrev_b32 v3, 3, v1
  s_lshr_b32 s10, s76, 7
  s_lshl_b32 s3, s68, 7
  s_add_u32 s10, s10, s3
  v_add_u32 v3, s10, v3
  s_cmp_eq_u32 s96, 1
  s_cselect_b32 s5, 128, 0
  s_add_u32 s5, s5, 2048
  s_lshl_b32 s6, s5, 3
  v_mul_u32_u24 v3, s5, v3
  v_lshrrev_b32 v2, 4, v1
  v_xor_b32 v4, v2, v10
  v_lshl_add_u32 v4, v4, 4, v3
  v_add_u32 v3, s6, v3
  v_add_u32 v5, 4, v2
  v_xor_b32 v5, v5, v10
  v_lshl_add_u32 v5, v5, 4, v3
  v_add_u32 v3, s6, v3
  v_xor_b32 v6, v2, v10
  v_lshl_add_u32 v6, v6, 4, v3
  v_add_u32 v3, s6, v3
  v_add_u32 v7, 4, v2
  v_xor_b32 v7, v7, v10
  v_lshl_add_u32 v7, v7, 4, v3
  v_lshrrev_b32 v3, 3, v1
  s_lshl_b32 s10, s9, 4
  v_add_u32 v3, s10, v3
  v_mul_u32_u24 v3, 6144, v3
  v_lshrrev_b32 v2, 3, v1
  v_and_b32 v2, 2, v2
  v_xor_b32 v2, v2, v10
  s_mul_i32 s10, s69, 128
  v_add_u32 v3, s10, v3
  v_lshl_add_u32 v8, v2, 4, v3
  v_xor_b32 v2, 4, v2
  v_add_u32 v3, 49152, v3
  v_lshl_add_u32 v9, v2, 4, v3
  s_and_b32 s10, s70, 3
  s_lshl_b32 s78, s10, 9
  s_add_u32 s78, s78, 40960
  s_lshl_b32 s14, s10, 2
  s_add_u32 s14, s14, s11
  s_sub_u32 s14, s14, 16
  v_lshrrev_b32 v3, 3, v1
  v_add_u32 v3, s14, v3
  v_max_i32 v3, 0, v3
  v_mul_u32_u24 v3, s5, v3
  s_lshl_b32 s14, s10, 1
  v_lshrrev_b32 v2, 4, v1
  v_add_u32 v2, s14, v2
  v_and_b32 v2, 7, v2
  v_xor_b32 v2, v2, v10
  v_lshl_add_u32 v28, v2, 4, v3
  s_cmp_eq_u32 s10, 0
  s_cselect_b32 s14, 0xffffff00, -1
  s_mov_b32 s15, 0
  s_mov_b32 s75, 0
  s_add_u32 s100, s68, s69
  s_mov_b32 s101, -1
  s_add_u32 s101, s101, 1
  s_sub_u32 s73, s101, s100
  s_lshl_b32 s73, s73, 3
  s_lshr_b32 s73, 0xf0f02, s73
  s_and_b32 s73, s73, 255
  s_add_u32 s73, s73, s101
  s_and_b32 s73, s73, 15
  s_mul_i32 s74, s73, 393216
  s_lshl_b32 s73, s73, 7
  s_waitcnt lgkmcnt(0)
  s_mov_b32 s36, s12
  s_and_b32 s37, s13, 0xffff
  s_mov_b32 s38, 4194304
  s_mov_b32 s39, 0x00020000
  s_cmp_eq_u32 s96, 1
  s_cselect_b32 s38, 128, 0
  s_add_u32 s38, s38, 2048
  s_lshl_b32 s38, s38, 11
  s_mov_b32 s40, s18
  s_and_b32 s41, s19, 0xffff
  s_mov_b32 s42, 6291456
  s_mov_b32 s43, 0x00020000
  s_cmp_lg_u32 s96, 0
  s_cbranch_scc1 L_attn_ld1
  s_mov_b32 s48, s28
  s_and_b32 s49, s29, 0xffff
  s_mov_b32 s50, 7340032
  s_mov_b32 s51, 0x00020000
  s_cmp_eq_u32 s96, 0
  s_cselect_b32 s50, s50, 0
  s_and_b32 s3, s70, 3
  s_lshl_b32 s4, s2, 2
  s_add_u32 s3, s3, s4
  s_mul_i32 s98, s3, 3584
  s_add_u32 s98, s98, 0
  s_add_u32 s3, s75, s76
  s_add_u32 m0, s3, 0
  s_nop 0
  buffer_load_dwordx4 v4, s[36:39], s73 offen lds
  s_add_u32 m0, s3, 1024
  s_nop 0
  buffer_load_dwordx4 v5, s[36:39], s73 offen lds
  s_add_u32 m0, s3, 2048
  s_nop 0
  buffer_load_dwordx4 v6, s[36:39], s73 offen lds
  s_add_u32 m0, s3, 3072
  s_nop 0
  buffer_load_dwordx4 v7, s[36:39], s73 offen lds
  s_add_u32 m0, s78, s75
  s_mov_b64 exec, s[14:15]
  buffer_load_dwordx4 v28, s[36:39], s73 offen lds
  s_mov_b64 exec, -1
  s_add_u32 s3, s75, s77
  s_add_u32 m0, s3, 0
  s_add_u32 s4, s74, 0
  buffer_load_dwordx4 v8, s[40:43], s4 offen lds
  s_add_u32 m0, s3, 1024
  s_nop 0
  buffer_load_dwordx4 v9, s[40:43], s4 offen lds
  s_add_u32 m0, s3, 8192
  s_add_u32 s4, s74, 2048
  buffer_load_dwordx4 v8, s[40:43], s4 offen lds
  s_add_u32 m0, s3, 9216
  s_nop 0
  buffer_load_dwordx4 v9, s[40:43], s4 offen lds
  s_add_u32 m0, s3, 16384
  s_add_u32 s4, s74, 4096
  buffer_load_dwordx4 v8, s[40:43], s4 offen lds
  s_add_u32 m0, s3, 17408
  s_nop 0
  buffer_load_dwordx4 v9, s[40:43], s4 offen lds
  s_add_u32 s101, s101, 1
  s_sub_u32 s73, s101, s100
  s_lshl_b32 s73, s73, 3
  s_lshr_b32 s73, 0xf0f02, s73
  s_and_b32 s73, s73, 255
  s_add_u32 s73, s73, s101
  s_and_b32 s73, s73, 15
  s_mul_i32 s74, s73, 393216
  s_lshl_b32 s73, s73, 7
  s_add_u32 s75, s75, 43008
  s_cmp_eq_u32 s75, 129024
  s_cselect_b32 s75, 0, s75
  s_add_u32 s3, s75, s76
  s_add_u32 m0, s3, 0
  s_nop 0
  buffer_load_dwordx4 v4, s[36:39], s73 offen lds
  s_add_u32 m0, s3, 1024
  s_nop 0
  buffer_load_dwordx4 v5, s[36:39], s73 offen lds
  s_add_u32 m0, s3, 2048
  s_nop 0
  buffer_load_dwordx4 v6, s[36:39], s73 offen lds
  s_add_u32 m0, s3, 3072
  s_nop 0
  buffer_load_dwordx4 v7, s[36:39], s73 offen lds
  s_add_u32 m0, s78, s75
  s_mov_b64 exec, s[14:15]
  buffer_load_dwordx4 v28, s[36:39], s73 offen lds
  s_mov_b64 exec, -1
  s_add_u32 s3, s75, s77
  s_add_u32 m0, s3, 0
  s_add_u32 s4, s74, 0
  buffer_load_dwordx4 v8, s[40:43], s4 offen lds
  s_add_u32 m0, s3, 1024
  s_nop 0
  buffer_load_dwordx4 v9, s[40:43], s4 offen lds
  s_add_u32 m0, s3, 8192
  s_add_u32 s4, s74, 2048
  buffer_load_dwordx4 v8, s[40:43], s4 offen lds
  s_add_u32 m0, s3, 9216
  s_nop 0
  buffer_load_dwordx4 v9, s[40:43], s4 offen lds
  s_add_u32 m0, s3, 16384
  s_add_u32 s4, s74, 4096
  buffer_load_dwordx4 v8, s[40:43], s4 offen lds
  s_add_u32 m0, s3, 17408
  s_nop 0
  buffer_load_dwordx4 v9, s[40:43], s4 offen lds
  s_add_u32 s101, s101, 1
  s_sub_u32 s73, s101, s100
  s_lshl_b32 s73, s73, 3
  s_lshr_b32 s73, 0xf0f02, s73
  s_and_b32 s73, s73, 255
  s_add_u32 s73, s73, s101
  s_and_b32 s73, s73, 15
  s_mul_i32 s74, s73, 393216
  s_lshl_b32 s73, s73, 7
  s_add_u32 s75, s75, 43008
  s_cmp_eq_u32 s75, 129024
  s_cselect_b32 s75, 0, s75
  s_and_b32 s3, s70, 3
  s_lshl_b32 s4, s2, 2
  s_add_u32 s3, s3, s4
  s_sub_u32 s4, 384, s40
  s_and_b32 s4, s4, 0x380
  s_mul_i32 s5, s3, 6144
  s_add_u32 s5, s5, s4
  s_buffer_load_dword s84, s[40:43], s5 offset:0
  s_buffer_load_dword s84, s[40:43], s5 offset:64
  s_buffer_load_dword s84, s[40:43], s5 offset:1024
  s_buffer_load_dword s84, s[40:43], s5 offset:1088
  s_buffer_load_dword s84, s[40:43], s5 offset:2048
  s_buffer_load_dword s84, s[40:43], s5 offset:2112
  s_buffer_load_dword s84, s[40:43], s5 offset:3072
  s_buffer_load_dword s84, s[40:43], s5 offset:3136
  s_buffer_load_dword s84, s[40:43], s5 offset:4096
  s_buffer_load_dword s84, s[40:43], s5 offset:4160
  s_buffer_load_dword s84, s[40:43], s5 offset:5120
  s_buffer_load_dword s84, s[40:43], s5 offset:5184
  s_waitcnt vmcnt(11)
  s_barrier
  s_mov_b32 s79, 13
L_attn0_ld1:
  s_add_u32 s3, s75, s76
  s_add_u32 m0, s3, 0
  s_nop 0
  buffer_load_dwordx4 v4, s[36:39], s73 offen lds
  s_add_u32 m0, s3, 1024
  s_nop 0
  buffer_load_dwordx4 v5, s[36:39], s73 offen lds
  s_add_u32 m0, s3, 2048
  s_nop 0
  buffer_load_dwordx4 v6, s[36:39], s73 offen lds
  s_add_u32 m0, s3, 3072
  s_nop 0
  buffer_load_dwordx4 v7, s[36:39], s73 offen lds
  s_add_u32 m0, s78, s75
  s_mov_b64 exec, s[14:15]
  buffer_load_dwordx4 v28, s[36:39], s73 offen lds
  s_mov_b64 exec, -1
  s_add_u32 s3, s75, s77
  s_add_u32 m0, s3, 0
  s_add_u32 s4, s74, 0
  buffer_load_dwordx4 v8, s[40:43], s4 offen lds
  s_add_u32 m0, s3, 1024
  s_nop 0
  buffer_load_dwordx4 v9, s[40:43], s4 offen lds
  s_add_u32 m0, s3, 8192
  s_add_u32 s4, s74, 2048
  buffer_load_dwordx4 v8, s[40:43], s4 offen lds
  s_add_u32 m0, s3, 9216
  s_nop 0
  buffer_load_dwordx4 v9, s[40:43], s4 offen lds
  s_add_u32 m0, s3, 16384
  s_add_u32 s4, s74, 4096
  buffer_load_dwordx4 v8, s[40:43], s4 offen lds
  s_add_u32 m0, s3, 17408
  s_nop 0
  buffer_load_dwordx4 v9, s[40:43], s4 offen lds
  s_add_u32 s101, s101, 1
  s_sub_u32 s73, s101, s100
  s_lshl_b32 s73, s73, 3
  s_lshr_b32 s73, 0xf0f02, s73
  s_and_b32 s73, s73, 255
  s_add_u32 s73, s73, s101
  s_and_b32 s73, s73, 15
  s_mul_i32 s74, s73, 393216
  s_lshl_b32 s73, s73, 7
  s_add_u32 s75, s75, 43008
  s_cmp_eq_u32 s75, 129024
  s_cselect_b32 s75, 0, s75
  s_buffer_load_dword s84, s[48:51], s98 offset:0
  s_buffer_load_dword s84, s[48:51], s98 offset:64
  s_buffer_load_dword s84, s[48:51], s98 offset:128
  s_buffer_load_dword s84, s[48:51], s98 offset:192
  s_add_u32 s98, s98, 256
  s_waitcnt vmcnt(11)
  s_barrier
  s_sub_u32 s79, s79, 1
  s_cmp_lg_u32 s79, 0
  s_cbranch_scc1 L_attn0_ld1
  s_add_u32 s3, s75, s76
  s_add_u32 m0, s3, 0
  s_nop 0
  buffer_load_dwordx4 v4, s[36:39], s73 offen lds
  s_add_u32 m0, s3, 1024
  s_nop 0
  buffer_load_dwordx4 v5, s[36:39], s73 offen lds
  s_add_u32 m0, s3, 2048
  s_nop 0
  buffer_load_dwordx4 v6, s[36:39], s73 offen lds
  s_add_u32 m0, s3, 3072
  s_nop 0
  buffer_load_dwordx4 v7, s[36:39], s73 offen lds
  s_add_u32 m0, s78, s75
  s_mov_b64 exec, s[14:15]
  buffer_load_dwordx4 v28, s[36:39], s73 offen lds
  s_mov_b64 exec, -1
  s_add_u32 s3, s75, s77
  s_add_u32 m0, s3, 0
  s_add_u32 s4, s74, 0
  buffer_load_dwordx4 v8, s[40:43], s4 offen lds
  s_add_u32 m0, s3, 1024
  s_nop 0
  buffer_load_dwordx4 v9, s[40:43], s4 offen lds
  s_add_u32 m0, s3, 8192
  s_add_u32 s4, s74, 2048
  buffer_load_dwordx4 v8, s[40:43], s4 offen lds
  s_add_u32 m0, s3, 9216
  s_nop 0
  buffer_load_dwordx4 v9, s[40:43], s4 offen lds
  s_add_u32 m0, s3, 16384
  s_add_u32 s4, s74, 4096
  buffer_load_dwordx4 v8, s[40:43], s4 offen lds
  s_add_u32 m0, s3, 17408
  s_nop 0
  buffer_load_dwordx4 v9, s[40:43], s4 offen lds
  s_add_u32 s101, s101, 1
  s_sub_u32 s73, s101, s100
  s_lshl_b32 s73, s73, 3
  s_lshr_b32 s73, 0xf0f02, s73
  s_and_b32 s73, s73, 255
  s_add_u32 s73, s73, s101
  s_and_b32 s73, s73, 15
  s_mul_i32 s74, s73, 393216
  s_lshl_b32 s73, s73, 7
  s_add_u32 s75, s75, 43008
  s_cmp_eq_u32 s75, 129024
  s_cselect_b32 s75, 0, s75
  s_buffer_load_dword s84, s[48:51], s98 offset:0
  s_buffer_load_dword s84, s[48:51], s98 offset:64
  s_buffer_load_dword s84, s[48:51], s98 offset:128
  s_buffer_load_dword s84, s[48:51], s98 offset:192
  s_add_u32 s98, s98, 256
  s_mov_b32 s64, s24
  s_and_b32 s65, s25, 0xffff
  s_mov_b32 s66, 7340032
  s_mov_b32 s67, 0x00020000
  s_min_u32 s3, s2, 223
  s_mul_i32 s4, s3, 4682
  s_lshr_b32 s4, s4, 16
  s_mul_i32 s5, s4, 14
  s_sub_u32 s3, s3, s5
  s_lshl_b32 s3, s3, 2
  s_and_b32 s5, s70, 3
  s_add_u32 s3, s3, s5
  s_mul_i32 s5, s4, 458752
  s_lshl_b32 s8, s3, 7
  s_add_u32 s5, s5, s8
  s_lshl_b32 s9, s4, 14
  s_lshl_b32 s8, s3, 8
  s_add_u32 s94, s9, s8
  v_lshrrev_b32 v2, 3, v1
  v_mul_u32_u24 v2, 7168, v2
  v_and_b32 v3, 7, v1
  v_lshl_add_u32 v2, v3, 4, v2
  buffer_load_dwordx4 v[64:67], v2, s[64:67], s5 offen
  s_add_u32 s5, s5, 57344
  buffer_load_dwordx4 v[68:71], v2, s[64:67], s5 offen
  s_add_u32 s5, s5, 57344
  buffer_load_dwordx4 v[72:75], v2, s[64:67], s5 offen
  s_add_u32 s5, s5, 57344
  buffer_load_dwordx4 v[76:79], v2, s[64:67], s5 offen
  s_add_u32 s5, s5, 57344
  buffer_load_dwordx4 v[80:83], v2, s[64:67], s5 offen
  s_add_u32 s5, s5, 57344
  buffer_load_dwordx4 v[84:87], v2, s[64:67], s5 offen
  s_add_u32 s5, s5, 57344
  buffer_load_dwordx4 v[88:91], v2, s[64:67], s5 offen
  s_add_u32 s5, s5, 57344
  buffer_load_dwordx4 v[92:95], v2, s[64:67], s5 offen
  s_mov_b32 s60, s20
  s_and_b32 s61, s21, 0xffff
  s_mov_b32 s62, 2097152
  s_mov_b32 s63, 0x00020000
  s_and_b32 s3, s70, 3
  s_mul_i32 s3, s3, 8
  s_mul_i32 s4, s99, 32
  s_add_u32 s3, s3, s4
  v_lshrrev_b32 v2, 3, v1
  v_add_u32 v2, s3, v2
  v_mul_u32_u24 v2, 2048, v2
  v_and_b32 v3, 7, v1
  v_lshl_add_u32 v2, v3, 8, v2
  s_and_b32 s3, s2, 7
  s_lshr_b32 s3, s3, 2
  s_mul_i32 s3, s3, 128
  buffer_load_dword v96, v2, s[60:63], s3 offen
  s_waitcnt vmcnt(20)
  s_barrier
  s_waitcnt vmcnt(9)
  s_barrier
  s_barrier
  s_barrier
  s_barrier
  s_branch L_attn_ldend
L_attn_ld1:
  s_add_u32 s56, s22, 24379392
  s_addc_u32 s57, s23, 0
  s_and_b32 s57, s57, 0xffff
  s_mov_b32 s58, 262144
  s_mov_b32 s59, 0x00020000
  s_mov_b32 s75, 86016
  s_add_u32 s44, s22, 41943040
  s_addc_u32 s45, s23, 0
  s_and_b32 s45, s45, 0xffff
  s_mov_b32 s46, 524288
  s_mov_b32 s47, 0x00020000
  s_lshl4_add_u32 s3, s97, s68
  s_and_b32 s4, s69, 15
  s_lshl4_add_u32 s3, s3, s4
  s_lshl_b32 s3, s3, 7
  s_sub_u32 s3, s3, 32768
  v_lshlrev_b32 v11, 7, v1
  s_cmp_eq_u32 s68, 0
  s_cselect_b32 s4, 15, 31
  v_and_b32 v2, 16, v1
  v_lshl_add_u32 v11, v2, 2, v11
  v_and_b32 v2, s4, v1
  v_lshlrev_b32 v2, 2, v2
  v_mov_b32 v3, 1
  s_mov_b32 s79, 0x100000
  s_cmp_lg_u32 s70, 4
  s_barrier
  s_cbranch_scc1 L_attn_nofl
  s_mov_b32 exec_lo, 0xffffffff
  s_mov_b32 exec_hi, 0
  buffer_store_dword v3, v11, s[44:47], s87 offen sc1
  s_mov_b64 exec, -1
L_attn_nofl:
  s_mov_b32 s5, s3
  s_mov_b32 s88, s73
  s_add_u32 m0, s77, 0
  s_add_u32 s4, s74, 0
  buffer_load_dwordx4 v8, s[40:43], s4 offen lds
  s_add_u32 m0, s77, 1024
  s_nop 0
  buffer_load_dwordx4 v9, s[40:43], s4 offen lds
  s_add_u32 m0, s77, 8192
  s_add_u32 s4, s74, 2048
  buffer_load_dwordx4 v8, s[40:43], s4 offen lds
  s_add_u32 m0, s77, 9216
  s_nop 0
  buffer_load_dwordx4 v9, s[40:43], s4 offen lds
  s_add_u32 m0, s77, 16384
  s_add_u32 s4, s74, 4096
  buffer_load_dwordx4 v8, s[40:43], s4 offen lds
  s_add_u32 m0, s77, 17408
  s_nop 0
  buffer_load_dwordx4 v9, s[40:43], s4 offen lds
  s_add_u32 s101, s101, 1
  s_sub_u32 s73, s101, s100
  s_lshl_b32 s73, s73, 3
  s_lshr_b32 s73, 0xf0f02, s73
  s_and_b32 s73, s73, 255
  s_add_u32 s73, s73, s101
  s_and_b32 s73, s73, 15
  s_mul_i32 s74, s73, 393216
  s_lshl_b32 s73, s73, 7
  s_mov_b32 s89, s73
  s_add_u32 m0, s77, 43008
  s_add_u32 s4, s74, 0
  buffer_load_dwordx4 v8, s[40:43], s4 offen lds
  s_add_u32 m0, s77, 44032
  s_nop 0
  buffer_load_dwordx4 v9, s[40:43], s4 offen lds
  s_add_u32 m0, s77, 51200
  s_add_u32 s4, s74, 2048
  buffer_load_dwordx4 v8, s[40:43], s4 offen lds
  s_add_u32 m0, s77, 52224
  s_nop 0
  buffer_load_dwordx4 v9, s[40:43], s4 offen lds
  s_add_u32 m0, s77, 59392
  s_add_u32 s4, s74, 4096
  buffer_load_dwordx4 v8, s[40:43], s4 offen lds
  s_add_u32 m0, s77, 60416
  s_nop 0
  buffer_load_dwordx4 v9, s[40:43], s4 offen lds
  s_add_u32 s101, s101, 1
  s_sub_u32 s73, s101, s100
  s_lshl_b32 s73, s73, 3
  s_lshr_b32 s73, 0xf0f02, s73
  s_and_b32 s73, s73, 255
  s_add_u32 s73, s73, s101
  s_and_b32 s73, s73, 15
  s_mul_i32 s74, s73, 393216
  s_lshl_b32 s73, s73, 7
  s_mov_b32 s3, s5
  s_cmp_lg_u32 s70, 4
  s_cbranch_scc1 L_attn_dep
L_attn_poll:
  buffer_load_dword v3, v2, s[44:47], s3 offen sc1
  s_sub_u32 s79, s79, 1
  s_cbranch_scc1 L_attn_dep
  s_waitcnt vmcnt(0)
  v_cmp_ne_u32 vcc, 1, v3
  s_cbranch_vccnz L_attn_poll
L_attn_dep:
  s_barrier
  s_add_u32 m0, s76, 0
  s_nop 0
  buffer_load_dwordx4 v4, s[36:39], s88 offen lds
  s_add_u32 m0, s76, 1024
  s_nop 0
  buffer_load_dwordx4 v5, s[36:39], s88 offen lds
  s_add_u32 m0, s76, 2048
  s_nop 0
  buffer_load_dwordx4 v6, s[36:39], s88 offen lds
  s_add_u32 m0, s76, 3072
  s_nop 0
  buffer_load_dwordx4 v7, s[36:39], s88 offen lds
  s_add_u32 m0, s78, 0
  s_mov_b64 exec, s[14:15]
  buffer_load_dwordx4 v28, s[36:39], s88 offen lds
  s_mov_b64 exec, -1
  s_add_u32 m0, s76, 43008
  s_nop 0
  buffer_load_dwordx4 v4, s[36:39], s89 offen lds
  s_add_u32 m0, s76, 44032
  s_nop 0
  buffer_load_dwordx4 v5, s[36:39], s89 offen lds
  s_add_u32 m0, s76, 45056
  s_nop 0
  buffer_load_dwordx4 v6, s[36:39], s89 offen lds
  s_add_u32 m0, s76, 46080
  s_nop 0
  buffer_load_dwordx4 v7, s[36:39], s89 offen lds
  s_add_u32 m0, s78, 43008
  s_mov_b64 exec, s[14:15]
  buffer_load_dwordx4 v28, s[36:39], s89 offen lds
  s_mov_b64 exec, -1
  s_waitcnt vmcnt(5)
  s_barrier
  s_mov_b32 s79, 13
L_attn1_ld1:
  s_add_u32 s3, s75, s76
  s_add_u32 m0, s3, 0
  s_nop 0
  buffer_load_dwordx4 v4, s[36:39], s73 offen lds
  s_add_u32 m0, s3, 1024
  s_nop 0
  buffer_load_dwordx4 v5, s[36:39], s73 offen lds
  s_add_u32 m0, s3, 2048
  s_nop 0
  buffer_load_dwordx4 v6, s[36:39], s73 offen lds
  s_add_u32 m0, s3, 3072
  s_nop 0
  buffer_load_dwordx4 v7, s[36:39], s73 offen lds
  s_add_u32 m0, s78, s75
  s_mov_b64 exec, s[14:15]
  buffer_load_dwordx4 v28, s[36:39], s73 offen lds
  s_mov_b64 exec, -1
  s_add_u32 s3, s75, s77
  s_add_u32 m0, s3, 0
  s_add_u32 s4, s74, 0
  buffer_load_dwordx4 v8, s[40:43], s4 offen lds
  s_add_u32 m0, s3, 1024
  s_nop 0
  buffer_load_dwordx4 v9, s[40:43], s4 offen lds
  s_add_u32 m0, s3, 8192
  s_add_u32 s4, s74, 2048
  buffer_load_dwordx4 v8, s[40:43], s4 offen lds
  s_add_u32 m0, s3, 9216
  s_nop 0
  buffer_load_dwordx4 v9, s[40:43], s4 offen lds
  s_add_u32 m0, s3, 16384
  s_add_u32 s4, s74, 4096
  buffer_load_dwordx4 v8, s[40:43], s4 offen lds
  s_add_u32 m0, s3, 17408
  s_nop 0
  buffer_load_dwordx4 v9, s[40:43], s4 offen lds
  s_add_u32 s101, s101, 1
  s_sub_u32 s73, s101, s100
  s_lshl_b32 s73, s73, 3
  s_lshr_b32 s73, 0xf0f02, s73
  s_and_b32 s73, s73, 255
  s_add_u32 s73, s73, s101
  s_and_b32 s73, s73, 15
  s_mul_i32 s74, s73, 393216
  s_lshl_b32 s73, s73, 7
  s_add_u32 s75, s75, 43008
  s_cmp_eq_u32 s75, 129024
  s_cselect_b32 s75, 0, s75
  s_waitcnt vmcnt(11)
  s_barrier
  s_sub_u32 s79, s79, 1
  s_cmp_lg_u32 s79, 0
  s_cbranch_scc1 L_attn1_ld1
  s_add_u32 s3, s75, s76
  s_add_u32 m0, s3, 0
  s_nop 0
  buffer_load_dwordx4 v4, s[36:39], s73 offen lds
  s_add_u32 m0, s3, 1024
  s_nop 0
  buffer_load_dwordx4 v5, s[36:39], s73 offen lds
  s_add_u32 m0, s3, 2048
  s_nop 0
  buffer_load_dwordx4 v6, s[36:39], s73 offen lds
  s_add_u32 m0, s3, 3072
  s_nop 0
  buffer_load_dwordx4 v7, s[36:39], s73 offen lds
  s_add_u32 m0, s78, s75
  s_mov_b64 exec, s[14:15]
  buffer_load_dwordx4 v28, s[36:39], s73 offen lds
  s_mov_b64 exec, -1
  s_add_u32 s3, s75, s77
  s_add_u32 m0, s3, 0
  s_add_u32 s4, s74, 0
  buffer_load_dwordx4 v8, s[40:43], s4 offen lds
  s_add_u32 m0, s3, 1024
  s_nop 0
  buffer_load_dwordx4 v9, s[40:43], s4 offen lds
  s_add_u32 m0, s3, 8192
  s_add_u32 s4, s74, 2048
  buffer_load_dwordx4 v8, s[40:43], s4 offen lds
  s_add_u32 m0, s3, 9216
  s_nop 0
  buffer_load_dwordx4 v9, s[40:43], s4 offen lds
  s_add_u32 m0, s3, 16384
  s_add_u32 s4, s74, 4096
  buffer_load_dwordx4 v8, s[40:43], s4 offen lds
  s_add_u32 m0, s3, 17408
  s_nop 0
  buffer_load_dwordx4 v9, s[40:43], s4 offen lds
  s_add_u32 s101, s101, 1
  s_sub_u32 s73, s101, s100
  s_lshl_b32 s73, s73, 3
  s_lshr_b32 s73, 0xf0f02, s73
  s_and_b32 s73, s73, 255
  s_add_u32 s73, s73, s101
  s_and_b32 s73, s73, 15
  s_mul_i32 s74, s73, 393216
  s_lshl_b32 s73, s73, 7
  s_add_u32 s75, s75, 43008
  s_cmp_eq_u32 s75, 129024
  s_cselect_b32 s75, 0, s75
  s_and_b32 s3, s70, 3
  s_lshl_b32 s4, s68, 7
  s_lshl_b32 s5, s3, 6
  s_add_u32 s5, s5, s4
  v_add_u32 v2, s5, v1
  s_sub_u32 s4, s4, 16
  v_and_b32 v3, 15, v1
  v_add_u32 v3, s4, v3
  v_max_i32 v3, 0, v3
  s_cmp_ge_u32 s3, 2
  s_cselect_b64 vcc, -1, 0
  v_cndmask_b32 v2, v2, v3, vcc
  v_lshlrev_b32 v2, 3, v2
  s_mov_b32 s3, 0
  buffer_load_dwordx2 v[32:33], v2, s[56:59], s3 offen
  s_add_u32 s3, s3, 16384
  buffer_load_dwordx2 v[34:35], v2, s[56:59], s3 offen
  s_add_u32 s3, s3, 16384
  buffer_load_dwordx2 v[36:37], v2, s[56:59], s3 offen
  s_add_u32 s3, s3, 16384
  buffer_load_dwordx2 v[38:39], v2, s[56:59], s3 offen
  s_add_u32 s3, s3, 16384
  buffer_load_dwordx2 v[40:41], v2, s[56:59], s3 offen
  s_add_u32 s3, s3, 16384
  buffer_load_dwordx2 v[42:43], v2, s[56:59], s3 offen
  s_add_u32 s3, s3, 16384
  buffer_load_dwordx2 v[44:45], v2, s[56:59], s3 offen
  s_add_u32 s3, s3, 16384
  buffer_load_dwordx2 v[46:47], v2, s[56:59], s3 offen
  s_add_u32 s3, s3, 16384
  buffer_load_dwordx2 v[48:49], v2, s[56:59], s3 offen
  s_add_u32 s3, s3, 16384
  buffer_load_dwordx2 v[50:51], v2, s[56:59], s3 offen
  s_add_u32 s3, s3, 16384
  buffer_load_dwordx2 v[52:53], v2, s[56:59], s3 offen
  s_add_u32 s3, s3, 16384
  buffer_load_dwordx2 v[54:55], v2, s[56:59], s3 offen
  s_add_u32 s3, s3, 16384
  buffer_load_dwordx2 v[56:57], v2, s[56:59], s3 offen
  s_add_u32 s3, s3, 16384
  buffer_load_dwordx2 v[58:59], v2, s[56:59], s3 offen
  s_add_u32 s3, s3, 16384
  buffer_load_dwordx2 v[60:61], v2, s[56:59], s3 offen
  s_add_u32 s3, s3, 16384
  buffer_load_dwordx2 v[62:63], v2, s[56:59], s3 offen
  s_mov_b32 s60, s20
  s_and_b32 s61, s21, 0xffff
  s_mov_b32 s62, 2097152
  s_mov_b32 s63, 0x00020000
  s_and_b32 s3, s70, 3
  s_mul_i32 s3, s3, 8
  s_mul_i32 s4, s99, 32
  s_add_u32 s3, s3, s4
  v_lshrrev_b32 v2, 3, v1
  v_add_u32 v2, s3, v2
  v_mul_u32_u24 v2, 2048, v2
  v_and_b32 v3, 7, v1
  v_lshl_add_u32 v2, v3, 8, v2
  s_and_b32 s3, s2, 7
  s_lshr_b32 s3, s3, 2
  s_mul_i32 s3, s3, 128
  buffer_load_dword v96, v2, s[60:63], s3 offen
  s_waitcnt vmcnt(28)
  s_barrier
  s_waitcnt vmcnt(17)
  s_barrier
  s_waitcnt vmcnt(1)
  v_add_f32 v32, v32, v34
  v_add_f32 v33, v33, v35
  v_add_f32 v48, v48, v50
  v_add_f32 v49, v49, v51
  v_add_f32 v32, v32, v36
  v_add_f32 v33, v33, v37
  v_add_f32 v48, v48, v52
  v_add_f32 v49, v49, v53
  v_add_f32 v32, v32, v38
  v_add_f32 v33, v33, v39
  v_add_f32 v48, v48, v54
  v_add_f32 v49, v49, v55
  v_add_f32 v32, v32, v40
  v_add_f32 v33, v33, v41
  v_add_f32 v48, v48, v56
  v_add_f32 v49, v49, v57
  v_add_f32 v32, v32, v42
  v_add_f32 v33, v33, v43
  v_add_f32 v48, v48, v58
  v_add_f32 v49, v49, v59
  v_add_f32 v32, v32, v44
  v_add_f32 v33, v33, v45
  v_add_f32 v48, v48, v60
  v_add_f32 v49, v49, v61
  v_add_f32 v32, v32, v46
  v_add_f32 v33, v33, v47
  v_add_f32 v48, v48, v62
  v_add_f32 v49, v49, v63
  v_add_f32 v32, v32, v48
  v_add_f32 v33, v33, v49
  v_mul_f32 v32, 0x3a800000, v32
  v_mul_f32 v33, 0x3a800000, v33
  v_fma_f32 v33, -v32, v32, v33
  v_max_f32 v33, 0, v33
  v_add_f32 v33, 0x3727c5ac, v33
  v_rsq_f32 v33, v33
  s_nop 0
  s_and_b32 s3, s70, 3
  s_lshl_b32 s5, s3, 6
  s_add_u32 s5, s5, 16
  v_add_u32 v2, s5, v1
  v_and_b32 v3, 15, v1
  s_cmp_ge_u32 s3, 2
  s_cselect_b64 vcc, -1, 0
  v_cndmask_b32 v2, v2, v3, vcc
  v_lshlrev_b32 v2, 2, v2
  v_add_u32 v2, 129024, v2
  ds_write2_b32 v2, v32, v33 offset0:0 offset1:160
  s_waitcnt lgkmcnt(0)
  s_barrier
  s_barrier
L_attn_ldend:
  s_lshl_b32 s87, s97, 15
  s_lshl_b32 s4, s68, 11
  s_add_u32 s87, s87, s4
  s_lshl_b32 s4, s69, 2
  s_add_u32 s87, s87, s4
  s_add_u32 s97, s97, 1
  s_branch L_wo_body
L_attn_end:
  s_endpgm
L_attn_compute:
  s_and_b32 s71, s70, 1
  s_lshr_b32 s72, s70, 1
  v_and_b32 v3, 31, v1
  v_lshlrev_b32 v3, 2, v3
  v_add_u32 v3, 40960, v3
  v_mov_b32 v236, 0x3f803f80
  v_mov_b32 v237, 0x3f803f80
  v_mov_b32 v238, 0x3f803f80
  v_mov_b32 v239, 0x3f803f80
  ds_write_b32 v3, v236
  ds_write_b32 v3, v236 offset:43008
  v_add_u32 v3, 86016, v3
  ds_write_b32 v3, v236
  v_and_b32 v3, 15, v1
  v_lshrrev_b32 v2, 4, v1
  v_lshrrev_b32 v33, 1, v3
  s_lshl_b32 s8, s71, 13
  v_xor_b32 v4, v2, v33
  v_lshlrev_b32 v4, 4, v4
  v_lshl_add_u32 v4, v3, 7, v4
  v_add_u32 v8, 40960, v4
  v_add_u32 v4, s8, v4
  v_add_u32 v5, 4, v2
  v_xor_b32 v5, v5, v33
  v_lshlrev_b32 v5, 4, v5
  v_lshl_add_u32 v5, v3, 7, v5
  v_add_u32 v9, 40960, v5
  v_add_u32 v5, s8, v5
  v_bfe_u32 v34, v1, 2, 2
  v_lshl_add_u32 v34, v2, 3, v34
  v_lshlrev_b32 v34, 7, v34
  v_and_b32 v33, 3, v1
  v_lshl_add_u32 v34, v33, 3, v34
  v_bfe_u32 v33, v1, 3, 2
  v_lshl_add_u32 v34, v33, 5, v34
  v_and_b32 v35, 1, v2
  v_xor_b32 v35, s71, v35
  s_lshl_b32 s8, s70, 5
  v_xor_b32 v34, s8, v34
  v_add_u32 v6, 16384, v34
  v_xor_b32 v7, 32, v6
  s_lshl_b32 s8, s68, 7
  s_lshl_b32 s9, s71, 6
  s_add_u32 s8, s8, s9
  s_add_u32 s10, s8, s69
  s_lshl_b32 s10, s10, 11
  s_lshl_b32 s11, s72, 10
  s_add_u32 s10, s10, s11
  v_lshl_add_u32 v33, v3, 4, s10
  v_lshl_add_u32 v33, v35, 9, v33
  v_lshrrev_b32 v34, 1, v2
  v_lshl_add_u32 v31, v34, 8, v33
  s_mul_i32 s10, s72, 14336
  s_add_u32 s10, s10, 1024
  s_lshl_b32 s11, s71, 10
  s_add_u32 s4, s10, s11
  s_sub_u32 s5, s10, s11
  s_mul_i32 s6, s71, 6144
  v_lshl_add_u32 v16, v1, 4, s4
  v_add_u32 v17, s6, v16
  v_lshl_add_u32 v18, v1, 4, s5
  v_add_u32 v18, s6, v18
  v_lshl_add_u32 v19, v2, 8, s4
  v_lshl_add_u32 v20, v2, 8, s5
  v_lshl_add_u32 v21, v3, 4, s4
  v_lshl_add_u32 v22, v3, 4, s5
  s_lshl_b32 s10, s71, 8
  s_add_u32 s10, s10, 129024
  v_lshl_add_u32 v23, v3, 2, s10
  v_lshl_add_u32 v24, v2, 4, s10
  v_and_b32 v33, 1, v3
  v_cmp_eq_u32 s[48:49], 1, v33
  v_lshl_add_u32 v34, v2, 2, v33
  v_add_u32 v35, 2, v34
  v_cmp_gt_u32 s[50:51], v34, v3
  v_cmp_gt_u32 s[52:53], v35, v3
  v_mov_b32 v36, 0xffff
  v_mov_b32 v37, 0xffff0000
  v_cndmask_b32 v36, v36, v37, s[48:49]
  s_add_u32 s10, s10, 704
  v_lshl_add_u32 v34, v34, 2, s10
  v_lshl_add_u32 v35, v35, 2, s10
  v_subrev_u32 v38, 64, v34
  v_subrev_u32 v39, 64, v35
  v_cndmask_b32 v25, v34, v38, s[50:51]
  v_cndmask_b32 v26, v35, v39, s[52:53]
  v_cndmask_b32 v27, 0, v36, s[50:51]
  v_cndmask_b32 v29, 0, v36, s[52:53]
  v_xor_b32 v28, v27, v36
  v_xor_b32 v30, v29, v36
  s_cmp_eq_u32 s8, 0
  s_cselect_b64 s[54:55], s[50:51], 0
  s_cselect_b64 s[14:15], s[52:53], 0
  v_mov_b32 v120, 0
  v_mov_b32 v121, 0
  v_mov_b32 v122, 0
  v_mov_b32 v123, 0
  v_mov_b32 v124, 0
  v_mov_b32 v125, 0
  v_mov_b32 v126, 0
  v_mov_b32 v127, 0
  v_mov_b32 v128, 0
  v_mov_b32 v129, 0
  v_mov_b32 v130, 0
  v_mov_b32 v131, 0
  v_mov_b32 v132, 0
  v_mov_b32 v133, 0
  v_mov_b32 v134, 0
  v_mov_b32 v135, 0
  v_mov_b32 v136, 0
  v_mov_b32 v137, 0
  v_mov_b32 v138, 0
  v_mov_b32 v139, 0
  v_mov_b32 v140, 0
  v_mov_b32 v141, 0
  v_mov_b32 v142, 0
  v_mov_b32 v143, 0
  v_mov_b32 v144, 0
  v_mov_b32 v145, 0
  v_mov_b32 v146, 0
  v_mov_b32 v147, 0
  v_mov_b32 v148, 0
  v_mov_b32 v149, 0
  v_mov_b32 v150, 0
  v_mov_b32 v151, 0
  v_mov_b32 v152, 0
  v_mov_b32 v153, 0
  v_mov_b32 v154, 0
  v_mov_b32 v155, 0
  v_mov_b32 v156, 0
  v_mov_b32 v157, 0
  v_mov_b32 v158, 0
  v_mov_b32 v159, 0
  v_mov_b32 v160, 0
  v_mov_b32 v161, 0
  v_mov_b32 v162, 0
  v_mov_b32 v163, 0
  v_mov_b32 v164, 0
  v_mov_b32 v165, 0
  v_mov_b32 v166, 0
  v_mov_b32 v167, 0
  v_mov_b32 v168, 0
  v_mov_b32 v169, 0
  v_mov_b32 v170, 0
  v_mov_b32 v171, 0
  v_mov_b32 v172, 0
  v_mov_b32 v173, 0
  v_mov_b32 v174, 0
  v_mov_b32 v175, 0
  v_mov_b32 v176, 0
  v_mov_b32 v177, 0
  v_mov_b32 v178, 0
  v_mov_b32 v179, 0
  v_mov_b32 v180, 0
  v_mov_b32 v181, 0
  v_mov_b32 v182, 0
  v_mov_b32 v183, 0
  v_mov_b32 v184, 0
  v_mov_b32 v185, 0
  v_mov_b32 v186, 0
  v_mov_b32 v187, 0
  v_mov_b32 v188, 0
  v_mov_b32 v189, 0
  v_mov_b32 v190, 0
  v_mov_b32 v191, 0
  v_mov_b32 v192, 0
  v_mov_b32 v193, 0
  v_mov_b32 v194, 0
  v_mov_b32 v195, 0
  v_mov_b32 v196, 0
  v_mov_b32 v197, 0
  v_mov_b32 v198, 0
  v_mov_b32 v199, 0
  v_mov_b32 v200, 0
  v_mov_b32 v201, 0
  v_mov_b32 v202, 0
  v_mov_b32 v203, 0
  v_mov_b32 v204, 0
  v_mov_b32 v205, 0
  v_mov_b32 v206, 0
  v_mov_b32 v207, 0
  v_mov_b32 v208, 0
  v_mov_b32 v209, 0
  v_mov_b32 v210, 0
  v_mov_b32 v211, 0
  v_mov_b32 v212, 0
  v_mov_b32 v213, 0
  v_mov_b32 v214, 0
  v_mov_b32 v215, 0
  v_mov_b32 v216, 0
  v_mov_b32 v217, 0
  v_mov_b32 v218, 0
  v_mov_b32 v219, 0
  v_mov_b32 v220, 0
  v_mov_b32 v221, 0
  v_mov_b32 v222, 0
  v_mov_b32 v223, 0
  v_mov_b32 v224, 0
  v_mov_b32 v225, 0
  v_mov_b32 v226, 0
  v_mov_b32 v227, 0
  v_mov_b32 v228, 0
  v_mov_b32 v229, 0
  v_mov_b32 v230, 0
  v_mov_b32 v231, 0
  v_mov_b32 v232, 0
  v_mov_b32 v233, 0
  v_mov_b32 v234, 0
  v_mov_b32 v235, 0
  s_waitcnt lgkmcnt(0)
  s_mov_b32 s44, s34
  s_and_b32 s45, s35, 0xffff
  s_mov_b32 s46, 4194304
  s_mov_b32 s47, 0x00020000
  s_load_dwordx2 s[64:65], s[0:1], 72
  s_or_b32 s3, s96, s70
  s_cbranch_scc1 L_clr_skip0
  s_add_u32 s60, s22, 41943040
  s_addc_u32 s61, s23, 0
  s_and_b32 s61, s61, 0xffff
  s_mov_b32 s62, 524288
  s_mov_b32 s63, 0x00020000
  s_lshl_b32 s3, s2, 11
  v_lshlrev_b32 v2, 4, v1
  buffer_store_dwordx4 v[128:131], v2, s[60:63], s3 offen sc1
  buffer_store_dwordx4 v[128:131], v2, s[60:63], s3 offen offset:1024 sc1
L_clr_skip0:
  s_cmp_lg_u32 s96, 0
  s_cbranch_scc1 L_pfc1_skip
  s_getpc_b64 s[4:5]
L_pfc1:
  s_lshl_b32 s3, s99, 2
  s_add_u32 s3, s3, s70
  s_mul_i32 s3, s3, 256
  s_min_u32 s3, s3, L_w2_c1-L_attn_c0-256
  s_add_i32 s3, s3, L_attn_c0-L_pfc1
  s_ashr_i32 s6, s3, 31
  s_add_u32 s4, s4, s3
  s_addc_u32 s5, s5, s6
  s_load_dword s36, s[4:5], 0
  s_load_dword s37, s[4:5], 64
  s_load_dword s38, s[4:5], 128
  s_load_dword s39, s[4:5], 192
L_pfc1_skip:
  s_mov_b32 s75, 0
  v_add_u32_e64 v10, s75, v4
  v_add_u32_e64 v11, s75, v5
  v_add_u32_e64 v12, s75, v6
  v_add_u32_e64 v13, s75, v7
  v_add_u32_e64 v14, s75, v8
  v_add_u32_e64 v15, s75, v9
  s_add_u32 s75, s75, 43008
  s_cmp_eq_u32 s75, 129024
  s_cselect_b32 s75, 0, s75
  s_mov_b32 s79, 16
  s_cmp_eq_u32 s96, 0
  s_cbranch_scc1 L_attn_nog
  s_barrier
L_attn_nog:
  s_barrier
  ds_read_b128 v[32:35], v10 offset:0
  ds_read_b128 v[36:39], v10 offset:2048
  ds_read_b128 v[40:43], v10 offset:4096
  ds_read_b128 v[44:47], v10 offset:6144
  ds_read_b128 v[48:51], v14
  ds_read_b64_tr_b16 v[52:53], v12 offset:0
  ds_read_b64_tr_b16 v[54:55], v12 offset:512
  ds_read_b64_tr_b16 v[56:57], v13 offset:0
  ds_read_b64_tr_b16 v[58:59], v13 offset:512
  ds_read_b64_tr_b16 v[60:61], v12 offset:8192
  ds_read_b64_tr_b16 v[62:63], v12 offset:8704
  ds_read_b64_tr_b16 v[64:65], v13 offset:8192
  ds_read_b64_tr_b16 v[66:67], v13 offset:8704
  ds_read_b64_tr_b16 v[68:69], v12 offset:16384
  ds_read_b64_tr_b16 v[70:71], v12 offset:16896
  ds_read_b64_tr_b16 v[72:73], v13 offset:16384
  ds_read_b64_tr_b16 v[74:75], v13 offset:16896
  s_waitcnt lgkmcnt(0)
  s_cmp_lg_u32 s96, 0
  s_cbranch_scc1 L_attn_loop
  v_mov_b32 v240, 0
  v_mov_b32 v241, 0
  v_mov_b32 v242, 0
  v_mov_b32 v243, 0
  v_mov_b32 v244, 0
  v_mov_b32 v245, 0
  v_mov_b32 v246, 0
  v_mov_b32 v247, 0
  v_mov_b32 v248, 0
  v_mov_b32 v249, 0
  v_mov_b32 v250, 0
  v_mov_b32 v251, 0
  v_mov_b32 v252, 0
  v_mov_b32 v253, 0
  v_mov_b32 v254, 0
  v_mov_b32 v255, 0
  s_cmp_lg_u32 s72, 0
  s_cbranch_scc1 L_attn_loopb
  s_or_b32 s3, s96, s70
  s_cbranch_scc1 L_clr_skip1
  v_mov_b32 v3, 1
  s_and_b32 s65, s65, 0xffff
  s_mov_b32 s66, 256
  s_mov_b32 s67, 0x00020000
  s_mov_b64 exec, 1
  s_waitcnt vmcnt(0)
  buffer_store_byte v3, off, s[64:67], s2 sc1
  s_mov_b64 exec, -1
L_clr_skip1:
.p2align 3
L_attn_loopa:
  v_mfma_f32_16x16x32_bf16 v[240:243], v[236:239], v[32:35], v[240:243]
  ds_read_b128 v[76:79], v11 offset:0
  v_mfma_f32_16x16x32_bf16 v[244:247], v[32:35], v[32:35], v[244:247]
  ds_read_b128 v[80:83], v11 offset:2048
  v_mfma_f32_16x16x32_bf16 v[248:251], v[236:239], v[36:39], v[248:251]
  ds_read_b128 v[84:87], v11 offset:4096
  v_mfma_f32_16x16x32_bf16 v[252:255], v[36:39], v[36:39], v[252:255]
  ds_read_b128 v[88:91], v11 offset:6144
  v_mfma_f32_16x16x32_bf16 v[120:123], v[236:239], v[48:51], v[120:123]
  ds_read_b128 v[92:95], v15
  v_mfma_f32_16x16x32_bf16 v[124:127], v[48:51], v[48:51], v[124:127]
  ds_read_b64_tr_b16 v[96:97], v12 offset:4096
  v_mfma_f32_16x16x32_bf16 v[128:131], v[52:55], v[32:35], v[128:131]
  ds_read_b64_tr_b16 v[98:99], v12 offset:4608
  v_mfma_f32_16x16x32_bf16 v[132:135], v[52:55], v[36:39], v[132:135]
  ds_read_b64_tr_b16 v[100:101], v13 offset:4096
  v_mfma_f32_16x16x32_bf16 v[136:139], v[52:55], v[40:43], v[136:139]
  ds_read_b64_tr_b16 v[102:103], v13 offset:4608
  v_mfma_f32_16x16x32_bf16 v[140:143], v[52:55], v[44:47], v[140:143]
  ds_read_b64_tr_b16 v[104:105], v12 offset:12288
  v_mfma_f32_16x16x32_bf16 v[224:227], v[52:55], v[48:51], v[224:227]
  ds_read_b64_tr_b16 v[106:107], v12 offset:12800
  v_mfma_f32_16x16x32_bf16 v[156:159], v[56:59], v[44:47], v[156:159]
  ds_read_b64_tr_b16 v[108:109], v13 offset:12288
  v_mfma_f32_16x16x32_bf16 v[152:155], v[56:59], v[40:43], v[152:155]
  ds_read_b64_tr_b16 v[110:111], v13 offset:12800
  v_mfma_f32_16x16x32_bf16 v[148:151], v[56:59], v[36:39], v[148:151]
  ds_read_b64_tr_b16 v[112:113], v12 offset:20480
  v_mfma_f32_16x16x32_bf16 v[144:147], v[56:59], v[32:35], v[144:147]
  ds_read_b64_tr_b16 v[114:115], v12 offset:20992
  v_mfma_f32_16x16x32_bf16 v[160:163], v[60:63], v[32:35], v[160:163]
  ds_read_b64_tr_b16 v[116:117], v13 offset:20480
  v_mfma_f32_16x16x32_bf16 v[164:167], v[60:63], v[36:39], v[164:167]
  ds_read_b64_tr_b16 v[118:119], v13 offset:20992
  v_mfma_f32_16x16x32_bf16 v[168:171], v[60:63], v[40:43], v[168:171]
  v_add_u32_e64 v10, s75, v4
  v_mfma_f32_16x16x32_bf16 v[172:175], v[60:63], v[44:47], v[172:175]
  v_add_u32_e64 v11, s75, v5
  v_mfma_f32_16x16x32_bf16 v[228:231], v[60:63], v[48:51], v[228:231]
  v_add_u32_e64 v12, s75, v6
  v_mfma_f32_16x16x32_bf16 v[188:191], v[64:67], v[44:47], v[188:191]
  v_add_u32_e64 v13, s75, v7
  v_mfma_f32_16x16x32_bf16 v[184:187], v[64:67], v[40:43], v[184:187]
  v_add_u32_e64 v14, s75, v8
  v_mfma_f32_16x16x32_bf16 v[180:183], v[64:67], v[36:39], v[180:183]
  v_add_u32_e64 v15, s75, v9
  v_mfma_f32_16x16x32_bf16 v[176:179], v[64:67], v[32:35], v[176:179]
  s_add_u32 s75, s75, 43008
  v_mfma_f32_16x16x32_bf16 v[192:195], v[32:35], v[68:71], v[192:195]
  s_cmp_eq_u32 s75, 129024
  v_mfma_f32_16x16x32_bf16 v[196:199], v[36:39], v[68:71], v[196:199]
  s_cselect_b32 s75, 0, s75
  s_sub_u32 s79, s79, 1
  v_mfma_f32_16x16x32_bf16 v[200:203], v[40:43], v[68:71], v[200:203]
  v_mfma_f32_16x16x32_bf16 v[204:207], v[44:47], v[68:71], v[204:207]
  v_mfma_f32_16x16x32_bf16 v[232:235], v[48:51], v[68:71], v[232:235]
  v_mfma_f32_16x16x32_bf16 v[220:223], v[44:47], v[72:75], v[220:223]
  v_mfma_f32_16x16x32_bf16 v[216:219], v[40:43], v[72:75], v[216:219]
  v_mfma_f32_16x16x32_bf16 v[212:215], v[36:39], v[72:75], v[212:215]
  v_mfma_f32_16x16x32_bf16 v[208:211], v[32:35], v[72:75], v[208:211]
  s_waitcnt lgkmcnt(0)
  s_barrier
  v_mfma_f32_16x16x32_bf16 v[240:243], v[236:239], v[76:79], v[240:243]
  ds_read_b128 v[32:35], v10 offset:0
  v_mfma_f32_16x16x32_bf16 v[244:247], v[76:79], v[76:79], v[244:247]
  ds_read_b128 v[36:39], v10 offset:2048
  v_mfma_f32_16x16x32_bf16 v[248:251], v[236:239], v[80:83], v[248:251]
  ds_read_b128 v[40:43], v10 offset:4096
  v_mfma_f32_16x16x32_bf16 v[252:255], v[80:83], v[80:83], v[252:255]
  ds_read_b128 v[44:47], v10 offset:6144
  v_mfma_f32_16x16x32_bf16 v[120:123], v[236:239], v[92:95], v[120:123]
  ds_read_b128 v[48:51], v14
  v_mfma_f32_16x16x32_bf16 v[124:127], v[92:95], v[92:95], v[124:127]
  ds_read_b64_tr_b16 v[52:53], v12 offset:0
  v_mfma_f32_16x16x32_bf16 v[128:131], v[96:99], v[76:79], v[128:131]
  ds_read_b64_tr_b16 v[54:55], v12 offset:512
  v_mfma_f32_16x16x32_bf16 v[132:135], v[96:99], v[80:83], v[132:135]
  ds_read_b64_tr_b16 v[56:57], v13 offset:0
  v_mfma_f32_16x16x32_bf16 v[136:139], v[96:99], v[84:87], v[136:139]
  ds_read_b64_tr_b16 v[58:59], v13 offset:512
  v_mfma_f32_16x16x32_bf16 v[140:143], v[96:99], v[88:91], v[140:143]
  ds_read_b64_tr_b16 v[60:61], v12 offset:8192
  v_mfma_f32_16x16x32_bf16 v[224:227], v[96:99], v[92:95], v[224:227]
  ds_read_b64_tr_b16 v[62:63], v12 offset:8704
  v_mfma_f32_16x16x32_bf16 v[156:159], v[100:103], v[88:91], v[156:159]
  ds_read_b64_tr_b16 v[64:65], v13 offset:8192
  v_mfma_f32_16x16x32_bf16 v[152:155], v[100:103], v[84:87], v[152:155]
  ds_read_b64_tr_b16 v[66:67], v13 offset:8704
  v_mfma_f32_16x16x32_bf16 v[148:151], v[100:103], v[80:83], v[148:151]
  ds_read_b64_tr_b16 v[68:69], v12 offset:16384
  v_mfma_f32_16x16x32_bf16 v[144:147], v[100:103], v[76:79], v[144:147]
  ds_read_b64_tr_b16 v[70:71], v12 offset:16896
  v_mfma_f32_16x16x32_bf16 v[160:163], v[104:107], v[76:79], v[160:163]
  ds_read_b64_tr_b16 v[72:73], v13 offset:16384
  v_mfma_f32_16x16x32_bf16 v[164:167], v[104:107], v[80:83], v[164:167]
  ds_read_b64_tr_b16 v[74:75], v13 offset:16896
  v_mfma_f32_16x16x32_bf16 v[168:171], v[104:107], v[84:87], v[168:171]
  s_cmp_lg_u32 s79, 0
  s_nop 0
  v_mfma_f32_16x16x32_bf16 v[172:175], v[104:107], v[88:91], v[172:175]
  v_mfma_f32_16x16x32_bf16 v[228:231], v[104:107], v[92:95], v[228:231]
  v_mfma_f32_16x16x32_bf16 v[188:191], v[108:111], v[88:91], v[188:191]
  v_mfma_f32_16x16x32_bf16 v[184:187], v[108:111], v[84:87], v[184:187]
  v_mfma_f32_16x16x32_bf16 v[180:183], v[108:111], v[80:83], v[180:183]
  v_mfma_f32_16x16x32_bf16 v[176:179], v[108:111], v[76:79], v[176:179]
  v_mfma_f32_16x16x32_bf16 v[192:195], v[76:79], v[112:115], v[192:195]
  v_mfma_f32_16x16x32_bf16 v[196:199], v[80:83], v[112:115], v[196:199]
  v_mfma_f32_16x16x32_bf16 v[200:203], v[84:87], v[112:115], v[200:203]
  v_mfma_f32_16x16x32_bf16 v[204:207], v[88:91], v[112:115], v[204:207]
  v_mfma_f32_16x16x32_bf16 v[232:235], v[92:95], v[112:115], v[232:235]
  v_mfma_f32_16x16x32_bf16 v[220:223], v[88:91], v[116:119], v[220:223]
  v_mfma_f32_16x16x32_bf16 v[216:219], v[84:87], v[116:119], v[216:219]
  v_mfma_f32_16x16x32_bf16 v[212:215], v[80:83], v[116:119], v[212:215]
  v_mfma_f32_16x16x32_bf16 v[208:211], v[76:79], v[116:119], v[208:211]
  s_waitcnt lgkmcnt(0)
  s_cbranch_scc1 L_attn_loopa
  s_branch L_attn_post
.p2align 3
L_attn_loopb:
  v_mfma_f32_16x16x32_bf16 v[240:243], v[236:239], v[40:43], v[240:243]
  ds_read_b128 v[76:79], v11 offset:0
  v_mfma_f32_16x16x32_bf16 v[244:247], v[40:43], v[40:43], v[244:247]
  ds_read_b128 v[80:83], v11 offset:2048
  v_mfma_f32_16x16x32_bf16 v[248:251], v[236:239], v[44:47], v[248:251]
  ds_read_b128 v[84:87], v11 offset:4096
  v_mfma_f32_16x16x32_bf16 v[252:255], v[44:47], v[44:47], v[252:255]
  ds_read_b128 v[88:91], v11 offset:6144
  v_mfma_f32_16x16x32_bf16 v[128:131], v[52:55], v[32:35], v[128:131]
  ds_read_b128 v[92:95], v15
  v_mfma_f32_16x16x32_bf16 v[132:135], v[52:55], v[36:39], v[132:135]
  ds_read_b64_tr_b16 v[96:97], v12 offset:4096
  v_mfma_f32_16x16x32_bf16 v[136:139], v[52:55], v[40:43], v[136:139]
  ds_read_b64_tr_b16 v[98:99], v12 offset:4608
  v_mfma_f32_16x16x32_bf16 v[140:143], v[52:55], v[44:47], v[140:143]
  ds_read_b64_tr_b16 v[100:101], v13 offset:4096
  v_mfma_f32_16x16x32_bf16 v[224:227], v[52:55], v[48:51], v[224:227]
  ds_read_b64_tr_b16 v[102:103], v13 offset:4608
  v_mfma_f32_16x16x32_bf16 v[156:159], v[56:59], v[44:47], v[156:159]
  ds_read_b64_tr_b16 v[104:105], v12 offset:12288
  v_mfma_f32_16x16x32_bf16 v[152:155], v[56:59], v[40:43], v[152:155]
  ds_read_b64_tr_b16 v[106:107], v12 offset:12800
  v_mfma_f32_16x16x32_bf16 v[148:151], v[56:59], v[36:39], v[148:151]
  ds_read_b64_tr_b16 v[108:109], v13 offset:12288
  v_mfma_f32_16x16x32_bf16 v[144:147], v[56:59], v[32:35], v[144:147]
  ds_read_b64_tr_b16 v[110:111], v13 offset:12800
  v_mfma_f32_16x16x32_bf16 v[160:163], v[60:63], v[32:35], v[160:163]
  ds_read_b64_tr_b16 v[112:113], v12 offset:20480
  v_mfma_f32_16x16x32_bf16 v[164:167], v[60:63], v[36:39], v[164:167]
  ds_read_b64_tr_b16 v[114:115], v12 offset:20992
  v_mfma_f32_16x16x32_bf16 v[168:171], v[60:63], v[40:43], v[168:171]
  ds_read_b64_tr_b16 v[116:117], v13 offset:20480
  v_mfma_f32_16x16x32_bf16 v[172:175], v[60:63], v[44:47], v[172:175]
  ds_read_b64_tr_b16 v[118:119], v13 offset:20992
  v_mfma_f32_16x16x32_bf16 v[228:231], v[60:63], v[48:51], v[228:231]
  v_add_u32_e64 v10, s75, v4
  v_mfma_f32_16x16x32_bf16 v[188:191], v[64:67], v[44:47], v[188:191]
  v_add_u32_e64 v11, s75, v5
  v_mfma_f32_16x16x32_bf16 v[184:187], v[64:67], v[40:43], v[184:187]
  v_add_u32_e64 v12, s75, v6
  v_mfma_f32_16x16x32_bf16 v[180:183], v[64:67], v[36:39], v[180:183]
  v_add_u32_e64 v13, s75, v7
  v_mfma_f32_16x16x32_bf16 v[176:179], v[64:67], v[32:35], v[176:179]
  v_add_u32_e64 v14, s75, v8
  v_mfma_f32_16x16x32_bf16 v[192:195], v[32:35], v[68:71], v[192:195]
  v_add_u32_e64 v15, s75, v9
  v_mfma_f32_16x16x32_bf16 v[196:199], v[36:39], v[68:71], v[196:199]
  s_add_u32 s75, s75, 43008
  v_mfma_f32_16x16x32_bf16 v[200:203], v[40:43], v[68:71], v[200:203]
  s_cmp_eq_u32 s75, 129024
  v_mfma_f32_16x16x32_bf16 v[204:207], v[44:47], v[68:71], v[204:207]
  s_cselect_b32 s75, 0, s75
  s_sub_u32 s79, s79, 1
  v_mfma_f32_16x16x32_bf16 v[232:235], v[48:51], v[68:71], v[232:235]
  v_mfma_f32_16x16x32_bf16 v[220:223], v[44:47], v[72:75], v[220:223]
  v_mfma_f32_16x16x32_bf16 v[216:219], v[40:43], v[72:75], v[216:219]
  v_mfma_f32_16x16x32_bf16 v[212:215], v[36:39], v[72:75], v[212:215]
  v_mfma_f32_16x16x32_bf16 v[208:211], v[32:35], v[72:75], v[208:211]
  s_waitcnt lgkmcnt(0)
  s_barrier
  v_mfma_f32_16x16x32_bf16 v[240:243], v[236:239], v[84:87], v[240:243]
  ds_read_b128 v[32:35], v10 offset:0
  v_mfma_f32_16x16x32_bf16 v[244:247], v[84:87], v[84:87], v[244:247]
  ds_read_b128 v[36:39], v10 offset:2048
  v_mfma_f32_16x16x32_bf16 v[248:251], v[236:239], v[88:91], v[248:251]
  ds_read_b128 v[40:43], v10 offset:4096
  v_mfma_f32_16x16x32_bf16 v[252:255], v[88:91], v[88:91], v[252:255]
  ds_read_b128 v[44:47], v10 offset:6144
  v_mfma_f32_16x16x32_bf16 v[128:131], v[96:99], v[76:79], v[128:131]
  ds_read_b128 v[48:51], v14
  v_mfma_f32_16x16x32_bf16 v[132:135], v[96:99], v[80:83], v[132:135]
  ds_read_b64_tr_b16 v[52:53], v12 offset:0
  v_mfma_f32_16x16x32_bf16 v[136:139], v[96:99], v[84:87], v[136:139]
  ds_read_b64_tr_b16 v[54:55], v12 offset:512
  v_mfma_f32_16x16x32_bf16 v[140:143], v[96:99], v[88:91], v[140:143]
  ds_read_b64_tr_b16 v[56:57], v13 offset:0
  v_mfma_f32_16x16x32_bf16 v[224:227], v[96:99], v[92:95], v[224:227]
  ds_read_b64_tr_b16 v[58:59], v13 offset:512
  v_mfma_f32_16x16x32_bf16 v[156:159], v[100:103], v[88:91], v[156:159]
  ds_read_b64_tr_b16 v[60:61], v12 offset:8192
  v_mfma_f32_16x16x32_bf16 v[152:155], v[100:103], v[84:87], v[152:155]
  ds_read_b64_tr_b16 v[62:63], v12 offset:8704
  v_mfma_f32_16x16x32_bf16 v[148:151], v[100:103], v[80:83], v[148:151]
  ds_read_b64_tr_b16 v[64:65], v13 offset:8192
  v_mfma_f32_16x16x32_bf16 v[144:147], v[100:103], v[76:79], v[144:147]
  ds_read_b64_tr_b16 v[66:67], v13 offset:8704
  v_mfma_f32_16x16x32_bf16 v[160:163], v[104:107], v[76:79], v[160:163]
  ds_read_b64_tr_b16 v[68:69], v12 offset:16384
  v_mfma_f32_16x16x32_bf16 v[164:167], v[104:107], v[80:83], v[164:167]
  ds_read_b64_tr_b16 v[70:71], v12 offset:16896
  v_mfma_f32_16x16x32_bf16 v[168:171], v[104:107], v[84:87], v[168:171]
  ds_read_b64_tr_b16 v[72:73], v13 offset:16384
  v_mfma_f32_16x16x32_bf16 v[172:175], v[104:107], v[88:91], v[172:175]
  ds_read_b64_tr_b16 v[74:75], v13 offset:16896
  v_mfma_f32_16x16x32_bf16 v[228:231], v[104:107], v[92:95], v[228:231]
  s_cmp_lg_u32 s79, 0
  s_nop 0
  v_mfma_f32_16x16x32_bf16 v[188:191], v[108:111], v[88:91], v[188:191]
  v_mfma_f32_16x16x32_bf16 v[184:187], v[108:111], v[84:87], v[184:187]
  v_mfma_f32_16x16x32_bf16 v[180:183], v[108:111], v[80:83], v[180:183]
  v_mfma_f32_16x16x32_bf16 v[176:179], v[108:111], v[76:79], v[176:179]
  v_mfma_f32_16x16x32_bf16 v[192:195], v[76:79], v[112:115], v[192:195]
  v_mfma_f32_16x16x32_bf16 v[196:199], v[80:83], v[112:115], v[196:199]
  v_mfma_f32_16x16x32_bf16 v[200:203], v[84:87], v[112:115], v[200:203]
  v_mfma_f32_16x16x32_bf16 v[204:207], v[88:91], v[112:115], v[204:207]
  v_mfma_f32_16x16x32_bf16 v[232:235], v[92:95], v[112:115], v[232:235]
  v_mfma_f32_16x16x32_bf16 v[220:223], v[88:91], v[116:119], v[220:223]
  v_mfma_f32_16x16x32_bf16 v[216:219], v[84:87], v[116:119], v[216:219]
  v_mfma_f32_16x16x32_bf16 v[212:215], v[80:83], v[116:119], v[212:215]
  v_mfma_f32_16x16x32_bf16 v[208:211], v[76:79], v[116:119], v[208:211]
  s_waitcnt lgkmcnt(0)
  s_cbranch_scc1 L_attn_loopb
L_attn_post:
  v_and_b32 v32, 3, v1
  v_cmp_eq_u32 s[4:5], 1, v32
  v_cmp_eq_u32 s[6:7], 2, v32
  v_cmp_eq_u32 s[8:9], 3, v32
  v_bfe_u32 v33, v1, 2, 2
  v_lshrrev_b32 v34, 4, v1
  v_cmp_eq_u32 s[10:11], v33, v34
  s_lshl_b32 s3, s72, 7
  v_add_u32 v35, s3, v23
  v_and_b32 v36, 15, v1
  s_cmp_eq_u32 s70, 0
  s_cselect_b32 s3, 0, 576
  s_add_u32 s3, s3, 129024
  v_lshl_add_u32 v36, v36, 2, s3
  v_cndmask_b32 v241, v244, v245, s[4:5]
  v_cndmask_b32 v249, v252, v253, s[4:5]
  v_cndmask_b32 v121, v124, v125, s[4:5]
  v_cndmask_b32 v241, v241, v246, s[6:7]
  v_cndmask_b32 v249, v249, v254, s[6:7]
  v_cndmask_b32 v121, v121, v126, s[6:7]
  v_cndmask_b32 v241, v241, v247, s[8:9]
  v_cndmask_b32 v249, v249, v255, s[8:9]
  v_cndmask_b32 v121, v121, v127, s[8:9]
  v_mul_f32 v240, 0x3a800000, v240
  v_mul_f32 v241, 0x3a800000, v241
  v_fma_f32 v241, -v240, v240, v241
  v_max_f32 v241, 0, v241
  v_add_f32 v241, 0x3727c5ac, v241
  v_rsq_f32 v241, v241
  s_nop 0
  v_mul_f32 v248, 0x3a800000, v248
  v_mul_f32 v249, 0x3a800000, v249
  v_fma_f32 v249, -v248, v248, v249
  v_max_f32 v249, 0, v249
  v_add_f32 v249, 0x3727c5ac, v249
  v_rsq_f32 v249, v249
  s_nop 0
  v_mul_f32 v120, 0x3a800000, v120
  v_mul_f32 v121, 0x3a800000, v121
  v_fma_f32 v121, -v120, v120, v121
  v_max_f32 v121, 0, v121
  v_add_f32 v121, 0x3727c5ac, v121
  v_rsq_f32 v121, v121
  s_nop 0
  s_mov_b64 exec, s[10:11]
  ds_write2_b32 v35, v240, v241 offset0:16 offset1:176
  ds_write2_b32 v35, v248, v249 offset0:32 offset1:192
  ds_write2_b32 v36, v120, v121 offset0:0 offset1:160
  s_mov_b64 exec, -1
  s_mov_b32 s36, s16
  s_and_b32 s37, s17, 0xffff
  s_mov_b32 s38, 4194304
  s_mov_b32 s39, 0x00020000
  s_and_b32 s3, s2, 3
  s_and_b32 s4, s99, 3
  s_lshl2_add_u32 s3, s3, s4
  s_lshl2_add_u32 s3, s3, s70
  s_lshl_b32 s3, s3, 16
  s_bfe_u32 s4, s2, 0x10002
  s_lshr_b32 s5, s99, 2
  s_lshl1_add_u32 s4, s5, s4
  s_lshl_b32 s4, s4, 7
  s_add_u32 s3, s3, s4
  s_add_u32 s4, s3, 32768
  v_and_b32 v32, 15, v1
  v_lshlrev_b32 v33, 1, v1
  v_and_b32 v33, 32, v33
  v_lshl_add_u32 v32, v32, 11, v33
  v_lshrrev_b32 v33, 1, v1
  v_and_b32 v33, 16, v33
  v_add_u32 v32, v32, v33
  s_waitcnt lgkmcnt(0)
  buffer_load_dwordx4 v[240:243], v32, s[36:39], s3 offen offset:0
  buffer_load_dwordx4 v[244:247], v32, s[36:39], s3 offen offset:64
  buffer_load_dwordx4 v[248:251], v32, s[36:39], s4 offen offset:0
  buffer_load_dwordx4 v[252:255], v32, s[36:39], s4 offen offset:64
  s_barrier
  s_branch L_attn_exit
.p2align 3
L_attn_loop:
  v_mfma_f32_16x16x32_bf16 v[128:131], v[52:55], v[32:35], v[128:131]
  ds_read_b128 v[76:79], v11 offset:0
  v_mfma_f32_16x16x32_bf16 v[132:135], v[52:55], v[36:39], v[132:135]
  ds_read_b128 v[80:83], v11 offset:2048
  v_mfma_f32_16x16x32_bf16 v[136:139], v[52:55], v[40:43], v[136:139]
  ds_read_b128 v[84:87], v11 offset:4096
  v_mfma_f32_16x16x32_bf16 v[140:143], v[52:55], v[44:47], v[140:143]
  ds_read_b128 v[88:91], v11 offset:6144
  v_mfma_f32_16x16x32_bf16 v[224:227], v[52:55], v[48:51], v[224:227]
  ds_read_b128 v[92:95], v15
  v_mfma_f32_16x16x32_bf16 v[156:159], v[56:59], v[44:47], v[156:159]
  ds_read_b64_tr_b16 v[96:97], v12 offset:4096
  v_mfma_f32_16x16x32_bf16 v[152:155], v[56:59], v[40:43], v[152:155]
  ds_read_b64_tr_b16 v[98:99], v12 offset:4608
  v_mfma_f32_16x16x32_bf16 v[148:151], v[56:59], v[36:39], v[148:151]
  ds_read_b64_tr_b16 v[100:101], v13 offset:4096
  v_mfma_f32_16x16x32_bf16 v[144:147], v[56:59], v[32:35], v[144:147]
  ds_read_b64_tr_b16 v[102:103], v13 offset:4608
  v_mfma_f32_16x16x32_bf16 v[160:163], v[60:63], v[32:35], v[160:163]
  ds_read_b64_tr_b16 v[104:105], v12 offset:12288
  v_mfma_f32_16x16x32_bf16 v[164:167], v[60:63], v[36:39], v[164:167]
  ds_read_b64_tr_b16 v[106:107], v12 offset:12800
  v_mfma_f32_16x16x32_bf16 v[168:171], v[60:63], v[40:43], v[168:171]
  ds_read_b64_tr_b16 v[108:109], v13 offset:12288
  v_mfma_f32_16x16x32_bf16 v[172:175], v[60:63], v[44:47], v[172:175]
  ds_read_b64_tr_b16 v[110:111], v13 offset:12800
  v_mfma_f32_16x16x32_bf16 v[228:231], v[60:63], v[48:51], v[228:231]
  ds_read_b64_tr_b16 v[112:113], v12 offset:20480
  v_mfma_f32_16x16x32_bf16 v[188:191], v[64:67], v[44:47], v[188:191]
  ds_read_b64_tr_b16 v[114:115], v12 offset:20992
  v_mfma_f32_16x16x32_bf16 v[184:187], v[64:67], v[40:43], v[184:187]
  ds_read_b64_tr_b16 v[116:117], v13 offset:20480
  v_mfma_f32_16x16x32_bf16 v[180:183], v[64:67], v[36:39], v[180:183]
  ds_read_b64_tr_b16 v[118:119], v13 offset:20992
  v_mfma_f32_16x16x32_bf16 v[176:179], v[64:67], v[32:35], v[176:179]
  v_add_u32_e64 v10, s75, v4
  v_mfma_f32_16x16x32_bf16 v[192:195], v[32:35], v[68:71], v[192:195]
  v_add_u32_e64 v11, s75, v5
  v_mfma_f32_16x16x32_bf16 v[196:199], v[36:39], v[68:71], v[196:199]
  v_add_u32_e64 v12, s75, v6
  v_mfma_f32_16x16x32_bf16 v[200:203], v[40:43], v[68:71], v[200:203]
  v_add_u32_e64 v13, s75, v7
  v_mfma_f32_16x16x32_bf16 v[204:207], v[44:47], v[68:71], v[204:207]
  v_add_u32_e64 v14, s75, v8
  v_mfma_f32_16x16x32_bf16 v[232:235], v[48:51], v[68:71], v[232:235]
  v_add_u32_e64 v15, s75, v9
  v_mfma_f32_16x16x32_bf16 v[220:223], v[44:47], v[72:75], v[220:223]
  s_add_u32 s75, s75, 43008
  v_mfma_f32_16x16x32_bf16 v[216:219], v[40:43], v[72:75], v[216:219]
  s_cmp_eq_u32 s75, 129024
  v_mfma_f32_16x16x32_bf16 v[212:215], v[36:39], v[72:75], v[212:215]
  s_cselect_b32 s75, 0, s75
  s_sub_u32 s79, s79, 1
  v_mfma_f32_16x16x32_bf16 v[208:211], v[32:35], v[72:75], v[208:211]
  s_waitcnt lgkmcnt(0)
  s_barrier
  v_mfma_f32_16x16x32_bf16 v[128:131], v[96:99], v[76:79], v[128:131]
  ds_read_b128 v[32:35], v10 offset:0
  v_mfma_f32_16x16x32_bf16 v[132:135], v[96:99], v[80:83], v[132:135]
  ds_read_b128 v[36:39], v10 offset:2048
  v_mfma_f32_16x16x32_bf16 v[136:139], v[96:99], v[84:87], v[136:139]
  ds_read_b128 v[40:43], v10 offset:4096
  v_mfma_f32_16x16x32_bf16 v[140:143], v[96:99], v[88:91], v[140:143]
  ds_read_b128 v[44:47], v10 offset:6144
  v_mfma_f32_16x16x32_bf16 v[224:227], v[96:99], v[92:95], v[224:227]
  ds_read_b128 v[48:51], v14
  v_mfma_f32_16x16x32_bf16 v[156:159], v[100:103], v[88:91], v[156:159]
  ds_read_b64_tr_b16 v[52:53], v12 offset:0
  v_mfma_f32_16x16x32_bf16 v[152:155], v[100:103], v[84:87], v[152:155]
  ds_read_b64_tr_b16 v[54:55], v12 offset:512
  v_mfma_f32_16x16x32_bf16 v[148:151], v[100:103], v[80:83], v[148:151]
  ds_read_b64_tr_b16 v[56:57], v13 offset:0
  v_mfma_f32_16x16x32_bf16 v[144:147], v[100:103], v[76:79], v[144:147]
  ds_read_b64_tr_b16 v[58:59], v13 offset:512
  v_mfma_f32_16x16x32_bf16 v[160:163], v[104:107], v[76:79], v[160:163]
  ds_read_b64_tr_b16 v[60:61], v12 offset:8192
  v_mfma_f32_16x16x32_bf16 v[164:167], v[104:107], v[80:83], v[164:167]
  ds_read_b64_tr_b16 v[62:63], v12 offset:8704
  v_mfma_f32_16x16x32_bf16 v[168:171], v[104:107], v[84:87], v[168:171]
  ds_read_b64_tr_b16 v[64:65], v13 offset:8192
  v_mfma_f32_16x16x32_bf16 v[172:175], v[104:107], v[88:91], v[172:175]
  ds_read_b64_tr_b16 v[66:67], v13 offset:8704
  v_mfma_f32_16x16x32_bf16 v[228:231], v[104:107], v[92:95], v[228:231]
  ds_read_b64_tr_b16 v[68:69], v12 offset:16384
  v_mfma_f32_16x16x32_bf16 v[188:191], v[108:111], v[88:91], v[188:191]
  ds_read_b64_tr_b16 v[70:71], v12 offset:16896
  v_mfma_f32_16x16x32_bf16 v[184:187], v[108:111], v[84:87], v[184:187]
  ds_read_b64_tr_b16 v[72:73], v13 offset:16384
  v_mfma_f32_16x16x32_bf16 v[180:183], v[108:111], v[80:83], v[180:183]
  ds_read_b64_tr_b16 v[74:75], v13 offset:16896
  v_mfma_f32_16x16x32_bf16 v[176:179], v[108:111], v[76:79], v[176:179]
  s_cmp_lg_u32 s79, 0
  s_nop 0
  v_mfma_f32_16x16x32_bf16 v[192:195], v[76:79], v[112:115], v[192:195]
  v_mfma_f32_16x16x32_bf16 v[196:199], v[80:83], v[112:115], v[196:199]
  v_mfma_f32_16x16x32_bf16 v[200:203], v[84:87], v[112:115], v[200:203]
  v_mfma_f32_16x16x32_bf16 v[204:207], v[88:91], v[112:115], v[204:207]
  v_mfma_f32_16x16x32_bf16 v[232:235], v[92:95], v[112:115], v[232:235]
  v_mfma_f32_16x16x32_bf16 v[220:223], v[88:91], v[116:119], v[220:223]
  v_mfma_f32_16x16x32_bf16 v[216:219], v[84:87], v[116:119], v[216:219]
  v_mfma_f32_16x16x32_bf16 v[212:215], v[80:83], v[116:119], v[212:215]
  v_mfma_f32_16x16x32_bf16 v[208:211], v[76:79], v[116:119], v[208:211]
  s_waitcnt lgkmcnt(0)
  s_cbranch_scc1 L_attn_loop
L_attn_exit:
  ds_read2_b32 v[66:67], v23 offset0:0 offset1:160
  ds_read2_b32 v[68:69], v23 offset0:16 offset1:176
  ds_read2_b32 v[70:71], v23 offset0:32 offset1:192
  ds_read2_b32 v[72:73], v23 offset0:48 offset1:208
  ds_read2_b32 v[74:75], v23 offset0:64 offset1:224
  ds_read2_b32 v[76:77], v25 offset0:0 offset1:16
  ds_read2_b32 v[80:81], v26 offset0:0 offset1:16
  ds_read2_b32 v[78:79], v25 offset0:32 offset1:48
  ds_read2_b32 v[82:83], v26 offset0:32 offset1:48
  ds_write_b128 v16, v[224:227] offset:0
  ds_write_b128 v16, v[228:231] offset:2048
  ds_write_b128 v16, v[232:235] offset:4096
  s_cmp_eq_u32 s71, 1
  s_cbranch_scc1 L_attn_nop3
  ds_write_b128 v16, v[172:175] offset:8192
  ds_write_b128 v16, v[188:191] offset:9216
  ds_write_b128 v16, v[204:207] offset:10240
  ds_write_b128 v16, v[220:223] offset:11264
L_attn_nop3:
  ds_read_b128 v[84:87], v24 offset:0
  ds_read_b128 v[104:107], v24 offset:640
  ds_read_b128 v[88:91], v24 offset:64
  ds_read_b128 v[108:111], v24 offset:704
  ds_read_b128 v[92:95], v24 offset:128
  ds_read_b128 v[112:115], v24 offset:768
  ds_read_b128 v[96:99], v24 offset:192
  ds_read_b128 v[116:119], v24 offset:832
  ds_read_b128 v[100:103], v24 offset:256
  ds_read_b128 v[120:123], v24 offset:896
  s_waitcnt lgkmcnt(10)
  s_barrier
  ds_read_b128 v[48:51], v19 offset:0
  ds_read_b128 v[52:55], v20 offset:1024
  ds_read_b128 v[56:59], v19 offset:2048
  ds_read_b128 v[60:63], v20 offset:3072
  ds_read_b32 v64, v21 offset:4096
  ds_read_b32 v65, v22 offset:5120
  ds_read_b128 v[32:35], v17 offset:2048
  ds_read_b128 v[36:39], v18 offset:3072
  ds_read_b128 v[40:43], v17 offset:4096
  ds_read_b128 v[44:47], v18 offset:5120
  v_mul_f32 v69, 0x3e8293ee, v69
  v_mul_f32 v71, 0x3e8293ee, v71
  v_mul_f32 v73, 0x3e8293ee, v73
  v_mul_f32 v75, 0x3e8293ee, v75
  v_mul_f32 v76, v76, v69
  v_mul_f32 v80, v80, v69
  v_mul_f32 v77, v77, v71
  v_mul_f32 v81, v81, v71
  v_mul_f32 v78, v78, v73
  v_mul_f32 v82, v82, v73
  v_mul_f32 v79, v79, v75
  v_mul_f32 v83, v83, v75
  s_waitcnt lgkmcnt(6)
  v_pk_fma_f32 v[128:129], v[48:49], v[68:69], v[128:129] op_sel:[0,0,0] op_sel_hi:[1,0,1] neg_lo:[0,1,0] neg_hi:[0,1,0]
  v_pk_fma_f32 v[130:131], v[50:51], v[68:69], v[130:131] op_sel:[0,0,0] op_sel_hi:[1,0,1] neg_lo:[0,1,0] neg_hi:[0,1,0]
  v_pk_fma_f32 v[144:145], v[52:53], v[68:69], v[144:145] op_sel:[0,0,0] op_sel_hi:[1,0,1] neg_lo:[0,1,0] neg_hi:[0,1,0]
  v_pk_fma_f32 v[146:147], v[54:55], v[68:69], v[146:147] op_sel:[0,0,0] op_sel_hi:[1,0,1] neg_lo:[0,1,0] neg_hi:[0,1,0]
  v_cvt_pk_bf16_f32 v128, v128, v129
  v_cvt_pk_bf16_f32 v129, v130, v131
  v_cvt_pk_bf16_f32 v130, v144, v145
  v_cvt_pk_bf16_f32 v131, v146, v147
  v_pk_fma_f32 v[160:161], v[56:57], v[68:69], v[160:161] op_sel:[0,0,0] op_sel_hi:[1,0,1] neg_lo:[0,1,0] neg_hi:[0,1,0]
  v_pk_fma_f32 v[162:163], v[58:59], v[68:69], v[162:163] op_sel:[0,0,0] op_sel_hi:[1,0,1] neg_lo:[0,1,0] neg_hi:[0,1,0]
  v_pk_fma_f32 v[176:177], v[60:61], v[68:69], v[176:177] op_sel:[0,0,0] op_sel_hi:[1,0,1] neg_lo:[0,1,0] neg_hi:[0,1,0]
  v_pk_fma_f32 v[178:179], v[62:63], v[68:69], v[178:179] op_sel:[0,0,0] op_sel_hi:[1,0,1] neg_lo:[0,1,0] neg_hi:[0,1,0]
  v_cvt_pk_bf16_f32 v160, v160, v161
  v_cvt_pk_bf16_f32 v161, v162, v163
  v_cvt_pk_bf16_f32 v162, v176, v177
  v_cvt_pk_bf16_f32 v163, v178, v179
  v_pk_fma_f32 v[132:133], v[48:49], v[70:71], v[132:133] op_sel:[0,0,0] op_sel_hi:[1,0,1] neg_lo:[0,1,0] neg_hi:[0,1,0]
  v_pk_fma_f32 v[134:135], v[50:51], v[70:71], v[134:135] op_sel:[0,0,0] op_sel_hi:[1,0,1] neg_lo:[0,1,0] neg_hi:[0,1,0]
  v_pk_fma_f32 v[148:149], v[52:53], v[70:71], v[148:149] op_sel:[0,0,0] op_sel_hi:[1,0,1] neg_lo:[0,1,0] neg_hi:[0,1,0]
  v_pk_fma_f32 v[150:151], v[54:55], v[70:71], v[150:151] op_sel:[0,0,0] op_sel_hi:[1,0,1] neg_lo:[0,1,0] neg_hi:[0,1,0]
  v_cvt_pk_bf16_f32 v132, v132, v133
  v_cvt_pk_bf16_f32 v133, v134, v135
  v_cvt_pk_bf16_f32 v134, v148, v149
  v_cvt_pk_bf16_f32 v135, v150, v151
  v_pk_fma_f32 v[164:165], v[56:57], v[70:71], v[164:165] op_sel:[0,0,0] op_sel_hi:[1,0,1] neg_lo:[0,1,0] neg_hi:[0,1,0]
  v_pk_fma_f32 v[166:167], v[58:59], v[70:71], v[166:167] op_sel:[0,0,0] op_sel_hi:[1,0,1] neg_lo:[0,1,0] neg_hi:[0,1,0]
  v_pk_fma_f32 v[180:181], v[60:61], v[70:71], v[180:181] op_sel:[0,0,0] op_sel_hi:[1,0,1] neg_lo:[0,1,0] neg_hi:[0,1,0]
  v_pk_fma_f32 v[182:183], v[62:63], v[70:71], v[182:183] op_sel:[0,0,0] op_sel_hi:[1,0,1] neg_lo:[0,1,0] neg_hi:[0,1,0]
  v_cvt_pk_bf16_f32 v164, v164, v165
  v_cvt_pk_bf16_f32 v165, v166, v167
  v_cvt_pk_bf16_f32 v166, v180, v181
  v_cvt_pk_bf16_f32 v167, v182, v183
  v_mfma_f32_16x16x32_bf16 v[144:147], v[160:163], v[128:131], 0
  v_pk_fma_f32 v[136:137], v[48:49], v[72:73], v[136:137] op_sel:[0,0,0] op_sel_hi:[1,0,1] neg_lo:[0,1,0] neg_hi:[0,1,0]
  v_pk_fma_f32 v[138:139], v[50:51], v[72:73], v[138:139] op_sel:[0,0,0] op_sel_hi:[1,0,1] neg_lo:[0,1,0] neg_hi:[0,1,0]
  v_pk_fma_f32 v[152:153], v[52:53], v[72:73], v[152:153] op_sel:[0,0,0] op_sel_hi:[1,0,1] neg_lo:[0,1,0] neg_hi:[0,1,0]
  v_pk_fma_f32 v[154:155], v[54:55], v[72:73], v[154:155] op_sel:[0,0,0] op_sel_hi:[1,0,1] neg_lo:[0,1,0] neg_hi:[0,1,0]
  v_cvt_pk_bf16_f32 v136, v136, v137
  v_cvt_pk_bf16_f32 v137, v138, v139
  v_cvt_pk_bf16_f32 v138, v152, v153
  v_cvt_pk_bf16_f32 v139, v154, v155
  v_pk_fma_f32 v[168:169], v[56:57], v[72:73], v[168:169] op_sel:[0,0,0] op_sel_hi:[1,0,1] neg_lo:[0,1,0] neg_hi:[0,1,0]
  v_pk_fma_f32 v[170:171], v[58:59], v[72:73], v[170:171] op_sel:[0,0,0] op_sel_hi:[1,0,1] neg_lo:[0,1,0] neg_hi:[0,1,0]
  v_pk_fma_f32 v[184:185], v[60:61], v[72:73], v[184:185] op_sel:[0,0,0] op_sel_hi:[1,0,1] neg_lo:[0,1,0] neg_hi:[0,1,0]
  v_pk_fma_f32 v[186:187], v[62:63], v[72:73], v[186:187] op_sel:[0,0,0] op_sel_hi:[1,0,1] neg_lo:[0,1,0] neg_hi:[0,1,0]
  v_cvt_pk_bf16_f32 v168, v168, v169
  v_cvt_pk_bf16_f32 v169, v170, v171
  v_cvt_pk_bf16_f32 v170, v184, v185
  v_cvt_pk_bf16_f32 v171, v186, v187
  v_mfma_f32_16x16x32_bf16 v[148:151], v[164:167], v[132:135], 0
  v_mfma_f32_16x16x32_bf16 v[180:183], v[160:163], v[132:135], 0
  v_pk_fma_f32 v[140:141], v[48:49], v[74:75], v[140:141] op_sel:[0,0,0] op_sel_hi:[1,0,1] neg_lo:[0,1,0] neg_hi:[0,1,0]
  v_pk_fma_f32 v[142:143], v[50:51], v[74:75], v[142:143] op_sel:[0,0,0] op_sel_hi:[1,0,1] neg_lo:[0,1,0] neg_hi:[0,1,0]
  v_pk_fma_f32 v[156:157], v[52:53], v[74:75], v[156:157] op_sel:[0,0,0] op_sel_hi:[1,0,1] neg_lo:[0,1,0] neg_hi:[0,1,0]
  v_pk_fma_f32 v[158:159], v[54:55], v[74:75], v[158:159] op_sel:[0,0,0] op_sel_hi:[1,0,1] neg_lo:[0,1,0] neg_hi:[0,1,0]
  v_cvt_pk_bf16_f32 v140, v140, v141
  v_cvt_pk_bf16_f32 v141, v142, v143
  v_cvt_pk_bf16_f32 v142, v156, v157
  v_cvt_pk_bf16_f32 v143, v158, v159
  v_pk_fma_f32 v[172:173], v[56:57], v[74:75], v[172:173] op_sel:[0,0,0] op_sel_hi:[1,0,1] neg_lo:[0,1,0] neg_hi:[0,1,0]
  v_pk_fma_f32 v[174:175], v[58:59], v[74:75], v[174:175] op_sel:[0,0,0] op_sel_hi:[1,0,1] neg_lo:[0,1,0] neg_hi:[0,1,0]
  v_pk_fma_f32 v[188:189], v[60:61], v[74:75], v[188:189] op_sel:[0,0,0] op_sel_hi:[1,0,1] neg_lo:[0,1,0] neg_hi:[0,1,0]
  v_pk_fma_f32 v[190:191], v[62:63], v[74:75], v[190:191] op_sel:[0,0,0] op_sel_hi:[1,0,1] neg_lo:[0,1,0] neg_hi:[0,1,0]
  v_cvt_pk_bf16_f32 v172, v172, v173
  v_cvt_pk_bf16_f32 v173, v174, v175
  v_cvt_pk_bf16_f32 v174, v188, v189
  v_cvt_pk_bf16_f32 v175, v190, v191
  s_waitcnt lgkmcnt(0)
  v_pk_fma_f32 v[32:33], v[56:57], v[66:67], v[32:33] op_sel:[0,0,0] op_sel_hi:[1,0,1] neg_lo:[0,1,0] neg_hi:[0,1,0]
  v_pk_fma_f32 v[34:35], v[58:59], v[66:67], v[34:35] op_sel:[0,0,0] op_sel_hi:[1,0,1] neg_lo:[0,1,0] neg_hi:[0,1,0]
  v_pk_fma_f32 v[36:37], v[60:61], v[66:67], v[36:37] op_sel:[0,0,0] op_sel_hi:[1,0,1] neg_lo:[0,1,0] neg_hi:[0,1,0]
  v_pk_fma_f32 v[38:39], v[62:63], v[66:67], v[38:39] op_sel:[0,0,0] op_sel_hi:[1,0,1] neg_lo:[0,1,0] neg_hi:[0,1,0]
  v_cvt_pk_bf16_f32 v32, v32, v33
  v_cvt_pk_bf16_f32 v33, v34, v35
  v_cvt_pk_bf16_f32 v34, v36, v37
  v_cvt_pk_bf16_f32 v35, v38, v39
  v_mfma_f32_16x16x32_bf16 v[152:155], v[168:171], v[136:139], 0
  v_mfma_f32_16x16x32_bf16 v[184:187], v[164:167], v[136:139], 0
  v_mfma_f32_16x16x32_bf16 v[156:159], v[172:175], v[140:143], 0
  v_mfma_f32_16x16x32_bf16 v[188:191], v[168:171], v[140:143], 0
  v_mfma_f32_16x16x32_bf16 v[176:179], v[32:35], v[128:131], 0
  v_pk_fma_f32 v[40:41], v[84:85], v[64:65], v[40:41] op_sel:[0,0,0] op_sel_hi:[1,0,1] neg_lo:[1,0,0] neg_hi:[1,0,0]
  v_pk_fma_f32 v[42:43], v[86:87], v[64:65], v[42:43] op_sel:[0,0,0] op_sel_hi:[1,0,1] neg_lo:[1,0,0] neg_hi:[1,0,0]
  v_pk_mul_f32 v[40:41], v[40:41], v[104:105]
  v_pk_mul_f32 v[42:43], v[42:43], v[106:107]
  v_cvt_pk_bf16_f32 v4, v40, v41
  v_cvt_pk_bf16_f32 v5, v42, v43
  v_pk_fma_f32 v[192:193], v[88:89], v[64:65], v[192:193] op_sel:[0,0,0] op_sel_hi:[1,0,1] neg_lo:[1,0,0] neg_hi:[1,0,0]
  v_pk_fma_f32 v[194:195], v[90:91], v[64:65], v[194:195] op_sel:[0,0,0] op_sel_hi:[1,0,1] neg_lo:[1,0,0] neg_hi:[1,0,0]
  v_pk_mul_f32 v[192:193], v[192:193], v[108:109]
  v_pk_mul_f32 v[194:195], v[194:195], v[110:111]
  v_cvt_pk_bf16_f32 v6, v192, v193
  v_cvt_pk_bf16_f32 v7, v194, v195
  v_pk_fma_f32 v[196:197], v[92:93], v[64:65], v[196:197] op_sel:[0,0,0] op_sel_hi:[1,0,1] neg_lo:[1,0,0] neg_hi:[1,0,0]
  v_pk_fma_f32 v[198:199], v[94:95], v[64:65], v[198:199] op_sel:[0,0,0] op_sel_hi:[1,0,1] neg_lo:[1,0,0] neg_hi:[1,0,0]
  v_pk_mul_f32 v[196:197], v[196:197], v[112:113]
  v_pk_mul_f32 v[198:199], v[198:199], v[114:115]
  v_cvt_pk_bf16_f32 v8, v196, v197
  v_cvt_pk_bf16_f32 v9, v198, v199
  v_pk_fma_f32 v[200:201], v[96:97], v[64:65], v[200:201] op_sel:[0,0,0] op_sel_hi:[1,0,1] neg_lo:[1,0,0] neg_hi:[1,0,0]
  v_pk_fma_f32 v[202:203], v[98:99], v[64:65], v[202:203] op_sel:[0,0,0] op_sel_hi:[1,0,1] neg_lo:[1,0,0] neg_hi:[1,0,0]
  v_pk_mul_f32 v[200:201], v[200:201], v[116:117]
  v_pk_mul_f32 v[202:203], v[202:203], v[118:119]
  v_cvt_pk_bf16_f32 v10, v200, v201
  v_cvt_pk_bf16_f32 v11, v202, v203
  v_pk_fma_f32 v[204:205], v[100:101], v[64:65], v[204:205] op_sel:[0,0,0] op_sel_hi:[1,0,1] neg_lo:[1,0,0] neg_hi:[1,0,0]
  v_pk_fma_f32 v[206:207], v[102:103], v[64:65], v[206:207] op_sel:[0,0,0] op_sel_hi:[1,0,1] neg_lo:[1,0,0] neg_hi:[1,0,0]
  v_pk_mul_f32 v[204:205], v[204:205], v[120:121]
  v_pk_mul_f32 v[206:207], v[206:207], v[122:123]
  v_cvt_pk_bf16_f32 v12, v204, v205
  v_cvt_pk_bf16_f32 v13, v206, v207
  v_pk_fma_f32 v[44:45], v[84:85], v[64:65], v[44:45] op_sel:[0,1,0] op_sel_hi:[1,1,1] neg_lo:[1,0,0] neg_hi:[1,0,0]
  v_pk_fma_f32 v[46:47], v[86:87], v[64:65], v[46:47] op_sel:[0,1,0] op_sel_hi:[1,1,1] neg_lo:[1,0,0] neg_hi:[1,0,0]
  v_pk_mul_f32 v[44:45], v[44:45], v[104:105]
  v_pk_mul_f32 v[46:47], v[46:47], v[106:107]
  v_cvt_pk_bf16_f32 v224, v44, v45
  v_cvt_pk_bf16_f32 v225, v46, v47
  v_pk_fma_f32 v[208:209], v[88:89], v[64:65], v[208:209] op_sel:[0,1,0] op_sel_hi:[1,1,1] neg_lo:[1,0,0] neg_hi:[1,0,0]
  v_pk_fma_f32 v[210:211], v[90:91], v[64:65], v[210:211] op_sel:[0,1,0] op_sel_hi:[1,1,1] neg_lo:[1,0,0] neg_hi:[1,0,0]
  v_pk_mul_f32 v[208:209], v[208:209], v[108:109]
  v_pk_mul_f32 v[210:211], v[210:211], v[110:111]
  v_cvt_pk_bf16_f32 v226, v208, v209
  v_cvt_pk_bf16_f32 v227, v210, v211
  v_pk_fma_f32 v[212:213], v[92:93], v[64:65], v[212:213] op_sel:[0,1,0] op_sel_hi:[1,1,1] neg_lo:[1,0,0] neg_hi:[1,0,0]
  v_pk_fma_f32 v[214:215], v[94:95], v[64:65], v[214:215] op_sel:[0,1,0] op_sel_hi:[1,1,1] neg_lo:[1,0,0] neg_hi:[1,0,0]
  v_pk_mul_f32 v[212:213], v[212:213], v[112:113]
  v_pk_mul_f32 v[214:215], v[214:215], v[114:115]
  v_cvt_pk_bf16_f32 v228, v212, v213
  v_cvt_pk_bf16_f32 v229, v214, v215
  v_pk_fma_f32 v[216:217], v[96:97], v[64:65], v[216:217] op_sel:[0,1,0] op_sel_hi:[1,1,1] neg_lo:[1,0,0] neg_hi:[1,0,0]
  v_pk_fma_f32 v[218:219], v[98:99], v[64:65], v[218:219] op_sel:[0,1,0] op_sel_hi:[1,1,1] neg_lo:[1,0,0] neg_hi:[1,0,0]
  v_pk_mul_f32 v[216:217], v[216:217], v[116:117]
  v_pk_mul_f32 v[218:219], v[218:219], v[118:119]
  v_cvt_pk_bf16_f32 v230, v216, v217
  v_cvt_pk_bf16_f32 v231, v218, v219
  v_pk_fma_f32 v[220:221], v[100:101], v[64:65], v[220:221] op_sel:[0,1,0] op_sel_hi:[1,1,1] neg_lo:[1,0,0] neg_hi:[1,0,0]
  v_pk_fma_f32 v[222:223], v[102:103], v[64:65], v[222:223] op_sel:[0,1,0] op_sel_hi:[1,1,1] neg_lo:[1,0,0] neg_hi:[1,0,0]
  v_pk_mul_f32 v[220:221], v[220:221], v[120:121]
  v_pk_mul_f32 v[222:223], v[222:223], v[122:123]
  v_cvt_pk_bf16_f32 v232, v220, v221
  v_cvt_pk_bf16_f32 v233, v222, v223
  v_cndmask_b32 v148, v148, v149, s[48:49]
  v_cndmask_b32 v180, v180, v181, s[48:49]
  v_cndmask_b32 v150, v150, v151, s[48:49]
  v_cndmask_b32 v182, v182, v183, s[48:49]
  v_cndmask_b32 v36, v148, v180, s[50:51]
  v_cndmask_b32 v37, v150, v182, s[52:53]
  v_mul_f32 v36, v36, v77
  v_mul_f32 v37, v37, v81
  v_cndmask_b32 v152, v152, v153, s[48:49]
  v_cndmask_b32 v184, v184, v185, s[48:49]
  v_cndmask_b32 v154, v154, v155, s[48:49]
  v_cndmask_b32 v186, v186, v187, s[48:49]
  v_cndmask_b32 v40, v152, v184, s[50:51]
  v_cndmask_b32 v41, v154, v186, s[52:53]
  v_mul_f32 v40, v40, v78
  v_mul_f32 v41, v41, v82
  v_cndmask_b32 v156, v156, v157, s[48:49]
  v_cndmask_b32 v188, v188, v189, s[48:49]
  v_cndmask_b32 v158, v158, v159, s[48:49]
  v_cndmask_b32 v190, v190, v191, s[48:49]
  v_cndmask_b32 v44, v156, v188, s[50:51]
  v_cndmask_b32 v45, v158, v190, s[52:53]
  v_mul_f32 v44, v44, v79
  v_mul_f32 v45, v45, v83
  v_cndmask_b32 v144, v144, v145, s[48:49]
  v_cndmask_b32 v176, v176, v177, s[48:49]
  v_cndmask_b32 v146, v146, v147, s[48:49]
  v_cndmask_b32 v178, v178, v179, s[48:49]
  v_cndmask_b32 v32, v144, v176, s[50:51]
  v_cndmask_b32 v33, v146, v178, s[52:53]
  v_mul_f32 v32, v32, v76
  v_mul_f32 v33, v33, v80
  v_mov_b32 v48, 0xceabfb8f
  v_cndmask_b32 v32, v32, v48, s[54:55]
  v_cndmask_b32 v33, v33, v48, s[14:15]
  v_max_f32 v34, v32, v33
  v_max_f32 v38, v36, v37
  v_max_f32 v42, v40, v41
  v_max_f32 v46, v44, v45
  v_mov_b32 v35, v34
  v_mov_b32 v39, v38
  v_mov_b32 v43, v42
  v_mov_b32 v47, v46
  v_permlane32_swap_b32 v34, v35
  v_permlane32_swap_b32 v38, v39
  v_permlane32_swap_b32 v42, v43
  v_permlane32_swap_b32 v46, v47
  v_max_f32 v34, v34, v35
  v_max_f32 v38, v38, v39
  v_max_f32 v42, v42, v43
  v_max_f32 v46, v46, v47
  v_mov_b32 v35, v34
  v_mov_b32 v39, v38
  v_mov_b32 v43, v42
  v_mov_b32 v47, v46
  v_permlane16_swap_b32 v34, v35
  v_permlane16_swap_b32 v38, v39
  v_permlane16_swap_b32 v42, v43
  v_permlane16_swap_b32 v46, v47
  v_max_f32 v34, v34, v35
  v_max_f32 v38, v38, v39
  v_max_f32 v42, v42, v43
  v_max_f32 v46, v46, v47
  v_sub_f32 v32, v32, v34
  v_sub_f32 v33, v33, v34
  v_sub_f32 v36, v36, v38
  v_sub_f32 v37, v37, v38
  v_sub_f32 v40, v40, v42
  v_sub_f32 v41, v41, v42
  v_sub_f32 v44, v44, v46
  v_sub_f32 v45, v45, v46
  v_exp_f32 v32, v32
  v_exp_f32 v33, v33
  v_exp_f32 v36, v36
  v_exp_f32 v37, v37
  v_exp_f32 v40, v40
  v_exp_f32 v41, v41
  v_exp_f32 v44, v44
  v_exp_f32 v45, v45
  v_cvt_pk_bf16_f32 v32, v32, v32
  v_cvt_pk_bf16_f32 v33, v33, v33
  v_and_b32 v128, v32, v27
  v_and_b32 v129, v33, v29
  v_and_b32 v130, v32, v28
  v_and_b32 v131, v33, v30
  v_cvt_pk_bf16_f32 v36, v36, v36
  v_cvt_pk_bf16_f32 v37, v37, v37
  v_and_b32 v132, v36, v27
  v_and_b32 v133, v37, v29
  v_and_b32 v134, v36, v28
  v_and_b32 v135, v37, v30
  v_mfma_f32_16x16x32_bf16 v[144:147], v[236:239], v[128:131], 0
  v_mfma_f32_16x16x32_bf16 v[192:195], v[4:7], v[128:131], 0
  v_mfma_f32_16x16x32_bf16 v[208:211], v[224:227], v[128:131], 0
  v_cvt_pk_bf16_f32 v40, v40, v40
  v_cvt_pk_bf16_f32 v41, v41, v41
  v_and_b32 v136, v40, v27
  v_and_b32 v137, v41, v29
  v_and_b32 v138, v40, v28
  v_and_b32 v139, v41, v30
  v_mfma_f32_16x16x32_bf16 v[148:151], v[236:239], v[132:135], 0
  v_mfma_f32_16x16x32_bf16 v[196:199], v[6:9], v[132:135], 0
  v_mfma_f32_16x16x32_bf16 v[212:215], v[226:229], v[132:135], 0
  v_cvt_pk_bf16_f32 v44, v44, v44
  v_cvt_pk_bf16_f32 v45, v45, v45
  v_and_b32 v140, v44, v27
  v_and_b32 v141, v45, v29
  v_and_b32 v142, v44, v28
  v_and_b32 v143, v45, v30
  v_mfma_f32_16x16x32_bf16 v[152:155], v[236:239], v[136:139], 0
  v_mfma_f32_16x16x32_bf16 v[200:203], v[8:11], v[136:139], 0
  v_mfma_f32_16x16x32_bf16 v[216:219], v[228:231], v[136:139], 0
  v_mfma_f32_16x16x32_bf16 v[156:159], v[236:239], v[140:143], 0
  v_mfma_f32_16x16x32_bf16 v[204:207], v[10:13], v[140:143], 0
  v_mfma_f32_16x16x32_bf16 v[220:223], v[230:233], v[140:143], 0
  v_rcp_f32 v144, v144
  s_mov_b32 s3, 0
  v_pk_mul_f32 v[192:193], v[192:193], v[144:145] op_sel_hi:[1,0]
  v_pk_mul_f32 v[194:195], v[194:195], v[144:145] op_sel_hi:[1,0]
  v_pk_mul_f32 v[208:209], v[208:209], v[144:145] op_sel_hi:[1,0]
  v_pk_mul_f32 v[210:211], v[210:211], v[144:145] op_sel_hi:[1,0]
  v_cvt_pk_bf16_f32 v48, v192, v193
  v_cvt_pk_bf16_f32 v49, v194, v195
  v_cvt_pk_bf16_f32 v50, v208, v209
  v_cvt_pk_bf16_f32 v51, v210, v211
  s_nop 1
  v_permlane16_swap_b32 v48, v50
  v_permlane16_swap_b32 v49, v51
  buffer_store_dwordx4 v[48:51], v31, s[44:47], s3 offen sc1
  v_rcp_f32 v148, v148
  s_mov_b32 s3, 32768
  v_pk_mul_f32 v[196:197], v[196:197], v[148:149] op_sel_hi:[1,0]
  v_pk_mul_f32 v[198:199], v[198:199], v[148:149] op_sel_hi:[1,0]
  v_pk_mul_f32 v[212:213], v[212:213], v[148:149] op_sel_hi:[1,0]
  v_pk_mul_f32 v[214:215], v[214:215], v[148:149] op_sel_hi:[1,0]
  v_cvt_pk_bf16_f32 v52, v196, v197
  v_cvt_pk_bf16_f32 v53, v198, v199
  v_cvt_pk_bf16_f32 v54, v212, v213
  v_cvt_pk_bf16_f32 v55, v214, v215
  s_nop 1
  v_permlane16_swap_b32 v52, v54
  v_permlane16_swap_b32 v53, v55
  buffer_store_dwordx4 v[52:55], v31, s[44:47], s3 offen sc1
  v_rcp_f32 v152, v152
  s_mov_b32 s3, 65536
  v_pk_mul_f32 v[200:201], v[200:201], v[152:153] op_sel_hi:[1,0]
  v_pk_mul_f32 v[202:203], v[202:203], v[152:153] op_sel_hi:[1,0]
  v_pk_mul_f32 v[216:217], v[216:217], v[152:153] op_sel_hi:[1,0]
  v_pk_mul_f32 v[218:219], v[218:219], v[152:153] op_sel_hi:[1,0]
  v_cvt_pk_bf16_f32 v56, v200, v201
  v_cvt_pk_bf16_f32 v57, v202, v203
  v_cvt_pk_bf16_f32 v58, v216, v217
  v_cvt_pk_bf16_f32 v59, v218, v219
  s_nop 1
  v_permlane16_swap_b32 v56, v58
  v_permlane16_swap_b32 v57, v59
  buffer_store_dwordx4 v[56:59], v31, s[44:47], s3 offen sc1
  v_rcp_f32 v156, v156
  s_mov_b32 s3, 98304
  v_pk_mul_f32 v[204:205], v[204:205], v[156:157] op_sel_hi:[1,0]
  v_pk_mul_f32 v[206:207], v[206:207], v[156:157] op_sel_hi:[1,0]
  v_pk_mul_f32 v[220:221], v[220:221], v[156:157] op_sel_hi:[1,0]
  v_pk_mul_f32 v[222:223], v[222:223], v[156:157] op_sel_hi:[1,0]
  v_cvt_pk_bf16_f32 v60, v204, v205
  v_cvt_pk_bf16_f32 v61, v206, v207
  v_cvt_pk_bf16_f32 v62, v220, v221
  v_cvt_pk_bf16_f32 v63, v222, v223
  s_nop 1
  v_permlane16_swap_b32 v60, v62
  v_permlane16_swap_b32 v61, v63
  buffer_store_dwordx4 v[60:63], v31, s[44:47], s3 offen sc1
  s_waitcnt vmcnt(0) lgkmcnt(0)
  s_barrier
  s_add_u32 s97, s97, 1
  s_branch L_wo_body
.section .rodata,"a"
.p2align 6
.amdhsa_kernel interleave_layers__sliding_local_dilated__dense_activation_gelu__prompt_kernel
  .amdhsa_next_free_vgpr 256
  .amdhsa_next_free_sgpr 102
  .amdhsa_accum_offset 256
  .amdhsa_group_segment_fixed_size 0
  .amdhsa_kernarg_size 88
  .amdhsa_user_sgpr_count 2
  .amdhsa_user_sgpr_kernarg_segment_ptr 1
  .amdhsa_system_sgpr_workgroup_id_x 1
  .amdhsa_float_denorm_mode_32 3
  .amdhsa_float_denorm_mode_16_64 3
.end_amdhsa_kernel
.text
L_attn_c1:
L_wo_c0:
L_wo_body:
  s_cmp_ge_u32 s2, 256
  s_cbranch_scc1 L_wo_end
  v_lshrrev_b32 v2, 6, v0
  v_and_b32 v1, 63, v0
  v_readfirstlane_b32 s70, v2
  s_and_b32 s3, s2, 7
  s_lshr_b32 s99, s2, 3
  s_and_b32 s5, s3, 3
  s_lshl_b32 s5, s5, 2
  s_and_b32 s6, s99, 3
  s_add_u32 s68, s5, s6
  s_lshr_b32 s5, s3, 2
  s_lshr_b32 s78, s99, 2
  s_lshl1_add_u32 s69, s78, s5
  s_add_u32 s3, s68, s78
  s_lshl_b32 s3, s3, 3
  s_lshl_b32 s85, 0xffff02, s3
  s_sub_u32 s3, 0, s3
  s_lshr_b32 s3, 0xffff02, s3
  s_or_b32 s85, s85, s3
  s_cmp_lt_u32 s70, 4
  s_cbranch_scc1 L_wo_compute
L_wo_loader:
  s_add_u32 s3, s96, s70
  s_cmp_lg_u32 s3, 4
  s_cbranch_scc1 L_wo_chk0
  s_load_dwordx2 s[64:65], s[0:1], 72
  s_waitcnt lgkmcnt(0)
  s_and_b32 s65, s65, 0xffff
  s_mov_b32 s66, 256
  s_mov_b32 s67, 0x00020000
  v_lshlrev_b32 v17, 2, v1
  buffer_load_dword v12, v17, s[64:67], 0 offen sc1
L_wo_chk0:
  s_cmp_lg_u32 s96, 0
  s_cbranch_scc1 L_wo_nofirst
  s_waitcnt vmcnt(1)
  s_mov_b32 s7, 0xffff0000
  v_lshlrev_b32 v32, 16, v64
  v_and_b32 v33, s7, v64
  v_lshlrev_b32 v34, 16, v65
  v_and_b32 v35, s7, v65
  v_lshlrev_b32 v36, 16, v66
  v_and_b32 v37, s7, v66
  v_lshlrev_b32 v38, 16, v67
  v_and_b32 v39, s7, v67
  v_lshlrev_b32 v40, 16, v68
  v_and_b32 v41, s7, v68
  v_pk_add_f32 v[32:33], v[32:33], v[40:41]
  v_lshlrev_b32 v40, 16, v69
  v_and_b32 v41, s7, v69
  v_pk_add_f32 v[34:35], v[34:35], v[40:41]
  v_lshlrev_b32 v40, 16, v70
  v_and_b32 v41, s7, v70
  v_pk_add_f32 v[36:37], v[36:37], v[40:41]
  v_lshlrev_b32 v40, 16, v71
  v_and_b32 v41, s7, v71
  v_pk_add_f32 v[38:39], v[38:39], v[40:41]
  v_lshlrev_b32 v40, 16, v72
  v_and_b32 v41, s7, v72
  v_pk_add_f32 v[32:33], v[32:33], v[40:41]
  v_lshlrev_b32 v40, 16, v73
  v_and_b32 v41, s7, v73
  v_pk_add_f32 v[34:35], v[34:35], v[40:41]
  v_lshlrev_b32 v40, 16, v74
  v_and_b32 v41, s7, v74
  v_pk_add_f32 v[36:37], v[36:37], v[40:41]
  v_lshlrev_b32 v40, 16, v75
  v_and_b32 v41, s7, v75
  v_pk_add_f32 v[38:39], v[38:39], v[40:41]
  v_lshlrev_b32 v40, 16, v76
  v_and_b32 v41, s7, v76
  v_pk_add_f32 v[32:33], v[32:33], v[40:41]
  v_lshlrev_b32 v40, 16, v77
  v_and_b32 v41, s7, v77
  v_pk_add_f32 v[34:35], v[34:35], v[40:41]
  v_lshlrev_b32 v40, 16, v78
  v_and_b32 v41, s7, v78
  v_pk_add_f32 v[36:37], v[36:37], v[40:41]
  v_lshlrev_b32 v40, 16, v79
  v_and_b32 v41, s7, v79
  v_pk_add_f32 v[38:39], v[38:39], v[40:41]
  v_lshlrev_b32 v40, 16, v80
  v_and_b32 v41, s7, v80
  v_pk_add_f32 v[32:33], v[32:33], v[40:41]
  v_lshlrev_b32 v40, 16, v81
  v_and_b32 v41, s7, v81
  v_pk_add_f32 v[34:35], v[34:35], v[40:41]
  v_lshlrev_b32 v40, 16, v82
  v_and_b32 v41, s7, v82
  v_pk_add_f32 v[36:37], v[36:37], v[40:41]
  v_lshlrev_b32 v40, 16, v83
  v_and_b32 v41, s7, v83
  v_pk_add_f32 v[38:39], v[38:39], v[40:41]
  v_lshlrev_b32 v40, 16, v84
  v_and_b32 v41, s7, v84
  v_pk_add_f32 v[32:33], v[32:33], v[40:41]
  v_lshlrev_b32 v40, 16, v85
  v_and_b32 v41, s7, v85
  v_pk_add_f32 v[34:35], v[34:35], v[40:41]
  v_lshlrev_b32 v40, 16, v86
  v_and_b32 v41, s7, v86
  v_pk_add_f32 v[36:37], v[36:37], v[40:41]
  v_lshlrev_b32 v40, 16, v87
  v_and_b32 v41, s7, v87
  v_pk_add_f32 v[38:39], v[38:39], v[40:41]
  v_lshlrev_b32 v40, 16, v88
  v_and_b32 v41, s7, v88
  v_pk_add_f32 v[32:33], v[32:33], v[40:41]
  v_lshlrev_b32 v40, 16, v89
  v_and_b32 v41, s7, v89
  v_pk_add_f32 v[34:35], v[34:35], v[40:41]
  v_lshlrev_b32 v40, 16, v90
  v_and_b32 v41, s7, v90
  v_pk_add_f32 v[36:37], v[36:37], v[40:41]
  v_lshlrev_b32 v40, 16, v91
  v_and_b32 v41, s7, v91
  v_pk_add_f32 v[38:39], v[38:39], v[40:41]
  v_lshlrev_b32 v40, 16, v92
  v_and_b32 v41, s7, v92
  v_pk_add_f32 v[32:33], v[32:33], v[40:41]
  v_lshlrev_b32 v40, 16, v93
  v_and_b32 v41, s7, v93
  v_pk_add_f32 v[34:35], v[34:35], v[40:41]
  v_lshlrev_b32 v40, 16, v94
  v_and_b32 v41, s7, v94
  v_pk_add_f32 v[36:37], v[36:37], v[40:41]
  v_lshlrev_b32 v40, 16, v95
  v_and_b32 v41, s7, v95
  v_pk_add_f32 v[38:39], v[38:39], v[40:41]
  s_add_u32 s52, s22, 24641536
  s_addc_u32 s53, s23, 0
  s_and_b32 s53, s53, 0xffff
  s_mov_b32 s54, 262144
  s_mov_b32 s55, 0x00020000
  v_permlane32_swap_b32 v32, v36
  v_permlane32_swap_b32 v33, v37
  v_permlane32_swap_b32 v34, v38
  v_permlane32_swap_b32 v35, v39
  v_add_f32 v32, v32, v36
  v_add_f32 v33, v33, v37
  v_add_f32 v34, v34, v38
  v_add_f32 v35, v35, v39
  v_and_b32 v2, 7, v1
  v_lshlrev_b32 v2, 5, v2
  v_permlane16_swap_b32 v32, v34
  v_permlane16_swap_b32 v33, v35
  v_add_f32 v32, v32, v34
  v_add_f32 v33, v33, v35
  v_lshrrev_b32 v3, 4, v1
  v_lshl_add_u32 v2, v3, 3, v2
  v_add_f32_dpp v32, v32, v32 row_ror:8 row_mask:0xf bank_mask:0xf
  v_add_f32_dpp v33, v33, v33 row_ror:8 row_mask:0xf bank_mask:0xf
  buffer_store_dwordx2 v[32:33], v2, s[52:55], s94 offen sc1
L_wo_nofirst:
  v_and_b32 v2, 3, v1
  v_lshlrev_b32 v2, 3, v2
  v_bfe_i32 v16, s85, v2, 8
  s_and_b32 s3, s68, 3
  s_mul_i32 s4, s3, 4
  v_add3_u32 v3, v16, v1, s4
  v_and_b32 v3, 15, v3
  v_lshlrev_b32 v16, 17, v3
  s_add_u32 s9, s70, s68
  s_and_b32 s9, s9, 3
  s_lshl_b32 s77, s9, 11
  v_and_b32 v10, 7, v1
  v_lshrrev_b32 v3, 3, v1
  s_lshl_b32 s10, s9, 4
  v_add_u32 v3, s10, v3
  v_mul_u32_u24 v3, 2048, v3
  v_lshrrev_b32 v2, 3, v1
  v_and_b32 v2, 2, v2
  v_xor_b32 v2, v2, v10
  s_lshl_b32 s10, s69, 7
  v_add_u32 v3, s10, v3
  v_lshl_add_u32 v8, v2, 4, v3
  v_xor_b32 v2, 4, v2
  v_add_u32 v3, 16384, v3
  v_lshl_add_u32 v9, v2, 4, v3
  s_mov_b32 s40, s20
  s_and_b32 s41, s21, 0xffff
  s_mov_b32 s42, 2097152
  s_mov_b32 s43, 0x00020000
  v_readlane_b32 s74, v16, 0
  s_add_u32 m0, s77, 131072
  s_add_u32 s4, s74, 0
  buffer_load_dwordx4 v8, s[40:43], s4 offen lds
  s_add_u32 m0, s77, 132096
  s_nop 0
  buffer_load_dwordx4 v9, s[40:43], s4 offen lds
  v_readlane_b32 s74, v16, 1
  s_add_u32 m0, s77, 139264
  s_add_u32 s4, s74, 0
  buffer_load_dwordx4 v8, s[40:43], s4 offen lds
  s_add_u32 m0, s77, 140288
  s_nop 0
  buffer_load_dwordx4 v9, s[40:43], s4 offen lds
  v_readlane_b32 s74, v16, 2
  s_add_u32 m0, s77, 147456
  s_add_u32 s4, s74, 0
  buffer_load_dwordx4 v8, s[40:43], s4 offen lds
  s_add_u32 m0, s77, 148480
  s_nop 0
  buffer_load_dwordx4 v9, s[40:43], s4 offen lds
  v_readlane_b32 s74, v16, 3
  s_add_u32 m0, s77, 155648
  s_add_u32 s4, s74, 0
  buffer_load_dwordx4 v8, s[40:43], s4 offen lds
  s_add_u32 m0, s77, 156672
  s_nop 0
  buffer_load_dwordx4 v9, s[40:43], s4 offen lds
  v_readlane_b32 s74, v16, 4
  s_add_u32 m0, s77, 28672
  s_add_u32 s4, s74, 0
  buffer_load_dwordx4 v8, s[40:43], s4 offen lds
  s_add_u32 m0, s77, 29696
  s_nop 0
  buffer_load_dwordx4 v9, s[40:43], s4 offen lds
  v_readlane_b32 s74, v16, 5
  s_add_u32 m0, s77, 36864
  s_add_u32 s4, s74, 0
  buffer_load_dwordx4 v8, s[40:43], s4 offen lds
  s_add_u32 m0, s77, 37888
  s_nop 0
  buffer_load_dwordx4 v9, s[40:43], s4 offen lds
  s_waitcnt vmcnt(12)
  s_add_u32 s3, s96, s70
  s_cmp_lg_u32 s3, 4
  s_cbranch_scc1 L_wo_chk1
  v_cmp_ne_u32 vcc, 0x01010101, v12
  s_cbranch_vccz L_wo_chk1
  s_load_dwordx2 s[64:65], s[0:1], 72
  s_waitcnt lgkmcnt(0)
  s_and_b32 s65, s65, 0xffff
  s_mov_b32 s66, 256
  s_mov_b32 s67, 0x00020000
  v_lshlrev_b32 v17, 2, v1
  s_mov_b32 s79, 0x100000
L_wo_chkl:
  buffer_load_dword v12, v17, s[64:67], 0 offen sc1
  s_sub_u32 s79, s79, 1
  s_cbranch_scc1 L_wo_chk1
  s_waitcnt vmcnt(0)
  v_cmp_ne_u32 vcc, 0x01010101, v12
  s_cbranch_vccnz L_wo_chkl
L_wo_chk1:
  s_add_u32 s44, s22, 41943040
  s_addc_u32 s45, s23, 0
  s_and_b32 s45, s45, 0xffff
  s_mov_b32 s46, 524288
  s_mov_b32 s47, 0x00020000
  s_lshl4_add_u32 s3, s97, s68
  s_and_b32 s4, s69, 15
  s_lshl4_add_u32 s3, s3, s4
  s_lshl_b32 s3, s3, 7
  s_sub_u32 s3, s3, 32768
  v_lshlrev_b32 v11, 7, v1
  v_and_b32 v2, 15, v1
  v_lshlrev_b32 v2, 2, v2
  v_mov_b32 v3, 1
  s_mov_b32 s79, 0x100000
  s_cmp_lg_u32 s70, 4
  s_barrier
  s_cbranch_scc1 L_wo_nofl
  s_mov_b32 exec_lo, 0xffff
  s_mov_b32 exec_hi, 0
  buffer_store_dword v3, v11, s[44:47], s87 offen sc1
  s_mov_b64 exec, -1
L_wo_nofl:
  s_mov_b32 s5, s3
  v_readlane_b32 s74, v16, 6
  s_add_u32 m0, s77, 45056
  s_add_u32 s4, s74, 0
  buffer_load_dwordx4 v8, s[40:43], s4 offen lds
  s_add_u32 m0, s77, 46080
  s_nop 0
  buffer_load_dwordx4 v9, s[40:43], s4 offen lds
  v_readlane_b32 s74, v16, 7
  s_add_u32 m0, s77, 53248
  s_add_u32 s4, s74, 0
  buffer_load_dwordx4 v8, s[40:43], s4 offen lds
  s_add_u32 m0, s77, 54272
  s_nop 0
  buffer_load_dwordx4 v9, s[40:43], s4 offen lds
  v_readlane_b32 s74, v16, 8
  s_add_u32 m0, s77, 61440
  s_add_u32 s4, s74, 0
  buffer_load_dwordx4 v8, s[40:43], s4 offen lds
  s_add_u32 m0, s77, 62464
  s_nop 0
  buffer_load_dwordx4 v9, s[40:43], s4 offen lds
  v_readlane_b32 s74, v16, 9
  s_add_u32 m0, s77, 69632
  s_add_u32 s4, s74, 0
  buffer_load_dwordx4 v8, s[40:43], s4 offen lds
  s_add_u32 m0, s77, 70656
  s_nop 0
  buffer_load_dwordx4 v9, s[40:43], s4 offen lds
  v_readlane_b32 s74, v16, 10
  s_add_u32 m0, s77, 77824
  s_add_u32 s4, s74, 0
  buffer_load_dwordx4 v8, s[40:43], s4 offen lds
  s_add_u32 m0, s77, 78848
  s_nop 0
  buffer_load_dwordx4 v9, s[40:43], s4 offen lds
  v_readlane_b32 s74, v16, 11
  s_add_u32 m0, s77, 86016
  s_add_u32 s4, s74, 0
  buffer_load_dwordx4 v8, s[40:43], s4 offen lds
  s_add_u32 m0, s77, 87040
  s_nop 0
  buffer_load_dwordx4 v9, s[40:43], s4 offen lds
  v_readlane_b32 s74, v16, 12
  s_add_u32 m0, s77, 94208
  s_add_u32 s4, s74, 0
  buffer_load_dwordx4 v8, s[40:43], s4 offen lds
  s_add_u32 m0, s77, 95232
  s_nop 0
  buffer_load_dwordx4 v9, s[40:43], s4 offen lds
  v_readlane_b32 s74, v16, 13
  s_add_u32 m0, s77, 102400
  s_add_u32 s4, s74, 0
  buffer_load_dwordx4 v8, s[40:43], s4 offen lds
  s_add_u32 m0, s77, 103424
  s_nop 0
  buffer_load_dwordx4 v9, s[40:43], s4 offen lds
  v_readlane_b32 s74, v16, 14
  s_add_u32 m0, s77, 110592
  s_add_u32 s4, s74, 0
  buffer_load_dwordx4 v8, s[40:43], s4 offen lds
  s_add_u32 m0, s77, 111616
  s_nop 0
  buffer_load_dwordx4 v9, s[40:43], s4 offen lds
  v_readlane_b32 s74, v16, 15
  s_add_u32 m0, s77, 118784
  s_add_u32 s4, s74, 0
  buffer_load_dwordx4 v8, s[40:43], s4 offen lds
  s_add_u32 m0, s77, 119808
  s_nop 0
  buffer_load_dwordx4 v9, s[40:43], s4 offen lds
  s_mov_b32 s3, s5
  s_cmp_lg_u32 s70, 4
  s_cbranch_scc1 L_wo_dep
L_wo_poll:
  buffer_load_dword v3, v2, s[44:47], s3 offen sc1
  s_sub_u32 s79, s79, 1
  s_cbranch_scc1 L_wo_dep
  s_waitcnt vmcnt(0)
  v_cmp_ne_u32 vcc, 1, v3
  s_cbranch_vccnz L_wo_poll
L_wo_dep:
  s_waitcnt vmcnt(22) lgkmcnt(0)
  s_barrier
  s_waitcnt vmcnt(14)
  s_barrier
  s_waitcnt vmcnt(4)
  s_barrier
  s_waitcnt vmcnt(0)
  s_barrier
  s_waitcnt vmcnt(0)
  s_lshl_b32 s87, s97, 15
  s_lshl_b32 s4, s68, 11
  s_add_u32 s87, s87, s4
  s_lshl_b32 s4, s69, 2
  s_add_u32 s87, s87, s4
  s_add_u32 s97, s97, 1
  s_branch L_w1_body
L_wo_end:
  s_endpgm
L_wo_compute:
  v_and_b32 v2, 3, v1
  v_lshlrev_b32 v2, 3, v2
  v_bfe_i32 v15, s85, v2, 8
  s_and_b32 s3, s68, 3
  s_mul_i32 s4, s3, 4
  v_add3_u32 v3, v15, v1, s4
  v_and_b32 v3, 15, v3
  v_lshlrev_b32 v15, 11, v3
  v_and_b32 v3, 15, v1
  v_lshrrev_b32 v2, 4, v1
  s_lshl_b32 s8, s68, 7
  s_lshl_b32 s9, s70, 5
  s_add_u32 s8, s8, s9
  s_mul_i32 s9, s8, 2048
  v_lshl_add_u32 v4, v1, 4, s9
  v_add_u32 v5, 32768, v4
  v_add_u32 v13, s8, v3
  s_lshl_b32 s10, s69, 7
  v_lshl_add_u32 v14, v2, 3, s10
  v_and_b32 v16, 1, v2
  v_lshrrev_b32 v17, 1, v2
  v_lshl_add_u32 v16, v16, 1, v17
  v_lshlrev_b32 v16, 8, v16
  v_lshl_add_u32 v16, v3, 4, v16
  s_add_u32 s9, s8, s69
  s_lshl_b32 s9, s9, 11
  v_add_u32 v12, s9, v16
  v_lshl_add_u32 v18, v17, 4, v13
  v_lshlrev_b32 v18, 3, v18
  v_and_b32 v16, 1, v2
  v_lshl_add_u32 v18, v16, 2, v18
  s_lshl_b32 s10, s69, 14
  v_add_u32 v18, s10, v18
  v_bfe_u32 v6, v1, 2, 2
  v_lshl_add_u32 v6, v2, 3, v6
  v_lshlrev_b32 v6, 7, v6
  v_and_b32 v17, 3, v1
  v_lshl_add_u32 v6, v17, 3, v6
  v_bfe_u32 v17, v1, 3, 2
  v_lshl_add_u32 v6, v17, 5, v6
  v_xor_b32 v7, 32, v6
  v_xor_b32 v8, 64, v6
  v_xor_b32 v9, 96, v6
  s_mov_b32 s11, 0xffff0000
  s_mov_b32 s36, s34
  s_and_b32 s37, s35, 0xffff
  s_mov_b32 s38, 4194304
  s_mov_b32 s39, 0x00020000
  s_add_u32 s44, s34, 4194304
  s_addc_u32 s45, s35, 0
  s_and_b32 s45, s45, 0xffff
  s_mov_b32 s46, 4194304
  s_mov_b32 s47, 0x00020000
  s_add_u32 s56, s34, 24117248
  s_addc_u32 s57, s35, 0
  s_and_b32 s57, s57, 0xffff
  s_mov_b32 s58, 262144
  s_mov_b32 s59, 0x00020000
  s_mul_i32 s9, s8, 2048
  s_add_u32 s36, s36, s9
  s_addc_u32 s37, s37, 0x100000
  s_add_u32 s64, s36, 32768
  s_addc_u32 s65, s37, 0
  s_mov_b32 s38, 32768
  s_mov_b32 s39, 0x00800000
  s_mov_b32 s66, 32768
  s_mov_b32 s67, 0x00800000
  s_cmp_lg_u32 s96, 0
  s_cbranch_scc1 L_pfc2_skip
  s_getpc_b64 s[4:5]
L_pfc2:
  s_lshl_b32 s3, s99, 2
  s_add_u32 s3, s3, s70
  s_mul_i32 s3, s3, 128
  s_min_u32 s3, s3, L_w1_c1-L_w1_c0-128
  s_add_i32 s3, s3, L_w1_c0-L_pfc2
  s_ashr_i32 s6, s3, 31
  s_add_u32 s4, s4, s3
  s_addc_u32 s5, s5, s6
  s_load_dword s40, s[4:5], 0
  s_load_dword s41, s[4:5], 64
L_pfc2_skip:
  v_add_u32 v26, 155648, v6
  v_add_u32 v27, 155648, v7
  v_add_u32 v28, 155648, v8
  v_add_u32 v29, 155648, v9
  v_add_u32 v20, 94208, v6
  v_add_u32 v21, 94208, v7
  v_add_u32 v22, 94208, v8
  v_add_u32 v23, 94208, v9
  v_add_u32 v6, 28672, v6
  v_add_u32 v7, 28672, v7
  v_add_u32 v8, 28672, v8
  v_add_u32 v9, 28672, v9
  v_readlane_b32 s48, v15, 0
  v_readlane_b32 s49, v15, 1
  v_readlane_b32 s50, v15, 2
  v_permlane16_swap_b32 v240, v242
  v_permlane16_swap_b32 v241, v243
  v_permlane16_swap_b32 v244, v246
  v_permlane16_swap_b32 v245, v247
  v_permlane16_swap_b32 v248, v250
  v_permlane16_swap_b32 v249, v251
  v_permlane16_swap_b32 v252, v254
  v_permlane16_swap_b32 v253, v255
  s_waitcnt lgkmcnt(0)
  s_barrier
  buffer_load_dwordx4 v[32:35], off, s[36:39], s48 offset:0
  buffer_load_dwordx4 v[36:39], off, s[64:67], s48 offset:0
  buffer_load_dwordx4 v[40:43], off, s[36:39], s48 offset:1024
  buffer_load_dwordx4 v[44:47], off, s[64:67], s48 offset:1024
  buffer_load_dwordx4 v[48:51], off, s[36:39], s49 offset:0
  buffer_load_dwordx4 v[52:55], off, s[64:67], s49 offset:0
  buffer_load_dwordx4 v[56:59], off, s[36:39], s49 offset:1024
  buffer_load_dwordx4 v[60:63], off, s[64:67], s49 offset:1024
  buffer_load_dwordx4 v[64:67], off, s[36:39], s50 offset:0
  buffer_load_dwordx4 v[68:71], off, s[64:67], s50 offset:0
  buffer_load_dwordx4 v[72:75], off, s[36:39], s50 offset:1024
  buffer_load_dwordx4 v[76:79], off, s[64:67], s50 offset:1024
  ds_read_b64_tr_b16 v[160:161], v20 offset:36864
  ds_read_b64_tr_b16 v[162:163], v20 offset:37376
  ds_read_b64_tr_b16 v[164:165], v21 offset:36864
  ds_read_b64_tr_b16 v[166:167], v21 offset:37376
  ds_read_b64_tr_b16 v[168:169], v22 offset:36864
  ds_read_b64_tr_b16 v[170:171], v22 offset:37376
  ds_read_b64_tr_b16 v[172:173], v23 offset:36864
  ds_read_b64_tr_b16 v[174:175], v23 offset:37376
  ds_read_b64_tr_b16 v[176:177], v20 offset:40960
  ds_read_b64_tr_b16 v[178:179], v20 offset:41472
  ds_read_b64_tr_b16 v[180:181], v21 offset:40960
  ds_read_b64_tr_b16 v[182:183], v21 offset:41472
  ds_read_b64_tr_b16 v[184:185], v22 offset:40960
  ds_read_b64_tr_b16 v[186:187], v22 offset:41472
  ds_read_b64_tr_b16 v[188:189], v23 offset:40960
  ds_read_b64_tr_b16 v[190:191], v23 offset:41472
  v_lshlrev_b32 v96, 16, v240
  v_and_b32 v97, s11, v240
  v_lshlrev_b32 v98, 16, v241
  v_and_b32 v99, s11, v241
  v_lshlrev_b32 v100, 16, v248
  v_and_b32 v101, s11, v248
  v_lshlrev_b32 v102, 16, v249
  v_and_b32 v103, s11, v249
  v_lshlrev_b32 v104, 16, v242
  v_and_b32 v105, s11, v242
  v_lshlrev_b32 v106, 16, v243
  v_and_b32 v107, s11, v243
  v_lshlrev_b32 v108, 16, v250
  v_and_b32 v109, s11, v250
  v_lshlrev_b32 v110, 16, v251
  v_and_b32 v111, s11, v251
  v_lshlrev_b32 v112, 16, v244
  v_and_b32 v113, s11, v244
  v_lshlrev_b32 v114, 16, v245
  v_and_b32 v115, s11, v245
  v_lshlrev_b32 v116, 16, v252
  v_and_b32 v117, s11, v252
  v_lshlrev_b32 v118, 16, v253
  v_and_b32 v119, s11, v253
  v_lshlrev_b32 v120, 16, v246
  v_and_b32 v121, s11, v246
  v_lshlrev_b32 v122, 16, v247
  v_and_b32 v123, s11, v247
  v_lshlrev_b32 v124, 16, v254
  v_and_b32 v125, s11, v254
  v_lshlrev_b32 v126, 16, v255
  v_and_b32 v127, s11, v255
  s_waitcnt vmcnt(10) lgkmcnt(8)
  v_mfma_f32_16x16x32_bf16 v[96:99], v[160:163], v[32:35], v[96:99]
  ds_read_b64_tr_b16 v[192:193], v20 offset:45056
  v_readlane_b32 s51, v15, 3
  v_mfma_f32_16x16x32_bf16 v[100:103], v[160:163], v[36:39], v[100:103]
  ds_read_b64_tr_b16 v[194:195], v20 offset:45568
  v_mfma_f32_16x16x32_bf16 v[108:111], v[164:167], v[36:39], v[108:111]
  ds_read_b64_tr_b16 v[196:197], v21 offset:45056
  v_mfma_f32_16x16x32_bf16 v[104:107], v[164:167], v[32:35], v[104:107]
  buffer_load_dwordx4 v[80:83], off, s[36:39], s51 offset:0
  v_mfma_f32_16x16x32_bf16 v[112:115], v[168:171], v[32:35], v[112:115]
  ds_read_b64_tr_b16 v[198:199], v21 offset:45568
  ds_read_b64_tr_b16 v[200:201], v22 offset:45056
  v_mfma_f32_16x16x32_bf16 v[116:119], v[168:171], v[36:39], v[116:119]
  ds_read_b64_tr_b16 v[202:203], v22 offset:45568
  ds_read_b64_tr_b16 v[204:205], v23 offset:45056
  v_mfma_f32_16x16x32_bf16 v[124:127], v[172:175], v[36:39], v[124:127]
  buffer_load_dwordx4 v[84:87], off, s[64:67], s51 offset:0
  v_mfma_f32_16x16x32_bf16 v[120:123], v[172:175], v[32:35], v[120:123]
  ds_read_b64_tr_b16 v[206:207], v23 offset:45568
  s_waitcnt vmcnt(10) lgkmcnt(8)
  v_mfma_f32_16x16x32_bf16 v[96:99], v[176:179], v[40:43], v[96:99]
  ds_read_b64_tr_b16 v[208:209], v20 offset:49152
  v_mfma_f32_16x16x32_bf16 v[100:103], v[176:179], v[44:47], v[100:103]
  buffer_load_dwordx4 v[88:91], off, s[36:39], s51 offset:1024
  v_mfma_f32_16x16x32_bf16 v[108:111], v[180:183], v[44:47], v[108:111]
  ds_read_b64_tr_b16 v[210:211], v20 offset:49664
  ds_read_b64_tr_b16 v[212:213], v21 offset:49152
  v_mfma_f32_16x16x32_bf16 v[104:107], v[180:183], v[40:43], v[104:107]
  ds_read_b64_tr_b16 v[214:215], v21 offset:49664
  ds_read_b64_tr_b16 v[216:217], v22 offset:49152
  v_mfma_f32_16x16x32_bf16 v[112:115], v[184:187], v[40:43], v[112:115]
  buffer_load_dwordx4 v[92:95], off, s[64:67], s51 offset:1024
  v_mfma_f32_16x16x32_bf16 v[116:119], v[184:187], v[44:47], v[116:119]
  ds_read_b64_tr_b16 v[218:219], v22 offset:49664
  v_readlane_b32 s48, v15, 4
  v_mfma_f32_16x16x32_bf16 v[124:127], v[188:191], v[44:47], v[124:127]
  ds_read_b64_tr_b16 v[220:221], v23 offset:49152
  v_mfma_f32_16x16x32_bf16 v[120:123], v[188:191], v[40:43], v[120:123]
  ds_read_b64_tr_b16 v[222:223], v23 offset:49664
  s_waitcnt vmcnt(10) lgkmcnt(8)
  v_mfma_f32_16x16x32_bf16 v[96:99], v[192:195], v[48:51], v[96:99]
  buffer_load_dwordx4 v[32:35], off, s[36:39], s48 offset:0
  v_mfma_f32_16x16x32_bf16 v[100:103], v[192:195], v[52:55], v[100:103]
  ds_read_b64_tr_b16 v[160:161], v20 offset:53248
  ds_read_b64_tr_b16 v[162:163], v20 offset:53760
  v_mfma_f32_16x16x32_bf16 v[108:111], v[196:199], v[52:55], v[108:111]
  ds_read_b64_tr_b16 v[164:165], v21 offset:53248
  v_mfma_f32_16x16x32_bf16 v[104:107], v[196:199], v[48:51], v[104:107]
  buffer_load_dwordx4 v[36:39], off, s[64:67], s48 offset:0
  v_mfma_f32_16x16x32_bf16 v[112:115], v[200:203], v[48:51], v[112:115]
  ds_read_b64_tr_b16 v[166:167], v21 offset:53760
  ds_read_b64_tr_b16 v[168:169], v22 offset:53248
  v_mfma_f32_16x16x32_bf16 v[116:119], v[200:203], v[52:55], v[116:119]
  ds_read_b64_tr_b16 v[170:171], v22 offset:53760
  ds_read_b64_tr_b16 v[172:173], v23 offset:53248
  v_mfma_f32_16x16x32_bf16 v[124:127], v[204:207], v[52:55], v[124:127]
  buffer_load_dwordx4 v[40:43], off, s[36:39], s48 offset:1024
  v_mfma_f32_16x16x32_bf16 v[120:123], v[204:207], v[48:51], v[120:123]
  ds_read_b64_tr_b16 v[174:175], v23 offset:53760
  s_waitcnt vmcnt(11) lgkmcnt(8)
  v_mfma_f32_16x16x32_bf16 v[96:99], v[208:211], v[56:59], v[96:99]
  ds_read_b64_tr_b16 v[176:177], v20 offset:57344
  v_mfma_f32_16x16x32_bf16 v[100:103], v[208:211], v[60:63], v[100:103]
  buffer_load_dwordx4 v[44:47], off, s[64:67], s48 offset:1024
  v_mfma_f32_16x16x32_bf16 v[108:111], v[212:215], v[60:63], v[108:111]
  ds_read_b64_tr_b16 v[178:179], v20 offset:57856
  ds_read_b64_tr_b16 v[180:181], v21 offset:57344
  v_mfma_f32_16x16x32_bf16 v[104:107], v[212:215], v[56:59], v[104:107]
  ds_read_b64_tr_b16 v[182:183], v21 offset:57856
  v_mfma_f32_16x16x32_bf16 v[112:115], v[216:219], v[56:59], v[112:115]
  ds_read_b64_tr_b16 v[184:185], v22 offset:57344
  v_mfma_f32_16x16x32_bf16 v[116:119], v[216:219], v[60:63], v[116:119]
  ds_read_b64_tr_b16 v[186:187], v22 offset:57856
  v_readlane_b32 s49, v15, 5
  v_mfma_f32_16x16x32_bf16 v[124:127], v[220:223], v[60:63], v[124:127]
  ds_read_b64_tr_b16 v[188:189], v23 offset:57344
  v_mfma_f32_16x16x32_bf16 v[120:123], v[220:223], v[56:59], v[120:123]
  ds_read_b64_tr_b16 v[190:191], v23 offset:57856
  s_waitcnt vmcnt(10) lgkmcnt(8)
  v_mfma_f32_16x16x32_bf16 v[96:99], v[160:163], v[64:67], v[96:99]
  buffer_load_dwordx4 v[48:51], off, s[36:39], s49 offset:0
  v_mfma_f32_16x16x32_bf16 v[100:103], v[160:163], v[68:71], v[100:103]
  ds_read_b64_tr_b16 v[192:193], v26 offset:0
  ds_read_b64_tr_b16 v[194:195], v26 offset:512
  v_mfma_f32_16x16x32_bf16 v[108:111], v[164:167], v[68:71], v[108:111]
  ds_read_b64_tr_b16 v[196:197], v27 offset:0
  v_mfma_f32_16x16x32_bf16 v[104:107], v[164:167], v[64:67], v[104:107]
  buffer_load_dwordx4 v[52:55], off, s[64:67], s49 offset:0
  v_mfma_f32_16x16x32_bf16 v[112:115], v[168:171], v[64:67], v[112:115]
  ds_read_b64_tr_b16 v[198:199], v27 offset:512
  ds_read_b64_tr_b16 v[200:201], v28 offset:0
  v_mfma_f32_16x16x32_bf16 v[116:119], v[168:171], v[68:71], v[116:119]
  ds_read_b64_tr_b16 v[202:203], v28 offset:512
  ds_read_b64_tr_b16 v[204:205], v29 offset:0
  v_mfma_f32_16x16x32_bf16 v[124:127], v[172:175], v[68:71], v[124:127]
  buffer_load_dwordx4 v[56:59], off, s[36:39], s49 offset:1024
  v_mfma_f32_16x16x32_bf16 v[120:123], v[172:175], v[64:67], v[120:123]
  ds_read_b64_tr_b16 v[206:207], v29 offset:512
  s_waitcnt vmcnt(11) lgkmcnt(8)
  v_mfma_f32_16x16x32_bf16 v[96:99], v[176:179], v[72:75], v[96:99]
  ds_read_b64_tr_b16 v[208:209], v26 offset:4096
  v_mfma_f32_16x16x32_bf16 v[100:103], v[176:179], v[76:79], v[100:103]
  buffer_load_dwordx4 v[60:63], off, s[64:67], s49 offset:1024
  v_mfma_f32_16x16x32_bf16 v[108:111], v[180:183], v[76:79], v[108:111]
  ds_read_b64_tr_b16 v[210:211], v26 offset:4608
  ds_read_b64_tr_b16 v[212:213], v27 offset:4096
  v_mfma_f32_16x16x32_bf16 v[104:107], v[180:183], v[72:75], v[104:107]
  ds_read_b64_tr_b16 v[214:215], v27 offset:4608
  v_mfma_f32_16x16x32_bf16 v[112:115], v[184:187], v[72:75], v[112:115]
  ds_read_b64_tr_b16 v[216:217], v28 offset:4096
  v_mfma_f32_16x16x32_bf16 v[116:119], v[184:187], v[76:79], v[116:119]
  ds_read_b64_tr_b16 v[218:219], v28 offset:4608
  v_readlane_b32 s50, v15, 6
  v_mfma_f32_16x16x32_bf16 v[124:127], v[188:191], v[76:79], v[124:127]
  ds_read_b64_tr_b16 v[220:221], v29 offset:4096
  v_mfma_f32_16x16x32_bf16 v[120:123], v[188:191], v[72:75], v[120:123]
  ds_read_b64_tr_b16 v[222:223], v29 offset:4608
  s_waitcnt vmcnt(10) lgkmcnt(8)
  v_mfma_f32_16x16x32_bf16 v[96:99], v[192:195], v[80:83], v[96:99]
  buffer_load_dwordx4 v[64:67], off, s[36:39], s50 offset:0
  v_mfma_f32_16x16x32_bf16 v[100:103], v[192:195], v[84:87], v[100:103]
  ds_read_b64_tr_b16 v[160:161], v6 offset:0
  ds_read_b64_tr_b16 v[162:163], v6 offset:512
  v_mfma_f32_16x16x32_bf16 v[108:111], v[196:199], v[84:87], v[108:111]
  ds_read_b64_tr_b16 v[164:165], v7 offset:0
  v_mfma_f32_16x16x32_bf16 v[104:107], v[196:199], v[80:83], v[104:107]
  buffer_load_dwordx4 v[68:71], off, s[64:67], s50 offset:0
  v_mfma_f32_16x16x32_bf16 v[112:115], v[200:203], v[80:83], v[112:115]
  ds_read_b64_tr_b16 v[166:167], v7 offset:512
  ds_read_b64_tr_b16 v[168:169], v8 offset:0
  v_mfma_f32_16x16x32_bf16 v[116:119], v[200:203], v[84:87], v[116:119]
  ds_read_b64_tr_b16 v[170:171], v8 offset:512
  ds_read_b64_tr_b16 v[172:173], v9 offset:0
  v_mfma_f32_16x16x32_bf16 v[124:127], v[204:207], v[84:87], v[124:127]
  buffer_load_dwordx4 v[72:75], off, s[36:39], s50 offset:1024
  v_mfma_f32_16x16x32_bf16 v[120:123], v[204:207], v[80:83], v[120:123]
  ds_read_b64_tr_b16 v[174:175], v9 offset:512
  s_waitcnt vmcnt(11) lgkmcnt(8)
  s_barrier
  v_mfma_f32_16x16x32_bf16 v[96:99], v[208:211], v[88:91], v[96:99]
  ds_read_b64_tr_b16 v[176:177], v6 offset:4096
  v_mfma_f32_16x16x32_bf16 v[100:103], v[208:211], v[92:95], v[100:103]
  buffer_load_dwordx4 v[76:79], off, s[64:67], s50 offset:1024
  v_mfma_f32_16x16x32_bf16 v[108:111], v[212:215], v[92:95], v[108:111]
  ds_read_b64_tr_b16 v[178:179], v6 offset:4608
  ds_read_b64_tr_b16 v[180:181], v7 offset:4096
  v_mfma_f32_16x16x32_bf16 v[104:107], v[212:215], v[88:91], v[104:107]
  ds_read_b64_tr_b16 v[182:183], v7 offset:4608
  v_mfma_f32_16x16x32_bf16 v[112:115], v[216:219], v[88:91], v[112:115]
  ds_read_b64_tr_b16 v[184:185], v8 offset:4096
  v_mfma_f32_16x16x32_bf16 v[116:119], v[216:219], v[92:95], v[116:119]
  ds_read_b64_tr_b16 v[186:187], v8 offset:4608
  v_readlane_b32 s51, v15, 7
  v_mfma_f32_16x16x32_bf16 v[124:127], v[220:223], v[92:95], v[124:127]
  ds_read_b64_tr_b16 v[188:189], v9 offset:4096
  v_mfma_f32_16x16x32_bf16 v[120:123], v[220:223], v[88:91], v[120:123]
  ds_read_b64_tr_b16 v[190:191], v9 offset:4608
  s_waitcnt vmcnt(10) lgkmcnt(8)
  v_mfma_f32_16x16x32_bf16 v[96:99], v[160:163], v[32:35], v[96:99]
  buffer_load_dwordx4 v[80:83], off, s[36:39], s51 offset:0
  v_mfma_f32_16x16x32_bf16 v[100:103], v[160:163], v[36:39], v[100:103]
  ds_read_b64_tr_b16 v[192:193], v6 offset:8192
  ds_read_b64_tr_b16 v[194:195], v6 offset:8704
  v_mfma_f32_16x16x32_bf16 v[108:111], v[164:167], v[36:39], v[108:111]
  ds_read_b64_tr_b16 v[196:197], v7 offset:8192
  v_mfma_f32_16x16x32_bf16 v[104:107], v[164:167], v[32:35], v[104:107]
  buffer_load_dwordx4 v[84:87], off, s[64:67], s51 offset:0
  v_mfma_f32_16x16x32_bf16 v[112:115], v[168:171], v[32:35], v[112:115]
  ds_read_b64_tr_b16 v[198:199], v7 offset:8704
  ds_read_b64_tr_b16 v[200:201], v8 offset:8192
  v_mfma_f32_16x16x32_bf16 v[116:119], v[168:171], v[36:39], v[116:119]
  ds_read_b64_tr_b16 v[202:203], v8 offset:8704
  ds_read_b64_tr_b16 v[204:205], v9 offset:8192
  v_mfma_f32_16x16x32_bf16 v[124:127], v[172:175], v[36:39], v[124:127]
  buffer_load_dwordx4 v[88:91], off, s[36:39], s51 offset:1024
  v_mfma_f32_16x16x32_bf16 v[120:123], v[172:175], v[32:35], v[120:123]
  ds_read_b64_tr_b16 v[206:207], v9 offset:8704
  s_waitcnt vmcnt(11) lgkmcnt(8)
  v_mfma_f32_16x16x32_bf16 v[96:99], v[176:179], v[40:43], v[96:99]
  ds_read_b64_tr_b16 v[208:209], v6 offset:12288
  v_mfma_f32_16x16x32_bf16 v[100:103], v[176:179], v[44:47], v[100:103]
  buffer_load_dwordx4 v[92:95], off, s[64:67], s51 offset:1024
  v_mfma_f32_16x16x32_bf16 v[108:111], v[180:183], v[44:47], v[108:111]
  ds_read_b64_tr_b16 v[210:211], v6 offset:12800
  ds_read_b64_tr_b16 v[212:213], v7 offset:12288
  v_mfma_f32_16x16x32_bf16 v[104:107], v[180:183], v[40:43], v[104:107]
  ds_read_b64_tr_b16 v[214:215], v7 offset:12800
  v_mfma_f32_16x16x32_bf16 v[112:115], v[184:187], v[40:43], v[112:115]
  ds_read_b64_tr_b16 v[216:217], v8 offset:12288
  v_mfma_f32_16x16x32_bf16 v[116:119], v[184:187], v[44:47], v[116:119]
  ds_read_b64_tr_b16 v[218:219], v8 offset:12800
  v_readlane_b32 s48, v15, 8
  v_mfma_f32_16x16x32_bf16 v[124:127], v[188:191], v[44:47], v[124:127]
  ds_read_b64_tr_b16 v[220:221], v9 offset:12288
  v_mfma_f32_16x16x32_bf16 v[120:123], v[188:191], v[40:43], v[120:123]
  ds_read_b64_tr_b16 v[222:223], v9 offset:12800
  s_waitcnt vmcnt(10) lgkmcnt(8)
  v_mfma_f32_16x16x32_bf16 v[96:99], v[192:195], v[48:51], v[96:99]
  buffer_load_dwordx4 v[32:35], off, s[36:39], s48 offset:0
  v_mfma_f32_16x16x32_bf16 v[100:103], v[192:195], v[52:55], v[100:103]
  ds_read_b64_tr_b16 v[160:161], v6 offset:16384
  ds_read_b64_tr_b16 v[162:163], v6 offset:16896
  v_mfma_f32_16x16x32_bf16 v[108:111], v[196:199], v[52:55], v[108:111]
  ds_read_b64_tr_b16 v[164:165], v7 offset:16384
  v_mfma_f32_16x16x32_bf16 v[104:107], v[196:199], v[48:51], v[104:107]
  buffer_load_dwordx4 v[36:39], off, s[64:67], s48 offset:0
  v_mfma_f32_16x16x32_bf16 v[112:115], v[200:203], v[48:51], v[112:115]
  ds_read_b64_tr_b16 v[166:167], v7 offset:16896
  ds_read_b64_tr_b16 v[168:169], v8 offset:16384
  v_mfma_f32_16x16x32_bf16 v[116:119], v[200:203], v[52:55], v[116:119]
  ds_read_b64_tr_b16 v[170:171], v8 offset:16896
  ds_read_b64_tr_b16 v[172:173], v9 offset:16384
  v_mfma_f32_16x16x32_bf16 v[124:127], v[204:207], v[52:55], v[124:127]
  buffer_load_dwordx4 v[40:43], off, s[36:39], s48 offset:1024
  v_mfma_f32_16x16x32_bf16 v[120:123], v[204:207], v[48:51], v[120:123]
  ds_read_b64_tr_b16 v[174:175], v9 offset:16896
  s_waitcnt vmcnt(11) lgkmcnt(8)
  v_mfma_f32_16x16x32_bf16 v[96:99], v[208:211], v[56:59], v[96:99]
  ds_read_b64_tr_b16 v[176:177], v6 offset:20480
  v_mfma_f32_16x16x32_bf16 v[100:103], v[208:211], v[60:63], v[100:103]
  buffer_load_dwordx4 v[44:47], off, s[64:67], s48 offset:1024
  v_mfma_f32_16x16x32_bf16 v[108:111], v[212:215], v[60:63], v[108:111]
  ds_read_b64_tr_b16 v[178:179], v6 offset:20992
  ds_read_b64_tr_b16 v[180:181], v7 offset:20480
  v_mfma_f32_16x16x32_bf16 v[104:107], v[212:215], v[56:59], v[104:107]
  ds_read_b64_tr_b16 v[182:183], v7 offset:20992
  v_mfma_f32_16x16x32_bf16 v[112:115], v[216:219], v[56:59], v[112:115]
  ds_read_b64_tr_b16 v[184:185], v8 offset:20480
  v_mfma_f32_16x16x32_bf16 v[116:119], v[216:219], v[60:63], v[116:119]
  ds_read_b64_tr_b16 v[186:187], v8 offset:20992
  v_readlane_b32 s49, v15, 9
  v_mfma_f32_16x16x32_bf16 v[124:127], v[220:223], v[60:63], v[124:127]
  ds_read_b64_tr_b16 v[188:189], v9 offset:20480
  v_mfma_f32_16x16x32_bf16 v[120:123], v[220:223], v[56:59], v[120:123]
  ds_read_b64_tr_b16 v[190:191], v9 offset:20992
  s_waitcnt vmcnt(10) lgkmcnt(8)
  v_mfma_f32_16x16x32_bf16 v[96:99], v[160:163], v[64:67], v[96:99]
  buffer_load_dwordx4 v[48:51], off, s[36:39], s49 offset:0
  v_mfma_f32_16x16x32_bf16 v[100:103], v[160:163], v[68:71], v[100:103]
  ds_read_b64_tr_b16 v[192:193], v6 offset:24576
  ds_read_b64_tr_b16 v[194:195], v6 offset:25088
  v_mfma_f32_16x16x32_bf16 v[108:111], v[164:167], v[68:71], v[108:111]
  ds_read_b64_tr_b16 v[196:197], v7 offset:24576
  v_mfma_f32_16x16x32_bf16 v[104:107], v[164:167], v[64:67], v[104:107]
  buffer_load_dwordx4 v[52:55], off, s[64:67], s49 offset:0
  v_mfma_f32_16x16x32_bf16 v[112:115], v[168:171], v[64:67], v[112:115]
  ds_read_b64_tr_b16 v[198:199], v7 offset:25088
  ds_read_b64_tr_b16 v[200:201], v8 offset:24576
  v_mfma_f32_16x16x32_bf16 v[116:119], v[168:171], v[68:71], v[116:119]
  ds_read_b64_tr_b16 v[202:203], v8 offset:25088
  ds_read_b64_tr_b16 v[204:205], v9 offset:24576
  v_mfma_f32_16x16x32_bf16 v[124:127], v[172:175], v[68:71], v[124:127]
  buffer_load_dwordx4 v[56:59], off, s[36:39], s49 offset:1024
  v_mfma_f32_16x16x32_bf16 v[120:123], v[172:175], v[64:67], v[120:123]
  ds_read_b64_tr_b16 v[206:207], v9 offset:25088
  s_waitcnt vmcnt(11) lgkmcnt(8)
  v_mfma_f32_16x16x32_bf16 v[96:99], v[176:179], v[72:75], v[96:99]
  ds_read_b64_tr_b16 v[208:209], v6 offset:28672
  v_mfma_f32_16x16x32_bf16 v[100:103], v[176:179], v[76:79], v[100:103]
  buffer_load_dwordx4 v[60:63], off, s[64:67], s49 offset:1024
  v_mfma_f32_16x16x32_bf16 v[108:111], v[180:183], v[76:79], v[108:111]
  ds_read_b64_tr_b16 v[210:211], v6 offset:29184
  ds_read_b64_tr_b16 v[212:213], v7 offset:28672
  v_mfma_f32_16x16x32_bf16 v[104:107], v[180:183], v[72:75], v[104:107]
  ds_read_b64_tr_b16 v[214:215], v7 offset:29184
  v_mfma_f32_16x16x32_bf16 v[112:115], v[184:187], v[72:75], v[112:115]
  ds_read_b64_tr_b16 v[216:217], v8 offset:28672
  v_mfma_f32_16x16x32_bf16 v[116:119], v[184:187], v[76:79], v[116:119]
  ds_read_b64_tr_b16 v[218:219], v8 offset:29184
  v_readlane_b32 s50, v15, 10
  v_mfma_f32_16x16x32_bf16 v[124:127], v[188:191], v[76:79], v[124:127]
  ds_read_b64_tr_b16 v[220:221], v9 offset:28672
  v_mfma_f32_16x16x32_bf16 v[120:123], v[188:191], v[72:75], v[120:123]
  ds_read_b64_tr_b16 v[222:223], v9 offset:29184
  s_waitcnt vmcnt(10) lgkmcnt(8)
  v_mfma_f32_16x16x32_bf16 v[96:99], v[192:195], v[80:83], v[96:99]
  buffer_load_dwordx4 v[64:67], off, s[36:39], s50 offset:0
  v_mfma_f32_16x16x32_bf16 v[100:103], v[192:195], v[84:87], v[100:103]
  ds_read_b64_tr_b16 v[160:161], v6 offset:32768
  ds_read_b64_tr_b16 v[162:163], v6 offset:33280
  v_mfma_f32_16x16x32_bf16 v[108:111], v[196:199], v[84:87], v[108:111]
  ds_read_b64_tr_b16 v[164:165], v7 offset:32768
  v_mfma_f32_16x16x32_bf16 v[104:107], v[196:199], v[80:83], v[104:107]
  buffer_load_dwordx4 v[68:71], off, s[64:67], s50 offset:0
  v_mfma_f32_16x16x32_bf16 v[112:115], v[200:203], v[80:83], v[112:115]
  ds_read_b64_tr_b16 v[166:167], v7 offset:33280
  ds_read_b64_tr_b16 v[168:169], v8 offset:32768
  v_mfma_f32_16x16x32_bf16 v[116:119], v[200:203], v[84:87], v[116:119]
  ds_read_b64_tr_b16 v[170:171], v8 offset:33280
  ds_read_b64_tr_b16 v[172:173], v9 offset:32768
  v_mfma_f32_16x16x32_bf16 v[124:127], v[204:207], v[84:87], v[124:127]
  buffer_load_dwordx4 v[72:75], off, s[36:39], s50 offset:1024
  v_mfma_f32_16x16x32_bf16 v[120:123], v[204:207], v[80:83], v[120:123]
  ds_read_b64_tr_b16 v[174:175], v9 offset:33280
  s_waitcnt vmcnt(11) lgkmcnt(8)
  s_barrier
  v_mfma_f32_16x16x32_bf16 v[96:99], v[208:211], v[88:91], v[96:99]
  ds_read_b64_tr_b16 v[176:177], v6 offset:36864
  v_mfma_f32_16x16x32_bf16 v[100:103], v[208:211], v[92:95], v[100:103]
  buffer_load_dwordx4 v[76:79], off, s[64:67], s50 offset:1024
  v_mfma_f32_16x16x32_bf16 v[108:111], v[212:215], v[92:95], v[108:111]
  ds_read_b64_tr_b16 v[178:179], v6 offset:37376
  ds_read_b64_tr_b16 v[180:181], v7 offset:36864
  v_mfma_f32_16x16x32_bf16 v[104:107], v[212:215], v[88:91], v[104:107]
  ds_read_b64_tr_b16 v[182:183], v7 offset:37376
  v_mfma_f32_16x16x32_bf16 v[112:115], v[216:219], v[88:91], v[112:115]
  ds_read_b64_tr_b16 v[184:185], v8 offset:36864
  v_mfma_f32_16x16x32_bf16 v[116:119], v[216:219], v[92:95], v[116:119]
  ds_read_b64_tr_b16 v[186:187], v8 offset:37376
  v_readlane_b32 s51, v15, 11
  v_mfma_f32_16x16x32_bf16 v[124:127], v[220:223], v[92:95], v[124:127]
  ds_read_b64_tr_b16 v[188:189], v9 offset:36864
  v_mfma_f32_16x16x32_bf16 v[120:123], v[220:223], v[88:91], v[120:123]
  ds_read_b64_tr_b16 v[190:191], v9 offset:37376
  s_waitcnt vmcnt(10) lgkmcnt(8)
  v_mfma_f32_16x16x32_bf16 v[96:99], v[160:163], v[32:35], v[96:99]
  buffer_load_dwordx4 v[80:83], off, s[36:39], s51 offset:0
  v_mfma_f32_16x16x32_bf16 v[100:103], v[160:163], v[36:39], v[100:103]
  ds_read_b64_tr_b16 v[192:193], v6 offset:40960
  ds_read_b64_tr_b16 v[194:195], v6 offset:41472
  v_mfma_f32_16x16x32_bf16 v[108:111], v[164:167], v[36:39], v[108:111]
  ds_read_b64_tr_b16 v[196:197], v7 offset:40960
  v_mfma_f32_16x16x32_bf16 v[104:107], v[164:167], v[32:35], v[104:107]
  buffer_load_dwordx4 v[84:87], off, s[64:67], s51 offset:0
  v_mfma_f32_16x16x32_bf16 v[112:115], v[168:171], v[32:35], v[112:115]
  ds_read_b64_tr_b16 v[198:199], v7 offset:41472
  ds_read_b64_tr_b16 v[200:201], v8 offset:40960
  v_mfma_f32_16x16x32_bf16 v[116:119], v[168:171], v[36:39], v[116:119]
  ds_read_b64_tr_b16 v[202:203], v8 offset:41472
  ds_read_b64_tr_b16 v[204:205], v9 offset:40960
  v_mfma_f32_16x16x32_bf16 v[124:127], v[172:175], v[36:39], v[124:127]
  buffer_load_dwordx4 v[88:91], off, s[36:39], s51 offset:1024
  v_mfma_f32_16x16x32_bf16 v[120:123], v[172:175], v[32:35], v[120:123]
  ds_read_b64_tr_b16 v[206:207], v9 offset:41472
  s_waitcnt vmcnt(11) lgkmcnt(8)
  v_mfma_f32_16x16x32_bf16 v[96:99], v[176:179], v[40:43], v[96:99]
  ds_read_b64_tr_b16 v[208:209], v6 offset:45056
  v_mfma_f32_16x16x32_bf16 v[100:103], v[176:179], v[44:47], v[100:103]
  buffer_load_dwordx4 v[92:95], off, s[64:67], s51 offset:1024
  v_mfma_f32_16x16x32_bf16 v[108:111], v[180:183], v[44:47], v[108:111]
  ds_read_b64_tr_b16 v[210:211], v6 offset:45568
  ds_read_b64_tr_b16 v[212:213], v7 offset:45056
  v_mfma_f32_16x16x32_bf16 v[104:107], v[180:183], v[40:43], v[104:107]
  ds_read_b64_tr_b16 v[214:215], v7 offset:45568
  v_mfma_f32_16x16x32_bf16 v[112:115], v[184:187], v[40:43], v[112:115]
  ds_read_b64_tr_b16 v[216:217], v8 offset:45056
  v_mfma_f32_16x16x32_bf16 v[116:119], v[184:187], v[44:47], v[116:119]
  ds_read_b64_tr_b16 v[218:219], v8 offset:45568
  v_readlane_b32 s48, v15, 12
  v_mfma_f32_16x16x32_bf16 v[124:127], v[188:191], v[44:47], v[124:127]
  ds_read_b64_tr_b16 v[220:221], v9 offset:45056
  v_mfma_f32_16x16x32_bf16 v[120:123], v[188:191], v[40:43], v[120:123]
  ds_read_b64_tr_b16 v[222:223], v9 offset:45568
  s_waitcnt vmcnt(10) lgkmcnt(8)
  v_mfma_f32_16x16x32_bf16 v[96:99], v[192:195], v[48:51], v[96:99]
  buffer_load_dwordx4 v[32:35], off, s[36:39], s48 offset:0
  v_mfma_f32_16x16x32_bf16 v[100:103], v[192:195], v[52:55], v[100:103]
  ds_read_b64_tr_b16 v[160:161], v6 offset:49152
  ds_read_b64_tr_b16 v[162:163], v6 offset:49664
  v_mfma_f32_16x16x32_bf16 v[108:111], v[196:199], v[52:55], v[108:111]
  ds_read_b64_tr_b16 v[164:165], v7 offset:49152
  v_mfma_f32_16x16x32_bf16 v[104:107], v[196:199], v[48:51], v[104:107]
  buffer_load_dwordx4 v[36:39], off, s[64:67], s48 offset:0
  v_mfma_f32_16x16x32_bf16 v[112:115], v[200:203], v[48:51], v[112:115]
  ds_read_b64_tr_b16 v[166:167], v7 offset:49664
  ds_read_b64_tr_b16 v[168:169], v8 offset:49152
  v_mfma_f32_16x16x32_bf16 v[116:119], v[200:203], v[52:55], v[116:119]
  ds_read_b64_tr_b16 v[170:171], v8 offset:49664
  ds_read_b64_tr_b16 v[172:173], v9 offset:49152
  v_mfma_f32_16x16x32_bf16 v[124:127], v[204:207], v[52:55], v[124:127]
  buffer_load_dwordx4 v[40:43], off, s[36:39], s48 offset:1024
  v_mfma_f32_16x16x32_bf16 v[120:123], v[204:207], v[48:51], v[120:123]
  ds_read_b64_tr_b16 v[174:175], v9 offset:49664
  s_waitcnt vmcnt(11) lgkmcnt(8)
  v_mfma_f32_16x16x32_bf16 v[96:99], v[208:211], v[56:59], v[96:99]
  ds_read_b64_tr_b16 v[176:177], v6 offset:53248
  v_mfma_f32_16x16x32_bf16 v[100:103], v[208:211], v[60:63], v[100:103]
  buffer_load_dwordx4 v[44:47], off, s[64:67], s48 offset:1024
  v_mfma_f32_16x16x32_bf16 v[108:111], v[212:215], v[60:63], v[108:111]
  ds_read_b64_tr_b16 v[178:179], v6 offset:53760
  ds_read_b64_tr_b16 v[180:181], v7 offset:53248
  v_mfma_f32_16x16x32_bf16 v[104:107], v[212:215], v[56:59], v[104:107]
  ds_read_b64_tr_b16 v[182:183], v7 offset:53760
  v_mfma_f32_16x16x32_bf16 v[112:115], v[216:219], v[56:59], v[112:115]
  ds_read_b64_tr_b16 v[184:185], v8 offset:53248
  v_mfma_f32_16x16x32_bf16 v[116:119], v[216:219], v[60:63], v[116:119]
  ds_read_b64_tr_b16 v[186:187], v8 offset:53760
  v_readlane_b32 s49, v15, 13
  v_mfma_f32_16x16x32_bf16 v[124:127], v[220:223], v[60:63], v[124:127]
  ds_read_b64_tr_b16 v[188:189], v9 offset:53248
  v_mfma_f32_16x16x32_bf16 v[120:123], v[220:223], v[56:59], v[120:123]
  ds_read_b64_tr_b16 v[190:191], v9 offset:53760
  s_waitcnt vmcnt(10) lgkmcnt(8)
  v_mfma_f32_16x16x32_bf16 v[96:99], v[160:163], v[64:67], v[96:99]
  buffer_load_dwordx4 v[48:51], off, s[36:39], s49 offset:0
  v_mfma_f32_16x16x32_bf16 v[100:103], v[160:163], v[68:71], v[100:103]
  ds_read_b64_tr_b16 v[192:193], v6 offset:57344
  ds_read_b64_tr_b16 v[194:195], v6 offset:57856
  v_mfma_f32_16x16x32_bf16 v[108:111], v[164:167], v[68:71], v[108:111]
  ds_read_b64_tr_b16 v[196:197], v7 offset:57344
  v_mfma_f32_16x16x32_bf16 v[104:107], v[164:167], v[64:67], v[104:107]
  buffer_load_dwordx4 v[52:55], off, s[64:67], s49 offset:0
  v_mfma_f32_16x16x32_bf16 v[112:115], v[168:171], v[64:67], v[112:115]
  ds_read_b64_tr_b16 v[198:199], v7 offset:57856
  ds_read_b64_tr_b16 v[200:201], v8 offset:57344
  v_mfma_f32_16x16x32_bf16 v[116:119], v[168:171], v[68:71], v[116:119]
  ds_read_b64_tr_b16 v[202:203], v8 offset:57856
  ds_read_b64_tr_b16 v[204:205], v9 offset:57344
  v_mfma_f32_16x16x32_bf16 v[124:127], v[172:175], v[68:71], v[124:127]
  buffer_load_dwordx4 v[56:59], off, s[36:39], s49 offset:1024
  v_mfma_f32_16x16x32_bf16 v[120:123], v[172:175], v[64:67], v[120:123]
  ds_read_b64_tr_b16 v[206:207], v9 offset:57856
  s_waitcnt vmcnt(11) lgkmcnt(8)
  v_mfma_f32_16x16x32_bf16 v[96:99], v[176:179], v[72:75], v[96:99]
  ds_read_b64_tr_b16 v[208:209], v6 offset:61440
  v_mfma_f32_16x16x32_bf16 v[100:103], v[176:179], v[76:79], v[100:103]
  buffer_load_dwordx4 v[60:63], off, s[64:67], s49 offset:1024
  v_mfma_f32_16x16x32_bf16 v[108:111], v[180:183], v[76:79], v[108:111]
  ds_read_b64_tr_b16 v[210:211], v6 offset:61952
  ds_read_b64_tr_b16 v[212:213], v7 offset:61440
  v_mfma_f32_16x16x32_bf16 v[104:107], v[180:183], v[72:75], v[104:107]
  ds_read_b64_tr_b16 v[214:215], v7 offset:61952
  v_mfma_f32_16x16x32_bf16 v[112:115], v[184:187], v[72:75], v[112:115]
  ds_read_b64_tr_b16 v[216:217], v8 offset:61440
  v_mfma_f32_16x16x32_bf16 v[116:119], v[184:187], v[76:79], v[116:119]
  ds_read_b64_tr_b16 v[218:219], v8 offset:61952
  v_readlane_b32 s50, v15, 14
  v_mfma_f32_16x16x32_bf16 v[124:127], v[188:191], v[76:79], v[124:127]
  ds_read_b64_tr_b16 v[220:221], v9 offset:61440
  v_mfma_f32_16x16x32_bf16 v[120:123], v[188:191], v[72:75], v[120:123]
  ds_read_b64_tr_b16 v[222:223], v9 offset:61952
  s_waitcnt vmcnt(10) lgkmcnt(8)
  v_mfma_f32_16x16x32_bf16 v[96:99], v[192:195], v[80:83], v[96:99]
  buffer_load_dwordx4 v[64:67], off, s[36:39], s50 offset:0
  v_mfma_f32_16x16x32_bf16 v[100:103], v[192:195], v[84:87], v[100:103]
  ds_read_b64_tr_b16 v[160:161], v20 offset:0
  ds_read_b64_tr_b16 v[162:163], v20 offset:512
  v_mfma_f32_16x16x32_bf16 v[108:111], v[196:199], v[84:87], v[108:111]
  ds_read_b64_tr_b16 v[164:165], v21 offset:0
  v_mfma_f32_16x16x32_bf16 v[104:107], v[196:199], v[80:83], v[104:107]
  buffer_load_dwordx4 v[68:71], off, s[64:67], s50 offset:0
  v_mfma_f32_16x16x32_bf16 v[112:115], v[200:203], v[80:83], v[112:115]
  ds_read_b64_tr_b16 v[166:167], v21 offset:512
  ds_read_b64_tr_b16 v[168:169], v22 offset:0
  v_mfma_f32_16x16x32_bf16 v[116:119], v[200:203], v[84:87], v[116:119]
  ds_read_b64_tr_b16 v[170:171], v22 offset:512
  ds_read_b64_tr_b16 v[172:173], v23 offset:0
  v_mfma_f32_16x16x32_bf16 v[124:127], v[204:207], v[84:87], v[124:127]
  buffer_load_dwordx4 v[72:75], off, s[36:39], s50 offset:1024
  v_mfma_f32_16x16x32_bf16 v[120:123], v[204:207], v[80:83], v[120:123]
  ds_read_b64_tr_b16 v[174:175], v23 offset:512
  s_waitcnt vmcnt(11) lgkmcnt(8)
  v_mfma_f32_16x16x32_bf16 v[96:99], v[208:211], v[88:91], v[96:99]
  ds_read_b64_tr_b16 v[176:177], v20 offset:4096
  v_mfma_f32_16x16x32_bf16 v[100:103], v[208:211], v[92:95], v[100:103]
  buffer_load_dwordx4 v[76:79], off, s[64:67], s50 offset:1024
  v_mfma_f32_16x16x32_bf16 v[108:111], v[212:215], v[92:95], v[108:111]
  ds_read_b64_tr_b16 v[178:179], v20 offset:4608
  ds_read_b64_tr_b16 v[180:181], v21 offset:4096
  v_mfma_f32_16x16x32_bf16 v[104:107], v[212:215], v[88:91], v[104:107]
  ds_read_b64_tr_b16 v[182:183], v21 offset:4608
  v_mfma_f32_16x16x32_bf16 v[112:115], v[216:219], v[88:91], v[112:115]
  ds_read_b64_tr_b16 v[184:185], v22 offset:4096
  v_mfma_f32_16x16x32_bf16 v[116:119], v[216:219], v[92:95], v[116:119]
  ds_read_b64_tr_b16 v[186:187], v22 offset:4608
  v_readlane_b32 s51, v15, 15
  v_mfma_f32_16x16x32_bf16 v[124:127], v[220:223], v[92:95], v[124:127]
  ds_read_b64_tr_b16 v[188:189], v23 offset:4096
  v_mfma_f32_16x16x32_bf16 v[120:123], v[220:223], v[88:91], v[120:123]
  ds_read_b64_tr_b16 v[190:191], v23 offset:4608
  s_waitcnt vmcnt(10) lgkmcnt(8)
  v_mfma_f32_16x16x32_bf16 v[96:99], v[160:163], v[32:35], v[96:99]
  buffer_load_dwordx4 v[80:83], off, s[36:39], s51 offset:0
  v_mfma_f32_16x16x32_bf16 v[100:103], v[160:163], v[36:39], v[100:103]
  ds_read_b64_tr_b16 v[192:193], v20 offset:8192
  ds_read_b64_tr_b16 v[194:195], v20 offset:8704
  v_mfma_f32_16x16x32_bf16 v[108:111], v[164:167], v[36:39], v[108:111]
  ds_read_b64_tr_b16 v[196:197], v21 offset:8192
  v_mfma_f32_16x16x32_bf16 v[104:107], v[164:167], v[32:35], v[104:107]
  buffer_load_dwordx4 v[84:87], off, s[64:67], s51 offset:0
  v_mfma_f32_16x16x32_bf16 v[112:115], v[168:171], v[32:35], v[112:115]
  ds_read_b64_tr_b16 v[198:199], v21 offset:8704
  ds_read_b64_tr_b16 v[200:201], v22 offset:8192
  v_mfma_f32_16x16x32_bf16 v[116:119], v[168:171], v[36:39], v[116:119]
  ds_read_b64_tr_b16 v[202:203], v22 offset:8704
  ds_read_b64_tr_b16 v[204:205], v23 offset:8192
  v_mfma_f32_16x16x32_bf16 v[124:127], v[172:175], v[36:39], v[124:127]
  buffer_load_dwordx4 v[88:91], off, s[36:39], s51 offset:1024
  v_mfma_f32_16x16x32_bf16 v[120:123], v[172:175], v[32:35], v[120:123]
  ds_read_b64_tr_b16 v[206:207], v23 offset:8704
  s_waitcnt vmcnt(11) lgkmcnt(8)
  s_barrier
  v_mfma_f32_16x16x32_bf16 v[96:99], v[176:179], v[40:43], v[96:99]
  ds_read_b64_tr_b16 v[208:209], v20 offset:12288
  v_mfma_f32_16x16x32_bf16 v[100:103], v[176:179], v[44:47], v[100:103]
  buffer_load_dwordx4 v[92:95], off, s[64:67], s51 offset:1024
  v_mfma_f32_16x16x32_bf16 v[108:111], v[180:183], v[44:47], v[108:111]
  ds_read_b64_tr_b16 v[210:211], v20 offset:12800
  ds_read_b64_tr_b16 v[212:213], v21 offset:12288
  v_mfma_f32_16x16x32_bf16 v[104:107], v[180:183], v[40:43], v[104:107]
  ds_read_b64_tr_b16 v[214:215], v21 offset:12800
  v_mfma_f32_16x16x32_bf16 v[112:115], v[184:187], v[40:43], v[112:115]
  ds_read_b64_tr_b16 v[216:217], v22 offset:12288
  v_mfma_f32_16x16x32_bf16 v[116:119], v[184:187], v[44:47], v[116:119]
  ds_read_b64_tr_b16 v[218:219], v22 offset:12800
  v_mfma_f32_16x16x32_bf16 v[124:127], v[188:191], v[44:47], v[124:127]
  ds_read_b64_tr_b16 v[220:221], v23 offset:12288
  v_mfma_f32_16x16x32_bf16 v[120:123], v[188:191], v[40:43], v[120:123]
  ds_read_b64_tr_b16 v[222:223], v23 offset:12800
  s_waitcnt vmcnt(10) lgkmcnt(8)
  v_mfma_f32_16x16x32_bf16 v[96:99], v[192:195], v[48:51], v[96:99]
  ds_read_b64_tr_b16 v[160:161], v20 offset:16384
  v_mfma_f32_16x16x32_bf16 v[100:103], v[192:195], v[52:55], v[100:103]
  ds_read_b64_tr_b16 v[162:163], v20 offset:16896
  v_mfma_f32_16x16x32_bf16 v[108:111], v[196:199], v[52:55], v[108:111]
  ds_read_b64_tr_b16 v[164:165], v21 offset:16384
  v_mfma_f32_16x16x32_bf16 v[104:107], v[196:199], v[48:51], v[104:107]
  ds_read_b64_tr_b16 v[166:167], v21 offset:16896
  v_mfma_f32_16x16x32_bf16 v[112:115], v[200:203], v[48:51], v[112:115]
  ds_read_b64_tr_b16 v[168:169], v22 offset:16384
  v_mfma_f32_16x16x32_bf16 v[116:119], v[200:203], v[52:55], v[116:119]
  ds_read_b64_tr_b16 v[170:171], v22 offset:16896
  v_mfma_f32_16x16x32_bf16 v[124:127], v[204:207], v[52:55], v[124:127]
  ds_read_b64_tr_b16 v[172:173], v23 offset:16384
  v_mfma_f32_16x16x32_bf16 v[120:123], v[204:207], v[48:51], v[120:123]
  ds_read_b64_tr_b16 v[174:175], v23 offset:16896
  s_waitcnt vmcnt(8) lgkmcnt(8)
  v_mfma_f32_16x16x32_bf16 v[96:99], v[208:211], v[56:59], v[96:99]
  ds_read_b64_tr_b16 v[176:177], v20 offset:20480
  v_mfma_f32_16x16x32_bf16 v[100:103], v[208:211], v[60:63], v[100:103]
  ds_read_b64_tr_b16 v[178:179], v20 offset:20992
  v_mfma_f32_16x16x32_bf16 v[108:111], v[212:215], v[60:63], v[108:111]
  ds_read_b64_tr_b16 v[180:181], v21 offset:20480
  v_mfma_f32_16x16x32_bf16 v[104:107], v[212:215], v[56:59], v[104:107]
  ds_read_b64_tr_b16 v[182:183], v21 offset:20992
  v_mfma_f32_16x16x32_bf16 v[112:115], v[216:219], v[56:59], v[112:115]
  ds_read_b64_tr_b16 v[184:185], v22 offset:20480
  v_mfma_f32_16x16x32_bf16 v[116:119], v[216:219], v[60:63], v[116:119]
  ds_read_b64_tr_b16 v[186:187], v22 offset:20992
  v_mfma_f32_16x16x32_bf16 v[124:127], v[220:223], v[60:63], v[124:127]
  ds_read_b64_tr_b16 v[188:189], v23 offset:20480
  v_mfma_f32_16x16x32_bf16 v[120:123], v[220:223], v[56:59], v[120:123]
  ds_read_b64_tr_b16 v[190:191], v23 offset:20992
  s_waitcnt vmcnt(6) lgkmcnt(8)
  v_mfma_f32_16x16x32_bf16 v[96:99], v[160:163], v[64:67], v[96:99]
  ds_read_b64_tr_b16 v[192:193], v20 offset:24576
  v_mfma_f32_16x16x32_bf16 v[100:103], v[160:163], v[68:71], v[100:103]
  ds_read_b64_tr_b16 v[194:195], v20 offset:25088
  v_mfma_f32_16x16x32_bf16 v[108:111], v[164:167], v[68:71], v[108:111]
  ds_read_b64_tr_b16 v[196:197], v21 offset:24576
  v_mfma_f32_16x16x32_bf16 v[104:107], v[164:167], v[64:67], v[104:107]
  ds_read_b64_tr_b16 v[198:199], v21 offset:25088
  v_mfma_f32_16x16x32_bf16 v[112:115], v[168:171], v[64:67], v[112:115]
  ds_read_b64_tr_b16 v[200:201], v22 offset:24576
  v_mfma_f32_16x16x32_bf16 v[116:119], v[168:171], v[68:71], v[116:119]
  ds_read_b64_tr_b16 v[202:203], v22 offset:25088
  v_mfma_f32_16x16x32_bf16 v[124:127], v[172:175], v[68:71], v[124:127]
  ds_read_b64_tr_b16 v[204:205], v23 offset:24576
  v_mfma_f32_16x16x32_bf16 v[120:123], v[172:175], v[64:67], v[120:123]
  ds_read_b64_tr_b16 v[206:207], v23 offset:25088
  s_waitcnt vmcnt(4) lgkmcnt(8)
  v_mfma_f32_16x16x32_bf16 v[96:99], v[176:179], v[72:75], v[96:99]
  ds_read_b64_tr_b16 v[208:209], v20 offset:28672
  v_mfma_f32_16x16x32_bf16 v[100:103], v[176:179], v[76:79], v[100:103]
  ds_read_b64_tr_b16 v[210:211], v20 offset:29184
  v_mfma_f32_16x16x32_bf16 v[108:111], v[180:183], v[76:79], v[108:111]
  ds_read_b64_tr_b16 v[212:213], v21 offset:28672
  v_mfma_f32_16x16x32_bf16 v[104:107], v[180:183], v[72:75], v[104:107]
  ds_read_b64_tr_b16 v[214:215], v21 offset:29184
  v_mfma_f32_16x16x32_bf16 v[112:115], v[184:187], v[72:75], v[112:115]
  ds_read_b64_tr_b16 v[216:217], v22 offset:28672
  v_mfma_f32_16x16x32_bf16 v[116:119], v[184:187], v[76:79], v[116:119]
  ds_read_b64_tr_b16 v[218:219], v22 offset:29184
  v_mfma_f32_16x16x32_bf16 v[124:127], v[188:191], v[76:79], v[124:127]
  ds_read_b64_tr_b16 v[220:221], v23 offset:28672
  v_mfma_f32_16x16x32_bf16 v[120:123], v[188:191], v[72:75], v[120:123]
  ds_read_b64_tr_b16 v[222:223], v23 offset:29184
  s_waitcnt vmcnt(2) lgkmcnt(8)
  v_mfma_f32_16x16x32_bf16 v[96:99], v[192:195], v[80:83], v[96:99]
  v_mov_b32 v20, 0
  v_mov_b32 v21, 0
  v_mfma_f32_16x16x32_bf16 v[100:103], v[192:195], v[84:87], v[100:103]
  v_mov_b32 v22, 0
  v_mov_b32 v23, 0
  v_mfma_f32_16x16x32_bf16 v[108:111], v[196:199], v[84:87], v[108:111]
  v_mfma_f32_16x16x32_bf16 v[104:107], v[196:199], v[80:83], v[104:107]
  v_mfma_f32_16x16x32_bf16 v[112:115], v[200:203], v[80:83], v[112:115]
  v_mfma_f32_16x16x32_bf16 v[116:119], v[200:203], v[84:87], v[116:119]
  v_mfma_f32_16x16x32_bf16 v[124:127], v[204:207], v[84:87], v[124:127]
  v_mfma_f32_16x16x32_bf16 v[120:123], v[204:207], v[80:83], v[120:123]
  s_waitcnt vmcnt(0) lgkmcnt(0)
  v_mfma_f32_16x16x32_bf16 v[96:99], v[208:211], v[88:91], v[96:99]
  v_mfma_f32_16x16x32_bf16 v[100:103], v[208:211], v[92:95], v[100:103]
  v_mfma_f32_16x16x32_bf16 v[108:111], v[212:215], v[92:95], v[108:111]
  v_mfma_f32_16x16x32_bf16 v[104:107], v[212:215], v[88:91], v[104:107]
  v_mfma_f32_16x16x32_bf16 v[112:115], v[216:219], v[88:91], v[112:115]
  v_mfma_f32_16x16x32_bf16 v[116:119], v[216:219], v[92:95], v[116:119]
  v_mfma_f32_16x16x32_bf16 v[124:127], v[220:223], v[92:95], v[124:127]
  v_mfma_f32_16x16x32_bf16 v[120:123], v[220:223], v[88:91], v[120:123]
  s_mov_b32 s3, 32768
  s_mov_b32 s10, 0x3f803f80
  s_nop 4
  v_cvt_pk_bf16_f32 v240, v96, v97
  v_cvt_pk_bf16_f32 v241, v98, v99
  v_cvt_pk_bf16_f32 v242, v104, v105
  v_cvt_pk_bf16_f32 v243, v106, v107
  s_nop 1
  v_permlane16_swap_b32 v240, v242
  v_permlane16_swap_b32 v241, v243
  buffer_store_dwordx4 v[240:243], v12, s[44:47], 0 offen offset:0 sc1
  v_cvt_pk_bf16_f32 v244, v112, v113
  v_cvt_pk_bf16_f32 v245, v114, v115
  v_cvt_pk_bf16_f32 v246, v120, v121
  v_cvt_pk_bf16_f32 v247, v122, v123
  s_nop 1
  v_permlane16_swap_b32 v244, v246
  v_permlane16_swap_b32 v245, v247
  buffer_store_dwordx4 v[244:247], v12, s[44:47], 0 offen offset:1024 sc1
  v_cvt_pk_bf16_f32 v248, v100, v101
  v_cvt_pk_bf16_f32 v249, v102, v103
  v_cvt_pk_bf16_f32 v250, v108, v109
  v_cvt_pk_bf16_f32 v251, v110, v111
  s_nop 1
  v_permlane16_swap_b32 v248, v250
  v_permlane16_swap_b32 v249, v251
  buffer_store_dwordx4 v[248:251], v12, s[44:47], s3 offen offset:0 sc1
  v_cvt_pk_bf16_f32 v252, v116, v117
  v_cvt_pk_bf16_f32 v253, v118, v119
  v_cvt_pk_bf16_f32 v254, v124, v125
  v_cvt_pk_bf16_f32 v255, v126, v127
  s_nop 1
  v_permlane16_swap_b32 v252, v254
  v_permlane16_swap_b32 v253, v255
  buffer_store_dwordx4 v[252:255], v12, s[44:47], s3 offen offset:1024 sc1
  v_dot2_f32_bf16 v20, v240, s10, v20
  v_dot2_f32_bf16 v22, v240, v240, v22
  v_dot2_f32_bf16 v20, v241, s10, v20
  v_dot2_f32_bf16 v22, v241, v241, v22
  v_dot2_f32_bf16 v20, v242, s10, v20
  v_dot2_f32_bf16 v22, v242, v242, v22
  v_dot2_f32_bf16 v20, v243, s10, v20
  v_dot2_f32_bf16 v22, v243, v243, v22
  v_dot2_f32_bf16 v20, v244, s10, v20
  v_dot2_f32_bf16 v22, v244, v244, v22
  v_dot2_f32_bf16 v20, v245, s10, v20
  v_dot2_f32_bf16 v22, v245, v245, v22
  v_dot2_f32_bf16 v20, v246, s10, v20
  v_dot2_f32_bf16 v22, v246, v246, v22
  v_dot2_f32_bf16 v20, v247, s10, v20
  v_dot2_f32_bf16 v22, v247, v247, v22
  v_dot2_f32_bf16 v21, v248, s10, v21
  v_dot2_f32_bf16 v23, v248, v248, v23
  v_dot2_f32_bf16 v21, v249, s10, v21
  v_dot2_f32_bf16 v23, v249, v249, v23
  v_dot2_f32_bf16 v21, v250, s10, v21
  v_dot2_f32_bf16 v23, v250, v250, v23
  v_dot2_f32_bf16 v21, v251, s10, v21
  v_dot2_f32_bf16 v23, v251, v251, v23
  v_dot2_f32_bf16 v21, v252, s10, v21
  v_dot2_f32_bf16 v23, v252, v252, v23
  v_dot2_f32_bf16 v21, v253, s10, v21
  v_dot2_f32_bf16 v23, v253, v253, v23
  v_dot2_f32_bf16 v21, v254, s10, v21
  v_dot2_f32_bf16 v23, v254, v254, v23
  v_dot2_f32_bf16 v21, v255, s10, v21
  v_dot2_f32_bf16 v23, v255, v255, v23
  s_nop 2
  v_permlane32_swap_b32 v20, v21
  v_permlane32_swap_b32 v22, v23
  v_add_f32 v20, v20, v21
  v_add_f32 v22, v22, v23
  s_nop 1
  v_permlane16_swap_b32 v20, v22
  v_add_f32 v20, v20, v22
  buffer_store_dword v20, v18, s[56:59], 0 offen sc1
  s_waitcnt vmcnt(0) lgkmcnt(0)
  s_barrier
  s_add_u32 s97, s97, 1
  s_branch L_w1_body
L_wo_c1:
L_w1_c0:
L_w1_body:
  s_cmp_ge_u32 s2, 256
  s_cbranch_scc1 L_w1_end
  v_lshrrev_b32 v2, 6, v0
  v_and_b32 v1, 63, v0
  v_readfirstlane_b32 s70, v2
  s_and_b32 s3, s2, 7
  s_lshr_b32 s99, s2, 3
  s_and_b32 s5, s3, 1
  s_lshl_b32 s5, s5, 3
  s_and_b32 s6, s99, 7
  s_add_u32 s68, s5, s6
  s_lshr_b32 s5, s3, 1
  s_lshl_b32 s5, s5, 2
  s_lshr_b32 s6, s99, 3
  s_add_u32 s69, s5, s6
  s_cmp_lt_u32 s70, 4
  s_cbranch_scc1 L_w1_compute
L_w1_loader:
  s_add_u32 s8, s70, s69
  s_and_b32 s8, s8, 3
  s_add_u32 s9, s70, s68
  s_and_b32 s9, s9, 3
  s_lshl_b32 s76, s8, 12
  s_lshl_b32 s77, s9, 11
  s_add_u32 s77, s77, 16384
  s_lshl_b32 s11, s68, 7
  v_and_b32 v10, 7, v1
  s_lshr_b32 s10, s76, 11
  s_lshl_b32 s3, s68, 3
  s_add_u32 s10, s10, s3
  s_mul_i32 s10, s10, 32768
  v_lshl_add_u32 v4, v1, 4, s10
  v_add_u32 v5, 32768, v4
  v_lshrrev_b32 v3, 3, v1
  s_lshl_b32 s10, s9, 4
  v_add_u32 v3, s10, v3
  v_mul_u32_u24 v3, 7168, v3
  v_lshrrev_b32 v2, 3, v1
  v_and_b32 v2, 2, v2
  v_xor_b32 v2, v2, v10
  s_mul_i32 s10, s69, 128
  v_add_u32 v3, s10, v3
  v_lshl_add_u32 v8, v2, 4, v3
  v_xor_b32 v2, 4, v2
  v_add_u32 v3, 57344, v3
  v_lshl_add_u32 v9, v2, 4, v3
  v_lshrrev_b32 v3, 2, v1
  s_lshl_b32 s10, s9, 4
  v_add_u32 v3, s10, v3
  v_mul_u32_u24 v3, 7168, v3
  v_lshrrev_b32 v2, 4, v1
  v_and_b32 v2, 2, v2
  v_xor_b32 v2, v2, v1
  v_and_b32 v2, 3, v2
  s_lshl_b32 s10, s69, 6
  s_add_u32 s10, s10, 2048
  v_add_u32 v3, s10, v3
  v_lshl_add_u32 v28, v2, 4, v3
  s_lshl_b32 s78, s69, 7
  s_add_u32 s78, s78, 3072
  s_mov_b32 s75, 0
  s_add_u32 s100, s68, s69
  s_mov_b32 s101, -1
  s_add_u32 s101, s101, 1
  s_sub_u32 s73, s101, s100
  s_lshl_b32 s73, s73, 3
  s_lshr_b32 s73, 0xf0f02, s73
  s_and_b32 s73, s73, 255
  s_add_u32 s73, s73, s101
  s_and_b32 s73, s73, 15
  s_mul_i32 s74, s73, 458752
  s_lshl_b32 s73, s73, 11
  s_waitcnt lgkmcnt(0)
  s_add_u32 s36, s34, 4194304
  s_addc_u32 s37, s35, 0
  s_and_b32 s37, s37, 0xffff
  s_mov_b32 s38, 4194304
  s_mov_b32 s39, 0x00020000
  s_mov_b32 s40, s24
  s_and_b32 s41, s25, 0xffff
  s_mov_b32 s42, 7340032
  s_mov_b32 s43, 0x00020000
  s_add_u32 s56, s34, 24117248
  s_addc_u32 s57, s35, 0
  s_and_b32 s57, s57, 0xffff
  s_mov_b32 s58, 262144
  s_mov_b32 s59, 0x00020000
  s_add_u32 s64, s22, 24641536
  s_addc_u32 s65, s23, 0
  s_and_b32 s65, s65, 0xffff
  s_mov_b32 s66, 262144
  s_mov_b32 s67, 0x00020000
  s_mov_b32 s52, s26
  s_and_b32 s53, s27, 0xffff
  s_mov_b32 s54, 7168
  s_mov_b32 s55, 0x00020000
  s_mov_b32 s60, s28
  s_and_b32 s61, s29, 0xffff
  s_mov_b32 s62, 7340032
  s_mov_b32 s63, 0x00020000
  s_cmp_eq_u32 s96, 0
  s_cselect_b32 s62, s62, 0
  s_and_b32 s3, s70, 3
  s_lshl_b32 s4, s2, 2
  s_add_u32 s3, s3, s4
  s_mul_i32 s98, s3, 3584
  s_add_u32 s98, s98, 3670016
  s_add_u32 s3, s96, s70
  s_cmp_lg_u32 s3, 4
  s_cbranch_scc1 L_w1_chkNone
  s_add_u32 s44, s22, 41943040
  s_addc_u32 s45, s23, 0
  s_and_b32 s45, s45, 0xffff
  s_mov_b32 s46, 524288
  s_mov_b32 s47, 0x00020000
  v_lshrrev_b32 v2, 2, v1
  v_and_b32 v3, 3, v1
  v_lshlrev_b32 v2, 11, v2
  v_lshl_add_u32 v17, v3, 4, v2
  s_and_b32 s3, s69, 15
  s_lshl_b32 s3, s3, 7
  s_mov_b32 s79, 0x100000
L_w1_chkl:
  buffer_load_dwordx4 v[12:15], v17, s[44:47], s3 offen sc1
  s_sub_u32 s79, s79, 1
  s_cbranch_scc1 L_w1_chkNone
  s_waitcnt vmcnt(0)
  v_and_b32 v12, v12, v13
  v_and_b32 v14, v14, v15
  v_and_b32 v12, v12, v14
  v_cmp_ne_u32 vcc, 1, v12
  s_cbranch_vccnz L_w1_chkl
L_w1_chkNone:
  s_mov_b32 s75, 98304
  s_add_u32 s44, s22, 41943040
  s_addc_u32 s45, s23, 0
  s_and_b32 s45, s45, 0xffff
  s_mov_b32 s46, 524288
  s_mov_b32 s47, 0x00020000
  s_lshl4_add_u32 s3, s97, s68
  s_and_b32 s4, s69, 15
  s_lshl4_add_u32 s3, s3, s4
  s_lshl_b32 s3, s3, 7
  s_sub_u32 s3, s3, 32768
  v_lshlrev_b32 v11, 7, v1
  v_and_b32 v2, 15, v1
  v_lshlrev_b32 v2, 2, v2
  v_mov_b32 v3, 1
  s_mov_b32 s79, 0x100000
  s_cmp_lg_u32 s70, 4
  s_barrier
  s_cbranch_scc1 L_w1_nofl
  s_mov_b32 exec_lo, 0xffff
  s_mov_b32 exec_hi, 0
  buffer_store_dword v3, v11, s[44:47], s87 offen sc1
  s_mov_b64 exec, -1
L_w1_nofl:
  s_mov_b32 s5, s3
  s_mov_b32 s88, s73
  s_add_u32 m0, s77, 0
  s_add_u32 s4, s74, 0
  buffer_load_dwordx4 v8, s[40:43], s4 offen lds
  s_add_u32 m0, s77, 1024
  s_nop 0
  buffer_load_dwordx4 v9, s[40:43], s4 offen lds
  s_add_u32 m0, s77, 8192
  s_add_u32 s4, s74, s78
  buffer_load_dwordx4 v8, s[40:43], s4 offen lds
  s_add_u32 m0, s77, 9216
  s_nop 0
  buffer_load_dwordx4 v9, s[40:43], s4 offen lds
  s_add_u32 m0, s77, 16384
  s_add_u32 s4, s4, 128
  buffer_load_dwordx4 v8, s[40:43], s4 offen lds
  s_add_u32 m0, s77, 17408
  s_nop 0
  buffer_load_dwordx4 v9, s[40:43], s4 offen lds
  s_add_u32 m0, s77, 24576
  s_nop 0
  buffer_load_dwordx4 v28, s[40:43], s74 offen lds
  s_add_u32 s101, s101, 1
  s_sub_u32 s73, s101, s100
  s_lshl_b32 s73, s73, 3
  s_lshr_b32 s73, 0xf0f02, s73
  s_and_b32 s73, s73, 255
  s_add_u32 s73, s73, s101
  s_and_b32 s73, s73, 15
  s_mul_i32 s74, s73, 458752
  s_lshl_b32 s73, s73, 11
  s_mov_b32 s89, s73
  s_add_u32 m0, s77, 49152
  s_add_u32 s4, s74, 0
  buffer_load_dwordx4 v8, s[40:43], s4 offen lds
  s_add_u32 m0, s77, 50176
  s_nop 0
  buffer_load_dwordx4 v9, s[40:43], s4 offen lds
  s_add_u32 m0, s77, 57344
  s_add_u32 s4, s74, s78
  buffer_load_dwordx4 v8, s[40:43], s4 offen lds
  s_add_u32 m0, s77, 58368
  s_nop 0
  buffer_load_dwordx4 v9, s[40:43], s4 offen lds
  s_add_u32 m0, s77, 65536
  s_add_u32 s4, s4, 128
  buffer_load_dwordx4 v8, s[40:43], s4 offen lds
  s_add_u32 m0, s77, 66560
  s_nop 0
  buffer_load_dwordx4 v9, s[40:43], s4 offen lds
  s_add_u32 m0, s77, 73728
  s_nop 0
  buffer_load_dwordx4 v28, s[40:43], s74 offen lds
  s_add_u32 s101, s101, 1
  s_sub_u32 s73, s101, s100
  s_lshl_b32 s73, s73, 3
  s_lshr_b32 s73, 0xf0f02, s73
  s_and_b32 s73, s73, 255
  s_add_u32 s73, s73, s101
  s_and_b32 s73, s73, 15
  s_mul_i32 s74, s73, 458752
  s_lshl_b32 s73, s73, 11
  s_mov_b32 s3, s5
  s_cmp_lg_u32 s70, 4
  s_cbranch_scc1 L_w1_dep
L_w1_poll:
  buffer_load_dword v3, v2, s[44:47], s3 offen sc1
  s_sub_u32 s79, s79, 1
  s_cbranch_scc1 L_w1_dep
  s_waitcnt vmcnt(0)
  v_cmp_ne_u32 vcc, 1, v3
  s_cbranch_vccnz L_w1_poll
L_w1_dep:
  s_barrier
  s_add_u32 m0, s76, 0
  s_nop 0
  buffer_load_dwordx4 v4, s[36:39], s88 offen offset:0 lds
  buffer_load_dwordx4 v4, s[36:39], s88 offen offset:1024 lds
  s_add_u32 m0, s76, 2048
  s_nop 0
  buffer_load_dwordx4 v5, s[36:39], s88 offen offset:0 lds
  buffer_load_dwordx4 v5, s[36:39], s88 offen offset:1024 lds
  s_add_u32 m0, s76, 49152
  s_nop 0
  buffer_load_dwordx4 v4, s[36:39], s89 offen offset:0 lds
  buffer_load_dwordx4 v4, s[36:39], s89 offen offset:1024 lds
  s_add_u32 m0, s76, 51200
  s_nop 0
  buffer_load_dwordx4 v5, s[36:39], s89 offen offset:0 lds
  buffer_load_dwordx4 v5, s[36:39], s89 offen offset:1024 lds
  s_waitcnt vmcnt(4)
  s_barrier
  s_mov_b32 s79, 13
L_w1_ld1:
  s_add_u32 s3, s75, s76
  s_add_u32 m0, s3, 0
  s_nop 0
  buffer_load_dwordx4 v4, s[36:39], s73 offen offset:0 lds
  buffer_load_dwordx4 v4, s[36:39], s73 offen offset:1024 lds
  s_add_u32 m0, s3, 2048
  s_nop 0
  buffer_load_dwordx4 v5, s[36:39], s73 offen offset:0 lds
  buffer_load_dwordx4 v5, s[36:39], s73 offen offset:1024 lds
  s_add_u32 s3, s75, s77
  s_add_u32 m0, s3, 0
  s_add_u32 s4, s74, 0
  buffer_load_dwordx4 v8, s[40:43], s4 offen lds
  s_add_u32 m0, s3, 1024
  s_nop 0
  buffer_load_dwordx4 v9, s[40:43], s4 offen lds
  s_add_u32 m0, s3, 8192
  s_add_u32 s4, s74, s78
  buffer_load_dwordx4 v8, s[40:43], s4 offen lds
  s_add_u32 m0, s3, 9216
  s_nop 0
  buffer_load_dwordx4 v9, s[40:43], s4 offen lds
  s_add_u32 m0, s3, 16384
  s_add_u32 s4, s4, 128
  buffer_load_dwordx4 v8, s[40:43], s4 offen lds
  s_add_u32 m0, s3, 17408
  s_nop 0
  buffer_load_dwordx4 v9, s[40:43], s4 offen lds
  s_add_u32 m0, s3, 24576
  s_nop 0
  buffer_load_dwordx4 v28, s[40:43], s74 offen lds
  s_add_u32 s101, s101, 1
  s_sub_u32 s73, s101, s100
  s_lshl_b32 s73, s73, 3
  s_lshr_b32 s73, 0xf0f02, s73
  s_and_b32 s73, s73, 255
  s_add_u32 s73, s73, s101
  s_and_b32 s73, s73, 15
  s_mul_i32 s74, s73, 458752
  s_lshl_b32 s73, s73, 11
  s_add_u32 s75, s75, 49152
  s_cmp_eq_u32 s75, 147456
  s_cselect_b32 s75, 0, s75
  s_buffer_load_dword s84, s[60:63], s98 offset:0
  s_buffer_load_dword s84, s[60:63], s98 offset:64
  s_buffer_load_dword s84, s[60:63], s98 offset:128
  s_buffer_load_dword s84, s[60:63], s98 offset:192
  s_add_u32 s98, s98, 256
  s_waitcnt vmcnt(11)
  s_barrier
  s_sub_u32 s79, s79, 1
  s_cmp_lg_u32 s79, 0
  s_cbranch_scc1 L_w1_ld1
  s_add_u32 s3, s75, s76
  s_add_u32 m0, s3, 0
  s_nop 0
  buffer_load_dwordx4 v4, s[36:39], s73 offen offset:0 lds
  buffer_load_dwordx4 v4, s[36:39], s73 offen offset:1024 lds
  s_add_u32 m0, s3, 2048
  s_nop 0
  buffer_load_dwordx4 v5, s[36:39], s73 offen offset:0 lds
  buffer_load_dwordx4 v5, s[36:39], s73 offen offset:1024 lds
  s_add_u32 s3, s75, s77
  s_add_u32 m0, s3, 0
  s_add_u32 s4, s74, 0
  buffer_load_dwordx4 v8, s[40:43], s4 offen lds
  s_add_u32 m0, s3, 1024
  s_nop 0
  buffer_load_dwordx4 v9, s[40:43], s4 offen lds
  s_add_u32 m0, s3, 8192
  s_add_u32 s4, s74, s78
  buffer_load_dwordx4 v8, s[40:43], s4 offen lds
  s_add_u32 m0, s3, 9216
  s_nop 0
  buffer_load_dwordx4 v9, s[40:43], s4 offen lds
  s_add_u32 m0, s3, 16384
  s_add_u32 s4, s4, 128
  buffer_load_dwordx4 v8, s[40:43], s4 offen lds
  s_add_u32 m0, s3, 17408
  s_nop 0
  buffer_load_dwordx4 v9, s[40:43], s4 offen lds
  s_add_u32 m0, s3, 24576
  s_nop 0
  buffer_load_dwordx4 v28, s[40:43], s74 offen lds
  s_add_u32 s101, s101, 1
  s_sub_u32 s73, s101, s100
  s_lshl_b32 s73, s73, 3
  s_lshr_b32 s73, 0xf0f02, s73
  s_and_b32 s73, s73, 255
  s_add_u32 s73, s73, s101
  s_and_b32 s73, s73, 15
  s_mul_i32 s74, s73, 458752
  s_lshl_b32 s73, s73, 11
  s_add_u32 s75, s75, 49152
  s_cmp_eq_u32 s75, 147456
  s_cselect_b32 s75, 0, s75
  s_buffer_load_dword s84, s[60:63], s98 offset:0
  s_buffer_load_dword s84, s[60:63], s98 offset:64
  s_buffer_load_dword s84, s[60:63], s98 offset:128
  s_buffer_load_dword s84, s[60:63], s98 offset:192
  s_add_u32 s98, s98, 256
  s_and_b32 s3, s70, 3
  s_lshl_b32 s4, s68, 7
  s_lshl_b32 s5, s3, 6
  s_add_u32 s5, s5, s4
  v_add_u32 v2, s5, v1
  s_sub_u32 s4, s4, 16
  v_and_b32 v3, 15, v1
  v_add_u32 v3, s4, v3
  v_max_i32 v3, 0, v3
  s_cmp_ge_u32 s3, 2
  s_cselect_b64 vcc, -1, 0
  v_cndmask_b32 v2, v2, v3, vcc
  v_lshlrev_b32 v2, 3, v2
  s_mov_b32 s3, 0
  buffer_load_dwordx2 v[32:33], v2, s[56:59], s3 offen
  s_add_u32 s3, s3, 16384
  buffer_load_dwordx2 v[34:35], v2, s[56:59], s3 offen
  s_add_u32 s3, s3, 16384
  buffer_load_dwordx2 v[36:37], v2, s[56:59], s3 offen
  s_add_u32 s3, s3, 16384
  buffer_load_dwordx2 v[38:39], v2, s[56:59], s3 offen
  s_add_u32 s3, s3, 16384
  buffer_load_dwordx2 v[40:41], v2, s[56:59], s3 offen
  s_add_u32 s3, s3, 16384
  buffer_load_dwordx2 v[42:43], v2, s[56:59], s3 offen
  s_add_u32 s3, s3, 16384
  buffer_load_dwordx2 v[44:45], v2, s[56:59], s3 offen
  s_add_u32 s3, s3, 16384
  buffer_load_dwordx2 v[46:47], v2, s[56:59], s3 offen
  s_add_u32 s3, s3, 16384
  buffer_load_dwordx2 v[48:49], v2, s[56:59], s3 offen
  s_add_u32 s3, s3, 16384
  buffer_load_dwordx2 v[50:51], v2, s[56:59], s3 offen
  s_add_u32 s3, s3, 16384
  buffer_load_dwordx2 v[52:53], v2, s[56:59], s3 offen
  s_add_u32 s3, s3, 16384
  buffer_load_dwordx2 v[54:55], v2, s[56:59], s3 offen
  s_add_u32 s3, s3, 16384
  buffer_load_dwordx2 v[56:57], v2, s[56:59], s3 offen
  s_add_u32 s3, s3, 16384
  buffer_load_dwordx2 v[58:59], v2, s[56:59], s3 offen
  s_add_u32 s3, s3, 16384
  buffer_load_dwordx2 v[60:61], v2, s[56:59], s3 offen
  s_add_u32 s3, s3, 16384
  buffer_load_dwordx2 v[62:63], v2, s[56:59], s3 offen
  s_lshl_b32 s4, s69, 7
  s_lshl_b32 s5, s70, 6
  s_add_u32 s4, s4, s5
  s_add_u32 s4, s4, 1216
  s_lshl_b32 s5, s69, 6
  s_cmp_eq_u32 s70, 4
  s_cselect_b32 s4, s5, s4
  s_lshr_b32 s5, s5, 1
  s_add_u32 s5, s5, 1024
  s_cmp_eq_u32 s70, 7
  s_cselect_b32 s4, s5, s4
  v_add_u32 v3, s4, v1
  v_lshlrev_b32 v2, 2, v3
  v_lshlrev_b32 v3, 1, v3
  s_mov_b32 s3, 0
  buffer_load_dword v64, v2, s[64:67], s3 offen
  s_add_u32 s3, s3, 16384
  buffer_load_dword v65, v2, s[64:67], s3 offen
  s_add_u32 s3, s3, 16384
  buffer_load_dword v66, v2, s[64:67], s3 offen
  s_add_u32 s3, s3, 16384
  buffer_load_dword v67, v2, s[64:67], s3 offen
  s_add_u32 s3, s3, 16384
  buffer_load_dword v68, v2, s[64:67], s3 offen
  s_add_u32 s3, s3, 16384
  buffer_load_dword v69, v2, s[64:67], s3 offen
  s_add_u32 s3, s3, 16384
  buffer_load_dword v70, v2, s[64:67], s3 offen
  s_add_u32 s3, s3, 16384
  buffer_load_dword v71, v2, s[64:67], s3 offen
  s_add_u32 s3, s3, 16384
  buffer_load_dword v72, v2, s[64:67], s3 offen
  s_add_u32 s3, s3, 16384
  buffer_load_dword v73, v2, s[64:67], s3 offen
  s_add_u32 s3, s3, 16384
  buffer_load_dword v74, v2, s[64:67], s3 offen
  s_add_u32 s3, s3, 16384
  buffer_load_dword v75, v2, s[64:67], s3 offen
  s_add_u32 s3, s3, 16384
  buffer_load_dword v76, v2, s[64:67], s3 offen
  s_add_u32 s3, s3, 16384
  buffer_load_dword v77, v2, s[64:67], s3 offen
  s_add_u32 s3, s3, 16384
  buffer_load_dword v78, v2, s[64:67], s3 offen
  s_add_u32 s3, s3, 16384
  buffer_load_dword v79, v2, s[64:67], s3 offen
  buffer_load_ushort v80, v3, s[52:55], 0 offen
  s_waitcnt vmcnt(44)
  s_barrier
  s_waitcnt vmcnt(33)
  s_barrier
  s_waitcnt vmcnt(0)
  v_add_f32 v32, v32, v34
  v_add_f32 v33, v33, v35
  v_add_f32 v48, v48, v50
  v_add_f32 v49, v49, v51
  v_add_f32 v32, v32, v36
  v_add_f32 v33, v33, v37
  v_add_f32 v48, v48, v52
  v_add_f32 v49, v49, v53
  v_add_f32 v32, v32, v38
  v_add_f32 v33, v33, v39
  v_add_f32 v48, v48, v54
  v_add_f32 v49, v49, v55
  v_add_f32 v32, v32, v40
  v_add_f32 v33, v33, v41
  v_add_f32 v48, v48, v56
  v_add_f32 v49, v49, v57
  v_add_f32 v32, v32, v42
  v_add_f32 v33, v33, v43
  v_add_f32 v48, v48, v58
  v_add_f32 v49, v49, v59
  v_add_f32 v32, v32, v44
  v_add_f32 v33, v33, v45
  v_add_f32 v48, v48, v60
  v_add_f32 v49, v49, v61
  v_add_f32 v32, v32, v46
  v_add_f32 v33, v33, v47
  v_add_f32 v48, v48, v62
  v_add_f32 v49, v49, v63
  v_add_f32 v32, v32, v48
  v_add_f32 v33, v33, v49
  v_mul_f32 v32, 0x3a800000, v32
  v_mul_f32 v33, 0x3a800000, v33
  v_fma_f32 v33, -v32, v32, v33
  v_max_f32 v33, 0, v33
  v_add_f32 v33, 0x3727c5ac, v33
  v_rsq_f32 v33, v33
  s_nop 0
  s_and_b32 s3, s70, 3
  s_lshl_b32 s5, s3, 6
  s_add_u32 s5, s5, 16
  v_add_u32 v2, s5, v1
  v_and_b32 v3, 15, v1
  s_cmp_ge_u32 s3, 2
  s_cselect_b64 vcc, -1, 0
  v_cndmask_b32 v2, v2, v3, vcc
  v_lshlrev_b32 v2, 2, v2
  v_add_u32 v2, 147456, v2
  ds_write2_b32 v2, v32, v33 offset0:0 offset1:160
  v_add_f32 v64, v64, v72
  v_add_f32 v65, v65, v73
  v_add_f32 v66, v66, v74
  v_add_f32 v67, v67, v75
  v_add_f32 v68, v68, v76
  v_add_f32 v69, v69, v77
  v_add_f32 v70, v70, v78
  v_add_f32 v71, v71, v79
  v_add_f32 v64, v64, v68
  v_add_f32 v65, v65, v69
  v_add_f32 v66, v66, v70
  v_add_f32 v67, v67, v71
  v_add_f32 v64, v64, v65
  v_add_f32 v66, v66, v67
  v_add_f32 v64, v64, v66
  v_lshlrev_b32 v80, 16, v80
  v_lshlrev_b32 v2, 2, v0
  v_add_u32 v2, 147712, v2
  ds_write_b32 v2, v64
  ds_write_b32 v2, v80 offset:1024
  s_waitcnt lgkmcnt(0)
  s_barrier
  s_lshl_b32 s87, s97, 15
  s_lshl_b32 s4, s68, 11
  s_add_u32 s87, s87, s4
  s_lshl_b32 s4, s69, 2
  s_add_u32 s87, s87, s4
  s_add_u32 s97, s97, 1
  s_branch L_w2_body
L_w1_end:
  s_endpgm
L_w1_compute:
  s_and_b32 s71, s70, 1
  s_lshr_b32 s72, s70, 1
  v_and_b32 v3, 15, v1
  v_lshrrev_b32 v2, 4, v1
  s_lshl_b32 s8, s71, 13
  v_lshl_add_u32 v4, v1, 4, s8
  v_bfe_u32 v13, v1, 2, 2
  v_lshl_add_u32 v13, v2, 3, v13
  v_lshlrev_b32 v13, 7, v13
  v_and_b32 v17, 3, v1
  v_lshl_add_u32 v13, v17, 3, v13
  v_bfe_u32 v17, v1, 3, 2
  v_lshl_add_u32 v13, v17, 5, v13
  s_lshl_b32 s9, s72, 6
  v_xor_b32 v13, s9, v13
  v_add_u32 v5, 16384, v13
  v_xor_b32 v6, 32, v5
  v_and_b32 v16, 1, v2
  v_lshrrev_b32 v17, 1, v2
  v_bfe_u32 v13, v1, 2, 2
  v_lshl_add_u32 v13, v16, 3, v13
  v_lshl_add_u32 v13, v17, 5, v13
  v_xor_b32 v14, s72, v16
  v_lshl_add_u32 v13, v13, 1, v14
  v_and_b32 v14, 3, v1
  v_lshl_add_u32 v13, v13, 2, v14
  v_lshlrev_b32 v13, 3, v13
  v_add_u32 v7, 40960, v13
  s_lshl_b32 s8, s68, 7
  s_lshl_b32 s9, s71, 6
  s_add_u32 s8, s8, s9
  s_mul_i32 s8, s8, 7168
  v_lshlrev_b32 v14, 8, v17
  v_lshl_add_u32 v14, v3, 4, v14
  v_add_u32 v14, s8, v14
  s_lshl_b32 s10, s69, 11
  s_lshl_b32 s9, s72, 10
  s_add_u32 s9, s9, s10
  v_lshl_add_u32 v12, v16, 9, v14
  v_add_u32 v12, s9, v12
  v_mul_u32_u24 v16, 114688, v16
  s_lshr_b32 s9, s9, 1
  v_add3_u32 v13, v16, v14, s9
  s_lshl_b32 s9, s71, 8
  s_add_u32 s9, s9, 147520
  v_lshl_add_u32 v14, v3, 2, s9
  s_lshl_b32 s9, s72, 7
  s_add_u32 s9, s9, 148736
  v_lshl_add_u32 v15, v2, 4, s9
  s_lshl_b32 s9, s72, 6
  s_add_u32 s9, s9, 148736
  v_lshl_add_u32 v16, v2, 4, s9
  v_mov_b32 v128, 0
  v_mov_b32 v129, 0
  v_mov_b32 v130, 0
  v_mov_b32 v131, 0
  v_mov_b32 v132, 0
  v_mov_b32 v133, 0
  v_mov_b32 v134, 0
  v_mov_b32 v135, 0
  v_mov_b32 v136, 0
  v_mov_b32 v137, 0
  v_mov_b32 v138, 0
  v_mov_b32 v139, 0
  v_mov_b32 v140, 0
  v_mov_b32 v141, 0
  v_mov_b32 v142, 0
  v_mov_b32 v143, 0
  v_mov_b32 v144, 0
  v_mov_b32 v145, 0
  v_mov_b32 v146, 0
  v_mov_b32 v147, 0
  v_mov_b32 v148, 0
  v_mov_b32 v149, 0
  v_mov_b32 v150, 0
  v_mov_b32 v151, 0
  v_mov_b32 v152, 0
  v_mov_b32 v153, 0
  v_mov_b32 v154, 0
  v_mov_b32 v155, 0
  v_mov_b32 v156, 0
  v_mov_b32 v157, 0
  v_mov_b32 v158, 0
  v_mov_b32 v159, 0
  v_mov_b32 v160, 0
  v_mov_b32 v161, 0
  v_mov_b32 v162, 0
  v_mov_b32 v163, 0
  v_mov_b32 v164, 0
  v_mov_b32 v165, 0
  v_mov_b32 v166, 0
  v_mov_b32 v167, 0
  v_mov_b32 v168, 0
  v_mov_b32 v169, 0
  v_mov_b32 v170, 0
  v_mov_b32 v171, 0
  v_mov_b32 v172, 0
  v_mov_b32 v173, 0
  v_mov_b32 v174, 0
  v_mov_b32 v175, 0
  v_mov_b32 v176, 0
  v_mov_b32 v177, 0
  v_mov_b32 v178, 0
  v_mov_b32 v179, 0
  v_mov_b32 v180, 0
  v_mov_b32 v181, 0
  v_mov_b32 v182, 0
  v_mov_b32 v183, 0
  v_mov_b32 v184, 0
  v_mov_b32 v185, 0
  v_mov_b32 v186, 0
  v_mov_b32 v187, 0
  v_mov_b32 v188, 0
  v_mov_b32 v189, 0
  v_mov_b32 v190, 0
  v_mov_b32 v191, 0
  v_mov_b32 v192, 0
  v_mov_b32 v193, 0
  v_mov_b32 v194, 0
  v_mov_b32 v195, 0
  v_mov_b32 v196, 0
  v_mov_b32 v197, 0
  v_mov_b32 v198, 0
  v_mov_b32 v199, 0
  v_mov_b32 v200, 0
  v_mov_b32 v201, 0
  v_mov_b32 v202, 0
  v_mov_b32 v203, 0
  v_mov_b32 v204, 0
  v_mov_b32 v205, 0
  v_mov_b32 v206, 0
  v_mov_b32 v207, 0
  v_mov_b32 v208, 0
  v_mov_b32 v209, 0
  v_mov_b32 v210, 0
  v_mov_b32 v211, 0
  v_mov_b32 v212, 0
  v_mov_b32 v213, 0
  v_mov_b32 v214, 0
  v_mov_b32 v215, 0
  v_mov_b32 v216, 0
  v_mov_b32 v217, 0
  v_mov_b32 v218, 0
  v_mov_b32 v219, 0
  v_mov_b32 v220, 0
  v_mov_b32 v221, 0
  v_mov_b32 v222, 0
  v_mov_b32 v223, 0
  v_mov_b32 v224, 0
  v_mov_b32 v225, 0
  v_mov_b32 v226, 0
  v_mov_b32 v227, 0
  v_mov_b32 v228, 0
  v_mov_b32 v229, 0
  v_mov_b32 v230, 0
  v_mov_b32 v231, 0
  v_mov_b32 v232, 0
  v_mov_b32 v233, 0
  v_mov_b32 v234, 0
  v_mov_b32 v235, 0
  v_mov_b32 v236, 0
  v_mov_b32 v237, 0
  v_mov_b32 v238, 0
  v_mov_b32 v239, 0
  s_waitcnt lgkmcnt(0)
  s_add_u32 s44, s34, 8388608
  s_addc_u32 s45, s35, 0
  s_and_b32 s45, s45, 0xffff
  s_mov_b32 s46, 14680064
  s_mov_b32 s47, 0x00020000
  s_cmp_lg_u32 s96, 0
  s_cbranch_scc1 L_pfc3_skip
  s_getpc_b64 s[4:5]
L_pfc3:
  s_lshl_b32 s3, s99, 2
  s_add_u32 s3, s3, s70
  s_mul_i32 s3, s3, 192
  s_min_u32 s3, s3, L_w2_c1-L_w2_c0-192
  s_add_i32 s3, s3, L_w2_c0-L_pfc3
  s_ashr_i32 s6, s3, 31
  s_add_u32 s4, s4, s3
  s_addc_u32 s5, s5, s6
  s_load_dword s36, s[4:5], 0
  s_load_dword s37, s[4:5], 64
  s_load_dword s38, s[4:5], 128
L_pfc3_skip:
  s_mov_b32 s75, 0
  v_add_u32_e64 v20, s75, v4
  v_add_u32_e64 v21, s75, v5
  v_add_u32_e64 v22, s75, v6
  v_add_u32_e64 v23, s75, v7
  s_add_u32 s75, s75, 49152
  s_cmp_eq_u32 s75, 147456
  s_cselect_b32 s75, 0, s75
  s_mov_b32 s79, 16
  s_barrier
  s_barrier
  ds_read_b128 v[32:35], v20 offset:0
  ds_read_b128 v[36:39], v20 offset:2048
  ds_read_b128 v[40:43], v20 offset:4096
  ds_read_b128 v[44:47], v20 offset:6144
  ds_read_b64_tr_b16 v[48:49], v21 offset:0
  ds_read_b64_tr_b16 v[50:51], v21 offset:512
  ds_read_b64_tr_b16 v[52:53], v22 offset:0
  ds_read_b64_tr_b16 v[54:55], v22 offset:512
  ds_read_b64_tr_b16 v[56:57], v21 offset:8192
  ds_read_b64_tr_b16 v[58:59], v21 offset:8704
  ds_read_b64_tr_b16 v[60:61], v22 offset:8192
  ds_read_b64_tr_b16 v[62:63], v22 offset:8704
  ds_read_b64_tr_b16 v[64:65], v21 offset:16384
  ds_read_b64_tr_b16 v[66:67], v21 offset:16896
  ds_read_b64_tr_b16 v[68:69], v22 offset:16384
  ds_read_b64_tr_b16 v[70:71], v22 offset:16896
  ds_read_b64_tr_b16 v[72:73], v23 offset:0
  ds_read_b64_tr_b16 v[74:75], v23 offset:256
  s_waitcnt lgkmcnt(0)
.p2align 3
L_w1_loop:
  v_mfma_f32_16x16x32_bf16 v[128:131], v[48:51], v[32:35], v[128:131]
  ds_read_b128 v[80:83], v20 offset:1024
  v_mfma_f32_16x16x32_bf16 v[132:135], v[48:51], v[36:39], v[132:135]
  ds_read_b128 v[84:87], v20 offset:3072
  v_mfma_f32_16x16x32_bf16 v[136:139], v[48:51], v[40:43], v[136:139]
  ds_read_b128 v[88:91], v20 offset:5120
  v_mfma_f32_16x16x32_bf16 v[140:143], v[48:51], v[44:47], v[140:143]
  ds_read_b128 v[92:95], v20 offset:7168
  v_mfma_f32_16x16x32_bf16 v[156:159], v[52:55], v[44:47], v[156:159]
  ds_read_b64_tr_b16 v[96:97], v21 offset:4096
  v_mfma_f32_16x16x32_bf16 v[152:155], v[52:55], v[40:43], v[152:155]
  ds_read_b64_tr_b16 v[98:99], v21 offset:4608
  v_mfma_f32_16x16x32_bf16 v[148:151], v[52:55], v[36:39], v[148:151]
  ds_read_b64_tr_b16 v[100:101], v22 offset:4096
  v_mfma_f32_16x16x32_bf16 v[144:147], v[52:55], v[32:35], v[144:147]
  ds_read_b64_tr_b16 v[102:103], v22 offset:4608
  v_mfma_f32_16x16x32_bf16 v[160:163], v[56:59], v[32:35], v[160:163]
  ds_read_b64_tr_b16 v[104:105], v21 offset:12288
  v_mfma_f32_16x16x32_bf16 v[164:167], v[56:59], v[36:39], v[164:167]
  ds_read_b64_tr_b16 v[106:107], v21 offset:12800
  v_mfma_f32_16x16x32_bf16 v[168:171], v[56:59], v[40:43], v[168:171]
  ds_read_b64_tr_b16 v[108:109], v22 offset:12288
  v_mfma_f32_16x16x32_bf16 v[172:175], v[56:59], v[44:47], v[172:175]
  ds_read_b64_tr_b16 v[110:111], v22 offset:12800
  v_mfma_f32_16x16x32_bf16 v[188:191], v[60:63], v[44:47], v[188:191]
  ds_read_b64_tr_b16 v[112:113], v21 offset:20480
  v_mfma_f32_16x16x32_bf16 v[184:187], v[60:63], v[40:43], v[184:187]
  ds_read_b64_tr_b16 v[114:115], v21 offset:20992
  v_mfma_f32_16x16x32_bf16 v[180:183], v[60:63], v[36:39], v[180:183]
  ds_read_b64_tr_b16 v[116:117], v22 offset:20480
  v_mfma_f32_16x16x32_bf16 v[176:179], v[60:63], v[32:35], v[176:179]
  ds_read_b64_tr_b16 v[118:119], v22 offset:20992
  v_mfma_f32_16x16x32_bf16 v[192:195], v[64:67], v[32:35], v[192:195]
  ds_read_b64_tr_b16 v[120:121], v23 offset:4096
  v_mfma_f32_16x16x32_bf16 v[196:199], v[64:67], v[36:39], v[196:199]
  ds_read_b64_tr_b16 v[122:123], v23 offset:4352
  v_mfma_f32_16x16x32_bf16 v[200:203], v[64:67], v[40:43], v[200:203]
  v_add_u32_e64 v20, s75, v4
  v_mfma_f32_16x16x32_bf16 v[204:207], v[64:67], v[44:47], v[204:207]
  v_add_u32_e64 v21, s75, v5
  v_mfma_f32_16x16x32_bf16 v[220:223], v[68:71], v[44:47], v[220:223]
  v_add_u32_e64 v22, s75, v6
  v_mfma_f32_16x16x32_bf16 v[216:219], v[68:71], v[40:43], v[216:219]
  v_add_u32_e64 v23, s75, v7
  v_mfma_f32_16x16x32_bf16 v[212:215], v[68:71], v[36:39], v[212:215]
  s_add_u32 s75, s75, 49152
  v_mfma_f32_16x16x32_bf16 v[208:211], v[68:71], v[32:35], v[208:211]
  s_cmp_eq_u32 s75, 147456
  v_mfma_f32_16x16x32_bf16 v[224:227], v[72:75], v[32:35], v[224:227]
  s_cselect_b32 s75, 0, s75
  s_sub_u32 s79, s79, 1
  v_mfma_f32_16x16x32_bf16 v[228:231], v[72:75], v[36:39], v[228:231]
  v_mfma_f32_16x16x32_bf16 v[232:235], v[72:75], v[40:43], v[232:235]
  v_mfma_f32_16x16x32_bf16 v[236:239], v[72:75], v[44:47], v[236:239]
  s_waitcnt lgkmcnt(0)
  s_barrier
  v_mfma_f32_16x16x32_bf16 v[128:131], v[96:99], v[80:83], v[128:131]
  ds_read_b128 v[32:35], v20 offset:0
  v_mfma_f32_16x16x32_bf16 v[132:135], v[96:99], v[84:87], v[132:135]
  ds_read_b128 v[36:39], v20 offset:2048
  v_mfma_f32_16x16x32_bf16 v[136:139], v[96:99], v[88:91], v[136:139]
  ds_read_b128 v[40:43], v20 offset:4096
  v_mfma_f32_16x16x32_bf16 v[140:143], v[96:99], v[92:95], v[140:143]
  ds_read_b128 v[44:47], v20 offset:6144
  v_mfma_f32_16x16x32_bf16 v[156:159], v[100:103], v[92:95], v[156:159]
  ds_read_b64_tr_b16 v[48:49], v21 offset:0
  v_mfma_f32_16x16x32_bf16 v[152:155], v[100:103], v[88:91], v[152:155]
  ds_read_b64_tr_b16 v[50:51], v21 offset:512
  v_mfma_f32_16x16x32_bf16 v[148:151], v[100:103], v[84:87], v[148:151]
  ds_read_b64_tr_b16 v[52:53], v22 offset:0
  v_mfma_f32_16x16x32_bf16 v[144:147], v[100:103], v[80:83], v[144:147]
  ds_read_b64_tr_b16 v[54:55], v22 offset:512
  v_mfma_f32_16x16x32_bf16 v[160:163], v[104:107], v[80:83], v[160:163]
  ds_read_b64_tr_b16 v[56:57], v21 offset:8192
  v_mfma_f32_16x16x32_bf16 v[164:167], v[104:107], v[84:87], v[164:167]
  ds_read_b64_tr_b16 v[58:59], v21 offset:8704
  v_mfma_f32_16x16x32_bf16 v[168:171], v[104:107], v[88:91], v[168:171]
  ds_read_b64_tr_b16 v[60:61], v22 offset:8192
  v_mfma_f32_16x16x32_bf16 v[172:175], v[104:107], v[92:95], v[172:175]
  ds_read_b64_tr_b16 v[62:63], v22 offset:8704
  v_mfma_f32_16x16x32_bf16 v[188:191], v[108:111], v[92:95], v[188:191]
  ds_read_b64_tr_b16 v[64:65], v21 offset:16384
  v_mfma_f32_16x16x32_bf16 v[184:187], v[108:111], v[88:91], v[184:187]
  ds_read_b64_tr_b16 v[66:67], v21 offset:16896
  v_mfma_f32_16x16x32_bf16 v[180:183], v[108:111], v[84:87], v[180:183]
  ds_read_b64_tr_b16 v[68:69], v22 offset:16384
  v_mfma_f32_16x16x32_bf16 v[176:179], v[108:111], v[80:83], v[176:179]
  ds_read_b64_tr_b16 v[70:71], v22 offset:16896
  v_mfma_f32_16x16x32_bf16 v[192:195], v[112:115], v[80:83], v[192:195]
  ds_read_b64_tr_b16 v[72:73], v23 offset:0
  v_mfma_f32_16x16x32_bf16 v[196:199], v[112:115], v[84:87], v[196:199]
  ds_read_b64_tr_b16 v[74:75], v23 offset:256
  v_mfma_f32_16x16x32_bf16 v[200:203], v[112:115], v[88:91], v[200:203]
  s_cmp_lg_u32 s79, 0
  s_nop 0
  v_mfma_f32_16x16x32_bf16 v[204:207], v[112:115], v[92:95], v[204:207]
  v_mfma_f32_16x16x32_bf16 v[220:223], v[116:119], v[92:95], v[220:223]
  v_mfma_f32_16x16x32_bf16 v[216:219], v[116:119], v[88:91], v[216:219]
  v_mfma_f32_16x16x32_bf16 v[212:215], v[116:119], v[84:87], v[212:215]
  v_mfma_f32_16x16x32_bf16 v[208:211], v[116:119], v[80:83], v[208:211]
  v_mfma_f32_16x16x32_bf16 v[224:227], v[120:123], v[80:83], v[224:227]
  v_mfma_f32_16x16x32_bf16 v[228:231], v[120:123], v[84:87], v[228:231]
  v_mfma_f32_16x16x32_bf16 v[232:235], v[120:123], v[88:91], v[232:235]
  v_mfma_f32_16x16x32_bf16 v[236:239], v[120:123], v[92:95], v[236:239]
  s_waitcnt lgkmcnt(0)
  s_cbranch_scc1 L_w1_loop
L_w1_exit:
  ds_read2_b32 v[88:89], v14 offset0:0 offset1:160
  ds_read2_b32 v[90:91], v14 offset0:16 offset1:176
  ds_read2_b32 v[92:93], v14 offset0:32 offset1:192
  ds_read2_b32 v[94:95], v14 offset0:48 offset1:208
  ds_read_b128 v[32:35], v15 offset:0
  ds_read_b128 v[60:63], v15 offset:1024
  ds_read_b128 v[36:39], v15 offset:64
  ds_read_b128 v[64:67], v15 offset:1088
  ds_read_b128 v[40:43], v15 offset:256
  ds_read_b128 v[68:71], v15 offset:1280
  ds_read_b128 v[44:47], v15 offset:320
  ds_read_b128 v[72:75], v15 offset:1344
  ds_read_b128 v[48:51], v15 offset:512
  ds_read_b128 v[76:79], v15 offset:1536
  ds_read_b128 v[52:55], v15 offset:576
  ds_read_b128 v[80:83], v15 offset:1600
  ds_read_b128 v[56:59], v16 offset:768
  ds_read_b128 v[84:87], v16 offset:1792
  v_mov_b32 v96, 0xc0135761
  v_mov_b32 v97, 0xbdd2d3e8
  v_mov_b32 v98, 1.0
  s_waitcnt lgkmcnt(0)
  v_mul_f32 v88, v88, v89
  v_mul_f32 v90, v90, v91
  v_mul_f32 v92, v92, v93
  v_mul_f32 v94, v94, v95
  v_pk_fma_f32 v[100:101], v[32:33], v[88:89], v[60:61] op_sel:[0,0,0] op_sel_hi:[1,0,1] neg_lo:[0,1,0] neg_hi:[0,1,0]
  v_pk_fma_f32 v[102:103], v[34:35], v[88:89], v[62:63] op_sel:[0,0,0] op_sel_hi:[1,0,1] neg_lo:[0,1,0] neg_hi:[0,1,0]
  v_pk_fma_f32 v[128:129], v[128:129], v[88:89], v[100:101] op_sel:[0,1,0] op_sel_hi:[1,1,1]
  v_pk_fma_f32 v[130:131], v[130:131], v[88:89], v[102:103] op_sel:[0,1,0] op_sel_hi:[1,1,1]
  v_pk_mul_f32 v[100:101], v[128:129], v[128:129]
  v_pk_mul_f32 v[102:103], v[130:131], v[130:131]
  v_pk_fma_f32 v[100:101], v[100:101], v[96:97], v[96:97] op_sel:[0,1,0] op_sel_hi:[1,1,0]
  v_pk_fma_f32 v[102:103], v[102:103], v[96:97], v[96:97] op_sel:[0,1,0] op_sel_hi:[1,1,0]
  v_pk_mul_f32 v[100:101], v[100:101], v[128:129]
  v_pk_mul_f32 v[102:103], v[102:103], v[130:131]
  v_exp_f32 v100, v100
  v_exp_f32 v101, v101
  v_exp_f32 v102, v102
  v_exp_f32 v103, v103
  v_pk_add_f32 v[100:101], v[100:101], v[98:99] op_sel_hi:[1,0]
  v_pk_add_f32 v[102:103], v[102:103], v[98:99] op_sel_hi:[1,0]
  v_rcp_f32 v100, v100
  v_rcp_f32 v101, v101
  v_rcp_f32 v102, v102
  v_rcp_f32 v103, v103
  v_pk_mul_f32 v[128:129], v[128:129], v[100:101]
  v_pk_mul_f32 v[130:131], v[130:131], v[102:103]
  v_cvt_pk_bf16_f32 v108, v128, v129
  v_cvt_pk_bf16_f32 v109, v130, v131
  v_pk_fma_f32 v[104:105], v[36:37], v[88:89], v[64:65] op_sel:[0,0,0] op_sel_hi:[1,0,1] neg_lo:[0,1,0] neg_hi:[0,1,0]
  v_pk_fma_f32 v[106:107], v[38:39], v[88:89], v[66:67] op_sel:[0,0,0] op_sel_hi:[1,0,1] neg_lo:[0,1,0] neg_hi:[0,1,0]
  v_pk_fma_f32 v[144:145], v[144:145], v[88:89], v[104:105] op_sel:[0,1,0] op_sel_hi:[1,1,1]
  v_pk_fma_f32 v[146:147], v[146:147], v[88:89], v[106:107] op_sel:[0,1,0] op_sel_hi:[1,1,1]
  v_pk_mul_f32 v[104:105], v[144:145], v[144:145]
  v_pk_mul_f32 v[106:107], v[146:147], v[146:147]
  v_pk_fma_f32 v[104:105], v[104:105], v[96:97], v[96:97] op_sel:[0,1,0] op_sel_hi:[1,1,0]
  v_pk_fma_f32 v[106:107], v[106:107], v[96:97], v[96:97] op_sel:[0,1,0] op_sel_hi:[1,1,0]
  v_pk_mul_f32 v[104:105], v[104:105], v[144:145]
  v_pk_mul_f32 v[106:107], v[106:107], v[146:147]
  v_exp_f32 v104, v104
  v_exp_f32 v105, v105
  v_exp_f32 v106, v106
  v_exp_f32 v107, v107
  v_pk_add_f32 v[104:105], v[104:105], v[98:99] op_sel_hi:[1,0]
  v_pk_add_f32 v[106:107], v[106:107], v[98:99] op_sel_hi:[1,0]
  v_rcp_f32 v104, v104
  v_rcp_f32 v105, v105
  v_rcp_f32 v106, v106
  v_rcp_f32 v107, v107
  v_pk_mul_f32 v[144:145], v[144:145], v[104:105]
  v_pk_mul_f32 v[146:147], v[146:147], v[106:107]
  v_cvt_pk_bf16_f32 v110, v144, v145
  v_cvt_pk_bf16_f32 v111, v146, v147
  s_mov_b32 s3, 0
  s_nop 0
  v_permlane16_swap_b32 v108, v110
  v_permlane16_swap_b32 v109, v111
  buffer_store_dwordx4 v[108:111], v12, s[44:47], s3 offen sc1
  v_pk_fma_f32 v[100:101], v[32:33], v[90:91], v[60:61] op_sel:[0,0,0] op_sel_hi:[1,0,1] neg_lo:[0,1,0] neg_hi:[0,1,0]
  v_pk_fma_f32 v[102:103], v[34:35], v[90:91], v[62:63] op_sel:[0,0,0] op_sel_hi:[1,0,1] neg_lo:[0,1,0] neg_hi:[0,1,0]
  v_pk_fma_f32 v[132:133], v[132:133], v[90:91], v[100:101] op_sel:[0,1,0] op_sel_hi:[1,1,1]
  v_pk_fma_f32 v[134:135], v[134:135], v[90:91], v[102:103] op_sel:[0,1,0] op_sel_hi:[1,1,1]
  v_pk_mul_f32 v[100:101], v[132:133], v[132:133]
  v_pk_mul_f32 v[102:103], v[134:135], v[134:135]
  v_pk_fma_f32 v[100:101], v[100:101], v[96:97], v[96:97] op_sel:[0,1,0] op_sel_hi:[1,1,0]
  v_pk_fma_f32 v[102:103], v[102:103], v[96:97], v[96:97] op_sel:[0,1,0] op_sel_hi:[1,1,0]
  v_pk_mul_f32 v[100:101], v[100:101], v[132:133]
  v_pk_mul_f32 v[102:103], v[102:103], v[134:135]
  v_exp_f32 v100, v100
  v_exp_f32 v101, v101
  v_exp_f32 v102, v102
  v_exp_f32 v103, v103
  v_pk_add_f32 v[100:101], v[100:101], v[98:99] op_sel_hi:[1,0]
  v_pk_add_f32 v[102:103], v[102:103], v[98:99] op_sel_hi:[1,0]
  v_rcp_f32 v100, v100
  v_rcp_f32 v101, v101
  v_rcp_f32 v102, v102
  v_rcp_f32 v103, v103
  v_pk_mul_f32 v[132:133], v[132:133], v[100:101]
  v_pk_mul_f32 v[134:135], v[134:135], v[102:103]
  v_cvt_pk_bf16_f32 v112, v132, v133
  v_cvt_pk_bf16_f32 v113, v134, v135
  v_pk_fma_f32 v[104:105], v[36:37], v[90:91], v[64:65] op_sel:[0,0,0] op_sel_hi:[1,0,1] neg_lo:[0,1,0] neg_hi:[0,1,0]
  v_pk_fma_f32 v[106:107], v[38:39], v[90:91], v[66:67] op_sel:[0,0,0] op_sel_hi:[1,0,1] neg_lo:[0,1,0] neg_hi:[0,1,0]
  v_pk_fma_f32 v[148:149], v[148:149], v[90:91], v[104:105] op_sel:[0,1,0] op_sel_hi:[1,1,1]
  v_pk_fma_f32 v[150:151], v[150:151], v[90:91], v[106:107] op_sel:[0,1,0] op_sel_hi:[1,1,1]
  v_pk_mul_f32 v[104:105], v[148:149], v[148:149]
  v_pk_mul_f32 v[106:107], v[150:151], v[150:151]
  v_pk_fma_f32 v[104:105], v[104:105], v[96:97], v[96:97] op_sel:[0,1,0] op_sel_hi:[1,1,0]
  v_pk_fma_f32 v[106:107], v[106:107], v[96:97], v[96:97] op_sel:[0,1,0] op_sel_hi:[1,1,0]
  v_pk_mul_f32 v[104:105], v[104:105], v[148:149]
  v_pk_mul_f32 v[106:107], v[106:107], v[150:151]
  v_exp_f32 v104, v104
  v_exp_f32 v105, v105
  v_exp_f32 v106, v106
  v_exp_f32 v107, v107
  v_pk_add_f32 v[104:105], v[104:105], v[98:99] op_sel_hi:[1,0]
  v_pk_add_f32 v[106:107], v[106:107], v[98:99] op_sel_hi:[1,0]
  v_rcp_f32 v104, v104
  v_rcp_f32 v105, v105
  v_rcp_f32 v106, v106
  v_rcp_f32 v107, v107
  v_pk_mul_f32 v[148:149], v[148:149], v[104:105]
  v_pk_mul_f32 v[150:151], v[150:151], v[106:107]
  v_cvt_pk_bf16_f32 v114, v148, v149
  v_cvt_pk_bf16_f32 v115, v150, v151
  s_mov_b32 s3, 114688
  s_nop 0
  v_permlane16_swap_b32 v112, v114
  v_permlane16_swap_b32 v113, v115
  buffer_store_dwordx4 v[112:115], v12, s[44:47], s3 offen sc1
  v_pk_fma_f32 v[100:101], v[32:33], v[92:93], v[60:61] op_sel:[0,0,0] op_sel_hi:[1,0,1] neg_lo:[0,1,0] neg_hi:[0,1,0]
  v_pk_fma_f32 v[102:103], v[34:35], v[92:93], v[62:63] op_sel:[0,0,0] op_sel_hi:[1,0,1] neg_lo:[0,1,0] neg_hi:[0,1,0]
  v_pk_fma_f32 v[136:137], v[136:137], v[92:93], v[100:101] op_sel:[0,1,0] op_sel_hi:[1,1,1]
  v_pk_fma_f32 v[138:139], v[138:139], v[92:93], v[102:103] op_sel:[0,1,0] op_sel_hi:[1,1,1]
  v_pk_mul_f32 v[100:101], v[136:137], v[136:137]
  v_pk_mul_f32 v[102:103], v[138:139], v[138:139]
  v_pk_fma_f32 v[100:101], v[100:101], v[96:97], v[96:97] op_sel:[0,1,0] op_sel_hi:[1,1,0]
  v_pk_fma_f32 v[102:103], v[102:103], v[96:97], v[96:97] op_sel:[0,1,0] op_sel_hi:[1,1,0]
  v_pk_mul_f32 v[100:101], v[100:101], v[136:137]
  v_pk_mul_f32 v[102:103], v[102:103], v[138:139]
  v_exp_f32 v100, v100
  v_exp_f32 v101, v101
  v_exp_f32 v102, v102
  v_exp_f32 v103, v103
  v_pk_add_f32 v[100:101], v[100:101], v[98:99] op_sel_hi:[1,0]
  v_pk_add_f32 v[102:103], v[102:103], v[98:99] op_sel_hi:[1,0]
  v_rcp_f32 v100, v100
  v_rcp_f32 v101, v101
  v_rcp_f32 v102, v102
  v_rcp_f32 v103, v103
  v_pk_mul_f32 v[136:137], v[136:137], v[100:101]
  v_pk_mul_f32 v[138:139], v[138:139], v[102:103]
  v_cvt_pk_bf16_f32 v116, v136, v137
  v_cvt_pk_bf16_f32 v117, v138, v139
  v_pk_fma_f32 v[104:105], v[36:37], v[92:93], v[64:65] op_sel:[0,0,0] op_sel_hi:[1,0,1] neg_lo:[0,1,0] neg_hi:[0,1,0]
  v_pk_fma_f32 v[106:107], v[38:39], v[92:93], v[66:67] op_sel:[0,0,0] op_sel_hi:[1,0,1] neg_lo:[0,1,0] neg_hi:[0,1,0]
  v_pk_fma_f32 v[152:153], v[152:153], v[92:93], v[104:105] op_sel:[0,1,0] op_sel_hi:[1,1,1]
  v_pk_fma_f32 v[154:155], v[154:155], v[92:93], v[106:107] op_sel:[0,1,0] op_sel_hi:[1,1,1]
  v_pk_mul_f32 v[104:105], v[152:153], v[152:153]
  v_pk_mul_f32 v[106:107], v[154:155], v[154:155]
  v_pk_fma_f32 v[104:105], v[104:105], v[96:97], v[96:97] op_sel:[0,1,0] op_sel_hi:[1,1,0]
  v_pk_fma_f32 v[106:107], v[106:107], v[96:97], v[96:97] op_sel:[0,1,0] op_sel_hi:[1,1,0]
  v_pk_mul_f32 v[104:105], v[104:105], v[152:153]
  v_pk_mul_f32 v[106:107], v[106:107], v[154:155]
  v_exp_f32 v104, v104
  v_exp_f32 v105, v105
  v_exp_f32 v106, v106
  v_exp_f32 v107, v107
  v_pk_add_f32 v[104:105], v[104:105], v[98:99] op_sel_hi:[1,0]
  v_pk_add_f32 v[106:107], v[106:107], v[98:99] op_sel_hi:[1,0]
  v_rcp_f32 v104, v104
  v_rcp_f32 v105, v105
  v_rcp_f32 v106, v106
  v_rcp_f32 v107, v107
  v_pk_mul_f32 v[152:153], v[152:153], v[104:105]
  v_pk_mul_f32 v[154:155], v[154:155], v[106:107]
  v_cvt_pk_bf16_f32 v118, v152, v153
  v_cvt_pk_bf16_f32 v119, v154, v155
  s_mov_b32 s3, 229376
  s_nop 0
  v_permlane16_swap_b32 v116, v118
  v_permlane16_swap_b32 v117, v119
  buffer_store_dwordx4 v[116:119], v12, s[44:47], s3 offen sc1
  v_pk_fma_f32 v[100:101], v[32:33], v[94:95], v[60:61] op_sel:[0,0,0] op_sel_hi:[1,0,1] neg_lo:[0,1,0] neg_hi:[0,1,0]
  v_pk_fma_f32 v[102:103], v[34:35], v[94:95], v[62:63] op_sel:[0,0,0] op_sel_hi:[1,0,1] neg_lo:[0,1,0] neg_hi:[0,1,0]
  v_pk_fma_f32 v[140:141], v[140:141], v[94:95], v[100:101] op_sel:[0,1,0] op_sel_hi:[1,1,1]
  v_pk_fma_f32 v[142:143], v[142:143], v[94:95], v[102:103] op_sel:[0,1,0] op_sel_hi:[1,1,1]
  v_pk_mul_f32 v[100:101], v[140:141], v[140:141]
  v_pk_mul_f32 v[102:103], v[142:143], v[142:143]
  v_pk_fma_f32 v[100:101], v[100:101], v[96:97], v[96:97] op_sel:[0,1,0] op_sel_hi:[1,1,0]
  v_pk_fma_f32 v[102:103], v[102:103], v[96:97], v[96:97] op_sel:[0,1,0] op_sel_hi:[1,1,0]
  v_pk_mul_f32 v[100:101], v[100:101], v[140:141]
  v_pk_mul_f32 v[102:103], v[102:103], v[142:143]
  v_exp_f32 v100, v100
  v_exp_f32 v101, v101
  v_exp_f32 v102, v102
  v_exp_f32 v103, v103
  v_pk_add_f32 v[100:101], v[100:101], v[98:99] op_sel_hi:[1,0]
  v_pk_add_f32 v[102:103], v[102:103], v[98:99] op_sel_hi:[1,0]
  v_rcp_f32 v100, v100
  v_rcp_f32 v101, v101
  v_rcp_f32 v102, v102
  v_rcp_f32 v103, v103
  v_pk_mul_f32 v[140:141], v[140:141], v[100:101]
  v_pk_mul_f32 v[142:143], v[142:143], v[102:103]
  v_cvt_pk_bf16_f32 v120, v140, v141
  v_cvt_pk_bf16_f32 v121, v142, v143
  v_pk_fma_f32 v[104:105], v[36:37], v[94:95], v[64:65] op_sel:[0,0,0] op_sel_hi:[1,0,1] neg_lo:[0,1,0] neg_hi:[0,1,0]
  v_pk_fma_f32 v[106:107], v[38:39], v[94:95], v[66:67] op_sel:[0,0,0] op_sel_hi:[1,0,1] neg_lo:[0,1,0] neg_hi:[0,1,0]
  v_pk_fma_f32 v[156:157], v[156:157], v[94:95], v[104:105] op_sel:[0,1,0] op_sel_hi:[1,1,1]
  v_pk_fma_f32 v[158:159], v[158:159], v[94:95], v[106:107] op_sel:[0,1,0] op_sel_hi:[1,1,1]
  v_pk_mul_f32 v[104:105], v[156:157], v[156:157]
  v_pk_mul_f32 v[106:107], v[158:159], v[158:159]
  v_pk_fma_f32 v[104:105], v[104:105], v[96:97], v[96:97] op_sel:[0,1,0] op_sel_hi:[1,1,0]
  v_pk_fma_f32 v[106:107], v[106:107], v[96:97], v[96:97] op_sel:[0,1,0] op_sel_hi:[1,1,0]
  v_pk_mul_f32 v[104:105], v[104:105], v[156:157]
  v_pk_mul_f32 v[106:107], v[106:107], v[158:159]
  v_exp_f32 v104, v104
  v_exp_f32 v105, v105
  v_exp_f32 v106, v106
  v_exp_f32 v107, v107
  v_pk_add_f32 v[104:105], v[104:105], v[98:99] op_sel_hi:[1,0]
  v_pk_add_f32 v[106:107], v[106:107], v[98:99] op_sel_hi:[1,0]
  v_rcp_f32 v104, v104
  v_rcp_f32 v105, v105
  v_rcp_f32 v106, v106
  v_rcp_f32 v107, v107
  v_pk_mul_f32 v[156:157], v[156:157], v[104:105]
  v_pk_mul_f32 v[158:159], v[158:159], v[106:107]
  v_cvt_pk_bf16_f32 v122, v156, v157
  v_cvt_pk_bf16_f32 v123, v158, v159
  s_mov_b32 s3, 344064
  s_nop 0
  v_permlane16_swap_b32 v120, v122
  v_permlane16_swap_b32 v121, v123
  buffer_store_dwordx4 v[120:123], v12, s[44:47], s3 offen sc1
  v_pk_fma_f32 v[100:101], v[56:57], v[88:89], v[84:85] op_sel:[0,0,0] op_sel_hi:[1,0,1] neg_lo:[0,1,0] neg_hi:[0,1,0]
  v_pk_fma_f32 v[102:103], v[58:59], v[88:89], v[86:87] op_sel:[0,0,0] op_sel_hi:[1,0,1] neg_lo:[0,1,0] neg_hi:[0,1,0]
  v_pk_fma_f32 v[224:225], v[224:225], v[88:89], v[100:101] op_sel:[0,1,0] op_sel_hi:[1,1,1]
  v_pk_fma_f32 v[226:227], v[226:227], v[88:89], v[102:103] op_sel:[0,1,0] op_sel_hi:[1,1,1]
  v_pk_mul_f32 v[100:101], v[224:225], v[224:225]
  v_pk_mul_f32 v[102:103], v[226:227], v[226:227]
  v_pk_fma_f32 v[100:101], v[100:101], v[96:97], v[96:97] op_sel:[0,1,0] op_sel_hi:[1,1,0]
  v_pk_fma_f32 v[102:103], v[102:103], v[96:97], v[96:97] op_sel:[0,1,0] op_sel_hi:[1,1,0]
  v_pk_mul_f32 v[100:101], v[100:101], v[224:225]
  v_pk_mul_f32 v[102:103], v[102:103], v[226:227]
  v_exp_f32 v100, v100
  v_exp_f32 v101, v101
  v_exp_f32 v102, v102
  v_exp_f32 v103, v103
  v_pk_add_f32 v[100:101], v[100:101], v[98:99] op_sel_hi:[1,0]
  v_pk_add_f32 v[102:103], v[102:103], v[98:99] op_sel_hi:[1,0]
  v_rcp_f32 v100, v100
  v_rcp_f32 v101, v101
  v_rcp_f32 v102, v102
  v_rcp_f32 v103, v103
  v_pk_mul_f32 v[224:225], v[224:225], v[100:101]
  v_pk_mul_f32 v[226:227], v[226:227], v[102:103]
  v_cvt_pk_bf16_f32 v108, v224, v225
  v_cvt_pk_bf16_f32 v109, v226, v227
  v_pk_fma_f32 v[100:101], v[56:57], v[90:91], v[84:85] op_sel:[0,0,0] op_sel_hi:[1,0,1] neg_lo:[0,1,0] neg_hi:[0,1,0]
  v_pk_fma_f32 v[102:103], v[58:59], v[90:91], v[86:87] op_sel:[0,0,0] op_sel_hi:[1,0,1] neg_lo:[0,1,0] neg_hi:[0,1,0]
  v_pk_fma_f32 v[228:229], v[228:229], v[90:91], v[100:101] op_sel:[0,1,0] op_sel_hi:[1,1,1]
  v_pk_fma_f32 v[230:231], v[230:231], v[90:91], v[102:103] op_sel:[0,1,0] op_sel_hi:[1,1,1]
  v_pk_mul_f32 v[100:101], v[228:229], v[228:229]
  v_pk_mul_f32 v[102:103], v[230:231], v[230:231]
  v_pk_fma_f32 v[100:101], v[100:101], v[96:97], v[96:97] op_sel:[0,1,0] op_sel_hi:[1,1,0]
  v_pk_fma_f32 v[102:103], v[102:103], v[96:97], v[96:97] op_sel:[0,1,0] op_sel_hi:[1,1,0]
  v_pk_mul_f32 v[100:101], v[100:101], v[228:229]
  v_pk_mul_f32 v[102:103], v[102:103], v[230:231]
  v_exp_f32 v100, v100
  v_exp_f32 v101, v101
  v_exp_f32 v102, v102
  v_exp_f32 v103, v103
  v_pk_add_f32 v[100:101], v[100:101], v[98:99] op_sel_hi:[1,0]
  v_pk_add_f32 v[102:103], v[102:103], v[98:99] op_sel_hi:[1,0]
  v_rcp_f32 v100, v100
  v_rcp_f32 v101, v101
  v_rcp_f32 v102, v102
  v_rcp_f32 v103, v103
  v_pk_mul_f32 v[228:229], v[228:229], v[100:101]
  v_pk_mul_f32 v[230:231], v[230:231], v[102:103]
  v_cvt_pk_bf16_f32 v110, v228, v229
  v_cvt_pk_bf16_f32 v111, v230, v231
  s_mov_b32 s3, 32768
  s_nop 0
  v_permlane16_swap_b32 v108, v110
  v_permlane16_swap_b32 v109, v111
  buffer_store_dwordx4 v[108:111], v13, s[44:47], s3 offen sc1
  v_pk_fma_f32 v[100:101], v[56:57], v[92:93], v[84:85] op_sel:[0,0,0] op_sel_hi:[1,0,1] neg_lo:[0,1,0] neg_hi:[0,1,0]
  v_pk_fma_f32 v[102:103], v[58:59], v[92:93], v[86:87] op_sel:[0,0,0] op_sel_hi:[1,0,1] neg_lo:[0,1,0] neg_hi:[0,1,0]
  v_pk_fma_f32 v[232:233], v[232:233], v[92:93], v[100:101] op_sel:[0,1,0] op_sel_hi:[1,1,1]
  v_pk_fma_f32 v[234:235], v[234:235], v[92:93], v[102:103] op_sel:[0,1,0] op_sel_hi:[1,1,1]
  v_pk_mul_f32 v[100:101], v[232:233], v[232:233]
  v_pk_mul_f32 v[102:103], v[234:235], v[234:235]
  v_pk_fma_f32 v[100:101], v[100:101], v[96:97], v[96:97] op_sel:[0,1,0] op_sel_hi:[1,1,0]
  v_pk_fma_f32 v[102:103], v[102:103], v[96:97], v[96:97] op_sel:[0,1,0] op_sel_hi:[1,1,0]
  v_pk_mul_f32 v[100:101], v[100:101], v[232:233]
  v_pk_mul_f32 v[102:103], v[102:103], v[234:235]
  v_exp_f32 v100, v100
  v_exp_f32 v101, v101
  v_exp_f32 v102, v102
  v_exp_f32 v103, v103
  v_pk_add_f32 v[100:101], v[100:101], v[98:99] op_sel_hi:[1,0]
  v_pk_add_f32 v[102:103], v[102:103], v[98:99] op_sel_hi:[1,0]
  v_rcp_f32 v100, v100
  v_rcp_f32 v101, v101
  v_rcp_f32 v102, v102
  v_rcp_f32 v103, v103
  v_pk_mul_f32 v[232:233], v[232:233], v[100:101]
  v_pk_mul_f32 v[234:235], v[234:235], v[102:103]
  v_cvt_pk_bf16_f32 v112, v232, v233
  v_cvt_pk_bf16_f32 v113, v234, v235
  v_pk_fma_f32 v[100:101], v[56:57], v[94:95], v[84:85] op_sel:[0,0,0] op_sel_hi:[1,0,1] neg_lo:[0,1,0] neg_hi:[0,1,0]
  v_pk_fma_f32 v[102:103], v[58:59], v[94:95], v[86:87] op_sel:[0,0,0] op_sel_hi:[1,0,1] neg_lo:[0,1,0] neg_hi:[0,1,0]
  v_pk_fma_f32 v[236:237], v[236:237], v[94:95], v[100:101] op_sel:[0,1,0] op_sel_hi:[1,1,1]
  v_pk_fma_f32 v[238:239], v[238:239], v[94:95], v[102:103] op_sel:[0,1,0] op_sel_hi:[1,1,1]
  v_pk_mul_f32 v[100:101], v[236:237], v[236:237]
  v_pk_mul_f32 v[102:103], v[238:239], v[238:239]
  v_pk_fma_f32 v[100:101], v[100:101], v[96:97], v[96:97] op_sel:[0,1,0] op_sel_hi:[1,1,0]
  v_pk_fma_f32 v[102:103], v[102:103], v[96:97], v[96:97] op_sel:[0,1,0] op_sel_hi:[1,1,0]
  v_pk_mul_f32 v[100:101], v[100:101], v[236:237]
  v_pk_mul_f32 v[102:103], v[102:103], v[238:239]
  v_exp_f32 v100, v100
  v_exp_f32 v101, v101
  v_exp_f32 v102, v102
  v_exp_f32 v103, v103
  v_pk_add_f32 v[100:101], v[100:101], v[98:99] op_sel_hi:[1,0]
  v_pk_add_f32 v[102:103], v[102:103], v[98:99] op_sel_hi:[1,0]
  v_rcp_f32 v100, v100
  v_rcp_f32 v101, v101
  v_rcp_f32 v102, v102
  v_rcp_f32 v103, v103
  v_pk_mul_f32 v[236:237], v[236:237], v[100:101]
  v_pk_mul_f32 v[238:239], v[238:239], v[102:103]
  v_cvt_pk_bf16_f32 v114, v236, v237
  v_cvt_pk_bf16_f32 v115, v238, v239
  s_mov_b32 s3, 262144
  s_nop 0
  v_permlane16_swap_b32 v112, v114
  v_permlane16_swap_b32 v113, v115
  buffer_store_dwordx4 v[112:115], v13, s[44:47], s3 offen sc1
  v_pk_fma_f32 v[100:101], v[40:41], v[88:89], v[68:69] op_sel:[0,0,0] op_sel_hi:[1,0,1] neg_lo:[0,1,0] neg_hi:[0,1,0]
  v_pk_fma_f32 v[102:103], v[42:43], v[88:89], v[70:71] op_sel:[0,0,0] op_sel_hi:[1,0,1] neg_lo:[0,1,0] neg_hi:[0,1,0]
  v_pk_fma_f32 v[160:161], v[160:161], v[88:89], v[100:101] op_sel:[0,1,0] op_sel_hi:[1,1,1]
  v_pk_fma_f32 v[162:163], v[162:163], v[88:89], v[102:103] op_sel:[0,1,0] op_sel_hi:[1,1,1]
  v_pk_mul_f32 v[100:101], v[160:161], v[160:161]
  v_pk_mul_f32 v[102:103], v[162:163], v[162:163]
  v_pk_fma_f32 v[100:101], v[100:101], v[96:97], v[96:97] op_sel:[0,1,0] op_sel_hi:[1,1,0]
  v_pk_fma_f32 v[102:103], v[102:103], v[96:97], v[96:97] op_sel:[0,1,0] op_sel_hi:[1,1,0]
  v_pk_mul_f32 v[100:101], v[100:101], v[160:161]
  v_pk_mul_f32 v[102:103], v[102:103], v[162:163]
  v_exp_f32 v100, v100
  v_exp_f32 v101, v101
  v_exp_f32 v102, v102
  v_exp_f32 v103, v103
  v_pk_add_f32 v[100:101], v[100:101], v[98:99] op_sel_hi:[1,0]
  v_pk_add_f32 v[102:103], v[102:103], v[98:99] op_sel_hi:[1,0]
  v_rcp_f32 v100, v100
  v_rcp_f32 v101, v101
  v_rcp_f32 v102, v102
  v_rcp_f32 v103, v103
  v_pk_mul_f32 v[160:161], v[160:161], v[100:101]
  v_pk_mul_f32 v[162:163], v[162:163], v[102:103]
  v_cvt_pk_bf16_f32 v116, v160, v161
  v_cvt_pk_bf16_f32 v117, v162, v163
  v_pk_fma_f32 v[104:105], v[44:45], v[88:89], v[72:73] op_sel:[0,0,0] op_sel_hi:[1,0,1] neg_lo:[0,1,0] neg_hi:[0,1,0]
  v_pk_fma_f32 v[106:107], v[46:47], v[88:89], v[74:75] op_sel:[0,0,0] op_sel_hi:[1,0,1] neg_lo:[0,1,0] neg_hi:[0,1,0]
  v_pk_fma_f32 v[176:177], v[176:177], v[88:89], v[104:105] op_sel:[0,1,0] op_sel_hi:[1,1,1]
  v_pk_fma_f32 v[178:179], v[178:179], v[88:89], v[106:107] op_sel:[0,1,0] op_sel_hi:[1,1,1]
  v_pk_mul_f32 v[104:105], v[176:177], v[176:177]
  v_pk_mul_f32 v[106:107], v[178:179], v[178:179]
  v_pk_fma_f32 v[104:105], v[104:105], v[96:97], v[96:97] op_sel:[0,1,0] op_sel_hi:[1,1,0]
  v_pk_fma_f32 v[106:107], v[106:107], v[96:97], v[96:97] op_sel:[0,1,0] op_sel_hi:[1,1,0]
  v_pk_mul_f32 v[104:105], v[104:105], v[176:177]
  v_pk_mul_f32 v[106:107], v[106:107], v[178:179]
  v_exp_f32 v104, v104
  v_exp_f32 v105, v105
  v_exp_f32 v106, v106
  v_exp_f32 v107, v107
  v_pk_add_f32 v[104:105], v[104:105], v[98:99] op_sel_hi:[1,0]
  v_pk_add_f32 v[106:107], v[106:107], v[98:99] op_sel_hi:[1,0]
  v_rcp_f32 v104, v104
  v_rcp_f32 v105, v105
  v_rcp_f32 v106, v106
  v_rcp_f32 v107, v107
  v_pk_mul_f32 v[176:177], v[176:177], v[104:105]
  v_pk_mul_f32 v[178:179], v[178:179], v[106:107]
  v_cvt_pk_bf16_f32 v118, v176, v177
  v_cvt_pk_bf16_f32 v119, v178, v179
  s_add_u32 s3, s10, 49152
  s_nop 0
  v_permlane16_swap_b32 v116, v118
  v_permlane16_swap_b32 v117, v119
  buffer_store_dwordx4 v[116:119], v12, s[44:47], s3 offen sc1
  v_pk_fma_f32 v[100:101], v[48:49], v[88:89], v[76:77] op_sel:[0,0,0] op_sel_hi:[1,0,1] neg_lo:[0,1,0] neg_hi:[0,1,0]
  v_pk_fma_f32 v[102:103], v[50:51], v[88:89], v[78:79] op_sel:[0,0,0] op_sel_hi:[1,0,1] neg_lo:[0,1,0] neg_hi:[0,1,0]
  v_pk_fma_f32 v[192:193], v[192:193], v[88:89], v[100:101] op_sel:[0,1,0] op_sel_hi:[1,1,1]
  v_pk_fma_f32 v[194:195], v[194:195], v[88:89], v[102:103] op_sel:[0,1,0] op_sel_hi:[1,1,1]
  v_pk_mul_f32 v[100:101], v[192:193], v[192:193]
  v_pk_mul_f32 v[102:103], v[194:195], v[194:195]
  v_pk_fma_f32 v[100:101], v[100:101], v[96:97], v[96:97] op_sel:[0,1,0] op_sel_hi:[1,1,0]
  v_pk_fma_f32 v[102:103], v[102:103], v[96:97], v[96:97] op_sel:[0,1,0] op_sel_hi:[1,1,0]
  v_pk_mul_f32 v[100:101], v[100:101], v[192:193]
  v_pk_mul_f32 v[102:103], v[102:103], v[194:195]
  v_exp_f32 v100, v100
  v_exp_f32 v101, v101
  v_exp_f32 v102, v102
  v_exp_f32 v103, v103
  v_pk_add_f32 v[100:101], v[100:101], v[98:99] op_sel_hi:[1,0]
  v_pk_add_f32 v[102:103], v[102:103], v[98:99] op_sel_hi:[1,0]
  v_rcp_f32 v100, v100
  v_rcp_f32 v101, v101
  v_rcp_f32 v102, v102
  v_rcp_f32 v103, v103
  v_pk_mul_f32 v[192:193], v[192:193], v[100:101]
  v_pk_mul_f32 v[194:195], v[194:195], v[102:103]
  v_cvt_pk_bf16_f32 v120, v192, v193
  v_cvt_pk_bf16_f32 v121, v194, v195
  v_pk_fma_f32 v[104:105], v[52:53], v[88:89], v[80:81] op_sel:[0,0,0] op_sel_hi:[1,0,1] neg_lo:[0,1,0] neg_hi:[0,1,0]
  v_pk_fma_f32 v[106:107], v[54:55], v[88:89], v[82:83] op_sel:[0,0,0] op_sel_hi:[1,0,1] neg_lo:[0,1,0] neg_hi:[0,1,0]
  v_pk_fma_f32 v[208:209], v[208:209], v[88:89], v[104:105] op_sel:[0,1,0] op_sel_hi:[1,1,1]
  v_pk_fma_f32 v[210:211], v[210:211], v[88:89], v[106:107] op_sel:[0,1,0] op_sel_hi:[1,1,1]
  v_pk_mul_f32 v[104:105], v[208:209], v[208:209]
  v_pk_mul_f32 v[106:107], v[210:211], v[210:211]
  v_pk_fma_f32 v[104:105], v[104:105], v[96:97], v[96:97] op_sel:[0,1,0] op_sel_hi:[1,1,0]
  v_pk_fma_f32 v[106:107], v[106:107], v[96:97], v[96:97] op_sel:[0,1,0] op_sel_hi:[1,1,0]
  v_pk_mul_f32 v[104:105], v[104:105], v[208:209]
  v_pk_mul_f32 v[106:107], v[106:107], v[210:211]
  v_exp_f32 v104, v104
  v_exp_f32 v105, v105
  v_exp_f32 v106, v106
  v_exp_f32 v107, v107
  v_pk_add_f32 v[104:105], v[104:105], v[98:99] op_sel_hi:[1,0]
  v_pk_add_f32 v[106:107], v[106:107], v[98:99] op_sel_hi:[1,0]
  v_rcp_f32 v104, v104
  v_rcp_f32 v105, v105
  v_rcp_f32 v106, v106
  v_rcp_f32 v107, v107
  v_pk_mul_f32 v[208:209], v[208:209], v[104:105]
  v_pk_mul_f32 v[210:211], v[210:211], v[106:107]
  v_cvt_pk_bf16_f32 v122, v208, v209
  v_cvt_pk_bf16_f32 v123, v210, v211
  s_add_u32 s3, s10, 51200
  s_nop 0
  v_permlane16_swap_b32 v120, v122
  v_permlane16_swap_b32 v121, v123
  buffer_store_dwordx4 v[120:123], v12, s[44:47], s3 offen sc1
  v_pk_fma_f32 v[100:101], v[40:41], v[90:91], v[68:69] op_sel:[0,0,0] op_sel_hi:[1,0,1] neg_lo:[0,1,0] neg_hi:[0,1,0]
  v_pk_fma_f32 v[102:103], v[42:43], v[90:91], v[70:71] op_sel:[0,0,0] op_sel_hi:[1,0,1] neg_lo:[0,1,0] neg_hi:[0,1,0]
  v_pk_fma_f32 v[164:165], v[164:165], v[90:91], v[100:101] op_sel:[0,1,0] op_sel_hi:[1,1,1]
  v_pk_fma_f32 v[166:167], v[166:167], v[90:91], v[102:103] op_sel:[0,1,0] op_sel_hi:[1,1,1]
  v_pk_mul_f32 v[100:101], v[164:165], v[164:165]
  v_pk_mul_f32 v[102:103], v[166:167], v[166:167]
  v_pk_fma_f32 v[100:101], v[100:101], v[96:97], v[96:97] op_sel:[0,1,0] op_sel_hi:[1,1,0]
  v_pk_fma_f32 v[102:103], v[102:103], v[96:97], v[96:97] op_sel:[0,1,0] op_sel_hi:[1,1,0]
  v_pk_mul_f32 v[100:101], v[100:101], v[164:165]
  v_pk_mul_f32 v[102:103], v[102:103], v[166:167]
  v_exp_f32 v100, v100
  v_exp_f32 v101, v101
  v_exp_f32 v102, v102
  v_exp_f32 v103, v103
  v_pk_add_f32 v[100:101], v[100:101], v[98:99] op_sel_hi:[1,0]
  v_pk_add_f32 v[102:103], v[102:103], v[98:99] op_sel_hi:[1,0]
  v_rcp_f32 v100, v100
  v_rcp_f32 v101, v101
  v_rcp_f32 v102, v102
  v_rcp_f32 v103, v103
  v_pk_mul_f32 v[164:165], v[164:165], v[100:101]
  v_pk_mul_f32 v[166:167], v[166:167], v[102:103]
  v_cvt_pk_bf16_f32 v108, v164, v165
  v_cvt_pk_bf16_f32 v109, v166, v167
  v_pk_fma_f32 v[104:105], v[44:45], v[90:91], v[72:73] op_sel:[0,0,0] op_sel_hi:[1,0,1] neg_lo:[0,1,0] neg_hi:[0,1,0]
  v_pk_fma_f32 v[106:107], v[46:47], v[90:91], v[74:75] op_sel:[0,0,0] op_sel_hi:[1,0,1] neg_lo:[0,1,0] neg_hi:[0,1,0]
  v_pk_fma_f32 v[180:181], v[180:181], v[90:91], v[104:105] op_sel:[0,1,0] op_sel_hi:[1,1,1]
  v_pk_fma_f32 v[182:183], v[182:183], v[90:91], v[106:107] op_sel:[0,1,0] op_sel_hi:[1,1,1]
  v_pk_mul_f32 v[104:105], v[180:181], v[180:181]
  v_pk_mul_f32 v[106:107], v[182:183], v[182:183]
  v_pk_fma_f32 v[104:105], v[104:105], v[96:97], v[96:97] op_sel:[0,1,0] op_sel_hi:[1,1,0]
  v_pk_fma_f32 v[106:107], v[106:107], v[96:97], v[96:97] op_sel:[0,1,0] op_sel_hi:[1,1,0]
  v_pk_mul_f32 v[104:105], v[104:105], v[180:181]
  v_pk_mul_f32 v[106:107], v[106:107], v[182:183]
  v_exp_f32 v104, v104
  v_exp_f32 v105, v105
  v_exp_f32 v106, v106
  v_exp_f32 v107, v107
  v_pk_add_f32 v[104:105], v[104:105], v[98:99] op_sel_hi:[1,0]
  v_pk_add_f32 v[106:107], v[106:107], v[98:99] op_sel_hi:[1,0]
  v_rcp_f32 v104, v104
  v_rcp_f32 v105, v105
  v_rcp_f32 v106, v106
  v_rcp_f32 v107, v107
  v_pk_mul_f32 v[180:181], v[180:181], v[104:105]
  v_pk_mul_f32 v[182:183], v[182:183], v[106:107]
  v_cvt_pk_bf16_f32 v110, v180, v181
  v_cvt_pk_bf16_f32 v111, v182, v183
  s_add_u32 s3, s10, 163840
  s_nop 0
  v_permlane16_swap_b32 v108, v110
  v_permlane16_swap_b32 v109, v111
  buffer_store_dwordx4 v[108:111], v12, s[44:47], s3 offen sc1
  v_pk_fma_f32 v[100:101], v[48:49], v[90:91], v[76:77] op_sel:[0,0,0] op_sel_hi:[1,0,1] neg_lo:[0,1,0] neg_hi:[0,1,0]
  v_pk_fma_f32 v[102:103], v[50:51], v[90:91], v[78:79] op_sel:[0,0,0] op_sel_hi:[1,0,1] neg_lo:[0,1,0] neg_hi:[0,1,0]
  v_pk_fma_f32 v[196:197], v[196:197], v[90:91], v[100:101] op_sel:[0,1,0] op_sel_hi:[1,1,1]
  v_pk_fma_f32 v[198:199], v[198:199], v[90:91], v[102:103] op_sel:[0,1,0] op_sel_hi:[1,1,1]
  v_pk_mul_f32 v[100:101], v[196:197], v[196:197]
  v_pk_mul_f32 v[102:103], v[198:199], v[198:199]
  v_pk_fma_f32 v[100:101], v[100:101], v[96:97], v[96:97] op_sel:[0,1,0] op_sel_hi:[1,1,0]
  v_pk_fma_f32 v[102:103], v[102:103], v[96:97], v[96:97] op_sel:[0,1,0] op_sel_hi:[1,1,0]
  v_pk_mul_f32 v[100:101], v[100:101], v[196:197]
  v_pk_mul_f32 v[102:103], v[102:103], v[198:199]
  v_exp_f32 v100, v100
  v_exp_f32 v101, v101
  v_exp_f32 v102, v102
  v_exp_f32 v103, v103
  v_pk_add_f32 v[100:101], v[100:101], v[98:99] op_sel_hi:[1,0]
  v_pk_add_f32 v[102:103], v[102:103], v[98:99] op_sel_hi:[1,0]
  v_rcp_f32 v100, v100
  v_rcp_f32 v101, v101
  v_rcp_f32 v102, v102
  v_rcp_f32 v103, v103
  v_pk_mul_f32 v[196:197], v[196:197], v[100:101]
  v_pk_mul_f32 v[198:199], v[198:199], v[102:103]
  v_cvt_pk_bf16_f32 v112, v196, v197
  v_cvt_pk_bf16_f32 v113, v198, v199
  v_pk_fma_f32 v[104:105], v[52:53], v[90:91], v[80:81] op_sel:[0,0,0] op_sel_hi:[1,0,1] neg_lo:[0,1,0] neg_hi:[0,1,0]
  v_pk_fma_f32 v[106:107], v[54:55], v[90:91], v[82:83] op_sel:[0,0,0] op_sel_hi:[1,0,1] neg_lo:[0,1,0] neg_hi:[0,1,0]
  v_pk_fma_f32 v[212:213], v[212:213], v[90:91], v[104:105] op_sel:[0,1,0] op_sel_hi:[1,1,1]
  v_pk_fma_f32 v[214:215], v[214:215], v[90:91], v[106:107] op_sel:[0,1,0] op_sel_hi:[1,1,1]
  v_pk_mul_f32 v[104:105], v[212:213], v[212:213]
  v_pk_mul_f32 v[106:107], v[214:215], v[214:215]
  v_pk_fma_f32 v[104:105], v[104:105], v[96:97], v[96:97] op_sel:[0,1,0] op_sel_hi:[1,1,0]
  v_pk_fma_f32 v[106:107], v[106:107], v[96:97], v[96:97] op_sel:[0,1,0] op_sel_hi:[1,1,0]
  v_pk_mul_f32 v[104:105], v[104:105], v[212:213]
  v_pk_mul_f32 v[106:107], v[106:107], v[214:215]
  v_exp_f32 v104, v104
  v_exp_f32 v105, v105
  v_exp_f32 v106, v106
  v_exp_f32 v107, v107
  v_pk_add_f32 v[104:105], v[104:105], v[98:99] op_sel_hi:[1,0]
  v_pk_add_f32 v[106:107], v[106:107], v[98:99] op_sel_hi:[1,0]
  v_rcp_f32 v104, v104
  v_rcp_f32 v105, v105
  v_rcp_f32 v106, v106
  v_rcp_f32 v107, v107
  v_pk_mul_f32 v[212:213], v[212:213], v[104:105]
  v_pk_mul_f32 v[214:215], v[214:215], v[106:107]
  v_cvt_pk_bf16_f32 v114, v212, v213
  v_cvt_pk_bf16_f32 v115, v214, v215
  s_add_u32 s3, s10, 165888
  s_nop 0
  v_permlane16_swap_b32 v112, v114
  v_permlane16_swap_b32 v113, v115
  buffer_store_dwordx4 v[112:115], v12, s[44:47], s3 offen sc1
  v_pk_fma_f32 v[100:101], v[40:41], v[92:93], v[68:69] op_sel:[0,0,0] op_sel_hi:[1,0,1] neg_lo:[0,1,0] neg_hi:[0,1,0]
  v_pk_fma_f32 v[102:103], v[42:43], v[92:93], v[70:71] op_sel:[0,0,0] op_sel_hi:[1,0,1] neg_lo:[0,1,0] neg_hi:[0,1,0]
  v_pk_fma_f32 v[168:169], v[168:169], v[92:93], v[100:101] op_sel:[0,1,0] op_sel_hi:[1,1,1]
  v_pk_fma_f32 v[170:171], v[170:171], v[92:93], v[102:103] op_sel:[0,1,0] op_sel_hi:[1,1,1]
  v_pk_mul_f32 v[100:101], v[168:169], v[168:169]
  v_pk_mul_f32 v[102:103], v[170:171], v[170:171]
  v_pk_fma_f32 v[100:101], v[100:101], v[96:97], v[96:97] op_sel:[0,1,0] op_sel_hi:[1,1,0]
  v_pk_fma_f32 v[102:103], v[102:103], v[96:97], v[96:97] op_sel:[0,1,0] op_sel_hi:[1,1,0]
  v_pk_mul_f32 v[100:101], v[100:101], v[168:169]
  v_pk_mul_f32 v[102:103], v[102:103], v[170:171]
  v_exp_f32 v100, v100
  v_exp_f32 v101, v101
  v_exp_f32 v102, v102
  v_exp_f32 v103, v103
  v_pk_add_f32 v[100:101], v[100:101], v[98:99] op_sel_hi:[1,0]
  v_pk_add_f32 v[102:103], v[102:103], v[98:99] op_sel_hi:[1,0]
  v_rcp_f32 v100, v100
  v_rcp_f32 v101, v101
  v_rcp_f32 v102, v102
  v_rcp_f32 v103, v103
  v_pk_mul_f32 v[168:169], v[168:169], v[100:101]
  v_pk_mul_f32 v[170:171], v[170:171], v[102:103]
  v_cvt_pk_bf16_f32 v116, v168, v169
  v_cvt_pk_bf16_f32 v117, v170, v171
  v_pk_fma_f32 v[104:105], v[44:45], v[92:93], v[72:73] op_sel:[0,0,0] op_sel_hi:[1,0,1] neg_lo:[0,1,0] neg_hi:[0,1,0]
  v_pk_fma_f32 v[106:107], v[46:47], v[92:93], v[74:75] op_sel:[0,0,0] op_sel_hi:[1,0,1] neg_lo:[0,1,0] neg_hi:[0,1,0]
  v_pk_fma_f32 v[184:185], v[184:185], v[92:93], v[104:105] op_sel:[0,1,0] op_sel_hi:[1,1,1]
  v_pk_fma_f32 v[186:187], v[186:187], v[92:93], v[106:107] op_sel:[0,1,0] op_sel_hi:[1,1,1]
  v_pk_mul_f32 v[104:105], v[184:185], v[184:185]
  v_pk_mul_f32 v[106:107], v[186:187], v[186:187]
  v_pk_fma_f32 v[104:105], v[104:105], v[96:97], v[96:97] op_sel:[0,1,0] op_sel_hi:[1,1,0]
  v_pk_fma_f32 v[106:107], v[106:107], v[96:97], v[96:97] op_sel:[0,1,0] op_sel_hi:[1,1,0]
  v_pk_mul_f32 v[104:105], v[104:105], v[184:185]
  v_pk_mul_f32 v[106:107], v[106:107], v[186:187]
  v_exp_f32 v104, v104
  v_exp_f32 v105, v105
  v_exp_f32 v106, v106
  v_exp_f32 v107, v107
  v_pk_add_f32 v[104:105], v[104:105], v[98:99] op_sel_hi:[1,0]
  v_pk_add_f32 v[106:107], v[106:107], v[98:99] op_sel_hi:[1,0]
  v_rcp_f32 v104, v104
  v_rcp_f32 v105, v105
  v_rcp_f32 v106, v106
  v_rcp_f32 v107, v107
  v_pk_mul_f32 v[184:185], v[184:185], v[104:105]
  v_pk_mul_f32 v[186:187], v[186:187], v[106:107]
  v_cvt_pk_bf16_f32 v118, v184, v185
  v_cvt_pk_bf16_f32 v119, v186, v187
  s_add_u32 s3, s10, 278528
  s_nop 0
  v_permlane16_swap_b32 v116, v118
  v_permlane16_swap_b32 v117, v119
  buffer_store_dwordx4 v[116:119], v12, s[44:47], s3 offen sc1
  v_pk_fma_f32 v[100:101], v[48:49], v[92:93], v[76:77] op_sel:[0,0,0] op_sel_hi:[1,0,1] neg_lo:[0,1,0] neg_hi:[0,1,0]
  v_pk_fma_f32 v[102:103], v[50:51], v[92:93], v[78:79] op_sel:[0,0,0] op_sel_hi:[1,0,1] neg_lo:[0,1,0] neg_hi:[0,1,0]
  v_pk_fma_f32 v[200:201], v[200:201], v[92:93], v[100:101] op_sel:[0,1,0] op_sel_hi:[1,1,1]
  v_pk_fma_f32 v[202:203], v[202:203], v[92:93], v[102:103] op_sel:[0,1,0] op_sel_hi:[1,1,1]
  v_pk_mul_f32 v[100:101], v[200:201], v[200:201]
  v_pk_mul_f32 v[102:103], v[202:203], v[202:203]
  v_pk_fma_f32 v[100:101], v[100:101], v[96:97], v[96:97] op_sel:[0,1,0] op_sel_hi:[1,1,0]
  v_pk_fma_f32 v[102:103], v[102:103], v[96:97], v[96:97] op_sel:[0,1,0] op_sel_hi:[1,1,0]
  v_pk_mul_f32 v[100:101], v[100:101], v[200:201]
  v_pk_mul_f32 v[102:103], v[102:103], v[202:203]
  v_exp_f32 v100, v100
  v_exp_f32 v101, v101
  v_exp_f32 v102, v102
  v_exp_f32 v103, v103
  v_pk_add_f32 v[100:101], v[100:101], v[98:99] op_sel_hi:[1,0]
  v_pk_add_f32 v[102:103], v[102:103], v[98:99] op_sel_hi:[1,0]
  v_rcp_f32 v100, v100
  v_rcp_f32 v101, v101
  v_rcp_f32 v102, v102
  v_rcp_f32 v103, v103
  v_pk_mul_f32 v[200:201], v[200:201], v[100:101]
  v_pk_mul_f32 v[202:203], v[202:203], v[102:103]
  v_cvt_pk_bf16_f32 v120, v200, v201
  v_cvt_pk_bf16_f32 v121, v202, v203
  v_pk_fma_f32 v[104:105], v[52:53], v[92:93], v[80:81] op_sel:[0,0,0] op_sel_hi:[1,0,1] neg_lo:[0,1,0] neg_hi:[0,1,0]
  v_pk_fma_f32 v[106:107], v[54:55], v[92:93], v[82:83] op_sel:[0,0,0] op_sel_hi:[1,0,1] neg_lo:[0,1,0] neg_hi:[0,1,0]
  v_pk_fma_f32 v[216:217], v[216:217], v[92:93], v[104:105] op_sel:[0,1,0] op_sel_hi:[1,1,1]
  v_pk_fma_f32 v[218:219], v[218:219], v[92:93], v[106:107] op_sel:[0,1,0] op_sel_hi:[1,1,1]
  v_pk_mul_f32 v[104:105], v[216:217], v[216:217]
  v_pk_mul_f32 v[106:107], v[218:219], v[218:219]
  v_pk_fma_f32 v[104:105], v[104:105], v[96:97], v[96:97] op_sel:[0,1,0] op_sel_hi:[1,1,0]
  v_pk_fma_f32 v[106:107], v[106:107], v[96:97], v[96:97] op_sel:[0,1,0] op_sel_hi:[1,1,0]
  v_pk_mul_f32 v[104:105], v[104:105], v[216:217]
  v_pk_mul_f32 v[106:107], v[106:107], v[218:219]
  v_exp_f32 v104, v104
  v_exp_f32 v105, v105
  v_exp_f32 v106, v106
  v_exp_f32 v107, v107
  v_pk_add_f32 v[104:105], v[104:105], v[98:99] op_sel_hi:[1,0]
  v_pk_add_f32 v[106:107], v[106:107], v[98:99] op_sel_hi:[1,0]
  v_rcp_f32 v104, v104
  v_rcp_f32 v105, v105
  v_rcp_f32 v106, v106
  v_rcp_f32 v107, v107
  v_pk_mul_f32 v[216:217], v[216:217], v[104:105]
  v_pk_mul_f32 v[218:219], v[218:219], v[106:107]
  v_cvt_pk_bf16_f32 v122, v216, v217
  v_cvt_pk_bf16_f32 v123, v218, v219
  s_add_u32 s3, s10, 280576
  s_nop 0
  v_permlane16_swap_b32 v120, v122
  v_permlane16_swap_b32 v121, v123
  buffer_store_dwordx4 v[120:123], v12, s[44:47], s3 offen sc1
  v_pk_fma_f32 v[100:101], v[40:41], v[94:95], v[68:69] op_sel:[0,0,0] op_sel_hi:[1,0,1] neg_lo:[0,1,0] neg_hi:[0,1,0]
  v_pk_fma_f32 v[102:103], v[42:43], v[94:95], v[70:71] op_sel:[0,0,0] op_sel_hi:[1,0,1] neg_lo:[0,1,0] neg_hi:[0,1,0]
  v_pk_fma_f32 v[172:173], v[172:173], v[94:95], v[100:101] op_sel:[0,1,0] op_sel_hi:[1,1,1]
  v_pk_fma_f32 v[174:175], v[174:175], v[94:95], v[102:103] op_sel:[0,1,0] op_sel_hi:[1,1,1]
  v_pk_mul_f32 v[100:101], v[172:173], v[172:173]
  v_pk_mul_f32 v[102:103], v[174:175], v[174:175]
  v_pk_fma_f32 v[100:101], v[100:101], v[96:97], v[96:97] op_sel:[0,1,0] op_sel_hi:[1,1,0]
  v_pk_fma_f32 v[102:103], v[102:103], v[96:97], v[96:97] op_sel:[0,1,0] op_sel_hi:[1,1,0]
  v_pk_mul_f32 v[100:101], v[100:101], v[172:173]
  v_pk_mul_f32 v[102:103], v[102:103], v[174:175]
  v_exp_f32 v100, v100
  v_exp_f32 v101, v101
  v_exp_f32 v102, v102
  v_exp_f32 v103, v103
  v_pk_add_f32 v[100:101], v[100:101], v[98:99] op_sel_hi:[1,0]
  v_pk_add_f32 v[102:103], v[102:103], v[98:99] op_sel_hi:[1,0]
  v_rcp_f32 v100, v100
  v_rcp_f32 v101, v101
  v_rcp_f32 v102, v102
  v_rcp_f32 v103, v103
  v_pk_mul_f32 v[172:173], v[172:173], v[100:101]
  v_pk_mul_f32 v[174:175], v[174:175], v[102:103]
  v_cvt_pk_bf16_f32 v108, v172, v173
  v_cvt_pk_bf16_f32 v109, v174, v175
  v_pk_fma_f32 v[104:105], v[44:45], v[94:95], v[72:73] op_sel:[0,0,0] op_sel_hi:[1,0,1] neg_lo:[0,1,0] neg_hi:[0,1,0]
  v_pk_fma_f32 v[106:107], v[46:47], v[94:95], v[74:75] op_sel:[0,0,0] op_sel_hi:[1,0,1] neg_lo:[0,1,0] neg_hi:[0,1,0]
  v_pk_fma_f32 v[188:189], v[188:189], v[94:95], v[104:105] op_sel:[0,1,0] op_sel_hi:[1,1,1]
  v_pk_fma_f32 v[190:191], v[190:191], v[94:95], v[106:107] op_sel:[0,1,0] op_sel_hi:[1,1,1]
  v_pk_mul_f32 v[104:105], v[188:189], v[188:189]
  v_pk_mul_f32 v[106:107], v[190:191], v[190:191]
  v_pk_fma_f32 v[104:105], v[104:105], v[96:97], v[96:97] op_sel:[0,1,0] op_sel_hi:[1,1,0]
  v_pk_fma_f32 v[106:107], v[106:107], v[96:97], v[96:97] op_sel:[0,1,0] op_sel_hi:[1,1,0]
  v_pk_mul_f32 v[104:105], v[104:105], v[188:189]
  v_pk_mul_f32 v[106:107], v[106:107], v[190:191]
  v_exp_f32 v104, v104
  v_exp_f32 v105, v105
  v_exp_f32 v106, v106
  v_exp_f32 v107, v107
  v_pk_add_f32 v[104:105], v[104:105], v[98:99] op_sel_hi:[1,0]
  v_pk_add_f32 v[106:107], v[106:107], v[98:99] op_sel_hi:[1,0]
  v_rcp_f32 v104, v104
  v_rcp_f32 v105, v105
  v_rcp_f32 v106, v106
  v_rcp_f32 v107, v107
  v_pk_mul_f32 v[188:189], v[188:189], v[104:105]
  v_pk_mul_f32 v[190:191], v[190:191], v[106:107]
  v_cvt_pk_bf16_f32 v110, v188, v189
  v_cvt_pk_bf16_f32 v111, v190, v191
  s_add_u32 s3, s10, 393216
  s_nop 0
  v_permlane16_swap_b32 v108, v110
  v_permlane16_swap_b32 v109, v111
  buffer_store_dwordx4 v[108:111], v12, s[44:47], s3 offen sc1
  v_pk_fma_f32 v[100:101], v[48:49], v[94:95], v[76:77] op_sel:[0,0,0] op_sel_hi:[1,0,1] neg_lo:[0,1,0] neg_hi:[0,1,0]
  v_pk_fma_f32 v[102:103], v[50:51], v[94:95], v[78:79] op_sel:[0,0,0] op_sel_hi:[1,0,1] neg_lo:[0,1,0] neg_hi:[0,1,0]
  v_pk_fma_f32 v[204:205], v[204:205], v[94:95], v[100:101] op_sel:[0,1,0] op_sel_hi:[1,1,1]
  v_pk_fma_f32 v[206:207], v[206:207], v[94:95], v[102:103] op_sel:[0,1,0] op_sel_hi:[1,1,1]
  v_pk_mul_f32 v[100:101], v[204:205], v[204:205]
  v_pk_mul_f32 v[102:103], v[206:207], v[206:207]
  v_pk_fma_f32 v[100:101], v[100:101], v[96:97], v[96:97] op_sel:[0,1,0] op_sel_hi:[1,1,0]
  v_pk_fma_f32 v[102:103], v[102:103], v[96:97], v[96:97] op_sel:[0,1,0] op_sel_hi:[1,1,0]
  v_pk_mul_f32 v[100:101], v[100:101], v[204:205]
  v_pk_mul_f32 v[102:103], v[102:103], v[206:207]
  v_exp_f32 v100, v100
  v_exp_f32 v101, v101
  v_exp_f32 v102, v102
  v_exp_f32 v103, v103
  v_pk_add_f32 v[100:101], v[100:101], v[98:99] op_sel_hi:[1,0]
  v_pk_add_f32 v[102:103], v[102:103], v[98:99] op_sel_hi:[1,0]
  v_rcp_f32 v100, v100
  v_rcp_f32 v101, v101
  v_rcp_f32 v102, v102
  v_rcp_f32 v103, v103
  v_pk_mul_f32 v[204:205], v[204:205], v[100:101]
  v_pk_mul_f32 v[206:207], v[206:207], v[102:103]
  v_cvt_pk_bf16_f32 v112, v204, v205
  v_cvt_pk_bf16_f32 v113, v206, v207
  v_pk_fma_f32 v[104:105], v[52:53], v[94:95], v[80:81] op_sel:[0,0,0] op_sel_hi:[1,0,1] neg_lo:[0,1,0] neg_hi:[0,1,0]
  v_pk_fma_f32 v[106:107], v[54:55], v[94:95], v[82:83] op_sel:[0,0,0] op_sel_hi:[1,0,1] neg_lo:[0,1,0] neg_hi:[0,1,0]
  v_pk_fma_f32 v[220:221], v[220:221], v[94:95], v[104:105] op_sel:[0,1,0] op_sel_hi:[1,1,1]
  v_pk_fma_f32 v[222:223], v[222:223], v[94:95], v[106:107] op_sel:[0,1,0] op_sel_hi:[1,1,1]
  v_pk_mul_f32 v[104:105], v[220:221], v[220:221]
  v_pk_mul_f32 v[106:107], v[222:223], v[222:223]
  v_pk_fma_f32 v[104:105], v[104:105], v[96:97], v[96:97] op_sel:[0,1,0] op_sel_hi:[1,1,0]
  v_pk_fma_f32 v[106:107], v[106:107], v[96:97], v[96:97] op_sel:[0,1,0] op_sel_hi:[1,1,0]
  v_pk_mul_f32 v[104:105], v[104:105], v[220:221]
  v_pk_mul_f32 v[106:107], v[106:107], v[222:223]
  v_exp_f32 v104, v104
  v_exp_f32 v105, v105
  v_exp_f32 v106, v106
  v_exp_f32 v107, v107
  v_pk_add_f32 v[104:105], v[104:105], v[98:99] op_sel_hi:[1,0]
  v_pk_add_f32 v[106:107], v[106:107], v[98:99] op_sel_hi:[1,0]
  v_rcp_f32 v104, v104
  v_rcp_f32 v105, v105
  v_rcp_f32 v106, v106
  v_rcp_f32 v107, v107
  v_pk_mul_f32 v[220:221], v[220:221], v[104:105]
  v_pk_mul_f32 v[222:223], v[222:223], v[106:107]
  v_cvt_pk_bf16_f32 v114, v220, v221
  v_cvt_pk_bf16_f32 v115, v222, v223
  s_add_u32 s3, s10, 395264
  s_nop 0
  v_permlane16_swap_b32 v112, v114
  v_permlane16_swap_b32 v113, v115
  buffer_store_dwordx4 v[112:115], v12, s[44:47], s3 offen sc1
  s_waitcnt vmcnt(0) lgkmcnt(0)
  s_barrier
  s_add_u32 s97, s97, 1
  s_branch L_w2_body
L_w1_c1:
L_w2_c0:
L_w2_body:
  s_cmp_ge_u32 s2, 256
  s_cbranch_scc1 L_w2_end
  v_lshrrev_b32 v2, 6, v0
  v_and_b32 v1, 63, v0
  v_readfirstlane_b32 s70, v2
  s_and_b32 s3, s2, 7
  s_lshr_b32 s99, s2, 3
  s_and_b32 s5, s3, 3
  s_lshl_b32 s5, s5, 2
  s_and_b32 s6, s99, 3
  s_add_u32 s68, s5, s6
  s_lshr_b32 s5, s3, 2
  s_lshr_b32 s78, s99, 2
  s_lshl1_add_u32 s69, s78, s5
  s_add_u32 s3, s68, s78
  s_lshl_b32 s3, s3, 3
  s_lshl_b32 s85, 0xffff02, s3
  s_sub_u32 s3, 0, s3
  s_lshr_b32 s3, 0xffff02, s3
  s_or_b32 s85, s85, s3
  s_cmp_lt_u32 s70, 4
  s_cbranch_scc1 L_w2_compute
L_w2_loader:
  v_and_b32 v2, 3, v1
  v_lshlrev_b32 v2, 3, v2
  v_bfe_i32 v16, s85, v2, 8
  s_and_b32 s3, s68, 3
  s_mul_i32 s4, s3, 4
  v_add3_u32 v3, v16, v1, s4
  v_subrev_u32 v3, 20, v3
  v_and_b32 v3, 15, v3
  s_mul_i32 s3, s3, 1
  v_add3_u32 v16, v16, v1, 20
  s_bitcmp1_b32 s69, 0
  s_cselect_b32 s4, 20, 0
  v_subrev_u32 v2, 20, v16
  v_min_u32 v16, v16, v2
  v_subrev_u32 v2, 20, v16
  v_min_u32 v16, v16, v2
  v_cmp_gt_u32 vcc, 4, v16
  v_add_u32 v2, s3, v16
  v_subrev_u32 v17, 4, v2
  v_min_u32 v2, v17, v2
  v_cndmask_b32 v16, v16, v2, vcc
  v_cmp_gt_u32 vcc, 20, v1
  v_add_u32 v16, s4, v16
  v_add_u32 v3, 40, v3
  v_cndmask_b32 v3, v3, v16, vcc
  v_lshlrev_b32 v16, 17, v3
  s_add_u32 s9, s70, s68
  s_and_b32 s9, s9, 3
  s_lshl_b32 s77, s9, 11
  v_and_b32 v10, 7, v1
  v_lshrrev_b32 v3, 3, v1
  s_lshl_b32 s10, s9, 4
  v_add_u32 v3, s10, v3
  v_mul_u32_u24 v3, 2048, v3
  v_lshrrev_b32 v2, 3, v1
  v_and_b32 v2, 2, v2
  v_xor_b32 v2, v2, v10
  s_lshl_b32 s10, s69, 7
  v_add_u32 v3, s10, v3
  v_lshl_add_u32 v8, v2, 4, v3
  v_xor_b32 v2, 4, v2
  v_add_u32 v3, 16384, v3
  v_lshl_add_u32 v9, v2, 4, v3
  s_mov_b32 s40, s28
  s_and_b32 s41, s29, 0xffff
  s_mov_b32 s42, 7340032
  s_mov_b32 s43, 0x00020000
  s_bitcmp1_b32 s69, 0
  s_mov_b32 s76, 128
  s_cselect_b32 s76, -128, s76
  v_readlane_b32 s74, v16, 0
  s_add_u32 m0, s77, 0
  s_add_u32 s4, s74, s76
  buffer_load_dwordx4 v8, s[40:43], s4 offen lds
  s_add_u32 m0, s77, 1024
  s_nop 0
  buffer_load_dwordx4 v9, s[40:43], s4 offen lds
  s_add_u32 m0, s77, 8192
  s_add_u32 s4, s74, 0
  buffer_load_dwordx4 v8, s[40:43], s4 offen lds
  s_add_u32 m0, s77, 9216
  s_nop 0
  buffer_load_dwordx4 v9, s[40:43], s4 offen lds
  v_readlane_b32 s74, v16, 1
  s_add_u32 m0, s77, 16384
  s_add_u32 s4, s74, s76
  buffer_load_dwordx4 v8, s[40:43], s4 offen lds
  s_add_u32 m0, s77, 17408
  s_nop 0
  buffer_load_dwordx4 v9, s[40:43], s4 offen lds
  s_add_u32 m0, s77, 24576
  s_add_u32 s4, s74, 0
  buffer_load_dwordx4 v8, s[40:43], s4 offen lds
  s_add_u32 m0, s77, 25600
  s_nop 0
  buffer_load_dwordx4 v9, s[40:43], s4 offen lds
  v_readlane_b32 s74, v16, 2
  s_add_u32 m0, s77, 32768
  s_add_u32 s4, s74, s76
  buffer_load_dwordx4 v8, s[40:43], s4 offen lds
  s_add_u32 m0, s77, 33792
  s_nop 0
  buffer_load_dwordx4 v9, s[40:43], s4 offen lds
  s_add_u32 m0, s77, 40960
  s_add_u32 s4, s74, 0
  buffer_load_dwordx4 v8, s[40:43], s4 offen lds
  s_add_u32 m0, s77, 41984
  s_nop 0
  buffer_load_dwordx4 v9, s[40:43], s4 offen lds
  v_readlane_b32 s74, v16, 3
  s_add_u32 m0, s77, 49152
  s_add_u32 s4, s74, s76
  buffer_load_dwordx4 v8, s[40:43], s4 offen lds
  s_add_u32 m0, s77, 50176
  s_nop 0
  buffer_load_dwordx4 v9, s[40:43], s4 offen lds
  s_add_u32 m0, s77, 57344
  s_add_u32 s4, s74, 0
  buffer_load_dwordx4 v8, s[40:43], s4 offen lds
  s_add_u32 m0, s77, 58368
  s_nop 0
  buffer_load_dwordx4 v9, s[40:43], s4 offen lds
  v_readlane_b32 s74, v16, 4
  s_add_u32 m0, s77, 65536
  s_add_u32 s4, s74, s76
  buffer_load_dwordx4 v8, s[40:43], s4 offen lds
  s_add_u32 m0, s77, 66560
  s_nop 0
  buffer_load_dwordx4 v9, s[40:43], s4 offen lds
  s_add_u32 m0, s77, 73728
  s_add_u32 s4, s74, 0
  buffer_load_dwordx4 v8, s[40:43], s4 offen lds
  s_add_u32 m0, s77, 74752
  s_nop 0
  buffer_load_dwordx4 v9, s[40:43], s4 offen lds
  s_add_u32 s44, s22, 41943040
  s_addc_u32 s45, s23, 0
  s_and_b32 s45, s45, 0xffff
  s_mov_b32 s46, 524288
  s_mov_b32 s47, 0x00020000
  s_lshl4_add_u32 s3, s97, s68
  s_and_b32 s4, s69, 15
  s_lshl4_add_u32 s3, s3, s4
  s_lshl_b32 s3, s3, 7
  s_sub_u32 s3, s3, 32768
  v_lshlrev_b32 v11, 7, v1
  v_and_b32 v2, 15, v1
  v_lshlrev_b32 v2, 2, v2
  v_mov_b32 v3, 1
  s_mov_b32 s79, 0x100000
  s_cmp_lg_u32 s70, 4
  s_barrier
  s_cbranch_scc1 L_w2_nofl
  s_mov_b32 exec_lo, 0xffff
  s_mov_b32 exec_hi, 0
  buffer_store_dword v3, v11, s[44:47], s87 offen sc1
  s_mov_b64 exec, -1
L_w2_nofl:
  s_mov_b32 s5, s3
  v_readlane_b32 s74, v16, 5
  s_add_u32 m0, s77, 81920
  s_add_u32 s4, s74, s76
  buffer_load_dwordx4 v8, s[40:43], s4 offen lds
  s_add_u32 m0, s77, 82944
  s_nop 0
  buffer_load_dwordx4 v9, s[40:43], s4 offen lds
  s_add_u32 m0, s77, 90112
  s_add_u32 s4, s74, 0
  buffer_load_dwordx4 v8, s[40:43], s4 offen lds
  s_add_u32 m0, s77, 91136
  s_nop 0
  buffer_load_dwordx4 v9, s[40:43], s4 offen lds
  v_readlane_b32 s74, v16, 6
  s_add_u32 m0, s77, 98304
  s_add_u32 s4, s74, s76
  buffer_load_dwordx4 v8, s[40:43], s4 offen lds
  s_add_u32 m0, s77, 99328
  s_nop 0
  buffer_load_dwordx4 v9, s[40:43], s4 offen lds
  s_add_u32 m0, s77, 106496
  s_add_u32 s4, s74, 0
  buffer_load_dwordx4 v8, s[40:43], s4 offen lds
  s_add_u32 m0, s77, 107520
  s_nop 0
  buffer_load_dwordx4 v9, s[40:43], s4 offen lds
  v_readlane_b32 s74, v16, 7
  s_add_u32 m0, s77, 114688
  s_add_u32 s4, s74, s76
  buffer_load_dwordx4 v8, s[40:43], s4 offen lds
  s_add_u32 m0, s77, 115712
  s_nop 0
  buffer_load_dwordx4 v9, s[40:43], s4 offen lds
  s_add_u32 m0, s77, 122880
  s_add_u32 s4, s74, 0
  buffer_load_dwordx4 v8, s[40:43], s4 offen lds
  s_add_u32 m0, s77, 123904
  s_nop 0
  buffer_load_dwordx4 v9, s[40:43], s4 offen lds
  v_readlane_b32 s74, v16, 8
  s_add_u32 m0, s77, 131072
  s_add_u32 s4, s74, s76
  buffer_load_dwordx4 v8, s[40:43], s4 offen lds
  s_add_u32 m0, s77, 132096
  s_nop 0
  buffer_load_dwordx4 v9, s[40:43], s4 offen lds
  s_add_u32 m0, s77, 139264
  s_add_u32 s4, s74, 0
  buffer_load_dwordx4 v8, s[40:43], s4 offen lds
  s_add_u32 m0, s77, 140288
  s_nop 0
  buffer_load_dwordx4 v9, s[40:43], s4 offen lds
  v_readlane_b32 s74, v16, 9
  s_add_u32 m0, s77, 147456
  s_add_u32 s4, s74, s76
  buffer_load_dwordx4 v8, s[40:43], s4 offen lds
  s_add_u32 m0, s77, 148480
  s_nop 0
  buffer_load_dwordx4 v9, s[40:43], s4 offen lds
  s_add_u32 m0, s77, 155648
  s_add_u32 s4, s74, 0
  buffer_load_dwordx4 v8, s[40:43], s4 offen lds
  s_add_u32 m0, s77, 156672
  s_nop 0
  buffer_load_dwordx4 v9, s[40:43], s4 offen lds
  s_mov_b32 s3, s5
  s_cmp_lg_u32 s70, 4
  s_cbranch_scc1 L_w2_dep
L_w2_poll:
  buffer_load_dword v3, v2, s[44:47], s3 offen sc1
  s_sub_u32 s79, s79, 1
  s_cbranch_scc1 L_w2_dep
  s_waitcnt vmcnt(0)
  v_cmp_ne_u32 vcc, 1, v3
  s_cbranch_vccnz L_w2_poll
L_w2_dep:
  s_waitcnt vmcnt(30) lgkmcnt(0)
  s_barrier
  s_waitcnt vmcnt(22)
  s_barrier
  v_readlane_b32 s74, v16, 10
  s_add_u32 m0, s77, 0
  s_add_u32 s4, s74, s76
  buffer_load_dwordx4 v8, s[40:43], s4 offen lds
  s_add_u32 m0, s77, 1024
  s_nop 0
  buffer_load_dwordx4 v9, s[40:43], s4 offen lds
  s_waitcnt vmcnt(4)
  s_add_u32 m0, s77, 8192
  s_add_u32 s4, s74, 0
  buffer_load_dwordx4 v8, s[40:43], s4 offen lds
  s_add_u32 m0, s77, 9216
  s_nop 0
  buffer_load_dwordx4 v9, s[40:43], s4 offen lds
  s_waitcnt vmcnt(4)
  v_readlane_b32 s74, v16, 11
  s_add_u32 m0, s77, 16384
  s_add_u32 s4, s74, s76
  buffer_load_dwordx4 v8, s[40:43], s4 offen lds
  s_add_u32 m0, s77, 17408
  s_nop 0
  buffer_load_dwordx4 v9, s[40:43], s4 offen lds
  s_waitcnt vmcnt(4)
  s_add_u32 m0, s77, 24576
  s_add_u32 s4, s74, 0
  buffer_load_dwordx4 v8, s[40:43], s4 offen lds
  s_add_u32 m0, s77, 25600
  s_nop 0
  buffer_load_dwordx4 v9, s[40:43], s4 offen lds
  s_waitcnt vmcnt(22)
  s_barrier
  v_readlane_b32 s74, v16, 12
  s_add_u32 m0, s77, 32768
  s_add_u32 s4, s74, s76
  buffer_load_dwordx4 v8, s[40:43], s4 offen lds
  s_add_u32 m0, s77, 33792
  s_nop 0
  buffer_load_dwordx4 v9, s[40:43], s4 offen lds
  s_waitcnt vmcnt(4)
  s_add_u32 m0, s77, 40960
  s_add_u32 s4, s74, 0
  buffer_load_dwordx4 v8, s[40:43], s4 offen lds
  s_add_u32 m0, s77, 41984
  s_nop 0
  buffer_load_dwordx4 v9, s[40:43], s4 offen lds
  s_waitcnt vmcnt(4)
  v_readlane_b32 s74, v16, 13
  s_add_u32 m0, s77, 49152
  s_add_u32 s4, s74, s76
  buffer_load_dwordx4 v8, s[40:43], s4 offen lds
  s_add_u32 m0, s77, 50176
  s_nop 0
  buffer_load_dwordx4 v9, s[40:43], s4 offen lds
  s_waitcnt vmcnt(4)
  s_add_u32 m0, s77, 57344
  s_add_u32 s4, s74, 0
  buffer_load_dwordx4 v8, s[40:43], s4 offen lds
  s_add_u32 m0, s77, 58368
  s_nop 0
  buffer_load_dwordx4 v9, s[40:43], s4 offen lds
  s_waitcnt vmcnt(22)
  s_barrier
  v_readlane_b32 s74, v16, 14
  s_add_u32 m0, s77, 65536
  s_add_u32 s4, s74, s76
  buffer_load_dwordx4 v8, s[40:43], s4 offen lds
  s_add_u32 m0, s77, 66560
  s_nop 0
  buffer_load_dwordx4 v9, s[40:43], s4 offen lds
  s_waitcnt vmcnt(4)
  s_add_u32 m0, s77, 73728
  s_add_u32 s4, s74, 0
  buffer_load_dwordx4 v8, s[40:43], s4 offen lds
  s_add_u32 m0, s77, 74752
  s_nop 0
  buffer_load_dwordx4 v9, s[40:43], s4 offen lds
  s_waitcnt vmcnt(4)
  v_readlane_b32 s74, v16, 15
  s_add_u32 m0, s77, 81920
  s_add_u32 s4, s74, s76
  buffer_load_dwordx4 v8, s[40:43], s4 offen lds
  s_add_u32 m0, s77, 82944
  s_nop 0
  buffer_load_dwordx4 v9, s[40:43], s4 offen lds
  s_waitcnt vmcnt(4)
  s_add_u32 m0, s77, 90112
  s_add_u32 s4, s74, 0
  buffer_load_dwordx4 v8, s[40:43], s4 offen lds
  s_add_u32 m0, s77, 91136
  s_nop 0
  buffer_load_dwordx4 v9, s[40:43], s4 offen lds
  s_waitcnt vmcnt(22)
  s_barrier
  v_readlane_b32 s74, v16, 16
  s_add_u32 m0, s77, 98304
  s_add_u32 s4, s74, s76
  buffer_load_dwordx4 v8, s[40:43], s4 offen lds
  s_add_u32 m0, s77, 99328
  s_nop 0
  buffer_load_dwordx4 v9, s[40:43], s4 offen lds
  s_waitcnt vmcnt(4)
  s_add_u32 m0, s77, 106496
  s_add_u32 s4, s74, 0
  buffer_load_dwordx4 v8, s[40:43], s4 offen lds
  s_add_u32 m0, s77, 107520
  s_nop 0
  buffer_load_dwordx4 v9, s[40:43], s4 offen lds
  s_waitcnt vmcnt(4)
  v_readlane_b32 s74, v16, 17
  s_add_u32 m0, s77, 114688
  s_add_u32 s4, s74, s76
  buffer_load_dwordx4 v8, s[40:43], s4 offen lds
  s_add_u32 m0, s77, 115712
  s_nop 0
  buffer_load_dwordx4 v9, s[40:43], s4 offen lds
  s_waitcnt vmcnt(4)
  s_add_u32 m0, s77, 122880
  s_add_u32 s4, s74, 0
  buffer_load_dwordx4 v8, s[40:43], s4 offen lds
  s_add_u32 m0, s77, 123904
  s_nop 0
  buffer_load_dwordx4 v9, s[40:43], s4 offen lds
  s_waitcnt vmcnt(22)
  s_barrier
  v_readlane_b32 s74, v16, 18
  s_add_u32 m0, s77, 131072
  s_add_u32 s4, s74, s76
  buffer_load_dwordx4 v8, s[40:43], s4 offen lds
  s_add_u32 m0, s77, 132096
  s_nop 0
  buffer_load_dwordx4 v9, s[40:43], s4 offen lds
  s_waitcnt vmcnt(4)
  s_add_u32 m0, s77, 139264
  s_add_u32 s4, s74, 0
  buffer_load_dwordx4 v8, s[40:43], s4 offen lds
  s_add_u32 m0, s77, 140288
  s_nop 0
  buffer_load_dwordx4 v9, s[40:43], s4 offen lds
  s_waitcnt vmcnt(4)
  v_readlane_b32 s74, v16, 19
  s_add_u32 m0, s77, 147456
  s_add_u32 s4, s74, s76
  buffer_load_dwordx4 v8, s[40:43], s4 offen lds
  s_add_u32 m0, s77, 148480
  s_nop 0
  buffer_load_dwordx4 v9, s[40:43], s4 offen lds
  s_waitcnt vmcnt(4)
  s_add_u32 m0, s77, 155648
  s_add_u32 s4, s74, 0
  buffer_load_dwordx4 v8, s[40:43], s4 offen lds
  s_add_u32 m0, s77, 156672
  s_nop 0
  buffer_load_dwordx4 v9, s[40:43], s4 offen lds
  s_waitcnt vmcnt(22)
  s_barrier
  v_readlane_b32 s74, v16, 20
  s_add_u32 m0, s77, 0
  s_add_u32 s4, s74, 0
  buffer_load_dwordx4 v8, s[40:43], s4 offen lds
  s_add_u32 m0, s77, 1024
  s_nop 0
  buffer_load_dwordx4 v9, s[40:43], s4 offen lds
  s_waitcnt vmcnt(4)
  v_readlane_b32 s74, v16, 21
  s_add_u32 m0, s77, 8192
  s_add_u32 s4, s74, 0
  buffer_load_dwordx4 v8, s[40:43], s4 offen lds
  s_add_u32 m0, s77, 9216
  s_nop 0
  buffer_load_dwordx4 v9, s[40:43], s4 offen lds
  s_waitcnt vmcnt(4)
  v_readlane_b32 s74, v16, 22
  s_add_u32 m0, s77, 16384
  s_add_u32 s4, s74, 0
  buffer_load_dwordx4 v8, s[40:43], s4 offen lds
  s_add_u32 m0, s77, 17408
  s_nop 0
  buffer_load_dwordx4 v9, s[40:43], s4 offen lds
  s_waitcnt vmcnt(4)
  v_readlane_b32 s74, v16, 23
  s_add_u32 m0, s77, 24576
  s_add_u32 s4, s74, 0
  buffer_load_dwordx4 v8, s[40:43], s4 offen lds
  s_add_u32 m0, s77, 25600
  s_nop 0
  buffer_load_dwordx4 v9, s[40:43], s4 offen lds
  s_waitcnt vmcnt(22)
  s_barrier
  v_readlane_b32 s74, v16, 24
  s_add_u32 m0, s77, 32768
  s_add_u32 s4, s74, 0
  buffer_load_dwordx4 v8, s[40:43], s4 offen lds
  s_add_u32 m0, s77, 33792
  s_nop 0
  buffer_load_dwordx4 v9, s[40:43], s4 offen lds
  s_waitcnt vmcnt(4)
  v_readlane_b32 s74, v16, 25
  s_add_u32 m0, s77, 40960
  s_add_u32 s4, s74, 0
  buffer_load_dwordx4 v8, s[40:43], s4 offen lds
  s_add_u32 m0, s77, 41984
  s_nop 0
  buffer_load_dwordx4 v9, s[40:43], s4 offen lds
  s_waitcnt vmcnt(4)
  v_readlane_b32 s74, v16, 26
  s_add_u32 m0, s77, 49152
  s_add_u32 s4, s74, 0
  buffer_load_dwordx4 v8, s[40:43], s4 offen lds
  s_add_u32 m0, s77, 50176
  s_nop 0
  buffer_load_dwordx4 v9, s[40:43], s4 offen lds
  s_waitcnt vmcnt(4)
  v_readlane_b32 s74, v16, 27
  s_add_u32 m0, s77, 57344
  s_add_u32 s4, s74, 0
  buffer_load_dwordx4 v8, s[40:43], s4 offen lds
  s_add_u32 m0, s77, 58368
  s_nop 0
  buffer_load_dwordx4 v9, s[40:43], s4 offen lds
  s_waitcnt vmcnt(22)
  s_barrier
  v_readlane_b32 s74, v16, 28
  s_add_u32 m0, s77, 65536
  s_add_u32 s4, s74, 0
  buffer_load_dwordx4 v8, s[40:43], s4 offen lds
  s_add_u32 m0, s77, 66560
  s_nop 0
  buffer_load_dwordx4 v9, s[40:43], s4 offen lds
  s_waitcnt vmcnt(4)
  v_readlane_b32 s74, v16, 29
  s_add_u32 m0, s77, 73728
  s_add_u32 s4, s74, 0
  buffer_load_dwordx4 v8, s[40:43], s4 offen lds
  s_add_u32 m0, s77, 74752
  s_nop 0
  buffer_load_dwordx4 v9, s[40:43], s4 offen lds
  s_waitcnt vmcnt(4)
  v_readlane_b32 s74, v16, 30
  s_add_u32 m0, s77, 81920
  s_add_u32 s4, s74, 0
  buffer_load_dwordx4 v8, s[40:43], s4 offen lds
  s_add_u32 m0, s77, 82944
  s_nop 0
  buffer_load_dwordx4 v9, s[40:43], s4 offen lds
  s_waitcnt vmcnt(4)
  v_readlane_b32 s74, v16, 31
  s_add_u32 m0, s77, 90112
  s_add_u32 s4, s74, 0
  buffer_load_dwordx4 v8, s[40:43], s4 offen lds
  s_add_u32 m0, s77, 91136
  s_nop 0
  buffer_load_dwordx4 v9, s[40:43], s4 offen lds
  s_waitcnt vmcnt(22)
  s_barrier
  v_readlane_b32 s74, v16, 32
  s_add_u32 m0, s77, 98304
  s_add_u32 s4, s74, 0
  buffer_load_dwordx4 v8, s[40:43], s4 offen lds
  s_add_u32 m0, s77, 99328
  s_nop 0
  buffer_load_dwordx4 v9, s[40:43], s4 offen lds
  s_waitcnt vmcnt(4)
  v_readlane_b32 s74, v16, 33
  s_add_u32 m0, s77, 106496
  s_add_u32 s4, s74, 0
  buffer_load_dwordx4 v8, s[40:43], s4 offen lds
  s_add_u32 m0, s77, 107520
  s_nop 0
  buffer_load_dwordx4 v9, s[40:43], s4 offen lds
  s_waitcnt vmcnt(4)
  v_readlane_b32 s74, v16, 34
  s_add_u32 m0, s77, 114688
  s_add_u32 s4, s74, 0
  buffer_load_dwordx4 v8, s[40:43], s4 offen lds
  s_add_u32 m0, s77, 115712
  s_nop 0
  buffer_load_dwordx4 v9, s[40:43], s4 offen lds
  s_waitcnt vmcnt(4)
  v_readlane_b32 s74, v16, 35
  s_add_u32 m0, s77, 122880
  s_add_u32 s4, s74, 0
  buffer_load_dwordx4 v8, s[40:43], s4 offen lds
  s_add_u32 m0, s77, 123904
  s_nop 0
  buffer_load_dwordx4 v9, s[40:43], s4 offen lds
  s_waitcnt vmcnt(18)
  s_barrier
  s_add_u32 s64, s22, 41943040
  s_addc_u32 s65, s23, 0
  s_and_b32 s65, s65, 0xffff
  s_mov_b32 s66, 524288
  s_mov_b32 s67, 0x00020000
  s_lshl4_add_u32 s6, s68, s69
  s_xor_b32 s6, s6, 1
  s_add_u32 s7, s96, 4
  s_lshl_b32 s7, s7, 8
  s_add_u32 s6, s6, s7
  s_lshl_b32 s6, s6, 8
  v_and_b32 v2, 3, v1
  v_lshlrev_b32 v2, 6, v2
  s_mov_b32 s79, 0x100000
  s_waitcnt vmcnt(8)
  s_barrier
  s_cmp_lg_u32 s70, 4
  s_cbranch_scc1 L_w2_xgo
  s_setprio 3
L_w2_xpoll:
  buffer_load_dword v5, v2, s[64:67], s6 offen sc1
  s_sub_u32 s79, s79, 1
  s_cbranch_scc1 L_w2_xgo
  s_waitcnt vmcnt(0)
  v_cmp_ne_u32 vcc, 1, v5
  s_cbranch_vccnz L_w2_xpoll
L_w2_xgo:
  s_setprio 0
  s_waitcnt vmcnt(0)
  s_barrier
  s_cmp_eq_u32 s96, 1
  s_cbranch_scc1 L_w2_end
  s_lshl_b32 s87, s97, 15
  s_lshl_b32 s4, s68, 11
  s_add_u32 s87, s87, s4
  s_lshl_b32 s4, s69, 2
  s_add_u32 s87, s87, s4
  s_mov_b32 s96, 1
  s_add_u32 s12, s22, 33554432
  s_addc_u32 s13, s23, 0
  s_add_u32 s34, s22, 67108864
  s_addc_u32 s35, s23, 0
  s_add_u32 s97, s97, 1
  s_branch L_attn_body
L_w2_end:
  s_endpgm
L_w2_compute:
  v_and_b32 v2, 3, v1
  v_lshlrev_b32 v2, 3, v2
  v_bfe_i32 v15, s85, v2, 8
  s_and_b32 s3, s68, 3
  s_mul_i32 s4, s3, 4
  v_add3_u32 v3, v15, v1, s4
  v_subrev_u32 v3, 20, v3
  v_and_b32 v3, 15, v3
  s_mul_i32 s3, s3, 1
  v_add3_u32 v15, v15, v1, 20
  s_bitcmp1_b32 s69, 0
  s_cselect_b32 s4, 20, 0
  v_subrev_u32 v2, 20, v15
  v_min_u32 v15, v15, v2
  v_subrev_u32 v2, 20, v15
  v_min_u32 v15, v15, v2
  v_cmp_gt_u32 vcc, 4, v15
  v_add_u32 v2, s3, v15
  v_subrev_u32 v16, 4, v2
  v_min_u32 v2, v16, v2
  v_cndmask_b32 v15, v15, v2, vcc
  v_cmp_gt_u32 vcc, 20, v1
  v_add_u32 v15, s4, v15
  v_add_u32 v3, 40, v3
  v_cndmask_b32 v3, v3, v15, vcc
  v_lshlrev_b32 v15, 11, v3
  v_and_b32 v3, 15, v1
  v_lshrrev_b32 v2, 4, v1
  s_lshl_b32 s8, s68, 7
  s_lshl_b32 s9, s70, 5
  s_add_u32 s8, s8, s9
  s_mul_i32 s9, s8, 7168
  v_lshl_add_u32 v4, v1, 4, s9
  v_add_u32 v5, 114688, v4
  v_add_u32 v13, s8, v3
  s_lshl_b32 s10, s69, 7
  v_lshl_add_u32 v14, v2, 3, s10
  v_and_b32 v16, 1, v2
  v_lshrrev_b32 v17, 1, v2
  v_lshlrev_b32 v16, 5, v16
  v_lshl_add_u32 v16, v17, 4, v16
  v_add_u32 v16, s10, v16
  s_cmp_eq_u32 s96, 0
  s_cselect_b32 s7, 128, 0
  s_add_u32 s7, s7, 2048
  v_mad_u32_u24 v12, v13, s7, v16
  v_lshl_add_u32 v18, v17, 4, v13
  v_lshlrev_b32 v18, 3, v18
  v_and_b32 v16, 1, v2
  v_lshl_add_u32 v18, v16, 2, v18
  s_lshl_b32 s10, s69, 14
  v_add_u32 v18, s10, v18
  v_bfe_u32 v6, v1, 2, 2
  v_lshl_add_u32 v6, v2, 3, v6
  v_lshlrev_b32 v6, 7, v6
  v_and_b32 v17, 3, v1
  v_lshl_add_u32 v6, v17, 3, v6
  v_bfe_u32 v17, v1, 3, 2
  v_lshl_add_u32 v6, v17, 5, v6
  v_xor_b32 v7, 32, v6
  v_xor_b32 v8, 64, v6
  v_xor_b32 v9, 96, v6
  s_mov_b32 s11, 0xffff0000
  s_mov_b32 s52, s30
  s_and_b32 s53, s31, 0xffff
  s_mov_b32 s54, 2048
  s_mov_b32 s55, 0x00020000
  buffer_load_dwordx2 v[192:193], v14, s[52:55], 0 offen offset:0
  buffer_load_dwordx2 v[194:195], v14, s[52:55], 0 offen offset:32
  buffer_load_dwordx2 v[196:197], v14, s[52:55], 0 offen offset:64
  buffer_load_dwordx2 v[198:199], v14, s[52:55], 0 offen offset:96
  s_add_u32 s36, s34, 8388608
  s_addc_u32 s37, s35, 0
  s_and_b32 s37, s37, 0xffff
  s_mov_b32 s38, 14680064
  s_mov_b32 s39, 0x00020000
  s_mov_b32 s44, s32
  s_and_b32 s45, s33, 0xffff
  s_mov_b32 s46, 4194304
  s_mov_b32 s47, 0x00020000
  s_add_u32 s48, s22, 33554432
  s_addc_u32 s49, s23, 0
  s_and_b32 s49, s49, 0xffff
  s_mov_b32 s50, 4194304
  s_mov_b32 s51, 0x00020000
  s_cmp_eq_u32 s96, 0
  s_cselect_b64 s[44:45], s[48:49], s[44:45]
  s_lshl_b32 s46, s7, 11
  s_add_u32 s56, s34, 24379392
  s_addc_u32 s57, s35, 0
  s_and_b32 s57, s57, 0xffff
  s_mov_b32 s58, 262144
  s_mov_b32 s59, 0x00020000
  s_mul_i32 s9, s8, 7168
  s_add_u32 s36, s36, s9
  s_addc_u32 s37, s37, 0x100000
  s_add_u32 s64, s36, 114688
  s_addc_u32 s65, s37, 0
  s_mov_b32 s38, 114688
  s_mov_b32 s39, 0x00800000
  s_mov_b32 s66, 114688
  s_mov_b32 s67, 0x00800000
  s_add_u32 s60, s34, 25165824
  s_addc_u32 s61, s35, 0
  s_and_b32 s61, s61, 0xffff
  s_mov_b32 s62, 4194304
  s_mov_b32 s63, 0x00020000
  s_or_b32 s61, s61, 0x100000
  s_mov_b32 s63, 0x00800000
  s_lshl4_add_u32 s4, s68, s69
  s_lshl2_add_u32 s4, s4, s70
  s_add_u32 s52, s22, 41943040
  s_addc_u32 s53, s23, 0
  s_and_b32 s53, s53, 0xffff
  s_mov_b32 s54, 524288
  s_mov_b32 s55, 0x00020000
  s_add_u32 s6, s96, 4
  s_lshl_b32 s6, s6, 10
  s_add_u32 s6, s6, s4
  s_lshl_b32 s6, s6, 6
  v_mov_b32 v19, 1
  s_lshl_b32 s4, s4, 12
  s_xor_b32 s5, s4, 16384
  v_mov_b32 v128, 0
  v_mov_b32 v129, 0
  v_mov_b32 v130, 0
  v_mov_b32 v131, 0
  v_mov_b32 v132, 0
  v_mov_b32 v133, 0
  v_mov_b32 v134, 0
  v_mov_b32 v135, 0
  v_mov_b32 v136, 0
  v_mov_b32 v137, 0
  v_mov_b32 v138, 0
  v_mov_b32 v139, 0
  v_mov_b32 v140, 0
  v_mov_b32 v141, 0
  v_mov_b32 v142, 0
  v_mov_b32 v143, 0
  v_mov_b32 v144, 0
  v_mov_b32 v145, 0
  v_mov_b32 v146, 0
  v_mov_b32 v147, 0
  v_mov_b32 v148, 0
  v_mov_b32 v149, 0
  v_mov_b32 v150, 0
  v_mov_b32 v151, 0
  v_mov_b32 v152, 0
  v_mov_b32 v153, 0
  v_mov_b32 v154, 0
  v_mov_b32 v155, 0
  v_mov_b32 v156, 0
  v_mov_b32 v157, 0
  v_mov_b32 v158, 0
  v_mov_b32 v159, 0
  v_add_u32 v26, 131072, v6
  v_add_u32 v27, 131072, v7
  v_add_u32 v28, 131072, v8
  v_add_u32 v29, 131072, v9
  v_add_u32 v20, 65536, v6
  v_add_u32 v21, 65536, v7
  v_add_u32 v22, 65536, v8
  v_add_u32 v23, 65536, v9
  v_readlane_b32 s48, v15, 0
  v_readlane_b32 s49, v15, 1
  v_readlane_b32 s50, v15, 2
  v_permlane16_swap_b32 v240, v242
  v_permlane16_swap_b32 v241, v243
  v_permlane16_swap_b32 v244, v246
  v_permlane16_swap_b32 v245, v247
  v_permlane16_swap_b32 v248, v250
  v_permlane16_swap_b32 v249, v251
  v_permlane16_swap_b32 v252, v254
  v_permlane16_swap_b32 v253, v255
  s_waitcnt lgkmcnt(0)
  s_barrier
  buffer_load_dwordx4 v[32:35], off, s[36:39], s48 offset:0
  buffer_load_dwordx4 v[36:39], off, s[64:67], s48 offset:0
  buffer_load_dwordx4 v[40:43], off, s[36:39], s48 offset:1024
  buffer_load_dwordx4 v[44:47], off, s[64:67], s48 offset:1024
  buffer_load_dwordx4 v[48:51], off, s[36:39], s49 offset:0
  buffer_load_dwordx4 v[52:55], off, s[64:67], s49 offset:0
  buffer_load_dwordx4 v[56:59], off, s[36:39], s49 offset:1024
  buffer_load_dwordx4 v[60:63], off, s[64:67], s49 offset:1024
  buffer_load_dwordx4 v[64:67], off, s[36:39], s50 offset:0
  buffer_load_dwordx4 v[68:71], off, s[64:67], s50 offset:0
  buffer_load_dwordx4 v[72:75], off, s[36:39], s50 offset:1024
  buffer_load_dwordx4 v[76:79], off, s[64:67], s50 offset:1024
  ds_read_b64_tr_b16 v[160:161], v6 offset:0
  ds_read_b64_tr_b16 v[162:163], v6 offset:512
  ds_read_b64_tr_b16 v[164:165], v7 offset:0
  ds_read_b64_tr_b16 v[166:167], v7 offset:512
  ds_read_b64_tr_b16 v[168:169], v8 offset:0
  ds_read_b64_tr_b16 v[170:171], v8 offset:512
  ds_read_b64_tr_b16 v[172:173], v9 offset:0
  ds_read_b64_tr_b16 v[174:175], v9 offset:512
  ds_read_b64_tr_b16 v[176:177], v6 offset:4096
  ds_read_b64_tr_b16 v[178:179], v6 offset:4608
  ds_read_b64_tr_b16 v[180:181], v7 offset:4096
  ds_read_b64_tr_b16 v[182:183], v7 offset:4608
  ds_read_b64_tr_b16 v[184:185], v8 offset:4096
  ds_read_b64_tr_b16 v[186:187], v8 offset:4608
  ds_read_b64_tr_b16 v[188:189], v9 offset:4096
  ds_read_b64_tr_b16 v[190:191], v9 offset:4608
  s_waitcnt vmcnt(12)
  v_lshlrev_b32 v216, 16, v192
  v_and_b32 v217, s11, v192
  v_lshlrev_b32 v218, 16, v193
  v_and_b32 v219, s11, v193
  v_lshlrev_b32 v96, 16, v240
  v_and_b32 v97, s11, v240
  v_pk_add_f32 v[96:97], v[96:97], v[216:217]
  v_lshlrev_b32 v98, 16, v241
  v_and_b32 v99, s11, v241
  v_pk_add_f32 v[98:99], v[98:99], v[218:219]
  v_lshlrev_b32 v100, 16, v248
  v_and_b32 v101, s11, v248
  v_pk_add_f32 v[100:101], v[100:101], v[216:217]
  v_lshlrev_b32 v102, 16, v249
  v_and_b32 v103, s11, v249
  v_pk_add_f32 v[102:103], v[102:103], v[218:219]
  v_lshlrev_b32 v216, 16, v194
  v_and_b32 v217, s11, v194
  v_lshlrev_b32 v218, 16, v195
  v_and_b32 v219, s11, v195
  v_lshlrev_b32 v104, 16, v242
  v_and_b32 v105, s11, v242
  v_pk_add_f32 v[104:105], v[104:105], v[216:217]
  v_lshlrev_b32 v106, 16, v243
  v_and_b32 v107, s11, v243
  v_pk_add_f32 v[106:107], v[106:107], v[218:219]
  v_lshlrev_b32 v108, 16, v250
  v_and_b32 v109, s11, v250
  v_pk_add_f32 v[108:109], v[108:109], v[216:217]
  v_lshlrev_b32 v110, 16, v251
  v_and_b32 v111, s11, v251
  v_pk_add_f32 v[110:111], v[110:111], v[218:219]
  v_lshlrev_b32 v216, 16, v196
  v_and_b32 v217, s11, v196
  v_lshlrev_b32 v218, 16, v197
  v_and_b32 v219, s11, v197
  v_lshlrev_b32 v112, 16, v244
  v_and_b32 v113, s11, v244
  v_pk_add_f32 v[112:113], v[112:113], v[216:217]
  v_lshlrev_b32 v114, 16, v245
  v_and_b32 v115, s11, v245
  v_pk_add_f32 v[114:115], v[114:115], v[218:219]
  v_lshlrev_b32 v116, 16, v252
  v_and_b32 v117, s11, v252
  v_pk_add_f32 v[116:117], v[116:117], v[216:217]
  v_lshlrev_b32 v118, 16, v253
  v_and_b32 v119, s11, v253
  v_pk_add_f32 v[118:119], v[118:119], v[218:219]
  v_lshlrev_b32 v216, 16, v198
  v_and_b32 v217, s11, v198
  v_lshlrev_b32 v218, 16, v199
  v_and_b32 v219, s11, v199
  v_lshlrev_b32 v120, 16, v246
  v_and_b32 v121, s11, v246
  v_pk_add_f32 v[120:121], v[120:121], v[216:217]
  v_lshlrev_b32 v122, 16, v247
  v_and_b32 v123, s11, v247
  v_pk_add_f32 v[122:123], v[122:123], v[218:219]
  v_lshlrev_b32 v124, 16, v254
  v_and_b32 v125, s11, v254
  v_pk_add_f32 v[124:125], v[124:125], v[216:217]
  v_lshlrev_b32 v126, 16, v255
  v_and_b32 v127, s11, v255
  v_pk_add_f32 v[126:127], v[126:127], v[218:219]
  s_waitcnt vmcnt(10) lgkmcnt(8)
  v_mfma_f32_16x16x32_bf16 v[128:131], v[160:163], v[32:35], v[128:131]
  ds_read_b64_tr_b16 v[192:193], v6 offset:8192
  v_readlane_b32 s51, v15, 3
  v_mfma_f32_16x16x32_bf16 v[132:135], v[160:163], v[36:39], v[132:135]
  ds_read_b64_tr_b16 v[194:195], v6 offset:8704
  v_mfma_f32_16x16x32_bf16 v[140:143], v[164:167], v[36:39], v[140:143]
  ds_read_b64_tr_b16 v[196:197], v7 offset:8192
  v_mfma_f32_16x16x32_bf16 v[136:139], v[164:167], v[32:35], v[136:139]
  buffer_load_dwordx4 v[80:83], off, s[36:39], s51 offset:0
  v_mfma_f32_16x16x32_bf16 v[144:147], v[168:171], v[32:35], v[144:147]
  ds_read_b64_tr_b16 v[198:199], v7 offset:8704
  ds_read_b64_tr_b16 v[200:201], v8 offset:8192
  v_mfma_f32_16x16x32_bf16 v[148:151], v[168:171], v[36:39], v[148:151]
  ds_read_b64_tr_b16 v[202:203], v8 offset:8704
  ds_read_b64_tr_b16 v[204:205], v9 offset:8192
  v_mfma_f32_16x16x32_bf16 v[156:159], v[172:175], v[36:39], v[156:159]
  buffer_load_dwordx4 v[84:87], off, s[64:67], s51 offset:0
  v_mfma_f32_16x16x32_bf16 v[152:155], v[172:175], v[32:35], v[152:155]
  ds_read_b64_tr_b16 v[206:207], v9 offset:8704
  s_waitcnt vmcnt(10) lgkmcnt(8)
  v_mfma_f32_16x16x32_bf16 v[128:131], v[176:179], v[40:43], v[128:131]
  ds_read_b64_tr_b16 v[208:209], v6 offset:12288
  v_mfma_f32_16x16x32_bf16 v[132:135], v[176:179], v[44:47], v[132:135]
  buffer_load_dwordx4 v[88:91], off, s[36:39], s51 offset:1024
  v_mfma_f32_16x16x32_bf16 v[140:143], v[180:183], v[44:47], v[140:143]
  ds_read_b64_tr_b16 v[210:211], v6 offset:12800
  ds_read_b64_tr_b16 v[212:213], v7 offset:12288
  v_mfma_f32_16x16x32_bf16 v[136:139], v[180:183], v[40:43], v[136:139]
  ds_read_b64_tr_b16 v[214:215], v7 offset:12800
  ds_read_b64_tr_b16 v[216:217], v8 offset:12288
  v_mfma_f32_16x16x32_bf16 v[144:147], v[184:187], v[40:43], v[144:147]
  buffer_load_dwordx4 v[92:95], off, s[64:67], s51 offset:1024
  v_mfma_f32_16x16x32_bf16 v[148:151], v[184:187], v[44:47], v[148:151]
  ds_read_b64_tr_b16 v[218:219], v8 offset:12800
  v_readlane_b32 s48, v15, 4
  v_mfma_f32_16x16x32_bf16 v[156:159], v[188:191], v[44:47], v[156:159]
  ds_read_b64_tr_b16 v[220:221], v9 offset:12288
  v_mfma_f32_16x16x32_bf16 v[152:155], v[188:191], v[40:43], v[152:155]
  ds_read_b64_tr_b16 v[222:223], v9 offset:12800
  s_waitcnt lgkmcnt(8)
  v_mfma_f32_16x16x32_bf16 v[96:99], v[192:195], v[32:35], v[96:99]
  buffer_load_dwordx4 v[224:227], off, s[36:39], s48 offset:0
  v_mfma_f32_16x16x32_bf16 v[100:103], v[192:195], v[36:39], v[100:103]
  ds_read_b64_tr_b16 v[160:161], v6 offset:16384
  ds_read_b64_tr_b16 v[162:163], v6 offset:16896
  v_mfma_f32_16x16x32_bf16 v[108:111], v[196:199], v[36:39], v[108:111]
  ds_read_b64_tr_b16 v[164:165], v7 offset:16384
  v_mfma_f32_16x16x32_bf16 v[104:107], v[196:199], v[32:35], v[104:107]
  buffer_load_dwordx4 v[228:231], off, s[64:67], s48 offset:0
  v_mfma_f32_16x16x32_bf16 v[112:115], v[200:203], v[32:35], v[112:115]
  ds_read_b64_tr_b16 v[166:167], v7 offset:16896
  ds_read_b64_tr_b16 v[168:169], v8 offset:16384
  v_mfma_f32_16x16x32_bf16 v[116:119], v[200:203], v[36:39], v[116:119]
  ds_read_b64_tr_b16 v[170:171], v8 offset:16896
  ds_read_b64_tr_b16 v[172:173], v9 offset:16384
  v_mfma_f32_16x16x32_bf16 v[124:127], v[204:207], v[36:39], v[124:127]
  buffer_load_dwordx4 v[232:235], off, s[36:39], s48 offset:1024
  v_mfma_f32_16x16x32_bf16 v[120:123], v[204:207], v[32:35], v[120:123]
  ds_read_b64_tr_b16 v[174:175], v9 offset:16896
  s_waitcnt lgkmcnt(8)
  v_mfma_f32_16x16x32_bf16 v[96:99], v[208:211], v[40:43], v[96:99]
  ds_read_b64_tr_b16 v[176:177], v6 offset:20480
  ds_read_b64_tr_b16 v[178:179], v6 offset:20992
  v_mfma_f32_16x16x32_bf16 v[100:103], v[208:211], v[44:47], v[100:103]
  buffer_load_dwordx4 v[236:239], off, s[64:67], s48 offset:1024
  v_mfma_f32_16x16x32_bf16 v[108:111], v[212:215], v[44:47], v[108:111]
  ds_read_b64_tr_b16 v[180:181], v7 offset:20480
  v_readlane_b32 s49, v15, 5
  v_mfma_f32_16x16x32_bf16 v[104:107], v[212:215], v[40:43], v[104:107]
  ds_read_b64_tr_b16 v[182:183], v7 offset:20992
  v_mfma_f32_16x16x32_bf16 v[112:115], v[216:219], v[40:43], v[112:115]
  ds_read_b64_tr_b16 v[184:185], v8 offset:20480
  v_mfma_f32_16x16x32_bf16 v[116:119], v[216:219], v[44:47], v[116:119]
  buffer_load_dwordx4 v[240:243], off, s[36:39], s49 offset:0
  v_mfma_f32_16x16x32_bf16 v[124:127], v[220:223], v[44:47], v[124:127]
  ds_read_b64_tr_b16 v[186:187], v8 offset:20992
  ds_read_b64_tr_b16 v[188:189], v9 offset:20480
  v_mfma_f32_16x16x32_bf16 v[120:123], v[220:223], v[40:43], v[120:123]
  ds_read_b64_tr_b16 v[190:191], v9 offset:20992
  s_waitcnt vmcnt(15) lgkmcnt(8)
  v_mfma_f32_16x16x32_bf16 v[128:131], v[160:163], v[48:51], v[128:131]
  buffer_load_dwordx4 v[244:247], off, s[64:67], s49 offset:0
  v_mfma_f32_16x16x32_bf16 v[132:135], v[160:163], v[52:55], v[132:135]
  ds_read_b64_tr_b16 v[192:193], v6 offset:24576
  ds_read_b64_tr_b16 v[194:195], v6 offset:25088
  v_mfma_f32_16x16x32_bf16 v[140:143], v[164:167], v[52:55], v[140:143]
  ds_read_b64_tr_b16 v[196:197], v7 offset:24576
  v_mfma_f32_16x16x32_bf16 v[136:139], v[164:167], v[48:51], v[136:139]
  buffer_load_dwordx4 v[248:251], off, s[36:39], s49 offset:1024
  v_mfma_f32_16x16x32_bf16 v[144:147], v[168:171], v[48:51], v[144:147]
  ds_read_b64_tr_b16 v[198:199], v7 offset:25088
  ds_read_b64_tr_b16 v[200:201], v8 offset:24576
  v_mfma_f32_16x16x32_bf16 v[148:151], v[168:171], v[52:55], v[148:151]
  ds_read_b64_tr_b16 v[202:203], v8 offset:25088
  ds_read_b64_tr_b16 v[204:205], v9 offset:24576
  v_mfma_f32_16x16x32_bf16 v[156:159], v[172:175], v[52:55], v[156:159]
  buffer_load_dwordx4 v[252:255], off, s[64:67], s49 offset:1024
  v_mfma_f32_16x16x32_bf16 v[152:155], v[172:175], v[48:51], v[152:155]
  ds_read_b64_tr_b16 v[206:207], v9 offset:25088
  s_waitcnt vmcnt(16) lgkmcnt(8)
  v_mfma_f32_16x16x32_bf16 v[128:131], v[176:179], v[56:59], v[128:131]
  ds_read_b64_tr_b16 v[208:209], v6 offset:28672
  v_readlane_b32 s50, v15, 6
  v_mfma_f32_16x16x32_bf16 v[132:135], v[176:179], v[60:63], v[132:135]
  ds_read_b64_tr_b16 v[210:211], v6 offset:29184
  v_mfma_f32_16x16x32_bf16 v[140:143], v[180:183], v[60:63], v[140:143]
  ds_read_b64_tr_b16 v[212:213], v7 offset:28672
  v_mfma_f32_16x16x32_bf16 v[136:139], v[180:183], v[56:59], v[136:139]
  buffer_load_dwordx4 v[32:35], off, s[36:39], s50 offset:0
  v_mfma_f32_16x16x32_bf16 v[144:147], v[184:187], v[56:59], v[144:147]
  ds_read_b64_tr_b16 v[214:215], v7 offset:29184
  ds_read_b64_tr_b16 v[216:217], v8 offset:28672
  v_mfma_f32_16x16x32_bf16 v[148:151], v[184:187], v[60:63], v[148:151]
  ds_read_b64_tr_b16 v[218:219], v8 offset:29184
  v_mfma_f32_16x16x32_bf16 v[156:159], v[188:191], v[60:63], v[156:159]
  ds_read_b64_tr_b16 v[220:221], v9 offset:28672
  v_mfma_f32_16x16x32_bf16 v[152:155], v[188:191], v[56:59], v[152:155]
  ds_read_b64_tr_b16 v[222:223], v9 offset:29184
  s_waitcnt lgkmcnt(8)
  v_mfma_f32_16x16x32_bf16 v[96:99], v[192:195], v[48:51], v[96:99]
  ds_read_b64_tr_b16 v[160:161], v6 offset:32768
  v_mfma_f32_16x16x32_bf16 v[100:103], v[192:195], v[52:55], v[100:103]
  ds_read_b64_tr_b16 v[162:163], v6 offset:33280
  v_mfma_f32_16x16x32_bf16 v[108:111], v[196:199], v[52:55], v[108:111]
  buffer_load_dwordx4 v[36:39], off, s[64:67], s50 offset:0
  v_mfma_f32_16x16x32_bf16 v[104:107], v[196:199], v[48:51], v[104:107]
  ds_read_b64_tr_b16 v[164:165], v7 offset:32768
  ds_read_b64_tr_b16 v[166:167], v7 offset:33280
  v_mfma_f32_16x16x32_bf16 v[112:115], v[200:203], v[48:51], v[112:115]
  ds_read_b64_tr_b16 v[168:169], v8 offset:32768
  v_mfma_f32_16x16x32_bf16 v[116:119], v[200:203], v[52:55], v[116:119]
  ds_read_b64_tr_b16 v[170:171], v8 offset:33280
  v_mfma_f32_16x16x32_bf16 v[124:127], v[204:207], v[52:55], v[124:127]
  ds_read_b64_tr_b16 v[172:173], v9 offset:32768
  v_mfma_f32_16x16x32_bf16 v[120:123], v[204:207], v[48:51], v[120:123]
  ds_read_b64_tr_b16 v[174:175], v9 offset:33280
  s_waitcnt lgkmcnt(8)
  s_barrier
  v_mfma_f32_16x16x32_bf16 v[96:99], v[208:211], v[56:59], v[96:99]
  ds_read_b64_tr_b16 v[176:177], v6 offset:36864
  v_mfma_f32_16x16x32_bf16 v[100:103], v[208:211], v[60:63], v[100:103]
  buffer_load_dwordx4 v[40:43], off, s[36:39], s50 offset:1024
  v_mfma_f32_16x16x32_bf16 v[108:111], v[212:215], v[60:63], v[108:111]
  ds_read_b64_tr_b16 v[178:179], v6 offset:37376
  ds_read_b64_tr_b16 v[180:181], v7 offset:36864
  v_mfma_f32_16x16x32_bf16 v[104:107], v[212:215], v[56:59], v[104:107]
  ds_read_b64_tr_b16 v[182:183], v7 offset:37376
  v_mfma_f32_16x16x32_bf16 v[112:115], v[216:219], v[56:59], v[112:115]
  ds_read_b64_tr_b16 v[184:185], v8 offset:36864
  v_mfma_f32_16x16x32_bf16 v[116:119], v[216:219], v[60:63], v[116:119]
  ds_read_b64_tr_b16 v[186:187], v8 offset:37376
  v_mfma_f32_16x16x32_bf16 v[124:127], v[220:223], v[60:63], v[124:127]
  ds_read_b64_tr_b16 v[188:189], v9 offset:36864
  v_mfma_f32_16x16x32_bf16 v[120:123], v[220:223], v[56:59], v[120:123]
  ds_read_b64_tr_b16 v[190:191], v9 offset:37376
  s_waitcnt vmcnt(17) lgkmcnt(8)
  v_mfma_f32_16x16x32_bf16 v[128:131], v[160:163], v[64:67], v[128:131]
  buffer_load_dwordx4 v[44:47], off, s[64:67], s50 offset:1024
  v_mfma_f32_16x16x32_bf16 v[132:135], v[160:163], v[68:71], v[132:135]
  ds_read_b64_tr_b16 v[192:193], v6 offset:40960
  ds_read_b64_tr_b16 v[194:195], v6 offset:41472
  v_mfma_f32_16x16x32_bf16 v[140:143], v[164:167], v[68:71], v[140:143]
  ds_read_b64_tr_b16 v[196:197], v7 offset:40960
  v_mfma_f32_16x16x32_bf16 v[136:139], v[164:167], v[64:67], v[136:139]
  ds_read_b64_tr_b16 v[198:199], v7 offset:41472
  v_mfma_f32_16x16x32_bf16 v[144:147], v[168:171], v[64:67], v[144:147]
  ds_read_b64_tr_b16 v[200:201], v8 offset:40960
  v_mfma_f32_16x16x32_bf16 v[148:151], v[168:171], v[68:71], v[148:151]
  ds_read_b64_tr_b16 v[202:203], v8 offset:41472
  v_readlane_b32 s51, v15, 7
  v_mfma_f32_16x16x32_bf16 v[156:159], v[172:175], v[68:71], v[156:159]
  ds_read_b64_tr_b16 v[204:205], v9 offset:40960
  v_mfma_f32_16x16x32_bf16 v[152:155], v[172:175], v[64:67], v[152:155]
  ds_read_b64_tr_b16 v[206:207], v9 offset:41472
  s_waitcnt vmcnt(16) lgkmcnt(8)
  v_mfma_f32_16x16x32_bf16 v[128:131], v[176:179], v[72:75], v[128:131]
  buffer_load_dwordx4 v[48:51], off, s[36:39], s51 offset:0
  v_mfma_f32_16x16x32_bf16 v[132:135], v[176:179], v[76:79], v[132:135]
  ds_read_b64_tr_b16 v[208:209], v6 offset:45056
  ds_read_b64_tr_b16 v[210:211], v6 offset:45568
  v_mfma_f32_16x16x32_bf16 v[140:143], v[180:183], v[76:79], v[140:143]
  ds_read_b64_tr_b16 v[212:213], v7 offset:45056
  v_mfma_f32_16x16x32_bf16 v[136:139], v[180:183], v[72:75], v[136:139]
  ds_read_b64_tr_b16 v[214:215], v7 offset:45568
  v_mfma_f32_16x16x32_bf16 v[144:147], v[184:187], v[72:75], v[144:147]
  ds_read_b64_tr_b16 v[216:217], v8 offset:45056
  v_mfma_f32_16x16x32_bf16 v[148:151], v[184:187], v[76:79], v[148:151]
  ds_read_b64_tr_b16 v[218:219], v8 offset:45568
  v_mfma_f32_16x16x32_bf16 v[156:159], v[188:191], v[76:79], v[156:159]
  ds_read_b64_tr_b16 v[220:221], v9 offset:45056
  v_mfma_f32_16x16x32_bf16 v[152:155], v[188:191], v[72:75], v[152:155]
  ds_read_b64_tr_b16 v[222:223], v9 offset:45568
  s_waitcnt lgkmcnt(8)
  v_mfma_f32_16x16x32_bf16 v[96:99], v[192:195], v[64:67], v[96:99]
  buffer_load_dwordx4 v[52:55], off, s[64:67], s51 offset:0
  v_mfma_f32_16x16x32_bf16 v[100:103], v[192:195], v[68:71], v[100:103]
  ds_read_b64_tr_b16 v[160:161], v6 offset:49152
  ds_read_b64_tr_b16 v[162:163], v6 offset:49664
  v_mfma_f32_16x16x32_bf16 v[108:111], v[196:199], v[68:71], v[108:111]
  ds_read_b64_tr_b16 v[164:165], v7 offset:49152
  v_mfma_f32_16x16x32_bf16 v[104:107], v[196:199], v[64:67], v[104:107]
  ds_read_b64_tr_b16 v[166:167], v7 offset:49664
  v_mfma_f32_16x16x32_bf16 v[112:115], v[200:203], v[64:67], v[112:115]
  ds_read_b64_tr_b16 v[168:169], v8 offset:49152
  v_mfma_f32_16x16x32_bf16 v[116:119], v[200:203], v[68:71], v[116:119]
  ds_read_b64_tr_b16 v[170:171], v8 offset:49664
  v_mfma_f32_16x16x32_bf16 v[124:127], v[204:207], v[68:71], v[124:127]
  ds_read_b64_tr_b16 v[172:173], v9 offset:49152
  v_mfma_f32_16x16x32_bf16 v[120:123], v[204:207], v[64:67], v[120:123]
  ds_read_b64_tr_b16 v[174:175], v9 offset:49664
  s_waitcnt lgkmcnt(8)
  v_mfma_f32_16x16x32_bf16 v[96:99], v[208:211], v[72:75], v[96:99]
  buffer_load_dwordx4 v[56:59], off, s[36:39], s51 offset:1024
  v_mfma_f32_16x16x32_bf16 v[100:103], v[208:211], v[76:79], v[100:103]
  ds_read_b64_tr_b16 v[176:177], v6 offset:53248
  ds_read_b64_tr_b16 v[178:179], v6 offset:53760
  v_mfma_f32_16x16x32_bf16 v[108:111], v[212:215], v[76:79], v[108:111]
  ds_read_b64_tr_b16 v[180:181], v7 offset:53248
  v_mfma_f32_16x16x32_bf16 v[104:107], v[212:215], v[72:75], v[104:107]
  ds_read_b64_tr_b16 v[182:183], v7 offset:53760
  v_mfma_f32_16x16x32_bf16 v[112:115], v[216:219], v[72:75], v[112:115]
  ds_read_b64_tr_b16 v[184:185], v8 offset:53248
  v_mfma_f32_16x16x32_bf16 v[116:119], v[216:219], v[76:79], v[116:119]
  ds_read_b64_tr_b16 v[186:187], v8 offset:53760
  v_mfma_f32_16x16x32_bf16 v[124:127], v[220:223], v[76:79], v[124:127]
  ds_read_b64_tr_b16 v[188:189], v9 offset:53248
  v_mfma_f32_16x16x32_bf16 v[120:123], v[220:223], v[72:75], v[120:123]
  ds_read_b64_tr_b16 v[190:191], v9 offset:53760
  s_waitcnt vmcnt(17) lgkmcnt(8)
  v_mfma_f32_16x16x32_bf16 v[128:131], v[160:163], v[80:83], v[128:131]
  buffer_load_dwordx4 v[60:63], off, s[64:67], s51 offset:1024
  v_mfma_f32_16x16x32_bf16 v[132:135], v[160:163], v[84:87], v[132:135]
  ds_read_b64_tr_b16 v[192:193], v6 offset:57344
  ds_read_b64_tr_b16 v[194:195], v6 offset:57856
  v_mfma_f32_16x16x32_bf16 v[140:143], v[164:167], v[84:87], v[140:143]
  ds_read_b64_tr_b16 v[196:197], v7 offset:57344
  v_mfma_f32_16x16x32_bf16 v[136:139], v[164:167], v[80:83], v[136:139]
  ds_read_b64_tr_b16 v[198:199], v7 offset:57856
  v_mfma_f32_16x16x32_bf16 v[144:147], v[168:171], v[80:83], v[144:147]
  ds_read_b64_tr_b16 v[200:201], v8 offset:57344
  v_mfma_f32_16x16x32_bf16 v[148:151], v[168:171], v[84:87], v[148:151]
  ds_read_b64_tr_b16 v[202:203], v8 offset:57856
  v_readlane_b32 s48, v15, 8
  v_mfma_f32_16x16x32_bf16 v[156:159], v[172:175], v[84:87], v[156:159]
  ds_read_b64_tr_b16 v[204:205], v9 offset:57344
  v_mfma_f32_16x16x32_bf16 v[152:155], v[172:175], v[80:83], v[152:155]
  ds_read_b64_tr_b16 v[206:207], v9 offset:57856
  s_waitcnt vmcnt(16) lgkmcnt(8)
  v_mfma_f32_16x16x32_bf16 v[128:131], v[176:179], v[88:91], v[128:131]
  buffer_load_dwordx4 v[64:67], off, s[36:39], s48 offset:0
  v_mfma_f32_16x16x32_bf16 v[132:135], v[176:179], v[92:95], v[132:135]
  ds_read_b64_tr_b16 v[208:209], v6 offset:61440
  ds_read_b64_tr_b16 v[210:211], v6 offset:61952
  v_mfma_f32_16x16x32_bf16 v[140:143], v[180:183], v[92:95], v[140:143]
  ds_read_b64_tr_b16 v[212:213], v7 offset:61440
  v_mfma_f32_16x16x32_bf16 v[136:139], v[180:183], v[88:91], v[136:139]
  ds_read_b64_tr_b16 v[214:215], v7 offset:61952
  v_mfma_f32_16x16x32_bf16 v[144:147], v[184:187], v[88:91], v[144:147]
  ds_read_b64_tr_b16 v[216:217], v8 offset:61440
  v_mfma_f32_16x16x32_bf16 v[148:151], v[184:187], v[92:95], v[148:151]
  ds_read_b64_tr_b16 v[218:219], v8 offset:61952
  v_mfma_f32_16x16x32_bf16 v[156:159], v[188:191], v[92:95], v[156:159]
  ds_read_b64_tr_b16 v[220:221], v9 offset:61440
  v_mfma_f32_16x16x32_bf16 v[152:155], v[188:191], v[88:91], v[152:155]
  ds_read_b64_tr_b16 v[222:223], v9 offset:61952
  s_waitcnt lgkmcnt(8)
  v_mfma_f32_16x16x32_bf16 v[96:99], v[192:195], v[80:83], v[96:99]
  buffer_load_dwordx4 v[68:71], off, s[64:67], s48 offset:0
  v_mfma_f32_16x16x32_bf16 v[100:103], v[192:195], v[84:87], v[100:103]
  ds_read_b64_tr_b16 v[160:161], v20 offset:0
  ds_read_b64_tr_b16 v[162:163], v20 offset:512
  v_mfma_f32_16x16x32_bf16 v[108:111], v[196:199], v[84:87], v[108:111]
  ds_read_b64_tr_b16 v[164:165], v21 offset:0
  v_mfma_f32_16x16x32_bf16 v[104:107], v[196:199], v[80:83], v[104:107]
  ds_read_b64_tr_b16 v[166:167], v21 offset:512
  v_mfma_f32_16x16x32_bf16 v[112:115], v[200:203], v[80:83], v[112:115]
  ds_read_b64_tr_b16 v[168:169], v22 offset:0
  v_mfma_f32_16x16x32_bf16 v[116:119], v[200:203], v[84:87], v[116:119]
  ds_read_b64_tr_b16 v[170:171], v22 offset:512
  v_mfma_f32_16x16x32_bf16 v[124:127], v[204:207], v[84:87], v[124:127]
  ds_read_b64_tr_b16 v[172:173], v23 offset:0
  v_mfma_f32_16x16x32_bf16 v[120:123], v[204:207], v[80:83], v[120:123]
  ds_read_b64_tr_b16 v[174:175], v23 offset:512
  s_waitcnt lgkmcnt(8)
  s_barrier
  v_mfma_f32_16x16x32_bf16 v[96:99], v[208:211], v[88:91], v[96:99]
  buffer_load_dwordx4 v[72:75], off, s[36:39], s48 offset:1024
  v_mfma_f32_16x16x32_bf16 v[100:103], v[208:211], v[92:95], v[100:103]
  ds_read_b64_tr_b16 v[176:177], v20 offset:4096
  ds_read_b64_tr_b16 v[178:179], v20 offset:4608
  v_mfma_f32_16x16x32_bf16 v[108:111], v[212:215], v[92:95], v[108:111]
  ds_read_b64_tr_b16 v[180:181], v21 offset:4096
  v_mfma_f32_16x16x32_bf16 v[104:107], v[212:215], v[88:91], v[104:107]
  ds_read_b64_tr_b16 v[182:183], v21 offset:4608
  v_mfma_f32_16x16x32_bf16 v[112:115], v[216:219], v[88:91], v[112:115]
  ds_read_b64_tr_b16 v[184:185], v22 offset:4096
  v_mfma_f32_16x16x32_bf16 v[116:119], v[216:219], v[92:95], v[116:119]
  ds_read_b64_tr_b16 v[186:187], v22 offset:4608
  v_mfma_f32_16x16x32_bf16 v[124:127], v[220:223], v[92:95], v[124:127]
  ds_read_b64_tr_b16 v[188:189], v23 offset:4096
  v_mfma_f32_16x16x32_bf16 v[120:123], v[220:223], v[88:91], v[120:123]
  ds_read_b64_tr_b16 v[190:191], v23 offset:4608
  s_waitcnt vmcnt(17) lgkmcnt(8)
  v_mfma_f32_16x16x32_bf16 v[128:131], v[160:163], v[224:227], v[128:131]
  buffer_load_dwordx4 v[76:79], off, s[64:67], s48 offset:1024
  v_mfma_f32_16x16x32_bf16 v[132:135], v[160:163], v[228:231], v[132:135]
  ds_read_b64_tr_b16 v[192:193], v20 offset:8192
  ds_read_b64_tr_b16 v[194:195], v20 offset:8704
  v_mfma_f32_16x16x32_bf16 v[140:143], v[164:167], v[228:231], v[140:143]
  ds_read_b64_tr_b16 v[196:197], v21 offset:8192
  v_mfma_f32_16x16x32_bf16 v[136:139], v[164:167], v[224:227], v[136:139]
  ds_read_b64_tr_b16 v[198:199], v21 offset:8704
  v_mfma_f32_16x16x32_bf16 v[144:147], v[168:171], v[224:227], v[144:147]
  ds_read_b64_tr_b16 v[200:201], v22 offset:8192
  v_mfma_f32_16x16x32_bf16 v[148:151], v[168:171], v[228:231], v[148:151]
  ds_read_b64_tr_b16 v[202:203], v22 offset:8704
  v_readlane_b32 s49, v15, 9
  v_mfma_f32_16x16x32_bf16 v[156:159], v[172:175], v[228:231], v[156:159]
  ds_read_b64_tr_b16 v[204:205], v23 offset:8192
  v_mfma_f32_16x16x32_bf16 v[152:155], v[172:175], v[224:227], v[152:155]
  ds_read_b64_tr_b16 v[206:207], v23 offset:8704
  s_waitcnt vmcnt(16) lgkmcnt(8)
  v_mfma_f32_16x16x32_bf16 v[128:131], v[176:179], v[232:235], v[128:131]
  buffer_load_dwordx4 v[80:83], off, s[36:39], s49 offset:0
  v_mfma_f32_16x16x32_bf16 v[132:135], v[176:179], v[236:239], v[132:135]
  ds_read_b64_tr_b16 v[208:209], v20 offset:12288
  ds_read_b64_tr_b16 v[210:211], v20 offset:12800
  v_mfma_f32_16x16x32_bf16 v[140:143], v[180:183], v[236:239], v[140:143]
  ds_read_b64_tr_b16 v[212:213], v21 offset:12288
  v_mfma_f32_16x16x32_bf16 v[136:139], v[180:183], v[232:235], v[136:139]
  ds_read_b64_tr_b16 v[214:215], v21 offset:12800
  v_mfma_f32_16x16x32_bf16 v[144:147], v[184:187], v[232:235], v[144:147]
  ds_read_b64_tr_b16 v[216:217], v22 offset:12288
  v_mfma_f32_16x16x32_bf16 v[148:151], v[184:187], v[236:239], v[148:151]
  ds_read_b64_tr_b16 v[218:219], v22 offset:12800
  v_mfma_f32_16x16x32_bf16 v[156:159], v[188:191], v[236:239], v[156:159]
  ds_read_b64_tr_b16 v[220:221], v23 offset:12288
  v_mfma_f32_16x16x32_bf16 v[152:155], v[188:191], v[232:235], v[152:155]
  ds_read_b64_tr_b16 v[222:223], v23 offset:12800
  s_waitcnt lgkmcnt(8)
  v_mfma_f32_16x16x32_bf16 v[96:99], v[192:195], v[224:227], v[96:99]
  buffer_load_dwordx4 v[84:87], off, s[64:67], s49 offset:0
  v_mfma_f32_16x16x32_bf16 v[100:103], v[192:195], v[228:231], v[100:103]
  ds_read_b64_tr_b16 v[160:161], v20 offset:16384
  ds_read_b64_tr_b16 v[162:163], v20 offset:16896
  v_mfma_f32_16x16x32_bf16 v[108:111], v[196:199], v[228:231], v[108:111]
  ds_read_b64_tr_b16 v[164:165], v21 offset:16384
  v_mfma_f32_16x16x32_bf16 v[104:107], v[196:199], v[224:227], v[104:107]
  ds_read_b64_tr_b16 v[166:167], v21 offset:16896
  v_mfma_f32_16x16x32_bf16 v[112:115], v[200:203], v[224:227], v[112:115]
  ds_read_b64_tr_b16 v[168:169], v22 offset:16384
  v_mfma_f32_16x16x32_bf16 v[116:119], v[200:203], v[228:231], v[116:119]
  ds_read_b64_tr_b16 v[170:171], v22 offset:16896
  v_mfma_f32_16x16x32_bf16 v[124:127], v[204:207], v[228:231], v[124:127]
  ds_read_b64_tr_b16 v[172:173], v23 offset:16384
  v_mfma_f32_16x16x32_bf16 v[120:123], v[204:207], v[224:227], v[120:123]
  ds_read_b64_tr_b16 v[174:175], v23 offset:16896
  s_waitcnt lgkmcnt(8)
  v_mfma_f32_16x16x32_bf16 v[96:99], v[208:211], v[232:235], v[96:99]
  buffer_load_dwordx4 v[88:91], off, s[36:39], s49 offset:1024
  v_mfma_f32_16x16x32_bf16 v[100:103], v[208:211], v[236:239], v[100:103]
  ds_read_b64_tr_b16 v[176:177], v20 offset:20480
  ds_read_b64_tr_b16 v[178:179], v20 offset:20992
  v_mfma_f32_16x16x32_bf16 v[108:111], v[212:215], v[236:239], v[108:111]
  ds_read_b64_tr_b16 v[180:181], v21 offset:20480
  v_mfma_f32_16x16x32_bf16 v[104:107], v[212:215], v[232:235], v[104:107]
  ds_read_b64_tr_b16 v[182:183], v21 offset:20992
  v_mfma_f32_16x16x32_bf16 v[112:115], v[216:219], v[232:235], v[112:115]
  ds_read_b64_tr_b16 v[184:185], v22 offset:20480
  v_mfma_f32_16x16x32_bf16 v[116:119], v[216:219], v[236:239], v[116:119]
  ds_read_b64_tr_b16 v[186:187], v22 offset:20992
  v_mfma_f32_16x16x32_bf16 v[124:127], v[220:223], v[236:239], v[124:127]
  ds_read_b64_tr_b16 v[188:189], v23 offset:20480
  v_mfma_f32_16x16x32_bf16 v[120:123], v[220:223], v[232:235], v[120:123]
  ds_read_b64_tr_b16 v[190:191], v23 offset:20992
  s_waitcnt vmcnt(17) lgkmcnt(8)
  v_mfma_f32_16x16x32_bf16 v[128:131], v[160:163], v[240:243], v[128:131]
  buffer_load_dwordx4 v[92:95], off, s[64:67], s49 offset:1024
  v_mfma_f32_16x16x32_bf16 v[132:135], v[160:163], v[244:247], v[132:135]
  ds_read_b64_tr_b16 v[192:193], v20 offset:24576
  ds_read_b64_tr_b16 v[194:195], v20 offset:25088
  v_mfma_f32_16x16x32_bf16 v[140:143], v[164:167], v[244:247], v[140:143]
  ds_read_b64_tr_b16 v[196:197], v21 offset:24576
  v_mfma_f32_16x16x32_bf16 v[136:139], v[164:167], v[240:243], v[136:139]
  ds_read_b64_tr_b16 v[198:199], v21 offset:25088
  v_mfma_f32_16x16x32_bf16 v[144:147], v[168:171], v[240:243], v[144:147]
  ds_read_b64_tr_b16 v[200:201], v22 offset:24576
  v_mfma_f32_16x16x32_bf16 v[148:151], v[168:171], v[244:247], v[148:151]
  ds_read_b64_tr_b16 v[202:203], v22 offset:25088
  v_readlane_b32 s50, v15, 10
  v_mfma_f32_16x16x32_bf16 v[156:159], v[172:175], v[244:247], v[156:159]
  ds_read_b64_tr_b16 v[204:205], v23 offset:24576
  v_mfma_f32_16x16x32_bf16 v[152:155], v[172:175], v[240:243], v[152:155]
  ds_read_b64_tr_b16 v[206:207], v23 offset:25088
  s_waitcnt vmcnt(16) lgkmcnt(8)
  v_mfma_f32_16x16x32_bf16 v[128:131], v[176:179], v[248:251], v[128:131]
  buffer_load_dwordx4 v[224:227], off, s[36:39], s50 offset:0
  v_mfma_f32_16x16x32_bf16 v[132:135], v[176:179], v[252:255], v[132:135]
  ds_read_b64_tr_b16 v[208:209], v20 offset:28672
  ds_read_b64_tr_b16 v[210:211], v20 offset:29184
  v_mfma_f32_16x16x32_bf16 v[140:143], v[180:183], v[252:255], v[140:143]
  ds_read_b64_tr_b16 v[212:213], v21 offset:28672
  v_mfma_f32_16x16x32_bf16 v[136:139], v[180:183], v[248:251], v[136:139]
  ds_read_b64_tr_b16 v[214:215], v21 offset:29184
  v_mfma_f32_16x16x32_bf16 v[144:147], v[184:187], v[248:251], v[144:147]
  ds_read_b64_tr_b16 v[216:217], v22 offset:28672
  v_mfma_f32_16x16x32_bf16 v[148:151], v[184:187], v[252:255], v[148:151]
  ds_read_b64_tr_b16 v[218:219], v22 offset:29184
  v_mfma_f32_16x16x32_bf16 v[156:159], v[188:191], v[252:255], v[156:159]
  ds_read_b64_tr_b16 v[220:221], v23 offset:28672
  v_mfma_f32_16x16x32_bf16 v[152:155], v[188:191], v[248:251], v[152:155]
  ds_read_b64_tr_b16 v[222:223], v23 offset:29184
  s_waitcnt lgkmcnt(8)
  v_mfma_f32_16x16x32_bf16 v[96:99], v[192:195], v[240:243], v[96:99]
  buffer_load_dwordx4 v[228:231], off, s[64:67], s50 offset:0
  v_mfma_f32_16x16x32_bf16 v[100:103], v[192:195], v[244:247], v[100:103]
  ds_read_b64_tr_b16 v[160:161], v20 offset:32768
  ds_read_b64_tr_b16 v[162:163], v20 offset:33280
  v_mfma_f32_16x16x32_bf16 v[108:111], v[196:199], v[244:247], v[108:111]
  ds_read_b64_tr_b16 v[164:165], v21 offset:32768
  v_mfma_f32_16x16x32_bf16 v[104:107], v[196:199], v[240:243], v[104:107]
  ds_read_b64_tr_b16 v[166:167], v21 offset:33280
  v_mfma_f32_16x16x32_bf16 v[112:115], v[200:203], v[240:243], v[112:115]
  ds_read_b64_tr_b16 v[168:169], v22 offset:32768
  v_mfma_f32_16x16x32_bf16 v[116:119], v[200:203], v[244:247], v[116:119]
  ds_read_b64_tr_b16 v[170:171], v22 offset:33280
  v_mfma_f32_16x16x32_bf16 v[124:127], v[204:207], v[244:247], v[124:127]
  ds_read_b64_tr_b16 v[172:173], v23 offset:32768
  v_mfma_f32_16x16x32_bf16 v[120:123], v[204:207], v[240:243], v[120:123]
  ds_read_b64_tr_b16 v[174:175], v23 offset:33280
  s_waitcnt lgkmcnt(8)
  s_barrier
  v_mfma_f32_16x16x32_bf16 v[96:99], v[208:211], v[248:251], v[96:99]
  buffer_load_dwordx4 v[232:235], off, s[36:39], s50 offset:1024
  v_mfma_f32_16x16x32_bf16 v[100:103], v[208:211], v[252:255], v[100:103]
  ds_read_b64_tr_b16 v[176:177], v20 offset:36864
  ds_read_b64_tr_b16 v[178:179], v20 offset:37376
  v_mfma_f32_16x16x32_bf16 v[108:111], v[212:215], v[252:255], v[108:111]
  ds_read_b64_tr_b16 v[180:181], v21 offset:36864
  v_mfma_f32_16x16x32_bf16 v[104:107], v[212:215], v[248:251], v[104:107]
  ds_read_b64_tr_b16 v[182:183], v21 offset:37376
  v_mfma_f32_16x16x32_bf16 v[112:115], v[216:219], v[248:251], v[112:115]
  ds_read_b64_tr_b16 v[184:185], v22 offset:36864
  v_mfma_f32_16x16x32_bf16 v[116:119], v[216:219], v[252:255], v[116:119]
  ds_read_b64_tr_b16 v[186:187], v22 offset:37376
  v_mfma_f32_16x16x32_bf16 v[124:127], v[220:223], v[252:255], v[124:127]
  ds_read_b64_tr_b16 v[188:189], v23 offset:36864
  v_mfma_f32_16x16x32_bf16 v[120:123], v[220:223], v[248:251], v[120:123]
  ds_read_b64_tr_b16 v[190:191], v23 offset:37376
  s_waitcnt vmcnt(17) lgkmcnt(8)
  v_mfma_f32_16x16x32_bf16 v[128:131], v[160:163], v[32:35], v[128:131]
  buffer_load_dwordx4 v[236:239], off, s[64:67], s50 offset:1024
  v_mfma_f32_16x16x32_bf16 v[132:135], v[160:163], v[36:39], v[132:135]
  ds_read_b64_tr_b16 v[192:193], v20 offset:40960
  ds_read_b64_tr_b16 v[194:195], v20 offset:41472
  v_mfma_f32_16x16x32_bf16 v[140:143], v[164:167], v[36:39], v[140:143]
  ds_read_b64_tr_b16 v[196:197], v21 offset:40960
  v_mfma_f32_16x16x32_bf16 v[136:139], v[164:167], v[32:35], v[136:139]
  ds_read_b64_tr_b16 v[198:199], v21 offset:41472
  v_mfma_f32_16x16x32_bf16 v[144:147], v[168:171], v[32:35], v[144:147]
  ds_read_b64_tr_b16 v[200:201], v22 offset:40960
  v_mfma_f32_16x16x32_bf16 v[148:151], v[168:171], v[36:39], v[148:151]
  ds_read_b64_tr_b16 v[202:203], v22 offset:41472
  v_readlane_b32 s51, v15, 11
  v_mfma_f32_16x16x32_bf16 v[156:159], v[172:175], v[36:39], v[156:159]
  ds_read_b64_tr_b16 v[204:205], v23 offset:40960
  v_mfma_f32_16x16x32_bf16 v[152:155], v[172:175], v[32:35], v[152:155]
  ds_read_b64_tr_b16 v[206:207], v23 offset:41472
  s_waitcnt vmcnt(16) lgkmcnt(8)
  v_mfma_f32_16x16x32_bf16 v[128:131], v[176:179], v[40:43], v[128:131]
  buffer_load_dwordx4 v[240:243], off, s[36:39], s51 offset:0
  v_mfma_f32_16x16x32_bf16 v[132:135], v[176:179], v[44:47], v[132:135]
  ds_read_b64_tr_b16 v[208:209], v20 offset:45056
  ds_read_b64_tr_b16 v[210:211], v20 offset:45568
  v_mfma_f32_16x16x32_bf16 v[140:143], v[180:183], v[44:47], v[140:143]
  ds_read_b64_tr_b16 v[212:213], v21 offset:45056
  v_mfma_f32_16x16x32_bf16 v[136:139], v[180:183], v[40:43], v[136:139]
  ds_read_b64_tr_b16 v[214:215], v21 offset:45568
  v_mfma_f32_16x16x32_bf16 v[144:147], v[184:187], v[40:43], v[144:147]
  ds_read_b64_tr_b16 v[216:217], v22 offset:45056
  v_mfma_f32_16x16x32_bf16 v[148:151], v[184:187], v[44:47], v[148:151]
  ds_read_b64_tr_b16 v[218:219], v22 offset:45568
  v_mfma_f32_16x16x32_bf16 v[156:159], v[188:191], v[44:47], v[156:159]
  ds_read_b64_tr_b16 v[220:221], v23 offset:45056
  v_mfma_f32_16x16x32_bf16 v[152:155], v[188:191], v[40:43], v[152:155]
  ds_read_b64_tr_b16 v[222:223], v23 offset:45568
  s_waitcnt lgkmcnt(8)
  v_mfma_f32_16x16x32_bf16 v[96:99], v[192:195], v[32:35], v[96:99]
  buffer_load_dwordx4 v[244:247], off, s[64:67], s51 offset:0
  v_mfma_f32_16x16x32_bf16 v[100:103], v[192:195], v[36:39], v[100:103]
  ds_read_b64_tr_b16 v[160:161], v20 offset:49152
  ds_read_b64_tr_b16 v[162:163], v20 offset:49664
  v_mfma_f32_16x16x32_bf16 v[108:111], v[196:199], v[36:39], v[108:111]
  ds_read_b64_tr_b16 v[164:165], v21 offset:49152
  v_mfma_f32_16x16x32_bf16 v[104:107], v[196:199], v[32:35], v[104:107]
  ds_read_b64_tr_b16 v[166:167], v21 offset:49664
  v_mfma_f32_16x16x32_bf16 v[112:115], v[200:203], v[32:35], v[112:115]
  ds_read_b64_tr_b16 v[168:169], v22 offset:49152
  v_mfma_f32_16x16x32_bf16 v[116:119], v[200:203], v[36:39], v[116:119]
  ds_read_b64_tr_b16 v[170:171], v22 offset:49664
  v_mfma_f32_16x16x32_bf16 v[124:127], v[204:207], v[36:39], v[124:127]
  ds_read_b64_tr_b16 v[172:173], v23 offset:49152
  v_mfma_f32_16x16x32_bf16 v[120:123], v[204:207], v[32:35], v[120:123]
  ds_read_b64_tr_b16 v[174:175], v23 offset:49664
  s_waitcnt lgkmcnt(8)
  v_mfma_f32_16x16x32_bf16 v[96:99], v[208:211], v[40:43], v[96:99]
  buffer_load_dwordx4 v[248:251], off, s[36:39], s51 offset:1024
  v_mfma_f32_16x16x32_bf16 v[100:103], v[208:211], v[44:47], v[100:103]
  ds_read_b64_tr_b16 v[176:177], v20 offset:53248
  ds_read_b64_tr_b16 v[178:179], v20 offset:53760
  v_mfma_f32_16x16x32_bf16 v[108:111], v[212:215], v[44:47], v[108:111]
  ds_read_b64_tr_b16 v[180:181], v21 offset:53248
  v_mfma_f32_16x16x32_bf16 v[104:107], v[212:215], v[40:43], v[104:107]
  ds_read_b64_tr_b16 v[182:183], v21 offset:53760
  v_mfma_f32_16x16x32_bf16 v[112:115], v[216:219], v[40:43], v[112:115]
  ds_read_b64_tr_b16 v[184:185], v22 offset:53248
  v_mfma_f32_16x16x32_bf16 v[116:119], v[216:219], v[44:47], v[116:119]
  ds_read_b64_tr_b16 v[186:187], v22 offset:53760
  v_mfma_f32_16x16x32_bf16 v[124:127], v[220:223], v[44:47], v[124:127]
  ds_read_b64_tr_b16 v[188:189], v23 offset:53248
  v_mfma_f32_16x16x32_bf16 v[120:123], v[220:223], v[40:43], v[120:123]
  ds_read_b64_tr_b16 v[190:191], v23 offset:53760
  s_waitcnt vmcnt(17) lgkmcnt(8)
  v_mfma_f32_16x16x32_bf16 v[128:131], v[160:163], v[48:51], v[128:131]
  buffer_load_dwordx4 v[252:255], off, s[64:67], s51 offset:1024
  v_mfma_f32_16x16x32_bf16 v[132:135], v[160:163], v[52:55], v[132:135]
  ds_read_b64_tr_b16 v[192:193], v20 offset:57344
  ds_read_b64_tr_b16 v[194:195], v20 offset:57856
  v_mfma_f32_16x16x32_bf16 v[140:143], v[164:167], v[52:55], v[140:143]
  ds_read_b64_tr_b16 v[196:197], v21 offset:57344
  v_mfma_f32_16x16x32_bf16 v[136:139], v[164:167], v[48:51], v[136:139]
  ds_read_b64_tr_b16 v[198:199], v21 offset:57856
  v_mfma_f32_16x16x32_bf16 v[144:147], v[168:171], v[48:51], v[144:147]
  ds_read_b64_tr_b16 v[200:201], v22 offset:57344
  v_mfma_f32_16x16x32_bf16 v[148:151], v[168:171], v[52:55], v[148:151]
  ds_read_b64_tr_b16 v[202:203], v22 offset:57856
  v_readlane_b32 s48, v15, 12
  v_mfma_f32_16x16x32_bf16 v[156:159], v[172:175], v[52:55], v[156:159]
  ds_read_b64_tr_b16 v[204:205], v23 offset:57344
  v_mfma_f32_16x16x32_bf16 v[152:155], v[172:175], v[48:51], v[152:155]
  ds_read_b64_tr_b16 v[206:207], v23 offset:57856
  s_waitcnt vmcnt(16) lgkmcnt(8)
  v_mfma_f32_16x16x32_bf16 v[128:131], v[176:179], v[56:59], v[128:131]
  buffer_load_dwordx4 v[32:35], off, s[36:39], s48 offset:0
  v_mfma_f32_16x16x32_bf16 v[132:135], v[176:179], v[60:63], v[132:135]
  ds_read_b64_tr_b16 v[208:209], v20 offset:61440
  ds_read_b64_tr_b16 v[210:211], v20 offset:61952
  v_mfma_f32_16x16x32_bf16 v[140:143], v[180:183], v[60:63], v[140:143]
  ds_read_b64_tr_b16 v[212:213], v21 offset:61440
  v_mfma_f32_16x16x32_bf16 v[136:139], v[180:183], v[56:59], v[136:139]
  ds_read_b64_tr_b16 v[214:215], v21 offset:61952
  v_mfma_f32_16x16x32_bf16 v[144:147], v[184:187], v[56:59], v[144:147]
  ds_read_b64_tr_b16 v[216:217], v22 offset:61440
  v_mfma_f32_16x16x32_bf16 v[148:151], v[184:187], v[60:63], v[148:151]
  ds_read_b64_tr_b16 v[218:219], v22 offset:61952
  v_mfma_f32_16x16x32_bf16 v[156:159], v[188:191], v[60:63], v[156:159]
  ds_read_b64_tr_b16 v[220:221], v23 offset:61440
  v_mfma_f32_16x16x32_bf16 v[152:155], v[188:191], v[56:59], v[152:155]
  ds_read_b64_tr_b16 v[222:223], v23 offset:61952
  s_waitcnt lgkmcnt(8)
  v_mfma_f32_16x16x32_bf16 v[96:99], v[192:195], v[48:51], v[96:99]
  buffer_load_dwordx4 v[36:39], off, s[64:67], s48 offset:0
  v_mfma_f32_16x16x32_bf16 v[100:103], v[192:195], v[52:55], v[100:103]
  ds_read_b64_tr_b16 v[160:161], v26 offset:0
  ds_read_b64_tr_b16 v[162:163], v26 offset:512
  v_mfma_f32_16x16x32_bf16 v[108:111], v[196:199], v[52:55], v[108:111]
  ds_read_b64_tr_b16 v[164:165], v27 offset:0
  v_mfma_f32_16x16x32_bf16 v[104:107], v[196:199], v[48:51], v[104:107]
  ds_read_b64_tr_b16 v[166:167], v27 offset:512
  v_mfma_f32_16x16x32_bf16 v[112:115], v[200:203], v[48:51], v[112:115]
  ds_read_b64_tr_b16 v[168:169], v28 offset:0
  v_mfma_f32_16x16x32_bf16 v[116:119], v[200:203], v[52:55], v[116:119]
  ds_read_b64_tr_b16 v[170:171], v28 offset:512
  v_mfma_f32_16x16x32_bf16 v[124:127], v[204:207], v[52:55], v[124:127]
  ds_read_b64_tr_b16 v[172:173], v29 offset:0
  v_mfma_f32_16x16x32_bf16 v[120:123], v[204:207], v[48:51], v[120:123]
  ds_read_b64_tr_b16 v[174:175], v29 offset:512
  s_waitcnt lgkmcnt(8)
  s_barrier
  v_mfma_f32_16x16x32_bf16 v[96:99], v[208:211], v[56:59], v[96:99]
  buffer_load_dwordx4 v[40:43], off, s[36:39], s48 offset:1024
  v_mfma_f32_16x16x32_bf16 v[100:103], v[208:211], v[60:63], v[100:103]
  ds_read_b64_tr_b16 v[176:177], v26 offset:4096
  ds_read_b64_tr_b16 v[178:179], v26 offset:4608
  v_mfma_f32_16x16x32_bf16 v[108:111], v[212:215], v[60:63], v[108:111]
  ds_read_b64_tr_b16 v[180:181], v27 offset:4096
  v_mfma_f32_16x16x32_bf16 v[104:107], v[212:215], v[56:59], v[104:107]
  ds_read_b64_tr_b16 v[182:183], v27 offset:4608
  v_mfma_f32_16x16x32_bf16 v[112:115], v[216:219], v[56:59], v[112:115]
  ds_read_b64_tr_b16 v[184:185], v28 offset:4096
  v_mfma_f32_16x16x32_bf16 v[116:119], v[216:219], v[60:63], v[116:119]
  ds_read_b64_tr_b16 v[186:187], v28 offset:4608
  v_mfma_f32_16x16x32_bf16 v[124:127], v[220:223], v[60:63], v[124:127]
  ds_read_b64_tr_b16 v[188:189], v29 offset:4096
  v_mfma_f32_16x16x32_bf16 v[120:123], v[220:223], v[56:59], v[120:123]
  ds_read_b64_tr_b16 v[190:191], v29 offset:4608
  s_waitcnt vmcnt(17) lgkmcnt(8)
  v_mfma_f32_16x16x32_bf16 v[128:131], v[160:163], v[64:67], v[128:131]
  buffer_load_dwordx4 v[44:47], off, s[64:67], s48 offset:1024
  v_mfma_f32_16x16x32_bf16 v[132:135], v[160:163], v[68:71], v[132:135]
  ds_read_b64_tr_b16 v[192:193], v26 offset:8192
  ds_read_b64_tr_b16 v[194:195], v26 offset:8704
  v_mfma_f32_16x16x32_bf16 v[140:143], v[164:167], v[68:71], v[140:143]
  ds_read_b64_tr_b16 v[196:197], v27 offset:8192
  v_mfma_f32_16x16x32_bf16 v[136:139], v[164:167], v[64:67], v[136:139]
  ds_read_b64_tr_b16 v[198:199], v27 offset:8704
  v_mfma_f32_16x16x32_bf16 v[144:147], v[168:171], v[64:67], v[144:147]
  ds_read_b64_tr_b16 v[200:201], v28 offset:8192
  v_mfma_f32_16x16x32_bf16 v[148:151], v[168:171], v[68:71], v[148:151]
  ds_read_b64_tr_b16 v[202:203], v28 offset:8704
  v_readlane_b32 s49, v15, 13
  v_mfma_f32_16x16x32_bf16 v[156:159], v[172:175], v[68:71], v[156:159]
  ds_read_b64_tr_b16 v[204:205], v29 offset:8192
  v_mfma_f32_16x16x32_bf16 v[152:155], v[172:175], v[64:67], v[152:155]
  ds_read_b64_tr_b16 v[206:207], v29 offset:8704
  s_waitcnt vmcnt(16) lgkmcnt(8)
  v_mfma_f32_16x16x32_bf16 v[128:131], v[176:179], v[72:75], v[128:131]
  buffer_load_dwordx4 v[48:51], off, s[36:39], s49 offset:0
  v_mfma_f32_16x16x32_bf16 v[132:135], v[176:179], v[76:79], v[132:135]
  ds_read_b64_tr_b16 v[208:209], v26 offset:12288
  ds_read_b64_tr_b16 v[210:211], v26 offset:12800
  v_mfma_f32_16x16x32_bf16 v[140:143], v[180:183], v[76:79], v[140:143]
  ds_read_b64_tr_b16 v[212:213], v27 offset:12288
  v_mfma_f32_16x16x32_bf16 v[136:139], v[180:183], v[72:75], v[136:139]
  ds_read_b64_tr_b16 v[214:215], v27 offset:12800
  v_mfma_f32_16x16x32_bf16 v[144:147], v[184:187], v[72:75], v[144:147]
  ds_read_b64_tr_b16 v[216:217], v28 offset:12288
  v_mfma_f32_16x16x32_bf16 v[148:151], v[184:187], v[76:79], v[148:151]
  ds_read_b64_tr_b16 v[218:219], v28 offset:12800
  v_mfma_f32_16x16x32_bf16 v[156:159], v[188:191], v[76:79], v[156:159]
  ds_read_b64_tr_b16 v[220:221], v29 offset:12288
  v_mfma_f32_16x16x32_bf16 v[152:155], v[188:191], v[72:75], v[152:155]
  ds_read_b64_tr_b16 v[222:223], v29 offset:12800
  s_waitcnt lgkmcnt(8)
  v_mfma_f32_16x16x32_bf16 v[96:99], v[192:195], v[64:67], v[96:99]
  buffer_load_dwordx4 v[52:55], off, s[64:67], s49 offset:0
  v_mfma_f32_16x16x32_bf16 v[100:103], v[192:195], v[68:71], v[100:103]
  ds_read_b64_tr_b16 v[160:161], v26 offset:16384
  ds_read_b64_tr_b16 v[162:163], v26 offset:16896
  v_mfma_f32_16x16x32_bf16 v[108:111], v[196:199], v[68:71], v[108:111]
  ds_read_b64_tr_b16 v[164:165], v27 offset:16384
  v_mfma_f32_16x16x32_bf16 v[104:107], v[196:199], v[64:67], v[104:107]
  ds_read_b64_tr_b16 v[166:167], v27 offset:16896
  v_mfma_f32_16x16x32_bf16 v[112:115], v[200:203], v[64:67], v[112:115]
  ds_read_b64_tr_b16 v[168:169], v28 offset:16384
  v_mfma_f32_16x16x32_bf16 v[116:119], v[200:203], v[68:71], v[116:119]
  ds_read_b64_tr_b16 v[170:171], v28 offset:16896
  v_mfma_f32_16x16x32_bf16 v[124:127], v[204:207], v[68:71], v[124:127]
  ds_read_b64_tr_b16 v[172:173], v29 offset:16384
  v_mfma_f32_16x16x32_bf16 v[120:123], v[204:207], v[64:67], v[120:123]
  ds_read_b64_tr_b16 v[174:175], v29 offset:16896
  s_waitcnt lgkmcnt(8)
  v_mfma_f32_16x16x32_bf16 v[96:99], v[208:211], v[72:75], v[96:99]
  buffer_load_dwordx4 v[56:59], off, s[36:39], s49 offset:1024
  v_mfma_f32_16x16x32_bf16 v[100:103], v[208:211], v[76:79], v[100:103]
  ds_read_b64_tr_b16 v[176:177], v26 offset:20480
  ds_read_b64_tr_b16 v[178:179], v26 offset:20992
  v_mfma_f32_16x16x32_bf16 v[108:111], v[212:215], v[76:79], v[108:111]
  ds_read_b64_tr_b16 v[180:181], v27 offset:20480
  v_mfma_f32_16x16x32_bf16 v[104:107], v[212:215], v[72:75], v[104:107]
  ds_read_b64_tr_b16 v[182:183], v27 offset:20992
  v_mfma_f32_16x16x32_bf16 v[112:115], v[216:219], v[72:75], v[112:115]
  ds_read_b64_tr_b16 v[184:185], v28 offset:20480
  v_mfma_f32_16x16x32_bf16 v[116:119], v[216:219], v[76:79], v[116:119]
  ds_read_b64_tr_b16 v[186:187], v28 offset:20992
  v_mfma_f32_16x16x32_bf16 v[124:127], v[220:223], v[76:79], v[124:127]
  ds_read_b64_tr_b16 v[188:189], v29 offset:20480
  v_mfma_f32_16x16x32_bf16 v[120:123], v[220:223], v[72:75], v[120:123]
  ds_read_b64_tr_b16 v[190:191], v29 offset:20992
  s_waitcnt vmcnt(17) lgkmcnt(8)
  v_mfma_f32_16x16x32_bf16 v[128:131], v[160:163], v[80:83], v[128:131]
  buffer_load_dwordx4 v[60:63], off, s[64:67], s49 offset:1024
  v_mfma_f32_16x16x32_bf16 v[132:135], v[160:163], v[84:87], v[132:135]
  ds_read_b64_tr_b16 v[192:193], v26 offset:24576
  ds_read_b64_tr_b16 v[194:195], v26 offset:25088
  v_mfma_f32_16x16x32_bf16 v[140:143], v[164:167], v[84:87], v[140:143]
  ds_read_b64_tr_b16 v[196:197], v27 offset:24576
  v_mfma_f32_16x16x32_bf16 v[136:139], v[164:167], v[80:83], v[136:139]
  ds_read_b64_tr_b16 v[198:199], v27 offset:25088
  v_mfma_f32_16x16x32_bf16 v[144:147], v[168:171], v[80:83], v[144:147]
  ds_read_b64_tr_b16 v[200:201], v28 offset:24576
  v_mfma_f32_16x16x32_bf16 v[148:151], v[168:171], v[84:87], v[148:151]
  ds_read_b64_tr_b16 v[202:203], v28 offset:25088
  v_readlane_b32 s50, v15, 14
  v_mfma_f32_16x16x32_bf16 v[156:159], v[172:175], v[84:87], v[156:159]
  ds_read_b64_tr_b16 v[204:205], v29 offset:24576
  v_mfma_f32_16x16x32_bf16 v[152:155], v[172:175], v[80:83], v[152:155]
  ds_read_b64_tr_b16 v[206:207], v29 offset:25088
  s_waitcnt vmcnt(16) lgkmcnt(8)
  v_mfma_f32_16x16x32_bf16 v[128:131], v[176:179], v[88:91], v[128:131]
  buffer_load_dwordx4 v[64:67], off, s[36:39], s50 offset:0
  v_mfma_f32_16x16x32_bf16 v[132:135], v[176:179], v[92:95], v[132:135]
  ds_read_b64_tr_b16 v[208:209], v26 offset:28672
  ds_read_b64_tr_b16 v[210:211], v26 offset:29184
  v_mfma_f32_16x16x32_bf16 v[140:143], v[180:183], v[92:95], v[140:143]
  ds_read_b64_tr_b16 v[212:213], v27 offset:28672
  v_mfma_f32_16x16x32_bf16 v[136:139], v[180:183], v[88:91], v[136:139]
  ds_read_b64_tr_b16 v[214:215], v27 offset:29184
  v_mfma_f32_16x16x32_bf16 v[144:147], v[184:187], v[88:91], v[144:147]
  ds_read_b64_tr_b16 v[216:217], v28 offset:28672
  v_mfma_f32_16x16x32_bf16 v[148:151], v[184:187], v[92:95], v[148:151]
  ds_read_b64_tr_b16 v[218:219], v28 offset:29184
  v_mfma_f32_16x16x32_bf16 v[156:159], v[188:191], v[92:95], v[156:159]
  ds_read_b64_tr_b16 v[220:221], v29 offset:28672
  v_mfma_f32_16x16x32_bf16 v[152:155], v[188:191], v[88:91], v[152:155]
  ds_read_b64_tr_b16 v[222:223], v29 offset:29184
  s_waitcnt lgkmcnt(8)
  v_mfma_f32_16x16x32_bf16 v[96:99], v[192:195], v[80:83], v[96:99]
  buffer_load_dwordx4 v[68:71], off, s[64:67], s50 offset:0
  v_mfma_f32_16x16x32_bf16 v[100:103], v[192:195], v[84:87], v[100:103]
  ds_read_b64_tr_b16 v[160:161], v6 offset:0
  ds_read_b64_tr_b16 v[162:163], v6 offset:512
  v_mfma_f32_16x16x32_bf16 v[108:111], v[196:199], v[84:87], v[108:111]
  ds_read_b64_tr_b16 v[164:165], v7 offset:0
  v_mfma_f32_16x16x32_bf16 v[104:107], v[196:199], v[80:83], v[104:107]
  ds_read_b64_tr_b16 v[166:167], v7 offset:512
  v_mfma_f32_16x16x32_bf16 v[112:115], v[200:203], v[80:83], v[112:115]
  ds_read_b64_tr_b16 v[168:169], v8 offset:0
  v_mfma_f32_16x16x32_bf16 v[116:119], v[200:203], v[84:87], v[116:119]
  ds_read_b64_tr_b16 v[170:171], v8 offset:512
  v_mfma_f32_16x16x32_bf16 v[124:127], v[204:207], v[84:87], v[124:127]
  ds_read_b64_tr_b16 v[172:173], v9 offset:0
  v_mfma_f32_16x16x32_bf16 v[120:123], v[204:207], v[80:83], v[120:123]
  ds_read_b64_tr_b16 v[174:175], v9 offset:512
  s_waitcnt lgkmcnt(8)
  s_barrier
  v_mfma_f32_16x16x32_bf16 v[96:99], v[208:211], v[88:91], v[96:99]
  buffer_load_dwordx4 v[72:75], off, s[36:39], s50 offset:1024
  v_mfma_f32_16x16x32_bf16 v[100:103], v[208:211], v[92:95], v[100:103]
  ds_read_b64_tr_b16 v[176:177], v6 offset:4096
  ds_read_b64_tr_b16 v[178:179], v6 offset:4608
  v_mfma_f32_16x16x32_bf16 v[108:111], v[212:215], v[92:95], v[108:111]
  ds_read_b64_tr_b16 v[180:181], v7 offset:4096
  v_mfma_f32_16x16x32_bf16 v[104:107], v[212:215], v[88:91], v[104:107]
  ds_read_b64_tr_b16 v[182:183], v7 offset:4608
  v_mfma_f32_16x16x32_bf16 v[112:115], v[216:219], v[88:91], v[112:115]
  ds_read_b64_tr_b16 v[184:185], v8 offset:4096
  v_mfma_f32_16x16x32_bf16 v[116:119], v[216:219], v[92:95], v[116:119]
  ds_read_b64_tr_b16 v[186:187], v8 offset:4608
  v_mfma_f32_16x16x32_bf16 v[124:127], v[220:223], v[92:95], v[124:127]
  ds_read_b64_tr_b16 v[188:189], v9 offset:4096
  v_mfma_f32_16x16x32_bf16 v[120:123], v[220:223], v[88:91], v[120:123]
  ds_read_b64_tr_b16 v[190:191], v9 offset:4608
  s_waitcnt vmcnt(17) lgkmcnt(8)
  v_mfma_f32_16x16x32_bf16 v[128:131], v[160:163], v[224:227], v[128:131]
  buffer_load_dwordx4 v[76:79], off, s[64:67], s50 offset:1024
  v_mfma_f32_16x16x32_bf16 v[132:135], v[160:163], v[228:231], v[132:135]
  ds_read_b64_tr_b16 v[192:193], v6 offset:8192
  ds_read_b64_tr_b16 v[194:195], v6 offset:8704
  v_mfma_f32_16x16x32_bf16 v[140:143], v[164:167], v[228:231], v[140:143]
  ds_read_b64_tr_b16 v[196:197], v7 offset:8192
  v_mfma_f32_16x16x32_bf16 v[136:139], v[164:167], v[224:227], v[136:139]
  ds_read_b64_tr_b16 v[198:199], v7 offset:8704
  v_mfma_f32_16x16x32_bf16 v[144:147], v[168:171], v[224:227], v[144:147]
  ds_read_b64_tr_b16 v[200:201], v8 offset:8192
  v_mfma_f32_16x16x32_bf16 v[148:151], v[168:171], v[228:231], v[148:151]
  ds_read_b64_tr_b16 v[202:203], v8 offset:8704
  v_readlane_b32 s51, v15, 15
  v_mfma_f32_16x16x32_bf16 v[156:159], v[172:175], v[228:231], v[156:159]
  ds_read_b64_tr_b16 v[204:205], v9 offset:8192
  v_mfma_f32_16x16x32_bf16 v[152:155], v[172:175], v[224:227], v[152:155]
  ds_read_b64_tr_b16 v[206:207], v9 offset:8704
  s_waitcnt vmcnt(16) lgkmcnt(8)
  v_mfma_f32_16x16x32_bf16 v[128:131], v[176:179], v[232:235], v[128:131]
  buffer_load_dwordx4 v[80:83], off, s[36:39], s51 offset:0
  v_mfma_f32_16x16x32_bf16 v[132:135], v[176:179], v[236:239], v[132:135]
  ds_read_b64_tr_b16 v[208:209], v6 offset:12288
  ds_read_b64_tr_b16 v[210:211], v6 offset:12800
  v_mfma_f32_16x16x32_bf16 v[140:143], v[180:183], v[236:239], v[140:143]
  ds_read_b64_tr_b16 v[212:213], v7 offset:12288
  v_mfma_f32_16x16x32_bf16 v[136:139], v[180:183], v[232:235], v[136:139]
  ds_read_b64_tr_b16 v[214:215], v7 offset:12800
  v_mfma_f32_16x16x32_bf16 v[144:147], v[184:187], v[232:235], v[144:147]
  ds_read_b64_tr_b16 v[216:217], v8 offset:12288
  v_mfma_f32_16x16x32_bf16 v[148:151], v[184:187], v[236:239], v[148:151]
  ds_read_b64_tr_b16 v[218:219], v8 offset:12800
  v_mfma_f32_16x16x32_bf16 v[156:159], v[188:191], v[236:239], v[156:159]
  ds_read_b64_tr_b16 v[220:221], v9 offset:12288
  v_mfma_f32_16x16x32_bf16 v[152:155], v[188:191], v[232:235], v[152:155]
  ds_read_b64_tr_b16 v[222:223], v9 offset:12800
  s_waitcnt lgkmcnt(8)
  v_mfma_f32_16x16x32_bf16 v[96:99], v[192:195], v[224:227], v[96:99]
  buffer_load_dwordx4 v[84:87], off, s[64:67], s51 offset:0
  v_mfma_f32_16x16x32_bf16 v[100:103], v[192:195], v[228:231], v[100:103]
  ds_read_b64_tr_b16 v[160:161], v6 offset:16384
  ds_read_b64_tr_b16 v[162:163], v6 offset:16896
  v_mfma_f32_16x16x32_bf16 v[108:111], v[196:199], v[228:231], v[108:111]
  ds_read_b64_tr_b16 v[164:165], v7 offset:16384
  v_mfma_f32_16x16x32_bf16 v[104:107], v[196:199], v[224:227], v[104:107]
  ds_read_b64_tr_b16 v[166:167], v7 offset:16896
  v_mfma_f32_16x16x32_bf16 v[112:115], v[200:203], v[224:227], v[112:115]
  ds_read_b64_tr_b16 v[168:169], v8 offset:16384
  v_mfma_f32_16x16x32_bf16 v[116:119], v[200:203], v[228:231], v[116:119]
  ds_read_b64_tr_b16 v[170:171], v8 offset:16896
  v_mfma_f32_16x16x32_bf16 v[124:127], v[204:207], v[228:231], v[124:127]
  ds_read_b64_tr_b16 v[172:173], v9 offset:16384
  v_mfma_f32_16x16x32_bf16 v[120:123], v[204:207], v[224:227], v[120:123]
  ds_read_b64_tr_b16 v[174:175], v9 offset:16896
  s_waitcnt lgkmcnt(8)
  v_mfma_f32_16x16x32_bf16 v[96:99], v[208:211], v[232:235], v[96:99]
  buffer_load_dwordx4 v[88:91], off, s[36:39], s51 offset:1024
  v_mfma_f32_16x16x32_bf16 v[100:103], v[208:211], v[236:239], v[100:103]
  ds_read_b64_tr_b16 v[176:177], v6 offset:20480
  ds_read_b64_tr_b16 v[178:179], v6 offset:20992
  v_mfma_f32_16x16x32_bf16 v[108:111], v[212:215], v[236:239], v[108:111]
  ds_read_b64_tr_b16 v[180:181], v7 offset:20480
  v_mfma_f32_16x16x32_bf16 v[104:107], v[212:215], v[232:235], v[104:107]
  ds_read_b64_tr_b16 v[182:183], v7 offset:20992
  v_mfma_f32_16x16x32_bf16 v[112:115], v[216:219], v[232:235], v[112:115]
  ds_read_b64_tr_b16 v[184:185], v8 offset:20480
  v_mfma_f32_16x16x32_bf16 v[116:119], v[216:219], v[236:239], v[116:119]
  ds_read_b64_tr_b16 v[186:187], v8 offset:20992
  v_mfma_f32_16x16x32_bf16 v[124:127], v[220:223], v[236:239], v[124:127]
  ds_read_b64_tr_b16 v[188:189], v9 offset:20480
  v_mfma_f32_16x16x32_bf16 v[120:123], v[220:223], v[232:235], v[120:123]
  ds_read_b64_tr_b16 v[190:191], v9 offset:20992
  s_waitcnt vmcnt(17) lgkmcnt(8)
  v_mfma_f32_16x16x32_bf16 v[128:131], v[160:163], v[240:243], v[128:131]
  buffer_load_dwordx4 v[92:95], off, s[64:67], s51 offset:1024
  v_mfma_f32_16x16x32_bf16 v[132:135], v[160:163], v[244:247], v[132:135]
  ds_read_b64_tr_b16 v[192:193], v6 offset:24576
  ds_read_b64_tr_b16 v[194:195], v6 offset:25088
  v_mfma_f32_16x16x32_bf16 v[140:143], v[164:167], v[244:247], v[140:143]
  ds_read_b64_tr_b16 v[196:197], v7 offset:24576
  v_mfma_f32_16x16x32_bf16 v[136:139], v[164:167], v[240:243], v[136:139]
  ds_read_b64_tr_b16 v[198:199], v7 offset:25088
  v_mfma_f32_16x16x32_bf16 v[144:147], v[168:171], v[240:243], v[144:147]
  ds_read_b64_tr_b16 v[200:201], v8 offset:24576
  v_mfma_f32_16x16x32_bf16 v[148:151], v[168:171], v[244:247], v[148:151]
  ds_read_b64_tr_b16 v[202:203], v8 offset:25088
  v_readlane_b32 s48, v15, 16
  v_mfma_f32_16x16x32_bf16 v[156:159], v[172:175], v[244:247], v[156:159]
  ds_read_b64_tr_b16 v[204:205], v9 offset:24576
  v_mfma_f32_16x16x32_bf16 v[152:155], v[172:175], v[240:243], v[152:155]
  ds_read_b64_tr_b16 v[206:207], v9 offset:25088
  s_waitcnt vmcnt(16) lgkmcnt(8)
  v_mfma_f32_16x16x32_bf16 v[128:131], v[176:179], v[248:251], v[128:131]
  buffer_load_dwordx4 v[224:227], off, s[36:39], s48 offset:0
  v_mfma_f32_16x16x32_bf16 v[132:135], v[176:179], v[252:255], v[132:135]
  ds_read_b64_tr_b16 v[208:209], v6 offset:28672
  ds_read_b64_tr_b16 v[210:211], v6 offset:29184
  v_mfma_f32_16x16x32_bf16 v[140:143], v[180:183], v[252:255], v[140:143]
  ds_read_b64_tr_b16 v[212:213], v7 offset:28672
  v_mfma_f32_16x16x32_bf16 v[136:139], v[180:183], v[248:251], v[136:139]
  ds_read_b64_tr_b16 v[214:215], v7 offset:29184
  v_mfma_f32_16x16x32_bf16 v[144:147], v[184:187], v[248:251], v[144:147]
  ds_read_b64_tr_b16 v[216:217], v8 offset:28672
  v_mfma_f32_16x16x32_bf16 v[148:151], v[184:187], v[252:255], v[148:151]
  ds_read_b64_tr_b16 v[218:219], v8 offset:29184
  v_mfma_f32_16x16x32_bf16 v[156:159], v[188:191], v[252:255], v[156:159]
  ds_read_b64_tr_b16 v[220:221], v9 offset:28672
  v_mfma_f32_16x16x32_bf16 v[152:155], v[188:191], v[248:251], v[152:155]
  ds_read_b64_tr_b16 v[222:223], v9 offset:29184
  s_waitcnt lgkmcnt(8)
  v_mfma_f32_16x16x32_bf16 v[96:99], v[192:195], v[240:243], v[96:99]
  buffer_load_dwordx4 v[228:231], off, s[64:67], s48 offset:0
  v_mfma_f32_16x16x32_bf16 v[100:103], v[192:195], v[244:247], v[100:103]
  ds_read_b64_tr_b16 v[160:161], v6 offset:32768
  ds_read_b64_tr_b16 v[162:163], v6 offset:33280
  v_mfma_f32_16x16x32_bf16 v[108:111], v[196:199], v[244:247], v[108:111]
  ds_read_b64_tr_b16 v[164:165], v7 offset:32768
  v_mfma_f32_16x16x32_bf16 v[104:107], v[196:199], v[240:243], v[104:107]
  ds_read_b64_tr_b16 v[166:167], v7 offset:33280
  v_mfma_f32_16x16x32_bf16 v[112:115], v[200:203], v[240:243], v[112:115]
  ds_read_b64_tr_b16 v[168:169], v8 offset:32768
  v_mfma_f32_16x16x32_bf16 v[116:119], v[200:203], v[244:247], v[116:119]
  ds_read_b64_tr_b16 v[170:171], v8 offset:33280
  v_mfma_f32_16x16x32_bf16 v[124:127], v[204:207], v[244:247], v[124:127]
  ds_read_b64_tr_b16 v[172:173], v9 offset:32768
  v_mfma_f32_16x16x32_bf16 v[120:123], v[204:207], v[240:243], v[120:123]
  ds_read_b64_tr_b16 v[174:175], v9 offset:33280
  s_waitcnt lgkmcnt(8)
  s_barrier
  v_mfma_f32_16x16x32_bf16 v[96:99], v[208:211], v[248:251], v[96:99]
  buffer_load_dwordx4 v[232:235], off, s[36:39], s48 offset:1024
  v_mfma_f32_16x16x32_bf16 v[100:103], v[208:211], v[252:255], v[100:103]
  ds_read_b64_tr_b16 v[176:177], v6 offset:36864
  ds_read_b64_tr_b16 v[178:179], v6 offset:37376
  v_mfma_f32_16x16x32_bf16 v[108:111], v[212:215], v[252:255], v[108:111]
  ds_read_b64_tr_b16 v[180:181], v7 offset:36864
  v_mfma_f32_16x16x32_bf16 v[104:107], v[212:215], v[248:251], v[104:107]
  ds_read_b64_tr_b16 v[182:183], v7 offset:37376
  v_mfma_f32_16x16x32_bf16 v[112:115], v[216:219], v[248:251], v[112:115]
  ds_read_b64_tr_b16 v[184:185], v8 offset:36864
  v_mfma_f32_16x16x32_bf16 v[116:119], v[216:219], v[252:255], v[116:119]
  ds_read_b64_tr_b16 v[186:187], v8 offset:37376
  v_mfma_f32_16x16x32_bf16 v[124:127], v[220:223], v[252:255], v[124:127]
  ds_read_b64_tr_b16 v[188:189], v9 offset:36864
  v_mfma_f32_16x16x32_bf16 v[120:123], v[220:223], v[248:251], v[120:123]
  ds_read_b64_tr_b16 v[190:191], v9 offset:37376
  s_waitcnt vmcnt(17) lgkmcnt(8)
  v_mfma_f32_16x16x32_bf16 v[128:131], v[160:163], v[32:35], v[128:131]
  buffer_load_dwordx4 v[236:239], off, s[64:67], s48 offset:1024
  v_mfma_f32_16x16x32_bf16 v[132:135], v[160:163], v[36:39], v[132:135]
  ds_read_b64_tr_b16 v[192:193], v6 offset:40960
  ds_read_b64_tr_b16 v[194:195], v6 offset:41472
  v_mfma_f32_16x16x32_bf16 v[140:143], v[164:167], v[36:39], v[140:143]
  ds_read_b64_tr_b16 v[196:197], v7 offset:40960
  v_mfma_f32_16x16x32_bf16 v[136:139], v[164:167], v[32:35], v[136:139]
  ds_read_b64_tr_b16 v[198:199], v7 offset:41472
  v_mfma_f32_16x16x32_bf16 v[144:147], v[168:171], v[32:35], v[144:147]
  ds_read_b64_tr_b16 v[200:201], v8 offset:40960
  v_mfma_f32_16x16x32_bf16 v[148:151], v[168:171], v[36:39], v[148:151]
  ds_read_b64_tr_b16 v[202:203], v8 offset:41472
  v_readlane_b32 s49, v15, 17
  v_mfma_f32_16x16x32_bf16 v[156:159], v[172:175], v[36:39], v[156:159]
  ds_read_b64_tr_b16 v[204:205], v9 offset:40960
  v_mfma_f32_16x16x32_bf16 v[152:155], v[172:175], v[32:35], v[152:155]
  ds_read_b64_tr_b16 v[206:207], v9 offset:41472
  s_waitcnt vmcnt(16) lgkmcnt(8)
  v_mfma_f32_16x16x32_bf16 v[128:131], v[176:179], v[40:43], v[128:131]
  buffer_load_dwordx4 v[240:243], off, s[36:39], s49 offset:0
  v_mfma_f32_16x16x32_bf16 v[132:135], v[176:179], v[44:47], v[132:135]
  ds_read_b64_tr_b16 v[208:209], v6 offset:45056
  ds_read_b64_tr_b16 v[210:211], v6 offset:45568
  v_mfma_f32_16x16x32_bf16 v[140:143], v[180:183], v[44:47], v[140:143]
  ds_read_b64_tr_b16 v[212:213], v7 offset:45056
  v_mfma_f32_16x16x32_bf16 v[136:139], v[180:183], v[40:43], v[136:139]
  ds_read_b64_tr_b16 v[214:215], v7 offset:45568
  v_mfma_f32_16x16x32_bf16 v[144:147], v[184:187], v[40:43], v[144:147]
  ds_read_b64_tr_b16 v[216:217], v8 offset:45056
  v_mfma_f32_16x16x32_bf16 v[148:151], v[184:187], v[44:47], v[148:151]
  ds_read_b64_tr_b16 v[218:219], v8 offset:45568
  v_mfma_f32_16x16x32_bf16 v[156:159], v[188:191], v[44:47], v[156:159]
  ds_read_b64_tr_b16 v[220:221], v9 offset:45056
  v_mfma_f32_16x16x32_bf16 v[152:155], v[188:191], v[40:43], v[152:155]
  ds_read_b64_tr_b16 v[222:223], v9 offset:45568
  s_waitcnt lgkmcnt(8)
  v_mfma_f32_16x16x32_bf16 v[96:99], v[192:195], v[32:35], v[96:99]
  buffer_load_dwordx4 v[244:247], off, s[64:67], s49 offset:0
  v_mfma_f32_16x16x32_bf16 v[100:103], v[192:195], v[36:39], v[100:103]
  ds_read_b64_tr_b16 v[160:161], v6 offset:49152
  ds_read_b64_tr_b16 v[162:163], v6 offset:49664
  v_mfma_f32_16x16x32_bf16 v[108:111], v[196:199], v[36:39], v[108:111]
  ds_read_b64_tr_b16 v[164:165], v7 offset:49152
  v_mfma_f32_16x16x32_bf16 v[104:107], v[196:199], v[32:35], v[104:107]
  ds_read_b64_tr_b16 v[166:167], v7 offset:49664
  v_mfma_f32_16x16x32_bf16 v[112:115], v[200:203], v[32:35], v[112:115]
  ds_read_b64_tr_b16 v[168:169], v8 offset:49152
  v_mfma_f32_16x16x32_bf16 v[116:119], v[200:203], v[36:39], v[116:119]
  ds_read_b64_tr_b16 v[170:171], v8 offset:49664
  v_mfma_f32_16x16x32_bf16 v[124:127], v[204:207], v[36:39], v[124:127]
  ds_read_b64_tr_b16 v[172:173], v9 offset:49152
  v_mfma_f32_16x16x32_bf16 v[120:123], v[204:207], v[32:35], v[120:123]
  ds_read_b64_tr_b16 v[174:175], v9 offset:49664
  s_waitcnt lgkmcnt(8)
  v_mfma_f32_16x16x32_bf16 v[96:99], v[208:211], v[40:43], v[96:99]
  buffer_load_dwordx4 v[248:251], off, s[36:39], s49 offset:1024
  v_mfma_f32_16x16x32_bf16 v[100:103], v[208:211], v[44:47], v[100:103]
  ds_read_b64_tr_b16 v[176:177], v6 offset:53248
  ds_read_b64_tr_b16 v[178:179], v6 offset:53760
  v_mfma_f32_16x16x32_bf16 v[108:111], v[212:215], v[44:47], v[108:111]
  ds_read_b64_tr_b16 v[180:181], v7 offset:53248
  v_mfma_f32_16x16x32_bf16 v[104:107], v[212:215], v[40:43], v[104:107]
  ds_read_b64_tr_b16 v[182:183], v7 offset:53760
  v_mfma_f32_16x16x32_bf16 v[112:115], v[216:219], v[40:43], v[112:115]
  ds_read_b64_tr_b16 v[184:185], v8 offset:53248
  v_mfma_f32_16x16x32_bf16 v[116:119], v[216:219], v[44:47], v[116:119]
  ds_read_b64_tr_b16 v[186:187], v8 offset:53760
  v_mfma_f32_16x16x32_bf16 v[124:127], v[220:223], v[44:47], v[124:127]
  ds_read_b64_tr_b16 v[188:189], v9 offset:53248
  v_mfma_f32_16x16x32_bf16 v[120:123], v[220:223], v[40:43], v[120:123]
  ds_read_b64_tr_b16 v[190:191], v9 offset:53760
  s_waitcnt vmcnt(17) lgkmcnt(8)
  v_mfma_f32_16x16x32_bf16 v[128:131], v[160:163], v[48:51], v[128:131]
  buffer_load_dwordx4 v[252:255], off, s[64:67], s49 offset:1024
  v_mfma_f32_16x16x32_bf16 v[132:135], v[160:163], v[52:55], v[132:135]
  ds_read_b64_tr_b16 v[192:193], v6 offset:57344
  ds_read_b64_tr_b16 v[194:195], v6 offset:57856
  v_mfma_f32_16x16x32_bf16 v[140:143], v[164:167], v[52:55], v[140:143]
  ds_read_b64_tr_b16 v[196:197], v7 offset:57344
  v_mfma_f32_16x16x32_bf16 v[136:139], v[164:167], v[48:51], v[136:139]
  ds_read_b64_tr_b16 v[198:199], v7 offset:57856
  v_mfma_f32_16x16x32_bf16 v[144:147], v[168:171], v[48:51], v[144:147]
  ds_read_b64_tr_b16 v[200:201], v8 offset:57344
  v_mfma_f32_16x16x32_bf16 v[148:151], v[168:171], v[52:55], v[148:151]
  ds_read_b64_tr_b16 v[202:203], v8 offset:57856
  v_readlane_b32 s50, v15, 18
  v_mfma_f32_16x16x32_bf16 v[156:159], v[172:175], v[52:55], v[156:159]
  ds_read_b64_tr_b16 v[204:205], v9 offset:57344
  v_mfma_f32_16x16x32_bf16 v[152:155], v[172:175], v[48:51], v[152:155]
  ds_read_b64_tr_b16 v[206:207], v9 offset:57856
  s_waitcnt vmcnt(16) lgkmcnt(8)
  v_mfma_f32_16x16x32_bf16 v[128:131], v[176:179], v[56:59], v[128:131]
  buffer_load_dwordx4 v[32:35], off, s[36:39], s50 offset:0
  v_mfma_f32_16x16x32_bf16 v[132:135], v[176:179], v[60:63], v[132:135]
  ds_read_b64_tr_b16 v[208:209], v6 offset:61440
  ds_read_b64_tr_b16 v[210:211], v6 offset:61952
  v_mfma_f32_16x16x32_bf16 v[140:143], v[180:183], v[60:63], v[140:143]
  ds_read_b64_tr_b16 v[212:213], v7 offset:61440
  v_mfma_f32_16x16x32_bf16 v[136:139], v[180:183], v[56:59], v[136:139]
  ds_read_b64_tr_b16 v[214:215], v7 offset:61952
  v_mfma_f32_16x16x32_bf16 v[144:147], v[184:187], v[56:59], v[144:147]
  ds_read_b64_tr_b16 v[216:217], v8 offset:61440
  v_mfma_f32_16x16x32_bf16 v[148:151], v[184:187], v[60:63], v[148:151]
  ds_read_b64_tr_b16 v[218:219], v8 offset:61952
  v_mfma_f32_16x16x32_bf16 v[156:159], v[188:191], v[60:63], v[156:159]
  ds_read_b64_tr_b16 v[220:221], v9 offset:61440
  v_mfma_f32_16x16x32_bf16 v[152:155], v[188:191], v[56:59], v[152:155]
  ds_read_b64_tr_b16 v[222:223], v9 offset:61952
  s_waitcnt lgkmcnt(8)
  v_mfma_f32_16x16x32_bf16 v[96:99], v[192:195], v[48:51], v[96:99]
  buffer_load_dwordx4 v[36:39], off, s[64:67], s50 offset:0
  v_mfma_f32_16x16x32_bf16 v[100:103], v[192:195], v[52:55], v[100:103]
  ds_read_b64_tr_b16 v[160:161], v20 offset:0
  ds_read_b64_tr_b16 v[162:163], v20 offset:512
  v_mfma_f32_16x16x32_bf16 v[108:111], v[196:199], v[52:55], v[108:111]
  ds_read_b64_tr_b16 v[164:165], v21 offset:0
  v_mfma_f32_16x16x32_bf16 v[104:107], v[196:199], v[48:51], v[104:107]
  ds_read_b64_tr_b16 v[166:167], v21 offset:512
  v_mfma_f32_16x16x32_bf16 v[112:115], v[200:203], v[48:51], v[112:115]
  ds_read_b64_tr_b16 v[168:169], v22 offset:0
  v_mfma_f32_16x16x32_bf16 v[116:119], v[200:203], v[52:55], v[116:119]
  ds_read_b64_tr_b16 v[170:171], v22 offset:512
  v_mfma_f32_16x16x32_bf16 v[124:127], v[204:207], v[52:55], v[124:127]
  ds_read_b64_tr_b16 v[172:173], v23 offset:0
  v_mfma_f32_16x16x32_bf16 v[120:123], v[204:207], v[48:51], v[120:123]
  ds_read_b64_tr_b16 v[174:175], v23 offset:512
  s_waitcnt lgkmcnt(8)
  s_barrier
  v_mfma_f32_16x16x32_bf16 v[96:99], v[208:211], v[56:59], v[96:99]
  buffer_load_dwordx4 v[40:43], off, s[36:39], s50 offset:1024
  v_mfma_f32_16x16x32_bf16 v[100:103], v[208:211], v[60:63], v[100:103]
  ds_read_b64_tr_b16 v[176:177], v20 offset:4096
  ds_read_b64_tr_b16 v[178:179], v20 offset:4608
  v_mfma_f32_16x16x32_bf16 v[108:111], v[212:215], v[60:63], v[108:111]
  ds_read_b64_tr_b16 v[180:181], v21 offset:4096
  v_mfma_f32_16x16x32_bf16 v[104:107], v[212:215], v[56:59], v[104:107]
  ds_read_b64_tr_b16 v[182:183], v21 offset:4608
  v_mfma_f32_16x16x32_bf16 v[112:115], v[216:219], v[56:59], v[112:115]
  ds_read_b64_tr_b16 v[184:185], v22 offset:4096
  v_mfma_f32_16x16x32_bf16 v[116:119], v[216:219], v[60:63], v[116:119]
  ds_read_b64_tr_b16 v[186:187], v22 offset:4608
  v_mfma_f32_16x16x32_bf16 v[124:127], v[220:223], v[60:63], v[124:127]
  ds_read_b64_tr_b16 v[188:189], v23 offset:4096
  v_mfma_f32_16x16x32_bf16 v[120:123], v[220:223], v[56:59], v[120:123]
  ds_read_b64_tr_b16 v[190:191], v23 offset:4608
  s_waitcnt vmcnt(17) lgkmcnt(8)
  v_mfma_f32_16x16x32_bf16 v[128:131], v[160:163], v[64:67], v[128:131]
  buffer_load_dwordx4 v[44:47], off, s[64:67], s50 offset:1024
  v_mfma_f32_16x16x32_bf16 v[132:135], v[160:163], v[68:71], v[132:135]
  ds_read_b64_tr_b16 v[192:193], v20 offset:8192
  ds_read_b64_tr_b16 v[194:195], v20 offset:8704
  v_mfma_f32_16x16x32_bf16 v[140:143], v[164:167], v[68:71], v[140:143]
  ds_read_b64_tr_b16 v[196:197], v21 offset:8192
  v_mfma_f32_16x16x32_bf16 v[136:139], v[164:167], v[64:67], v[136:139]
  ds_read_b64_tr_b16 v[198:199], v21 offset:8704
  v_mfma_f32_16x16x32_bf16 v[144:147], v[168:171], v[64:67], v[144:147]
  ds_read_b64_tr_b16 v[200:201], v22 offset:8192
  v_mfma_f32_16x16x32_bf16 v[148:151], v[168:171], v[68:71], v[148:151]
  ds_read_b64_tr_b16 v[202:203], v22 offset:8704
  v_readlane_b32 s51, v15, 19
  v_mfma_f32_16x16x32_bf16 v[156:159], v[172:175], v[68:71], v[156:159]
  ds_read_b64_tr_b16 v[204:205], v23 offset:8192
  v_mfma_f32_16x16x32_bf16 v[152:155], v[172:175], v[64:67], v[152:155]
  ds_read_b64_tr_b16 v[206:207], v23 offset:8704
  s_waitcnt vmcnt(16) lgkmcnt(8)
  v_mfma_f32_16x16x32_bf16 v[128:131], v[176:179], v[72:75], v[128:131]
  buffer_load_dwordx4 v[48:51], off, s[36:39], s51 offset:0
  v_mfma_f32_16x16x32_bf16 v[132:135], v[176:179], v[76:79], v[132:135]
  ds_read_b64_tr_b16 v[208:209], v20 offset:12288
  ds_read_b64_tr_b16 v[210:211], v20 offset:12800
  v_mfma_f32_16x16x32_bf16 v[140:143], v[180:183], v[76:79], v[140:143]
  ds_read_b64_tr_b16 v[212:213], v21 offset:12288
  v_mfma_f32_16x16x32_bf16 v[136:139], v[180:183], v[72:75], v[136:139]
  ds_read_b64_tr_b16 v[214:215], v21 offset:12800
  v_mfma_f32_16x16x32_bf16 v[144:147], v[184:187], v[72:75], v[144:147]
  ds_read_b64_tr_b16 v[216:217], v22 offset:12288
  v_mfma_f32_16x16x32_bf16 v[148:151], v[184:187], v[76:79], v[148:151]
  ds_read_b64_tr_b16 v[218:219], v22 offset:12800
  v_mfma_f32_16x16x32_bf16 v[156:159], v[188:191], v[76:79], v[156:159]
  ds_read_b64_tr_b16 v[220:221], v23 offset:12288
  v_mfma_f32_16x16x32_bf16 v[152:155], v[188:191], v[72:75], v[152:155]
  ds_read_b64_tr_b16 v[222:223], v23 offset:12800
  s_waitcnt lgkmcnt(8)
  v_mfma_f32_16x16x32_bf16 v[96:99], v[192:195], v[64:67], v[96:99]
  buffer_load_dwordx4 v[52:55], off, s[64:67], s51 offset:0
  v_mfma_f32_16x16x32_bf16 v[100:103], v[192:195], v[68:71], v[100:103]
  ds_read_b64_tr_b16 v[160:161], v20 offset:16384
  ds_read_b64_tr_b16 v[162:163], v20 offset:16896
  v_mfma_f32_16x16x32_bf16 v[108:111], v[196:199], v[68:71], v[108:111]
  ds_read_b64_tr_b16 v[164:165], v21 offset:16384
  v_mfma_f32_16x16x32_bf16 v[104:107], v[196:199], v[64:67], v[104:107]
  ds_read_b64_tr_b16 v[166:167], v21 offset:16896
  v_mfma_f32_16x16x32_bf16 v[112:115], v[200:203], v[64:67], v[112:115]
  ds_read_b64_tr_b16 v[168:169], v22 offset:16384
  v_mfma_f32_16x16x32_bf16 v[116:119], v[200:203], v[68:71], v[116:119]
  ds_read_b64_tr_b16 v[170:171], v22 offset:16896
  v_mfma_f32_16x16x32_bf16 v[124:127], v[204:207], v[68:71], v[124:127]
  ds_read_b64_tr_b16 v[172:173], v23 offset:16384
  v_mfma_f32_16x16x32_bf16 v[120:123], v[204:207], v[64:67], v[120:123]
  ds_read_b64_tr_b16 v[174:175], v23 offset:16896
  s_waitcnt lgkmcnt(8)
  v_mfma_f32_16x16x32_bf16 v[96:99], v[208:211], v[72:75], v[96:99]
  buffer_load_dwordx4 v[56:59], off, s[36:39], s51 offset:1024
  v_mfma_f32_16x16x32_bf16 v[100:103], v[208:211], v[76:79], v[100:103]
  ds_read_b64_tr_b16 v[176:177], v20 offset:20480
  ds_read_b64_tr_b16 v[178:179], v20 offset:20992
  v_mfma_f32_16x16x32_bf16 v[108:111], v[212:215], v[76:79], v[108:111]
  ds_read_b64_tr_b16 v[180:181], v21 offset:20480
  v_mfma_f32_16x16x32_bf16 v[104:107], v[212:215], v[72:75], v[104:107]
  ds_read_b64_tr_b16 v[182:183], v21 offset:20992
  v_mfma_f32_16x16x32_bf16 v[112:115], v[216:219], v[72:75], v[112:115]
  ds_read_b64_tr_b16 v[184:185], v22 offset:20480
  v_mfma_f32_16x16x32_bf16 v[116:119], v[216:219], v[76:79], v[116:119]
  ds_read_b64_tr_b16 v[186:187], v22 offset:20992
  v_mfma_f32_16x16x32_bf16 v[124:127], v[220:223], v[76:79], v[124:127]
  ds_read_b64_tr_b16 v[188:189], v23 offset:20480
  v_mfma_f32_16x16x32_bf16 v[120:123], v[220:223], v[72:75], v[120:123]
  ds_read_b64_tr_b16 v[190:191], v23 offset:20992
  s_waitcnt vmcnt(17) lgkmcnt(8)
  v_mfma_f32_16x16x32_bf16 v[128:131], v[160:163], v[80:83], v[128:131]
  buffer_load_dwordx4 v[60:63], off, s[64:67], s51 offset:1024
  v_mfma_f32_16x16x32_bf16 v[132:135], v[160:163], v[84:87], v[132:135]
  ds_read_b64_tr_b16 v[192:193], v20 offset:24576
  ds_read_b64_tr_b16 v[194:195], v20 offset:25088
  v_mfma_f32_16x16x32_bf16 v[140:143], v[164:167], v[84:87], v[140:143]
  ds_read_b64_tr_b16 v[196:197], v21 offset:24576
  v_mfma_f32_16x16x32_bf16 v[136:139], v[164:167], v[80:83], v[136:139]
  ds_read_b64_tr_b16 v[198:199], v21 offset:25088
  v_mfma_f32_16x16x32_bf16 v[144:147], v[168:171], v[80:83], v[144:147]
  ds_read_b64_tr_b16 v[200:201], v22 offset:24576
  v_mfma_f32_16x16x32_bf16 v[148:151], v[168:171], v[84:87], v[148:151]
  ds_read_b64_tr_b16 v[202:203], v22 offset:25088
  v_readlane_b32 s48, v15, 20
  v_mfma_f32_16x16x32_bf16 v[156:159], v[172:175], v[84:87], v[156:159]
  ds_read_b64_tr_b16 v[204:205], v23 offset:24576
  v_mfma_f32_16x16x32_bf16 v[152:155], v[172:175], v[80:83], v[152:155]
  ds_read_b64_tr_b16 v[206:207], v23 offset:25088
  s_waitcnt vmcnt(16) lgkmcnt(8)
  v_mfma_f32_16x16x32_bf16 v[128:131], v[176:179], v[88:91], v[128:131]
  buffer_load_dwordx4 v[64:67], off, s[36:39], s48 offset:0
  v_mfma_f32_16x16x32_bf16 v[132:135], v[176:179], v[92:95], v[132:135]
  ds_read_b64_tr_b16 v[208:209], v20 offset:28672
  ds_read_b64_tr_b16 v[210:211], v20 offset:29184
  v_mfma_f32_16x16x32_bf16 v[140:143], v[180:183], v[92:95], v[140:143]
  ds_read_b64_tr_b16 v[212:213], v21 offset:28672
  v_mfma_f32_16x16x32_bf16 v[136:139], v[180:183], v[88:91], v[136:139]
  ds_read_b64_tr_b16 v[214:215], v21 offset:29184
  v_mfma_f32_16x16x32_bf16 v[144:147], v[184:187], v[88:91], v[144:147]
  ds_read_b64_tr_b16 v[216:217], v22 offset:28672
  v_mfma_f32_16x16x32_bf16 v[148:151], v[184:187], v[92:95], v[148:151]
  ds_read_b64_tr_b16 v[218:219], v22 offset:29184
  v_mfma_f32_16x16x32_bf16 v[156:159], v[188:191], v[92:95], v[156:159]
  ds_read_b64_tr_b16 v[220:221], v23 offset:28672
  v_mfma_f32_16x16x32_bf16 v[152:155], v[188:191], v[88:91], v[152:155]
  ds_read_b64_tr_b16 v[222:223], v23 offset:29184
  s_waitcnt lgkmcnt(8)
  v_mfma_f32_16x16x32_bf16 v[96:99], v[192:195], v[80:83], v[96:99]
  buffer_load_dwordx4 v[68:71], off, s[64:67], s48 offset:0
  v_mfma_f32_16x16x32_bf16 v[100:103], v[192:195], v[84:87], v[100:103]
  ds_read_b64_tr_b16 v[160:161], v20 offset:32768
  ds_read_b64_tr_b16 v[162:163], v20 offset:33280
  v_mfma_f32_16x16x32_bf16 v[108:111], v[196:199], v[84:87], v[108:111]
  ds_read_b64_tr_b16 v[164:165], v21 offset:32768
  v_mfma_f32_16x16x32_bf16 v[104:107], v[196:199], v[80:83], v[104:107]
  ds_read_b64_tr_b16 v[166:167], v21 offset:33280
  v_mfma_f32_16x16x32_bf16 v[112:115], v[200:203], v[80:83], v[112:115]
  ds_read_b64_tr_b16 v[168:169], v22 offset:32768
  v_mfma_f32_16x16x32_bf16 v[116:119], v[200:203], v[84:87], v[116:119]
  ds_read_b64_tr_b16 v[170:171], v22 offset:33280
  v_mfma_f32_16x16x32_bf16 v[124:127], v[204:207], v[84:87], v[124:127]
  ds_read_b64_tr_b16 v[172:173], v23 offset:32768
  v_mfma_f32_16x16x32_bf16 v[120:123], v[204:207], v[80:83], v[120:123]
  ds_read_b64_tr_b16 v[174:175], v23 offset:33280
  s_waitcnt lgkmcnt(8)
  s_barrier
  v_mfma_f32_16x16x32_bf16 v[96:99], v[208:211], v[88:91], v[96:99]
  buffer_load_dwordx4 v[72:75], off, s[36:39], s48 offset:1024
  v_mfma_f32_16x16x32_bf16 v[100:103], v[208:211], v[92:95], v[100:103]
  ds_read_b64_tr_b16 v[176:177], v20 offset:36864
  ds_read_b64_tr_b16 v[178:179], v20 offset:37376
  v_mfma_f32_16x16x32_bf16 v[108:111], v[212:215], v[92:95], v[108:111]
  ds_read_b64_tr_b16 v[180:181], v21 offset:36864
  v_mfma_f32_16x16x32_bf16 v[104:107], v[212:215], v[88:91], v[104:107]
  ds_read_b64_tr_b16 v[182:183], v21 offset:37376
  v_mfma_f32_16x16x32_bf16 v[112:115], v[216:219], v[88:91], v[112:115]
  ds_read_b64_tr_b16 v[184:185], v22 offset:36864
  v_mfma_f32_16x16x32_bf16 v[116:119], v[216:219], v[92:95], v[116:119]
  ds_read_b64_tr_b16 v[186:187], v22 offset:37376
  v_mfma_f32_16x16x32_bf16 v[124:127], v[220:223], v[92:95], v[124:127]
  ds_read_b64_tr_b16 v[188:189], v23 offset:36864
  v_mfma_f32_16x16x32_bf16 v[120:123], v[220:223], v[88:91], v[120:123]
  ds_read_b64_tr_b16 v[190:191], v23 offset:37376
  s_waitcnt vmcnt(17) lgkmcnt(8)
  v_mfma_f32_16x16x32_bf16 v[128:131], v[160:163], v[224:227], v[128:131]
  buffer_load_dwordx4 v[76:79], off, s[64:67], s48 offset:1024
  v_mfma_f32_16x16x32_bf16 v[132:135], v[160:163], v[228:231], v[132:135]
  ds_read_b64_tr_b16 v[192:193], v20 offset:40960
  ds_read_b64_tr_b16 v[194:195], v20 offset:41472
  v_mfma_f32_16x16x32_bf16 v[140:143], v[164:167], v[228:231], v[140:143]
  ds_read_b64_tr_b16 v[196:197], v21 offset:40960
  v_mfma_f32_16x16x32_bf16 v[136:139], v[164:167], v[224:227], v[136:139]
  ds_read_b64_tr_b16 v[198:199], v21 offset:41472
  v_mfma_f32_16x16x32_bf16 v[144:147], v[168:171], v[224:227], v[144:147]
  ds_read_b64_tr_b16 v[200:201], v22 offset:40960
  v_mfma_f32_16x16x32_bf16 v[148:151], v[168:171], v[228:231], v[148:151]
  ds_read_b64_tr_b16 v[202:203], v22 offset:41472
  v_readlane_b32 s49, v15, 21
  v_mfma_f32_16x16x32_bf16 v[156:159], v[172:175], v[228:231], v[156:159]
  ds_read_b64_tr_b16 v[204:205], v23 offset:40960
  v_mfma_f32_16x16x32_bf16 v[152:155], v[172:175], v[224:227], v[152:155]
  ds_read_b64_tr_b16 v[206:207], v23 offset:41472
  s_waitcnt vmcnt(16) lgkmcnt(8)
  v_mfma_f32_16x16x32_bf16 v[128:131], v[176:179], v[232:235], v[128:131]
  buffer_load_dwordx4 v[80:83], off, s[36:39], s49 offset:0
  v_mfma_f32_16x16x32_bf16 v[132:135], v[176:179], v[236:239], v[132:135]
  ds_read_b64_tr_b16 v[208:209], v20 offset:45056
  ds_read_b64_tr_b16 v[210:211], v20 offset:45568
  v_mfma_f32_16x16x32_bf16 v[140:143], v[180:183], v[236:239], v[140:143]
  ds_read_b64_tr_b16 v[212:213], v21 offset:45056
  v_mfma_f32_16x16x32_bf16 v[136:139], v[180:183], v[232:235], v[136:139]
  ds_read_b64_tr_b16 v[214:215], v21 offset:45568
  v_mfma_f32_16x16x32_bf16 v[144:147], v[184:187], v[232:235], v[144:147]
  ds_read_b64_tr_b16 v[216:217], v22 offset:45056
  v_mfma_f32_16x16x32_bf16 v[148:151], v[184:187], v[236:239], v[148:151]
  ds_read_b64_tr_b16 v[218:219], v22 offset:45568
  v_mfma_f32_16x16x32_bf16 v[156:159], v[188:191], v[236:239], v[156:159]
  ds_read_b64_tr_b16 v[220:221], v23 offset:45056
  v_mfma_f32_16x16x32_bf16 v[152:155], v[188:191], v[232:235], v[152:155]
  ds_read_b64_tr_b16 v[222:223], v23 offset:45568
  s_waitcnt lgkmcnt(8)
  v_mfma_f32_16x16x32_bf16 v[96:99], v[192:195], v[224:227], v[96:99]
  buffer_load_dwordx4 v[84:87], off, s[64:67], s49 offset:0
  v_mfma_f32_16x16x32_bf16 v[100:103], v[192:195], v[228:231], v[100:103]
  ds_read_b64_tr_b16 v[160:161], v20 offset:49152
  ds_read_b64_tr_b16 v[162:163], v20 offset:49664
  v_mfma_f32_16x16x32_bf16 v[108:111], v[196:199], v[228:231], v[108:111]
  ds_read_b64_tr_b16 v[164:165], v21 offset:49152
  v_mfma_f32_16x16x32_bf16 v[104:107], v[196:199], v[224:227], v[104:107]
  ds_read_b64_tr_b16 v[166:167], v21 offset:49664
  v_mfma_f32_16x16x32_bf16 v[112:115], v[200:203], v[224:227], v[112:115]
  ds_read_b64_tr_b16 v[168:169], v22 offset:49152
  v_mfma_f32_16x16x32_bf16 v[116:119], v[200:203], v[228:231], v[116:119]
  ds_read_b64_tr_b16 v[170:171], v22 offset:49664
  v_mfma_f32_16x16x32_bf16 v[124:127], v[204:207], v[228:231], v[124:127]
  ds_read_b64_tr_b16 v[172:173], v23 offset:49152
  v_mfma_f32_16x16x32_bf16 v[120:123], v[204:207], v[224:227], v[120:123]
  ds_read_b64_tr_b16 v[174:175], v23 offset:49664
  s_waitcnt lgkmcnt(8)
  v_mfma_f32_16x16x32_bf16 v[96:99], v[208:211], v[232:235], v[96:99]
  buffer_load_dwordx4 v[88:91], off, s[36:39], s49 offset:1024
  v_mfma_f32_16x16x32_bf16 v[100:103], v[208:211], v[236:239], v[100:103]
  ds_read_b64_tr_b16 v[176:177], v20 offset:53248
  ds_read_b64_tr_b16 v[178:179], v20 offset:53760
  v_mfma_f32_16x16x32_bf16 v[108:111], v[212:215], v[236:239], v[108:111]
  ds_read_b64_tr_b16 v[180:181], v21 offset:53248
  v_mfma_f32_16x16x32_bf16 v[104:107], v[212:215], v[232:235], v[104:107]
  ds_read_b64_tr_b16 v[182:183], v21 offset:53760
  v_mfma_f32_16x16x32_bf16 v[112:115], v[216:219], v[232:235], v[112:115]
  ds_read_b64_tr_b16 v[184:185], v22 offset:53248
  v_mfma_f32_16x16x32_bf16 v[116:119], v[216:219], v[236:239], v[116:119]
  ds_read_b64_tr_b16 v[186:187], v22 offset:53760
  v_mfma_f32_16x16x32_bf16 v[124:127], v[220:223], v[236:239], v[124:127]
  ds_read_b64_tr_b16 v[188:189], v23 offset:53248
  v_mfma_f32_16x16x32_bf16 v[120:123], v[220:223], v[232:235], v[120:123]
  ds_read_b64_tr_b16 v[190:191], v23 offset:53760
  s_waitcnt vmcnt(17) lgkmcnt(8)
  v_mfma_f32_16x16x32_bf16 v[128:131], v[160:163], v[240:243], v[128:131]
  buffer_load_dwordx4 v[92:95], off, s[64:67], s49 offset:1024
  v_mfma_f32_16x16x32_bf16 v[132:135], v[160:163], v[244:247], v[132:135]
  ds_read_b64_tr_b16 v[192:193], v20 offset:57344
  ds_read_b64_tr_b16 v[194:195], v20 offset:57856
  v_mfma_f32_16x16x32_bf16 v[140:143], v[164:167], v[244:247], v[140:143]
  ds_read_b64_tr_b16 v[196:197], v21 offset:57344
  v_mfma_f32_16x16x32_bf16 v[136:139], v[164:167], v[240:243], v[136:139]
  ds_read_b64_tr_b16 v[198:199], v21 offset:57856
  v_mfma_f32_16x16x32_bf16 v[144:147], v[168:171], v[240:243], v[144:147]
  ds_read_b64_tr_b16 v[200:201], v22 offset:57344
  v_mfma_f32_16x16x32_bf16 v[148:151], v[168:171], v[244:247], v[148:151]
  ds_read_b64_tr_b16 v[202:203], v22 offset:57856
  v_readlane_b32 s50, v15, 22
  v_mfma_f32_16x16x32_bf16 v[156:159], v[172:175], v[244:247], v[156:159]
  ds_read_b64_tr_b16 v[204:205], v23 offset:57344
  v_mfma_f32_16x16x32_bf16 v[152:155], v[172:175], v[240:243], v[152:155]
  ds_read_b64_tr_b16 v[206:207], v23 offset:57856
  s_waitcnt vmcnt(16) lgkmcnt(8)
  v_mfma_f32_16x16x32_bf16 v[128:131], v[176:179], v[248:251], v[128:131]
  buffer_load_dwordx4 v[224:227], off, s[36:39], s50 offset:0
  v_mfma_f32_16x16x32_bf16 v[132:135], v[176:179], v[252:255], v[132:135]
  ds_read_b64_tr_b16 v[208:209], v20 offset:61440
  ds_read_b64_tr_b16 v[210:211], v20 offset:61952
  v_mfma_f32_16x16x32_bf16 v[140:143], v[180:183], v[252:255], v[140:143]
  ds_read_b64_tr_b16 v[212:213], v21 offset:61440
  v_mfma_f32_16x16x32_bf16 v[136:139], v[180:183], v[248:251], v[136:139]
  ds_read_b64_tr_b16 v[214:215], v21 offset:61952
  v_mfma_f32_16x16x32_bf16 v[144:147], v[184:187], v[248:251], v[144:147]
  ds_read_b64_tr_b16 v[216:217], v22 offset:61440
  v_mfma_f32_16x16x32_bf16 v[148:151], v[184:187], v[252:255], v[148:151]
  ds_read_b64_tr_b16 v[218:219], v22 offset:61952
  v_mfma_f32_16x16x32_bf16 v[156:159], v[188:191], v[252:255], v[156:159]
  ds_read_b64_tr_b16 v[220:221], v23 offset:61440
  v_mfma_f32_16x16x32_bf16 v[152:155], v[188:191], v[248:251], v[152:155]
  ds_read_b64_tr_b16 v[222:223], v23 offset:61952
  s_waitcnt lgkmcnt(8)
  v_mfma_f32_16x16x32_bf16 v[96:99], v[192:195], v[240:243], v[96:99]
  buffer_load_dwordx4 v[228:231], off, s[64:67], s50 offset:0
  v_mfma_f32_16x16x32_bf16 v[100:103], v[192:195], v[244:247], v[100:103]
  ds_read_b64_tr_b16 v[160:161], v26 offset:0
  ds_read_b64_tr_b16 v[162:163], v26 offset:512
  v_mfma_f32_16x16x32_bf16 v[108:111], v[196:199], v[244:247], v[108:111]
  ds_read_b64_tr_b16 v[164:165], v27 offset:0
  v_mfma_f32_16x16x32_bf16 v[104:107], v[196:199], v[240:243], v[104:107]
  ds_read_b64_tr_b16 v[166:167], v27 offset:512
  v_mfma_f32_16x16x32_bf16 v[112:115], v[200:203], v[240:243], v[112:115]
  ds_read_b64_tr_b16 v[168:169], v28 offset:0
  v_mfma_f32_16x16x32_bf16 v[116:119], v[200:203], v[244:247], v[116:119]
  ds_read_b64_tr_b16 v[170:171], v28 offset:512
  v_mfma_f32_16x16x32_bf16 v[124:127], v[204:207], v[244:247], v[124:127]
  ds_read_b64_tr_b16 v[172:173], v29 offset:0
  v_mfma_f32_16x16x32_bf16 v[120:123], v[204:207], v[240:243], v[120:123]
  ds_read_b64_tr_b16 v[174:175], v29 offset:512
  s_waitcnt lgkmcnt(8)
  s_barrier
  v_mfma_f32_16x16x32_bf16 v[96:99], v[208:211], v[248:251], v[96:99]
  buffer_load_dwordx4 v[232:235], off, s[36:39], s50 offset:1024
  v_mfma_f32_16x16x32_bf16 v[100:103], v[208:211], v[252:255], v[100:103]
  ds_read_b64_tr_b16 v[176:177], v26 offset:4096
  ds_read_b64_tr_b16 v[178:179], v26 offset:4608
  v_mfma_f32_16x16x32_bf16 v[108:111], v[212:215], v[252:255], v[108:111]
  ds_read_b64_tr_b16 v[180:181], v27 offset:4096
  v_mfma_f32_16x16x32_bf16 v[104:107], v[212:215], v[248:251], v[104:107]
  ds_read_b64_tr_b16 v[182:183], v27 offset:4608
  v_mfma_f32_16x16x32_bf16 v[112:115], v[216:219], v[248:251], v[112:115]
  ds_read_b64_tr_b16 v[184:185], v28 offset:4096
  v_mfma_f32_16x16x32_bf16 v[116:119], v[216:219], v[252:255], v[116:119]
  ds_read_b64_tr_b16 v[186:187], v28 offset:4608
  v_mfma_f32_16x16x32_bf16 v[124:127], v[220:223], v[252:255], v[124:127]
  ds_read_b64_tr_b16 v[188:189], v29 offset:4096
  v_mfma_f32_16x16x32_bf16 v[120:123], v[220:223], v[248:251], v[120:123]
  ds_read_b64_tr_b16 v[190:191], v29 offset:4608
  s_waitcnt vmcnt(17) lgkmcnt(8)
  v_mfma_f32_16x16x32_bf16 v[128:131], v[160:163], v[32:35], v[128:131]
  buffer_load_dwordx4 v[236:239], off, s[64:67], s50 offset:1024
  v_mfma_f32_16x16x32_bf16 v[132:135], v[160:163], v[36:39], v[132:135]
  ds_read_b64_tr_b16 v[192:193], v26 offset:8192
  ds_read_b64_tr_b16 v[194:195], v26 offset:8704
  v_mfma_f32_16x16x32_bf16 v[140:143], v[164:167], v[36:39], v[140:143]
  ds_read_b64_tr_b16 v[196:197], v27 offset:8192
  v_mfma_f32_16x16x32_bf16 v[136:139], v[164:167], v[32:35], v[136:139]
  ds_read_b64_tr_b16 v[198:199], v27 offset:8704
  v_mfma_f32_16x16x32_bf16 v[144:147], v[168:171], v[32:35], v[144:147]
  ds_read_b64_tr_b16 v[200:201], v28 offset:8192
  v_mfma_f32_16x16x32_bf16 v[148:151], v[168:171], v[36:39], v[148:151]
  ds_read_b64_tr_b16 v[202:203], v28 offset:8704
  v_readlane_b32 s51, v15, 23
  v_mfma_f32_16x16x32_bf16 v[156:159], v[172:175], v[36:39], v[156:159]
  ds_read_b64_tr_b16 v[204:205], v29 offset:8192
  v_mfma_f32_16x16x32_bf16 v[152:155], v[172:175], v[32:35], v[152:155]
  ds_read_b64_tr_b16 v[206:207], v29 offset:8704
  s_waitcnt vmcnt(16) lgkmcnt(8)
  v_mfma_f32_16x16x32_bf16 v[128:131], v[176:179], v[40:43], v[128:131]
  buffer_load_dwordx4 v[240:243], off, s[36:39], s51 offset:0
  v_mfma_f32_16x16x32_bf16 v[132:135], v[176:179], v[44:47], v[132:135]
  ds_read_b64_tr_b16 v[208:209], v26 offset:12288
  ds_read_b64_tr_b16 v[210:211], v26 offset:12800
  v_mfma_f32_16x16x32_bf16 v[140:143], v[180:183], v[44:47], v[140:143]
  ds_read_b64_tr_b16 v[212:213], v27 offset:12288
  v_mfma_f32_16x16x32_bf16 v[136:139], v[180:183], v[40:43], v[136:139]
  ds_read_b64_tr_b16 v[214:215], v27 offset:12800
  v_mfma_f32_16x16x32_bf16 v[144:147], v[184:187], v[40:43], v[144:147]
  ds_read_b64_tr_b16 v[216:217], v28 offset:12288
  v_mfma_f32_16x16x32_bf16 v[148:151], v[184:187], v[44:47], v[148:151]
  ds_read_b64_tr_b16 v[218:219], v28 offset:12800
  v_mfma_f32_16x16x32_bf16 v[156:159], v[188:191], v[44:47], v[156:159]
  ds_read_b64_tr_b16 v[220:221], v29 offset:12288
  v_mfma_f32_16x16x32_bf16 v[152:155], v[188:191], v[40:43], v[152:155]
  ds_read_b64_tr_b16 v[222:223], v29 offset:12800
  s_waitcnt lgkmcnt(8)
  v_mfma_f32_16x16x32_bf16 v[96:99], v[192:195], v[32:35], v[96:99]
  buffer_load_dwordx4 v[244:247], off, s[64:67], s51 offset:0
  v_mfma_f32_16x16x32_bf16 v[100:103], v[192:195], v[36:39], v[100:103]
  ds_read_b64_tr_b16 v[160:161], v26 offset:16384
  ds_read_b64_tr_b16 v[162:163], v26 offset:16896
  v_mfma_f32_16x16x32_bf16 v[108:111], v[196:199], v[36:39], v[108:111]
  ds_read_b64_tr_b16 v[164:165], v27 offset:16384
  v_mfma_f32_16x16x32_bf16 v[104:107], v[196:199], v[32:35], v[104:107]
  ds_read_b64_tr_b16 v[166:167], v27 offset:16896
  v_mfma_f32_16x16x32_bf16 v[112:115], v[200:203], v[32:35], v[112:115]
  ds_read_b64_tr_b16 v[168:169], v28 offset:16384
  v_mfma_f32_16x16x32_bf16 v[116:119], v[200:203], v[36:39], v[116:119]
  ds_read_b64_tr_b16 v[170:171], v28 offset:16896
  v_mfma_f32_16x16x32_bf16 v[124:127], v[204:207], v[36:39], v[124:127]
  ds_read_b64_tr_b16 v[172:173], v29 offset:16384
  v_mfma_f32_16x16x32_bf16 v[120:123], v[204:207], v[32:35], v[120:123]
  ds_read_b64_tr_b16 v[174:175], v29 offset:16896
  s_waitcnt lgkmcnt(8)
  v_mfma_f32_16x16x32_bf16 v[96:99], v[208:211], v[40:43], v[96:99]
  buffer_load_dwordx4 v[248:251], off, s[36:39], s51 offset:1024
  v_mfma_f32_16x16x32_bf16 v[100:103], v[208:211], v[44:47], v[100:103]
  ds_read_b64_tr_b16 v[176:177], v26 offset:20480
  ds_read_b64_tr_b16 v[178:179], v26 offset:20992
  v_mfma_f32_16x16x32_bf16 v[108:111], v[212:215], v[44:47], v[108:111]
  ds_read_b64_tr_b16 v[180:181], v27 offset:20480
  v_mfma_f32_16x16x32_bf16 v[104:107], v[212:215], v[40:43], v[104:107]
  ds_read_b64_tr_b16 v[182:183], v27 offset:20992
  v_mfma_f32_16x16x32_bf16 v[112:115], v[216:219], v[40:43], v[112:115]
  ds_read_b64_tr_b16 v[184:185], v28 offset:20480
  v_mfma_f32_16x16x32_bf16 v[116:119], v[216:219], v[44:47], v[116:119]
  ds_read_b64_tr_b16 v[186:187], v28 offset:20992
  v_mfma_f32_16x16x32_bf16 v[124:127], v[220:223], v[44:47], v[124:127]
  ds_read_b64_tr_b16 v[188:189], v29 offset:20480
  v_mfma_f32_16x16x32_bf16 v[120:123], v[220:223], v[40:43], v[120:123]
  ds_read_b64_tr_b16 v[190:191], v29 offset:20992
  s_waitcnt vmcnt(17) lgkmcnt(8)
  v_mfma_f32_16x16x32_bf16 v[128:131], v[160:163], v[48:51], v[128:131]
  buffer_load_dwordx4 v[252:255], off, s[64:67], s51 offset:1024
  v_mfma_f32_16x16x32_bf16 v[132:135], v[160:163], v[52:55], v[132:135]
  ds_read_b64_tr_b16 v[192:193], v26 offset:24576
  ds_read_b64_tr_b16 v[194:195], v26 offset:25088
  v_mfma_f32_16x16x32_bf16 v[140:143], v[164:167], v[52:55], v[140:143]
  ds_read_b64_tr_b16 v[196:197], v27 offset:24576
  v_mfma_f32_16x16x32_bf16 v[136:139], v[164:167], v[48:51], v[136:139]
  ds_read_b64_tr_b16 v[198:199], v27 offset:25088
  v_mfma_f32_16x16x32_bf16 v[144:147], v[168:171], v[48:51], v[144:147]
  ds_read_b64_tr_b16 v[200:201], v28 offset:24576
  v_mfma_f32_16x16x32_bf16 v[148:151], v[168:171], v[52:55], v[148:151]
  ds_read_b64_tr_b16 v[202:203], v28 offset:25088
  v_readlane_b32 s48, v15, 24
  v_mfma_f32_16x16x32_bf16 v[156:159], v[172:175], v[52:55], v[156:159]
  ds_read_b64_tr_b16 v[204:205], v29 offset:24576
  v_mfma_f32_16x16x32_bf16 v[152:155], v[172:175], v[48:51], v[152:155]
  ds_read_b64_tr_b16 v[206:207], v29 offset:25088
  s_waitcnt vmcnt(16) lgkmcnt(8)
  v_mfma_f32_16x16x32_bf16 v[128:131], v[176:179], v[56:59], v[128:131]
  buffer_load_dwordx4 v[32:35], off, s[36:39], s48 offset:0
  v_mfma_f32_16x16x32_bf16 v[132:135], v[176:179], v[60:63], v[132:135]
  ds_read_b64_tr_b16 v[208:209], v26 offset:28672
  ds_read_b64_tr_b16 v[210:211], v26 offset:29184
  v_mfma_f32_16x16x32_bf16 v[140:143], v[180:183], v[60:63], v[140:143]
  ds_read_b64_tr_b16 v[212:213], v27 offset:28672
  v_mfma_f32_16x16x32_bf16 v[136:139], v[180:183], v[56:59], v[136:139]
  ds_read_b64_tr_b16 v[214:215], v27 offset:29184
  v_mfma_f32_16x16x32_bf16 v[144:147], v[184:187], v[56:59], v[144:147]
  ds_read_b64_tr_b16 v[216:217], v28 offset:28672
  v_mfma_f32_16x16x32_bf16 v[148:151], v[184:187], v[60:63], v[148:151]
  ds_read_b64_tr_b16 v[218:219], v28 offset:29184
  v_mfma_f32_16x16x32_bf16 v[156:159], v[188:191], v[60:63], v[156:159]
  ds_read_b64_tr_b16 v[220:221], v29 offset:28672
  v_mfma_f32_16x16x32_bf16 v[152:155], v[188:191], v[56:59], v[152:155]
  ds_read_b64_tr_b16 v[222:223], v29 offset:29184
  s_waitcnt lgkmcnt(8)
  v_mfma_f32_16x16x32_bf16 v[96:99], v[192:195], v[48:51], v[96:99]
  buffer_load_dwordx4 v[36:39], off, s[64:67], s48 offset:0
  v_mfma_f32_16x16x32_bf16 v[100:103], v[192:195], v[52:55], v[100:103]
  ds_read_b64_tr_b16 v[160:161], v6 offset:0
  ds_read_b64_tr_b16 v[162:163], v6 offset:512
  v_mfma_f32_16x16x32_bf16 v[108:111], v[196:199], v[52:55], v[108:111]
  ds_read_b64_tr_b16 v[164:165], v7 offset:0
  v_cvt_pk_bf16_f32 v128, v128, v129
  v_mfma_f32_16x16x32_bf16 v[104:107], v[196:199], v[48:51], v[104:107]
  ds_read_b64_tr_b16 v[166:167], v7 offset:512
  v_cvt_pk_bf16_f32 v129, v130, v131
  v_mfma_f32_16x16x32_bf16 v[112:115], v[200:203], v[48:51], v[112:115]
  ds_read_b64_tr_b16 v[168:169], v8 offset:0
  v_cvt_pk_bf16_f32 v130, v132, v133
  v_mfma_f32_16x16x32_bf16 v[116:119], v[200:203], v[52:55], v[116:119]
  ds_read_b64_tr_b16 v[170:171], v8 offset:512
  v_cvt_pk_bf16_f32 v131, v134, v135
  v_mfma_f32_16x16x32_bf16 v[124:127], v[204:207], v[52:55], v[124:127]
  ds_read_b64_tr_b16 v[172:173], v9 offset:0
  buffer_store_dwordx4 v[128:131], off, s[60:63], s4 offset:0 sc1
  v_mfma_f32_16x16x32_bf16 v[120:123], v[204:207], v[48:51], v[120:123]
  ds_read_b64_tr_b16 v[174:175], v9 offset:512
  s_waitcnt lgkmcnt(8)
  s_barrier
  v_mfma_f32_16x16x32_bf16 v[96:99], v[208:211], v[56:59], v[96:99]
  ds_read_b64_tr_b16 v[176:177], v6 offset:4096
  buffer_load_dwordx4 v[40:43], off, s[36:39], s48 offset:1024
  v_mfma_f32_16x16x32_bf16 v[100:103], v[208:211], v[60:63], v[100:103]
  ds_read_b64_tr_b16 v[178:179], v6 offset:4608
  v_cvt_pk_bf16_f32 v132, v136, v137
  v_mfma_f32_16x16x32_bf16 v[108:111], v[212:215], v[60:63], v[108:111]
  ds_read_b64_tr_b16 v[180:181], v7 offset:4096
  v_cvt_pk_bf16_f32 v133, v138, v139
  v_mfma_f32_16x16x32_bf16 v[104:107], v[212:215], v[56:59], v[104:107]
  ds_read_b64_tr_b16 v[182:183], v7 offset:4608
  v_cvt_pk_bf16_f32 v134, v140, v141
  v_mfma_f32_16x16x32_bf16 v[112:115], v[216:219], v[56:59], v[112:115]
  ds_read_b64_tr_b16 v[184:185], v8 offset:4096
  v_cvt_pk_bf16_f32 v135, v142, v143
  v_mfma_f32_16x16x32_bf16 v[116:119], v[216:219], v[60:63], v[116:119]
  ds_read_b64_tr_b16 v[186:187], v8 offset:4608
  buffer_store_dwordx4 v[132:135], off, s[60:63], s4 offset:1024 sc1
  v_mfma_f32_16x16x32_bf16 v[124:127], v[220:223], v[60:63], v[124:127]
  ds_read_b64_tr_b16 v[188:189], v9 offset:4096
  v_cvt_pk_bf16_f32 v136, v144, v145
  v_mfma_f32_16x16x32_bf16 v[120:123], v[220:223], v[56:59], v[120:123]
  ds_read_b64_tr_b16 v[190:191], v9 offset:4608
  s_waitcnt vmcnt(19) lgkmcnt(8)
  v_mfma_f32_16x16x32_bf16 v[96:99], v[160:163], v[64:67], v[96:99]
  ds_read_b64_tr_b16 v[192:193], v6 offset:8192
  buffer_load_dwordx4 v[44:47], off, s[64:67], s48 offset:1024
  v_mfma_f32_16x16x32_bf16 v[100:103], v[160:163], v[68:71], v[100:103]
  ds_read_b64_tr_b16 v[194:195], v6 offset:8704
  v_cvt_pk_bf16_f32 v137, v146, v147
  v_mfma_f32_16x16x32_bf16 v[108:111], v[164:167], v[68:71], v[108:111]
  ds_read_b64_tr_b16 v[196:197], v7 offset:8192
  v_cvt_pk_bf16_f32 v138, v148, v149
  v_mfma_f32_16x16x32_bf16 v[104:107], v[164:167], v[64:67], v[104:107]
  ds_read_b64_tr_b16 v[198:199], v7 offset:8704
  v_cvt_pk_bf16_f32 v139, v150, v151
  v_mfma_f32_16x16x32_bf16 v[112:115], v[168:171], v[64:67], v[112:115]
  ds_read_b64_tr_b16 v[200:201], v8 offset:8192
  buffer_store_dwordx4 v[136:139], off, s[60:63], s4 offset:2048 sc1
  v_mfma_f32_16x16x32_bf16 v[116:119], v[168:171], v[68:71], v[116:119]
  ds_read_b64_tr_b16 v[202:203], v8 offset:8704
  v_readlane_b32 s49, v15, 25
  v_mfma_f32_16x16x32_bf16 v[124:127], v[172:175], v[68:71], v[124:127]
  ds_read_b64_tr_b16 v[204:205], v9 offset:8192
  v_cvt_pk_bf16_f32 v140, v152, v153
  v_mfma_f32_16x16x32_bf16 v[120:123], v[172:175], v[64:67], v[120:123]
  ds_read_b64_tr_b16 v[206:207], v9 offset:8704
  s_waitcnt vmcnt(19) lgkmcnt(8)
  v_mfma_f32_16x16x32_bf16 v[96:99], v[176:179], v[72:75], v[96:99]
  ds_read_b64_tr_b16 v[208:209], v6 offset:12288
  buffer_load_dwordx4 v[48:51], off, s[36:39], s49 offset:0
  v_mfma_f32_16x16x32_bf16 v[100:103], v[176:179], v[76:79], v[100:103]
  ds_read_b64_tr_b16 v[210:211], v6 offset:12800
  v_cvt_pk_bf16_f32 v141, v154, v155
  v_mfma_f32_16x16x32_bf16 v[108:111], v[180:183], v[76:79], v[108:111]
  ds_read_b64_tr_b16 v[212:213], v7 offset:12288
  v_cvt_pk_bf16_f32 v142, v156, v157
  v_mfma_f32_16x16x32_bf16 v[104:107], v[180:183], v[72:75], v[104:107]
  ds_read_b64_tr_b16 v[214:215], v7 offset:12800
  v_cvt_pk_bf16_f32 v143, v158, v159
  v_mfma_f32_16x16x32_bf16 v[112:115], v[184:187], v[72:75], v[112:115]
  ds_read_b64_tr_b16 v[216:217], v8 offset:12288
  buffer_load_dwordx4 v[52:55], off, s[64:67], s49 offset:0
  v_mfma_f32_16x16x32_bf16 v[116:119], v[184:187], v[76:79], v[116:119]
  buffer_store_dwordx4 v[140:143], off, s[60:63], s4 offset:3072 sc1
  v_mfma_f32_16x16x32_bf16 v[124:127], v[188:191], v[76:79], v[124:127]
  ds_read_b64_tr_b16 v[218:219], v8 offset:12800
  ds_read_b64_tr_b16 v[220:221], v9 offset:12288
  v_mfma_f32_16x16x32_bf16 v[120:123], v[188:191], v[72:75], v[120:123]
  ds_read_b64_tr_b16 v[222:223], v9 offset:12800
  s_waitcnt vmcnt(20) lgkmcnt(8)
  v_mfma_f32_16x16x32_bf16 v[96:99], v[192:195], v[80:83], v[96:99]
  buffer_load_dwordx4 v[56:59], off, s[36:39], s49 offset:1024
  v_mfma_f32_16x16x32_bf16 v[100:103], v[192:195], v[84:87], v[100:103]
  ds_read_b64_tr_b16 v[160:161], v6 offset:16384
  ds_read_b64_tr_b16 v[162:163], v6 offset:16896
  v_mfma_f32_16x16x32_bf16 v[108:111], v[196:199], v[84:87], v[108:111]
  ds_read_b64_tr_b16 v[164:165], v7 offset:16384
  v_mfma_f32_16x16x32_bf16 v[104:107], v[196:199], v[80:83], v[104:107]
  ds_read_b64_tr_b16 v[166:167], v7 offset:16896
  v_mfma_f32_16x16x32_bf16 v[112:115], v[200:203], v[80:83], v[112:115]
  buffer_load_dwordx4 v[60:63], off, s[64:67], s49 offset:1024
  v_mfma_f32_16x16x32_bf16 v[116:119], v[200:203], v[84:87], v[116:119]
  ds_read_b64_tr_b16 v[168:169], v8 offset:16384
  ds_read_b64_tr_b16 v[170:171], v8 offset:16896
  v_mfma_f32_16x16x32_bf16 v[124:127], v[204:207], v[84:87], v[124:127]
  ds_read_b64_tr_b16 v[172:173], v9 offset:16384
  v_readlane_b32 s50, v15, 26
  v_mfma_f32_16x16x32_bf16 v[120:123], v[204:207], v[80:83], v[120:123]
  ds_read_b64_tr_b16 v[174:175], v9 offset:16896
  s_waitcnt vmcnt(20) lgkmcnt(8)
  v_mfma_f32_16x16x32_bf16 v[96:99], v[208:211], v[88:91], v[96:99]
  ds_read_b64_tr_b16 v[176:177], v6 offset:20480
  v_mfma_f32_16x16x32_bf16 v[100:103], v[208:211], v[92:95], v[100:103]
  buffer_load_dwordx4 v[64:67], off, s[36:39], s50 offset:0
  v_mfma_f32_16x16x32_bf16 v[108:111], v[212:215], v[92:95], v[108:111]
  ds_read_b64_tr_b16 v[178:179], v6 offset:20992
  ds_read_b64_tr_b16 v[180:181], v7 offset:20480
  v_mfma_f32_16x16x32_bf16 v[104:107], v[212:215], v[88:91], v[104:107]
  ds_read_b64_tr_b16 v[182:183], v7 offset:20992
  v_mfma_f32_16x16x32_bf16 v[112:115], v[216:219], v[88:91], v[112:115]
  ds_read_b64_tr_b16 v[184:185], v8 offset:20480
  v_mfma_f32_16x16x32_bf16 v[116:119], v[216:219], v[92:95], v[116:119]
  buffer_load_dwordx4 v[68:71], off, s[64:67], s50 offset:0
  v_mfma_f32_16x16x32_bf16 v[124:127], v[220:223], v[92:95], v[124:127]
  ds_read_b64_tr_b16 v[186:187], v8 offset:20992
  ds_read_b64_tr_b16 v[188:189], v9 offset:20480
  v_mfma_f32_16x16x32_bf16 v[120:123], v[220:223], v[88:91], v[120:123]
  ds_read_b64_tr_b16 v[190:191], v9 offset:20992
  s_waitcnt vmcnt(20) lgkmcnt(8)
  v_mfma_f32_16x16x32_bf16 v[96:99], v[160:163], v[224:227], v[96:99]
  ds_read_b64_tr_b16 v[192:193], v6 offset:24576
  v_mfma_f32_16x16x32_bf16 v[100:103], v[160:163], v[228:231], v[100:103]
  buffer_load_dwordx4 v[72:75], off, s[36:39], s50 offset:1024
  v_mfma_f32_16x16x32_bf16 v[108:111], v[164:167], v[228:231], v[108:111]
  ds_read_b64_tr_b16 v[194:195], v6 offset:25088
  ds_read_b64_tr_b16 v[196:197], v7 offset:24576
  v_mfma_f32_16x16x32_bf16 v[104:107], v[164:167], v[224:227], v[104:107]
  ds_read_b64_tr_b16 v[198:199], v7 offset:25088
  v_mfma_f32_16x16x32_bf16 v[112:115], v[168:171], v[224:227], v[112:115]
  ds_read_b64_tr_b16 v[200:201], v8 offset:24576
  v_mfma_f32_16x16x32_bf16 v[116:119], v[168:171], v[228:231], v[116:119]
  buffer_load_dwordx4 v[76:79], off, s[64:67], s50 offset:1024
  v_mfma_f32_16x16x32_bf16 v[124:127], v[172:175], v[228:231], v[124:127]
  ds_read_b64_tr_b16 v[202:203], v8 offset:25088
  ds_read_b64_tr_b16 v[204:205], v9 offset:24576
  v_mfma_f32_16x16x32_bf16 v[120:123], v[172:175], v[224:227], v[120:123]
  ds_read_b64_tr_b16 v[206:207], v9 offset:25088
  s_waitcnt vmcnt(20) lgkmcnt(8)
  v_mfma_f32_16x16x32_bf16 v[96:99], v[176:179], v[232:235], v[96:99]
  ds_read_b64_tr_b16 v[208:209], v6 offset:28672
  v_readlane_b32 s51, v15, 27
  v_mfma_f32_16x16x32_bf16 v[100:103], v[176:179], v[236:239], v[100:103]
  ds_read_b64_tr_b16 v[210:211], v6 offset:29184
  v_mfma_f32_16x16x32_bf16 v[108:111], v[180:183], v[236:239], v[108:111]
  ds_read_b64_tr_b16 v[212:213], v7 offset:28672
  v_mfma_f32_16x16x32_bf16 v[104:107], v[180:183], v[232:235], v[104:107]
  buffer_load_dwordx4 v[80:83], off, s[36:39], s51 offset:0
  v_mfma_f32_16x16x32_bf16 v[112:115], v[184:187], v[232:235], v[112:115]
  ds_read_b64_tr_b16 v[214:215], v7 offset:29184
  ds_read_b64_tr_b16 v[216:217], v8 offset:28672
  v_mfma_f32_16x16x32_bf16 v[116:119], v[184:187], v[236:239], v[116:119]
  ds_read_b64_tr_b16 v[218:219], v8 offset:29184
  v_mfma_f32_16x16x32_bf16 v[124:127], v[188:191], v[236:239], v[124:127]
  ds_read_b64_tr_b16 v[220:221], v9 offset:28672
  v_mfma_f32_16x16x32_bf16 v[120:123], v[188:191], v[232:235], v[120:123]
  ds_read_b64_tr_b16 v[222:223], v9 offset:29184
  s_waitcnt vmcnt(19) lgkmcnt(8)
  v_mfma_f32_16x16x32_bf16 v[96:99], v[192:195], v[240:243], v[96:99]
  ds_read_b64_tr_b16 v[160:161], v6 offset:32768
  buffer_load_dwordx4 v[84:87], off, s[64:67], s51 offset:0
  v_mfma_f32_16x16x32_bf16 v[100:103], v[192:195], v[244:247], v[100:103]
  ds_read_b64_tr_b16 v[162:163], v6 offset:33280
  s_waitcnt vmcnt(8)
  v_mfma_f32_16x16x32_bf16 v[108:111], v[196:199], v[244:247], v[108:111]
  buffer_store_dword v19, off, s[52:55], s6 sc1
  v_mfma_f32_16x16x32_bf16 v[104:107], v[196:199], v[240:243], v[104:107]
  ds_read_b64_tr_b16 v[164:165], v7 offset:32768
  ds_read_b64_tr_b16 v[166:167], v7 offset:33280
  v_mfma_f32_16x16x32_bf16 v[112:115], v[200:203], v[240:243], v[112:115]
  buffer_load_dwordx4 v[88:91], off, s[36:39], s51 offset:1024
  v_mfma_f32_16x16x32_bf16 v[116:119], v[200:203], v[244:247], v[116:119]
  ds_read_b64_tr_b16 v[168:169], v8 offset:32768
  ds_read_b64_tr_b16 v[170:171], v8 offset:33280
  v_mfma_f32_16x16x32_bf16 v[124:127], v[204:207], v[244:247], v[124:127]
  ds_read_b64_tr_b16 v[172:173], v9 offset:32768
  v_mfma_f32_16x16x32_bf16 v[120:123], v[204:207], v[240:243], v[120:123]
  ds_read_b64_tr_b16 v[174:175], v9 offset:33280
  s_waitcnt lgkmcnt(8)
  v_mfma_f32_16x16x32_bf16 v[96:99], v[208:211], v[248:251], v[96:99]
  buffer_load_dwordx4 v[92:95], off, s[64:67], s51 offset:1024
  v_mfma_f32_16x16x32_bf16 v[100:103], v[208:211], v[252:255], v[100:103]
  ds_read_b64_tr_b16 v[176:177], v6 offset:36864
  ds_read_b64_tr_b16 v[178:179], v6 offset:37376
  v_mfma_f32_16x16x32_bf16 v[108:111], v[212:215], v[252:255], v[108:111]
  ds_read_b64_tr_b16 v[180:181], v7 offset:36864
  v_readlane_b32 s48, v15, 28
  v_mfma_f32_16x16x32_bf16 v[104:107], v[212:215], v[248:251], v[104:107]
  ds_read_b64_tr_b16 v[182:183], v7 offset:37376
  v_mfma_f32_16x16x32_bf16 v[112:115], v[216:219], v[248:251], v[112:115]
  ds_read_b64_tr_b16 v[184:185], v8 offset:36864
  v_mfma_f32_16x16x32_bf16 v[116:119], v[216:219], v[252:255], v[116:119]
  buffer_load_dwordx4 v[224:227], off, s[36:39], s48 offset:0
  v_mfma_f32_16x16x32_bf16 v[124:127], v[220:223], v[252:255], v[124:127]
  ds_read_b64_tr_b16 v[186:187], v8 offset:37376
  ds_read_b64_tr_b16 v[188:189], v9 offset:36864
  v_mfma_f32_16x16x32_bf16 v[120:123], v[220:223], v[248:251], v[120:123]
  ds_read_b64_tr_b16 v[190:191], v9 offset:37376
  s_waitcnt lgkmcnt(8)
  v_mfma_f32_16x16x32_bf16 v[96:99], v[160:163], v[32:35], v[96:99]
  ds_read_b64_tr_b16 v[192:193], v6 offset:40960
  v_mfma_f32_16x16x32_bf16 v[100:103], v[160:163], v[36:39], v[100:103]
  buffer_load_dwordx4 v[228:231], off, s[64:67], s48 offset:0
  v_mfma_f32_16x16x32_bf16 v[108:111], v[164:167], v[36:39], v[108:111]
  ds_read_b64_tr_b16 v[194:195], v6 offset:41472
  ds_read_b64_tr_b16 v[196:197], v7 offset:40960
  v_mfma_f32_16x16x32_bf16 v[104:107], v[164:167], v[32:35], v[104:107]
  ds_read_b64_tr_b16 v[198:199], v7 offset:41472
  v_mfma_f32_16x16x32_bf16 v[112:115], v[168:171], v[32:35], v[112:115]
  ds_read_b64_tr_b16 v[200:201], v8 offset:40960
  v_mfma_f32_16x16x32_bf16 v[116:119], v[168:171], v[36:39], v[116:119]
  buffer_load_dwordx4 v[232:235], off, s[36:39], s48 offset:1024
  v_mfma_f32_16x16x32_bf16 v[124:127], v[172:175], v[36:39], v[124:127]
  ds_read_b64_tr_b16 v[202:203], v8 offset:41472
  ds_read_b64_tr_b16 v[204:205], v9 offset:40960
  v_mfma_f32_16x16x32_bf16 v[120:123], v[172:175], v[32:35], v[120:123]
  ds_read_b64_tr_b16 v[206:207], v9 offset:41472
  s_waitcnt lgkmcnt(8)
  v_mfma_f32_16x16x32_bf16 v[96:99], v[176:179], v[40:43], v[96:99]
  ds_read_b64_tr_b16 v[208:209], v6 offset:45056
  v_mfma_f32_16x16x32_bf16 v[100:103], v[176:179], v[44:47], v[100:103]
  buffer_load_dwordx4 v[236:239], off, s[64:67], s48 offset:1024
  v_mfma_f32_16x16x32_bf16 v[108:111], v[180:183], v[44:47], v[108:111]
  ds_read_b64_tr_b16 v[210:211], v6 offset:45568
  ds_read_b64_tr_b16 v[212:213], v7 offset:45056
  v_mfma_f32_16x16x32_bf16 v[104:107], v[180:183], v[40:43], v[104:107]
  ds_read_b64_tr_b16 v[214:215], v7 offset:45568
  v_readlane_b32 s49, v15, 29
  v_mfma_f32_16x16x32_bf16 v[112:115], v[184:187], v[40:43], v[112:115]
  ds_read_b64_tr_b16 v[216:217], v8 offset:45056
  v_mfma_f32_16x16x32_bf16 v[116:119], v[184:187], v[44:47], v[116:119]
  ds_read_b64_tr_b16 v[218:219], v8 offset:45568
  ds_read_b64_tr_b16 v[220:221], v9 offset:45056
  v_mfma_f32_16x16x32_bf16 v[124:127], v[188:191], v[44:47], v[124:127]
  buffer_load_dwordx4 v[240:243], off, s[36:39], s49 offset:0
  v_mfma_f32_16x16x32_bf16 v[120:123], v[188:191], v[40:43], v[120:123]
  ds_read_b64_tr_b16 v[222:223], v9 offset:45568
  s_waitcnt lgkmcnt(8)
  v_mfma_f32_16x16x32_bf16 v[96:99], v[192:195], v[48:51], v[96:99]
  ds_read_b64_tr_b16 v[160:161], v6 offset:49152
  v_mfma_f32_16x16x32_bf16 v[100:103], v[192:195], v[52:55], v[100:103]
  ds_read_b64_tr_b16 v[162:163], v6 offset:49664
  v_mfma_f32_16x16x32_bf16 v[108:111], v[196:199], v[52:55], v[108:111]
  buffer_load_dwordx4 v[244:247], off, s[64:67], s49 offset:0
  v_mfma_f32_16x16x32_bf16 v[104:107], v[196:199], v[48:51], v[104:107]
  ds_read_b64_tr_b16 v[164:165], v7 offset:49152
  ds_read_b64_tr_b16 v[166:167], v7 offset:49664
  v_mfma_f32_16x16x32_bf16 v[112:115], v[200:203], v[48:51], v[112:115]
  ds_read_b64_tr_b16 v[168:169], v8 offset:49152
  v_mfma_f32_16x16x32_bf16 v[116:119], v[200:203], v[52:55], v[116:119]
  ds_read_b64_tr_b16 v[170:171], v8 offset:49664
  ds_read_b64_tr_b16 v[172:173], v9 offset:49152
  v_mfma_f32_16x16x32_bf16 v[124:127], v[204:207], v[52:55], v[124:127]
  buffer_load_dwordx4 v[248:251], off, s[36:39], s49 offset:1024
  v_mfma_f32_16x16x32_bf16 v[120:123], v[204:207], v[48:51], v[120:123]
  ds_read_b64_tr_b16 v[174:175], v9 offset:49664
  s_waitcnt vmcnt(16) lgkmcnt(8)
  s_barrier
  v_mfma_f32_16x16x32_bf16 v[96:99], v[208:211], v[56:59], v[96:99]
  ds_read_b64_tr_b16 v[176:177], v6 offset:53248
  v_mfma_f32_16x16x32_bf16 v[100:103], v[208:211], v[60:63], v[100:103]
  ds_read_b64_tr_b16 v[178:179], v6 offset:53760
  v_mfma_f32_16x16x32_bf16 v[108:111], v[212:215], v[60:63], v[108:111]
  buffer_load_dwordx4 v[252:255], off, s[64:67], s49 offset:1024
  v_mfma_f32_16x16x32_bf16 v[104:107], v[212:215], v[56:59], v[104:107]
  ds_read_b64_tr_b16 v[180:181], v7 offset:53248
  ds_read_b64_tr_b16 v[182:183], v7 offset:53760
  v_mfma_f32_16x16x32_bf16 v[112:115], v[216:219], v[56:59], v[112:115]
  ds_read_b64_tr_b16 v[184:185], v8 offset:53248
  v_readlane_b32 s50, v15, 30
  v_mfma_f32_16x16x32_bf16 v[116:119], v[216:219], v[60:63], v[116:119]
  ds_read_b64_tr_b16 v[186:187], v8 offset:53760
  v_mfma_f32_16x16x32_bf16 v[124:127], v[220:223], v[60:63], v[124:127]
  ds_read_b64_tr_b16 v[188:189], v9 offset:53248
  v_mfma_f32_16x16x32_bf16 v[120:123], v[220:223], v[56:59], v[120:123]
  ds_read_b64_tr_b16 v[190:191], v9 offset:53760
  s_waitcnt vmcnt(15) lgkmcnt(8)
  v_mfma_f32_16x16x32_bf16 v[96:99], v[160:163], v[64:67], v[96:99]
  buffer_load_dwordx4 v[32:35], off, s[36:39], s50 offset:0
  v_mfma_f32_16x16x32_bf16 v[100:103], v[160:163], v[68:71], v[100:103]
  ds_read_b64_tr_b16 v[192:193], v6 offset:57344
  ds_read_b64_tr_b16 v[194:195], v6 offset:57856
  v_mfma_f32_16x16x32_bf16 v[108:111], v[164:167], v[68:71], v[108:111]
  ds_read_b64_tr_b16 v[196:197], v7 offset:57344
  v_mfma_f32_16x16x32_bf16 v[104:107], v[164:167], v[64:67], v[104:107]
  ds_read_b64_tr_b16 v[198:199], v7 offset:57856
  v_mfma_f32_16x16x32_bf16 v[112:115], v[168:171], v[64:67], v[112:115]
  buffer_load_dwordx4 v[36:39], off, s[64:67], s50 offset:0
  v_mfma_f32_16x16x32_bf16 v[116:119], v[168:171], v[68:71], v[116:119]
  ds_read_b64_tr_b16 v[200:201], v8 offset:57344
  ds_read_b64_tr_b16 v[202:203], v8 offset:57856
  v_mfma_f32_16x16x32_bf16 v[124:127], v[172:175], v[68:71], v[124:127]
  ds_read_b64_tr_b16 v[204:205], v9 offset:57344
  v_mfma_f32_16x16x32_bf16 v[120:123], v[172:175], v[64:67], v[120:123]
  ds_read_b64_tr_b16 v[206:207], v9 offset:57856
  s_waitcnt vmcnt(15) lgkmcnt(8)
  v_mfma_f32_16x16x32_bf16 v[96:99], v[176:179], v[72:75], v[96:99]
  buffer_load_dwordx4 v[40:43], off, s[36:39], s50 offset:1024
  v_mfma_f32_16x16x32_bf16 v[100:103], v[176:179], v[76:79], v[100:103]
  ds_read_b64_tr_b16 v[208:209], v6 offset:61440
  ds_read_b64_tr_b16 v[210:211], v6 offset:61952
  v_mfma_f32_16x16x32_bf16 v[108:111], v[180:183], v[76:79], v[108:111]
  ds_read_b64_tr_b16 v[212:213], v7 offset:61440
  v_mfma_f32_16x16x32_bf16 v[104:107], v[180:183], v[72:75], v[104:107]
  ds_read_b64_tr_b16 v[214:215], v7 offset:61952
  v_mfma_f32_16x16x32_bf16 v[112:115], v[184:187], v[72:75], v[112:115]
  buffer_load_dwordx4 v[44:47], off, s[64:67], s50 offset:1024
  v_mfma_f32_16x16x32_bf16 v[116:119], v[184:187], v[76:79], v[116:119]
  ds_read_b64_tr_b16 v[216:217], v8 offset:61440
  ds_read_b64_tr_b16 v[218:219], v8 offset:61952
  v_mfma_f32_16x16x32_bf16 v[124:127], v[188:191], v[76:79], v[124:127]
  ds_read_b64_tr_b16 v[220:221], v9 offset:61440
  v_readlane_b32 s51, v15, 31
  v_mfma_f32_16x16x32_bf16 v[120:123], v[188:191], v[72:75], v[120:123]
  ds_read_b64_tr_b16 v[222:223], v9 offset:61952
  s_waitcnt vmcnt(15) lgkmcnt(8)
  v_mfma_f32_16x16x32_bf16 v[96:99], v[192:195], v[80:83], v[96:99]
  ds_read_b64_tr_b16 v[160:161], v20 offset:0
  v_mfma_f32_16x16x32_bf16 v[100:103], v[192:195], v[84:87], v[100:103]
  buffer_load_dwordx4 v[48:51], off, s[36:39], s51 offset:0
  v_mfma_f32_16x16x32_bf16 v[108:111], v[196:199], v[84:87], v[108:111]
  ds_read_b64_tr_b16 v[162:163], v20 offset:512
  ds_read_b64_tr_b16 v[164:165], v21 offset:0
  v_mfma_f32_16x16x32_bf16 v[104:107], v[196:199], v[80:83], v[104:107]
  ds_read_b64_tr_b16 v[166:167], v21 offset:512
  v_mfma_f32_16x16x32_bf16 v[112:115], v[200:203], v[80:83], v[112:115]
  ds_read_b64_tr_b16 v[168:169], v22 offset:0
  v_mfma_f32_16x16x32_bf16 v[116:119], v[200:203], v[84:87], v[116:119]
  buffer_load_dwordx4 v[52:55], off, s[64:67], s51 offset:0
  v_mfma_f32_16x16x32_bf16 v[124:127], v[204:207], v[84:87], v[124:127]
  ds_read_b64_tr_b16 v[170:171], v22 offset:512
  ds_read_b64_tr_b16 v[172:173], v23 offset:0
  v_mfma_f32_16x16x32_bf16 v[120:123], v[204:207], v[80:83], v[120:123]
  ds_read_b64_tr_b16 v[174:175], v23 offset:512
  s_waitcnt vmcnt(14) lgkmcnt(8)
  v_mfma_f32_16x16x32_bf16 v[96:99], v[208:211], v[88:91], v[96:99]
  ds_read_b64_tr_b16 v[176:177], v20 offset:4096
  v_mfma_f32_16x16x32_bf16 v[100:103], v[208:211], v[92:95], v[100:103]
  buffer_load_dwordx4 v[56:59], off, s[36:39], s51 offset:1024
  v_mfma_f32_16x16x32_bf16 v[108:111], v[212:215], v[92:95], v[108:111]
  ds_read_b64_tr_b16 v[178:179], v20 offset:4608
  ds_read_b64_tr_b16 v[180:181], v21 offset:4096
  v_mfma_f32_16x16x32_bf16 v[104:107], v[212:215], v[88:91], v[104:107]
  ds_read_b64_tr_b16 v[182:183], v21 offset:4608
  v_mfma_f32_16x16x32_bf16 v[112:115], v[216:219], v[88:91], v[112:115]
  ds_read_b64_tr_b16 v[184:185], v22 offset:4096
  v_mfma_f32_16x16x32_bf16 v[116:119], v[216:219], v[92:95], v[116:119]
  buffer_load_dwordx4 v[60:63], off, s[64:67], s51 offset:1024
  v_mfma_f32_16x16x32_bf16 v[124:127], v[220:223], v[92:95], v[124:127]
  ds_read_b64_tr_b16 v[186:187], v22 offset:4608
  ds_read_b64_tr_b16 v[188:189], v23 offset:4096
  v_mfma_f32_16x16x32_bf16 v[120:123], v[220:223], v[88:91], v[120:123]
  ds_read_b64_tr_b16 v[190:191], v23 offset:4608
  s_waitcnt vmcnt(14) lgkmcnt(8)
  v_mfma_f32_16x16x32_bf16 v[96:99], v[160:163], v[224:227], v[96:99]
  ds_read_b64_tr_b16 v[192:193], v20 offset:8192
  v_readlane_b32 s48, v15, 32
  v_mfma_f32_16x16x32_bf16 v[100:103], v[160:163], v[228:231], v[100:103]
  ds_read_b64_tr_b16 v[194:195], v20 offset:8704
  v_mfma_f32_16x16x32_bf16 v[108:111], v[164:167], v[228:231], v[108:111]
  ds_read_b64_tr_b16 v[196:197], v21 offset:8192
  v_mfma_f32_16x16x32_bf16 v[104:107], v[164:167], v[224:227], v[104:107]
  buffer_load_dwordx4 v[64:67], off, s[36:39], s48 offset:0
  v_mfma_f32_16x16x32_bf16 v[112:115], v[168:171], v[224:227], v[112:115]
  ds_read_b64_tr_b16 v[198:199], v21 offset:8704
  ds_read_b64_tr_b16 v[200:201], v22 offset:8192
  v_mfma_f32_16x16x32_bf16 v[116:119], v[168:171], v[228:231], v[116:119]
  ds_read_b64_tr_b16 v[202:203], v22 offset:8704
  v_mfma_f32_16x16x32_bf16 v[124:127], v[172:175], v[228:231], v[124:127]
  ds_read_b64_tr_b16 v[204:205], v23 offset:8192
  v_mfma_f32_16x16x32_bf16 v[120:123], v[172:175], v[224:227], v[120:123]
  ds_read_b64_tr_b16 v[206:207], v23 offset:8704
  s_waitcnt vmcnt(13) lgkmcnt(8)
  v_mfma_f32_16x16x32_bf16 v[96:99], v[176:179], v[232:235], v[96:99]
  buffer_load_dwordx4 v[68:71], off, s[64:67], s48 offset:0
  v_mfma_f32_16x16x32_bf16 v[100:103], v[176:179], v[236:239], v[100:103]
  ds_read_b64_tr_b16 v[208:209], v20 offset:12288
  ds_read_b64_tr_b16 v[210:211], v20 offset:12800
  v_mfma_f32_16x16x32_bf16 v[108:111], v[180:183], v[236:239], v[108:111]
  ds_read_b64_tr_b16 v[212:213], v21 offset:12288
  v_mfma_f32_16x16x32_bf16 v[104:107], v[180:183], v[232:235], v[104:107]
  ds_read_b64_tr_b16 v[214:215], v21 offset:12800
  v_mfma_f32_16x16x32_bf16 v[112:115], v[184:187], v[232:235], v[112:115]
  buffer_load_dwordx4 v[72:75], off, s[36:39], s48 offset:1024
  v_mfma_f32_16x16x32_bf16 v[116:119], v[184:187], v[236:239], v[116:119]
  ds_read_b64_tr_b16 v[216:217], v22 offset:12288
  ds_read_b64_tr_b16 v[218:219], v22 offset:12800
  v_mfma_f32_16x16x32_bf16 v[124:127], v[188:191], v[236:239], v[124:127]
  ds_read_b64_tr_b16 v[220:221], v23 offset:12288
  v_mfma_f32_16x16x32_bf16 v[120:123], v[188:191], v[232:235], v[120:123]
  ds_read_b64_tr_b16 v[222:223], v23 offset:12800
  s_waitcnt vmcnt(13) lgkmcnt(8)
  v_mfma_f32_16x16x32_bf16 v[96:99], v[192:195], v[240:243], v[96:99]
  buffer_load_dwordx4 v[76:79], off, s[64:67], s48 offset:1024
  v_mfma_f32_16x16x32_bf16 v[100:103], v[192:195], v[244:247], v[100:103]
  ds_read_b64_tr_b16 v[160:161], v20 offset:16384
  ds_read_b64_tr_b16 v[162:163], v20 offset:16896
  v_mfma_f32_16x16x32_bf16 v[108:111], v[196:199], v[244:247], v[108:111]
  ds_read_b64_tr_b16 v[164:165], v21 offset:16384
  v_readlane_b32 s49, v15, 33
  v_mfma_f32_16x16x32_bf16 v[104:107], v[196:199], v[240:243], v[104:107]
  ds_read_b64_tr_b16 v[166:167], v21 offset:16896
  v_mfma_f32_16x16x32_bf16 v[112:115], v[200:203], v[240:243], v[112:115]
  ds_read_b64_tr_b16 v[168:169], v22 offset:16384
  v_mfma_f32_16x16x32_bf16 v[116:119], v[200:203], v[244:247], v[116:119]
  buffer_load_dwordx4 v[80:83], off, s[36:39], s49 offset:0
  v_mfma_f32_16x16x32_bf16 v[124:127], v[204:207], v[244:247], v[124:127]
  ds_read_b64_tr_b16 v[170:171], v22 offset:16896
  ds_read_b64_tr_b16 v[172:173], v23 offset:16384
  v_mfma_f32_16x16x32_bf16 v[120:123], v[204:207], v[240:243], v[120:123]
  ds_read_b64_tr_b16 v[174:175], v23 offset:16896
  s_waitcnt vmcnt(13) lgkmcnt(8)
  v_mfma_f32_16x16x32_bf16 v[96:99], v[208:211], v[248:251], v[96:99]
  ds_read_b64_tr_b16 v[176:177], v20 offset:20480
  v_mfma_f32_16x16x32_bf16 v[100:103], v[208:211], v[252:255], v[100:103]
  buffer_load_dwordx4 v[84:87], off, s[64:67], s49 offset:0
  v_mfma_f32_16x16x32_bf16 v[108:111], v[212:215], v[252:255], v[108:111]
  ds_read_b64_tr_b16 v[178:179], v20 offset:20992
  ds_read_b64_tr_b16 v[180:181], v21 offset:20480
  v_mfma_f32_16x16x32_bf16 v[104:107], v[212:215], v[248:251], v[104:107]
  ds_read_b64_tr_b16 v[182:183], v21 offset:20992
  v_mfma_f32_16x16x32_bf16 v[112:115], v[216:219], v[248:251], v[112:115]
  ds_read_b64_tr_b16 v[184:185], v22 offset:20480
  v_mfma_f32_16x16x32_bf16 v[116:119], v[216:219], v[252:255], v[116:119]
  buffer_load_dwordx4 v[88:91], off, s[36:39], s49 offset:1024
  v_mfma_f32_16x16x32_bf16 v[124:127], v[220:223], v[252:255], v[124:127]
  ds_read_b64_tr_b16 v[186:187], v22 offset:20992
  ds_read_b64_tr_b16 v[188:189], v23 offset:20480
  v_mfma_f32_16x16x32_bf16 v[120:123], v[220:223], v[248:251], v[120:123]
  ds_read_b64_tr_b16 v[190:191], v23 offset:20992
  s_waitcnt vmcnt(13) lgkmcnt(8)
  v_mfma_f32_16x16x32_bf16 v[96:99], v[160:163], v[32:35], v[96:99]
  ds_read_b64_tr_b16 v[192:193], v20 offset:24576
  v_mfma_f32_16x16x32_bf16 v[100:103], v[160:163], v[36:39], v[100:103]
  buffer_load_dwordx4 v[92:95], off, s[64:67], s49 offset:1024
  v_mfma_f32_16x16x32_bf16 v[108:111], v[164:167], v[36:39], v[108:111]
  ds_read_b64_tr_b16 v[194:195], v20 offset:25088
  ds_read_b64_tr_b16 v[196:197], v21 offset:24576
  v_mfma_f32_16x16x32_bf16 v[104:107], v[164:167], v[32:35], v[104:107]
  ds_read_b64_tr_b16 v[198:199], v21 offset:25088
  v_readlane_b32 s50, v15, 34
  v_mfma_f32_16x16x32_bf16 v[112:115], v[168:171], v[32:35], v[112:115]
  ds_read_b64_tr_b16 v[200:201], v22 offset:24576
  v_mfma_f32_16x16x32_bf16 v[116:119], v[168:171], v[36:39], v[116:119]
  ds_read_b64_tr_b16 v[202:203], v22 offset:25088
  ds_read_b64_tr_b16 v[204:205], v23 offset:24576
  v_mfma_f32_16x16x32_bf16 v[124:127], v[172:175], v[36:39], v[124:127]
  buffer_load_dwordx4 v[224:227], off, s[36:39], s50 offset:0
  v_mfma_f32_16x16x32_bf16 v[120:123], v[172:175], v[32:35], v[120:123]
  ds_read_b64_tr_b16 v[206:207], v23 offset:25088
  s_waitcnt vmcnt(13) lgkmcnt(8)
  s_barrier
  v_mfma_f32_16x16x32_bf16 v[96:99], v[176:179], v[40:43], v[96:99]
  buffer_load_dwordx4 v[144:147], off, s[60:63], s5 offset:0 sc1
  v_mfma_f32_16x16x32_bf16 v[100:103], v[176:179], v[44:47], v[100:103]
  ds_read_b64_tr_b16 v[208:209], v20 offset:28672
  ds_read_b64_tr_b16 v[210:211], v20 offset:29184
  v_mfma_f32_16x16x32_bf16 v[108:111], v[180:183], v[44:47], v[108:111]
  ds_read_b64_tr_b16 v[212:213], v21 offset:28672
  buffer_load_dwordx4 v[228:231], off, s[64:67], s50 offset:0
  v_mfma_f32_16x16x32_bf16 v[104:107], v[180:183], v[40:43], v[104:107]
  buffer_load_dwordx4 v[148:151], off, s[60:63], s5 offset:1024 sc1
  v_mfma_f32_16x16x32_bf16 v[112:115], v[184:187], v[40:43], v[112:115]
  ds_read_b64_tr_b16 v[214:215], v21 offset:29184
  ds_read_b64_tr_b16 v[216:217], v22 offset:28672
  v_mfma_f32_16x16x32_bf16 v[116:119], v[184:187], v[44:47], v[116:119]
  ds_read_b64_tr_b16 v[218:219], v22 offset:29184
  buffer_load_dwordx4 v[152:155], off, s[60:63], s5 offset:2048 sc1
  v_mfma_f32_16x16x32_bf16 v[124:127], v[188:191], v[44:47], v[124:127]
  ds_read_b64_tr_b16 v[220:221], v23 offset:28672
  buffer_load_dwordx4 v[232:235], off, s[36:39], s50 offset:1024
  v_mfma_f32_16x16x32_bf16 v[120:123], v[188:191], v[40:43], v[120:123]
  ds_read_b64_tr_b16 v[222:223], v23 offset:29184
  s_waitcnt vmcnt(16) lgkmcnt(8)
  v_mfma_f32_16x16x32_bf16 v[96:99], v[192:195], v[48:51], v[96:99]
  buffer_load_dwordx4 v[156:159], off, s[60:63], s5 offset:3072 sc1
  v_mfma_f32_16x16x32_bf16 v[100:103], v[192:195], v[52:55], v[100:103]
  ds_read_b64_tr_b16 v[160:161], v20 offset:32768
  ds_read_b64_tr_b16 v[162:163], v20 offset:33280
  v_mfma_f32_16x16x32_bf16 v[108:111], v[196:199], v[52:55], v[108:111]
  buffer_load_dwordx4 v[236:239], off, s[64:67], s50 offset:1024
  v_mfma_f32_16x16x32_bf16 v[104:107], v[196:199], v[48:51], v[104:107]
  ds_read_b64_tr_b16 v[164:165], v21 offset:32768
  ds_read_b64_tr_b16 v[166:167], v21 offset:33280
  v_mfma_f32_16x16x32_bf16 v[112:115], v[200:203], v[48:51], v[112:115]
  ds_read_b64_tr_b16 v[168:169], v22 offset:32768
  v_readlane_b32 s51, v15, 35
  v_mfma_f32_16x16x32_bf16 v[116:119], v[200:203], v[52:55], v[116:119]
  ds_read_b64_tr_b16 v[170:171], v22 offset:33280
  v_mfma_f32_16x16x32_bf16 v[124:127], v[204:207], v[52:55], v[124:127]
  ds_read_b64_tr_b16 v[172:173], v23 offset:32768
  v_mfma_f32_16x16x32_bf16 v[120:123], v[204:207], v[48:51], v[120:123]
  ds_read_b64_tr_b16 v[174:175], v23 offset:33280
  s_waitcnt vmcnt(16) lgkmcnt(8)
  v_mfma_f32_16x16x32_bf16 v[96:99], v[208:211], v[56:59], v[96:99]
  buffer_load_dwordx4 v[240:243], off, s[36:39], s51 offset:0
  v_mfma_f32_16x16x32_bf16 v[100:103], v[208:211], v[60:63], v[100:103]
  ds_read_b64_tr_b16 v[176:177], v20 offset:36864
  ds_read_b64_tr_b16 v[178:179], v20 offset:37376
  v_mfma_f32_16x16x32_bf16 v[108:111], v[212:215], v[60:63], v[108:111]
  ds_read_b64_tr_b16 v[180:181], v21 offset:36864
  v_mfma_f32_16x16x32_bf16 v[104:107], v[212:215], v[56:59], v[104:107]
  ds_read_b64_tr_b16 v[182:183], v21 offset:37376
  v_mfma_f32_16x16x32_bf16 v[112:115], v[216:219], v[56:59], v[112:115]
  buffer_load_dwordx4 v[244:247], off, s[64:67], s51 offset:0
  v_mfma_f32_16x16x32_bf16 v[116:119], v[216:219], v[60:63], v[116:119]
  ds_read_b64_tr_b16 v[184:185], v22 offset:36864
  ds_read_b64_tr_b16 v[186:187], v22 offset:37376
  v_mfma_f32_16x16x32_bf16 v[124:127], v[220:223], v[60:63], v[124:127]
  ds_read_b64_tr_b16 v[188:189], v23 offset:36864
  v_mfma_f32_16x16x32_bf16 v[120:123], v[220:223], v[56:59], v[120:123]
  ds_read_b64_tr_b16 v[190:191], v23 offset:37376
  s_waitcnt vmcnt(16) lgkmcnt(8)
  v_mfma_f32_16x16x32_bf16 v[96:99], v[160:163], v[64:67], v[96:99]
  buffer_load_dwordx4 v[248:251], off, s[36:39], s51 offset:1024
  v_mfma_f32_16x16x32_bf16 v[100:103], v[160:163], v[68:71], v[100:103]
  ds_read_b64_tr_b16 v[192:193], v20 offset:40960
  ds_read_b64_tr_b16 v[194:195], v20 offset:41472
  v_mfma_f32_16x16x32_bf16 v[108:111], v[164:167], v[68:71], v[108:111]
  ds_read_b64_tr_b16 v[196:197], v21 offset:40960
  v_mfma_f32_16x16x32_bf16 v[104:107], v[164:167], v[64:67], v[104:107]
  ds_read_b64_tr_b16 v[198:199], v21 offset:41472
  v_mfma_f32_16x16x32_bf16 v[112:115], v[168:171], v[64:67], v[112:115]
  buffer_load_dwordx4 v[252:255], off, s[64:67], s51 offset:1024
  v_mfma_f32_16x16x32_bf16 v[116:119], v[168:171], v[68:71], v[116:119]
  ds_read_b64_tr_b16 v[200:201], v22 offset:40960
  ds_read_b64_tr_b16 v[202:203], v22 offset:41472
  v_mfma_f32_16x16x32_bf16 v[124:127], v[172:175], v[68:71], v[124:127]
  ds_read_b64_tr_b16 v[204:205], v23 offset:40960
  v_mfma_f32_16x16x32_bf16 v[120:123], v[172:175], v[64:67], v[120:123]
  ds_read_b64_tr_b16 v[206:207], v23 offset:41472
  s_waitcnt vmcnt(16) lgkmcnt(8)
  v_mfma_f32_16x16x32_bf16 v[96:99], v[176:179], v[72:75], v[96:99]
  ds_read_b64_tr_b16 v[208:209], v20 offset:45056
  v_mfma_f32_16x16x32_bf16 v[100:103], v[176:179], v[76:79], v[100:103]
  ds_read_b64_tr_b16 v[210:211], v20 offset:45568
  v_mfma_f32_16x16x32_bf16 v[108:111], v[180:183], v[76:79], v[108:111]
  ds_read_b64_tr_b16 v[212:213], v21 offset:45056
  v_mfma_f32_16x16x32_bf16 v[104:107], v[180:183], v[72:75], v[104:107]
  ds_read_b64_tr_b16 v[214:215], v21 offset:45568
  v_mfma_f32_16x16x32_bf16 v[112:115], v[184:187], v[72:75], v[112:115]
  ds_read_b64_tr_b16 v[216:217], v22 offset:45056
  v_mfma_f32_16x16x32_bf16 v[116:119], v[184:187], v[76:79], v[116:119]
  ds_read_b64_tr_b16 v[218:219], v22 offset:45568
  v_mfma_f32_16x16x32_bf16 v[124:127], v[188:191], v[76:79], v[124:127]
  ds_read_b64_tr_b16 v[220:221], v23 offset:45056
  v_mfma_f32_16x16x32_bf16 v[120:123], v[188:191], v[72:75], v[120:123]
  ds_read_b64_tr_b16 v[222:223], v23 offset:45568
  s_waitcnt vmcnt(14) lgkmcnt(8)
  v_mfma_f32_16x16x32_bf16 v[96:99], v[192:195], v[80:83], v[96:99]
  ds_read_b64_tr_b16 v[160:161], v20 offset:49152
  v_mfma_f32_16x16x32_bf16 v[100:103], v[192:195], v[84:87], v[100:103]
  ds_read_b64_tr_b16 v[162:163], v20 offset:49664
  v_mfma_f32_16x16x32_bf16 v[108:111], v[196:199], v[84:87], v[108:111]
  ds_read_b64_tr_b16 v[164:165], v21 offset:49152
  v_mfma_f32_16x16x32_bf16 v[104:107], v[196:199], v[80:83], v[104:107]
  ds_read_b64_tr_b16 v[166:167], v21 offset:49664
  v_mfma_f32_16x16x32_bf16 v[112:115], v[200:203], v[80:83], v[112:115]
  ds_read_b64_tr_b16 v[168:169], v22 offset:49152
  v_mfma_f32_16x16x32_bf16 v[116:119], v[200:203], v[84:87], v[116:119]
  ds_read_b64_tr_b16 v[170:171], v22 offset:49664
  v_mfma_f32_16x16x32_bf16 v[124:127], v[204:207], v[84:87], v[124:127]
  ds_read_b64_tr_b16 v[172:173], v23 offset:49152
  v_mfma_f32_16x16x32_bf16 v[120:123], v[204:207], v[80:83], v[120:123]
  ds_read_b64_tr_b16 v[174:175], v23 offset:49664
  s_waitcnt vmcnt(12) lgkmcnt(8)
  v_mfma_f32_16x16x32_bf16 v[96:99], v[208:211], v[88:91], v[96:99]
  ds_read_b64_tr_b16 v[176:177], v20 offset:53248
  v_mfma_f32_16x16x32_bf16 v[100:103], v[208:211], v[92:95], v[100:103]
  ds_read_b64_tr_b16 v[178:179], v20 offset:53760
  v_mfma_f32_16x16x32_bf16 v[108:111], v[212:215], v[92:95], v[108:111]
  ds_read_b64_tr_b16 v[180:181], v21 offset:53248
  v_mfma_f32_16x16x32_bf16 v[104:107], v[212:215], v[88:91], v[104:107]
  ds_read_b64_tr_b16 v[182:183], v21 offset:53760
  v_mfma_f32_16x16x32_bf16 v[112:115], v[216:219], v[88:91], v[112:115]
  ds_read_b64_tr_b16 v[184:185], v22 offset:53248
  v_mfma_f32_16x16x32_bf16 v[116:119], v[216:219], v[92:95], v[116:119]
  ds_read_b64_tr_b16 v[186:187], v22 offset:53760
  v_mfma_f32_16x16x32_bf16 v[124:127], v[220:223], v[92:95], v[124:127]
  ds_read_b64_tr_b16 v[188:189], v23 offset:53248
  v_mfma_f32_16x16x32_bf16 v[120:123], v[220:223], v[88:91], v[120:123]
  ds_read_b64_tr_b16 v[190:191], v23 offset:53760
  s_waitcnt vmcnt(9) lgkmcnt(8)
  v_mfma_f32_16x16x32_bf16 v[96:99], v[160:163], v[224:227], v[96:99]
  ds_read_b64_tr_b16 v[192:193], v20 offset:57344
  s_waitcnt vmcnt(5)
  v_mfma_f32_16x16x32_bf16 v[100:103], v[160:163], v[228:231], v[100:103]
  ds_read_b64_tr_b16 v[194:195], v20 offset:57856
  v_lshlrev_b32 v128, 16, v144
  v_mfma_f32_16x16x32_bf16 v[108:111], v[164:167], v[228:231], v[108:111]
  ds_read_b64_tr_b16 v[196:197], v21 offset:57344
  v_and_b32 v129, s11, v144
  v_mfma_f32_16x16x32_bf16 v[104:107], v[164:167], v[224:227], v[104:107]
  ds_read_b64_tr_b16 v[198:199], v21 offset:57856
  v_lshlrev_b32 v130, 16, v145
  v_mfma_f32_16x16x32_bf16 v[112:115], v[168:171], v[224:227], v[112:115]
  ds_read_b64_tr_b16 v[200:201], v22 offset:57344
  v_and_b32 v131, s11, v145
  v_mfma_f32_16x16x32_bf16 v[116:119], v[168:171], v[228:231], v[116:119]
  ds_read_b64_tr_b16 v[202:203], v22 offset:57856
  v_lshlrev_b32 v132, 16, v146
  v_mfma_f32_16x16x32_bf16 v[124:127], v[172:175], v[228:231], v[124:127]
  ds_read_b64_tr_b16 v[204:205], v23 offset:57344
  v_and_b32 v133, s11, v146
  v_mfma_f32_16x16x32_bf16 v[120:123], v[172:175], v[224:227], v[120:123]
  ds_read_b64_tr_b16 v[206:207], v23 offset:57856
  s_waitcnt vmcnt(4) lgkmcnt(8)
  v_mfma_f32_16x16x32_bf16 v[96:99], v[176:179], v[232:235], v[96:99]
  ds_read_b64_tr_b16 v[208:209], v20 offset:61440
  v_lshlrev_b32 v134, 16, v147
  v_mfma_f32_16x16x32_bf16 v[100:103], v[176:179], v[236:239], v[100:103]
  ds_read_b64_tr_b16 v[210:211], v20 offset:61952
  v_and_b32 v135, s11, v147
  v_mfma_f32_16x16x32_bf16 v[108:111], v[180:183], v[236:239], v[108:111]
  ds_read_b64_tr_b16 v[212:213], v21 offset:61440
  v_lshlrev_b32 v136, 16, v148
  v_mfma_f32_16x16x32_bf16 v[104:107], v[180:183], v[232:235], v[104:107]
  ds_read_b64_tr_b16 v[214:215], v21 offset:61952
  v_and_b32 v137, s11, v148
  v_mfma_f32_16x16x32_bf16 v[112:115], v[184:187], v[232:235], v[112:115]
  ds_read_b64_tr_b16 v[216:217], v22 offset:61440
  v_lshlrev_b32 v138, 16, v149
  v_mfma_f32_16x16x32_bf16 v[116:119], v[184:187], v[236:239], v[116:119]
  ds_read_b64_tr_b16 v[218:219], v22 offset:61952
  v_and_b32 v139, s11, v149
  v_mfma_f32_16x16x32_bf16 v[124:127], v[188:191], v[236:239], v[124:127]
  ds_read_b64_tr_b16 v[220:221], v23 offset:61440
  v_lshlrev_b32 v140, 16, v150
  v_mfma_f32_16x16x32_bf16 v[120:123], v[188:191], v[232:235], v[120:123]
  ds_read_b64_tr_b16 v[222:223], v23 offset:61952
  s_waitcnt vmcnt(2) lgkmcnt(8)
  v_mfma_f32_16x16x32_bf16 v[96:99], v[192:195], v[240:243], v[96:99]
  v_mov_b32 v20, 0
  v_mov_b32 v21, 0
  v_mfma_f32_16x16x32_bf16 v[100:103], v[192:195], v[244:247], v[100:103]
  v_mov_b32 v22, 0
  v_mov_b32 v23, 0
  v_mfma_f32_16x16x32_bf16 v[108:111], v[196:199], v[244:247], v[108:111]
  v_and_b32 v141, s11, v150
  v_lshlrev_b32 v142, 16, v151
  v_and_b32 v143, s11, v151
  v_mfma_f32_16x16x32_bf16 v[104:107], v[196:199], v[240:243], v[104:107]
  v_lshlrev_b32 v144, 16, v152
  v_and_b32 v145, s11, v152
  v_lshlrev_b32 v146, 16, v153
  v_mfma_f32_16x16x32_bf16 v[112:115], v[200:203], v[240:243], v[112:115]
  v_and_b32 v147, s11, v153
  v_lshlrev_b32 v148, 16, v154
  v_and_b32 v149, s11, v154
  v_mfma_f32_16x16x32_bf16 v[116:119], v[200:203], v[244:247], v[116:119]
  v_lshlrev_b32 v150, 16, v155
  v_and_b32 v151, s11, v155
  v_lshlrev_b32 v152, 16, v156
  v_mfma_f32_16x16x32_bf16 v[124:127], v[204:207], v[244:247], v[124:127]
  v_and_b32 v153, s11, v156
  v_lshlrev_b32 v154, 16, v157
  v_and_b32 v155, s11, v157
  v_mfma_f32_16x16x32_bf16 v[120:123], v[204:207], v[240:243], v[120:123]
  s_waitcnt vmcnt(0) lgkmcnt(0)
  v_lshlrev_b32 v156, 16, v158
  v_and_b32 v157, s11, v158
  v_mfma_f32_16x16x32_bf16 v[96:99], v[208:211], v[248:251], v[96:99]
  v_lshlrev_b32 v158, 16, v159
  v_and_b32 v159, s11, v159
  v_mfma_f32_16x16x32_bf16 v[100:103], v[208:211], v[252:255], v[100:103]
  v_mfma_f32_16x16x32_bf16 v[108:111], v[212:215], v[252:255], v[108:111]
  v_mfma_f32_16x16x32_bf16 v[104:107], v[212:215], v[248:251], v[104:107]
  v_mfma_f32_16x16x32_bf16 v[112:115], v[216:219], v[248:251], v[112:115]
  v_mfma_f32_16x16x32_bf16 v[116:119], v[216:219], v[252:255], v[116:119]
  v_mfma_f32_16x16x32_bf16 v[124:127], v[220:223], v[252:255], v[124:127]
  v_mfma_f32_16x16x32_bf16 v[120:123], v[220:223], v[248:251], v[120:123]
  s_lshl_b32 s3, s7, 4
  s_mov_b32 s10, 0x3f803f80
  s_nop 4
  v_pk_add_f32 v[96:97], v[96:97], v[128:129]
  v_pk_add_f32 v[98:99], v[98:99], v[130:131]
  v_cvt_pk_bf16_f32 v240, v96, v97
  v_cvt_pk_bf16_f32 v241, v98, v99
  v_pk_add_f32 v[104:105], v[104:105], v[136:137]
  v_pk_add_f32 v[106:107], v[106:107], v[138:139]
  v_cvt_pk_bf16_f32 v242, v104, v105
  v_cvt_pk_bf16_f32 v243, v106, v107
  s_nop 1
  v_permlane16_swap_b32 v240, v242
  v_permlane16_swap_b32 v241, v243
  buffer_store_dwordx4 v[240:243], v12, s[44:47], 0 offen offset:0 sc1
  v_pk_add_f32 v[112:113], v[112:113], v[144:145]
  v_pk_add_f32 v[114:115], v[114:115], v[146:147]
  v_cvt_pk_bf16_f32 v244, v112, v113
  v_cvt_pk_bf16_f32 v245, v114, v115
  v_pk_add_f32 v[120:121], v[120:121], v[152:153]
  v_pk_add_f32 v[122:123], v[122:123], v[154:155]
  v_cvt_pk_bf16_f32 v246, v120, v121
  v_cvt_pk_bf16_f32 v247, v122, v123
  s_nop 1
  v_permlane16_swap_b32 v244, v246
  v_permlane16_swap_b32 v245, v247
  buffer_store_dwordx4 v[244:247], v12, s[44:47], 0 offen offset:64 sc1
  v_pk_add_f32 v[100:101], v[100:101], v[132:133]
  v_pk_add_f32 v[102:103], v[102:103], v[134:135]
  v_cvt_pk_bf16_f32 v248, v100, v101
  v_cvt_pk_bf16_f32 v249, v102, v103
  v_pk_add_f32 v[108:109], v[108:109], v[140:141]
  v_pk_add_f32 v[110:111], v[110:111], v[142:143]
  v_cvt_pk_bf16_f32 v250, v108, v109
  v_cvt_pk_bf16_f32 v251, v110, v111
  s_nop 1
  v_permlane16_swap_b32 v248, v250
  v_permlane16_swap_b32 v249, v251
  buffer_store_dwordx4 v[248:251], v12, s[44:47], s3 offen offset:0 sc1
  v_pk_add_f32 v[116:117], v[116:117], v[148:149]
  v_pk_add_f32 v[118:119], v[118:119], v[150:151]
  v_cvt_pk_bf16_f32 v252, v116, v117
  v_cvt_pk_bf16_f32 v253, v118, v119
  v_pk_add_f32 v[124:125], v[124:125], v[156:157]
  v_pk_add_f32 v[126:127], v[126:127], v[158:159]
  v_cvt_pk_bf16_f32 v254, v124, v125
  v_cvt_pk_bf16_f32 v255, v126, v127
  s_nop 1
  v_permlane16_swap_b32 v252, v254
  v_permlane16_swap_b32 v253, v255
  buffer_store_dwordx4 v[252:255], v12, s[44:47], s3 offen offset:64 sc1
  v_dot2_f32_bf16 v20, v240, s10, v20
  v_dot2_f32_bf16 v22, v240, v240, v22
  v_dot2_f32_bf16 v20, v241, s10, v20
  v_dot2_f32_bf16 v22, v241, v241, v22
  v_dot2_f32_bf16 v20, v242, s10, v20
  v_dot2_f32_bf16 v22, v242, v242, v22
  v_dot2_f32_bf16 v20, v243, s10, v20
  v_dot2_f32_bf16 v22, v243, v243, v22
  v_dot2_f32_bf16 v20, v244, s10, v20
  v_dot2_f32_bf16 v22, v244, v244, v22
  v_dot2_f32_bf16 v20, v245, s10, v20
  v_dot2_f32_bf16 v22, v245, v245, v22
  v_dot2_f32_bf16 v20, v246, s10, v20
  v_dot2_f32_bf16 v22, v246, v246, v22
  v_dot2_f32_bf16 v20, v247, s10, v20
  v_dot2_f32_bf16 v22, v247, v247, v22
  v_dot2_f32_bf16 v21, v248, s10, v21
  v_dot2_f32_bf16 v23, v248, v248, v23
  v_dot2_f32_bf16 v21, v249, s10, v21
  v_dot2_f32_bf16 v23, v249, v249, v23
  v_dot2_f32_bf16 v21, v250, s10, v21
  v_dot2_f32_bf16 v23, v250, v250, v23
  v_dot2_f32_bf16 v21, v251, s10, v21
  v_dot2_f32_bf16 v23, v251, v251, v23
  v_dot2_f32_bf16 v21, v252, s10, v21
  v_dot2_f32_bf16 v23, v252, v252, v23
  v_dot2_f32_bf16 v21, v253, s10, v21
  v_dot2_f32_bf16 v23, v253, v253, v23
  v_dot2_f32_bf16 v21, v254, s10, v21
  v_dot2_f32_bf16 v23, v254, v254, v23
  v_dot2_f32_bf16 v21, v255, s10, v21
  v_dot2_f32_bf16 v23, v255, v255, v23
  s_nop 2
  v_permlane32_swap_b32 v20, v21
  v_permlane32_swap_b32 v22, v23
  v_add_f32 v20, v20, v21
  v_add_f32 v22, v22, v23
  s_nop 1
  v_permlane16_swap_b32 v20, v22
  v_add_f32 v20, v20, v22
  buffer_store_dword v20, v18, s[56:59], 0 offen sc1
  s_cmp_eq_u32 s96, 1
  s_cbranch_scc1 L_w2_end
  s_waitcnt vmcnt(0) lgkmcnt(0)
  s_barrier
  s_mov_b32 s96, 1
  s_add_u32 s12, s22, 33554432
  s_addc_u32 s13, s23, 0
  s_add_u32 s34, s22, 67108864
  s_addc_u32 s35, s23, 0
  s_add_u32 s97, s97, 1
  s_branch L_attn_body
L_w2_c1:
```

```asm
; @launch grid=(256,1,1) block=(512,1,1) lds=163840
.amdgcn_target "amdgcn-amd-amdhsa--gfx950"
L_attn_c0:
.text
.globl interleave_layers__sliding_local_dilated__dense_activation_gelu__prompt_kernel
.p2align 8
.type interleave_layers__sliding_local_dilated__dense_activation_gelu__prompt_kernel,@function
interleave_layers__sliding_local_dilated__dense_activation_gelu__prompt_kernel:
  s_load_dwordx4 s[16:19], s[0:1], 0
  s_load_dwordx2 s[20:21], s[0:1], 16
  s_load_dwordx2 s[22:23], s[0:1], 80
  s_load_dwordx8 s[24:31], s[0:1], 32
  s_load_dwordx2 s[32:33], s[0:1], 64
  s_load_dwordx2 s[34:35], s[0:1], 80
  s_load_dwordx2 s[12:13], s[0:1], 0
  s_mov_b32 s96, 0
  s_mov_b32 s97, 0
L_attn_body:
  s_cmp_ge_u32 s2, 256
  s_cbranch_scc1 L_attn_end
  v_lshrrev_b32 v2, 6, v0
  v_and_b32 v1, 63, v0
  v_readfirstlane_b32 s70, v2
  s_and_b32 s3, s2, 7
  s_lshr_b32 s99, s2, 3
  s_and_b32 s5, s3, 1
  s_lshl_b32 s5, s5, 3
  s_and_b32 s6, s99, 7
  s_add_u32 s68, s5, s6
  s_lshr_b32 s5, s3, 1
  s_lshl_b32 s5, s5, 2
  s_lshr_b32 s6, s99, 3
  s_add_u32 s69, s5, s6
  s_cmp_lt_u32 s70, 4
  s_cbranch_scc1 L_attn_compute
L_attn_loader:
  s_add_u32 s8, s70, s69
  s_and_b32 s8, s8, 3
  s_add_u32 s9, s70, s68
  s_and_b32 s9, s9, 3
  s_lshl_b32 s76, s8, 12
  s_lshl_b32 s77, s9, 11
  s_add_u32 s77, s77, 16384
  s_lshl_b32 s11, s68, 7
  v_and_b32 v10, 7, v1
  v_lshrrev_b32 v3, 3, v1
  s_lshr_b32 s10, s76, 7
  s_lshl_b32 s3, s68, 7
  s_add_u32 s10, s10, s3
  v_add_u32 v3, s10, v3
  s_cmp_eq_u32 s96, 1
  s_cselect_b32 s5, 128, 0
  s_add_u32 s5, s5, 2048
  s_lshl_b32 s6, s5, 3
  v_mul_u32_u24 v3, s5, v3
  v_lshrrev_b32 v2, 4, v1
  v_xor_b32 v4, v2, v10
  v_lshl_add_u32 v4, v4, 4, v3
  v_add_u32 v3, s6, v3
  v_add_u32 v5, 4, v2
  v_xor_b32 v5, v5, v10
  v_lshl_add_u32 v5, v5, 4, v3
  v_add_u32 v3, s6, v3
  v_xor_b32 v6, v2, v10
  v_lshl_add_u32 v6, v6, 4, v3
  v_add_u32 v3, s6, v3
  v_add_u32 v7, 4, v2
  v_xor_b32 v7, v7, v10
  v_lshl_add_u32 v7, v7, 4, v3
  v_lshrrev_b32 v3, 3, v1
  s_lshl_b32 s10, s9, 4
  v_add_u32 v3, s10, v3
  v_mul_u32_u24 v3, 6144, v3
  v_lshrrev_b32 v2, 3, v1
  v_and_b32 v2, 2, v2
  v_xor_b32 v2, v2, v10
  s_mul_i32 s10, s69, 128
  v_add_u32 v3, s10, v3
  v_lshl_add_u32 v8, v2, 4, v3
  v_xor_b32 v2, 4, v2
  v_add_u32 v3, 49152, v3
  v_lshl_add_u32 v9, v2, 4, v3
  s_and_b32 s10, s70, 3
  s_lshl_b32 s78, s10, 9
  s_add_u32 s78, s78, 40960
  s_lshl_b32 s14, s10, 2
  s_add_u32 s14, s14, s11
  s_sub_u32 s14, s14, 16
  v_lshrrev_b32 v3, 3, v1
  v_add_u32 v3, s14, v3
  v_max_i32 v3, 0, v3
  v_mul_u32_u24 v3, s5, v3
  s_lshl_b32 s14, s10, 1
  v_lshrrev_b32 v2, 4, v1
  v_add_u32 v2, s14, v2
  v_and_b32 v2, 7, v2
  v_xor_b32 v2, v2, v10
  v_lshl_add_u32 v28, v2, 4, v3
  s_cmp_eq_u32 s10, 0
  s_cselect_b32 s14, 0xffffff00, -1
  s_mov_b32 s15, 0
  s_mov_b32 s75, 0
  s_add_u32 s100, s68, s69
  s_mov_b32 s101, -1
  s_add_u32 s101, s101, 1
  s_sub_u32 s73, s101, s100
  s_lshl_b32 s73, s73, 3
  s_lshr_b32 s73, 0xf0f02, s73
  s_and_b32 s73, s73, 255
  s_add_u32 s73, s73, s101
  s_and_b32 s73, s73, 15
  s_mul_i32 s74, s73, 393216
  s_lshl_b32 s73, s73, 7
  s_waitcnt lgkmcnt(0)
  s_mov_b32 s36, s12
  s_and_b32 s37, s13, 0xffff
  s_mov_b32 s38, 4194304
  s_mov_b32 s39, 0x00020000
  s_cmp_eq_u32 s96, 1
  s_cselect_b32 s38, 128, 0
  s_add_u32 s38, s38, 2048
  s_lshl_b32 s38, s38, 11
  s_mov_b32 s40, s18
  s_and_b32 s41, s19, 0xffff
  s_mov_b32 s42, 6291456
  s_mov_b32 s43, 0x00020000
  s_cmp_lg_u32 s96, 0
  s_cbranch_scc1 L_attn_ld1
  s_mov_b32 s48, s28
  s_and_b32 s49, s29, 0xffff
  s_mov_b32 s50, 7340032
  s_mov_b32 s51, 0x00020000
  s_cmp_eq_u32 s96, 0
  s_cselect_b32 s50, s50, 0
  s_and_b32 s3, s70, 3
  s_lshl_b32 s4, s2, 2
  s_add_u32 s3, s3, s4
  s_mul_i32 s98, s3, 3584
  s_add_u32 s98, s98, 0
  s_add_u32 s3, s75, s76
  s_add_u32 m0, s3, 0
  s_nop 0
  buffer_load_dwordx4 v4, s[36:39], s73 offen lds
  s_add_u32 m0, s3, 1024
  s_nop 0
  buffer_load_dwordx4 v5, s[36:39], s73 offen lds
  s_add_u32 m0, s3, 2048
  s_nop 0
  buffer_load_dwordx4 v6, s[36:39], s73 offen lds
  s_add_u32 m0, s3, 3072
  s_nop 0
  buffer_load_dwordx4 v7, s[36:39], s73 offen lds
  s_add_u32 m0, s78, s75
  s_mov_b64 exec, s[14:15]
  buffer_load_dwordx4 v28, s[36:39], s73 offen lds
  s_mov_b64 exec, -1
  s_add_u32 s3, s75, s77
  s_add_u32 m0, s3, 0
  s_add_u32 s4, s74, 0
  buffer_load_dwordx4 v8, s[40:43], s4 offen lds
  s_add_u32 m0, s3, 1024
  s_nop 0
  buffer_load_dwordx4 v9, s[40:43], s4 offen lds
  s_add_u32 m0, s3, 8192
  s_add_u32 s4, s74, 2048
  buffer_load_dwordx4 v8, s[40:43], s4 offen lds
  s_add_u32 m0, s3, 9216
  s_nop 0
  buffer_load_dwordx4 v9, s[40:43], s4 offen lds
  s_add_u32 m0, s3, 16384
  s_add_u32 s4, s74, 4096
  buffer_load_dwordx4 v8, s[40:43], s4 offen lds
  s_add_u32 m0, s3, 17408
  s_nop 0
  buffer_load_dwordx4 v9, s[40:43], s4 offen lds
  s_add_u32 s101, s101, 1
  s_sub_u32 s73, s101, s100
  s_lshl_b32 s73, s73, 3
  s_lshr_b32 s73, 0xf0f02, s73
  s_and_b32 s73, s73, 255
  s_add_u32 s73, s73, s101
  s_and_b32 s73, s73, 15
  s_mul_i32 s74, s73, 393216
  s_lshl_b32 s73, s73, 7
  s_add_u32 s75, s75, 43008
  s_cmp_eq_u32 s75, 129024
  s_cselect_b32 s75, 0, s75
  s_add_u32 s3, s75, s76
  s_add_u32 m0, s3, 0
  s_nop 0
  buffer_load_dwordx4 v4, s[36:39], s73 offen lds
  s_add_u32 m0, s3, 1024
  s_nop 0
  buffer_load_dwordx4 v5, s[36:39], s73 offen lds
  s_add_u32 m0, s3, 2048
  s_nop 0
  buffer_load_dwordx4 v6, s[36:39], s73 offen lds
  s_add_u32 m0, s3, 3072
  s_nop 0
  buffer_load_dwordx4 v7, s[36:39], s73 offen lds
  s_add_u32 m0, s78, s75
  s_mov_b64 exec, s[14:15]
  buffer_load_dwordx4 v28, s[36:39], s73 offen lds
  s_mov_b64 exec, -1
  s_add_u32 s3, s75, s77
  s_add_u32 m0, s3, 0
  s_add_u32 s4, s74, 0
  buffer_load_dwordx4 v8, s[40:43], s4 offen lds
  s_add_u32 m0, s3, 1024
  s_nop 0
  buffer_load_dwordx4 v9, s[40:43], s4 offen lds
  s_add_u32 m0, s3, 8192
  s_add_u32 s4, s74, 2048
  buffer_load_dwordx4 v8, s[40:43], s4 offen lds
  s_add_u32 m0, s3, 9216
  s_nop 0
  buffer_load_dwordx4 v9, s[40:43], s4 offen lds
  s_add_u32 m0, s3, 16384
  s_add_u32 s4, s74, 4096
  buffer_load_dwordx4 v8, s[40:43], s4 offen lds
  s_add_u32 m0, s3, 17408
  s_nop 0
  buffer_load_dwordx4 v9, s[40:43], s4 offen lds
  s_add_u32 s101, s101, 1
  s_sub_u32 s73, s101, s100
  s_lshl_b32 s73, s73, 3
  s_lshr_b32 s73, 0xf0f02, s73
  s_and_b32 s73, s73, 255
  s_add_u32 s73, s73, s101
  s_and_b32 s73, s73, 15
  s_mul_i32 s74, s73, 393216
  s_lshl_b32 s73, s73, 7
  s_add_u32 s75, s75, 43008
  s_cmp_eq_u32 s75, 129024
  s_cselect_b32 s75, 0, s75
  s_and_b32 s3, s70, 3
  s_lshl_b32 s4, s2, 2
  s_add_u32 s3, s3, s4
  s_sub_u32 s4, 384, s40
  s_and_b32 s4, s4, 0x380
  s_mul_i32 s5, s3, 6144
  s_add_u32 s5, s5, s4
  s_buffer_load_dword s84, s[40:43], s5 offset:0
  s_buffer_load_dword s84, s[40:43], s5 offset:64
  s_buffer_load_dword s84, s[40:43], s5 offset:1024
  s_buffer_load_dword s84, s[40:43], s5 offset:1088
  s_buffer_load_dword s84, s[40:43], s5 offset:2048
  s_buffer_load_dword s84, s[40:43], s5 offset:2112
  s_buffer_load_dword s84, s[40:43], s5 offset:3072
  s_buffer_load_dword s84, s[40:43], s5 offset:3136
  s_buffer_load_dword s84, s[40:43], s5 offset:4096
  s_buffer_load_dword s84, s[40:43], s5 offset:4160
  s_buffer_load_dword s84, s[40:43], s5 offset:5120
  s_buffer_load_dword s84, s[40:43], s5 offset:5184
  s_waitcnt vmcnt(11)
  s_barrier
  s_mov_b32 s79, 13
L_attn0_ld1:
  s_add_u32 s3, s75, s76
  s_add_u32 m0, s3, 0
  s_nop 0
  buffer_load_dwordx4 v4, s[36:39], s73 offen lds
  s_add_u32 m0, s3, 1024
  s_nop 0
  buffer_load_dwordx4 v5, s[36:39], s73 offen lds
  s_add_u32 m0, s3, 2048
  s_nop 0
  buffer_load_dwordx4 v6, s[36:39], s73 offen lds
  s_add_u32 m0, s3, 3072
  s_nop 0
  buffer_load_dwordx4 v7, s[36:39], s73 offen lds
  s_add_u32 m0, s78, s75
  s_mov_b64 exec, s[14:15]
  buffer_load_dwordx4 v28, s[36:39], s73 offen lds
  s_mov_b64 exec, -1
  s_add_u32 s3, s75, s77
  s_add_u32 m0, s3, 0
  s_add_u32 s4, s74, 0
  buffer_load_dwordx4 v8, s[40:43], s4 offen lds
  s_add_u32 m0, s3, 1024
  s_nop 0
  buffer_load_dwordx4 v9, s[40:43], s4 offen lds
  s_add_u32 m0, s3, 8192
  s_add_u32 s4, s74, 2048
  buffer_load_dwordx4 v8, s[40:43], s4 offen lds
  s_add_u32 m0, s3, 9216
  s_nop 0
  buffer_load_dwordx4 v9, s[40:43], s4 offen lds
  s_add_u32 m0, s3, 16384
  s_add_u32 s4, s74, 4096
  buffer_load_dwordx4 v8, s[40:43], s4 offen lds
  s_add_u32 m0, s3, 17408
  s_nop 0
  buffer_load_dwordx4 v9, s[40:43], s4 offen lds
  s_add_u32 s101, s101, 1
  s_sub_u32 s73, s101, s100
  s_lshl_b32 s73, s73, 3
  s_lshr_b32 s73, 0xf0f02, s73
  s_and_b32 s73, s73, 255
  s_add_u32 s73, s73, s101
  s_and_b32 s73, s73, 15
  s_mul_i32 s74, s73, 393216
  s_lshl_b32 s73, s73, 7
  s_add_u32 s75, s75, 43008
  s_cmp_eq_u32 s75, 129024
  s_cselect_b32 s75, 0, s75
  s_buffer_load_dword s84, s[48:51], s98 offset:0
  s_buffer_load_dword s84, s[48:51], s98 offset:64
  s_buffer_load_dword s84, s[48:51], s98 offset:128
  s_buffer_load_dword s84, s[48:51], s98 offset:192
  s_add_u32 s98, s98, 256
  s_waitcnt vmcnt(11)
  s_barrier
  s_sub_u32 s79, s79, 1
  s_cmp_lg_u32 s79, 0
  s_cbranch_scc1 L_attn0_ld1
  s_add_u32 s3, s75, s76
  s_add_u32 m0, s3, 0
  s_nop 0
  buffer_load_dwordx4 v4, s[36:39], s73 offen lds
  s_add_u32 m0, s3, 1024
  s_nop 0
  buffer_load_dwordx4 v5, s[36:39], s73 offen lds
  s_add_u32 m0, s3, 2048
  s_nop 0
  buffer_load_dwordx4 v6, s[36:39], s73 offen lds
  s_add_u32 m0, s3, 3072
  s_nop 0
  buffer_load_dwordx4 v7, s[36:39], s73 offen lds
  s_add_u32 m0, s78, s75
  s_mov_b64 exec, s[14:15]
  buffer_load_dwordx4 v28, s[36:39], s73 offen lds
  s_mov_b64 exec, -1
  s_add_u32 s3, s75, s77
  s_add_u32 m0, s3, 0
  s_add_u32 s4, s74, 0
  buffer_load_dwordx4 v8, s[40:43], s4 offen lds
  s_add_u32 m0, s3, 1024
  s_nop 0
  buffer_load_dwordx4 v9, s[40:43], s4 offen lds
  s_add_u32 m0, s3, 8192
  s_add_u32 s4, s74, 2048
  buffer_load_dwordx4 v8, s[40:43], s4 offen lds
  s_add_u32 m0, s3, 9216
  s_nop 0
  buffer_load_dwordx4 v9, s[40:43], s4 offen lds
  s_add_u32 m0, s3, 16384
  s_add_u32 s4, s74, 4096
  buffer_load_dwordx4 v8, s[40:43], s4 offen lds
  s_add_u32 m0, s3, 17408
  s_nop 0
  buffer_load_dwordx4 v9, s[40:43], s4 offen lds
  s_add_u32 s101, s101, 1
  s_sub_u32 s73, s101, s100
  s_lshl_b32 s73, s73, 3
  s_lshr_b32 s73, 0xf0f02, s73
  s_and_b32 s73, s73, 255
  s_add_u32 s73, s73, s101
  s_and_b32 s73, s73, 15
  s_mul_i32 s74, s73, 393216
  s_lshl_b32 s73, s73, 7
  s_add_u32 s75, s75, 43008
  s_cmp_eq_u32 s75, 129024
  s_cselect_b32 s75, 0, s75
  s_buffer_load_dword s84, s[48:51], s98 offset:0
  s_buffer_load_dword s84, s[48:51], s98 offset:64
  s_buffer_load_dword s84, s[48:51], s98 offset:128
  s_buffer_load_dword s84, s[48:51], s98 offset:192
  s_add_u32 s98, s98, 256
  s_mov_b32 s64, s24
  s_and_b32 s65, s25, 0xffff
  s_mov_b32 s66, 7340032
  s_mov_b32 s67, 0x00020000
  s_min_u32 s3, s2, 223
  s_mul_i32 s4, s3, 4682
  s_lshr_b32 s4, s4, 16
  s_mul_i32 s5, s4, 14
  s_sub_u32 s3, s3, s5
  s_lshl_b32 s3, s3, 2
  s_and_b32 s5, s70, 3
  s_add_u32 s3, s3, s5
  s_mul_i32 s5, s4, 458752
  s_lshl_b32 s8, s3, 7
  s_add_u32 s5, s5, s8
  s_lshl_b32 s9, s4, 14
  s_lshl_b32 s8, s3, 8
  s_add_u32 s94, s9, s8
  v_lshrrev_b32 v2, 3, v1
  v_mul_u32_u24 v2, 7168, v2
  v_and_b32 v3, 7, v1
  v_lshl_add_u32 v2, v3, 4, v2
  buffer_load_dwordx4 v[64:67], v2, s[64:67], s5 offen
  s_add_u32 s5, s5, 57344
  buffer_load_dwordx4 v[68:71], v2, s[64:67], s5 offen
  s_add_u32 s5, s5, 57344
  buffer_load_dwordx4 v[72:75], v2, s[64:67], s5 offen
  s_add_u32 s5, s5, 57344
  buffer_load_dwordx4 v[76:79], v2, s[64:67], s5 offen
  s_add_u32 s5, s5, 57344
  buffer_load_dwordx4 v[80:83], v2, s[64:67], s5 offen
  s_add_u32 s5, s5, 57344
  buffer_load_dwordx4 v[84:87], v2, s[64:67], s5 offen
  s_add_u32 s5, s5, 57344
  buffer_load_dwordx4 v[88:91], v2, s[64:67], s5 offen
  s_add_u32 s5, s5, 57344
  buffer_load_dwordx4 v[92:95], v2, s[64:67], s5 offen
  s_mov_b32 s60, s20
  s_and_b32 s61, s21, 0xffff
  s_mov_b32 s62, 2097152
  s_mov_b32 s63, 0x00020000
  s_and_b32 s3, s70, 3
  s_mul_i32 s3, s3, 8
  s_mul_i32 s4, s99, 32
  s_add_u32 s3, s3, s4
  v_lshrrev_b32 v2, 3, v1
  v_add_u32 v2, s3, v2
  v_mul_u32_u24 v2, 2048, v2
  v_and_b32 v3, 7, v1
  v_lshl_add_u32 v2, v3, 8, v2
  s_and_b32 s3, s2, 7
  s_lshr_b32 s3, s3, 2
  s_mul_i32 s3, s3, 128
  buffer_load_dword v96, v2, s[60:63], s3 offen
  s_waitcnt vmcnt(20)
  s_barrier
  s_waitcnt vmcnt(9)
  s_barrier
  s_barrier
  s_barrier
  s_barrier
  s_branch L_attn_ldend
L_attn_ld1:
  s_add_u32 s56, s22, 24379392
  s_addc_u32 s57, s23, 0
  s_and_b32 s57, s57, 0xffff
  s_mov_b32 s58, 262144
  s_mov_b32 s59, 0x00020000
  s_and_b32 s3, s70, 3
  s_lshl2_add_u32 s4, s68, s3
  s_lshl_b32 s4, s4, 8
  v_lshrrev_b32 v2, 4, v1
  v_and_b32 v3, 15, v1
  v_lshl_add_u32 v3, v3, 4, s4
  v_lshl_add_u32 v18, v2, 14, v3
  s_lshl_b32 s4, s68, 5
  s_add_u32 s4, s4, s3
  s_sub_u32 s4, s4, 4
  s_max_i32 s4, s4, 0
  s_lshl_b32 s4, s4, 5
  v_lshrrev_b32 v2, 2, v1
  v_and_b32 v3, 3, v1
  v_lshl_add_u32 v3, v3, 3, s4
  v_lshl_add_u32 v19, v2, 14, v3
  s_mov_b32 s75, 86016
  s_add_u32 s44, s22, 41943040
  s_addc_u32 s45, s23, 0
  s_and_b32 s45, s45, 0xffff
  s_mov_b32 s46, 524288
  s_mov_b32 s47, 0x00020000
  s_lshl4_add_u32 s3, s97, s68
  s_and_b32 s4, s69, 15
  s_lshl4_add_u32 s3, s3, s4
  s_lshl_b32 s3, s3, 7
  s_sub_u32 s3, s3, 32768
  v_lshlrev_b32 v11, 7, v1
  s_cmp_eq_u32 s68, 0
  s_cselect_b32 s4, 15, 31
  v_and_b32 v2, 16, v1
  v_lshl_add_u32 v11, v2, 2, v11
  v_and_b32 v2, s4, v1
  v_lshlrev_b32 v2, 2, v2
  v_mov_b32 v3, 1
  s_mov_b32 s79, 0x100000
  s_cmp_lg_u32 s70, 4
  s_barrier
  s_cbranch_scc1 L_attn_nofl
  s_mov_b32 exec_lo, 0xffffffff
  s_mov_b32 exec_hi, 0
  buffer_store_dword v3, v11, s[44:47], s87 offen sc1
  s_mov_b64 exec, -1
L_attn_nofl:
  s_mov_b32 s5, s3
  s_mov_b32 s88, s73
  s_add_u32 m0, s77, 0
  s_add_u32 s4, s74, 0
  buffer_load_dwordx4 v8, s[40:43], s4 offen lds
  s_add_u32 m0, s77, 1024
  s_nop 0
  buffer_load_dwordx4 v9, s[40:43], s4 offen lds
  s_add_u32 m0, s77, 8192
  s_add_u32 s4, s74, 2048
  buffer_load_dwordx4 v8, s[40:43], s4 offen lds
  s_add_u32 m0, s77, 9216
  s_nop 0
  buffer_load_dwordx4 v9, s[40:43], s4 offen lds
  s_add_u32 m0, s77, 16384
  s_add_u32 s4, s74, 4096
  buffer_load_dwordx4 v8, s[40:43], s4 offen lds
  s_add_u32 m0, s77, 17408
  s_nop 0
  buffer_load_dwordx4 v9, s[40:43], s4 offen lds
  s_add_u32 s101, s101, 1
  s_sub_u32 s73, s101, s100
  s_lshl_b32 s73, s73, 3
  s_lshr_b32 s73, 0xf0f02, s73
  s_and_b32 s73, s73, 255
  s_add_u32 s73, s73, s101
  s_and_b32 s73, s73, 15
  s_mul_i32 s74, s73, 393216
  s_lshl_b32 s73, s73, 7
  s_mov_b32 s89, s73
  s_add_u32 m0, s77, 43008
  s_add_u32 s4, s74, 0
  buffer_load_dwordx4 v8, s[40:43], s4 offen lds
  s_add_u32 m0, s77, 44032
  s_nop 0
  buffer_load_dwordx4 v9, s[40:43], s4 offen lds
  s_add_u32 m0, s77, 51200
  s_add_u32 s4, s74, 2048
  buffer_load_dwordx4 v8, s[40:43], s4 offen lds
  s_add_u32 m0, s77, 52224
  s_nop 0
  buffer_load_dwordx4 v9, s[40:43], s4 offen lds
  s_add_u32 m0, s77, 59392
  s_add_u32 s4, s74, 4096
  buffer_load_dwordx4 v8, s[40:43], s4 offen lds
  s_add_u32 m0, s77, 60416
  s_nop 0
  buffer_load_dwordx4 v9, s[40:43], s4 offen lds
  s_add_u32 s101, s101, 1
  s_sub_u32 s73, s101, s100
  s_lshl_b32 s73, s73, 3
  s_lshr_b32 s73, 0xf0f02, s73
  s_and_b32 s73, s73, 255
  s_add_u32 s73, s73, s101
  s_and_b32 s73, s73, 15
  s_mul_i32 s74, s73, 393216
  s_lshl_b32 s73, s73, 7
  s_mov_b32 s3, s5
  s_cmp_lg_u32 s70, 4
  s_cbranch_scc1 L_attn_dep
L_attn_poll:
  buffer_load_dword v3, v2, s[44:47], s3 offen sc1
  s_sub_u32 s79, s79, 1
  s_cbranch_scc1 L_attn_dep
  s_waitcnt vmcnt(0)
  v_cmp_ne_u32 vcc, 1, v3
  s_cbranch_vccnz L_attn_poll
L_attn_dep:
  s_barrier
  s_add_u32 m0, s76, 0
  s_nop 0
  buffer_load_dwordx4 v4, s[36:39], s88 offen lds
  s_add_u32 m0, s76, 1024
  s_nop 0
  buffer_load_dwordx4 v5, s[36:39], s88 offen lds
  s_add_u32 m0, s76, 2048
  s_nop 0
  buffer_load_dwordx4 v6, s[36:39], s88 offen lds
  s_add_u32 m0, s76, 3072
  s_nop 0
  buffer_load_dwordx4 v7, s[36:39], s88 offen lds
  s_add_u32 m0, s78, 0
  s_mov_b64 exec, s[14:15]
  buffer_load_dwordx4 v28, s[36:39], s88 offen lds
  s_mov_b64 exec, -1
  s_add_u32 m0, s76, 43008
  s_nop 0
  buffer_load_dwordx4 v4, s[36:39], s89 offen lds
  s_add_u32 m0, s76, 44032
  s_nop 0
  buffer_load_dwordx4 v5, s[36:39], s89 offen lds
  s_add_u32 m0, s76, 45056
  s_nop 0
  buffer_load_dwordx4 v6, s[36:39], s89 offen lds
  s_add_u32 m0, s76, 46080
  s_nop 0
  buffer_load_dwordx4 v7, s[36:39], s89 offen lds
  s_add_u32 m0, s78, 43008
  s_mov_b64 exec, s[14:15]
  buffer_load_dwordx4 v28, s[36:39], s89 offen lds
  s_mov_b64 exec, -1
  s_waitcnt vmcnt(5)
  s_barrier
  s_mov_b32 s79, 13
L_attn1_ld1:
  s_add_u32 s3, s75, s76
  s_add_u32 m0, s3, 0
  s_nop 0
  buffer_load_dwordx4 v4, s[36:39], s73 offen lds
  s_add_u32 m0, s3, 1024
  s_nop 0
  buffer_load_dwordx4 v5, s[36:39], s73 offen lds
  s_add_u32 m0, s3, 2048
  s_nop 0
  buffer_load_dwordx4 v6, s[36:39], s73 offen lds
  s_add_u32 m0, s3, 3072
  s_nop 0
  buffer_load_dwordx4 v7, s[36:39], s73 offen lds
  s_add_u32 m0, s78, s75
  s_mov_b64 exec, s[14:15]
  buffer_load_dwordx4 v28, s[36:39], s73 offen lds
  s_mov_b64 exec, -1
  s_add_u32 s3, s75, s77
  s_add_u32 m0, s3, 0
  s_add_u32 s4, s74, 0
  buffer_load_dwordx4 v8, s[40:43], s4 offen lds
  s_add_u32 m0, s3, 1024
  s_nop 0
  buffer_load_dwordx4 v9, s[40:43], s4 offen lds
  s_add_u32 m0, s3, 8192
  s_add_u32 s4, s74, 2048
  buffer_load_dwordx4 v8, s[40:43], s4 offen lds
  s_add_u32 m0, s3, 9216
  s_nop 0
  buffer_load_dwordx4 v9, s[40:43], s4 offen lds
  s_add_u32 m0, s3, 16384
  s_add_u32 s4, s74, 4096
  buffer_load_dwordx4 v8, s[40:43], s4 offen lds
  s_add_u32 m0, s3, 17408
  s_nop 0
  buffer_load_dwordx4 v9, s[40:43], s4 offen lds
  s_add_u32 s101, s101, 1
  s_sub_u32 s73, s101, s100
  s_lshl_b32 s73, s73, 3
  s_lshr_b32 s73, 0xf0f02, s73
  s_and_b32 s73, s73, 255
  s_add_u32 s73, s73, s101
  s_and_b32 s73, s73, 15
  s_mul_i32 s74, s73, 393216
  s_lshl_b32 s73, s73, 7
  s_add_u32 s75, s75, 43008
  s_cmp_eq_u32 s75, 129024
  s_cselect_b32 s75, 0, s75
  s_waitcnt vmcnt(11)
  s_barrier
  s_sub_u32 s79, s79, 1
  s_cmp_lg_u32 s79, 0
  s_cbranch_scc1 L_attn1_ld1
  s_add_u32 s3, s75, s76
  s_add_u32 m0, s3, 0
  s_nop 0
  buffer_load_dwordx4 v4, s[36:39], s73 offen lds
  s_add_u32 m0, s3, 1024
  s_nop 0
  buffer_load_dwordx4 v5, s[36:39], s73 offen lds
  s_add_u32 m0, s3, 2048
  s_nop 0
  buffer_load_dwordx4 v6, s[36:39], s73 offen lds
  s_add_u32 m0, s3, 3072
  s_nop 0
  buffer_load_dwordx4 v7, s[36:39], s73 offen lds
  s_add_u32 m0, s78, s75
  s_mov_b64 exec, s[14:15]
  buffer_load_dwordx4 v28, s[36:39], s73 offen lds
  s_mov_b64 exec, -1
  s_add_u32 s3, s75, s77
  s_add_u32 m0, s3, 0
  s_add_u32 s4, s74, 0
  buffer_load_dwordx4 v8, s[40:43], s4 offen lds
  s_add_u32 m0, s3, 1024
  s_nop 0
  buffer_load_dwordx4 v9, s[40:43], s4 offen lds
  s_add_u32 m0, s3, 8192
  s_add_u32 s4, s74, 2048
  buffer_load_dwordx4 v8, s[40:43], s4 offen lds
  s_add_u32 m0, s3, 9216
  s_nop 0
  buffer_load_dwordx4 v9, s[40:43], s4 offen lds
  s_add_u32 m0, s3, 16384
  s_add_u32 s4, s74, 4096
  buffer_load_dwordx4 v8, s[40:43], s4 offen lds
  s_add_u32 m0, s3, 17408
  s_nop 0
  buffer_load_dwordx4 v9, s[40:43], s4 offen lds
  s_add_u32 s101, s101, 1
  s_sub_u32 s73, s101, s100
  s_lshl_b32 s73, s73, 3
  s_lshr_b32 s73, 0xf0f02, s73
  s_and_b32 s73, s73, 255
  s_add_u32 s73, s73, s101
  s_and_b32 s73, s73, 15
  s_mul_i32 s74, s73, 393216
  s_lshl_b32 s73, s73, 7
  s_add_u32 s75, s75, 43008
  s_cmp_eq_u32 s75, 129024
  s_cselect_b32 s75, 0, s75
  s_mov_b32 s60, s20
  s_and_b32 s61, s21, 0xffff
  s_mov_b32 s62, 2097152
  s_mov_b32 s63, 0x00020000
  s_and_b32 s3, s70, 3
  s_mul_i32 s3, s3, 8
  s_mul_i32 s4, s99, 32
  s_add_u32 s3, s3, s4
  v_lshrrev_b32 v2, 3, v1
  v_add_u32 v2, s3, v2
  v_mul_u32_u24 v2, 2048, v2
  v_and_b32 v3, 7, v1
  v_lshl_add_u32 v2, v3, 8, v2
  s_and_b32 s3, s2, 7
  s_lshr_b32 s3, s3, 2
  s_mul_i32 s3, s3, 128
  buffer_load_dword v96, v2, s[60:63], s3 offen
  s_waitcnt vmcnt(12)
  s_barrier
  buffer_load_dwordx4 v[32:35], v18, s[56:59], 0 offen
  s_mov_b32 s3, 65536
  buffer_load_dwordx4 v[36:39], v18, s[56:59], s3 offen
  s_mov_b32 s3, 131072
  buffer_load_dwordx4 v[40:43], v18, s[56:59], s3 offen
  s_mov_b32 s3, 196608
  buffer_load_dwordx4 v[44:47], v18, s[56:59], s3 offen
  buffer_load_dwordx2 v[48:49], v19, s[56:59], 0 offen
  s_waitcnt vmcnt(6)
  s_barrier
  s_waitcnt vmcnt(0)
  v_pk_add_f32 v[32:33], v[32:33], v[36:37]
  v_pk_add_f32 v[34:35], v[34:35], v[38:39]
  v_pk_add_f32 v[40:41], v[40:41], v[44:45]
  v_pk_add_f32 v[42:43], v[42:43], v[46:47]
  v_pk_add_f32 v[32:33], v[32:33], v[40:41]
  v_pk_add_f32 v[34:35], v[34:35], v[42:43]
  s_nop 1
  v_permlane32_swap_b32 v32, v34
  v_permlane32_swap_b32 v33, v35
  v_pk_add_f32 v[32:33], v[32:33], v[34:35]
  v_mov_b32 v34, v32
  v_mov_b32 v35, v33
  s_nop 0
  v_permlane16_swap_b32 v32, v34
  v_permlane16_swap_b32 v33, v35
  v_pk_add_f32 v[32:33], v[32:33], v[34:35]
  v_mul_f32 v32, 0x3a800000, v32
  v_mul_f32 v33, 0x3a800000, v33
  v_fma_f32 v33, -v32, v32, v33
  v_max_f32 v33, 0, v33
  v_add_f32 v33, 0x3727c5ac, v33
  v_rsq_f32 v33, v33
  s_nop 0
  s_and_b32 s3, s70, 3
  s_lshl_b32 s5, s3, 7
  s_add_u32 s5, s5, 129088
  v_and_b32 v3, 15, v1
  v_lshrrev_b32 v2, 5, v1
  v_lshl_add_u32 v2, v3, 1, v2
  v_lshl_add_u32 v2, v2, 2, s5
  ds_write2_b32 v2, v32, v33 offset0:0 offset1:160
  v_mov_b32 v50, v48
  v_mov_b32 v51, v49
  s_nop 0
  v_permlane32_swap_b32 v48, v50
  v_permlane32_swap_b32 v49, v51
  v_pk_add_f32 v[48:49], v[48:49], v[50:51]
  v_mov_b32 v50, v48
  v_mov_b32 v51, v49
  s_nop 0
  v_permlane16_swap_b32 v48, v50
  v_permlane16_swap_b32 v49, v51
  v_pk_add_f32 v[48:49], v[48:49], v[50:51]
  s_nop 1
  v_add_f32_dpp v48, v48, v48 row_ror:8 row_mask:0xf bank_mask:0xf
  v_add_f32_dpp v49, v49, v49 row_ror:8 row_mask:0xf bank_mask:0xf
  s_nop 1
  v_add_f32_dpp v48, v48, v48 row_ror:4 row_mask:0xf bank_mask:0xf
  v_add_f32_dpp v49, v49, v49 row_ror:4 row_mask:0xf bank_mask:0xf
  v_mul_f32 v48, 0x3a800000, v48
  v_mul_f32 v49, 0x3a800000, v49
  v_fma_f32 v49, -v48, v48, v49
  v_max_f32 v49, 0, v49
  v_add_f32 v49, 0x3727c5ac, v49
  v_rsq_f32 v49, v49
  s_nop 0
  s_lshl_b32 s5, s3, 4
  s_add_u32 s5, s5, 129024
  v_and_b32 v3, 3, v1
  v_lshl_add_u32 v2, v3, 2, s5
  ds_write2_b32 v2, v48, v49 offset0:0 offset1:160
  s_waitcnt lgkmcnt(0)
  s_barrier
  s_barrier
L_attn_ldend:
  s_lshl_b32 s87, s97, 15
  s_lshl_b32 s4, s68, 11
  s_add_u32 s87, s87, s4
  s_lshl_b32 s4, s69, 2
  s_add_u32 s87, s87, s4
  s_add_u32 s97, s97, 1
  s_branch L_wo_body
L_attn_end:
  s_endpgm
L_attn_compute:
  s_and_b32 s71, s70, 1
  s_lshr_b32 s72, s70, 1
  v_and_b32 v3, 31, v1
  v_lshlrev_b32 v3, 2, v3
  v_add_u32 v3, 40960, v3
  v_mov_b32 v236, 0x3f803f80
  v_mov_b32 v237, 0x3f803f80
  v_mov_b32 v238, 0x3f803f80
  v_mov_b32 v239, 0x3f803f80
  ds_write_b32 v3, v236
  ds_write_b32 v3, v236 offset:43008
  v_add_u32 v3, 86016, v3
  ds_write_b32 v3, v236
  v_and_b32 v3, 15, v1
  v_lshrrev_b32 v2, 4, v1
  v_lshrrev_b32 v33, 1, v3
  s_lshl_b32 s8, s71, 13
  v_xor_b32 v4, v2, v33
  v_lshlrev_b32 v4, 4, v4
  v_lshl_add_u32 v4, v3, 7, v4
  v_add_u32 v8, 40960, v4
  v_add_u32 v4, s8, v4
  v_add_u32 v5, 4, v2
  v_xor_b32 v5, v5, v33
  v_lshlrev_b32 v5, 4, v5
  v_lshl_add_u32 v5, v3, 7, v5
  v_add_u32 v9, 40960, v5
  v_add_u32 v5, s8, v5
  v_bfe_u32 v34, v1, 2, 2
  v_lshl_add_u32 v34, v2, 3, v34
  v_lshlrev_b32 v34, 7, v34
  v_and_b32 v33, 3, v1
  v_lshl_add_u32 v34, v33, 3, v34
  v_bfe_u32 v33, v1, 3, 2
  v_lshl_add_u32 v34, v33, 5, v34
  v_and_b32 v35, 1, v2
  v_xor_b32 v35, s71, v35
  s_lshl_b32 s8, s70, 5
  v_xor_b32 v34, s8, v34
  v_add_u32 v6, 16384, v34
  v_xor_b32 v7, 32, v6
  s_lshl_b32 s8, s68, 7
  s_lshl_b32 s9, s71, 6
  s_add_u32 s8, s8, s9
  s_add_u32 s10, s8, s69
  s_lshl_b32 s10, s10, 11
  s_lshl_b32 s11, s72, 10
  s_add_u32 s10, s10, s11
  v_lshl_add_u32 v33, v3, 4, s10
  v_lshl_add_u32 v33, v35, 9, v33
  v_lshrrev_b32 v34, 1, v2
  v_lshl_add_u32 v31, v34, 8, v33
  s_mul_i32 s10, s72, 14336
  s_add_u32 s10, s10, 1024
  s_lshl_b32 s11, s71, 10
  s_add_u32 s4, s10, s11
  s_sub_u32 s5, s10, s11
  s_mul_i32 s6, s71, 6144
  v_lshl_add_u32 v16, v1, 4, s4
  v_add_u32 v17, s6, v16
  v_lshl_add_u32 v18, v1, 4, s5
  v_add_u32 v18, s6, v18
  v_lshl_add_u32 v19, v2, 8, s4
  v_lshl_add_u32 v20, v2, 8, s5
  v_lshl_add_u32 v21, v3, 4, s4
  v_lshl_add_u32 v22, v3, 4, s5
  s_lshl_b32 s10, s71, 8
  s_add_u32 s10, s10, 129024
  v_lshl_add_u32 v23, v3, 2, s10
  v_lshl_add_u32 v24, v2, 4, s10
  v_and_b32 v33, 1, v3
  v_cmp_eq_u32 s[48:49], 1, v33
  v_lshl_add_u32 v34, v2, 2, v33
  v_add_u32 v35, 2, v34
  v_cmp_gt_u32 s[50:51], v34, v3
  v_cmp_gt_u32 s[52:53], v35, v3
  v_mov_b32 v36, 0xffff
  v_mov_b32 v37, 0xffff0000
  v_cndmask_b32 v36, v36, v37, s[48:49]
  s_add_u32 s10, s10, 704
  v_lshl_add_u32 v34, v34, 2, s10
  v_lshl_add_u32 v35, v35, 2, s10
  v_subrev_u32 v38, 64, v34
  v_subrev_u32 v39, 64, v35
  v_cndmask_b32 v25, v34, v38, s[50:51]
  v_cndmask_b32 v26, v35, v39, s[52:53]
  v_cndmask_b32 v27, 0, v36, s[50:51]
  v_cndmask_b32 v29, 0, v36, s[52:53]
  v_xor_b32 v28, v27, v36
  v_xor_b32 v30, v29, v36
  s_cmp_eq_u32 s8, 0
  s_cselect_b64 s[54:55], s[50:51], 0
  s_cselect_b64 s[14:15], s[52:53], 0
  v_mov_b32 v120, 0
  v_mov_b32 v121, 0
  v_mov_b32 v122, 0
  v_mov_b32 v123, 0
  v_mov_b32 v124, 0
  v_mov_b32 v125, 0
  v_mov_b32 v126, 0
  v_mov_b32 v127, 0
  v_mov_b32 v128, 0
  v_mov_b32 v129, 0
  v_mov_b32 v130, 0
  v_mov_b32 v131, 0
  v_mov_b32 v132, 0
  v_mov_b32 v133, 0
  v_mov_b32 v134, 0
  v_mov_b32 v135, 0
  v_mov_b32 v136, 0
  v_mov_b32 v137, 0
  v_mov_b32 v138, 0
  v_mov_b32 v139, 0
  v_mov_b32 v140, 0
  v_mov_b32 v141, 0
  v_mov_b32 v142, 0
  v_mov_b32 v143, 0
  v_mov_b32 v144, 0
  v_mov_b32 v145, 0
  v_mov_b32 v146, 0
  v_mov_b32 v147, 0
  v_mov_b32 v148, 0
  v_mov_b32 v149, 0
  v_mov_b32 v150, 0
  v_mov_b32 v151, 0
  v_mov_b32 v152, 0
  v_mov_b32 v153, 0
  v_mov_b32 v154, 0
  v_mov_b32 v155, 0
  v_mov_b32 v156, 0
  v_mov_b32 v157, 0
  v_mov_b32 v158, 0
  v_mov_b32 v159, 0
  v_mov_b32 v160, 0
  v_mov_b32 v161, 0
  v_mov_b32 v162, 0
  v_mov_b32 v163, 0
  v_mov_b32 v164, 0
  v_mov_b32 v165, 0
  v_mov_b32 v166, 0
  v_mov_b32 v167, 0
  v_mov_b32 v168, 0
  v_mov_b32 v169, 0
  v_mov_b32 v170, 0
  v_mov_b32 v171, 0
  v_mov_b32 v172, 0
  v_mov_b32 v173, 0
  v_mov_b32 v174, 0
  v_mov_b32 v175, 0
  v_mov_b32 v176, 0
  v_mov_b32 v177, 0
  v_mov_b32 v178, 0
  v_mov_b32 v179, 0
  v_mov_b32 v180, 0
  v_mov_b32 v181, 0
  v_mov_b32 v182, 0
  v_mov_b32 v183, 0
  v_mov_b32 v184, 0
  v_mov_b32 v185, 0
  v_mov_b32 v186, 0
  v_mov_b32 v187, 0
  v_mov_b32 v188, 0
  v_mov_b32 v189, 0
  v_mov_b32 v190, 0
  v_mov_b32 v191, 0
  v_mov_b32 v192, 0
  v_mov_b32 v193, 0
  v_mov_b32 v194, 0
  v_mov_b32 v195, 0
  v_mov_b32 v196, 0
  v_mov_b32 v197, 0
  v_mov_b32 v198, 0
  v_mov_b32 v199, 0
  v_mov_b32 v200, 0
  v_mov_b32 v201, 0
  v_mov_b32 v202, 0
  v_mov_b32 v203, 0
  v_mov_b32 v204, 0
  v_mov_b32 v205, 0
  v_mov_b32 v206, 0
  v_mov_b32 v207, 0
  v_mov_b32 v208, 0
  v_mov_b32 v209, 0
  v_mov_b32 v210, 0
  v_mov_b32 v211, 0
  v_mov_b32 v212, 0
  v_mov_b32 v213, 0
  v_mov_b32 v214, 0
  v_mov_b32 v215, 0
  v_mov_b32 v216, 0
  v_mov_b32 v217, 0
  v_mov_b32 v218, 0
  v_mov_b32 v219, 0
  v_mov_b32 v220, 0
  v_mov_b32 v221, 0
  v_mov_b32 v222, 0
  v_mov_b32 v223, 0
  v_mov_b32 v224, 0
  v_mov_b32 v225, 0
  v_mov_b32 v226, 0
  v_mov_b32 v227, 0
  v_mov_b32 v228, 0
  v_mov_b32 v229, 0
  v_mov_b32 v230, 0
  v_mov_b32 v231, 0
  v_mov_b32 v232, 0
  v_mov_b32 v233, 0
  v_mov_b32 v234, 0
  v_mov_b32 v235, 0
  s_waitcnt lgkmcnt(0)
  s_mov_b32 s44, s34
  s_and_b32 s45, s35, 0xffff
  s_mov_b32 s46, 4194304
  s_mov_b32 s47, 0x00020000
  s_load_dwordx2 s[64:65], s[0:1], 72
  s_or_b32 s3, s96, s70
  s_cbranch_scc1 L_clr_skip0
  s_add_u32 s60, s22, 41943040
  s_addc_u32 s61, s23, 0
  s_and_b32 s61, s61, 0xffff
  s_mov_b32 s62, 524288
  s_mov_b32 s63, 0x00020000
  s_lshl_b32 s3, s2, 11
  v_lshlrev_b32 v2, 4, v1
  buffer_store_dwordx4 v[128:131], v2, s[60:63], s3 offen sc1
  buffer_store_dwordx4 v[128:131], v2, s[60:63], s3 offen offset:1024 sc1
L_clr_skip0:
  s_cmp_lg_u32 s96, 0
  s_cbranch_scc1 L_pfc1_skip
  s_getpc_b64 s[4:5]
L_pfc1:
  s_lshl_b32 s3, s99, 2
  s_add_u32 s3, s3, s70
  s_mul_i32 s3, s3, 256
  s_min_u32 s3, s3, L_w2_c1-L_attn_c0-256
  s_add_i32 s3, s3, L_attn_c0-L_pfc1
  s_ashr_i32 s6, s3, 31
  s_add_u32 s4, s4, s3
  s_addc_u32 s5, s5, s6
  s_load_dword s36, s[4:5], 0
  s_load_dword s37, s[4:5], 64
  s_load_dword s38, s[4:5], 128
  s_load_dword s39, s[4:5], 192
L_pfc1_skip:
  s_mov_b32 s75, 0
  v_add_u32_e64 v10, s75, v4
  v_add_u32_e64 v11, s75, v5
  v_add_u32_e64 v12, s75, v6
  v_add_u32_e64 v13, s75, v7
  v_add_u32_e64 v14, s75, v8
  v_add_u32_e64 v15, s75, v9
  s_add_u32 s75, s75, 43008
  s_cmp_eq_u32 s75, 129024
  s_cselect_b32 s75, 0, s75
  s_mov_b32 s79, 16
  s_cmp_eq_u32 s96, 0
  s_cbranch_scc1 L_attn_nog
  s_barrier
L_attn_nog:
  s_barrier
  ds_read_b128 v[32:35], v10 offset:0
  ds_read_b128 v[36:39], v10 offset:2048
  ds_read_b128 v[40:43], v10 offset:4096
  ds_read_b128 v[44:47], v10 offset:6144
  ds_read_b128 v[48:51], v14
  ds_read_b64_tr_b16 v[52:53], v12 offset:0
  ds_read_b64_tr_b16 v[54:55], v12 offset:512
  ds_read_b64_tr_b16 v[56:57], v13 offset:0
  ds_read_b64_tr_b16 v[58:59], v13 offset:512
  ds_read_b64_tr_b16 v[60:61], v12 offset:8192
  ds_read_b64_tr_b16 v[62:63], v12 offset:8704
  ds_read_b64_tr_b16 v[64:65], v13 offset:8192
  ds_read_b64_tr_b16 v[66:67], v13 offset:8704
  ds_read_b64_tr_b16 v[68:69], v12 offset:16384
  ds_read_b64_tr_b16 v[70:71], v12 offset:16896
  ds_read_b64_tr_b16 v[72:73], v13 offset:16384
  ds_read_b64_tr_b16 v[74:75], v13 offset:16896
  s_waitcnt lgkmcnt(0)
  s_cmp_lg_u32 s96, 0
  s_cbranch_scc1 L_attn_loop
  v_mov_b32 v240, 0
  v_mov_b32 v241, 0
  v_mov_b32 v242, 0
  v_mov_b32 v243, 0
  v_mov_b32 v244, 0
  v_mov_b32 v245, 0
  v_mov_b32 v246, 0
  v_mov_b32 v247, 0
  v_mov_b32 v248, 0
  v_mov_b32 v249, 0
  v_mov_b32 v250, 0
  v_mov_b32 v251, 0
  v_mov_b32 v252, 0
  v_mov_b32 v253, 0
  v_mov_b32 v254, 0
  v_mov_b32 v255, 0
  s_cmp_lg_u32 s72, 0
  s_cbranch_scc1 L_attn_loopb
  s_or_b32 s3, s96, s70
  s_cbranch_scc1 L_clr_skip1
  v_mov_b32 v3, 1
  s_and_b32 s65, s65, 0xffff
  s_mov_b32 s66, 256
  s_mov_b32 s67, 0x00020000
  s_mov_b64 exec, 1
  s_waitcnt vmcnt(0)
  buffer_store_byte v3, off, s[64:67], s2 sc1
  s_mov_b64 exec, -1
L_clr_skip1:
.p2align 3
L_attn_loopa:
  v_mfma_f32_16x16x32_bf16 v[240:243], v[236:239], v[32:35], v[240:243]
  ds_read_b128 v[76:79], v11 offset:0
  v_mfma_f32_16x16x32_bf16 v[244:247], v[32:35], v[32:35], v[244:247]
  ds_read_b128 v[80:83], v11 offset:2048
  v_mfma_f32_16x16x32_bf16 v[248:251], v[236:239], v[36:39], v[248:251]
  ds_read_b128 v[84:87], v11 offset:4096
  v_mfma_f32_16x16x32_bf16 v[252:255], v[36:39], v[36:39], v[252:255]
  ds_read_b128 v[88:91], v11 offset:6144
  v_mfma_f32_16x16x32_bf16 v[120:123], v[236:239], v[48:51], v[120:123]
  ds_read_b128 v[92:95], v15
  v_mfma_f32_16x16x32_bf16 v[124:127], v[48:51], v[48:51], v[124:127]
  ds_read_b64_tr_b16 v[96:97], v12 offset:4096
  v_mfma_f32_16x16x32_bf16 v[128:131], v[52:55], v[32:35], v[128:131]
  ds_read_b64_tr_b16 v[98:99], v12 offset:4608
  v_mfma_f32_16x16x32_bf16 v[132:135], v[52:55], v[36:39], v[132:135]
  ds_read_b64_tr_b16 v[100:101], v13 offset:4096
  v_mfma_f32_16x16x32_bf16 v[136:139], v[52:55], v[40:43], v[136:139]
  ds_read_b64_tr_b16 v[102:103], v13 offset:4608
  v_mfma_f32_16x16x32_bf16 v[140:143], v[52:55], v[44:47], v[140:143]
  ds_read_b64_tr_b16 v[104:105], v12 offset:12288
  v_mfma_f32_16x16x32_bf16 v[224:227], v[52:55], v[48:51], v[224:227]
  ds_read_b64_tr_b16 v[106:107], v12 offset:12800
  v_mfma_f32_16x16x32_bf16 v[156:159], v[56:59], v[44:47], v[156:159]
  ds_read_b64_tr_b16 v[108:109], v13 offset:12288
  v_mfma_f32_16x16x32_bf16 v[152:155], v[56:59], v[40:43], v[152:155]
  ds_read_b64_tr_b16 v[110:111], v13 offset:12800
  v_mfma_f32_16x16x32_bf16 v[148:151], v[56:59], v[36:39], v[148:151]
  ds_read_b64_tr_b16 v[112:113], v12 offset:20480
  v_mfma_f32_16x16x32_bf16 v[144:147], v[56:59], v[32:35], v[144:147]
  ds_read_b64_tr_b16 v[114:115], v12 offset:20992
  v_mfma_f32_16x16x32_bf16 v[160:163], v[60:63], v[32:35], v[160:163]
  ds_read_b64_tr_b16 v[116:117], v13 offset:20480
  v_mfma_f32_16x16x32_bf16 v[164:167], v[60:63], v[36:39], v[164:167]
  ds_read_b64_tr_b16 v[118:119], v13 offset:20992
  v_mfma_f32_16x16x32_bf16 v[168:171], v[60:63], v[40:43], v[168:171]
  v_add_u32_e64 v10, s75, v4
  v_mfma_f32_16x16x32_bf16 v[172:175], v[60:63], v[44:47], v[172:175]
  v_add_u32_e64 v11, s75, v5
  v_mfma_f32_16x16x32_bf16 v[228:231], v[60:63], v[48:51], v[228:231]
  v_add_u32_e64 v12, s75, v6
  v_mfma_f32_16x16x32_bf16 v[188:191], v[64:67], v[44:47], v[188:191]
  v_add_u32_e64 v13, s75, v7
  v_mfma_f32_16x16x32_bf16 v[184:187], v[64:67], v[40:43], v[184:187]
  v_add_u32_e64 v14, s75, v8
  v_mfma_f32_16x16x32_bf16 v[180:183], v[64:67], v[36:39], v[180:183]
  v_add_u32_e64 v15, s75, v9
  v_mfma_f32_16x16x32_bf16 v[176:179], v[64:67], v[32:35], v[176:179]
  s_add_u32 s75, s75, 43008
  v_mfma_f32_16x16x32_bf16 v[192:195], v[32:35], v[68:71], v[192:195]
  s_cmp_eq_u32 s75, 129024
  v_mfma_f32_16x16x32_bf16 v[196:199], v[36:39], v[68:71], v[196:199]
  s_cselect_b32 s75, 0, s75
  s_sub_u32 s79, s79, 1
  v_mfma_f32_16x16x32_bf16 v[200:203], v[40:43], v[68:71], v[200:203]
  v_mfma_f32_16x16x32_bf16 v[204:207], v[44:47], v[68:71], v[204:207]
  v_mfma_f32_16x16x32_bf16 v[232:235], v[48:51], v[68:71], v[232:235]
  v_mfma_f32_16x16x32_bf16 v[220:223], v[44:47], v[72:75], v[220:223]
  v_mfma_f32_16x16x32_bf16 v[216:219], v[40:43], v[72:75], v[216:219]
  v_mfma_f32_16x16x32_bf16 v[212:215], v[36:39], v[72:75], v[212:215]
  v_mfma_f32_16x16x32_bf16 v[208:211], v[32:35], v[72:75], v[208:211]
  s_waitcnt lgkmcnt(0)
  s_barrier
  v_mfma_f32_16x16x32_bf16 v[240:243], v[236:239], v[76:79], v[240:243]
  ds_read_b128 v[32:35], v10 offset:0
  v_mfma_f32_16x16x32_bf16 v[244:247], v[76:79], v[76:79], v[244:247]
  ds_read_b128 v[36:39], v10 offset:2048
  v_mfma_f32_16x16x32_bf16 v[248:251], v[236:239], v[80:83], v[248:251]
  ds_read_b128 v[40:43], v10 offset:4096
  v_mfma_f32_16x16x32_bf16 v[252:255], v[80:83], v[80:83], v[252:255]
  ds_read_b128 v[44:47], v10 offset:6144
  v_mfma_f32_16x16x32_bf16 v[120:123], v[236:239], v[92:95], v[120:123]
  ds_read_b128 v[48:51], v14
  v_mfma_f32_16x16x32_bf16 v[124:127], v[92:95], v[92:95], v[124:127]
  ds_read_b64_tr_b16 v[52:53], v12 offset:0
  v_mfma_f32_16x16x32_bf16 v[128:131], v[96:99], v[76:79], v[128:131]
  ds_read_b64_tr_b16 v[54:55], v12 offset:512
  v_mfma_f32_16x16x32_bf16 v[132:135], v[96:99], v[80:83], v[132:135]
  ds_read_b64_tr_b16 v[56:57], v13 offset:0
  v_mfma_f32_16x16x32_bf16 v[136:139], v[96:99], v[84:87], v[136:139]
  ds_read_b64_tr_b16 v[58:59], v13 offset:512
  v_mfma_f32_16x16x32_bf16 v[140:143], v[96:99], v[88:91], v[140:143]
  ds_read_b64_tr_b16 v[60:61], v12 offset:8192
  v_mfma_f32_16x16x32_bf16 v[224:227], v[96:99], v[92:95], v[224:227]
  ds_read_b64_tr_b16 v[62:63], v12 offset:8704
  v_mfma_f32_16x16x32_bf16 v[156:159], v[100:103], v[88:91], v[156:159]
  ds_read_b64_tr_b16 v[64:65], v13 offset:8192
  v_mfma_f32_16x16x32_bf16 v[152:155], v[100:103], v[84:87], v[152:155]
  ds_read_b64_tr_b16 v[66:67], v13 offset:8704
  v_mfma_f32_16x16x32_bf16 v[148:151], v[100:103], v[80:83], v[148:151]
  ds_read_b64_tr_b16 v[68:69], v12 offset:16384
  v_mfma_f32_16x16x32_bf16 v[144:147], v[100:103], v[76:79], v[144:147]
  ds_read_b64_tr_b16 v[70:71], v12 offset:16896
  v_mfma_f32_16x16x32_bf16 v[160:163], v[104:107], v[76:79], v[160:163]
  ds_read_b64_tr_b16 v[72:73], v13 offset:16384
  v_mfma_f32_16x16x32_bf16 v[164:167], v[104:107], v[80:83], v[164:167]
  ds_read_b64_tr_b16 v[74:75], v13 offset:16896
  v_mfma_f32_16x16x32_bf16 v[168:171], v[104:107], v[84:87], v[168:171]
  s_cmp_lg_u32 s79, 0
  s_nop 0
  v_mfma_f32_16x16x32_bf16 v[172:175], v[104:107], v[88:91], v[172:175]
  v_mfma_f32_16x16x32_bf16 v[228:231], v[104:107], v[92:95], v[228:231]
  v_mfma_f32_16x16x32_bf16 v[188:191], v[108:111], v[88:91], v[188:191]
  v_mfma_f32_16x16x32_bf16 v[184:187], v[108:111], v[84:87], v[184:187]
  v_mfma_f32_16x16x32_bf16 v[180:183], v[108:111], v[80:83], v[180:183]
  v_mfma_f32_16x16x32_bf16 v[176:179], v[108:111], v[76:79], v[176:179]
  v_mfma_f32_16x16x32_bf16 v[192:195], v[76:79], v[112:115], v[192:195]
  v_mfma_f32_16x16x32_bf16 v[196:199], v[80:83], v[112:115], v[196:199]
  v_mfma_f32_16x16x32_bf16 v[200:203], v[84:87], v[112:115], v[200:203]
  v_mfma_f32_16x16x32_bf16 v[204:207], v[88:91], v[112:115], v[204:207]
  v_mfma_f32_16x16x32_bf16 v[232:235], v[92:95], v[112:115], v[232:235]
  v_mfma_f32_16x16x32_bf16 v[220:223], v[88:91], v[116:119], v[220:223]
  v_mfma_f32_16x16x32_bf16 v[216:219], v[84:87], v[116:119], v[216:219]
  v_mfma_f32_16x16x32_bf16 v[212:215], v[80:83], v[116:119], v[212:215]
  v_mfma_f32_16x16x32_bf16 v[208:211], v[76:79], v[116:119], v[208:211]
  s_waitcnt lgkmcnt(0)
  s_cbranch_scc1 L_attn_loopa
  s_branch L_attn_post
.p2align 3
L_attn_loopb:
  v_mfma_f32_16x16x32_bf16 v[240:243], v[236:239], v[40:43], v[240:243]
  ds_read_b128 v[76:79], v11 offset:0
  v_mfma_f32_16x16x32_bf16 v[244:247], v[40:43], v[40:43], v[244:247]
  ds_read_b128 v[80:83], v11 offset:2048
  v_mfma_f32_16x16x32_bf16 v[248:251], v[236:239], v[44:47], v[248:251]
  ds_read_b128 v[84:87], v11 offset:4096
  v_mfma_f32_16x16x32_bf16 v[252:255], v[44:47], v[44:47], v[252:255]
  ds_read_b128 v[88:91], v11 offset:6144
  v_mfma_f32_16x16x32_bf16 v[128:131], v[52:55], v[32:35], v[128:131]
  ds_read_b128 v[92:95], v15
  v_mfma_f32_16x16x32_bf16 v[132:135], v[52:55], v[36:39], v[132:135]
  ds_read_b64_tr_b16 v[96:97], v12 offset:4096
  v_mfma_f32_16x16x32_bf16 v[136:139], v[52:55], v[40:43], v[136:139]
  ds_read_b64_tr_b16 v[98:99], v12 offset:4608
  v_mfma_f32_16x16x32_bf16 v[140:143], v[52:55], v[44:47], v[140:143]
  ds_read_b64_tr_b16 v[100:101], v13 offset:4096
  v_mfma_f32_16x16x32_bf16 v[224:227], v[52:55], v[48:51], v[224:227]
  ds_read_b64_tr_b16 v[102:103], v13 offset:4608
  v_mfma_f32_16x16x32_bf16 v[156:159], v[56:59], v[44:47], v[156:159]
  ds_read_b64_tr_b16 v[104:105], v12 offset:12288
  v_mfma_f32_16x16x32_bf16 v[152:155], v[56:59], v[40:43], v[152:155]
  ds_read_b64_tr_b16 v[106:107], v12 offset:12800
  v_mfma_f32_16x16x32_bf16 v[148:151], v[56:59], v[36:39], v[148:151]
  ds_read_b64_tr_b16 v[108:109], v13 offset:12288
  v_mfma_f32_16x16x32_bf16 v[144:147], v[56:59], v[32:35], v[144:147]
  ds_read_b64_tr_b16 v[110:111], v13 offset:12800
  v_mfma_f32_16x16x32_bf16 v[160:163], v[60:63], v[32:35], v[160:163]
  ds_read_b64_tr_b16 v[112:113], v12 offset:20480
  v_mfma_f32_16x16x32_bf16 v[164:167], v[60:63], v[36:39], v[164:167]
  ds_read_b64_tr_b16 v[114:115], v12 offset:20992
  v_mfma_f32_16x16x32_bf16 v[168:171], v[60:63], v[40:43], v[168:171]
  ds_read_b64_tr_b16 v[116:117], v13 offset:20480
  v_mfma_f32_16x16x32_bf16 v[172:175], v[60:63], v[44:47], v[172:175]
  ds_read_b64_tr_b16 v[118:119], v13 offset:20992
  v_mfma_f32_16x16x32_bf16 v[228:231], v[60:63], v[48:51], v[228:231]
  v_add_u32_e64 v10, s75, v4
  v_mfma_f32_16x16x32_bf16 v[188:191], v[64:67], v[44:47], v[188:191]
  v_add_u32_e64 v11, s75, v5
  v_mfma_f32_16x16x32_bf16 v[184:187], v[64:67], v[40:43], v[184:187]
  v_add_u32_e64 v12, s75, v6
  v_mfma_f32_16x16x32_bf16 v[180:183], v[64:67], v[36:39], v[180:183]
  v_add_u32_e64 v13, s75, v7
  v_mfma_f32_16x16x32_bf16 v[176:179], v[64:67], v[32:35], v[176:179]
  v_add_u32_e64 v14, s75, v8
  v_mfma_f32_16x16x32_bf16 v[192:195], v[32:35], v[68:71], v[192:195]
  v_add_u32_e64 v15, s75, v9
  v_mfma_f32_16x16x32_bf16 v[196:199], v[36:39], v[68:71], v[196:199]
  s_add_u32 s75, s75, 43008
  v_mfma_f32_16x16x32_bf16 v[200:203], v[40:43], v[68:71], v[200:203]
  s_cmp_eq_u32 s75, 129024
  v_mfma_f32_16x16x32_bf16 v[204:207], v[44:47], v[68:71], v[204:207]
  s_cselect_b32 s75, 0, s75
  s_sub_u32 s79, s79, 1
  v_mfma_f32_16x16x32_bf16 v[232:235], v[48:51], v[68:71], v[232:235]
  v_mfma_f32_16x16x32_bf16 v[220:223], v[44:47], v[72:75], v[220:223]
  v_mfma_f32_16x16x32_bf16 v[216:219], v[40:43], v[72:75], v[216:219]
  v_mfma_f32_16x16x32_bf16 v[212:215], v[36:39], v[72:75], v[212:215]
  v_mfma_f32_16x16x32_bf16 v[208:211], v[32:35], v[72:75], v[208:211]
  s_waitcnt lgkmcnt(0)
  s_barrier
  v_mfma_f32_16x16x32_bf16 v[240:243], v[236:239], v[84:87], v[240:243]
  ds_read_b128 v[32:35], v10 offset:0
  v_mfma_f32_16x16x32_bf16 v[244:247], v[84:87], v[84:87], v[244:247]
  ds_read_b128 v[36:39], v10 offset:2048
  v_mfma_f32_16x16x32_bf16 v[248:251], v[236:239], v[88:91], v[248:251]
  ds_read_b128 v[40:43], v10 offset:4096
  v_mfma_f32_16x16x32_bf16 v[252:255], v[88:91], v[88:91], v[252:255]
  ds_read_b128 v[44:47], v10 offset:6144
  v_mfma_f32_16x16x32_bf16 v[128:131], v[96:99], v[76:79], v[128:131]
  ds_read_b128 v[48:51], v14
  v_mfma_f32_16x16x32_bf16 v[132:135], v[96:99], v[80:83], v[132:135]
  ds_read_b64_tr_b16 v[52:53], v12 offset:0
  v_mfma_f32_16x16x32_bf16 v[136:139], v[96:99], v[84:87], v[136:139]
  ds_read_b64_tr_b16 v[54:55], v12 offset:512
  v_mfma_f32_16x16x32_bf16 v[140:143], v[96:99], v[88:91], v[140:143]
  ds_read_b64_tr_b16 v[56:57], v13 offset:0
  v_mfma_f32_16x16x32_bf16 v[224:227], v[96:99], v[92:95], v[224:227]
  ds_read_b64_tr_b16 v[58:59], v13 offset:512
  v_mfma_f32_16x16x32_bf16 v[156:159], v[100:103], v[88:91], v[156:159]
  ds_read_b64_tr_b16 v[60:61], v12 offset:8192
  v_mfma_f32_16x16x32_bf16 v[152:155], v[100:103], v[84:87], v[152:155]
  ds_read_b64_tr_b16 v[62:63], v12 offset:8704
  v_mfma_f32_16x16x32_bf16 v[148:151], v[100:103], v[80:83], v[148:151]
  ds_read_b64_tr_b16 v[64:65], v13 offset:8192
  v_mfma_f32_16x16x32_bf16 v[144:147], v[100:103], v[76:79], v[144:147]
  ds_read_b64_tr_b16 v[66:67], v13 offset:8704
  v_mfma_f32_16x16x32_bf16 v[160:163], v[104:107], v[76:79], v[160:163]
  ds_read_b64_tr_b16 v[68:69], v12 offset:16384
  v_mfma_f32_16x16x32_bf16 v[164:167], v[104:107], v[80:83], v[164:167]
  ds_read_b64_tr_b16 v[70:71], v12 offset:16896
  v_mfma_f32_16x16x32_bf16 v[168:171], v[104:107], v[84:87], v[168:171]
  ds_read_b64_tr_b16 v[72:73], v13 offset:16384
  v_mfma_f32_16x16x32_bf16 v[172:175], v[104:107], v[88:91], v[172:175]
  ds_read_b64_tr_b16 v[74:75], v13 offset:16896
  v_mfma_f32_16x16x32_bf16 v[228:231], v[104:107], v[92:95], v[228:231]
  s_cmp_lg_u32 s79, 0
  s_nop 0
  v_mfma_f32_16x16x32_bf16 v[188:191], v[108:111], v[88:91], v[188:191]
  v_mfma_f32_16x16x32_bf16 v[184:187], v[108:111], v[84:87], v[184:187]
  v_mfma_f32_16x16x32_bf16 v[180:183], v[108:111], v[80:83], v[180:183]
  v_mfma_f32_16x16x32_bf16 v[176:179], v[108:111], v[76:79], v[176:179]
  v_mfma_f32_16x16x32_bf16 v[192:195], v[76:79], v[112:115], v[192:195]
  v_mfma_f32_16x16x32_bf16 v[196:199], v[80:83], v[112:115], v[196:199]
  v_mfma_f32_16x16x32_bf16 v[200:203], v[84:87], v[112:115], v[200:203]
  v_mfma_f32_16x16x32_bf16 v[204:207], v[88:91], v[112:115], v[204:207]
  v_mfma_f32_16x16x32_bf16 v[232:235], v[92:95], v[112:115], v[232:235]
  v_mfma_f32_16x16x32_bf16 v[220:223], v[88:91], v[116:119], v[220:223]
  v_mfma_f32_16x16x32_bf16 v[216:219], v[84:87], v[116:119], v[216:219]
  v_mfma_f32_16x16x32_bf16 v[212:215], v[80:83], v[116:119], v[212:215]
  v_mfma_f32_16x16x32_bf16 v[208:211], v[76:79], v[116:119], v[208:211]
  s_waitcnt lgkmcnt(0)
  s_cbranch_scc1 L_attn_loopb
L_attn_post:
  v_and_b32 v32, 3, v1
  v_cmp_eq_u32 s[4:5], 1, v32
  v_cmp_eq_u32 s[6:7], 2, v32
  v_cmp_eq_u32 s[8:9], 3, v32
  v_bfe_u32 v33, v1, 2, 2
  v_lshrrev_b32 v34, 4, v1
  v_cmp_eq_u32 s[10:11], v33, v34
  s_lshl_b32 s3, s72, 7
  v_add_u32 v35, s3, v23
  v_and_b32 v36, 15, v1
  s_cmp_eq_u32 s70, 0
  s_cselect_b32 s3, 0, 576
  s_add_u32 s3, s3, 129024
  v_lshl_add_u32 v36, v36, 2, s3
  v_cndmask_b32 v241, v244, v245, s[4:5]
  v_cndmask_b32 v249, v252, v253, s[4:5]
  v_cndmask_b32 v121, v124, v125, s[4:5]
  v_cndmask_b32 v241, v241, v246, s[6:7]
  v_cndmask_b32 v249, v249, v254, s[6:7]
  v_cndmask_b32 v121, v121, v126, s[6:7]
  v_cndmask_b32 v241, v241, v247, s[8:9]
  v_cndmask_b32 v249, v249, v255, s[8:9]
  v_cndmask_b32 v121, v121, v127, s[8:9]
  v_mul_f32 v240, 0x3a800000, v240
  v_mul_f32 v241, 0x3a800000, v241
  v_fma_f32 v241, -v240, v240, v241
  v_max_f32 v241, 0, v241
  v_add_f32 v241, 0x3727c5ac, v241
  v_rsq_f32 v241, v241
  s_nop 0
  v_mul_f32 v248, 0x3a800000, v248
  v_mul_f32 v249, 0x3a800000, v249
  v_fma_f32 v249, -v248, v248, v249
  v_max_f32 v249, 0, v249
  v_add_f32 v249, 0x3727c5ac, v249
  v_rsq_f32 v249, v249
  s_nop 0
  v_mul_f32 v120, 0x3a800000, v120
  v_mul_f32 v121, 0x3a800000, v121
  v_fma_f32 v121, -v120, v120, v121
  v_max_f32 v121, 0, v121
  v_add_f32 v121, 0x3727c5ac, v121
  v_rsq_f32 v121, v121
  s_nop 0
  s_mov_b64 exec, s[10:11]
  ds_write2_b32 v35, v240, v241 offset0:16 offset1:176
  ds_write2_b32 v35, v248, v249 offset0:32 offset1:192
  ds_write2_b32 v36, v120, v121 offset0:0 offset1:160
  s_mov_b64 exec, -1
  s_mov_b32 s36, s16
  s_and_b32 s37, s17, 0xffff
  s_mov_b32 s38, 4194304
  s_mov_b32 s39, 0x00020000
  s_and_b32 s3, s2, 3
  s_and_b32 s4, s99, 3
  s_lshl2_add_u32 s3, s3, s4
  s_lshl2_add_u32 s3, s3, s70
  s_lshl_b32 s3, s3, 16
  s_bfe_u32 s4, s2, 0x10002
  s_lshr_b32 s5, s99, 2
  s_lshl1_add_u32 s4, s5, s4
  s_lshl_b32 s4, s4, 7
  s_add_u32 s3, s3, s4
  s_add_u32 s4, s3, 32768
  v_and_b32 v32, 15, v1
  v_lshlrev_b32 v33, 1, v1
  v_and_b32 v33, 32, v33
  v_lshl_add_u32 v32, v32, 11, v33
  v_lshrrev_b32 v33, 1, v1
  v_and_b32 v33, 16, v33
  v_add_u32 v32, v32, v33
  s_waitcnt lgkmcnt(0)
  buffer_load_dwordx4 v[240:243], v32, s[36:39], s3 offen offset:0
  buffer_load_dwordx4 v[244:247], v32, s[36:39], s3 offen offset:64
  buffer_load_dwordx4 v[248:251], v32, s[36:39], s4 offen offset:0
  buffer_load_dwordx4 v[252:255], v32, s[36:39], s4 offen offset:64
  s_barrier
  s_branch L_attn_exit
.p2align 3
L_attn_loop:
  v_mfma_f32_16x16x32_bf16 v[128:131], v[52:55], v[32:35], v[128:131]
  ds_read_b128 v[76:79], v11 offset:0
  v_mfma_f32_16x16x32_bf16 v[132:135], v[52:55], v[36:39], v[132:135]
  ds_read_b128 v[80:83], v11 offset:2048
  v_mfma_f32_16x16x32_bf16 v[136:139], v[52:55], v[40:43], v[136:139]
  ds_read_b128 v[84:87], v11 offset:4096
  v_mfma_f32_16x16x32_bf16 v[140:143], v[52:55], v[44:47], v[140:143]
  ds_read_b128 v[88:91], v11 offset:6144
  v_mfma_f32_16x16x32_bf16 v[224:227], v[52:55], v[48:51], v[224:227]
  ds_read_b128 v[92:95], v15
  v_mfma_f32_16x16x32_bf16 v[156:159], v[56:59], v[44:47], v[156:159]
  ds_read_b64_tr_b16 v[96:97], v12 offset:4096
  v_mfma_f32_16x16x32_bf16 v[152:155], v[56:59], v[40:43], v[152:155]
  ds_read_b64_tr_b16 v[98:99], v12 offset:4608
  v_mfma_f32_16x16x32_bf16 v[148:151], v[56:59], v[36:39], v[148:151]
  ds_read_b64_tr_b16 v[100:101], v13 offset:4096
  v_mfma_f32_16x16x32_bf16 v[144:147], v[56:59], v[32:35], v[144:147]
  ds_read_b64_tr_b16 v[102:103], v13 offset:4608
  v_mfma_f32_16x16x32_bf16 v[160:163], v[60:63], v[32:35], v[160:163]
  ds_read_b64_tr_b16 v[104:105], v12 offset:12288
  v_mfma_f32_16x16x32_bf16 v[164:167], v[60:63], v[36:39], v[164:167]
  ds_read_b64_tr_b16 v[106:107], v12 offset:12800
  v_mfma_f32_16x16x32_bf16 v[168:171], v[60:63], v[40:43], v[168:171]
  ds_read_b64_tr_b16 v[108:109], v13 offset:12288
  v_mfma_f32_16x16x32_bf16 v[172:175], v[60:63], v[44:47], v[172:175]
  ds_read_b64_tr_b16 v[110:111], v13 offset:12800
  v_mfma_f32_16x16x32_bf16 v[228:231], v[60:63], v[48:51], v[228:231]
  ds_read_b64_tr_b16 v[112:113], v12 offset:20480
  v_mfma_f32_16x16x32_bf16 v[188:191], v[64:67], v[44:47], v[188:191]
  ds_read_b64_tr_b16 v[114:115], v12 offset:20992
  v_mfma_f32_16x16x32_bf16 v[184:187], v[64:67], v[40:43], v[184:187]
  ds_read_b64_tr_b16 v[116:117], v13 offset:20480
  v_mfma_f32_16x16x32_bf16 v[180:183], v[64:67], v[36:39], v[180:183]
  ds_read_b64_tr_b16 v[118:119], v13 offset:20992
  v_mfma_f32_16x16x32_bf16 v[176:179], v[64:67], v[32:35], v[176:179]
  v_add_u32_e64 v10, s75, v4
  v_mfma_f32_16x16x32_bf16 v[192:195], v[32:35], v[68:71], v[192:195]
  v_add_u32_e64 v11, s75, v5
  v_mfma_f32_16x16x32_bf16 v[196:199], v[36:39], v[68:71], v[196:199]
  v_add_u32_e64 v12, s75, v6
  v_mfma_f32_16x16x32_bf16 v[200:203], v[40:43], v[68:71], v[200:203]
  v_add_u32_e64 v13, s75, v7
  v_mfma_f32_16x16x32_bf16 v[204:207], v[44:47], v[68:71], v[204:207]
  v_add_u32_e64 v14, s75, v8
  v_mfma_f32_16x16x32_bf16 v[232:235], v[48:51], v[68:71], v[232:235]
  v_add_u32_e64 v15, s75, v9
  v_mfma_f32_16x16x32_bf16 v[220:223], v[44:47], v[72:75], v[220:223]
  s_add_u32 s75, s75, 43008
  v_mfma_f32_16x16x32_bf16 v[216:219], v[40:43], v[72:75], v[216:219]
  s_cmp_eq_u32 s75, 129024
  v_mfma_f32_16x16x32_bf16 v[212:215], v[36:39], v[72:75], v[212:215]
  s_cselect_b32 s75, 0, s75
  s_sub_u32 s79, s79, 1
  v_mfma_f32_16x16x32_bf16 v[208:211], v[32:35], v[72:75], v[208:211]
  s_waitcnt lgkmcnt(0)
  s_barrier
  v_mfma_f32_16x16x32_bf16 v[128:131], v[96:99], v[76:79], v[128:131]
  ds_read_b128 v[32:35], v10 offset:0
  v_mfma_f32_16x16x32_bf16 v[132:135], v[96:99], v[80:83], v[132:135]
  ds_read_b128 v[36:39], v10 offset:2048
  v_mfma_f32_16x16x32_bf16 v[136:139], v[96:99], v[84:87], v[136:139]
  ds_read_b128 v[40:43], v10 offset:4096
  v_mfma_f32_16x16x32_bf16 v[140:143], v[96:99], v[88:91], v[140:143]
  ds_read_b128 v[44:47], v10 offset:6144
  v_mfma_f32_16x16x32_bf16 v[224:227], v[96:99], v[92:95], v[224:227]
  ds_read_b128 v[48:51], v14
  v_mfma_f32_16x16x32_bf16 v[156:159], v[100:103], v[88:91], v[156:159]
  ds_read_b64_tr_b16 v[52:53], v12 offset:0
  v_mfma_f32_16x16x32_bf16 v[152:155], v[100:103], v[84:87], v[152:155]
  ds_read_b64_tr_b16 v[54:55], v12 offset:512
  v_mfma_f32_16x16x32_bf16 v[148:151], v[100:103], v[80:83], v[148:151]
  ds_read_b64_tr_b16 v[56:57], v13 offset:0
  v_mfma_f32_16x16x32_bf16 v[144:147], v[100:103], v[76:79], v[144:147]
  ds_read_b64_tr_b16 v[58:59], v13 offset:512
  v_mfma_f32_16x16x32_bf16 v[160:163], v[104:107], v[76:79], v[160:163]
  ds_read_b64_tr_b16 v[60:61], v12 offset:8192
  v_mfma_f32_16x16x32_bf16 v[164:167], v[104:107], v[80:83], v[164:167]
  ds_read_b64_tr_b16 v[62:63], v12 offset:8704
  v_mfma_f32_16x16x32_bf16 v[168:171], v[104:107], v[84:87], v[168:171]
  ds_read_b64_tr_b16 v[64:65], v13 offset:8192
  v_mfma_f32_16x16x32_bf16 v[172:175], v[104:107], v[88:91], v[172:175]
  ds_read_b64_tr_b16 v[66:67], v13 offset:8704
  v_mfma_f32_16x16x32_bf16 v[228:231], v[104:107], v[92:95], v[228:231]
  ds_read_b64_tr_b16 v[68:69], v12 offset:16384
  v_mfma_f32_16x16x32_bf16 v[188:191], v[108:111], v[88:91], v[188:191]
  ds_read_b64_tr_b16 v[70:71], v12 offset:16896
  v_mfma_f32_16x16x32_bf16 v[184:187], v[108:111], v[84:87], v[184:187]
  ds_read_b64_tr_b16 v[72:73], v13 offset:16384
  v_mfma_f32_16x16x32_bf16 v[180:183], v[108:111], v[80:83], v[180:183]
  ds_read_b64_tr_b16 v[74:75], v13 offset:16896
  v_mfma_f32_16x16x32_bf16 v[176:179], v[108:111], v[76:79], v[176:179]
  s_cmp_lg_u32 s79, 0
  s_nop 0
  v_mfma_f32_16x16x32_bf16 v[192:195], v[76:79], v[112:115], v[192:195]
  v_mfma_f32_16x16x32_bf16 v[196:199], v[80:83], v[112:115], v[196:199]
  v_mfma_f32_16x16x32_bf16 v[200:203], v[84:87], v[112:115], v[200:203]
  v_mfma_f32_16x16x32_bf16 v[204:207], v[88:91], v[112:115], v[204:207]
  v_mfma_f32_16x16x32_bf16 v[232:235], v[92:95], v[112:115], v[232:235]
  v_mfma_f32_16x16x32_bf16 v[220:223], v[88:91], v[116:119], v[220:223]
  v_mfma_f32_16x16x32_bf16 v[216:219], v[84:87], v[116:119], v[216:219]
  v_mfma_f32_16x16x32_bf16 v[212:215], v[80:83], v[116:119], v[212:215]
  v_mfma_f32_16x16x32_bf16 v[208:211], v[76:79], v[116:119], v[208:211]
  s_waitcnt lgkmcnt(0)
  s_cbranch_scc1 L_attn_loop
L_attn_exit:
  ds_read2_b32 v[66:67], v23 offset0:0 offset1:160
  ds_read2_b32 v[68:69], v23 offset0:16 offset1:176
  ds_read2_b32 v[70:71], v23 offset0:32 offset1:192
  ds_read2_b32 v[72:73], v23 offset0:48 offset1:208
  ds_read2_b32 v[74:75], v23 offset0:64 offset1:224
  ds_read2_b32 v[76:77], v25 offset0:0 offset1:16
  ds_read2_b32 v[80:81], v26 offset0:0 offset1:16
  ds_read2_b32 v[78:79], v25 offset0:32 offset1:48
  ds_read2_b32 v[82:83], v26 offset0:32 offset1:48
  ds_write_b128 v16, v[224:227] offset:0
  ds_write_b128 v16, v[228:231] offset:2048
  ds_write_b128 v16, v[232:235] offset:4096
  s_cmp_eq_u32 s71, 1
  s_cbranch_scc1 L_attn_nop3
  ds_write_b128 v16, v[172:175] offset:8192
  ds_write_b128 v16, v[188:191] offset:9216
  ds_write_b128 v16, v[204:207] offset:10240
  ds_write_b128 v16, v[220:223] offset:11264
L_attn_nop3:
  ds_read_b128 v[84:87], v24 offset:0
  ds_read_b128 v[104:107], v24 offset:640
  ds_read_b128 v[88:91], v24 offset:64
  ds_read_b128 v[108:111], v24 offset:704
  ds_read_b128 v[92:95], v24 offset:128
  ds_read_b128 v[112:115], v24 offset:768
  ds_read_b128 v[96:99], v24 offset:192
  ds_read_b128 v[116:119], v24 offset:832
  ds_read_b128 v[100:103], v24 offset:256
  ds_read_b128 v[120:123], v24 offset:896
  s_waitcnt lgkmcnt(10)
  s_barrier
  ds_read_b128 v[48:51], v19 offset:0
  ds_read_b128 v[52:55], v20 offset:1024
  ds_read_b128 v[56:59], v19 offset:2048
  ds_read_b128 v[60:63], v20 offset:3072
  ds_read_b32 v64, v21 offset:4096
  ds_read_b32 v65, v22 offset:5120
  ds_read_b128 v[32:35], v17 offset:2048
  ds_read_b128 v[36:39], v18 offset:3072
  ds_read_b128 v[40:43], v17 offset:4096
  ds_read_b128 v[44:47], v18 offset:5120
  v_mul_f32 v69, 0x3e8293ee, v69
  v_mul_f32 v71, 0x3e8293ee, v71
  v_mul_f32 v73, 0x3e8293ee, v73
  v_mul_f32 v75, 0x3e8293ee, v75
  v_mul_f32 v76, v76, v69
  v_mul_f32 v80, v80, v69
  v_mul_f32 v77, v77, v71
  v_mul_f32 v81, v81, v71
  v_mul_f32 v78, v78, v73
  v_mul_f32 v82, v82, v73
  v_mul_f32 v79, v79, v75
  v_mul_f32 v83, v83, v75
  s_waitcnt lgkmcnt(6)
  v_pk_fma_f32 v[128:129], v[48:49], v[68:69], v[128:129] op_sel:[0,0,0] op_sel_hi:[1,0,1] neg_lo:[0,1,0] neg_hi:[0,1,0]
  v_pk_fma_f32 v[130:131], v[50:51], v[68:69], v[130:131] op_sel:[0,0,0] op_sel_hi:[1,0,1] neg_lo:[0,1,0] neg_hi:[0,1,0]
  v_pk_fma_f32 v[144:145], v[52:53], v[68:69], v[144:145] op_sel:[0,0,0] op_sel_hi:[1,0,1] neg_lo:[0,1,0] neg_hi:[0,1,0]
  v_pk_fma_f32 v[146:147], v[54:55], v[68:69], v[146:147] op_sel:[0,0,0] op_sel_hi:[1,0,1] neg_lo:[0,1,0] neg_hi:[0,1,0]
  v_cvt_pk_bf16_f32 v128, v128, v129
  v_cvt_pk_bf16_f32 v129, v130, v131
  v_cvt_pk_bf16_f32 v130, v144, v145
  v_cvt_pk_bf16_f32 v131, v146, v147
  v_pk_fma_f32 v[160:161], v[56:57], v[68:69], v[160:161] op_sel:[0,0,0] op_sel_hi:[1,0,1] neg_lo:[0,1,0] neg_hi:[0,1,0]
  v_pk_fma_f32 v[162:163], v[58:59], v[68:69], v[162:163] op_sel:[0,0,0] op_sel_hi:[1,0,1] neg_lo:[0,1,0] neg_hi:[0,1,0]
  v_pk_fma_f32 v[176:177], v[60:61], v[68:69], v[176:177] op_sel:[0,0,0] op_sel_hi:[1,0,1] neg_lo:[0,1,0] neg_hi:[0,1,0]
  v_pk_fma_f32 v[178:179], v[62:63], v[68:69], v[178:179] op_sel:[0,0,0] op_sel_hi:[1,0,1] neg_lo:[0,1,0] neg_hi:[0,1,0]
  v_cvt_pk_bf16_f32 v160, v160, v161
  v_cvt_pk_bf16_f32 v161, v162, v163
  v_cvt_pk_bf16_f32 v162, v176, v177
  v_cvt_pk_bf16_f32 v163, v178, v179
  v_pk_fma_f32 v[132:133], v[48:49], v[70:71], v[132:133] op_sel:[0,0,0] op_sel_hi:[1,0,1] neg_lo:[0,1,0] neg_hi:[0,1,0]
  v_pk_fma_f32 v[134:135], v[50:51], v[70:71], v[134:135] op_sel:[0,0,0] op_sel_hi:[1,0,1] neg_lo:[0,1,0] neg_hi:[0,1,0]
  v_pk_fma_f32 v[148:149], v[52:53], v[70:71], v[148:149] op_sel:[0,0,0] op_sel_hi:[1,0,1] neg_lo:[0,1,0] neg_hi:[0,1,0]
  v_pk_fma_f32 v[150:151], v[54:55], v[70:71], v[150:151] op_sel:[0,0,0] op_sel_hi:[1,0,1] neg_lo:[0,1,0] neg_hi:[0,1,0]
  v_cvt_pk_bf16_f32 v132, v132, v133
  v_cvt_pk_bf16_f32 v133, v134, v135
  v_cvt_pk_bf16_f32 v134, v148, v149
  v_cvt_pk_bf16_f32 v135, v150, v151
  v_pk_fma_f32 v[164:165], v[56:57], v[70:71], v[164:165] op_sel:[0,0,0] op_sel_hi:[1,0,1] neg_lo:[0,1,0] neg_hi:[0,1,0]
  v_pk_fma_f32 v[166:167], v[58:59], v[70:71], v[166:167] op_sel:[0,0,0] op_sel_hi:[1,0,1] neg_lo:[0,1,0] neg_hi:[0,1,0]
  v_pk_fma_f32 v[180:181], v[60:61], v[70:71], v[180:181] op_sel:[0,0,0] op_sel_hi:[1,0,1] neg_lo:[0,1,0] neg_hi:[0,1,0]
  v_pk_fma_f32 v[182:183], v[62:63], v[70:71], v[182:183] op_sel:[0,0,0] op_sel_hi:[1,0,1] neg_lo:[0,1,0] neg_hi:[0,1,0]
  v_cvt_pk_bf16_f32 v164, v164, v165
  v_cvt_pk_bf16_f32 v165, v166, v167
  v_cvt_pk_bf16_f32 v166, v180, v181
  v_cvt_pk_bf16_f32 v167, v182, v183
  v_mfma_f32_16x16x32_bf16 v[144:147], v[160:163], v[128:131], 0
  v_pk_fma_f32 v[136:137], v[48:49], v[72:73], v[136:137] op_sel:[0,0,0] op_sel_hi:[1,0,1] neg_lo:[0,1,0] neg_hi:[0,1,0]
  v_pk_fma_f32 v[138:139], v[50:51], v[72:73], v[138:139] op_sel:[0,0,0] op_sel_hi:[1,0,1] neg_lo:[0,1,0] neg_hi:[0,1,0]
  v_pk_fma_f32 v[152:153], v[52:53], v[72:73], v[152:153] op_sel:[0,0,0] op_sel_hi:[1,0,1] neg_lo:[0,1,0] neg_hi:[0,1,0]
  v_pk_fma_f32 v[154:155], v[54:55], v[72:73], v[154:155] op_sel:[0,0,0] op_sel_hi:[1,0,1] neg_lo:[0,1,0] neg_hi:[0,1,0]
  v_cvt_pk_bf16_f32 v136, v136, v137
  v_cvt_pk_bf16_f32 v137, v138, v139
  v_cvt_pk_bf16_f32 v138, v152, v153
  v_cvt_pk_bf16_f32 v139, v154, v155
  v_pk_fma_f32 v[168:169], v[56:57], v[72:73], v[168:169] op_sel:[0,0,0] op_sel_hi:[1,0,1] neg_lo:[0,1,0] neg_hi:[0,1,0]
  v_pk_fma_f32 v[170:171], v[58:59], v[72:73], v[170:171] op_sel:[0,0,0] op_sel_hi:[1,0,1] neg_lo:[0,1,0] neg_hi:[0,1,0]
  v_pk_fma_f32 v[184:185], v[60:61], v[72:73], v[184:185] op_sel:[0,0,0] op_sel_hi:[1,0,1] neg_lo:[0,1,0] neg_hi:[0,1,0]
  v_pk_fma_f32 v[186:187], v[62:63], v[72:73], v[186:187] op_sel:[0,0,0] op_sel_hi:[1,0,1] neg_lo:[0,1,0] neg_hi:[0,1,0]
  v_cvt_pk_bf16_f32 v168, v168, v169
  v_cvt_pk_bf16_f32 v169, v170, v171
  v_cvt_pk_bf16_f32 v170, v184, v185
  v_cvt_pk_bf16_f32 v171, v186, v187
  v_mfma_f32_16x16x32_bf16 v[148:151], v[164:167], v[132:135], 0
  v_mfma_f32_16x16x32_bf16 v[180:183], v[160:163], v[132:135], 0
  v_pk_fma_f32 v[140:141], v[48:49], v[74:75], v[140:141] op_sel:[0,0,0] op_sel_hi:[1,0,1] neg_lo:[0,1,0] neg_hi:[0,1,0]
  v_pk_fma_f32 v[142:143], v[50:51], v[74:75], v[142:143] op_sel:[0,0,0] op_sel_hi:[1,0,1] neg_lo:[0,1,0] neg_hi:[0,1,0]
  v_pk_fma_f32 v[156:157], v[52:53], v[74:75], v[156:157] op_sel:[0,0,0] op_sel_hi:[1,0,1] neg_lo:[0,1,0] neg_hi:[0,1,0]
  v_pk_fma_f32 v[158:159], v[54:55], v[74:75], v[158:159] op_sel:[0,0,0] op_sel_hi:[1,0,1] neg_lo:[0,1,0] neg_hi:[0,1,0]
  v_cvt_pk_bf16_f32 v140, v140, v141
  v_cvt_pk_bf16_f32 v141, v142, v143
  v_cvt_pk_bf16_f32 v142, v156, v157
  v_cvt_pk_bf16_f32 v143, v158, v159
  v_pk_fma_f32 v[172:173], v[56:57], v[74:75], v[172:173] op_sel:[0,0,0] op_sel_hi:[1,0,1] neg_lo:[0,1,0] neg_hi:[0,1,0]
  v_pk_fma_f32 v[174:175], v[58:59], v[74:75], v[174:175] op_sel:[0,0,0] op_sel_hi:[1,0,1] neg_lo:[0,1,0] neg_hi:[0,1,0]
  v_pk_fma_f32 v[188:189], v[60:61], v[74:75], v[188:189] op_sel:[0,0,0] op_sel_hi:[1,0,1] neg_lo:[0,1,0] neg_hi:[0,1,0]
  v_pk_fma_f32 v[190:191], v[62:63], v[74:75], v[190:191] op_sel:[0,0,0] op_sel_hi:[1,0,1] neg_lo:[0,1,0] neg_hi:[0,1,0]
  v_cvt_pk_bf16_f32 v172, v172, v173
  v_cvt_pk_bf16_f32 v173, v174, v175
  v_cvt_pk_bf16_f32 v174, v188, v189
  v_cvt_pk_bf16_f32 v175, v190, v191
  s_waitcnt lgkmcnt(0)
  v_pk_fma_f32 v[32:33], v[56:57], v[66:67], v[32:33] op_sel:[0,0,0] op_sel_hi:[1,0,1] neg_lo:[0,1,0] neg_hi:[0,1,0]
  v_pk_fma_f32 v[34:35], v[58:59], v[66:67], v[34:35] op_sel:[0,0,0] op_sel_hi:[1,0,1] neg_lo:[0,1,0] neg_hi:[0,1,0]
  v_pk_fma_f32 v[36:37], v[60:61], v[66:67], v[36:37] op_sel:[0,0,0] op_sel_hi:[1,0,1] neg_lo:[0,1,0] neg_hi:[0,1,0]
  v_pk_fma_f32 v[38:39], v[62:63], v[66:67], v[38:39] op_sel:[0,0,0] op_sel_hi:[1,0,1] neg_lo:[0,1,0] neg_hi:[0,1,0]
  v_cvt_pk_bf16_f32 v32, v32, v33
  v_cvt_pk_bf16_f32 v33, v34, v35
  v_cvt_pk_bf16_f32 v34, v36, v37
  v_cvt_pk_bf16_f32 v35, v38, v39
  v_mfma_f32_16x16x32_bf16 v[152:155], v[168:171], v[136:139], 0
  v_mfma_f32_16x16x32_bf16 v[184:187], v[164:167], v[136:139], 0
  v_mfma_f32_16x16x32_bf16 v[156:159], v[172:175], v[140:143], 0
  v_mfma_f32_16x16x32_bf16 v[188:191], v[168:171], v[140:143], 0
  v_mfma_f32_16x16x32_bf16 v[176:179], v[32:35], v[128:131], 0
  v_pk_fma_f32 v[40:41], v[84:85], v[64:65], v[40:41] op_sel:[0,0,0] op_sel_hi:[1,0,1] neg_lo:[1,0,0] neg_hi:[1,0,0]
  v_pk_fma_f32 v[42:43], v[86:87], v[64:65], v[42:43] op_sel:[0,0,0] op_sel_hi:[1,0,1] neg_lo:[1,0,0] neg_hi:[1,0,0]
  v_pk_mul_f32 v[40:41], v[40:41], v[104:105]
  v_pk_mul_f32 v[42:43], v[42:43], v[106:107]
  v_cvt_pk_bf16_f32 v4, v40, v41
  v_cvt_pk_bf16_f32 v5, v42, v43
  v_pk_fma_f32 v[192:193], v[88:89], v[64:65], v[192:193] op_sel:[0,0,0] op_sel_hi:[1,0,1] neg_lo:[1,0,0] neg_hi:[1,0,0]
  v_pk_fma_f32 v[194:195], v[90:91], v[64:65], v[194:195] op_sel:[0,0,0] op_sel_hi:[1,0,1] neg_lo:[1,0,0] neg_hi:[1,0,0]
  v_pk_mul_f32 v[192:193], v[192:193], v[108:109]
  v_pk_mul_f32 v[194:195], v[194:195], v[110:111]
  v_cvt_pk_bf16_f32 v6, v192, v193
  v_cvt_pk_bf16_f32 v7, v194, v195
  v_pk_fma_f32 v[196:197], v[92:93], v[64:65], v[196:197] op_sel:[0,0,0] op_sel_hi:[1,0,1] neg_lo:[1,0,0] neg_hi:[1,0,0]
  v_pk_fma_f32 v[198:199], v[94:95], v[64:65], v[198:199] op_sel:[0,0,0] op_sel_hi:[1,0,1] neg_lo:[1,0,0] neg_hi:[1,0,0]
  v_pk_mul_f32 v[196:197], v[196:197], v[112:113]
  v_pk_mul_f32 v[198:199], v[198:199], v[114:115]
  v_cvt_pk_bf16_f32 v8, v196, v197
  v_cvt_pk_bf16_f32 v9, v198, v199
  v_pk_fma_f32 v[200:201], v[96:97], v[64:65], v[200:201] op_sel:[0,0,0] op_sel_hi:[1,0,1] neg_lo:[1,0,0] neg_hi:[1,0,0]
  v_pk_fma_f32 v[202:203], v[98:99], v[64:65], v[202:203] op_sel:[0,0,0] op_sel_hi:[1,0,1] neg_lo:[1,0,0] neg_hi:[1,0,0]
  v_pk_mul_f32 v[200:201], v[200:201], v[116:117]
  v_pk_mul_f32 v[202:203], v[202:203], v[118:119]
  v_cvt_pk_bf16_f32 v10, v200, v201
  v_cvt_pk_bf16_f32 v11, v202, v203
  v_pk_fma_f32 v[204:205], v[100:101], v[64:65], v[204:205] op_sel:[0,0,0] op_sel_hi:[1,0,1] neg_lo:[1,0,0] neg_hi:[1,0,0]
  v_pk_fma_f32 v[206:207], v[102:103], v[64:65], v[206:207] op_sel:[0,0,0] op_sel_hi:[1,0,1] neg_lo:[1,0,0] neg_hi:[1,0,0]
  v_pk_mul_f32 v[204:205], v[204:205], v[120:121]
  v_pk_mul_f32 v[206:207], v[206:207], v[122:123]
  v_cvt_pk_bf16_f32 v12, v204, v205
  v_cvt_pk_bf16_f32 v13, v206, v207
  v_pk_fma_f32 v[44:45], v[84:85], v[64:65], v[44:45] op_sel:[0,1,0] op_sel_hi:[1,1,1] neg_lo:[1,0,0] neg_hi:[1,0,0]
  v_pk_fma_f32 v[46:47], v[86:87], v[64:65], v[46:47] op_sel:[0,1,0] op_sel_hi:[1,1,1] neg_lo:[1,0,0] neg_hi:[1,0,0]
  v_pk_mul_f32 v[44:45], v[44:45], v[104:105]
  v_pk_mul_f32 v[46:47], v[46:47], v[106:107]
  v_cvt_pk_bf16_f32 v224, v44, v45
  v_cvt_pk_bf16_f32 v225, v46, v47
  v_pk_fma_f32 v[208:209], v[88:89], v[64:65], v[208:209] op_sel:[0,1,0] op_sel_hi:[1,1,1] neg_lo:[1,0,0] neg_hi:[1,0,0]
  v_pk_fma_f32 v[210:211], v[90:91], v[64:65], v[210:211] op_sel:[0,1,0] op_sel_hi:[1,1,1] neg_lo:[1,0,0] neg_hi:[1,0,0]
  v_pk_mul_f32 v[208:209], v[208:209], v[108:109]
  v_pk_mul_f32 v[210:211], v[210:211], v[110:111]
  v_cvt_pk_bf16_f32 v226, v208, v209
  v_cvt_pk_bf16_f32 v227, v210, v211
  v_pk_fma_f32 v[212:213], v[92:93], v[64:65], v[212:213] op_sel:[0,1,0] op_sel_hi:[1,1,1] neg_lo:[1,0,0] neg_hi:[1,0,0]
  v_pk_fma_f32 v[214:215], v[94:95], v[64:65], v[214:215] op_sel:[0,1,0] op_sel_hi:[1,1,1] neg_lo:[1,0,0] neg_hi:[1,0,0]
  v_pk_mul_f32 v[212:213], v[212:213], v[112:113]
  v_pk_mul_f32 v[214:215], v[214:215], v[114:115]
  v_cvt_pk_bf16_f32 v228, v212, v213
  v_cvt_pk_bf16_f32 v229, v214, v215
  v_pk_fma_f32 v[216:217], v[96:97], v[64:65], v[216:217] op_sel:[0,1,0] op_sel_hi:[1,1,1] neg_lo:[1,0,0] neg_hi:[1,0,0]
  v_pk_fma_f32 v[218:219], v[98:99], v[64:65], v[218:219] op_sel:[0,1,0] op_sel_hi:[1,1,1] neg_lo:[1,0,0] neg_hi:[1,0,0]
  v_pk_mul_f32 v[216:217], v[216:217], v[116:117]
  v_pk_mul_f32 v[218:219], v[218:219], v[118:119]
  v_cvt_pk_bf16_f32 v230, v216, v217
  v_cvt_pk_bf16_f32 v231, v218, v219
  v_pk_fma_f32 v[220:221], v[100:101], v[64:65], v[220:221] op_sel:[0,1,0] op_sel_hi:[1,1,1] neg_lo:[1,0,0] neg_hi:[1,0,0]
  v_pk_fma_f32 v[222:223], v[102:103], v[64:65], v[222:223] op_sel:[0,1,0] op_sel_hi:[1,1,1] neg_lo:[1,0,0] neg_hi:[1,0,0]
  v_pk_mul_f32 v[220:221], v[220:221], v[120:121]
  v_pk_mul_f32 v[222:223], v[222:223], v[122:123]
  v_cvt_pk_bf16_f32 v232, v220, v221
  v_cvt_pk_bf16_f32 v233, v222, v223
  v_cndmask_b32 v148, v148, v149, s[48:49]
  v_cndmask_b32 v180, v180, v181, s[48:49]
  v_cndmask_b32 v150, v150, v151, s[48:49]
  v_cndmask_b32 v182, v182, v183, s[48:49]
  v_cndmask_b32 v36, v148, v180, s[50:51]
  v_cndmask_b32 v37, v150, v182, s[52:53]
  v_mul_f32 v36, v36, v77
  v_mul_f32 v37, v37, v81
  v_cndmask_b32 v152, v152, v153, s[48:49]
  v_cndmask_b32 v184, v184, v185, s[48:49]
  v_cndmask_b32 v154, v154, v155, s[48:49]
  v_cndmask_b32 v186, v186, v187, s[48:49]
  v_cndmask_b32 v40, v152, v184, s[50:51]
  v_cndmask_b32 v41, v154, v186, s[52:53]
  v_mul_f32 v40, v40, v78
  v_mul_f32 v41, v41, v82
  v_cndmask_b32 v156, v156, v157, s[48:49]
  v_cndmask_b32 v188, v188, v189, s[48:49]
  v_cndmask_b32 v158, v158, v159, s[48:49]
  v_cndmask_b32 v190, v190, v191, s[48:49]
  v_cndmask_b32 v44, v156, v188, s[50:51]
  v_cndmask_b32 v45, v158, v190, s[52:53]
  v_mul_f32 v44, v44, v79
  v_mul_f32 v45, v45, v83
  v_cndmask_b32 v144, v144, v145, s[48:49]
  v_cndmask_b32 v176, v176, v177, s[48:49]
  v_cndmask_b32 v146, v146, v147, s[48:49]
  v_cndmask_b32 v178, v178, v179, s[48:49]
  v_cndmask_b32 v32, v144, v176, s[50:51]
  v_cndmask_b32 v33, v146, v178, s[52:53]
  v_mul_f32 v32, v32, v76
  v_mul_f32 v33, v33, v80
  v_mov_b32 v48, 0xceabfb8f
  v_cndmask_b32 v32, v32, v48, s[54:55]
  v_cndmask_b32 v33, v33, v48, s[14:15]
  v_max_f32 v34, v32, v33
  v_max_f32 v38, v36, v37
  v_max_f32 v42, v40, v41
  v_max_f32 v46, v44, v45
  v_mov_b32 v35, v34
  v_mov_b32 v39, v38
  v_mov_b32 v43, v42
  v_mov_b32 v47, v46
  v_permlane32_swap_b32 v34, v35
  v_permlane32_swap_b32 v38, v39
  v_permlane32_swap_b32 v42, v43
  v_permlane32_swap_b32 v46, v47
  v_max_f32 v34, v34, v35
  v_max_f32 v38, v38, v39
  v_max_f32 v42, v42, v43
  v_max_f32 v46, v46, v47
  v_mov_b32 v35, v34
  v_mov_b32 v39, v38
  v_mov_b32 v43, v42
  v_mov_b32 v47, v46
  v_permlane16_swap_b32 v34, v35
  v_permlane16_swap_b32 v38, v39
  v_permlane16_swap_b32 v42, v43
  v_permlane16_swap_b32 v46, v47
  v_max_f32 v34, v34, v35
  v_max_f32 v38, v38, v39
  v_max_f32 v42, v42, v43
  v_max_f32 v46, v46, v47
  v_sub_f32 v32, v32, v34
  v_sub_f32 v33, v33, v34
  v_sub_f32 v36, v36, v38
  v_sub_f32 v37, v37, v38
  v_sub_f32 v40, v40, v42
  v_sub_f32 v41, v41, v42
  v_sub_f32 v44, v44, v46
  v_sub_f32 v45, v45, v46
  v_exp_f32 v32, v32
  v_exp_f32 v33, v33
  v_exp_f32 v36, v36
  v_exp_f32 v37, v37
  v_exp_f32 v40, v40
  v_exp_f32 v41, v41
  v_exp_f32 v44, v44
  v_exp_f32 v45, v45
  v_cvt_pk_bf16_f32 v32, v32, v32
  v_cvt_pk_bf16_f32 v33, v33, v33
  v_and_b32 v128, v32, v27
  v_and_b32 v129, v33, v29
  v_and_b32 v130, v32, v28
  v_and_b32 v131, v33, v30
  v_cvt_pk_bf16_f32 v36, v36, v36
  v_cvt_pk_bf16_f32 v37, v37, v37
  v_and_b32 v132, v36, v27
  v_and_b32 v133, v37, v29
  v_and_b32 v134, v36, v28
  v_and_b32 v135, v37, v30
  v_mfma_f32_16x16x32_bf16 v[144:147], v[236:239], v[128:131], 0
  v_mfma_f32_16x16x32_bf16 v[192:195], v[4:7], v[128:131], 0
  v_mfma_f32_16x16x32_bf16 v[208:211], v[224:227], v[128:131], 0
  v_cvt_pk_bf16_f32 v40, v40, v40
  v_cvt_pk_bf16_f32 v41, v41, v41
  v_and_b32 v136, v40, v27
  v_and_b32 v137, v41, v29
  v_and_b32 v138, v40, v28
  v_and_b32 v139, v41, v30
  v_mfma_f32_16x16x32_bf16 v[148:151], v[236:239], v[132:135], 0
  v_mfma_f32_16x16x32_bf16 v[196:199], v[6:9], v[132:135], 0
  v_mfma_f32_16x16x32_bf16 v[212:215], v[226:229], v[132:135], 0
  v_cvt_pk_bf16_f32 v44, v44, v44
  v_cvt_pk_bf16_f32 v45, v45, v45
  v_and_b32 v140, v44, v27
  v_and_b32 v141, v45, v29
  v_and_b32 v142, v44, v28
  v_and_b32 v143, v45, v30
  v_mfma_f32_16x16x32_bf16 v[152:155], v[236:239], v[136:139], 0
  v_mfma_f32_16x16x32_bf16 v[200:203], v[8:11], v[136:139], 0
  v_mfma_f32_16x16x32_bf16 v[216:219], v[228:231], v[136:139], 0
  v_mfma_f32_16x16x32_bf16 v[156:159], v[236:239], v[140:143], 0
  v_mfma_f32_16x16x32_bf16 v[204:207], v[10:13], v[140:143], 0
  v_mfma_f32_16x16x32_bf16 v[220:223], v[230:233], v[140:143], 0
  v_rcp_f32 v144, v144
  s_mov_b32 s3, 0
  v_pk_mul_f32 v[192:193], v[192:193], v[144:145] op_sel_hi:[1,0]
  v_pk_mul_f32 v[194:195], v[194:195], v[144:145] op_sel_hi:[1,0]
  v_pk_mul_f32 v[208:209], v[208:209], v[144:145] op_sel_hi:[1,0]
  v_pk_mul_f32 v[210:211], v[210:211], v[144:145] op_sel_hi:[1,0]
  v_cvt_pk_bf16_f32 v48, v192, v193
  v_cvt_pk_bf16_f32 v49, v194, v195
  v_cvt_pk_bf16_f32 v50, v208, v209
  v_cvt_pk_bf16_f32 v51, v210, v211
  s_nop 1
  v_permlane16_swap_b32 v48, v50
  v_permlane16_swap_b32 v49, v51
  buffer_store_dwordx4 v[48:51], v31, s[44:47], s3 offen sc1
  v_rcp_f32 v148, v148
  s_mov_b32 s3, 32768
  v_pk_mul_f32 v[196:197], v[196:197], v[148:149] op_sel_hi:[1,0]
  v_pk_mul_f32 v[198:199], v[198:199], v[148:149] op_sel_hi:[1,0]
  v_pk_mul_f32 v[212:213], v[212:213], v[148:149] op_sel_hi:[1,0]
  v_pk_mul_f32 v[214:215], v[214:215], v[148:149] op_sel_hi:[1,0]
  v_cvt_pk_bf16_f32 v52, v196, v197
  v_cvt_pk_bf16_f32 v53, v198, v199
  v_cvt_pk_bf16_f32 v54, v212, v213
  v_cvt_pk_bf16_f32 v55, v214, v215
  s_nop 1
  v_permlane16_swap_b32 v52, v54
  v_permlane16_swap_b32 v53, v55
  buffer_store_dwordx4 v[52:55], v31, s[44:47], s3 offen sc1
  v_rcp_f32 v152, v152
  s_mov_b32 s3, 65536
  v_pk_mul_f32 v[200:201], v[200:201], v[152:153] op_sel_hi:[1,0]
  v_pk_mul_f32 v[202:203], v[202:203], v[152:153] op_sel_hi:[1,0]
  v_pk_mul_f32 v[216:217], v[216:217], v[152:153] op_sel_hi:[1,0]
  v_pk_mul_f32 v[218:219], v[218:219], v[152:153] op_sel_hi:[1,0]
  v_cvt_pk_bf16_f32 v56, v200, v201
  v_cvt_pk_bf16_f32 v57, v202, v203
  v_cvt_pk_bf16_f32 v58, v216, v217
  v_cvt_pk_bf16_f32 v59, v218, v219
  s_nop 1
  v_permlane16_swap_b32 v56, v58
  v_permlane16_swap_b32 v57, v59
  buffer_store_dwordx4 v[56:59], v31, s[44:47], s3 offen sc1
  v_rcp_f32 v156, v156
  s_mov_b32 s3, 98304
  v_pk_mul_f32 v[204:205], v[204:205], v[156:157] op_sel_hi:[1,0]
  v_pk_mul_f32 v[206:207], v[206:207], v[156:157] op_sel_hi:[1,0]
  v_pk_mul_f32 v[220:221], v[220:221], v[156:157] op_sel_hi:[1,0]
  v_pk_mul_f32 v[222:223], v[222:223], v[156:157] op_sel_hi:[1,0]
  v_cvt_pk_bf16_f32 v60, v204, v205
  v_cvt_pk_bf16_f32 v61, v206, v207
  v_cvt_pk_bf16_f32 v62, v220, v221
  v_cvt_pk_bf16_f32 v63, v222, v223
  s_nop 1
  v_permlane16_swap_b32 v60, v62
  v_permlane16_swap_b32 v61, v63
  buffer_store_dwordx4 v[60:63], v31, s[44:47], s3 offen sc1
  s_waitcnt vmcnt(0) lgkmcnt(0)
  s_barrier
  s_add_u32 s97, s97, 1
  s_branch L_wo_body
.section .rodata,"a"
.p2align 6
.amdhsa_kernel interleave_layers__sliding_local_dilated__dense_activation_gelu__prompt_kernel
  .amdhsa_next_free_vgpr 256
  .amdhsa_next_free_sgpr 102
  .amdhsa_accum_offset 256
  .amdhsa_group_segment_fixed_size 0
  .amdhsa_kernarg_size 88
  .amdhsa_user_sgpr_count 2
  .amdhsa_user_sgpr_kernarg_segment_ptr 1
  .amdhsa_system_sgpr_workgroup_id_x 1
  .amdhsa_float_denorm_mode_32 3
  .amdhsa_float_denorm_mode_16_64 3
.end_amdhsa_kernel
.text
L_attn_c1:
L_wo_c0:
L_wo_body:
  s_cmp_ge_u32 s2, 256
  s_cbranch_scc1 L_wo_end
  v_lshrrev_b32 v2, 6, v0
  v_and_b32 v1, 63, v0
  v_readfirstlane_b32 s70, v2
  s_and_b32 s3, s2, 7
  s_lshr_b32 s99, s2, 3
  s_and_b32 s5, s3, 3
  s_lshl_b32 s5, s5, 2
  s_and_b32 s6, s99, 3
  s_add_u32 s68, s5, s6
  s_lshr_b32 s5, s3, 2
  s_lshr_b32 s78, s99, 2
  s_lshl1_add_u32 s69, s78, s5
  s_add_u32 s3, s68, s78
  s_lshl_b32 s3, s3, 3
  s_lshl_b32 s85, 0xffff02, s3
  s_sub_u32 s3, 0, s3
  s_lshr_b32 s3, 0xffff02, s3
  s_or_b32 s85, s85, s3
  s_cmp_lt_u32 s70, 4
  s_cbranch_scc1 L_wo_compute
L_wo_loader:
  s_add_u32 s3, s96, s70
  s_cmp_lg_u32 s3, 4
  s_cbranch_scc1 L_wo_chk0
  s_load_dwordx2 s[64:65], s[0:1], 72
  s_waitcnt lgkmcnt(0)
  s_and_b32 s65, s65, 0xffff
  s_mov_b32 s66, 256
  s_mov_b32 s67, 0x00020000
  v_lshlrev_b32 v17, 2, v1
  buffer_load_dword v12, v17, s[64:67], 0 offen sc1
L_wo_chk0:
  s_cmp_lg_u32 s96, 0
  s_cbranch_scc1 L_wo_nofirst
  s_waitcnt vmcnt(1)
  s_mov_b32 s7, 0xffff0000
  v_lshlrev_b32 v32, 16, v64
  v_and_b32 v33, s7, v64
  v_lshlrev_b32 v34, 16, v65
  v_and_b32 v35, s7, v65
  v_lshlrev_b32 v36, 16, v66
  v_and_b32 v37, s7, v66
  v_lshlrev_b32 v38, 16, v67
  v_and_b32 v39, s7, v67
  v_lshlrev_b32 v40, 16, v68
  v_and_b32 v41, s7, v68
  v_pk_add_f32 v[32:33], v[32:33], v[40:41]
  v_lshlrev_b32 v40, 16, v69
  v_and_b32 v41, s7, v69
  v_pk_add_f32 v[34:35], v[34:35], v[40:41]
  v_lshlrev_b32 v40, 16, v70
  v_and_b32 v41, s7, v70
  v_pk_add_f32 v[36:37], v[36:37], v[40:41]
  v_lshlrev_b32 v40, 16, v71
  v_and_b32 v41, s7, v71
  v_pk_add_f32 v[38:39], v[38:39], v[40:41]
  v_lshlrev_b32 v40, 16, v72
  v_and_b32 v41, s7, v72
  v_pk_add_f32 v[32:33], v[32:33], v[40:41]
  v_lshlrev_b32 v40, 16, v73
  v_and_b32 v41, s7, v73
  v_pk_add_f32 v[34:35], v[34:35], v[40:41]
  v_lshlrev_b32 v40, 16, v74
  v_and_b32 v41, s7, v74
  v_pk_add_f32 v[36:37], v[36:37], v[40:41]
  v_lshlrev_b32 v40, 16, v75
  v_and_b32 v41, s7, v75
  v_pk_add_f32 v[38:39], v[38:39], v[40:41]
  v_lshlrev_b32 v40, 16, v76
  v_and_b32 v41, s7, v76
  v_pk_add_f32 v[32:33], v[32:33], v[40:41]
  v_lshlrev_b32 v40, 16, v77
  v_and_b32 v41, s7, v77
  v_pk_add_f32 v[34:35], v[34:35], v[40:41]
  v_lshlrev_b32 v40, 16, v78
  v_and_b32 v41, s7, v78
  v_pk_add_f32 v[36:37], v[36:37], v[40:41]
  v_lshlrev_b32 v40, 16, v79
  v_and_b32 v41, s7, v79
  v_pk_add_f32 v[38:39], v[38:39], v[40:41]
  v_lshlrev_b32 v40, 16, v80
  v_and_b32 v41, s7, v80
  v_pk_add_f32 v[32:33], v[32:33], v[40:41]
  v_lshlrev_b32 v40, 16, v81
  v_and_b32 v41, s7, v81
  v_pk_add_f32 v[34:35], v[34:35], v[40:41]
  v_lshlrev_b32 v40, 16, v82
  v_and_b32 v41, s7, v82
  v_pk_add_f32 v[36:37], v[36:37], v[40:41]
  v_lshlrev_b32 v40, 16, v83
  v_and_b32 v41, s7, v83
  v_pk_add_f32 v[38:39], v[38:39], v[40:41]
  v_lshlrev_b32 v40, 16, v84
  v_and_b32 v41, s7, v84
  v_pk_add_f32 v[32:33], v[32:33], v[40:41]
  v_lshlrev_b32 v40, 16, v85
  v_and_b32 v41, s7, v85
  v_pk_add_f32 v[34:35], v[34:35], v[40:41]
  v_lshlrev_b32 v40, 16, v86
  v_and_b32 v41, s7, v86
  v_pk_add_f32 v[36:37], v[36:37], v[40:41]
  v_lshlrev_b32 v40, 16, v87
  v_and_b32 v41, s7, v87
  v_pk_add_f32 v[38:39], v[38:39], v[40:41]
  v_lshlrev_b32 v40, 16, v88
  v_and_b32 v41, s7, v88
  v_pk_add_f32 v[32:33], v[32:33], v[40:41]
  v_lshlrev_b32 v40, 16, v89
  v_and_b32 v41, s7, v89
  v_pk_add_f32 v[34:35], v[34:35], v[40:41]
  v_lshlrev_b32 v40, 16, v90
  v_and_b32 v41, s7, v90
  v_pk_add_f32 v[36:37], v[36:37], v[40:41]
  v_lshlrev_b32 v40, 16, v91
  v_and_b32 v41, s7, v91
  v_pk_add_f32 v[38:39], v[38:39], v[40:41]
  v_lshlrev_b32 v40, 16, v92
  v_and_b32 v41, s7, v92
  v_pk_add_f32 v[32:33], v[32:33], v[40:41]
  v_lshlrev_b32 v40, 16, v93
  v_and_b32 v41, s7, v93
  v_pk_add_f32 v[34:35], v[34:35], v[40:41]
  v_lshlrev_b32 v40, 16, v94
  v_and_b32 v41, s7, v94
  v_pk_add_f32 v[36:37], v[36:37], v[40:41]
  v_lshlrev_b32 v40, 16, v95
  v_and_b32 v41, s7, v95
  v_pk_add_f32 v[38:39], v[38:39], v[40:41]
  s_add_u32 s52, s22, 24641536
  s_addc_u32 s53, s23, 0
  s_and_b32 s53, s53, 0xffff
  s_mov_b32 s54, 262144
  s_mov_b32 s55, 0x00020000
  v_permlane32_swap_b32 v32, v36
  v_permlane32_swap_b32 v33, v37
  v_permlane32_swap_b32 v34, v38
  v_permlane32_swap_b32 v35, v39
  v_add_f32 v32, v32, v36
  v_add_f32 v33, v33, v37
  v_add_f32 v34, v34, v38
  v_add_f32 v35, v35, v39
  v_and_b32 v2, 7, v1
  v_lshlrev_b32 v2, 5, v2
  v_permlane16_swap_b32 v32, v34
  v_permlane16_swap_b32 v33, v35
  v_add_f32 v32, v32, v34
  v_add_f32 v33, v33, v35
  v_lshrrev_b32 v3, 4, v1
  v_lshl_add_u32 v2, v3, 3, v2
  v_add_f32_dpp v32, v32, v32 row_ror:8 row_mask:0xf bank_mask:0xf
  v_add_f32_dpp v33, v33, v33 row_ror:8 row_mask:0xf bank_mask:0xf
  buffer_store_dwordx2 v[32:33], v2, s[52:55], s94 offen sc1
L_wo_nofirst:
  v_and_b32 v2, 3, v1
  v_lshlrev_b32 v2, 3, v2
  v_bfe_i32 v16, s85, v2, 8
  s_and_b32 s3, s68, 3
  s_mul_i32 s4, s3, 4
  v_add3_u32 v3, v16, v1, s4
  v_and_b32 v3, 15, v3
  v_lshlrev_b32 v16, 17, v3
  s_add_u32 s9, s70, s68
  s_and_b32 s9, s9, 3
  s_lshl_b32 s77, s9, 11
  v_and_b32 v10, 7, v1
  v_lshrrev_b32 v3, 3, v1
  s_lshl_b32 s10, s9, 4
  v_add_u32 v3, s10, v3
  v_mul_u32_u24 v3, 2048, v3
  v_lshrrev_b32 v2, 3, v1
  v_and_b32 v2, 2, v2
  v_xor_b32 v2, v2, v10
  s_lshl_b32 s10, s69, 7
  v_add_u32 v3, s10, v3
  v_lshl_add_u32 v8, v2, 4, v3
  v_xor_b32 v2, 4, v2
  v_add_u32 v3, 16384, v3
  v_lshl_add_u32 v9, v2, 4, v3
  s_mov_b32 s40, s20
  s_and_b32 s41, s21, 0xffff
  s_mov_b32 s42, 2097152
  s_mov_b32 s43, 0x00020000
  v_readlane_b32 s74, v16, 0
  s_add_u32 m0, s77, 131072
  s_add_u32 s4, s74, 0
  buffer_load_dwordx4 v8, s[40:43], s4 offen lds
  s_add_u32 m0, s77, 132096
  s_nop 0
  buffer_load_dwordx4 v9, s[40:43], s4 offen lds
  v_readlane_b32 s74, v16, 1
  s_add_u32 m0, s77, 139264
  s_add_u32 s4, s74, 0
  buffer_load_dwordx4 v8, s[40:43], s4 offen lds
  s_add_u32 m0, s77, 140288
  s_nop 0
  buffer_load_dwordx4 v9, s[40:43], s4 offen lds
  v_readlane_b32 s74, v16, 2
  s_add_u32 m0, s77, 147456
  s_add_u32 s4, s74, 0
  buffer_load_dwordx4 v8, s[40:43], s4 offen lds
  s_add_u32 m0, s77, 148480
  s_nop 0
  buffer_load_dwordx4 v9, s[40:43], s4 offen lds
  v_readlane_b32 s74, v16, 3
  s_add_u32 m0, s77, 155648
  s_add_u32 s4, s74, 0
  buffer_load_dwordx4 v8, s[40:43], s4 offen lds
  s_add_u32 m0, s77, 156672
  s_nop 0
  buffer_load_dwordx4 v9, s[40:43], s4 offen lds
  v_readlane_b32 s74, v16, 4
  s_add_u32 m0, s77, 28672
  s_add_u32 s4, s74, 0
  buffer_load_dwordx4 v8, s[40:43], s4 offen lds
  s_add_u32 m0, s77, 29696
  s_nop 0
  buffer_load_dwordx4 v9, s[40:43], s4 offen lds
  v_readlane_b32 s74, v16, 5
  s_add_u32 m0, s77, 36864
  s_add_u32 s4, s74, 0
  buffer_load_dwordx4 v8, s[40:43], s4 offen lds
  s_add_u32 m0, s77, 37888
  s_nop 0
  buffer_load_dwordx4 v9, s[40:43], s4 offen lds
  s_waitcnt vmcnt(12)
  s_add_u32 s3, s96, s70
  s_cmp_lg_u32 s3, 4
  s_cbranch_scc1 L_wo_chk1
  v_cmp_ne_u32 vcc, 0x01010101, v12
  s_cbranch_vccz L_wo_chk1
  s_load_dwordx2 s[64:65], s[0:1], 72
  s_waitcnt lgkmcnt(0)
  s_and_b32 s65, s65, 0xffff
  s_mov_b32 s66, 256
  s_mov_b32 s67, 0x00020000
  v_lshlrev_b32 v17, 2, v1
  s_mov_b32 s79, 0x100000
L_wo_chkl:
  buffer_load_dword v12, v17, s[64:67], 0 offen sc1
  s_sub_u32 s79, s79, 1
  s_cbranch_scc1 L_wo_chk1
  s_waitcnt vmcnt(0)
  v_cmp_ne_u32 vcc, 0x01010101, v12
  s_cbranch_vccnz L_wo_chkl
L_wo_chk1:
  s_add_u32 s44, s22, 41943040
  s_addc_u32 s45, s23, 0
  s_and_b32 s45, s45, 0xffff
  s_mov_b32 s46, 524288
  s_mov_b32 s47, 0x00020000
  s_lshl4_add_u32 s3, s97, s68
  s_and_b32 s4, s69, 15
  s_lshl4_add_u32 s3, s3, s4
  s_lshl_b32 s3, s3, 7
  s_sub_u32 s3, s3, 32768
  v_lshlrev_b32 v11, 7, v1
  v_and_b32 v2, 15, v1
  v_lshlrev_b32 v2, 2, v2
  v_mov_b32 v3, 1
  s_mov_b32 s79, 0x100000
  s_cmp_lg_u32 s70, 4
  s_barrier
  s_cbranch_scc1 L_wo_nofl
  s_mov_b32 exec_lo, 0xffff
  s_mov_b32 exec_hi, 0
  buffer_store_dword v3, v11, s[44:47], s87 offen sc1
  s_mov_b64 exec, -1
L_wo_nofl:
  s_mov_b32 s5, s3
  v_readlane_b32 s74, v16, 6
  s_add_u32 m0, s77, 45056
  s_add_u32 s4, s74, 0
  buffer_load_dwordx4 v8, s[40:43], s4 offen lds
  s_add_u32 m0, s77, 46080
  s_nop 0
  buffer_load_dwordx4 v9, s[40:43], s4 offen lds
  v_readlane_b32 s74, v16, 7
  s_add_u32 m0, s77, 53248
  s_add_u32 s4, s74, 0
  buffer_load_dwordx4 v8, s[40:43], s4 offen lds
  s_add_u32 m0, s77, 54272
  s_nop 0
  buffer_load_dwordx4 v9, s[40:43], s4 offen lds
  v_readlane_b32 s74, v16, 8
  s_add_u32 m0, s77, 61440
  s_add_u32 s4, s74, 0
  buffer_load_dwordx4 v8, s[40:43], s4 offen lds
  s_add_u32 m0, s77, 62464
  s_nop 0
  buffer_load_dwordx4 v9, s[40:43], s4 offen lds
  v_readlane_b32 s74, v16, 9
  s_add_u32 m0, s77, 69632
  s_add_u32 s4, s74, 0
  buffer_load_dwordx4 v8, s[40:43], s4 offen lds
  s_add_u32 m0, s77, 70656
  s_nop 0
  buffer_load_dwordx4 v9, s[40:43], s4 offen lds
  v_readlane_b32 s74, v16, 10
  s_add_u32 m0, s77, 77824
  s_add_u32 s4, s74, 0
  buffer_load_dwordx4 v8, s[40:43], s4 offen lds
  s_add_u32 m0, s77, 78848
  s_nop 0
  buffer_load_dwordx4 v9, s[40:43], s4 offen lds
  v_readlane_b32 s74, v16, 11
  s_add_u32 m0, s77, 86016
  s_add_u32 s4, s74, 0
  buffer_load_dwordx4 v8, s[40:43], s4 offen lds
  s_add_u32 m0, s77, 87040
  s_nop 0
  buffer_load_dwordx4 v9, s[40:43], s4 offen lds
  v_readlane_b32 s74, v16, 12
  s_add_u32 m0, s77, 94208
  s_add_u32 s4, s74, 0
  buffer_load_dwordx4 v8, s[40:43], s4 offen lds
  s_add_u32 m0, s77, 95232
  s_nop 0
  buffer_load_dwordx4 v9, s[40:43], s4 offen lds
  v_readlane_b32 s74, v16, 13
  s_add_u32 m0, s77, 102400
  s_add_u32 s4, s74, 0
  buffer_load_dwordx4 v8, s[40:43], s4 offen lds
  s_add_u32 m0, s77, 103424
  s_nop 0
  buffer_load_dwordx4 v9, s[40:43], s4 offen lds
  v_readlane_b32 s74, v16, 14
  s_add_u32 m0, s77, 110592
  s_add_u32 s4, s74, 0
  buffer_load_dwordx4 v8, s[40:43], s4 offen lds
  s_add_u32 m0, s77, 111616
  s_nop 0
  buffer_load_dwordx4 v9, s[40:43], s4 offen lds
  v_readlane_b32 s74, v16, 15
  s_add_u32 m0, s77, 118784
  s_add_u32 s4, s74, 0
  buffer_load_dwordx4 v8, s[40:43], s4 offen lds
  s_add_u32 m0, s77, 119808
  s_nop 0
  buffer_load_dwordx4 v9, s[40:43], s4 offen lds
  s_mov_b32 s3, s5
  s_cmp_lg_u32 s70, 4
  s_cbranch_scc1 L_wo_dep
L_wo_poll:
  buffer_load_dword v3, v2, s[44:47], s3 offen sc1
  s_sub_u32 s79, s79, 1
  s_cbranch_scc1 L_wo_dep
  s_waitcnt vmcnt(0)
  v_cmp_ne_u32 vcc, 1, v3
  s_cbranch_vccnz L_wo_poll
L_wo_dep:
  s_waitcnt vmcnt(22) lgkmcnt(0)
  s_barrier
  s_waitcnt vmcnt(14)
  s_barrier
  s_waitcnt vmcnt(4)
  s_barrier
  s_waitcnt vmcnt(0)
  s_barrier
  s_waitcnt vmcnt(0)
  s_lshl_b32 s87, s97, 15
  s_lshl_b32 s4, s68, 11
  s_add_u32 s87, s87, s4
  s_lshl_b32 s4, s69, 2
  s_add_u32 s87, s87, s4
  s_add_u32 s97, s97, 1
  s_branch L_w1_body
L_wo_end:
  s_endpgm
L_wo_compute:
  v_and_b32 v2, 3, v1
  v_lshlrev_b32 v2, 3, v2
  v_bfe_i32 v15, s85, v2, 8
  s_and_b32 s3, s68, 3
  s_mul_i32 s4, s3, 4
  v_add3_u32 v3, v15, v1, s4
  v_and_b32 v3, 15, v3
  v_lshlrev_b32 v15, 11, v3
  v_and_b32 v3, 15, v1
  v_lshrrev_b32 v2, 4, v1
  s_lshl_b32 s8, s68, 7
  s_lshl_b32 s9, s70, 5
  s_add_u32 s8, s8, s9
  s_mul_i32 s9, s8, 2048
  v_lshl_add_u32 v4, v1, 4, s9
  v_add_u32 v5, 32768, v4
  v_add_u32 v13, s8, v3
  s_lshl_b32 s10, s69, 7
  v_lshl_add_u32 v14, v2, 3, s10
  v_and_b32 v16, 1, v2
  v_lshrrev_b32 v17, 1, v2
  v_lshl_add_u32 v16, v16, 1, v17
  v_lshlrev_b32 v16, 8, v16
  v_lshl_add_u32 v16, v3, 4, v16
  s_add_u32 s9, s8, s69
  s_lshl_b32 s9, s9, 11
  v_add_u32 v12, s9, v16
  v_lshl_add_u32 v18, v17, 4, v13
  v_lshlrev_b32 v18, 3, v18
  v_and_b32 v16, 1, v2
  v_lshl_add_u32 v18, v16, 2, v18
  s_lshl_b32 s10, s69, 14
  v_add_u32 v18, s10, v18
  v_bfe_u32 v6, v1, 2, 2
  v_lshl_add_u32 v6, v2, 3, v6
  v_lshlrev_b32 v6, 7, v6
  v_and_b32 v17, 3, v1
  v_lshl_add_u32 v6, v17, 3, v6
  v_bfe_u32 v17, v1, 3, 2
  v_lshl_add_u32 v6, v17, 5, v6
  v_xor_b32 v7, 32, v6
  v_xor_b32 v8, 64, v6
  v_xor_b32 v9, 96, v6
  s_mov_b32 s11, 0xffff0000
  s_mov_b32 s36, s34
  s_and_b32 s37, s35, 0xffff
  s_mov_b32 s38, 4194304
  s_mov_b32 s39, 0x00020000
  s_add_u32 s44, s34, 4194304
  s_addc_u32 s45, s35, 0
  s_and_b32 s45, s45, 0xffff
  s_mov_b32 s46, 4194304
  s_mov_b32 s47, 0x00020000
  s_add_u32 s56, s34, 24117248
  s_addc_u32 s57, s35, 0
  s_and_b32 s57, s57, 0xffff
  s_mov_b32 s58, 262144
  s_mov_b32 s59, 0x00020000
  s_mul_i32 s9, s8, 2048
  s_add_u32 s36, s36, s9
  s_addc_u32 s37, s37, 0x100000
  s_add_u32 s64, s36, 32768
  s_addc_u32 s65, s37, 0
  s_mov_b32 s38, 32768
  s_mov_b32 s39, 0x00800000
  s_mov_b32 s66, 32768
  s_mov_b32 s67, 0x00800000
  s_cmp_lg_u32 s96, 0
  s_cbranch_scc1 L_pfc2_skip
  s_getpc_b64 s[4:5]
L_pfc2:
  s_lshl_b32 s3, s99, 2
  s_add_u32 s3, s3, s70
  s_mul_i32 s3, s3, 128
  s_min_u32 s3, s3, L_w1_c1-L_w1_c0-128
  s_add_i32 s3, s3, L_w1_c0-L_pfc2
  s_ashr_i32 s6, s3, 31
  s_add_u32 s4, s4, s3
  s_addc_u32 s5, s5, s6
  s_load_dword s40, s[4:5], 0
  s_load_dword s41, s[4:5], 64
L_pfc2_skip:
  v_add_u32 v26, 155648, v6
  v_add_u32 v27, 155648, v7
  v_add_u32 v28, 155648, v8
  v_add_u32 v29, 155648, v9
  v_add_u32 v20, 94208, v6
  v_add_u32 v21, 94208, v7
  v_add_u32 v22, 94208, v8
  v_add_u32 v23, 94208, v9
  v_add_u32 v6, 28672, v6
  v_add_u32 v7, 28672, v7
  v_add_u32 v8, 28672, v8
  v_add_u32 v9, 28672, v9
  v_readlane_b32 s48, v15, 0
  v_readlane_b32 s49, v15, 1
  v_readlane_b32 s50, v15, 2
  v_permlane16_swap_b32 v240, v242
  v_permlane16_swap_b32 v241, v243
  v_permlane16_swap_b32 v244, v246
  v_permlane16_swap_b32 v245, v247
  v_permlane16_swap_b32 v248, v250
  v_permlane16_swap_b32 v249, v251
  v_permlane16_swap_b32 v252, v254
  v_permlane16_swap_b32 v253, v255
  s_waitcnt lgkmcnt(0)
  s_barrier
  buffer_load_dwordx4 v[32:35], off, s[36:39], s48 offset:0
  buffer_load_dwordx4 v[36:39], off, s[64:67], s48 offset:0
  buffer_load_dwordx4 v[40:43], off, s[36:39], s48 offset:1024
  buffer_load_dwordx4 v[44:47], off, s[64:67], s48 offset:1024
  buffer_load_dwordx4 v[48:51], off, s[36:39], s49 offset:0
  buffer_load_dwordx4 v[52:55], off, s[64:67], s49 offset:0
  buffer_load_dwordx4 v[56:59], off, s[36:39], s49 offset:1024
  buffer_load_dwordx4 v[60:63], off, s[64:67], s49 offset:1024
  buffer_load_dwordx4 v[64:67], off, s[36:39], s50 offset:0
  buffer_load_dwordx4 v[68:71], off, s[64:67], s50 offset:0
  buffer_load_dwordx4 v[72:75], off, s[36:39], s50 offset:1024
  buffer_load_dwordx4 v[76:79], off, s[64:67], s50 offset:1024
  ds_read_b64_tr_b16 v[160:161], v20 offset:36864
  ds_read_b64_tr_b16 v[162:163], v20 offset:37376
  ds_read_b64_tr_b16 v[164:165], v21 offset:36864
  ds_read_b64_tr_b16 v[166:167], v21 offset:37376
  ds_read_b64_tr_b16 v[168:169], v22 offset:36864
  ds_read_b64_tr_b16 v[170:171], v22 offset:37376
  ds_read_b64_tr_b16 v[172:173], v23 offset:36864
  ds_read_b64_tr_b16 v[174:175], v23 offset:37376
  ds_read_b64_tr_b16 v[176:177], v20 offset:40960
  ds_read_b64_tr_b16 v[178:179], v20 offset:41472
  ds_read_b64_tr_b16 v[180:181], v21 offset:40960
  ds_read_b64_tr_b16 v[182:183], v21 offset:41472
  ds_read_b64_tr_b16 v[184:185], v22 offset:40960
  ds_read_b64_tr_b16 v[186:187], v22 offset:41472
  ds_read_b64_tr_b16 v[188:189], v23 offset:40960
  ds_read_b64_tr_b16 v[190:191], v23 offset:41472
  v_lshlrev_b32 v96, 16, v240
  v_and_b32 v97, s11, v240
  v_lshlrev_b32 v98, 16, v241
  v_and_b32 v99, s11, v241
  v_lshlrev_b32 v100, 16, v248
  v_and_b32 v101, s11, v248
  v_lshlrev_b32 v102, 16, v249
  v_and_b32 v103, s11, v249
  v_lshlrev_b32 v104, 16, v242
  v_and_b32 v105, s11, v242
  v_lshlrev_b32 v106, 16, v243
  v_and_b32 v107, s11, v243
  v_lshlrev_b32 v108, 16, v250
  v_and_b32 v109, s11, v250
  v_lshlrev_b32 v110, 16, v251
  v_and_b32 v111, s11, v251
  v_lshlrev_b32 v112, 16, v244
  v_and_b32 v113, s11, v244
  v_lshlrev_b32 v114, 16, v245
  v_and_b32 v115, s11, v245
  v_lshlrev_b32 v116, 16, v252
  v_and_b32 v117, s11, v252
  v_lshlrev_b32 v118, 16, v253
  v_and_b32 v119, s11, v253
  v_lshlrev_b32 v120, 16, v246
  v_and_b32 v121, s11, v246
  v_lshlrev_b32 v122, 16, v247
  v_and_b32 v123, s11, v247
  v_lshlrev_b32 v124, 16, v254
  v_and_b32 v125, s11, v254
  v_lshlrev_b32 v126, 16, v255
  v_and_b32 v127, s11, v255
  s_waitcnt vmcnt(10) lgkmcnt(8)
  v_mfma_f32_16x16x32_bf16 v[96:99], v[160:163], v[32:35], v[96:99]
  ds_read_b64_tr_b16 v[192:193], v20 offset:45056
  v_readlane_b32 s51, v15, 3
  v_mfma_f32_16x16x32_bf16 v[100:103], v[160:163], v[36:39], v[100:103]
  ds_read_b64_tr_b16 v[194:195], v20 offset:45568
  v_mfma_f32_16x16x32_bf16 v[108:111], v[164:167], v[36:39], v[108:111]
  ds_read_b64_tr_b16 v[196:197], v21 offset:45056
  v_mfma_f32_16x16x32_bf16 v[104:107], v[164:167], v[32:35], v[104:107]
  buffer_load_dwordx4 v[80:83], off, s[36:39], s51 offset:0
  v_mfma_f32_16x16x32_bf16 v[112:115], v[168:171], v[32:35], v[112:115]
  ds_read_b64_tr_b16 v[198:199], v21 offset:45568
  ds_read_b64_tr_b16 v[200:201], v22 offset:45056
  v_mfma_f32_16x16x32_bf16 v[116:119], v[168:171], v[36:39], v[116:119]
  ds_read_b64_tr_b16 v[202:203], v22 offset:45568
  ds_read_b64_tr_b16 v[204:205], v23 offset:45056
  v_mfma_f32_16x16x32_bf16 v[124:127], v[172:175], v[36:39], v[124:127]
  buffer_load_dwordx4 v[84:87], off, s[64:67], s51 offset:0
  v_mfma_f32_16x16x32_bf16 v[120:123], v[172:175], v[32:35], v[120:123]
  ds_read_b64_tr_b16 v[206:207], v23 offset:45568
  s_waitcnt vmcnt(10) lgkmcnt(8)
  v_mfma_f32_16x16x32_bf16 v[96:99], v[176:179], v[40:43], v[96:99]
  ds_read_b64_tr_b16 v[208:209], v20 offset:49152
  v_mfma_f32_16x16x32_bf16 v[100:103], v[176:179], v[44:47], v[100:103]
  buffer_load_dwordx4 v[88:91], off, s[36:39], s51 offset:1024
  v_mfma_f32_16x16x32_bf16 v[108:111], v[180:183], v[44:47], v[108:111]
  ds_read_b64_tr_b16 v[210:211], v20 offset:49664
  ds_read_b64_tr_b16 v[212:213], v21 offset:49152
  v_mfma_f32_16x16x32_bf16 v[104:107], v[180:183], v[40:43], v[104:107]
  ds_read_b64_tr_b16 v[214:215], v21 offset:49664
  ds_read_b64_tr_b16 v[216:217], v22 offset:49152
  v_mfma_f32_16x16x32_bf16 v[112:115], v[184:187], v[40:43], v[112:115]
  buffer_load_dwordx4 v[92:95], off, s[64:67], s51 offset:1024
  v_mfma_f32_16x16x32_bf16 v[116:119], v[184:187], v[44:47], v[116:119]
  ds_read_b64_tr_b16 v[218:219], v22 offset:49664
  v_readlane_b32 s48, v15, 4
  v_mfma_f32_16x16x32_bf16 v[124:127], v[188:191], v[44:47], v[124:127]
  ds_read_b64_tr_b16 v[220:221], v23 offset:49152
  v_mfma_f32_16x16x32_bf16 v[120:123], v[188:191], v[40:43], v[120:123]
  ds_read_b64_tr_b16 v[222:223], v23 offset:49664
  s_waitcnt vmcnt(10) lgkmcnt(8)
  v_mfma_f32_16x16x32_bf16 v[96:99], v[192:195], v[48:51], v[96:99]
  buffer_load_dwordx4 v[32:35], off, s[36:39], s48 offset:0
  v_mfma_f32_16x16x32_bf16 v[100:103], v[192:195], v[52:55], v[100:103]
  ds_read_b64_tr_b16 v[160:161], v20 offset:53248
  ds_read_b64_tr_b16 v[162:163], v20 offset:53760
  v_mfma_f32_16x16x32_bf16 v[108:111], v[196:199], v[52:55], v[108:111]
  ds_read_b64_tr_b16 v[164:165], v21 offset:53248
  v_mfma_f32_16x16x32_bf16 v[104:107], v[196:199], v[48:51], v[104:107]
  buffer_load_dwordx4 v[36:39], off, s[64:67], s48 offset:0
  v_mfma_f32_16x16x32_bf16 v[112:115], v[200:203], v[48:51], v[112:115]
  ds_read_b64_tr_b16 v[166:167], v21 offset:53760
  ds_read_b64_tr_b16 v[168:169], v22 offset:53248
  v_mfma_f32_16x16x32_bf16 v[116:119], v[200:203], v[52:55], v[116:119]
  ds_read_b64_tr_b16 v[170:171], v22 offset:53760
  ds_read_b64_tr_b16 v[172:173], v23 offset:53248
  v_mfma_f32_16x16x32_bf16 v[124:127], v[204:207], v[52:55], v[124:127]
  buffer_load_dwordx4 v[40:43], off, s[36:39], s48 offset:1024
  v_mfma_f32_16x16x32_bf16 v[120:123], v[204:207], v[48:51], v[120:123]
  ds_read_b64_tr_b16 v[174:175], v23 offset:53760
  s_waitcnt vmcnt(11) lgkmcnt(8)
  v_mfma_f32_16x16x32_bf16 v[96:99], v[208:211], v[56:59], v[96:99]
  ds_read_b64_tr_b16 v[176:177], v20 offset:57344
  v_mfma_f32_16x16x32_bf16 v[100:103], v[208:211], v[60:63], v[100:103]
  buffer_load_dwordx4 v[44:47], off, s[64:67], s48 offset:1024
  v_mfma_f32_16x16x32_bf16 v[108:111], v[212:215], v[60:63], v[108:111]
  ds_read_b64_tr_b16 v[178:179], v20 offset:57856
  ds_read_b64_tr_b16 v[180:181], v21 offset:57344
  v_mfma_f32_16x16x32_bf16 v[104:107], v[212:215], v[56:59], v[104:107]
  ds_read_b64_tr_b16 v[182:183], v21 offset:57856
  v_mfma_f32_16x16x32_bf16 v[112:115], v[216:219], v[56:59], v[112:115]
  ds_read_b64_tr_b16 v[184:185], v22 offset:57344
  v_mfma_f32_16x16x32_bf16 v[116:119], v[216:219], v[60:63], v[116:119]
  ds_read_b64_tr_b16 v[186:187], v22 offset:57856
  v_readlane_b32 s49, v15, 5
  v_mfma_f32_16x16x32_bf16 v[124:127], v[220:223], v[60:63], v[124:127]
  ds_read_b64_tr_b16 v[188:189], v23 offset:57344
  v_mfma_f32_16x16x32_bf16 v[120:123], v[220:223], v[56:59], v[120:123]
  ds_read_b64_tr_b16 v[190:191], v23 offset:57856
  s_waitcnt vmcnt(10) lgkmcnt(8)
  v_mfma_f32_16x16x32_bf16 v[96:99], v[160:163], v[64:67], v[96:99]
  buffer_load_dwordx4 v[48:51], off, s[36:39], s49 offset:0
  v_mfma_f32_16x16x32_bf16 v[100:103], v[160:163], v[68:71], v[100:103]
  ds_read_b64_tr_b16 v[192:193], v26 offset:0
  ds_read_b64_tr_b16 v[194:195], v26 offset:512
  v_mfma_f32_16x16x32_bf16 v[108:111], v[164:167], v[68:71], v[108:111]
  ds_read_b64_tr_b16 v[196:197], v27 offset:0
  v_mfma_f32_16x16x32_bf16 v[104:107], v[164:167], v[64:67], v[104:107]
  buffer_load_dwordx4 v[52:55], off, s[64:67], s49 offset:0
  v_mfma_f32_16x16x32_bf16 v[112:115], v[168:171], v[64:67], v[112:115]
  ds_read_b64_tr_b16 v[198:199], v27 offset:512
  ds_read_b64_tr_b16 v[200:201], v28 offset:0
  v_mfma_f32_16x16x32_bf16 v[116:119], v[168:171], v[68:71], v[116:119]
  ds_read_b64_tr_b16 v[202:203], v28 offset:512
  ds_read_b64_tr_b16 v[204:205], v29 offset:0
  v_mfma_f32_16x16x32_bf16 v[124:127], v[172:175], v[68:71], v[124:127]
  buffer_load_dwordx4 v[56:59], off, s[36:39], s49 offset:1024
  v_mfma_f32_16x16x32_bf16 v[120:123], v[172:175], v[64:67], v[120:123]
  ds_read_b64_tr_b16 v[206:207], v29 offset:512
  s_waitcnt vmcnt(11) lgkmcnt(8)
  v_mfma_f32_16x16x32_bf16 v[96:99], v[176:179], v[72:75], v[96:99]
  ds_read_b64_tr_b16 v[208:209], v26 offset:4096
  v_mfma_f32_16x16x32_bf16 v[100:103], v[176:179], v[76:79], v[100:103]
  buffer_load_dwordx4 v[60:63], off, s[64:67], s49 offset:1024
  v_mfma_f32_16x16x32_bf16 v[108:111], v[180:183], v[76:79], v[108:111]
  ds_read_b64_tr_b16 v[210:211], v26 offset:4608
  ds_read_b64_tr_b16 v[212:213], v27 offset:4096
  v_mfma_f32_16x16x32_bf16 v[104:107], v[180:183], v[72:75], v[104:107]
  ds_read_b64_tr_b16 v[214:215], v27 offset:4608
  v_mfma_f32_16x16x32_bf16 v[112:115], v[184:187], v[72:75], v[112:115]
  ds_read_b64_tr_b16 v[216:217], v28 offset:4096
  v_mfma_f32_16x16x32_bf16 v[116:119], v[184:187], v[76:79], v[116:119]
  ds_read_b64_tr_b16 v[218:219], v28 offset:4608
  v_readlane_b32 s50, v15, 6
  v_mfma_f32_16x16x32_bf16 v[124:127], v[188:191], v[76:79], v[124:127]
  ds_read_b64_tr_b16 v[220:221], v29 offset:4096
  v_mfma_f32_16x16x32_bf16 v[120:123], v[188:191], v[72:75], v[120:123]
  ds_read_b64_tr_b16 v[222:223], v29 offset:4608
  s_waitcnt vmcnt(10) lgkmcnt(8)
  v_mfma_f32_16x16x32_bf16 v[96:99], v[192:195], v[80:83], v[96:99]
  buffer_load_dwordx4 v[64:67], off, s[36:39], s50 offset:0
  v_mfma_f32_16x16x32_bf16 v[100:103], v[192:195], v[84:87], v[100:103]
  ds_read_b64_tr_b16 v[160:161], v6 offset:0
  ds_read_b64_tr_b16 v[162:163], v6 offset:512
  v_mfma_f32_16x16x32_bf16 v[108:111], v[196:199], v[84:87], v[108:111]
  ds_read_b64_tr_b16 v[164:165], v7 offset:0
  v_mfma_f32_16x16x32_bf16 v[104:107], v[196:199], v[80:83], v[104:107]
  buffer_load_dwordx4 v[68:71], off, s[64:67], s50 offset:0
  v_mfma_f32_16x16x32_bf16 v[112:115], v[200:203], v[80:83], v[112:115]
  ds_read_b64_tr_b16 v[166:167], v7 offset:512
  ds_read_b64_tr_b16 v[168:169], v8 offset:0
  v_mfma_f32_16x16x32_bf16 v[116:119], v[200:203], v[84:87], v[116:119]
  ds_read_b64_tr_b16 v[170:171], v8 offset:512
  ds_read_b64_tr_b16 v[172:173], v9 offset:0
  v_mfma_f32_16x16x32_bf16 v[124:127], v[204:207], v[84:87], v[124:127]
  buffer_load_dwordx4 v[72:75], off, s[36:39], s50 offset:1024
  v_mfma_f32_16x16x32_bf16 v[120:123], v[204:207], v[80:83], v[120:123]
  ds_read_b64_tr_b16 v[174:175], v9 offset:512
  s_waitcnt vmcnt(11) lgkmcnt(8)
  s_barrier
  v_mfma_f32_16x16x32_bf16 v[96:99], v[208:211], v[88:91], v[96:99]
  ds_read_b64_tr_b16 v[176:177], v6 offset:4096
  v_mfma_f32_16x16x32_bf16 v[100:103], v[208:211], v[92:95], v[100:103]
  buffer_load_dwordx4 v[76:79], off, s[64:67], s50 offset:1024
  v_mfma_f32_16x16x32_bf16 v[108:111], v[212:215], v[92:95], v[108:111]
  ds_read_b64_tr_b16 v[178:179], v6 offset:4608
  ds_read_b64_tr_b16 v[180:181], v7 offset:4096
  v_mfma_f32_16x16x32_bf16 v[104:107], v[212:215], v[88:91], v[104:107]
  ds_read_b64_tr_b16 v[182:183], v7 offset:4608
  v_mfma_f32_16x16x32_bf16 v[112:115], v[216:219], v[88:91], v[112:115]
  ds_read_b64_tr_b16 v[184:185], v8 offset:4096
  v_mfma_f32_16x16x32_bf16 v[116:119], v[216:219], v[92:95], v[116:119]
  ds_read_b64_tr_b16 v[186:187], v8 offset:4608
  v_readlane_b32 s51, v15, 7
  v_mfma_f32_16x16x32_bf16 v[124:127], v[220:223], v[92:95], v[124:127]
  ds_read_b64_tr_b16 v[188:189], v9 offset:4096
  v_mfma_f32_16x16x32_bf16 v[120:123], v[220:223], v[88:91], v[120:123]
  ds_read_b64_tr_b16 v[190:191], v9 offset:4608
  s_waitcnt vmcnt(10) lgkmcnt(8)
  v_mfma_f32_16x16x32_bf16 v[96:99], v[160:163], v[32:35], v[96:99]
  buffer_load_dwordx4 v[80:83], off, s[36:39], s51 offset:0
  v_mfma_f32_16x16x32_bf16 v[100:103], v[160:163], v[36:39], v[100:103]
  ds_read_b64_tr_b16 v[192:193], v6 offset:8192
  ds_read_b64_tr_b16 v[194:195], v6 offset:8704
  v_mfma_f32_16x16x32_bf16 v[108:111], v[164:167], v[36:39], v[108:111]
  ds_read_b64_tr_b16 v[196:197], v7 offset:8192
  v_mfma_f32_16x16x32_bf16 v[104:107], v[164:167], v[32:35], v[104:107]
  buffer_load_dwordx4 v[84:87], off, s[64:67], s51 offset:0
  v_mfma_f32_16x16x32_bf16 v[112:115], v[168:171], v[32:35], v[112:115]
  ds_read_b64_tr_b16 v[198:199], v7 offset:8704
  ds_read_b64_tr_b16 v[200:201], v8 offset:8192
  v_mfma_f32_16x16x32_bf16 v[116:119], v[168:171], v[36:39], v[116:119]
  ds_read_b64_tr_b16 v[202:203], v8 offset:8704
  ds_read_b64_tr_b16 v[204:205], v9 offset:8192
  v_mfma_f32_16x16x32_bf16 v[124:127], v[172:175], v[36:39], v[124:127]
  buffer_load_dwordx4 v[88:91], off, s[36:39], s51 offset:1024
  v_mfma_f32_16x16x32_bf16 v[120:123], v[172:175], v[32:35], v[120:123]
  ds_read_b64_tr_b16 v[206:207], v9 offset:8704
  s_waitcnt vmcnt(11) lgkmcnt(8)
  v_mfma_f32_16x16x32_bf16 v[96:99], v[176:179], v[40:43], v[96:99]
  ds_read_b64_tr_b16 v[208:209], v6 offset:12288
  v_mfma_f32_16x16x32_bf16 v[100:103], v[176:179], v[44:47], v[100:103]
  buffer_load_dwordx4 v[92:95], off, s[64:67], s51 offset:1024
  v_mfma_f32_16x16x32_bf16 v[108:111], v[180:183], v[44:47], v[108:111]
  ds_read_b64_tr_b16 v[210:211], v6 offset:12800
  ds_read_b64_tr_b16 v[212:213], v7 offset:12288
  v_mfma_f32_16x16x32_bf16 v[104:107], v[180:183], v[40:43], v[104:107]
  ds_read_b64_tr_b16 v[214:215], v7 offset:12800
  v_mfma_f32_16x16x32_bf16 v[112:115], v[184:187], v[40:43], v[112:115]
  ds_read_b64_tr_b16 v[216:217], v8 offset:12288
  v_mfma_f32_16x16x32_bf16 v[116:119], v[184:187], v[44:47], v[116:119]
  ds_read_b64_tr_b16 v[218:219], v8 offset:12800
  v_readlane_b32 s48, v15, 8
  v_mfma_f32_16x16x32_bf16 v[124:127], v[188:191], v[44:47], v[124:127]
  ds_read_b64_tr_b16 v[220:221], v9 offset:12288
  v_mfma_f32_16x16x32_bf16 v[120:123], v[188:191], v[40:43], v[120:123]
  ds_read_b64_tr_b16 v[222:223], v9 offset:12800
  s_waitcnt vmcnt(10) lgkmcnt(8)
  v_mfma_f32_16x16x32_bf16 v[96:99], v[192:195], v[48:51], v[96:99]
  buffer_load_dwordx4 v[32:35], off, s[36:39], s48 offset:0
  v_mfma_f32_16x16x32_bf16 v[100:103], v[192:195], v[52:55], v[100:103]
  ds_read_b64_tr_b16 v[160:161], v6 offset:16384
  ds_read_b64_tr_b16 v[162:163], v6 offset:16896
  v_mfma_f32_16x16x32_bf16 v[108:111], v[196:199], v[52:55], v[108:111]
  ds_read_b64_tr_b16 v[164:165], v7 offset:16384
  v_mfma_f32_16x16x32_bf16 v[104:107], v[196:199], v[48:51], v[104:107]
  buffer_load_dwordx4 v[36:39], off, s[64:67], s48 offset:0
  v_mfma_f32_16x16x32_bf16 v[112:115], v[200:203], v[48:51], v[112:115]
  ds_read_b64_tr_b16 v[166:167], v7 offset:16896
  ds_read_b64_tr_b16 v[168:169], v8 offset:16384
  v_mfma_f32_16x16x32_bf16 v[116:119], v[200:203], v[52:55], v[116:119]
  ds_read_b64_tr_b16 v[170:171], v8 offset:16896
  ds_read_b64_tr_b16 v[172:173], v9 offset:16384
  v_mfma_f32_16x16x32_bf16 v[124:127], v[204:207], v[52:55], v[124:127]
  buffer_load_dwordx4 v[40:43], off, s[36:39], s48 offset:1024
  v_mfma_f32_16x16x32_bf16 v[120:123], v[204:207], v[48:51], v[120:123]
  ds_read_b64_tr_b16 v[174:175], v9 offset:16896
  s_waitcnt vmcnt(11) lgkmcnt(8)
  v_mfma_f32_16x16x32_bf16 v[96:99], v[208:211], v[56:59], v[96:99]
  ds_read_b64_tr_b16 v[176:177], v6 offset:20480
  v_mfma_f32_16x16x32_bf16 v[100:103], v[208:211], v[60:63], v[100:103]
  buffer_load_dwordx4 v[44:47], off, s[64:67], s48 offset:1024
  v_mfma_f32_16x16x32_bf16 v[108:111], v[212:215], v[60:63], v[108:111]
  ds_read_b64_tr_b16 v[178:179], v6 offset:20992
  ds_read_b64_tr_b16 v[180:181], v7 offset:20480
  v_mfma_f32_16x16x32_bf16 v[104:107], v[212:215], v[56:59], v[104:107]
  ds_read_b64_tr_b16 v[182:183], v7 offset:20992
  v_mfma_f32_16x16x32_bf16 v[112:115], v[216:219], v[56:59], v[112:115]
  ds_read_b64_tr_b16 v[184:185], v8 offset:20480
  v_mfma_f32_16x16x32_bf16 v[116:119], v[216:219], v[60:63], v[116:119]
  ds_read_b64_tr_b16 v[186:187], v8 offset:20992
  v_readlane_b32 s49, v15, 9
  v_mfma_f32_16x16x32_bf16 v[124:127], v[220:223], v[60:63], v[124:127]
  ds_read_b64_tr_b16 v[188:189], v9 offset:20480
  v_mfma_f32_16x16x32_bf16 v[120:123], v[220:223], v[56:59], v[120:123]
  ds_read_b64_tr_b16 v[190:191], v9 offset:20992
  s_waitcnt vmcnt(10) lgkmcnt(8)
  v_mfma_f32_16x16x32_bf16 v[96:99], v[160:163], v[64:67], v[96:99]
  buffer_load_dwordx4 v[48:51], off, s[36:39], s49 offset:0
  v_mfma_f32_16x16x32_bf16 v[100:103], v[160:163], v[68:71], v[100:103]
  ds_read_b64_tr_b16 v[192:193], v6 offset:24576
  ds_read_b64_tr_b16 v[194:195], v6 offset:25088
  v_mfma_f32_16x16x32_bf16 v[108:111], v[164:167], v[68:71], v[108:111]
  ds_read_b64_tr_b16 v[196:197], v7 offset:24576
  v_mfma_f32_16x16x32_bf16 v[104:107], v[164:167], v[64:67], v[104:107]
  buffer_load_dwordx4 v[52:55], off, s[64:67], s49 offset:0
  v_mfma_f32_16x16x32_bf16 v[112:115], v[168:171], v[64:67], v[112:115]
  ds_read_b64_tr_b16 v[198:199], v7 offset:25088
  ds_read_b64_tr_b16 v[200:201], v8 offset:24576
  v_mfma_f32_16x16x32_bf16 v[116:119], v[168:171], v[68:71], v[116:119]
  ds_read_b64_tr_b16 v[202:203], v8 offset:25088
  ds_read_b64_tr_b16 v[204:205], v9 offset:24576
  v_mfma_f32_16x16x32_bf16 v[124:127], v[172:175], v[68:71], v[124:127]
  buffer_load_dwordx4 v[56:59], off, s[36:39], s49 offset:1024
  v_mfma_f32_16x16x32_bf16 v[120:123], v[172:175], v[64:67], v[120:123]
  ds_read_b64_tr_b16 v[206:207], v9 offset:25088
  s_waitcnt vmcnt(11) lgkmcnt(8)
  v_mfma_f32_16x16x32_bf16 v[96:99], v[176:179], v[72:75], v[96:99]
  ds_read_b64_tr_b16 v[208:209], v6 offset:28672
  v_mfma_f32_16x16x32_bf16 v[100:103], v[176:179], v[76:79], v[100:103]
  buffer_load_dwordx4 v[60:63], off, s[64:67], s49 offset:1024
  v_mfma_f32_16x16x32_bf16 v[108:111], v[180:183], v[76:79], v[108:111]
  ds_read_b64_tr_b16 v[210:211], v6 offset:29184
  ds_read_b64_tr_b16 v[212:213], v7 offset:28672
  v_mfma_f32_16x16x32_bf16 v[104:107], v[180:183], v[72:75], v[104:107]
  ds_read_b64_tr_b16 v[214:215], v7 offset:29184
  v_mfma_f32_16x16x32_bf16 v[112:115], v[184:187], v[72:75], v[112:115]
  ds_read_b64_tr_b16 v[216:217], v8 offset:28672
  v_mfma_f32_16x16x32_bf16 v[116:119], v[184:187], v[76:79], v[116:119]
  ds_read_b64_tr_b16 v[218:219], v8 offset:29184
  v_readlane_b32 s50, v15, 10
  v_mfma_f32_16x16x32_bf16 v[124:127], v[188:191], v[76:79], v[124:127]
  ds_read_b64_tr_b16 v[220:221], v9 offset:28672
  v_mfma_f32_16x16x32_bf16 v[120:123], v[188:191], v[72:75], v[120:123]
  ds_read_b64_tr_b16 v[222:223], v9 offset:29184
  s_waitcnt vmcnt(10) lgkmcnt(8)
  v_mfma_f32_16x16x32_bf16 v[96:99], v[192:195], v[80:83], v[96:99]
  buffer_load_dwordx4 v[64:67], off, s[36:39], s50 offset:0
  v_mfma_f32_16x16x32_bf16 v[100:103], v[192:195], v[84:87], v[100:103]
  ds_read_b64_tr_b16 v[160:161], v6 offset:32768
  ds_read_b64_tr_b16 v[162:163], v6 offset:33280
  v_mfma_f32_16x16x32_bf16 v[108:111], v[196:199], v[84:87], v[108:111]
  ds_read_b64_tr_b16 v[164:165], v7 offset:32768
  v_mfma_f32_16x16x32_bf16 v[104:107], v[196:199], v[80:83], v[104:107]
  buffer_load_dwordx4 v[68:71], off, s[64:67], s50 offset:0
  v_mfma_f32_16x16x32_bf16 v[112:115], v[200:203], v[80:83], v[112:115]
  ds_read_b64_tr_b16 v[166:167], v7 offset:33280
  ds_read_b64_tr_b16 v[168:169], v8 offset:32768
  v_mfma_f32_16x16x32_bf16 v[116:119], v[200:203], v[84:87], v[116:119]
  ds_read_b64_tr_b16 v[170:171], v8 offset:33280
  ds_read_b64_tr_b16 v[172:173], v9 offset:32768
  v_mfma_f32_16x16x32_bf16 v[124:127], v[204:207], v[84:87], v[124:127]
  buffer_load_dwordx4 v[72:75], off, s[36:39], s50 offset:1024
  v_mfma_f32_16x16x32_bf16 v[120:123], v[204:207], v[80:83], v[120:123]
  ds_read_b64_tr_b16 v[174:175], v9 offset:33280
  s_waitcnt vmcnt(11) lgkmcnt(8)
  s_barrier
  v_mfma_f32_16x16x32_bf16 v[96:99], v[208:211], v[88:91], v[96:99]
  ds_read_b64_tr_b16 v[176:177], v6 offset:36864
  v_mfma_f32_16x16x32_bf16 v[100:103], v[208:211], v[92:95], v[100:103]
  buffer_load_dwordx4 v[76:79], off, s[64:67], s50 offset:1024
  v_mfma_f32_16x16x32_bf16 v[108:111], v[212:215], v[92:95], v[108:111]
  ds_read_b64_tr_b16 v[178:179], v6 offset:37376
  ds_read_b64_tr_b16 v[180:181], v7 offset:36864
  v_mfma_f32_16x16x32_bf16 v[104:107], v[212:215], v[88:91], v[104:107]
  ds_read_b64_tr_b16 v[182:183], v7 offset:37376
  v_mfma_f32_16x16x32_bf16 v[112:115], v[216:219], v[88:91], v[112:115]
  ds_read_b64_tr_b16 v[184:185], v8 offset:36864
  v_mfma_f32_16x16x32_bf16 v[116:119], v[216:219], v[92:95], v[116:119]
  ds_read_b64_tr_b16 v[186:187], v8 offset:37376
  v_readlane_b32 s51, v15, 11
  v_mfma_f32_16x16x32_bf16 v[124:127], v[220:223], v[92:95], v[124:127]
  ds_read_b64_tr_b16 v[188:189], v9 offset:36864
  v_mfma_f32_16x16x32_bf16 v[120:123], v[220:223], v[88:91], v[120:123]
  ds_read_b64_tr_b16 v[190:191], v9 offset:37376
  s_waitcnt vmcnt(10) lgkmcnt(8)
  v_mfma_f32_16x16x32_bf16 v[96:99], v[160:163], v[32:35], v[96:99]
  buffer_load_dwordx4 v[80:83], off, s[36:39], s51 offset:0
  v_mfma_f32_16x16x32_bf16 v[100:103], v[160:163], v[36:39], v[100:103]
  ds_read_b64_tr_b16 v[192:193], v6 offset:40960
  ds_read_b64_tr_b16 v[194:195], v6 offset:41472
  v_mfma_f32_16x16x32_bf16 v[108:111], v[164:167], v[36:39], v[108:111]
  ds_read_b64_tr_b16 v[196:197], v7 offset:40960
  v_mfma_f32_16x16x32_bf16 v[104:107], v[164:167], v[32:35], v[104:107]
  buffer_load_dwordx4 v[84:87], off, s[64:67], s51 offset:0
  v_mfma_f32_16x16x32_bf16 v[112:115], v[168:171], v[32:35], v[112:115]
  ds_read_b64_tr_b16 v[198:199], v7 offset:41472
  ds_read_b64_tr_b16 v[200:201], v8 offset:40960
  v_mfma_f32_16x16x32_bf16 v[116:119], v[168:171], v[36:39], v[116:119]
  ds_read_b64_tr_b16 v[202:203], v8 offset:41472
  ds_read_b64_tr_b16 v[204:205], v9 offset:40960
  v_mfma_f32_16x16x32_bf16 v[124:127], v[172:175], v[36:39], v[124:127]
  buffer_load_dwordx4 v[88:91], off, s[36:39], s51 offset:1024
  v_mfma_f32_16x16x32_bf16 v[120:123], v[172:175], v[32:35], v[120:123]
  ds_read_b64_tr_b16 v[206:207], v9 offset:41472
  s_waitcnt vmcnt(11) lgkmcnt(8)
  v_mfma_f32_16x16x32_bf16 v[96:99], v[176:179], v[40:43], v[96:99]
  ds_read_b64_tr_b16 v[208:209], v6 offset:45056
  v_mfma_f32_16x16x32_bf16 v[100:103], v[176:179], v[44:47], v[100:103]
  buffer_load_dwordx4 v[92:95], off, s[64:67], s51 offset:1024
  v_mfma_f32_16x16x32_bf16 v[108:111], v[180:183], v[44:47], v[108:111]
  ds_read_b64_tr_b16 v[210:211], v6 offset:45568
  ds_read_b64_tr_b16 v[212:213], v7 offset:45056
  v_mfma_f32_16x16x32_bf16 v[104:107], v[180:183], v[40:43], v[104:107]
  ds_read_b64_tr_b16 v[214:215], v7 offset:45568
  v_mfma_f32_16x16x32_bf16 v[112:115], v[184:187], v[40:43], v[112:115]
  ds_read_b64_tr_b16 v[216:217], v8 offset:45056
  v_mfma_f32_16x16x32_bf16 v[116:119], v[184:187], v[44:47], v[116:119]
  ds_read_b64_tr_b16 v[218:219], v8 offset:45568
  v_readlane_b32 s48, v15, 12
  v_mfma_f32_16x16x32_bf16 v[124:127], v[188:191], v[44:47], v[124:127]
  ds_read_b64_tr_b16 v[220:221], v9 offset:45056
  v_mfma_f32_16x16x32_bf16 v[120:123], v[188:191], v[40:43], v[120:123]
  ds_read_b64_tr_b16 v[222:223], v9 offset:45568
  s_waitcnt vmcnt(10) lgkmcnt(8)
  v_mfma_f32_16x16x32_bf16 v[96:99], v[192:195], v[48:51], v[96:99]
  buffer_load_dwordx4 v[32:35], off, s[36:39], s48 offset:0
  v_mfma_f32_16x16x32_bf16 v[100:103], v[192:195], v[52:55], v[100:103]
  ds_read_b64_tr_b16 v[160:161], v6 offset:49152
  ds_read_b64_tr_b16 v[162:163], v6 offset:49664
  v_mfma_f32_16x16x32_bf16 v[108:111], v[196:199], v[52:55], v[108:111]
  ds_read_b64_tr_b16 v[164:165], v7 offset:49152
  v_mfma_f32_16x16x32_bf16 v[104:107], v[196:199], v[48:51], v[104:107]
  buffer_load_dwordx4 v[36:39], off, s[64:67], s48 offset:0
  v_mfma_f32_16x16x32_bf16 v[112:115], v[200:203], v[48:51], v[112:115]
  ds_read_b64_tr_b16 v[166:167], v7 offset:49664
  ds_read_b64_tr_b16 v[168:169], v8 offset:49152
  v_mfma_f32_16x16x32_bf16 v[116:119], v[200:203], v[52:55], v[116:119]
  ds_read_b64_tr_b16 v[170:171], v8 offset:49664
  ds_read_b64_tr_b16 v[172:173], v9 offset:49152
  v_mfma_f32_16x16x32_bf16 v[124:127], v[204:207], v[52:55], v[124:127]
  buffer_load_dwordx4 v[40:43], off, s[36:39], s48 offset:1024
  v_mfma_f32_16x16x32_bf16 v[120:123], v[204:207], v[48:51], v[120:123]
  ds_read_b64_tr_b16 v[174:175], v9 offset:49664
  s_waitcnt vmcnt(11) lgkmcnt(8)
  v_mfma_f32_16x16x32_bf16 v[96:99], v[208:211], v[56:59], v[96:99]
  ds_read_b64_tr_b16 v[176:177], v6 offset:53248
  v_mfma_f32_16x16x32_bf16 v[100:103], v[208:211], v[60:63], v[100:103]
  buffer_load_dwordx4 v[44:47], off, s[64:67], s48 offset:1024
  v_mfma_f32_16x16x32_bf16 v[108:111], v[212:215], v[60:63], v[108:111]
  ds_read_b64_tr_b16 v[178:179], v6 offset:53760
  ds_read_b64_tr_b16 v[180:181], v7 offset:53248
  v_mfma_f32_16x16x32_bf16 v[104:107], v[212:215], v[56:59], v[104:107]
  ds_read_b64_tr_b16 v[182:183], v7 offset:53760
  v_mfma_f32_16x16x32_bf16 v[112:115], v[216:219], v[56:59], v[112:115]
  ds_read_b64_tr_b16 v[184:185], v8 offset:53248
  v_mfma_f32_16x16x32_bf16 v[116:119], v[216:219], v[60:63], v[116:119]
  ds_read_b64_tr_b16 v[186:187], v8 offset:53760
  v_readlane_b32 s49, v15, 13
  v_mfma_f32_16x16x32_bf16 v[124:127], v[220:223], v[60:63], v[124:127]
  ds_read_b64_tr_b16 v[188:189], v9 offset:53248
  v_mfma_f32_16x16x32_bf16 v[120:123], v[220:223], v[56:59], v[120:123]
  ds_read_b64_tr_b16 v[190:191], v9 offset:53760
  s_waitcnt vmcnt(10) lgkmcnt(8)
  v_mfma_f32_16x16x32_bf16 v[96:99], v[160:163], v[64:67], v[96:99]
  buffer_load_dwordx4 v[48:51], off, s[36:39], s49 offset:0
  v_mfma_f32_16x16x32_bf16 v[100:103], v[160:163], v[68:71], v[100:103]
  ds_read_b64_tr_b16 v[192:193], v6 offset:57344
  ds_read_b64_tr_b16 v[194:195], v6 offset:57856
  v_mfma_f32_16x16x32_bf16 v[108:111], v[164:167], v[68:71], v[108:111]
  ds_read_b64_tr_b16 v[196:197], v7 offset:57344
  v_mfma_f32_16x16x32_bf16 v[104:107], v[164:167], v[64:67], v[104:107]
  buffer_load_dwordx4 v[52:55], off, s[64:67], s49 offset:0
  v_mfma_f32_16x16x32_bf16 v[112:115], v[168:171], v[64:67], v[112:115]
  ds_read_b64_tr_b16 v[198:199], v7 offset:57856
  ds_read_b64_tr_b16 v[200:201], v8 offset:57344
  v_mfma_f32_16x16x32_bf16 v[116:119], v[168:171], v[68:71], v[116:119]
  ds_read_b64_tr_b16 v[202:203], v8 offset:57856
  ds_read_b64_tr_b16 v[204:205], v9 offset:57344
  v_mfma_f32_16x16x32_bf16 v[124:127], v[172:175], v[68:71], v[124:127]
  buffer_load_dwordx4 v[56:59], off, s[36:39], s49 offset:1024
  v_mfma_f32_16x16x32_bf16 v[120:123], v[172:175], v[64:67], v[120:123]
  ds_read_b64_tr_b16 v[206:207], v9 offset:57856
  s_waitcnt vmcnt(11) lgkmcnt(8)
  v_mfma_f32_16x16x32_bf16 v[96:99], v[176:179], v[72:75], v[96:99]
  ds_read_b64_tr_b16 v[208:209], v6 offset:61440
  v_mfma_f32_16x16x32_bf16 v[100:103], v[176:179], v[76:79], v[100:103]
  buffer_load_dwordx4 v[60:63], off, s[64:67], s49 offset:1024
  v_mfma_f32_16x16x32_bf16 v[108:111], v[180:183], v[76:79], v[108:111]
  ds_read_b64_tr_b16 v[210:211], v6 offset:61952
  ds_read_b64_tr_b16 v[212:213], v7 offset:61440
  v_mfma_f32_16x16x32_bf16 v[104:107], v[180:183], v[72:75], v[104:107]
  ds_read_b64_tr_b16 v[214:215], v7 offset:61952
  v_mfma_f32_16x16x32_bf16 v[112:115], v[184:187], v[72:75], v[112:115]
  ds_read_b64_tr_b16 v[216:217], v8 offset:61440
  v_mfma_f32_16x16x32_bf16 v[116:119], v[184:187], v[76:79], v[116:119]
  ds_read_b64_tr_b16 v[218:219], v8 offset:61952
  v_readlane_b32 s50, v15, 14
  v_mfma_f32_16x16x32_bf16 v[124:127], v[188:191], v[76:79], v[124:127]
  ds_read_b64_tr_b16 v[220:221], v9 offset:61440
  v_mfma_f32_16x16x32_bf16 v[120:123], v[188:191], v[72:75], v[120:123]
  ds_read_b64_tr_b16 v[222:223], v9 offset:61952
  s_waitcnt vmcnt(10) lgkmcnt(8)
  v_mfma_f32_16x16x32_bf16 v[96:99], v[192:195], v[80:83], v[96:99]
  buffer_load_dwordx4 v[64:67], off, s[36:39], s50 offset:0
  v_mfma_f32_16x16x32_bf16 v[100:103], v[192:195], v[84:87], v[100:103]
  ds_read_b64_tr_b16 v[160:161], v20 offset:0
  ds_read_b64_tr_b16 v[162:163], v20 offset:512
  v_mfma_f32_16x16x32_bf16 v[108:111], v[196:199], v[84:87], v[108:111]
  ds_read_b64_tr_b16 v[164:165], v21 offset:0
  v_mfma_f32_16x16x32_bf16 v[104:107], v[196:199], v[80:83], v[104:107]
  buffer_load_dwordx4 v[68:71], off, s[64:67], s50 offset:0
  v_mfma_f32_16x16x32_bf16 v[112:115], v[200:203], v[80:83], v[112:115]
  ds_read_b64_tr_b16 v[166:167], v21 offset:512
  ds_read_b64_tr_b16 v[168:169], v22 offset:0
  v_mfma_f32_16x16x32_bf16 v[116:119], v[200:203], v[84:87], v[116:119]
  ds_read_b64_tr_b16 v[170:171], v22 offset:512
  ds_read_b64_tr_b16 v[172:173], v23 offset:0
  v_mfma_f32_16x16x32_bf16 v[124:127], v[204:207], v[84:87], v[124:127]
  buffer_load_dwordx4 v[72:75], off, s[36:39], s50 offset:1024
  v_mfma_f32_16x16x32_bf16 v[120:123], v[204:207], v[80:83], v[120:123]
  ds_read_b64_tr_b16 v[174:175], v23 offset:512
  s_waitcnt vmcnt(11) lgkmcnt(8)
  v_mfma_f32_16x16x32_bf16 v[96:99], v[208:211], v[88:91], v[96:99]
  ds_read_b64_tr_b16 v[176:177], v20 offset:4096
  v_mfma_f32_16x16x32_bf16 v[100:103], v[208:211], v[92:95], v[100:103]
  buffer_load_dwordx4 v[76:79], off, s[64:67], s50 offset:1024
  v_mfma_f32_16x16x32_bf16 v[108:111], v[212:215], v[92:95], v[108:111]
  ds_read_b64_tr_b16 v[178:179], v20 offset:4608
  ds_read_b64_tr_b16 v[180:181], v21 offset:4096
  v_mfma_f32_16x16x32_bf16 v[104:107], v[212:215], v[88:91], v[104:107]
  ds_read_b64_tr_b16 v[182:183], v21 offset:4608
  v_mfma_f32_16x16x32_bf16 v[112:115], v[216:219], v[88:91], v[112:115]
  ds_read_b64_tr_b16 v[184:185], v22 offset:4096
  v_mfma_f32_16x16x32_bf16 v[116:119], v[216:219], v[92:95], v[116:119]
  ds_read_b64_tr_b16 v[186:187], v22 offset:4608
  v_readlane_b32 s51, v15, 15
  v_mfma_f32_16x16x32_bf16 v[124:127], v[220:223], v[92:95], v[124:127]
  ds_read_b64_tr_b16 v[188:189], v23 offset:4096
  v_mfma_f32_16x16x32_bf16 v[120:123], v[220:223], v[88:91], v[120:123]
  ds_read_b64_tr_b16 v[190:191], v23 offset:4608
  s_waitcnt vmcnt(10) lgkmcnt(8)
  v_mfma_f32_16x16x32_bf16 v[96:99], v[160:163], v[32:35], v[96:99]
  buffer_load_dwordx4 v[80:83], off, s[36:39], s51 offset:0
  v_mfma_f32_16x16x32_bf16 v[100:103], v[160:163], v[36:39], v[100:103]
  ds_read_b64_tr_b16 v[192:193], v20 offset:8192
  ds_read_b64_tr_b16 v[194:195], v20 offset:8704
  v_mfma_f32_16x16x32_bf16 v[108:111], v[164:167], v[36:39], v[108:111]
  ds_read_b64_tr_b16 v[196:197], v21 offset:8192
  v_mfma_f32_16x16x32_bf16 v[104:107], v[164:167], v[32:35], v[104:107]
  buffer_load_dwordx4 v[84:87], off, s[64:67], s51 offset:0
  v_mfma_f32_16x16x32_bf16 v[112:115], v[168:171], v[32:35], v[112:115]
  ds_read_b64_tr_b16 v[198:199], v21 offset:8704
  ds_read_b64_tr_b16 v[200:201], v22 offset:8192
  v_mfma_f32_16x16x32_bf16 v[116:119], v[168:171], v[36:39], v[116:119]
  ds_read_b64_tr_b16 v[202:203], v22 offset:8704
  ds_read_b64_tr_b16 v[204:205], v23 offset:8192
  v_mfma_f32_16x16x32_bf16 v[124:127], v[172:175], v[36:39], v[124:127]
  buffer_load_dwordx4 v[88:91], off, s[36:39], s51 offset:1024
  v_mfma_f32_16x16x32_bf16 v[120:123], v[172:175], v[32:35], v[120:123]
  ds_read_b64_tr_b16 v[206:207], v23 offset:8704
  s_waitcnt vmcnt(11) lgkmcnt(8)
  s_barrier
  v_mfma_f32_16x16x32_bf16 v[96:99], v[176:179], v[40:43], v[96:99]
  ds_read_b64_tr_b16 v[208:209], v20 offset:12288
  v_mfma_f32_16x16x32_bf16 v[100:103], v[176:179], v[44:47], v[100:103]
  buffer_load_dwordx4 v[92:95], off, s[64:67], s51 offset:1024
  v_mfma_f32_16x16x32_bf16 v[108:111], v[180:183], v[44:47], v[108:111]
  ds_read_b64_tr_b16 v[210:211], v20 offset:12800
  ds_read_b64_tr_b16 v[212:213], v21 offset:12288
  v_mfma_f32_16x16x32_bf16 v[104:107], v[180:183], v[40:43], v[104:107]
  ds_read_b64_tr_b16 v[214:215], v21 offset:12800
  v_mfma_f32_16x16x32_bf16 v[112:115], v[184:187], v[40:43], v[112:115]
  ds_read_b64_tr_b16 v[216:217], v22 offset:12288
  v_mfma_f32_16x16x32_bf16 v[116:119], v[184:187], v[44:47], v[116:119]
  ds_read_b64_tr_b16 v[218:219], v22 offset:12800
  v_mfma_f32_16x16x32_bf16 v[124:127], v[188:191], v[44:47], v[124:127]
  ds_read_b64_tr_b16 v[220:221], v23 offset:12288
  v_mfma_f32_16x16x32_bf16 v[120:123], v[188:191], v[40:43], v[120:123]
  ds_read_b64_tr_b16 v[222:223], v23 offset:12800
  s_waitcnt vmcnt(10) lgkmcnt(8)
  v_mfma_f32_16x16x32_bf16 v[96:99], v[192:195], v[48:51], v[96:99]
  ds_read_b64_tr_b16 v[160:161], v20 offset:16384
  v_mfma_f32_16x16x32_bf16 v[100:103], v[192:195], v[52:55], v[100:103]
  ds_read_b64_tr_b16 v[162:163], v20 offset:16896
  v_mfma_f32_16x16x32_bf16 v[108:111], v[196:199], v[52:55], v[108:111]
  ds_read_b64_tr_b16 v[164:165], v21 offset:16384
  v_mfma_f32_16x16x32_bf16 v[104:107], v[196:199], v[48:51], v[104:107]
  ds_read_b64_tr_b16 v[166:167], v21 offset:16896
  v_mfma_f32_16x16x32_bf16 v[112:115], v[200:203], v[48:51], v[112:115]
  ds_read_b64_tr_b16 v[168:169], v22 offset:16384
  v_mfma_f32_16x16x32_bf16 v[116:119], v[200:203], v[52:55], v[116:119]
  ds_read_b64_tr_b16 v[170:171], v22 offset:16896
  v_mfma_f32_16x16x32_bf16 v[124:127], v[204:207], v[52:55], v[124:127]
  ds_read_b64_tr_b16 v[172:173], v23 offset:16384
  v_mfma_f32_16x16x32_bf16 v[120:123], v[204:207], v[48:51], v[120:123]
  ds_read_b64_tr_b16 v[174:175], v23 offset:16896
  s_waitcnt vmcnt(8) lgkmcnt(8)
  v_mfma_f32_16x16x32_bf16 v[96:99], v[208:211], v[56:59], v[96:99]
  ds_read_b64_tr_b16 v[176:177], v20 offset:20480
  v_mfma_f32_16x16x32_bf16 v[100:103], v[208:211], v[60:63], v[100:103]
  ds_read_b64_tr_b16 v[178:179], v20 offset:20992
  v_mfma_f32_16x16x32_bf16 v[108:111], v[212:215], v[60:63], v[108:111]
  ds_read_b64_tr_b16 v[180:181], v21 offset:20480
  v_mfma_f32_16x16x32_bf16 v[104:107], v[212:215], v[56:59], v[104:107]
  ds_read_b64_tr_b16 v[182:183], v21 offset:20992
  v_mfma_f32_16x16x32_bf16 v[112:115], v[216:219], v[56:59], v[112:115]
  ds_read_b64_tr_b16 v[184:185], v22 offset:20480
  v_mfma_f32_16x16x32_bf16 v[116:119], v[216:219], v[60:63], v[116:119]
  ds_read_b64_tr_b16 v[186:187], v22 offset:20992
  v_mfma_f32_16x16x32_bf16 v[124:127], v[220:223], v[60:63], v[124:127]
  ds_read_b64_tr_b16 v[188:189], v23 offset:20480
  v_mfma_f32_16x16x32_bf16 v[120:123], v[220:223], v[56:59], v[120:123]
  ds_read_b64_tr_b16 v[190:191], v23 offset:20992
  s_waitcnt vmcnt(6) lgkmcnt(8)
  v_mfma_f32_16x16x32_bf16 v[96:99], v[160:163], v[64:67], v[96:99]
  ds_read_b64_tr_b16 v[192:193], v20 offset:24576
  v_mfma_f32_16x16x32_bf16 v[100:103], v[160:163], v[68:71], v[100:103]
  ds_read_b64_tr_b16 v[194:195], v20 offset:25088
  v_mfma_f32_16x16x32_bf16 v[108:111], v[164:167], v[68:71], v[108:111]
  ds_read_b64_tr_b16 v[196:197], v21 offset:24576
  v_mfma_f32_16x16x32_bf16 v[104:107], v[164:167], v[64:67], v[104:107]
  ds_read_b64_tr_b16 v[198:199], v21 offset:25088
  v_mfma_f32_16x16x32_bf16 v[112:115], v[168:171], v[64:67], v[112:115]
  ds_read_b64_tr_b16 v[200:201], v22 offset:24576
  v_mfma_f32_16x16x32_bf16 v[116:119], v[168:171], v[68:71], v[116:119]
  ds_read_b64_tr_b16 v[202:203], v22 offset:25088
  v_mfma_f32_16x16x32_bf16 v[124:127], v[172:175], v[68:71], v[124:127]
  ds_read_b64_tr_b16 v[204:205], v23 offset:24576
  v_mfma_f32_16x16x32_bf16 v[120:123], v[172:175], v[64:67], v[120:123]
  ds_read_b64_tr_b16 v[206:207], v23 offset:25088
  s_waitcnt vmcnt(4) lgkmcnt(8)
  v_mfma_f32_16x16x32_bf16 v[96:99], v[176:179], v[72:75], v[96:99]
  ds_read_b64_tr_b16 v[208:209], v20 offset:28672
  v_mfma_f32_16x16x32_bf16 v[100:103], v[176:179], v[76:79], v[100:103]
  ds_read_b64_tr_b16 v[210:211], v20 offset:29184
  v_mfma_f32_16x16x32_bf16 v[108:111], v[180:183], v[76:79], v[108:111]
  ds_read_b64_tr_b16 v[212:213], v21 offset:28672
  v_mfma_f32_16x16x32_bf16 v[104:107], v[180:183], v[72:75], v[104:107]
  ds_read_b64_tr_b16 v[214:215], v21 offset:29184
  v_mfma_f32_16x16x32_bf16 v[112:115], v[184:187], v[72:75], v[112:115]
  ds_read_b64_tr_b16 v[216:217], v22 offset:28672
  v_mfma_f32_16x16x32_bf16 v[116:119], v[184:187], v[76:79], v[116:119]
  ds_read_b64_tr_b16 v[218:219], v22 offset:29184
  v_mfma_f32_16x16x32_bf16 v[124:127], v[188:191], v[76:79], v[124:127]
  ds_read_b64_tr_b16 v[220:221], v23 offset:28672
  v_mfma_f32_16x16x32_bf16 v[120:123], v[188:191], v[72:75], v[120:123]
  ds_read_b64_tr_b16 v[222:223], v23 offset:29184
  s_waitcnt vmcnt(2) lgkmcnt(8)
  v_mfma_f32_16x16x32_bf16 v[96:99], v[192:195], v[80:83], v[96:99]
  v_mov_b32 v20, 0
  v_mov_b32 v21, 0
  v_mfma_f32_16x16x32_bf16 v[100:103], v[192:195], v[84:87], v[100:103]
  v_mov_b32 v22, 0
  v_mov_b32 v23, 0
  v_mfma_f32_16x16x32_bf16 v[108:111], v[196:199], v[84:87], v[108:111]
  v_mfma_f32_16x16x32_bf16 v[104:107], v[196:199], v[80:83], v[104:107]
  v_mfma_f32_16x16x32_bf16 v[112:115], v[200:203], v[80:83], v[112:115]
  v_mfma_f32_16x16x32_bf16 v[116:119], v[200:203], v[84:87], v[116:119]
  v_mfma_f32_16x16x32_bf16 v[124:127], v[204:207], v[84:87], v[124:127]
  v_mfma_f32_16x16x32_bf16 v[120:123], v[204:207], v[80:83], v[120:123]
  s_waitcnt vmcnt(0) lgkmcnt(0)
  v_mfma_f32_16x16x32_bf16 v[96:99], v[208:211], v[88:91], v[96:99]
  v_mfma_f32_16x16x32_bf16 v[100:103], v[208:211], v[92:95], v[100:103]
  v_mfma_f32_16x16x32_bf16 v[108:111], v[212:215], v[92:95], v[108:111]
  v_mfma_f32_16x16x32_bf16 v[104:107], v[212:215], v[88:91], v[104:107]
  v_mfma_f32_16x16x32_bf16 v[112:115], v[216:219], v[88:91], v[112:115]
  v_mfma_f32_16x16x32_bf16 v[116:119], v[216:219], v[92:95], v[116:119]
  v_mfma_f32_16x16x32_bf16 v[124:127], v[220:223], v[92:95], v[124:127]
  v_mfma_f32_16x16x32_bf16 v[120:123], v[220:223], v[88:91], v[120:123]
  s_mov_b32 s3, 32768
  s_mov_b32 s10, 0x3f803f80
  s_nop 4
  v_cvt_pk_bf16_f32 v240, v96, v97
  v_cvt_pk_bf16_f32 v241, v98, v99
  v_cvt_pk_bf16_f32 v242, v104, v105
  v_cvt_pk_bf16_f32 v243, v106, v107
  s_nop 1
  v_permlane16_swap_b32 v240, v242
  v_permlane16_swap_b32 v241, v243
  buffer_store_dwordx4 v[240:243], v12, s[44:47], 0 offen offset:0 sc1
  v_cvt_pk_bf16_f32 v244, v112, v113
  v_cvt_pk_bf16_f32 v245, v114, v115
  v_cvt_pk_bf16_f32 v246, v120, v121
  v_cvt_pk_bf16_f32 v247, v122, v123
  s_nop 1
  v_permlane16_swap_b32 v244, v246
  v_permlane16_swap_b32 v245, v247
  buffer_store_dwordx4 v[244:247], v12, s[44:47], 0 offen offset:1024 sc1
  v_cvt_pk_bf16_f32 v248, v100, v101
  v_cvt_pk_bf16_f32 v249, v102, v103
  v_cvt_pk_bf16_f32 v250, v108, v109
  v_cvt_pk_bf16_f32 v251, v110, v111
  s_nop 1
  v_permlane16_swap_b32 v248, v250
  v_permlane16_swap_b32 v249, v251
  buffer_store_dwordx4 v[248:251], v12, s[44:47], s3 offen offset:0 sc1
  v_cvt_pk_bf16_f32 v252, v116, v117
  v_cvt_pk_bf16_f32 v253, v118, v119
  v_cvt_pk_bf16_f32 v254, v124, v125
  v_cvt_pk_bf16_f32 v255, v126, v127
  s_nop 1
  v_permlane16_swap_b32 v252, v254
  v_permlane16_swap_b32 v253, v255
  buffer_store_dwordx4 v[252:255], v12, s[44:47], s3 offen offset:1024 sc1
  v_dot2_f32_bf16 v20, v240, s10, v20
  v_dot2_f32_bf16 v22, v240, v240, v22
  v_dot2_f32_bf16 v20, v241, s10, v20
  v_dot2_f32_bf16 v22, v241, v241, v22
  v_dot2_f32_bf16 v20, v242, s10, v20
  v_dot2_f32_bf16 v22, v242, v242, v22
  v_dot2_f32_bf16 v20, v243, s10, v20
  v_dot2_f32_bf16 v22, v243, v243, v22
  v_dot2_f32_bf16 v20, v244, s10, v20
  v_dot2_f32_bf16 v22, v244, v244, v22
  v_dot2_f32_bf16 v20, v245, s10, v20
  v_dot2_f32_bf16 v22, v245, v245, v22
  v_dot2_f32_bf16 v20, v246, s10, v20
  v_dot2_f32_bf16 v22, v246, v246, v22
  v_dot2_f32_bf16 v20, v247, s10, v20
  v_dot2_f32_bf16 v22, v247, v247, v22
  v_dot2_f32_bf16 v21, v248, s10, v21
  v_dot2_f32_bf16 v23, v248, v248, v23
  v_dot2_f32_bf16 v21, v249, s10, v21
  v_dot2_f32_bf16 v23, v249, v249, v23
  v_dot2_f32_bf16 v21, v250, s10, v21
  v_dot2_f32_bf16 v23, v250, v250, v23
  v_dot2_f32_bf16 v21, v251, s10, v21
  v_dot2_f32_bf16 v23, v251, v251, v23
  v_dot2_f32_bf16 v21, v252, s10, v21
  v_dot2_f32_bf16 v23, v252, v252, v23
  v_dot2_f32_bf16 v21, v253, s10, v21
  v_dot2_f32_bf16 v23, v253, v253, v23
  v_dot2_f32_bf16 v21, v254, s10, v21
  v_dot2_f32_bf16 v23, v254, v254, v23
  v_dot2_f32_bf16 v21, v255, s10, v21
  v_dot2_f32_bf16 v23, v255, v255, v23
  s_nop 2
  v_permlane32_swap_b32 v20, v21
  v_permlane32_swap_b32 v22, v23
  v_add_f32 v20, v20, v21
  v_add_f32 v22, v22, v23
  s_nop 1
  v_permlane16_swap_b32 v20, v22
  v_add_f32 v20, v20, v22
  buffer_store_dword v20, v18, s[56:59], 0 offen sc1
  s_waitcnt vmcnt(0) lgkmcnt(0)
  s_barrier
  s_add_u32 s97, s97, 1
  s_branch L_w1_body
L_wo_c1:
L_w1_c0:
L_w1_body:
  s_cmp_ge_u32 s2, 256
  s_cbranch_scc1 L_w1_end
  v_lshrrev_b32 v2, 6, v0
  v_and_b32 v1, 63, v0
  v_readfirstlane_b32 s70, v2
  s_and_b32 s3, s2, 7
  s_lshr_b32 s99, s2, 3
  s_and_b32 s5, s3, 1
  s_lshl_b32 s5, s5, 3
  s_and_b32 s6, s99, 7
  s_add_u32 s68, s5, s6
  s_lshr_b32 s5, s3, 1
  s_lshl_b32 s5, s5, 2
  s_lshr_b32 s6, s99, 3
  s_add_u32 s69, s5, s6
  s_cmp_lt_u32 s70, 4
  s_cbranch_scc1 L_w1_compute
L_w1_loader:
  s_add_u32 s8, s70, s69
  s_and_b32 s8, s8, 3
  s_add_u32 s9, s70, s68
  s_and_b32 s9, s9, 3
  s_lshl_b32 s76, s8, 12
  s_lshl_b32 s77, s9, 11
  s_add_u32 s77, s77, 16384
  s_lshl_b32 s11, s68, 7
  v_and_b32 v10, 7, v1
  s_lshr_b32 s10, s76, 11
  s_lshl_b32 s3, s68, 3
  s_add_u32 s10, s10, s3
  s_mul_i32 s10, s10, 32768
  v_lshl_add_u32 v4, v1, 4, s10
  v_add_u32 v5, 32768, v4
  v_lshrrev_b32 v3, 3, v1
  s_lshl_b32 s10, s9, 4
  v_add_u32 v3, s10, v3
  v_mul_u32_u24 v3, 7168, v3
  v_lshrrev_b32 v2, 3, v1
  v_and_b32 v2, 2, v2
  v_xor_b32 v2, v2, v10
  s_mul_i32 s10, s69, 128
  v_add_u32 v3, s10, v3
  v_lshl_add_u32 v8, v2, 4, v3
  v_xor_b32 v2, 4, v2
  v_add_u32 v3, 57344, v3
  v_lshl_add_u32 v9, v2, 4, v3
  v_lshrrev_b32 v3, 2, v1
  s_lshl_b32 s10, s9, 4
  v_add_u32 v3, s10, v3
  v_mul_u32_u24 v3, 7168, v3
  v_lshrrev_b32 v2, 4, v1
  v_and_b32 v2, 2, v2
  v_xor_b32 v2, v2, v1
  v_and_b32 v2, 3, v2
  s_lshl_b32 s10, s69, 6
  s_add_u32 s10, s10, 2048
  v_add_u32 v3, s10, v3
  v_lshl_add_u32 v28, v2, 4, v3
  s_lshl_b32 s78, s69, 7
  s_add_u32 s78, s78, 3072
  s_mov_b32 s75, 0
  s_add_u32 s100, s68, s69
  s_mov_b32 s101, -1
  s_add_u32 s101, s101, 1
  s_sub_u32 s73, s101, s100
  s_lshl_b32 s73, s73, 3
  s_lshr_b32 s73, 0xf0f02, s73
  s_and_b32 s73, s73, 255
  s_add_u32 s73, s73, s101
  s_and_b32 s73, s73, 15
  s_mul_i32 s74, s73, 458752
  s_lshl_b32 s73, s73, 11
  s_waitcnt lgkmcnt(0)
  s_add_u32 s36, s34, 4194304
  s_addc_u32 s37, s35, 0
  s_and_b32 s37, s37, 0xffff
  s_mov_b32 s38, 4194304
  s_mov_b32 s39, 0x00020000
  s_mov_b32 s40, s24
  s_and_b32 s41, s25, 0xffff
  s_mov_b32 s42, 7340032
  s_mov_b32 s43, 0x00020000
  s_add_u32 s56, s34, 24117248
  s_addc_u32 s57, s35, 0
  s_and_b32 s57, s57, 0xffff
  s_mov_b32 s58, 262144
  s_mov_b32 s59, 0x00020000
  s_add_u32 s64, s22, 24641536
  s_addc_u32 s65, s23, 0
  s_and_b32 s65, s65, 0xffff
  s_mov_b32 s66, 262144
  s_mov_b32 s67, 0x00020000
  s_mov_b32 s52, s26
  s_and_b32 s53, s27, 0xffff
  s_mov_b32 s54, 7168
  s_mov_b32 s55, 0x00020000
  s_and_b32 s3, s70, 3
  s_lshl2_add_u32 s4, s68, s3
  s_lshl_b32 s4, s4, 8
  v_lshrrev_b32 v2, 4, v1
  v_and_b32 v3, 15, v1
  v_lshl_add_u32 v3, v3, 4, s4
  v_lshl_add_u32 v18, v2, 14, v3
  s_lshl_b32 s4, s69, 7
  s_lshl_b32 s5, s70, 6
  s_add_u32 s4, s4, s5
  s_add_u32 s4, s4, 1216
  s_lshl_b32 s5, s69, 6
  s_cmp_eq_u32 s70, 4
  s_cselect_b32 s4, s5, s4
  s_lshr_b32 s5, s5, 1
  s_add_u32 s5, s5, 1024
  s_cmp_eq_u32 s70, 7
  s_cselect_b32 s4, s5, s4
  v_and_b32 v3, 15, v1
  v_lshl_add_u32 v3, v3, 2, s4
  v_lshrrev_b32 v2, 4, v1
  v_add_lshl_u32 v23, v3, v2, 1
  v_lshlrev_b32 v3, 2, v3
  v_lshl_add_u32 v22, v2, 14, v3
  s_mov_b32 s60, s28
  s_and_b32 s61, s29, 0xffff
  s_mov_b32 s62, 7340032
  s_mov_b32 s63, 0x00020000
  s_cmp_eq_u32 s96, 0
  s_cselect_b32 s62, s62, 0
  s_and_b32 s3, s70, 3
  s_lshl_b32 s4, s2, 2
  s_add_u32 s3, s3, s4
  s_mul_i32 s98, s3, 3584
  s_add_u32 s98, s98, 3670016
  s_add_u32 s3, s96, s70
  s_cmp_lg_u32 s3, 4
  s_cbranch_scc1 L_w1_chkNone
  s_add_u32 s44, s22, 41943040
  s_addc_u32 s45, s23, 0
  s_and_b32 s45, s45, 0xffff
  s_mov_b32 s46, 524288
  s_mov_b32 s47, 0x00020000
  v_lshrrev_b32 v2, 2, v1
  v_and_b32 v3, 3, v1
  v_lshlrev_b32 v2, 11, v2
  v_lshl_add_u32 v17, v3, 4, v2
  s_and_b32 s3, s69, 15
  s_lshl_b32 s3, s3, 7
  s_mov_b32 s79, 0x100000
L_w1_chkl:
  buffer_load_dwordx4 v[12:15], v17, s[44:47], s3 offen sc1
  s_sub_u32 s79, s79, 1
  s_cbranch_scc1 L_w1_chkNone
  s_waitcnt vmcnt(0)
  v_and_b32 v12, v12, v13
  v_and_b32 v14, v14, v15
  v_and_b32 v12, v12, v14
  v_cmp_ne_u32 vcc, 1, v12
  s_cbranch_vccnz L_w1_chkl
L_w1_chkNone:
  s_mov_b32 s75, 98304
  s_add_u32 s44, s22, 41943040
  s_addc_u32 s45, s23, 0
  s_and_b32 s45, s45, 0xffff
  s_mov_b32 s46, 524288
  s_mov_b32 s47, 0x00020000
  s_lshl4_add_u32 s3, s97, s68
  s_and_b32 s4, s69, 15
  s_lshl4_add_u32 s3, s3, s4
  s_lshl_b32 s3, s3, 7
  s_sub_u32 s3, s3, 32768
  v_lshlrev_b32 v11, 7, v1
  v_and_b32 v2, 15, v1
  v_lshlrev_b32 v2, 2, v2
  v_mov_b32 v3, 1
  s_mov_b32 s79, 0x100000
  s_cmp_lg_u32 s70, 4
  s_barrier
  s_cbranch_scc1 L_w1_nofl
  s_mov_b32 exec_lo, 0xffff
  s_mov_b32 exec_hi, 0
  buffer_store_dword v3, v11, s[44:47], s87 offen sc1
  s_mov_b64 exec, -1
L_w1_nofl:
  s_mov_b32 s5, s3
  s_mov_b32 s88, s73
  s_add_u32 m0, s77, 0
  s_add_u32 s4, s74, 0
  buffer_load_dwordx4 v8, s[40:43], s4 offen lds
  s_add_u32 m0, s77, 1024
  s_nop 0
  buffer_load_dwordx4 v9, s[40:43], s4 offen lds
  s_add_u32 m0, s77, 8192
  s_add_u32 s4, s74, s78
  buffer_load_dwordx4 v8, s[40:43], s4 offen lds
  s_add_u32 m0, s77, 9216
  s_nop 0
  buffer_load_dwordx4 v9, s[40:43], s4 offen lds
  s_add_u32 m0, s77, 16384
  s_add_u32 s4, s4, 128
  buffer_load_dwordx4 v8, s[40:43], s4 offen lds
  s_add_u32 m0, s77, 17408
  s_nop 0
  buffer_load_dwordx4 v9, s[40:43], s4 offen lds
  s_add_u32 m0, s77, 24576
  s_nop 0
  buffer_load_dwordx4 v28, s[40:43], s74 offen lds
  s_add_u32 s101, s101, 1
  s_sub_u32 s73, s101, s100
  s_lshl_b32 s73, s73, 3
  s_lshr_b32 s73, 0xf0f02, s73
  s_and_b32 s73, s73, 255
  s_add_u32 s73, s73, s101
  s_and_b32 s73, s73, 15
  s_mul_i32 s74, s73, 458752
  s_lshl_b32 s73, s73, 11
  s_mov_b32 s89, s73
  s_add_u32 m0, s77, 49152
  s_add_u32 s4, s74, 0
  buffer_load_dwordx4 v8, s[40:43], s4 offen lds
  s_add_u32 m0, s77, 50176
  s_nop 0
  buffer_load_dwordx4 v9, s[40:43], s4 offen lds
  s_add_u32 m0, s77, 57344
  s_add_u32 s4, s74, s78
  buffer_load_dwordx4 v8, s[40:43], s4 offen lds
  s_add_u32 m0, s77, 58368
  s_nop 0
  buffer_load_dwordx4 v9, s[40:43], s4 offen lds
  s_add_u32 m0, s77, 65536
  s_add_u32 s4, s4, 128
  buffer_load_dwordx4 v8, s[40:43], s4 offen lds
  s_add_u32 m0, s77, 66560
  s_nop 0
  buffer_load_dwordx4 v9, s[40:43], s4 offen lds
  s_add_u32 m0, s77, 73728
  s_nop 0
  buffer_load_dwordx4 v28, s[40:43], s74 offen lds
  s_add_u32 s101, s101, 1
  s_sub_u32 s73, s101, s100
  s_lshl_b32 s73, s73, 3
  s_lshr_b32 s73, 0xf0f02, s73
  s_and_b32 s73, s73, 255
  s_add_u32 s73, s73, s101
  s_and_b32 s73, s73, 15
  s_mul_i32 s74, s73, 458752
  s_lshl_b32 s73, s73, 11
  s_mov_b32 s3, s5
  s_cmp_lg_u32 s70, 4
  s_cbranch_scc1 L_w1_dep
L_w1_poll:
  buffer_load_dword v3, v2, s[44:47], s3 offen sc1
  s_sub_u32 s79, s79, 1
  s_cbranch_scc1 L_w1_dep
  s_waitcnt vmcnt(0)
  v_cmp_ne_u32 vcc, 1, v3
  s_cbranch_vccnz L_w1_poll
L_w1_dep:
  s_barrier
  s_add_u32 m0, s76, 0
  s_nop 0
  buffer_load_dwordx4 v4, s[36:39], s88 offen offset:0 lds
  buffer_load_dwordx4 v4, s[36:39], s88 offen offset:1024 lds
  s_add_u32 m0, s76, 2048
  s_nop 0
  buffer_load_dwordx4 v5, s[36:39], s88 offen offset:0 lds
  buffer_load_dwordx4 v5, s[36:39], s88 offen offset:1024 lds
  s_add_u32 m0, s76, 49152
  s_nop 0
  buffer_load_dwordx4 v4, s[36:39], s89 offen offset:0 lds
  buffer_load_dwordx4 v4, s[36:39], s89 offen offset:1024 lds
  s_add_u32 m0, s76, 51200
  s_nop 0
  buffer_load_dwordx4 v5, s[36:39], s89 offen offset:0 lds
  buffer_load_dwordx4 v5, s[36:39], s89 offen offset:1024 lds
  s_waitcnt vmcnt(4)
  s_barrier
  s_mov_b32 s79, 14
L_w1_ld1:
  s_add_u32 s3, s75, s76
  s_add_u32 m0, s3, 0
  s_nop 0
  buffer_load_dwordx4 v4, s[36:39], s73 offen offset:0 lds
  buffer_load_dwordx4 v4, s[36:39], s73 offen offset:1024 lds
  s_add_u32 m0, s3, 2048
  s_nop 0
  buffer_load_dwordx4 v5, s[36:39], s73 offen offset:0 lds
  buffer_load_dwordx4 v5, s[36:39], s73 offen offset:1024 lds
  s_add_u32 s3, s75, s77
  s_add_u32 m0, s3, 0
  s_add_u32 s4, s74, 0
  buffer_load_dwordx4 v8, s[40:43], s4 offen lds
  s_add_u32 m0, s3, 1024
  s_nop 0
  buffer_load_dwordx4 v9, s[40:43], s4 offen lds
  s_add_u32 m0, s3, 8192
  s_add_u32 s4, s74, s78
  buffer_load_dwordx4 v8, s[40:43], s4 offen lds
  s_add_u32 m0, s3, 9216
  s_nop 0
  buffer_load_dwordx4 v9, s[40:43], s4 offen lds
  s_add_u32 m0, s3, 16384
  s_add_u32 s4, s4, 128
  buffer_load_dwordx4 v8, s[40:43], s4 offen lds
  s_add_u32 m0, s3, 17408
  s_nop 0
  buffer_load_dwordx4 v9, s[40:43], s4 offen lds
  s_add_u32 m0, s3, 24576
  s_nop 0
  buffer_load_dwordx4 v28, s[40:43], s74 offen lds
  s_add_u32 s101, s101, 1
  s_sub_u32 s73, s101, s100
  s_lshl_b32 s73, s73, 3
  s_lshr_b32 s73, 0xf0f02, s73
  s_and_b32 s73, s73, 255
  s_add_u32 s73, s73, s101
  s_and_b32 s73, s73, 15
  s_mul_i32 s74, s73, 458752
  s_lshl_b32 s73, s73, 11
  s_add_u32 s75, s75, 49152
  s_cmp_eq_u32 s75, 147456
  s_cselect_b32 s75, 0, s75
  s_buffer_load_dword s84, s[60:63], s98 offset:0
  s_buffer_load_dword s84, s[60:63], s98 offset:64
  s_buffer_load_dword s84, s[60:63], s98 offset:128
  s_buffer_load_dword s84, s[60:63], s98 offset:192
  s_add_u32 s98, s98, 256
  s_waitcnt vmcnt(11)
  s_barrier
  s_sub_u32 s79, s79, 1
  s_cmp_lg_u32 s79, 0
  s_cbranch_scc1 L_w1_ld1
  buffer_load_dwordx4 v[64:67], v22, s[64:67], 0 offen
  s_mov_b32 s3, 65536
  buffer_load_dwordx4 v[68:71], v22, s[64:67], s3 offen
  s_mov_b32 s3, 131072
  buffer_load_dwordx4 v[72:75], v22, s[64:67], s3 offen
  s_mov_b32 s3, 196608
  buffer_load_dwordx4 v[76:79], v22, s[64:67], s3 offen
  buffer_load_ushort v80, v23, s[52:55], 0 offen
  buffer_load_dwordx4 v[32:35], v18, s[56:59], 0 offen
  s_mov_b32 s3, 65536
  buffer_load_dwordx4 v[36:39], v18, s[56:59], s3 offen
  s_mov_b32 s3, 131072
  buffer_load_dwordx4 v[40:43], v18, s[56:59], s3 offen
  s_mov_b32 s3, 196608
  buffer_load_dwordx4 v[44:47], v18, s[56:59], s3 offen
  s_waitcnt vmcnt(9)
  s_barrier
  s_waitcnt vmcnt(0)
  v_pk_add_f32 v[32:33], v[32:33], v[36:37]
  v_pk_add_f32 v[34:35], v[34:35], v[38:39]
  v_pk_add_f32 v[40:41], v[40:41], v[44:45]
  v_pk_add_f32 v[42:43], v[42:43], v[46:47]
  v_pk_add_f32 v[32:33], v[32:33], v[40:41]
  v_pk_add_f32 v[34:35], v[34:35], v[42:43]
  s_nop 1
  v_permlane32_swap_b32 v32, v34
  v_permlane32_swap_b32 v33, v35
  v_pk_add_f32 v[32:33], v[32:33], v[34:35]
  v_mov_b32 v34, v32
  v_mov_b32 v35, v33
  s_nop 0
  v_permlane16_swap_b32 v32, v34
  v_permlane16_swap_b32 v33, v35
  v_pk_add_f32 v[32:33], v[32:33], v[34:35]
  v_mul_f32 v32, 0x3a800000, v32
  v_mul_f32 v33, 0x3a800000, v33
  v_fma_f32 v33, -v32, v32, v33
  v_max_f32 v33, 0, v33
  v_add_f32 v33, 0x3727c5ac, v33
  v_rsq_f32 v33, v33
  s_nop 0
  s_and_b32 s3, s70, 3
  s_lshl_b32 s5, s3, 7
  s_add_u32 s5, s5, 147520
  v_and_b32 v3, 15, v1
  v_lshrrev_b32 v2, 5, v1
  v_lshl_add_u32 v2, v3, 1, v2
  v_lshl_add_u32 v2, v2, 2, s5
  ds_write2_b32 v2, v32, v33 offset0:0 offset1:160
  v_pk_add_f32 v[64:65], v[64:65], v[68:69]
  v_pk_add_f32 v[66:67], v[66:67], v[70:71]
  v_pk_add_f32 v[72:73], v[72:73], v[76:77]
  v_pk_add_f32 v[74:75], v[74:75], v[78:79]
  v_pk_add_f32 v[64:65], v[64:65], v[72:73]
  v_pk_add_f32 v[66:67], v[66:67], v[74:75]
  s_nop 1
  v_permlane32_swap_b32 v64, v66
  v_permlane32_swap_b32 v65, v67
  v_pk_add_f32 v[64:65], v[64:65], v[66:67]
  v_lshlrev_b32 v80, 16, v80
  s_lshl_b32 s5, s3, 8
  s_add_u32 s5, s5, 148736
  v_permlane16_swap_b32 v64, v65
  v_lshrrev_b32 v2, 4, v1
  v_lshl_add_u32 v2, v3, 2, v2
  v_lshl_add_u32 v2, v2, 2, s5
  v_add_f32 v64, v64, v65
  ds_write2st64_b32 v2, v64, v80 offset0:0 offset1:4
  s_waitcnt lgkmcnt(0)
  s_barrier
  s_lshl_b32 s87, s97, 15
  s_lshl_b32 s4, s68, 11
  s_add_u32 s87, s87, s4
  s_lshl_b32 s4, s69, 2
  s_add_u32 s87, s87, s4
  s_add_u32 s97, s97, 1
  s_branch L_w2_body
L_w1_end:
  s_endpgm
L_w1_compute:
  s_and_b32 s71, s70, 1
  s_lshr_b32 s72, s70, 1
  v_and_b32 v3, 15, v1
  v_lshrrev_b32 v2, 4, v1
  s_lshl_b32 s8, s71, 13
  v_lshl_add_u32 v4, v1, 4, s8
  v_bfe_u32 v13, v1, 2, 2
  v_lshl_add_u32 v13, v2, 3, v13
  v_lshlrev_b32 v13, 7, v13
  v_and_b32 v17, 3, v1
  v_lshl_add_u32 v13, v17, 3, v13
  v_bfe_u32 v17, v1, 3, 2
  v_lshl_add_u32 v13, v17, 5, v13
  s_lshl_b32 s9, s72, 6
  v_xor_b32 v13, s9, v13
  v_add_u32 v5, 16384, v13
  v_xor_b32 v6, 32, v5
  v_and_b32 v16, 1, v2
  v_lshrrev_b32 v17, 1, v2
  v_bfe_u32 v13, v1, 2, 2
  v_lshl_add_u32 v13, v16, 3, v13
  v_lshl_add_u32 v13, v17, 5, v13
  v_xor_b32 v14, s72, v16
  v_lshl_add_u32 v13, v13, 1, v14
  v_and_b32 v14, 3, v1
  v_lshl_add_u32 v13, v13, 2, v14
  v_lshlrev_b32 v13, 3, v13
  v_add_u32 v7, 40960, v13
  s_lshl_b32 s8, s68, 7
  s_lshl_b32 s9, s71, 6
  s_add_u32 s8, s8, s9
  s_mul_i32 s8, s8, 7168
  v_lshlrev_b32 v14, 8, v17
  v_lshl_add_u32 v14, v3, 4, v14
  v_add_u32 v14, s8, v14
  s_lshl_b32 s10, s69, 11
  s_lshl_b32 s9, s72, 10
  s_add_u32 s9, s9, s10
  v_lshl_add_u32 v12, v16, 9, v14
  v_add_u32 v12, s9, v12
  v_mul_u32_u24 v16, 114688, v16
  s_lshr_b32 s9, s9, 1
  v_add3_u32 v13, v16, v14, s9
  s_lshl_b32 s9, s71, 8
  s_add_u32 s9, s9, 147520
  v_lshl_add_u32 v14, v3, 2, s9
  s_lshl_b32 s9, s72, 7
  s_add_u32 s9, s9, 148736
  v_lshl_add_u32 v15, v2, 4, s9
  s_lshl_b32 s9, s72, 6
  s_add_u32 s9, s9, 148736
  v_lshl_add_u32 v16, v2, 4, s9
  v_mov_b32 v128, 0
  v_mov_b32 v129, 0
  v_mov_b32 v130, 0
  v_mov_b32 v131, 0
  v_mov_b32 v132, 0
  v_mov_b32 v133, 0
  v_mov_b32 v134, 0
  v_mov_b32 v135, 0
  v_mov_b32 v136, 0
  v_mov_b32 v137, 0
  v_mov_b32 v138, 0
  v_mov_b32 v139, 0
  v_mov_b32 v140, 0
  v_mov_b32 v141, 0
  v_mov_b32 v142, 0
  v_mov_b32 v143, 0
  v_mov_b32 v144, 0
  v_mov_b32 v145, 0
  v_mov_b32 v146, 0
  v_mov_b32 v147, 0
  v_mov_b32 v148, 0
  v_mov_b32 v149, 0
  v_mov_b32 v150, 0
  v_mov_b32 v151, 0
  v_mov_b32 v152, 0
  v_mov_b32 v153, 0
  v_mov_b32 v154, 0
  v_mov_b32 v155, 0
  v_mov_b32 v156, 0
  v_mov_b32 v157, 0
  v_mov_b32 v158, 0
  v_mov_b32 v159, 0
  v_mov_b32 v160, 0
  v_mov_b32 v161, 0
  v_mov_b32 v162, 0
  v_mov_b32 v163, 0
  v_mov_b32 v164, 0
  v_mov_b32 v165, 0
  v_mov_b32 v166, 0
  v_mov_b32 v167, 0
  v_mov_b32 v168, 0
  v_mov_b32 v169, 0
  v_mov_b32 v170, 0
  v_mov_b32 v171, 0
  v_mov_b32 v172, 0
  v_mov_b32 v173, 0
  v_mov_b32 v174, 0
  v_mov_b32 v175, 0
  v_mov_b32 v176, 0
  v_mov_b32 v177, 0
  v_mov_b32 v178, 0
  v_mov_b32 v179, 0
  v_mov_b32 v180, 0
  v_mov_b32 v181, 0
  v_mov_b32 v182, 0
  v_mov_b32 v183, 0
  v_mov_b32 v184, 0
  v_mov_b32 v185, 0
  v_mov_b32 v186, 0
  v_mov_b32 v187, 0
  v_mov_b32 v188, 0
  v_mov_b32 v189, 0
  v_mov_b32 v190, 0
  v_mov_b32 v191, 0
  v_mov_b32 v192, 0
  v_mov_b32 v193, 0
  v_mov_b32 v194, 0
  v_mov_b32 v195, 0
  v_mov_b32 v196, 0
  v_mov_b32 v197, 0
  v_mov_b32 v198, 0
  v_mov_b32 v199, 0
  v_mov_b32 v200, 0
  v_mov_b32 v201, 0
  v_mov_b32 v202, 0
  v_mov_b32 v203, 0
  v_mov_b32 v204, 0
  v_mov_b32 v205, 0
  v_mov_b32 v206, 0
  v_mov_b32 v207, 0
  v_mov_b32 v208, 0
  v_mov_b32 v209, 0
  v_mov_b32 v210, 0
  v_mov_b32 v211, 0
  v_mov_b32 v212, 0
  v_mov_b32 v213, 0
  v_mov_b32 v214, 0
  v_mov_b32 v215, 0
  v_mov_b32 v216, 0
  v_mov_b32 v217, 0
  v_mov_b32 v218, 0
  v_mov_b32 v219, 0
  v_mov_b32 v220, 0
  v_mov_b32 v221, 0
  v_mov_b32 v222, 0
  v_mov_b32 v223, 0
  v_mov_b32 v224, 0
  v_mov_b32 v225, 0
  v_mov_b32 v226, 0
  v_mov_b32 v227, 0
  v_mov_b32 v228, 0
  v_mov_b32 v229, 0
  v_mov_b32 v230, 0
  v_mov_b32 v231, 0
  v_mov_b32 v232, 0
  v_mov_b32 v233, 0
  v_mov_b32 v234, 0
  v_mov_b32 v235, 0
  v_mov_b32 v236, 0
  v_mov_b32 v237, 0
  v_mov_b32 v238, 0
  v_mov_b32 v239, 0
  s_waitcnt lgkmcnt(0)
  s_add_u32 s44, s34, 8388608
  s_addc_u32 s45, s35, 0
  s_and_b32 s45, s45, 0xffff
  s_mov_b32 s46, 14680064
  s_mov_b32 s47, 0x00020000
  s_cmp_lg_u32 s96, 0
  s_cbranch_scc1 L_pfc3_skip
  s_getpc_b64 s[4:5]
L_pfc3:
  s_lshl_b32 s3, s99, 2
  s_add_u32 s3, s3, s70
  s_mul_i32 s3, s3, 192
  s_min_u32 s3, s3, L_w2_c1-L_w2_c0-192
  s_add_i32 s3, s3, L_w2_c0-L_pfc3
  s_ashr_i32 s6, s3, 31
  s_add_u32 s4, s4, s3
  s_addc_u32 s5, s5, s6
  s_load_dword s36, s[4:5], 0
  s_load_dword s37, s[4:5], 64
  s_load_dword s38, s[4:5], 128
L_pfc3_skip:
  s_mov_b32 s75, 0
  v_add_u32_e64 v20, s75, v4
  v_add_u32_e64 v21, s75, v5
  v_add_u32_e64 v22, s75, v6
  v_add_u32_e64 v23, s75, v7
  s_add_u32 s75, s75, 49152
  s_cmp_eq_u32 s75, 147456
  s_cselect_b32 s75, 0, s75
  s_mov_b32 s79, 16
  s_barrier
  s_barrier
  ds_read_b128 v[32:35], v20 offset:0
  ds_read_b128 v[36:39], v20 offset:2048
  ds_read_b128 v[40:43], v20 offset:4096
  ds_read_b128 v[44:47], v20 offset:6144
  ds_read_b64_tr_b16 v[48:49], v21 offset:0
  ds_read_b64_tr_b16 v[50:51], v21 offset:512
  ds_read_b64_tr_b16 v[52:53], v22 offset:0
  ds_read_b64_tr_b16 v[54:55], v22 offset:512
  ds_read_b64_tr_b16 v[56:57], v21 offset:8192
  ds_read_b64_tr_b16 v[58:59], v21 offset:8704
  ds_read_b64_tr_b16 v[60:61], v22 offset:8192
  ds_read_b64_tr_b16 v[62:63], v22 offset:8704
  ds_read_b64_tr_b16 v[64:65], v21 offset:16384
  ds_read_b64_tr_b16 v[66:67], v21 offset:16896
  ds_read_b64_tr_b16 v[68:69], v22 offset:16384
  ds_read_b64_tr_b16 v[70:71], v22 offset:16896
  ds_read_b64_tr_b16 v[72:73], v23 offset:0
  ds_read_b64_tr_b16 v[74:75], v23 offset:256
  s_waitcnt lgkmcnt(0)
.p2align 3
L_w1_loop:
  v_mfma_f32_16x16x32_bf16 v[128:131], v[48:51], v[32:35], v[128:131]
  ds_read_b128 v[80:83], v20 offset:1024
  v_mfma_f32_16x16x32_bf16 v[132:135], v[48:51], v[36:39], v[132:135]
  ds_read_b128 v[84:87], v20 offset:3072
  v_mfma_f32_16x16x32_bf16 v[136:139], v[48:51], v[40:43], v[136:139]
  ds_read_b128 v[88:91], v20 offset:5120
  v_mfma_f32_16x16x32_bf16 v[140:143], v[48:51], v[44:47], v[140:143]
  ds_read_b128 v[92:95], v20 offset:7168
  v_mfma_f32_16x16x32_bf16 v[156:159], v[52:55], v[44:47], v[156:159]
  ds_read_b64_tr_b16 v[96:97], v21 offset:4096
  v_mfma_f32_16x16x32_bf16 v[152:155], v[52:55], v[40:43], v[152:155]
  ds_read_b64_tr_b16 v[98:99], v21 offset:4608
  v_mfma_f32_16x16x32_bf16 v[148:151], v[52:55], v[36:39], v[148:151]
  ds_read_b64_tr_b16 v[100:101], v22 offset:4096
  v_mfma_f32_16x16x32_bf16 v[144:147], v[52:55], v[32:35], v[144:147]
  ds_read_b64_tr_b16 v[102:103], v22 offset:4608
  v_mfma_f32_16x16x32_bf16 v[160:163], v[56:59], v[32:35], v[160:163]
  ds_read_b64_tr_b16 v[104:105], v21 offset:12288
  v_mfma_f32_16x16x32_bf16 v[164:167], v[56:59], v[36:39], v[164:167]
  ds_read_b64_tr_b16 v[106:107], v21 offset:12800
  v_mfma_f32_16x16x32_bf16 v[168:171], v[56:59], v[40:43], v[168:171]
  ds_read_b64_tr_b16 v[108:109], v22 offset:12288
  v_mfma_f32_16x16x32_bf16 v[172:175], v[56:59], v[44:47], v[172:175]
  ds_read_b64_tr_b16 v[110:111], v22 offset:12800
  v_mfma_f32_16x16x32_bf16 v[188:191], v[60:63], v[44:47], v[188:191]
  ds_read_b64_tr_b16 v[112:113], v21 offset:20480
  v_mfma_f32_16x16x32_bf16 v[184:187], v[60:63], v[40:43], v[184:187]
  ds_read_b64_tr_b16 v[114:115], v21 offset:20992
  v_mfma_f32_16x16x32_bf16 v[180:183], v[60:63], v[36:39], v[180:183]
  ds_read_b64_tr_b16 v[116:117], v22 offset:20480
  v_mfma_f32_16x16x32_bf16 v[176:179], v[60:63], v[32:35], v[176:179]
  ds_read_b64_tr_b16 v[118:119], v22 offset:20992
  v_mfma_f32_16x16x32_bf16 v[192:195], v[64:67], v[32:35], v[192:195]
  ds_read_b64_tr_b16 v[120:121], v23 offset:4096
  v_mfma_f32_16x16x32_bf16 v[196:199], v[64:67], v[36:39], v[196:199]
  ds_read_b64_tr_b16 v[122:123], v23 offset:4352
  v_mfma_f32_16x16x32_bf16 v[200:203], v[64:67], v[40:43], v[200:203]
  v_add_u32_e64 v20, s75, v4
  v_mfma_f32_16x16x32_bf16 v[204:207], v[64:67], v[44:47], v[204:207]
  v_add_u32_e64 v21, s75, v5
  v_mfma_f32_16x16x32_bf16 v[220:223], v[68:71], v[44:47], v[220:223]
  v_add_u32_e64 v22, s75, v6
  v_mfma_f32_16x16x32_bf16 v[216:219], v[68:71], v[40:43], v[216:219]
  v_add_u32_e64 v23, s75, v7
  v_mfma_f32_16x16x32_bf16 v[212:215], v[68:71], v[36:39], v[212:215]
  s_add_u32 s75, s75, 49152
  v_mfma_f32_16x16x32_bf16 v[208:211], v[68:71], v[32:35], v[208:211]
  s_cmp_eq_u32 s75, 147456
  v_mfma_f32_16x16x32_bf16 v[224:227], v[72:75], v[32:35], v[224:227]
  s_cselect_b32 s75, 0, s75
  s_sub_u32 s79, s79, 1
  v_mfma_f32_16x16x32_bf16 v[228:231], v[72:75], v[36:39], v[228:231]
  v_mfma_f32_16x16x32_bf16 v[232:235], v[72:75], v[40:43], v[232:235]
  v_mfma_f32_16x16x32_bf16 v[236:239], v[72:75], v[44:47], v[236:239]
  s_waitcnt lgkmcnt(0)
  s_barrier
  v_mfma_f32_16x16x32_bf16 v[128:131], v[96:99], v[80:83], v[128:131]
  ds_read_b128 v[32:35], v20 offset:0
  v_mfma_f32_16x16x32_bf16 v[132:135], v[96:99], v[84:87], v[132:135]
  ds_read_b128 v[36:39], v20 offset:2048
  v_mfma_f32_16x16x32_bf16 v[136:139], v[96:99], v[88:91], v[136:139]
  ds_read_b128 v[40:43], v20 offset:4096
  v_mfma_f32_16x16x32_bf16 v[140:143], v[96:99], v[92:95], v[140:143]
  ds_read_b128 v[44:47], v20 offset:6144
  v_mfma_f32_16x16x32_bf16 v[156:159], v[100:103], v[92:95], v[156:159]
  ds_read_b64_tr_b16 v[48:49], v21 offset:0
  v_mfma_f32_16x16x32_bf16 v[152:155], v[100:103], v[88:91], v[152:155]
  ds_read_b64_tr_b16 v[50:51], v21 offset:512
  v_mfma_f32_16x16x32_bf16 v[148:151], v[100:103], v[84:87], v[148:151]
  ds_read_b64_tr_b16 v[52:53], v22 offset:0
  v_mfma_f32_16x16x32_bf16 v[144:147], v[100:103], v[80:83], v[144:147]
  ds_read_b64_tr_b16 v[54:55], v22 offset:512
  v_mfma_f32_16x16x32_bf16 v[160:163], v[104:107], v[80:83], v[160:163]
  ds_read_b64_tr_b16 v[56:57], v21 offset:8192
  v_mfma_f32_16x16x32_bf16 v[164:167], v[104:107], v[84:87], v[164:167]
  ds_read_b64_tr_b16 v[58:59], v21 offset:8704
  v_mfma_f32_16x16x32_bf16 v[168:171], v[104:107], v[88:91], v[168:171]
  ds_read_b64_tr_b16 v[60:61], v22 offset:8192
  v_mfma_f32_16x16x32_bf16 v[172:175], v[104:107], v[92:95], v[172:175]
  ds_read_b64_tr_b16 v[62:63], v22 offset:8704
  v_mfma_f32_16x16x32_bf16 v[188:191], v[108:111], v[92:95], v[188:191]
  ds_read_b64_tr_b16 v[64:65], v21 offset:16384
  v_mfma_f32_16x16x32_bf16 v[184:187], v[108:111], v[88:91], v[184:187]
  ds_read_b64_tr_b16 v[66:67], v21 offset:16896
  v_mfma_f32_16x16x32_bf16 v[180:183], v[108:111], v[84:87], v[180:183]
  ds_read_b64_tr_b16 v[68:69], v22 offset:16384
  v_mfma_f32_16x16x32_bf16 v[176:179], v[108:111], v[80:83], v[176:179]
  ds_read_b64_tr_b16 v[70:71], v22 offset:16896
  v_mfma_f32_16x16x32_bf16 v[192:195], v[112:115], v[80:83], v[192:195]
  ds_read_b64_tr_b16 v[72:73], v23 offset:0
  v_mfma_f32_16x16x32_bf16 v[196:199], v[112:115], v[84:87], v[196:199]
  ds_read_b64_tr_b16 v[74:75], v23 offset:256
  v_mfma_f32_16x16x32_bf16 v[200:203], v[112:115], v[88:91], v[200:203]
  s_cmp_lg_u32 s79, 0
  s_nop 0
  v_mfma_f32_16x16x32_bf16 v[204:207], v[112:115], v[92:95], v[204:207]
  v_mfma_f32_16x16x32_bf16 v[220:223], v[116:119], v[92:95], v[220:223]
  v_mfma_f32_16x16x32_bf16 v[216:219], v[116:119], v[88:91], v[216:219]
  v_mfma_f32_16x16x32_bf16 v[212:215], v[116:119], v[84:87], v[212:215]
  v_mfma_f32_16x16x32_bf16 v[208:211], v[116:119], v[80:83], v[208:211]
  v_mfma_f32_16x16x32_bf16 v[224:227], v[120:123], v[80:83], v[224:227]
  v_mfma_f32_16x16x32_bf16 v[228:231], v[120:123], v[84:87], v[228:231]
  v_mfma_f32_16x16x32_bf16 v[232:235], v[120:123], v[88:91], v[232:235]
  v_mfma_f32_16x16x32_bf16 v[236:239], v[120:123], v[92:95], v[236:239]
  s_waitcnt lgkmcnt(0)
  s_cbranch_scc1 L_w1_loop
L_w1_exit:
  ds_read2_b32 v[88:89], v14 offset0:0 offset1:160
  ds_read2_b32 v[90:91], v14 offset0:16 offset1:176
  ds_read2_b32 v[92:93], v14 offset0:32 offset1:192
  ds_read2_b32 v[94:95], v14 offset0:48 offset1:208
  ds_read_b128 v[32:35], v15 offset:0
  ds_read_b128 v[60:63], v15 offset:1024
  ds_read_b128 v[36:39], v15 offset:64
  ds_read_b128 v[64:67], v15 offset:1088
  ds_read_b128 v[40:43], v15 offset:256
  ds_read_b128 v[68:71], v15 offset:1280
  ds_read_b128 v[44:47], v15 offset:320
  ds_read_b128 v[72:75], v15 offset:1344
  ds_read_b128 v[48:51], v15 offset:512
  ds_read_b128 v[76:79], v15 offset:1536
  ds_read_b128 v[52:55], v15 offset:576
  ds_read_b128 v[80:83], v15 offset:1600
  ds_read_b128 v[56:59], v16 offset:768
  ds_read_b128 v[84:87], v16 offset:1792
  v_mov_b32 v96, 0xc0135761
  v_mov_b32 v97, 0xbdd2d3e8
  v_mov_b32 v98, 1.0
  s_waitcnt lgkmcnt(0)
  v_mul_f32 v88, v88, v89
  v_mul_f32 v90, v90, v91
  v_mul_f32 v92, v92, v93
  v_mul_f32 v94, v94, v95
  v_pk_fma_f32 v[100:101], v[32:33], v[88:89], v[60:61] op_sel:[0,0,0] op_sel_hi:[1,0,1] neg_lo:[0,1,0] neg_hi:[0,1,0]
  v_pk_fma_f32 v[102:103], v[34:35], v[88:89], v[62:63] op_sel:[0,0,0] op_sel_hi:[1,0,1] neg_lo:[0,1,0] neg_hi:[0,1,0]
  v_pk_fma_f32 v[128:129], v[128:129], v[88:89], v[100:101] op_sel:[0,1,0] op_sel_hi:[1,1,1]
  v_pk_fma_f32 v[130:131], v[130:131], v[88:89], v[102:103] op_sel:[0,1,0] op_sel_hi:[1,1,1]
  v_pk_mul_f32 v[100:101], v[128:129], v[128:129]
  v_pk_mul_f32 v[102:103], v[130:131], v[130:131]
  v_pk_fma_f32 v[100:101], v[100:101], v[96:97], v[96:97] op_sel:[0,1,0] op_sel_hi:[1,1,0]
  v_pk_fma_f32 v[102:103], v[102:103], v[96:97], v[96:97] op_sel:[0,1,0] op_sel_hi:[1,1,0]
  v_pk_mul_f32 v[100:101], v[100:101], v[128:129]
  v_pk_mul_f32 v[102:103], v[102:103], v[130:131]
  v_exp_f32 v100, v100
  v_exp_f32 v101, v101
  v_exp_f32 v102, v102
  v_exp_f32 v103, v103
  v_pk_add_f32 v[100:101], v[100:101], v[98:99] op_sel_hi:[1,0]
  v_pk_add_f32 v[102:103], v[102:103], v[98:99] op_sel_hi:[1,0]
  v_rcp_f32 v100, v100
  v_rcp_f32 v101, v101
  v_rcp_f32 v102, v102
  v_rcp_f32 v103, v103
  v_pk_mul_f32 v[128:129], v[128:129], v[100:101]
  v_pk_mul_f32 v[130:131], v[130:131], v[102:103]
  v_cvt_pk_bf16_f32 v108, v128, v129
  v_cvt_pk_bf16_f32 v109, v130, v131
  v_pk_fma_f32 v[104:105], v[36:37], v[88:89], v[64:65] op_sel:[0,0,0] op_sel_hi:[1,0,1] neg_lo:[0,1,0] neg_hi:[0,1,0]
  v_pk_fma_f32 v[106:107], v[38:39], v[88:89], v[66:67] op_sel:[0,0,0] op_sel_hi:[1,0,1] neg_lo:[0,1,0] neg_hi:[0,1,0]
  v_pk_fma_f32 v[144:145], v[144:145], v[88:89], v[104:105] op_sel:[0,1,0] op_sel_hi:[1,1,1]
  v_pk_fma_f32 v[146:147], v[146:147], v[88:89], v[106:107] op_sel:[0,1,0] op_sel_hi:[1,1,1]
  v_pk_mul_f32 v[104:105], v[144:145], v[144:145]
  v_pk_mul_f32 v[106:107], v[146:147], v[146:147]
  v_pk_fma_f32 v[104:105], v[104:105], v[96:97], v[96:97] op_sel:[0,1,0] op_sel_hi:[1,1,0]
  v_pk_fma_f32 v[106:107], v[106:107], v[96:97], v[96:97] op_sel:[0,1,0] op_sel_hi:[1,1,0]
  v_pk_mul_f32 v[104:105], v[104:105], v[144:145]
  v_pk_mul_f32 v[106:107], v[106:107], v[146:147]
  v_exp_f32 v104, v104
  v_exp_f32 v105, v105
  v_exp_f32 v106, v106
  v_exp_f32 v107, v107
  v_pk_add_f32 v[104:105], v[104:105], v[98:99] op_sel_hi:[1,0]
  v_pk_add_f32 v[106:107], v[106:107], v[98:99] op_sel_hi:[1,0]
  v_rcp_f32 v104, v104
  v_rcp_f32 v105, v105
  v_rcp_f32 v106, v106
  v_rcp_f32 v107, v107
  v_pk_mul_f32 v[144:145], v[144:145], v[104:105]
  v_pk_mul_f32 v[146:147], v[146:147], v[106:107]
  v_cvt_pk_bf16_f32 v110, v144, v145
  v_cvt_pk_bf16_f32 v111, v146, v147
  s_mov_b32 s3, 0
  s_nop 0
  v_permlane16_swap_b32 v108, v110
  v_permlane16_swap_b32 v109, v111
  buffer_store_dwordx4 v[108:111], v12, s[44:47], s3 offen sc1
  v_pk_fma_f32 v[100:101], v[32:33], v[90:91], v[60:61] op_sel:[0,0,0] op_sel_hi:[1,0,1] neg_lo:[0,1,0] neg_hi:[0,1,0]
  v_pk_fma_f32 v[102:103], v[34:35], v[90:91], v[62:63] op_sel:[0,0,0] op_sel_hi:[1,0,1] neg_lo:[0,1,0] neg_hi:[0,1,0]
  v_pk_fma_f32 v[132:133], v[132:133], v[90:91], v[100:101] op_sel:[0,1,0] op_sel_hi:[1,1,1]
  v_pk_fma_f32 v[134:135], v[134:135], v[90:91], v[102:103] op_sel:[0,1,0] op_sel_hi:[1,1,1]
  v_pk_mul_f32 v[100:101], v[132:133], v[132:133]
  v_pk_mul_f32 v[102:103], v[134:135], v[134:135]
  v_pk_fma_f32 v[100:101], v[100:101], v[96:97], v[96:97] op_sel:[0,1,0] op_sel_hi:[1,1,0]
  v_pk_fma_f32 v[102:103], v[102:103], v[96:97], v[96:97] op_sel:[0,1,0] op_sel_hi:[1,1,0]
  v_pk_mul_f32 v[100:101], v[100:101], v[132:133]
  v_pk_mul_f32 v[102:103], v[102:103], v[134:135]
  v_exp_f32 v100, v100
  v_exp_f32 v101, v101
  v_exp_f32 v102, v102
  v_exp_f32 v103, v103
  v_pk_add_f32 v[100:101], v[100:101], v[98:99] op_sel_hi:[1,0]
  v_pk_add_f32 v[102:103], v[102:103], v[98:99] op_sel_hi:[1,0]
  v_rcp_f32 v100, v100
  v_rcp_f32 v101, v101
  v_rcp_f32 v102, v102
  v_rcp_f32 v103, v103
  v_pk_mul_f32 v[132:133], v[132:133], v[100:101]
  v_pk_mul_f32 v[134:135], v[134:135], v[102:103]
  v_cvt_pk_bf16_f32 v112, v132, v133
  v_cvt_pk_bf16_f32 v113, v134, v135
  v_pk_fma_f32 v[104:105], v[36:37], v[90:91], v[64:65] op_sel:[0,0,0] op_sel_hi:[1,0,1] neg_lo:[0,1,0] neg_hi:[0,1,0]
  v_pk_fma_f32 v[106:107], v[38:39], v[90:91], v[66:67] op_sel:[0,0,0] op_sel_hi:[1,0,1] neg_lo:[0,1,0] neg_hi:[0,1,0]
  v_pk_fma_f32 v[148:149], v[148:149], v[90:91], v[104:105] op_sel:[0,1,0] op_sel_hi:[1,1,1]
  v_pk_fma_f32 v[150:151], v[150:151], v[90:91], v[106:107] op_sel:[0,1,0] op_sel_hi:[1,1,1]
  v_pk_mul_f32 v[104:105], v[148:149], v[148:149]
  v_pk_mul_f32 v[106:107], v[150:151], v[150:151]
  v_pk_fma_f32 v[104:105], v[104:105], v[96:97], v[96:97] op_sel:[0,1,0] op_sel_hi:[1,1,0]
  v_pk_fma_f32 v[106:107], v[106:107], v[96:97], v[96:97] op_sel:[0,1,0] op_sel_hi:[1,1,0]
  v_pk_mul_f32 v[104:105], v[104:105], v[148:149]
  v_pk_mul_f32 v[106:107], v[106:107], v[150:151]
  v_exp_f32 v104, v104
  v_exp_f32 v105, v105
  v_exp_f32 v106, v106
  v_exp_f32 v107, v107
  v_pk_add_f32 v[104:105], v[104:105], v[98:99] op_sel_hi:[1,0]
  v_pk_add_f32 v[106:107], v[106:107], v[98:99] op_sel_hi:[1,0]
  v_rcp_f32 v104, v104
  v_rcp_f32 v105, v105
  v_rcp_f32 v106, v106
  v_rcp_f32 v107, v107
  v_pk_mul_f32 v[148:149], v[148:149], v[104:105]
  v_pk_mul_f32 v[150:151], v[150:151], v[106:107]
  v_cvt_pk_bf16_f32 v114, v148, v149
  v_cvt_pk_bf16_f32 v115, v150, v151
  s_mov_b32 s3, 114688
  s_nop 0
  v_permlane16_swap_b32 v112, v114
  v_permlane16_swap_b32 v113, v115
  buffer_store_dwordx4 v[112:115], v12, s[44:47], s3 offen sc1
  v_pk_fma_f32 v[100:101], v[32:33], v[92:93], v[60:61] op_sel:[0,0,0] op_sel_hi:[1,0,1] neg_lo:[0,1,0] neg_hi:[0,1,0]
  v_pk_fma_f32 v[102:103], v[34:35], v[92:93], v[62:63] op_sel:[0,0,0] op_sel_hi:[1,0,1] neg_lo:[0,1,0] neg_hi:[0,1,0]
  v_pk_fma_f32 v[136:137], v[136:137], v[92:93], v[100:101] op_sel:[0,1,0] op_sel_hi:[1,1,1]
  v_pk_fma_f32 v[138:139], v[138:139], v[92:93], v[102:103] op_sel:[0,1,0] op_sel_hi:[1,1,1]
  v_pk_mul_f32 v[100:101], v[136:137], v[136:137]
  v_pk_mul_f32 v[102:103], v[138:139], v[138:139]
  v_pk_fma_f32 v[100:101], v[100:101], v[96:97], v[96:97] op_sel:[0,1,0] op_sel_hi:[1,1,0]
  v_pk_fma_f32 v[102:103], v[102:103], v[96:97], v[96:97] op_sel:[0,1,0] op_sel_hi:[1,1,0]
  v_pk_mul_f32 v[100:101], v[100:101], v[136:137]
  v_pk_mul_f32 v[102:103], v[102:103], v[138:139]
  v_exp_f32 v100, v100
  v_exp_f32 v101, v101
  v_exp_f32 v102, v102
  v_exp_f32 v103, v103
  v_pk_add_f32 v[100:101], v[100:101], v[98:99] op_sel_hi:[1,0]
  v_pk_add_f32 v[102:103], v[102:103], v[98:99] op_sel_hi:[1,0]
  v_rcp_f32 v100, v100
  v_rcp_f32 v101, v101
  v_rcp_f32 v102, v102
  v_rcp_f32 v103, v103
  v_pk_mul_f32 v[136:137], v[136:137], v[100:101]
  v_pk_mul_f32 v[138:139], v[138:139], v[102:103]
  v_cvt_pk_bf16_f32 v116, v136, v137
  v_cvt_pk_bf16_f32 v117, v138, v139
  v_pk_fma_f32 v[104:105], v[36:37], v[92:93], v[64:65] op_sel:[0,0,0] op_sel_hi:[1,0,1] neg_lo:[0,1,0] neg_hi:[0,1,0]
  v_pk_fma_f32 v[106:107], v[38:39], v[92:93], v[66:67] op_sel:[0,0,0] op_sel_hi:[1,0,1] neg_lo:[0,1,0] neg_hi:[0,1,0]
  v_pk_fma_f32 v[152:153], v[152:153], v[92:93], v[104:105] op_sel:[0,1,0] op_sel_hi:[1,1,1]
  v_pk_fma_f32 v[154:155], v[154:155], v[92:93], v[106:107] op_sel:[0,1,0] op_sel_hi:[1,1,1]
  v_pk_mul_f32 v[104:105], v[152:153], v[152:153]
  v_pk_mul_f32 v[106:107], v[154:155], v[154:155]
  v_pk_fma_f32 v[104:105], v[104:105], v[96:97], v[96:97] op_sel:[0,1,0] op_sel_hi:[1,1,0]
  v_pk_fma_f32 v[106:107], v[106:107], v[96:97], v[96:97] op_sel:[0,1,0] op_sel_hi:[1,1,0]
  v_pk_mul_f32 v[104:105], v[104:105], v[152:153]
  v_pk_mul_f32 v[106:107], v[106:107], v[154:155]
  v_exp_f32 v104, v104
  v_exp_f32 v105, v105
  v_exp_f32 v106, v106
  v_exp_f32 v107, v107
  v_pk_add_f32 v[104:105], v[104:105], v[98:99] op_sel_hi:[1,0]
  v_pk_add_f32 v[106:107], v[106:107], v[98:99] op_sel_hi:[1,0]
  v_rcp_f32 v104, v104
  v_rcp_f32 v105, v105
  v_rcp_f32 v106, v106
  v_rcp_f32 v107, v107
  v_pk_mul_f32 v[152:153], v[152:153], v[104:105]
  v_pk_mul_f32 v[154:155], v[154:155], v[106:107]
  v_cvt_pk_bf16_f32 v118, v152, v153
  v_cvt_pk_bf16_f32 v119, v154, v155
  s_mov_b32 s3, 229376
  s_nop 0
  v_permlane16_swap_b32 v116, v118
  v_permlane16_swap_b32 v117, v119
  buffer_store_dwordx4 v[116:119], v12, s[44:47], s3 offen sc1
  v_pk_fma_f32 v[100:101], v[32:33], v[94:95], v[60:61] op_sel:[0,0,0] op_sel_hi:[1,0,1] neg_lo:[0,1,0] neg_hi:[0,1,0]
  v_pk_fma_f32 v[102:103], v[34:35], v[94:95], v[62:63] op_sel:[0,0,0] op_sel_hi:[1,0,1] neg_lo:[0,1,0] neg_hi:[0,1,0]
  v_pk_fma_f32 v[140:141], v[140:141], v[94:95], v[100:101] op_sel:[0,1,0] op_sel_hi:[1,1,1]
  v_pk_fma_f32 v[142:143], v[142:143], v[94:95], v[102:103] op_sel:[0,1,0] op_sel_hi:[1,1,1]
  v_pk_mul_f32 v[100:101], v[140:141], v[140:141]
  v_pk_mul_f32 v[102:103], v[142:143], v[142:143]
  v_pk_fma_f32 v[100:101], v[100:101], v[96:97], v[96:97] op_sel:[0,1,0] op_sel_hi:[1,1,0]
  v_pk_fma_f32 v[102:103], v[102:103], v[96:97], v[96:97] op_sel:[0,1,0] op_sel_hi:[1,1,0]
  v_pk_mul_f32 v[100:101], v[100:101], v[140:141]
  v_pk_mul_f32 v[102:103], v[102:103], v[142:143]
  v_exp_f32 v100, v100
  v_exp_f32 v101, v101
  v_exp_f32 v102, v102
  v_exp_f32 v103, v103
  v_pk_add_f32 v[100:101], v[100:101], v[98:99] op_sel_hi:[1,0]
  v_pk_add_f32 v[102:103], v[102:103], v[98:99] op_sel_hi:[1,0]
  v_rcp_f32 v100, v100
  v_rcp_f32 v101, v101
  v_rcp_f32 v102, v102
  v_rcp_f32 v103, v103
  v_pk_mul_f32 v[140:141], v[140:141], v[100:101]
  v_pk_mul_f32 v[142:143], v[142:143], v[102:103]
  v_cvt_pk_bf16_f32 v120, v140, v141
  v_cvt_pk_bf16_f32 v121, v142, v143
  v_pk_fma_f32 v[104:105], v[36:37], v[94:95], v[64:65] op_sel:[0,0,0] op_sel_hi:[1,0,1] neg_lo:[0,1,0] neg_hi:[0,1,0]
  v_pk_fma_f32 v[106:107], v[38:39], v[94:95], v[66:67] op_sel:[0,0,0] op_sel_hi:[1,0,1] neg_lo:[0,1,0] neg_hi:[0,1,0]
  v_pk_fma_f32 v[156:157], v[156:157], v[94:95], v[104:105] op_sel:[0,1,0] op_sel_hi:[1,1,1]
  v_pk_fma_f32 v[158:159], v[158:159], v[94:95], v[106:107] op_sel:[0,1,0] op_sel_hi:[1,1,1]
  v_pk_mul_f32 v[104:105], v[156:157], v[156:157]
  v_pk_mul_f32 v[106:107], v[158:159], v[158:159]
  v_pk_fma_f32 v[104:105], v[104:105], v[96:97], v[96:97] op_sel:[0,1,0] op_sel_hi:[1,1,0]
  v_pk_fma_f32 v[106:107], v[106:107], v[96:97], v[96:97] op_sel:[0,1,0] op_sel_hi:[1,1,0]
  v_pk_mul_f32 v[104:105], v[104:105], v[156:157]
  v_pk_mul_f32 v[106:107], v[106:107], v[158:159]
  v_exp_f32 v104, v104
  v_exp_f32 v105, v105
  v_exp_f32 v106, v106
  v_exp_f32 v107, v107
  v_pk_add_f32 v[104:105], v[104:105], v[98:99] op_sel_hi:[1,0]
  v_pk_add_f32 v[106:107], v[106:107], v[98:99] op_sel_hi:[1,0]
  v_rcp_f32 v104, v104
  v_rcp_f32 v105, v105
  v_rcp_f32 v106, v106
  v_rcp_f32 v107, v107
  v_pk_mul_f32 v[156:157], v[156:157], v[104:105]
  v_pk_mul_f32 v[158:159], v[158:159], v[106:107]
  v_cvt_pk_bf16_f32 v122, v156, v157
  v_cvt_pk_bf16_f32 v123, v158, v159
  s_mov_b32 s3, 344064
  s_nop 0
  v_permlane16_swap_b32 v120, v122
  v_permlane16_swap_b32 v121, v123
  buffer_store_dwordx4 v[120:123], v12, s[44:47], s3 offen sc1
  v_pk_fma_f32 v[100:101], v[56:57], v[88:89], v[84:85] op_sel:[0,0,0] op_sel_hi:[1,0,1] neg_lo:[0,1,0] neg_hi:[0,1,0]
  v_pk_fma_f32 v[102:103], v[58:59], v[88:89], v[86:87] op_sel:[0,0,0] op_sel_hi:[1,0,1] neg_lo:[0,1,0] neg_hi:[0,1,0]
  v_pk_fma_f32 v[224:225], v[224:225], v[88:89], v[100:101] op_sel:[0,1,0] op_sel_hi:[1,1,1]
  v_pk_fma_f32 v[226:227], v[226:227], v[88:89], v[102:103] op_sel:[0,1,0] op_sel_hi:[1,1,1]
  v_pk_mul_f32 v[100:101], v[224:225], v[224:225]
  v_pk_mul_f32 v[102:103], v[226:227], v[226:227]
  v_pk_fma_f32 v[100:101], v[100:101], v[96:97], v[96:97] op_sel:[0,1,0] op_sel_hi:[1,1,0]
  v_pk_fma_f32 v[102:103], v[102:103], v[96:97], v[96:97] op_sel:[0,1,0] op_sel_hi:[1,1,0]
  v_pk_mul_f32 v[100:101], v[100:101], v[224:225]
  v_pk_mul_f32 v[102:103], v[102:103], v[226:227]
  v_exp_f32 v100, v100
  v_exp_f32 v101, v101
  v_exp_f32 v102, v102
  v_exp_f32 v103, v103
  v_pk_add_f32 v[100:101], v[100:101], v[98:99] op_sel_hi:[1,0]
  v_pk_add_f32 v[102:103], v[102:103], v[98:99] op_sel_hi:[1,0]
  v_rcp_f32 v100, v100
  v_rcp_f32 v101, v101
  v_rcp_f32 v102, v102
  v_rcp_f32 v103, v103
  v_pk_mul_f32 v[224:225], v[224:225], v[100:101]
  v_pk_mul_f32 v[226:227], v[226:227], v[102:103]
  v_cvt_pk_bf16_f32 v108, v224, v225
  v_cvt_pk_bf16_f32 v109, v226, v227
  v_pk_fma_f32 v[100:101], v[56:57], v[90:91], v[84:85] op_sel:[0,0,0] op_sel_hi:[1,0,1] neg_lo:[0,1,0] neg_hi:[0,1,0]
  v_pk_fma_f32 v[102:103], v[58:59], v[90:91], v[86:87] op_sel:[0,0,0] op_sel_hi:[1,0,1] neg_lo:[0,1,0] neg_hi:[0,1,0]
  v_pk_fma_f32 v[228:229], v[228:229], v[90:91], v[100:101] op_sel:[0,1,0] op_sel_hi:[1,1,1]
  v_pk_fma_f32 v[230:231], v[230:231], v[90:91], v[102:103] op_sel:[0,1,0] op_sel_hi:[1,1,1]
  v_pk_mul_f32 v[100:101], v[228:229], v[228:229]
  v_pk_mul_f32 v[102:103], v[230:231], v[230:231]
  v_pk_fma_f32 v[100:101], v[100:101], v[96:97], v[96:97] op_sel:[0,1,0] op_sel_hi:[1,1,0]
  v_pk_fma_f32 v[102:103], v[102:103], v[96:97], v[96:97] op_sel:[0,1,0] op_sel_hi:[1,1,0]
  v_pk_mul_f32 v[100:101], v[100:101], v[228:229]
  v_pk_mul_f32 v[102:103], v[102:103], v[230:231]
  v_exp_f32 v100, v100
  v_exp_f32 v101, v101
  v_exp_f32 v102, v102
  v_exp_f32 v103, v103
  v_pk_add_f32 v[100:101], v[100:101], v[98:99] op_sel_hi:[1,0]
  v_pk_add_f32 v[102:103], v[102:103], v[98:99] op_sel_hi:[1,0]
  v_rcp_f32 v100, v100
  v_rcp_f32 v101, v101
  v_rcp_f32 v102, v102
  v_rcp_f32 v103, v103
  v_pk_mul_f32 v[228:229], v[228:229], v[100:101]
  v_pk_mul_f32 v[230:231], v[230:231], v[102:103]
  v_cvt_pk_bf16_f32 v110, v228, v229
  v_cvt_pk_bf16_f32 v111, v230, v231
  s_mov_b32 s3, 32768
  s_nop 0
  v_permlane16_swap_b32 v108, v110
  v_permlane16_swap_b32 v109, v111
  buffer_store_dwordx4 v[108:111], v13, s[44:47], s3 offen sc1
  v_pk_fma_f32 v[100:101], v[56:57], v[92:93], v[84:85] op_sel:[0,0,0] op_sel_hi:[1,0,1] neg_lo:[0,1,0] neg_hi:[0,1,0]
  v_pk_fma_f32 v[102:103], v[58:59], v[92:93], v[86:87] op_sel:[0,0,0] op_sel_hi:[1,0,1] neg_lo:[0,1,0] neg_hi:[0,1,0]
  v_pk_fma_f32 v[232:233], v[232:233], v[92:93], v[100:101] op_sel:[0,1,0] op_sel_hi:[1,1,1]
  v_pk_fma_f32 v[234:235], v[234:235], v[92:93], v[102:103] op_sel:[0,1,0] op_sel_hi:[1,1,1]
  v_pk_mul_f32 v[100:101], v[232:233], v[232:233]
  v_pk_mul_f32 v[102:103], v[234:235], v[234:235]
  v_pk_fma_f32 v[100:101], v[100:101], v[96:97], v[96:97] op_sel:[0,1,0] op_sel_hi:[1,1,0]
  v_pk_fma_f32 v[102:103], v[102:103], v[96:97], v[96:97] op_sel:[0,1,0] op_sel_hi:[1,1,0]
  v_pk_mul_f32 v[100:101], v[100:101], v[232:233]
  v_pk_mul_f32 v[102:103], v[102:103], v[234:235]
  v_exp_f32 v100, v100
  v_exp_f32 v101, v101
  v_exp_f32 v102, v102
  v_exp_f32 v103, v103
  v_pk_add_f32 v[100:101], v[100:101], v[98:99] op_sel_hi:[1,0]
  v_pk_add_f32 v[102:103], v[102:103], v[98:99] op_sel_hi:[1,0]
  v_rcp_f32 v100, v100
  v_rcp_f32 v101, v101
  v_rcp_f32 v102, v102
  v_rcp_f32 v103, v103
  v_pk_mul_f32 v[232:233], v[232:233], v[100:101]
  v_pk_mul_f32 v[234:235], v[234:235], v[102:103]
  v_cvt_pk_bf16_f32 v112, v232, v233
  v_cvt_pk_bf16_f32 v113, v234, v235
  v_pk_fma_f32 v[100:101], v[56:57], v[94:95], v[84:85] op_sel:[0,0,0] op_sel_hi:[1,0,1] neg_lo:[0,1,0] neg_hi:[0,1,0]
  v_pk_fma_f32 v[102:103], v[58:59], v[94:95], v[86:87] op_sel:[0,0,0] op_sel_hi:[1,0,1] neg_lo:[0,1,0] neg_hi:[0,1,0]
  v_pk_fma_f32 v[236:237], v[236:237], v[94:95], v[100:101] op_sel:[0,1,0] op_sel_hi:[1,1,1]
  v_pk_fma_f32 v[238:239], v[238:239], v[94:95], v[102:103] op_sel:[0,1,0] op_sel_hi:[1,1,1]
  v_pk_mul_f32 v[100:101], v[236:237], v[236:237]
  v_pk_mul_f32 v[102:103], v[238:239], v[238:239]
  v_pk_fma_f32 v[100:101], v[100:101], v[96:97], v[96:97] op_sel:[0,1,0] op_sel_hi:[1,1,0]
  v_pk_fma_f32 v[102:103], v[102:103], v[96:97], v[96:97] op_sel:[0,1,0] op_sel_hi:[1,1,0]
  v_pk_mul_f32 v[100:101], v[100:101], v[236:237]
  v_pk_mul_f32 v[102:103], v[102:103], v[238:239]
  v_exp_f32 v100, v100
  v_exp_f32 v101, v101
  v_exp_f32 v102, v102
  v_exp_f32 v103, v103
  v_pk_add_f32 v[100:101], v[100:101], v[98:99] op_sel_hi:[1,0]
  v_pk_add_f32 v[102:103], v[102:103], v[98:99] op_sel_hi:[1,0]
  v_rcp_f32 v100, v100
  v_rcp_f32 v101, v101
  v_rcp_f32 v102, v102
  v_rcp_f32 v103, v103
  v_pk_mul_f32 v[236:237], v[236:237], v[100:101]
  v_pk_mul_f32 v[238:239], v[238:239], v[102:103]
  v_cvt_pk_bf16_f32 v114, v236, v237
  v_cvt_pk_bf16_f32 v115, v238, v239
  s_mov_b32 s3, 262144
  s_nop 0
  v_permlane16_swap_b32 v112, v114
  v_permlane16_swap_b32 v113, v115
  buffer_store_dwordx4 v[112:115], v13, s[44:47], s3 offen sc1
  v_pk_fma_f32 v[100:101], v[40:41], v[88:89], v[68:69] op_sel:[0,0,0] op_sel_hi:[1,0,1] neg_lo:[0,1,0] neg_hi:[0,1,0]
  v_pk_fma_f32 v[102:103], v[42:43], v[88:89], v[70:71] op_sel:[0,0,0] op_sel_hi:[1,0,1] neg_lo:[0,1,0] neg_hi:[0,1,0]
  v_pk_fma_f32 v[160:161], v[160:161], v[88:89], v[100:101] op_sel:[0,1,0] op_sel_hi:[1,1,1]
  v_pk_fma_f32 v[162:163], v[162:163], v[88:89], v[102:103] op_sel:[0,1,0] op_sel_hi:[1,1,1]
  v_pk_mul_f32 v[100:101], v[160:161], v[160:161]
  v_pk_mul_f32 v[102:103], v[162:163], v[162:163]
  v_pk_fma_f32 v[100:101], v[100:101], v[96:97], v[96:97] op_sel:[0,1,0] op_sel_hi:[1,1,0]
  v_pk_fma_f32 v[102:103], v[102:103], v[96:97], v[96:97] op_sel:[0,1,0] op_sel_hi:[1,1,0]
  v_pk_mul_f32 v[100:101], v[100:101], v[160:161]
  v_pk_mul_f32 v[102:103], v[102:103], v[162:163]
  v_exp_f32 v100, v100
  v_exp_f32 v101, v101
  v_exp_f32 v102, v102
  v_exp_f32 v103, v103
  v_pk_add_f32 v[100:101], v[100:101], v[98:99] op_sel_hi:[1,0]
  v_pk_add_f32 v[102:103], v[102:103], v[98:99] op_sel_hi:[1,0]
  v_rcp_f32 v100, v100
  v_rcp_f32 v101, v101
  v_rcp_f32 v102, v102
  v_rcp_f32 v103, v103
  v_pk_mul_f32 v[160:161], v[160:161], v[100:101]
  v_pk_mul_f32 v[162:163], v[162:163], v[102:103]
  v_cvt_pk_bf16_f32 v116, v160, v161
  v_cvt_pk_bf16_f32 v117, v162, v163
  v_pk_fma_f32 v[104:105], v[44:45], v[88:89], v[72:73] op_sel:[0,0,0] op_sel_hi:[1,0,1] neg_lo:[0,1,0] neg_hi:[0,1,0]
  v_pk_fma_f32 v[106:107], v[46:47], v[88:89], v[74:75] op_sel:[0,0,0] op_sel_hi:[1,0,1] neg_lo:[0,1,0] neg_hi:[0,1,0]
  v_pk_fma_f32 v[176:177], v[176:177], v[88:89], v[104:105] op_sel:[0,1,0] op_sel_hi:[1,1,1]
  v_pk_fma_f32 v[178:179], v[178:179], v[88:89], v[106:107] op_sel:[0,1,0] op_sel_hi:[1,1,1]
  v_pk_mul_f32 v[104:105], v[176:177], v[176:177]
  v_pk_mul_f32 v[106:107], v[178:179], v[178:179]
  v_pk_fma_f32 v[104:105], v[104:105], v[96:97], v[96:97] op_sel:[0,1,0] op_sel_hi:[1,1,0]
  v_pk_fma_f32 v[106:107], v[106:107], v[96:97], v[96:97] op_sel:[0,1,0] op_sel_hi:[1,1,0]
  v_pk_mul_f32 v[104:105], v[104:105], v[176:177]
  v_pk_mul_f32 v[106:107], v[106:107], v[178:179]
  v_exp_f32 v104, v104
  v_exp_f32 v105, v105
  v_exp_f32 v106, v106
  v_exp_f32 v107, v107
  v_pk_add_f32 v[104:105], v[104:105], v[98:99] op_sel_hi:[1,0]
  v_pk_add_f32 v[106:107], v[106:107], v[98:99] op_sel_hi:[1,0]
  v_rcp_f32 v104, v104
  v_rcp_f32 v105, v105
  v_rcp_f32 v106, v106
  v_rcp_f32 v107, v107
  v_pk_mul_f32 v[176:177], v[176:177], v[104:105]
  v_pk_mul_f32 v[178:179], v[178:179], v[106:107]
  v_cvt_pk_bf16_f32 v118, v176, v177
  v_cvt_pk_bf16_f32 v119, v178, v179
  s_add_u32 s3, s10, 49152
  s_nop 0
  v_permlane16_swap_b32 v116, v118
  v_permlane16_swap_b32 v117, v119
  buffer_store_dwordx4 v[116:119], v12, s[44:47], s3 offen sc1
  v_pk_fma_f32 v[100:101], v[48:49], v[88:89], v[76:77] op_sel:[0,0,0] op_sel_hi:[1,0,1] neg_lo:[0,1,0] neg_hi:[0,1,0]
  v_pk_fma_f32 v[102:103], v[50:51], v[88:89], v[78:79] op_sel:[0,0,0] op_sel_hi:[1,0,1] neg_lo:[0,1,0] neg_hi:[0,1,0]
  v_pk_fma_f32 v[192:193], v[192:193], v[88:89], v[100:101] op_sel:[0,1,0] op_sel_hi:[1,1,1]
  v_pk_fma_f32 v[194:195], v[194:195], v[88:89], v[102:103] op_sel:[0,1,0] op_sel_hi:[1,1,1]
  v_pk_mul_f32 v[100:101], v[192:193], v[192:193]
  v_pk_mul_f32 v[102:103], v[194:195], v[194:195]
  v_pk_fma_f32 v[100:101], v[100:101], v[96:97], v[96:97] op_sel:[0,1,0] op_sel_hi:[1,1,0]
  v_pk_fma_f32 v[102:103], v[102:103], v[96:97], v[96:97] op_sel:[0,1,0] op_sel_hi:[1,1,0]
  v_pk_mul_f32 v[100:101], v[100:101], v[192:193]
  v_pk_mul_f32 v[102:103], v[102:103], v[194:195]
  v_exp_f32 v100, v100
  v_exp_f32 v101, v101
  v_exp_f32 v102, v102
  v_exp_f32 v103, v103
  v_pk_add_f32 v[100:101], v[100:101], v[98:99] op_sel_hi:[1,0]
  v_pk_add_f32 v[102:103], v[102:103], v[98:99] op_sel_hi:[1,0]
  v_rcp_f32 v100, v100
  v_rcp_f32 v101, v101
  v_rcp_f32 v102, v102
  v_rcp_f32 v103, v103
  v_pk_mul_f32 v[192:193], v[192:193], v[100:101]
  v_pk_mul_f32 v[194:195], v[194:195], v[102:103]
  v_cvt_pk_bf16_f32 v120, v192, v193
  v_cvt_pk_bf16_f32 v121, v194, v195
  v_pk_fma_f32 v[104:105], v[52:53], v[88:89], v[80:81] op_sel:[0,0,0] op_sel_hi:[1,0,1] neg_lo:[0,1,0] neg_hi:[0,1,0]
  v_pk_fma_f32 v[106:107], v[54:55], v[88:89], v[82:83] op_sel:[0,0,0] op_sel_hi:[1,0,1] neg_lo:[0,1,0] neg_hi:[0,1,0]
  v_pk_fma_f32 v[208:209], v[208:209], v[88:89], v[104:105] op_sel:[0,1,0] op_sel_hi:[1,1,1]
  v_pk_fma_f32 v[210:211], v[210:211], v[88:89], v[106:107] op_sel:[0,1,0] op_sel_hi:[1,1,1]
  v_pk_mul_f32 v[104:105], v[208:209], v[208:209]
  v_pk_mul_f32 v[106:107], v[210:211], v[210:211]
  v_pk_fma_f32 v[104:105], v[104:105], v[96:97], v[96:97] op_sel:[0,1,0] op_sel_hi:[1,1,0]
  v_pk_fma_f32 v[106:107], v[106:107], v[96:97], v[96:97] op_sel:[0,1,0] op_sel_hi:[1,1,0]
  v_pk_mul_f32 v[104:105], v[104:105], v[208:209]
  v_pk_mul_f32 v[106:107], v[106:107], v[210:211]
  v_exp_f32 v104, v104
  v_exp_f32 v105, v105
  v_exp_f32 v106, v106
  v_exp_f32 v107, v107
  v_pk_add_f32 v[104:105], v[104:105], v[98:99] op_sel_hi:[1,0]
  v_pk_add_f32 v[106:107], v[106:107], v[98:99] op_sel_hi:[1,0]
  v_rcp_f32 v104, v104
  v_rcp_f32 v105, v105
  v_rcp_f32 v106, v106
  v_rcp_f32 v107, v107
  v_pk_mul_f32 v[208:209], v[208:209], v[104:105]
  v_pk_mul_f32 v[210:211], v[210:211], v[106:107]
  v_cvt_pk_bf16_f32 v122, v208, v209
  v_cvt_pk_bf16_f32 v123, v210, v211
  s_add_u32 s3, s10, 51200
  s_nop 0
  v_permlane16_swap_b32 v120, v122
  v_permlane16_swap_b32 v121, v123
  buffer_store_dwordx4 v[120:123], v12, s[44:47], s3 offen sc1
  v_pk_fma_f32 v[100:101], v[40:41], v[90:91], v[68:69] op_sel:[0,0,0] op_sel_hi:[1,0,1] neg_lo:[0,1,0] neg_hi:[0,1,0]
  v_pk_fma_f32 v[102:103], v[42:43], v[90:91], v[70:71] op_sel:[0,0,0] op_sel_hi:[1,0,1] neg_lo:[0,1,0] neg_hi:[0,1,0]
  v_pk_fma_f32 v[164:165], v[164:165], v[90:91], v[100:101] op_sel:[0,1,0] op_sel_hi:[1,1,1]
  v_pk_fma_f32 v[166:167], v[166:167], v[90:91], v[102:103] op_sel:[0,1,0] op_sel_hi:[1,1,1]
  v_pk_mul_f32 v[100:101], v[164:165], v[164:165]
  v_pk_mul_f32 v[102:103], v[166:167], v[166:167]
  v_pk_fma_f32 v[100:101], v[100:101], v[96:97], v[96:97] op_sel:[0,1,0] op_sel_hi:[1,1,0]
  v_pk_fma_f32 v[102:103], v[102:103], v[96:97], v[96:97] op_sel:[0,1,0] op_sel_hi:[1,1,0]
  v_pk_mul_f32 v[100:101], v[100:101], v[164:165]
  v_pk_mul_f32 v[102:103], v[102:103], v[166:167]
  v_exp_f32 v100, v100
  v_exp_f32 v101, v101
  v_exp_f32 v102, v102
  v_exp_f32 v103, v103
  v_pk_add_f32 v[100:101], v[100:101], v[98:99] op_sel_hi:[1,0]
  v_pk_add_f32 v[102:103], v[102:103], v[98:99] op_sel_hi:[1,0]
  v_rcp_f32 v100, v100
  v_rcp_f32 v101, v101
  v_rcp_f32 v102, v102
  v_rcp_f32 v103, v103
  v_pk_mul_f32 v[164:165], v[164:165], v[100:101]
  v_pk_mul_f32 v[166:167], v[166:167], v[102:103]
  v_cvt_pk_bf16_f32 v108, v164, v165
  v_cvt_pk_bf16_f32 v109, v166, v167
  v_pk_fma_f32 v[104:105], v[44:45], v[90:91], v[72:73] op_sel:[0,0,0] op_sel_hi:[1,0,1] neg_lo:[0,1,0] neg_hi:[0,1,0]
  v_pk_fma_f32 v[106:107], v[46:47], v[90:91], v[74:75] op_sel:[0,0,0] op_sel_hi:[1,0,1] neg_lo:[0,1,0] neg_hi:[0,1,0]
  v_pk_fma_f32 v[180:181], v[180:181], v[90:91], v[104:105] op_sel:[0,1,0] op_sel_hi:[1,1,1]
  v_pk_fma_f32 v[182:183], v[182:183], v[90:91], v[106:107] op_sel:[0,1,0] op_sel_hi:[1,1,1]
  v_pk_mul_f32 v[104:105], v[180:181], v[180:181]
  v_pk_mul_f32 v[106:107], v[182:183], v[182:183]
  v_pk_fma_f32 v[104:105], v[104:105], v[96:97], v[96:97] op_sel:[0,1,0] op_sel_hi:[1,1,0]
  v_pk_fma_f32 v[106:107], v[106:107], v[96:97], v[96:97] op_sel:[0,1,0] op_sel_hi:[1,1,0]
  v_pk_mul_f32 v[104:105], v[104:105], v[180:181]
  v_pk_mul_f32 v[106:107], v[106:107], v[182:183]
  v_exp_f32 v104, v104
  v_exp_f32 v105, v105
  v_exp_f32 v106, v106
  v_exp_f32 v107, v107
  v_pk_add_f32 v[104:105], v[104:105], v[98:99] op_sel_hi:[1,0]
  v_pk_add_f32 v[106:107], v[106:107], v[98:99] op_sel_hi:[1,0]
  v_rcp_f32 v104, v104
  v_rcp_f32 v105, v105
  v_rcp_f32 v106, v106
  v_rcp_f32 v107, v107
  v_pk_mul_f32 v[180:181], v[180:181], v[104:105]
  v_pk_mul_f32 v[182:183], v[182:183], v[106:107]
  v_cvt_pk_bf16_f32 v110, v180, v181
  v_cvt_pk_bf16_f32 v111, v182, v183
  s_add_u32 s3, s10, 163840
  s_nop 0
  v_permlane16_swap_b32 v108, v110
  v_permlane16_swap_b32 v109, v111
  buffer_store_dwordx4 v[108:111], v12, s[44:47], s3 offen sc1
  v_pk_fma_f32 v[100:101], v[48:49], v[90:91], v[76:77] op_sel:[0,0,0] op_sel_hi:[1,0,1] neg_lo:[0,1,0] neg_hi:[0,1,0]
  v_pk_fma_f32 v[102:103], v[50:51], v[90:91], v[78:79] op_sel:[0,0,0] op_sel_hi:[1,0,1] neg_lo:[0,1,0] neg_hi:[0,1,0]
  v_pk_fma_f32 v[196:197], v[196:197], v[90:91], v[100:101] op_sel:[0,1,0] op_sel_hi:[1,1,1]
  v_pk_fma_f32 v[198:199], v[198:199], v[90:91], v[102:103] op_sel:[0,1,0] op_sel_hi:[1,1,1]
  v_pk_mul_f32 v[100:101], v[196:197], v[196:197]
  v_pk_mul_f32 v[102:103], v[198:199], v[198:199]
  v_pk_fma_f32 v[100:101], v[100:101], v[96:97], v[96:97] op_sel:[0,1,0] op_sel_hi:[1,1,0]
  v_pk_fma_f32 v[102:103], v[102:103], v[96:97], v[96:97] op_sel:[0,1,0] op_sel_hi:[1,1,0]
  v_pk_mul_f32 v[100:101], v[100:101], v[196:197]
  v_pk_mul_f32 v[102:103], v[102:103], v[198:199]
  v_exp_f32 v100, v100
  v_exp_f32 v101, v101
  v_exp_f32 v102, v102
  v_exp_f32 v103, v103
  v_pk_add_f32 v[100:101], v[100:101], v[98:99] op_sel_hi:[1,0]
  v_pk_add_f32 v[102:103], v[102:103], v[98:99] op_sel_hi:[1,0]
  v_rcp_f32 v100, v100
  v_rcp_f32 v101, v101
  v_rcp_f32 v102, v102
  v_rcp_f32 v103, v103
  v_pk_mul_f32 v[196:197], v[196:197], v[100:101]
  v_pk_mul_f32 v[198:199], v[198:199], v[102:103]
  v_cvt_pk_bf16_f32 v112, v196, v197
  v_cvt_pk_bf16_f32 v113, v198, v199
  v_pk_fma_f32 v[104:105], v[52:53], v[90:91], v[80:81] op_sel:[0,0,0] op_sel_hi:[1,0,1] neg_lo:[0,1,0] neg_hi:[0,1,0]
  v_pk_fma_f32 v[106:107], v[54:55], v[90:91], v[82:83] op_sel:[0,0,0] op_sel_hi:[1,0,1] neg_lo:[0,1,0] neg_hi:[0,1,0]
  v_pk_fma_f32 v[212:213], v[212:213], v[90:91], v[104:105] op_sel:[0,1,0] op_sel_hi:[1,1,1]
  v_pk_fma_f32 v[214:215], v[214:215], v[90:91], v[106:107] op_sel:[0,1,0] op_sel_hi:[1,1,1]
  v_pk_mul_f32 v[104:105], v[212:213], v[212:213]
  v_pk_mul_f32 v[106:107], v[214:215], v[214:215]
  v_pk_fma_f32 v[104:105], v[104:105], v[96:97], v[96:97] op_sel:[0,1,0] op_sel_hi:[1,1,0]
  v_pk_fma_f32 v[106:107], v[106:107], v[96:97], v[96:97] op_sel:[0,1,0] op_sel_hi:[1,1,0]
  v_pk_mul_f32 v[104:105], v[104:105], v[212:213]
  v_pk_mul_f32 v[106:107], v[106:107], v[214:215]
  v_exp_f32 v104, v104
  v_exp_f32 v105, v105
  v_exp_f32 v106, v106
  v_exp_f32 v107, v107
  v_pk_add_f32 v[104:105], v[104:105], v[98:99] op_sel_hi:[1,0]
  v_pk_add_f32 v[106:107], v[106:107], v[98:99] op_sel_hi:[1,0]
  v_rcp_f32 v104, v104
  v_rcp_f32 v105, v105
  v_rcp_f32 v106, v106
  v_rcp_f32 v107, v107
  v_pk_mul_f32 v[212:213], v[212:213], v[104:105]
  v_pk_mul_f32 v[214:215], v[214:215], v[106:107]
  v_cvt_pk_bf16_f32 v114, v212, v213
  v_cvt_pk_bf16_f32 v115, v214, v215
  s_add_u32 s3, s10, 165888
  s_nop 0
  v_permlane16_swap_b32 v112, v114
  v_permlane16_swap_b32 v113, v115
  buffer_store_dwordx4 v[112:115], v12, s[44:47], s3 offen sc1
  v_pk_fma_f32 v[100:101], v[40:41], v[92:93], v[68:69] op_sel:[0,0,0] op_sel_hi:[1,0,1] neg_lo:[0,1,0] neg_hi:[0,1,0]
  v_pk_fma_f32 v[102:103], v[42:43], v[92:93], v[70:71] op_sel:[0,0,0] op_sel_hi:[1,0,1] neg_lo:[0,1,0] neg_hi:[0,1,0]
  v_pk_fma_f32 v[168:169], v[168:169], v[92:93], v[100:101] op_sel:[0,1,0] op_sel_hi:[1,1,1]
  v_pk_fma_f32 v[170:171], v[170:171], v[92:93], v[102:103] op_sel:[0,1,0] op_sel_hi:[1,1,1]
  v_pk_mul_f32 v[100:101], v[168:169], v[168:169]
  v_pk_mul_f32 v[102:103], v[170:171], v[170:171]
  v_pk_fma_f32 v[100:101], v[100:101], v[96:97], v[96:97] op_sel:[0,1,0] op_sel_hi:[1,1,0]
  v_pk_fma_f32 v[102:103], v[102:103], v[96:97], v[96:97] op_sel:[0,1,0] op_sel_hi:[1,1,0]
  v_pk_mul_f32 v[100:101], v[100:101], v[168:169]
  v_pk_mul_f32 v[102:103], v[102:103], v[170:171]
  v_exp_f32 v100, v100
  v_exp_f32 v101, v101
  v_exp_f32 v102, v102
  v_exp_f32 v103, v103
  v_pk_add_f32 v[100:101], v[100:101], v[98:99] op_sel_hi:[1,0]
  v_pk_add_f32 v[102:103], v[102:103], v[98:99] op_sel_hi:[1,0]
  v_rcp_f32 v100, v100
  v_rcp_f32 v101, v101
  v_rcp_f32 v102, v102
  v_rcp_f32 v103, v103
  v_pk_mul_f32 v[168:169], v[168:169], v[100:101]
  v_pk_mul_f32 v[170:171], v[170:171], v[102:103]
  v_cvt_pk_bf16_f32 v116, v168, v169
  v_cvt_pk_bf16_f32 v117, v170, v171
  v_pk_fma_f32 v[104:105], v[44:45], v[92:93], v[72:73] op_sel:[0,0,0] op_sel_hi:[1,0,1] neg_lo:[0,1,0] neg_hi:[0,1,0]
  v_pk_fma_f32 v[106:107], v[46:47], v[92:93], v[74:75] op_sel:[0,0,0] op_sel_hi:[1,0,1] neg_lo:[0,1,0] neg_hi:[0,1,0]
  v_pk_fma_f32 v[184:185], v[184:185], v[92:93], v[104:105] op_sel:[0,1,0] op_sel_hi:[1,1,1]
  v_pk_fma_f32 v[186:187], v[186:187], v[92:93], v[106:107] op_sel:[0,1,0] op_sel_hi:[1,1,1]
  v_pk_mul_f32 v[104:105], v[184:185], v[184:185]
  v_pk_mul_f32 v[106:107], v[186:187], v[186:187]
  v_pk_fma_f32 v[104:105], v[104:105], v[96:97], v[96:97] op_sel:[0,1,0] op_sel_hi:[1,1,0]
  v_pk_fma_f32 v[106:107], v[106:107], v[96:97], v[96:97] op_sel:[0,1,0] op_sel_hi:[1,1,0]
  v_pk_mul_f32 v[104:105], v[104:105], v[184:185]
  v_pk_mul_f32 v[106:107], v[106:107], v[186:187]
  v_exp_f32 v104, v104
  v_exp_f32 v105, v105
  v_exp_f32 v106, v106
  v_exp_f32 v107, v107
  v_pk_add_f32 v[104:105], v[104:105], v[98:99] op_sel_hi:[1,0]
  v_pk_add_f32 v[106:107], v[106:107], v[98:99] op_sel_hi:[1,0]
  v_rcp_f32 v104, v104
  v_rcp_f32 v105, v105
  v_rcp_f32 v106, v106
  v_rcp_f32 v107, v107
  v_pk_mul_f32 v[184:185], v[184:185], v[104:105]
  v_pk_mul_f32 v[186:187], v[186:187], v[106:107]
  v_cvt_pk_bf16_f32 v118, v184, v185
  v_cvt_pk_bf16_f32 v119, v186, v187
  s_add_u32 s3, s10, 278528
  s_nop 0
  v_permlane16_swap_b32 v116, v118
  v_permlane16_swap_b32 v117, v119
  buffer_store_dwordx4 v[116:119], v12, s[44:47], s3 offen sc1
  v_pk_fma_f32 v[100:101], v[48:49], v[92:93], v[76:77] op_sel:[0,0,0] op_sel_hi:[1,0,1] neg_lo:[0,1,0] neg_hi:[0,1,0]
  v_pk_fma_f32 v[102:103], v[50:51], v[92:93], v[78:79] op_sel:[0,0,0] op_sel_hi:[1,0,1] neg_lo:[0,1,0] neg_hi:[0,1,0]
  v_pk_fma_f32 v[200:201], v[200:201], v[92:93], v[100:101] op_sel:[0,1,0] op_sel_hi:[1,1,1]
  v_pk_fma_f32 v[202:203], v[202:203], v[92:93], v[102:103] op_sel:[0,1,0] op_sel_hi:[1,1,1]
  v_pk_mul_f32 v[100:101], v[200:201], v[200:201]
  v_pk_mul_f32 v[102:103], v[202:203], v[202:203]
  v_pk_fma_f32 v[100:101], v[100:101], v[96:97], v[96:97] op_sel:[0,1,0] op_sel_hi:[1,1,0]
  v_pk_fma_f32 v[102:103], v[102:103], v[96:97], v[96:97] op_sel:[0,1,0] op_sel_hi:[1,1,0]
  v_pk_mul_f32 v[100:101], v[100:101], v[200:201]
  v_pk_mul_f32 v[102:103], v[102:103], v[202:203]
  v_exp_f32 v100, v100
  v_exp_f32 v101, v101
  v_exp_f32 v102, v102
  v_exp_f32 v103, v103
  v_pk_add_f32 v[100:101], v[100:101], v[98:99] op_sel_hi:[1,0]
  v_pk_add_f32 v[102:103], v[102:103], v[98:99] op_sel_hi:[1,0]
  v_rcp_f32 v100, v100
  v_rcp_f32 v101, v101
  v_rcp_f32 v102, v102
  v_rcp_f32 v103, v103
  v_pk_mul_f32 v[200:201], v[200:201], v[100:101]
  v_pk_mul_f32 v[202:203], v[202:203], v[102:103]
  v_cvt_pk_bf16_f32 v120, v200, v201
  v_cvt_pk_bf16_f32 v121, v202, v203
  v_pk_fma_f32 v[104:105], v[52:53], v[92:93], v[80:81] op_sel:[0,0,0] op_sel_hi:[1,0,1] neg_lo:[0,1,0] neg_hi:[0,1,0]
  v_pk_fma_f32 v[106:107], v[54:55], v[92:93], v[82:83] op_sel:[0,0,0] op_sel_hi:[1,0,1] neg_lo:[0,1,0] neg_hi:[0,1,0]
  v_pk_fma_f32 v[216:217], v[216:217], v[92:93], v[104:105] op_sel:[0,1,0] op_sel_hi:[1,1,1]
  v_pk_fma_f32 v[218:219], v[218:219], v[92:93], v[106:107] op_sel:[0,1,0] op_sel_hi:[1,1,1]
  v_pk_mul_f32 v[104:105], v[216:217], v[216:217]
  v_pk_mul_f32 v[106:107], v[218:219], v[218:219]
  v_pk_fma_f32 v[104:105], v[104:105], v[96:97], v[96:97] op_sel:[0,1,0] op_sel_hi:[1,1,0]
  v_pk_fma_f32 v[106:107], v[106:107], v[96:97], v[96:97] op_sel:[0,1,0] op_sel_hi:[1,1,0]
  v_pk_mul_f32 v[104:105], v[104:105], v[216:217]
  v_pk_mul_f32 v[106:107], v[106:107], v[218:219]
  v_exp_f32 v104, v104
  v_exp_f32 v105, v105
  v_exp_f32 v106, v106
  v_exp_f32 v107, v107
  v_pk_add_f32 v[104:105], v[104:105], v[98:99] op_sel_hi:[1,0]
  v_pk_add_f32 v[106:107], v[106:107], v[98:99] op_sel_hi:[1,0]
  v_rcp_f32 v104, v104
  v_rcp_f32 v105, v105
  v_rcp_f32 v106, v106
  v_rcp_f32 v107, v107
  v_pk_mul_f32 v[216:217], v[216:217], v[104:105]
  v_pk_mul_f32 v[218:219], v[218:219], v[106:107]
  v_cvt_pk_bf16_f32 v122, v216, v217
  v_cvt_pk_bf16_f32 v123, v218, v219
  s_add_u32 s3, s10, 280576
  s_nop 0
  v_permlane16_swap_b32 v120, v122
  v_permlane16_swap_b32 v121, v123
  buffer_store_dwordx4 v[120:123], v12, s[44:47], s3 offen sc1
  v_pk_fma_f32 v[100:101], v[40:41], v[94:95], v[68:69] op_sel:[0,0,0] op_sel_hi:[1,0,1] neg_lo:[0,1,0] neg_hi:[0,1,0]
  v_pk_fma_f32 v[102:103], v[42:43], v[94:95], v[70:71] op_sel:[0,0,0] op_sel_hi:[1,0,1] neg_lo:[0,1,0] neg_hi:[0,1,0]
  v_pk_fma_f32 v[172:173], v[172:173], v[94:95], v[100:101] op_sel:[0,1,0] op_sel_hi:[1,1,1]
  v_pk_fma_f32 v[174:175], v[174:175], v[94:95], v[102:103] op_sel:[0,1,0] op_sel_hi:[1,1,1]
  v_pk_mul_f32 v[100:101], v[172:173], v[172:173]
  v_pk_mul_f32 v[102:103], v[174:175], v[174:175]
  v_pk_fma_f32 v[100:101], v[100:101], v[96:97], v[96:97] op_sel:[0,1,0] op_sel_hi:[1,1,0]
  v_pk_fma_f32 v[102:103], v[102:103], v[96:97], v[96:97] op_sel:[0,1,0] op_sel_hi:[1,1,0]
  v_pk_mul_f32 v[100:101], v[100:101], v[172:173]
  v_pk_mul_f32 v[102:103], v[102:103], v[174:175]
  v_exp_f32 v100, v100
  v_exp_f32 v101, v101
  v_exp_f32 v102, v102
  v_exp_f32 v103, v103
  v_pk_add_f32 v[100:101], v[100:101], v[98:99] op_sel_hi:[1,0]
  v_pk_add_f32 v[102:103], v[102:103], v[98:99] op_sel_hi:[1,0]
  v_rcp_f32 v100, v100
  v_rcp_f32 v101, v101
  v_rcp_f32 v102, v102
  v_rcp_f32 v103, v103
  v_pk_mul_f32 v[172:173], v[172:173], v[100:101]
  v_pk_mul_f32 v[174:175], v[174:175], v[102:103]
  v_cvt_pk_bf16_f32 v108, v172, v173
  v_cvt_pk_bf16_f32 v109, v174, v175
  v_pk_fma_f32 v[104:105], v[44:45], v[94:95], v[72:73] op_sel:[0,0,0] op_sel_hi:[1,0,1] neg_lo:[0,1,0] neg_hi:[0,1,0]
  v_pk_fma_f32 v[106:107], v[46:47], v[94:95], v[74:75] op_sel:[0,0,0] op_sel_hi:[1,0,1] neg_lo:[0,1,0] neg_hi:[0,1,0]
  v_pk_fma_f32 v[188:189], v[188:189], v[94:95], v[104:105] op_sel:[0,1,0] op_sel_hi:[1,1,1]
  v_pk_fma_f32 v[190:191], v[190:191], v[94:95], v[106:107] op_sel:[0,1,0] op_sel_hi:[1,1,1]
  v_pk_mul_f32 v[104:105], v[188:189], v[188:189]
  v_pk_mul_f32 v[106:107], v[190:191], v[190:191]
  v_pk_fma_f32 v[104:105], v[104:105], v[96:97], v[96:97] op_sel:[0,1,0] op_sel_hi:[1,1,0]
  v_pk_fma_f32 v[106:107], v[106:107], v[96:97], v[96:97] op_sel:[0,1,0] op_sel_hi:[1,1,0]
  v_pk_mul_f32 v[104:105], v[104:105], v[188:189]
  v_pk_mul_f32 v[106:107], v[106:107], v[190:191]
  v_exp_f32 v104, v104
  v_exp_f32 v105, v105
  v_exp_f32 v106, v106
  v_exp_f32 v107, v107
  v_pk_add_f32 v[104:105], v[104:105], v[98:99] op_sel_hi:[1,0]
  v_pk_add_f32 v[106:107], v[106:107], v[98:99] op_sel_hi:[1,0]
  v_rcp_f32 v104, v104
  v_rcp_f32 v105, v105
  v_rcp_f32 v106, v106
  v_rcp_f32 v107, v107
  v_pk_mul_f32 v[188:189], v[188:189], v[104:105]
  v_pk_mul_f32 v[190:191], v[190:191], v[106:107]
  v_cvt_pk_bf16_f32 v110, v188, v189
  v_cvt_pk_bf16_f32 v111, v190, v191
  s_add_u32 s3, s10, 393216
  s_nop 0
  v_permlane16_swap_b32 v108, v110
  v_permlane16_swap_b32 v109, v111
  buffer_store_dwordx4 v[108:111], v12, s[44:47], s3 offen sc1
  v_pk_fma_f32 v[100:101], v[48:49], v[94:95], v[76:77] op_sel:[0,0,0] op_sel_hi:[1,0,1] neg_lo:[0,1,0] neg_hi:[0,1,0]
  v_pk_fma_f32 v[102:103], v[50:51], v[94:95], v[78:79] op_sel:[0,0,0] op_sel_hi:[1,0,1] neg_lo:[0,1,0] neg_hi:[0,1,0]
  v_pk_fma_f32 v[204:205], v[204:205], v[94:95], v[100:101] op_sel:[0,1,0] op_sel_hi:[1,1,1]
  v_pk_fma_f32 v[206:207], v[206:207], v[94:95], v[102:103] op_sel:[0,1,0] op_sel_hi:[1,1,1]
  v_pk_mul_f32 v[100:101], v[204:205], v[204:205]
  v_pk_mul_f32 v[102:103], v[206:207], v[206:207]
  v_pk_fma_f32 v[100:101], v[100:101], v[96:97], v[96:97] op_sel:[0,1,0] op_sel_hi:[1,1,0]
  v_pk_fma_f32 v[102:103], v[102:103], v[96:97], v[96:97] op_sel:[0,1,0] op_sel_hi:[1,1,0]
  v_pk_mul_f32 v[100:101], v[100:101], v[204:205]
  v_pk_mul_f32 v[102:103], v[102:103], v[206:207]
  v_exp_f32 v100, v100
  v_exp_f32 v101, v101
  v_exp_f32 v102, v102
  v_exp_f32 v103, v103
  v_pk_add_f32 v[100:101], v[100:101], v[98:99] op_sel_hi:[1,0]
  v_pk_add_f32 v[102:103], v[102:103], v[98:99] op_sel_hi:[1,0]
  v_rcp_f32 v100, v100
  v_rcp_f32 v101, v101
  v_rcp_f32 v102, v102
  v_rcp_f32 v103, v103
  v_pk_mul_f32 v[204:205], v[204:205], v[100:101]
  v_pk_mul_f32 v[206:207], v[206:207], v[102:103]
  v_cvt_pk_bf16_f32 v112, v204, v205
  v_cvt_pk_bf16_f32 v113, v206, v207
  v_pk_fma_f32 v[104:105], v[52:53], v[94:95], v[80:81] op_sel:[0,0,0] op_sel_hi:[1,0,1] neg_lo:[0,1,0] neg_hi:[0,1,0]
  v_pk_fma_f32 v[106:107], v[54:55], v[94:95], v[82:83] op_sel:[0,0,0] op_sel_hi:[1,0,1] neg_lo:[0,1,0] neg_hi:[0,1,0]
  v_pk_fma_f32 v[220:221], v[220:221], v[94:95], v[104:105] op_sel:[0,1,0] op_sel_hi:[1,1,1]
  v_pk_fma_f32 v[222:223], v[222:223], v[94:95], v[106:107] op_sel:[0,1,0] op_sel_hi:[1,1,1]
  v_pk_mul_f32 v[104:105], v[220:221], v[220:221]
  v_pk_mul_f32 v[106:107], v[222:223], v[222:223]
  v_pk_fma_f32 v[104:105], v[104:105], v[96:97], v[96:97] op_sel:[0,1,0] op_sel_hi:[1,1,0]
  v_pk_fma_f32 v[106:107], v[106:107], v[96:97], v[96:97] op_sel:[0,1,0] op_sel_hi:[1,1,0]
  v_pk_mul_f32 v[104:105], v[104:105], v[220:221]
  v_pk_mul_f32 v[106:107], v[106:107], v[222:223]
  v_exp_f32 v104, v104
  v_exp_f32 v105, v105
  v_exp_f32 v106, v106
  v_exp_f32 v107, v107
  v_pk_add_f32 v[104:105], v[104:105], v[98:99] op_sel_hi:[1,0]
  v_pk_add_f32 v[106:107], v[106:107], v[98:99] op_sel_hi:[1,0]
  v_rcp_f32 v104, v104
  v_rcp_f32 v105, v105
  v_rcp_f32 v106, v106
  v_rcp_f32 v107, v107
  v_pk_mul_f32 v[220:221], v[220:221], v[104:105]
  v_pk_mul_f32 v[222:223], v[222:223], v[106:107]
  v_cvt_pk_bf16_f32 v114, v220, v221
  v_cvt_pk_bf16_f32 v115, v222, v223
  s_add_u32 s3, s10, 395264
  s_nop 0
  v_permlane16_swap_b32 v112, v114
  v_permlane16_swap_b32 v113, v115
  buffer_store_dwordx4 v[112:115], v12, s[44:47], s3 offen sc1
  s_waitcnt vmcnt(0) lgkmcnt(0)
  s_barrier
  s_add_u32 s97, s97, 1
  s_branch L_w2_body
L_w1_c1:
L_w2_c0:
L_w2_body:
  s_cmp_ge_u32 s2, 256
  s_cbranch_scc1 L_w2_end
  v_lshrrev_b32 v2, 6, v0
  v_and_b32 v1, 63, v0
  v_readfirstlane_b32 s70, v2
  s_and_b32 s3, s2, 7
  s_lshr_b32 s99, s2, 3
  s_and_b32 s5, s3, 3
  s_lshl_b32 s5, s5, 2
  s_and_b32 s6, s99, 3
  s_add_u32 s68, s5, s6
  s_lshr_b32 s5, s3, 2
  s_lshr_b32 s78, s99, 2
  s_lshl1_add_u32 s69, s78, s5
  s_add_u32 s3, s68, s78
  s_lshl_b32 s3, s3, 3
  s_lshl_b32 s85, 0xffff02, s3
  s_sub_u32 s3, 0, s3
  s_lshr_b32 s3, 0xffff02, s3
  s_or_b32 s85, s85, s3
  s_cmp_lt_u32 s70, 4
  s_cbranch_scc1 L_w2_compute
L_w2_loader:
  v_and_b32 v2, 3, v1
  v_lshlrev_b32 v2, 3, v2
  v_bfe_i32 v16, s85, v2, 8
  s_and_b32 s3, s68, 3
  s_mul_i32 s4, s3, 4
  v_add3_u32 v3, v16, v1, s4
  v_subrev_u32 v3, 20, v3
  v_and_b32 v3, 15, v3
  s_mul_i32 s3, s3, 1
  v_add3_u32 v16, v16, v1, 20
  s_bitcmp1_b32 s69, 0
  s_cselect_b32 s4, 20, 0
  v_subrev_u32 v2, 20, v16
  v_min_u32 v16, v16, v2
  v_subrev_u32 v2, 20, v16
  v_min_u32 v16, v16, v2
  v_cmp_gt_u32 vcc, 4, v16
  v_add_u32 v2, s3, v16
  v_subrev_u32 v17, 4, v2
  v_min_u32 v2, v17, v2
  v_cndmask_b32 v16, v16, v2, vcc
  v_cmp_gt_u32 vcc, 20, v1
  v_add_u32 v16, s4, v16
  v_add_u32 v3, 40, v3
  v_cndmask_b32 v3, v3, v16, vcc
  v_lshlrev_b32 v16, 17, v3
  s_add_u32 s9, s70, s68
  s_and_b32 s9, s9, 3
  s_lshl_b32 s77, s9, 11
  v_and_b32 v10, 7, v1
  v_lshrrev_b32 v3, 3, v1
  s_lshl_b32 s10, s9, 4
  v_add_u32 v3, s10, v3
  v_mul_u32_u24 v3, 2048, v3
  v_lshrrev_b32 v2, 3, v1
  v_and_b32 v2, 2, v2
  v_xor_b32 v2, v2, v10
  s_lshl_b32 s10, s69, 7
  v_add_u32 v3, s10, v3
  v_lshl_add_u32 v8, v2, 4, v3
  v_xor_b32 v2, 4, v2
  v_add_u32 v3, 16384, v3
  v_lshl_add_u32 v9, v2, 4, v3
  s_mov_b32 s40, s28
  s_and_b32 s41, s29, 0xffff
  s_mov_b32 s42, 7340032
  s_mov_b32 s43, 0x00020000
  s_bitcmp1_b32 s69, 0
  s_mov_b32 s76, 128
  s_cselect_b32 s76, -128, s76
  v_readlane_b32 s74, v16, 0
  s_add_u32 m0, s77, 0
  s_add_u32 s4, s74, s76
  buffer_load_dwordx4 v8, s[40:43], s4 offen lds
  s_add_u32 m0, s77, 1024
  s_nop 0
  buffer_load_dwordx4 v9, s[40:43], s4 offen lds
  s_add_u32 m0, s77, 8192
  s_add_u32 s4, s74, 0
  buffer_load_dwordx4 v8, s[40:43], s4 offen lds
  s_add_u32 m0, s77, 9216
  s_nop 0
  buffer_load_dwordx4 v9, s[40:43], s4 offen lds
  v_readlane_b32 s74, v16, 1
  s_add_u32 m0, s77, 16384
  s_add_u32 s4, s74, s76
  buffer_load_dwordx4 v8, s[40:43], s4 offen lds
  s_add_u32 m0, s77, 17408
  s_nop 0
  buffer_load_dwordx4 v9, s[40:43], s4 offen lds
  s_add_u32 m0, s77, 24576
  s_add_u32 s4, s74, 0
  buffer_load_dwordx4 v8, s[40:43], s4 offen lds
  s_add_u32 m0, s77, 25600
  s_nop 0
  buffer_load_dwordx4 v9, s[40:43], s4 offen lds
  v_readlane_b32 s74, v16, 2
  s_add_u32 m0, s77, 32768
  s_add_u32 s4, s74, s76
  buffer_load_dwordx4 v8, s[40:43], s4 offen lds
  s_add_u32 m0, s77, 33792
  s_nop 0
  buffer_load_dwordx4 v9, s[40:43], s4 offen lds
  s_add_u32 m0, s77, 40960
  s_add_u32 s4, s74, 0
  buffer_load_dwordx4 v8, s[40:43], s4 offen lds
  s_add_u32 m0, s77, 41984
  s_nop 0
  buffer_load_dwordx4 v9, s[40:43], s4 offen lds
  v_readlane_b32 s74, v16, 3
  s_add_u32 m0, s77, 49152
  s_add_u32 s4, s74, s76
  buffer_load_dwordx4 v8, s[40:43], s4 offen lds
  s_add_u32 m0, s77, 50176
  s_nop 0
  buffer_load_dwordx4 v9, s[40:43], s4 offen lds
  s_add_u32 m0, s77, 57344
  s_add_u32 s4, s74, 0
  buffer_load_dwordx4 v8, s[40:43], s4 offen lds
  s_add_u32 m0, s77, 58368
  s_nop 0
  buffer_load_dwordx4 v9, s[40:43], s4 offen lds
  v_readlane_b32 s74, v16, 4
  s_add_u32 m0, s77, 65536
  s_add_u32 s4, s74, s76
  buffer_load_dwordx4 v8, s[40:43], s4 offen lds
  s_add_u32 m0, s77, 66560
  s_nop 0
  buffer_load_dwordx4 v9, s[40:43], s4 offen lds
  s_add_u32 m0, s77, 73728
  s_add_u32 s4, s74, 0
  buffer_load_dwordx4 v8, s[40:43], s4 offen lds
  s_add_u32 m0, s77, 74752
  s_nop 0
  buffer_load_dwordx4 v9, s[40:43], s4 offen lds
  s_add_u32 s44, s22, 41943040
  s_addc_u32 s45, s23, 0
  s_and_b32 s45, s45, 0xffff
  s_mov_b32 s46, 524288
  s_mov_b32 s47, 0x00020000
  s_lshl4_add_u32 s3, s97, s68
  s_and_b32 s4, s69, 15
  s_lshl4_add_u32 s3, s3, s4
  s_lshl_b32 s3, s3, 7
  s_sub_u32 s3, s3, 32768
  v_lshlrev_b32 v11, 7, v1
  v_and_b32 v2, 15, v1
  v_lshlrev_b32 v2, 2, v2
  v_mov_b32 v3, 1
  s_mov_b32 s79, 0x100000
  s_cmp_lg_u32 s70, 4
  s_barrier
  s_cbranch_scc1 L_w2_nofl
  s_mov_b32 exec_lo, 0xffff
  s_mov_b32 exec_hi, 0
  buffer_store_dword v3, v11, s[44:47], s87 offen sc1
  s_mov_b64 exec, -1
L_w2_nofl:
  s_mov_b32 s5, s3
  v_readlane_b32 s74, v16, 5
  s_add_u32 m0, s77, 81920
  s_add_u32 s4, s74, s76
  buffer_load_dwordx4 v8, s[40:43], s4 offen lds
  s_add_u32 m0, s77, 82944
  s_nop 0
  buffer_load_dwordx4 v9, s[40:43], s4 offen lds
  s_add_u32 m0, s77, 90112
  s_add_u32 s4, s74, 0
  buffer_load_dwordx4 v8, s[40:43], s4 offen lds
  s_add_u32 m0, s77, 91136
  s_nop 0
  buffer_load_dwordx4 v9, s[40:43], s4 offen lds
  v_readlane_b32 s74, v16, 6
  s_add_u32 m0, s77, 98304
  s_add_u32 s4, s74, s76
  buffer_load_dwordx4 v8, s[40:43], s4 offen lds
  s_add_u32 m0, s77, 99328
  s_nop 0
  buffer_load_dwordx4 v9, s[40:43], s4 offen lds
  s_add_u32 m0, s77, 106496
  s_add_u32 s4, s74, 0
  buffer_load_dwordx4 v8, s[40:43], s4 offen lds
  s_add_u32 m0, s77, 107520
  s_nop 0
  buffer_load_dwordx4 v9, s[40:43], s4 offen lds
  v_readlane_b32 s74, v16, 7
  s_add_u32 m0, s77, 114688
  s_add_u32 s4, s74, s76
  buffer_load_dwordx4 v8, s[40:43], s4 offen lds
  s_add_u32 m0, s77, 115712
  s_nop 0
  buffer_load_dwordx4 v9, s[40:43], s4 offen lds
  s_add_u32 m0, s77, 122880
  s_add_u32 s4, s74, 0
  buffer_load_dwordx4 v8, s[40:43], s4 offen lds
  s_add_u32 m0, s77, 123904
  s_nop 0
  buffer_load_dwordx4 v9, s[40:43], s4 offen lds
  v_readlane_b32 s74, v16, 8
  s_add_u32 m0, s77, 131072
  s_add_u32 s4, s74, s76
  buffer_load_dwordx4 v8, s[40:43], s4 offen lds
  s_add_u32 m0, s77, 132096
  s_nop 0
  buffer_load_dwordx4 v9, s[40:43], s4 offen lds
  s_add_u32 m0, s77, 139264
  s_add_u32 s4, s74, 0
  buffer_load_dwordx4 v8, s[40:43], s4 offen lds
  s_add_u32 m0, s77, 140288
  s_nop 0
  buffer_load_dwordx4 v9, s[40:43], s4 offen lds
  v_readlane_b32 s74, v16, 9
  s_add_u32 m0, s77, 147456
  s_add_u32 s4, s74, s76
  buffer_load_dwordx4 v8, s[40:43], s4 offen lds
  s_add_u32 m0, s77, 148480
  s_nop 0
  buffer_load_dwordx4 v9, s[40:43], s4 offen lds
  s_add_u32 m0, s77, 155648
  s_add_u32 s4, s74, 0
  buffer_load_dwordx4 v8, s[40:43], s4 offen lds
  s_add_u32 m0, s77, 156672
  s_nop 0
  buffer_load_dwordx4 v9, s[40:43], s4 offen lds
  s_mov_b32 s3, s5
  s_cmp_lg_u32 s70, 4
  s_cbranch_scc1 L_w2_dep
L_w2_poll:
  buffer_load_dword v3, v2, s[44:47], s3 offen sc1
  s_sub_u32 s79, s79, 1
  s_cbranch_scc1 L_w2_dep
  s_waitcnt vmcnt(0)
  v_cmp_ne_u32 vcc, 1, v3
  s_cbranch_vccnz L_w2_poll
L_w2_dep:
  s_waitcnt vmcnt(30) lgkmcnt(0)
  s_barrier
  s_waitcnt vmcnt(22)
  s_barrier
  v_readlane_b32 s74, v16, 10
  s_add_u32 m0, s77, 0
  s_add_u32 s4, s74, s76
  buffer_load_dwordx4 v8, s[40:43], s4 offen lds
  s_add_u32 m0, s77, 1024
  s_nop 0
  buffer_load_dwordx4 v9, s[40:43], s4 offen lds
  s_waitcnt vmcnt(4)
  s_add_u32 m0, s77, 8192
  s_add_u32 s4, s74, 0
  buffer_load_dwordx4 v8, s[40:43], s4 offen lds
  s_add_u32 m0, s77, 9216
  s_nop 0
  buffer_load_dwordx4 v9, s[40:43], s4 offen lds
  s_waitcnt vmcnt(4)
  v_readlane_b32 s74, v16, 11
  s_add_u32 m0, s77, 16384
  s_add_u32 s4, s74, s76
  buffer_load_dwordx4 v8, s[40:43], s4 offen lds
  s_add_u32 m0, s77, 17408
  s_nop 0
  buffer_load_dwordx4 v9, s[40:43], s4 offen lds
  s_waitcnt vmcnt(4)
  s_add_u32 m0, s77, 24576
  s_add_u32 s4, s74, 0
  buffer_load_dwordx4 v8, s[40:43], s4 offen lds
  s_add_u32 m0, s77, 25600
  s_nop 0
  buffer_load_dwordx4 v9, s[40:43], s4 offen lds
  s_waitcnt vmcnt(22)
  s_barrier
  v_readlane_b32 s74, v16, 12
  s_add_u32 m0, s77, 32768
  s_add_u32 s4, s74, s76
  buffer_load_dwordx4 v8, s[40:43], s4 offen lds
  s_add_u32 m0, s77, 33792
  s_nop 0
  buffer_load_dwordx4 v9, s[40:43], s4 offen lds
  s_waitcnt vmcnt(4)
  s_add_u32 m0, s77, 40960
  s_add_u32 s4, s74, 0
  buffer_load_dwordx4 v8, s[40:43], s4 offen lds
  s_add_u32 m0, s77, 41984
  s_nop 0
  buffer_load_dwordx4 v9, s[40:43], s4 offen lds
  s_waitcnt vmcnt(4)
  v_readlane_b32 s74, v16, 13
  s_add_u32 m0, s77, 49152
  s_add_u32 s4, s74, s76
  buffer_load_dwordx4 v8, s[40:43], s4 offen lds
  s_add_u32 m0, s77, 50176
  s_nop 0
  buffer_load_dwordx4 v9, s[40:43], s4 offen lds
  s_waitcnt vmcnt(4)
  s_add_u32 m0, s77, 57344
  s_add_u32 s4, s74, 0
  buffer_load_dwordx4 v8, s[40:43], s4 offen lds
  s_add_u32 m0, s77, 58368
  s_nop 0
  buffer_load_dwordx4 v9, s[40:43], s4 offen lds
  s_waitcnt vmcnt(22)
  s_barrier
  v_readlane_b32 s74, v16, 14
  s_add_u32 m0, s77, 65536
  s_add_u32 s4, s74, s76
  buffer_load_dwordx4 v8, s[40:43], s4 offen lds
  s_add_u32 m0, s77, 66560
  s_nop 0
  buffer_load_dwordx4 v9, s[40:43], s4 offen lds
  s_waitcnt vmcnt(4)
  s_add_u32 m0, s77, 73728
  s_add_u32 s4, s74, 0
  buffer_load_dwordx4 v8, s[40:43], s4 offen lds
  s_add_u32 m0, s77, 74752
  s_nop 0
  buffer_load_dwordx4 v9, s[40:43], s4 offen lds
  s_waitcnt vmcnt(4)
  v_readlane_b32 s74, v16, 15
  s_add_u32 m0, s77, 81920
  s_add_u32 s4, s74, s76
  buffer_load_dwordx4 v8, s[40:43], s4 offen lds
  s_add_u32 m0, s77, 82944
  s_nop 0
  buffer_load_dwordx4 v9, s[40:43], s4 offen lds
  s_waitcnt vmcnt(4)
  s_add_u32 m0, s77, 90112
  s_add_u32 s4, s74, 0
  buffer_load_dwordx4 v8, s[40:43], s4 offen lds
  s_add_u32 m0, s77, 91136
  s_nop 0
  buffer_load_dwordx4 v9, s[40:43], s4 offen lds
  s_waitcnt vmcnt(22)
  s_barrier
  v_readlane_b32 s74, v16, 16
  s_add_u32 m0, s77, 98304
  s_add_u32 s4, s74, s76
  buffer_load_dwordx4 v8, s[40:43], s4 offen lds
  s_add_u32 m0, s77, 99328
  s_nop 0
  buffer_load_dwordx4 v9, s[40:43], s4 offen lds
  s_waitcnt vmcnt(4)
  s_add_u32 m0, s77, 106496
  s_add_u32 s4, s74, 0
  buffer_load_dwordx4 v8, s[40:43], s4 offen lds
  s_add_u32 m0, s77, 107520
  s_nop 0
  buffer_load_dwordx4 v9, s[40:43], s4 offen lds
  s_waitcnt vmcnt(4)
  v_readlane_b32 s74, v16, 17
  s_add_u32 m0, s77, 114688
  s_add_u32 s4, s74, s76
  buffer_load_dwordx4 v8, s[40:43], s4 offen lds
  s_add_u32 m0, s77, 115712
  s_nop 0
  buffer_load_dwordx4 v9, s[40:43], s4 offen lds
  s_waitcnt vmcnt(4)
  s_add_u32 m0, s77, 122880
  s_add_u32 s4, s74, 0
  buffer_load_dwordx4 v8, s[40:43], s4 offen lds
  s_add_u32 m0, s77, 123904
  s_nop 0
  buffer_load_dwordx4 v9, s[40:43], s4 offen lds
  s_waitcnt vmcnt(22)
  s_barrier
  v_readlane_b32 s74, v16, 18
  s_add_u32 m0, s77, 131072
  s_add_u32 s4, s74, s76
  buffer_load_dwordx4 v8, s[40:43], s4 offen lds
  s_add_u32 m0, s77, 132096
  s_nop 0
  buffer_load_dwordx4 v9, s[40:43], s4 offen lds
  s_waitcnt vmcnt(4)
  s_add_u32 m0, s77, 139264
  s_add_u32 s4, s74, 0
  buffer_load_dwordx4 v8, s[40:43], s4 offen lds
  s_add_u32 m0, s77, 140288
  s_nop 0
  buffer_load_dwordx4 v9, s[40:43], s4 offen lds
  s_waitcnt vmcnt(4)
  v_readlane_b32 s74, v16, 19
  s_add_u32 m0, s77, 147456
  s_add_u32 s4, s74, s76
  buffer_load_dwordx4 v8, s[40:43], s4 offen lds
  s_add_u32 m0, s77, 148480
  s_nop 0
  buffer_load_dwordx4 v9, s[40:43], s4 offen lds
  s_waitcnt vmcnt(4)
  s_add_u32 m0, s77, 155648
  s_add_u32 s4, s74, 0
  buffer_load_dwordx4 v8, s[40:43], s4 offen lds
  s_add_u32 m0, s77, 156672
  s_nop 0
  buffer_load_dwordx4 v9, s[40:43], s4 offen lds
  s_waitcnt vmcnt(22)
  s_barrier
  v_readlane_b32 s74, v16, 20
  s_add_u32 m0, s77, 0
  s_add_u32 s4, s74, 0
  buffer_load_dwordx4 v8, s[40:43], s4 offen lds
  s_add_u32 m0, s77, 1024
  s_nop 0
  buffer_load_dwordx4 v9, s[40:43], s4 offen lds
  s_waitcnt vmcnt(4)
  v_readlane_b32 s74, v16, 21
  s_add_u32 m0, s77, 8192
  s_add_u32 s4, s74, 0
  buffer_load_dwordx4 v8, s[40:43], s4 offen lds
  s_add_u32 m0, s77, 9216
  s_nop 0
  buffer_load_dwordx4 v9, s[40:43], s4 offen lds
  s_waitcnt vmcnt(4)
  v_readlane_b32 s74, v16, 22
  s_add_u32 m0, s77, 16384
  s_add_u32 s4, s74, 0
  buffer_load_dwordx4 v8, s[40:43], s4 offen lds
  s_add_u32 m0, s77, 17408
  s_nop 0
  buffer_load_dwordx4 v9, s[40:43], s4 offen lds
  s_waitcnt vmcnt(4)
  v_readlane_b32 s74, v16, 23
  s_add_u32 m0, s77, 24576
  s_add_u32 s4, s74, 0
  buffer_load_dwordx4 v8, s[40:43], s4 offen lds
  s_add_u32 m0, s77, 25600
  s_nop 0
  buffer_load_dwordx4 v9, s[40:43], s4 offen lds
  s_waitcnt vmcnt(22)
  s_barrier
  v_readlane_b32 s74, v16, 24
  s_add_u32 m0, s77, 32768
  s_add_u32 s4, s74, 0
  buffer_load_dwordx4 v8, s[40:43], s4 offen lds
  s_add_u32 m0, s77, 33792
  s_nop 0
  buffer_load_dwordx4 v9, s[40:43], s4 offen lds
  s_waitcnt vmcnt(4)
  v_readlane_b32 s74, v16, 25
  s_add_u32 m0, s77, 40960
  s_add_u32 s4, s74, 0
  buffer_load_dwordx4 v8, s[40:43], s4 offen lds
  s_add_u32 m0, s77, 41984
  s_nop 0
  buffer_load_dwordx4 v9, s[40:43], s4 offen lds
  s_waitcnt vmcnt(4)
  v_readlane_b32 s74, v16, 26
  s_add_u32 m0, s77, 49152
  s_add_u32 s4, s74, 0
  buffer_load_dwordx4 v8, s[40:43], s4 offen lds
  s_add_u32 m0, s77, 50176
  s_nop 0
  buffer_load_dwordx4 v9, s[40:43], s4 offen lds
  s_waitcnt vmcnt(4)
  v_readlane_b32 s74, v16, 27
  s_add_u32 m0, s77, 57344
  s_add_u32 s4, s74, 0
  buffer_load_dwordx4 v8, s[40:43], s4 offen lds
  s_add_u32 m0, s77, 58368
  s_nop 0
  buffer_load_dwordx4 v9, s[40:43], s4 offen lds
  s_waitcnt vmcnt(22)
  s_barrier
  v_readlane_b32 s74, v16, 28
  s_add_u32 m0, s77, 65536
  s_add_u32 s4, s74, 0
  buffer_load_dwordx4 v8, s[40:43], s4 offen lds
  s_add_u32 m0, s77, 66560
  s_nop 0
  buffer_load_dwordx4 v9, s[40:43], s4 offen lds
  s_waitcnt vmcnt(4)
  v_readlane_b32 s74, v16, 29
  s_add_u32 m0, s77, 73728
  s_add_u32 s4, s74, 0
  buffer_load_dwordx4 v8, s[40:43], s4 offen lds
  s_add_u32 m0, s77, 74752
  s_nop 0
  buffer_load_dwordx4 v9, s[40:43], s4 offen lds
  s_waitcnt vmcnt(4)
  v_readlane_b32 s74, v16, 30
  s_add_u32 m0, s77, 81920
  s_add_u32 s4, s74, 0
  buffer_load_dwordx4 v8, s[40:43], s4 offen lds
  s_add_u32 m0, s77, 82944
  s_nop 0
  buffer_load_dwordx4 v9, s[40:43], s4 offen lds
  s_waitcnt vmcnt(4)
  v_readlane_b32 s74, v16, 31
  s_add_u32 m0, s77, 90112
  s_add_u32 s4, s74, 0
  buffer_load_dwordx4 v8, s[40:43], s4 offen lds
  s_add_u32 m0, s77, 91136
  s_nop 0
  buffer_load_dwordx4 v9, s[40:43], s4 offen lds
  s_waitcnt vmcnt(22)
  s_barrier
  v_readlane_b32 s74, v16, 32
  s_add_u32 m0, s77, 98304
  s_add_u32 s4, s74, 0
  buffer_load_dwordx4 v8, s[40:43], s4 offen lds
  s_add_u32 m0, s77, 99328
  s_nop 0
  buffer_load_dwordx4 v9, s[40:43], s4 offen lds
  s_waitcnt vmcnt(4)
  v_readlane_b32 s74, v16, 33
  s_add_u32 m0, s77, 106496
  s_add_u32 s4, s74, 0
  buffer_load_dwordx4 v8, s[40:43], s4 offen lds
  s_add_u32 m0, s77, 107520
  s_nop 0
  buffer_load_dwordx4 v9, s[40:43], s4 offen lds
  s_waitcnt vmcnt(4)
  v_readlane_b32 s74, v16, 34
  s_add_u32 m0, s77, 114688
  s_add_u32 s4, s74, 0
  buffer_load_dwordx4 v8, s[40:43], s4 offen lds
  s_add_u32 m0, s77, 115712
  s_nop 0
  buffer_load_dwordx4 v9, s[40:43], s4 offen lds
  s_waitcnt vmcnt(4)
  v_readlane_b32 s74, v16, 35
  s_add_u32 m0, s77, 122880
  s_add_u32 s4, s74, 0
  buffer_load_dwordx4 v8, s[40:43], s4 offen lds
  s_add_u32 m0, s77, 123904
  s_nop 0
  buffer_load_dwordx4 v9, s[40:43], s4 offen lds
  s_waitcnt vmcnt(18)
  s_barrier
  s_add_u32 s64, s22, 41943040
  s_addc_u32 s65, s23, 0
  s_and_b32 s65, s65, 0xffff
  s_mov_b32 s66, 524288
  s_mov_b32 s67, 0x00020000
  s_lshl4_add_u32 s6, s68, s69
  s_xor_b32 s6, s6, 1
  s_add_u32 s7, s96, 4
  s_lshl_b32 s7, s7, 8
  s_add_u32 s6, s6, s7
  s_lshl_b32 s6, s6, 8
  v_and_b32 v2, 3, v1
  v_lshlrev_b32 v2, 6, v2
  s_mov_b32 s79, 0x100000
  s_waitcnt vmcnt(8)
  s_barrier
  s_cmp_lg_u32 s70, 4
  s_cbranch_scc1 L_w2_xgo
  s_setprio 3
L_w2_xpoll:
  buffer_load_dword v5, v2, s[64:67], s6 offen sc1
  s_sub_u32 s79, s79, 1
  s_cbranch_scc1 L_w2_xgo
  s_waitcnt vmcnt(0)
  v_cmp_ne_u32 vcc, 1, v5
  s_cbranch_vccnz L_w2_xpoll
L_w2_xgo:
  s_setprio 0
  s_waitcnt vmcnt(0)
  s_barrier
  s_cmp_eq_u32 s96, 1
  s_cbranch_scc1 L_w2_end
  s_lshl_b32 s87, s97, 15
  s_lshl_b32 s4, s68, 11
  s_add_u32 s87, s87, s4
  s_lshl_b32 s4, s69, 2
  s_add_u32 s87, s87, s4
  s_mov_b32 s96, 1
  s_add_u32 s12, s22, 33554432
  s_addc_u32 s13, s23, 0
  s_add_u32 s34, s22, 67108864
  s_addc_u32 s35, s23, 0
  s_add_u32 s97, s97, 1
  s_branch L_attn_body
L_w2_end:
  s_endpgm
L_w2_compute:
  v_and_b32 v2, 3, v1
  v_lshlrev_b32 v2, 3, v2
  v_bfe_i32 v15, s85, v2, 8
  s_and_b32 s3, s68, 3
  s_mul_i32 s4, s3, 4
  v_add3_u32 v3, v15, v1, s4
  v_subrev_u32 v3, 20, v3
  v_and_b32 v3, 15, v3
  s_mul_i32 s3, s3, 1
  v_add3_u32 v15, v15, v1, 20
  s_bitcmp1_b32 s69, 0
  s_cselect_b32 s4, 20, 0
  v_subrev_u32 v2, 20, v15
  v_min_u32 v15, v15, v2
  v_subrev_u32 v2, 20, v15
  v_min_u32 v15, v15, v2
  v_cmp_gt_u32 vcc, 4, v15
  v_add_u32 v2, s3, v15
  v_subrev_u32 v16, 4, v2
  v_min_u32 v2, v16, v2
  v_cndmask_b32 v15, v15, v2, vcc
  v_cmp_gt_u32 vcc, 20, v1
  v_add_u32 v15, s4, v15
  v_add_u32 v3, 40, v3
  v_cndmask_b32 v3, v3, v15, vcc
  v_lshlrev_b32 v15, 11, v3
  v_and_b32 v3, 15, v1
  v_lshrrev_b32 v2, 4, v1
  s_lshl_b32 s8, s68, 7
  s_lshl_b32 s9, s70, 5
  s_add_u32 s8, s8, s9
  s_mul_i32 s9, s8, 7168
  v_lshl_add_u32 v4, v1, 4, s9
  v_add_u32 v5, 114688, v4
  v_add_u32 v13, s8, v3
  s_lshl_b32 s10, s69, 7
  v_lshl_add_u32 v14, v2, 3, s10
  v_and_b32 v16, 1, v2
  v_lshrrev_b32 v17, 1, v2
  v_lshlrev_b32 v16, 5, v16
  v_lshl_add_u32 v16, v17, 4, v16
  v_add_u32 v16, s10, v16
  s_cmp_eq_u32 s96, 0
  s_cselect_b32 s7, 128, 0
  s_add_u32 s7, s7, 2048
  v_mad_u32_u24 v12, v13, s7, v16
  v_lshl_add_u32 v18, v17, 4, v13
  v_lshlrev_b32 v18, 3, v18
  v_and_b32 v16, 1, v2
  v_lshl_add_u32 v18, v16, 2, v18
  s_lshl_b32 s10, s69, 14
  v_add_u32 v18, s10, v18
  v_bfe_u32 v6, v1, 2, 2
  v_lshl_add_u32 v6, v2, 3, v6
  v_lshlrev_b32 v6, 7, v6
  v_and_b32 v17, 3, v1
  v_lshl_add_u32 v6, v17, 3, v6
  v_bfe_u32 v17, v1, 3, 2
  v_lshl_add_u32 v6, v17, 5, v6
  v_xor_b32 v7, 32, v6
  v_xor_b32 v8, 64, v6
  v_xor_b32 v9, 96, v6
  s_mov_b32 s11, 0xffff0000
  s_mov_b32 s52, s30
  s_and_b32 s53, s31, 0xffff
  s_mov_b32 s54, 2048
  s_mov_b32 s55, 0x00020000
  buffer_load_dwordx2 v[192:193], v14, s[52:55], 0 offen offset:0
  buffer_load_dwordx2 v[194:195], v14, s[52:55], 0 offen offset:32
  buffer_load_dwordx2 v[196:197], v14, s[52:55], 0 offen offset:64
  buffer_load_dwordx2 v[198:199], v14, s[52:55], 0 offen offset:96
  s_add_u32 s36, s34, 8388608
  s_addc_u32 s37, s35, 0
  s_and_b32 s37, s37, 0xffff
  s_mov_b32 s38, 14680064
  s_mov_b32 s39, 0x00020000
  s_mov_b32 s44, s32
  s_and_b32 s45, s33, 0xffff
  s_mov_b32 s46, 4194304
  s_mov_b32 s47, 0x00020000
  s_add_u32 s48, s22, 33554432
  s_addc_u32 s49, s23, 0
  s_and_b32 s49, s49, 0xffff
  s_mov_b32 s50, 4194304
  s_mov_b32 s51, 0x00020000
  s_cmp_eq_u32 s96, 0
  s_cselect_b64 s[44:45], s[48:49], s[44:45]
  s_lshl_b32 s46, s7, 11
  s_add_u32 s56, s34, 24379392
  s_addc_u32 s57, s35, 0
  s_and_b32 s57, s57, 0xffff
  s_mov_b32 s58, 262144
  s_mov_b32 s59, 0x00020000
  s_mul_i32 s9, s8, 7168
  s_add_u32 s36, s36, s9
  s_addc_u32 s37, s37, 0x100000
  s_add_u32 s64, s36, 114688
  s_addc_u32 s65, s37, 0
  s_mov_b32 s38, 114688
  s_mov_b32 s39, 0x00800000
  s_mov_b32 s66, 114688
  s_mov_b32 s67, 0x00800000
  s_add_u32 s60, s34, 25165824
  s_addc_u32 s61, s35, 0
  s_and_b32 s61, s61, 0xffff
  s_mov_b32 s62, 4194304
  s_mov_b32 s63, 0x00020000
  s_or_b32 s61, s61, 0x100000
  s_mov_b32 s63, 0x00800000
  s_lshl4_add_u32 s4, s68, s69
  s_lshl2_add_u32 s4, s4, s70
  s_add_u32 s52, s22, 41943040
  s_addc_u32 s53, s23, 0
  s_and_b32 s53, s53, 0xffff
  s_mov_b32 s54, 524288
  s_mov_b32 s55, 0x00020000
  s_add_u32 s6, s96, 4
  s_lshl_b32 s6, s6, 10
  s_add_u32 s6, s6, s4
  s_lshl_b32 s6, s6, 6
  v_mov_b32 v19, 1
  s_lshl_b32 s4, s4, 12
  s_xor_b32 s5, s4, 16384
  v_mov_b32 v128, 0
  v_mov_b32 v129, 0
  v_mov_b32 v130, 0
  v_mov_b32 v131, 0
  v_mov_b32 v132, 0
  v_mov_b32 v133, 0
  v_mov_b32 v134, 0
  v_mov_b32 v135, 0
  v_mov_b32 v136, 0
  v_mov_b32 v137, 0
  v_mov_b32 v138, 0
  v_mov_b32 v139, 0
  v_mov_b32 v140, 0
  v_mov_b32 v141, 0
  v_mov_b32 v142, 0
  v_mov_b32 v143, 0
  v_mov_b32 v144, 0
  v_mov_b32 v145, 0
  v_mov_b32 v146, 0
  v_mov_b32 v147, 0
  v_mov_b32 v148, 0
  v_mov_b32 v149, 0
  v_mov_b32 v150, 0
  v_mov_b32 v151, 0
  v_mov_b32 v152, 0
  v_mov_b32 v153, 0
  v_mov_b32 v154, 0
  v_mov_b32 v155, 0
  v_mov_b32 v156, 0
  v_mov_b32 v157, 0
  v_mov_b32 v158, 0
  v_mov_b32 v159, 0
  v_add_u32 v26, 131072, v6
  v_add_u32 v27, 131072, v7
  v_add_u32 v28, 131072, v8
  v_add_u32 v29, 131072, v9
  v_add_u32 v20, 65536, v6
  v_add_u32 v21, 65536, v7
  v_add_u32 v22, 65536, v8
  v_add_u32 v23, 65536, v9
  v_readlane_b32 s48, v15, 0
  v_readlane_b32 s49, v15, 1
  v_readlane_b32 s50, v15, 2
  v_permlane16_swap_b32 v240, v242
  v_permlane16_swap_b32 v241, v243
  v_permlane16_swap_b32 v244, v246
  v_permlane16_swap_b32 v245, v247
  v_permlane16_swap_b32 v248, v250
  v_permlane16_swap_b32 v249, v251
  v_permlane16_swap_b32 v252, v254
  v_permlane16_swap_b32 v253, v255
  s_waitcnt lgkmcnt(0)
  s_barrier
  buffer_load_dwordx4 v[32:35], off, s[36:39], s48 offset:0
  buffer_load_dwordx4 v[36:39], off, s[64:67], s48 offset:0
  buffer_load_dwordx4 v[40:43], off, s[36:39], s48 offset:1024
  buffer_load_dwordx4 v[44:47], off, s[64:67], s48 offset:1024
  buffer_load_dwordx4 v[48:51], off, s[36:39], s49 offset:0
  buffer_load_dwordx4 v[52:55], off, s[64:67], s49 offset:0
  buffer_load_dwordx4 v[56:59], off, s[36:39], s49 offset:1024
  buffer_load_dwordx4 v[60:63], off, s[64:67], s49 offset:1024
  buffer_load_dwordx4 v[64:67], off, s[36:39], s50 offset:0
  buffer_load_dwordx4 v[68:71], off, s[64:67], s50 offset:0
  buffer_load_dwordx4 v[72:75], off, s[36:39], s50 offset:1024
  buffer_load_dwordx4 v[76:79], off, s[64:67], s50 offset:1024
  ds_read_b64_tr_b16 v[160:161], v6 offset:0
  ds_read_b64_tr_b16 v[162:163], v6 offset:512
  ds_read_b64_tr_b16 v[164:165], v7 offset:0
  ds_read_b64_tr_b16 v[166:167], v7 offset:512
  ds_read_b64_tr_b16 v[168:169], v8 offset:0
  ds_read_b64_tr_b16 v[170:171], v8 offset:512
  ds_read_b64_tr_b16 v[172:173], v9 offset:0
  ds_read_b64_tr_b16 v[174:175], v9 offset:512
  ds_read_b64_tr_b16 v[176:177], v6 offset:4096
  ds_read_b64_tr_b16 v[178:179], v6 offset:4608
  ds_read_b64_tr_b16 v[180:181], v7 offset:4096
  ds_read_b64_tr_b16 v[182:183], v7 offset:4608
  ds_read_b64_tr_b16 v[184:185], v8 offset:4096
  ds_read_b64_tr_b16 v[186:187], v8 offset:4608
  ds_read_b64_tr_b16 v[188:189], v9 offset:4096
  ds_read_b64_tr_b16 v[190:191], v9 offset:4608
  s_waitcnt vmcnt(12)
  v_lshlrev_b32 v216, 16, v192
  v_and_b32 v217, s11, v192
  v_lshlrev_b32 v218, 16, v193
  v_and_b32 v219, s11, v193
  v_lshlrev_b32 v96, 16, v240
  v_and_b32 v97, s11, v240
  v_pk_add_f32 v[96:97], v[96:97], v[216:217]
  v_lshlrev_b32 v98, 16, v241
  v_and_b32 v99, s11, v241
  v_pk_add_f32 v[98:99], v[98:99], v[218:219]
  v_lshlrev_b32 v100, 16, v248
  v_and_b32 v101, s11, v248
  v_pk_add_f32 v[100:101], v[100:101], v[216:217]
  v_lshlrev_b32 v102, 16, v249
  v_and_b32 v103, s11, v249
  v_pk_add_f32 v[102:103], v[102:103], v[218:219]
  v_lshlrev_b32 v216, 16, v194
  v_and_b32 v217, s11, v194
  v_lshlrev_b32 v218, 16, v195
  v_and_b32 v219, s11, v195
  v_lshlrev_b32 v104, 16, v242
  v_and_b32 v105, s11, v242
  v_pk_add_f32 v[104:105], v[104:105], v[216:217]
  v_lshlrev_b32 v106, 16, v243
  v_and_b32 v107, s11, v243
  v_pk_add_f32 v[106:107], v[106:107], v[218:219]
  v_lshlrev_b32 v108, 16, v250
  v_and_b32 v109, s11, v250
  v_pk_add_f32 v[108:109], v[108:109], v[216:217]
  v_lshlrev_b32 v110, 16, v251
  v_and_b32 v111, s11, v251
  v_pk_add_f32 v[110:111], v[110:111], v[218:219]
  v_lshlrev_b32 v216, 16, v196
  v_and_b32 v217, s11, v196
  v_lshlrev_b32 v218, 16, v197
  v_and_b32 v219, s11, v197
  v_lshlrev_b32 v112, 16, v244
  v_and_b32 v113, s11, v244
  v_pk_add_f32 v[112:113], v[112:113], v[216:217]
  v_lshlrev_b32 v114, 16, v245
  v_and_b32 v115, s11, v245
  v_pk_add_f32 v[114:115], v[114:115], v[218:219]
  v_lshlrev_b32 v116, 16, v252
  v_and_b32 v117, s11, v252
  v_pk_add_f32 v[116:117], v[116:117], v[216:217]
  v_lshlrev_b32 v118, 16, v253
  v_and_b32 v119, s11, v253
  v_pk_add_f32 v[118:119], v[118:119], v[218:219]
  v_lshlrev_b32 v216, 16, v198
  v_and_b32 v217, s11, v198
  v_lshlrev_b32 v218, 16, v199
  v_and_b32 v219, s11, v199
  v_lshlrev_b32 v120, 16, v246
  v_and_b32 v121, s11, v246
  v_pk_add_f32 v[120:121], v[120:121], v[216:217]
  v_lshlrev_b32 v122, 16, v247
  v_and_b32 v123, s11, v247
  v_pk_add_f32 v[122:123], v[122:123], v[218:219]
  v_lshlrev_b32 v124, 16, v254
  v_and_b32 v125, s11, v254
  v_pk_add_f32 v[124:125], v[124:125], v[216:217]
  v_lshlrev_b32 v126, 16, v255
  v_and_b32 v127, s11, v255
  v_pk_add_f32 v[126:127], v[126:127], v[218:219]
  s_waitcnt vmcnt(10) lgkmcnt(8)
  v_mfma_f32_16x16x32_bf16 v[128:131], v[160:163], v[32:35], v[128:131]
  ds_read_b64_tr_b16 v[192:193], v6 offset:8192
  v_readlane_b32 s51, v15, 3
  v_mfma_f32_16x16x32_bf16 v[132:135], v[160:163], v[36:39], v[132:135]
  ds_read_b64_tr_b16 v[194:195], v6 offset:8704
  v_mfma_f32_16x16x32_bf16 v[140:143], v[164:167], v[36:39], v[140:143]
  ds_read_b64_tr_b16 v[196:197], v7 offset:8192
  v_mfma_f32_16x16x32_bf16 v[136:139], v[164:167], v[32:35], v[136:139]
  buffer_load_dwordx4 v[80:83], off, s[36:39], s51 offset:0
  v_mfma_f32_16x16x32_bf16 v[144:147], v[168:171], v[32:35], v[144:147]
  ds_read_b64_tr_b16 v[198:199], v7 offset:8704
  ds_read_b64_tr_b16 v[200:201], v8 offset:8192
  v_mfma_f32_16x16x32_bf16 v[148:151], v[168:171], v[36:39], v[148:151]
  ds_read_b64_tr_b16 v[202:203], v8 offset:8704
  ds_read_b64_tr_b16 v[204:205], v9 offset:8192
  v_mfma_f32_16x16x32_bf16 v[156:159], v[172:175], v[36:39], v[156:159]
  buffer_load_dwordx4 v[84:87], off, s[64:67], s51 offset:0
  v_mfma_f32_16x16x32_bf16 v[152:155], v[172:175], v[32:35], v[152:155]
  ds_read_b64_tr_b16 v[206:207], v9 offset:8704
  s_waitcnt vmcnt(10) lgkmcnt(8)
  v_mfma_f32_16x16x32_bf16 v[128:131], v[176:179], v[40:43], v[128:131]
  ds_read_b64_tr_b16 v[208:209], v6 offset:12288
  v_mfma_f32_16x16x32_bf16 v[132:135], v[176:179], v[44:47], v[132:135]
  buffer_load_dwordx4 v[88:91], off, s[36:39], s51 offset:1024
  v_mfma_f32_16x16x32_bf16 v[140:143], v[180:183], v[44:47], v[140:143]
  ds_read_b64_tr_b16 v[210:211], v6 offset:12800
  ds_read_b64_tr_b16 v[212:213], v7 offset:12288
  v_mfma_f32_16x16x32_bf16 v[136:139], v[180:183], v[40:43], v[136:139]
  ds_read_b64_tr_b16 v[214:215], v7 offset:12800
  ds_read_b64_tr_b16 v[216:217], v8 offset:12288
  v_mfma_f32_16x16x32_bf16 v[144:147], v[184:187], v[40:43], v[144:147]
  buffer_load_dwordx4 v[92:95], off, s[64:67], s51 offset:1024
  v_mfma_f32_16x16x32_bf16 v[148:151], v[184:187], v[44:47], v[148:151]
  ds_read_b64_tr_b16 v[218:219], v8 offset:12800
  v_readlane_b32 s48, v15, 4
  v_mfma_f32_16x16x32_bf16 v[156:159], v[188:191], v[44:47], v[156:159]
  ds_read_b64_tr_b16 v[220:221], v9 offset:12288
  v_mfma_f32_16x16x32_bf16 v[152:155], v[188:191], v[40:43], v[152:155]
  ds_read_b64_tr_b16 v[222:223], v9 offset:12800
  s_waitcnt lgkmcnt(8)
  v_mfma_f32_16x16x32_bf16 v[96:99], v[192:195], v[32:35], v[96:99]
  buffer_load_dwordx4 v[224:227], off, s[36:39], s48 offset:0
  v_mfma_f32_16x16x32_bf16 v[100:103], v[192:195], v[36:39], v[100:103]
  ds_read_b64_tr_b16 v[160:161], v6 offset:16384
  ds_read_b64_tr_b16 v[162:163], v6 offset:16896
  v_mfma_f32_16x16x32_bf16 v[108:111], v[196:199], v[36:39], v[108:111]
  ds_read_b64_tr_b16 v[164:165], v7 offset:16384
  v_mfma_f32_16x16x32_bf16 v[104:107], v[196:199], v[32:35], v[104:107]
  buffer_load_dwordx4 v[228:231], off, s[64:67], s48 offset:0
  v_mfma_f32_16x16x32_bf16 v[112:115], v[200:203], v[32:35], v[112:115]
  ds_read_b64_tr_b16 v[166:167], v7 offset:16896
  ds_read_b64_tr_b16 v[168:169], v8 offset:16384
  v_mfma_f32_16x16x32_bf16 v[116:119], v[200:203], v[36:39], v[116:119]
  ds_read_b64_tr_b16 v[170:171], v8 offset:16896
  ds_read_b64_tr_b16 v[172:173], v9 offset:16384
  v_mfma_f32_16x16x32_bf16 v[124:127], v[204:207], v[36:39], v[124:127]
  buffer_load_dwordx4 v[232:235], off, s[36:39], s48 offset:1024
  v_mfma_f32_16x16x32_bf16 v[120:123], v[204:207], v[32:35], v[120:123]
  ds_read_b64_tr_b16 v[174:175], v9 offset:16896
  s_waitcnt lgkmcnt(8)
  v_mfma_f32_16x16x32_bf16 v[96:99], v[208:211], v[40:43], v[96:99]
  ds_read_b64_tr_b16 v[176:177], v6 offset:20480
  ds_read_b64_tr_b16 v[178:179], v6 offset:20992
  v_mfma_f32_16x16x32_bf16 v[100:103], v[208:211], v[44:47], v[100:103]
  buffer_load_dwordx4 v[236:239], off, s[64:67], s48 offset:1024
  v_mfma_f32_16x16x32_bf16 v[108:111], v[212:215], v[44:47], v[108:111]
  ds_read_b64_tr_b16 v[180:181], v7 offset:20480
  v_readlane_b32 s49, v15, 5
  v_mfma_f32_16x16x32_bf16 v[104:107], v[212:215], v[40:43], v[104:107]
  ds_read_b64_tr_b16 v[182:183], v7 offset:20992
  v_mfma_f32_16x16x32_bf16 v[112:115], v[216:219], v[40:43], v[112:115]
  ds_read_b64_tr_b16 v[184:185], v8 offset:20480
  v_mfma_f32_16x16x32_bf16 v[116:119], v[216:219], v[44:47], v[116:119]
  buffer_load_dwordx4 v[240:243], off, s[36:39], s49 offset:0
  v_mfma_f32_16x16x32_bf16 v[124:127], v[220:223], v[44:47], v[124:127]
  ds_read_b64_tr_b16 v[186:187], v8 offset:20992
  ds_read_b64_tr_b16 v[188:189], v9 offset:20480
  v_mfma_f32_16x16x32_bf16 v[120:123], v[220:223], v[40:43], v[120:123]
  ds_read_b64_tr_b16 v[190:191], v9 offset:20992
  s_waitcnt vmcnt(15) lgkmcnt(8)
  v_mfma_f32_16x16x32_bf16 v[128:131], v[160:163], v[48:51], v[128:131]
  buffer_load_dwordx4 v[244:247], off, s[64:67], s49 offset:0
  v_mfma_f32_16x16x32_bf16 v[132:135], v[160:163], v[52:55], v[132:135]
  ds_read_b64_tr_b16 v[192:193], v6 offset:24576
  ds_read_b64_tr_b16 v[194:195], v6 offset:25088
  v_mfma_f32_16x16x32_bf16 v[140:143], v[164:167], v[52:55], v[140:143]
  ds_read_b64_tr_b16 v[196:197], v7 offset:24576
  v_mfma_f32_16x16x32_bf16 v[136:139], v[164:167], v[48:51], v[136:139]
  buffer_load_dwordx4 v[248:251], off, s[36:39], s49 offset:1024
  v_mfma_f32_16x16x32_bf16 v[144:147], v[168:171], v[48:51], v[144:147]
  ds_read_b64_tr_b16 v[198:199], v7 offset:25088
  ds_read_b64_tr_b16 v[200:201], v8 offset:24576
  v_mfma_f32_16x16x32_bf16 v[148:151], v[168:171], v[52:55], v[148:151]
  ds_read_b64_tr_b16 v[202:203], v8 offset:25088
  ds_read_b64_tr_b16 v[204:205], v9 offset:24576
  v_mfma_f32_16x16x32_bf16 v[156:159], v[172:175], v[52:55], v[156:159]
  buffer_load_dwordx4 v[252:255], off, s[64:67], s49 offset:1024
  v_mfma_f32_16x16x32_bf16 v[152:155], v[172:175], v[48:51], v[152:155]
  ds_read_b64_tr_b16 v[206:207], v9 offset:25088
  s_waitcnt vmcnt(16) lgkmcnt(8)
  v_mfma_f32_16x16x32_bf16 v[128:131], v[176:179], v[56:59], v[128:131]
  ds_read_b64_tr_b16 v[208:209], v6 offset:28672
  v_readlane_b32 s50, v15, 6
  v_mfma_f32_16x16x32_bf16 v[132:135], v[176:179], v[60:63], v[132:135]
  ds_read_b64_tr_b16 v[210:211], v6 offset:29184
  v_mfma_f32_16x16x32_bf16 v[140:143], v[180:183], v[60:63], v[140:143]
  ds_read_b64_tr_b16 v[212:213], v7 offset:28672
  v_mfma_f32_16x16x32_bf16 v[136:139], v[180:183], v[56:59], v[136:139]
  buffer_load_dwordx4 v[32:35], off, s[36:39], s50 offset:0
  v_mfma_f32_16x16x32_bf16 v[144:147], v[184:187], v[56:59], v[144:147]
  ds_read_b64_tr_b16 v[214:215], v7 offset:29184
  ds_read_b64_tr_b16 v[216:217], v8 offset:28672
  v_mfma_f32_16x16x32_bf16 v[148:151], v[184:187], v[60:63], v[148:151]
  ds_read_b64_tr_b16 v[218:219], v8 offset:29184
  v_mfma_f32_16x16x32_bf16 v[156:159], v[188:191], v[60:63], v[156:159]
  ds_read_b64_tr_b16 v[220:221], v9 offset:28672
  v_mfma_f32_16x16x32_bf16 v[152:155], v[188:191], v[56:59], v[152:155]
  ds_read_b64_tr_b16 v[222:223], v9 offset:29184
  s_waitcnt lgkmcnt(8)
  v_mfma_f32_16x16x32_bf16 v[96:99], v[192:195], v[48:51], v[96:99]
  ds_read_b64_tr_b16 v[160:161], v6 offset:32768
  v_mfma_f32_16x16x32_bf16 v[100:103], v[192:195], v[52:55], v[100:103]
  ds_read_b64_tr_b16 v[162:163], v6 offset:33280
  v_mfma_f32_16x16x32_bf16 v[108:111], v[196:199], v[52:55], v[108:111]
  buffer_load_dwordx4 v[36:39], off, s[64:67], s50 offset:0
  v_mfma_f32_16x16x32_bf16 v[104:107], v[196:199], v[48:51], v[104:107]
  ds_read_b64_tr_b16 v[164:165], v7 offset:32768
  ds_read_b64_tr_b16 v[166:167], v7 offset:33280
  v_mfma_f32_16x16x32_bf16 v[112:115], v[200:203], v[48:51], v[112:115]
  ds_read_b64_tr_b16 v[168:169], v8 offset:32768
  v_mfma_f32_16x16x32_bf16 v[116:119], v[200:203], v[52:55], v[116:119]
  ds_read_b64_tr_b16 v[170:171], v8 offset:33280
  v_mfma_f32_16x16x32_bf16 v[124:127], v[204:207], v[52:55], v[124:127]
  ds_read_b64_tr_b16 v[172:173], v9 offset:32768
  v_mfma_f32_16x16x32_bf16 v[120:123], v[204:207], v[48:51], v[120:123]
  ds_read_b64_tr_b16 v[174:175], v9 offset:33280
  s_waitcnt lgkmcnt(8)
  s_barrier
  v_mfma_f32_16x16x32_bf16 v[96:99], v[208:211], v[56:59], v[96:99]
  ds_read_b64_tr_b16 v[176:177], v6 offset:36864
  v_mfma_f32_16x16x32_bf16 v[100:103], v[208:211], v[60:63], v[100:103]
  buffer_load_dwordx4 v[40:43], off, s[36:39], s50 offset:1024
  v_mfma_f32_16x16x32_bf16 v[108:111], v[212:215], v[60:63], v[108:111]
  ds_read_b64_tr_b16 v[178:179], v6 offset:37376
  ds_read_b64_tr_b16 v[180:181], v7 offset:36864
  v_mfma_f32_16x16x32_bf16 v[104:107], v[212:215], v[56:59], v[104:107]
  ds_read_b64_tr_b16 v[182:183], v7 offset:37376
  v_mfma_f32_16x16x32_bf16 v[112:115], v[216:219], v[56:59], v[112:115]
  ds_read_b64_tr_b16 v[184:185], v8 offset:36864
  v_mfma_f32_16x16x32_bf16 v[116:119], v[216:219], v[60:63], v[116:119]
  ds_read_b64_tr_b16 v[186:187], v8 offset:37376
  v_mfma_f32_16x16x32_bf16 v[124:127], v[220:223], v[60:63], v[124:127]
  ds_read_b64_tr_b16 v[188:189], v9 offset:36864
  v_mfma_f32_16x16x32_bf16 v[120:123], v[220:223], v[56:59], v[120:123]
  ds_read_b64_tr_b16 v[190:191], v9 offset:37376
  s_waitcnt vmcnt(17) lgkmcnt(8)
  v_mfma_f32_16x16x32_bf16 v[128:131], v[160:163], v[64:67], v[128:131]
  buffer_load_dwordx4 v[44:47], off, s[64:67], s50 offset:1024
  v_mfma_f32_16x16x32_bf16 v[132:135], v[160:163], v[68:71], v[132:135]
  ds_read_b64_tr_b16 v[192:193], v6 offset:40960
  ds_read_b64_tr_b16 v[194:195], v6 offset:41472
  v_mfma_f32_16x16x32_bf16 v[140:143], v[164:167], v[68:71], v[140:143]
  ds_read_b64_tr_b16 v[196:197], v7 offset:40960
  v_mfma_f32_16x16x32_bf16 v[136:139], v[164:167], v[64:67], v[136:139]
  ds_read_b64_tr_b16 v[198:199], v7 offset:41472
  v_mfma_f32_16x16x32_bf16 v[144:147], v[168:171], v[64:67], v[144:147]
  ds_read_b64_tr_b16 v[200:201], v8 offset:40960
  v_mfma_f32_16x16x32_bf16 v[148:151], v[168:171], v[68:71], v[148:151]
  ds_read_b64_tr_b16 v[202:203], v8 offset:41472
  v_readlane_b32 s51, v15, 7
  v_mfma_f32_16x16x32_bf16 v[156:159], v[172:175], v[68:71], v[156:159]
  ds_read_b64_tr_b16 v[204:205], v9 offset:40960
  v_mfma_f32_16x16x32_bf16 v[152:155], v[172:175], v[64:67], v[152:155]
  ds_read_b64_tr_b16 v[206:207], v9 offset:41472
  s_waitcnt vmcnt(16) lgkmcnt(8)
  v_mfma_f32_16x16x32_bf16 v[128:131], v[176:179], v[72:75], v[128:131]
  buffer_load_dwordx4 v[48:51], off, s[36:39], s51 offset:0
  v_mfma_f32_16x16x32_bf16 v[132:135], v[176:179], v[76:79], v[132:135]
  ds_read_b64_tr_b16 v[208:209], v6 offset:45056
  ds_read_b64_tr_b16 v[210:211], v6 offset:45568
  v_mfma_f32_16x16x32_bf16 v[140:143], v[180:183], v[76:79], v[140:143]
  ds_read_b64_tr_b16 v[212:213], v7 offset:45056
  v_mfma_f32_16x16x32_bf16 v[136:139], v[180:183], v[72:75], v[136:139]
  ds_read_b64_tr_b16 v[214:215], v7 offset:45568
  v_mfma_f32_16x16x32_bf16 v[144:147], v[184:187], v[72:75], v[144:147]
  ds_read_b64_tr_b16 v[216:217], v8 offset:45056
  v_mfma_f32_16x16x32_bf16 v[148:151], v[184:187], v[76:79], v[148:151]
  ds_read_b64_tr_b16 v[218:219], v8 offset:45568
  v_mfma_f32_16x16x32_bf16 v[156:159], v[188:191], v[76:79], v[156:159]
  ds_read_b64_tr_b16 v[220:221], v9 offset:45056
  v_mfma_f32_16x16x32_bf16 v[152:155], v[188:191], v[72:75], v[152:155]
  ds_read_b64_tr_b16 v[222:223], v9 offset:45568
  s_waitcnt lgkmcnt(8)
  v_mfma_f32_16x16x32_bf16 v[96:99], v[192:195], v[64:67], v[96:99]
  buffer_load_dwordx4 v[52:55], off, s[64:67], s51 offset:0
  v_mfma_f32_16x16x32_bf16 v[100:103], v[192:195], v[68:71], v[100:103]
  ds_read_b64_tr_b16 v[160:161], v6 offset:49152
  ds_read_b64_tr_b16 v[162:163], v6 offset:49664
  v_mfma_f32_16x16x32_bf16 v[108:111], v[196:199], v[68:71], v[108:111]
  ds_read_b64_tr_b16 v[164:165], v7 offset:49152
  v_mfma_f32_16x16x32_bf16 v[104:107], v[196:199], v[64:67], v[104:107]
  ds_read_b64_tr_b16 v[166:167], v7 offset:49664
  v_mfma_f32_16x16x32_bf16 v[112:115], v[200:203], v[64:67], v[112:115]
  ds_read_b64_tr_b16 v[168:169], v8 offset:49152
  v_mfma_f32_16x16x32_bf16 v[116:119], v[200:203], v[68:71], v[116:119]
  ds_read_b64_tr_b16 v[170:171], v8 offset:49664
  v_mfma_f32_16x16x32_bf16 v[124:127], v[204:207], v[68:71], v[124:127]
  ds_read_b64_tr_b16 v[172:173], v9 offset:49152
  v_mfma_f32_16x16x32_bf16 v[120:123], v[204:207], v[64:67], v[120:123]
  ds_read_b64_tr_b16 v[174:175], v9 offset:49664
  s_waitcnt lgkmcnt(8)
  v_mfma_f32_16x16x32_bf16 v[96:99], v[208:211], v[72:75], v[96:99]
  buffer_load_dwordx4 v[56:59], off, s[36:39], s51 offset:1024
  v_mfma_f32_16x16x32_bf16 v[100:103], v[208:211], v[76:79], v[100:103]
  ds_read_b64_tr_b16 v[176:177], v6 offset:53248
  ds_read_b64_tr_b16 v[178:179], v6 offset:53760
  v_mfma_f32_16x16x32_bf16 v[108:111], v[212:215], v[76:79], v[108:111]
  ds_read_b64_tr_b16 v[180:181], v7 offset:53248
  v_mfma_f32_16x16x32_bf16 v[104:107], v[212:215], v[72:75], v[104:107]
  ds_read_b64_tr_b16 v[182:183], v7 offset:53760
  v_mfma_f32_16x16x32_bf16 v[112:115], v[216:219], v[72:75], v[112:115]
  ds_read_b64_tr_b16 v[184:185], v8 offset:53248
  v_mfma_f32_16x16x32_bf16 v[116:119], v[216:219], v[76:79], v[116:119]
  ds_read_b64_tr_b16 v[186:187], v8 offset:53760
  v_mfma_f32_16x16x32_bf16 v[124:127], v[220:223], v[76:79], v[124:127]
  ds_read_b64_tr_b16 v[188:189], v9 offset:53248
  v_mfma_f32_16x16x32_bf16 v[120:123], v[220:223], v[72:75], v[120:123]
  ds_read_b64_tr_b16 v[190:191], v9 offset:53760
  s_waitcnt vmcnt(17) lgkmcnt(8)
  v_mfma_f32_16x16x32_bf16 v[128:131], v[160:163], v[80:83], v[128:131]
  buffer_load_dwordx4 v[60:63], off, s[64:67], s51 offset:1024
  v_mfma_f32_16x16x32_bf16 v[132:135], v[160:163], v[84:87], v[132:135]
  ds_read_b64_tr_b16 v[192:193], v6 offset:57344
  ds_read_b64_tr_b16 v[194:195], v6 offset:57856
  v_mfma_f32_16x16x32_bf16 v[140:143], v[164:167], v[84:87], v[140:143]
  ds_read_b64_tr_b16 v[196:197], v7 offset:57344
  v_mfma_f32_16x16x32_bf16 v[136:139], v[164:167], v[80:83], v[136:139]
  ds_read_b64_tr_b16 v[198:199], v7 offset:57856
  v_mfma_f32_16x16x32_bf16 v[144:147], v[168:171], v[80:83], v[144:147]
  ds_read_b64_tr_b16 v[200:201], v8 offset:57344
  v_mfma_f32_16x16x32_bf16 v[148:151], v[168:171], v[84:87], v[148:151]
  ds_read_b64_tr_b16 v[202:203], v8 offset:57856
  v_readlane_b32 s48, v15, 8
  v_mfma_f32_16x16x32_bf16 v[156:159], v[172:175], v[84:87], v[156:159]
  ds_read_b64_tr_b16 v[204:205], v9 offset:57344
  v_mfma_f32_16x16x32_bf16 v[152:155], v[172:175], v[80:83], v[152:155]
  ds_read_b64_tr_b16 v[206:207], v9 offset:57856
  s_waitcnt vmcnt(16) lgkmcnt(8)
  v_mfma_f32_16x16x32_bf16 v[128:131], v[176:179], v[88:91], v[128:131]
  buffer_load_dwordx4 v[64:67], off, s[36:39], s48 offset:0
  v_mfma_f32_16x16x32_bf16 v[132:135], v[176:179], v[92:95], v[132:135]
  ds_read_b64_tr_b16 v[208:209], v6 offset:61440
  ds_read_b64_tr_b16 v[210:211], v6 offset:61952
  v_mfma_f32_16x16x32_bf16 v[140:143], v[180:183], v[92:95], v[140:143]
  ds_read_b64_tr_b16 v[212:213], v7 offset:61440
  v_mfma_f32_16x16x32_bf16 v[136:139], v[180:183], v[88:91], v[136:139]
  ds_read_b64_tr_b16 v[214:215], v7 offset:61952
  v_mfma_f32_16x16x32_bf16 v[144:147], v[184:187], v[88:91], v[144:147]
  ds_read_b64_tr_b16 v[216:217], v8 offset:61440
  v_mfma_f32_16x16x32_bf16 v[148:151], v[184:187], v[92:95], v[148:151]
  ds_read_b64_tr_b16 v[218:219], v8 offset:61952
  v_mfma_f32_16x16x32_bf16 v[156:159], v[188:191], v[92:95], v[156:159]
  ds_read_b64_tr_b16 v[220:221], v9 offset:61440
  v_mfma_f32_16x16x32_bf16 v[152:155], v[188:191], v[88:91], v[152:155]
  ds_read_b64_tr_b16 v[222:223], v9 offset:61952
  s_waitcnt lgkmcnt(8)
  v_mfma_f32_16x16x32_bf16 v[96:99], v[192:195], v[80:83], v[96:99]
  buffer_load_dwordx4 v[68:71], off, s[64:67], s48 offset:0
  v_mfma_f32_16x16x32_bf16 v[100:103], v[192:195], v[84:87], v[100:103]
  ds_read_b64_tr_b16 v[160:161], v20 offset:0
  ds_read_b64_tr_b16 v[162:163], v20 offset:512
  v_mfma_f32_16x16x32_bf16 v[108:111], v[196:199], v[84:87], v[108:111]
  ds_read_b64_tr_b16 v[164:165], v21 offset:0
  v_mfma_f32_16x16x32_bf16 v[104:107], v[196:199], v[80:83], v[104:107]
  ds_read_b64_tr_b16 v[166:167], v21 offset:512
  v_mfma_f32_16x16x32_bf16 v[112:115], v[200:203], v[80:83], v[112:115]
  ds_read_b64_tr_b16 v[168:169], v22 offset:0
  v_mfma_f32_16x16x32_bf16 v[116:119], v[200:203], v[84:87], v[116:119]
  ds_read_b64_tr_b16 v[170:171], v22 offset:512
  v_mfma_f32_16x16x32_bf16 v[124:127], v[204:207], v[84:87], v[124:127]
  ds_read_b64_tr_b16 v[172:173], v23 offset:0
  v_mfma_f32_16x16x32_bf16 v[120:123], v[204:207], v[80:83], v[120:123]
  ds_read_b64_tr_b16 v[174:175], v23 offset:512
  s_waitcnt lgkmcnt(8)
  s_barrier
  v_mfma_f32_16x16x32_bf16 v[96:99], v[208:211], v[88:91], v[96:99]
  buffer_load_dwordx4 v[72:75], off, s[36:39], s48 offset:1024
  v_mfma_f32_16x16x32_bf16 v[100:103], v[208:211], v[92:95], v[100:103]
  ds_read_b64_tr_b16 v[176:177], v20 offset:4096
  ds_read_b64_tr_b16 v[178:179], v20 offset:4608
  v_mfma_f32_16x16x32_bf16 v[108:111], v[212:215], v[92:95], v[108:111]
  ds_read_b64_tr_b16 v[180:181], v21 offset:4096
  v_mfma_f32_16x16x32_bf16 v[104:107], v[212:215], v[88:91], v[104:107]
  ds_read_b64_tr_b16 v[182:183], v21 offset:4608
  v_mfma_f32_16x16x32_bf16 v[112:115], v[216:219], v[88:91], v[112:115]
  ds_read_b64_tr_b16 v[184:185], v22 offset:4096
  v_mfma_f32_16x16x32_bf16 v[116:119], v[216:219], v[92:95], v[116:119]
  ds_read_b64_tr_b16 v[186:187], v22 offset:4608
  v_mfma_f32_16x16x32_bf16 v[124:127], v[220:223], v[92:95], v[124:127]
  ds_read_b64_tr_b16 v[188:189], v23 offset:4096
  v_mfma_f32_16x16x32_bf16 v[120:123], v[220:223], v[88:91], v[120:123]
  ds_read_b64_tr_b16 v[190:191], v23 offset:4608
  s_waitcnt vmcnt(17) lgkmcnt(8)
  v_mfma_f32_16x16x32_bf16 v[128:131], v[160:163], v[224:227], v[128:131]
  buffer_load_dwordx4 v[76:79], off, s[64:67], s48 offset:1024
  v_mfma_f32_16x16x32_bf16 v[132:135], v[160:163], v[228:231], v[132:135]
  ds_read_b64_tr_b16 v[192:193], v20 offset:8192
  ds_read_b64_tr_b16 v[194:195], v20 offset:8704
  v_mfma_f32_16x16x32_bf16 v[140:143], v[164:167], v[228:231], v[140:143]
  ds_read_b64_tr_b16 v[196:197], v21 offset:8192
  v_mfma_f32_16x16x32_bf16 v[136:139], v[164:167], v[224:227], v[136:139]
  ds_read_b64_tr_b16 v[198:199], v21 offset:8704
  v_mfma_f32_16x16x32_bf16 v[144:147], v[168:171], v[224:227], v[144:147]
  ds_read_b64_tr_b16 v[200:201], v22 offset:8192
  v_mfma_f32_16x16x32_bf16 v[148:151], v[168:171], v[228:231], v[148:151]
  ds_read_b64_tr_b16 v[202:203], v22 offset:8704
  v_readlane_b32 s49, v15, 9
  v_mfma_f32_16x16x32_bf16 v[156:159], v[172:175], v[228:231], v[156:159]
  ds_read_b64_tr_b16 v[204:205], v23 offset:8192
  v_mfma_f32_16x16x32_bf16 v[152:155], v[172:175], v[224:227], v[152:155]
  ds_read_b64_tr_b16 v[206:207], v23 offset:8704
  s_waitcnt vmcnt(16) lgkmcnt(8)
  v_mfma_f32_16x16x32_bf16 v[128:131], v[176:179], v[232:235], v[128:131]
  buffer_load_dwordx4 v[80:83], off, s[36:39], s49 offset:0
  v_mfma_f32_16x16x32_bf16 v[132:135], v[176:179], v[236:239], v[132:135]
  ds_read_b64_tr_b16 v[208:209], v20 offset:12288
  ds_read_b64_tr_b16 v[210:211], v20 offset:12800
  v_mfma_f32_16x16x32_bf16 v[140:143], v[180:183], v[236:239], v[140:143]
  ds_read_b64_tr_b16 v[212:213], v21 offset:12288
  v_mfma_f32_16x16x32_bf16 v[136:139], v[180:183], v[232:235], v[136:139]
  ds_read_b64_tr_b16 v[214:215], v21 offset:12800
  v_mfma_f32_16x16x32_bf16 v[144:147], v[184:187], v[232:235], v[144:147]
  ds_read_b64_tr_b16 v[216:217], v22 offset:12288
  v_mfma_f32_16x16x32_bf16 v[148:151], v[184:187], v[236:239], v[148:151]
  ds_read_b64_tr_b16 v[218:219], v22 offset:12800
  v_mfma_f32_16x16x32_bf16 v[156:159], v[188:191], v[236:239], v[156:159]
  ds_read_b64_tr_b16 v[220:221], v23 offset:12288
  v_mfma_f32_16x16x32_bf16 v[152:155], v[188:191], v[232:235], v[152:155]
  ds_read_b64_tr_b16 v[222:223], v23 offset:12800
  s_waitcnt lgkmcnt(8)
  v_mfma_f32_16x16x32_bf16 v[96:99], v[192:195], v[224:227], v[96:99]
  buffer_load_dwordx4 v[84:87], off, s[64:67], s49 offset:0
  v_mfma_f32_16x16x32_bf16 v[100:103], v[192:195], v[228:231], v[100:103]
  ds_read_b64_tr_b16 v[160:161], v20 offset:16384
  ds_read_b64_tr_b16 v[162:163], v20 offset:16896
  v_mfma_f32_16x16x32_bf16 v[108:111], v[196:199], v[228:231], v[108:111]
  ds_read_b64_tr_b16 v[164:165], v21 offset:16384
  v_mfma_f32_16x16x32_bf16 v[104:107], v[196:199], v[224:227], v[104:107]
  ds_read_b64_tr_b16 v[166:167], v21 offset:16896
  v_mfma_f32_16x16x32_bf16 v[112:115], v[200:203], v[224:227], v[112:115]
  ds_read_b64_tr_b16 v[168:169], v22 offset:16384
  v_mfma_f32_16x16x32_bf16 v[116:119], v[200:203], v[228:231], v[116:119]
  ds_read_b64_tr_b16 v[170:171], v22 offset:16896
  v_mfma_f32_16x16x32_bf16 v[124:127], v[204:207], v[228:231], v[124:127]
  ds_read_b64_tr_b16 v[172:173], v23 offset:16384
  v_mfma_f32_16x16x32_bf16 v[120:123], v[204:207], v[224:227], v[120:123]
  ds_read_b64_tr_b16 v[174:175], v23 offset:16896
  s_waitcnt lgkmcnt(8)
  v_mfma_f32_16x16x32_bf16 v[96:99], v[208:211], v[232:235], v[96:99]
  buffer_load_dwordx4 v[88:91], off, s[36:39], s49 offset:1024
  v_mfma_f32_16x16x32_bf16 v[100:103], v[208:211], v[236:239], v[100:103]
  ds_read_b64_tr_b16 v[176:177], v20 offset:20480
  ds_read_b64_tr_b16 v[178:179], v20 offset:20992
  v_mfma_f32_16x16x32_bf16 v[108:111], v[212:215], v[236:239], v[108:111]
  ds_read_b64_tr_b16 v[180:181], v21 offset:20480
  v_mfma_f32_16x16x32_bf16 v[104:107], v[212:215], v[232:235], v[104:107]
  ds_read_b64_tr_b16 v[182:183], v21 offset:20992
  v_mfma_f32_16x16x32_bf16 v[112:115], v[216:219], v[232:235], v[112:115]
  ds_read_b64_tr_b16 v[184:185], v22 offset:20480
  v_mfma_f32_16x16x32_bf16 v[116:119], v[216:219], v[236:239], v[116:119]
  ds_read_b64_tr_b16 v[186:187], v22 offset:20992
  v_mfma_f32_16x16x32_bf16 v[124:127], v[220:223], v[236:239], v[124:127]
  ds_read_b64_tr_b16 v[188:189], v23 offset:20480
  v_mfma_f32_16x16x32_bf16 v[120:123], v[220:223], v[232:235], v[120:123]
  ds_read_b64_tr_b16 v[190:191], v23 offset:20992
  s_waitcnt vmcnt(17) lgkmcnt(8)
  v_mfma_f32_16x16x32_bf16 v[128:131], v[160:163], v[240:243], v[128:131]
  buffer_load_dwordx4 v[92:95], off, s[64:67], s49 offset:1024
  v_mfma_f32_16x16x32_bf16 v[132:135], v[160:163], v[244:247], v[132:135]
  ds_read_b64_tr_b16 v[192:193], v20 offset:24576
  ds_read_b64_tr_b16 v[194:195], v20 offset:25088
  v_mfma_f32_16x16x32_bf16 v[140:143], v[164:167], v[244:247], v[140:143]
  ds_read_b64_tr_b16 v[196:197], v21 offset:24576
  v_mfma_f32_16x16x32_bf16 v[136:139], v[164:167], v[240:243], v[136:139]
  ds_read_b64_tr_b16 v[198:199], v21 offset:25088
  v_mfma_f32_16x16x32_bf16 v[144:147], v[168:171], v[240:243], v[144:147]
  ds_read_b64_tr_b16 v[200:201], v22 offset:24576
  v_mfma_f32_16x16x32_bf16 v[148:151], v[168:171], v[244:247], v[148:151]
  ds_read_b64_tr_b16 v[202:203], v22 offset:25088
  v_readlane_b32 s50, v15, 10
  v_mfma_f32_16x16x32_bf16 v[156:159], v[172:175], v[244:247], v[156:159]
  ds_read_b64_tr_b16 v[204:205], v23 offset:24576
  v_mfma_f32_16x16x32_bf16 v[152:155], v[172:175], v[240:243], v[152:155]
  ds_read_b64_tr_b16 v[206:207], v23 offset:25088
  s_waitcnt vmcnt(16) lgkmcnt(8)
  v_mfma_f32_16x16x32_bf16 v[128:131], v[176:179], v[248:251], v[128:131]
  buffer_load_dwordx4 v[224:227], off, s[36:39], s50 offset:0
  v_mfma_f32_16x16x32_bf16 v[132:135], v[176:179], v[252:255], v[132:135]
  ds_read_b64_tr_b16 v[208:209], v20 offset:28672
  ds_read_b64_tr_b16 v[210:211], v20 offset:29184
  v_mfma_f32_16x16x32_bf16 v[140:143], v[180:183], v[252:255], v[140:143]
  ds_read_b64_tr_b16 v[212:213], v21 offset:28672
  v_mfma_f32_16x16x32_bf16 v[136:139], v[180:183], v[248:251], v[136:139]
  ds_read_b64_tr_b16 v[214:215], v21 offset:29184
  v_mfma_f32_16x16x32_bf16 v[144:147], v[184:187], v[248:251], v[144:147]
  ds_read_b64_tr_b16 v[216:217], v22 offset:28672
  v_mfma_f32_16x16x32_bf16 v[148:151], v[184:187], v[252:255], v[148:151]
  ds_read_b64_tr_b16 v[218:219], v22 offset:29184
  v_mfma_f32_16x16x32_bf16 v[156:159], v[188:191], v[252:255], v[156:159]
  ds_read_b64_tr_b16 v[220:221], v23 offset:28672
  v_mfma_f32_16x16x32_bf16 v[152:155], v[188:191], v[248:251], v[152:155]
  ds_read_b64_tr_b16 v[222:223], v23 offset:29184
  s_waitcnt lgkmcnt(8)
  v_mfma_f32_16x16x32_bf16 v[96:99], v[192:195], v[240:243], v[96:99]
  buffer_load_dwordx4 v[228:231], off, s[64:67], s50 offset:0
  v_mfma_f32_16x16x32_bf16 v[100:103], v[192:195], v[244:247], v[100:103]
  ds_read_b64_tr_b16 v[160:161], v20 offset:32768
  ds_read_b64_tr_b16 v[162:163], v20 offset:33280
  v_mfma_f32_16x16x32_bf16 v[108:111], v[196:199], v[244:247], v[108:111]
  ds_read_b64_tr_b16 v[164:165], v21 offset:32768
  v_mfma_f32_16x16x32_bf16 v[104:107], v[196:199], v[240:243], v[104:107]
  ds_read_b64_tr_b16 v[166:167], v21 offset:33280
  v_mfma_f32_16x16x32_bf16 v[112:115], v[200:203], v[240:243], v[112:115]
  ds_read_b64_tr_b16 v[168:169], v22 offset:32768
  v_mfma_f32_16x16x32_bf16 v[116:119], v[200:203], v[244:247], v[116:119]
  ds_read_b64_tr_b16 v[170:171], v22 offset:33280
  v_mfma_f32_16x16x32_bf16 v[124:127], v[204:207], v[244:247], v[124:127]
  ds_read_b64_tr_b16 v[172:173], v23 offset:32768
  v_mfma_f32_16x16x32_bf16 v[120:123], v[204:207], v[240:243], v[120:123]
  ds_read_b64_tr_b16 v[174:175], v23 offset:33280
  s_waitcnt lgkmcnt(8)
  s_barrier
  v_mfma_f32_16x16x32_bf16 v[96:99], v[208:211], v[248:251], v[96:99]
  buffer_load_dwordx4 v[232:235], off, s[36:39], s50 offset:1024
  v_mfma_f32_16x16x32_bf16 v[100:103], v[208:211], v[252:255], v[100:103]
  ds_read_b64_tr_b16 v[176:177], v20 offset:36864
  ds_read_b64_tr_b16 v[178:179], v20 offset:37376
  v_mfma_f32_16x16x32_bf16 v[108:111], v[212:215], v[252:255], v[108:111]
  ds_read_b64_tr_b16 v[180:181], v21 offset:36864
  v_mfma_f32_16x16x32_bf16 v[104:107], v[212:215], v[248:251], v[104:107]
  ds_read_b64_tr_b16 v[182:183], v21 offset:37376
  v_mfma_f32_16x16x32_bf16 v[112:115], v[216:219], v[248:251], v[112:115]
  ds_read_b64_tr_b16 v[184:185], v22 offset:36864
  v_mfma_f32_16x16x32_bf16 v[116:119], v[216:219], v[252:255], v[116:119]
  ds_read_b64_tr_b16 v[186:187], v22 offset:37376
  v_mfma_f32_16x16x32_bf16 v[124:127], v[220:223], v[252:255], v[124:127]
  ds_read_b64_tr_b16 v[188:189], v23 offset:36864
  v_mfma_f32_16x16x32_bf16 v[120:123], v[220:223], v[248:251], v[120:123]
  ds_read_b64_tr_b16 v[190:191], v23 offset:37376
  s_waitcnt vmcnt(17) lgkmcnt(8)
  v_mfma_f32_16x16x32_bf16 v[128:131], v[160:163], v[32:35], v[128:131]
  buffer_load_dwordx4 v[236:239], off, s[64:67], s50 offset:1024
  v_mfma_f32_16x16x32_bf16 v[132:135], v[160:163], v[36:39], v[132:135]
  ds_read_b64_tr_b16 v[192:193], v20 offset:40960
  ds_read_b64_tr_b16 v[194:195], v20 offset:41472
  v_mfma_f32_16x16x32_bf16 v[140:143], v[164:167], v[36:39], v[140:143]
  ds_read_b64_tr_b16 v[196:197], v21 offset:40960
  v_mfma_f32_16x16x32_bf16 v[136:139], v[164:167], v[32:35], v[136:139]
  ds_read_b64_tr_b16 v[198:199], v21 offset:41472
  v_mfma_f32_16x16x32_bf16 v[144:147], v[168:171], v[32:35], v[144:147]
  ds_read_b64_tr_b16 v[200:201], v22 offset:40960
  v_mfma_f32_16x16x32_bf16 v[148:151], v[168:171], v[36:39], v[148:151]
  ds_read_b64_tr_b16 v[202:203], v22 offset:41472
  v_readlane_b32 s51, v15, 11
  v_mfma_f32_16x16x32_bf16 v[156:159], v[172:175], v[36:39], v[156:159]
  ds_read_b64_tr_b16 v[204:205], v23 offset:40960
  v_mfma_f32_16x16x32_bf16 v[152:155], v[172:175], v[32:35], v[152:155]
  ds_read_b64_tr_b16 v[206:207], v23 offset:41472
  s_waitcnt vmcnt(16) lgkmcnt(8)
  v_mfma_f32_16x16x32_bf16 v[128:131], v[176:179], v[40:43], v[128:131]
  buffer_load_dwordx4 v[240:243], off, s[36:39], s51 offset:0
  v_mfma_f32_16x16x32_bf16 v[132:135], v[176:179], v[44:47], v[132:135]
  ds_read_b64_tr_b16 v[208:209], v20 offset:45056
  ds_read_b64_tr_b16 v[210:211], v20 offset:45568
  v_mfma_f32_16x16x32_bf16 v[140:143], v[180:183], v[44:47], v[140:143]
  ds_read_b64_tr_b16 v[212:213], v21 offset:45056
  v_mfma_f32_16x16x32_bf16 v[136:139], v[180:183], v[40:43], v[136:139]
  ds_read_b64_tr_b16 v[214:215], v21 offset:45568
  v_mfma_f32_16x16x32_bf16 v[144:147], v[184:187], v[40:43], v[144:147]
  ds_read_b64_tr_b16 v[216:217], v22 offset:45056
  v_mfma_f32_16x16x32_bf16 v[148:151], v[184:187], v[44:47], v[148:151]
  ds_read_b64_tr_b16 v[218:219], v22 offset:45568
  v_mfma_f32_16x16x32_bf16 v[156:159], v[188:191], v[44:47], v[156:159]
  ds_read_b64_tr_b16 v[220:221], v23 offset:45056
  v_mfma_f32_16x16x32_bf16 v[152:155], v[188:191], v[40:43], v[152:155]
  ds_read_b64_tr_b16 v[222:223], v23 offset:45568
  s_waitcnt lgkmcnt(8)
  v_mfma_f32_16x16x32_bf16 v[96:99], v[192:195], v[32:35], v[96:99]
  buffer_load_dwordx4 v[244:247], off, s[64:67], s51 offset:0
  v_mfma_f32_16x16x32_bf16 v[100:103], v[192:195], v[36:39], v[100:103]
  ds_read_b64_tr_b16 v[160:161], v20 offset:49152
  ds_read_b64_tr_b16 v[162:163], v20 offset:49664
  v_mfma_f32_16x16x32_bf16 v[108:111], v[196:199], v[36:39], v[108:111]
  ds_read_b64_tr_b16 v[164:165], v21 offset:49152
  v_mfma_f32_16x16x32_bf16 v[104:107], v[196:199], v[32:35], v[104:107]
  ds_read_b64_tr_b16 v[166:167], v21 offset:49664
  v_mfma_f32_16x16x32_bf16 v[112:115], v[200:203], v[32:35], v[112:115]
  ds_read_b64_tr_b16 v[168:169], v22 offset:49152
  v_mfma_f32_16x16x32_bf16 v[116:119], v[200:203], v[36:39], v[116:119]
  ds_read_b64_tr_b16 v[170:171], v22 offset:49664
  v_mfma_f32_16x16x32_bf16 v[124:127], v[204:207], v[36:39], v[124:127]
  ds_read_b64_tr_b16 v[172:173], v23 offset:49152
  v_mfma_f32_16x16x32_bf16 v[120:123], v[204:207], v[32:35], v[120:123]
  ds_read_b64_tr_b16 v[174:175], v23 offset:49664
  s_waitcnt lgkmcnt(8)
  v_mfma_f32_16x16x32_bf16 v[96:99], v[208:211], v[40:43], v[96:99]
  buffer_load_dwordx4 v[248:251], off, s[36:39], s51 offset:1024
  v_mfma_f32_16x16x32_bf16 v[100:103], v[208:211], v[44:47], v[100:103]
  ds_read_b64_tr_b16 v[176:177], v20 offset:53248
  ds_read_b64_tr_b16 v[178:179], v20 offset:53760
  v_mfma_f32_16x16x32_bf16 v[108:111], v[212:215], v[44:47], v[108:111]
  ds_read_b64_tr_b16 v[180:181], v21 offset:53248
  v_mfma_f32_16x16x32_bf16 v[104:107], v[212:215], v[40:43], v[104:107]
  ds_read_b64_tr_b16 v[182:183], v21 offset:53760
  v_mfma_f32_16x16x32_bf16 v[112:115], v[216:219], v[40:43], v[112:115]
  ds_read_b64_tr_b16 v[184:185], v22 offset:53248
  v_mfma_f32_16x16x32_bf16 v[116:119], v[216:219], v[44:47], v[116:119]
  ds_read_b64_tr_b16 v[186:187], v22 offset:53760
  v_mfma_f32_16x16x32_bf16 v[124:127], v[220:223], v[44:47], v[124:127]
  ds_read_b64_tr_b16 v[188:189], v23 offset:53248
  v_mfma_f32_16x16x32_bf16 v[120:123], v[220:223], v[40:43], v[120:123]
  ds_read_b64_tr_b16 v[190:191], v23 offset:53760
  s_waitcnt vmcnt(17) lgkmcnt(8)
  v_mfma_f32_16x16x32_bf16 v[128:131], v[160:163], v[48:51], v[128:131]
  buffer_load_dwordx4 v[252:255], off, s[64:67], s51 offset:1024
  v_mfma_f32_16x16x32_bf16 v[132:135], v[160:163], v[52:55], v[132:135]
  ds_read_b64_tr_b16 v[192:193], v20 offset:57344
  ds_read_b64_tr_b16 v[194:195], v20 offset:57856
  v_mfma_f32_16x16x32_bf16 v[140:143], v[164:167], v[52:55], v[140:143]
  ds_read_b64_tr_b16 v[196:197], v21 offset:57344
  v_mfma_f32_16x16x32_bf16 v[136:139], v[164:167], v[48:51], v[136:139]
  ds_read_b64_tr_b16 v[198:199], v21 offset:57856
  v_mfma_f32_16x16x32_bf16 v[144:147], v[168:171], v[48:51], v[144:147]
  ds_read_b64_tr_b16 v[200:201], v22 offset:57344
  v_mfma_f32_16x16x32_bf16 v[148:151], v[168:171], v[52:55], v[148:151]
  ds_read_b64_tr_b16 v[202:203], v22 offset:57856
  v_readlane_b32 s48, v15, 12
  v_mfma_f32_16x16x32_bf16 v[156:159], v[172:175], v[52:55], v[156:159]
  ds_read_b64_tr_b16 v[204:205], v23 offset:57344
  v_mfma_f32_16x16x32_bf16 v[152:155], v[172:175], v[48:51], v[152:155]
  ds_read_b64_tr_b16 v[206:207], v23 offset:57856
  s_waitcnt vmcnt(16) lgkmcnt(8)
  v_mfma_f32_16x16x32_bf16 v[128:131], v[176:179], v[56:59], v[128:131]
  buffer_load_dwordx4 v[32:35], off, s[36:39], s48 offset:0
  v_mfma_f32_16x16x32_bf16 v[132:135], v[176:179], v[60:63], v[132:135]
  ds_read_b64_tr_b16 v[208:209], v20 offset:61440
  ds_read_b64_tr_b16 v[210:211], v20 offset:61952
  v_mfma_f32_16x16x32_bf16 v[140:143], v[180:183], v[60:63], v[140:143]
  ds_read_b64_tr_b16 v[212:213], v21 offset:61440
  v_mfma_f32_16x16x32_bf16 v[136:139], v[180:183], v[56:59], v[136:139]
  ds_read_b64_tr_b16 v[214:215], v21 offset:61952
  v_mfma_f32_16x16x32_bf16 v[144:147], v[184:187], v[56:59], v[144:147]
  ds_read_b64_tr_b16 v[216:217], v22 offset:61440
  v_mfma_f32_16x16x32_bf16 v[148:151], v[184:187], v[60:63], v[148:151]
  ds_read_b64_tr_b16 v[218:219], v22 offset:61952
  v_mfma_f32_16x16x32_bf16 v[156:159], v[188:191], v[60:63], v[156:159]
  ds_read_b64_tr_b16 v[220:221], v23 offset:61440
  v_mfma_f32_16x16x32_bf16 v[152:155], v[188:191], v[56:59], v[152:155]
  ds_read_b64_tr_b16 v[222:223], v23 offset:61952
  s_waitcnt lgkmcnt(8)
  v_mfma_f32_16x16x32_bf16 v[96:99], v[192:195], v[48:51], v[96:99]
  buffer_load_dwordx4 v[36:39], off, s[64:67], s48 offset:0
  v_mfma_f32_16x16x32_bf16 v[100:103], v[192:195], v[52:55], v[100:103]
  ds_read_b64_tr_b16 v[160:161], v26 offset:0
  ds_read_b64_tr_b16 v[162:163], v26 offset:512
  v_mfma_f32_16x16x32_bf16 v[108:111], v[196:199], v[52:55], v[108:111]
  ds_read_b64_tr_b16 v[164:165], v27 offset:0
  v_mfma_f32_16x16x32_bf16 v[104:107], v[196:199], v[48:51], v[104:107]
  ds_read_b64_tr_b16 v[166:167], v27 offset:512
  v_mfma_f32_16x16x32_bf16 v[112:115], v[200:203], v[48:51], v[112:115]
  ds_read_b64_tr_b16 v[168:169], v28 offset:0
  v_mfma_f32_16x16x32_bf16 v[116:119], v[200:203], v[52:55], v[116:119]
  ds_read_b64_tr_b16 v[170:171], v28 offset:512
  v_mfma_f32_16x16x32_bf16 v[124:127], v[204:207], v[52:55], v[124:127]
  ds_read_b64_tr_b16 v[172:173], v29 offset:0
  v_mfma_f32_16x16x32_bf16 v[120:123], v[204:207], v[48:51], v[120:123]
  ds_read_b64_tr_b16 v[174:175], v29 offset:512
  s_waitcnt lgkmcnt(8)
  s_barrier
  v_mfma_f32_16x16x32_bf16 v[96:99], v[208:211], v[56:59], v[96:99]
  buffer_load_dwordx4 v[40:43], off, s[36:39], s48 offset:1024
  v_mfma_f32_16x16x32_bf16 v[100:103], v[208:211], v[60:63], v[100:103]
  ds_read_b64_tr_b16 v[176:177], v26 offset:4096
  ds_read_b64_tr_b16 v[178:179], v26 offset:4608
  v_mfma_f32_16x16x32_bf16 v[108:111], v[212:215], v[60:63], v[108:111]
  ds_read_b64_tr_b16 v[180:181], v27 offset:4096
  v_mfma_f32_16x16x32_bf16 v[104:107], v[212:215], v[56:59], v[104:107]
  ds_read_b64_tr_b16 v[182:183], v27 offset:4608
  v_mfma_f32_16x16x32_bf16 v[112:115], v[216:219], v[56:59], v[112:115]
  ds_read_b64_tr_b16 v[184:185], v28 offset:4096
  v_mfma_f32_16x16x32_bf16 v[116:119], v[216:219], v[60:63], v[116:119]
  ds_read_b64_tr_b16 v[186:187], v28 offset:4608
  v_mfma_f32_16x16x32_bf16 v[124:127], v[220:223], v[60:63], v[124:127]
  ds_read_b64_tr_b16 v[188:189], v29 offset:4096
  v_mfma_f32_16x16x32_bf16 v[120:123], v[220:223], v[56:59], v[120:123]
  ds_read_b64_tr_b16 v[190:191], v29 offset:4608
  s_waitcnt vmcnt(17) lgkmcnt(8)
  v_mfma_f32_16x16x32_bf16 v[128:131], v[160:163], v[64:67], v[128:131]
  buffer_load_dwordx4 v[44:47], off, s[64:67], s48 offset:1024
  v_mfma_f32_16x16x32_bf16 v[132:135], v[160:163], v[68:71], v[132:135]
  ds_read_b64_tr_b16 v[192:193], v26 offset:8192
  ds_read_b64_tr_b16 v[194:195], v26 offset:8704
  v_mfma_f32_16x16x32_bf16 v[140:143], v[164:167], v[68:71], v[140:143]
  ds_read_b64_tr_b16 v[196:197], v27 offset:8192
  v_mfma_f32_16x16x32_bf16 v[136:139], v[164:167], v[64:67], v[136:139]
  ds_read_b64_tr_b16 v[198:199], v27 offset:8704
  v_mfma_f32_16x16x32_bf16 v[144:147], v[168:171], v[64:67], v[144:147]
  ds_read_b64_tr_b16 v[200:201], v28 offset:8192
  v_mfma_f32_16x16x32_bf16 v[148:151], v[168:171], v[68:71], v[148:151]
  ds_read_b64_tr_b16 v[202:203], v28 offset:8704
  v_readlane_b32 s49, v15, 13
  v_mfma_f32_16x16x32_bf16 v[156:159], v[172:175], v[68:71], v[156:159]
  ds_read_b64_tr_b16 v[204:205], v29 offset:8192
  v_mfma_f32_16x16x32_bf16 v[152:155], v[172:175], v[64:67], v[152:155]
  ds_read_b64_tr_b16 v[206:207], v29 offset:8704
  s_waitcnt vmcnt(16) lgkmcnt(8)
  v_mfma_f32_16x16x32_bf16 v[128:131], v[176:179], v[72:75], v[128:131]
  buffer_load_dwordx4 v[48:51], off, s[36:39], s49 offset:0
  v_mfma_f32_16x16x32_bf16 v[132:135], v[176:179], v[76:79], v[132:135]
  ds_read_b64_tr_b16 v[208:209], v26 offset:12288
  ds_read_b64_tr_b16 v[210:211], v26 offset:12800
  v_mfma_f32_16x16x32_bf16 v[140:143], v[180:183], v[76:79], v[140:143]
  ds_read_b64_tr_b16 v[212:213], v27 offset:12288
  v_mfma_f32_16x16x32_bf16 v[136:139], v[180:183], v[72:75], v[136:139]
  ds_read_b64_tr_b16 v[214:215], v27 offset:12800
  v_mfma_f32_16x16x32_bf16 v[144:147], v[184:187], v[72:75], v[144:147]
  ds_read_b64_tr_b16 v[216:217], v28 offset:12288
  v_mfma_f32_16x16x32_bf16 v[148:151], v[184:187], v[76:79], v[148:151]
  ds_read_b64_tr_b16 v[218:219], v28 offset:12800
  v_mfma_f32_16x16x32_bf16 v[156:159], v[188:191], v[76:79], v[156:159]
  ds_read_b64_tr_b16 v[220:221], v29 offset:12288
  v_mfma_f32_16x16x32_bf16 v[152:155], v[188:191], v[72:75], v[152:155]
  ds_read_b64_tr_b16 v[222:223], v29 offset:12800
  s_waitcnt lgkmcnt(8)
  v_mfma_f32_16x16x32_bf16 v[96:99], v[192:195], v[64:67], v[96:99]
  buffer_load_dwordx4 v[52:55], off, s[64:67], s49 offset:0
  v_mfma_f32_16x16x32_bf16 v[100:103], v[192:195], v[68:71], v[100:103]
  ds_read_b64_tr_b16 v[160:161], v26 offset:16384
  ds_read_b64_tr_b16 v[162:163], v26 offset:16896
  v_mfma_f32_16x16x32_bf16 v[108:111], v[196:199], v[68:71], v[108:111]
  ds_read_b64_tr_b16 v[164:165], v27 offset:16384
  v_mfma_f32_16x16x32_bf16 v[104:107], v[196:199], v[64:67], v[104:107]
  ds_read_b64_tr_b16 v[166:167], v27 offset:16896
  v_mfma_f32_16x16x32_bf16 v[112:115], v[200:203], v[64:67], v[112:115]
  ds_read_b64_tr_b16 v[168:169], v28 offset:16384
  v_mfma_f32_16x16x32_bf16 v[116:119], v[200:203], v[68:71], v[116:119]
  ds_read_b64_tr_b16 v[170:171], v28 offset:16896
  v_mfma_f32_16x16x32_bf16 v[124:127], v[204:207], v[68:71], v[124:127]
  ds_read_b64_tr_b16 v[172:173], v29 offset:16384
  v_mfma_f32_16x16x32_bf16 v[120:123], v[204:207], v[64:67], v[120:123]
  ds_read_b64_tr_b16 v[174:175], v29 offset:16896
  s_waitcnt lgkmcnt(8)
  v_mfma_f32_16x16x32_bf16 v[96:99], v[208:211], v[72:75], v[96:99]
  buffer_load_dwordx4 v[56:59], off, s[36:39], s49 offset:1024
  v_mfma_f32_16x16x32_bf16 v[100:103], v[208:211], v[76:79], v[100:103]
  ds_read_b64_tr_b16 v[176:177], v26 offset:20480
  ds_read_b64_tr_b16 v[178:179], v26 offset:20992
  v_mfma_f32_16x16x32_bf16 v[108:111], v[212:215], v[76:79], v[108:111]
  ds_read_b64_tr_b16 v[180:181], v27 offset:20480
  v_mfma_f32_16x16x32_bf16 v[104:107], v[212:215], v[72:75], v[104:107]
  ds_read_b64_tr_b16 v[182:183], v27 offset:20992
  v_mfma_f32_16x16x32_bf16 v[112:115], v[216:219], v[72:75], v[112:115]
  ds_read_b64_tr_b16 v[184:185], v28 offset:20480
  v_mfma_f32_16x16x32_bf16 v[116:119], v[216:219], v[76:79], v[116:119]
  ds_read_b64_tr_b16 v[186:187], v28 offset:20992
  v_mfma_f32_16x16x32_bf16 v[124:127], v[220:223], v[76:79], v[124:127]
  ds_read_b64_tr_b16 v[188:189], v29 offset:20480
  v_mfma_f32_16x16x32_bf16 v[120:123], v[220:223], v[72:75], v[120:123]
  ds_read_b64_tr_b16 v[190:191], v29 offset:20992
  s_waitcnt vmcnt(17) lgkmcnt(8)
  v_mfma_f32_16x16x32_bf16 v[128:131], v[160:163], v[80:83], v[128:131]
  buffer_load_dwordx4 v[60:63], off, s[64:67], s49 offset:1024
  v_mfma_f32_16x16x32_bf16 v[132:135], v[160:163], v[84:87], v[132:135]
  ds_read_b64_tr_b16 v[192:193], v26 offset:24576
  ds_read_b64_tr_b16 v[194:195], v26 offset:25088
  v_mfma_f32_16x16x32_bf16 v[140:143], v[164:167], v[84:87], v[140:143]
  ds_read_b64_tr_b16 v[196:197], v27 offset:24576
  v_mfma_f32_16x16x32_bf16 v[136:139], v[164:167], v[80:83], v[136:139]
  ds_read_b64_tr_b16 v[198:199], v27 offset:25088
  v_mfma_f32_16x16x32_bf16 v[144:147], v[168:171], v[80:83], v[144:147]
  ds_read_b64_tr_b16 v[200:201], v28 offset:24576
  v_mfma_f32_16x16x32_bf16 v[148:151], v[168:171], v[84:87], v[148:151]
  ds_read_b64_tr_b16 v[202:203], v28 offset:25088
  v_readlane_b32 s50, v15, 14
  v_mfma_f32_16x16x32_bf16 v[156:159], v[172:175], v[84:87], v[156:159]
  ds_read_b64_tr_b16 v[204:205], v29 offset:24576
  v_mfma_f32_16x16x32_bf16 v[152:155], v[172:175], v[80:83], v[152:155]
  ds_read_b64_tr_b16 v[206:207], v29 offset:25088
  s_waitcnt vmcnt(16) lgkmcnt(8)
  v_mfma_f32_16x16x32_bf16 v[128:131], v[176:179], v[88:91], v[128:131]
  buffer_load_dwordx4 v[64:67], off, s[36:39], s50 offset:0
  v_mfma_f32_16x16x32_bf16 v[132:135], v[176:179], v[92:95], v[132:135]
  ds_read_b64_tr_b16 v[208:209], v26 offset:28672
  ds_read_b64_tr_b16 v[210:211], v26 offset:29184
  v_mfma_f32_16x16x32_bf16 v[140:143], v[180:183], v[92:95], v[140:143]
  ds_read_b64_tr_b16 v[212:213], v27 offset:28672
  v_mfma_f32_16x16x32_bf16 v[136:139], v[180:183], v[88:91], v[136:139]
  ds_read_b64_tr_b16 v[214:215], v27 offset:29184
  v_mfma_f32_16x16x32_bf16 v[144:147], v[184:187], v[88:91], v[144:147]
  ds_read_b64_tr_b16 v[216:217], v28 offset:28672
  v_mfma_f32_16x16x32_bf16 v[148:151], v[184:187], v[92:95], v[148:151]
  ds_read_b64_tr_b16 v[218:219], v28 offset:29184
  v_mfma_f32_16x16x32_bf16 v[156:159], v[188:191], v[92:95], v[156:159]
  ds_read_b64_tr_b16 v[220:221], v29 offset:28672
  v_mfma_f32_16x16x32_bf16 v[152:155], v[188:191], v[88:91], v[152:155]
  ds_read_b64_tr_b16 v[222:223], v29 offset:29184
  s_waitcnt lgkmcnt(8)
  v_mfma_f32_16x16x32_bf16 v[96:99], v[192:195], v[80:83], v[96:99]
  buffer_load_dwordx4 v[68:71], off, s[64:67], s50 offset:0
  v_mfma_f32_16x16x32_bf16 v[100:103], v[192:195], v[84:87], v[100:103]
  ds_read_b64_tr_b16 v[160:161], v6 offset:0
  ds_read_b64_tr_b16 v[162:163], v6 offset:512
  v_mfma_f32_16x16x32_bf16 v[108:111], v[196:199], v[84:87], v[108:111]
  ds_read_b64_tr_b16 v[164:165], v7 offset:0
  v_mfma_f32_16x16x32_bf16 v[104:107], v[196:199], v[80:83], v[104:107]
  ds_read_b64_tr_b16 v[166:167], v7 offset:512
  v_mfma_f32_16x16x32_bf16 v[112:115], v[200:203], v[80:83], v[112:115]
  ds_read_b64_tr_b16 v[168:169], v8 offset:0
  v_mfma_f32_16x16x32_bf16 v[116:119], v[200:203], v[84:87], v[116:119]
  ds_read_b64_tr_b16 v[170:171], v8 offset:512
  v_mfma_f32_16x16x32_bf16 v[124:127], v[204:207], v[84:87], v[124:127]
  ds_read_b64_tr_b16 v[172:173], v9 offset:0
  v_mfma_f32_16x16x32_bf16 v[120:123], v[204:207], v[80:83], v[120:123]
  ds_read_b64_tr_b16 v[174:175], v9 offset:512
  s_waitcnt lgkmcnt(8)
  s_barrier
  v_mfma_f32_16x16x32_bf16 v[96:99], v[208:211], v[88:91], v[96:99]
  buffer_load_dwordx4 v[72:75], off, s[36:39], s50 offset:1024
  v_mfma_f32_16x16x32_bf16 v[100:103], v[208:211], v[92:95], v[100:103]
  ds_read_b64_tr_b16 v[176:177], v6 offset:4096
  ds_read_b64_tr_b16 v[178:179], v6 offset:4608
  v_mfma_f32_16x16x32_bf16 v[108:111], v[212:215], v[92:95], v[108:111]
  ds_read_b64_tr_b16 v[180:181], v7 offset:4096
  v_mfma_f32_16x16x32_bf16 v[104:107], v[212:215], v[88:91], v[104:107]
  ds_read_b64_tr_b16 v[182:183], v7 offset:4608
  v_mfma_f32_16x16x32_bf16 v[112:115], v[216:219], v[88:91], v[112:115]
  ds_read_b64_tr_b16 v[184:185], v8 offset:4096
  v_mfma_f32_16x16x32_bf16 v[116:119], v[216:219], v[92:95], v[116:119]
  ds_read_b64_tr_b16 v[186:187], v8 offset:4608
  v_mfma_f32_16x16x32_bf16 v[124:127], v[220:223], v[92:95], v[124:127]
  ds_read_b64_tr_b16 v[188:189], v9 offset:4096
  v_mfma_f32_16x16x32_bf16 v[120:123], v[220:223], v[88:91], v[120:123]
  ds_read_b64_tr_b16 v[190:191], v9 offset:4608
  s_waitcnt vmcnt(17) lgkmcnt(8)
  v_mfma_f32_16x16x32_bf16 v[128:131], v[160:163], v[224:227], v[128:131]
  buffer_load_dwordx4 v[76:79], off, s[64:67], s50 offset:1024
  v_mfma_f32_16x16x32_bf16 v[132:135], v[160:163], v[228:231], v[132:135]
  ds_read_b64_tr_b16 v[192:193], v6 offset:8192
  ds_read_b64_tr_b16 v[194:195], v6 offset:8704
  v_mfma_f32_16x16x32_bf16 v[140:143], v[164:167], v[228:231], v[140:143]
  ds_read_b64_tr_b16 v[196:197], v7 offset:8192
  v_mfma_f32_16x16x32_bf16 v[136:139], v[164:167], v[224:227], v[136:139]
  ds_read_b64_tr_b16 v[198:199], v7 offset:8704
  v_mfma_f32_16x16x32_bf16 v[144:147], v[168:171], v[224:227], v[144:147]
  ds_read_b64_tr_b16 v[200:201], v8 offset:8192
  v_mfma_f32_16x16x32_bf16 v[148:151], v[168:171], v[228:231], v[148:151]
  ds_read_b64_tr_b16 v[202:203], v8 offset:8704
  v_readlane_b32 s51, v15, 15
  v_mfma_f32_16x16x32_bf16 v[156:159], v[172:175], v[228:231], v[156:159]
  ds_read_b64_tr_b16 v[204:205], v9 offset:8192
  v_mfma_f32_16x16x32_bf16 v[152:155], v[172:175], v[224:227], v[152:155]
  ds_read_b64_tr_b16 v[206:207], v9 offset:8704
  s_waitcnt vmcnt(16) lgkmcnt(8)
  v_mfma_f32_16x16x32_bf16 v[128:131], v[176:179], v[232:235], v[128:131]
  buffer_load_dwordx4 v[80:83], off, s[36:39], s51 offset:0
  v_mfma_f32_16x16x32_bf16 v[132:135], v[176:179], v[236:239], v[132:135]
  ds_read_b64_tr_b16 v[208:209], v6 offset:12288
  ds_read_b64_tr_b16 v[210:211], v6 offset:12800
  v_mfma_f32_16x16x32_bf16 v[140:143], v[180:183], v[236:239], v[140:143]
  ds_read_b64_tr_b16 v[212:213], v7 offset:12288
  v_mfma_f32_16x16x32_bf16 v[136:139], v[180:183], v[232:235], v[136:139]
  ds_read_b64_tr_b16 v[214:215], v7 offset:12800
  v_mfma_f32_16x16x32_bf16 v[144:147], v[184:187], v[232:235], v[144:147]
  ds_read_b64_tr_b16 v[216:217], v8 offset:12288
  v_mfma_f32_16x16x32_bf16 v[148:151], v[184:187], v[236:239], v[148:151]
  ds_read_b64_tr_b16 v[218:219], v8 offset:12800
  v_mfma_f32_16x16x32_bf16 v[156:159], v[188:191], v[236:239], v[156:159]
  ds_read_b64_tr_b16 v[220:221], v9 offset:12288
  v_mfma_f32_16x16x32_bf16 v[152:155], v[188:191], v[232:235], v[152:155]
  ds_read_b64_tr_b16 v[222:223], v9 offset:12800
  s_waitcnt lgkmcnt(8)
  v_mfma_f32_16x16x32_bf16 v[96:99], v[192:195], v[224:227], v[96:99]
  buffer_load_dwordx4 v[84:87], off, s[64:67], s51 offset:0
  v_mfma_f32_16x16x32_bf16 v[100:103], v[192:195], v[228:231], v[100:103]
  ds_read_b64_tr_b16 v[160:161], v6 offset:16384
  ds_read_b64_tr_b16 v[162:163], v6 offset:16896
  v_mfma_f32_16x16x32_bf16 v[108:111], v[196:199], v[228:231], v[108:111]
  ds_read_b64_tr_b16 v[164:165], v7 offset:16384
  v_mfma_f32_16x16x32_bf16 v[104:107], v[196:199], v[224:227], v[104:107]
  ds_read_b64_tr_b16 v[166:167], v7 offset:16896
  v_mfma_f32_16x16x32_bf16 v[112:115], v[200:203], v[224:227], v[112:115]
  ds_read_b64_tr_b16 v[168:169], v8 offset:16384
  v_mfma_f32_16x16x32_bf16 v[116:119], v[200:203], v[228:231], v[116:119]
  ds_read_b64_tr_b16 v[170:171], v8 offset:16896
  v_mfma_f32_16x16x32_bf16 v[124:127], v[204:207], v[228:231], v[124:127]
  ds_read_b64_tr_b16 v[172:173], v9 offset:16384
  v_mfma_f32_16x16x32_bf16 v[120:123], v[204:207], v[224:227], v[120:123]
  ds_read_b64_tr_b16 v[174:175], v9 offset:16896
  s_waitcnt lgkmcnt(8)
  v_mfma_f32_16x16x32_bf16 v[96:99], v[208:211], v[232:235], v[96:99]
  buffer_load_dwordx4 v[88:91], off, s[36:39], s51 offset:1024
  v_mfma_f32_16x16x32_bf16 v[100:103], v[208:211], v[236:239], v[100:103]
  ds_read_b64_tr_b16 v[176:177], v6 offset:20480
  ds_read_b64_tr_b16 v[178:179], v6 offset:20992
  v_mfma_f32_16x16x32_bf16 v[108:111], v[212:215], v[236:239], v[108:111]
  ds_read_b64_tr_b16 v[180:181], v7 offset:20480
  v_mfma_f32_16x16x32_bf16 v[104:107], v[212:215], v[232:235], v[104:107]
  ds_read_b64_tr_b16 v[182:183], v7 offset:20992
  v_mfma_f32_16x16x32_bf16 v[112:115], v[216:219], v[232:235], v[112:115]
  ds_read_b64_tr_b16 v[184:185], v8 offset:20480
  v_mfma_f32_16x16x32_bf16 v[116:119], v[216:219], v[236:239], v[116:119]
  ds_read_b64_tr_b16 v[186:187], v8 offset:20992
  v_mfma_f32_16x16x32_bf16 v[124:127], v[220:223], v[236:239], v[124:127]
  ds_read_b64_tr_b16 v[188:189], v9 offset:20480
  v_mfma_f32_16x16x32_bf16 v[120:123], v[220:223], v[232:235], v[120:123]
  ds_read_b64_tr_b16 v[190:191], v9 offset:20992
  s_waitcnt vmcnt(17) lgkmcnt(8)
  v_mfma_f32_16x16x32_bf16 v[128:131], v[160:163], v[240:243], v[128:131]
  buffer_load_dwordx4 v[92:95], off, s[64:67], s51 offset:1024
  v_mfma_f32_16x16x32_bf16 v[132:135], v[160:163], v[244:247], v[132:135]
  ds_read_b64_tr_b16 v[192:193], v6 offset:24576
  ds_read_b64_tr_b16 v[194:195], v6 offset:25088
  v_mfma_f32_16x16x32_bf16 v[140:143], v[164:167], v[244:247], v[140:143]
  ds_read_b64_tr_b16 v[196:197], v7 offset:24576
  v_mfma_f32_16x16x32_bf16 v[136:139], v[164:167], v[240:243], v[136:139]
  ds_read_b64_tr_b16 v[198:199], v7 offset:25088
  v_mfma_f32_16x16x32_bf16 v[144:147], v[168:171], v[240:243], v[144:147]
  ds_read_b64_tr_b16 v[200:201], v8 offset:24576
  v_mfma_f32_16x16x32_bf16 v[148:151], v[168:171], v[244:247], v[148:151]
  ds_read_b64_tr_b16 v[202:203], v8 offset:25088
  v_readlane_b32 s48, v15, 16
  v_mfma_f32_16x16x32_bf16 v[156:159], v[172:175], v[244:247], v[156:159]
  ds_read_b64_tr_b16 v[204:205], v9 offset:24576
  v_mfma_f32_16x16x32_bf16 v[152:155], v[172:175], v[240:243], v[152:155]
  ds_read_b64_tr_b16 v[206:207], v9 offset:25088
  s_waitcnt vmcnt(16) lgkmcnt(8)
  v_mfma_f32_16x16x32_bf16 v[128:131], v[176:179], v[248:251], v[128:131]
  buffer_load_dwordx4 v[224:227], off, s[36:39], s48 offset:0
  v_mfma_f32_16x16x32_bf16 v[132:135], v[176:179], v[252:255], v[132:135]
  ds_read_b64_tr_b16 v[208:209], v6 offset:28672
  ds_read_b64_tr_b16 v[210:211], v6 offset:29184
  v_mfma_f32_16x16x32_bf16 v[140:143], v[180:183], v[252:255], v[140:143]
  ds_read_b64_tr_b16 v[212:213], v7 offset:28672
  v_mfma_f32_16x16x32_bf16 v[136:139], v[180:183], v[248:251], v[136:139]
  ds_read_b64_tr_b16 v[214:215], v7 offset:29184
  v_mfma_f32_16x16x32_bf16 v[144:147], v[184:187], v[248:251], v[144:147]
  ds_read_b64_tr_b16 v[216:217], v8 offset:28672
  v_mfma_f32_16x16x32_bf16 v[148:151], v[184:187], v[252:255], v[148:151]
  ds_read_b64_tr_b16 v[218:219], v8 offset:29184
  v_mfma_f32_16x16x32_bf16 v[156:159], v[188:191], v[252:255], v[156:159]
  ds_read_b64_tr_b16 v[220:221], v9 offset:28672
  v_mfma_f32_16x16x32_bf16 v[152:155], v[188:191], v[248:251], v[152:155]
  ds_read_b64_tr_b16 v[222:223], v9 offset:29184
  s_waitcnt lgkmcnt(8)
  v_mfma_f32_16x16x32_bf16 v[96:99], v[192:195], v[240:243], v[96:99]
  buffer_load_dwordx4 v[228:231], off, s[64:67], s48 offset:0
  v_mfma_f32_16x16x32_bf16 v[100:103], v[192:195], v[244:247], v[100:103]
  ds_read_b64_tr_b16 v[160:161], v6 offset:32768
  ds_read_b64_tr_b16 v[162:163], v6 offset:33280
  v_mfma_f32_16x16x32_bf16 v[108:111], v[196:199], v[244:247], v[108:111]
  ds_read_b64_tr_b16 v[164:165], v7 offset:32768
  v_mfma_f32_16x16x32_bf16 v[104:107], v[196:199], v[240:243], v[104:107]
  ds_read_b64_tr_b16 v[166:167], v7 offset:33280
  v_mfma_f32_16x16x32_bf16 v[112:115], v[200:203], v[240:243], v[112:115]
  ds_read_b64_tr_b16 v[168:169], v8 offset:32768
  v_mfma_f32_16x16x32_bf16 v[116:119], v[200:203], v[244:247], v[116:119]
  ds_read_b64_tr_b16 v[170:171], v8 offset:33280
  v_mfma_f32_16x16x32_bf16 v[124:127], v[204:207], v[244:247], v[124:127]
  ds_read_b64_tr_b16 v[172:173], v9 offset:32768
  v_mfma_f32_16x16x32_bf16 v[120:123], v[204:207], v[240:243], v[120:123]
  ds_read_b64_tr_b16 v[174:175], v9 offset:33280
  s_waitcnt lgkmcnt(8)
  s_barrier
  v_mfma_f32_16x16x32_bf16 v[96:99], v[208:211], v[248:251], v[96:99]
  buffer_load_dwordx4 v[232:235], off, s[36:39], s48 offset:1024
  v_mfma_f32_16x16x32_bf16 v[100:103], v[208:211], v[252:255], v[100:103]
  ds_read_b64_tr_b16 v[176:177], v6 offset:36864
  ds_read_b64_tr_b16 v[178:179], v6 offset:37376
  v_mfma_f32_16x16x32_bf16 v[108:111], v[212:215], v[252:255], v[108:111]
  ds_read_b64_tr_b16 v[180:181], v7 offset:36864
  v_mfma_f32_16x16x32_bf16 v[104:107], v[212:215], v[248:251], v[104:107]
  ds_read_b64_tr_b16 v[182:183], v7 offset:37376
  v_mfma_f32_16x16x32_bf16 v[112:115], v[216:219], v[248:251], v[112:115]
  ds_read_b64_tr_b16 v[184:185], v8 offset:36864
  v_mfma_f32_16x16x32_bf16 v[116:119], v[216:219], v[252:255], v[116:119]
  ds_read_b64_tr_b16 v[186:187], v8 offset:37376
  v_mfma_f32_16x16x32_bf16 v[124:127], v[220:223], v[252:255], v[124:127]
  ds_read_b64_tr_b16 v[188:189], v9 offset:36864
  v_mfma_f32_16x16x32_bf16 v[120:123], v[220:223], v[248:251], v[120:123]
  ds_read_b64_tr_b16 v[190:191], v9 offset:37376
  s_waitcnt vmcnt(17) lgkmcnt(8)
  v_mfma_f32_16x16x32_bf16 v[128:131], v[160:163], v[32:35], v[128:131]
  buffer_load_dwordx4 v[236:239], off, s[64:67], s48 offset:1024
  v_mfma_f32_16x16x32_bf16 v[132:135], v[160:163], v[36:39], v[132:135]
  ds_read_b64_tr_b16 v[192:193], v6 offset:40960
  ds_read_b64_tr_b16 v[194:195], v6 offset:41472
  v_mfma_f32_16x16x32_bf16 v[140:143], v[164:167], v[36:39], v[140:143]
  ds_read_b64_tr_b16 v[196:197], v7 offset:40960
  v_mfma_f32_16x16x32_bf16 v[136:139], v[164:167], v[32:35], v[136:139]
  ds_read_b64_tr_b16 v[198:199], v7 offset:41472
  v_mfma_f32_16x16x32_bf16 v[144:147], v[168:171], v[32:35], v[144:147]
  ds_read_b64_tr_b16 v[200:201], v8 offset:40960
  v_mfma_f32_16x16x32_bf16 v[148:151], v[168:171], v[36:39], v[148:151]
  ds_read_b64_tr_b16 v[202:203], v8 offset:41472
  v_readlane_b32 s49, v15, 17
  v_mfma_f32_16x16x32_bf16 v[156:159], v[172:175], v[36:39], v[156:159]
  ds_read_b64_tr_b16 v[204:205], v9 offset:40960
  v_mfma_f32_16x16x32_bf16 v[152:155], v[172:175], v[32:35], v[152:155]
  ds_read_b64_tr_b16 v[206:207], v9 offset:41472
  s_waitcnt vmcnt(16) lgkmcnt(8)
  v_mfma_f32_16x16x32_bf16 v[128:131], v[176:179], v[40:43], v[128:131]
  buffer_load_dwordx4 v[240:243], off, s[36:39], s49 offset:0
  v_mfma_f32_16x16x32_bf16 v[132:135], v[176:179], v[44:47], v[132:135]
  ds_read_b64_tr_b16 v[208:209], v6 offset:45056
  ds_read_b64_tr_b16 v[210:211], v6 offset:45568
  v_mfma_f32_16x16x32_bf16 v[140:143], v[180:183], v[44:47], v[140:143]
  ds_read_b64_tr_b16 v[212:213], v7 offset:45056
  v_mfma_f32_16x16x32_bf16 v[136:139], v[180:183], v[40:43], v[136:139]
  ds_read_b64_tr_b16 v[214:215], v7 offset:45568
  v_mfma_f32_16x16x32_bf16 v[144:147], v[184:187], v[40:43], v[144:147]
  ds_read_b64_tr_b16 v[216:217], v8 offset:45056
  v_mfma_f32_16x16x32_bf16 v[148:151], v[184:187], v[44:47], v[148:151]
  ds_read_b64_tr_b16 v[218:219], v8 offset:45568
  v_mfma_f32_16x16x32_bf16 v[156:159], v[188:191], v[44:47], v[156:159]
  ds_read_b64_tr_b16 v[220:221], v9 offset:45056
  v_mfma_f32_16x16x32_bf16 v[152:155], v[188:191], v[40:43], v[152:155]
  ds_read_b64_tr_b16 v[222:223], v9 offset:45568
  s_waitcnt lgkmcnt(8)
  v_mfma_f32_16x16x32_bf16 v[96:99], v[192:195], v[32:35], v[96:99]
  buffer_load_dwordx4 v[244:247], off, s[64:67], s49 offset:0
  v_mfma_f32_16x16x32_bf16 v[100:103], v[192:195], v[36:39], v[100:103]
  ds_read_b64_tr_b16 v[160:161], v6 offset:49152
  ds_read_b64_tr_b16 v[162:163], v6 offset:49664
  v_mfma_f32_16x16x32_bf16 v[108:111], v[196:199], v[36:39], v[108:111]
  ds_read_b64_tr_b16 v[164:165], v7 offset:49152
  v_mfma_f32_16x16x32_bf16 v[104:107], v[196:199], v[32:35], v[104:107]
  ds_read_b64_tr_b16 v[166:167], v7 offset:49664
  v_mfma_f32_16x16x32_bf16 v[112:115], v[200:203], v[32:35], v[112:115]
  ds_read_b64_tr_b16 v[168:169], v8 offset:49152
  v_mfma_f32_16x16x32_bf16 v[116:119], v[200:203], v[36:39], v[116:119]
  ds_read_b64_tr_b16 v[170:171], v8 offset:49664
  v_mfma_f32_16x16x32_bf16 v[124:127], v[204:207], v[36:39], v[124:127]
  ds_read_b64_tr_b16 v[172:173], v9 offset:49152
  v_mfma_f32_16x16x32_bf16 v[120:123], v[204:207], v[32:35], v[120:123]
  ds_read_b64_tr_b16 v[174:175], v9 offset:49664
  s_waitcnt lgkmcnt(8)
  v_mfma_f32_16x16x32_bf16 v[96:99], v[208:211], v[40:43], v[96:99]
  buffer_load_dwordx4 v[248:251], off, s[36:39], s49 offset:1024
  v_mfma_f32_16x16x32_bf16 v[100:103], v[208:211], v[44:47], v[100:103]
  ds_read_b64_tr_b16 v[176:177], v6 offset:53248
  ds_read_b64_tr_b16 v[178:179], v6 offset:53760
  v_mfma_f32_16x16x32_bf16 v[108:111], v[212:215], v[44:47], v[108:111]
  ds_read_b64_tr_b16 v[180:181], v7 offset:53248
  v_mfma_f32_16x16x32_bf16 v[104:107], v[212:215], v[40:43], v[104:107]
  ds_read_b64_tr_b16 v[182:183], v7 offset:53760
  v_mfma_f32_16x16x32_bf16 v[112:115], v[216:219], v[40:43], v[112:115]
  ds_read_b64_tr_b16 v[184:185], v8 offset:53248
  v_mfma_f32_16x16x32_bf16 v[116:119], v[216:219], v[44:47], v[116:119]
  ds_read_b64_tr_b16 v[186:187], v8 offset:53760
  v_mfma_f32_16x16x32_bf16 v[124:127], v[220:223], v[44:47], v[124:127]
  ds_read_b64_tr_b16 v[188:189], v9 offset:53248
  v_mfma_f32_16x16x32_bf16 v[120:123], v[220:223], v[40:43], v[120:123]
  ds_read_b64_tr_b16 v[190:191], v9 offset:53760
  s_waitcnt vmcnt(17) lgkmcnt(8)
  v_mfma_f32_16x16x32_bf16 v[128:131], v[160:163], v[48:51], v[128:131]
  buffer_load_dwordx4 v[252:255], off, s[64:67], s49 offset:1024
  v_mfma_f32_16x16x32_bf16 v[132:135], v[160:163], v[52:55], v[132:135]
  ds_read_b64_tr_b16 v[192:193], v6 offset:57344
  ds_read_b64_tr_b16 v[194:195], v6 offset:57856
  v_mfma_f32_16x16x32_bf16 v[140:143], v[164:167], v[52:55], v[140:143]
  ds_read_b64_tr_b16 v[196:197], v7 offset:57344
  v_mfma_f32_16x16x32_bf16 v[136:139], v[164:167], v[48:51], v[136:139]
  ds_read_b64_tr_b16 v[198:199], v7 offset:57856
  v_mfma_f32_16x16x32_bf16 v[144:147], v[168:171], v[48:51], v[144:147]
  ds_read_b64_tr_b16 v[200:201], v8 offset:57344
  v_mfma_f32_16x16x32_bf16 v[148:151], v[168:171], v[52:55], v[148:151]
  ds_read_b64_tr_b16 v[202:203], v8 offset:57856
  v_readlane_b32 s50, v15, 18
  v_mfma_f32_16x16x32_bf16 v[156:159], v[172:175], v[52:55], v[156:159]
  ds_read_b64_tr_b16 v[204:205], v9 offset:57344
  v_mfma_f32_16x16x32_bf16 v[152:155], v[172:175], v[48:51], v[152:155]
  ds_read_b64_tr_b16 v[206:207], v9 offset:57856
  s_waitcnt vmcnt(16) lgkmcnt(8)
  v_mfma_f32_16x16x32_bf16 v[128:131], v[176:179], v[56:59], v[128:131]
  buffer_load_dwordx4 v[32:35], off, s[36:39], s50 offset:0
  v_mfma_f32_16x16x32_bf16 v[132:135], v[176:179], v[60:63], v[132:135]
  ds_read_b64_tr_b16 v[208:209], v6 offset:61440
  ds_read_b64_tr_b16 v[210:211], v6 offset:61952
  v_mfma_f32_16x16x32_bf16 v[140:143], v[180:183], v[60:63], v[140:143]
  ds_read_b64_tr_b16 v[212:213], v7 offset:61440
  v_mfma_f32_16x16x32_bf16 v[136:139], v[180:183], v[56:59], v[136:139]
  ds_read_b64_tr_b16 v[214:215], v7 offset:61952
  v_mfma_f32_16x16x32_bf16 v[144:147], v[184:187], v[56:59], v[144:147]
  ds_read_b64_tr_b16 v[216:217], v8 offset:61440
  v_mfma_f32_16x16x32_bf16 v[148:151], v[184:187], v[60:63], v[148:151]
  ds_read_b64_tr_b16 v[218:219], v8 offset:61952
  v_mfma_f32_16x16x32_bf16 v[156:159], v[188:191], v[60:63], v[156:159]
  ds_read_b64_tr_b16 v[220:221], v9 offset:61440
  v_mfma_f32_16x16x32_bf16 v[152:155], v[188:191], v[56:59], v[152:155]
  ds_read_b64_tr_b16 v[222:223], v9 offset:61952
  s_waitcnt lgkmcnt(8)
  v_mfma_f32_16x16x32_bf16 v[96:99], v[192:195], v[48:51], v[96:99]
  buffer_load_dwordx4 v[36:39], off, s[64:67], s50 offset:0
  v_mfma_f32_16x16x32_bf16 v[100:103], v[192:195], v[52:55], v[100:103]
  ds_read_b64_tr_b16 v[160:161], v20 offset:0
  ds_read_b64_tr_b16 v[162:163], v20 offset:512
  v_mfma_f32_16x16x32_bf16 v[108:111], v[196:199], v[52:55], v[108:111]
  ds_read_b64_tr_b16 v[164:165], v21 offset:0
  v_mfma_f32_16x16x32_bf16 v[104:107], v[196:199], v[48:51], v[104:107]
  ds_read_b64_tr_b16 v[166:167], v21 offset:512
  v_mfma_f32_16x16x32_bf16 v[112:115], v[200:203], v[48:51], v[112:115]
  ds_read_b64_tr_b16 v[168:169], v22 offset:0
  v_mfma_f32_16x16x32_bf16 v[116:119], v[200:203], v[52:55], v[116:119]
  ds_read_b64_tr_b16 v[170:171], v22 offset:512
  v_mfma_f32_16x16x32_bf16 v[124:127], v[204:207], v[52:55], v[124:127]
  ds_read_b64_tr_b16 v[172:173], v23 offset:0
  v_mfma_f32_16x16x32_bf16 v[120:123], v[204:207], v[48:51], v[120:123]
  ds_read_b64_tr_b16 v[174:175], v23 offset:512
  s_waitcnt lgkmcnt(8)
  s_barrier
  v_mfma_f32_16x16x32_bf16 v[96:99], v[208:211], v[56:59], v[96:99]
  buffer_load_dwordx4 v[40:43], off, s[36:39], s50 offset:1024
  v_mfma_f32_16x16x32_bf16 v[100:103], v[208:211], v[60:63], v[100:103]
  ds_read_b64_tr_b16 v[176:177], v20 offset:4096
  ds_read_b64_tr_b16 v[178:179], v20 offset:4608
  v_mfma_f32_16x16x32_bf16 v[108:111], v[212:215], v[60:63], v[108:111]
  ds_read_b64_tr_b16 v[180:181], v21 offset:4096
  v_mfma_f32_16x16x32_bf16 v[104:107], v[212:215], v[56:59], v[104:107]
  ds_read_b64_tr_b16 v[182:183], v21 offset:4608
  v_mfma_f32_16x16x32_bf16 v[112:115], v[216:219], v[56:59], v[112:115]
  ds_read_b64_tr_b16 v[184:185], v22 offset:4096
  v_mfma_f32_16x16x32_bf16 v[116:119], v[216:219], v[60:63], v[116:119]
  ds_read_b64_tr_b16 v[186:187], v22 offset:4608
  v_mfma_f32_16x16x32_bf16 v[124:127], v[220:223], v[60:63], v[124:127]
  ds_read_b64_tr_b16 v[188:189], v23 offset:4096
  v_mfma_f32_16x16x32_bf16 v[120:123], v[220:223], v[56:59], v[120:123]
  ds_read_b64_tr_b16 v[190:191], v23 offset:4608
  s_waitcnt vmcnt(17) lgkmcnt(8)
  v_mfma_f32_16x16x32_bf16 v[128:131], v[160:163], v[64:67], v[128:131]
  buffer_load_dwordx4 v[44:47], off, s[64:67], s50 offset:1024
  v_mfma_f32_16x16x32_bf16 v[132:135], v[160:163], v[68:71], v[132:135]
  ds_read_b64_tr_b16 v[192:193], v20 offset:8192
  ds_read_b64_tr_b16 v[194:195], v20 offset:8704
  v_mfma_f32_16x16x32_bf16 v[140:143], v[164:167], v[68:71], v[140:143]
  ds_read_b64_tr_b16 v[196:197], v21 offset:8192
  v_mfma_f32_16x16x32_bf16 v[136:139], v[164:167], v[64:67], v[136:139]
  ds_read_b64_tr_b16 v[198:199], v21 offset:8704
  v_mfma_f32_16x16x32_bf16 v[144:147], v[168:171], v[64:67], v[144:147]
  ds_read_b64_tr_b16 v[200:201], v22 offset:8192
  v_mfma_f32_16x16x32_bf16 v[148:151], v[168:171], v[68:71], v[148:151]
  ds_read_b64_tr_b16 v[202:203], v22 offset:8704
  v_readlane_b32 s51, v15, 19
  v_mfma_f32_16x16x32_bf16 v[156:159], v[172:175], v[68:71], v[156:159]
  ds_read_b64_tr_b16 v[204:205], v23 offset:8192
  v_mfma_f32_16x16x32_bf16 v[152:155], v[172:175], v[64:67], v[152:155]
  ds_read_b64_tr_b16 v[206:207], v23 offset:8704
  s_waitcnt vmcnt(16) lgkmcnt(8)
  v_mfma_f32_16x16x32_bf16 v[128:131], v[176:179], v[72:75], v[128:131]
  buffer_load_dwordx4 v[48:51], off, s[36:39], s51 offset:0
  v_mfma_f32_16x16x32_bf16 v[132:135], v[176:179], v[76:79], v[132:135]
  ds_read_b64_tr_b16 v[208:209], v20 offset:12288
  ds_read_b64_tr_b16 v[210:211], v20 offset:12800
  v_mfma_f32_16x16x32_bf16 v[140:143], v[180:183], v[76:79], v[140:143]
  ds_read_b64_tr_b16 v[212:213], v21 offset:12288
  v_mfma_f32_16x16x32_bf16 v[136:139], v[180:183], v[72:75], v[136:139]
  ds_read_b64_tr_b16 v[214:215], v21 offset:12800
  v_mfma_f32_16x16x32_bf16 v[144:147], v[184:187], v[72:75], v[144:147]
  ds_read_b64_tr_b16 v[216:217], v22 offset:12288
  v_mfma_f32_16x16x32_bf16 v[148:151], v[184:187], v[76:79], v[148:151]
  ds_read_b64_tr_b16 v[218:219], v22 offset:12800
  v_mfma_f32_16x16x32_bf16 v[156:159], v[188:191], v[76:79], v[156:159]
  ds_read_b64_tr_b16 v[220:221], v23 offset:12288
  v_mfma_f32_16x16x32_bf16 v[152:155], v[188:191], v[72:75], v[152:155]
  ds_read_b64_tr_b16 v[222:223], v23 offset:12800
  s_waitcnt lgkmcnt(8)
  v_mfma_f32_16x16x32_bf16 v[96:99], v[192:195], v[64:67], v[96:99]
  buffer_load_dwordx4 v[52:55], off, s[64:67], s51 offset:0
  v_mfma_f32_16x16x32_bf16 v[100:103], v[192:195], v[68:71], v[100:103]
  ds_read_b64_tr_b16 v[160:161], v20 offset:16384
  ds_read_b64_tr_b16 v[162:163], v20 offset:16896
  v_mfma_f32_16x16x32_bf16 v[108:111], v[196:199], v[68:71], v[108:111]
  ds_read_b64_tr_b16 v[164:165], v21 offset:16384
  v_mfma_f32_16x16x32_bf16 v[104:107], v[196:199], v[64:67], v[104:107]
  ds_read_b64_tr_b16 v[166:167], v21 offset:16896
  v_mfma_f32_16x16x32_bf16 v[112:115], v[200:203], v[64:67], v[112:115]
  ds_read_b64_tr_b16 v[168:169], v22 offset:16384
  v_mfma_f32_16x16x32_bf16 v[116:119], v[200:203], v[68:71], v[116:119]
  ds_read_b64_tr_b16 v[170:171], v22 offset:16896
  v_mfma_f32_16x16x32_bf16 v[124:127], v[204:207], v[68:71], v[124:127]
  ds_read_b64_tr_b16 v[172:173], v23 offset:16384
  v_mfma_f32_16x16x32_bf16 v[120:123], v[204:207], v[64:67], v[120:123]
  ds_read_b64_tr_b16 v[174:175], v23 offset:16896
  s_waitcnt lgkmcnt(8)
  v_mfma_f32_16x16x32_bf16 v[96:99], v[208:211], v[72:75], v[96:99]
  buffer_load_dwordx4 v[56:59], off, s[36:39], s51 offset:1024
  v_mfma_f32_16x16x32_bf16 v[100:103], v[208:211], v[76:79], v[100:103]
  ds_read_b64_tr_b16 v[176:177], v20 offset:20480
  ds_read_b64_tr_b16 v[178:179], v20 offset:20992
  v_mfma_f32_16x16x32_bf16 v[108:111], v[212:215], v[76:79], v[108:111]
  ds_read_b64_tr_b16 v[180:181], v21 offset:20480
  v_mfma_f32_16x16x32_bf16 v[104:107], v[212:215], v[72:75], v[104:107]
  ds_read_b64_tr_b16 v[182:183], v21 offset:20992
  v_mfma_f32_16x16x32_bf16 v[112:115], v[216:219], v[72:75], v[112:115]
  ds_read_b64_tr_b16 v[184:185], v22 offset:20480
  v_mfma_f32_16x16x32_bf16 v[116:119], v[216:219], v[76:79], v[116:119]
  ds_read_b64_tr_b16 v[186:187], v22 offset:20992
  v_mfma_f32_16x16x32_bf16 v[124:127], v[220:223], v[76:79], v[124:127]
  ds_read_b64_tr_b16 v[188:189], v23 offset:20480
  v_mfma_f32_16x16x32_bf16 v[120:123], v[220:223], v[72:75], v[120:123]
  ds_read_b64_tr_b16 v[190:191], v23 offset:20992
  s_waitcnt vmcnt(17) lgkmcnt(8)
  v_mfma_f32_16x16x32_bf16 v[128:131], v[160:163], v[80:83], v[128:131]
  buffer_load_dwordx4 v[60:63], off, s[64:67], s51 offset:1024
  v_mfma_f32_16x16x32_bf16 v[132:135], v[160:163], v[84:87], v[132:135]
  ds_read_b64_tr_b16 v[192:193], v20 offset:24576
  ds_read_b64_tr_b16 v[194:195], v20 offset:25088
  v_mfma_f32_16x16x32_bf16 v[140:143], v[164:167], v[84:87], v[140:143]
  ds_read_b64_tr_b16 v[196:197], v21 offset:24576
  v_mfma_f32_16x16x32_bf16 v[136:139], v[164:167], v[80:83], v[136:139]
  ds_read_b64_tr_b16 v[198:199], v21 offset:25088
  v_mfma_f32_16x16x32_bf16 v[144:147], v[168:171], v[80:83], v[144:147]
  ds_read_b64_tr_b16 v[200:201], v22 offset:24576
  v_mfma_f32_16x16x32_bf16 v[148:151], v[168:171], v[84:87], v[148:151]
  ds_read_b64_tr_b16 v[202:203], v22 offset:25088
  v_readlane_b32 s48, v15, 20
  v_mfma_f32_16x16x32_bf16 v[156:159], v[172:175], v[84:87], v[156:159]
  ds_read_b64_tr_b16 v[204:205], v23 offset:24576
  v_mfma_f32_16x16x32_bf16 v[152:155], v[172:175], v[80:83], v[152:155]
  ds_read_b64_tr_b16 v[206:207], v23 offset:25088
  s_waitcnt vmcnt(16) lgkmcnt(8)
  v_mfma_f32_16x16x32_bf16 v[128:131], v[176:179], v[88:91], v[128:131]
  buffer_load_dwordx4 v[64:67], off, s[36:39], s48 offset:0
  v_mfma_f32_16x16x32_bf16 v[132:135], v[176:179], v[92:95], v[132:135]
  ds_read_b64_tr_b16 v[208:209], v20 offset:28672
  ds_read_b64_tr_b16 v[210:211], v20 offset:29184
  v_mfma_f32_16x16x32_bf16 v[140:143], v[180:183], v[92:95], v[140:143]
  ds_read_b64_tr_b16 v[212:213], v21 offset:28672
  v_mfma_f32_16x16x32_bf16 v[136:139], v[180:183], v[88:91], v[136:139]
  ds_read_b64_tr_b16 v[214:215], v21 offset:29184
  v_mfma_f32_16x16x32_bf16 v[144:147], v[184:187], v[88:91], v[144:147]
  ds_read_b64_tr_b16 v[216:217], v22 offset:28672
  v_mfma_f32_16x16x32_bf16 v[148:151], v[184:187], v[92:95], v[148:151]
  ds_read_b64_tr_b16 v[218:219], v22 offset:29184
  v_mfma_f32_16x16x32_bf16 v[156:159], v[188:191], v[92:95], v[156:159]
  ds_read_b64_tr_b16 v[220:221], v23 offset:28672
  v_mfma_f32_16x16x32_bf16 v[152:155], v[188:191], v[88:91], v[152:155]
  ds_read_b64_tr_b16 v[222:223], v23 offset:29184
  s_waitcnt lgkmcnt(8)
  v_mfma_f32_16x16x32_bf16 v[96:99], v[192:195], v[80:83], v[96:99]
  buffer_load_dwordx4 v[68:71], off, s[64:67], s48 offset:0
  v_mfma_f32_16x16x32_bf16 v[100:103], v[192:195], v[84:87], v[100:103]
  ds_read_b64_tr_b16 v[160:161], v20 offset:32768
  ds_read_b64_tr_b16 v[162:163], v20 offset:33280
  v_mfma_f32_16x16x32_bf16 v[108:111], v[196:199], v[84:87], v[108:111]
  ds_read_b64_tr_b16 v[164:165], v21 offset:32768
  v_mfma_f32_16x16x32_bf16 v[104:107], v[196:199], v[80:83], v[104:107]
  ds_read_b64_tr_b16 v[166:167], v21 offset:33280
  v_mfma_f32_16x16x32_bf16 v[112:115], v[200:203], v[80:83], v[112:115]
  ds_read_b64_tr_b16 v[168:169], v22 offset:32768
  v_mfma_f32_16x16x32_bf16 v[116:119], v[200:203], v[84:87], v[116:119]
  ds_read_b64_tr_b16 v[170:171], v22 offset:33280
  v_mfma_f32_16x16x32_bf16 v[124:127], v[204:207], v[84:87], v[124:127]
  ds_read_b64_tr_b16 v[172:173], v23 offset:32768
  v_mfma_f32_16x16x32_bf16 v[120:123], v[204:207], v[80:83], v[120:123]
  ds_read_b64_tr_b16 v[174:175], v23 offset:33280
  s_waitcnt lgkmcnt(8)
  s_barrier
  v_mfma_f32_16x16x32_bf16 v[96:99], v[208:211], v[88:91], v[96:99]
  buffer_load_dwordx4 v[72:75], off, s[36:39], s48 offset:1024
  v_mfma_f32_16x16x32_bf16 v[100:103], v[208:211], v[92:95], v[100:103]
  ds_read_b64_tr_b16 v[176:177], v20 offset:36864
  ds_read_b64_tr_b16 v[178:179], v20 offset:37376
  v_mfma_f32_16x16x32_bf16 v[108:111], v[212:215], v[92:95], v[108:111]
  ds_read_b64_tr_b16 v[180:181], v21 offset:36864
  v_mfma_f32_16x16x32_bf16 v[104:107], v[212:215], v[88:91], v[104:107]
  ds_read_b64_tr_b16 v[182:183], v21 offset:37376
  v_mfma_f32_16x16x32_bf16 v[112:115], v[216:219], v[88:91], v[112:115]
  ds_read_b64_tr_b16 v[184:185], v22 offset:36864
  v_mfma_f32_16x16x32_bf16 v[116:119], v[216:219], v[92:95], v[116:119]
  ds_read_b64_tr_b16 v[186:187], v22 offset:37376
  v_mfma_f32_16x16x32_bf16 v[124:127], v[220:223], v[92:95], v[124:127]
  ds_read_b64_tr_b16 v[188:189], v23 offset:36864
  v_mfma_f32_16x16x32_bf16 v[120:123], v[220:223], v[88:91], v[120:123]
  ds_read_b64_tr_b16 v[190:191], v23 offset:37376
  s_waitcnt vmcnt(17) lgkmcnt(8)
  v_mfma_f32_16x16x32_bf16 v[128:131], v[160:163], v[224:227], v[128:131]
  buffer_load_dwordx4 v[76:79], off, s[64:67], s48 offset:1024
  v_mfma_f32_16x16x32_bf16 v[132:135], v[160:163], v[228:231], v[132:135]
  ds_read_b64_tr_b16 v[192:193], v20 offset:40960
  ds_read_b64_tr_b16 v[194:195], v20 offset:41472
  v_mfma_f32_16x16x32_bf16 v[140:143], v[164:167], v[228:231], v[140:143]
  ds_read_b64_tr_b16 v[196:197], v21 offset:40960
  v_mfma_f32_16x16x32_bf16 v[136:139], v[164:167], v[224:227], v[136:139]
  ds_read_b64_tr_b16 v[198:199], v21 offset:41472
  v_mfma_f32_16x16x32_bf16 v[144:147], v[168:171], v[224:227], v[144:147]
  ds_read_b64_tr_b16 v[200:201], v22 offset:40960
  v_mfma_f32_16x16x32_bf16 v[148:151], v[168:171], v[228:231], v[148:151]
  ds_read_b64_tr_b16 v[202:203], v22 offset:41472
  v_readlane_b32 s49, v15, 21
  v_mfma_f32_16x16x32_bf16 v[156:159], v[172:175], v[228:231], v[156:159]
  ds_read_b64_tr_b16 v[204:205], v23 offset:40960
  v_mfma_f32_16x16x32_bf16 v[152:155], v[172:175], v[224:227], v[152:155]
  ds_read_b64_tr_b16 v[206:207], v23 offset:41472
  s_waitcnt vmcnt(16) lgkmcnt(8)
  v_mfma_f32_16x16x32_bf16 v[128:131], v[176:179], v[232:235], v[128:131]
  buffer_load_dwordx4 v[80:83], off, s[36:39], s49 offset:0
  v_mfma_f32_16x16x32_bf16 v[132:135], v[176:179], v[236:239], v[132:135]
  ds_read_b64_tr_b16 v[208:209], v20 offset:45056
  ds_read_b64_tr_b16 v[210:211], v20 offset:45568
  v_mfma_f32_16x16x32_bf16 v[140:143], v[180:183], v[236:239], v[140:143]
  ds_read_b64_tr_b16 v[212:213], v21 offset:45056
  v_mfma_f32_16x16x32_bf16 v[136:139], v[180:183], v[232:235], v[136:139]
  ds_read_b64_tr_b16 v[214:215], v21 offset:45568
  v_mfma_f32_16x16x32_bf16 v[144:147], v[184:187], v[232:235], v[144:147]
  ds_read_b64_tr_b16 v[216:217], v22 offset:45056
  v_mfma_f32_16x16x32_bf16 v[148:151], v[184:187], v[236:239], v[148:151]
  ds_read_b64_tr_b16 v[218:219], v22 offset:45568
  v_mfma_f32_16x16x32_bf16 v[156:159], v[188:191], v[236:239], v[156:159]
  ds_read_b64_tr_b16 v[220:221], v23 offset:45056
  v_mfma_f32_16x16x32_bf16 v[152:155], v[188:191], v[232:235], v[152:155]
  ds_read_b64_tr_b16 v[222:223], v23 offset:45568
  s_waitcnt lgkmcnt(8)
  v_mfma_f32_16x16x32_bf16 v[96:99], v[192:195], v[224:227], v[96:99]
  buffer_load_dwordx4 v[84:87], off, s[64:67], s49 offset:0
  v_mfma_f32_16x16x32_bf16 v[100:103], v[192:195], v[228:231], v[100:103]
  ds_read_b64_tr_b16 v[160:161], v20 offset:49152
  ds_read_b64_tr_b16 v[162:163], v20 offset:49664
  v_mfma_f32_16x16x32_bf16 v[108:111], v[196:199], v[228:231], v[108:111]
  ds_read_b64_tr_b16 v[164:165], v21 offset:49152
  v_mfma_f32_16x16x32_bf16 v[104:107], v[196:199], v[224:227], v[104:107]
  ds_read_b64_tr_b16 v[166:167], v21 offset:49664
  v_mfma_f32_16x16x32_bf16 v[112:115], v[200:203], v[224:227], v[112:115]
  ds_read_b64_tr_b16 v[168:169], v22 offset:49152
  v_mfma_f32_16x16x32_bf16 v[116:119], v[200:203], v[228:231], v[116:119]
  ds_read_b64_tr_b16 v[170:171], v22 offset:49664
  v_mfma_f32_16x16x32_bf16 v[124:127], v[204:207], v[228:231], v[124:127]
  ds_read_b64_tr_b16 v[172:173], v23 offset:49152
  v_mfma_f32_16x16x32_bf16 v[120:123], v[204:207], v[224:227], v[120:123]
  ds_read_b64_tr_b16 v[174:175], v23 offset:49664
  s_waitcnt lgkmcnt(8)
  v_mfma_f32_16x16x32_bf16 v[96:99], v[208:211], v[232:235], v[96:99]
  buffer_load_dwordx4 v[88:91], off, s[36:39], s49 offset:1024
  v_mfma_f32_16x16x32_bf16 v[100:103], v[208:211], v[236:239], v[100:103]
  ds_read_b64_tr_b16 v[176:177], v20 offset:53248
  ds_read_b64_tr_b16 v[178:179], v20 offset:53760
  v_mfma_f32_16x16x32_bf16 v[108:111], v[212:215], v[236:239], v[108:111]
  ds_read_b64_tr_b16 v[180:181], v21 offset:53248
  v_mfma_f32_16x16x32_bf16 v[104:107], v[212:215], v[232:235], v[104:107]
  ds_read_b64_tr_b16 v[182:183], v21 offset:53760
  v_mfma_f32_16x16x32_bf16 v[112:115], v[216:219], v[232:235], v[112:115]
  ds_read_b64_tr_b16 v[184:185], v22 offset:53248
  v_mfma_f32_16x16x32_bf16 v[116:119], v[216:219], v[236:239], v[116:119]
  ds_read_b64_tr_b16 v[186:187], v22 offset:53760
  v_mfma_f32_16x16x32_bf16 v[124:127], v[220:223], v[236:239], v[124:127]
  ds_read_b64_tr_b16 v[188:189], v23 offset:53248
  v_mfma_f32_16x16x32_bf16 v[120:123], v[220:223], v[232:235], v[120:123]
  ds_read_b64_tr_b16 v[190:191], v23 offset:53760
  s_waitcnt vmcnt(17) lgkmcnt(8)
  v_mfma_f32_16x16x32_bf16 v[128:131], v[160:163], v[240:243], v[128:131]
  buffer_load_dwordx4 v[92:95], off, s[64:67], s49 offset:1024
  v_mfma_f32_16x16x32_bf16 v[132:135], v[160:163], v[244:247], v[132:135]
  ds_read_b64_tr_b16 v[192:193], v20 offset:57344
  ds_read_b64_tr_b16 v[194:195], v20 offset:57856
  v_mfma_f32_16x16x32_bf16 v[140:143], v[164:167], v[244:247], v[140:143]
  ds_read_b64_tr_b16 v[196:197], v21 offset:57344
  v_mfma_f32_16x16x32_bf16 v[136:139], v[164:167], v[240:243], v[136:139]
  ds_read_b64_tr_b16 v[198:199], v21 offset:57856
  v_mfma_f32_16x16x32_bf16 v[144:147], v[168:171], v[240:243], v[144:147]
  ds_read_b64_tr_b16 v[200:201], v22 offset:57344
  v_mfma_f32_16x16x32_bf16 v[148:151], v[168:171], v[244:247], v[148:151]
  ds_read_b64_tr_b16 v[202:203], v22 offset:57856
  v_readlane_b32 s50, v15, 22
  v_mfma_f32_16x16x32_bf16 v[156:159], v[172:175], v[244:247], v[156:159]
  ds_read_b64_tr_b16 v[204:205], v23 offset:57344
  v_mfma_f32_16x16x32_bf16 v[152:155], v[172:175], v[240:243], v[152:155]
  ds_read_b64_tr_b16 v[206:207], v23 offset:57856
  s_waitcnt vmcnt(16) lgkmcnt(8)
  v_mfma_f32_16x16x32_bf16 v[128:131], v[176:179], v[248:251], v[128:131]
  buffer_load_dwordx4 v[224:227], off, s[36:39], s50 offset:0
  v_mfma_f32_16x16x32_bf16 v[132:135], v[176:179], v[252:255], v[132:135]
  ds_read_b64_tr_b16 v[208:209], v20 offset:61440
  ds_read_b64_tr_b16 v[210:211], v20 offset:61952
  v_mfma_f32_16x16x32_bf16 v[140:143], v[180:183], v[252:255], v[140:143]
  ds_read_b64_tr_b16 v[212:213], v21 offset:61440
  v_mfma_f32_16x16x32_bf16 v[136:139], v[180:183], v[248:251], v[136:139]
  ds_read_b64_tr_b16 v[214:215], v21 offset:61952
  v_mfma_f32_16x16x32_bf16 v[144:147], v[184:187], v[248:251], v[144:147]
  ds_read_b64_tr_b16 v[216:217], v22 offset:61440
  v_mfma_f32_16x16x32_bf16 v[148:151], v[184:187], v[252:255], v[148:151]
  ds_read_b64_tr_b16 v[218:219], v22 offset:61952
  v_mfma_f32_16x16x32_bf16 v[156:159], v[188:191], v[252:255], v[156:159]
  ds_read_b64_tr_b16 v[220:221], v23 offset:61440
  v_mfma_f32_16x16x32_bf16 v[152:155], v[188:191], v[248:251], v[152:155]
  ds_read_b64_tr_b16 v[222:223], v23 offset:61952
  s_waitcnt lgkmcnt(8)
  v_mfma_f32_16x16x32_bf16 v[96:99], v[192:195], v[240:243], v[96:99]
  buffer_load_dwordx4 v[228:231], off, s[64:67], s50 offset:0
  v_mfma_f32_16x16x32_bf16 v[100:103], v[192:195], v[244:247], v[100:103]
  ds_read_b64_tr_b16 v[160:161], v26 offset:0
  ds_read_b64_tr_b16 v[162:163], v26 offset:512
  v_mfma_f32_16x16x32_bf16 v[108:111], v[196:199], v[244:247], v[108:111]
  ds_read_b64_tr_b16 v[164:165], v27 offset:0
  v_mfma_f32_16x16x32_bf16 v[104:107], v[196:199], v[240:243], v[104:107]
  ds_read_b64_tr_b16 v[166:167], v27 offset:512
  v_mfma_f32_16x16x32_bf16 v[112:115], v[200:203], v[240:243], v[112:115]
  ds_read_b64_tr_b16 v[168:169], v28 offset:0
  v_mfma_f32_16x16x32_bf16 v[116:119], v[200:203], v[244:247], v[116:119]
  ds_read_b64_tr_b16 v[170:171], v28 offset:512
  v_mfma_f32_16x16x32_bf16 v[124:127], v[204:207], v[244:247], v[124:127]
  ds_read_b64_tr_b16 v[172:173], v29 offset:0
  v_mfma_f32_16x16x32_bf16 v[120:123], v[204:207], v[240:243], v[120:123]
  ds_read_b64_tr_b16 v[174:175], v29 offset:512
  s_waitcnt lgkmcnt(8)
  s_barrier
  v_mfma_f32_16x16x32_bf16 v[96:99], v[208:211], v[248:251], v[96:99]
  buffer_load_dwordx4 v[232:235], off, s[36:39], s50 offset:1024
  v_mfma_f32_16x16x32_bf16 v[100:103], v[208:211], v[252:255], v[100:103]
  ds_read_b64_tr_b16 v[176:177], v26 offset:4096
  ds_read_b64_tr_b16 v[178:179], v26 offset:4608
  v_mfma_f32_16x16x32_bf16 v[108:111], v[212:215], v[252:255], v[108:111]
  ds_read_b64_tr_b16 v[180:181], v27 offset:4096
  v_mfma_f32_16x16x32_bf16 v[104:107], v[212:215], v[248:251], v[104:107]
  ds_read_b64_tr_b16 v[182:183], v27 offset:4608
  v_mfma_f32_16x16x32_bf16 v[112:115], v[216:219], v[248:251], v[112:115]
  ds_read_b64_tr_b16 v[184:185], v28 offset:4096
  v_mfma_f32_16x16x32_bf16 v[116:119], v[216:219], v[252:255], v[116:119]
  ds_read_b64_tr_b16 v[186:187], v28 offset:4608
  v_mfma_f32_16x16x32_bf16 v[124:127], v[220:223], v[252:255], v[124:127]
  ds_read_b64_tr_b16 v[188:189], v29 offset:4096
  v_mfma_f32_16x16x32_bf16 v[120:123], v[220:223], v[248:251], v[120:123]
  ds_read_b64_tr_b16 v[190:191], v29 offset:4608
  s_waitcnt vmcnt(17) lgkmcnt(8)
  v_mfma_f32_16x16x32_bf16 v[128:131], v[160:163], v[32:35], v[128:131]
  buffer_load_dwordx4 v[236:239], off, s[64:67], s50 offset:1024
  v_mfma_f32_16x16x32_bf16 v[132:135], v[160:163], v[36:39], v[132:135]
  ds_read_b64_tr_b16 v[192:193], v26 offset:8192
  ds_read_b64_tr_b16 v[194:195], v26 offset:8704
  v_mfma_f32_16x16x32_bf16 v[140:143], v[164:167], v[36:39], v[140:143]
  ds_read_b64_tr_b16 v[196:197], v27 offset:8192
  v_mfma_f32_16x16x32_bf16 v[136:139], v[164:167], v[32:35], v[136:139]
  ds_read_b64_tr_b16 v[198:199], v27 offset:8704
  v_mfma_f32_16x16x32_bf16 v[144:147], v[168:171], v[32:35], v[144:147]
  ds_read_b64_tr_b16 v[200:201], v28 offset:8192
  v_mfma_f32_16x16x32_bf16 v[148:151], v[168:171], v[36:39], v[148:151]
  ds_read_b64_tr_b16 v[202:203], v28 offset:8704
  v_readlane_b32 s51, v15, 23
  v_mfma_f32_16x16x32_bf16 v[156:159], v[172:175], v[36:39], v[156:159]
  ds_read_b64_tr_b16 v[204:205], v29 offset:8192
  v_mfma_f32_16x16x32_bf16 v[152:155], v[172:175], v[32:35], v[152:155]
  ds_read_b64_tr_b16 v[206:207], v29 offset:8704
  s_waitcnt vmcnt(16) lgkmcnt(8)
  v_mfma_f32_16x16x32_bf16 v[128:131], v[176:179], v[40:43], v[128:131]
  buffer_load_dwordx4 v[240:243], off, s[36:39], s51 offset:0
  v_mfma_f32_16x16x32_bf16 v[132:135], v[176:179], v[44:47], v[132:135]
  ds_read_b64_tr_b16 v[208:209], v26 offset:12288
  ds_read_b64_tr_b16 v[210:211], v26 offset:12800
  v_mfma_f32_16x16x32_bf16 v[140:143], v[180:183], v[44:47], v[140:143]
  ds_read_b64_tr_b16 v[212:213], v27 offset:12288
  v_mfma_f32_16x16x32_bf16 v[136:139], v[180:183], v[40:43], v[136:139]
  ds_read_b64_tr_b16 v[214:215], v27 offset:12800
  v_mfma_f32_16x16x32_bf16 v[144:147], v[184:187], v[40:43], v[144:147]
  ds_read_b64_tr_b16 v[216:217], v28 offset:12288
  v_mfma_f32_16x16x32_bf16 v[148:151], v[184:187], v[44:47], v[148:151]
  ds_read_b64_tr_b16 v[218:219], v28 offset:12800
  v_mfma_f32_16x16x32_bf16 v[156:159], v[188:191], v[44:47], v[156:159]
  ds_read_b64_tr_b16 v[220:221], v29 offset:12288
  v_mfma_f32_16x16x32_bf16 v[152:155], v[188:191], v[40:43], v[152:155]
  ds_read_b64_tr_b16 v[222:223], v29 offset:12800
  s_waitcnt lgkmcnt(8)
  v_mfma_f32_16x16x32_bf16 v[96:99], v[192:195], v[32:35], v[96:99]
  buffer_load_dwordx4 v[244:247], off, s[64:67], s51 offset:0
  v_mfma_f32_16x16x32_bf16 v[100:103], v[192:195], v[36:39], v[100:103]
  ds_read_b64_tr_b16 v[160:161], v26 offset:16384
  ds_read_b64_tr_b16 v[162:163], v26 offset:16896
  v_mfma_f32_16x16x32_bf16 v[108:111], v[196:199], v[36:39], v[108:111]
  ds_read_b64_tr_b16 v[164:165], v27 offset:16384
  v_mfma_f32_16x16x32_bf16 v[104:107], v[196:199], v[32:35], v[104:107]
  ds_read_b64_tr_b16 v[166:167], v27 offset:16896
  v_mfma_f32_16x16x32_bf16 v[112:115], v[200:203], v[32:35], v[112:115]
  ds_read_b64_tr_b16 v[168:169], v28 offset:16384
  v_mfma_f32_16x16x32_bf16 v[116:119], v[200:203], v[36:39], v[116:119]
  ds_read_b64_tr_b16 v[170:171], v28 offset:16896
  v_mfma_f32_16x16x32_bf16 v[124:127], v[204:207], v[36:39], v[124:127]
  ds_read_b64_tr_b16 v[172:173], v29 offset:16384
  v_mfma_f32_16x16x32_bf16 v[120:123], v[204:207], v[32:35], v[120:123]
  ds_read_b64_tr_b16 v[174:175], v29 offset:16896
  s_waitcnt lgkmcnt(8)
  v_mfma_f32_16x16x32_bf16 v[96:99], v[208:211], v[40:43], v[96:99]
  buffer_load_dwordx4 v[248:251], off, s[36:39], s51 offset:1024
  v_mfma_f32_16x16x32_bf16 v[100:103], v[208:211], v[44:47], v[100:103]
  ds_read_b64_tr_b16 v[176:177], v26 offset:20480
  ds_read_b64_tr_b16 v[178:179], v26 offset:20992
  v_mfma_f32_16x16x32_bf16 v[108:111], v[212:215], v[44:47], v[108:111]
  ds_read_b64_tr_b16 v[180:181], v27 offset:20480
  v_mfma_f32_16x16x32_bf16 v[104:107], v[212:215], v[40:43], v[104:107]
  ds_read_b64_tr_b16 v[182:183], v27 offset:20992
  v_mfma_f32_16x16x32_bf16 v[112:115], v[216:219], v[40:43], v[112:115]
  ds_read_b64_tr_b16 v[184:185], v28 offset:20480
  v_mfma_f32_16x16x32_bf16 v[116:119], v[216:219], v[44:47], v[116:119]
  ds_read_b64_tr_b16 v[186:187], v28 offset:20992
  v_mfma_f32_16x16x32_bf16 v[124:127], v[220:223], v[44:47], v[124:127]
  ds_read_b64_tr_b16 v[188:189], v29 offset:20480
  v_mfma_f32_16x16x32_bf16 v[120:123], v[220:223], v[40:43], v[120:123]
  ds_read_b64_tr_b16 v[190:191], v29 offset:20992
  s_waitcnt vmcnt(17) lgkmcnt(8)
  v_mfma_f32_16x16x32_bf16 v[128:131], v[160:163], v[48:51], v[128:131]
  buffer_load_dwordx4 v[252:255], off, s[64:67], s51 offset:1024
  v_mfma_f32_16x16x32_bf16 v[132:135], v[160:163], v[52:55], v[132:135]
  ds_read_b64_tr_b16 v[192:193], v26 offset:24576
  ds_read_b64_tr_b16 v[194:195], v26 offset:25088
  v_mfma_f32_16x16x32_bf16 v[140:143], v[164:167], v[52:55], v[140:143]
  ds_read_b64_tr_b16 v[196:197], v27 offset:24576
  v_mfma_f32_16x16x32_bf16 v[136:139], v[164:167], v[48:51], v[136:139]
  ds_read_b64_tr_b16 v[198:199], v27 offset:25088
  v_mfma_f32_16x16x32_bf16 v[144:147], v[168:171], v[48:51], v[144:147]
  ds_read_b64_tr_b16 v[200:201], v28 offset:24576
  v_mfma_f32_16x16x32_bf16 v[148:151], v[168:171], v[52:55], v[148:151]
  ds_read_b64_tr_b16 v[202:203], v28 offset:25088
  v_readlane_b32 s48, v15, 24
  v_mfma_f32_16x16x32_bf16 v[156:159], v[172:175], v[52:55], v[156:159]
  ds_read_b64_tr_b16 v[204:205], v29 offset:24576
  v_mfma_f32_16x16x32_bf16 v[152:155], v[172:175], v[48:51], v[152:155]
  ds_read_b64_tr_b16 v[206:207], v29 offset:25088
  s_waitcnt vmcnt(16) lgkmcnt(8)
  v_mfma_f32_16x16x32_bf16 v[128:131], v[176:179], v[56:59], v[128:131]
  buffer_load_dwordx4 v[32:35], off, s[36:39], s48 offset:0
  v_mfma_f32_16x16x32_bf16 v[132:135], v[176:179], v[60:63], v[132:135]
  ds_read_b64_tr_b16 v[208:209], v26 offset:28672
  ds_read_b64_tr_b16 v[210:211], v26 offset:29184
  v_mfma_f32_16x16x32_bf16 v[140:143], v[180:183], v[60:63], v[140:143]
  ds_read_b64_tr_b16 v[212:213], v27 offset:28672
  v_mfma_f32_16x16x32_bf16 v[136:139], v[180:183], v[56:59], v[136:139]
  ds_read_b64_tr_b16 v[214:215], v27 offset:29184
  v_mfma_f32_16x16x32_bf16 v[144:147], v[184:187], v[56:59], v[144:147]
  ds_read_b64_tr_b16 v[216:217], v28 offset:28672
  v_mfma_f32_16x16x32_bf16 v[148:151], v[184:187], v[60:63], v[148:151]
  ds_read_b64_tr_b16 v[218:219], v28 offset:29184
  v_mfma_f32_16x16x32_bf16 v[156:159], v[188:191], v[60:63], v[156:159]
  ds_read_b64_tr_b16 v[220:221], v29 offset:28672
  v_mfma_f32_16x16x32_bf16 v[152:155], v[188:191], v[56:59], v[152:155]
  ds_read_b64_tr_b16 v[222:223], v29 offset:29184
  s_waitcnt lgkmcnt(8)
  v_mfma_f32_16x16x32_bf16 v[96:99], v[192:195], v[48:51], v[96:99]
  buffer_load_dwordx4 v[36:39], off, s[64:67], s48 offset:0
  v_mfma_f32_16x16x32_bf16 v[100:103], v[192:195], v[52:55], v[100:103]
  ds_read_b64_tr_b16 v[160:161], v6 offset:0
  ds_read_b64_tr_b16 v[162:163], v6 offset:512
  v_mfma_f32_16x16x32_bf16 v[108:111], v[196:199], v[52:55], v[108:111]
  ds_read_b64_tr_b16 v[164:165], v7 offset:0
  v_cvt_pk_bf16_f32 v128, v128, v129
  v_mfma_f32_16x16x32_bf16 v[104:107], v[196:199], v[48:51], v[104:107]
  ds_read_b64_tr_b16 v[166:167], v7 offset:512
  v_cvt_pk_bf16_f32 v129, v130, v131
  v_mfma_f32_16x16x32_bf16 v[112:115], v[200:203], v[48:51], v[112:115]
  ds_read_b64_tr_b16 v[168:169], v8 offset:0
  v_cvt_pk_bf16_f32 v130, v132, v133
  v_mfma_f32_16x16x32_bf16 v[116:119], v[200:203], v[52:55], v[116:119]
  ds_read_b64_tr_b16 v[170:171], v8 offset:512
  v_cvt_pk_bf16_f32 v131, v134, v135
  v_mfma_f32_16x16x32_bf16 v[124:127], v[204:207], v[52:55], v[124:127]
  ds_read_b64_tr_b16 v[172:173], v9 offset:0
  buffer_store_dwordx4 v[128:131], off, s[60:63], s4 offset:0 sc1
  v_mfma_f32_16x16x32_bf16 v[120:123], v[204:207], v[48:51], v[120:123]
  ds_read_b64_tr_b16 v[174:175], v9 offset:512
  s_waitcnt lgkmcnt(8)
  s_barrier
  v_mfma_f32_16x16x32_bf16 v[96:99], v[208:211], v[56:59], v[96:99]
  ds_read_b64_tr_b16 v[176:177], v6 offset:4096
  buffer_load_dwordx4 v[40:43], off, s[36:39], s48 offset:1024
  v_mfma_f32_16x16x32_bf16 v[100:103], v[208:211], v[60:63], v[100:103]
  ds_read_b64_tr_b16 v[178:179], v6 offset:4608
  v_cvt_pk_bf16_f32 v132, v136, v137
  v_mfma_f32_16x16x32_bf16 v[108:111], v[212:215], v[60:63], v[108:111]
  ds_read_b64_tr_b16 v[180:181], v7 offset:4096
  v_cvt_pk_bf16_f32 v133, v138, v139
  v_mfma_f32_16x16x32_bf16 v[104:107], v[212:215], v[56:59], v[104:107]
  ds_read_b64_tr_b16 v[182:183], v7 offset:4608
  v_cvt_pk_bf16_f32 v134, v140, v141
  v_mfma_f32_16x16x32_bf16 v[112:115], v[216:219], v[56:59], v[112:115]
  ds_read_b64_tr_b16 v[184:185], v8 offset:4096
  v_cvt_pk_bf16_f32 v135, v142, v143
  v_mfma_f32_16x16x32_bf16 v[116:119], v[216:219], v[60:63], v[116:119]
  ds_read_b64_tr_b16 v[186:187], v8 offset:4608
  buffer_store_dwordx4 v[132:135], off, s[60:63], s4 offset:1024 sc1
  v_mfma_f32_16x16x32_bf16 v[124:127], v[220:223], v[60:63], v[124:127]
  ds_read_b64_tr_b16 v[188:189], v9 offset:4096
  v_cvt_pk_bf16_f32 v136, v144, v145
  v_mfma_f32_16x16x32_bf16 v[120:123], v[220:223], v[56:59], v[120:123]
  ds_read_b64_tr_b16 v[190:191], v9 offset:4608
  s_waitcnt vmcnt(19) lgkmcnt(8)
  v_mfma_f32_16x16x32_bf16 v[96:99], v[160:163], v[64:67], v[96:99]
  ds_read_b64_tr_b16 v[192:193], v6 offset:8192
  buffer_load_dwordx4 v[44:47], off, s[64:67], s48 offset:1024
  v_mfma_f32_16x16x32_bf16 v[100:103], v[160:163], v[68:71], v[100:103]
  ds_read_b64_tr_b16 v[194:195], v6 offset:8704
  v_cvt_pk_bf16_f32 v137, v146, v147
  v_mfma_f32_16x16x32_bf16 v[108:111], v[164:167], v[68:71], v[108:111]
  ds_read_b64_tr_b16 v[196:197], v7 offset:8192
  v_cvt_pk_bf16_f32 v138, v148, v149
  v_mfma_f32_16x16x32_bf16 v[104:107], v[164:167], v[64:67], v[104:107]
  ds_read_b64_tr_b16 v[198:199], v7 offset:8704
  v_cvt_pk_bf16_f32 v139, v150, v151
  v_mfma_f32_16x16x32_bf16 v[112:115], v[168:171], v[64:67], v[112:115]
  ds_read_b64_tr_b16 v[200:201], v8 offset:8192
  buffer_store_dwordx4 v[136:139], off, s[60:63], s4 offset:2048 sc1
  v_mfma_f32_16x16x32_bf16 v[116:119], v[168:171], v[68:71], v[116:119]
  ds_read_b64_tr_b16 v[202:203], v8 offset:8704
  v_readlane_b32 s49, v15, 25
  v_mfma_f32_16x16x32_bf16 v[124:127], v[172:175], v[68:71], v[124:127]
  ds_read_b64_tr_b16 v[204:205], v9 offset:8192
  v_cvt_pk_bf16_f32 v140, v152, v153
  v_mfma_f32_16x16x32_bf16 v[120:123], v[172:175], v[64:67], v[120:123]
  ds_read_b64_tr_b16 v[206:207], v9 offset:8704
  s_waitcnt vmcnt(19) lgkmcnt(8)
  v_mfma_f32_16x16x32_bf16 v[96:99], v[176:179], v[72:75], v[96:99]
  ds_read_b64_tr_b16 v[208:209], v6 offset:12288
  buffer_load_dwordx4 v[48:51], off, s[36:39], s49 offset:0
  v_mfma_f32_16x16x32_bf16 v[100:103], v[176:179], v[76:79], v[100:103]
  ds_read_b64_tr_b16 v[210:211], v6 offset:12800
  v_cvt_pk_bf16_f32 v141, v154, v155
  v_mfma_f32_16x16x32_bf16 v[108:111], v[180:183], v[76:79], v[108:111]
  ds_read_b64_tr_b16 v[212:213], v7 offset:12288
  v_cvt_pk_bf16_f32 v142, v156, v157
  v_mfma_f32_16x16x32_bf16 v[104:107], v[180:183], v[72:75], v[104:107]
  ds_read_b64_tr_b16 v[214:215], v7 offset:12800
  v_cvt_pk_bf16_f32 v143, v158, v159
  v_mfma_f32_16x16x32_bf16 v[112:115], v[184:187], v[72:75], v[112:115]
  ds_read_b64_tr_b16 v[216:217], v8 offset:12288
  buffer_load_dwordx4 v[52:55], off, s[64:67], s49 offset:0
  v_mfma_f32_16x16x32_bf16 v[116:119], v[184:187], v[76:79], v[116:119]
  buffer_store_dwordx4 v[140:143], off, s[60:63], s4 offset:3072 sc1
  v_mfma_f32_16x16x32_bf16 v[124:127], v[188:191], v[76:79], v[124:127]
  ds_read_b64_tr_b16 v[218:219], v8 offset:12800
  ds_read_b64_tr_b16 v[220:221], v9 offset:12288
  v_mfma_f32_16x16x32_bf16 v[120:123], v[188:191], v[72:75], v[120:123]
  ds_read_b64_tr_b16 v[222:223], v9 offset:12800
  s_waitcnt vmcnt(20) lgkmcnt(8)
  v_mfma_f32_16x16x32_bf16 v[96:99], v[192:195], v[80:83], v[96:99]
  buffer_load_dwordx4 v[56:59], off, s[36:39], s49 offset:1024
  v_mfma_f32_16x16x32_bf16 v[100:103], v[192:195], v[84:87], v[100:103]
  ds_read_b64_tr_b16 v[160:161], v6 offset:16384
  ds_read_b64_tr_b16 v[162:163], v6 offset:16896
  v_mfma_f32_16x16x32_bf16 v[108:111], v[196:199], v[84:87], v[108:111]
  ds_read_b64_tr_b16 v[164:165], v7 offset:16384
  v_mfma_f32_16x16x32_bf16 v[104:107], v[196:199], v[80:83], v[104:107]
  ds_read_b64_tr_b16 v[166:167], v7 offset:16896
  v_mfma_f32_16x16x32_bf16 v[112:115], v[200:203], v[80:83], v[112:115]
  buffer_load_dwordx4 v[60:63], off, s[64:67], s49 offset:1024
  v_mfma_f32_16x16x32_bf16 v[116:119], v[200:203], v[84:87], v[116:119]
  ds_read_b64_tr_b16 v[168:169], v8 offset:16384
  ds_read_b64_tr_b16 v[170:171], v8 offset:16896
  v_mfma_f32_16x16x32_bf16 v[124:127], v[204:207], v[84:87], v[124:127]
  ds_read_b64_tr_b16 v[172:173], v9 offset:16384
  v_readlane_b32 s50, v15, 26
  v_mfma_f32_16x16x32_bf16 v[120:123], v[204:207], v[80:83], v[120:123]
  ds_read_b64_tr_b16 v[174:175], v9 offset:16896
  s_waitcnt vmcnt(20) lgkmcnt(8)
  v_mfma_f32_16x16x32_bf16 v[96:99], v[208:211], v[88:91], v[96:99]
  ds_read_b64_tr_b16 v[176:177], v6 offset:20480
  v_mfma_f32_16x16x32_bf16 v[100:103], v[208:211], v[92:95], v[100:103]
  buffer_load_dwordx4 v[64:67], off, s[36:39], s50 offset:0
  v_mfma_f32_16x16x32_bf16 v[108:111], v[212:215], v[92:95], v[108:111]
  ds_read_b64_tr_b16 v[178:179], v6 offset:20992
  ds_read_b64_tr_b16 v[180:181], v7 offset:20480
  v_mfma_f32_16x16x32_bf16 v[104:107], v[212:215], v[88:91], v[104:107]
  ds_read_b64_tr_b16 v[182:183], v7 offset:20992
  v_mfma_f32_16x16x32_bf16 v[112:115], v[216:219], v[88:91], v[112:115]
  ds_read_b64_tr_b16 v[184:185], v8 offset:20480
  v_mfma_f32_16x16x32_bf16 v[116:119], v[216:219], v[92:95], v[116:119]
  buffer_load_dwordx4 v[68:71], off, s[64:67], s50 offset:0
  v_mfma_f32_16x16x32_bf16 v[124:127], v[220:223], v[92:95], v[124:127]
  ds_read_b64_tr_b16 v[186:187], v8 offset:20992
  ds_read_b64_tr_b16 v[188:189], v9 offset:20480
  v_mfma_f32_16x16x32_bf16 v[120:123], v[220:223], v[88:91], v[120:123]
  ds_read_b64_tr_b16 v[190:191], v9 offset:20992
  s_waitcnt vmcnt(20) lgkmcnt(8)
  v_mfma_f32_16x16x32_bf16 v[96:99], v[160:163], v[224:227], v[96:99]
  ds_read_b64_tr_b16 v[192:193], v6 offset:24576
  v_mfma_f32_16x16x32_bf16 v[100:103], v[160:163], v[228:231], v[100:103]
  buffer_load_dwordx4 v[72:75], off, s[36:39], s50 offset:1024
  v_mfma_f32_16x16x32_bf16 v[108:111], v[164:167], v[228:231], v[108:111]
  ds_read_b64_tr_b16 v[194:195], v6 offset:25088
  ds_read_b64_tr_b16 v[196:197], v7 offset:24576
  v_mfma_f32_16x16x32_bf16 v[104:107], v[164:167], v[224:227], v[104:107]
  ds_read_b64_tr_b16 v[198:199], v7 offset:25088
  v_mfma_f32_16x16x32_bf16 v[112:115], v[168:171], v[224:227], v[112:115]
  ds_read_b64_tr_b16 v[200:201], v8 offset:24576
  v_mfma_f32_16x16x32_bf16 v[116:119], v[168:171], v[228:231], v[116:119]
  buffer_load_dwordx4 v[76:79], off, s[64:67], s50 offset:1024
  v_mfma_f32_16x16x32_bf16 v[124:127], v[172:175], v[228:231], v[124:127]
  ds_read_b64_tr_b16 v[202:203], v8 offset:25088
  ds_read_b64_tr_b16 v[204:205], v9 offset:24576
  v_mfma_f32_16x16x32_bf16 v[120:123], v[172:175], v[224:227], v[120:123]
  ds_read_b64_tr_b16 v[206:207], v9 offset:25088
  s_waitcnt vmcnt(20) lgkmcnt(8)
  v_mfma_f32_16x16x32_bf16 v[96:99], v[176:179], v[232:235], v[96:99]
  ds_read_b64_tr_b16 v[208:209], v6 offset:28672
  v_readlane_b32 s51, v15, 27
  v_mfma_f32_16x16x32_bf16 v[100:103], v[176:179], v[236:239], v[100:103]
  ds_read_b64_tr_b16 v[210:211], v6 offset:29184
  v_mfma_f32_16x16x32_bf16 v[108:111], v[180:183], v[236:239], v[108:111]
  ds_read_b64_tr_b16 v[212:213], v7 offset:28672
  v_mfma_f32_16x16x32_bf16 v[104:107], v[180:183], v[232:235], v[104:107]
  buffer_load_dwordx4 v[80:83], off, s[36:39], s51 offset:0
  v_mfma_f32_16x16x32_bf16 v[112:115], v[184:187], v[232:235], v[112:115]
  ds_read_b64_tr_b16 v[214:215], v7 offset:29184
  ds_read_b64_tr_b16 v[216:217], v8 offset:28672
  v_mfma_f32_16x16x32_bf16 v[116:119], v[184:187], v[236:239], v[116:119]
  ds_read_b64_tr_b16 v[218:219], v8 offset:29184
  v_mfma_f32_16x16x32_bf16 v[124:127], v[188:191], v[236:239], v[124:127]
  ds_read_b64_tr_b16 v[220:221], v9 offset:28672
  v_mfma_f32_16x16x32_bf16 v[120:123], v[188:191], v[232:235], v[120:123]
  ds_read_b64_tr_b16 v[222:223], v9 offset:29184
  s_waitcnt vmcnt(19) lgkmcnt(8)
  v_mfma_f32_16x16x32_bf16 v[96:99], v[192:195], v[240:243], v[96:99]
  ds_read_b64_tr_b16 v[160:161], v6 offset:32768
  buffer_load_dwordx4 v[84:87], off, s[64:67], s51 offset:0
  v_mfma_f32_16x16x32_bf16 v[100:103], v[192:195], v[244:247], v[100:103]
  ds_read_b64_tr_b16 v[162:163], v6 offset:33280
  s_waitcnt vmcnt(8)
  v_mfma_f32_16x16x32_bf16 v[108:111], v[196:199], v[244:247], v[108:111]
  buffer_store_dword v19, off, s[52:55], s6 sc1
  v_mfma_f32_16x16x32_bf16 v[104:107], v[196:199], v[240:243], v[104:107]
  ds_read_b64_tr_b16 v[164:165], v7 offset:32768
  ds_read_b64_tr_b16 v[166:167], v7 offset:33280
  v_mfma_f32_16x16x32_bf16 v[112:115], v[200:203], v[240:243], v[112:115]
  buffer_load_dwordx4 v[88:91], off, s[36:39], s51 offset:1024
  v_mfma_f32_16x16x32_bf16 v[116:119], v[200:203], v[244:247], v[116:119]
  ds_read_b64_tr_b16 v[168:169], v8 offset:32768
  ds_read_b64_tr_b16 v[170:171], v8 offset:33280
  v_mfma_f32_16x16x32_bf16 v[124:127], v[204:207], v[244:247], v[124:127]
  ds_read_b64_tr_b16 v[172:173], v9 offset:32768
  v_mfma_f32_16x16x32_bf16 v[120:123], v[204:207], v[240:243], v[120:123]
  ds_read_b64_tr_b16 v[174:175], v9 offset:33280
  s_waitcnt lgkmcnt(8)
  v_mfma_f32_16x16x32_bf16 v[96:99], v[208:211], v[248:251], v[96:99]
  buffer_load_dwordx4 v[92:95], off, s[64:67], s51 offset:1024
  v_mfma_f32_16x16x32_bf16 v[100:103], v[208:211], v[252:255], v[100:103]
  ds_read_b64_tr_b16 v[176:177], v6 offset:36864
  ds_read_b64_tr_b16 v[178:179], v6 offset:37376
  v_mfma_f32_16x16x32_bf16 v[108:111], v[212:215], v[252:255], v[108:111]
  ds_read_b64_tr_b16 v[180:181], v7 offset:36864
  v_readlane_b32 s48, v15, 28
  v_mfma_f32_16x16x32_bf16 v[104:107], v[212:215], v[248:251], v[104:107]
  ds_read_b64_tr_b16 v[182:183], v7 offset:37376
  v_mfma_f32_16x16x32_bf16 v[112:115], v[216:219], v[248:251], v[112:115]
  ds_read_b64_tr_b16 v[184:185], v8 offset:36864
  v_mfma_f32_16x16x32_bf16 v[116:119], v[216:219], v[252:255], v[116:119]
  buffer_load_dwordx4 v[224:227], off, s[36:39], s48 offset:0
  v_mfma_f32_16x16x32_bf16 v[124:127], v[220:223], v[252:255], v[124:127]
  ds_read_b64_tr_b16 v[186:187], v8 offset:37376
  ds_read_b64_tr_b16 v[188:189], v9 offset:36864
  v_mfma_f32_16x16x32_bf16 v[120:123], v[220:223], v[248:251], v[120:123]
  ds_read_b64_tr_b16 v[190:191], v9 offset:37376
  s_waitcnt lgkmcnt(8)
  v_mfma_f32_16x16x32_bf16 v[96:99], v[160:163], v[32:35], v[96:99]
  ds_read_b64_tr_b16 v[192:193], v6 offset:40960
  v_mfma_f32_16x16x32_bf16 v[100:103], v[160:163], v[36:39], v[100:103]
  buffer_load_dwordx4 v[228:231], off, s[64:67], s48 offset:0
  v_mfma_f32_16x16x32_bf16 v[108:111], v[164:167], v[36:39], v[108:111]
  ds_read_b64_tr_b16 v[194:195], v6 offset:41472
  ds_read_b64_tr_b16 v[196:197], v7 offset:40960
  v_mfma_f32_16x16x32_bf16 v[104:107], v[164:167], v[32:35], v[104:107]
  ds_read_b64_tr_b16 v[198:199], v7 offset:41472
  v_mfma_f32_16x16x32_bf16 v[112:115], v[168:171], v[32:35], v[112:115]
  ds_read_b64_tr_b16 v[200:201], v8 offset:40960
  v_mfma_f32_16x16x32_bf16 v[116:119], v[168:171], v[36:39], v[116:119]
  buffer_load_dwordx4 v[232:235], off, s[36:39], s48 offset:1024
  v_mfma_f32_16x16x32_bf16 v[124:127], v[172:175], v[36:39], v[124:127]
  ds_read_b64_tr_b16 v[202:203], v8 offset:41472
  ds_read_b64_tr_b16 v[204:205], v9 offset:40960
  v_mfma_f32_16x16x32_bf16 v[120:123], v[172:175], v[32:35], v[120:123]
  ds_read_b64_tr_b16 v[206:207], v9 offset:41472
  s_waitcnt lgkmcnt(8)
  v_mfma_f32_16x16x32_bf16 v[96:99], v[176:179], v[40:43], v[96:99]
  ds_read_b64_tr_b16 v[208:209], v6 offset:45056
  v_mfma_f32_16x16x32_bf16 v[100:103], v[176:179], v[44:47], v[100:103]
  buffer_load_dwordx4 v[236:239], off, s[64:67], s48 offset:1024
  v_mfma_f32_16x16x32_bf16 v[108:111], v[180:183], v[44:47], v[108:111]
  ds_read_b64_tr_b16 v[210:211], v6 offset:45568
  ds_read_b64_tr_b16 v[212:213], v7 offset:45056
  v_mfma_f32_16x16x32_bf16 v[104:107], v[180:183], v[40:43], v[104:107]
  ds_read_b64_tr_b16 v[214:215], v7 offset:45568
  v_readlane_b32 s49, v15, 29
  v_mfma_f32_16x16x32_bf16 v[112:115], v[184:187], v[40:43], v[112:115]
  ds_read_b64_tr_b16 v[216:217], v8 offset:45056
  v_mfma_f32_16x16x32_bf16 v[116:119], v[184:187], v[44:47], v[116:119]
  ds_read_b64_tr_b16 v[218:219], v8 offset:45568
  ds_read_b64_tr_b16 v[220:221], v9 offset:45056
  v_mfma_f32_16x16x32_bf16 v[124:127], v[188:191], v[44:47], v[124:127]
  buffer_load_dwordx4 v[240:243], off, s[36:39], s49 offset:0
  v_mfma_f32_16x16x32_bf16 v[120:123], v[188:191], v[40:43], v[120:123]
  ds_read_b64_tr_b16 v[222:223], v9 offset:45568
  s_waitcnt lgkmcnt(8)
  v_mfma_f32_16x16x32_bf16 v[96:99], v[192:195], v[48:51], v[96:99]
  ds_read_b64_tr_b16 v[160:161], v6 offset:49152
  v_mfma_f32_16x16x32_bf16 v[100:103], v[192:195], v[52:55], v[100:103]
  ds_read_b64_tr_b16 v[162:163], v6 offset:49664
  v_mfma_f32_16x16x32_bf16 v[108:111], v[196:199], v[52:55], v[108:111]
  buffer_load_dwordx4 v[244:247], off, s[64:67], s49 offset:0
  v_mfma_f32_16x16x32_bf16 v[104:107], v[196:199], v[48:51], v[104:107]
  ds_read_b64_tr_b16 v[164:165], v7 offset:49152
  ds_read_b64_tr_b16 v[166:167], v7 offset:49664
  v_mfma_f32_16x16x32_bf16 v[112:115], v[200:203], v[48:51], v[112:115]
  ds_read_b64_tr_b16 v[168:169], v8 offset:49152
  v_mfma_f32_16x16x32_bf16 v[116:119], v[200:203], v[52:55], v[116:119]
  ds_read_b64_tr_b16 v[170:171], v8 offset:49664
  ds_read_b64_tr_b16 v[172:173], v9 offset:49152
  v_mfma_f32_16x16x32_bf16 v[124:127], v[204:207], v[52:55], v[124:127]
  buffer_load_dwordx4 v[248:251], off, s[36:39], s49 offset:1024
  v_mfma_f32_16x16x32_bf16 v[120:123], v[204:207], v[48:51], v[120:123]
  ds_read_b64_tr_b16 v[174:175], v9 offset:49664
  s_waitcnt vmcnt(16) lgkmcnt(8)
  s_barrier
  v_mfma_f32_16x16x32_bf16 v[96:99], v[208:211], v[56:59], v[96:99]
  ds_read_b64_tr_b16 v[176:177], v6 offset:53248
  v_mfma_f32_16x16x32_bf16 v[100:103], v[208:211], v[60:63], v[100:103]
  ds_read_b64_tr_b16 v[178:179], v6 offset:53760
  v_mfma_f32_16x16x32_bf16 v[108:111], v[212:215], v[60:63], v[108:111]
  buffer_load_dwordx4 v[252:255], off, s[64:67], s49 offset:1024
  v_mfma_f32_16x16x32_bf16 v[104:107], v[212:215], v[56:59], v[104:107]
  ds_read_b64_tr_b16 v[180:181], v7 offset:53248
  ds_read_b64_tr_b16 v[182:183], v7 offset:53760
  v_mfma_f32_16x16x32_bf16 v[112:115], v[216:219], v[56:59], v[112:115]
  ds_read_b64_tr_b16 v[184:185], v8 offset:53248
  v_readlane_b32 s50, v15, 30
  v_mfma_f32_16x16x32_bf16 v[116:119], v[216:219], v[60:63], v[116:119]
  ds_read_b64_tr_b16 v[186:187], v8 offset:53760
  v_mfma_f32_16x16x32_bf16 v[124:127], v[220:223], v[60:63], v[124:127]
  ds_read_b64_tr_b16 v[188:189], v9 offset:53248
  v_mfma_f32_16x16x32_bf16 v[120:123], v[220:223], v[56:59], v[120:123]
  ds_read_b64_tr_b16 v[190:191], v9 offset:53760
  s_waitcnt vmcnt(15) lgkmcnt(8)
  v_mfma_f32_16x16x32_bf16 v[96:99], v[160:163], v[64:67], v[96:99]
  buffer_load_dwordx4 v[32:35], off, s[36:39], s50 offset:0
  v_mfma_f32_16x16x32_bf16 v[100:103], v[160:163], v[68:71], v[100:103]
  ds_read_b64_tr_b16 v[192:193], v6 offset:57344
  ds_read_b64_tr_b16 v[194:195], v6 offset:57856
  v_mfma_f32_16x16x32_bf16 v[108:111], v[164:167], v[68:71], v[108:111]
  ds_read_b64_tr_b16 v[196:197], v7 offset:57344
  v_mfma_f32_16x16x32_bf16 v[104:107], v[164:167], v[64:67], v[104:107]
  ds_read_b64_tr_b16 v[198:199], v7 offset:57856
  v_mfma_f32_16x16x32_bf16 v[112:115], v[168:171], v[64:67], v[112:115]
  buffer_load_dwordx4 v[36:39], off, s[64:67], s50 offset:0
  v_mfma_f32_16x16x32_bf16 v[116:119], v[168:171], v[68:71], v[116:119]
  ds_read_b64_tr_b16 v[200:201], v8 offset:57344
  ds_read_b64_tr_b16 v[202:203], v8 offset:57856
  v_mfma_f32_16x16x32_bf16 v[124:127], v[172:175], v[68:71], v[124:127]
  ds_read_b64_tr_b16 v[204:205], v9 offset:57344
  v_mfma_f32_16x16x32_bf16 v[120:123], v[172:175], v[64:67], v[120:123]
  ds_read_b64_tr_b16 v[206:207], v9 offset:57856
  s_waitcnt vmcnt(15) lgkmcnt(8)
  v_mfma_f32_16x16x32_bf16 v[96:99], v[176:179], v[72:75], v[96:99]
  buffer_load_dwordx4 v[40:43], off, s[36:39], s50 offset:1024
  v_mfma_f32_16x16x32_bf16 v[100:103], v[176:179], v[76:79], v[100:103]
  ds_read_b64_tr_b16 v[208:209], v6 offset:61440
  ds_read_b64_tr_b16 v[210:211], v6 offset:61952
  v_mfma_f32_16x16x32_bf16 v[108:111], v[180:183], v[76:79], v[108:111]
  ds_read_b64_tr_b16 v[212:213], v7 offset:61440
  v_mfma_f32_16x16x32_bf16 v[104:107], v[180:183], v[72:75], v[104:107]
  ds_read_b64_tr_b16 v[214:215], v7 offset:61952
  v_mfma_f32_16x16x32_bf16 v[112:115], v[184:187], v[72:75], v[112:115]
  buffer_load_dwordx4 v[44:47], off, s[64:67], s50 offset:1024
  v_mfma_f32_16x16x32_bf16 v[116:119], v[184:187], v[76:79], v[116:119]
  ds_read_b64_tr_b16 v[216:217], v8 offset:61440
  ds_read_b64_tr_b16 v[218:219], v8 offset:61952
  v_mfma_f32_16x16x32_bf16 v[124:127], v[188:191], v[76:79], v[124:127]
  ds_read_b64_tr_b16 v[220:221], v9 offset:61440
  v_readlane_b32 s51, v15, 31
  v_mfma_f32_16x16x32_bf16 v[120:123], v[188:191], v[72:75], v[120:123]
  ds_read_b64_tr_b16 v[222:223], v9 offset:61952
  s_waitcnt vmcnt(15) lgkmcnt(8)
  v_mfma_f32_16x16x32_bf16 v[96:99], v[192:195], v[80:83], v[96:99]
  ds_read_b64_tr_b16 v[160:161], v20 offset:0
  v_mfma_f32_16x16x32_bf16 v[100:103], v[192:195], v[84:87], v[100:103]
  buffer_load_dwordx4 v[48:51], off, s[36:39], s51 offset:0
  v_mfma_f32_16x16x32_bf16 v[108:111], v[196:199], v[84:87], v[108:111]
  ds_read_b64_tr_b16 v[162:163], v20 offset:512
  ds_read_b64_tr_b16 v[164:165], v21 offset:0
  v_mfma_f32_16x16x32_bf16 v[104:107], v[196:199], v[80:83], v[104:107]
  ds_read_b64_tr_b16 v[166:167], v21 offset:512
  v_mfma_f32_16x16x32_bf16 v[112:115], v[200:203], v[80:83], v[112:115]
  ds_read_b64_tr_b16 v[168:169], v22 offset:0
  v_mfma_f32_16x16x32_bf16 v[116:119], v[200:203], v[84:87], v[116:119]
  buffer_load_dwordx4 v[52:55], off, s[64:67], s51 offset:0
  v_mfma_f32_16x16x32_bf16 v[124:127], v[204:207], v[84:87], v[124:127]
  ds_read_b64_tr_b16 v[170:171], v22 offset:512
  ds_read_b64_tr_b16 v[172:173], v23 offset:0
  v_mfma_f32_16x16x32_bf16 v[120:123], v[204:207], v[80:83], v[120:123]
  ds_read_b64_tr_b16 v[174:175], v23 offset:512
  s_waitcnt vmcnt(14) lgkmcnt(8)
  v_mfma_f32_16x16x32_bf16 v[96:99], v[208:211], v[88:91], v[96:99]
  ds_read_b64_tr_b16 v[176:177], v20 offset:4096
  v_mfma_f32_16x16x32_bf16 v[100:103], v[208:211], v[92:95], v[100:103]
  buffer_load_dwordx4 v[56:59], off, s[36:39], s51 offset:1024
  v_mfma_f32_16x16x32_bf16 v[108:111], v[212:215], v[92:95], v[108:111]
  ds_read_b64_tr_b16 v[178:179], v20 offset:4608
  ds_read_b64_tr_b16 v[180:181], v21 offset:4096
  v_mfma_f32_16x16x32_bf16 v[104:107], v[212:215], v[88:91], v[104:107]
  ds_read_b64_tr_b16 v[182:183], v21 offset:4608
  v_mfma_f32_16x16x32_bf16 v[112:115], v[216:219], v[88:91], v[112:115]
  ds_read_b64_tr_b16 v[184:185], v22 offset:4096
  v_mfma_f32_16x16x32_bf16 v[116:119], v[216:219], v[92:95], v[116:119]
  buffer_load_dwordx4 v[60:63], off, s[64:67], s51 offset:1024
  v_mfma_f32_16x16x32_bf16 v[124:127], v[220:223], v[92:95], v[124:127]
  ds_read_b64_tr_b16 v[186:187], v22 offset:4608
  ds_read_b64_tr_b16 v[188:189], v23 offset:4096
  v_mfma_f32_16x16x32_bf16 v[120:123], v[220:223], v[88:91], v[120:123]
  ds_read_b64_tr_b16 v[190:191], v23 offset:4608
  s_waitcnt vmcnt(14) lgkmcnt(8)
  v_mfma_f32_16x16x32_bf16 v[96:99], v[160:163], v[224:227], v[96:99]
  ds_read_b64_tr_b16 v[192:193], v20 offset:8192
  v_readlane_b32 s48, v15, 32
  v_mfma_f32_16x16x32_bf16 v[100:103], v[160:163], v[228:231], v[100:103]
  ds_read_b64_tr_b16 v[194:195], v20 offset:8704
  v_mfma_f32_16x16x32_bf16 v[108:111], v[164:167], v[228:231], v[108:111]
  ds_read_b64_tr_b16 v[196:197], v21 offset:8192
  v_mfma_f32_16x16x32_bf16 v[104:107], v[164:167], v[224:227], v[104:107]
  buffer_load_dwordx4 v[64:67], off, s[36:39], s48 offset:0
  v_mfma_f32_16x16x32_bf16 v[112:115], v[168:171], v[224:227], v[112:115]
  ds_read_b64_tr_b16 v[198:199], v21 offset:8704
  ds_read_b64_tr_b16 v[200:201], v22 offset:8192
  v_mfma_f32_16x16x32_bf16 v[116:119], v[168:171], v[228:231], v[116:119]
  ds_read_b64_tr_b16 v[202:203], v22 offset:8704
  v_mfma_f32_16x16x32_bf16 v[124:127], v[172:175], v[228:231], v[124:127]
  ds_read_b64_tr_b16 v[204:205], v23 offset:8192
  v_mfma_f32_16x16x32_bf16 v[120:123], v[172:175], v[224:227], v[120:123]
  ds_read_b64_tr_b16 v[206:207], v23 offset:8704
  s_waitcnt vmcnt(13) lgkmcnt(8)
  v_mfma_f32_16x16x32_bf16 v[96:99], v[176:179], v[232:235], v[96:99]
  buffer_load_dwordx4 v[68:71], off, s[64:67], s48 offset:0
  v_mfma_f32_16x16x32_bf16 v[100:103], v[176:179], v[236:239], v[100:103]
  ds_read_b64_tr_b16 v[208:209], v20 offset:12288
  ds_read_b64_tr_b16 v[210:211], v20 offset:12800
  v_mfma_f32_16x16x32_bf16 v[108:111], v[180:183], v[236:239], v[108:111]
  ds_read_b64_tr_b16 v[212:213], v21 offset:12288
  v_mfma_f32_16x16x32_bf16 v[104:107], v[180:183], v[232:235], v[104:107]
  ds_read_b64_tr_b16 v[214:215], v21 offset:12800
  v_mfma_f32_16x16x32_bf16 v[112:115], v[184:187], v[232:235], v[112:115]
  buffer_load_dwordx4 v[72:75], off, s[36:39], s48 offset:1024
  v_mfma_f32_16x16x32_bf16 v[116:119], v[184:187], v[236:239], v[116:119]
  ds_read_b64_tr_b16 v[216:217], v22 offset:12288
  ds_read_b64_tr_b16 v[218:219], v22 offset:12800
  v_mfma_f32_16x16x32_bf16 v[124:127], v[188:191], v[236:239], v[124:127]
  ds_read_b64_tr_b16 v[220:221], v23 offset:12288
  v_mfma_f32_16x16x32_bf16 v[120:123], v[188:191], v[232:235], v[120:123]
  ds_read_b64_tr_b16 v[222:223], v23 offset:12800
  s_waitcnt vmcnt(13) lgkmcnt(8)
  v_mfma_f32_16x16x32_bf16 v[96:99], v[192:195], v[240:243], v[96:99]
  buffer_load_dwordx4 v[76:79], off, s[64:67], s48 offset:1024
  v_mfma_f32_16x16x32_bf16 v[100:103], v[192:195], v[244:247], v[100:103]
  ds_read_b64_tr_b16 v[160:161], v20 offset:16384
  ds_read_b64_tr_b16 v[162:163], v20 offset:16896
  v_mfma_f32_16x16x32_bf16 v[108:111], v[196:199], v[244:247], v[108:111]
  ds_read_b64_tr_b16 v[164:165], v21 offset:16384
  v_readlane_b32 s49, v15, 33
  v_mfma_f32_16x16x32_bf16 v[104:107], v[196:199], v[240:243], v[104:107]
  ds_read_b64_tr_b16 v[166:167], v21 offset:16896
  v_mfma_f32_16x16x32_bf16 v[112:115], v[200:203], v[240:243], v[112:115]
  ds_read_b64_tr_b16 v[168:169], v22 offset:16384
  v_mfma_f32_16x16x32_bf16 v[116:119], v[200:203], v[244:247], v[116:119]
  buffer_load_dwordx4 v[80:83], off, s[36:39], s49 offset:0
  v_mfma_f32_16x16x32_bf16 v[124:127], v[204:207], v[244:247], v[124:127]
  ds_read_b64_tr_b16 v[170:171], v22 offset:16896
  ds_read_b64_tr_b16 v[172:173], v23 offset:16384
  v_mfma_f32_16x16x32_bf16 v[120:123], v[204:207], v[240:243], v[120:123]
  ds_read_b64_tr_b16 v[174:175], v23 offset:16896
  s_waitcnt vmcnt(13) lgkmcnt(8)
  v_mfma_f32_16x16x32_bf16 v[96:99], v[208:211], v[248:251], v[96:99]
  ds_read_b64_tr_b16 v[176:177], v20 offset:20480
  v_mfma_f32_16x16x32_bf16 v[100:103], v[208:211], v[252:255], v[100:103]
  buffer_load_dwordx4 v[84:87], off, s[64:67], s49 offset:0
  v_mfma_f32_16x16x32_bf16 v[108:111], v[212:215], v[252:255], v[108:111]
  ds_read_b64_tr_b16 v[178:179], v20 offset:20992
  ds_read_b64_tr_b16 v[180:181], v21 offset:20480
  v_mfma_f32_16x16x32_bf16 v[104:107], v[212:215], v[248:251], v[104:107]
  ds_read_b64_tr_b16 v[182:183], v21 offset:20992
  v_mfma_f32_16x16x32_bf16 v[112:115], v[216:219], v[248:251], v[112:115]
  ds_read_b64_tr_b16 v[184:185], v22 offset:20480
  v_mfma_f32_16x16x32_bf16 v[116:119], v[216:219], v[252:255], v[116:119]
  buffer_load_dwordx4 v[88:91], off, s[36:39], s49 offset:1024
  v_mfma_f32_16x16x32_bf16 v[124:127], v[220:223], v[252:255], v[124:127]
  ds_read_b64_tr_b16 v[186:187], v22 offset:20992
  ds_read_b64_tr_b16 v[188:189], v23 offset:20480
  v_mfma_f32_16x16x32_bf16 v[120:123], v[220:223], v[248:251], v[120:123]
  ds_read_b64_tr_b16 v[190:191], v23 offset:20992
  s_waitcnt vmcnt(13) lgkmcnt(8)
  v_mfma_f32_16x16x32_bf16 v[96:99], v[160:163], v[32:35], v[96:99]
  ds_read_b64_tr_b16 v[192:193], v20 offset:24576
  v_mfma_f32_16x16x32_bf16 v[100:103], v[160:163], v[36:39], v[100:103]
  buffer_load_dwordx4 v[92:95], off, s[64:67], s49 offset:1024
  v_mfma_f32_16x16x32_bf16 v[108:111], v[164:167], v[36:39], v[108:111]
  ds_read_b64_tr_b16 v[194:195], v20 offset:25088
  ds_read_b64_tr_b16 v[196:197], v21 offset:24576
  v_mfma_f32_16x16x32_bf16 v[104:107], v[164:167], v[32:35], v[104:107]
  ds_read_b64_tr_b16 v[198:199], v21 offset:25088
  v_readlane_b32 s50, v15, 34
  v_mfma_f32_16x16x32_bf16 v[112:115], v[168:171], v[32:35], v[112:115]
  ds_read_b64_tr_b16 v[200:201], v22 offset:24576
  v_mfma_f32_16x16x32_bf16 v[116:119], v[168:171], v[36:39], v[116:119]
  ds_read_b64_tr_b16 v[202:203], v22 offset:25088
  ds_read_b64_tr_b16 v[204:205], v23 offset:24576
  v_mfma_f32_16x16x32_bf16 v[124:127], v[172:175], v[36:39], v[124:127]
  buffer_load_dwordx4 v[224:227], off, s[36:39], s50 offset:0
  v_mfma_f32_16x16x32_bf16 v[120:123], v[172:175], v[32:35], v[120:123]
  ds_read_b64_tr_b16 v[206:207], v23 offset:25088
  s_waitcnt vmcnt(13) lgkmcnt(8)
  s_barrier
  v_mfma_f32_16x16x32_bf16 v[96:99], v[176:179], v[40:43], v[96:99]
  buffer_load_dwordx4 v[144:147], off, s[60:63], s5 offset:0 sc1
  v_mfma_f32_16x16x32_bf16 v[100:103], v[176:179], v[44:47], v[100:103]
  ds_read_b64_tr_b16 v[208:209], v20 offset:28672
  ds_read_b64_tr_b16 v[210:211], v20 offset:29184
  v_mfma_f32_16x16x32_bf16 v[108:111], v[180:183], v[44:47], v[108:111]
  ds_read_b64_tr_b16 v[212:213], v21 offset:28672
  buffer_load_dwordx4 v[228:231], off, s[64:67], s50 offset:0
  v_mfma_f32_16x16x32_bf16 v[104:107], v[180:183], v[40:43], v[104:107]
  buffer_load_dwordx4 v[148:151], off, s[60:63], s5 offset:1024 sc1
  v_mfma_f32_16x16x32_bf16 v[112:115], v[184:187], v[40:43], v[112:115]
  ds_read_b64_tr_b16 v[214:215], v21 offset:29184
  ds_read_b64_tr_b16 v[216:217], v22 offset:28672
  v_mfma_f32_16x16x32_bf16 v[116:119], v[184:187], v[44:47], v[116:119]
  ds_read_b64_tr_b16 v[218:219], v22 offset:29184
  buffer_load_dwordx4 v[152:155], off, s[60:63], s5 offset:2048 sc1
  v_mfma_f32_16x16x32_bf16 v[124:127], v[188:191], v[44:47], v[124:127]
  ds_read_b64_tr_b16 v[220:221], v23 offset:28672
  buffer_load_dwordx4 v[232:235], off, s[36:39], s50 offset:1024
  v_mfma_f32_16x16x32_bf16 v[120:123], v[188:191], v[40:43], v[120:123]
  ds_read_b64_tr_b16 v[222:223], v23 offset:29184
  s_waitcnt vmcnt(16) lgkmcnt(8)
  v_mfma_f32_16x16x32_bf16 v[96:99], v[192:195], v[48:51], v[96:99]
  buffer_load_dwordx4 v[156:159], off, s[60:63], s5 offset:3072 sc1
  v_mfma_f32_16x16x32_bf16 v[100:103], v[192:195], v[52:55], v[100:103]
  ds_read_b64_tr_b16 v[160:161], v20 offset:32768
  ds_read_b64_tr_b16 v[162:163], v20 offset:33280
  v_mfma_f32_16x16x32_bf16 v[108:111], v[196:199], v[52:55], v[108:111]
  buffer_load_dwordx4 v[236:239], off, s[64:67], s50 offset:1024
  v_mfma_f32_16x16x32_bf16 v[104:107], v[196:199], v[48:51], v[104:107]
  ds_read_b64_tr_b16 v[164:165], v21 offset:32768
  ds_read_b64_tr_b16 v[166:167], v21 offset:33280
  v_mfma_f32_16x16x32_bf16 v[112:115], v[200:203], v[48:51], v[112:115]
  ds_read_b64_tr_b16 v[168:169], v22 offset:32768
  v_readlane_b32 s51, v15, 35
  v_mfma_f32_16x16x32_bf16 v[116:119], v[200:203], v[52:55], v[116:119]
  ds_read_b64_tr_b16 v[170:171], v22 offset:33280
  v_mfma_f32_16x16x32_bf16 v[124:127], v[204:207], v[52:55], v[124:127]
  ds_read_b64_tr_b16 v[172:173], v23 offset:32768
  v_mfma_f32_16x16x32_bf16 v[120:123], v[204:207], v[48:51], v[120:123]
  ds_read_b64_tr_b16 v[174:175], v23 offset:33280
  s_waitcnt vmcnt(16) lgkmcnt(8)
  v_mfma_f32_16x16x32_bf16 v[96:99], v[208:211], v[56:59], v[96:99]
  buffer_load_dwordx4 v[240:243], off, s[36:39], s51 offset:0
  v_mfma_f32_16x16x32_bf16 v[100:103], v[208:211], v[60:63], v[100:103]
  ds_read_b64_tr_b16 v[176:177], v20 offset:36864
  ds_read_b64_tr_b16 v[178:179], v20 offset:37376
  v_mfma_f32_16x16x32_bf16 v[108:111], v[212:215], v[60:63], v[108:111]
  ds_read_b64_tr_b16 v[180:181], v21 offset:36864
  v_mfma_f32_16x16x32_bf16 v[104:107], v[212:215], v[56:59], v[104:107]
  ds_read_b64_tr_b16 v[182:183], v21 offset:37376
  v_mfma_f32_16x16x32_bf16 v[112:115], v[216:219], v[56:59], v[112:115]
  buffer_load_dwordx4 v[244:247], off, s[64:67], s51 offset:0
  v_mfma_f32_16x16x32_bf16 v[116:119], v[216:219], v[60:63], v[116:119]
  ds_read_b64_tr_b16 v[184:185], v22 offset:36864
  ds_read_b64_tr_b16 v[186:187], v22 offset:37376
  v_mfma_f32_16x16x32_bf16 v[124:127], v[220:223], v[60:63], v[124:127]
  ds_read_b64_tr_b16 v[188:189], v23 offset:36864
  v_mfma_f32_16x16x32_bf16 v[120:123], v[220:223], v[56:59], v[120:123]
  ds_read_b64_tr_b16 v[190:191], v23 offset:37376
  s_waitcnt vmcnt(16) lgkmcnt(8)
  v_mfma_f32_16x16x32_bf16 v[96:99], v[160:163], v[64:67], v[96:99]
  buffer_load_dwordx4 v[248:251], off, s[36:39], s51 offset:1024
  v_mfma_f32_16x16x32_bf16 v[100:103], v[160:163], v[68:71], v[100:103]
  ds_read_b64_tr_b16 v[192:193], v20 offset:40960
  ds_read_b64_tr_b16 v[194:195], v20 offset:41472
  v_mfma_f32_16x16x32_bf16 v[108:111], v[164:167], v[68:71], v[108:111]
  ds_read_b64_tr_b16 v[196:197], v21 offset:40960
  v_mfma_f32_16x16x32_bf16 v[104:107], v[164:167], v[64:67], v[104:107]
  ds_read_b64_tr_b16 v[198:199], v21 offset:41472
  v_mfma_f32_16x16x32_bf16 v[112:115], v[168:171], v[64:67], v[112:115]
  buffer_load_dwordx4 v[252:255], off, s[64:67], s51 offset:1024
  v_mfma_f32_16x16x32_bf16 v[116:119], v[168:171], v[68:71], v[116:119]
  ds_read_b64_tr_b16 v[200:201], v22 offset:40960
  ds_read_b64_tr_b16 v[202:203], v22 offset:41472
  v_mfma_f32_16x16x32_bf16 v[124:127], v[172:175], v[68:71], v[124:127]
  ds_read_b64_tr_b16 v[204:205], v23 offset:40960
  v_mfma_f32_16x16x32_bf16 v[120:123], v[172:175], v[64:67], v[120:123]
  ds_read_b64_tr_b16 v[206:207], v23 offset:41472
  s_waitcnt vmcnt(16) lgkmcnt(8)
  v_mfma_f32_16x16x32_bf16 v[96:99], v[176:179], v[72:75], v[96:99]
  ds_read_b64_tr_b16 v[208:209], v20 offset:45056
  v_mfma_f32_16x16x32_bf16 v[100:103], v[176:179], v[76:79], v[100:103]
  ds_read_b64_tr_b16 v[210:211], v20 offset:45568
  v_mfma_f32_16x16x32_bf16 v[108:111], v[180:183], v[76:79], v[108:111]
  ds_read_b64_tr_b16 v[212:213], v21 offset:45056
  v_mfma_f32_16x16x32_bf16 v[104:107], v[180:183], v[72:75], v[104:107]
  ds_read_b64_tr_b16 v[214:215], v21 offset:45568
  v_mfma_f32_16x16x32_bf16 v[112:115], v[184:187], v[72:75], v[112:115]
  ds_read_b64_tr_b16 v[216:217], v22 offset:45056
  v_mfma_f32_16x16x32_bf16 v[116:119], v[184:187], v[76:79], v[116:119]
  ds_read_b64_tr_b16 v[218:219], v22 offset:45568
  v_mfma_f32_16x16x32_bf16 v[124:127], v[188:191], v[76:79], v[124:127]
  ds_read_b64_tr_b16 v[220:221], v23 offset:45056
  v_mfma_f32_16x16x32_bf16 v[120:123], v[188:191], v[72:75], v[120:123]
  ds_read_b64_tr_b16 v[222:223], v23 offset:45568
  s_waitcnt vmcnt(14) lgkmcnt(8)
  v_mfma_f32_16x16x32_bf16 v[96:99], v[192:195], v[80:83], v[96:99]
  ds_read_b64_tr_b16 v[160:161], v20 offset:49152
  v_mfma_f32_16x16x32_bf16 v[100:103], v[192:195], v[84:87], v[100:103]
  ds_read_b64_tr_b16 v[162:163], v20 offset:49664
  v_mfma_f32_16x16x32_bf16 v[108:111], v[196:199], v[84:87], v[108:111]
  ds_read_b64_tr_b16 v[164:165], v21 offset:49152
  v_mfma_f32_16x16x32_bf16 v[104:107], v[196:199], v[80:83], v[104:107]
  ds_read_b64_tr_b16 v[166:167], v21 offset:49664
  v_mfma_f32_16x16x32_bf16 v[112:115], v[200:203], v[80:83], v[112:115]
  ds_read_b64_tr_b16 v[168:169], v22 offset:49152
  v_mfma_f32_16x16x32_bf16 v[116:119], v[200:203], v[84:87], v[116:119]
  ds_read_b64_tr_b16 v[170:171], v22 offset:49664
  v_mfma_f32_16x16x32_bf16 v[124:127], v[204:207], v[84:87], v[124:127]
  ds_read_b64_tr_b16 v[172:173], v23 offset:49152
  v_mfma_f32_16x16x32_bf16 v[120:123], v[204:207], v[80:83], v[120:123]
  ds_read_b64_tr_b16 v[174:175], v23 offset:49664
  s_waitcnt vmcnt(12) lgkmcnt(8)
  v_mfma_f32_16x16x32_bf16 v[96:99], v[208:211], v[88:91], v[96:99]
  ds_read_b64_tr_b16 v[176:177], v20 offset:53248
  v_mfma_f32_16x16x32_bf16 v[100:103], v[208:211], v[92:95], v[100:103]
  ds_read_b64_tr_b16 v[178:179], v20 offset:53760
  v_mfma_f32_16x16x32_bf16 v[108:111], v[212:215], v[92:95], v[108:111]
  ds_read_b64_tr_b16 v[180:181], v21 offset:53248
  v_mfma_f32_16x16x32_bf16 v[104:107], v[212:215], v[88:91], v[104:107]
  ds_read_b64_tr_b16 v[182:183], v21 offset:53760
  v_mfma_f32_16x16x32_bf16 v[112:115], v[216:219], v[88:91], v[112:115]
  ds_read_b64_tr_b16 v[184:185], v22 offset:53248
  v_mfma_f32_16x16x32_bf16 v[116:119], v[216:219], v[92:95], v[116:119]
  ds_read_b64_tr_b16 v[186:187], v22 offset:53760
  v_mfma_f32_16x16x32_bf16 v[124:127], v[220:223], v[92:95], v[124:127]
  ds_read_b64_tr_b16 v[188:189], v23 offset:53248
  v_mfma_f32_16x16x32_bf16 v[120:123], v[220:223], v[88:91], v[120:123]
  ds_read_b64_tr_b16 v[190:191], v23 offset:53760
  s_waitcnt vmcnt(9) lgkmcnt(8)
  v_mfma_f32_16x16x32_bf16 v[96:99], v[160:163], v[224:227], v[96:99]
  ds_read_b64_tr_b16 v[192:193], v20 offset:57344
  s_waitcnt vmcnt(5)
  v_mfma_f32_16x16x32_bf16 v[100:103], v[160:163], v[228:231], v[100:103]
  ds_read_b64_tr_b16 v[194:195], v20 offset:57856
  v_lshlrev_b32 v128, 16, v144
  v_mfma_f32_16x16x32_bf16 v[108:111], v[164:167], v[228:231], v[108:111]
  ds_read_b64_tr_b16 v[196:197], v21 offset:57344
  v_and_b32 v129, s11, v144
  v_mfma_f32_16x16x32_bf16 v[104:107], v[164:167], v[224:227], v[104:107]
  ds_read_b64_tr_b16 v[198:199], v21 offset:57856
  v_lshlrev_b32 v130, 16, v145
  v_mfma_f32_16x16x32_bf16 v[112:115], v[168:171], v[224:227], v[112:115]
  ds_read_b64_tr_b16 v[200:201], v22 offset:57344
  v_and_b32 v131, s11, v145
  v_mfma_f32_16x16x32_bf16 v[116:119], v[168:171], v[228:231], v[116:119]
  ds_read_b64_tr_b16 v[202:203], v22 offset:57856
  v_lshlrev_b32 v132, 16, v146
  v_mfma_f32_16x16x32_bf16 v[124:127], v[172:175], v[228:231], v[124:127]
  ds_read_b64_tr_b16 v[204:205], v23 offset:57344
  v_and_b32 v133, s11, v146
  v_mfma_f32_16x16x32_bf16 v[120:123], v[172:175], v[224:227], v[120:123]
  ds_read_b64_tr_b16 v[206:207], v23 offset:57856
  s_waitcnt vmcnt(4) lgkmcnt(8)
  v_mfma_f32_16x16x32_bf16 v[96:99], v[176:179], v[232:235], v[96:99]
  ds_read_b64_tr_b16 v[208:209], v20 offset:61440
  v_lshlrev_b32 v134, 16, v147
  v_mfma_f32_16x16x32_bf16 v[100:103], v[176:179], v[236:239], v[100:103]
  ds_read_b64_tr_b16 v[210:211], v20 offset:61952
  v_and_b32 v135, s11, v147
  v_mfma_f32_16x16x32_bf16 v[108:111], v[180:183], v[236:239], v[108:111]
  ds_read_b64_tr_b16 v[212:213], v21 offset:61440
  v_lshlrev_b32 v136, 16, v148
  v_mfma_f32_16x16x32_bf16 v[104:107], v[180:183], v[232:235], v[104:107]
  ds_read_b64_tr_b16 v[214:215], v21 offset:61952
  v_and_b32 v137, s11, v148
  v_mfma_f32_16x16x32_bf16 v[112:115], v[184:187], v[232:235], v[112:115]
  ds_read_b64_tr_b16 v[216:217], v22 offset:61440
  v_lshlrev_b32 v138, 16, v149
  v_mfma_f32_16x16x32_bf16 v[116:119], v[184:187], v[236:239], v[116:119]
  ds_read_b64_tr_b16 v[218:219], v22 offset:61952
  v_and_b32 v139, s11, v149
  v_mfma_f32_16x16x32_bf16 v[124:127], v[188:191], v[236:239], v[124:127]
  ds_read_b64_tr_b16 v[220:221], v23 offset:61440
  v_lshlrev_b32 v140, 16, v150
  v_mfma_f32_16x16x32_bf16 v[120:123], v[188:191], v[232:235], v[120:123]
  ds_read_b64_tr_b16 v[222:223], v23 offset:61952
  s_waitcnt vmcnt(2) lgkmcnt(8)
  v_mfma_f32_16x16x32_bf16 v[96:99], v[192:195], v[240:243], v[96:99]
  v_mov_b32 v20, 0
  v_mov_b32 v21, 0
  v_mfma_f32_16x16x32_bf16 v[100:103], v[192:195], v[244:247], v[100:103]
  v_mov_b32 v22, 0
  v_mov_b32 v23, 0
  v_mfma_f32_16x16x32_bf16 v[108:111], v[196:199], v[244:247], v[108:111]
  v_and_b32 v141, s11, v150
  v_lshlrev_b32 v142, 16, v151
  v_and_b32 v143, s11, v151
  v_mfma_f32_16x16x32_bf16 v[104:107], v[196:199], v[240:243], v[104:107]
  v_lshlrev_b32 v144, 16, v152
  v_and_b32 v145, s11, v152
  v_lshlrev_b32 v146, 16, v153
  v_mfma_f32_16x16x32_bf16 v[112:115], v[200:203], v[240:243], v[112:115]
  v_and_b32 v147, s11, v153
  v_lshlrev_b32 v148, 16, v154
  v_and_b32 v149, s11, v154
  v_mfma_f32_16x16x32_bf16 v[116:119], v[200:203], v[244:247], v[116:119]
  v_lshlrev_b32 v150, 16, v155
  v_and_b32 v151, s11, v155
  v_lshlrev_b32 v152, 16, v156
  v_mfma_f32_16x16x32_bf16 v[124:127], v[204:207], v[244:247], v[124:127]
  v_and_b32 v153, s11, v156
  v_lshlrev_b32 v154, 16, v157
  v_and_b32 v155, s11, v157
  v_mfma_f32_16x16x32_bf16 v[120:123], v[204:207], v[240:243], v[120:123]
  s_waitcnt vmcnt(0) lgkmcnt(0)
  v_lshlrev_b32 v156, 16, v158
  v_and_b32 v157, s11, v158
  v_mfma_f32_16x16x32_bf16 v[96:99], v[208:211], v[248:251], v[96:99]
  v_lshlrev_b32 v158, 16, v159
  v_and_b32 v159, s11, v159
  v_mfma_f32_16x16x32_bf16 v[100:103], v[208:211], v[252:255], v[100:103]
  v_mfma_f32_16x16x32_bf16 v[108:111], v[212:215], v[252:255], v[108:111]
  v_mfma_f32_16x16x32_bf16 v[104:107], v[212:215], v[248:251], v[104:107]
  v_mfma_f32_16x16x32_bf16 v[112:115], v[216:219], v[248:251], v[112:115]
  v_mfma_f32_16x16x32_bf16 v[116:119], v[216:219], v[252:255], v[116:119]
  v_mfma_f32_16x16x32_bf16 v[124:127], v[220:223], v[252:255], v[124:127]
  v_mfma_f32_16x16x32_bf16 v[120:123], v[220:223], v[248:251], v[120:123]
  s_lshl_b32 s3, s7, 4
  s_mov_b32 s10, 0x3f803f80
  s_nop 4
  v_pk_add_f32 v[96:97], v[96:97], v[128:129]
  v_pk_add_f32 v[98:99], v[98:99], v[130:131]
  v_cvt_pk_bf16_f32 v240, v96, v97
  v_cvt_pk_bf16_f32 v241, v98, v99
  v_pk_add_f32 v[104:105], v[104:105], v[136:137]
  v_pk_add_f32 v[106:107], v[106:107], v[138:139]
  v_cvt_pk_bf16_f32 v242, v104, v105
  v_cvt_pk_bf16_f32 v243, v106, v107
  s_nop 1
  v_permlane16_swap_b32 v240, v242
  v_permlane16_swap_b32 v241, v243
  buffer_store_dwordx4 v[240:243], v12, s[44:47], 0 offen offset:0 sc1
  v_pk_add_f32 v[112:113], v[112:113], v[144:145]
  v_pk_add_f32 v[114:115], v[114:115], v[146:147]
  v_cvt_pk_bf16_f32 v244, v112, v113
  v_cvt_pk_bf16_f32 v245, v114, v115
  v_pk_add_f32 v[120:121], v[120:121], v[152:153]
  v_pk_add_f32 v[122:123], v[122:123], v[154:155]
  v_cvt_pk_bf16_f32 v246, v120, v121
  v_cvt_pk_bf16_f32 v247, v122, v123
  s_nop 1
  v_permlane16_swap_b32 v244, v246
  v_permlane16_swap_b32 v245, v247
  buffer_store_dwordx4 v[244:247], v12, s[44:47], 0 offen offset:64 sc1
  v_pk_add_f32 v[100:101], v[100:101], v[132:133]
  v_pk_add_f32 v[102:103], v[102:103], v[134:135]
  v_cvt_pk_bf16_f32 v248, v100, v101
  v_cvt_pk_bf16_f32 v249, v102, v103
  v_pk_add_f32 v[108:109], v[108:109], v[140:141]
  v_pk_add_f32 v[110:111], v[110:111], v[142:143]
  v_cvt_pk_bf16_f32 v250, v108, v109
  v_cvt_pk_bf16_f32 v251, v110, v111
  s_nop 1
  v_permlane16_swap_b32 v248, v250
  v_permlane16_swap_b32 v249, v251
  buffer_store_dwordx4 v[248:251], v12, s[44:47], s3 offen offset:0 sc1
  v_pk_add_f32 v[116:117], v[116:117], v[148:149]
  v_pk_add_f32 v[118:119], v[118:119], v[150:151]
  v_cvt_pk_bf16_f32 v252, v116, v117
  v_cvt_pk_bf16_f32 v253, v118, v119
  v_pk_add_f32 v[124:125], v[124:125], v[156:157]
  v_pk_add_f32 v[126:127], v[126:127], v[158:159]
  v_cvt_pk_bf16_f32 v254, v124, v125
  v_cvt_pk_bf16_f32 v255, v126, v127
  s_nop 1
  v_permlane16_swap_b32 v252, v254
  v_permlane16_swap_b32 v253, v255
  buffer_store_dwordx4 v[252:255], v12, s[44:47], s3 offen offset:64 sc1
  v_dot2_f32_bf16 v20, v240, s10, v20
  v_dot2_f32_bf16 v22, v240, v240, v22
  v_dot2_f32_bf16 v20, v241, s10, v20
  v_dot2_f32_bf16 v22, v241, v241, v22
  v_dot2_f32_bf16 v20, v242, s10, v20
  v_dot2_f32_bf16 v22, v242, v242, v22
  v_dot2_f32_bf16 v20, v243, s10, v20
  v_dot2_f32_bf16 v22, v243, v243, v22
  v_dot2_f32_bf16 v20, v244, s10, v20
  v_dot2_f32_bf16 v22, v244, v244, v22
  v_dot2_f32_bf16 v20, v245, s10, v20
  v_dot2_f32_bf16 v22, v245, v245, v22
  v_dot2_f32_bf16 v20, v246, s10, v20
  v_dot2_f32_bf16 v22, v246, v246, v22
  v_dot2_f32_bf16 v20, v247, s10, v20
  v_dot2_f32_bf16 v22, v247, v247, v22
  v_dot2_f32_bf16 v21, v248, s10, v21
  v_dot2_f32_bf16 v23, v248, v248, v23
  v_dot2_f32_bf16 v21, v249, s10, v21
  v_dot2_f32_bf16 v23, v249, v249, v23
  v_dot2_f32_bf16 v21, v250, s10, v21
  v_dot2_f32_bf16 v23, v250, v250, v23
  v_dot2_f32_bf16 v21, v251, s10, v21
  v_dot2_f32_bf16 v23, v251, v251, v23
  v_dot2_f32_bf16 v21, v252, s10, v21
  v_dot2_f32_bf16 v23, v252, v252, v23
  v_dot2_f32_bf16 v21, v253, s10, v21
  v_dot2_f32_bf16 v23, v253, v253, v23
  v_dot2_f32_bf16 v21, v254, s10, v21
  v_dot2_f32_bf16 v23, v254, v254, v23
  v_dot2_f32_bf16 v21, v255, s10, v21
  v_dot2_f32_bf16 v23, v255, v255, v23
  s_nop 2
  v_permlane32_swap_b32 v20, v21
  v_permlane32_swap_b32 v22, v23
  v_add_f32 v20, v20, v21
  v_add_f32 v22, v22, v23
  s_nop 1
  v_permlane16_swap_b32 v20, v22
  v_add_f32 v20, v20, v22
  buffer_store_dword v20, v18, s[56:59], 0 offen sc1
  s_cmp_eq_u32 s96, 1
  s_cbranch_scc1 L_w2_end
  s_waitcnt vmcnt(0) lgkmcnt(0)
  s_barrier
  s_mov_b32 s96, 1
  s_add_u32 s12, s22, 33554432
  s_addc_u32 s13, s23, 0
  s_add_u32 s34, s22, 67108864
  s_addc_u32 s35, s23, 0
  s_add_u32 s97, s97, 1
  s_branch L_attn_body
L_w2_c1:
```

```asm
; @launch grid=(256,1,1) block=(512,1,1) lds=163840
.amdgcn_target "amdgcn-amd-amdhsa--gfx950"
L_attn_c0:
.text
.globl interleave_layers__sliding_local_dilated__dense_activation_gelu__prompt_kernel
.p2align 8
.type interleave_layers__sliding_local_dilated__dense_activation_gelu__prompt_kernel,@function
interleave_layers__sliding_local_dilated__dense_activation_gelu__prompt_kernel:
  s_load_dwordx4 s[16:19], s[0:1], 0
  s_load_dwordx2 s[20:21], s[0:1], 16
  s_load_dwordx2 s[22:23], s[0:1], 80
  s_load_dwordx8 s[24:31], s[0:1], 32
  s_load_dwordx2 s[32:33], s[0:1], 64
  s_load_dwordx2 s[34:35], s[0:1], 80
  s_load_dwordx2 s[12:13], s[0:1], 0
  s_mov_b32 s96, 0
  s_mov_b32 s97, 0
L_attn_body:
  s_cmp_ge_u32 s2, 256
  s_cbranch_scc1 L_attn_end
  v_lshrrev_b32 v2, 6, v0
  v_and_b32 v1, 63, v0
  v_readfirstlane_b32 s70, v2
  s_and_b32 s3, s2, 7
  s_lshr_b32 s99, s2, 3
  s_and_b32 s5, s3, 1
  s_lshl_b32 s5, s5, 3
  s_and_b32 s6, s99, 7
  s_add_u32 s68, s5, s6
  s_lshr_b32 s5, s3, 1
  s_lshl_b32 s5, s5, 2
  s_lshr_b32 s6, s99, 3
  s_add_u32 s69, s5, s6
  s_cmp_eq_u32 s96, 0
  s_cbranch_scc1 L_attn_map
  s_and_b32 s3, s2, 7
  s_and_b32 s5, s3, 3
  s_lshl_b32 s5, s5, 2
  s_and_b32 s6, s99, 3
  s_add_u32 s68, s5, s6
  s_lshr_b32 s5, s3, 2
  s_lshl_b32 s5, s5, 3
  s_lshr_b32 s6, s99, 2
  s_add_u32 s69, s5, s6
L_attn_map:
  s_cmp_lt_u32 s70, 4
  s_cbranch_scc1 L_attn_compute
L_attn_loader:
  s_add_u32 s8, s70, s69
  s_and_b32 s8, s8, 3
  s_add_u32 s9, s70, s68
  s_and_b32 s9, s9, 3
  s_lshl_b32 s76, s8, 12
  s_lshl_b32 s77, s9, 11
  s_add_u32 s77, s77, 16384
  s_lshl_b32 s11, s68, 7
  v_and_b32 v10, 7, v1
  v_lshrrev_b32 v3, 3, v1
  s_lshr_b32 s10, s76, 7
  s_lshl_b32 s3, s68, 7
  s_add_u32 s10, s10, s3
  v_add_u32 v3, s10, v3
  s_cmp_eq_u32 s96, 1
  s_cselect_b32 s5, 128, 0
  s_add_u32 s5, s5, 2048
  s_lshl_b32 s6, s5, 3
  v_mul_u32_u24 v3, s5, v3
  v_lshrrev_b32 v2, 4, v1
  v_xor_b32 v4, v2, v10
  v_lshl_add_u32 v4, v4, 4, v3
  v_add_u32 v3, s6, v3
  v_add_u32 v5, 4, v2
  v_xor_b32 v5, v5, v10
  v_lshl_add_u32 v5, v5, 4, v3
  v_add_u32 v3, s6, v3
  v_xor_b32 v6, v2, v10
  v_lshl_add_u32 v6, v6, 4, v3
  v_add_u32 v3, s6, v3
  v_add_u32 v7, 4, v2
  v_xor_b32 v7, v7, v10
  v_lshl_add_u32 v7, v7, 4, v3
  v_lshrrev_b32 v3, 3, v1
  s_lshl_b32 s10, s9, 4
  v_add_u32 v3, s10, v3
  v_mul_u32_u24 v3, 6144, v3
  v_lshrrev_b32 v2, 3, v1
  v_and_b32 v2, 2, v2
  v_xor_b32 v2, v2, v10
  s_mul_i32 s10, s69, 128
  v_add_u32 v3, s10, v3
  v_lshl_add_u32 v8, v2, 4, v3
  v_xor_b32 v2, 4, v2
  v_add_u32 v3, 49152, v3
  v_lshl_add_u32 v9, v2, 4, v3
  s_and_b32 s10, s70, 3
  s_lshl_b32 s78, s10, 9
  s_add_u32 s78, s78, 40960
  s_lshl_b32 s14, s10, 2
  s_add_u32 s14, s14, s11
  s_sub_u32 s14, s14, 16
  v_lshrrev_b32 v3, 3, v1
  v_add_u32 v3, s14, v3
  v_max_i32 v3, 0, v3
  v_mul_u32_u24 v3, s5, v3
  s_lshl_b32 s14, s10, 1
  v_lshrrev_b32 v2, 4, v1
  v_add_u32 v2, s14, v2
  v_and_b32 v2, 7, v2
  v_xor_b32 v2, v2, v10
  v_lshl_add_u32 v28, v2, 4, v3
  s_cmp_eq_u32 s10, 0
  s_cselect_b32 s14, 0xffffff00, -1
  s_mov_b32 s15, 0
  s_mov_b32 s75, 0
  s_add_u32 s100, s68, s69
  s_mov_b32 s101, -1
  s_add_u32 s3, s68, s69
  s_and_b32 s3, s3, 3
  s_mov_b32 s100, 0x75463102
  s_mov_b32 s101, 0xfdceb98a
  s_cmp_eq_u32 s3, 1
  s_cselect_b32 s100, 0x65742130, s100
  s_cselect_b32 s101, 0xedfca9b8, s101
  s_cmp_eq_u32 s3, 2
  s_cselect_b32 s100, 0x68532410, s100
  s_cselect_b32 s101, 0xfedbac97, s101
  s_cmp_eq_u32 s3, 3
  s_cselect_b32 s100, 0x96435210, s100
  s_cselect_b32 s101, 0xfecbda87, s101
  s_and_b32 s73, s100, 15
  s_lshr_b64 s[100:101], s[100:101], 4
  s_mul_i32 s74, s73, 393216
  s_lshl_b32 s73, s73, 7
  s_waitcnt lgkmcnt(0)
  s_mov_b32 s36, s12
  s_and_b32 s37, s13, 0xffff
  s_mov_b32 s38, 4194304
  s_mov_b32 s39, 0x00020000
  s_cmp_eq_u32 s96, 1
  s_cselect_b32 s38, 128, 0
  s_add_u32 s38, s38, 2048
  s_lshl_b32 s38, s38, 11
  s_mov_b32 s40, s18
  s_and_b32 s41, s19, 0xffff
  s_mov_b32 s42, 6291456
  s_mov_b32 s43, 0x00020000
  s_cmp_lg_u32 s96, 0
  s_cbranch_scc1 L_attn_ld1
  s_mov_b32 s48, s28
  s_and_b32 s49, s29, 0xffff
  s_mov_b32 s50, 7340032
  s_mov_b32 s51, 0x00020000
  s_cmp_eq_u32 s96, 0
  s_cselect_b32 s50, s50, 0
  s_and_b32 s3, s70, 3
  s_lshl_b32 s4, s2, 2
  s_add_u32 s3, s3, s4
  s_mul_i32 s98, s3, 3584
  s_add_u32 s98, s98, 0
  s_add_u32 s3, s75, s76
  s_add_u32 m0, s3, 0
  s_nop 0
  buffer_load_dwordx4 v4, s[36:39], s73 offen lds
  s_add_u32 m0, s3, 1024
  s_nop 0
  buffer_load_dwordx4 v5, s[36:39], s73 offen lds
  s_add_u32 m0, s3, 2048
  s_nop 0
  buffer_load_dwordx4 v6, s[36:39], s73 offen lds
  s_add_u32 m0, s3, 3072
  s_nop 0
  buffer_load_dwordx4 v7, s[36:39], s73 offen lds
  s_add_u32 m0, s78, s75
  s_mov_b64 exec, s[14:15]
  buffer_load_dwordx4 v28, s[36:39], s73 offen lds
  s_mov_b64 exec, -1
  s_add_u32 s3, s75, s77
  s_add_u32 m0, s3, 0
  s_add_u32 s4, s74, 0
  buffer_load_dwordx4 v8, s[40:43], s4 offen lds
  s_add_u32 m0, s3, 1024
  s_nop 0
  buffer_load_dwordx4 v9, s[40:43], s4 offen lds
  s_add_u32 m0, s3, 8192
  s_add_u32 s4, s74, 2048
  buffer_load_dwordx4 v8, s[40:43], s4 offen lds
  s_add_u32 m0, s3, 9216
  s_nop 0
  buffer_load_dwordx4 v9, s[40:43], s4 offen lds
  s_add_u32 m0, s3, 16384
  s_add_u32 s4, s74, 4096
  buffer_load_dwordx4 v8, s[40:43], s4 offen lds
  s_add_u32 m0, s3, 17408
  s_nop 0
  buffer_load_dwordx4 v9, s[40:43], s4 offen lds
  s_and_b32 s73, s100, 15
  s_lshr_b64 s[100:101], s[100:101], 4
  s_mul_i32 s74, s73, 393216
  s_lshl_b32 s73, s73, 7
  s_add_u32 s75, s75, 43008
  s_cmp_eq_u32 s75, 129024
  s_cselect_b32 s75, 0, s75
  s_add_u32 s3, s75, s76
  s_add_u32 m0, s3, 0
  s_nop 0
  buffer_load_dwordx4 v4, s[36:39], s73 offen lds
  s_add_u32 m0, s3, 1024
  s_nop 0
  buffer_load_dwordx4 v5, s[36:39], s73 offen lds
  s_add_u32 m0, s3, 2048
  s_nop 0
  buffer_load_dwordx4 v6, s[36:39], s73 offen lds
  s_add_u32 m0, s3, 3072
  s_nop 0
  buffer_load_dwordx4 v7, s[36:39], s73 offen lds
  s_add_u32 m0, s78, s75
  s_mov_b64 exec, s[14:15]
  buffer_load_dwordx4 v28, s[36:39], s73 offen lds
  s_mov_b64 exec, -1
  s_add_u32 s3, s75, s77
  s_add_u32 m0, s3, 0
  s_add_u32 s4, s74, 0
  buffer_load_dwordx4 v8, s[40:43], s4 offen lds
  s_add_u32 m0, s3, 1024
  s_nop 0
  buffer_load_dwordx4 v9, s[40:43], s4 offen lds
  s_add_u32 m0, s3, 8192
  s_add_u32 s4, s74, 2048
  buffer_load_dwordx4 v8, s[40:43], s4 offen lds
  s_add_u32 m0, s3, 9216
  s_nop 0
  buffer_load_dwordx4 v9, s[40:43], s4 offen lds
  s_add_u32 m0, s3, 16384
  s_add_u32 s4, s74, 4096
  buffer_load_dwordx4 v8, s[40:43], s4 offen lds
  s_add_u32 m0, s3, 17408
  s_nop 0
  buffer_load_dwordx4 v9, s[40:43], s4 offen lds
  s_and_b32 s73, s100, 15
  s_lshr_b64 s[100:101], s[100:101], 4
  s_mul_i32 s74, s73, 393216
  s_lshl_b32 s73, s73, 7
  s_add_u32 s75, s75, 43008
  s_cmp_eq_u32 s75, 129024
  s_cselect_b32 s75, 0, s75
  s_and_b32 s3, s70, 3
  s_lshl_b32 s4, s2, 2
  s_add_u32 s3, s3, s4
  s_sub_u32 s4, 384, s40
  s_and_b32 s4, s4, 0x380
  s_mul_i32 s5, s3, 6144
  s_add_u32 s5, s5, s4
  s_buffer_load_dword s84, s[40:43], s5 offset:0
  s_buffer_load_dword s84, s[40:43], s5 offset:64
  s_buffer_load_dword s84, s[40:43], s5 offset:1024
  s_buffer_load_dword s84, s[40:43], s5 offset:1088
  s_buffer_load_dword s84, s[40:43], s5 offset:2048
  s_buffer_load_dword s84, s[40:43], s5 offset:2112
  s_buffer_load_dword s84, s[40:43], s5 offset:3072
  s_buffer_load_dword s84, s[40:43], s5 offset:3136
  s_buffer_load_dword s84, s[40:43], s5 offset:4096
  s_buffer_load_dword s84, s[40:43], s5 offset:4160
  s_buffer_load_dword s84, s[40:43], s5 offset:5120
  s_buffer_load_dword s84, s[40:43], s5 offset:5184
  s_waitcnt vmcnt(11)
  s_barrier
  s_mov_b32 s79, 13
L_attn0_ld1:
  s_add_u32 s3, s75, s76
  s_add_u32 m0, s3, 0
  s_nop 0
  buffer_load_dwordx4 v4, s[36:39], s73 offen lds
  s_add_u32 m0, s3, 1024
  s_nop 0
  buffer_load_dwordx4 v5, s[36:39], s73 offen lds
  s_add_u32 m0, s3, 2048
  s_nop 0
  buffer_load_dwordx4 v6, s[36:39], s73 offen lds
  s_add_u32 m0, s3, 3072
  s_nop 0
  buffer_load_dwordx4 v7, s[36:39], s73 offen lds
  s_add_u32 m0, s78, s75
  s_mov_b64 exec, s[14:15]
  buffer_load_dwordx4 v28, s[36:39], s73 offen lds
  s_mov_b64 exec, -1
  s_add_u32 s3, s75, s77
  s_add_u32 m0, s3, 0
  s_add_u32 s4, s74, 0
  buffer_load_dwordx4 v8, s[40:43], s4 offen lds
  s_add_u32 m0, s3, 1024
  s_nop 0
  buffer_load_dwordx4 v9, s[40:43], s4 offen lds
  s_add_u32 m0, s3, 8192
  s_add_u32 s4, s74, 2048
  buffer_load_dwordx4 v8, s[40:43], s4 offen lds
  s_add_u32 m0, s3, 9216
  s_nop 0
  buffer_load_dwordx4 v9, s[40:43], s4 offen lds
  s_add_u32 m0, s3, 16384
  s_add_u32 s4, s74, 4096
  buffer_load_dwordx4 v8, s[40:43], s4 offen lds
  s_add_u32 m0, s3, 17408
  s_nop 0
  buffer_load_dwordx4 v9, s[40:43], s4 offen lds
  s_and_b32 s73, s100, 15
  s_lshr_b64 s[100:101], s[100:101], 4
  s_mul_i32 s74, s73, 393216
  s_lshl_b32 s73, s73, 7
  s_add_u32 s75, s75, 43008
  s_cmp_eq_u32 s75, 129024
  s_cselect_b32 s75, 0, s75
  s_buffer_load_dword s84, s[48:51], s98 offset:0
  s_buffer_load_dword s84, s[48:51], s98 offset:64
  s_buffer_load_dword s84, s[48:51], s98 offset:128
  s_buffer_load_dword s84, s[48:51], s98 offset:192
  s_add_u32 s98, s98, 256
  s_waitcnt vmcnt(11)
  s_barrier
  s_sub_u32 s79, s79, 1
  s_cmp_lg_u32 s79, 0
  s_cbranch_scc1 L_attn0_ld1
  s_add_u32 s3, s75, s76
  s_add_u32 m0, s3, 0
  s_nop 0
  buffer_load_dwordx4 v4, s[36:39], s73 offen lds
  s_add_u32 m0, s3, 1024
  s_nop 0
  buffer_load_dwordx4 v5, s[36:39], s73 offen lds
  s_add_u32 m0, s3, 2048
  s_nop 0
  buffer_load_dwordx4 v6, s[36:39], s73 offen lds
  s_add_u32 m0, s3, 3072
  s_nop 0
  buffer_load_dwordx4 v7, s[36:39], s73 offen lds
  s_add_u32 m0, s78, s75
  s_mov_b64 exec, s[14:15]
  buffer_load_dwordx4 v28, s[36:39], s73 offen lds
  s_mov_b64 exec, -1
  s_add_u32 s3, s75, s77
  s_add_u32 m0, s3, 0
  s_add_u32 s4, s74, 0
  buffer_load_dwordx4 v8, s[40:43], s4 offen lds
  s_add_u32 m0, s3, 1024
  s_nop 0
  buffer_load_dwordx4 v9, s[40:43], s4 offen lds
  s_add_u32 m0, s3, 8192
  s_add_u32 s4, s74, 2048
  buffer_load_dwordx4 v8, s[40:43], s4 offen lds
  s_add_u32 m0, s3, 9216
  s_nop 0
  buffer_load_dwordx4 v9, s[40:43], s4 offen lds
  s_add_u32 m0, s3, 16384
  s_add_u32 s4, s74, 4096
  buffer_load_dwordx4 v8, s[40:43], s4 offen lds
  s_add_u32 m0, s3, 17408
  s_nop 0
  buffer_load_dwordx4 v9, s[40:43], s4 offen lds
  s_and_b32 s73, s100, 15
  s_lshr_b64 s[100:101], s[100:101], 4
  s_mul_i32 s74, s73, 393216
  s_lshl_b32 s73, s73, 7
  s_add_u32 s75, s75, 43008
  s_cmp_eq_u32 s75, 129024
  s_cselect_b32 s75, 0, s75
  s_buffer_load_dword s84, s[48:51], s98 offset:0
  s_buffer_load_dword s84, s[48:51], s98 offset:64
  s_buffer_load_dword s84, s[48:51], s98 offset:128
  s_buffer_load_dword s84, s[48:51], s98 offset:192
  s_add_u32 s98, s98, 256
  s_mov_b32 s64, s24
  s_and_b32 s65, s25, 0xffff
  s_mov_b32 s66, 7340032
  s_mov_b32 s67, 0x00020000
  s_min_u32 s3, s2, 223
  s_mul_i32 s4, s3, 4682
  s_lshr_b32 s4, s4, 16
  s_mul_i32 s5, s4, 14
  s_sub_u32 s3, s3, s5
  s_lshl_b32 s3, s3, 2
  s_and_b32 s5, s70, 3
  s_add_u32 s3, s3, s5
  s_mul_i32 s5, s4, 458752
  s_lshl_b32 s8, s3, 7
  s_add_u32 s5, s5, s8
  s_lshl_b32 s9, s4, 14
  s_lshl_b32 s8, s3, 8
  s_add_u32 s94, s9, s8
  v_lshrrev_b32 v2, 3, v1
  v_mul_u32_u24 v2, 7168, v2
  v_and_b32 v3, 7, v1
  v_lshl_add_u32 v2, v3, 4, v2
  buffer_load_dwordx4 v[64:67], v2, s[64:67], s5 offen
  s_add_u32 s5, s5, 57344
  buffer_load_dwordx4 v[68:71], v2, s[64:67], s5 offen
  s_add_u32 s5, s5, 57344
  buffer_load_dwordx4 v[72:75], v2, s[64:67], s5 offen
  s_add_u32 s5, s5, 57344
  buffer_load_dwordx4 v[76:79], v2, s[64:67], s5 offen
  s_add_u32 s5, s5, 57344
  buffer_load_dwordx4 v[80:83], v2, s[64:67], s5 offen
  s_add_u32 s5, s5, 57344
  buffer_load_dwordx4 v[84:87], v2, s[64:67], s5 offen
  s_add_u32 s5, s5, 57344
  buffer_load_dwordx4 v[88:91], v2, s[64:67], s5 offen
  s_add_u32 s5, s5, 57344
  buffer_load_dwordx4 v[92:95], v2, s[64:67], s5 offen
  s_mov_b32 s60, s20
  s_and_b32 s61, s21, 0xffff
  s_mov_b32 s62, 2097152
  s_mov_b32 s63, 0x00020000
  s_and_b32 s3, s70, 3
  s_mul_i32 s3, s3, 8
  s_mul_i32 s4, s99, 32
  s_add_u32 s3, s3, s4
  v_lshrrev_b32 v2, 3, v1
  v_add_u32 v2, s3, v2
  v_mul_u32_u24 v2, 2048, v2
  v_and_b32 v3, 7, v1
  v_lshl_add_u32 v2, v3, 8, v2
  s_and_b32 s3, s2, 7
  s_lshr_b32 s3, s3, 2
  s_mul_i32 s3, s3, 128
  buffer_load_dword v96, v2, s[60:63], s3 offen
  s_waitcnt vmcnt(20)
  s_barrier
  s_waitcnt vmcnt(9)
  s_barrier
  s_barrier
  s_barrier
  s_barrier
  s_branch L_attn_ldend
L_attn_ld1:
  s_add_u32 s3, s68, s69
  s_and_b32 s3, s3, 3
  s_mov_b32 s100, 0x68532410
  s_mov_b32 s101, 0xfedbac97
  s_cmp_eq_u32 s3, 1
  s_cselect_b32 s100, 0x96435210, s100
  s_cselect_b32 s101, 0xfecbda87, s101
  s_cmp_eq_u32 s3, 2
  s_cselect_b32 s100, 0x75463210, s100
  s_cselect_b32 s101, 0xfdceb98a, s101
  s_cmp_eq_u32 s3, 3
  s_cselect_b32 s100, 0x65743210, s100
  s_cselect_b32 s101, 0xedfca9b8, s101
  s_add_u32 s56, s22, 24379392
  s_addc_u32 s57, s23, 0
  s_and_b32 s57, s57, 0xffff
  s_mov_b32 s58, 262144
  s_mov_b32 s59, 0x00020000
  s_and_b32 s3, s70, 3
  s_lshl2_add_u32 s4, s68, s3
  s_lshl_b32 s4, s4, 8
  v_lshrrev_b32 v2, 4, v1
  v_and_b32 v3, 15, v1
  v_lshl_add_u32 v3, v3, 4, s4
  v_lshl_add_u32 v18, v2, 14, v3
  s_lshl_b32 s4, s68, 5
  s_add_u32 s4, s4, s3
  s_sub_u32 s4, s4, 4
  s_max_i32 s4, s4, 0
  s_lshl_b32 s4, s4, 5
  v_lshrrev_b32 v2, 2, v1
  v_and_b32 v3, 3, v1
  v_lshl_add_u32 v3, v3, 3, s4
  v_lshl_add_u32 v19, v2, 14, v3
  s_lshr_b32 s3, s69, 3
  s_and_b32 s73, s69, 7
  s_lshl1_add_u32 s91, s73, s3
  s_mul_i32 s74, s91, 393216
  s_lshl_b32 s73, s91, 7
  s_mov_b32 s88, s73
  s_add_u32 m0, s77, 0
  s_add_u32 s4, s74, 0
  buffer_load_dwordx4 v8, s[40:43], s4 offen lds
  s_add_u32 m0, s77, 1024
  s_nop 0
  buffer_load_dwordx4 v9, s[40:43], s4 offen lds
  s_add_u32 m0, s77, 8192
  s_add_u32 s4, s74, 2048
  buffer_load_dwordx4 v8, s[40:43], s4 offen lds
  s_add_u32 m0, s77, 9216
  s_nop 0
  buffer_load_dwordx4 v9, s[40:43], s4 offen lds
  s_add_u32 m0, s77, 16384
  s_add_u32 s4, s74, 4096
  buffer_load_dwordx4 v8, s[40:43], s4 offen lds
  s_add_u32 m0, s77, 17408
  s_nop 0
  buffer_load_dwordx4 v9, s[40:43], s4 offen lds
  s_and_b32 s73, s100, 15
  s_cmp_eq_u32 s73, s91
  s_cselect_b32 s74, 4, 0
  s_lshr_b64 s[100:101], s[100:101], s74
  s_and_b32 s73, s100, 15
  s_lshr_b64 s[100:101], s[100:101], 4
  s_mul_i32 s74, s73, 393216
  s_lshl_b32 s73, s73, 7
  s_mov_b32 s75, 0
  s_add_u32 s44, s22, 41943040
  s_addc_u32 s45, s23, 0
  s_and_b32 s45, s45, 0xffff
  s_mov_b32 s46, 524288
  s_mov_b32 s47, 0x00020000
  s_lshl4_add_u32 s3, s97, s68
  s_and_b32 s4, s69, 15
  s_lshl4_add_u32 s3, s3, s4
  s_lshl_b32 s3, s3, 7
  s_sub_u32 s3, s3, 32768
  v_lshlrev_b32 v11, 7, v1
  s_cmp_eq_u32 s68, 0
  s_cselect_b32 s4, 15, 31
  v_and_b32 v2, 16, v1
  v_lshl_add_u32 v11, v2, 2, v11
  v_and_b32 v2, s4, v1
  v_lshlrev_b32 v2, 2, v2
  v_mov_b32 v3, 1
  s_mov_b32 s79, 0x100000
  s_waitcnt vmcnt(0)
  s_cmp_lg_u32 s70, 4
  s_barrier
  s_cbranch_scc1 L_attn_nofl
  s_mov_b32 exec_lo, 0xffffffff
  s_mov_b32 exec_hi, 0
  buffer_store_dword v3, v11, s[44:47], s87 offen sc1
  s_mov_b64 exec, -1
L_attn_nofl:
  s_mov_b32 s5, s3
  s_mov_b32 s89, s73
  s_add_u32 m0, s77, 43008
  s_add_u32 s4, s74, 0
  buffer_load_dwordx4 v8, s[40:43], s4 offen lds
  s_add_u32 m0, s77, 44032
  s_nop 0
  buffer_load_dwordx4 v9, s[40:43], s4 offen lds
  s_add_u32 m0, s77, 51200
  s_add_u32 s4, s74, 2048
  buffer_load_dwordx4 v8, s[40:43], s4 offen lds
  s_add_u32 m0, s77, 52224
  s_nop 0
  buffer_load_dwordx4 v9, s[40:43], s4 offen lds
  s_add_u32 m0, s77, 59392
  s_add_u32 s4, s74, 4096
  buffer_load_dwordx4 v8, s[40:43], s4 offen lds
  s_add_u32 m0, s77, 60416
  s_nop 0
  buffer_load_dwordx4 v9, s[40:43], s4 offen lds
  s_and_b32 s73, s100, 15
  s_cmp_eq_u32 s73, s91
  s_cselect_b32 s74, 4, 0
  s_lshr_b64 s[100:101], s[100:101], s74
  s_and_b32 s73, s100, 15
  s_lshr_b64 s[100:101], s[100:101], 4
  s_mul_i32 s74, s73, 393216
  s_lshl_b32 s73, s73, 7
  s_mov_b32 s90, s73
  s_add_u32 m0, s77, 86016
  s_add_u32 s4, s74, 0
  buffer_load_dwordx4 v8, s[40:43], s4 offen lds
  s_add_u32 m0, s77, 87040
  s_nop 0
  buffer_load_dwordx4 v9, s[40:43], s4 offen lds
  s_add_u32 m0, s77, 94208
  s_add_u32 s4, s74, 2048
  buffer_load_dwordx4 v8, s[40:43], s4 offen lds
  s_add_u32 m0, s77, 95232
  s_nop 0
  buffer_load_dwordx4 v9, s[40:43], s4 offen lds
  s_add_u32 m0, s77, 102400
  s_add_u32 s4, s74, 4096
  buffer_load_dwordx4 v8, s[40:43], s4 offen lds
  s_add_u32 m0, s77, 103424
  s_nop 0
  buffer_load_dwordx4 v9, s[40:43], s4 offen lds
  s_and_b32 s73, s100, 15
  s_cmp_eq_u32 s73, s91
  s_cselect_b32 s74, 4, 0
  s_lshr_b64 s[100:101], s[100:101], s74
  s_and_b32 s73, s100, 15
  s_lshr_b64 s[100:101], s[100:101], 4
  s_mul_i32 s74, s73, 393216
  s_lshl_b32 s73, s73, 7
  s_mov_b32 s3, s5
  s_cmp_lg_u32 s70, 4
  s_cbranch_scc1 L_attn_dep
L_attn_poll:
  buffer_load_dword v3, v2, s[44:47], s3 offen sc1
  s_sub_u32 s79, s79, 1
  s_cbranch_scc1 L_attn_dep
  s_waitcnt vmcnt(0)
  v_cmp_ne_u32 vcc, 1, v3
  s_cbranch_vccnz L_attn_poll
L_attn_dep:
  s_barrier
  s_add_u32 m0, s78, 89344
  s_mov_b64 exec, s[14:15]
  buffer_load_dwordx4 v28, s[36:39], s88 offen lds
  s_mov_b64 exec, -1
  s_add_u32 m0, s76, 43008
  s_nop 0
  buffer_load_dwordx4 v4, s[36:39], s89 offen lds
  s_add_u32 m0, s76, 44032
  s_nop 0
  buffer_load_dwordx4 v5, s[36:39], s89 offen lds
  s_add_u32 m0, s76, 45056
  s_nop 0
  buffer_load_dwordx4 v6, s[36:39], s89 offen lds
  s_add_u32 m0, s76, 46080
  s_nop 0
  buffer_load_dwordx4 v7, s[36:39], s89 offen lds
  s_add_u32 m0, s78, 43008
  s_mov_b64 exec, s[14:15]
  buffer_load_dwordx4 v28, s[36:39], s89 offen lds
  s_mov_b64 exec, -1
  s_add_u32 m0, s76, 86016
  s_nop 0
  buffer_load_dwordx4 v4, s[36:39], s90 offen lds
  s_add_u32 m0, s76, 87040
  s_nop 0
  buffer_load_dwordx4 v5, s[36:39], s90 offen lds
  s_add_u32 m0, s76, 88064
  s_nop 0
  buffer_load_dwordx4 v6, s[36:39], s90 offen lds
  s_add_u32 m0, s76, 89088
  s_nop 0
  buffer_load_dwordx4 v7, s[36:39], s90 offen lds
  s_add_u32 m0, s78, 86016
  s_mov_b64 exec, s[14:15]
  buffer_load_dwordx4 v28, s[36:39], s90 offen lds
  s_mov_b64 exec, -1
  s_waitcnt vmcnt(5)
  s_barrier
  s_mov_b32 s79, 12
L_attn1_ld1:
  s_add_u32 s3, s75, s76
  s_add_u32 m0, s3, 0
  s_nop 0
  buffer_load_dwordx4 v4, s[36:39], s73 offen lds
  s_add_u32 m0, s3, 1024
  s_nop 0
  buffer_load_dwordx4 v5, s[36:39], s73 offen lds
  s_add_u32 m0, s3, 2048
  s_nop 0
  buffer_load_dwordx4 v6, s[36:39], s73 offen lds
  s_add_u32 m0, s3, 3072
  s_nop 0
  buffer_load_dwordx4 v7, s[36:39], s73 offen lds
  s_add_u32 m0, s78, s75
  s_mov_b64 exec, s[14:15]
  buffer_load_dwordx4 v28, s[36:39], s73 offen lds
  s_mov_b64 exec, -1
  s_add_u32 s3, s75, s77
  s_add_u32 m0, s3, 0
  s_add_u32 s4, s74, 0
  buffer_load_dwordx4 v8, s[40:43], s4 offen lds
  s_add_u32 m0, s3, 1024
  s_nop 0
  buffer_load_dwordx4 v9, s[40:43], s4 offen lds
  s_add_u32 m0, s3, 8192
  s_add_u32 s4, s74, 2048
  buffer_load_dwordx4 v8, s[40:43], s4 offen lds
  s_add_u32 m0, s3, 9216
  s_nop 0
  buffer_load_dwordx4 v9, s[40:43], s4 offen lds
  s_add_u32 m0, s3, 16384
  s_add_u32 s4, s74, 4096
  buffer_load_dwordx4 v8, s[40:43], s4 offen lds
  s_add_u32 m0, s3, 17408
  s_nop 0
  buffer_load_dwordx4 v9, s[40:43], s4 offen lds
  s_and_b32 s73, s100, 15
  s_cmp_eq_u32 s73, s91
  s_cselect_b32 s74, 4, 0
  s_lshr_b64 s[100:101], s[100:101], s74
  s_and_b32 s73, s100, 15
  s_lshr_b64 s[100:101], s[100:101], 4
  s_mul_i32 s74, s73, 393216
  s_lshl_b32 s73, s73, 7
  s_add_u32 s75, s75, 43008
  s_cmp_eq_u32 s75, 129024
  s_cselect_b32 s75, 0, s75
  s_waitcnt vmcnt(11)
  s_barrier
  s_sub_u32 s79, s79, 1
  s_cmp_lg_u32 s79, 0
  s_cbranch_scc1 L_attn1_ld1
  s_add_u32 s3, s75, s76
  s_add_u32 m0, s3, 0
  s_nop 0
  buffer_load_dwordx4 v4, s[36:39], s73 offen lds
  s_add_u32 m0, s3, 1024
  s_nop 0
  buffer_load_dwordx4 v5, s[36:39], s73 offen lds
  s_add_u32 m0, s3, 2048
  s_nop 0
  buffer_load_dwordx4 v6, s[36:39], s73 offen lds
  s_add_u32 m0, s3, 3072
  s_nop 0
  buffer_load_dwordx4 v7, s[36:39], s73 offen lds
  s_add_u32 m0, s78, s75
  s_mov_b64 exec, s[14:15]
  buffer_load_dwordx4 v28, s[36:39], s73 offen lds
  s_mov_b64 exec, -1
  s_add_u32 s3, s75, s77
  s_add_u32 m0, s3, 0
  s_add_u32 s4, s74, 0
  buffer_load_dwordx4 v8, s[40:43], s4 offen lds
  s_add_u32 m0, s3, 1024
  s_nop 0
  buffer_load_dwordx4 v9, s[40:43], s4 offen lds
  s_add_u32 m0, s3, 8192
  s_add_u32 s4, s74, 2048
  buffer_load_dwordx4 v8, s[40:43], s4 offen lds
  s_add_u32 m0, s3, 9216
  s_nop 0
  buffer_load_dwordx4 v9, s[40:43], s4 offen lds
  s_add_u32 m0, s3, 16384
  s_add_u32 s4, s74, 4096
  buffer_load_dwordx4 v8, s[40:43], s4 offen lds
  s_add_u32 m0, s3, 17408
  s_nop 0
  buffer_load_dwordx4 v9, s[40:43], s4 offen lds
  s_and_b32 s73, s100, 15
  s_cmp_eq_u32 s73, s91
  s_cselect_b32 s74, 4, 0
  s_lshr_b64 s[100:101], s[100:101], s74
  s_and_b32 s73, s100, 15
  s_lshr_b64 s[100:101], s[100:101], 4
  s_mul_i32 s74, s73, 393216
  s_lshl_b32 s73, s73, 7
  s_add_u32 s75, s75, 43008
  s_cmp_eq_u32 s75, 129024
  s_cselect_b32 s75, 0, s75
  s_mov_b32 s60, s20
  s_and_b32 s61, s21, 0xffff
  s_mov_b32 s62, 2097152
  s_mov_b32 s63, 0x00020000
  s_and_b32 s3, s70, 3
  s_mul_i32 s3, s3, 8
  s_mul_i32 s4, s99, 32
  s_add_u32 s3, s3, s4
  v_lshrrev_b32 v2, 3, v1
  v_add_u32 v2, s3, v2
  v_mul_u32_u24 v2, 2048, v2
  v_and_b32 v3, 7, v1
  v_lshl_add_u32 v2, v3, 8, v2
  s_and_b32 s3, s2, 7
  s_lshr_b32 s3, s3, 2
  s_mul_i32 s3, s3, 128
  buffer_load_dword v96, v2, s[60:63], s3 offen
  s_waitcnt vmcnt(12)
  s_barrier
  buffer_load_dwordx4 v[32:35], v18, s[56:59], 0 offen
  s_mov_b32 s3, 65536
  buffer_load_dwordx4 v[36:39], v18, s[56:59], s3 offen
  s_mov_b32 s3, 131072
  buffer_load_dwordx4 v[40:43], v18, s[56:59], s3 offen
  s_mov_b32 s3, 196608
  buffer_load_dwordx4 v[44:47], v18, s[56:59], s3 offen
  buffer_load_dwordx2 v[48:49], v19, s[56:59], 0 offen
  s_waitcnt vmcnt(6)
  s_barrier
  s_waitcnt vmcnt(0)
  v_pk_add_f32 v[32:33], v[32:33], v[36:37]
  v_pk_add_f32 v[34:35], v[34:35], v[38:39]
  v_pk_add_f32 v[40:41], v[40:41], v[44:45]
  v_pk_add_f32 v[42:43], v[42:43], v[46:47]
  v_pk_add_f32 v[32:33], v[32:33], v[40:41]
  v_pk_add_f32 v[34:35], v[34:35], v[42:43]
  s_nop 1
  v_permlane32_swap_b32 v32, v34
  v_permlane32_swap_b32 v33, v35
  v_pk_add_f32 v[32:33], v[32:33], v[34:35]
  v_mov_b32 v34, v32
  v_mov_b32 v35, v33
  s_nop 0
  v_permlane16_swap_b32 v32, v34
  v_permlane16_swap_b32 v33, v35
  v_pk_add_f32 v[32:33], v[32:33], v[34:35]
  v_mul_f32 v32, 0x3a800000, v32
  v_mul_f32 v33, 0x3a800000, v33
  v_fma_f32 v33, -v32, v32, v33
  v_max_f32 v33, 0, v33
  v_add_f32 v33, 0x3727c5ac, v33
  v_rsq_f32 v33, v33
  s_nop 0
  s_and_b32 s3, s70, 3
  s_lshl_b32 s5, s3, 7
  s_add_u32 s5, s5, 129088
  v_and_b32 v3, 15, v1
  v_lshrrev_b32 v2, 5, v1
  v_lshl_add_u32 v2, v3, 1, v2
  v_lshl_add_u32 v2, v2, 2, s5
  ds_write2_b32 v2, v32, v33 offset0:0 offset1:160
  v_mov_b32 v50, v48
  v_mov_b32 v51, v49
  s_nop 0
  v_permlane32_swap_b32 v48, v50
  v_permlane32_swap_b32 v49, v51
  v_pk_add_f32 v[48:49], v[48:49], v[50:51]
  v_mov_b32 v50, v48
  v_mov_b32 v51, v49
  s_nop 0
  v_permlane16_swap_b32 v48, v50
  v_permlane16_swap_b32 v49, v51
  v_pk_add_f32 v[48:49], v[48:49], v[50:51]
  s_nop 1
  v_add_f32_dpp v48, v48, v48 row_ror:8 row_mask:0xf bank_mask:0xf
  v_add_f32_dpp v49, v49, v49 row_ror:8 row_mask:0xf bank_mask:0xf
  s_nop 1
  v_add_f32_dpp v48, v48, v48 row_ror:4 row_mask:0xf bank_mask:0xf
  v_add_f32_dpp v49, v49, v49 row_ror:4 row_mask:0xf bank_mask:0xf
  v_mul_f32 v48, 0x3a800000, v48
  v_mul_f32 v49, 0x3a800000, v49
  v_fma_f32 v49, -v48, v48, v49
  v_max_f32 v49, 0, v49
  v_add_f32 v49, 0x3727c5ac, v49
  v_rsq_f32 v49, v49
  s_nop 0
  s_lshl_b32 s5, s3, 4
  s_add_u32 s5, s5, 129024
  v_and_b32 v3, 3, v1
  v_lshl_add_u32 v2, v3, 2, s5
  ds_write2_b32 v2, v48, v49 offset0:0 offset1:160
  s_waitcnt lgkmcnt(0)
  s_barrier
  s_barrier
L_attn_ldend:
  s_lshl_b32 s87, s97, 15
  s_lshl_b32 s4, s68, 11
  s_add_u32 s87, s87, s4
  s_lshl_b32 s4, s69, 2
  s_add_u32 s87, s87, s4
  s_add_u32 s97, s97, 1
  s_branch L_wo_body
L_attn_end:
  s_endpgm
L_attn_compute:
  s_and_b32 s71, s70, 1
  s_lshr_b32 s72, s70, 1
  v_and_b32 v3, 31, v1
  v_lshlrev_b32 v3, 2, v3
  v_add_u32 v3, 40960, v3
  v_mov_b32 v236, 0x3f803f80
  v_mov_b32 v237, 0x3f803f80
  v_mov_b32 v238, 0x3f803f80
  v_mov_b32 v239, 0x3f803f80
  ds_write_b32 v3, v236
  ds_write_b32 v3, v236 offset:43008
  v_add_u32 v3, 86016, v3
  ds_write_b32 v3, v236
  ds_write_b32 v3, v236 offset:3328
  v_and_b32 v3, 15, v1
  v_lshrrev_b32 v2, 4, v1
  v_lshrrev_b32 v33, 1, v3
  s_lshl_b32 s8, s71, 13
  v_xor_b32 v4, v2, v33
  v_lshlrev_b32 v4, 4, v4
  v_lshl_add_u32 v4, v3, 7, v4
  v_add_u32 v8, 40960, v4
  v_add_u32 v4, s8, v4
  v_add_u32 v5, 4, v2
  v_xor_b32 v5, v5, v33
  v_lshlrev_b32 v5, 4, v5
  v_lshl_add_u32 v5, v3, 7, v5
  v_add_u32 v9, 40960, v5
  v_add_u32 v5, s8, v5
  v_bfe_u32 v34, v1, 2, 2
  v_lshl_add_u32 v34, v2, 3, v34
  v_lshlrev_b32 v34, 7, v34
  v_and_b32 v33, 3, v1
  v_lshl_add_u32 v34, v33, 3, v34
  v_bfe_u32 v33, v1, 3, 2
  v_lshl_add_u32 v34, v33, 5, v34
  s_lshl_b32 s8, s70, 5
  v_xor_b32 v34, s8, v34
  v_add_u32 v6, 16384, v34
  v_xor_b32 v7, 32, v6
  s_mov_b32 s75, 0
  v_add_u32_e64 v10, s75, v4
  v_add_u32_e64 v11, s75, v5
  v_add_u32_e64 v12, s75, v6
  v_add_u32_e64 v13, s75, v7
  v_add_u32_e64 v14, s75, v8
  v_add_u32_e64 v15, s75, v9
  s_add_u32 s75, s75, 43008
  s_cmp_eq_u32 s75, 129024
  s_cselect_b32 s75, 0, s75
  s_mov_b32 s79, 16
  s_cmp_eq_u32 s96, 0
  s_cbranch_scc1 L_attn_nog
  s_mov_b32 s79, 15
  ds_read_b128 v[32:35], v10 offset:0
  ds_read_b128 v[36:39], v10 offset:2048
  ds_read_b128 v[40:43], v10 offset:4096
  ds_read_b128 v[44:47], v10 offset:6144
  ds_read_b64_tr_b16 v[52:53], v12 offset:0
  ds_read_b64_tr_b16 v[54:55], v12 offset:512
  ds_read_b64_tr_b16 v[56:57], v13 offset:0
  ds_read_b64_tr_b16 v[58:59], v13 offset:512
  ds_read_b64_tr_b16 v[60:61], v12 offset:8192
  ds_read_b64_tr_b16 v[62:63], v12 offset:8704
  ds_read_b64_tr_b16 v[64:65], v13 offset:8192
  ds_read_b64_tr_b16 v[66:67], v13 offset:8704
  ds_read_b64_tr_b16 v[68:69], v12 offset:16384
  ds_read_b64_tr_b16 v[70:71], v12 offset:16896
  ds_read_b64_tr_b16 v[72:73], v13 offset:16384
  ds_read_b64_tr_b16 v[74:75], v13 offset:16896
  s_waitcnt lgkmcnt(0)
  v_mfma_f32_16x16x32_bf16 v[128:131], v[52:55], v[32:35], 0
  ds_read_b128 v[76:79], v11 offset:0
  v_mfma_f32_16x16x32_bf16 v[132:135], v[52:55], v[36:39], 0
  ds_read_b128 v[80:83], v11 offset:2048
  v_mfma_f32_16x16x32_bf16 v[136:139], v[52:55], v[40:43], 0
  ds_read_b128 v[84:87], v11 offset:4096
  v_mfma_f32_16x16x32_bf16 v[140:143], v[52:55], v[44:47], 0
  ds_read_b128 v[88:91], v11 offset:6144
  v_mfma_f32_16x16x32_bf16 v[156:159], v[56:59], v[44:47], 0
  ds_read_b64_tr_b16 v[96:97], v12 offset:4096
  v_mfma_f32_16x16x32_bf16 v[152:155], v[56:59], v[40:43], 0
  ds_read_b64_tr_b16 v[98:99], v12 offset:4608
  v_mfma_f32_16x16x32_bf16 v[148:151], v[56:59], v[36:39], 0
  ds_read_b64_tr_b16 v[100:101], v13 offset:4096
  v_mfma_f32_16x16x32_bf16 v[144:147], v[56:59], v[32:35], 0
  ds_read_b64_tr_b16 v[102:103], v13 offset:4608
  v_mfma_f32_16x16x32_bf16 v[160:163], v[60:63], v[32:35], 0
  ds_read_b64_tr_b16 v[104:105], v12 offset:12288
  v_mfma_f32_16x16x32_bf16 v[164:167], v[60:63], v[36:39], 0
  ds_read_b64_tr_b16 v[106:107], v12 offset:12800
  v_mfma_f32_16x16x32_bf16 v[168:171], v[60:63], v[40:43], 0
  ds_read_b64_tr_b16 v[108:109], v13 offset:12288
  v_mfma_f32_16x16x32_bf16 v[172:175], v[60:63], v[44:47], 0
  ds_read_b64_tr_b16 v[110:111], v13 offset:12800
  v_mfma_f32_16x16x32_bf16 v[188:191], v[64:67], v[44:47], 0
  ds_read_b64_tr_b16 v[112:113], v12 offset:20480
  v_mfma_f32_16x16x32_bf16 v[184:187], v[64:67], v[40:43], 0
  ds_read_b64_tr_b16 v[114:115], v12 offset:20992
  v_mfma_f32_16x16x32_bf16 v[180:183], v[64:67], v[36:39], 0
  ds_read_b64_tr_b16 v[116:117], v13 offset:20480
  v_mfma_f32_16x16x32_bf16 v[176:179], v[64:67], v[32:35], 0
  ds_read_b64_tr_b16 v[118:119], v13 offset:20992
  v_mfma_f32_16x16x32_bf16 v[192:195], v[32:35], v[68:71], 0
  v_add_u32_e64 v10, s75, v4
  v_mfma_f32_16x16x32_bf16 v[196:199], v[36:39], v[68:71], 0
  v_add_u32_e64 v11, s75, v5
  v_mfma_f32_16x16x32_bf16 v[200:203], v[40:43], v[68:71], 0
  v_add_u32_e64 v12, s75, v6
  v_mfma_f32_16x16x32_bf16 v[204:207], v[44:47], v[68:71], 0
  v_add_u32_e64 v13, s75, v7
  v_mfma_f32_16x16x32_bf16 v[220:223], v[44:47], v[72:75], 0
  v_add_u32_e64 v14, s75, v8
  v_mfma_f32_16x16x32_bf16 v[216:219], v[40:43], v[72:75], 0
  v_add_u32_e64 v15, s75, v9
  v_mfma_f32_16x16x32_bf16 v[212:215], v[36:39], v[72:75], 0
  s_add_u32 s75, s75, 43008
  v_mfma_f32_16x16x32_bf16 v[208:211], v[32:35], v[72:75], 0
  s_cmp_eq_u32 s75, 129024
  s_cselect_b32 s75, 0, s75
  s_waitcnt lgkmcnt(0)
  v_mfma_f32_16x16x32_bf16 v[128:131], v[96:99], v[76:79], v[128:131]
  v_mfma_f32_16x16x32_bf16 v[132:135], v[96:99], v[80:83], v[132:135]
  v_mfma_f32_16x16x32_bf16 v[136:139], v[96:99], v[84:87], v[136:139]
  v_mfma_f32_16x16x32_bf16 v[140:143], v[96:99], v[88:91], v[140:143]
  v_mfma_f32_16x16x32_bf16 v[156:159], v[100:103], v[88:91], v[156:159]
  v_mfma_f32_16x16x32_bf16 v[152:155], v[100:103], v[84:87], v[152:155]
  v_mfma_f32_16x16x32_bf16 v[148:151], v[100:103], v[80:83], v[148:151]
  v_mfma_f32_16x16x32_bf16 v[144:147], v[100:103], v[76:79], v[144:147]
  v_mfma_f32_16x16x32_bf16 v[160:163], v[104:107], v[76:79], v[160:163]
  v_mfma_f32_16x16x32_bf16 v[164:167], v[104:107], v[80:83], v[164:167]
  v_mfma_f32_16x16x32_bf16 v[168:171], v[104:107], v[84:87], v[168:171]
  v_mfma_f32_16x16x32_bf16 v[172:175], v[104:107], v[88:91], v[172:175]
  v_mfma_f32_16x16x32_bf16 v[188:191], v[108:111], v[88:91], v[188:191]
  v_mfma_f32_16x16x32_bf16 v[184:187], v[108:111], v[84:87], v[184:187]
  v_mfma_f32_16x16x32_bf16 v[180:183], v[108:111], v[80:83], v[180:183]
  v_mfma_f32_16x16x32_bf16 v[176:179], v[108:111], v[76:79], v[176:179]
  v_mfma_f32_16x16x32_bf16 v[192:195], v[76:79], v[112:115], v[192:195]
  v_mfma_f32_16x16x32_bf16 v[196:199], v[80:83], v[112:115], v[196:199]
  v_mfma_f32_16x16x32_bf16 v[200:203], v[84:87], v[112:115], v[200:203]
  v_mfma_f32_16x16x32_bf16 v[204:207], v[88:91], v[112:115], v[204:207]
  v_mfma_f32_16x16x32_bf16 v[220:223], v[88:91], v[116:119], v[220:223]
  v_mfma_f32_16x16x32_bf16 v[216:219], v[84:87], v[116:119], v[216:219]
  v_mfma_f32_16x16x32_bf16 v[212:215], v[80:83], v[116:119], v[212:215]
  v_mfma_f32_16x16x32_bf16 v[208:211], v[76:79], v[116:119], v[208:211]
  s_barrier
  v_mov_b32 v76, v52
  v_mov_b32 v77, v53
  v_mov_b32 v78, v54
  v_mov_b32 v79, v55
  v_mov_b32 v80, v60
  v_mov_b32 v81, v61
  v_mov_b32 v82, v62
  v_mov_b32 v83, v63
  v_mov_b32 v84, v68
  v_mov_b32 v85, v69
  v_mov_b32 v86, v70
  v_mov_b32 v87, v71
L_attn_nog:
  v_and_b32 v35, 1, v2
  v_xor_b32 v35, s71, v35
  s_lshl_b32 s8, s68, 7
  s_lshl_b32 s9, s71, 6
  s_add_u32 s8, s8, s9
  s_add_u32 s10, s8, s69
  s_lshl_b32 s10, s10, 11
  s_lshl_b32 s11, s72, 10
  s_add_u32 s10, s10, s11
  v_lshl_add_u32 v33, v3, 4, s10
  v_lshl_add_u32 v33, v35, 9, v33
  v_lshrrev_b32 v34, 1, v2
  v_lshl_add_u32 v31, v34, 8, v33
  s_mul_i32 s10, s72, 14336
  s_add_u32 s10, s10, 1024
  s_lshl_b32 s11, s71, 10
  s_add_u32 s4, s10, s11
  s_sub_u32 s5, s10, s11
  s_mul_i32 s6, s71, 6144
  v_lshl_add_u32 v16, v1, 4, s4
  v_add_u32 v17, s6, v16
  v_lshl_add_u32 v18, v1, 4, s5
  v_add_u32 v18, s6, v18
  v_lshl_add_u32 v19, v2, 8, s4
  v_lshl_add_u32 v20, v2, 8, s5
  v_lshl_add_u32 v21, v3, 4, s4
  v_lshl_add_u32 v22, v3, 4, s5
  s_lshl_b32 s10, s71, 8
  s_add_u32 s10, s10, 129024
  v_lshl_add_u32 v23, v3, 2, s10
  v_lshl_add_u32 v24, v2, 4, s10
  v_and_b32 v33, 1, v3
  v_cmp_eq_u32 s[48:49], 1, v33
  v_lshl_add_u32 v34, v2, 2, v33
  v_add_u32 v35, 2, v34
  v_cmp_gt_u32 s[50:51], v34, v3
  v_cmp_gt_u32 s[52:53], v35, v3
  v_mov_b32 v36, 0xffff
  v_mov_b32 v37, 0xffff0000
  v_cndmask_b32 v36, v36, v37, s[48:49]
  s_add_u32 s10, s10, 704
  v_lshl_add_u32 v34, v34, 2, s10
  v_lshl_add_u32 v35, v35, 2, s10
  v_subrev_u32 v38, 64, v34
  v_subrev_u32 v39, 64, v35
  v_cndmask_b32 v25, v34, v38, s[50:51]
  v_cndmask_b32 v26, v35, v39, s[52:53]
  v_cndmask_b32 v27, 0, v36, s[50:51]
  v_cndmask_b32 v29, 0, v36, s[52:53]
  v_xor_b32 v28, v27, v36
  v_xor_b32 v30, v29, v36
  s_cmp_eq_u32 s8, 0
  s_cselect_b64 s[54:55], s[50:51], 0
  s_cselect_b64 s[14:15], s[52:53], 0
  s_cmp_lg_u32 s96, 0
  s_cbranch_scc1 L_attn_nozero
  v_mov_b32 v120, 0
  v_mov_b32 v121, 0
  v_mov_b32 v122, 0
  v_mov_b32 v123, 0
  v_mov_b32 v124, 0
  v_mov_b32 v125, 0
  v_mov_b32 v126, 0
  v_mov_b32 v127, 0
  v_mov_b32 v128, 0
  v_mov_b32 v129, 0
  v_mov_b32 v130, 0
  v_mov_b32 v131, 0
  v_mov_b32 v132, 0
  v_mov_b32 v133, 0
  v_mov_b32 v134, 0
  v_mov_b32 v135, 0
  v_mov_b32 v136, 0
  v_mov_b32 v137, 0
  v_mov_b32 v138, 0
  v_mov_b32 v139, 0
  v_mov_b32 v140, 0
  v_mov_b32 v141, 0
  v_mov_b32 v142, 0
  v_mov_b32 v143, 0
  v_mov_b32 v144, 0
  v_mov_b32 v145, 0
  v_mov_b32 v146, 0
  v_mov_b32 v147, 0
  v_mov_b32 v148, 0
  v_mov_b32 v149, 0
  v_mov_b32 v150, 0
  v_mov_b32 v151, 0
  v_mov_b32 v152, 0
  v_mov_b32 v153, 0
  v_mov_b32 v154, 0
  v_mov_b32 v155, 0
  v_mov_b32 v156, 0
  v_mov_b32 v157, 0
  v_mov_b32 v158, 0
  v_mov_b32 v159, 0
  v_mov_b32 v160, 0
  v_mov_b32 v161, 0
  v_mov_b32 v162, 0
  v_mov_b32 v163, 0
  v_mov_b32 v164, 0
  v_mov_b32 v165, 0
  v_mov_b32 v166, 0
  v_mov_b32 v167, 0
  v_mov_b32 v168, 0
  v_mov_b32 v169, 0
  v_mov_b32 v170, 0
  v_mov_b32 v171, 0
  v_mov_b32 v172, 0
  v_mov_b32 v173, 0
  v_mov_b32 v174, 0
  v_mov_b32 v175, 0
  v_mov_b32 v176, 0
  v_mov_b32 v177, 0
  v_mov_b32 v178, 0
  v_mov_b32 v179, 0
  v_mov_b32 v180, 0
  v_mov_b32 v181, 0
  v_mov_b32 v182, 0
  v_mov_b32 v183, 0
  v_mov_b32 v184, 0
  v_mov_b32 v185, 0
  v_mov_b32 v186, 0
  v_mov_b32 v187, 0
  v_mov_b32 v188, 0
  v_mov_b32 v189, 0
  v_mov_b32 v190, 0
  v_mov_b32 v191, 0
  v_mov_b32 v192, 0
  v_mov_b32 v193, 0
  v_mov_b32 v194, 0
  v_mov_b32 v195, 0
  v_mov_b32 v196, 0
  v_mov_b32 v197, 0
  v_mov_b32 v198, 0
  v_mov_b32 v199, 0
  v_mov_b32 v200, 0
  v_mov_b32 v201, 0
  v_mov_b32 v202, 0
  v_mov_b32 v203, 0
  v_mov_b32 v204, 0
  v_mov_b32 v205, 0
  v_mov_b32 v206, 0
  v_mov_b32 v207, 0
  v_mov_b32 v208, 0
  v_mov_b32 v209, 0
  v_mov_b32 v210, 0
  v_mov_b32 v211, 0
  v_mov_b32 v212, 0
  v_mov_b32 v213, 0
  v_mov_b32 v214, 0
  v_mov_b32 v215, 0
  v_mov_b32 v216, 0
  v_mov_b32 v217, 0
  v_mov_b32 v218, 0
  v_mov_b32 v219, 0
  v_mov_b32 v220, 0
  v_mov_b32 v221, 0
  v_mov_b32 v222, 0
  v_mov_b32 v223, 0
  v_mov_b32 v224, 0
  v_mov_b32 v225, 0
  v_mov_b32 v226, 0
  v_mov_b32 v227, 0
  v_mov_b32 v228, 0
  v_mov_b32 v229, 0
  v_mov_b32 v230, 0
  v_mov_b32 v231, 0
  v_mov_b32 v232, 0
  v_mov_b32 v233, 0
  v_mov_b32 v234, 0
  v_mov_b32 v235, 0
L_attn_nozero:
  s_waitcnt lgkmcnt(0)
  s_mov_b32 s44, s34
  s_and_b32 s45, s35, 0xffff
  s_mov_b32 s46, 4194304
  s_mov_b32 s47, 0x00020000
  s_or_b32 s3, s96, s70
  s_cbranch_scc1 L_clr_skip0
  s_add_u32 s60, s22, 41943040
  s_addc_u32 s61, s23, 0
  s_and_b32 s61, s61, 0xffff
  s_mov_b32 s62, 524288
  s_mov_b32 s63, 0x00020000
  s_lshl_b32 s3, s2, 11
  v_lshlrev_b32 v2, 4, v1
  buffer_store_dwordx4 v[128:131], v2, s[60:63], s3 offen sc1
  buffer_store_dwordx4 v[128:131], v2, s[60:63], s3 offen offset:1024 sc1
L_clr_skip0:
  s_cmp_lg_u32 s96, 0
  s_cbranch_scc1 L_pfc1_skip
  s_getpc_b64 s[4:5]
L_pfc1:
  s_lshl_b32 s3, s99, 2
  s_add_u32 s3, s3, s70
  s_mul_i32 s3, s3, 256
  s_min_u32 s3, s3, L_w2_c1-L_attn_c0-256
  s_add_i32 s3, s3, L_attn_c0-L_pfc1
  s_ashr_i32 s6, s3, 31
  s_add_u32 s4, s4, s3
  s_addc_u32 s5, s5, s6
  s_load_dword s36, s[4:5], 0
  s_load_dword s37, s[4:5], 64
  s_load_dword s38, s[4:5], 128
  s_load_dword s39, s[4:5], 192
L_pfc1_skip:
  s_cmp_eq_u32 s96, 0
  s_barrier
  s_cbranch_scc1 L_attn_first
  ds_read_b128 v[88:91], v14 offset:46336
  ds_read_b128 v[92:95], v15 offset:46336
  ds_read_b128 v[32:35], v10 offset:0
  ds_read_b128 v[36:39], v10 offset:2048
  ds_read_b128 v[40:43], v10 offset:4096
  ds_read_b128 v[44:47], v10 offset:6144
  ds_read_b128 v[48:51], v14
  ds_read_b64_tr_b16 v[52:53], v12 offset:0
  ds_read_b64_tr_b16 v[54:55], v12 offset:512
  ds_read_b64_tr_b16 v[56:57], v13 offset:0
  ds_read_b64_tr_b16 v[58:59], v13 offset:512
  ds_read_b64_tr_b16 v[60:61], v12 offset:8192
  ds_read_b64_tr_b16 v[62:63], v12 offset:8704
  ds_read_b64_tr_b16 v[64:65], v13 offset:8192
  ds_read_b64_tr_b16 v[66:67], v13 offset:8704
  ds_read_b64_tr_b16 v[68:69], v12 offset:16384
  ds_read_b64_tr_b16 v[70:71], v12 offset:16896
  ds_read_b64_tr_b16 v[72:73], v13 offset:16384
  ds_read_b64_tr_b16 v[74:75], v13 offset:16896
  s_waitcnt lgkmcnt(15)
  v_mfma_f32_16x16x32_bf16 v[224:227], v[76:79], v[88:91], 0
  v_mfma_f32_16x16x32_bf16 v[228:231], v[80:83], v[88:91], 0
  v_mfma_f32_16x16x32_bf16 v[232:235], v[88:91], v[84:87], 0
  v_mfma_f32_16x16x32_bf16 v[224:227], v[96:99], v[92:95], v[224:227]
  v_mfma_f32_16x16x32_bf16 v[228:231], v[104:107], v[92:95], v[228:231]
  v_mfma_f32_16x16x32_bf16 v[232:235], v[92:95], v[112:115], v[232:235]
  s_waitcnt lgkmcnt(0)
  s_branch L_attn_loop
L_attn_first:
  s_load_dwordx2 s[64:65], s[0:1], 72
  ds_read_b128 v[32:35], v10 offset:0
  ds_read_b128 v[36:39], v10 offset:2048
  ds_read_b128 v[40:43], v10 offset:4096
  ds_read_b128 v[44:47], v10 offset:6144
  ds_read_b128 v[48:51], v14
  ds_read_b64_tr_b16 v[52:53], v12 offset:0
  ds_read_b64_tr_b16 v[54:55], v12 offset:512
  ds_read_b64_tr_b16 v[56:57], v13 offset:0
  ds_read_b64_tr_b16 v[58:59], v13 offset:512
  ds_read_b64_tr_b16 v[60:61], v12 offset:8192
  ds_read_b64_tr_b16 v[62:63], v12 offset:8704
  ds_read_b64_tr_b16 v[64:65], v13 offset:8192
  ds_read_b64_tr_b16 v[66:67], v13 offset:8704
  ds_read_b64_tr_b16 v[68:69], v12 offset:16384
  ds_read_b64_tr_b16 v[70:71], v12 offset:16896
  ds_read_b64_tr_b16 v[72:73], v13 offset:16384
  ds_read_b64_tr_b16 v[74:75], v13 offset:16896
  s_waitcnt lgkmcnt(0)
  v_mov_b32 v240, 0
  v_mov_b32 v241, 0
  v_mov_b32 v242, 0
  v_mov_b32 v243, 0
  v_mov_b32 v244, 0
  v_mov_b32 v245, 0
  v_mov_b32 v246, 0
  v_mov_b32 v247, 0
  v_mov_b32 v248, 0
  v_mov_b32 v249, 0
  v_mov_b32 v250, 0
  v_mov_b32 v251, 0
  v_mov_b32 v252, 0
  v_mov_b32 v253, 0
  v_mov_b32 v254, 0
  v_mov_b32 v255, 0
  s_cmp_lg_u32 s72, 0
  s_cbranch_scc1 L_attn_loopb
  s_or_b32 s3, s96, s70
  s_cbranch_scc1 L_clr_skip1
  v_mov_b32 v3, 1
  s_and_b32 s65, s65, 0xffff
  s_mov_b32 s66, 256
  s_mov_b32 s67, 0x00020000
  s_mov_b64 exec, 1
  s_waitcnt vmcnt(0)
  buffer_store_byte v3, off, s[64:67], s2 sc1
  s_mov_b64 exec, -1
L_clr_skip1:
.p2align 3
L_attn_loopa:
  v_mfma_f32_16x16x32_bf16 v[240:243], v[236:239], v[32:35], v[240:243]
  ds_read_b128 v[76:79], v11 offset:0
  v_mfma_f32_16x16x32_bf16 v[244:247], v[32:35], v[32:35], v[244:247]
  ds_read_b128 v[80:83], v11 offset:2048
  v_mfma_f32_16x16x32_bf16 v[248:251], v[236:239], v[36:39], v[248:251]
  ds_read_b128 v[84:87], v11 offset:4096
  v_mfma_f32_16x16x32_bf16 v[252:255], v[36:39], v[36:39], v[252:255]
  ds_read_b128 v[88:91], v11 offset:6144
  v_mfma_f32_16x16x32_bf16 v[120:123], v[236:239], v[48:51], v[120:123]
  ds_read_b128 v[92:95], v15
  v_mfma_f32_16x16x32_bf16 v[124:127], v[48:51], v[48:51], v[124:127]
  ds_read_b64_tr_b16 v[96:97], v12 offset:4096
  v_mfma_f32_16x16x32_bf16 v[128:131], v[52:55], v[32:35], v[128:131]
  ds_read_b64_tr_b16 v[98:99], v12 offset:4608
  v_mfma_f32_16x16x32_bf16 v[132:135], v[52:55], v[36:39], v[132:135]
  ds_read_b64_tr_b16 v[100:101], v13 offset:4096
  v_mfma_f32_16x16x32_bf16 v[136:139], v[52:55], v[40:43], v[136:139]
  ds_read_b64_tr_b16 v[102:103], v13 offset:4608
  v_mfma_f32_16x16x32_bf16 v[140:143], v[52:55], v[44:47], v[140:143]
  ds_read_b64_tr_b16 v[104:105], v12 offset:12288
  v_mfma_f32_16x16x32_bf16 v[224:227], v[52:55], v[48:51], v[224:227]
  ds_read_b64_tr_b16 v[106:107], v12 offset:12800
  v_mfma_f32_16x16x32_bf16 v[156:159], v[56:59], v[44:47], v[156:159]
  ds_read_b64_tr_b16 v[108:109], v13 offset:12288
  v_mfma_f32_16x16x32_bf16 v[152:155], v[56:59], v[40:43], v[152:155]
  ds_read_b64_tr_b16 v[110:111], v13 offset:12800
  v_mfma_f32_16x16x32_bf16 v[148:151], v[56:59], v[36:39], v[148:151]
  ds_read_b64_tr_b16 v[112:113], v12 offset:20480
  v_mfma_f32_16x16x32_bf16 v[144:147], v[56:59], v[32:35], v[144:147]
  ds_read_b64_tr_b16 v[114:115], v12 offset:20992
  v_mfma_f32_16x16x32_bf16 v[160:163], v[60:63], v[32:35], v[160:163]
  ds_read_b64_tr_b16 v[116:117], v13 offset:20480
  v_mfma_f32_16x16x32_bf16 v[164:167], v[60:63], v[36:39], v[164:167]
  ds_read_b64_tr_b16 v[118:119], v13 offset:20992
  v_mfma_f32_16x16x32_bf16 v[168:171], v[60:63], v[40:43], v[168:171]
  v_add_u32_e64 v10, s75, v4
  v_mfma_f32_16x16x32_bf16 v[172:175], v[60:63], v[44:47], v[172:175]
  v_add_u32_e64 v11, s75, v5
  v_mfma_f32_16x16x32_bf16 v[228:231], v[60:63], v[48:51], v[228:231]
  v_add_u32_e64 v12, s75, v6
  v_mfma_f32_16x16x32_bf16 v[188:191], v[64:67], v[44:47], v[188:191]
  v_add_u32_e64 v13, s75, v7
  v_mfma_f32_16x16x32_bf16 v[184:187], v[64:67], v[40:43], v[184:187]
  v_add_u32_e64 v14, s75, v8
  v_mfma_f32_16x16x32_bf16 v[180:183], v[64:67], v[36:39], v[180:183]
  v_add_u32_e64 v15, s75, v9
  v_mfma_f32_16x16x32_bf16 v[176:179], v[64:67], v[32:35], v[176:179]
  s_add_u32 s75, s75, 43008
  v_mfma_f32_16x16x32_bf16 v[192:195], v[32:35], v[68:71], v[192:195]
  s_cmp_eq_u32 s75, 129024
  v_mfma_f32_16x16x32_bf16 v[196:199], v[36:39], v[68:71], v[196:199]
  s_cselect_b32 s75, 0, s75
  s_sub_u32 s79, s79, 1
  v_mfma_f32_16x16x32_bf16 v[200:203], v[40:43], v[68:71], v[200:203]
  v_mfma_f32_16x16x32_bf16 v[204:207], v[44:47], v[68:71], v[204:207]
  v_mfma_f32_16x16x32_bf16 v[232:235], v[48:51], v[68:71], v[232:235]
  v_mfma_f32_16x16x32_bf16 v[220:223], v[44:47], v[72:75], v[220:223]
  v_mfma_f32_16x16x32_bf16 v[216:219], v[40:43], v[72:75], v[216:219]
  v_mfma_f32_16x16x32_bf16 v[212:215], v[36:39], v[72:75], v[212:215]
  v_mfma_f32_16x16x32_bf16 v[208:211], v[32:35], v[72:75], v[208:211]
  s_waitcnt lgkmcnt(0)
  s_barrier
  v_mfma_f32_16x16x32_bf16 v[240:243], v[236:239], v[76:79], v[240:243]
  ds_read_b128 v[32:35], v10 offset:0
  v_mfma_f32_16x16x32_bf16 v[244:247], v[76:79], v[76:79], v[244:247]
  ds_read_b128 v[36:39], v10 offset:2048
  v_mfma_f32_16x16x32_bf16 v[248:251], v[236:239], v[80:83], v[248:251]
  ds_read_b128 v[40:43], v10 offset:4096
  v_mfma_f32_16x16x32_bf16 v[252:255], v[80:83], v[80:83], v[252:255]
  ds_read_b128 v[44:47], v10 offset:6144
  v_mfma_f32_16x16x32_bf16 v[120:123], v[236:239], v[92:95], v[120:123]
  ds_read_b128 v[48:51], v14
  v_mfma_f32_16x16x32_bf16 v[124:127], v[92:95], v[92:95], v[124:127]
  ds_read_b64_tr_b16 v[52:53], v12 offset:0
  v_mfma_f32_16x16x32_bf16 v[128:131], v[96:99], v[76:79], v[128:131]
  ds_read_b64_tr_b16 v[54:55], v12 offset:512
  v_mfma_f32_16x16x32_bf16 v[132:135], v[96:99], v[80:83], v[132:135]
  ds_read_b64_tr_b16 v[56:57], v13 offset:0
  v_mfma_f32_16x16x32_bf16 v[136:139], v[96:99], v[84:87], v[136:139]
  ds_read_b64_tr_b16 v[58:59], v13 offset:512
  v_mfma_f32_16x16x32_bf16 v[140:143], v[96:99], v[88:91], v[140:143]
  ds_read_b64_tr_b16 v[60:61], v12 offset:8192
  v_mfma_f32_16x16x32_bf16 v[224:227], v[96:99], v[92:95], v[224:227]
  ds_read_b64_tr_b16 v[62:63], v12 offset:8704
  v_mfma_f32_16x16x32_bf16 v[156:159], v[100:103], v[88:91], v[156:159]
  ds_read_b64_tr_b16 v[64:65], v13 offset:8192
  v_mfma_f32_16x16x32_bf16 v[152:155], v[100:103], v[84:87], v[152:155]
  ds_read_b64_tr_b16 v[66:67], v13 offset:8704
  v_mfma_f32_16x16x32_bf16 v[148:151], v[100:103], v[80:83], v[148:151]
  ds_read_b64_tr_b16 v[68:69], v12 offset:16384
  v_mfma_f32_16x16x32_bf16 v[144:147], v[100:103], v[76:79], v[144:147]
  ds_read_b64_tr_b16 v[70:71], v12 offset:16896
  v_mfma_f32_16x16x32_bf16 v[160:163], v[104:107], v[76:79], v[160:163]
  ds_read_b64_tr_b16 v[72:73], v13 offset:16384
  v_mfma_f32_16x16x32_bf16 v[164:167], v[104:107], v[80:83], v[164:167]
  ds_read_b64_tr_b16 v[74:75], v13 offset:16896
  v_mfma_f32_16x16x32_bf16 v[168:171], v[104:107], v[84:87], v[168:171]
  s_cmp_lg_u32 s79, 0
  s_nop 0
  v_mfma_f32_16x16x32_bf16 v[172:175], v[104:107], v[88:91], v[172:175]
  v_mfma_f32_16x16x32_bf16 v[228:231], v[104:107], v[92:95], v[228:231]
  v_mfma_f32_16x16x32_bf16 v[188:191], v[108:111], v[88:91], v[188:191]
  v_mfma_f32_16x16x32_bf16 v[184:187], v[108:111], v[84:87], v[184:187]
  v_mfma_f32_16x16x32_bf16 v[180:183], v[108:111], v[80:83], v[180:183]
  v_mfma_f32_16x16x32_bf16 v[176:179], v[108:111], v[76:79], v[176:179]
  v_mfma_f32_16x16x32_bf16 v[192:195], v[76:79], v[112:115], v[192:195]
  v_mfma_f32_16x16x32_bf16 v[196:199], v[80:83], v[112:115], v[196:199]
  v_mfma_f32_16x16x32_bf16 v[200:203], v[84:87], v[112:115], v[200:203]
  v_mfma_f32_16x16x32_bf16 v[204:207], v[88:91], v[112:115], v[204:207]
  v_mfma_f32_16x16x32_bf16 v[232:235], v[92:95], v[112:115], v[232:235]
  v_mfma_f32_16x16x32_bf16 v[220:223], v[88:91], v[116:119], v[220:223]
  v_mfma_f32_16x16x32_bf16 v[216:219], v[84:87], v[116:119], v[216:219]
  v_mfma_f32_16x16x32_bf16 v[212:215], v[80:83], v[116:119], v[212:215]
  v_mfma_f32_16x16x32_bf16 v[208:211], v[76:79], v[116:119], v[208:211]
  s_waitcnt lgkmcnt(0)
  s_cbranch_scc1 L_attn_loopa
  s_branch L_attn_post
.p2align 3
L_attn_loopb:
  v_mfma_f32_16x16x32_bf16 v[240:243], v[236:239], v[40:43], v[240:243]
  ds_read_b128 v[76:79], v11 offset:0
  v_mfma_f32_16x16x32_bf16 v[244:247], v[40:43], v[40:43], v[244:247]
  ds_read_b128 v[80:83], v11 offset:2048
  v_mfma_f32_16x16x32_bf16 v[248:251], v[236:239], v[44:47], v[248:251]
  ds_read_b128 v[84:87], v11 offset:4096
  v_mfma_f32_16x16x32_bf16 v[252:255], v[44:47], v[44:47], v[252:255]
  ds_read_b128 v[88:91], v11 offset:6144
  v_mfma_f32_16x16x32_bf16 v[128:131], v[52:55], v[32:35], v[128:131]
  ds_read_b128 v[92:95], v15
  v_mfma_f32_16x16x32_bf16 v[132:135], v[52:55], v[36:39], v[132:135]
  ds_read_b64_tr_b16 v[96:97], v12 offset:4096
  v_mfma_f32_16x16x32_bf16 v[136:139], v[52:55], v[40:43], v[136:139]
  ds_read_b64_tr_b16 v[98:99], v12 offset:4608
  v_mfma_f32_16x16x32_bf16 v[140:143], v[52:55], v[44:47], v[140:143]
  ds_read_b64_tr_b16 v[100:101], v13 offset:4096
  v_mfma_f32_16x16x32_bf16 v[224:227], v[52:55], v[48:51], v[224:227]
  ds_read_b64_tr_b16 v[102:103], v13 offset:4608
  v_mfma_f32_16x16x32_bf16 v[156:159], v[56:59], v[44:47], v[156:159]
  ds_read_b64_tr_b16 v[104:105], v12 offset:12288
  v_mfma_f32_16x16x32_bf16 v[152:155], v[56:59], v[40:43], v[152:155]
  ds_read_b64_tr_b16 v[106:107], v12 offset:12800
  v_mfma_f32_16x16x32_bf16 v[148:151], v[56:59], v[36:39], v[148:151]
  ds_read_b64_tr_b16 v[108:109], v13 offset:12288
  v_mfma_f32_16x16x32_bf16 v[144:147], v[56:59], v[32:35], v[144:147]
  ds_read_b64_tr_b16 v[110:111], v13 offset:12800
  v_mfma_f32_16x16x32_bf16 v[160:163], v[60:63], v[32:35], v[160:163]
  ds_read_b64_tr_b16 v[112:113], v12 offset:20480
  v_mfma_f32_16x16x32_bf16 v[164:167], v[60:63], v[36:39], v[164:167]
  ds_read_b64_tr_b16 v[114:115], v12 offset:20992
  v_mfma_f32_16x16x32_bf16 v[168:171], v[60:63], v[40:43], v[168:171]
  ds_read_b64_tr_b16 v[116:117], v13 offset:20480
  v_mfma_f32_16x16x32_bf16 v[172:175], v[60:63], v[44:47], v[172:175]
  ds_read_b64_tr_b16 v[118:119], v13 offset:20992
  v_mfma_f32_16x16x32_bf16 v[228:231], v[60:63], v[48:51], v[228:231]
  v_add_u32_e64 v10, s75, v4
  v_mfma_f32_16x16x32_bf16 v[188:191], v[64:67], v[44:47], v[188:191]
  v_add_u32_e64 v11, s75, v5
  v_mfma_f32_16x16x32_bf16 v[184:187], v[64:67], v[40:43], v[184:187]
  v_add_u32_e64 v12, s75, v6
  v_mfma_f32_16x16x32_bf16 v[180:183], v[64:67], v[36:39], v[180:183]
  v_add_u32_e64 v13, s75, v7
  v_mfma_f32_16x16x32_bf16 v[176:179], v[64:67], v[32:35], v[176:179]
  v_add_u32_e64 v14, s75, v8
  v_mfma_f32_16x16x32_bf16 v[192:195], v[32:35], v[68:71], v[192:195]
  v_add_u32_e64 v15, s75, v9
  v_mfma_f32_16x16x32_bf16 v[196:199], v[36:39], v[68:71], v[196:199]
  s_add_u32 s75, s75, 43008
  v_mfma_f32_16x16x32_bf16 v[200:203], v[40:43], v[68:71], v[200:203]
  s_cmp_eq_u32 s75, 129024
  v_mfma_f32_16x16x32_bf16 v[204:207], v[44:47], v[68:71], v[204:207]
  s_cselect_b32 s75, 0, s75
  s_sub_u32 s79, s79, 1
  v_mfma_f32_16x16x32_bf16 v[232:235], v[48:51], v[68:71], v[232:235]
  v_mfma_f32_16x16x32_bf16 v[220:223], v[44:47], v[72:75], v[220:223]
  v_mfma_f32_16x16x32_bf16 v[216:219], v[40:43], v[72:75], v[216:219]
  v_mfma_f32_16x16x32_bf16 v[212:215], v[36:39], v[72:75], v[212:215]
  v_mfma_f32_16x16x32_bf16 v[208:211], v[32:35], v[72:75], v[208:211]
  s_waitcnt lgkmcnt(0)
  s_barrier
  v_mfma_f32_16x16x32_bf16 v[240:243], v[236:239], v[84:87], v[240:243]
  ds_read_b128 v[32:35], v10 offset:0
  v_mfma_f32_16x16x32_bf16 v[244:247], v[84:87], v[84:87], v[244:247]
  ds_read_b128 v[36:39], v10 offset:2048
  v_mfma_f32_16x16x32_bf16 v[248:251], v[236:239], v[88:91], v[248:251]
  ds_read_b128 v[40:43], v10 offset:4096
  v_mfma_f32_16x16x32_bf16 v[252:255], v[88:91], v[88:91], v[252:255]
  ds_read_b128 v[44:47], v10 offset:6144
  v_mfma_f32_16x16x32_bf16 v[128:131], v[96:99], v[76:79], v[128:131]
  ds_read_b128 v[48:51], v14
  v_mfma_f32_16x16x32_bf16 v[132:135], v[96:99], v[80:83], v[132:135]
  ds_read_b64_tr_b16 v[52:53], v12 offset:0
  v_mfma_f32_16x16x32_bf16 v[136:139], v[96:99], v[84:87], v[136:139]
  ds_read_b64_tr_b16 v[54:55], v12 offset:512
  v_mfma_f32_16x16x32_bf16 v[140:143], v[96:99], v[88:91], v[140:143]
  ds_read_b64_tr_b16 v[56:57], v13 offset:0
  v_mfma_f32_16x16x32_bf16 v[224:227], v[96:99], v[92:95], v[224:227]
  ds_read_b64_tr_b16 v[58:59], v13 offset:512
  v_mfma_f32_16x16x32_bf16 v[156:159], v[100:103], v[88:91], v[156:159]
  ds_read_b64_tr_b16 v[60:61], v12 offset:8192
  v_mfma_f32_16x16x32_bf16 v[152:155], v[100:103], v[84:87], v[152:155]
  ds_read_b64_tr_b16 v[62:63], v12 offset:8704
  v_mfma_f32_16x16x32_bf16 v[148:151], v[100:103], v[80:83], v[148:151]
  ds_read_b64_tr_b16 v[64:65], v13 offset:8192
  v_mfma_f32_16x16x32_bf16 v[144:147], v[100:103], v[76:79], v[144:147]
  ds_read_b64_tr_b16 v[66:67], v13 offset:8704
  v_mfma_f32_16x16x32_bf16 v[160:163], v[104:107], v[76:79], v[160:163]
  ds_read_b64_tr_b16 v[68:69], v12 offset:16384
  v_mfma_f32_16x16x32_bf16 v[164:167], v[104:107], v[80:83], v[164:167]
  ds_read_b64_tr_b16 v[70:71], v12 offset:16896
  v_mfma_f32_16x16x32_bf16 v[168:171], v[104:107], v[84:87], v[168:171]
  ds_read_b64_tr_b16 v[72:73], v13 offset:16384
  v_mfma_f32_16x16x32_bf16 v[172:175], v[104:107], v[88:91], v[172:175]
  ds_read_b64_tr_b16 v[74:75], v13 offset:16896
  v_mfma_f32_16x16x32_bf16 v[228:231], v[104:107], v[92:95], v[228:231]
  s_cmp_lg_u32 s79, 0
  s_nop 0
  v_mfma_f32_16x16x32_bf16 v[188:191], v[108:111], v[88:91], v[188:191]
  v_mfma_f32_16x16x32_bf16 v[184:187], v[108:111], v[84:87], v[184:187]
  v_mfma_f32_16x16x32_bf16 v[180:183], v[108:111], v[80:83], v[180:183]
  v_mfma_f32_16x16x32_bf16 v[176:179], v[108:111], v[76:79], v[176:179]
  v_mfma_f32_16x16x32_bf16 v[192:195], v[76:79], v[112:115], v[192:195]
  v_mfma_f32_16x16x32_bf16 v[196:199], v[80:83], v[112:115], v[196:199]
  v_mfma_f32_16x16x32_bf16 v[200:203], v[84:87], v[112:115], v[200:203]
  v_mfma_f32_16x16x32_bf16 v[204:207], v[88:91], v[112:115], v[204:207]
  v_mfma_f32_16x16x32_bf16 v[232:235], v[92:95], v[112:115], v[232:235]
  v_mfma_f32_16x16x32_bf16 v[220:223], v[88:91], v[116:119], v[220:223]
  v_mfma_f32_16x16x32_bf16 v[216:219], v[84:87], v[116:119], v[216:219]
  v_mfma_f32_16x16x32_bf16 v[212:215], v[80:83], v[116:119], v[212:215]
  v_mfma_f32_16x16x32_bf16 v[208:211], v[76:79], v[116:119], v[208:211]
  s_waitcnt lgkmcnt(0)
  s_cbranch_scc1 L_attn_loopb
L_attn_post:
  v_and_b32 v32, 3, v1
  v_cmp_eq_u32 s[4:5], 1, v32
  v_cmp_eq_u32 s[6:7], 2, v32
  v_cmp_eq_u32 s[8:9], 3, v32
  v_bfe_u32 v33, v1, 2, 2
  v_lshrrev_b32 v34, 4, v1
  v_cmp_eq_u32 s[10:11], v33, v34
  s_lshl_b32 s3, s72, 7
  v_add_u32 v35, s3, v23
  v_and_b32 v36, 15, v1
  s_cmp_eq_u32 s70, 0
  s_cselect_b32 s3, 0, 576
  s_add_u32 s3, s3, 129024
  v_lshl_add_u32 v36, v36, 2, s3
  v_cndmask_b32 v241, v244, v245, s[4:5]
  v_cndmask_b32 v249, v252, v253, s[4:5]
  v_cndmask_b32 v121, v124, v125, s[4:5]
  v_cndmask_b32 v241, v241, v246, s[6:7]
  v_cndmask_b32 v249, v249, v254, s[6:7]
  v_cndmask_b32 v121, v121, v126, s[6:7]
  v_cndmask_b32 v241, v241, v247, s[8:9]
  v_cndmask_b32 v249, v249, v255, s[8:9]
  v_cndmask_b32 v121, v121, v127, s[8:9]
  v_mul_f32 v240, 0x3a800000, v240
  v_mul_f32 v241, 0x3a800000, v241
  v_fma_f32 v241, -v240, v240, v241
  v_max_f32 v241, 0, v241
  v_add_f32 v241, 0x3727c5ac, v241
  v_rsq_f32 v241, v241
  s_nop 0
  v_mul_f32 v248, 0x3a800000, v248
  v_mul_f32 v249, 0x3a800000, v249
  v_fma_f32 v249, -v248, v248, v249
  v_max_f32 v249, 0, v249
  v_add_f32 v249, 0x3727c5ac, v249
  v_rsq_f32 v249, v249
  s_nop 0
  v_mul_f32 v120, 0x3a800000, v120
  v_mul_f32 v121, 0x3a800000, v121
  v_fma_f32 v121, -v120, v120, v121
  v_max_f32 v121, 0, v121
  v_add_f32 v121, 0x3727c5ac, v121
  v_rsq_f32 v121, v121
  s_nop 0
  s_mov_b64 exec, s[10:11]
  ds_write2_b32 v35, v240, v241 offset0:16 offset1:176
  ds_write2_b32 v35, v248, v249 offset0:32 offset1:192
  ds_write2_b32 v36, v120, v121 offset0:0 offset1:160
  s_mov_b64 exec, -1
  s_mov_b32 s36, s16
  s_and_b32 s37, s17, 0xffff
  s_mov_b32 s38, 4194304
  s_mov_b32 s39, 0x00020000
  s_and_b32 s3, s2, 3
  s_and_b32 s4, s99, 3
  s_lshl2_add_u32 s3, s3, s4
  s_lshl2_add_u32 s3, s3, s70
  s_lshl_b32 s3, s3, 16
  s_bfe_u32 s4, s2, 0x10002
  s_lshr_b32 s5, s99, 2
  s_lshl1_add_u32 s4, s5, s4
  s_lshl_b32 s4, s4, 7
  s_add_u32 s3, s3, s4
  s_add_u32 s4, s3, 32768
  v_and_b32 v32, 15, v1
  v_lshlrev_b32 v33, 1, v1
  v_and_b32 v33, 32, v33
  v_lshl_add_u32 v32, v32, 11, v33
  v_lshrrev_b32 v33, 1, v1
  v_and_b32 v33, 16, v33
  v_add_u32 v32, v32, v33
  s_waitcnt lgkmcnt(0)
  buffer_load_dwordx4 v[240:243], v32, s[36:39], s3 offen offset:0
  buffer_load_dwordx4 v[244:247], v32, s[36:39], s3 offen offset:64
  buffer_load_dwordx4 v[248:251], v32, s[36:39], s4 offen offset:0
  buffer_load_dwordx4 v[252:255], v32, s[36:39], s4 offen offset:64
  s_barrier
  s_branch L_attn_exit
.p2align 3
L_attn_loop:
  v_mfma_f32_16x16x32_bf16 v[128:131], v[52:55], v[32:35], v[128:131]
  ds_read_b128 v[76:79], v11 offset:0
  v_mfma_f32_16x16x32_bf16 v[132:135], v[52:55], v[36:39], v[132:135]
  ds_read_b128 v[80:83], v11 offset:2048
  v_mfma_f32_16x16x32_bf16 v[136:139], v[52:55], v[40:43], v[136:139]
  ds_read_b128 v[84:87], v11 offset:4096
  v_mfma_f32_16x16x32_bf16 v[140:143], v[52:55], v[44:47], v[140:143]
  ds_read_b128 v[88:91], v11 offset:6144
  v_mfma_f32_16x16x32_bf16 v[224:227], v[52:55], v[48:51], v[224:227]
  ds_read_b128 v[92:95], v15
  v_mfma_f32_16x16x32_bf16 v[156:159], v[56:59], v[44:47], v[156:159]
  ds_read_b64_tr_b16 v[96:97], v12 offset:4096
  v_mfma_f32_16x16x32_bf16 v[152:155], v[56:59], v[40:43], v[152:155]
  ds_read_b64_tr_b16 v[98:99], v12 offset:4608
  v_mfma_f32_16x16x32_bf16 v[148:151], v[56:59], v[36:39], v[148:151]
  ds_read_b64_tr_b16 v[100:101], v13 offset:4096
  v_mfma_f32_16x16x32_bf16 v[144:147], v[56:59], v[32:35], v[144:147]
  ds_read_b64_tr_b16 v[102:103], v13 offset:4608
  v_mfma_f32_16x16x32_bf16 v[160:163], v[60:63], v[32:35], v[160:163]
  ds_read_b64_tr_b16 v[104:105], v12 offset:12288
  v_mfma_f32_16x16x32_bf16 v[164:167], v[60:63], v[36:39], v[164:167]
  ds_read_b64_tr_b16 v[106:107], v12 offset:12800
  v_mfma_f32_16x16x32_bf16 v[168:171], v[60:63], v[40:43], v[168:171]
  ds_read_b64_tr_b16 v[108:109], v13 offset:12288
  v_mfma_f32_16x16x32_bf16 v[172:175], v[60:63], v[44:47], v[172:175]
  ds_read_b64_tr_b16 v[110:111], v13 offset:12800
  v_mfma_f32_16x16x32_bf16 v[228:231], v[60:63], v[48:51], v[228:231]
  ds_read_b64_tr_b16 v[112:113], v12 offset:20480
  v_mfma_f32_16x16x32_bf16 v[188:191], v[64:67], v[44:47], v[188:191]
  ds_read_b64_tr_b16 v[114:115], v12 offset:20992
  v_mfma_f32_16x16x32_bf16 v[184:187], v[64:67], v[40:43], v[184:187]
  ds_read_b64_tr_b16 v[116:117], v13 offset:20480
  v_mfma_f32_16x16x32_bf16 v[180:183], v[64:67], v[36:39], v[180:183]
  ds_read_b64_tr_b16 v[118:119], v13 offset:20992
  v_mfma_f32_16x16x32_bf16 v[176:179], v[64:67], v[32:35], v[176:179]
  v_add_u32_e64 v10, s75, v4
  v_mfma_f32_16x16x32_bf16 v[192:195], v[32:35], v[68:71], v[192:195]
  v_add_u32_e64 v11, s75, v5
  v_mfma_f32_16x16x32_bf16 v[196:199], v[36:39], v[68:71], v[196:199]
  v_add_u32_e64 v12, s75, v6
  v_mfma_f32_16x16x32_bf16 v[200:203], v[40:43], v[68:71], v[200:203]
  v_add_u32_e64 v13, s75, v7
  v_mfma_f32_16x16x32_bf16 v[204:207], v[44:47], v[68:71], v[204:207]
  v_add_u32_e64 v14, s75, v8
  v_mfma_f32_16x16x32_bf16 v[232:235], v[48:51], v[68:71], v[232:235]
  v_add_u32_e64 v15, s75, v9
  v_mfma_f32_16x16x32_bf16 v[220:223], v[44:47], v[72:75], v[220:223]
  s_add_u32 s75, s75, 43008
  v_mfma_f32_16x16x32_bf16 v[216:219], v[40:43], v[72:75], v[216:219]
  s_cmp_eq_u32 s75, 129024
  v_mfma_f32_16x16x32_bf16 v[212:215], v[36:39], v[72:75], v[212:215]
  s_cselect_b32 s75, 0, s75
  s_sub_u32 s79, s79, 1
  v_mfma_f32_16x16x32_bf16 v[208:211], v[32:35], v[72:75], v[208:211]
  s_waitcnt lgkmcnt(0)
  s_barrier
  v_mfma_f32_16x16x32_bf16 v[128:131], v[96:99], v[76:79], v[128:131]
  ds_read_b128 v[32:35], v10 offset:0
  v_mfma_f32_16x16x32_bf16 v[132:135], v[96:99], v[80:83], v[132:135]
  ds_read_b128 v[36:39], v10 offset:2048
  v_mfma_f32_16x16x32_bf16 v[136:139], v[96:99], v[84:87], v[136:139]
  ds_read_b128 v[40:43], v10 offset:4096
  v_mfma_f32_16x16x32_bf16 v[140:143], v[96:99], v[88:91], v[140:143]
  ds_read_b128 v[44:47], v10 offset:6144
  v_mfma_f32_16x16x32_bf16 v[224:227], v[96:99], v[92:95], v[224:227]
  ds_read_b128 v[48:51], v14
  v_mfma_f32_16x16x32_bf16 v[156:159], v[100:103], v[88:91], v[156:159]
  ds_read_b64_tr_b16 v[52:53], v12 offset:0
  v_mfma_f32_16x16x32_bf16 v[152:155], v[100:103], v[84:87], v[152:155]
  ds_read_b64_tr_b16 v[54:55], v12 offset:512
  v_mfma_f32_16x16x32_bf16 v[148:151], v[100:103], v[80:83], v[148:151]
  ds_read_b64_tr_b16 v[56:57], v13 offset:0
  v_mfma_f32_16x16x32_bf16 v[144:147], v[100:103], v[76:79], v[144:147]
  ds_read_b64_tr_b16 v[58:59], v13 offset:512
  v_mfma_f32_16x16x32_bf16 v[160:163], v[104:107], v[76:79], v[160:163]
  ds_read_b64_tr_b16 v[60:61], v12 offset:8192
  v_mfma_f32_16x16x32_bf16 v[164:167], v[104:107], v[80:83], v[164:167]
  ds_read_b64_tr_b16 v[62:63], v12 offset:8704
  v_mfma_f32_16x16x32_bf16 v[168:171], v[104:107], v[84:87], v[168:171]
  ds_read_b64_tr_b16 v[64:65], v13 offset:8192
  v_mfma_f32_16x16x32_bf16 v[172:175], v[104:107], v[88:91], v[172:175]
  ds_read_b64_tr_b16 v[66:67], v13 offset:8704
  v_mfma_f32_16x16x32_bf16 v[228:231], v[104:107], v[92:95], v[228:231]
  ds_read_b64_tr_b16 v[68:69], v12 offset:16384
  v_mfma_f32_16x16x32_bf16 v[188:191], v[108:111], v[88:91], v[188:191]
  ds_read_b64_tr_b16 v[70:71], v12 offset:16896
  v_mfma_f32_16x16x32_bf16 v[184:187], v[108:111], v[84:87], v[184:187]
  ds_read_b64_tr_b16 v[72:73], v13 offset:16384
  v_mfma_f32_16x16x32_bf16 v[180:183], v[108:111], v[80:83], v[180:183]
  ds_read_b64_tr_b16 v[74:75], v13 offset:16896
  v_mfma_f32_16x16x32_bf16 v[176:179], v[108:111], v[76:79], v[176:179]
  s_cmp_lg_u32 s79, 0
  s_nop 0
  v_mfma_f32_16x16x32_bf16 v[192:195], v[76:79], v[112:115], v[192:195]
  v_mfma_f32_16x16x32_bf16 v[196:199], v[80:83], v[112:115], v[196:199]
  v_mfma_f32_16x16x32_bf16 v[200:203], v[84:87], v[112:115], v[200:203]
  v_mfma_f32_16x16x32_bf16 v[204:207], v[88:91], v[112:115], v[204:207]
  v_mfma_f32_16x16x32_bf16 v[232:235], v[92:95], v[112:115], v[232:235]
  v_mfma_f32_16x16x32_bf16 v[220:223], v[88:91], v[116:119], v[220:223]
  v_mfma_f32_16x16x32_bf16 v[216:219], v[84:87], v[116:119], v[216:219]
  v_mfma_f32_16x16x32_bf16 v[212:215], v[80:83], v[116:119], v[212:215]
  v_mfma_f32_16x16x32_bf16 v[208:211], v[76:79], v[116:119], v[208:211]
  s_waitcnt lgkmcnt(0)
  s_cbranch_scc1 L_attn_loop
L_attn_exit:
  ds_read2_b32 v[66:67], v23 offset0:0 offset1:160
  ds_read2_b32 v[68:69], v23 offset0:16 offset1:176
  ds_read2_b32 v[70:71], v23 offset0:32 offset1:192
  ds_read2_b32 v[72:73], v23 offset0:48 offset1:208
  ds_read2_b32 v[74:75], v23 offset0:64 offset1:224
  ds_read2_b32 v[76:77], v25 offset0:0 offset1:16
  ds_read2_b32 v[80:81], v26 offset0:0 offset1:16
  ds_read2_b32 v[78:79], v25 offset0:32 offset1:48
  ds_read2_b32 v[82:83], v26 offset0:32 offset1:48
  ds_write_b128 v16, v[224:227] offset:0
  ds_write_b128 v16, v[228:231] offset:2048
  ds_write_b128 v16, v[232:235] offset:4096
  s_cmp_eq_u32 s71, 1
  s_cbranch_scc1 L_attn_nop3
  ds_write_b128 v16, v[172:175] offset:8192
  ds_write_b128 v16, v[188:191] offset:9216
  ds_write_b128 v16, v[204:207] offset:10240
  ds_write_b128 v16, v[220:223] offset:11264
L_attn_nop3:
  ds_read_b128 v[84:87], v24 offset:0
  ds_read_b128 v[104:107], v24 offset:640
  ds_read_b128 v[88:91], v24 offset:64
  ds_read_b128 v[108:111], v24 offset:704
  ds_read_b128 v[92:95], v24 offset:128
  ds_read_b128 v[112:115], v24 offset:768
  ds_read_b128 v[96:99], v24 offset:192
  ds_read_b128 v[116:119], v24 offset:832
  ds_read_b128 v[100:103], v24 offset:256
  ds_read_b128 v[120:123], v24 offset:896
  s_waitcnt lgkmcnt(10)
  s_barrier
  ds_read_b128 v[48:51], v19 offset:0
  ds_read_b128 v[52:55], v20 offset:1024
  ds_read_b128 v[56:59], v19 offset:2048
  ds_read_b128 v[60:63], v20 offset:3072
  ds_read_b32 v64, v21 offset:4096
  ds_read_b32 v65, v22 offset:5120
  ds_read_b128 v[32:35], v17 offset:2048
  ds_read_b128 v[36:39], v18 offset:3072
  ds_read_b128 v[40:43], v17 offset:4096
  ds_read_b128 v[44:47], v18 offset:5120
  v_mul_f32 v69, 0x3e8293ee, v69
  v_mul_f32 v71, 0x3e8293ee, v71
  v_mul_f32 v73, 0x3e8293ee, v73
  v_mul_f32 v75, 0x3e8293ee, v75
  v_mul_f32 v76, v76, v69
  v_mul_f32 v80, v80, v69
  v_mul_f32 v77, v77, v71
  v_mul_f32 v81, v81, v71
  v_mul_f32 v78, v78, v73
  v_mul_f32 v82, v82, v73
  v_mul_f32 v79, v79, v75
  v_mul_f32 v83, v83, v75
  s_waitcnt lgkmcnt(6)
  v_pk_fma_f32 v[128:129], v[48:49], v[68:69], v[128:129] op_sel:[0,0,0] op_sel_hi:[1,0,1] neg_lo:[0,1,0] neg_hi:[0,1,0]
  v_pk_fma_f32 v[130:131], v[50:51], v[68:69], v[130:131] op_sel:[0,0,0] op_sel_hi:[1,0,1] neg_lo:[0,1,0] neg_hi:[0,1,0]
  v_pk_fma_f32 v[144:145], v[52:53], v[68:69], v[144:145] op_sel:[0,0,0] op_sel_hi:[1,0,1] neg_lo:[0,1,0] neg_hi:[0,1,0]
  v_pk_fma_f32 v[146:147], v[54:55], v[68:69], v[146:147] op_sel:[0,0,0] op_sel_hi:[1,0,1] neg_lo:[0,1,0] neg_hi:[0,1,0]
  v_cvt_pk_bf16_f32 v128, v128, v129
  v_cvt_pk_bf16_f32 v129, v130, v131
  v_cvt_pk_bf16_f32 v130, v144, v145
  v_cvt_pk_bf16_f32 v131, v146, v147
  v_pk_fma_f32 v[160:161], v[56:57], v[68:69], v[160:161] op_sel:[0,0,0] op_sel_hi:[1,0,1] neg_lo:[0,1,0] neg_hi:[0,1,0]
  v_pk_fma_f32 v[162:163], v[58:59], v[68:69], v[162:163] op_sel:[0,0,0] op_sel_hi:[1,0,1] neg_lo:[0,1,0] neg_hi:[0,1,0]
  v_pk_fma_f32 v[176:177], v[60:61], v[68:69], v[176:177] op_sel:[0,0,0] op_sel_hi:[1,0,1] neg_lo:[0,1,0] neg_hi:[0,1,0]
  v_pk_fma_f32 v[178:179], v[62:63], v[68:69], v[178:179] op_sel:[0,0,0] op_sel_hi:[1,0,1] neg_lo:[0,1,0] neg_hi:[0,1,0]
  v_cvt_pk_bf16_f32 v160, v160, v161
  v_cvt_pk_bf16_f32 v161, v162, v163
  v_cvt_pk_bf16_f32 v162, v176, v177
  v_cvt_pk_bf16_f32 v163, v178, v179
  v_pk_fma_f32 v[132:133], v[48:49], v[70:71], v[132:133] op_sel:[0,0,0] op_sel_hi:[1,0,1] neg_lo:[0,1,0] neg_hi:[0,1,0]
  v_pk_fma_f32 v[134:135], v[50:51], v[70:71], v[134:135] op_sel:[0,0,0] op_sel_hi:[1,0,1] neg_lo:[0,1,0] neg_hi:[0,1,0]
  v_pk_fma_f32 v[148:149], v[52:53], v[70:71], v[148:149] op_sel:[0,0,0] op_sel_hi:[1,0,1] neg_lo:[0,1,0] neg_hi:[0,1,0]
  v_pk_fma_f32 v[150:151], v[54:55], v[70:71], v[150:151] op_sel:[0,0,0] op_sel_hi:[1,0,1] neg_lo:[0,1,0] neg_hi:[0,1,0]
  v_cvt_pk_bf16_f32 v132, v132, v133
  v_cvt_pk_bf16_f32 v133, v134, v135
  v_cvt_pk_bf16_f32 v134, v148, v149
  v_cvt_pk_bf16_f32 v135, v150, v151
  v_pk_fma_f32 v[164:165], v[56:57], v[70:71], v[164:165] op_sel:[0,0,0] op_sel_hi:[1,0,1] neg_lo:[0,1,0] neg_hi:[0,1,0]
  v_pk_fma_f32 v[166:167], v[58:59], v[70:71], v[166:167] op_sel:[0,0,0] op_sel_hi:[1,0,1] neg_lo:[0,1,0] neg_hi:[0,1,0]
  v_pk_fma_f32 v[180:181], v[60:61], v[70:71], v[180:181] op_sel:[0,0,0] op_sel_hi:[1,0,1] neg_lo:[0,1,0] neg_hi:[0,1,0]
  v_pk_fma_f32 v[182:183], v[62:63], v[70:71], v[182:183] op_sel:[0,0,0] op_sel_hi:[1,0,1] neg_lo:[0,1,0] neg_hi:[0,1,0]
  v_cvt_pk_bf16_f32 v164, v164, v165
  v_cvt_pk_bf16_f32 v165, v166, v167
  v_cvt_pk_bf16_f32 v166, v180, v181
  v_cvt_pk_bf16_f32 v167, v182, v183
  v_mfma_f32_16x16x32_bf16 v[144:147], v[160:163], v[128:131], 0
  v_pk_fma_f32 v[136:137], v[48:49], v[72:73], v[136:137] op_sel:[0,0,0] op_sel_hi:[1,0,1] neg_lo:[0,1,0] neg_hi:[0,1,0]
  v_pk_fma_f32 v[138:139], v[50:51], v[72:73], v[138:139] op_sel:[0,0,0] op_sel_hi:[1,0,1] neg_lo:[0,1,0] neg_hi:[0,1,0]
  v_pk_fma_f32 v[152:153], v[52:53], v[72:73], v[152:153] op_sel:[0,0,0] op_sel_hi:[1,0,1] neg_lo:[0,1,0] neg_hi:[0,1,0]
  v_pk_fma_f32 v[154:155], v[54:55], v[72:73], v[154:155] op_sel:[0,0,0] op_sel_hi:[1,0,1] neg_lo:[0,1,0] neg_hi:[0,1,0]
  v_cvt_pk_bf16_f32 v136, v136, v137
  v_cvt_pk_bf16_f32 v137, v138, v139
  v_cvt_pk_bf16_f32 v138, v152, v153
  v_cvt_pk_bf16_f32 v139, v154, v155
  v_pk_fma_f32 v[168:169], v[56:57], v[72:73], v[168:169] op_sel:[0,0,0] op_sel_hi:[1,0,1] neg_lo:[0,1,0] neg_hi:[0,1,0]
  v_pk_fma_f32 v[170:171], v[58:59], v[72:73], v[170:171] op_sel:[0,0,0] op_sel_hi:[1,0,1] neg_lo:[0,1,0] neg_hi:[0,1,0]
  v_pk_fma_f32 v[184:185], v[60:61], v[72:73], v[184:185] op_sel:[0,0,0] op_sel_hi:[1,0,1] neg_lo:[0,1,0] neg_hi:[0,1,0]
  v_pk_fma_f32 v[186:187], v[62:63], v[72:73], v[186:187] op_sel:[0,0,0] op_sel_hi:[1,0,1] neg_lo:[0,1,0] neg_hi:[0,1,0]
  v_cvt_pk_bf16_f32 v168, v168, v169
  v_cvt_pk_bf16_f32 v169, v170, v171
  v_cvt_pk_bf16_f32 v170, v184, v185
  v_cvt_pk_bf16_f32 v171, v186, v187
  v_mfma_f32_16x16x32_bf16 v[148:151], v[164:167], v[132:135], 0
  v_mfma_f32_16x16x32_bf16 v[180:183], v[160:163], v[132:135], 0
  v_pk_fma_f32 v[140:141], v[48:49], v[74:75], v[140:141] op_sel:[0,0,0] op_sel_hi:[1,0,1] neg_lo:[0,1,0] neg_hi:[0,1,0]
  v_pk_fma_f32 v[142:143], v[50:51], v[74:75], v[142:143] op_sel:[0,0,0] op_sel_hi:[1,0,1] neg_lo:[0,1,0] neg_hi:[0,1,0]
  v_pk_fma_f32 v[156:157], v[52:53], v[74:75], v[156:157] op_sel:[0,0,0] op_sel_hi:[1,0,1] neg_lo:[0,1,0] neg_hi:[0,1,0]
  v_pk_fma_f32 v[158:159], v[54:55], v[74:75], v[158:159] op_sel:[0,0,0] op_sel_hi:[1,0,1] neg_lo:[0,1,0] neg_hi:[0,1,0]
  v_cvt_pk_bf16_f32 v140, v140, v141
  v_cvt_pk_bf16_f32 v141, v142, v143
  v_cvt_pk_bf16_f32 v142, v156, v157
  v_cvt_pk_bf16_f32 v143, v158, v159
  v_pk_fma_f32 v[172:173], v[56:57], v[74:75], v[172:173] op_sel:[0,0,0] op_sel_hi:[1,0,1] neg_lo:[0,1,0] neg_hi:[0,1,0]
  v_pk_fma_f32 v[174:175], v[58:59], v[74:75], v[174:175] op_sel:[0,0,0] op_sel_hi:[1,0,1] neg_lo:[0,1,0] neg_hi:[0,1,0]
  v_pk_fma_f32 v[188:189], v[60:61], v[74:75], v[188:189] op_sel:[0,0,0] op_sel_hi:[1,0,1] neg_lo:[0,1,0] neg_hi:[0,1,0]
  v_pk_fma_f32 v[190:191], v[62:63], v[74:75], v[190:191] op_sel:[0,0,0] op_sel_hi:[1,0,1] neg_lo:[0,1,0] neg_hi:[0,1,0]
  v_cvt_pk_bf16_f32 v172, v172, v173
  v_cvt_pk_bf16_f32 v173, v174, v175
  v_cvt_pk_bf16_f32 v174, v188, v189
  v_cvt_pk_bf16_f32 v175, v190, v191
  s_waitcnt lgkmcnt(0)
  v_pk_fma_f32 v[32:33], v[56:57], v[66:67], v[32:33] op_sel:[0,0,0] op_sel_hi:[1,0,1] neg_lo:[0,1,0] neg_hi:[0,1,0]
  v_pk_fma_f32 v[34:35], v[58:59], v[66:67], v[34:35] op_sel:[0,0,0] op_sel_hi:[1,0,1] neg_lo:[0,1,0] neg_hi:[0,1,0]
  v_pk_fma_f32 v[36:37], v[60:61], v[66:67], v[36:37] op_sel:[0,0,0] op_sel_hi:[1,0,1] neg_lo:[0,1,0] neg_hi:[0,1,0]
  v_pk_fma_f32 v[38:39], v[62:63], v[66:67], v[38:39] op_sel:[0,0,0] op_sel_hi:[1,0,1] neg_lo:[0,1,0] neg_hi:[0,1,0]
  v_cvt_pk_bf16_f32 v32, v32, v33
  v_cvt_pk_bf16_f32 v33, v34, v35
  v_cvt_pk_bf16_f32 v34, v36, v37
  v_cvt_pk_bf16_f32 v35, v38, v39
  v_mfma_f32_16x16x32_bf16 v[152:155], v[168:171], v[136:139], 0
  v_mfma_f32_16x16x32_bf16 v[184:187], v[164:167], v[136:139], 0
  v_mfma_f32_16x16x32_bf16 v[156:159], v[172:175], v[140:143], 0
  v_mfma_f32_16x16x32_bf16 v[188:191], v[168:171], v[140:143], 0
  v_mfma_f32_16x16x32_bf16 v[176:179], v[32:35], v[128:131], 0
  v_pk_fma_f32 v[40:41], v[84:85], v[64:65], v[40:41] op_sel:[0,0,0] op_sel_hi:[1,0,1] neg_lo:[1,0,0] neg_hi:[1,0,0]
  v_pk_fma_f32 v[42:43], v[86:87], v[64:65], v[42:43] op_sel:[0,0,0] op_sel_hi:[1,0,1] neg_lo:[1,0,0] neg_hi:[1,0,0]
  v_pk_mul_f32 v[40:41], v[40:41], v[104:105]
  v_pk_mul_f32 v[42:43], v[42:43], v[106:107]
  v_cvt_pk_bf16_f32 v4, v40, v41
  v_cvt_pk_bf16_f32 v5, v42, v43
  v_pk_fma_f32 v[192:193], v[88:89], v[64:65], v[192:193] op_sel:[0,0,0] op_sel_hi:[1,0,1] neg_lo:[1,0,0] neg_hi:[1,0,0]
  v_pk_fma_f32 v[194:195], v[90:91], v[64:65], v[194:195] op_sel:[0,0,0] op_sel_hi:[1,0,1] neg_lo:[1,0,0] neg_hi:[1,0,0]
  v_pk_mul_f32 v[192:193], v[192:193], v[108:109]
  v_pk_mul_f32 v[194:195], v[194:195], v[110:111]
  v_cvt_pk_bf16_f32 v6, v192, v193
  v_cvt_pk_bf16_f32 v7, v194, v195
  v_pk_fma_f32 v[196:197], v[92:93], v[64:65], v[196:197] op_sel:[0,0,0] op_sel_hi:[1,0,1] neg_lo:[1,0,0] neg_hi:[1,0,0]
  v_pk_fma_f32 v[198:199], v[94:95], v[64:65], v[198:199] op_sel:[0,0,0] op_sel_hi:[1,0,1] neg_lo:[1,0,0] neg_hi:[1,0,0]
  v_pk_mul_f32 v[196:197], v[196:197], v[112:113]
  v_pk_mul_f32 v[198:199], v[198:199], v[114:115]
  v_cvt_pk_bf16_f32 v8, v196, v197
  v_cvt_pk_bf16_f32 v9, v198, v199
  v_pk_fma_f32 v[200:201], v[96:97], v[64:65], v[200:201] op_sel:[0,0,0] op_sel_hi:[1,0,1] neg_lo:[1,0,0] neg_hi:[1,0,0]
  v_pk_fma_f32 v[202:203], v[98:99], v[64:65], v[202:203] op_sel:[0,0,0] op_sel_hi:[1,0,1] neg_lo:[1,0,0] neg_hi:[1,0,0]
  v_pk_mul_f32 v[200:201], v[200:201], v[116:117]
  v_pk_mul_f32 v[202:203], v[202:203], v[118:119]
  v_cvt_pk_bf16_f32 v10, v200, v201
  v_cvt_pk_bf16_f32 v11, v202, v203
  v_pk_fma_f32 v[204:205], v[100:101], v[64:65], v[204:205] op_sel:[0,0,0] op_sel_hi:[1,0,1] neg_lo:[1,0,0] neg_hi:[1,0,0]
  v_pk_fma_f32 v[206:207], v[102:103], v[64:65], v[206:207] op_sel:[0,0,0] op_sel_hi:[1,0,1] neg_lo:[1,0,0] neg_hi:[1,0,0]
  v_pk_mul_f32 v[204:205], v[204:205], v[120:121]
  v_pk_mul_f32 v[206:207], v[206:207], v[122:123]
  v_cvt_pk_bf16_f32 v12, v204, v205
  v_cvt_pk_bf16_f32 v13, v206, v207
  v_pk_fma_f32 v[44:45], v[84:85], v[64:65], v[44:45] op_sel:[0,1,0] op_sel_hi:[1,1,1] neg_lo:[1,0,0] neg_hi:[1,0,0]
  v_pk_fma_f32 v[46:47], v[86:87], v[64:65], v[46:47] op_sel:[0,1,0] op_sel_hi:[1,1,1] neg_lo:[1,0,0] neg_hi:[1,0,0]
  v_pk_mul_f32 v[44:45], v[44:45], v[104:105]
  v_pk_mul_f32 v[46:47], v[46:47], v[106:107]
  v_cvt_pk_bf16_f32 v224, v44, v45
  v_cvt_pk_bf16_f32 v225, v46, v47
  v_pk_fma_f32 v[208:209], v[88:89], v[64:65], v[208:209] op_sel:[0,1,0] op_sel_hi:[1,1,1] neg_lo:[1,0,0] neg_hi:[1,0,0]
  v_pk_fma_f32 v[210:211], v[90:91], v[64:65], v[210:211] op_sel:[0,1,0] op_sel_hi:[1,1,1] neg_lo:[1,0,0] neg_hi:[1,0,0]
  v_pk_mul_f32 v[208:209], v[208:209], v[108:109]
  v_pk_mul_f32 v[210:211], v[210:211], v[110:111]
  v_cvt_pk_bf16_f32 v226, v208, v209
  v_cvt_pk_bf16_f32 v227, v210, v211
  v_pk_fma_f32 v[212:213], v[92:93], v[64:65], v[212:213] op_sel:[0,1,0] op_sel_hi:[1,1,1] neg_lo:[1,0,0] neg_hi:[1,0,0]
  v_pk_fma_f32 v[214:215], v[94:95], v[64:65], v[214:215] op_sel:[0,1,0] op_sel_hi:[1,1,1] neg_lo:[1,0,0] neg_hi:[1,0,0]
  v_pk_mul_f32 v[212:213], v[212:213], v[112:113]
  v_pk_mul_f32 v[214:215], v[214:215], v[114:115]
  v_cvt_pk_bf16_f32 v228, v212, v213
  v_cvt_pk_bf16_f32 v229, v214, v215
  v_pk_fma_f32 v[216:217], v[96:97], v[64:65], v[216:217] op_sel:[0,1,0] op_sel_hi:[1,1,1] neg_lo:[1,0,0] neg_hi:[1,0,0]
  v_pk_fma_f32 v[218:219], v[98:99], v[64:65], v[218:219] op_sel:[0,1,0] op_sel_hi:[1,1,1] neg_lo:[1,0,0] neg_hi:[1,0,0]
  v_pk_mul_f32 v[216:217], v[216:217], v[116:117]
  v_pk_mul_f32 v[218:219], v[218:219], v[118:119]
  v_cvt_pk_bf16_f32 v230, v216, v217
  v_cvt_pk_bf16_f32 v231, v218, v219
  v_pk_fma_f32 v[220:221], v[100:101], v[64:65], v[220:221] op_sel:[0,1,0] op_sel_hi:[1,1,1] neg_lo:[1,0,0] neg_hi:[1,0,0]
  v_pk_fma_f32 v[222:223], v[102:103], v[64:65], v[222:223] op_sel:[0,1,0] op_sel_hi:[1,1,1] neg_lo:[1,0,0] neg_hi:[1,0,0]
  v_pk_mul_f32 v[220:221], v[220:221], v[120:121]
  v_pk_mul_f32 v[222:223], v[222:223], v[122:123]
  v_cvt_pk_bf16_f32 v232, v220, v221
  v_cvt_pk_bf16_f32 v233, v222, v223
  v_cndmask_b32 v148, v148, v149, s[48:49]
  v_cndmask_b32 v180, v180, v181, s[48:49]
  v_cndmask_b32 v150, v150, v151, s[48:49]
  v_cndmask_b32 v182, v182, v183, s[48:49]
  v_cndmask_b32 v36, v148, v180, s[50:51]
  v_cndmask_b32 v37, v150, v182, s[52:53]
  v_mul_f32 v36, v36, v77
  v_mul_f32 v37, v37, v81
  v_cndmask_b32 v152, v152, v153, s[48:49]
  v_cndmask_b32 v184, v184, v185, s[48:49]
  v_cndmask_b32 v154, v154, v155, s[48:49]
  v_cndmask_b32 v186, v186, v187, s[48:49]
  v_cndmask_b32 v40, v152, v184, s[50:51]
  v_cndmask_b32 v41, v154, v186, s[52:53]
  v_mul_f32 v40, v40, v78
  v_mul_f32 v41, v41, v82
  v_cndmask_b32 v156, v156, v157, s[48:49]
  v_cndmask_b32 v188, v188, v189, s[48:49]
  v_cndmask_b32 v158, v158, v159, s[48:49]
  v_cndmask_b32 v190, v190, v191, s[48:49]
  v_cndmask_b32 v44, v156, v188, s[50:51]
  v_cndmask_b32 v45, v158, v190, s[52:53]
  v_mul_f32 v44, v44, v79
  v_mul_f32 v45, v45, v83
  v_cndmask_b32 v144, v144, v145, s[48:49]
  v_cndmask_b32 v176, v176, v177, s[48:49]
  v_cndmask_b32 v146, v146, v147, s[48:49]
  v_cndmask_b32 v178, v178, v179, s[48:49]
  v_cndmask_b32 v32, v144, v176, s[50:51]
  v_cndmask_b32 v33, v146, v178, s[52:53]
  v_mul_f32 v32, v32, v76
  v_mul_f32 v33, v33, v80
  v_mov_b32 v48, 0xceabfb8f
  v_cndmask_b32 v32, v32, v48, s[54:55]
  v_cndmask_b32 v33, v33, v48, s[14:15]
  v_max_f32 v34, v32, v33
  v_max_f32 v38, v36, v37
  v_max_f32 v42, v40, v41
  v_max_f32 v46, v44, v45
  v_mov_b32 v35, v34
  v_mov_b32 v39, v38
  v_mov_b32 v43, v42
  v_mov_b32 v47, v46
  v_permlane32_swap_b32 v34, v35
  v_permlane32_swap_b32 v38, v39
  v_permlane32_swap_b32 v42, v43
  v_permlane32_swap_b32 v46, v47
  v_max_f32 v34, v34, v35
  v_max_f32 v38, v38, v39
  v_max_f32 v42, v42, v43
  v_max_f32 v46, v46, v47
  v_mov_b32 v35, v34
  v_mov_b32 v39, v38
  v_mov_b32 v43, v42
  v_mov_b32 v47, v46
  v_permlane16_swap_b32 v34, v35
  v_permlane16_swap_b32 v38, v39
  v_permlane16_swap_b32 v42, v43
  v_permlane16_swap_b32 v46, v47
  v_max_f32 v34, v34, v35
  v_max_f32 v38, v38, v39
  v_max_f32 v42, v42, v43
  v_max_f32 v46, v46, v47
  v_sub_f32 v32, v32, v34
  v_sub_f32 v33, v33, v34
  v_sub_f32 v36, v36, v38
  v_sub_f32 v37, v37, v38
  v_sub_f32 v40, v40, v42
  v_sub_f32 v41, v41, v42
  v_sub_f32 v44, v44, v46
  v_sub_f32 v45, v45, v46
  v_exp_f32 v32, v32
  v_exp_f32 v33, v33
  v_exp_f32 v36, v36
  v_exp_f32 v37, v37
  v_exp_f32 v40, v40
  v_exp_f32 v41, v41
  v_exp_f32 v44, v44
  v_exp_f32 v45, v45
  v_cvt_pk_bf16_f32 v32, v32, v32
  v_cvt_pk_bf16_f32 v33, v33, v33
  v_and_b32 v128, v32, v27
  v_and_b32 v129, v33, v29
  v_and_b32 v130, v32, v28
  v_and_b32 v131, v33, v30
  v_cvt_pk_bf16_f32 v36, v36, v36
  v_cvt_pk_bf16_f32 v37, v37, v37
  v_and_b32 v132, v36, v27
  v_and_b32 v133, v37, v29
  v_and_b32 v134, v36, v28
  v_and_b32 v135, v37, v30
  v_mfma_f32_16x16x32_bf16 v[144:147], v[236:239], v[128:131], 0
  v_mfma_f32_16x16x32_bf16 v[192:195], v[4:7], v[128:131], 0
  v_mfma_f32_16x16x32_bf16 v[208:211], v[224:227], v[128:131], 0
  v_cvt_pk_bf16_f32 v40, v40, v40
  v_cvt_pk_bf16_f32 v41, v41, v41
  v_and_b32 v136, v40, v27
  v_and_b32 v137, v41, v29
  v_and_b32 v138, v40, v28
  v_and_b32 v139, v41, v30
  v_mfma_f32_16x16x32_bf16 v[148:151], v[236:239], v[132:135], 0
  v_mfma_f32_16x16x32_bf16 v[196:199], v[6:9], v[132:135], 0
  v_mfma_f32_16x16x32_bf16 v[212:215], v[226:229], v[132:135], 0
  v_cvt_pk_bf16_f32 v44, v44, v44
  v_cvt_pk_bf16_f32 v45, v45, v45
  v_and_b32 v140, v44, v27
  v_and_b32 v141, v45, v29
  v_and_b32 v142, v44, v28
  v_and_b32 v143, v45, v30
  v_mfma_f32_16x16x32_bf16 v[152:155], v[236:239], v[136:139], 0
  v_mfma_f32_16x16x32_bf16 v[200:203], v[8:11], v[136:139], 0
  v_mfma_f32_16x16x32_bf16 v[216:219], v[228:231], v[136:139], 0
  v_mfma_f32_16x16x32_bf16 v[156:159], v[236:239], v[140:143], 0
  v_mfma_f32_16x16x32_bf16 v[204:207], v[10:13], v[140:143], 0
  v_mfma_f32_16x16x32_bf16 v[220:223], v[230:233], v[140:143], 0
  v_rcp_f32 v144, v144
  s_mov_b32 s3, 0
  v_pk_mul_f32 v[192:193], v[192:193], v[144:145] op_sel_hi:[1,0]
  v_pk_mul_f32 v[194:195], v[194:195], v[144:145] op_sel_hi:[1,0]
  v_pk_mul_f32 v[208:209], v[208:209], v[144:145] op_sel_hi:[1,0]
  v_pk_mul_f32 v[210:211], v[210:211], v[144:145] op_sel_hi:[1,0]
  v_cvt_pk_bf16_f32 v48, v192, v193
  v_cvt_pk_bf16_f32 v49, v194, v195
  v_cvt_pk_bf16_f32 v50, v208, v209
  v_cvt_pk_bf16_f32 v51, v210, v211
  s_nop 1
  v_permlane16_swap_b32 v48, v50
  v_permlane16_swap_b32 v49, v51
  buffer_store_dwordx4 v[48:51], v31, s[44:47], s3 offen sc1
  v_rcp_f32 v148, v148
  s_mov_b32 s3, 32768
  v_pk_mul_f32 v[196:197], v[196:197], v[148:149] op_sel_hi:[1,0]
  v_pk_mul_f32 v[198:199], v[198:199], v[148:149] op_sel_hi:[1,0]
  v_pk_mul_f32 v[212:213], v[212:213], v[148:149] op_sel_hi:[1,0]
  v_pk_mul_f32 v[214:215], v[214:215], v[148:149] op_sel_hi:[1,0]
  v_cvt_pk_bf16_f32 v52, v196, v197
  v_cvt_pk_bf16_f32 v53, v198, v199
  v_cvt_pk_bf16_f32 v54, v212, v213
  v_cvt_pk_bf16_f32 v55, v214, v215
  s_nop 1
  v_permlane16_swap_b32 v52, v54
  v_permlane16_swap_b32 v53, v55
  buffer_store_dwordx4 v[52:55], v31, s[44:47], s3 offen sc1
  v_rcp_f32 v152, v152
  s_mov_b32 s3, 65536
  v_pk_mul_f32 v[200:201], v[200:201], v[152:153] op_sel_hi:[1,0]
  v_pk_mul_f32 v[202:203], v[202:203], v[152:153] op_sel_hi:[1,0]
  v_pk_mul_f32 v[216:217], v[216:217], v[152:153] op_sel_hi:[1,0]
  v_pk_mul_f32 v[218:219], v[218:219], v[152:153] op_sel_hi:[1,0]
  v_cvt_pk_bf16_f32 v56, v200, v201
  v_cvt_pk_bf16_f32 v57, v202, v203
  v_cvt_pk_bf16_f32 v58, v216, v217
  v_cvt_pk_bf16_f32 v59, v218, v219
  s_nop 1
  v_permlane16_swap_b32 v56, v58
  v_permlane16_swap_b32 v57, v59
  buffer_store_dwordx4 v[56:59], v31, s[44:47], s3 offen sc1
  v_rcp_f32 v156, v156
  s_mov_b32 s3, 98304
  v_pk_mul_f32 v[204:205], v[204:205], v[156:157] op_sel_hi:[1,0]
  v_pk_mul_f32 v[206:207], v[206:207], v[156:157] op_sel_hi:[1,0]
  v_pk_mul_f32 v[220:221], v[220:221], v[156:157] op_sel_hi:[1,0]
  v_pk_mul_f32 v[222:223], v[222:223], v[156:157] op_sel_hi:[1,0]
  v_cvt_pk_bf16_f32 v60, v204, v205
  v_cvt_pk_bf16_f32 v61, v206, v207
  v_cvt_pk_bf16_f32 v62, v220, v221
  v_cvt_pk_bf16_f32 v63, v222, v223
  s_nop 1
  v_permlane16_swap_b32 v60, v62
  v_permlane16_swap_b32 v61, v63
  buffer_store_dwordx4 v[60:63], v31, s[44:47], s3 offen sc1
  s_waitcnt vmcnt(0) lgkmcnt(0)
  s_barrier
  s_add_u32 s97, s97, 1
  s_branch L_wo_body
.section .rodata,"a"
.p2align 6
.amdhsa_kernel interleave_layers__sliding_local_dilated__dense_activation_gelu__prompt_kernel
  .amdhsa_next_free_vgpr 256
  .amdhsa_next_free_sgpr 102
  .amdhsa_accum_offset 256
  .amdhsa_group_segment_fixed_size 0
  .amdhsa_kernarg_size 88
  .amdhsa_user_sgpr_count 2
  .amdhsa_user_sgpr_kernarg_segment_ptr 1
  .amdhsa_system_sgpr_workgroup_id_x 1
  .amdhsa_float_denorm_mode_32 3
  .amdhsa_float_denorm_mode_16_64 3
.end_amdhsa_kernel
.text
L_attn_c1:
L_wo_c0:
L_wo_body:
  s_cmp_ge_u32 s2, 256
  s_cbranch_scc1 L_wo_end
  v_lshrrev_b32 v2, 6, v0
  v_and_b32 v1, 63, v0
  v_readfirstlane_b32 s70, v2
  s_and_b32 s3, s2, 7
  s_lshr_b32 s99, s2, 3
  s_and_b32 s5, s3, 3
  s_lshl_b32 s5, s5, 2
  s_and_b32 s6, s99, 3
  s_add_u32 s68, s5, s6
  s_lshr_b32 s5, s3, 2
  s_lshr_b32 s78, s99, 2
  s_lshl1_add_u32 s69, s78, s5
  s_add_u32 s3, s68, s78
  s_lshl_b32 s3, s3, 3
  s_lshl_b32 s85, 0xffff02, s3
  s_sub_u32 s3, 0, s3
  s_lshr_b32 s3, 0xffff02, s3
  s_or_b32 s85, s85, s3
  s_cmp_lt_u32 s70, 4
  s_cbranch_scc1 L_wo_compute
L_wo_loader:
  s_add_u32 s3, s96, s70
  s_cmp_lg_u32 s3, 4
  s_cbranch_scc1 L_wo_chk0
  s_load_dwordx2 s[64:65], s[0:1], 72
  s_waitcnt lgkmcnt(0)
  s_and_b32 s65, s65, 0xffff
  s_mov_b32 s66, 256
  s_mov_b32 s67, 0x00020000
  v_lshlrev_b32 v17, 2, v1
  buffer_load_dword v12, v17, s[64:67], 0 offen sc1
L_wo_chk0:
  s_cmp_lg_u32 s96, 0
  s_cbranch_scc1 L_wo_nofirst
  s_waitcnt vmcnt(1)
  s_mov_b32 s7, 0xffff0000
  v_lshlrev_b32 v32, 16, v64
  v_and_b32 v33, s7, v64
  v_lshlrev_b32 v34, 16, v65
  v_and_b32 v35, s7, v65
  v_lshlrev_b32 v36, 16, v66
  v_and_b32 v37, s7, v66
  v_lshlrev_b32 v38, 16, v67
  v_and_b32 v39, s7, v67
  v_lshlrev_b32 v40, 16, v68
  v_and_b32 v41, s7, v68
  v_pk_add_f32 v[32:33], v[32:33], v[40:41]
  v_lshlrev_b32 v40, 16, v69
  v_and_b32 v41, s7, v69
  v_pk_add_f32 v[34:35], v[34:35], v[40:41]
  v_lshlrev_b32 v40, 16, v70
  v_and_b32 v41, s7, v70
  v_pk_add_f32 v[36:37], v[36:37], v[40:41]
  v_lshlrev_b32 v40, 16, v71
  v_and_b32 v41, s7, v71
  v_pk_add_f32 v[38:39], v[38:39], v[40:41]
  v_lshlrev_b32 v40, 16, v72
  v_and_b32 v41, s7, v72
  v_pk_add_f32 v[32:33], v[32:33], v[40:41]
  v_lshlrev_b32 v40, 16, v73
  v_and_b32 v41, s7, v73
  v_pk_add_f32 v[34:35], v[34:35], v[40:41]
  v_lshlrev_b32 v40, 16, v74
  v_and_b32 v41, s7, v74
  v_pk_add_f32 v[36:37], v[36:37], v[40:41]
  v_lshlrev_b32 v40, 16, v75
  v_and_b32 v41, s7, v75
  v_pk_add_f32 v[38:39], v[38:39], v[40:41]
  v_lshlrev_b32 v40, 16, v76
  v_and_b32 v41, s7, v76
  v_pk_add_f32 v[32:33], v[32:33], v[40:41]
  v_lshlrev_b32 v40, 16, v77
  v_and_b32 v41, s7, v77
  v_pk_add_f32 v[34:35], v[34:35], v[40:41]
  v_lshlrev_b32 v40, 16, v78
  v_and_b32 v41, s7, v78
  v_pk_add_f32 v[36:37], v[36:37], v[40:41]
  v_lshlrev_b32 v40, 16, v79
  v_and_b32 v41, s7, v79
  v_pk_add_f32 v[38:39], v[38:39], v[40:41]
  v_lshlrev_b32 v40, 16, v80
  v_and_b32 v41, s7, v80
  v_pk_add_f32 v[32:33], v[32:33], v[40:41]
  v_lshlrev_b32 v40, 16, v81
  v_and_b32 v41, s7, v81
  v_pk_add_f32 v[34:35], v[34:35], v[40:41]
  v_lshlrev_b32 v40, 16, v82
  v_and_b32 v41, s7, v82
  v_pk_add_f32 v[36:37], v[36:37], v[40:41]
  v_lshlrev_b32 v40, 16, v83
  v_and_b32 v41, s7, v83
  v_pk_add_f32 v[38:39], v[38:39], v[40:41]
  v_lshlrev_b32 v40, 16, v84
  v_and_b32 v41, s7, v84
  v_pk_add_f32 v[32:33], v[32:33], v[40:41]
  v_lshlrev_b32 v40, 16, v85
  v_and_b32 v41, s7, v85
  v_pk_add_f32 v[34:35], v[34:35], v[40:41]
  v_lshlrev_b32 v40, 16, v86
  v_and_b32 v41, s7, v86
  v_pk_add_f32 v[36:37], v[36:37], v[40:41]
  v_lshlrev_b32 v40, 16, v87
  v_and_b32 v41, s7, v87
  v_pk_add_f32 v[38:39], v[38:39], v[40:41]
  v_lshlrev_b32 v40, 16, v88
  v_and_b32 v41, s7, v88
  v_pk_add_f32 v[32:33], v[32:33], v[40:41]
  v_lshlrev_b32 v40, 16, v89
  v_and_b32 v41, s7, v89
  v_pk_add_f32 v[34:35], v[34:35], v[40:41]
  v_lshlrev_b32 v40, 16, v90
  v_and_b32 v41, s7, v90
  v_pk_add_f32 v[36:37], v[36:37], v[40:41]
  v_lshlrev_b32 v40, 16, v91
  v_and_b32 v41, s7, v91
  v_pk_add_f32 v[38:39], v[38:39], v[40:41]
  v_lshlrev_b32 v40, 16, v92
  v_and_b32 v41, s7, v92
  v_pk_add_f32 v[32:33], v[32:33], v[40:41]
  v_lshlrev_b32 v40, 16, v93
  v_and_b32 v41, s7, v93
  v_pk_add_f32 v[34:35], v[34:35], v[40:41]
  v_lshlrev_b32 v40, 16, v94
  v_and_b32 v41, s7, v94
  v_pk_add_f32 v[36:37], v[36:37], v[40:41]
  v_lshlrev_b32 v40, 16, v95
  v_and_b32 v41, s7, v95
  v_pk_add_f32 v[38:39], v[38:39], v[40:41]
  s_add_u32 s52, s22, 24641536
  s_addc_u32 s53, s23, 0
  s_and_b32 s53, s53, 0xffff
  s_mov_b32 s54, 262144
  s_mov_b32 s55, 0x00020000
  v_permlane32_swap_b32 v32, v36
  v_permlane32_swap_b32 v33, v37
  v_permlane32_swap_b32 v34, v38
  v_permlane32_swap_b32 v35, v39
  v_add_f32 v32, v32, v36
  v_add_f32 v33, v33, v37
  v_add_f32 v34, v34, v38
  v_add_f32 v35, v35, v39
  v_and_b32 v2, 7, v1
  v_lshlrev_b32 v2, 5, v2
  v_permlane16_swap_b32 v32, v34
  v_permlane16_swap_b32 v33, v35
  v_add_f32 v32, v32, v34
  v_add_f32 v33, v33, v35
  v_lshrrev_b32 v3, 4, v1
  v_lshl_add_u32 v2, v3, 3, v2
  v_add_f32_dpp v32, v32, v32 row_ror:8 row_mask:0xf bank_mask:0xf
  v_add_f32_dpp v33, v33, v33 row_ror:8 row_mask:0xf bank_mask:0xf
  buffer_store_dwordx2 v[32:33], v2, s[52:55], s94 offen sc1
L_wo_nofirst:
  v_and_b32 v2, 3, v1
  v_lshlrev_b32 v2, 3, v2
  v_bfe_i32 v16, s85, v2, 8
  s_and_b32 s3, s68, 3
  s_mul_i32 s4, s3, 4
  v_add3_u32 v3, v16, v1, s4
  v_and_b32 v3, 15, v3
  v_lshlrev_b32 v16, 17, v3
  s_add_u32 s9, s70, s68
  s_and_b32 s9, s9, 3
  s_lshl_b32 s77, s9, 11
  v_and_b32 v10, 7, v1
  v_lshrrev_b32 v3, 3, v1
  s_lshl_b32 s10, s9, 4
  v_add_u32 v3, s10, v3
  v_mul_u32_u24 v3, 2048, v3
  v_lshrrev_b32 v2, 3, v1
  v_and_b32 v2, 2, v2
  v_xor_b32 v2, v2, v10
  s_lshl_b32 s10, s69, 7
  v_add_u32 v3, s10, v3
  v_lshl_add_u32 v8, v2, 4, v3
  v_xor_b32 v2, 4, v2
  v_add_u32 v3, 16384, v3
  v_lshl_add_u32 v9, v2, 4, v3
  s_mov_b32 s40, s20
  s_and_b32 s41, s21, 0xffff
  s_mov_b32 s42, 2097152
  s_mov_b32 s43, 0x00020000
  v_readlane_b32 s74, v16, 0
  s_add_u32 m0, s77, 28672
  s_add_u32 s4, s74, 0
  buffer_load_dwordx4 v8, s[40:43], s4 offen lds
  s_add_u32 m0, s77, 29696
  s_nop 0
  buffer_load_dwordx4 v9, s[40:43], s4 offen lds
  v_readlane_b32 s74, v16, 1
  s_add_u32 m0, s77, 36864
  s_add_u32 s4, s74, 0
  buffer_load_dwordx4 v8, s[40:43], s4 offen lds
  s_add_u32 m0, s77, 37888
  s_nop 0
  buffer_load_dwordx4 v9, s[40:43], s4 offen lds
  v_readlane_b32 s74, v16, 2
  s_add_u32 m0, s77, 45056
  s_add_u32 s4, s74, 0
  buffer_load_dwordx4 v8, s[40:43], s4 offen lds
  s_add_u32 m0, s77, 46080
  s_nop 0
  buffer_load_dwordx4 v9, s[40:43], s4 offen lds
  v_readlane_b32 s74, v16, 3
  s_add_u32 m0, s77, 53248
  s_add_u32 s4, s74, 0
  buffer_load_dwordx4 v8, s[40:43], s4 offen lds
  s_add_u32 m0, s77, 54272
  s_nop 0
  buffer_load_dwordx4 v9, s[40:43], s4 offen lds
  v_readlane_b32 s74, v16, 4
  s_add_u32 m0, s77, 61440
  s_add_u32 s4, s74, 0
  buffer_load_dwordx4 v8, s[40:43], s4 offen lds
  s_add_u32 m0, s77, 62464
  s_nop 0
  buffer_load_dwordx4 v9, s[40:43], s4 offen lds
  v_readlane_b32 s74, v16, 5
  s_add_u32 m0, s77, 69632
  s_add_u32 s4, s74, 0
  buffer_load_dwordx4 v8, s[40:43], s4 offen lds
  s_add_u32 m0, s77, 70656
  s_nop 0
  buffer_load_dwordx4 v9, s[40:43], s4 offen lds
  s_waitcnt vmcnt(12)
  s_add_u32 s3, s96, s70
  s_cmp_lg_u32 s3, 4
  s_cbranch_scc1 L_wo_chk1
  v_cmp_ne_u32 vcc, 0x01010101, v12
  s_cbranch_vccz L_wo_chk1
  s_load_dwordx2 s[64:65], s[0:1], 72
  s_waitcnt lgkmcnt(0)
  s_and_b32 s65, s65, 0xffff
  s_mov_b32 s66, 256
  s_mov_b32 s67, 0x00020000
  v_lshlrev_b32 v17, 2, v1
  s_mov_b32 s79, 0x100000
L_wo_chkl:
  buffer_load_dword v12, v17, s[64:67], 0 offen sc1
  s_sub_u32 s79, s79, 1
  s_cbranch_scc1 L_wo_chk1
  s_waitcnt vmcnt(0)
  v_cmp_ne_u32 vcc, 0x01010101, v12
  s_cbranch_vccnz L_wo_chkl
L_wo_chk1:
  s_add_u32 s44, s22, 41943040
  s_addc_u32 s45, s23, 0
  s_and_b32 s45, s45, 0xffff
  s_mov_b32 s46, 524288
  s_mov_b32 s47, 0x00020000
  s_lshl4_add_u32 s3, s97, s68
  s_and_b32 s4, s69, 15
  s_lshl4_add_u32 s3, s3, s4
  s_lshl_b32 s3, s3, 7
  s_sub_u32 s3, s3, 32768
  v_lshlrev_b32 v11, 7, v1
  v_and_b32 v2, 15, v1
  v_lshlrev_b32 v2, 2, v2
  v_mov_b32 v3, 1
  s_mov_b32 s79, 0x100000
  s_cmp_lg_u32 s70, 4
  s_barrier
  s_cbranch_scc1 L_wo_nofl
  s_mov_b32 exec_lo, 0xffff
  s_mov_b32 exec_hi, 0
  buffer_store_dword v3, v11, s[44:47], s87 offen sc1
  s_mov_b64 exec, -1
L_wo_nofl:
  s_mov_b32 s5, s3
  v_readlane_b32 s74, v16, 6
  s_add_u32 m0, s77, 77824
  s_add_u32 s4, s74, 0
  buffer_load_dwordx4 v8, s[40:43], s4 offen lds
  s_add_u32 m0, s77, 78848
  s_nop 0
  buffer_load_dwordx4 v9, s[40:43], s4 offen lds
  v_readlane_b32 s74, v16, 7
  s_add_u32 m0, s77, 86016
  s_add_u32 s4, s74, 0
  buffer_load_dwordx4 v8, s[40:43], s4 offen lds
  s_add_u32 m0, s77, 87040
  s_nop 0
  buffer_load_dwordx4 v9, s[40:43], s4 offen lds
  v_readlane_b32 s74, v16, 8
  s_add_u32 m0, s77, 94208
  s_add_u32 s4, s74, 0
  buffer_load_dwordx4 v8, s[40:43], s4 offen lds
  s_add_u32 m0, s77, 95232
  s_nop 0
  buffer_load_dwordx4 v9, s[40:43], s4 offen lds
  v_readlane_b32 s74, v16, 9
  s_add_u32 m0, s77, 102400
  s_add_u32 s4, s74, 0
  buffer_load_dwordx4 v8, s[40:43], s4 offen lds
  s_add_u32 m0, s77, 103424
  s_nop 0
  buffer_load_dwordx4 v9, s[40:43], s4 offen lds
  v_readlane_b32 s74, v16, 10
  s_add_u32 m0, s77, 110592
  s_add_u32 s4, s74, 0
  buffer_load_dwordx4 v8, s[40:43], s4 offen lds
  s_add_u32 m0, s77, 111616
  s_nop 0
  buffer_load_dwordx4 v9, s[40:43], s4 offen lds
  v_readlane_b32 s74, v16, 11
  s_add_u32 m0, s77, 118784
  s_add_u32 s4, s74, 0
  buffer_load_dwordx4 v8, s[40:43], s4 offen lds
  s_add_u32 m0, s77, 119808
  s_nop 0
  buffer_load_dwordx4 v9, s[40:43], s4 offen lds
  v_readlane_b32 s74, v16, 12
  s_add_u32 m0, s77, 131072
  s_add_u32 s4, s74, 0
  buffer_load_dwordx4 v8, s[40:43], s4 offen lds
  s_add_u32 m0, s77, 132096
  s_nop 0
  buffer_load_dwordx4 v9, s[40:43], s4 offen lds
  v_readlane_b32 s74, v16, 13
  s_add_u32 m0, s77, 139264
  s_add_u32 s4, s74, 0
  buffer_load_dwordx4 v8, s[40:43], s4 offen lds
  s_add_u32 m0, s77, 140288
  s_nop 0
  buffer_load_dwordx4 v9, s[40:43], s4 offen lds
  v_readlane_b32 s74, v16, 14
  s_add_u32 m0, s77, 147456
  s_add_u32 s4, s74, 0
  buffer_load_dwordx4 v8, s[40:43], s4 offen lds
  s_add_u32 m0, s77, 148480
  s_nop 0
  buffer_load_dwordx4 v9, s[40:43], s4 offen lds
  v_readlane_b32 s74, v16, 15
  s_add_u32 m0, s77, 155648
  s_add_u32 s4, s74, 0
  buffer_load_dwordx4 v8, s[40:43], s4 offen lds
  s_add_u32 m0, s77, 156672
  s_nop 0
  buffer_load_dwordx4 v9, s[40:43], s4 offen lds
  s_mov_b32 s3, s5
  s_cmp_lg_u32 s70, 4
  s_cbranch_scc1 L_wo_dep
L_wo_poll:
  buffer_load_dword v3, v2, s[44:47], s3 offen sc1
  s_sub_u32 s79, s79, 1
  s_cbranch_scc1 L_wo_dep
  s_waitcnt vmcnt(0)
  v_cmp_ne_u32 vcc, 1, v3
  s_cbranch_vccnz L_wo_poll
L_wo_dep:
  s_waitcnt vmcnt(22) lgkmcnt(0)
  s_barrier
  s_waitcnt vmcnt(8)
  s_barrier
  s_waitcnt vmcnt(0)
  s_barrier
  s_waitcnt vmcnt(0)
  s_lshl_b32 s87, s97, 15
  s_lshl_b32 s4, s68, 11
  s_add_u32 s87, s87, s4
  s_lshl_b32 s4, s69, 2
  s_add_u32 s87, s87, s4
  s_add_u32 s97, s97, 1
  s_branch L_w1_body
L_wo_end:
  s_endpgm
L_wo_compute:
  v_and_b32 v2, 3, v1
  v_lshlrev_b32 v2, 3, v2
  v_bfe_i32 v15, s85, v2, 8
  s_and_b32 s3, s68, 3
  s_mul_i32 s4, s3, 4
  v_add3_u32 v3, v15, v1, s4
  v_and_b32 v3, 15, v3
  v_lshlrev_b32 v15, 11, v3
  v_and_b32 v3, 15, v1
  v_lshrrev_b32 v2, 4, v1
  s_lshl_b32 s8, s68, 7
  s_lshl_b32 s9, s70, 5
  s_add_u32 s8, s8, s9
  s_mul_i32 s9, s8, 2048
  v_add_u32 v13, s8, v3
  s_lshl_b32 s10, s69, 7
  v_lshl_add_u32 v14, v2, 3, s10
  v_and_b32 v16, 1, v2
  v_lshrrev_b32 v17, 1, v2
  v_lshl_add_u32 v16, v16, 1, v17
  v_lshlrev_b32 v16, 8, v16
  v_lshl_add_u32 v16, v3, 4, v16
  s_add_u32 s9, s8, s69
  s_lshl_b32 s9, s9, 11
  v_add_u32 v12, s9, v16
  s_lshl_b32 s9, s70, 12
  v_add_u32 v19, s9, v16
  v_lshl_add_u32 v18, v17, 4, v13
  v_lshlrev_b32 v18, 3, v18
  v_and_b32 v16, 1, v2
  v_lshl_add_u32 v18, v16, 2, v18
  s_lshl_b32 s10, s69, 14
  v_add_u32 v18, s10, v18
  v_bfe_u32 v6, v1, 2, 2
  v_lshl_add_u32 v6, v2, 3, v6
  v_lshlrev_b32 v6, 7, v6
  v_and_b32 v17, 3, v1
  v_lshl_add_u32 v6, v17, 3, v6
  v_bfe_u32 v17, v1, 3, 2
  v_lshl_add_u32 v6, v17, 5, v6
  v_xor_b32 v7, 32, v6
  v_xor_b32 v8, 64, v6
  v_xor_b32 v9, 96, v6
  s_mov_b32 s11, 0xffff0000
  s_mov_b32 s36, s34
  s_and_b32 s37, s35, 0xffff
  s_mov_b32 s38, 4194304
  s_mov_b32 s39, 0x00020000
  s_add_u32 s44, s34, 4194304
  s_addc_u32 s45, s35, 0
  s_and_b32 s45, s45, 0xffff
  s_mov_b32 s46, 4194304
  s_mov_b32 s47, 0x00020000
  s_add_u32 s56, s34, 24117248
  s_addc_u32 s57, s35, 0
  s_and_b32 s57, s57, 0xffff
  s_mov_b32 s58, 262144
  s_mov_b32 s59, 0x00020000
  s_mul_i32 s9, s8, 2048
  s_add_u32 s36, s36, s9
  s_addc_u32 s37, s37, 0x100000
  s_add_u32 s64, s36, 32768
  s_addc_u32 s65, s37, 0
  s_mov_b32 s38, 32768
  s_mov_b32 s39, 0x00800000
  s_mov_b32 s66, 32768
  s_mov_b32 s67, 0x00800000
  s_cmp_lg_u32 s96, 0
  s_cbranch_scc1 L_pfc2_skip
  s_getpc_b64 s[4:5]
L_pfc2:
  s_lshl_b32 s3, s99, 2
  s_add_u32 s3, s3, s70
  s_mul_i32 s3, s3, 128
  s_min_u32 s3, s3, L_w1_c1-L_w1_c0-128
  s_add_i32 s3, s3, L_w1_c0-L_pfc2
  s_ashr_i32 s6, s3, 31
  s_add_u32 s4, s4, s3
  s_addc_u32 s5, s5, s6
  s_load_dword s40, s[4:5], 0
  s_load_dword s41, s[4:5], 64
L_pfc2_skip:
  v_add_u32 v26, 155648, v6
  v_add_u32 v27, 155648, v7
  v_add_u32 v28, 155648, v8
  v_add_u32 v29, 155648, v9
  v_add_u32 v20, 94208, v6
  v_add_u32 v21, 94208, v7
  v_add_u32 v22, 94208, v8
  v_add_u32 v23, 94208, v9
  v_add_u32 v6, 28672, v6
  v_add_u32 v7, 28672, v7
  v_add_u32 v8, 28672, v8
  v_add_u32 v9, 28672, v9
  v_readlane_b32 s48, v15, 0
  v_readlane_b32 s49, v15, 1
  v_readlane_b32 s50, v15, 2
  v_permlane16_swap_b32 v240, v242
  v_permlane16_swap_b32 v241, v243
  v_permlane16_swap_b32 v244, v246
  v_permlane16_swap_b32 v245, v247
  v_permlane16_swap_b32 v248, v250
  v_permlane16_swap_b32 v249, v251
  v_permlane16_swap_b32 v252, v254
  v_permlane16_swap_b32 v253, v255
  s_waitcnt lgkmcnt(0)
  s_barrier
  buffer_load_dwordx4 v[32:35], off, s[36:39], s48 offset:0
  buffer_load_dwordx4 v[36:39], off, s[64:67], s48 offset:0
  buffer_load_dwordx4 v[40:43], off, s[36:39], s48 offset:1024
  buffer_load_dwordx4 v[44:47], off, s[64:67], s48 offset:1024
  buffer_load_dwordx4 v[48:51], off, s[36:39], s49 offset:0
  buffer_load_dwordx4 v[52:55], off, s[64:67], s49 offset:0
  buffer_load_dwordx4 v[56:59], off, s[36:39], s49 offset:1024
  buffer_load_dwordx4 v[60:63], off, s[64:67], s49 offset:1024
  buffer_load_dwordx4 v[64:67], off, s[36:39], s50 offset:0
  buffer_load_dwordx4 v[68:71], off, s[64:67], s50 offset:0
  buffer_load_dwordx4 v[72:75], off, s[36:39], s50 offset:1024
  buffer_load_dwordx4 v[76:79], off, s[64:67], s50 offset:1024
  ds_read_b64_tr_b16 v[160:161], v6 offset:0
  ds_read_b64_tr_b16 v[162:163], v6 offset:512
  ds_read_b64_tr_b16 v[164:165], v7 offset:0
  ds_read_b64_tr_b16 v[166:167], v7 offset:512
  ds_read_b64_tr_b16 v[168:169], v8 offset:0
  ds_read_b64_tr_b16 v[170:171], v8 offset:512
  ds_read_b64_tr_b16 v[172:173], v9 offset:0
  ds_read_b64_tr_b16 v[174:175], v9 offset:512
  ds_read_b64_tr_b16 v[176:177], v6 offset:4096
  ds_read_b64_tr_b16 v[178:179], v6 offset:4608
  ds_read_b64_tr_b16 v[180:181], v7 offset:4096
  ds_read_b64_tr_b16 v[182:183], v7 offset:4608
  ds_read_b64_tr_b16 v[184:185], v8 offset:4096
  ds_read_b64_tr_b16 v[186:187], v8 offset:4608
  ds_read_b64_tr_b16 v[188:189], v9 offset:4096
  ds_read_b64_tr_b16 v[190:191], v9 offset:4608
  v_lshlrev_b32 v96, 16, v240
  v_and_b32 v97, s11, v240
  v_lshlrev_b32 v98, 16, v241
  v_and_b32 v99, s11, v241
  v_lshlrev_b32 v100, 16, v248
  v_and_b32 v101, s11, v248
  v_lshlrev_b32 v102, 16, v249
  v_and_b32 v103, s11, v249
  v_lshlrev_b32 v104, 16, v242
  v_and_b32 v105, s11, v242
  v_lshlrev_b32 v106, 16, v243
  v_and_b32 v107, s11, v243
  v_lshlrev_b32 v108, 16, v250
  v_and_b32 v109, s11, v250
  v_lshlrev_b32 v110, 16, v251
  v_and_b32 v111, s11, v251
  v_lshlrev_b32 v112, 16, v244
  v_and_b32 v113, s11, v244
  v_lshlrev_b32 v114, 16, v245
  v_and_b32 v115, s11, v245
  v_lshlrev_b32 v116, 16, v252
  v_and_b32 v117, s11, v252
  v_lshlrev_b32 v118, 16, v253
  v_and_b32 v119, s11, v253
  v_lshlrev_b32 v120, 16, v246
  v_and_b32 v121, s11, v246
  v_lshlrev_b32 v122, 16, v247
  v_and_b32 v123, s11, v247
  v_lshlrev_b32 v124, 16, v254
  v_and_b32 v125, s11, v254
  v_lshlrev_b32 v126, 16, v255
  v_and_b32 v127, s11, v255
  s_waitcnt vmcnt(10) lgkmcnt(8)
  v_mfma_f32_16x16x32_bf16 v[96:99], v[160:163], v[32:35], v[96:99]
  ds_read_b64_tr_b16 v[192:193], v6 offset:8192
  v_readlane_b32 s51, v15, 3
  v_mfma_f32_16x16x32_bf16 v[100:103], v[160:163], v[36:39], v[100:103]
  ds_read_b64_tr_b16 v[194:195], v6 offset:8704
  v_mfma_f32_16x16x32_bf16 v[108:111], v[164:167], v[36:39], v[108:111]
  ds_read_b64_tr_b16 v[196:197], v7 offset:8192
  v_mfma_f32_16x16x32_bf16 v[104:107], v[164:167], v[32:35], v[104:107]
  buffer_load_dwordx4 v[80:83], off, s[36:39], s51 offset:0
  v_mfma_f32_16x16x32_bf16 v[112:115], v[168:171], v[32:35], v[112:115]
  ds_read_b64_tr_b16 v[198:199], v7 offset:8704
  ds_read_b64_tr_b16 v[200:201], v8 offset:8192
  v_mfma_f32_16x16x32_bf16 v[116:119], v[168:171], v[36:39], v[116:119]
  ds_read_b64_tr_b16 v[202:203], v8 offset:8704
  ds_read_b64_tr_b16 v[204:205], v9 offset:8192
  v_mfma_f32_16x16x32_bf16 v[124:127], v[172:175], v[36:39], v[124:127]
  buffer_load_dwordx4 v[84:87], off, s[64:67], s51 offset:0
  v_mfma_f32_16x16x32_bf16 v[120:123], v[172:175], v[32:35], v[120:123]
  ds_read_b64_tr_b16 v[206:207], v9 offset:8704
  s_waitcnt vmcnt(10) lgkmcnt(8)
  v_mfma_f32_16x16x32_bf16 v[96:99], v[176:179], v[40:43], v[96:99]
  ds_read_b64_tr_b16 v[208:209], v6 offset:12288
  v_mfma_f32_16x16x32_bf16 v[100:103], v[176:179], v[44:47], v[100:103]
  buffer_load_dwordx4 v[88:91], off, s[36:39], s51 offset:1024
  v_mfma_f32_16x16x32_bf16 v[108:111], v[180:183], v[44:47], v[108:111]
  ds_read_b64_tr_b16 v[210:211], v6 offset:12800
  ds_read_b64_tr_b16 v[212:213], v7 offset:12288
  v_mfma_f32_16x16x32_bf16 v[104:107], v[180:183], v[40:43], v[104:107]
  ds_read_b64_tr_b16 v[214:215], v7 offset:12800
  ds_read_b64_tr_b16 v[216:217], v8 offset:12288
  v_mfma_f32_16x16x32_bf16 v[112:115], v[184:187], v[40:43], v[112:115]
  buffer_load_dwordx4 v[92:95], off, s[64:67], s51 offset:1024
  v_mfma_f32_16x16x32_bf16 v[116:119], v[184:187], v[44:47], v[116:119]
  ds_read_b64_tr_b16 v[218:219], v8 offset:12800
  v_readlane_b32 s48, v15, 4
  v_mfma_f32_16x16x32_bf16 v[124:127], v[188:191], v[44:47], v[124:127]
  ds_read_b64_tr_b16 v[220:221], v9 offset:12288
  v_mfma_f32_16x16x32_bf16 v[120:123], v[188:191], v[40:43], v[120:123]
  ds_read_b64_tr_b16 v[222:223], v9 offset:12800
  s_waitcnt vmcnt(10) lgkmcnt(8)
  v_mfma_f32_16x16x32_bf16 v[96:99], v[192:195], v[48:51], v[96:99]
  buffer_load_dwordx4 v[32:35], off, s[36:39], s48 offset:0
  v_mfma_f32_16x16x32_bf16 v[100:103], v[192:195], v[52:55], v[100:103]
  ds_read_b64_tr_b16 v[160:161], v6 offset:16384
  ds_read_b64_tr_b16 v[162:163], v6 offset:16896
  v_mfma_f32_16x16x32_bf16 v[108:111], v[196:199], v[52:55], v[108:111]
  ds_read_b64_tr_b16 v[164:165], v7 offset:16384
  v_mfma_f32_16x16x32_bf16 v[104:107], v[196:199], v[48:51], v[104:107]
  buffer_load_dwordx4 v[36:39], off, s[64:67], s48 offset:0
  v_mfma_f32_16x16x32_bf16 v[112:115], v[200:203], v[48:51], v[112:115]
  ds_read_b64_tr_b16 v[166:167], v7 offset:16896
  ds_read_b64_tr_b16 v[168:169], v8 offset:16384
  v_mfma_f32_16x16x32_bf16 v[116:119], v[200:203], v[52:55], v[116:119]
  ds_read_b64_tr_b16 v[170:171], v8 offset:16896
  ds_read_b64_tr_b16 v[172:173], v9 offset:16384
  v_mfma_f32_16x16x32_bf16 v[124:127], v[204:207], v[52:55], v[124:127]
  buffer_load_dwordx4 v[40:43], off, s[36:39], s48 offset:1024
  v_mfma_f32_16x16x32_bf16 v[120:123], v[204:207], v[48:51], v[120:123]
  ds_read_b64_tr_b16 v[174:175], v9 offset:16896
  s_waitcnt vmcnt(11) lgkmcnt(8)
  v_mfma_f32_16x16x32_bf16 v[96:99], v[208:211], v[56:59], v[96:99]
  ds_read_b64_tr_b16 v[176:177], v6 offset:20480
  v_mfma_f32_16x16x32_bf16 v[100:103], v[208:211], v[60:63], v[100:103]
  buffer_load_dwordx4 v[44:47], off, s[64:67], s48 offset:1024
  v_mfma_f32_16x16x32_bf16 v[108:111], v[212:215], v[60:63], v[108:111]
  ds_read_b64_tr_b16 v[178:179], v6 offset:20992
  ds_read_b64_tr_b16 v[180:181], v7 offset:20480
  v_mfma_f32_16x16x32_bf16 v[104:107], v[212:215], v[56:59], v[104:107]
  ds_read_b64_tr_b16 v[182:183], v7 offset:20992
  v_mfma_f32_16x16x32_bf16 v[112:115], v[216:219], v[56:59], v[112:115]
  ds_read_b64_tr_b16 v[184:185], v8 offset:20480
  v_mfma_f32_16x16x32_bf16 v[116:119], v[216:219], v[60:63], v[116:119]
  ds_read_b64_tr_b16 v[186:187], v8 offset:20992
  v_readlane_b32 s49, v15, 5
  v_mfma_f32_16x16x32_bf16 v[124:127], v[220:223], v[60:63], v[124:127]
  ds_read_b64_tr_b16 v[188:189], v9 offset:20480
  v_mfma_f32_16x16x32_bf16 v[120:123], v[220:223], v[56:59], v[120:123]
  ds_read_b64_tr_b16 v[190:191], v9 offset:20992
  s_waitcnt vmcnt(10) lgkmcnt(8)
  v_mfma_f32_16x16x32_bf16 v[96:99], v[160:163], v[64:67], v[96:99]
  buffer_load_dwordx4 v[48:51], off, s[36:39], s49 offset:0
  v_mfma_f32_16x16x32_bf16 v[100:103], v[160:163], v[68:71], v[100:103]
  ds_read_b64_tr_b16 v[192:193], v6 offset:24576
  ds_read_b64_tr_b16 v[194:195], v6 offset:25088
  v_mfma_f32_16x16x32_bf16 v[108:111], v[164:167], v[68:71], v[108:111]
  ds_read_b64_tr_b16 v[196:197], v7 offset:24576
  v_mfma_f32_16x16x32_bf16 v[104:107], v[164:167], v[64:67], v[104:107]
  buffer_load_dwordx4 v[52:55], off, s[64:67], s49 offset:0
  v_mfma_f32_16x16x32_bf16 v[112:115], v[168:171], v[64:67], v[112:115]
  ds_read_b64_tr_b16 v[198:199], v7 offset:25088
  ds_read_b64_tr_b16 v[200:201], v8 offset:24576
  v_mfma_f32_16x16x32_bf16 v[116:119], v[168:171], v[68:71], v[116:119]
  ds_read_b64_tr_b16 v[202:203], v8 offset:25088
  ds_read_b64_tr_b16 v[204:205], v9 offset:24576
  v_mfma_f32_16x16x32_bf16 v[124:127], v[172:175], v[68:71], v[124:127]
  buffer_load_dwordx4 v[56:59], off, s[36:39], s49 offset:1024
  v_mfma_f32_16x16x32_bf16 v[120:123], v[172:175], v[64:67], v[120:123]
  ds_read_b64_tr_b16 v[206:207], v9 offset:25088
  s_waitcnt vmcnt(11) lgkmcnt(8)
  v_mfma_f32_16x16x32_bf16 v[96:99], v[176:179], v[72:75], v[96:99]
  ds_read_b64_tr_b16 v[208:209], v6 offset:28672
  v_mfma_f32_16x16x32_bf16 v[100:103], v[176:179], v[76:79], v[100:103]
  buffer_load_dwordx4 v[60:63], off, s[64:67], s49 offset:1024
  v_mfma_f32_16x16x32_bf16 v[108:111], v[180:183], v[76:79], v[108:111]
  ds_read_b64_tr_b16 v[210:211], v6 offset:29184
  ds_read_b64_tr_b16 v[212:213], v7 offset:28672
  v_mfma_f32_16x16x32_bf16 v[104:107], v[180:183], v[72:75], v[104:107]
  ds_read_b64_tr_b16 v[214:215], v7 offset:29184
  v_mfma_f32_16x16x32_bf16 v[112:115], v[184:187], v[72:75], v[112:115]
  ds_read_b64_tr_b16 v[216:217], v8 offset:28672
  v_mfma_f32_16x16x32_bf16 v[116:119], v[184:187], v[76:79], v[116:119]
  ds_read_b64_tr_b16 v[218:219], v8 offset:29184
  v_readlane_b32 s50, v15, 6
  v_mfma_f32_16x16x32_bf16 v[124:127], v[188:191], v[76:79], v[124:127]
  ds_read_b64_tr_b16 v[220:221], v9 offset:28672
  v_mfma_f32_16x16x32_bf16 v[120:123], v[188:191], v[72:75], v[120:123]
  ds_read_b64_tr_b16 v[222:223], v9 offset:29184
  s_waitcnt vmcnt(10) lgkmcnt(8)
  v_mfma_f32_16x16x32_bf16 v[96:99], v[192:195], v[80:83], v[96:99]
  buffer_load_dwordx4 v[64:67], off, s[36:39], s50 offset:0
  v_mfma_f32_16x16x32_bf16 v[100:103], v[192:195], v[84:87], v[100:103]
  ds_read_b64_tr_b16 v[160:161], v6 offset:32768
  ds_read_b64_tr_b16 v[162:163], v6 offset:33280
  v_mfma_f32_16x16x32_bf16 v[108:111], v[196:199], v[84:87], v[108:111]
  ds_read_b64_tr_b16 v[164:165], v7 offset:32768
  v_mfma_f32_16x16x32_bf16 v[104:107], v[196:199], v[80:83], v[104:107]
  buffer_load_dwordx4 v[68:71], off, s[64:67], s50 offset:0
  v_mfma_f32_16x16x32_bf16 v[112:115], v[200:203], v[80:83], v[112:115]
  ds_read_b64_tr_b16 v[166:167], v7 offset:33280
  ds_read_b64_tr_b16 v[168:169], v8 offset:32768
  v_mfma_f32_16x16x32_bf16 v[116:119], v[200:203], v[84:87], v[116:119]
  ds_read_b64_tr_b16 v[170:171], v8 offset:33280
  ds_read_b64_tr_b16 v[172:173], v9 offset:32768
  v_mfma_f32_16x16x32_bf16 v[124:127], v[204:207], v[84:87], v[124:127]
  buffer_load_dwordx4 v[72:75], off, s[36:39], s50 offset:1024
  v_mfma_f32_16x16x32_bf16 v[120:123], v[204:207], v[80:83], v[120:123]
  ds_read_b64_tr_b16 v[174:175], v9 offset:33280
  s_waitcnt vmcnt(11) lgkmcnt(8)
  s_barrier
  v_mfma_f32_16x16x32_bf16 v[96:99], v[208:211], v[88:91], v[96:99]
  ds_read_b64_tr_b16 v[176:177], v6 offset:36864
  v_mfma_f32_16x16x32_bf16 v[100:103], v[208:211], v[92:95], v[100:103]
  buffer_load_dwordx4 v[76:79], off, s[64:67], s50 offset:1024
  v_mfma_f32_16x16x32_bf16 v[108:111], v[212:215], v[92:95], v[108:111]
  ds_read_b64_tr_b16 v[178:179], v6 offset:37376
  ds_read_b64_tr_b16 v[180:181], v7 offset:36864
  v_mfma_f32_16x16x32_bf16 v[104:107], v[212:215], v[88:91], v[104:107]
  ds_read_b64_tr_b16 v[182:183], v7 offset:37376
  v_mfma_f32_16x16x32_bf16 v[112:115], v[216:219], v[88:91], v[112:115]
  ds_read_b64_tr_b16 v[184:185], v8 offset:36864
  v_mfma_f32_16x16x32_bf16 v[116:119], v[216:219], v[92:95], v[116:119]
  ds_read_b64_tr_b16 v[186:187], v8 offset:37376
  v_readlane_b32 s51, v15, 7
  v_mfma_f32_16x16x32_bf16 v[124:127], v[220:223], v[92:95], v[124:127]
  ds_read_b64_tr_b16 v[188:189], v9 offset:36864
  v_mfma_f32_16x16x32_bf16 v[120:123], v[220:223], v[88:91], v[120:123]
  ds_read_b64_tr_b16 v[190:191], v9 offset:37376
  s_waitcnt vmcnt(10) lgkmcnt(8)
  v_mfma_f32_16x16x32_bf16 v[96:99], v[160:163], v[32:35], v[96:99]
  buffer_load_dwordx4 v[80:83], off, s[36:39], s51 offset:0
  v_mfma_f32_16x16x32_bf16 v[100:103], v[160:163], v[36:39], v[100:103]
  ds_read_b64_tr_b16 v[192:193], v6 offset:40960
  ds_read_b64_tr_b16 v[194:195], v6 offset:41472
  v_mfma_f32_16x16x32_bf16 v[108:111], v[164:167], v[36:39], v[108:111]
  ds_read_b64_tr_b16 v[196:197], v7 offset:40960
  v_mfma_f32_16x16x32_bf16 v[104:107], v[164:167], v[32:35], v[104:107]
  buffer_load_dwordx4 v[84:87], off, s[64:67], s51 offset:0
  v_mfma_f32_16x16x32_bf16 v[112:115], v[168:171], v[32:35], v[112:115]
  ds_read_b64_tr_b16 v[198:199], v7 offset:41472
  ds_read_b64_tr_b16 v[200:201], v8 offset:40960
  v_mfma_f32_16x16x32_bf16 v[116:119], v[168:171], v[36:39], v[116:119]
  ds_read_b64_tr_b16 v[202:203], v8 offset:41472
  ds_read_b64_tr_b16 v[204:205], v9 offset:40960
  v_mfma_f32_16x16x32_bf16 v[124:127], v[172:175], v[36:39], v[124:127]
  buffer_load_dwordx4 v[88:91], off, s[36:39], s51 offset:1024
  v_mfma_f32_16x16x32_bf16 v[120:123], v[172:175], v[32:35], v[120:123]
  ds_read_b64_tr_b16 v[206:207], v9 offset:41472
  s_waitcnt vmcnt(11) lgkmcnt(8)
  v_mfma_f32_16x16x32_bf16 v[96:99], v[176:179], v[40:43], v[96:99]
  ds_read_b64_tr_b16 v[208:209], v6 offset:45056
  v_mfma_f32_16x16x32_bf16 v[100:103], v[176:179], v[44:47], v[100:103]
  buffer_load_dwordx4 v[92:95], off, s[64:67], s51 offset:1024
  v_mfma_f32_16x16x32_bf16 v[108:111], v[180:183], v[44:47], v[108:111]
  ds_read_b64_tr_b16 v[210:211], v6 offset:45568
  ds_read_b64_tr_b16 v[212:213], v7 offset:45056
  v_mfma_f32_16x16x32_bf16 v[104:107], v[180:183], v[40:43], v[104:107]
  ds_read_b64_tr_b16 v[214:215], v7 offset:45568
  v_mfma_f32_16x16x32_bf16 v[112:115], v[184:187], v[40:43], v[112:115]
  ds_read_b64_tr_b16 v[216:217], v8 offset:45056
  v_mfma_f32_16x16x32_bf16 v[116:119], v[184:187], v[44:47], v[116:119]
  ds_read_b64_tr_b16 v[218:219], v8 offset:45568
  v_readlane_b32 s48, v15, 8
  v_mfma_f32_16x16x32_bf16 v[124:127], v[188:191], v[44:47], v[124:127]
  ds_read_b64_tr_b16 v[220:221], v9 offset:45056
  v_mfma_f32_16x16x32_bf16 v[120:123], v[188:191], v[40:43], v[120:123]
  ds_read_b64_tr_b16 v[222:223], v9 offset:45568
  s_waitcnt vmcnt(10) lgkmcnt(8)
  v_mfma_f32_16x16x32_bf16 v[96:99], v[192:195], v[48:51], v[96:99]
  buffer_load_dwordx4 v[32:35], off, s[36:39], s48 offset:0
  v_mfma_f32_16x16x32_bf16 v[100:103], v[192:195], v[52:55], v[100:103]
  ds_read_b64_tr_b16 v[160:161], v6 offset:49152
  ds_read_b64_tr_b16 v[162:163], v6 offset:49664
  v_mfma_f32_16x16x32_bf16 v[108:111], v[196:199], v[52:55], v[108:111]
  ds_read_b64_tr_b16 v[164:165], v7 offset:49152
  v_mfma_f32_16x16x32_bf16 v[104:107], v[196:199], v[48:51], v[104:107]
  buffer_load_dwordx4 v[36:39], off, s[64:67], s48 offset:0
  v_mfma_f32_16x16x32_bf16 v[112:115], v[200:203], v[48:51], v[112:115]
  ds_read_b64_tr_b16 v[166:167], v7 offset:49664
  ds_read_b64_tr_b16 v[168:169], v8 offset:49152
  v_mfma_f32_16x16x32_bf16 v[116:119], v[200:203], v[52:55], v[116:119]
  ds_read_b64_tr_b16 v[170:171], v8 offset:49664
  ds_read_b64_tr_b16 v[172:173], v9 offset:49152
  v_mfma_f32_16x16x32_bf16 v[124:127], v[204:207], v[52:55], v[124:127]
  buffer_load_dwordx4 v[40:43], off, s[36:39], s48 offset:1024
  v_mfma_f32_16x16x32_bf16 v[120:123], v[204:207], v[48:51], v[120:123]
  ds_read_b64_tr_b16 v[174:175], v9 offset:49664
  s_waitcnt vmcnt(11) lgkmcnt(8)
  v_mfma_f32_16x16x32_bf16 v[96:99], v[208:211], v[56:59], v[96:99]
  ds_read_b64_tr_b16 v[176:177], v6 offset:53248
  v_mfma_f32_16x16x32_bf16 v[100:103], v[208:211], v[60:63], v[100:103]
  buffer_load_dwordx4 v[44:47], off, s[64:67], s48 offset:1024
  v_mfma_f32_16x16x32_bf16 v[108:111], v[212:215], v[60:63], v[108:111]
  ds_read_b64_tr_b16 v[178:179], v6 offset:53760
  ds_read_b64_tr_b16 v[180:181], v7 offset:53248
  v_mfma_f32_16x16x32_bf16 v[104:107], v[212:215], v[56:59], v[104:107]
  ds_read_b64_tr_b16 v[182:183], v7 offset:53760
  v_mfma_f32_16x16x32_bf16 v[112:115], v[216:219], v[56:59], v[112:115]
  ds_read_b64_tr_b16 v[184:185], v8 offset:53248
  v_mfma_f32_16x16x32_bf16 v[116:119], v[216:219], v[60:63], v[116:119]
  ds_read_b64_tr_b16 v[186:187], v8 offset:53760
  v_readlane_b32 s49, v15, 9
  v_mfma_f32_16x16x32_bf16 v[124:127], v[220:223], v[60:63], v[124:127]
  ds_read_b64_tr_b16 v[188:189], v9 offset:53248
  v_mfma_f32_16x16x32_bf16 v[120:123], v[220:223], v[56:59], v[120:123]
  ds_read_b64_tr_b16 v[190:191], v9 offset:53760
  s_waitcnt vmcnt(10) lgkmcnt(8)
  v_mfma_f32_16x16x32_bf16 v[96:99], v[160:163], v[64:67], v[96:99]
  buffer_load_dwordx4 v[48:51], off, s[36:39], s49 offset:0
  v_mfma_f32_16x16x32_bf16 v[100:103], v[160:163], v[68:71], v[100:103]
  ds_read_b64_tr_b16 v[192:193], v6 offset:57344
  ds_read_b64_tr_b16 v[194:195], v6 offset:57856
  v_mfma_f32_16x16x32_bf16 v[108:111], v[164:167], v[68:71], v[108:111]
  ds_read_b64_tr_b16 v[196:197], v7 offset:57344
  v_mfma_f32_16x16x32_bf16 v[104:107], v[164:167], v[64:67], v[104:107]
  buffer_load_dwordx4 v[52:55], off, s[64:67], s49 offset:0
  v_mfma_f32_16x16x32_bf16 v[112:115], v[168:171], v[64:67], v[112:115]
  ds_read_b64_tr_b16 v[198:199], v7 offset:57856
  ds_read_b64_tr_b16 v[200:201], v8 offset:57344
  v_mfma_f32_16x16x32_bf16 v[116:119], v[168:171], v[68:71], v[116:119]
  ds_read_b64_tr_b16 v[202:203], v8 offset:57856
  ds_read_b64_tr_b16 v[204:205], v9 offset:57344
  v_mfma_f32_16x16x32_bf16 v[124:127], v[172:175], v[68:71], v[124:127]
  buffer_load_dwordx4 v[56:59], off, s[36:39], s49 offset:1024
  v_mfma_f32_16x16x32_bf16 v[120:123], v[172:175], v[64:67], v[120:123]
  ds_read_b64_tr_b16 v[206:207], v9 offset:57856
  s_waitcnt vmcnt(11) lgkmcnt(8)
  v_mfma_f32_16x16x32_bf16 v[96:99], v[176:179], v[72:75], v[96:99]
  ds_read_b64_tr_b16 v[208:209], v6 offset:61440
  v_mfma_f32_16x16x32_bf16 v[100:103], v[176:179], v[76:79], v[100:103]
  buffer_load_dwordx4 v[60:63], off, s[64:67], s49 offset:1024
  v_mfma_f32_16x16x32_bf16 v[108:111], v[180:183], v[76:79], v[108:111]
  ds_read_b64_tr_b16 v[210:211], v6 offset:61952
  ds_read_b64_tr_b16 v[212:213], v7 offset:61440
  v_mfma_f32_16x16x32_bf16 v[104:107], v[180:183], v[72:75], v[104:107]
  ds_read_b64_tr_b16 v[214:215], v7 offset:61952
  v_mfma_f32_16x16x32_bf16 v[112:115], v[184:187], v[72:75], v[112:115]
  ds_read_b64_tr_b16 v[216:217], v8 offset:61440
  v_mfma_f32_16x16x32_bf16 v[116:119], v[184:187], v[76:79], v[116:119]
  ds_read_b64_tr_b16 v[218:219], v8 offset:61952
  v_readlane_b32 s50, v15, 10
  v_mfma_f32_16x16x32_bf16 v[124:127], v[188:191], v[76:79], v[124:127]
  ds_read_b64_tr_b16 v[220:221], v9 offset:61440
  v_mfma_f32_16x16x32_bf16 v[120:123], v[188:191], v[72:75], v[120:123]
  ds_read_b64_tr_b16 v[222:223], v9 offset:61952
  s_waitcnt vmcnt(10) lgkmcnt(8)
  v_mfma_f32_16x16x32_bf16 v[96:99], v[192:195], v[80:83], v[96:99]
  buffer_load_dwordx4 v[64:67], off, s[36:39], s50 offset:0
  v_mfma_f32_16x16x32_bf16 v[100:103], v[192:195], v[84:87], v[100:103]
  ds_read_b64_tr_b16 v[160:161], v20 offset:0
  ds_read_b64_tr_b16 v[162:163], v20 offset:512
  v_mfma_f32_16x16x32_bf16 v[108:111], v[196:199], v[84:87], v[108:111]
  ds_read_b64_tr_b16 v[164:165], v21 offset:0
  v_mfma_f32_16x16x32_bf16 v[104:107], v[196:199], v[80:83], v[104:107]
  buffer_load_dwordx4 v[68:71], off, s[64:67], s50 offset:0
  v_mfma_f32_16x16x32_bf16 v[112:115], v[200:203], v[80:83], v[112:115]
  ds_read_b64_tr_b16 v[166:167], v21 offset:512
  ds_read_b64_tr_b16 v[168:169], v22 offset:0
  v_mfma_f32_16x16x32_bf16 v[116:119], v[200:203], v[84:87], v[116:119]
  ds_read_b64_tr_b16 v[170:171], v22 offset:512
  ds_read_b64_tr_b16 v[172:173], v23 offset:0
  v_mfma_f32_16x16x32_bf16 v[124:127], v[204:207], v[84:87], v[124:127]
  buffer_load_dwordx4 v[72:75], off, s[36:39], s50 offset:1024
  v_mfma_f32_16x16x32_bf16 v[120:123], v[204:207], v[80:83], v[120:123]
  ds_read_b64_tr_b16 v[174:175], v23 offset:512
  s_waitcnt vmcnt(11) lgkmcnt(8)
  v_mfma_f32_16x16x32_bf16 v[96:99], v[208:211], v[88:91], v[96:99]
  ds_read_b64_tr_b16 v[176:177], v20 offset:4096
  v_mfma_f32_16x16x32_bf16 v[100:103], v[208:211], v[92:95], v[100:103]
  buffer_load_dwordx4 v[76:79], off, s[64:67], s50 offset:1024
  v_mfma_f32_16x16x32_bf16 v[108:111], v[212:215], v[92:95], v[108:111]
  ds_read_b64_tr_b16 v[178:179], v20 offset:4608
  ds_read_b64_tr_b16 v[180:181], v21 offset:4096
  v_mfma_f32_16x16x32_bf16 v[104:107], v[212:215], v[88:91], v[104:107]
  ds_read_b64_tr_b16 v[182:183], v21 offset:4608
  v_mfma_f32_16x16x32_bf16 v[112:115], v[216:219], v[88:91], v[112:115]
  ds_read_b64_tr_b16 v[184:185], v22 offset:4096
  v_mfma_f32_16x16x32_bf16 v[116:119], v[216:219], v[92:95], v[116:119]
  ds_read_b64_tr_b16 v[186:187], v22 offset:4608
  v_readlane_b32 s51, v15, 11
  v_mfma_f32_16x16x32_bf16 v[124:127], v[220:223], v[92:95], v[124:127]
  ds_read_b64_tr_b16 v[188:189], v23 offset:4096
  v_mfma_f32_16x16x32_bf16 v[120:123], v[220:223], v[88:91], v[120:123]
  ds_read_b64_tr_b16 v[190:191], v23 offset:4608
  s_waitcnt vmcnt(10) lgkmcnt(8)
  v_mfma_f32_16x16x32_bf16 v[96:99], v[160:163], v[32:35], v[96:99]
  buffer_load_dwordx4 v[80:83], off, s[36:39], s51 offset:0
  v_mfma_f32_16x16x32_bf16 v[100:103], v[160:163], v[36:39], v[100:103]
  ds_read_b64_tr_b16 v[192:193], v20 offset:8192
  ds_read_b64_tr_b16 v[194:195], v20 offset:8704
  v_mfma_f32_16x16x32_bf16 v[108:111], v[164:167], v[36:39], v[108:111]
  ds_read_b64_tr_b16 v[196:197], v21 offset:8192
  v_mfma_f32_16x16x32_bf16 v[104:107], v[164:167], v[32:35], v[104:107]
  buffer_load_dwordx4 v[84:87], off, s[64:67], s51 offset:0
  v_mfma_f32_16x16x32_bf16 v[112:115], v[168:171], v[32:35], v[112:115]
  ds_read_b64_tr_b16 v[198:199], v21 offset:8704
  ds_read_b64_tr_b16 v[200:201], v22 offset:8192
  v_mfma_f32_16x16x32_bf16 v[116:119], v[168:171], v[36:39], v[116:119]
  ds_read_b64_tr_b16 v[202:203], v22 offset:8704
  ds_read_b64_tr_b16 v[204:205], v23 offset:8192
  v_mfma_f32_16x16x32_bf16 v[124:127], v[172:175], v[36:39], v[124:127]
  buffer_load_dwordx4 v[88:91], off, s[36:39], s51 offset:1024
  v_mfma_f32_16x16x32_bf16 v[120:123], v[172:175], v[32:35], v[120:123]
  ds_read_b64_tr_b16 v[206:207], v23 offset:8704
  s_waitcnt vmcnt(11) lgkmcnt(8)
  v_mfma_f32_16x16x32_bf16 v[96:99], v[176:179], v[40:43], v[96:99]
  ds_read_b64_tr_b16 v[208:209], v20 offset:12288
  v_mfma_f32_16x16x32_bf16 v[100:103], v[176:179], v[44:47], v[100:103]
  buffer_load_dwordx4 v[92:95], off, s[64:67], s51 offset:1024
  v_mfma_f32_16x16x32_bf16 v[108:111], v[180:183], v[44:47], v[108:111]
  ds_read_b64_tr_b16 v[210:211], v20 offset:12800
  ds_read_b64_tr_b16 v[212:213], v21 offset:12288
  v_mfma_f32_16x16x32_bf16 v[104:107], v[180:183], v[40:43], v[104:107]
  ds_read_b64_tr_b16 v[214:215], v21 offset:12800
  v_mfma_f32_16x16x32_bf16 v[112:115], v[184:187], v[40:43], v[112:115]
  ds_read_b64_tr_b16 v[216:217], v22 offset:12288
  v_mfma_f32_16x16x32_bf16 v[116:119], v[184:187], v[44:47], v[116:119]
  ds_read_b64_tr_b16 v[218:219], v22 offset:12800
  v_readlane_b32 s48, v15, 12
  v_mfma_f32_16x16x32_bf16 v[124:127], v[188:191], v[44:47], v[124:127]
  ds_read_b64_tr_b16 v[220:221], v23 offset:12288
  v_mfma_f32_16x16x32_bf16 v[120:123], v[188:191], v[40:43], v[120:123]
  ds_read_b64_tr_b16 v[222:223], v23 offset:12800
  s_waitcnt vmcnt(10) lgkmcnt(8)
  v_mfma_f32_16x16x32_bf16 v[96:99], v[192:195], v[48:51], v[96:99]
  buffer_load_dwordx4 v[32:35], off, s[36:39], s48 offset:0
  v_mfma_f32_16x16x32_bf16 v[100:103], v[192:195], v[52:55], v[100:103]
  ds_read_b64_tr_b16 v[160:161], v20 offset:16384
  ds_read_b64_tr_b16 v[162:163], v20 offset:16896
  v_mfma_f32_16x16x32_bf16 v[108:111], v[196:199], v[52:55], v[108:111]
  ds_read_b64_tr_b16 v[164:165], v21 offset:16384
  v_mfma_f32_16x16x32_bf16 v[104:107], v[196:199], v[48:51], v[104:107]
  buffer_load_dwordx4 v[36:39], off, s[64:67], s48 offset:0
  v_mfma_f32_16x16x32_bf16 v[112:115], v[200:203], v[48:51], v[112:115]
  ds_read_b64_tr_b16 v[166:167], v21 offset:16896
  ds_read_b64_tr_b16 v[168:169], v22 offset:16384
  v_mfma_f32_16x16x32_bf16 v[116:119], v[200:203], v[52:55], v[116:119]
  ds_read_b64_tr_b16 v[170:171], v22 offset:16896
  ds_read_b64_tr_b16 v[172:173], v23 offset:16384
  v_mfma_f32_16x16x32_bf16 v[124:127], v[204:207], v[52:55], v[124:127]
  buffer_load_dwordx4 v[40:43], off, s[36:39], s48 offset:1024
  v_mfma_f32_16x16x32_bf16 v[120:123], v[204:207], v[48:51], v[120:123]
  ds_read_b64_tr_b16 v[174:175], v23 offset:16896
  s_waitcnt vmcnt(11) lgkmcnt(8)
  v_mfma_f32_16x16x32_bf16 v[96:99], v[208:211], v[56:59], v[96:99]
  ds_read_b64_tr_b16 v[176:177], v20 offset:20480
  v_mfma_f32_16x16x32_bf16 v[100:103], v[208:211], v[60:63], v[100:103]
  buffer_load_dwordx4 v[44:47], off, s[64:67], s48 offset:1024
  v_mfma_f32_16x16x32_bf16 v[108:111], v[212:215], v[60:63], v[108:111]
  ds_read_b64_tr_b16 v[178:179], v20 offset:20992
  ds_read_b64_tr_b16 v[180:181], v21 offset:20480
  v_mfma_f32_16x16x32_bf16 v[104:107], v[212:215], v[56:59], v[104:107]
  ds_read_b64_tr_b16 v[182:183], v21 offset:20992
  v_mfma_f32_16x16x32_bf16 v[112:115], v[216:219], v[56:59], v[112:115]
  ds_read_b64_tr_b16 v[184:185], v22 offset:20480
  v_mfma_f32_16x16x32_bf16 v[116:119], v[216:219], v[60:63], v[116:119]
  ds_read_b64_tr_b16 v[186:187], v22 offset:20992
  v_readlane_b32 s49, v15, 13
  v_mfma_f32_16x16x32_bf16 v[124:127], v[220:223], v[60:63], v[124:127]
  ds_read_b64_tr_b16 v[188:189], v23 offset:20480
  v_mfma_f32_16x16x32_bf16 v[120:123], v[220:223], v[56:59], v[120:123]
  ds_read_b64_tr_b16 v[190:191], v23 offset:20992
  s_waitcnt vmcnt(10) lgkmcnt(8)
  v_mfma_f32_16x16x32_bf16 v[96:99], v[160:163], v[64:67], v[96:99]
  buffer_load_dwordx4 v[48:51], off, s[36:39], s49 offset:0
  v_mfma_f32_16x16x32_bf16 v[100:103], v[160:163], v[68:71], v[100:103]
  ds_read_b64_tr_b16 v[192:193], v20 offset:24576
  ds_read_b64_tr_b16 v[194:195], v20 offset:25088
  v_mfma_f32_16x16x32_bf16 v[108:111], v[164:167], v[68:71], v[108:111]
  ds_read_b64_tr_b16 v[196:197], v21 offset:24576
  v_mfma_f32_16x16x32_bf16 v[104:107], v[164:167], v[64:67], v[104:107]
  buffer_load_dwordx4 v[52:55], off, s[64:67], s49 offset:0
  v_mfma_f32_16x16x32_bf16 v[112:115], v[168:171], v[64:67], v[112:115]
  ds_read_b64_tr_b16 v[198:199], v21 offset:25088
  ds_read_b64_tr_b16 v[200:201], v22 offset:24576
  v_mfma_f32_16x16x32_bf16 v[116:119], v[168:171], v[68:71], v[116:119]
  ds_read_b64_tr_b16 v[202:203], v22 offset:25088
  ds_read_b64_tr_b16 v[204:205], v23 offset:24576
  v_mfma_f32_16x16x32_bf16 v[124:127], v[172:175], v[68:71], v[124:127]
  buffer_load_dwordx4 v[56:59], off, s[36:39], s49 offset:1024
  v_mfma_f32_16x16x32_bf16 v[120:123], v[172:175], v[64:67], v[120:123]
  ds_read_b64_tr_b16 v[206:207], v23 offset:25088
  s_waitcnt vmcnt(11) lgkmcnt(8)
  s_barrier
  v_mfma_f32_16x16x32_bf16 v[96:99], v[176:179], v[72:75], v[96:99]
  ds_read_b64_tr_b16 v[208:209], v20 offset:28672
  v_mfma_f32_16x16x32_bf16 v[100:103], v[176:179], v[76:79], v[100:103]
  buffer_load_dwordx4 v[60:63], off, s[64:67], s49 offset:1024
  v_mfma_f32_16x16x32_bf16 v[108:111], v[180:183], v[76:79], v[108:111]
  ds_read_b64_tr_b16 v[210:211], v20 offset:29184
  ds_read_b64_tr_b16 v[212:213], v21 offset:28672
  v_mfma_f32_16x16x32_bf16 v[104:107], v[180:183], v[72:75], v[104:107]
  ds_read_b64_tr_b16 v[214:215], v21 offset:29184
  v_mfma_f32_16x16x32_bf16 v[112:115], v[184:187], v[72:75], v[112:115]
  ds_read_b64_tr_b16 v[216:217], v22 offset:28672
  v_mfma_f32_16x16x32_bf16 v[116:119], v[184:187], v[76:79], v[116:119]
  ds_read_b64_tr_b16 v[218:219], v22 offset:29184
  v_readlane_b32 s50, v15, 14
  v_mfma_f32_16x16x32_bf16 v[124:127], v[188:191], v[76:79], v[124:127]
  ds_read_b64_tr_b16 v[220:221], v23 offset:28672
  v_mfma_f32_16x16x32_bf16 v[120:123], v[188:191], v[72:75], v[120:123]
  ds_read_b64_tr_b16 v[222:223], v23 offset:29184
  s_waitcnt vmcnt(10) lgkmcnt(8)
  v_mfma_f32_16x16x32_bf16 v[96:99], v[192:195], v[80:83], v[96:99]
  buffer_load_dwordx4 v[64:67], off, s[36:39], s50 offset:0
  v_mfma_f32_16x16x32_bf16 v[100:103], v[192:195], v[84:87], v[100:103]
  ds_read_b64_tr_b16 v[160:161], v20 offset:36864
  ds_read_b64_tr_b16 v[162:163], v20 offset:37376
  v_mfma_f32_16x16x32_bf16 v[108:111], v[196:199], v[84:87], v[108:111]
  ds_read_b64_tr_b16 v[164:165], v21 offset:36864
  v_mfma_f32_16x16x32_bf16 v[104:107], v[196:199], v[80:83], v[104:107]
  buffer_load_dwordx4 v[68:71], off, s[64:67], s50 offset:0
  v_mfma_f32_16x16x32_bf16 v[112:115], v[200:203], v[80:83], v[112:115]
  ds_read_b64_tr_b16 v[166:167], v21 offset:37376
  ds_read_b64_tr_b16 v[168:169], v22 offset:36864
  v_mfma_f32_16x16x32_bf16 v[116:119], v[200:203], v[84:87], v[116:119]
  ds_read_b64_tr_b16 v[170:171], v22 offset:37376
  ds_read_b64_tr_b16 v[172:173], v23 offset:36864
  v_mfma_f32_16x16x32_bf16 v[124:127], v[204:207], v[84:87], v[124:127]
  buffer_load_dwordx4 v[72:75], off, s[36:39], s50 offset:1024
  v_mfma_f32_16x16x32_bf16 v[120:123], v[204:207], v[80:83], v[120:123]
  ds_read_b64_tr_b16 v[174:175], v23 offset:37376
  s_waitcnt vmcnt(11) lgkmcnt(8)
  v_mfma_f32_16x16x32_bf16 v[96:99], v[208:211], v[88:91], v[96:99]
  ds_read_b64_tr_b16 v[176:177], v20 offset:40960
  v_mfma_f32_16x16x32_bf16 v[100:103], v[208:211], v[92:95], v[100:103]
  buffer_load_dwordx4 v[76:79], off, s[64:67], s50 offset:1024
  v_mfma_f32_16x16x32_bf16 v[108:111], v[212:215], v[92:95], v[108:111]
  ds_read_b64_tr_b16 v[178:179], v20 offset:41472
  ds_read_b64_tr_b16 v[180:181], v21 offset:40960
  v_mfma_f32_16x16x32_bf16 v[104:107], v[212:215], v[88:91], v[104:107]
  ds_read_b64_tr_b16 v[182:183], v21 offset:41472
  v_mfma_f32_16x16x32_bf16 v[112:115], v[216:219], v[88:91], v[112:115]
  ds_read_b64_tr_b16 v[184:185], v22 offset:40960
  v_mfma_f32_16x16x32_bf16 v[116:119], v[216:219], v[92:95], v[116:119]
  ds_read_b64_tr_b16 v[186:187], v22 offset:41472
  v_readlane_b32 s51, v15, 15
  v_mfma_f32_16x16x32_bf16 v[124:127], v[220:223], v[92:95], v[124:127]
  ds_read_b64_tr_b16 v[188:189], v23 offset:40960
  v_mfma_f32_16x16x32_bf16 v[120:123], v[220:223], v[88:91], v[120:123]
  ds_read_b64_tr_b16 v[190:191], v23 offset:41472
  s_waitcnt vmcnt(10) lgkmcnt(8)
  v_mfma_f32_16x16x32_bf16 v[96:99], v[160:163], v[32:35], v[96:99]
  buffer_load_dwordx4 v[80:83], off, s[36:39], s51 offset:0
  v_mfma_f32_16x16x32_bf16 v[100:103], v[160:163], v[36:39], v[100:103]
  ds_read_b64_tr_b16 v[192:193], v20 offset:45056
  ds_read_b64_tr_b16 v[194:195], v20 offset:45568
  v_mfma_f32_16x16x32_bf16 v[108:111], v[164:167], v[36:39], v[108:111]
  ds_read_b64_tr_b16 v[196:197], v21 offset:45056
  v_mfma_f32_16x16x32_bf16 v[104:107], v[164:167], v[32:35], v[104:107]
  buffer_load_dwordx4 v[84:87], off, s[64:67], s51 offset:0
  v_mfma_f32_16x16x32_bf16 v[112:115], v[168:171], v[32:35], v[112:115]
  ds_read_b64_tr_b16 v[198:199], v21 offset:45568
  ds_read_b64_tr_b16 v[200:201], v22 offset:45056
  v_mfma_f32_16x16x32_bf16 v[116:119], v[168:171], v[36:39], v[116:119]
  ds_read_b64_tr_b16 v[202:203], v22 offset:45568
  ds_read_b64_tr_b16 v[204:205], v23 offset:45056
  v_mfma_f32_16x16x32_bf16 v[124:127], v[172:175], v[36:39], v[124:127]
  buffer_load_dwordx4 v[88:91], off, s[36:39], s51 offset:1024
  v_mfma_f32_16x16x32_bf16 v[120:123], v[172:175], v[32:35], v[120:123]
  ds_read_b64_tr_b16 v[206:207], v23 offset:45568
  s_waitcnt vmcnt(11) lgkmcnt(8)
  v_mfma_f32_16x16x32_bf16 v[96:99], v[176:179], v[40:43], v[96:99]
  ds_read_b64_tr_b16 v[208:209], v20 offset:49152
  v_mfma_f32_16x16x32_bf16 v[100:103], v[176:179], v[44:47], v[100:103]
  buffer_load_dwordx4 v[92:95], off, s[64:67], s51 offset:1024
  v_mfma_f32_16x16x32_bf16 v[108:111], v[180:183], v[44:47], v[108:111]
  ds_read_b64_tr_b16 v[210:211], v20 offset:49664
  ds_read_b64_tr_b16 v[212:213], v21 offset:49152
  v_mfma_f32_16x16x32_bf16 v[104:107], v[180:183], v[40:43], v[104:107]
  ds_read_b64_tr_b16 v[214:215], v21 offset:49664
  v_mfma_f32_16x16x32_bf16 v[112:115], v[184:187], v[40:43], v[112:115]
  ds_read_b64_tr_b16 v[216:217], v22 offset:49152
  v_mfma_f32_16x16x32_bf16 v[116:119], v[184:187], v[44:47], v[116:119]
  ds_read_b64_tr_b16 v[218:219], v22 offset:49664
  v_mfma_f32_16x16x32_bf16 v[124:127], v[188:191], v[44:47], v[124:127]
  ds_read_b64_tr_b16 v[220:221], v23 offset:49152
  v_mfma_f32_16x16x32_bf16 v[120:123], v[188:191], v[40:43], v[120:123]
  ds_read_b64_tr_b16 v[222:223], v23 offset:49664
  s_waitcnt vmcnt(10) lgkmcnt(8)
  v_mfma_f32_16x16x32_bf16 v[96:99], v[192:195], v[48:51], v[96:99]
  ds_read_b64_tr_b16 v[160:161], v20 offset:53248
  v_mfma_f32_16x16x32_bf16 v[100:103], v[192:195], v[52:55], v[100:103]
  ds_read_b64_tr_b16 v[162:163], v20 offset:53760
  v_mfma_f32_16x16x32_bf16 v[108:111], v[196:199], v[52:55], v[108:111]
  ds_read_b64_tr_b16 v[164:165], v21 offset:53248
  v_mfma_f32_16x16x32_bf16 v[104:107], v[196:199], v[48:51], v[104:107]
  ds_read_b64_tr_b16 v[166:167], v21 offset:53760
  v_mfma_f32_16x16x32_bf16 v[112:115], v[200:203], v[48:51], v[112:115]
  ds_read_b64_tr_b16 v[168:169], v22 offset:53248
  v_mfma_f32_16x16x32_bf16 v[116:119], v[200:203], v[52:55], v[116:119]
  ds_read_b64_tr_b16 v[170:171], v22 offset:53760
  v_mfma_f32_16x16x32_bf16 v[124:127], v[204:207], v[52:55], v[124:127]
  ds_read_b64_tr_b16 v[172:173], v23 offset:53248
  v_mfma_f32_16x16x32_bf16 v[120:123], v[204:207], v[48:51], v[120:123]
  ds_read_b64_tr_b16 v[174:175], v23 offset:53760
  s_waitcnt vmcnt(8) lgkmcnt(8)
  v_mfma_f32_16x16x32_bf16 v[96:99], v[208:211], v[56:59], v[96:99]
  ds_read_b64_tr_b16 v[176:177], v20 offset:57344
  v_mfma_f32_16x16x32_bf16 v[100:103], v[208:211], v[60:63], v[100:103]
  ds_read_b64_tr_b16 v[178:179], v20 offset:57856
  v_mfma_f32_16x16x32_bf16 v[108:111], v[212:215], v[60:63], v[108:111]
  ds_read_b64_tr_b16 v[180:181], v21 offset:57344
  v_mfma_f32_16x16x32_bf16 v[104:107], v[212:215], v[56:59], v[104:107]
  ds_read_b64_tr_b16 v[182:183], v21 offset:57856
  v_mfma_f32_16x16x32_bf16 v[112:115], v[216:219], v[56:59], v[112:115]
  ds_read_b64_tr_b16 v[184:185], v22 offset:57344
  v_mfma_f32_16x16x32_bf16 v[116:119], v[216:219], v[60:63], v[116:119]
  ds_read_b64_tr_b16 v[186:187], v22 offset:57856
  v_mfma_f32_16x16x32_bf16 v[124:127], v[220:223], v[60:63], v[124:127]
  ds_read_b64_tr_b16 v[188:189], v23 offset:57344
  v_mfma_f32_16x16x32_bf16 v[120:123], v[220:223], v[56:59], v[120:123]
  ds_read_b64_tr_b16 v[190:191], v23 offset:57856
  s_waitcnt vmcnt(6) lgkmcnt(8)
  v_mfma_f32_16x16x32_bf16 v[96:99], v[160:163], v[64:67], v[96:99]
  ds_read_b64_tr_b16 v[192:193], v26 offset:0
  v_mfma_f32_16x16x32_bf16 v[100:103], v[160:163], v[68:71], v[100:103]
  ds_read_b64_tr_b16 v[194:195], v26 offset:512
  v_mfma_f32_16x16x32_bf16 v[108:111], v[164:167], v[68:71], v[108:111]
  ds_read_b64_tr_b16 v[196:197], v27 offset:0
  v_mfma_f32_16x16x32_bf16 v[104:107], v[164:167], v[64:67], v[104:107]
  ds_read_b64_tr_b16 v[198:199], v27 offset:512
  v_mfma_f32_16x16x32_bf16 v[112:115], v[168:171], v[64:67], v[112:115]
  ds_read_b64_tr_b16 v[200:201], v28 offset:0
  v_mfma_f32_16x16x32_bf16 v[116:119], v[168:171], v[68:71], v[116:119]
  ds_read_b64_tr_b16 v[202:203], v28 offset:512
  v_mfma_f32_16x16x32_bf16 v[124:127], v[172:175], v[68:71], v[124:127]
  ds_read_b64_tr_b16 v[204:205], v29 offset:0
  v_mfma_f32_16x16x32_bf16 v[120:123], v[172:175], v[64:67], v[120:123]
  ds_read_b64_tr_b16 v[206:207], v29 offset:512
  s_waitcnt vmcnt(4) lgkmcnt(8)
  v_mfma_f32_16x16x32_bf16 v[96:99], v[176:179], v[72:75], v[96:99]
  ds_read_b64_tr_b16 v[208:209], v26 offset:4096
  v_mfma_f32_16x16x32_bf16 v[100:103], v[176:179], v[76:79], v[100:103]
  ds_read_b64_tr_b16 v[210:211], v26 offset:4608
  v_mfma_f32_16x16x32_bf16 v[108:111], v[180:183], v[76:79], v[108:111]
  ds_read_b64_tr_b16 v[212:213], v27 offset:4096
  v_mfma_f32_16x16x32_bf16 v[104:107], v[180:183], v[72:75], v[104:107]
  ds_read_b64_tr_b16 v[214:215], v27 offset:4608
  v_mfma_f32_16x16x32_bf16 v[112:115], v[184:187], v[72:75], v[112:115]
  ds_read_b64_tr_b16 v[216:217], v28 offset:4096
  v_mfma_f32_16x16x32_bf16 v[116:119], v[184:187], v[76:79], v[116:119]
  ds_read_b64_tr_b16 v[218:219], v28 offset:4608
  v_mfma_f32_16x16x32_bf16 v[124:127], v[188:191], v[76:79], v[124:127]
  ds_read_b64_tr_b16 v[220:221], v29 offset:4096
  v_mfma_f32_16x16x32_bf16 v[120:123], v[188:191], v[72:75], v[120:123]
  ds_read_b64_tr_b16 v[222:223], v29 offset:4608
  s_waitcnt vmcnt(2) lgkmcnt(8)
  v_mfma_f32_16x16x32_bf16 v[96:99], v[192:195], v[80:83], v[96:99]
  v_mov_b32 v20, 0
  v_mov_b32 v21, 0
  v_mfma_f32_16x16x32_bf16 v[100:103], v[192:195], v[84:87], v[100:103]
  v_mov_b32 v22, 0
  v_mov_b32 v23, 0
  v_mfma_f32_16x16x32_bf16 v[108:111], v[196:199], v[84:87], v[108:111]
  v_mfma_f32_16x16x32_bf16 v[104:107], v[196:199], v[80:83], v[104:107]
  v_mfma_f32_16x16x32_bf16 v[112:115], v[200:203], v[80:83], v[112:115]
  v_mfma_f32_16x16x32_bf16 v[116:119], v[200:203], v[84:87], v[116:119]
  v_mfma_f32_16x16x32_bf16 v[124:127], v[204:207], v[84:87], v[124:127]
  v_mfma_f32_16x16x32_bf16 v[120:123], v[204:207], v[80:83], v[120:123]
  s_waitcnt vmcnt(0) lgkmcnt(0)
  v_mfma_f32_16x16x32_bf16 v[96:99], v[208:211], v[88:91], v[96:99]
  v_mfma_f32_16x16x32_bf16 v[100:103], v[208:211], v[92:95], v[100:103]
  v_mfma_f32_16x16x32_bf16 v[108:111], v[212:215], v[92:95], v[108:111]
  v_mfma_f32_16x16x32_bf16 v[104:107], v[212:215], v[88:91], v[104:107]
  v_mfma_f32_16x16x32_bf16 v[112:115], v[216:219], v[88:91], v[112:115]
  v_mfma_f32_16x16x32_bf16 v[116:119], v[216:219], v[92:95], v[116:119]
  v_mfma_f32_16x16x32_bf16 v[124:127], v[220:223], v[92:95], v[124:127]
  v_mfma_f32_16x16x32_bf16 v[120:123], v[220:223], v[88:91], v[120:123]
  s_mov_b32 s3, 32768
  s_mov_b32 s10, 0x3f803f80
  s_nop 4
  v_cvt_pk_bf16_f32 v240, v96, v97
  v_cvt_pk_bf16_f32 v241, v98, v99
  v_cvt_pk_bf16_f32 v242, v104, v105
  v_cvt_pk_bf16_f32 v243, v106, v107
  s_nop 1
  v_permlane16_swap_b32 v240, v242
  v_permlane16_swap_b32 v241, v243
  buffer_store_dwordx4 v[240:243], v12, s[44:47], 0 offen offset:0 sc1
  ds_write_b128 v19, v[240:243] offset:0
  v_cvt_pk_bf16_f32 v244, v112, v113
  v_cvt_pk_bf16_f32 v245, v114, v115
  v_cvt_pk_bf16_f32 v246, v120, v121
  v_cvt_pk_bf16_f32 v247, v122, v123
  s_nop 1
  v_permlane16_swap_b32 v244, v246
  v_permlane16_swap_b32 v245, v247
  buffer_store_dwordx4 v[244:247], v12, s[44:47], 0 offen offset:1024 sc1
  ds_write_b128 v19, v[244:247] offset:1024
  v_cvt_pk_bf16_f32 v248, v100, v101
  v_cvt_pk_bf16_f32 v249, v102, v103
  v_cvt_pk_bf16_f32 v250, v108, v109
  v_cvt_pk_bf16_f32 v251, v110, v111
  s_nop 1
  v_permlane16_swap_b32 v248, v250
  v_permlane16_swap_b32 v249, v251
  buffer_store_dwordx4 v[248:251], v12, s[44:47], s3 offen offset:0 sc1
  ds_write_b128 v19, v[248:251] offset:2048
  v_cvt_pk_bf16_f32 v252, v116, v117
  v_cvt_pk_bf16_f32 v253, v118, v119
  v_cvt_pk_bf16_f32 v254, v124, v125
  v_cvt_pk_bf16_f32 v255, v126, v127
  s_nop 1
  v_permlane16_swap_b32 v252, v254
  v_permlane16_swap_b32 v253, v255
  buffer_store_dwordx4 v[252:255], v12, s[44:47], s3 offen offset:1024 sc1
  ds_write_b128 v19, v[252:255] offset:3072
  v_dot2_f32_bf16 v20, v240, s10, v20
  v_dot2_f32_bf16 v22, v240, v240, v22
  v_dot2_f32_bf16 v20, v241, s10, v20
  v_dot2_f32_bf16 v22, v241, v241, v22
  v_dot2_f32_bf16 v20, v242, s10, v20
  v_dot2_f32_bf16 v22, v242, v242, v22
  v_dot2_f32_bf16 v20, v243, s10, v20
  v_dot2_f32_bf16 v22, v243, v243, v22
  v_dot2_f32_bf16 v20, v244, s10, v20
  v_dot2_f32_bf16 v22, v244, v244, v22
  v_dot2_f32_bf16 v20, v245, s10, v20
  v_dot2_f32_bf16 v22, v245, v245, v22
  v_dot2_f32_bf16 v20, v246, s10, v20
  v_dot2_f32_bf16 v22, v246, v246, v22
  v_dot2_f32_bf16 v20, v247, s10, v20
  v_dot2_f32_bf16 v22, v247, v247, v22
  v_dot2_f32_bf16 v21, v248, s10, v21
  v_dot2_f32_bf16 v23, v248, v248, v23
  v_dot2_f32_bf16 v21, v249, s10, v21
  v_dot2_f32_bf16 v23, v249, v249, v23
  v_dot2_f32_bf16 v21, v250, s10, v21
  v_dot2_f32_bf16 v23, v250, v250, v23
  v_dot2_f32_bf16 v21, v251, s10, v21
  v_dot2_f32_bf16 v23, v251, v251, v23
  v_dot2_f32_bf16 v21, v252, s10, v21
  v_dot2_f32_bf16 v23, v252, v252, v23
  v_dot2_f32_bf16 v21, v253, s10, v21
  v_dot2_f32_bf16 v23, v253, v253, v23
  v_dot2_f32_bf16 v21, v254, s10, v21
  v_dot2_f32_bf16 v23, v254, v254, v23
  v_dot2_f32_bf16 v21, v255, s10, v21
  v_dot2_f32_bf16 v23, v255, v255, v23
  s_nop 2
  v_permlane32_swap_b32 v20, v21
  v_permlane32_swap_b32 v22, v23
  v_add_f32 v20, v20, v21
  v_add_f32 v22, v22, v23
  s_nop 1
  v_permlane16_swap_b32 v20, v22
  v_add_f32 v20, v20, v22
  buffer_store_dword v20, v18, s[56:59], 0 offen sc1
  s_waitcnt vmcnt(0) lgkmcnt(0)
  s_barrier
  s_add_u32 s97, s97, 1
  s_branch L_w1_body
L_wo_c1:
L_w1_c0:
L_w1_body:
  s_cmp_ge_u32 s2, 256
  s_cbranch_scc1 L_w1_end
  v_lshrrev_b32 v2, 6, v0
  v_and_b32 v1, 63, v0
  v_readfirstlane_b32 s70, v2
  s_and_b32 s3, s2, 7
  s_lshr_b32 s99, s2, 3
  s_and_b32 s5, s3, 3
  s_lshl_b32 s5, s5, 2
  s_and_b32 s6, s99, 3
  s_add_u32 s68, s5, s6
  s_lshr_b32 s5, s3, 2
  s_lshl_b32 s5, s5, 3
  s_lshr_b32 s6, s99, 2
  s_add_u32 s69, s5, s6
  s_cmp_lt_u32 s70, 4
  s_cbranch_scc1 L_w1_compute
L_w1_loader:
  s_add_u32 s8, s70, s69
  s_and_b32 s8, s8, 3
  s_add_u32 s9, s70, s68
  s_and_b32 s9, s9, 3
  s_lshl_b32 s76, s8, 12
  s_lshl_b32 s77, s9, 11
  s_add_u32 s77, s77, 16384
  s_lshl_b32 s11, s68, 7
  v_and_b32 v10, 7, v1
  s_lshr_b32 s10, s76, 11
  s_lshl_b32 s3, s68, 3
  s_add_u32 s10, s10, s3
  s_mul_i32 s10, s10, 32768
  v_lshl_add_u32 v4, v1, 4, s10
  v_add_u32 v5, 32768, v4
  v_lshrrev_b32 v3, 3, v1
  s_lshl_b32 s10, s9, 4
  v_add_u32 v3, s10, v3
  v_mul_u32_u24 v3, 7168, v3
  v_lshrrev_b32 v2, 3, v1
  v_and_b32 v2, 2, v2
  v_xor_b32 v2, v2, v10
  s_mul_i32 s10, s69, 128
  v_add_u32 v3, s10, v3
  v_lshl_add_u32 v8, v2, 4, v3
  v_xor_b32 v2, 4, v2
  v_add_u32 v3, 57344, v3
  v_lshl_add_u32 v9, v2, 4, v3
  v_lshrrev_b32 v3, 2, v1
  s_lshl_b32 s10, s9, 4
  v_add_u32 v3, s10, v3
  v_mul_u32_u24 v3, 7168, v3
  v_lshrrev_b32 v2, 4, v1
  v_and_b32 v2, 2, v2
  v_xor_b32 v2, v2, v1
  v_and_b32 v2, 3, v2
  s_lshl_b32 s10, s69, 6
  s_add_u32 s10, s10, 2048
  v_add_u32 v3, s10, v3
  v_lshl_add_u32 v28, v2, 4, v3
  s_lshl_b32 s78, s69, 7
  s_add_u32 s78, s78, 3072
  s_mov_b32 s75, 0
  s_add_u32 s100, s68, s69
  s_mov_b32 s101, -1
  s_add_u32 s3, s68, s69
  s_and_b32 s3, s3, 3
  s_mov_b32 s100, 0x68532410
  s_mov_b32 s101, 0xfedbac97
  s_cmp_eq_u32 s3, 1
  s_cselect_b32 s100, 0x96435210, s100
  s_cselect_b32 s101, 0xfecbda87, s101
  s_cmp_eq_u32 s3, 2
  s_cselect_b32 s100, 0x75463210, s100
  s_cselect_b32 s101, 0xfdceb98a, s101
  s_cmp_eq_u32 s3, 3
  s_cselect_b32 s100, 0x65743210, s100
  s_cselect_b32 s101, 0xedfca9b8, s101
  s_waitcnt lgkmcnt(0)
  s_cmp_lg_u32 s96, 0
  s_cbranch_scc1 L_pfc3_skip
  s_getpc_b64 s[4:5]
L_pfc3:
  s_lshl_b32 s3, s99, 2
  s_add_u32 s3, s3, s70
  s_sub_u32 s3, s3, 4
  s_mul_i32 s3, s3, 192
  s_min_u32 s3, s3, L_w2_c1-L_w2_c0-192
  s_add_i32 s3, s3, L_w2_c0-L_pfc3
  s_ashr_i32 s6, s3, 31
  s_add_u32 s4, s4, s3
  s_addc_u32 s5, s5, s6
  s_load_dword s84, s[4:5], 0
  s_load_dword s84, s[4:5], 64
  s_load_dword s84, s[4:5], 128
L_pfc3_skip:
  s_add_u32 s36, s34, 4194304
  s_addc_u32 s37, s35, 0
  s_and_b32 s37, s37, 0xffff
  s_mov_b32 s38, 4194304
  s_mov_b32 s39, 0x00020000
  s_mov_b32 s40, s24
  s_and_b32 s41, s25, 0xffff
  s_mov_b32 s42, 7340032
  s_mov_b32 s43, 0x00020000
  s_add_u32 s56, s34, 24117248
  s_addc_u32 s57, s35, 0
  s_and_b32 s57, s57, 0xffff
  s_mov_b32 s58, 262144
  s_mov_b32 s59, 0x00020000
  s_add_u32 s64, s22, 24641536
  s_addc_u32 s65, s23, 0
  s_and_b32 s65, s65, 0xffff
  s_mov_b32 s66, 262144
  s_mov_b32 s67, 0x00020000
  s_mov_b32 s52, s26
  s_and_b32 s53, s27, 0xffff
  s_mov_b32 s54, 7168
  s_mov_b32 s55, 0x00020000
  s_and_b32 s3, s70, 3
  s_lshl2_add_u32 s4, s68, s3
  s_lshl_b32 s4, s4, 8
  v_lshrrev_b32 v2, 4, v1
  v_and_b32 v3, 15, v1
  v_lshl_add_u32 v3, v3, 4, s4
  v_lshl_add_u32 v18, v2, 14, v3
  s_lshl_b32 s4, s69, 7
  s_lshl_b32 s5, s70, 6
  s_add_u32 s4, s4, s5
  s_add_u32 s4, s4, 1216
  s_lshl_b32 s5, s69, 6
  s_cmp_eq_u32 s70, 4
  s_cselect_b32 s4, s5, s4
  s_lshr_b32 s5, s5, 1
  s_add_u32 s5, s5, 1024
  s_cmp_eq_u32 s70, 7
  s_cselect_b32 s4, s5, s4
  v_and_b32 v3, 15, v1
  v_lshl_add_u32 v3, v3, 2, s4
  v_lshrrev_b32 v2, 4, v1
  v_add_lshl_u32 v23, v3, v2, 1
  v_lshlrev_b32 v3, 2, v3
  v_lshl_add_u32 v22, v2, 14, v3
  s_mov_b32 s60, s28
  s_and_b32 s61, s29, 0xffff
  s_mov_b32 s62, 7340032
  s_mov_b32 s63, 0x00020000
  s_cmp_eq_u32 s96, 0
  s_cselect_b32 s62, s62, 0
  s_and_b32 s3, s70, 3
  s_lshl_b32 s4, s2, 2
  s_add_u32 s3, s3, s4
  s_mul_i32 s98, s3, 3584
  s_add_u32 s98, s98, 3670016
  s_buffer_load_dword s84, s[60:63], s98 offset:0
  s_buffer_load_dword s84, s[60:63], s98 offset:64
  s_buffer_load_dword s84, s[60:63], s98 offset:128
  s_buffer_load_dword s84, s[60:63], s98 offset:192
  s_lshr_b32 s3, s69, 3
  s_and_b32 s73, s69, 7
  s_lshl1_add_u32 s91, s73, s3
  s_mul_i32 s74, s91, 458752
  s_lshl_b32 s73, s91, 11
  s_mov_b32 s88, s73
  s_add_u32 m0, s77, 0
  s_add_u32 s4, s74, 0
  buffer_load_dwordx4 v8, s[40:43], s4 offen lds
  s_add_u32 m0, s77, 1024
  s_nop 0
  buffer_load_dwordx4 v9, s[40:43], s4 offen lds
  s_add_u32 m0, s77, 8192
  s_add_u32 s4, s74, s78
  buffer_load_dwordx4 v8, s[40:43], s4 offen lds
  s_add_u32 m0, s77, 9216
  s_nop 0
  buffer_load_dwordx4 v9, s[40:43], s4 offen lds
  s_add_u32 m0, s77, 16384
  s_add_u32 s4, s4, 128
  buffer_load_dwordx4 v8, s[40:43], s4 offen lds
  s_add_u32 m0, s77, 17408
  s_nop 0
  buffer_load_dwordx4 v9, s[40:43], s4 offen lds
  s_add_u32 m0, s77, 24576
  s_nop 0
  buffer_load_dwordx4 v28, s[40:43], s74 offen lds
  s_and_b32 s73, s100, 15
  s_cmp_eq_u32 s73, s91
  s_cselect_b32 s74, 4, 0
  s_lshr_b64 s[100:101], s[100:101], s74
  s_and_b32 s73, s100, 15
  s_lshr_b64 s[100:101], s[100:101], 4
  s_mul_i32 s74, s73, 458752
  s_lshl_b32 s73, s73, 11
  s_add_u32 s3, s96, s70
  s_cmp_lg_u32 s3, 4
  s_cbranch_scc1 L_w1_chkNone
  s_add_u32 s44, s22, 41943040
  s_addc_u32 s45, s23, 0
  s_and_b32 s45, s45, 0xffff
  s_mov_b32 s46, 524288
  s_mov_b32 s47, 0x00020000
  v_lshrrev_b32 v2, 2, v1
  v_and_b32 v3, 3, v1
  v_lshlrev_b32 v2, 11, v2
  v_lshl_add_u32 v17, v3, 4, v2
  s_and_b32 s3, s69, 15
  s_lshl_b32 s3, s3, 7
  s_mov_b32 s79, 0x100000
L_w1_chkl:
  buffer_load_dwordx4 v[12:15], v17, s[44:47], s3 offen sc1
  s_sub_u32 s79, s79, 1
  s_cbranch_scc1 L_w1_chkNone
  s_waitcnt vmcnt(0)
  v_and_b32 v12, v12, v13
  v_and_b32 v14, v14, v15
  v_and_b32 v12, v12, v14
  v_cmp_ne_u32 vcc, 1, v12
  s_cbranch_vccnz L_w1_chkl
L_w1_chkNone:
  s_mov_b32 s75, 0
  s_add_u32 s44, s22, 41943040
  s_addc_u32 s45, s23, 0
  s_and_b32 s45, s45, 0xffff
  s_mov_b32 s46, 524288
  s_mov_b32 s47, 0x00020000
  s_lshl4_add_u32 s3, s97, s68
  s_and_b32 s4, s69, 15
  s_lshl4_add_u32 s3, s3, s4
  s_lshl_b32 s3, s3, 7
  s_sub_u32 s3, s3, 32768
  v_lshlrev_b32 v11, 7, v1
  v_and_b32 v2, 15, v1
  v_lshlrev_b32 v2, 2, v2
  v_mov_b32 v3, 1
  s_mov_b32 s79, 0x100000
  s_waitcnt vmcnt(0)
  s_cmp_lg_u32 s70, 4
  s_barrier
  s_cbranch_scc1 L_w1_nofl
  s_mov_b32 exec_lo, 0xffff
  s_mov_b32 exec_hi, 0
  buffer_store_dword v3, v11, s[44:47], s87 offen sc1
  s_mov_b64 exec, -1
L_w1_nofl:
  s_mov_b32 s5, s3
  s_mov_b32 s89, s73
  s_add_u32 m0, s77, 49152
  s_add_u32 s4, s74, 0
  buffer_load_dwordx4 v8, s[40:43], s4 offen lds
  s_add_u32 m0, s77, 50176
  s_nop 0
  buffer_load_dwordx4 v9, s[40:43], s4 offen lds
  s_add_u32 m0, s77, 57344
  s_add_u32 s4, s74, s78
  buffer_load_dwordx4 v8, s[40:43], s4 offen lds
  s_add_u32 m0, s77, 58368
  s_nop 0
  buffer_load_dwordx4 v9, s[40:43], s4 offen lds
  s_add_u32 m0, s77, 65536
  s_add_u32 s4, s4, 128
  buffer_load_dwordx4 v8, s[40:43], s4 offen lds
  s_add_u32 m0, s77, 66560
  s_nop 0
  buffer_load_dwordx4 v9, s[40:43], s4 offen lds
  s_add_u32 m0, s77, 73728
  s_nop 0
  buffer_load_dwordx4 v28, s[40:43], s74 offen lds
  s_and_b32 s73, s100, 15
  s_cmp_eq_u32 s73, s91
  s_cselect_b32 s74, 4, 0
  s_lshr_b64 s[100:101], s[100:101], s74
  s_and_b32 s73, s100, 15
  s_lshr_b64 s[100:101], s[100:101], 4
  s_mul_i32 s74, s73, 458752
  s_lshl_b32 s73, s73, 11
  s_mov_b32 s90, s73
  s_add_u32 m0, s77, 98304
  s_add_u32 s4, s74, 0
  buffer_load_dwordx4 v8, s[40:43], s4 offen lds
  s_add_u32 m0, s77, 99328
  s_nop 0
  buffer_load_dwordx4 v9, s[40:43], s4 offen lds
  s_add_u32 m0, s77, 106496
  s_add_u32 s4, s74, s78
  buffer_load_dwordx4 v8, s[40:43], s4 offen lds
  s_add_u32 m0, s77, 107520
  s_nop 0
  buffer_load_dwordx4 v9, s[40:43], s4 offen lds
  s_add_u32 m0, s77, 114688
  s_add_u32 s4, s4, 128
  buffer_load_dwordx4 v8, s[40:43], s4 offen lds
  s_add_u32 m0, s77, 115712
  s_nop 0
  buffer_load_dwordx4 v9, s[40:43], s4 offen lds
  s_add_u32 m0, s77, 122880
  s_nop 0
  buffer_load_dwordx4 v28, s[40:43], s74 offen lds
  s_and_b32 s73, s100, 15
  s_cmp_eq_u32 s73, s91
  s_cselect_b32 s74, 4, 0
  s_lshr_b64 s[100:101], s[100:101], s74
  s_and_b32 s73, s100, 15
  s_lshr_b64 s[100:101], s[100:101], 4
  s_mul_i32 s74, s73, 458752
  s_lshl_b32 s73, s73, 11
  s_mov_b32 s3, s5
  s_cmp_lg_u32 s70, 4
  s_cbranch_scc1 L_w1_dep
L_w1_poll:
  buffer_load_dword v3, v2, s[44:47], s3 offen sc1
  s_sub_u32 s79, s79, 1
  s_cbranch_scc1 L_w1_dep
  s_waitcnt vmcnt(0)
  v_cmp_ne_u32 vcc, 1, v3
  s_cbranch_vccnz L_w1_poll
L_w1_dep:
  s_barrier
  s_add_u32 m0, s76, 49152
  s_nop 0
  buffer_load_dwordx4 v4, s[36:39], s89 offen offset:0 lds
  buffer_load_dwordx4 v4, s[36:39], s89 offen offset:1024 lds
  s_add_u32 m0, s76, 51200
  s_nop 0
  buffer_load_dwordx4 v5, s[36:39], s89 offen offset:0 lds
  buffer_load_dwordx4 v5, s[36:39], s89 offen offset:1024 lds
  s_add_u32 m0, s76, 98304
  s_nop 0
  buffer_load_dwordx4 v4, s[36:39], s90 offen offset:0 lds
  buffer_load_dwordx4 v4, s[36:39], s90 offen offset:1024 lds
  s_add_u32 m0, s76, 100352
  s_nop 0
  buffer_load_dwordx4 v5, s[36:39], s90 offen offset:0 lds
  buffer_load_dwordx4 v5, s[36:39], s90 offen offset:1024 lds
  s_waitcnt vmcnt(4)
  s_barrier
  s_mov_b32 s79, 13
L_w1_ld1:
  s_add_u32 s3, s75, s76
  s_add_u32 m0, s3, 0
  s_nop 0
  buffer_load_dwordx4 v4, s[36:39], s73 offen offset:0 lds
  buffer_load_dwordx4 v4, s[36:39], s73 offen offset:1024 lds
  s_add_u32 m0, s3, 2048
  s_nop 0
  buffer_load_dwordx4 v5, s[36:39], s73 offen offset:0 lds
  buffer_load_dwordx4 v5, s[36:39], s73 offen offset:1024 lds
  s_add_u32 s3, s75, s77
  s_add_u32 m0, s3, 0
  s_add_u32 s4, s74, 0
  buffer_load_dwordx4 v8, s[40:43], s4 offen lds
  s_add_u32 m0, s3, 1024
  s_nop 0
  buffer_load_dwordx4 v9, s[40:43], s4 offen lds
  s_add_u32 m0, s3, 8192
  s_add_u32 s4, s74, s78
  buffer_load_dwordx4 v8, s[40:43], s4 offen lds
  s_add_u32 m0, s3, 9216
  s_nop 0
  buffer_load_dwordx4 v9, s[40:43], s4 offen lds
  s_add_u32 m0, s3, 16384
  s_add_u32 s4, s4, 128
  buffer_load_dwordx4 v8, s[40:43], s4 offen lds
  s_add_u32 m0, s3, 17408
  s_nop 0
  buffer_load_dwordx4 v9, s[40:43], s4 offen lds
  s_add_u32 m0, s3, 24576
  s_nop 0
  buffer_load_dwordx4 v28, s[40:43], s74 offen lds
  s_and_b32 s73, s100, 15
  s_cmp_eq_u32 s73, s91
  s_cselect_b32 s74, 4, 0
  s_lshr_b64 s[100:101], s[100:101], s74
  s_and_b32 s73, s100, 15
  s_lshr_b64 s[100:101], s[100:101], 4
  s_mul_i32 s74, s73, 458752
  s_lshl_b32 s73, s73, 11
  s_add_u32 s75, s75, 49152
  s_cmp_eq_u32 s75, 147456
  s_cselect_b32 s75, 0, s75
  s_buffer_load_dword s84, s[60:63], s98 offset:256
  s_buffer_load_dword s84, s[60:63], s98 offset:320
  s_buffer_load_dword s84, s[60:63], s98 offset:384
  s_buffer_load_dword s84, s[60:63], s98 offset:448
  s_add_u32 s98, s98, 256
  s_waitcnt vmcnt(11)
  s_barrier
  s_sub_u32 s79, s79, 1
  s_cmp_lg_u32 s79, 0
  s_cbranch_scc1 L_w1_ld1
  buffer_load_dwordx4 v[64:67], v22, s[64:67], 0 offen
  s_mov_b32 s3, 65536
  buffer_load_dwordx4 v[68:71], v22, s[64:67], s3 offen
  s_mov_b32 s3, 131072
  buffer_load_dwordx4 v[72:75], v22, s[64:67], s3 offen
  s_mov_b32 s3, 196608
  buffer_load_dwordx4 v[76:79], v22, s[64:67], s3 offen
  buffer_load_ushort v80, v23, s[52:55], 0 offen
  buffer_load_dwordx4 v[32:35], v18, s[56:59], 0 offen
  s_mov_b32 s3, 65536
  buffer_load_dwordx4 v[36:39], v18, s[56:59], s3 offen
  s_mov_b32 s3, 131072
  buffer_load_dwordx4 v[40:43], v18, s[56:59], s3 offen
  s_mov_b32 s3, 196608
  buffer_load_dwordx4 v[44:47], v18, s[56:59], s3 offen
  s_waitcnt vmcnt(9)
  s_barrier
  s_waitcnt vmcnt(0)
  v_pk_add_f32 v[32:33], v[32:33], v[36:37]
  v_pk_add_f32 v[34:35], v[34:35], v[38:39]
  v_pk_add_f32 v[40:41], v[40:41], v[44:45]
  v_pk_add_f32 v[42:43], v[42:43], v[46:47]
  v_pk_add_f32 v[32:33], v[32:33], v[40:41]
  v_pk_add_f32 v[34:35], v[34:35], v[42:43]
  s_nop 1
  v_permlane32_swap_b32 v32, v34
  v_permlane32_swap_b32 v33, v35
  v_pk_add_f32 v[32:33], v[32:33], v[34:35]
  v_mov_b32 v34, v32
  v_mov_b32 v35, v33
  s_nop 0
  v_permlane16_swap_b32 v32, v34
  v_permlane16_swap_b32 v33, v35
  v_pk_add_f32 v[32:33], v[32:33], v[34:35]
  v_mul_f32 v32, 0x3a800000, v32
  v_mul_f32 v33, 0x3a800000, v33
  v_fma_f32 v33, -v32, v32, v33
  v_max_f32 v33, 0, v33
  v_add_f32 v33, 0x3727c5ac, v33
  v_rsq_f32 v33, v33
  s_nop 0
  s_and_b32 s3, s70, 3
  s_lshl_b32 s5, s3, 7
  s_add_u32 s5, s5, 110656
  v_and_b32 v3, 15, v1
  v_lshrrev_b32 v2, 5, v1
  v_lshl_add_u32 v2, v3, 1, v2
  v_lshl_add_u32 v2, v2, 2, s5
  ds_write2_b32 v2, v32, v33 offset0:0 offset1:160
  v_pk_add_f32 v[64:65], v[64:65], v[68:69]
  v_pk_add_f32 v[66:67], v[66:67], v[70:71]
  v_pk_add_f32 v[72:73], v[72:73], v[76:77]
  v_pk_add_f32 v[74:75], v[74:75], v[78:79]
  v_pk_add_f32 v[64:65], v[64:65], v[72:73]
  v_pk_add_f32 v[66:67], v[66:67], v[74:75]
  s_nop 1
  v_permlane32_swap_b32 v64, v66
  v_permlane32_swap_b32 v65, v67
  v_pk_add_f32 v[64:65], v[64:65], v[66:67]
  v_lshlrev_b32 v80, 16, v80
  s_lshl_b32 s5, s3, 8
  s_add_u32 s5, s5, 111872
  v_permlane16_swap_b32 v64, v65
  v_lshrrev_b32 v2, 4, v1
  v_lshl_add_u32 v2, v3, 2, v2
  v_lshl_add_u32 v2, v2, 2, s5
  v_add_f32 v64, v64, v65
  ds_write2st64_b32 v2, v64, v80 offset0:0 offset1:4
  s_waitcnt lgkmcnt(0)
  s_barrier
  s_lshl_b32 s87, s97, 15
  s_lshl_b32 s4, s68, 11
  s_add_u32 s87, s87, s4
  s_lshl_b32 s4, s69, 2
  s_add_u32 s87, s87, s4
  s_add_u32 s97, s97, 1
  s_branch L_w2_body
L_w1_end:
  s_endpgm
L_w1_compute:
  s_and_b32 s71, s70, 1
  s_lshr_b32 s72, s70, 1
  v_and_b32 v3, 15, v1
  v_lshrrev_b32 v2, 4, v1
  s_lshl_b32 s8, s71, 13
  v_lshl_add_u32 v4, v1, 4, s8
  v_bfe_u32 v13, v1, 2, 2
  v_lshl_add_u32 v13, v2, 3, v13
  v_lshlrev_b32 v13, 7, v13
  v_and_b32 v17, 3, v1
  v_lshl_add_u32 v13, v17, 3, v13
  v_bfe_u32 v17, v1, 3, 2
  v_lshl_add_u32 v13, v17, 5, v13
  s_lshl_b32 s9, s72, 6
  v_xor_b32 v13, s9, v13
  v_add_u32 v5, 16384, v13
  v_xor_b32 v6, 32, v5
  v_and_b32 v16, 1, v2
  v_lshrrev_b32 v17, 1, v2
  v_bfe_u32 v13, v1, 2, 2
  v_lshl_add_u32 v13, v16, 3, v13
  v_lshl_add_u32 v13, v17, 5, v13
  v_xor_b32 v14, s72, v16
  v_lshl_add_u32 v13, v13, 1, v14
  v_and_b32 v14, 3, v1
  v_lshl_add_u32 v13, v13, 2, v14
  v_lshlrev_b32 v13, 3, v13
  v_add_u32 v7, 40960, v13
  s_mov_b32 s75, 0
  v_add_u32_e64 v20, s75, v4
  v_add_u32_e64 v21, s75, v5
  v_add_u32_e64 v22, s75, v6
  v_add_u32_e64 v23, s75, v7
  s_add_u32 s75, s75, 49152
  s_cmp_eq_u32 s75, 147456
  s_cselect_b32 s75, 0, s75
  s_mov_b32 s79, 15
  ds_read_b128 v[32:35], v20 offset:0
  ds_read_b128 v[36:39], v20 offset:2048
  ds_read_b128 v[40:43], v20 offset:4096
  ds_read_b128 v[44:47], v20 offset:6144
  ds_read_b64_tr_b16 v[48:49], v21 offset:0
  ds_read_b64_tr_b16 v[50:51], v21 offset:512
  ds_read_b64_tr_b16 v[52:53], v22 offset:0
  ds_read_b64_tr_b16 v[54:55], v22 offset:512
  ds_read_b64_tr_b16 v[56:57], v21 offset:8192
  ds_read_b64_tr_b16 v[58:59], v21 offset:8704
  ds_read_b64_tr_b16 v[60:61], v22 offset:8192
  ds_read_b64_tr_b16 v[62:63], v22 offset:8704
  ds_read_b64_tr_b16 v[64:65], v21 offset:16384
  ds_read_b64_tr_b16 v[66:67], v21 offset:16896
  ds_read_b64_tr_b16 v[68:69], v22 offset:16384
  ds_read_b64_tr_b16 v[70:71], v22 offset:16896
  ds_read_b64_tr_b16 v[72:73], v23 offset:0
  ds_read_b64_tr_b16 v[74:75], v23 offset:256
  s_waitcnt lgkmcnt(0)
  v_mfma_f32_16x16x32_bf16 v[128:131], v[48:51], v[32:35], 0
  ds_read_b128 v[80:83], v20 offset:1024
  v_mfma_f32_16x16x32_bf16 v[132:135], v[48:51], v[36:39], 0
  ds_read_b128 v[84:87], v20 offset:3072
  v_mfma_f32_16x16x32_bf16 v[136:139], v[48:51], v[40:43], 0
  ds_read_b128 v[88:91], v20 offset:5120
  v_mfma_f32_16x16x32_bf16 v[140:143], v[48:51], v[44:47], 0
  ds_read_b128 v[92:95], v20 offset:7168
  v_mfma_f32_16x16x32_bf16 v[156:159], v[52:55], v[44:47], 0
  ds_read_b64_tr_b16 v[96:97], v21 offset:4096
  v_mfma_f32_16x16x32_bf16 v[152:155], v[52:55], v[40:43], 0
  ds_read_b64_tr_b16 v[98:99], v21 offset:4608
  v_mfma_f32_16x16x32_bf16 v[148:151], v[52:55], v[36:39], 0
  ds_read_b64_tr_b16 v[100:101], v22 offset:4096
  v_mfma_f32_16x16x32_bf16 v[144:147], v[52:55], v[32:35], 0
  ds_read_b64_tr_b16 v[102:103], v22 offset:4608
  v_mfma_f32_16x16x32_bf16 v[160:163], v[56:59], v[32:35], 0
  ds_read_b64_tr_b16 v[104:105], v21 offset:12288
  v_mfma_f32_16x16x32_bf16 v[164:167], v[56:59], v[36:39], 0
  ds_read_b64_tr_b16 v[106:107], v21 offset:12800
  v_mfma_f32_16x16x32_bf16 v[168:171], v[56:59], v[40:43], 0
  ds_read_b64_tr_b16 v[108:109], v22 offset:12288
  v_mfma_f32_16x16x32_bf16 v[172:175], v[56:59], v[44:47], 0
  ds_read_b64_tr_b16 v[110:111], v22 offset:12800
  v_mfma_f32_16x16x32_bf16 v[188:191], v[60:63], v[44:47], 0
  ds_read_b64_tr_b16 v[112:113], v21 offset:20480
  v_mfma_f32_16x16x32_bf16 v[184:187], v[60:63], v[40:43], 0
  ds_read_b64_tr_b16 v[114:115], v21 offset:20992
  v_mfma_f32_16x16x32_bf16 v[180:183], v[60:63], v[36:39], 0
  ds_read_b64_tr_b16 v[116:117], v22 offset:20480
  v_mfma_f32_16x16x32_bf16 v[176:179], v[60:63], v[32:35], 0
  ds_read_b64_tr_b16 v[118:119], v22 offset:20992
  v_mfma_f32_16x16x32_bf16 v[192:195], v[64:67], v[32:35], 0
  ds_read_b64_tr_b16 v[120:121], v23 offset:4096
  v_mfma_f32_16x16x32_bf16 v[196:199], v[64:67], v[36:39], 0
  ds_read_b64_tr_b16 v[122:123], v23 offset:4352
  v_mfma_f32_16x16x32_bf16 v[200:203], v[64:67], v[40:43], 0
  v_add_u32_e64 v20, s75, v4
  v_mfma_f32_16x16x32_bf16 v[204:207], v[64:67], v[44:47], 0
  v_add_u32_e64 v21, s75, v5
  v_mfma_f32_16x16x32_bf16 v[220:223], v[68:71], v[44:47], 0
  v_add_u32_e64 v22, s75, v6
  v_mfma_f32_16x16x32_bf16 v[216:219], v[68:71], v[40:43], 0
  v_add_u32_e64 v23, s75, v7
  v_mfma_f32_16x16x32_bf16 v[212:215], v[68:71], v[36:39], 0
  s_add_u32 s75, s75, 49152
  v_mfma_f32_16x16x32_bf16 v[208:211], v[68:71], v[32:35], 0
  s_cmp_eq_u32 s75, 147456
  v_mfma_f32_16x16x32_bf16 v[224:227], v[72:75], v[32:35], 0
  s_cselect_b32 s75, 0, s75
  v_mfma_f32_16x16x32_bf16 v[228:231], v[72:75], v[36:39], 0
  v_mfma_f32_16x16x32_bf16 v[232:235], v[72:75], v[40:43], 0
  v_mfma_f32_16x16x32_bf16 v[236:239], v[72:75], v[44:47], 0
  s_waitcnt lgkmcnt(0)
  v_mfma_f32_16x16x32_bf16 v[128:131], v[96:99], v[80:83], v[128:131]
  v_mfma_f32_16x16x32_bf16 v[132:135], v[96:99], v[84:87], v[132:135]
  v_mfma_f32_16x16x32_bf16 v[136:139], v[96:99], v[88:91], v[136:139]
  v_mfma_f32_16x16x32_bf16 v[140:143], v[96:99], v[92:95], v[140:143]
  v_mfma_f32_16x16x32_bf16 v[156:159], v[100:103], v[92:95], v[156:159]
  v_mfma_f32_16x16x32_bf16 v[152:155], v[100:103], v[88:91], v[152:155]
  v_mfma_f32_16x16x32_bf16 v[148:151], v[100:103], v[84:87], v[148:151]
  v_mfma_f32_16x16x32_bf16 v[144:147], v[100:103], v[80:83], v[144:147]
  v_mfma_f32_16x16x32_bf16 v[160:163], v[104:107], v[80:83], v[160:163]
  v_mfma_f32_16x16x32_bf16 v[164:167], v[104:107], v[84:87], v[164:167]
  v_mfma_f32_16x16x32_bf16 v[168:171], v[104:107], v[88:91], v[168:171]
  v_mfma_f32_16x16x32_bf16 v[172:175], v[104:107], v[92:95], v[172:175]
  v_mfma_f32_16x16x32_bf16 v[188:191], v[108:111], v[92:95], v[188:191]
  v_mfma_f32_16x16x32_bf16 v[184:187], v[108:111], v[88:91], v[184:187]
  v_mfma_f32_16x16x32_bf16 v[180:183], v[108:111], v[84:87], v[180:183]
  v_mfma_f32_16x16x32_bf16 v[176:179], v[108:111], v[80:83], v[176:179]
  v_mfma_f32_16x16x32_bf16 v[192:195], v[112:115], v[80:83], v[192:195]
  v_mfma_f32_16x16x32_bf16 v[196:199], v[112:115], v[84:87], v[196:199]
  v_mfma_f32_16x16x32_bf16 v[200:203], v[112:115], v[88:91], v[200:203]
  v_mfma_f32_16x16x32_bf16 v[204:207], v[112:115], v[92:95], v[204:207]
  v_mfma_f32_16x16x32_bf16 v[220:223], v[116:119], v[92:95], v[220:223]
  v_mfma_f32_16x16x32_bf16 v[216:219], v[116:119], v[88:91], v[216:219]
  v_mfma_f32_16x16x32_bf16 v[212:215], v[116:119], v[84:87], v[212:215]
  v_mfma_f32_16x16x32_bf16 v[208:211], v[116:119], v[80:83], v[208:211]
  v_mfma_f32_16x16x32_bf16 v[224:227], v[120:123], v[80:83], v[224:227]
  v_mfma_f32_16x16x32_bf16 v[228:231], v[120:123], v[84:87], v[228:231]
  v_mfma_f32_16x16x32_bf16 v[232:235], v[120:123], v[88:91], v[232:235]
  v_mfma_f32_16x16x32_bf16 v[236:239], v[120:123], v[92:95], v[236:239]
  s_barrier
  s_lshl_b32 s8, s68, 7
  s_lshl_b32 s9, s71, 6
  s_add_u32 s8, s8, s9
  s_mul_i32 s8, s8, 7168
  v_lshlrev_b32 v14, 8, v17
  v_lshl_add_u32 v14, v3, 4, v14
  s_lshl3_add_u32 s9, s71, s72
  s_lshl_b32 s9, s9, 10
  s_add_u32 s9, s9, 114688
  v_lshl_add_u32 v18, v16, 9, v14
  v_add_u32 v18, s9, v18
  s_mov_b32 s52, s30
  s_and_b32 s53, s31, 0xffff
  s_mov_b32 s54, 2048
  s_mov_b32 s55, 0x00020000
  s_lshr_b32 s9, s69, 3
  s_and_b32 s10, s69, 7
  s_lshl1_add_u32 s9, s10, s9
  s_lshl_b32 s9, s9, 7
  v_lshl_add_u32 v19, v2, 3, s9
  v_add_u32 v14, s8, v14
  s_lshl_b32 s10, s69, 11
  s_lshl_b32 s9, s72, 10
  s_add_u32 s9, s9, s10
  v_lshl_add_u32 v12, v16, 9, v14
  v_add_u32 v12, s9, v12
  v_mul_u32_u24 v16, 114688, v16
  s_lshr_b32 s9, s9, 1
  v_add3_u32 v13, v16, v14, s9
  s_lshl_b32 s9, s71, 8
  s_add_u32 s9, s9, 110656
  v_lshl_add_u32 v14, v3, 2, s9
  s_lshl_b32 s9, s72, 7
  s_add_u32 s9, s9, 111872
  v_lshl_add_u32 v15, v2, 4, s9
  s_lshl_b32 s9, s72, 6
  s_add_u32 s9, s9, 111872
  v_lshl_add_u32 v16, v2, 4, s9
  s_add_u32 s44, s34, 8388608
  s_addc_u32 s45, s35, 0
  s_and_b32 s45, s45, 0xffff
  s_mov_b32 s46, 14680064
  s_mov_b32 s47, 0x00020000
  s_barrier
  ds_read_b128 v[32:35], v20 offset:0
  ds_read_b128 v[36:39], v20 offset:2048
  ds_read_b128 v[40:43], v20 offset:4096
  ds_read_b128 v[44:47], v20 offset:6144
  ds_read_b64_tr_b16 v[48:49], v21 offset:0
  ds_read_b64_tr_b16 v[50:51], v21 offset:512
  ds_read_b64_tr_b16 v[52:53], v22 offset:0
  ds_read_b64_tr_b16 v[54:55], v22 offset:512
  ds_read_b64_tr_b16 v[56:57], v21 offset:8192
  ds_read_b64_tr_b16 v[58:59], v21 offset:8704
  ds_read_b64_tr_b16 v[60:61], v22 offset:8192
  ds_read_b64_tr_b16 v[62:63], v22 offset:8704
  ds_read_b64_tr_b16 v[64:65], v21 offset:16384
  ds_read_b64_tr_b16 v[66:67], v21 offset:16896
  ds_read_b64_tr_b16 v[68:69], v22 offset:16384
  ds_read_b64_tr_b16 v[70:71], v22 offset:16896
  ds_read_b64_tr_b16 v[72:73], v23 offset:0
  ds_read_b64_tr_b16 v[74:75], v23 offset:256
  s_waitcnt lgkmcnt(0)
.p2align 3
L_w1_loop:
  v_mfma_f32_16x16x32_bf16 v[128:131], v[48:51], v[32:35], v[128:131]
  ds_read_b128 v[80:83], v20 offset:1024
  v_mfma_f32_16x16x32_bf16 v[132:135], v[48:51], v[36:39], v[132:135]
  ds_read_b128 v[84:87], v20 offset:3072
  v_mfma_f32_16x16x32_bf16 v[136:139], v[48:51], v[40:43], v[136:139]
  ds_read_b128 v[88:91], v20 offset:5120
  v_mfma_f32_16x16x32_bf16 v[140:143], v[48:51], v[44:47], v[140:143]
  ds_read_b128 v[92:95], v20 offset:7168
  v_mfma_f32_16x16x32_bf16 v[156:159], v[52:55], v[44:47], v[156:159]
  ds_read_b64_tr_b16 v[96:97], v21 offset:4096
  v_mfma_f32_16x16x32_bf16 v[152:155], v[52:55], v[40:43], v[152:155]
  ds_read_b64_tr_b16 v[98:99], v21 offset:4608
  v_mfma_f32_16x16x32_bf16 v[148:151], v[52:55], v[36:39], v[148:151]
  ds_read_b64_tr_b16 v[100:101], v22 offset:4096
  v_mfma_f32_16x16x32_bf16 v[144:147], v[52:55], v[32:35], v[144:147]
  ds_read_b64_tr_b16 v[102:103], v22 offset:4608
  v_mfma_f32_16x16x32_bf16 v[160:163], v[56:59], v[32:35], v[160:163]
  ds_read_b64_tr_b16 v[104:105], v21 offset:12288
  v_mfma_f32_16x16x32_bf16 v[164:167], v[56:59], v[36:39], v[164:167]
  ds_read_b64_tr_b16 v[106:107], v21 offset:12800
  v_mfma_f32_16x16x32_bf16 v[168:171], v[56:59], v[40:43], v[168:171]
  ds_read_b64_tr_b16 v[108:109], v22 offset:12288
  v_mfma_f32_16x16x32_bf16 v[172:175], v[56:59], v[44:47], v[172:175]
  ds_read_b64_tr_b16 v[110:111], v22 offset:12800
  v_mfma_f32_16x16x32_bf16 v[188:191], v[60:63], v[44:47], v[188:191]
  ds_read_b64_tr_b16 v[112:113], v21 offset:20480
  v_mfma_f32_16x16x32_bf16 v[184:187], v[60:63], v[40:43], v[184:187]
  ds_read_b64_tr_b16 v[114:115], v21 offset:20992
  v_mfma_f32_16x16x32_bf16 v[180:183], v[60:63], v[36:39], v[180:183]
  ds_read_b64_tr_b16 v[116:117], v22 offset:20480
  v_mfma_f32_16x16x32_bf16 v[176:179], v[60:63], v[32:35], v[176:179]
  ds_read_b64_tr_b16 v[118:119], v22 offset:20992
  v_mfma_f32_16x16x32_bf16 v[192:195], v[64:67], v[32:35], v[192:195]
  ds_read_b64_tr_b16 v[120:121], v23 offset:4096
  v_mfma_f32_16x16x32_bf16 v[196:199], v[64:67], v[36:39], v[196:199]
  ds_read_b64_tr_b16 v[122:123], v23 offset:4352
  v_mfma_f32_16x16x32_bf16 v[200:203], v[64:67], v[40:43], v[200:203]
  v_add_u32_e64 v20, s75, v4
  v_mfma_f32_16x16x32_bf16 v[204:207], v[64:67], v[44:47], v[204:207]
  v_add_u32_e64 v21, s75, v5
  v_mfma_f32_16x16x32_bf16 v[220:223], v[68:71], v[44:47], v[220:223]
  v_add_u32_e64 v22, s75, v6
  v_mfma_f32_16x16x32_bf16 v[216:219], v[68:71], v[40:43], v[216:219]
  v_add_u32_e64 v23, s75, v7
  v_mfma_f32_16x16x32_bf16 v[212:215], v[68:71], v[36:39], v[212:215]
  s_add_u32 s75, s75, 49152
  v_mfma_f32_16x16x32_bf16 v[208:211], v[68:71], v[32:35], v[208:211]
  s_cmp_eq_u32 s75, 147456
  v_mfma_f32_16x16x32_bf16 v[224:227], v[72:75], v[32:35], v[224:227]
  s_cselect_b32 s75, 0, s75
  s_sub_u32 s79, s79, 1
  v_mfma_f32_16x16x32_bf16 v[228:231], v[72:75], v[36:39], v[228:231]
  v_mfma_f32_16x16x32_bf16 v[232:235], v[72:75], v[40:43], v[232:235]
  v_mfma_f32_16x16x32_bf16 v[236:239], v[72:75], v[44:47], v[236:239]
  s_waitcnt lgkmcnt(0)
  s_barrier
  v_mfma_f32_16x16x32_bf16 v[128:131], v[96:99], v[80:83], v[128:131]
  ds_read_b128 v[32:35], v20 offset:0
  v_mfma_f32_16x16x32_bf16 v[132:135], v[96:99], v[84:87], v[132:135]
  ds_read_b128 v[36:39], v20 offset:2048
  v_mfma_f32_16x16x32_bf16 v[136:139], v[96:99], v[88:91], v[136:139]
  ds_read_b128 v[40:43], v20 offset:4096
  v_mfma_f32_16x16x32_bf16 v[140:143], v[96:99], v[92:95], v[140:143]
  ds_read_b128 v[44:47], v20 offset:6144
  v_mfma_f32_16x16x32_bf16 v[156:159], v[100:103], v[92:95], v[156:159]
  ds_read_b64_tr_b16 v[48:49], v21 offset:0
  v_mfma_f32_16x16x32_bf16 v[152:155], v[100:103], v[88:91], v[152:155]
  ds_read_b64_tr_b16 v[50:51], v21 offset:512
  v_mfma_f32_16x16x32_bf16 v[148:151], v[100:103], v[84:87], v[148:151]
  ds_read_b64_tr_b16 v[52:53], v22 offset:0
  v_mfma_f32_16x16x32_bf16 v[144:147], v[100:103], v[80:83], v[144:147]
  ds_read_b64_tr_b16 v[54:55], v22 offset:512
  v_mfma_f32_16x16x32_bf16 v[160:163], v[104:107], v[80:83], v[160:163]
  ds_read_b64_tr_b16 v[56:57], v21 offset:8192
  v_mfma_f32_16x16x32_bf16 v[164:167], v[104:107], v[84:87], v[164:167]
  ds_read_b64_tr_b16 v[58:59], v21 offset:8704
  v_mfma_f32_16x16x32_bf16 v[168:171], v[104:107], v[88:91], v[168:171]
  ds_read_b64_tr_b16 v[60:61], v22 offset:8192
  v_mfma_f32_16x16x32_bf16 v[172:175], v[104:107], v[92:95], v[172:175]
  ds_read_b64_tr_b16 v[62:63], v22 offset:8704
  v_mfma_f32_16x16x32_bf16 v[188:191], v[108:111], v[92:95], v[188:191]
  ds_read_b64_tr_b16 v[64:65], v21 offset:16384
  v_mfma_f32_16x16x32_bf16 v[184:187], v[108:111], v[88:91], v[184:187]
  ds_read_b64_tr_b16 v[66:67], v21 offset:16896
  v_mfma_f32_16x16x32_bf16 v[180:183], v[108:111], v[84:87], v[180:183]
  ds_read_b64_tr_b16 v[68:69], v22 offset:16384
  v_mfma_f32_16x16x32_bf16 v[176:179], v[108:111], v[80:83], v[176:179]
  ds_read_b64_tr_b16 v[70:71], v22 offset:16896
  v_mfma_f32_16x16x32_bf16 v[192:195], v[112:115], v[80:83], v[192:195]
  ds_read_b64_tr_b16 v[72:73], v23 offset:0
  v_mfma_f32_16x16x32_bf16 v[196:199], v[112:115], v[84:87], v[196:199]
  ds_read_b64_tr_b16 v[74:75], v23 offset:256
  v_mfma_f32_16x16x32_bf16 v[200:203], v[112:115], v[88:91], v[200:203]
  s_cmp_lg_u32 s79, 0
  s_nop 0
  v_mfma_f32_16x16x32_bf16 v[204:207], v[112:115], v[92:95], v[204:207]
  v_mfma_f32_16x16x32_bf16 v[220:223], v[116:119], v[92:95], v[220:223]
  v_mfma_f32_16x16x32_bf16 v[216:219], v[116:119], v[88:91], v[216:219]
  v_mfma_f32_16x16x32_bf16 v[212:215], v[116:119], v[84:87], v[212:215]
  v_mfma_f32_16x16x32_bf16 v[208:211], v[116:119], v[80:83], v[208:211]
  v_mfma_f32_16x16x32_bf16 v[224:227], v[120:123], v[80:83], v[224:227]
  v_mfma_f32_16x16x32_bf16 v[228:231], v[120:123], v[84:87], v[228:231]
  v_mfma_f32_16x16x32_bf16 v[232:235], v[120:123], v[88:91], v[232:235]
  v_mfma_f32_16x16x32_bf16 v[236:239], v[120:123], v[92:95], v[236:239]
  s_waitcnt lgkmcnt(0)
  s_cbranch_scc1 L_w1_loop
L_w1_exit:
  ds_read2_b32 v[88:89], v14 offset0:0 offset1:160
  ds_read2_b32 v[90:91], v14 offset0:16 offset1:176
  ds_read2_b32 v[92:93], v14 offset0:32 offset1:192
  ds_read2_b32 v[94:95], v14 offset0:48 offset1:208
  ds_read_b128 v[32:35], v15 offset:0
  ds_read_b128 v[60:63], v15 offset:1024
  ds_read_b128 v[36:39], v15 offset:64
  ds_read_b128 v[64:67], v15 offset:1088
  ds_read_b128 v[40:43], v15 offset:256
  ds_read_b128 v[68:71], v15 offset:1280
  ds_read_b128 v[44:47], v15 offset:320
  ds_read_b128 v[72:75], v15 offset:1344
  ds_read_b128 v[48:51], v15 offset:512
  ds_read_b128 v[76:79], v15 offset:1536
  ds_read_b128 v[52:55], v15 offset:576
  ds_read_b128 v[80:83], v15 offset:1600
  ds_read_b128 v[56:59], v16 offset:768
  ds_read_b128 v[84:87], v16 offset:1792
  buffer_load_dwordx2 v[10:11], v19, s[52:55], 0 offen offset:0
  buffer_load_dwordx2 v[24:25], v19, s[52:55], 0 offen offset:32
  buffer_load_dwordx2 v[124:125], v19, s[52:55], 0 offen offset:64
  buffer_load_dwordx2 v[126:127], v19, s[52:55], 0 offen offset:96
  v_mov_b32 v96, 0xc0135761
  v_mov_b32 v97, 0xbdd2d3e8
  v_mov_b32 v98, 1.0
  s_waitcnt lgkmcnt(0)
  v_mul_f32 v88, v88, v89
  v_mul_f32 v90, v90, v91
  v_mul_f32 v92, v92, v93
  v_mul_f32 v94, v94, v95
  v_pk_fma_f32 v[100:101], v[32:33], v[88:89], v[60:61] op_sel:[0,0,0] op_sel_hi:[1,0,1] neg_lo:[0,1,0] neg_hi:[0,1,0]
  v_pk_fma_f32 v[102:103], v[34:35], v[88:89], v[62:63] op_sel:[0,0,0] op_sel_hi:[1,0,1] neg_lo:[0,1,0] neg_hi:[0,1,0]
  v_pk_fma_f32 v[128:129], v[128:129], v[88:89], v[100:101] op_sel:[0,1,0] op_sel_hi:[1,1,1]
  v_pk_fma_f32 v[130:131], v[130:131], v[88:89], v[102:103] op_sel:[0,1,0] op_sel_hi:[1,1,1]
  v_pk_mul_f32 v[100:101], v[128:129], v[128:129]
  v_pk_mul_f32 v[102:103], v[130:131], v[130:131]
  v_pk_fma_f32 v[100:101], v[100:101], v[96:97], v[96:97] op_sel:[0,1,0] op_sel_hi:[1,1,0]
  v_pk_fma_f32 v[102:103], v[102:103], v[96:97], v[96:97] op_sel:[0,1,0] op_sel_hi:[1,1,0]
  v_pk_mul_f32 v[100:101], v[100:101], v[128:129]
  v_pk_mul_f32 v[102:103], v[102:103], v[130:131]
  v_exp_f32 v100, v100
  v_exp_f32 v101, v101
  v_exp_f32 v102, v102
  v_exp_f32 v103, v103
  v_pk_add_f32 v[100:101], v[100:101], v[98:99] op_sel_hi:[1,0]
  v_pk_add_f32 v[102:103], v[102:103], v[98:99] op_sel_hi:[1,0]
  v_rcp_f32 v100, v100
  v_rcp_f32 v101, v101
  v_rcp_f32 v102, v102
  v_rcp_f32 v103, v103
  v_pk_mul_f32 v[128:129], v[128:129], v[100:101]
  v_pk_mul_f32 v[130:131], v[130:131], v[102:103]
  v_cvt_pk_bf16_f32 v108, v128, v129
  v_cvt_pk_bf16_f32 v109, v130, v131
  v_pk_fma_f32 v[104:105], v[36:37], v[88:89], v[64:65] op_sel:[0,0,0] op_sel_hi:[1,0,1] neg_lo:[0,1,0] neg_hi:[0,1,0]
  v_pk_fma_f32 v[106:107], v[38:39], v[88:89], v[66:67] op_sel:[0,0,0] op_sel_hi:[1,0,1] neg_lo:[0,1,0] neg_hi:[0,1,0]
  v_pk_fma_f32 v[144:145], v[144:145], v[88:89], v[104:105] op_sel:[0,1,0] op_sel_hi:[1,1,1]
  v_pk_fma_f32 v[146:147], v[146:147], v[88:89], v[106:107] op_sel:[0,1,0] op_sel_hi:[1,1,1]
  v_pk_mul_f32 v[104:105], v[144:145], v[144:145]
  v_pk_mul_f32 v[106:107], v[146:147], v[146:147]
  v_pk_fma_f32 v[104:105], v[104:105], v[96:97], v[96:97] op_sel:[0,1,0] op_sel_hi:[1,1,0]
  v_pk_fma_f32 v[106:107], v[106:107], v[96:97], v[96:97] op_sel:[0,1,0] op_sel_hi:[1,1,0]
  v_pk_mul_f32 v[104:105], v[104:105], v[144:145]
  v_pk_mul_f32 v[106:107], v[106:107], v[146:147]
  v_exp_f32 v104, v104
  v_exp_f32 v105, v105
  v_exp_f32 v106, v106
  v_exp_f32 v107, v107
  v_pk_add_f32 v[104:105], v[104:105], v[98:99] op_sel_hi:[1,0]
  v_pk_add_f32 v[106:107], v[106:107], v[98:99] op_sel_hi:[1,0]
  v_rcp_f32 v104, v104
  v_rcp_f32 v105, v105
  v_rcp_f32 v106, v106
  v_rcp_f32 v107, v107
  v_pk_mul_f32 v[144:145], v[144:145], v[104:105]
  v_pk_mul_f32 v[146:147], v[146:147], v[106:107]
  v_cvt_pk_bf16_f32 v110, v144, v145
  v_cvt_pk_bf16_f32 v111, v146, v147
  s_mov_b32 s3, 0
  s_nop 0
  v_permlane16_swap_b32 v108, v110
  v_permlane16_swap_b32 v109, v111
  buffer_store_dwordx4 v[108:111], v12, s[44:47], s3 offen sc1
  ds_write_b128 v18, v[108:111] offset:32768
  v_pk_fma_f32 v[100:101], v[32:33], v[90:91], v[60:61] op_sel:[0,0,0] op_sel_hi:[1,0,1] neg_lo:[0,1,0] neg_hi:[0,1,0]
  v_pk_fma_f32 v[102:103], v[34:35], v[90:91], v[62:63] op_sel:[0,0,0] op_sel_hi:[1,0,1] neg_lo:[0,1,0] neg_hi:[0,1,0]
  v_pk_fma_f32 v[132:133], v[132:133], v[90:91], v[100:101] op_sel:[0,1,0] op_sel_hi:[1,1,1]
  v_pk_fma_f32 v[134:135], v[134:135], v[90:91], v[102:103] op_sel:[0,1,0] op_sel_hi:[1,1,1]
  v_pk_mul_f32 v[100:101], v[132:133], v[132:133]
  v_pk_mul_f32 v[102:103], v[134:135], v[134:135]
  v_pk_fma_f32 v[100:101], v[100:101], v[96:97], v[96:97] op_sel:[0,1,0] op_sel_hi:[1,1,0]
  v_pk_fma_f32 v[102:103], v[102:103], v[96:97], v[96:97] op_sel:[0,1,0] op_sel_hi:[1,1,0]
  v_pk_mul_f32 v[100:101], v[100:101], v[132:133]
  v_pk_mul_f32 v[102:103], v[102:103], v[134:135]
  v_exp_f32 v100, v100
  v_exp_f32 v101, v101
  v_exp_f32 v102, v102
  v_exp_f32 v103, v103
  v_pk_add_f32 v[100:101], v[100:101], v[98:99] op_sel_hi:[1,0]
  v_pk_add_f32 v[102:103], v[102:103], v[98:99] op_sel_hi:[1,0]
  v_rcp_f32 v100, v100
  v_rcp_f32 v101, v101
  v_rcp_f32 v102, v102
  v_rcp_f32 v103, v103
  v_pk_mul_f32 v[132:133], v[132:133], v[100:101]
  v_pk_mul_f32 v[134:135], v[134:135], v[102:103]
  v_cvt_pk_bf16_f32 v112, v132, v133
  v_cvt_pk_bf16_f32 v113, v134, v135
  v_pk_fma_f32 v[104:105], v[36:37], v[90:91], v[64:65] op_sel:[0,0,0] op_sel_hi:[1,0,1] neg_lo:[0,1,0] neg_hi:[0,1,0]
  v_pk_fma_f32 v[106:107], v[38:39], v[90:91], v[66:67] op_sel:[0,0,0] op_sel_hi:[1,0,1] neg_lo:[0,1,0] neg_hi:[0,1,0]
  v_pk_fma_f32 v[148:149], v[148:149], v[90:91], v[104:105] op_sel:[0,1,0] op_sel_hi:[1,1,1]
  v_pk_fma_f32 v[150:151], v[150:151], v[90:91], v[106:107] op_sel:[0,1,0] op_sel_hi:[1,1,1]
  v_pk_mul_f32 v[104:105], v[148:149], v[148:149]
  v_pk_mul_f32 v[106:107], v[150:151], v[150:151]
  v_pk_fma_f32 v[104:105], v[104:105], v[96:97], v[96:97] op_sel:[0,1,0] op_sel_hi:[1,1,0]
  v_pk_fma_f32 v[106:107], v[106:107], v[96:97], v[96:97] op_sel:[0,1,0] op_sel_hi:[1,1,0]
  v_pk_mul_f32 v[104:105], v[104:105], v[148:149]
  v_pk_mul_f32 v[106:107], v[106:107], v[150:151]
  v_exp_f32 v104, v104
  v_exp_f32 v105, v105
  v_exp_f32 v106, v106
  v_exp_f32 v107, v107
  v_pk_add_f32 v[104:105], v[104:105], v[98:99] op_sel_hi:[1,0]
  v_pk_add_f32 v[106:107], v[106:107], v[98:99] op_sel_hi:[1,0]
  v_rcp_f32 v104, v104
  v_rcp_f32 v105, v105
  v_rcp_f32 v106, v106
  v_rcp_f32 v107, v107
  v_pk_mul_f32 v[148:149], v[148:149], v[104:105]
  v_pk_mul_f32 v[150:151], v[150:151], v[106:107]
  v_cvt_pk_bf16_f32 v114, v148, v149
  v_cvt_pk_bf16_f32 v115, v150, v151
  s_mov_b32 s3, 114688
  s_nop 0
  v_permlane16_swap_b32 v112, v114
  v_permlane16_swap_b32 v113, v115
  buffer_store_dwordx4 v[112:115], v12, s[44:47], s3 offen sc1
  ds_write_b128 v18, v[112:115] offset:34816
  v_pk_fma_f32 v[100:101], v[32:33], v[92:93], v[60:61] op_sel:[0,0,0] op_sel_hi:[1,0,1] neg_lo:[0,1,0] neg_hi:[0,1,0]
  v_pk_fma_f32 v[102:103], v[34:35], v[92:93], v[62:63] op_sel:[0,0,0] op_sel_hi:[1,0,1] neg_lo:[0,1,0] neg_hi:[0,1,0]
  v_pk_fma_f32 v[136:137], v[136:137], v[92:93], v[100:101] op_sel:[0,1,0] op_sel_hi:[1,1,1]
  v_pk_fma_f32 v[138:139], v[138:139], v[92:93], v[102:103] op_sel:[0,1,0] op_sel_hi:[1,1,1]
  v_pk_mul_f32 v[100:101], v[136:137], v[136:137]
  v_pk_mul_f32 v[102:103], v[138:139], v[138:139]
  v_pk_fma_f32 v[100:101], v[100:101], v[96:97], v[96:97] op_sel:[0,1,0] op_sel_hi:[1,1,0]
  v_pk_fma_f32 v[102:103], v[102:103], v[96:97], v[96:97] op_sel:[0,1,0] op_sel_hi:[1,1,0]
  v_pk_mul_f32 v[100:101], v[100:101], v[136:137]
  v_pk_mul_f32 v[102:103], v[102:103], v[138:139]
  v_exp_f32 v100, v100
  v_exp_f32 v101, v101
  v_exp_f32 v102, v102
  v_exp_f32 v103, v103
  v_pk_add_f32 v[100:101], v[100:101], v[98:99] op_sel_hi:[1,0]
  v_pk_add_f32 v[102:103], v[102:103], v[98:99] op_sel_hi:[1,0]
  v_rcp_f32 v100, v100
  v_rcp_f32 v101, v101
  v_rcp_f32 v102, v102
  v_rcp_f32 v103, v103
  v_pk_mul_f32 v[136:137], v[136:137], v[100:101]
  v_pk_mul_f32 v[138:139], v[138:139], v[102:103]
  v_cvt_pk_bf16_f32 v116, v136, v137
  v_cvt_pk_bf16_f32 v117, v138, v139
  v_pk_fma_f32 v[104:105], v[36:37], v[92:93], v[64:65] op_sel:[0,0,0] op_sel_hi:[1,0,1] neg_lo:[0,1,0] neg_hi:[0,1,0]
  v_pk_fma_f32 v[106:107], v[38:39], v[92:93], v[66:67] op_sel:[0,0,0] op_sel_hi:[1,0,1] neg_lo:[0,1,0] neg_hi:[0,1,0]
  v_pk_fma_f32 v[152:153], v[152:153], v[92:93], v[104:105] op_sel:[0,1,0] op_sel_hi:[1,1,1]
  v_pk_fma_f32 v[154:155], v[154:155], v[92:93], v[106:107] op_sel:[0,1,0] op_sel_hi:[1,1,1]
  v_pk_mul_f32 v[104:105], v[152:153], v[152:153]
  v_pk_mul_f32 v[106:107], v[154:155], v[154:155]
  v_pk_fma_f32 v[104:105], v[104:105], v[96:97], v[96:97] op_sel:[0,1,0] op_sel_hi:[1,1,0]
  v_pk_fma_f32 v[106:107], v[106:107], v[96:97], v[96:97] op_sel:[0,1,0] op_sel_hi:[1,1,0]
  v_pk_mul_f32 v[104:105], v[104:105], v[152:153]
  v_pk_mul_f32 v[106:107], v[106:107], v[154:155]
  v_exp_f32 v104, v104
  v_exp_f32 v105, v105
  v_exp_f32 v106, v106
  v_exp_f32 v107, v107
  v_pk_add_f32 v[104:105], v[104:105], v[98:99] op_sel_hi:[1,0]
  v_pk_add_f32 v[106:107], v[106:107], v[98:99] op_sel_hi:[1,0]
  v_rcp_f32 v104, v104
  v_rcp_f32 v105, v105
  v_rcp_f32 v106, v106
  v_rcp_f32 v107, v107
  v_pk_mul_f32 v[152:153], v[152:153], v[104:105]
  v_pk_mul_f32 v[154:155], v[154:155], v[106:107]
  v_cvt_pk_bf16_f32 v118, v152, v153
  v_cvt_pk_bf16_f32 v119, v154, v155
  s_mov_b32 s3, 229376
  s_nop 0
  v_permlane16_swap_b32 v116, v118
  v_permlane16_swap_b32 v117, v119
  buffer_store_dwordx4 v[116:119], v12, s[44:47], s3 offen sc1
  ds_write_b128 v18, v[116:119] offset:36864
  v_pk_fma_f32 v[100:101], v[32:33], v[94:95], v[60:61] op_sel:[0,0,0] op_sel_hi:[1,0,1] neg_lo:[0,1,0] neg_hi:[0,1,0]
  v_pk_fma_f32 v[102:103], v[34:35], v[94:95], v[62:63] op_sel:[0,0,0] op_sel_hi:[1,0,1] neg_lo:[0,1,0] neg_hi:[0,1,0]
  v_pk_fma_f32 v[140:141], v[140:141], v[94:95], v[100:101] op_sel:[0,1,0] op_sel_hi:[1,1,1]
  v_pk_fma_f32 v[142:143], v[142:143], v[94:95], v[102:103] op_sel:[0,1,0] op_sel_hi:[1,1,1]
  v_pk_mul_f32 v[100:101], v[140:141], v[140:141]
  v_pk_mul_f32 v[102:103], v[142:143], v[142:143]
  v_pk_fma_f32 v[100:101], v[100:101], v[96:97], v[96:97] op_sel:[0,1,0] op_sel_hi:[1,1,0]
  v_pk_fma_f32 v[102:103], v[102:103], v[96:97], v[96:97] op_sel:[0,1,0] op_sel_hi:[1,1,0]
  v_pk_mul_f32 v[100:101], v[100:101], v[140:141]
  v_pk_mul_f32 v[102:103], v[102:103], v[142:143]
  v_exp_f32 v100, v100
  v_exp_f32 v101, v101
  v_exp_f32 v102, v102
  v_exp_f32 v103, v103
  v_pk_add_f32 v[100:101], v[100:101], v[98:99] op_sel_hi:[1,0]
  v_pk_add_f32 v[102:103], v[102:103], v[98:99] op_sel_hi:[1,0]
  v_rcp_f32 v100, v100
  v_rcp_f32 v101, v101
  v_rcp_f32 v102, v102
  v_rcp_f32 v103, v103
  v_pk_mul_f32 v[140:141], v[140:141], v[100:101]
  v_pk_mul_f32 v[142:143], v[142:143], v[102:103]
  v_cvt_pk_bf16_f32 v120, v140, v141
  v_cvt_pk_bf16_f32 v121, v142, v143
  v_pk_fma_f32 v[104:105], v[36:37], v[94:95], v[64:65] op_sel:[0,0,0] op_sel_hi:[1,0,1] neg_lo:[0,1,0] neg_hi:[0,1,0]
  v_pk_fma_f32 v[106:107], v[38:39], v[94:95], v[66:67] op_sel:[0,0,0] op_sel_hi:[1,0,1] neg_lo:[0,1,0] neg_hi:[0,1,0]
  v_pk_fma_f32 v[156:157], v[156:157], v[94:95], v[104:105] op_sel:[0,1,0] op_sel_hi:[1,1,1]
  v_pk_fma_f32 v[158:159], v[158:159], v[94:95], v[106:107] op_sel:[0,1,0] op_sel_hi:[1,1,1]
  v_pk_mul_f32 v[104:105], v[156:157], v[156:157]
  v_pk_mul_f32 v[106:107], v[158:159], v[158:159]
  v_pk_fma_f32 v[104:105], v[104:105], v[96:97], v[96:97] op_sel:[0,1,0] op_sel_hi:[1,1,0]
  v_pk_fma_f32 v[106:107], v[106:107], v[96:97], v[96:97] op_sel:[0,1,0] op_sel_hi:[1,1,0]
  v_pk_mul_f32 v[104:105], v[104:105], v[156:157]
  v_pk_mul_f32 v[106:107], v[106:107], v[158:159]
  v_exp_f32 v104, v104
  v_exp_f32 v105, v105
  v_exp_f32 v106, v106
  v_exp_f32 v107, v107
  v_pk_add_f32 v[104:105], v[104:105], v[98:99] op_sel_hi:[1,0]
  v_pk_add_f32 v[106:107], v[106:107], v[98:99] op_sel_hi:[1,0]
  v_rcp_f32 v104, v104
  v_rcp_f32 v105, v105
  v_rcp_f32 v106, v106
  v_rcp_f32 v107, v107
  v_pk_mul_f32 v[156:157], v[156:157], v[104:105]
  v_pk_mul_f32 v[158:159], v[158:159], v[106:107]
  v_cvt_pk_bf16_f32 v122, v156, v157
  v_cvt_pk_bf16_f32 v123, v158, v159
  s_mov_b32 s3, 344064
  s_nop 0
  v_permlane16_swap_b32 v120, v122
  v_permlane16_swap_b32 v121, v123
  buffer_store_dwordx4 v[120:123], v12, s[44:47], s3 offen sc1
  ds_write_b128 v18, v[120:123] offset:38912
  v_pk_fma_f32 v[100:101], v[56:57], v[88:89], v[84:85] op_sel:[0,0,0] op_sel_hi:[1,0,1] neg_lo:[0,1,0] neg_hi:[0,1,0]
  v_pk_fma_f32 v[102:103], v[58:59], v[88:89], v[86:87] op_sel:[0,0,0] op_sel_hi:[1,0,1] neg_lo:[0,1,0] neg_hi:[0,1,0]
  v_pk_fma_f32 v[224:225], v[224:225], v[88:89], v[100:101] op_sel:[0,1,0] op_sel_hi:[1,1,1]
  v_pk_fma_f32 v[226:227], v[226:227], v[88:89], v[102:103] op_sel:[0,1,0] op_sel_hi:[1,1,1]
  v_pk_mul_f32 v[100:101], v[224:225], v[224:225]
  v_pk_mul_f32 v[102:103], v[226:227], v[226:227]
  v_pk_fma_f32 v[100:101], v[100:101], v[96:97], v[96:97] op_sel:[0,1,0] op_sel_hi:[1,1,0]
  v_pk_fma_f32 v[102:103], v[102:103], v[96:97], v[96:97] op_sel:[0,1,0] op_sel_hi:[1,1,0]
  v_pk_mul_f32 v[100:101], v[100:101], v[224:225]
  v_pk_mul_f32 v[102:103], v[102:103], v[226:227]
  v_exp_f32 v100, v100
  v_exp_f32 v101, v101
  v_exp_f32 v102, v102
  v_exp_f32 v103, v103
  v_pk_add_f32 v[100:101], v[100:101], v[98:99] op_sel_hi:[1,0]
  v_pk_add_f32 v[102:103], v[102:103], v[98:99] op_sel_hi:[1,0]
  v_rcp_f32 v100, v100
  v_rcp_f32 v101, v101
  v_rcp_f32 v102, v102
  v_rcp_f32 v103, v103
  v_pk_mul_f32 v[224:225], v[224:225], v[100:101]
  v_pk_mul_f32 v[226:227], v[226:227], v[102:103]
  v_cvt_pk_bf16_f32 v108, v224, v225
  v_cvt_pk_bf16_f32 v109, v226, v227
  v_pk_fma_f32 v[100:101], v[56:57], v[90:91], v[84:85] op_sel:[0,0,0] op_sel_hi:[1,0,1] neg_lo:[0,1,0] neg_hi:[0,1,0]
  v_pk_fma_f32 v[102:103], v[58:59], v[90:91], v[86:87] op_sel:[0,0,0] op_sel_hi:[1,0,1] neg_lo:[0,1,0] neg_hi:[0,1,0]
  v_pk_fma_f32 v[228:229], v[228:229], v[90:91], v[100:101] op_sel:[0,1,0] op_sel_hi:[1,1,1]
  v_pk_fma_f32 v[230:231], v[230:231], v[90:91], v[102:103] op_sel:[0,1,0] op_sel_hi:[1,1,1]
  v_pk_mul_f32 v[100:101], v[228:229], v[228:229]
  v_pk_mul_f32 v[102:103], v[230:231], v[230:231]
  v_pk_fma_f32 v[100:101], v[100:101], v[96:97], v[96:97] op_sel:[0,1,0] op_sel_hi:[1,1,0]
  v_pk_fma_f32 v[102:103], v[102:103], v[96:97], v[96:97] op_sel:[0,1,0] op_sel_hi:[1,1,0]
  v_pk_mul_f32 v[100:101], v[100:101], v[228:229]
  v_pk_mul_f32 v[102:103], v[102:103], v[230:231]
  v_exp_f32 v100, v100
  v_exp_f32 v101, v101
  v_exp_f32 v102, v102
  v_exp_f32 v103, v103
  v_pk_add_f32 v[100:101], v[100:101], v[98:99] op_sel_hi:[1,0]
  v_pk_add_f32 v[102:103], v[102:103], v[98:99] op_sel_hi:[1,0]
  v_rcp_f32 v100, v100
  v_rcp_f32 v101, v101
  v_rcp_f32 v102, v102
  v_rcp_f32 v103, v103
  v_pk_mul_f32 v[228:229], v[228:229], v[100:101]
  v_pk_mul_f32 v[230:231], v[230:231], v[102:103]
  v_cvt_pk_bf16_f32 v110, v228, v229
  v_cvt_pk_bf16_f32 v111, v230, v231
  s_mov_b32 s3, 32768
  s_nop 0
  v_permlane16_swap_b32 v108, v110
  v_permlane16_swap_b32 v109, v111
  buffer_store_dwordx4 v[108:111], v13, s[44:47], s3 offen sc1
  v_pk_fma_f32 v[100:101], v[56:57], v[92:93], v[84:85] op_sel:[0,0,0] op_sel_hi:[1,0,1] neg_lo:[0,1,0] neg_hi:[0,1,0]
  v_pk_fma_f32 v[102:103], v[58:59], v[92:93], v[86:87] op_sel:[0,0,0] op_sel_hi:[1,0,1] neg_lo:[0,1,0] neg_hi:[0,1,0]
  v_pk_fma_f32 v[232:233], v[232:233], v[92:93], v[100:101] op_sel:[0,1,0] op_sel_hi:[1,1,1]
  v_pk_fma_f32 v[234:235], v[234:235], v[92:93], v[102:103] op_sel:[0,1,0] op_sel_hi:[1,1,1]
  v_pk_mul_f32 v[100:101], v[232:233], v[232:233]
  v_pk_mul_f32 v[102:103], v[234:235], v[234:235]
  v_pk_fma_f32 v[100:101], v[100:101], v[96:97], v[96:97] op_sel:[0,1,0] op_sel_hi:[1,1,0]
  v_pk_fma_f32 v[102:103], v[102:103], v[96:97], v[96:97] op_sel:[0,1,0] op_sel_hi:[1,1,0]
  v_pk_mul_f32 v[100:101], v[100:101], v[232:233]
  v_pk_mul_f32 v[102:103], v[102:103], v[234:235]
  v_exp_f32 v100, v100
  v_exp_f32 v101, v101
  v_exp_f32 v102, v102
  v_exp_f32 v103, v103
  v_pk_add_f32 v[100:101], v[100:101], v[98:99] op_sel_hi:[1,0]
  v_pk_add_f32 v[102:103], v[102:103], v[98:99] op_sel_hi:[1,0]
  v_rcp_f32 v100, v100
  v_rcp_f32 v101, v101
  v_rcp_f32 v102, v102
  v_rcp_f32 v103, v103
  v_pk_mul_f32 v[232:233], v[232:233], v[100:101]
  v_pk_mul_f32 v[234:235], v[234:235], v[102:103]
  v_cvt_pk_bf16_f32 v112, v232, v233
  v_cvt_pk_bf16_f32 v113, v234, v235
  v_pk_fma_f32 v[100:101], v[56:57], v[94:95], v[84:85] op_sel:[0,0,0] op_sel_hi:[1,0,1] neg_lo:[0,1,0] neg_hi:[0,1,0]
  v_pk_fma_f32 v[102:103], v[58:59], v[94:95], v[86:87] op_sel:[0,0,0] op_sel_hi:[1,0,1] neg_lo:[0,1,0] neg_hi:[0,1,0]
  v_pk_fma_f32 v[236:237], v[236:237], v[94:95], v[100:101] op_sel:[0,1,0] op_sel_hi:[1,1,1]
  v_pk_fma_f32 v[238:239], v[238:239], v[94:95], v[102:103] op_sel:[0,1,0] op_sel_hi:[1,1,1]
  v_pk_mul_f32 v[100:101], v[236:237], v[236:237]
  v_pk_mul_f32 v[102:103], v[238:239], v[238:239]
  v_pk_fma_f32 v[100:101], v[100:101], v[96:97], v[96:97] op_sel:[0,1,0] op_sel_hi:[1,1,0]
  v_pk_fma_f32 v[102:103], v[102:103], v[96:97], v[96:97] op_sel:[0,1,0] op_sel_hi:[1,1,0]
  v_pk_mul_f32 v[100:101], v[100:101], v[236:237]
  v_pk_mul_f32 v[102:103], v[102:103], v[238:239]
  v_exp_f32 v100, v100
  v_exp_f32 v101, v101
  v_exp_f32 v102, v102
  v_exp_f32 v103, v103
  v_pk_add_f32 v[100:101], v[100:101], v[98:99] op_sel_hi:[1,0]
  v_pk_add_f32 v[102:103], v[102:103], v[98:99] op_sel_hi:[1,0]
  v_rcp_f32 v100, v100
  v_rcp_f32 v101, v101
  v_rcp_f32 v102, v102
  v_rcp_f32 v103, v103
  v_pk_mul_f32 v[236:237], v[236:237], v[100:101]
  v_pk_mul_f32 v[238:239], v[238:239], v[102:103]
  v_cvt_pk_bf16_f32 v114, v236, v237
  v_cvt_pk_bf16_f32 v115, v238, v239
  s_mov_b32 s3, 262144
  s_nop 0
  v_permlane16_swap_b32 v112, v114
  v_permlane16_swap_b32 v113, v115
  buffer_store_dwordx4 v[112:115], v13, s[44:47], s3 offen sc1
  v_pk_fma_f32 v[100:101], v[40:41], v[88:89], v[68:69] op_sel:[0,0,0] op_sel_hi:[1,0,1] neg_lo:[0,1,0] neg_hi:[0,1,0]
  v_pk_fma_f32 v[102:103], v[42:43], v[88:89], v[70:71] op_sel:[0,0,0] op_sel_hi:[1,0,1] neg_lo:[0,1,0] neg_hi:[0,1,0]
  v_pk_fma_f32 v[160:161], v[160:161], v[88:89], v[100:101] op_sel:[0,1,0] op_sel_hi:[1,1,1]
  v_pk_fma_f32 v[162:163], v[162:163], v[88:89], v[102:103] op_sel:[0,1,0] op_sel_hi:[1,1,1]
  v_pk_mul_f32 v[100:101], v[160:161], v[160:161]
  v_pk_mul_f32 v[102:103], v[162:163], v[162:163]
  v_pk_fma_f32 v[100:101], v[100:101], v[96:97], v[96:97] op_sel:[0,1,0] op_sel_hi:[1,1,0]
  v_pk_fma_f32 v[102:103], v[102:103], v[96:97], v[96:97] op_sel:[0,1,0] op_sel_hi:[1,1,0]
  v_pk_mul_f32 v[100:101], v[100:101], v[160:161]
  v_pk_mul_f32 v[102:103], v[102:103], v[162:163]
  v_exp_f32 v100, v100
  v_exp_f32 v101, v101
  v_exp_f32 v102, v102
  v_exp_f32 v103, v103
  v_pk_add_f32 v[100:101], v[100:101], v[98:99] op_sel_hi:[1,0]
  v_pk_add_f32 v[102:103], v[102:103], v[98:99] op_sel_hi:[1,0]
  v_rcp_f32 v100, v100
  v_rcp_f32 v101, v101
  v_rcp_f32 v102, v102
  v_rcp_f32 v103, v103
  v_pk_mul_f32 v[160:161], v[160:161], v[100:101]
  v_pk_mul_f32 v[162:163], v[162:163], v[102:103]
  v_cvt_pk_bf16_f32 v116, v160, v161
  v_cvt_pk_bf16_f32 v117, v162, v163
  v_pk_fma_f32 v[104:105], v[44:45], v[88:89], v[72:73] op_sel:[0,0,0] op_sel_hi:[1,0,1] neg_lo:[0,1,0] neg_hi:[0,1,0]
  v_pk_fma_f32 v[106:107], v[46:47], v[88:89], v[74:75] op_sel:[0,0,0] op_sel_hi:[1,0,1] neg_lo:[0,1,0] neg_hi:[0,1,0]
  v_pk_fma_f32 v[176:177], v[176:177], v[88:89], v[104:105] op_sel:[0,1,0] op_sel_hi:[1,1,1]
  v_pk_fma_f32 v[178:179], v[178:179], v[88:89], v[106:107] op_sel:[0,1,0] op_sel_hi:[1,1,1]
  v_pk_mul_f32 v[104:105], v[176:177], v[176:177]
  v_pk_mul_f32 v[106:107], v[178:179], v[178:179]
  v_pk_fma_f32 v[104:105], v[104:105], v[96:97], v[96:97] op_sel:[0,1,0] op_sel_hi:[1,1,0]
  v_pk_fma_f32 v[106:107], v[106:107], v[96:97], v[96:97] op_sel:[0,1,0] op_sel_hi:[1,1,0]
  v_pk_mul_f32 v[104:105], v[104:105], v[176:177]
  v_pk_mul_f32 v[106:107], v[106:107], v[178:179]
  v_exp_f32 v104, v104
  v_exp_f32 v105, v105
  v_exp_f32 v106, v106
  v_exp_f32 v107, v107
  v_pk_add_f32 v[104:105], v[104:105], v[98:99] op_sel_hi:[1,0]
  v_pk_add_f32 v[106:107], v[106:107], v[98:99] op_sel_hi:[1,0]
  v_rcp_f32 v104, v104
  v_rcp_f32 v105, v105
  v_rcp_f32 v106, v106
  v_rcp_f32 v107, v107
  v_pk_mul_f32 v[176:177], v[176:177], v[104:105]
  v_pk_mul_f32 v[178:179], v[178:179], v[106:107]
  v_cvt_pk_bf16_f32 v118, v176, v177
  v_cvt_pk_bf16_f32 v119, v178, v179
  s_add_u32 s3, s10, 49152
  s_nop 0
  v_permlane16_swap_b32 v116, v118
  v_permlane16_swap_b32 v117, v119
  buffer_store_dwordx4 v[116:119], v12, s[44:47], s3 offen sc1
  ds_write_b128 v18, v[116:119] offset:0
  v_pk_fma_f32 v[100:101], v[48:49], v[88:89], v[76:77] op_sel:[0,0,0] op_sel_hi:[1,0,1] neg_lo:[0,1,0] neg_hi:[0,1,0]
  v_pk_fma_f32 v[102:103], v[50:51], v[88:89], v[78:79] op_sel:[0,0,0] op_sel_hi:[1,0,1] neg_lo:[0,1,0] neg_hi:[0,1,0]
  v_pk_fma_f32 v[192:193], v[192:193], v[88:89], v[100:101] op_sel:[0,1,0] op_sel_hi:[1,1,1]
  v_pk_fma_f32 v[194:195], v[194:195], v[88:89], v[102:103] op_sel:[0,1,0] op_sel_hi:[1,1,1]
  v_pk_mul_f32 v[100:101], v[192:193], v[192:193]
  v_pk_mul_f32 v[102:103], v[194:195], v[194:195]
  v_pk_fma_f32 v[100:101], v[100:101], v[96:97], v[96:97] op_sel:[0,1,0] op_sel_hi:[1,1,0]
  v_pk_fma_f32 v[102:103], v[102:103], v[96:97], v[96:97] op_sel:[0,1,0] op_sel_hi:[1,1,0]
  v_pk_mul_f32 v[100:101], v[100:101], v[192:193]
  v_pk_mul_f32 v[102:103], v[102:103], v[194:195]
  v_exp_f32 v100, v100
  v_exp_f32 v101, v101
  v_exp_f32 v102, v102
  v_exp_f32 v103, v103
  v_pk_add_f32 v[100:101], v[100:101], v[98:99] op_sel_hi:[1,0]
  v_pk_add_f32 v[102:103], v[102:103], v[98:99] op_sel_hi:[1,0]
  v_rcp_f32 v100, v100
  v_rcp_f32 v101, v101
  v_rcp_f32 v102, v102
  v_rcp_f32 v103, v103
  v_pk_mul_f32 v[192:193], v[192:193], v[100:101]
  v_pk_mul_f32 v[194:195], v[194:195], v[102:103]
  v_cvt_pk_bf16_f32 v120, v192, v193
  v_cvt_pk_bf16_f32 v121, v194, v195
  v_pk_fma_f32 v[104:105], v[52:53], v[88:89], v[80:81] op_sel:[0,0,0] op_sel_hi:[1,0,1] neg_lo:[0,1,0] neg_hi:[0,1,0]
  v_pk_fma_f32 v[106:107], v[54:55], v[88:89], v[82:83] op_sel:[0,0,0] op_sel_hi:[1,0,1] neg_lo:[0,1,0] neg_hi:[0,1,0]
  v_pk_fma_f32 v[208:209], v[208:209], v[88:89], v[104:105] op_sel:[0,1,0] op_sel_hi:[1,1,1]
  v_pk_fma_f32 v[210:211], v[210:211], v[88:89], v[106:107] op_sel:[0,1,0] op_sel_hi:[1,1,1]
  v_pk_mul_f32 v[104:105], v[208:209], v[208:209]
  v_pk_mul_f32 v[106:107], v[210:211], v[210:211]
  v_pk_fma_f32 v[104:105], v[104:105], v[96:97], v[96:97] op_sel:[0,1,0] op_sel_hi:[1,1,0]
  v_pk_fma_f32 v[106:107], v[106:107], v[96:97], v[96:97] op_sel:[0,1,0] op_sel_hi:[1,1,0]
  v_pk_mul_f32 v[104:105], v[104:105], v[208:209]
  v_pk_mul_f32 v[106:107], v[106:107], v[210:211]
  v_exp_f32 v104, v104
  v_exp_f32 v105, v105
  v_exp_f32 v106, v106
  v_exp_f32 v107, v107
  v_pk_add_f32 v[104:105], v[104:105], v[98:99] op_sel_hi:[1,0]
  v_pk_add_f32 v[106:107], v[106:107], v[98:99] op_sel_hi:[1,0]
  v_rcp_f32 v104, v104
  v_rcp_f32 v105, v105
  v_rcp_f32 v106, v106
  v_rcp_f32 v107, v107
  v_pk_mul_f32 v[208:209], v[208:209], v[104:105]
  v_pk_mul_f32 v[210:211], v[210:211], v[106:107]
  v_cvt_pk_bf16_f32 v122, v208, v209
  v_cvt_pk_bf16_f32 v123, v210, v211
  s_add_u32 s3, s10, 51200
  s_nop 0
  v_permlane16_swap_b32 v120, v122
  v_permlane16_swap_b32 v121, v123
  buffer_store_dwordx4 v[120:123], v12, s[44:47], s3 offen sc1
  ds_write_b128 v18, v[120:123] offset:16384
  v_pk_fma_f32 v[100:101], v[40:41], v[90:91], v[68:69] op_sel:[0,0,0] op_sel_hi:[1,0,1] neg_lo:[0,1,0] neg_hi:[0,1,0]
  v_pk_fma_f32 v[102:103], v[42:43], v[90:91], v[70:71] op_sel:[0,0,0] op_sel_hi:[1,0,1] neg_lo:[0,1,0] neg_hi:[0,1,0]
  v_pk_fma_f32 v[164:165], v[164:165], v[90:91], v[100:101] op_sel:[0,1,0] op_sel_hi:[1,1,1]
  v_pk_fma_f32 v[166:167], v[166:167], v[90:91], v[102:103] op_sel:[0,1,0] op_sel_hi:[1,1,1]
  v_pk_mul_f32 v[100:101], v[164:165], v[164:165]
  v_pk_mul_f32 v[102:103], v[166:167], v[166:167]
  v_pk_fma_f32 v[100:101], v[100:101], v[96:97], v[96:97] op_sel:[0,1,0] op_sel_hi:[1,1,0]
  v_pk_fma_f32 v[102:103], v[102:103], v[96:97], v[96:97] op_sel:[0,1,0] op_sel_hi:[1,1,0]
  v_pk_mul_f32 v[100:101], v[100:101], v[164:165]
  v_pk_mul_f32 v[102:103], v[102:103], v[166:167]
  v_exp_f32 v100, v100
  v_exp_f32 v101, v101
  v_exp_f32 v102, v102
  v_exp_f32 v103, v103
  v_pk_add_f32 v[100:101], v[100:101], v[98:99] op_sel_hi:[1,0]
  v_pk_add_f32 v[102:103], v[102:103], v[98:99] op_sel_hi:[1,0]
  v_rcp_f32 v100, v100
  v_rcp_f32 v101, v101
  v_rcp_f32 v102, v102
  v_rcp_f32 v103, v103
  v_pk_mul_f32 v[164:165], v[164:165], v[100:101]
  v_pk_mul_f32 v[166:167], v[166:167], v[102:103]
  v_cvt_pk_bf16_f32 v108, v164, v165
  v_cvt_pk_bf16_f32 v109, v166, v167
  v_pk_fma_f32 v[104:105], v[44:45], v[90:91], v[72:73] op_sel:[0,0,0] op_sel_hi:[1,0,1] neg_lo:[0,1,0] neg_hi:[0,1,0]
  v_pk_fma_f32 v[106:107], v[46:47], v[90:91], v[74:75] op_sel:[0,0,0] op_sel_hi:[1,0,1] neg_lo:[0,1,0] neg_hi:[0,1,0]
  v_pk_fma_f32 v[180:181], v[180:181], v[90:91], v[104:105] op_sel:[0,1,0] op_sel_hi:[1,1,1]
  v_pk_fma_f32 v[182:183], v[182:183], v[90:91], v[106:107] op_sel:[0,1,0] op_sel_hi:[1,1,1]
  v_pk_mul_f32 v[104:105], v[180:181], v[180:181]
  v_pk_mul_f32 v[106:107], v[182:183], v[182:183]
  v_pk_fma_f32 v[104:105], v[104:105], v[96:97], v[96:97] op_sel:[0,1,0] op_sel_hi:[1,1,0]
  v_pk_fma_f32 v[106:107], v[106:107], v[96:97], v[96:97] op_sel:[0,1,0] op_sel_hi:[1,1,0]
  v_pk_mul_f32 v[104:105], v[104:105], v[180:181]
  v_pk_mul_f32 v[106:107], v[106:107], v[182:183]
  v_exp_f32 v104, v104
  v_exp_f32 v105, v105
  v_exp_f32 v106, v106
  v_exp_f32 v107, v107
  v_pk_add_f32 v[104:105], v[104:105], v[98:99] op_sel_hi:[1,0]
  v_pk_add_f32 v[106:107], v[106:107], v[98:99] op_sel_hi:[1,0]
  v_rcp_f32 v104, v104
  v_rcp_f32 v105, v105
  v_rcp_f32 v106, v106
  v_rcp_f32 v107, v107
  v_pk_mul_f32 v[180:181], v[180:181], v[104:105]
  v_pk_mul_f32 v[182:183], v[182:183], v[106:107]
  v_cvt_pk_bf16_f32 v110, v180, v181
  v_cvt_pk_bf16_f32 v111, v182, v183
  s_add_u32 s3, s10, 163840
  s_nop 0
  v_permlane16_swap_b32 v108, v110
  v_permlane16_swap_b32 v109, v111
  buffer_store_dwordx4 v[108:111], v12, s[44:47], s3 offen sc1
  ds_write_b128 v18, v[108:111] offset:2048
  v_pk_fma_f32 v[100:101], v[48:49], v[90:91], v[76:77] op_sel:[0,0,0] op_sel_hi:[1,0,1] neg_lo:[0,1,0] neg_hi:[0,1,0]
  v_pk_fma_f32 v[102:103], v[50:51], v[90:91], v[78:79] op_sel:[0,0,0] op_sel_hi:[1,0,1] neg_lo:[0,1,0] neg_hi:[0,1,0]
  v_pk_fma_f32 v[196:197], v[196:197], v[90:91], v[100:101] op_sel:[0,1,0] op_sel_hi:[1,1,1]
  v_pk_fma_f32 v[198:199], v[198:199], v[90:91], v[102:103] op_sel:[0,1,0] op_sel_hi:[1,1,1]
  v_pk_mul_f32 v[100:101], v[196:197], v[196:197]
  v_pk_mul_f32 v[102:103], v[198:199], v[198:199]
  v_pk_fma_f32 v[100:101], v[100:101], v[96:97], v[96:97] op_sel:[0,1,0] op_sel_hi:[1,1,0]
  v_pk_fma_f32 v[102:103], v[102:103], v[96:97], v[96:97] op_sel:[0,1,0] op_sel_hi:[1,1,0]
  v_pk_mul_f32 v[100:101], v[100:101], v[196:197]
  v_pk_mul_f32 v[102:103], v[102:103], v[198:199]
  v_exp_f32 v100, v100
  v_exp_f32 v101, v101
  v_exp_f32 v102, v102
  v_exp_f32 v103, v103
  v_pk_add_f32 v[100:101], v[100:101], v[98:99] op_sel_hi:[1,0]
  v_pk_add_f32 v[102:103], v[102:103], v[98:99] op_sel_hi:[1,0]
  v_rcp_f32 v100, v100
  v_rcp_f32 v101, v101
  v_rcp_f32 v102, v102
  v_rcp_f32 v103, v103
  v_pk_mul_f32 v[196:197], v[196:197], v[100:101]
  v_pk_mul_f32 v[198:199], v[198:199], v[102:103]
  v_cvt_pk_bf16_f32 v112, v196, v197
  v_cvt_pk_bf16_f32 v113, v198, v199
  v_pk_fma_f32 v[104:105], v[52:53], v[90:91], v[80:81] op_sel:[0,0,0] op_sel_hi:[1,0,1] neg_lo:[0,1,0] neg_hi:[0,1,0]
  v_pk_fma_f32 v[106:107], v[54:55], v[90:91], v[82:83] op_sel:[0,0,0] op_sel_hi:[1,0,1] neg_lo:[0,1,0] neg_hi:[0,1,0]
  v_pk_fma_f32 v[212:213], v[212:213], v[90:91], v[104:105] op_sel:[0,1,0] op_sel_hi:[1,1,1]
  v_pk_fma_f32 v[214:215], v[214:215], v[90:91], v[106:107] op_sel:[0,1,0] op_sel_hi:[1,1,1]
  v_pk_mul_f32 v[104:105], v[212:213], v[212:213]
  v_pk_mul_f32 v[106:107], v[214:215], v[214:215]
  v_pk_fma_f32 v[104:105], v[104:105], v[96:97], v[96:97] op_sel:[0,1,0] op_sel_hi:[1,1,0]
  v_pk_fma_f32 v[106:107], v[106:107], v[96:97], v[96:97] op_sel:[0,1,0] op_sel_hi:[1,1,0]
  v_pk_mul_f32 v[104:105], v[104:105], v[212:213]
  v_pk_mul_f32 v[106:107], v[106:107], v[214:215]
  v_exp_f32 v104, v104
  v_exp_f32 v105, v105
  v_exp_f32 v106, v106
  v_exp_f32 v107, v107
  v_pk_add_f32 v[104:105], v[104:105], v[98:99] op_sel_hi:[1,0]
  v_pk_add_f32 v[106:107], v[106:107], v[98:99] op_sel_hi:[1,0]
  v_rcp_f32 v104, v104
  v_rcp_f32 v105, v105
  v_rcp_f32 v106, v106
  v_rcp_f32 v107, v107
  v_pk_mul_f32 v[212:213], v[212:213], v[104:105]
  v_pk_mul_f32 v[214:215], v[214:215], v[106:107]
  v_cvt_pk_bf16_f32 v114, v212, v213
  v_cvt_pk_bf16_f32 v115, v214, v215
  s_add_u32 s3, s10, 165888
  s_nop 0
  v_permlane16_swap_b32 v112, v114
  v_permlane16_swap_b32 v113, v115
  buffer_store_dwordx4 v[112:115], v12, s[44:47], s3 offen sc1
  ds_write_b128 v18, v[112:115] offset:18432
  v_pk_fma_f32 v[100:101], v[40:41], v[92:93], v[68:69] op_sel:[0,0,0] op_sel_hi:[1,0,1] neg_lo:[0,1,0] neg_hi:[0,1,0]
  v_pk_fma_f32 v[102:103], v[42:43], v[92:93], v[70:71] op_sel:[0,0,0] op_sel_hi:[1,0,1] neg_lo:[0,1,0] neg_hi:[0,1,0]
  v_pk_fma_f32 v[168:169], v[168:169], v[92:93], v[100:101] op_sel:[0,1,0] op_sel_hi:[1,1,1]
  v_pk_fma_f32 v[170:171], v[170:171], v[92:93], v[102:103] op_sel:[0,1,0] op_sel_hi:[1,1,1]
  v_pk_mul_f32 v[100:101], v[168:169], v[168:169]
  v_pk_mul_f32 v[102:103], v[170:171], v[170:171]
  v_pk_fma_f32 v[100:101], v[100:101], v[96:97], v[96:97] op_sel:[0,1,0] op_sel_hi:[1,1,0]
  v_pk_fma_f32 v[102:103], v[102:103], v[96:97], v[96:97] op_sel:[0,1,0] op_sel_hi:[1,1,0]
  v_pk_mul_f32 v[100:101], v[100:101], v[168:169]
  v_pk_mul_f32 v[102:103], v[102:103], v[170:171]
  v_exp_f32 v100, v100
  v_exp_f32 v101, v101
  v_exp_f32 v102, v102
  v_exp_f32 v103, v103
  v_pk_add_f32 v[100:101], v[100:101], v[98:99] op_sel_hi:[1,0]
  v_pk_add_f32 v[102:103], v[102:103], v[98:99] op_sel_hi:[1,0]
  v_rcp_f32 v100, v100
  v_rcp_f32 v101, v101
  v_rcp_f32 v102, v102
  v_rcp_f32 v103, v103
  v_pk_mul_f32 v[168:169], v[168:169], v[100:101]
  v_pk_mul_f32 v[170:171], v[170:171], v[102:103]
  v_cvt_pk_bf16_f32 v116, v168, v169
  v_cvt_pk_bf16_f32 v117, v170, v171
  v_pk_fma_f32 v[104:105], v[44:45], v[92:93], v[72:73] op_sel:[0,0,0] op_sel_hi:[1,0,1] neg_lo:[0,1,0] neg_hi:[0,1,0]
  v_pk_fma_f32 v[106:107], v[46:47], v[92:93], v[74:75] op_sel:[0,0,0] op_sel_hi:[1,0,1] neg_lo:[0,1,0] neg_hi:[0,1,0]
  v_pk_fma_f32 v[184:185], v[184:185], v[92:93], v[104:105] op_sel:[0,1,0] op_sel_hi:[1,1,1]
  v_pk_fma_f32 v[186:187], v[186:187], v[92:93], v[106:107] op_sel:[0,1,0] op_sel_hi:[1,1,1]
  v_pk_mul_f32 v[104:105], v[184:185], v[184:185]
  v_pk_mul_f32 v[106:107], v[186:187], v[186:187]
  v_pk_fma_f32 v[104:105], v[104:105], v[96:97], v[96:97] op_sel:[0,1,0] op_sel_hi:[1,1,0]
  v_pk_fma_f32 v[106:107], v[106:107], v[96:97], v[96:97] op_sel:[0,1,0] op_sel_hi:[1,1,0]
  v_pk_mul_f32 v[104:105], v[104:105], v[184:185]
  v_pk_mul_f32 v[106:107], v[106:107], v[186:187]
  v_exp_f32 v104, v104
  v_exp_f32 v105, v105
  v_exp_f32 v106, v106
  v_exp_f32 v107, v107
  v_pk_add_f32 v[104:105], v[104:105], v[98:99] op_sel_hi:[1,0]
  v_pk_add_f32 v[106:107], v[106:107], v[98:99] op_sel_hi:[1,0]
  v_rcp_f32 v104, v104
  v_rcp_f32 v105, v105
  v_rcp_f32 v106, v106
  v_rcp_f32 v107, v107
  v_pk_mul_f32 v[184:185], v[184:185], v[104:105]
  v_pk_mul_f32 v[186:187], v[186:187], v[106:107]
  v_cvt_pk_bf16_f32 v118, v184, v185
  v_cvt_pk_bf16_f32 v119, v186, v187
  s_add_u32 s3, s10, 278528
  s_nop 0
  v_permlane16_swap_b32 v116, v118
  v_permlane16_swap_b32 v117, v119
  buffer_store_dwordx4 v[116:119], v12, s[44:47], s3 offen sc1
  ds_write_b128 v18, v[116:119] offset:4096
  v_pk_fma_f32 v[100:101], v[48:49], v[92:93], v[76:77] op_sel:[0,0,0] op_sel_hi:[1,0,1] neg_lo:[0,1,0] neg_hi:[0,1,0]
  v_pk_fma_f32 v[102:103], v[50:51], v[92:93], v[78:79] op_sel:[0,0,0] op_sel_hi:[1,0,1] neg_lo:[0,1,0] neg_hi:[0,1,0]
  v_pk_fma_f32 v[200:201], v[200:201], v[92:93], v[100:101] op_sel:[0,1,0] op_sel_hi:[1,1,1]
  v_pk_fma_f32 v[202:203], v[202:203], v[92:93], v[102:103] op_sel:[0,1,0] op_sel_hi:[1,1,1]
  v_pk_mul_f32 v[100:101], v[200:201], v[200:201]
  v_pk_mul_f32 v[102:103], v[202:203], v[202:203]
  v_pk_fma_f32 v[100:101], v[100:101], v[96:97], v[96:97] op_sel:[0,1,0] op_sel_hi:[1,1,0]
  v_pk_fma_f32 v[102:103], v[102:103], v[96:97], v[96:97] op_sel:[0,1,0] op_sel_hi:[1,1,0]
  v_pk_mul_f32 v[100:101], v[100:101], v[200:201]
  v_pk_mul_f32 v[102:103], v[102:103], v[202:203]
  v_exp_f32 v100, v100
  v_exp_f32 v101, v101
  v_exp_f32 v102, v102
  v_exp_f32 v103, v103
  v_pk_add_f32 v[100:101], v[100:101], v[98:99] op_sel_hi:[1,0]
  v_pk_add_f32 v[102:103], v[102:103], v[98:99] op_sel_hi:[1,0]
  v_rcp_f32 v100, v100
  v_rcp_f32 v101, v101
  v_rcp_f32 v102, v102
  v_rcp_f32 v103, v103
  v_pk_mul_f32 v[200:201], v[200:201], v[100:101]
  v_pk_mul_f32 v[202:203], v[202:203], v[102:103]
  v_cvt_pk_bf16_f32 v120, v200, v201
  v_cvt_pk_bf16_f32 v121, v202, v203
  v_pk_fma_f32 v[104:105], v[52:53], v[92:93], v[80:81] op_sel:[0,0,0] op_sel_hi:[1,0,1] neg_lo:[0,1,0] neg_hi:[0,1,0]
  v_pk_fma_f32 v[106:107], v[54:55], v[92:93], v[82:83] op_sel:[0,0,0] op_sel_hi:[1,0,1] neg_lo:[0,1,0] neg_hi:[0,1,0]
  v_pk_fma_f32 v[216:217], v[216:217], v[92:93], v[104:105] op_sel:[0,1,0] op_sel_hi:[1,1,1]
  v_pk_fma_f32 v[218:219], v[218:219], v[92:93], v[106:107] op_sel:[0,1,0] op_sel_hi:[1,1,1]
  v_pk_mul_f32 v[104:105], v[216:217], v[216:217]
  v_pk_mul_f32 v[106:107], v[218:219], v[218:219]
  v_pk_fma_f32 v[104:105], v[104:105], v[96:97], v[96:97] op_sel:[0,1,0] op_sel_hi:[1,1,0]
  v_pk_fma_f32 v[106:107], v[106:107], v[96:97], v[96:97] op_sel:[0,1,0] op_sel_hi:[1,1,0]
  v_pk_mul_f32 v[104:105], v[104:105], v[216:217]
  v_pk_mul_f32 v[106:107], v[106:107], v[218:219]
  v_exp_f32 v104, v104
  v_exp_f32 v105, v105
  v_exp_f32 v106, v106
  v_exp_f32 v107, v107
  v_pk_add_f32 v[104:105], v[104:105], v[98:99] op_sel_hi:[1,0]
  v_pk_add_f32 v[106:107], v[106:107], v[98:99] op_sel_hi:[1,0]
  v_rcp_f32 v104, v104
  v_rcp_f32 v105, v105
  v_rcp_f32 v106, v106
  v_rcp_f32 v107, v107
  v_pk_mul_f32 v[216:217], v[216:217], v[104:105]
  v_pk_mul_f32 v[218:219], v[218:219], v[106:107]
  v_cvt_pk_bf16_f32 v122, v216, v217
  v_cvt_pk_bf16_f32 v123, v218, v219
  s_add_u32 s3, s10, 280576
  s_nop 0
  v_permlane16_swap_b32 v120, v122
  v_permlane16_swap_b32 v121, v123
  buffer_store_dwordx4 v[120:123], v12, s[44:47], s3 offen sc1
  ds_write_b128 v18, v[120:123] offset:20480
  v_pk_fma_f32 v[100:101], v[40:41], v[94:95], v[68:69] op_sel:[0,0,0] op_sel_hi:[1,0,1] neg_lo:[0,1,0] neg_hi:[0,1,0]
  v_pk_fma_f32 v[102:103], v[42:43], v[94:95], v[70:71] op_sel:[0,0,0] op_sel_hi:[1,0,1] neg_lo:[0,1,0] neg_hi:[0,1,0]
  v_pk_fma_f32 v[172:173], v[172:173], v[94:95], v[100:101] op_sel:[0,1,0] op_sel_hi:[1,1,1]
  v_pk_fma_f32 v[174:175], v[174:175], v[94:95], v[102:103] op_sel:[0,1,0] op_sel_hi:[1,1,1]
  v_pk_mul_f32 v[100:101], v[172:173], v[172:173]
  v_pk_mul_f32 v[102:103], v[174:175], v[174:175]
  v_pk_fma_f32 v[100:101], v[100:101], v[96:97], v[96:97] op_sel:[0,1,0] op_sel_hi:[1,1,0]
  v_pk_fma_f32 v[102:103], v[102:103], v[96:97], v[96:97] op_sel:[0,1,0] op_sel_hi:[1,1,0]
  v_pk_mul_f32 v[100:101], v[100:101], v[172:173]
  v_pk_mul_f32 v[102:103], v[102:103], v[174:175]
  v_exp_f32 v100, v100
  v_exp_f32 v101, v101
  v_exp_f32 v102, v102
  v_exp_f32 v103, v103
  v_pk_add_f32 v[100:101], v[100:101], v[98:99] op_sel_hi:[1,0]
  v_pk_add_f32 v[102:103], v[102:103], v[98:99] op_sel_hi:[1,0]
  v_rcp_f32 v100, v100
  v_rcp_f32 v101, v101
  v_rcp_f32 v102, v102
  v_rcp_f32 v103, v103
  v_pk_mul_f32 v[172:173], v[172:173], v[100:101]
  v_pk_mul_f32 v[174:175], v[174:175], v[102:103]
  v_cvt_pk_bf16_f32 v108, v172, v173
  v_cvt_pk_bf16_f32 v109, v174, v175
  v_pk_fma_f32 v[104:105], v[44:45], v[94:95], v[72:73] op_sel:[0,0,0] op_sel_hi:[1,0,1] neg_lo:[0,1,0] neg_hi:[0,1,0]
  v_pk_fma_f32 v[106:107], v[46:47], v[94:95], v[74:75] op_sel:[0,0,0] op_sel_hi:[1,0,1] neg_lo:[0,1,0] neg_hi:[0,1,0]
  v_pk_fma_f32 v[188:189], v[188:189], v[94:95], v[104:105] op_sel:[0,1,0] op_sel_hi:[1,1,1]
  v_pk_fma_f32 v[190:191], v[190:191], v[94:95], v[106:107] op_sel:[0,1,0] op_sel_hi:[1,1,1]
  v_pk_mul_f32 v[104:105], v[188:189], v[188:189]
  v_pk_mul_f32 v[106:107], v[190:191], v[190:191]
  v_pk_fma_f32 v[104:105], v[104:105], v[96:97], v[96:97] op_sel:[0,1,0] op_sel_hi:[1,1,0]
  v_pk_fma_f32 v[106:107], v[106:107], v[96:97], v[96:97] op_sel:[0,1,0] op_sel_hi:[1,1,0]
  v_pk_mul_f32 v[104:105], v[104:105], v[188:189]
  v_pk_mul_f32 v[106:107], v[106:107], v[190:191]
  v_exp_f32 v104, v104
  v_exp_f32 v105, v105
  v_exp_f32 v106, v106
  v_exp_f32 v107, v107
  v_pk_add_f32 v[104:105], v[104:105], v[98:99] op_sel_hi:[1,0]
  v_pk_add_f32 v[106:107], v[106:107], v[98:99] op_sel_hi:[1,0]
  v_rcp_f32 v104, v104
  v_rcp_f32 v105, v105
  v_rcp_f32 v106, v106
  v_rcp_f32 v107, v107
  v_pk_mul_f32 v[188:189], v[188:189], v[104:105]
  v_pk_mul_f32 v[190:191], v[190:191], v[106:107]
  v_cvt_pk_bf16_f32 v110, v188, v189
  v_cvt_pk_bf16_f32 v111, v190, v191
  s_add_u32 s3, s10, 393216
  s_nop 0
  v_permlane16_swap_b32 v108, v110
  v_permlane16_swap_b32 v109, v111
  buffer_store_dwordx4 v[108:111], v12, s[44:47], s3 offen sc1
  ds_write_b128 v18, v[108:111] offset:6144
  v_pk_fma_f32 v[100:101], v[48:49], v[94:95], v[76:77] op_sel:[0,0,0] op_sel_hi:[1,0,1] neg_lo:[0,1,0] neg_hi:[0,1,0]
  v_pk_fma_f32 v[102:103], v[50:51], v[94:95], v[78:79] op_sel:[0,0,0] op_sel_hi:[1,0,1] neg_lo:[0,1,0] neg_hi:[0,1,0]
  v_pk_fma_f32 v[204:205], v[204:205], v[94:95], v[100:101] op_sel:[0,1,0] op_sel_hi:[1,1,1]
  v_pk_fma_f32 v[206:207], v[206:207], v[94:95], v[102:103] op_sel:[0,1,0] op_sel_hi:[1,1,1]
  v_pk_mul_f32 v[100:101], v[204:205], v[204:205]
  v_pk_mul_f32 v[102:103], v[206:207], v[206:207]
  v_pk_fma_f32 v[100:101], v[100:101], v[96:97], v[96:97] op_sel:[0,1,0] op_sel_hi:[1,1,0]
  v_pk_fma_f32 v[102:103], v[102:103], v[96:97], v[96:97] op_sel:[0,1,0] op_sel_hi:[1,1,0]
  v_pk_mul_f32 v[100:101], v[100:101], v[204:205]
  v_pk_mul_f32 v[102:103], v[102:103], v[206:207]
  v_exp_f32 v100, v100
  v_exp_f32 v101, v101
  v_exp_f32 v102, v102
  v_exp_f32 v103, v103
  v_pk_add_f32 v[100:101], v[100:101], v[98:99] op_sel_hi:[1,0]
  v_pk_add_f32 v[102:103], v[102:103], v[98:99] op_sel_hi:[1,0]
  v_rcp_f32 v100, v100
  v_rcp_f32 v101, v101
  v_rcp_f32 v102, v102
  v_rcp_f32 v103, v103
  v_pk_mul_f32 v[204:205], v[204:205], v[100:101]
  v_pk_mul_f32 v[206:207], v[206:207], v[102:103]
  v_cvt_pk_bf16_f32 v112, v204, v205
  v_cvt_pk_bf16_f32 v113, v206, v207
  v_pk_fma_f32 v[104:105], v[52:53], v[94:95], v[80:81] op_sel:[0,0,0] op_sel_hi:[1,0,1] neg_lo:[0,1,0] neg_hi:[0,1,0]
  v_pk_fma_f32 v[106:107], v[54:55], v[94:95], v[82:83] op_sel:[0,0,0] op_sel_hi:[1,0,1] neg_lo:[0,1,0] neg_hi:[0,1,0]
  v_pk_fma_f32 v[220:221], v[220:221], v[94:95], v[104:105] op_sel:[0,1,0] op_sel_hi:[1,1,1]
  v_pk_fma_f32 v[222:223], v[222:223], v[94:95], v[106:107] op_sel:[0,1,0] op_sel_hi:[1,1,1]
  v_pk_mul_f32 v[104:105], v[220:221], v[220:221]
  v_pk_mul_f32 v[106:107], v[222:223], v[222:223]
  v_pk_fma_f32 v[104:105], v[104:105], v[96:97], v[96:97] op_sel:[0,1,0] op_sel_hi:[1,1,0]
  v_pk_fma_f32 v[106:107], v[106:107], v[96:97], v[96:97] op_sel:[0,1,0] op_sel_hi:[1,1,0]
  v_pk_mul_f32 v[104:105], v[104:105], v[220:221]
  v_pk_mul_f32 v[106:107], v[106:107], v[222:223]
  v_exp_f32 v104, v104
  v_exp_f32 v105, v105
  v_exp_f32 v106, v106
  v_exp_f32 v107, v107
  v_pk_add_f32 v[104:105], v[104:105], v[98:99] op_sel_hi:[1,0]
  v_pk_add_f32 v[106:107], v[106:107], v[98:99] op_sel_hi:[1,0]
  v_rcp_f32 v104, v104
  v_rcp_f32 v105, v105
  v_rcp_f32 v106, v106
  v_rcp_f32 v107, v107
  v_pk_mul_f32 v[220:221], v[220:221], v[104:105]
  v_pk_mul_f32 v[222:223], v[222:223], v[106:107]
  v_cvt_pk_bf16_f32 v114, v220, v221
  v_cvt_pk_bf16_f32 v115, v222, v223
  s_add_u32 s3, s10, 395264
  s_nop 0
  v_permlane16_swap_b32 v112, v114
  v_permlane16_swap_b32 v113, v115
  buffer_store_dwordx4 v[112:115], v12, s[44:47], s3 offen sc1
  ds_write_b128 v18, v[112:115] offset:22528
  s_waitcnt vmcnt(0) lgkmcnt(0)
  s_barrier
  s_add_u32 s97, s97, 1
  s_branch L_w2_body
L_w1_c1:
L_w2_c0:
L_w2_body:
  s_cmp_ge_u32 s2, 256
  s_cbranch_scc1 L_w2_end
  v_lshrrev_b32 v2, 6, v0
  v_and_b32 v1, 63, v0
  v_readfirstlane_b32 s70, v2
  s_and_b32 s3, s2, 7
  s_lshr_b32 s99, s2, 3
  s_and_b32 s5, s3, 3
  s_lshl_b32 s5, s5, 2
  s_and_b32 s6, s99, 3
  s_add_u32 s68, s5, s6
  s_lshr_b32 s5, s3, 2
  s_lshr_b32 s78, s99, 2
  s_lshl1_add_u32 s69, s78, s5
  s_add_u32 s3, s68, s78
  s_lshl_b32 s3, s3, 3
  s_lshl_b32 s85, 0xffff02, s3
  s_sub_u32 s3, 0, s3
  s_lshr_b32 s3, 0xffff02, s3
  s_or_b32 s85, s85, s3
  s_cmp_lt_u32 s70, 4
  s_cbranch_scc1 L_w2_compute
L_w2_loader:
  s_add_u32 s3, s68, s78
  s_and_b32 s3, s3, 3
  s_mov_b32 s4, 0x58585858
  s_cmp_eq_u32 s3, 1
  s_cselect_b32 s4, 0x1616160, s4
  s_cmp_eq_u32 s3, 2
  s_cselect_b32 s4, 0x5858580, s4
  s_cmp_eq_u32 s3, 3
  s_cselect_b32 s4, 0x16161600, s4
  v_subrev_u32 v2, 3, v1
  v_lshlrev_b32 v3, 1, v2
  v_bfe_i32 v16, s4, v3, 2
  v_sub_u32 v16, v1, v16
  v_subrev_u32 v16, 6, v16
  v_ashrrev_i32 v3, 1, v16
  v_cmp_eq_u32 vcc, s78, v3
  s_and_b32 s3, s69, 1
  v_or_b32 v2, 14, v16
  v_cndmask_b32 v2, v16, v2, vcc
  v_cmp_gt_i32 vcc, 0, v16
  s_lshl2_add_u32 s4, s3, 19
  v_add_u32 v16, s4, v16
  s_lshl4_add_u32 s4, s3, 24
  v_add_u32 v2, s4, v2
  v_cndmask_b32 v16, v2, v16, vcc
  v_and_b32 v2, 3, v1
  v_lshlrev_b32 v2, 3, v2
  v_bfe_i32 v3, s85, v2, 8
  s_lshl2_add_u32 s5, s68, 12
  v_add3_u32 v3, v3, v1, s5
  v_and_b32 v2, 7, v3
  v_cmp_eq_u32 vcc, s78, v2
  v_bfe_u32 v2, v3, 3, 1
  v_lshl_add_u32 v2, v2, 2, 19
  v_and_b32 v3, 15, v3
  v_cndmask_b32 v3, v3, v2, vcc
  v_cmp_gt_u32 vcc, 20, v1
  s_lshl1_add_u32 s4, s78, s4
  s_lshl3_add_u32 s3, s3, s78
  v_cndmask_b32 v3, v3, v16, vcc
  v_writelane_b32 v3, s4, 0
  s_add_u32 s4, s4, 1
  v_writelane_b32 v3, s3, 2
  v_writelane_b32 v3, s4, 1
  v_lshlrev_b32 v16, 17, v3
  s_add_u32 s9, s70, s68
  s_and_b32 s9, s9, 3
  s_lshl_b32 s77, s9, 11
  v_and_b32 v10, 7, v1
  v_lshrrev_b32 v3, 3, v1
  s_lshl_b32 s10, s9, 4
  v_add_u32 v3, s10, v3
  v_mul_u32_u24 v3, 2048, v3
  v_lshrrev_b32 v2, 3, v1
  v_and_b32 v2, 2, v2
  v_xor_b32 v2, v2, v10
  s_lshl_b32 s10, s69, 7
  v_add_u32 v3, s10, v3
  v_lshl_add_u32 v8, v2, 4, v3
  v_xor_b32 v2, 4, v2
  v_add_u32 v3, 16384, v3
  v_lshl_add_u32 v9, v2, 4, v3
  s_mov_b32 s40, s28
  s_and_b32 s41, s29, 0xffff
  s_mov_b32 s42, 7340032
  s_mov_b32 s43, 0x00020000
  s_bitcmp1_b32 s69, 0
  s_mov_b32 s76, 128
  s_cselect_b32 s76, -128, s76
  v_readlane_b32 s74, v16, 0
  s_add_u32 m0, s77, 0
  s_add_u32 s4, s74, s76
  buffer_load_dwordx4 v8, s[40:43], s4 offen lds
  s_add_u32 m0, s77, 1024
  s_nop 0
  buffer_load_dwordx4 v9, s[40:43], s4 offen lds
  s_add_u32 m0, s77, 8192
  s_add_u32 s4, s74, 0
  buffer_load_dwordx4 v8, s[40:43], s4 offen lds
  s_add_u32 m0, s77, 9216
  s_nop 0
  buffer_load_dwordx4 v9, s[40:43], s4 offen lds
  v_readlane_b32 s74, v16, 1
  s_add_u32 m0, s77, 16384
  s_add_u32 s4, s74, s76
  buffer_load_dwordx4 v8, s[40:43], s4 offen lds
  s_add_u32 m0, s77, 17408
  s_nop 0
  buffer_load_dwordx4 v9, s[40:43], s4 offen lds
  s_add_u32 m0, s77, 24576
  s_add_u32 s4, s74, 0
  buffer_load_dwordx4 v8, s[40:43], s4 offen lds
  s_add_u32 m0, s77, 25600
  s_nop 0
  buffer_load_dwordx4 v9, s[40:43], s4 offen lds
  v_readlane_b32 s74, v16, 2
  s_add_u32 m0, s77, 32768
  s_add_u32 s4, s74, s76
  buffer_load_dwordx4 v8, s[40:43], s4 offen lds
  s_add_u32 m0, s77, 33792
  s_nop 0
  buffer_load_dwordx4 v9, s[40:43], s4 offen lds
  s_add_u32 m0, s77, 40960
  s_add_u32 s4, s74, 0
  buffer_load_dwordx4 v8, s[40:43], s4 offen lds
  s_add_u32 m0, s77, 41984
  s_nop 0
  buffer_load_dwordx4 v9, s[40:43], s4 offen lds
  v_readlane_b32 s74, v16, 3
  s_add_u32 m0, s77, 49152
  s_add_u32 s4, s74, s76
  buffer_load_dwordx4 v8, s[40:43], s4 offen lds
  s_add_u32 m0, s77, 50176
  s_nop 0
  buffer_load_dwordx4 v9, s[40:43], s4 offen lds
  s_add_u32 m0, s77, 57344
  s_add_u32 s4, s74, 0
  buffer_load_dwordx4 v8, s[40:43], s4 offen lds
  s_add_u32 m0, s77, 58368
  s_nop 0
  buffer_load_dwordx4 v9, s[40:43], s4 offen lds
  v_readlane_b32 s74, v16, 4
  s_add_u32 m0, s77, 65536
  s_add_u32 s4, s74, s76
  buffer_load_dwordx4 v8, s[40:43], s4 offen lds
  s_add_u32 m0, s77, 66560
  s_nop 0
  buffer_load_dwordx4 v9, s[40:43], s4 offen lds
  s_add_u32 m0, s77, 73728
  s_add_u32 s4, s74, 0
  buffer_load_dwordx4 v8, s[40:43], s4 offen lds
  s_add_u32 m0, s77, 74752
  s_nop 0
  buffer_load_dwordx4 v9, s[40:43], s4 offen lds
  s_add_u32 s44, s22, 41943040
  s_addc_u32 s45, s23, 0
  s_and_b32 s45, s45, 0xffff
  s_mov_b32 s46, 524288
  s_mov_b32 s47, 0x00020000
  s_lshl4_add_u32 s3, s97, s68
  s_and_b32 s4, s69, 15
  s_lshl4_add_u32 s3, s3, s4
  s_lshl_b32 s3, s3, 7
  s_sub_u32 s3, s3, 32768
  v_lshlrev_b32 v11, 7, v1
  v_and_b32 v2, 15, v1
  v_lshlrev_b32 v2, 2, v2
  v_mov_b32 v3, 1
  s_mov_b32 s79, 0x100000
  s_cmp_lg_u32 s70, 4
  s_barrier
  s_cbranch_scc1 L_w2_nofl
  s_mov_b32 exec_lo, 0xffff
  s_mov_b32 exec_hi, 0
  buffer_store_dword v3, v11, s[44:47], s87 offen sc1
  s_mov_b64 exec, -1
L_w2_nofl:
  s_mov_b32 s5, s3
  v_readlane_b32 s74, v16, 5
  s_add_u32 m0, s77, 81920
  s_add_u32 s4, s74, s76
  buffer_load_dwordx4 v8, s[40:43], s4 offen lds
  s_add_u32 m0, s77, 82944
  s_nop 0
  buffer_load_dwordx4 v9, s[40:43], s4 offen lds
  s_add_u32 m0, s77, 90112
  s_add_u32 s4, s74, 0
  buffer_load_dwordx4 v8, s[40:43], s4 offen lds
  s_add_u32 m0, s77, 91136
  s_nop 0
  buffer_load_dwordx4 v9, s[40:43], s4 offen lds
  v_readlane_b32 s74, v16, 6
  s_add_u32 m0, s77, 98304
  s_add_u32 s4, s74, s76
  buffer_load_dwordx4 v8, s[40:43], s4 offen lds
  s_add_u32 m0, s77, 99328
  s_nop 0
  buffer_load_dwordx4 v9, s[40:43], s4 offen lds
  s_add_u32 m0, s77, 106496
  s_add_u32 s4, s74, 0
  buffer_load_dwordx4 v8, s[40:43], s4 offen lds
  s_add_u32 m0, s77, 107520
  s_nop 0
  buffer_load_dwordx4 v9, s[40:43], s4 offen lds
  s_waitcnt vmcnt(20)
  s_barrier
  v_readlane_b32 s74, v16, 7
  s_add_u32 m0, s77, 114688
  s_add_u32 s4, s74, s76
  buffer_load_dwordx4 v8, s[40:43], s4 offen lds
  s_add_u32 m0, s77, 115712
  s_nop 0
  buffer_load_dwordx4 v9, s[40:43], s4 offen lds
  s_add_u32 m0, s77, 122880
  s_add_u32 s4, s74, 0
  buffer_load_dwordx4 v8, s[40:43], s4 offen lds
  s_add_u32 m0, s77, 123904
  s_nop 0
  buffer_load_dwordx4 v9, s[40:43], s4 offen lds
  v_readlane_b32 s74, v16, 8
  s_add_u32 m0, s77, 131072
  s_add_u32 s4, s74, s76
  buffer_load_dwordx4 v8, s[40:43], s4 offen lds
  s_add_u32 m0, s77, 132096
  s_nop 0
  buffer_load_dwordx4 v9, s[40:43], s4 offen lds
  s_add_u32 m0, s77, 139264
  s_add_u32 s4, s74, 0
  buffer_load_dwordx4 v8, s[40:43], s4 offen lds
  s_add_u32 m0, s77, 140288
  s_nop 0
  buffer_load_dwordx4 v9, s[40:43], s4 offen lds
  v_readlane_b32 s74, v16, 9
  s_add_u32 m0, s77, 147456
  s_add_u32 s4, s74, s76
  buffer_load_dwordx4 v8, s[40:43], s4 offen lds
  s_add_u32 m0, s77, 148480
  s_nop 0
  buffer_load_dwordx4 v9, s[40:43], s4 offen lds
  s_add_u32 m0, s77, 155648
  s_add_u32 s4, s74, 0
  buffer_load_dwordx4 v8, s[40:43], s4 offen lds
  s_add_u32 m0, s77, 156672
  s_nop 0
  buffer_load_dwordx4 v9, s[40:43], s4 offen lds
  s_mov_b32 s3, s5
  s_cmp_lg_u32 s70, 4
  s_cbranch_scc1 L_w2_dep
L_w2_poll:
  buffer_load_dword v3, v2, s[44:47], s3 offen sc1
  s_sub_u32 s79, s79, 1
  s_cbranch_scc1 L_w2_dep
  s_waitcnt vmcnt(0)
  v_cmp_ne_u32 vcc, 1, v3
  s_cbranch_vccnz L_w2_poll
L_w2_dep:
  s_waitcnt vmcnt(22) lgkmcnt(0)
  s_barrier
  v_readlane_b32 s74, v16, 10
  s_add_u32 m0, s77, 0
  s_add_u32 s4, s74, s76
  buffer_load_dwordx4 v8, s[40:43], s4 offen lds
  s_add_u32 m0, s77, 1024
  s_nop 0
  buffer_load_dwordx4 v9, s[40:43], s4 offen lds
  s_waitcnt vmcnt(4)
  s_add_u32 m0, s77, 8192
  s_add_u32 s4, s74, 0
  buffer_load_dwordx4 v8, s[40:43], s4 offen lds
  s_add_u32 m0, s77, 9216
  s_nop 0
  buffer_load_dwordx4 v9, s[40:43], s4 offen lds
  s_waitcnt vmcnt(4)
  v_readlane_b32 s74, v16, 11
  s_add_u32 m0, s77, 16384
  s_add_u32 s4, s74, s76
  buffer_load_dwordx4 v8, s[40:43], s4 offen lds
  s_add_u32 m0, s77, 17408
  s_nop 0
  buffer_load_dwordx4 v9, s[40:43], s4 offen lds
  s_waitcnt vmcnt(20)
  s_barrier
  s_add_u32 m0, s77, 24576
  s_add_u32 s4, s74, 0
  buffer_load_dwordx4 v8, s[40:43], s4 offen lds
  s_add_u32 m0, s77, 25600
  s_nop 0
  buffer_load_dwordx4 v9, s[40:43], s4 offen lds
  s_waitcnt vmcnt(4)
  v_readlane_b32 s74, v16, 12
  s_add_u32 m0, s77, 32768
  s_add_u32 s4, s74, s76
  buffer_load_dwordx4 v8, s[40:43], s4 offen lds
  s_add_u32 m0, s77, 33792
  s_nop 0
  buffer_load_dwordx4 v9, s[40:43], s4 offen lds
  s_waitcnt vmcnt(4)
  s_add_u32 m0, s77, 40960
  s_add_u32 s4, s74, 0
  buffer_load_dwordx4 v8, s[40:43], s4 offen lds
  s_add_u32 m0, s77, 41984
  s_nop 0
  buffer_load_dwordx4 v9, s[40:43], s4 offen lds
  s_waitcnt vmcnt(4)
  v_readlane_b32 s74, v16, 13
  s_add_u32 m0, s77, 49152
  s_add_u32 s4, s74, s76
  buffer_load_dwordx4 v8, s[40:43], s4 offen lds
  s_add_u32 m0, s77, 50176
  s_nop 0
  buffer_load_dwordx4 v9, s[40:43], s4 offen lds
  s_waitcnt vmcnt(4)
  s_add_u32 m0, s77, 57344
  s_add_u32 s4, s74, 0
  buffer_load_dwordx4 v8, s[40:43], s4 offen lds
  s_add_u32 m0, s77, 58368
  s_nop 0
  buffer_load_dwordx4 v9, s[40:43], s4 offen lds
  s_waitcnt vmcnt(22)
  s_barrier
  v_readlane_b32 s74, v16, 14
  s_add_u32 m0, s77, 65536
  s_add_u32 s4, s74, s76
  buffer_load_dwordx4 v8, s[40:43], s4 offen lds
  s_add_u32 m0, s77, 66560
  s_nop 0
  buffer_load_dwordx4 v9, s[40:43], s4 offen lds
  s_waitcnt vmcnt(4)
  s_add_u32 m0, s77, 73728
  s_add_u32 s4, s74, 0
  buffer_load_dwordx4 v8, s[40:43], s4 offen lds
  s_add_u32 m0, s77, 74752
  s_nop 0
  buffer_load_dwordx4 v9, s[40:43], s4 offen lds
  s_waitcnt vmcnt(4)
  v_readlane_b32 s74, v16, 15
  s_add_u32 m0, s77, 81920
  s_add_u32 s4, s74, s76
  buffer_load_dwordx4 v8, s[40:43], s4 offen lds
  s_add_u32 m0, s77, 82944
  s_nop 0
  buffer_load_dwordx4 v9, s[40:43], s4 offen lds
  s_waitcnt vmcnt(4)
  s_add_u32 m0, s77, 90112
  s_add_u32 s4, s74, 0
  buffer_load_dwordx4 v8, s[40:43], s4 offen lds
  s_add_u32 m0, s77, 91136
  s_nop 0
  buffer_load_dwordx4 v9, s[40:43], s4 offen lds
  s_waitcnt vmcnt(22)
  s_barrier
  v_readlane_b32 s74, v16, 16
  s_add_u32 m0, s77, 98304
  s_add_u32 s4, s74, s76
  buffer_load_dwordx4 v8, s[40:43], s4 offen lds
  s_add_u32 m0, s77, 99328
  s_nop 0
  buffer_load_dwordx4 v9, s[40:43], s4 offen lds
  s_waitcnt vmcnt(4)
  s_add_u32 m0, s77, 106496
  s_add_u32 s4, s74, 0
  buffer_load_dwordx4 v8, s[40:43], s4 offen lds
  s_add_u32 m0, s77, 107520
  s_nop 0
  buffer_load_dwordx4 v9, s[40:43], s4 offen lds
  s_waitcnt vmcnt(4)
  v_readlane_b32 s74, v16, 17
  s_add_u32 m0, s77, 114688
  s_add_u32 s4, s74, s76
  buffer_load_dwordx4 v8, s[40:43], s4 offen lds
  s_add_u32 m0, s77, 115712
  s_nop 0
  buffer_load_dwordx4 v9, s[40:43], s4 offen lds
  s_waitcnt vmcnt(4)
  s_add_u32 m0, s77, 122880
  s_add_u32 s4, s74, 0
  buffer_load_dwordx4 v8, s[40:43], s4 offen lds
  s_add_u32 m0, s77, 123904
  s_nop 0
  buffer_load_dwordx4 v9, s[40:43], s4 offen lds
  s_waitcnt vmcnt(22)
  s_barrier
  v_readlane_b32 s74, v16, 18
  s_add_u32 m0, s77, 131072
  s_add_u32 s4, s74, s76
  buffer_load_dwordx4 v8, s[40:43], s4 offen lds
  s_add_u32 m0, s77, 132096
  s_nop 0
  buffer_load_dwordx4 v9, s[40:43], s4 offen lds
  s_waitcnt vmcnt(4)
  s_add_u32 m0, s77, 139264
  s_add_u32 s4, s74, 0
  buffer_load_dwordx4 v8, s[40:43], s4 offen lds
  s_add_u32 m0, s77, 140288
  s_nop 0
  buffer_load_dwordx4 v9, s[40:43], s4 offen lds
  s_waitcnt vmcnt(4)
  v_readlane_b32 s74, v16, 19
  s_add_u32 m0, s77, 147456
  s_add_u32 s4, s74, s76
  buffer_load_dwordx4 v8, s[40:43], s4 offen lds
  s_add_u32 m0, s77, 148480
  s_nop 0
  buffer_load_dwordx4 v9, s[40:43], s4 offen lds
  s_waitcnt vmcnt(4)
  s_add_u32 m0, s77, 155648
  s_add_u32 s4, s74, 0
  buffer_load_dwordx4 v8, s[40:43], s4 offen lds
  s_add_u32 m0, s77, 156672
  s_nop 0
  buffer_load_dwordx4 v9, s[40:43], s4 offen lds
  s_waitcnt vmcnt(22)
  s_barrier
  v_readlane_b32 s74, v16, 20
  s_add_u32 m0, s77, 0
  s_add_u32 s4, s74, 0
  buffer_load_dwordx4 v8, s[40:43], s4 offen lds
  s_add_u32 m0, s77, 1024
  s_nop 0
  buffer_load_dwordx4 v9, s[40:43], s4 offen lds
  s_waitcnt vmcnt(4)
  v_readlane_b32 s74, v16, 21
  s_add_u32 m0, s77, 8192
  s_add_u32 s4, s74, 0
  buffer_load_dwordx4 v8, s[40:43], s4 offen lds
  s_add_u32 m0, s77, 9216
  s_nop 0
  buffer_load_dwordx4 v9, s[40:43], s4 offen lds
  s_waitcnt vmcnt(4)
  v_readlane_b32 s74, v16, 22
  s_add_u32 m0, s77, 16384
  s_add_u32 s4, s74, 0
  buffer_load_dwordx4 v8, s[40:43], s4 offen lds
  s_add_u32 m0, s77, 17408
  s_nop 0
  buffer_load_dwordx4 v9, s[40:43], s4 offen lds
  s_waitcnt vmcnt(4)
  v_readlane_b32 s74, v16, 23
  s_add_u32 m0, s77, 24576
  s_add_u32 s4, s74, 0
  buffer_load_dwordx4 v8, s[40:43], s4 offen lds
  s_add_u32 m0, s77, 25600
  s_nop 0
  buffer_load_dwordx4 v9, s[40:43], s4 offen lds
  s_waitcnt vmcnt(22)
  s_barrier
  v_readlane_b32 s74, v16, 24
  s_add_u32 m0, s77, 32768
  s_add_u32 s4, s74, 0
  buffer_load_dwordx4 v8, s[40:43], s4 offen lds
  s_add_u32 m0, s77, 33792
  s_nop 0
  buffer_load_dwordx4 v9, s[40:43], s4 offen lds
  s_waitcnt vmcnt(4)
  v_readlane_b32 s74, v16, 25
  s_add_u32 m0, s77, 40960
  s_add_u32 s4, s74, 0
  buffer_load_dwordx4 v8, s[40:43], s4 offen lds
  s_add_u32 m0, s77, 41984
  s_nop 0
  buffer_load_dwordx4 v9, s[40:43], s4 offen lds
  s_waitcnt vmcnt(4)
  v_readlane_b32 s74, v16, 26
  s_add_u32 m0, s77, 49152
  s_add_u32 s4, s74, 0
  buffer_load_dwordx4 v8, s[40:43], s4 offen lds
  s_add_u32 m0, s77, 50176
  s_nop 0
  buffer_load_dwordx4 v9, s[40:43], s4 offen lds
  s_waitcnt vmcnt(4)
  v_readlane_b32 s74, v16, 27
  s_add_u32 m0, s77, 57344
  s_add_u32 s4, s74, 0
  buffer_load_dwordx4 v8, s[40:43], s4 offen lds
  s_add_u32 m0, s77, 58368
  s_nop 0
  buffer_load_dwordx4 v9, s[40:43], s4 offen lds
  s_waitcnt vmcnt(22)
  s_barrier
  v_readlane_b32 s74, v16, 28
  s_add_u32 m0, s77, 65536
  s_add_u32 s4, s74, 0
  buffer_load_dwordx4 v8, s[40:43], s4 offen lds
  s_add_u32 m0, s77, 66560
  s_nop 0
  buffer_load_dwordx4 v9, s[40:43], s4 offen lds
  s_waitcnt vmcnt(4)
  v_readlane_b32 s74, v16, 29
  s_add_u32 m0, s77, 73728
  s_add_u32 s4, s74, 0
  buffer_load_dwordx4 v8, s[40:43], s4 offen lds
  s_add_u32 m0, s77, 74752
  s_nop 0
  buffer_load_dwordx4 v9, s[40:43], s4 offen lds
  s_waitcnt vmcnt(4)
  v_readlane_b32 s74, v16, 30
  s_add_u32 m0, s77, 81920
  s_add_u32 s4, s74, 0
  buffer_load_dwordx4 v8, s[40:43], s4 offen lds
  s_add_u32 m0, s77, 82944
  s_nop 0
  buffer_load_dwordx4 v9, s[40:43], s4 offen lds
  s_waitcnt vmcnt(4)
  v_readlane_b32 s74, v16, 31
  s_add_u32 m0, s77, 90112
  s_add_u32 s4, s74, 0
  buffer_load_dwordx4 v8, s[40:43], s4 offen lds
  s_add_u32 m0, s77, 91136
  s_nop 0
  buffer_load_dwordx4 v9, s[40:43], s4 offen lds
  s_waitcnt vmcnt(22)
  s_barrier
  v_readlane_b32 s74, v16, 32
  s_add_u32 m0, s77, 98304
  s_add_u32 s4, s74, 0
  buffer_load_dwordx4 v8, s[40:43], s4 offen lds
  s_add_u32 m0, s77, 99328
  s_nop 0
  buffer_load_dwordx4 v9, s[40:43], s4 offen lds
  s_waitcnt vmcnt(4)
  v_readlane_b32 s74, v16, 33
  s_add_u32 m0, s77, 106496
  s_add_u32 s4, s74, 0
  buffer_load_dwordx4 v8, s[40:43], s4 offen lds
  s_add_u32 m0, s77, 107520
  s_nop 0
  buffer_load_dwordx4 v9, s[40:43], s4 offen lds
  s_waitcnt vmcnt(4)
  v_readlane_b32 s74, v16, 34
  s_add_u32 m0, s77, 114688
  s_add_u32 s4, s74, 0
  buffer_load_dwordx4 v8, s[40:43], s4 offen lds
  s_add_u32 m0, s77, 115712
  s_nop 0
  buffer_load_dwordx4 v9, s[40:43], s4 offen lds
  s_waitcnt vmcnt(4)
  v_readlane_b32 s74, v16, 35
  s_add_u32 m0, s77, 122880
  s_add_u32 s4, s74, 0
  buffer_load_dwordx4 v8, s[40:43], s4 offen lds
  s_add_u32 m0, s77, 123904
  s_nop 0
  buffer_load_dwordx4 v9, s[40:43], s4 offen lds
  s_waitcnt vmcnt(18)
  s_barrier
  s_add_u32 s64, s22, 41943040
  s_addc_u32 s65, s23, 0
  s_and_b32 s65, s65, 0xffff
  s_mov_b32 s66, 524288
  s_mov_b32 s67, 0x00020000
  s_lshl4_add_u32 s6, s68, s69
  s_xor_b32 s6, s6, 1
  s_add_u32 s7, s96, 4
  s_lshl_b32 s7, s7, 8
  s_add_u32 s6, s6, s7
  s_lshl_b32 s6, s6, 8
  v_and_b32 v2, 3, v1
  v_lshlrev_b32 v2, 6, v2
  s_mov_b32 s79, 0x100000
  s_waitcnt vmcnt(8)
  s_barrier
  s_cmp_lg_u32 s70, 4
  s_cbranch_scc1 L_w2_xgo
  s_setprio 3
L_w2_xpoll:
  buffer_load_dword v5, v2, s[64:67], s6 offen sc1
  s_sub_u32 s79, s79, 1
  s_cbranch_scc1 L_w2_xgo
  s_waitcnt vmcnt(0)
  v_cmp_ne_u32 vcc, 1, v5
  s_cbranch_vccnz L_w2_xpoll
L_w2_xgo:
  s_setprio 0
  s_waitcnt vmcnt(0)
  s_barrier
  s_cmp_eq_u32 s96, 1
  s_cbranch_scc1 L_w2_end
  s_lshl_b32 s87, s97, 15
  s_lshl_b32 s4, s68, 11
  s_add_u32 s87, s87, s4
  s_lshl_b32 s4, s69, 2
  s_add_u32 s87, s87, s4
  s_mov_b32 s96, 1
  s_add_u32 s12, s22, 33554432
  s_addc_u32 s13, s23, 0
  s_add_u32 s34, s22, 67108864
  s_addc_u32 s35, s23, 0
  s_add_u32 s97, s97, 1
  s_branch L_attn_body
L_w2_end:
  s_endpgm
L_w2_compute:
  s_lshl_b32 s3, s70, 12
  s_add_u32 s3, s3, 114688
  v_lshl_add_u32 v2, v1, 4, s3
  ds_read_b128 v[32:35], v2 offset:0
  ds_read_b128 v[36:39], v2 offset:2048
  ds_read_b128 v[40:43], v2 offset:1024
  ds_read_b128 v[44:47], v2 offset:3072
  ds_read_b128 v[48:51], v2 offset:16384
  ds_read_b128 v[52:55], v2 offset:18432
  ds_read_b128 v[56:59], v2 offset:17408
  ds_read_b128 v[60:63], v2 offset:19456
  ds_read_b128 v[64:67], v2 offset:32768
  ds_read_b128 v[68:71], v2 offset:34816
  ds_read_b128 v[72:75], v2 offset:33792
  ds_read_b128 v[76:79], v2 offset:35840
  s_add_u32 s3, s68, s78
  s_and_b32 s3, s3, 3
  s_mov_b32 s4, 0x58585858
  s_cmp_eq_u32 s3, 1
  s_cselect_b32 s4, 0x1616160, s4
  s_cmp_eq_u32 s3, 2
  s_cselect_b32 s4, 0x5858580, s4
  s_cmp_eq_u32 s3, 3
  s_cselect_b32 s4, 0x16161600, s4
  v_subrev_u32 v2, 3, v1
  v_lshlrev_b32 v3, 1, v2
  v_bfe_i32 v15, s4, v3, 2
  v_sub_u32 v15, v1, v15
  v_subrev_u32 v15, 6, v15
  v_ashrrev_i32 v3, 1, v15
  v_cmp_eq_u32 vcc, s78, v3
  s_and_b32 s3, s69, 1
  v_or_b32 v2, 14, v15
  v_cndmask_b32 v2, v15, v2, vcc
  v_cmp_gt_i32 vcc, 0, v15
  s_lshl2_add_u32 s4, s3, 19
  v_add_u32 v15, s4, v15
  s_lshl4_add_u32 s4, s3, 24
  v_add_u32 v2, s4, v2
  v_cndmask_b32 v15, v2, v15, vcc
  v_and_b32 v2, 3, v1
  v_lshlrev_b32 v2, 3, v2
  v_bfe_i32 v3, s85, v2, 8
  s_lshl2_add_u32 s5, s68, 12
  v_add3_u32 v3, v3, v1, s5
  v_and_b32 v2, 7, v3
  v_cmp_eq_u32 vcc, s78, v2
  v_bfe_u32 v2, v3, 3, 1
  v_lshl_add_u32 v2, v2, 2, 19
  v_and_b32 v3, 15, v3
  v_cndmask_b32 v3, v3, v2, vcc
  v_cmp_gt_u32 vcc, 20, v1
  s_lshl1_add_u32 s4, s78, s4
  s_lshl3_add_u32 s3, s3, s78
  v_cndmask_b32 v3, v3, v15, vcc
  v_writelane_b32 v3, s4, 0
  s_add_u32 s4, s4, 1
  v_writelane_b32 v3, s3, 2
  v_writelane_b32 v3, s4, 1
  v_lshlrev_b32 v15, 11, v3
  s_waitcnt lgkmcnt(0)
  s_barrier
  v_and_b32 v3, 15, v1
  v_lshrrev_b32 v2, 4, v1
  s_lshl_b32 s8, s68, 7
  s_lshl_b32 s9, s70, 5
  s_add_u32 s8, s8, s9
  s_mul_i32 s9, s8, 7168
  v_add_u32 v13, s8, v3
  s_lshl_b32 s10, s69, 7
  v_lshl_add_u32 v14, v2, 3, s10
  v_and_b32 v16, 1, v2
  v_lshrrev_b32 v17, 1, v2
  v_lshlrev_b32 v16, 5, v16
  v_lshl_add_u32 v16, v17, 4, v16
  v_lshlrev_b32 v4, 3, v3
  v_and_b32 v4, 0x70, v4
  v_xor_b32 v4, v4, v16
  v_lshl_add_u32 v4, v3, 7, v4
  s_lshl_b32 s3, s70, 12
  v_add_u32 v4, s3, v4
  v_xor_b32 v5, 64, v4
  v_add_u32 v16, s10, v16
  s_cmp_eq_u32 s96, 0
  s_cselect_b32 s7, 128, 0
  s_add_u32 s7, s7, 2048
  v_mad_u32_u24 v12, v13, s7, v16
  v_lshl_add_u32 v18, v17, 4, v13
  v_lshlrev_b32 v18, 3, v18
  v_and_b32 v16, 1, v2
  v_lshl_add_u32 v18, v16, 2, v18
  s_lshl_b32 s10, s69, 14
  v_add_u32 v18, s10, v18
  v_bfe_u32 v6, v1, 2, 2
  v_lshl_add_u32 v6, v2, 3, v6
  v_lshlrev_b32 v6, 7, v6
  v_and_b32 v17, 3, v1
  v_lshl_add_u32 v6, v17, 3, v6
  v_bfe_u32 v17, v1, 3, 2
  v_lshl_add_u32 v6, v17, 5, v6
  v_xor_b32 v7, 32, v6
  v_xor_b32 v8, 64, v6
  v_xor_b32 v9, 96, v6
  s_mov_b32 s11, 0xffff0000
  s_add_u32 s36, s34, 8388608
  s_addc_u32 s37, s35, 0
  s_and_b32 s37, s37, 0xffff
  s_mov_b32 s38, 14680064
  s_mov_b32 s39, 0x00020000
  s_mov_b32 s44, s32
  s_and_b32 s45, s33, 0xffff
  s_mov_b32 s46, 4194304
  s_mov_b32 s47, 0x00020000
  s_add_u32 s48, s22, 33554432
  s_addc_u32 s49, s23, 0
  s_and_b32 s49, s49, 0xffff
  s_mov_b32 s50, 4194304
  s_mov_b32 s51, 0x00020000
  s_cmp_eq_u32 s96, 0
  s_cselect_b64 s[44:45], s[48:49], s[44:45]
  s_lshl_b32 s46, s7, 11
  s_add_u32 s56, s34, 24379392
  s_addc_u32 s57, s35, 0
  s_and_b32 s57, s57, 0xffff
  s_mov_b32 s58, 262144
  s_mov_b32 s59, 0x00020000
  s_mul_i32 s9, s8, 7168
  s_add_u32 s36, s36, s9
  s_addc_u32 s37, s37, 0x100000
  s_add_u32 s64, s36, 114688
  s_addc_u32 s65, s37, 0
  s_mov_b32 s38, 114688
  s_mov_b32 s39, 0x00800000
  s_mov_b32 s66, 114688
  s_mov_b32 s67, 0x00800000
  s_add_u32 s60, s34, 25165824
  s_addc_u32 s61, s35, 0
  s_and_b32 s61, s61, 0xffff
  s_mov_b32 s62, 4194304
  s_mov_b32 s63, 0x00020000
  s_or_b32 s61, s61, 0x100000
  s_mov_b32 s63, 0x00800000
  s_lshl4_add_u32 s4, s68, s69
  s_lshl2_add_u32 s4, s4, s70
  s_add_u32 s52, s22, 41943040
  s_addc_u32 s53, s23, 0
  s_and_b32 s53, s53, 0xffff
  s_mov_b32 s54, 524288
  s_mov_b32 s55, 0x00020000
  s_add_u32 s6, s96, 4
  s_lshl_b32 s6, s6, 10
  s_add_u32 s6, s6, s4
  s_lshl_b32 s6, s6, 6
  v_mov_b32 v19, 1
  s_lshl_b32 s4, s4, 12
  s_xor_b32 s5, s4, 16384
  v_add_u32 v26, 131072, v6
  v_add_u32 v27, 131072, v7
  v_add_u32 v28, 131072, v8
  v_add_u32 v29, 131072, v9
  v_add_u32 v20, 65536, v6
  v_add_u32 v21, 65536, v7
  v_add_u32 v22, 65536, v8
  v_add_u32 v23, 65536, v9
  v_readlane_b32 s51, v15, 3
  v_readlane_b32 s48, v15, 4
  v_readlane_b32 s49, v15, 5
  v_permlane16_swap_b32 v240, v242
  v_permlane16_swap_b32 v241, v243
  v_permlane16_swap_b32 v244, v246
  v_permlane16_swap_b32 v245, v247
  v_permlane16_swap_b32 v248, v250
  v_permlane16_swap_b32 v249, v251
  v_permlane16_swap_b32 v252, v254
  v_permlane16_swap_b32 v253, v255
  s_waitcnt lgkmcnt(0)
  ds_read_b64_tr_b16 v[160:161], v6 offset:0
  ds_read_b64_tr_b16 v[162:163], v6 offset:512
  ds_read_b64_tr_b16 v[164:165], v7 offset:0
  ds_read_b64_tr_b16 v[166:167], v7 offset:512
  ds_read_b64_tr_b16 v[168:169], v8 offset:0
  ds_read_b64_tr_b16 v[170:171], v8 offset:512
  ds_read_b64_tr_b16 v[172:173], v9 offset:0
  ds_read_b64_tr_b16 v[174:175], v9 offset:512
  ds_read_b64_tr_b16 v[176:177], v6 offset:4096
  ds_read_b64_tr_b16 v[178:179], v6 offset:4608
  ds_read_b64_tr_b16 v[180:181], v7 offset:4096
  ds_read_b64_tr_b16 v[182:183], v7 offset:4608
  ds_read_b64_tr_b16 v[184:185], v8 offset:4096
  ds_read_b64_tr_b16 v[186:187], v8 offset:4608
  ds_read_b64_tr_b16 v[188:189], v9 offset:4096
  ds_read_b64_tr_b16 v[190:191], v9 offset:4608
  v_lshlrev_b32 v216, 16, v10
  v_and_b32 v217, s11, v10
  v_lshlrev_b32 v218, 16, v11
  v_and_b32 v219, s11, v11
  v_lshlrev_b32 v96, 16, v240
  v_and_b32 v97, s11, v240
  v_pk_add_f32 v[96:97], v[96:97], v[216:217]
  v_lshlrev_b32 v98, 16, v241
  v_and_b32 v99, s11, v241
  v_pk_add_f32 v[98:99], v[98:99], v[218:219]
  v_lshlrev_b32 v100, 16, v248
  v_and_b32 v101, s11, v248
  v_pk_add_f32 v[100:101], v[100:101], v[216:217]
  v_lshlrev_b32 v102, 16, v249
  v_and_b32 v103, s11, v249
  v_pk_add_f32 v[102:103], v[102:103], v[218:219]
  v_lshlrev_b32 v216, 16, v24
  v_and_b32 v217, s11, v24
  v_lshlrev_b32 v218, 16, v25
  v_and_b32 v219, s11, v25
  v_lshlrev_b32 v104, 16, v242
  v_and_b32 v105, s11, v242
  v_pk_add_f32 v[104:105], v[104:105], v[216:217]
  v_lshlrev_b32 v106, 16, v243
  v_and_b32 v107, s11, v243
  v_pk_add_f32 v[106:107], v[106:107], v[218:219]
  v_lshlrev_b32 v108, 16, v250
  v_and_b32 v109, s11, v250
  v_pk_add_f32 v[108:109], v[108:109], v[216:217]
  v_lshlrev_b32 v110, 16, v251
  v_and_b32 v111, s11, v251
  v_pk_add_f32 v[110:111], v[110:111], v[218:219]
  v_lshlrev_b32 v216, 16, v124
  v_and_b32 v217, s11, v124
  v_lshlrev_b32 v218, 16, v125
  v_and_b32 v219, s11, v125
  v_lshlrev_b32 v112, 16, v244
  v_and_b32 v113, s11, v244
  v_pk_add_f32 v[112:113], v[112:113], v[216:217]
  v_lshlrev_b32 v114, 16, v245
  v_and_b32 v115, s11, v245
  v_pk_add_f32 v[114:115], v[114:115], v[218:219]
  v_lshlrev_b32 v116, 16, v252
  v_and_b32 v117, s11, v252
  v_pk_add_f32 v[116:117], v[116:117], v[216:217]
  v_lshlrev_b32 v118, 16, v253
  v_and_b32 v119, s11, v253
  v_pk_add_f32 v[118:119], v[118:119], v[218:219]
  v_lshlrev_b32 v216, 16, v126
  v_and_b32 v217, s11, v126
  v_lshlrev_b32 v218, 16, v127
  v_and_b32 v219, s11, v127
  v_lshlrev_b32 v120, 16, v246
  v_and_b32 v121, s11, v246
  v_pk_add_f32 v[120:121], v[120:121], v[216:217]
  v_lshlrev_b32 v122, 16, v247
  v_and_b32 v123, s11, v247
  v_pk_add_f32 v[122:123], v[122:123], v[218:219]
  v_lshlrev_b32 v124, 16, v254
  v_and_b32 v125, s11, v254
  v_pk_add_f32 v[124:125], v[124:125], v[216:217]
  v_lshlrev_b32 v126, 16, v255
  v_and_b32 v127, s11, v255
  v_pk_add_f32 v[126:127], v[126:127], v[218:219]
  s_waitcnt lgkmcnt(8)
  v_mfma_f32_16x16x32_bf16 v[128:131], v[160:163], v[32:35], 0
  ds_read_b64_tr_b16 v[192:193], v6 offset:8192
  v_mfma_f32_16x16x32_bf16 v[132:135], v[160:163], v[36:39], 0
  ds_read_b64_tr_b16 v[194:195], v6 offset:8704
  v_mfma_f32_16x16x32_bf16 v[140:143], v[164:167], v[36:39], 0
  ds_read_b64_tr_b16 v[196:197], v7 offset:8192
  v_mfma_f32_16x16x32_bf16 v[136:139], v[164:167], v[32:35], 0
  ds_read_b64_tr_b16 v[198:199], v7 offset:8704
  v_mfma_f32_16x16x32_bf16 v[144:147], v[168:171], v[32:35], 0
  ds_read_b64_tr_b16 v[200:201], v8 offset:8192
  v_mfma_f32_16x16x32_bf16 v[148:151], v[168:171], v[36:39], 0
  ds_read_b64_tr_b16 v[202:203], v8 offset:8704
  v_mfma_f32_16x16x32_bf16 v[156:159], v[172:175], v[36:39], 0
  ds_read_b64_tr_b16 v[204:205], v9 offset:8192
  v_mfma_f32_16x16x32_bf16 v[152:155], v[172:175], v[32:35], 0
  ds_read_b64_tr_b16 v[206:207], v9 offset:8704
  s_waitcnt lgkmcnt(8)
  v_mfma_f32_16x16x32_bf16 v[128:131], v[176:179], v[40:43], v[128:131]
  ds_read_b64_tr_b16 v[208:209], v6 offset:12288
  v_mfma_f32_16x16x32_bf16 v[132:135], v[176:179], v[44:47], v[132:135]
  ds_read_b64_tr_b16 v[210:211], v6 offset:12800
  v_mfma_f32_16x16x32_bf16 v[140:143], v[180:183], v[44:47], v[140:143]
  ds_read_b64_tr_b16 v[212:213], v7 offset:12288
  v_mfma_f32_16x16x32_bf16 v[136:139], v[180:183], v[40:43], v[136:139]
  ds_read_b64_tr_b16 v[214:215], v7 offset:12800
  v_mfma_f32_16x16x32_bf16 v[144:147], v[184:187], v[40:43], v[144:147]
  ds_read_b64_tr_b16 v[216:217], v8 offset:12288
  v_mfma_f32_16x16x32_bf16 v[148:151], v[184:187], v[44:47], v[148:151]
  ds_read_b64_tr_b16 v[218:219], v8 offset:12800
  v_mfma_f32_16x16x32_bf16 v[156:159], v[188:191], v[44:47], v[156:159]
  ds_read_b64_tr_b16 v[220:221], v9 offset:12288
  v_mfma_f32_16x16x32_bf16 v[152:155], v[188:191], v[40:43], v[152:155]
  ds_read_b64_tr_b16 v[222:223], v9 offset:12800
  s_waitcnt lgkmcnt(8)
  v_mfma_f32_16x16x32_bf16 v[96:99], v[192:195], v[32:35], v[96:99]
  ds_read_b64_tr_b16 v[160:161], v6 offset:16384
  v_mfma_f32_16x16x32_bf16 v[100:103], v[192:195], v[36:39], v[100:103]
  ds_read_b64_tr_b16 v[162:163], v6 offset:16896
  v_mfma_f32_16x16x32_bf16 v[108:111], v[196:199], v[36:39], v[108:111]
  ds_read_b64_tr_b16 v[164:165], v7 offset:16384
  v_mfma_f32_16x16x32_bf16 v[104:107], v[196:199], v[32:35], v[104:107]
  ds_read_b64_tr_b16 v[166:167], v7 offset:16896
  v_mfma_f32_16x16x32_bf16 v[112:115], v[200:203], v[32:35], v[112:115]
  ds_read_b64_tr_b16 v[168:169], v8 offset:16384
  v_mfma_f32_16x16x32_bf16 v[116:119], v[200:203], v[36:39], v[116:119]
  ds_read_b64_tr_b16 v[170:171], v8 offset:16896
  v_mfma_f32_16x16x32_bf16 v[124:127], v[204:207], v[36:39], v[124:127]
  ds_read_b64_tr_b16 v[172:173], v9 offset:16384
  v_mfma_f32_16x16x32_bf16 v[120:123], v[204:207], v[32:35], v[120:123]
  ds_read_b64_tr_b16 v[174:175], v9 offset:16896
  s_waitcnt lgkmcnt(8)
  v_mfma_f32_16x16x32_bf16 v[96:99], v[208:211], v[40:43], v[96:99]
  ds_read_b64_tr_b16 v[176:177], v6 offset:20480
  v_mfma_f32_16x16x32_bf16 v[100:103], v[208:211], v[44:47], v[100:103]
  ds_read_b64_tr_b16 v[178:179], v6 offset:20992
  v_mfma_f32_16x16x32_bf16 v[108:111], v[212:215], v[44:47], v[108:111]
  ds_read_b64_tr_b16 v[180:181], v7 offset:20480
  v_mfma_f32_16x16x32_bf16 v[104:107], v[212:215], v[40:43], v[104:107]
  ds_read_b64_tr_b16 v[182:183], v7 offset:20992
  v_mfma_f32_16x16x32_bf16 v[112:115], v[216:219], v[40:43], v[112:115]
  ds_read_b64_tr_b16 v[184:185], v8 offset:20480
  v_mfma_f32_16x16x32_bf16 v[116:119], v[216:219], v[44:47], v[116:119]
  ds_read_b64_tr_b16 v[186:187], v8 offset:20992
  v_mfma_f32_16x16x32_bf16 v[124:127], v[220:223], v[44:47], v[124:127]
  ds_read_b64_tr_b16 v[188:189], v9 offset:20480
  v_mfma_f32_16x16x32_bf16 v[120:123], v[220:223], v[40:43], v[120:123]
  ds_read_b64_tr_b16 v[190:191], v9 offset:20992
  s_waitcnt lgkmcnt(8)
  v_mfma_f32_16x16x32_bf16 v[128:131], v[160:163], v[48:51], v[128:131]
  ds_read_b64_tr_b16 v[192:193], v6 offset:24576
  v_mfma_f32_16x16x32_bf16 v[132:135], v[160:163], v[52:55], v[132:135]
  ds_read_b64_tr_b16 v[194:195], v6 offset:25088
  v_mfma_f32_16x16x32_bf16 v[140:143], v[164:167], v[52:55], v[140:143]
  ds_read_b64_tr_b16 v[196:197], v7 offset:24576
  v_mfma_f32_16x16x32_bf16 v[136:139], v[164:167], v[48:51], v[136:139]
  ds_read_b64_tr_b16 v[198:199], v7 offset:25088
  v_mfma_f32_16x16x32_bf16 v[144:147], v[168:171], v[48:51], v[144:147]
  ds_read_b64_tr_b16 v[200:201], v8 offset:24576
  v_mfma_f32_16x16x32_bf16 v[148:151], v[168:171], v[52:55], v[148:151]
  ds_read_b64_tr_b16 v[202:203], v8 offset:25088
  v_mfma_f32_16x16x32_bf16 v[156:159], v[172:175], v[52:55], v[156:159]
  ds_read_b64_tr_b16 v[204:205], v9 offset:24576
  v_mfma_f32_16x16x32_bf16 v[152:155], v[172:175], v[48:51], v[152:155]
  ds_read_b64_tr_b16 v[206:207], v9 offset:25088
  s_waitcnt lgkmcnt(8)
  s_barrier
  buffer_load_dwordx4 v[80:83], off, s[36:39], s51 offset:0
  buffer_load_dwordx4 v[84:87], off, s[64:67], s51 offset:0
  buffer_load_dwordx4 v[88:91], off, s[36:39], s51 offset:1024
  buffer_load_dwordx4 v[92:95], off, s[64:67], s51 offset:1024
  buffer_load_dwordx4 v[224:227], off, s[36:39], s48 offset:0
  buffer_load_dwordx4 v[228:231], off, s[64:67], s48 offset:0
  buffer_load_dwordx4 v[232:235], off, s[36:39], s48 offset:1024
  buffer_load_dwordx4 v[236:239], off, s[64:67], s48 offset:1024
  buffer_load_dwordx4 v[240:243], off, s[36:39], s49 offset:0
  buffer_load_dwordx4 v[244:247], off, s[64:67], s49 offset:0
  buffer_load_dwordx4 v[248:251], off, s[36:39], s49 offset:1024
  buffer_load_dwordx4 v[252:255], off, s[64:67], s49 offset:1024
  v_mfma_f32_16x16x32_bf16 v[128:131], v[176:179], v[56:59], v[128:131]
  ds_read_b64_tr_b16 v[208:209], v6 offset:28672
  v_readlane_b32 s50, v15, 6
  v_mfma_f32_16x16x32_bf16 v[132:135], v[176:179], v[60:63], v[132:135]
  ds_read_b64_tr_b16 v[210:211], v6 offset:29184
  v_mfma_f32_16x16x32_bf16 v[140:143], v[180:183], v[60:63], v[140:143]
  ds_read_b64_tr_b16 v[212:213], v7 offset:28672
  v_mfma_f32_16x16x32_bf16 v[136:139], v[180:183], v[56:59], v[136:139]
  buffer_load_dwordx4 v[32:35], off, s[36:39], s50 offset:0
  v_mfma_f32_16x16x32_bf16 v[144:147], v[184:187], v[56:59], v[144:147]
  ds_read_b64_tr_b16 v[214:215], v7 offset:29184
  ds_read_b64_tr_b16 v[216:217], v8 offset:28672
  v_mfma_f32_16x16x32_bf16 v[148:151], v[184:187], v[60:63], v[148:151]
  ds_read_b64_tr_b16 v[218:219], v8 offset:29184
  ds_read_b64_tr_b16 v[220:221], v9 offset:28672
  v_mfma_f32_16x16x32_bf16 v[156:159], v[188:191], v[60:63], v[156:159]
  buffer_load_dwordx4 v[36:39], off, s[64:67], s50 offset:0
  v_mfma_f32_16x16x32_bf16 v[152:155], v[188:191], v[56:59], v[152:155]
  ds_read_b64_tr_b16 v[222:223], v9 offset:29184
  s_waitcnt lgkmcnt(8)
  v_mfma_f32_16x16x32_bf16 v[96:99], v[192:195], v[48:51], v[96:99]
  ds_read_b64_tr_b16 v[160:161], v6 offset:32768
  v_mfma_f32_16x16x32_bf16 v[100:103], v[192:195], v[52:55], v[100:103]
  buffer_load_dwordx4 v[40:43], off, s[36:39], s50 offset:1024
  v_mfma_f32_16x16x32_bf16 v[108:111], v[196:199], v[52:55], v[108:111]
  ds_read_b64_tr_b16 v[162:163], v6 offset:33280
  ds_read_b64_tr_b16 v[164:165], v7 offset:32768
  v_mfma_f32_16x16x32_bf16 v[104:107], v[196:199], v[48:51], v[104:107]
  ds_read_b64_tr_b16 v[166:167], v7 offset:33280
  v_mfma_f32_16x16x32_bf16 v[112:115], v[200:203], v[48:51], v[112:115]
  buffer_load_dwordx4 v[44:47], off, s[64:67], s50 offset:1024
  v_mfma_f32_16x16x32_bf16 v[116:119], v[200:203], v[52:55], v[116:119]
  ds_read_b64_tr_b16 v[168:169], v8 offset:32768
  ds_read_b64_tr_b16 v[170:171], v8 offset:33280
  v_mfma_f32_16x16x32_bf16 v[124:127], v[204:207], v[52:55], v[124:127]
  ds_read_b64_tr_b16 v[172:173], v9 offset:32768
  v_mfma_f32_16x16x32_bf16 v[120:123], v[204:207], v[48:51], v[120:123]
  ds_read_b64_tr_b16 v[174:175], v9 offset:33280
  s_waitcnt lgkmcnt(8)
  v_mfma_f32_16x16x32_bf16 v[96:99], v[208:211], v[56:59], v[96:99]
  ds_read_b64_tr_b16 v[176:177], v6 offset:36864
  v_mfma_f32_16x16x32_bf16 v[100:103], v[208:211], v[60:63], v[100:103]
  ds_read_b64_tr_b16 v[178:179], v6 offset:37376
  v_mfma_f32_16x16x32_bf16 v[108:111], v[212:215], v[60:63], v[108:111]
  ds_read_b64_tr_b16 v[180:181], v7 offset:36864
  v_mfma_f32_16x16x32_bf16 v[104:107], v[212:215], v[56:59], v[104:107]
  ds_read_b64_tr_b16 v[182:183], v7 offset:37376
  v_mfma_f32_16x16x32_bf16 v[112:115], v[216:219], v[56:59], v[112:115]
  ds_read_b64_tr_b16 v[184:185], v8 offset:36864
  v_mfma_f32_16x16x32_bf16 v[116:119], v[216:219], v[60:63], v[116:119]
  ds_read_b64_tr_b16 v[186:187], v8 offset:37376
  v_readlane_b32 s51, v15, 7
  v_mfma_f32_16x16x32_bf16 v[124:127], v[220:223], v[60:63], v[124:127]
  ds_read_b64_tr_b16 v[188:189], v9 offset:36864
  v_mfma_f32_16x16x32_bf16 v[120:123], v[220:223], v[56:59], v[120:123]
  ds_read_b64_tr_b16 v[190:191], v9 offset:37376
  s_waitcnt lgkmcnt(8)
  v_mfma_f32_16x16x32_bf16 v[128:131], v[160:163], v[64:67], v[128:131]
  buffer_load_dwordx4 v[48:51], off, s[36:39], s51 offset:0
  v_mfma_f32_16x16x32_bf16 v[132:135], v[160:163], v[68:71], v[132:135]
  ds_read_b64_tr_b16 v[192:193], v6 offset:40960
  ds_read_b64_tr_b16 v[194:195], v6 offset:41472
  v_mfma_f32_16x16x32_bf16 v[140:143], v[164:167], v[68:71], v[140:143]
  ds_read_b64_tr_b16 v[196:197], v7 offset:40960
  v_mfma_f32_16x16x32_bf16 v[136:139], v[164:167], v[64:67], v[136:139]
  buffer_load_dwordx4 v[52:55], off, s[64:67], s51 offset:0
  v_mfma_f32_16x16x32_bf16 v[144:147], v[168:171], v[64:67], v[144:147]
  ds_read_b64_tr_b16 v[198:199], v7 offset:41472
  ds_read_b64_tr_b16 v[200:201], v8 offset:40960
  v_mfma_f32_16x16x32_bf16 v[148:151], v[168:171], v[68:71], v[148:151]
  ds_read_b64_tr_b16 v[202:203], v8 offset:41472
  ds_read_b64_tr_b16 v[204:205], v9 offset:40960
  v_mfma_f32_16x16x32_bf16 v[156:159], v[172:175], v[68:71], v[156:159]
  buffer_load_dwordx4 v[56:59], off, s[36:39], s51 offset:1024
  v_mfma_f32_16x16x32_bf16 v[152:155], v[172:175], v[64:67], v[152:155]
  ds_read_b64_tr_b16 v[206:207], v9 offset:41472
  s_waitcnt lgkmcnt(8)
  v_mfma_f32_16x16x32_bf16 v[128:131], v[176:179], v[72:75], v[128:131]
  ds_read_b64_tr_b16 v[208:209], v6 offset:45056
  v_mfma_f32_16x16x32_bf16 v[132:135], v[176:179], v[76:79], v[132:135]
  buffer_load_dwordx4 v[60:63], off, s[64:67], s51 offset:1024
  v_mfma_f32_16x16x32_bf16 v[140:143], v[180:183], v[76:79], v[140:143]
  ds_read_b64_tr_b16 v[210:211], v6 offset:45568
  ds_read_b64_tr_b16 v[212:213], v7 offset:45056
  v_mfma_f32_16x16x32_bf16 v[136:139], v[180:183], v[72:75], v[136:139]
  ds_read_b64_tr_b16 v[214:215], v7 offset:45568
  v_mfma_f32_16x16x32_bf16 v[144:147], v[184:187], v[72:75], v[144:147]
  ds_read_b64_tr_b16 v[216:217], v8 offset:45056
  v_mfma_f32_16x16x32_bf16 v[148:151], v[184:187], v[76:79], v[148:151]
  ds_read_b64_tr_b16 v[218:219], v8 offset:45568
  v_mfma_f32_16x16x32_bf16 v[156:159], v[188:191], v[76:79], v[156:159]
  ds_read_b64_tr_b16 v[220:221], v9 offset:45056
  v_mfma_f32_16x16x32_bf16 v[152:155], v[188:191], v[72:75], v[152:155]
  ds_read_b64_tr_b16 v[222:223], v9 offset:45568
  s_waitcnt lgkmcnt(8)
  v_mfma_f32_16x16x32_bf16 v[96:99], v[192:195], v[64:67], v[96:99]
  ds_read_b64_tr_b16 v[160:161], v6 offset:49152
  v_mfma_f32_16x16x32_bf16 v[100:103], v[192:195], v[68:71], v[100:103]
  ds_read_b64_tr_b16 v[162:163], v6 offset:49664
  v_mfma_f32_16x16x32_bf16 v[108:111], v[196:199], v[68:71], v[108:111]
  ds_read_b64_tr_b16 v[164:165], v7 offset:49152
  v_mfma_f32_16x16x32_bf16 v[104:107], v[196:199], v[64:67], v[104:107]
  ds_read_b64_tr_b16 v[166:167], v7 offset:49664
  v_mfma_f32_16x16x32_bf16 v[112:115], v[200:203], v[64:67], v[112:115]
  ds_read_b64_tr_b16 v[168:169], v8 offset:49152
  v_mfma_f32_16x16x32_bf16 v[116:119], v[200:203], v[68:71], v[116:119]
  ds_read_b64_tr_b16 v[170:171], v8 offset:49664
  v_mfma_f32_16x16x32_bf16 v[124:127], v[204:207], v[68:71], v[124:127]
  ds_read_b64_tr_b16 v[172:173], v9 offset:49152
  v_mfma_f32_16x16x32_bf16 v[120:123], v[204:207], v[64:67], v[120:123]
  ds_read_b64_tr_b16 v[174:175], v9 offset:49664
  s_waitcnt lgkmcnt(8)
  v_mfma_f32_16x16x32_bf16 v[96:99], v[208:211], v[72:75], v[96:99]
  ds_read_b64_tr_b16 v[176:177], v6 offset:53248
  v_mfma_f32_16x16x32_bf16 v[100:103], v[208:211], v[76:79], v[100:103]
  ds_read_b64_tr_b16 v[178:179], v6 offset:53760
  v_mfma_f32_16x16x32_bf16 v[108:111], v[212:215], v[76:79], v[108:111]
  ds_read_b64_tr_b16 v[180:181], v7 offset:53248
  v_mfma_f32_16x16x32_bf16 v[104:107], v[212:215], v[72:75], v[104:107]
  ds_read_b64_tr_b16 v[182:183], v7 offset:53760
  v_mfma_f32_16x16x32_bf16 v[112:115], v[216:219], v[72:75], v[112:115]
  ds_read_b64_tr_b16 v[184:185], v8 offset:53248
  v_mfma_f32_16x16x32_bf16 v[116:119], v[216:219], v[76:79], v[116:119]
  ds_read_b64_tr_b16 v[186:187], v8 offset:53760
  v_readlane_b32 s48, v15, 8
  v_mfma_f32_16x16x32_bf16 v[124:127], v[220:223], v[76:79], v[124:127]
  ds_read_b64_tr_b16 v[188:189], v9 offset:53248
  v_mfma_f32_16x16x32_bf16 v[120:123], v[220:223], v[72:75], v[120:123]
  ds_read_b64_tr_b16 v[190:191], v9 offset:53760
  s_waitcnt vmcnt(18) lgkmcnt(8)
  v_mfma_f32_16x16x32_bf16 v[128:131], v[160:163], v[80:83], v[128:131]
  buffer_load_dwordx4 v[64:67], off, s[36:39], s48 offset:0
  v_mfma_f32_16x16x32_bf16 v[132:135], v[160:163], v[84:87], v[132:135]
  ds_read_b64_tr_b16 v[192:193], v6 offset:57344
  ds_read_b64_tr_b16 v[194:195], v6 offset:57856
  v_mfma_f32_16x16x32_bf16 v[140:143], v[164:167], v[84:87], v[140:143]
  ds_read_b64_tr_b16 v[196:197], v7 offset:57344
  v_mfma_f32_16x16x32_bf16 v[136:139], v[164:167], v[80:83], v[136:139]
  ds_read_b64_tr_b16 v[198:199], v7 offset:57856
  v_mfma_f32_16x16x32_bf16 v[144:147], v[168:171], v[80:83], v[144:147]
  ds_read_b64_tr_b16 v[200:201], v8 offset:57344
  v_mfma_f32_16x16x32_bf16 v[148:151], v[168:171], v[84:87], v[148:151]
  ds_read_b64_tr_b16 v[202:203], v8 offset:57856
  v_mfma_f32_16x16x32_bf16 v[156:159], v[172:175], v[84:87], v[156:159]
  ds_read_b64_tr_b16 v[204:205], v9 offset:57344
  v_mfma_f32_16x16x32_bf16 v[152:155], v[172:175], v[80:83], v[152:155]
  ds_read_b64_tr_b16 v[206:207], v9 offset:57856
  s_waitcnt vmcnt(17) lgkmcnt(8)
  v_mfma_f32_16x16x32_bf16 v[128:131], v[176:179], v[88:91], v[128:131]
  buffer_load_dwordx4 v[68:71], off, s[64:67], s48 offset:0
  v_mfma_f32_16x16x32_bf16 v[132:135], v[176:179], v[92:95], v[132:135]
  ds_read_b64_tr_b16 v[208:209], v6 offset:61440
  ds_read_b64_tr_b16 v[210:211], v6 offset:61952
  v_mfma_f32_16x16x32_bf16 v[140:143], v[180:183], v[92:95], v[140:143]
  ds_read_b64_tr_b16 v[212:213], v7 offset:61440
  v_mfma_f32_16x16x32_bf16 v[136:139], v[180:183], v[88:91], v[136:139]
  ds_read_b64_tr_b16 v[214:215], v7 offset:61952
  v_mfma_f32_16x16x32_bf16 v[144:147], v[184:187], v[88:91], v[144:147]
  ds_read_b64_tr_b16 v[216:217], v8 offset:61440
  v_mfma_f32_16x16x32_bf16 v[148:151], v[184:187], v[92:95], v[148:151]
  ds_read_b64_tr_b16 v[218:219], v8 offset:61952
  v_mfma_f32_16x16x32_bf16 v[156:159], v[188:191], v[92:95], v[156:159]
  ds_read_b64_tr_b16 v[220:221], v9 offset:61440
  v_mfma_f32_16x16x32_bf16 v[152:155], v[188:191], v[88:91], v[152:155]
  ds_read_b64_tr_b16 v[222:223], v9 offset:61952
  s_waitcnt lgkmcnt(8)
  v_mfma_f32_16x16x32_bf16 v[96:99], v[192:195], v[80:83], v[96:99]
  buffer_load_dwordx4 v[72:75], off, s[36:39], s48 offset:1024
  v_mfma_f32_16x16x32_bf16 v[100:103], v[192:195], v[84:87], v[100:103]
  ds_read_b64_tr_b16 v[160:161], v20 offset:0
  ds_read_b64_tr_b16 v[162:163], v20 offset:512
  v_mfma_f32_16x16x32_bf16 v[108:111], v[196:199], v[84:87], v[108:111]
  ds_read_b64_tr_b16 v[164:165], v21 offset:0
  v_mfma_f32_16x16x32_bf16 v[104:107], v[196:199], v[80:83], v[104:107]
  ds_read_b64_tr_b16 v[166:167], v21 offset:512
  v_mfma_f32_16x16x32_bf16 v[112:115], v[200:203], v[80:83], v[112:115]
  ds_read_b64_tr_b16 v[168:169], v22 offset:0
  v_mfma_f32_16x16x32_bf16 v[116:119], v[200:203], v[84:87], v[116:119]
  ds_read_b64_tr_b16 v[170:171], v22 offset:512
  v_mfma_f32_16x16x32_bf16 v[124:127], v[204:207], v[84:87], v[124:127]
  ds_read_b64_tr_b16 v[172:173], v23 offset:0
  v_mfma_f32_16x16x32_bf16 v[120:123], v[204:207], v[80:83], v[120:123]
  ds_read_b64_tr_b16 v[174:175], v23 offset:512
  s_waitcnt lgkmcnt(8)
  s_barrier
  v_mfma_f32_16x16x32_bf16 v[96:99], v[208:211], v[88:91], v[96:99]
  buffer_load_dwordx4 v[76:79], off, s[64:67], s48 offset:1024
  v_mfma_f32_16x16x32_bf16 v[100:103], v[208:211], v[92:95], v[100:103]
  ds_read_b64_tr_b16 v[176:177], v20 offset:4096
  ds_read_b64_tr_b16 v[178:179], v20 offset:4608
  v_mfma_f32_16x16x32_bf16 v[108:111], v[212:215], v[92:95], v[108:111]
  ds_read_b64_tr_b16 v[180:181], v21 offset:4096
  v_mfma_f32_16x16x32_bf16 v[104:107], v[212:215], v[88:91], v[104:107]
  ds_read_b64_tr_b16 v[182:183], v21 offset:4608
  v_mfma_f32_16x16x32_bf16 v[112:115], v[216:219], v[88:91], v[112:115]
  ds_read_b64_tr_b16 v[184:185], v22 offset:4096
  v_mfma_f32_16x16x32_bf16 v[116:119], v[216:219], v[92:95], v[116:119]
  ds_read_b64_tr_b16 v[186:187], v22 offset:4608
  v_readlane_b32 s49, v15, 9
  v_mfma_f32_16x16x32_bf16 v[124:127], v[220:223], v[92:95], v[124:127]
  ds_read_b64_tr_b16 v[188:189], v23 offset:4096
  v_mfma_f32_16x16x32_bf16 v[120:123], v[220:223], v[88:91], v[120:123]
  ds_read_b64_tr_b16 v[190:191], v23 offset:4608
  s_waitcnt vmcnt(18) lgkmcnt(8)
  v_mfma_f32_16x16x32_bf16 v[128:131], v[160:163], v[224:227], v[128:131]
  buffer_load_dwordx4 v[80:83], off, s[36:39], s49 offset:0
  v_mfma_f32_16x16x32_bf16 v[132:135], v[160:163], v[228:231], v[132:135]
  ds_read_b64_tr_b16 v[192:193], v20 offset:8192
  ds_read_b64_tr_b16 v[194:195], v20 offset:8704
  v_mfma_f32_16x16x32_bf16 v[140:143], v[164:167], v[228:231], v[140:143]
  ds_read_b64_tr_b16 v[196:197], v21 offset:8192
  v_mfma_f32_16x16x32_bf16 v[136:139], v[164:167], v[224:227], v[136:139]
  ds_read_b64_tr_b16 v[198:199], v21 offset:8704
  v_mfma_f32_16x16x32_bf16 v[144:147], v[168:171], v[224:227], v[144:147]
  ds_read_b64_tr_b16 v[200:201], v22 offset:8192
  v_mfma_f32_16x16x32_bf16 v[148:151], v[168:171], v[228:231], v[148:151]
  ds_read_b64_tr_b16 v[202:203], v22 offset:8704
  v_mfma_f32_16x16x32_bf16 v[156:159], v[172:175], v[228:231], v[156:159]
  ds_read_b64_tr_b16 v[204:205], v23 offset:8192
  v_mfma_f32_16x16x32_bf16 v[152:155], v[172:175], v[224:227], v[152:155]
  ds_read_b64_tr_b16 v[206:207], v23 offset:8704
  s_waitcnt vmcnt(17) lgkmcnt(8)
  v_mfma_f32_16x16x32_bf16 v[128:131], v[176:179], v[232:235], v[128:131]
  buffer_load_dwordx4 v[84:87], off, s[64:67], s49 offset:0
  v_mfma_f32_16x16x32_bf16 v[132:135], v[176:179], v[236:239], v[132:135]
  ds_read_b64_tr_b16 v[208:209], v20 offset:12288
  ds_read_b64_tr_b16 v[210:211], v20 offset:12800
  v_mfma_f32_16x16x32_bf16 v[140:143], v[180:183], v[236:239], v[140:143]
  ds_read_b64_tr_b16 v[212:213], v21 offset:12288
  v_mfma_f32_16x16x32_bf16 v[136:139], v[180:183], v[232:235], v[136:139]
  ds_read_b64_tr_b16 v[214:215], v21 offset:12800
  v_mfma_f32_16x16x32_bf16 v[144:147], v[184:187], v[232:235], v[144:147]
  ds_read_b64_tr_b16 v[216:217], v22 offset:12288
  v_mfma_f32_16x16x32_bf16 v[148:151], v[184:187], v[236:239], v[148:151]
  ds_read_b64_tr_b16 v[218:219], v22 offset:12800
  v_mfma_f32_16x16x32_bf16 v[156:159], v[188:191], v[236:239], v[156:159]
  ds_read_b64_tr_b16 v[220:221], v23 offset:12288
  v_mfma_f32_16x16x32_bf16 v[152:155], v[188:191], v[232:235], v[152:155]
  ds_read_b64_tr_b16 v[222:223], v23 offset:12800
  s_waitcnt lgkmcnt(8)
  v_mfma_f32_16x16x32_bf16 v[96:99], v[192:195], v[224:227], v[96:99]
  buffer_load_dwordx4 v[88:91], off, s[36:39], s49 offset:1024
  v_mfma_f32_16x16x32_bf16 v[100:103], v[192:195], v[228:231], v[100:103]
  ds_read_b64_tr_b16 v[160:161], v20 offset:16384
  ds_read_b64_tr_b16 v[162:163], v20 offset:16896
  v_mfma_f32_16x16x32_bf16 v[108:111], v[196:199], v[228:231], v[108:111]
  ds_read_b64_tr_b16 v[164:165], v21 offset:16384
  v_mfma_f32_16x16x32_bf16 v[104:107], v[196:199], v[224:227], v[104:107]
  ds_read_b64_tr_b16 v[166:167], v21 offset:16896
  v_mfma_f32_16x16x32_bf16 v[112:115], v[200:203], v[224:227], v[112:115]
  ds_read_b64_tr_b16 v[168:169], v22 offset:16384
  v_mfma_f32_16x16x32_bf16 v[116:119], v[200:203], v[228:231], v[116:119]
  ds_read_b64_tr_b16 v[170:171], v22 offset:16896
  v_mfma_f32_16x16x32_bf16 v[124:127], v[204:207], v[228:231], v[124:127]
  ds_read_b64_tr_b16 v[172:173], v23 offset:16384
  v_mfma_f32_16x16x32_bf16 v[120:123], v[204:207], v[224:227], v[120:123]
  ds_read_b64_tr_b16 v[174:175], v23 offset:16896
  s_waitcnt lgkmcnt(8)
  v_mfma_f32_16x16x32_bf16 v[96:99], v[208:211], v[232:235], v[96:99]
  buffer_load_dwordx4 v[92:95], off, s[64:67], s49 offset:1024
  v_mfma_f32_16x16x32_bf16 v[100:103], v[208:211], v[236:239], v[100:103]
  ds_read_b64_tr_b16 v[176:177], v20 offset:20480
  ds_read_b64_tr_b16 v[178:179], v20 offset:20992
  v_mfma_f32_16x16x32_bf16 v[108:111], v[212:215], v[236:239], v[108:111]
  ds_read_b64_tr_b16 v[180:181], v21 offset:20480
  v_mfma_f32_16x16x32_bf16 v[104:107], v[212:215], v[232:235], v[104:107]
  ds_read_b64_tr_b16 v[182:183], v21 offset:20992
  v_mfma_f32_16x16x32_bf16 v[112:115], v[216:219], v[232:235], v[112:115]
  ds_read_b64_tr_b16 v[184:185], v22 offset:20480
  v_mfma_f32_16x16x32_bf16 v[116:119], v[216:219], v[236:239], v[116:119]
  ds_read_b64_tr_b16 v[186:187], v22 offset:20992
  v_readlane_b32 s50, v15, 10
  v_mfma_f32_16x16x32_bf16 v[124:127], v[220:223], v[236:239], v[124:127]
  ds_read_b64_tr_b16 v[188:189], v23 offset:20480
  v_mfma_f32_16x16x32_bf16 v[120:123], v[220:223], v[232:235], v[120:123]
  ds_read_b64_tr_b16 v[190:191], v23 offset:20992
  s_waitcnt vmcnt(18) lgkmcnt(8)
  v_mfma_f32_16x16x32_bf16 v[128:131], v[160:163], v[240:243], v[128:131]
  buffer_load_dwordx4 v[224:227], off, s[36:39], s50 offset:0
  v_mfma_f32_16x16x32_bf16 v[132:135], v[160:163], v[244:247], v[132:135]
  ds_read_b64_tr_b16 v[192:193], v20 offset:24576
  ds_read_b64_tr_b16 v[194:195], v20 offset:25088
  v_mfma_f32_16x16x32_bf16 v[140:143], v[164:167], v[244:247], v[140:143]
  ds_read_b64_tr_b16 v[196:197], v21 offset:24576
  v_mfma_f32_16x16x32_bf16 v[136:139], v[164:167], v[240:243], v[136:139]
  ds_read_b64_tr_b16 v[198:199], v21 offset:25088
  v_mfma_f32_16x16x32_bf16 v[144:147], v[168:171], v[240:243], v[144:147]
  ds_read_b64_tr_b16 v[200:201], v22 offset:24576
  v_mfma_f32_16x16x32_bf16 v[148:151], v[168:171], v[244:247], v[148:151]
  ds_read_b64_tr_b16 v[202:203], v22 offset:25088
  v_mfma_f32_16x16x32_bf16 v[156:159], v[172:175], v[244:247], v[156:159]
  ds_read_b64_tr_b16 v[204:205], v23 offset:24576
  v_mfma_f32_16x16x32_bf16 v[152:155], v[172:175], v[240:243], v[152:155]
  ds_read_b64_tr_b16 v[206:207], v23 offset:25088
  s_waitcnt vmcnt(17) lgkmcnt(8)
  v_mfma_f32_16x16x32_bf16 v[128:131], v[176:179], v[248:251], v[128:131]
  buffer_load_dwordx4 v[228:231], off, s[64:67], s50 offset:0
  v_mfma_f32_16x16x32_bf16 v[132:135], v[176:179], v[252:255], v[132:135]
  ds_read_b64_tr_b16 v[208:209], v20 offset:28672
  ds_read_b64_tr_b16 v[210:211], v20 offset:29184
  v_mfma_f32_16x16x32_bf16 v[140:143], v[180:183], v[252:255], v[140:143]
  ds_read_b64_tr_b16 v[212:213], v21 offset:28672
  v_mfma_f32_16x16x32_bf16 v[136:139], v[180:183], v[248:251], v[136:139]
  ds_read_b64_tr_b16 v[214:215], v21 offset:29184
  v_mfma_f32_16x16x32_bf16 v[144:147], v[184:187], v[248:251], v[144:147]
  ds_read_b64_tr_b16 v[216:217], v22 offset:28672
  v_mfma_f32_16x16x32_bf16 v[148:151], v[184:187], v[252:255], v[148:151]
  ds_read_b64_tr_b16 v[218:219], v22 offset:29184
  v_mfma_f32_16x16x32_bf16 v[156:159], v[188:191], v[252:255], v[156:159]
  ds_read_b64_tr_b16 v[220:221], v23 offset:28672
  v_mfma_f32_16x16x32_bf16 v[152:155], v[188:191], v[248:251], v[152:155]
  ds_read_b64_tr_b16 v[222:223], v23 offset:29184
  s_waitcnt lgkmcnt(8)
  v_mfma_f32_16x16x32_bf16 v[96:99], v[192:195], v[240:243], v[96:99]
  buffer_load_dwordx4 v[232:235], off, s[36:39], s50 offset:1024
  v_mfma_f32_16x16x32_bf16 v[100:103], v[192:195], v[244:247], v[100:103]
  ds_read_b64_tr_b16 v[160:161], v20 offset:32768
  ds_read_b64_tr_b16 v[162:163], v20 offset:33280
  v_mfma_f32_16x16x32_bf16 v[108:111], v[196:199], v[244:247], v[108:111]
  ds_read_b64_tr_b16 v[164:165], v21 offset:32768
  v_mfma_f32_16x16x32_bf16 v[104:107], v[196:199], v[240:243], v[104:107]
  ds_read_b64_tr_b16 v[166:167], v21 offset:33280
  v_mfma_f32_16x16x32_bf16 v[112:115], v[200:203], v[240:243], v[112:115]
  ds_read_b64_tr_b16 v[168:169], v22 offset:32768
  v_mfma_f32_16x16x32_bf16 v[116:119], v[200:203], v[244:247], v[116:119]
  ds_read_b64_tr_b16 v[170:171], v22 offset:33280
  v_mfma_f32_16x16x32_bf16 v[124:127], v[204:207], v[244:247], v[124:127]
  ds_read_b64_tr_b16 v[172:173], v23 offset:32768
  v_mfma_f32_16x16x32_bf16 v[120:123], v[204:207], v[240:243], v[120:123]
  ds_read_b64_tr_b16 v[174:175], v23 offset:33280
  s_waitcnt lgkmcnt(8)
  s_barrier
  v_mfma_f32_16x16x32_bf16 v[96:99], v[208:211], v[248:251], v[96:99]
  buffer_load_dwordx4 v[236:239], off, s[64:67], s50 offset:1024
  v_mfma_f32_16x16x32_bf16 v[100:103], v[208:211], v[252:255], v[100:103]
  ds_read_b64_tr_b16 v[176:177], v20 offset:36864
  ds_read_b64_tr_b16 v[178:179], v20 offset:37376
  v_mfma_f32_16x16x32_bf16 v[108:111], v[212:215], v[252:255], v[108:111]
  ds_read_b64_tr_b16 v[180:181], v21 offset:36864
  v_mfma_f32_16x16x32_bf16 v[104:107], v[212:215], v[248:251], v[104:107]
  ds_read_b64_tr_b16 v[182:183], v21 offset:37376
  v_mfma_f32_16x16x32_bf16 v[112:115], v[216:219], v[248:251], v[112:115]
  ds_read_b64_tr_b16 v[184:185], v22 offset:36864
  v_mfma_f32_16x16x32_bf16 v[116:119], v[216:219], v[252:255], v[116:119]
  ds_read_b64_tr_b16 v[186:187], v22 offset:37376
  v_readlane_b32 s51, v15, 11
  v_mfma_f32_16x16x32_bf16 v[124:127], v[220:223], v[252:255], v[124:127]
  ds_read_b64_tr_b16 v[188:189], v23 offset:36864
  v_mfma_f32_16x16x32_bf16 v[120:123], v[220:223], v[248:251], v[120:123]
  ds_read_b64_tr_b16 v[190:191], v23 offset:37376
  s_waitcnt vmcnt(18) lgkmcnt(8)
  v_mfma_f32_16x16x32_bf16 v[128:131], v[160:163], v[32:35], v[128:131]
  buffer_load_dwordx4 v[240:243], off, s[36:39], s51 offset:0
  v_mfma_f32_16x16x32_bf16 v[132:135], v[160:163], v[36:39], v[132:135]
  ds_read_b64_tr_b16 v[192:193], v20 offset:40960
  ds_read_b64_tr_b16 v[194:195], v20 offset:41472
  v_mfma_f32_16x16x32_bf16 v[140:143], v[164:167], v[36:39], v[140:143]
  ds_read_b64_tr_b16 v[196:197], v21 offset:40960
  v_mfma_f32_16x16x32_bf16 v[136:139], v[164:167], v[32:35], v[136:139]
  ds_read_b64_tr_b16 v[198:199], v21 offset:41472
  v_mfma_f32_16x16x32_bf16 v[144:147], v[168:171], v[32:35], v[144:147]
  ds_read_b64_tr_b16 v[200:201], v22 offset:40960
  v_mfma_f32_16x16x32_bf16 v[148:151], v[168:171], v[36:39], v[148:151]
  ds_read_b64_tr_b16 v[202:203], v22 offset:41472
  v_mfma_f32_16x16x32_bf16 v[156:159], v[172:175], v[36:39], v[156:159]
  ds_read_b64_tr_b16 v[204:205], v23 offset:40960
  v_mfma_f32_16x16x32_bf16 v[152:155], v[172:175], v[32:35], v[152:155]
  ds_read_b64_tr_b16 v[206:207], v23 offset:41472
  s_waitcnt vmcnt(17) lgkmcnt(8)
  v_mfma_f32_16x16x32_bf16 v[128:131], v[176:179], v[40:43], v[128:131]
  buffer_load_dwordx4 v[244:247], off, s[64:67], s51 offset:0
  v_mfma_f32_16x16x32_bf16 v[132:135], v[176:179], v[44:47], v[132:135]
  ds_read_b64_tr_b16 v[208:209], v20 offset:45056
  ds_read_b64_tr_b16 v[210:211], v20 offset:45568
  v_mfma_f32_16x16x32_bf16 v[140:143], v[180:183], v[44:47], v[140:143]
  ds_read_b64_tr_b16 v[212:213], v21 offset:45056
  v_mfma_f32_16x16x32_bf16 v[136:139], v[180:183], v[40:43], v[136:139]
  ds_read_b64_tr_b16 v[214:215], v21 offset:45568
  v_mfma_f32_16x16x32_bf16 v[144:147], v[184:187], v[40:43], v[144:147]
  ds_read_b64_tr_b16 v[216:217], v22 offset:45056
  v_mfma_f32_16x16x32_bf16 v[148:151], v[184:187], v[44:47], v[148:151]
  ds_read_b64_tr_b16 v[218:219], v22 offset:45568
  v_mfma_f32_16x16x32_bf16 v[156:159], v[188:191], v[44:47], v[156:159]
  ds_read_b64_tr_b16 v[220:221], v23 offset:45056
  v_mfma_f32_16x16x32_bf16 v[152:155], v[188:191], v[40:43], v[152:155]
  ds_read_b64_tr_b16 v[222:223], v23 offset:45568
  s_waitcnt lgkmcnt(8)
  v_mfma_f32_16x16x32_bf16 v[96:99], v[192:195], v[32:35], v[96:99]
  buffer_load_dwordx4 v[248:251], off, s[36:39], s51 offset:1024
  v_mfma_f32_16x16x32_bf16 v[100:103], v[192:195], v[36:39], v[100:103]
  ds_read_b64_tr_b16 v[160:161], v20 offset:49152
  ds_read_b64_tr_b16 v[162:163], v20 offset:49664
  v_mfma_f32_16x16x32_bf16 v[108:111], v[196:199], v[36:39], v[108:111]
  ds_read_b64_tr_b16 v[164:165], v21 offset:49152
  v_mfma_f32_16x16x32_bf16 v[104:107], v[196:199], v[32:35], v[104:107]
  ds_read_b64_tr_b16 v[166:167], v21 offset:49664
  v_mfma_f32_16x16x32_bf16 v[112:115], v[200:203], v[32:35], v[112:115]
  ds_read_b64_tr_b16 v[168:169], v22 offset:49152
  v_mfma_f32_16x16x32_bf16 v[116:119], v[200:203], v[36:39], v[116:119]
  ds_read_b64_tr_b16 v[170:171], v22 offset:49664
  v_mfma_f32_16x16x32_bf16 v[124:127], v[204:207], v[36:39], v[124:127]
  ds_read_b64_tr_b16 v[172:173], v23 offset:49152
  v_mfma_f32_16x16x32_bf16 v[120:123], v[204:207], v[32:35], v[120:123]
  ds_read_b64_tr_b16 v[174:175], v23 offset:49664
  s_waitcnt lgkmcnt(8)
  v_mfma_f32_16x16x32_bf16 v[96:99], v[208:211], v[40:43], v[96:99]
  buffer_load_dwordx4 v[252:255], off, s[64:67], s51 offset:1024
  v_mfma_f32_16x16x32_bf16 v[100:103], v[208:211], v[44:47], v[100:103]
  ds_read_b64_tr_b16 v[176:177], v20 offset:53248
  ds_read_b64_tr_b16 v[178:179], v20 offset:53760
  v_mfma_f32_16x16x32_bf16 v[108:111], v[212:215], v[44:47], v[108:111]
  ds_read_b64_tr_b16 v[180:181], v21 offset:53248
  v_mfma_f32_16x16x32_bf16 v[104:107], v[212:215], v[40:43], v[104:107]
  ds_read_b64_tr_b16 v[182:183], v21 offset:53760
  v_mfma_f32_16x16x32_bf16 v[112:115], v[216:219], v[40:43], v[112:115]
  ds_read_b64_tr_b16 v[184:185], v22 offset:53248
  v_mfma_f32_16x16x32_bf16 v[116:119], v[216:219], v[44:47], v[116:119]
  ds_read_b64_tr_b16 v[186:187], v22 offset:53760
  v_readlane_b32 s48, v15, 12
  v_mfma_f32_16x16x32_bf16 v[124:127], v[220:223], v[44:47], v[124:127]
  ds_read_b64_tr_b16 v[188:189], v23 offset:53248
  v_mfma_f32_16x16x32_bf16 v[120:123], v[220:223], v[40:43], v[120:123]
  ds_read_b64_tr_b16 v[190:191], v23 offset:53760
  s_waitcnt vmcnt(18) lgkmcnt(8)
  v_mfma_f32_16x16x32_bf16 v[128:131], v[160:163], v[48:51], v[128:131]
  buffer_load_dwordx4 v[32:35], off, s[36:39], s48 offset:0
  v_mfma_f32_16x16x32_bf16 v[132:135], v[160:163], v[52:55], v[132:135]
  ds_read_b64_tr_b16 v[192:193], v20 offset:57344
  ds_read_b64_tr_b16 v[194:195], v20 offset:57856
  v_mfma_f32_16x16x32_bf16 v[140:143], v[164:167], v[52:55], v[140:143]
  ds_read_b64_tr_b16 v[196:197], v21 offset:57344
  v_mfma_f32_16x16x32_bf16 v[136:139], v[164:167], v[48:51], v[136:139]
  ds_read_b64_tr_b16 v[198:199], v21 offset:57856
  v_mfma_f32_16x16x32_bf16 v[144:147], v[168:171], v[48:51], v[144:147]
  ds_read_b64_tr_b16 v[200:201], v22 offset:57344
  v_mfma_f32_16x16x32_bf16 v[148:151], v[168:171], v[52:55], v[148:151]
  ds_read_b64_tr_b16 v[202:203], v22 offset:57856
  v_mfma_f32_16x16x32_bf16 v[156:159], v[172:175], v[52:55], v[156:159]
  ds_read_b64_tr_b16 v[204:205], v23 offset:57344
  v_mfma_f32_16x16x32_bf16 v[152:155], v[172:175], v[48:51], v[152:155]
  ds_read_b64_tr_b16 v[206:207], v23 offset:57856
  s_waitcnt vmcnt(17) lgkmcnt(8)
  v_mfma_f32_16x16x32_bf16 v[128:131], v[176:179], v[56:59], v[128:131]
  buffer_load_dwordx4 v[36:39], off, s[64:67], s48 offset:0
  v_mfma_f32_16x16x32_bf16 v[132:135], v[176:179], v[60:63], v[132:135]
  ds_read_b64_tr_b16 v[208:209], v20 offset:61440
  ds_read_b64_tr_b16 v[210:211], v20 offset:61952
  v_mfma_f32_16x16x32_bf16 v[140:143], v[180:183], v[60:63], v[140:143]
  ds_read_b64_tr_b16 v[212:213], v21 offset:61440
  v_mfma_f32_16x16x32_bf16 v[136:139], v[180:183], v[56:59], v[136:139]
  ds_read_b64_tr_b16 v[214:215], v21 offset:61952
  v_mfma_f32_16x16x32_bf16 v[144:147], v[184:187], v[56:59], v[144:147]
  ds_read_b64_tr_b16 v[216:217], v22 offset:61440
  v_mfma_f32_16x16x32_bf16 v[148:151], v[184:187], v[60:63], v[148:151]
  ds_read_b64_tr_b16 v[218:219], v22 offset:61952
  v_mfma_f32_16x16x32_bf16 v[156:159], v[188:191], v[60:63], v[156:159]
  ds_read_b64_tr_b16 v[220:221], v23 offset:61440
  v_mfma_f32_16x16x32_bf16 v[152:155], v[188:191], v[56:59], v[152:155]
  ds_read_b64_tr_b16 v[222:223], v23 offset:61952
  s_waitcnt lgkmcnt(8)
  v_mfma_f32_16x16x32_bf16 v[96:99], v[192:195], v[48:51], v[96:99]
  buffer_load_dwordx4 v[40:43], off, s[36:39], s48 offset:1024
  v_mfma_f32_16x16x32_bf16 v[100:103], v[192:195], v[52:55], v[100:103]
  ds_read_b64_tr_b16 v[160:161], v26 offset:0
  ds_read_b64_tr_b16 v[162:163], v26 offset:512
  v_mfma_f32_16x16x32_bf16 v[108:111], v[196:199], v[52:55], v[108:111]
  ds_read_b64_tr_b16 v[164:165], v27 offset:0
  v_mfma_f32_16x16x32_bf16 v[104:107], v[196:199], v[48:51], v[104:107]
  ds_read_b64_tr_b16 v[166:167], v27 offset:512
  v_mfma_f32_16x16x32_bf16 v[112:115], v[200:203], v[48:51], v[112:115]
  ds_read_b64_tr_b16 v[168:169], v28 offset:0
  v_mfma_f32_16x16x32_bf16 v[116:119], v[200:203], v[52:55], v[116:119]
  ds_read_b64_tr_b16 v[170:171], v28 offset:512
  v_mfma_f32_16x16x32_bf16 v[124:127], v[204:207], v[52:55], v[124:127]
  ds_read_b64_tr_b16 v[172:173], v29 offset:0
  v_mfma_f32_16x16x32_bf16 v[120:123], v[204:207], v[48:51], v[120:123]
  ds_read_b64_tr_b16 v[174:175], v29 offset:512
  s_waitcnt lgkmcnt(8)
  s_barrier
  v_mfma_f32_16x16x32_bf16 v[96:99], v[208:211], v[56:59], v[96:99]
  buffer_load_dwordx4 v[44:47], off, s[64:67], s48 offset:1024
  v_mfma_f32_16x16x32_bf16 v[100:103], v[208:211], v[60:63], v[100:103]
  ds_read_b64_tr_b16 v[176:177], v26 offset:4096
  ds_read_b64_tr_b16 v[178:179], v26 offset:4608
  v_mfma_f32_16x16x32_bf16 v[108:111], v[212:215], v[60:63], v[108:111]
  ds_read_b64_tr_b16 v[180:181], v27 offset:4096
  v_mfma_f32_16x16x32_bf16 v[104:107], v[212:215], v[56:59], v[104:107]
  ds_read_b64_tr_b16 v[182:183], v27 offset:4608
  v_mfma_f32_16x16x32_bf16 v[112:115], v[216:219], v[56:59], v[112:115]
  ds_read_b64_tr_b16 v[184:185], v28 offset:4096
  v_mfma_f32_16x16x32_bf16 v[116:119], v[216:219], v[60:63], v[116:119]
  ds_read_b64_tr_b16 v[186:187], v28 offset:4608
  v_readlane_b32 s49, v15, 13
  v_mfma_f32_16x16x32_bf16 v[124:127], v[220:223], v[60:63], v[124:127]
  ds_read_b64_tr_b16 v[188:189], v29 offset:4096
  v_mfma_f32_16x16x32_bf16 v[120:123], v[220:223], v[56:59], v[120:123]
  ds_read_b64_tr_b16 v[190:191], v29 offset:4608
  s_waitcnt vmcnt(18) lgkmcnt(8)
  v_mfma_f32_16x16x32_bf16 v[128:131], v[160:163], v[64:67], v[128:131]
  buffer_load_dwordx4 v[48:51], off, s[36:39], s49 offset:0
  v_mfma_f32_16x16x32_bf16 v[132:135], v[160:163], v[68:71], v[132:135]
  ds_read_b64_tr_b16 v[192:193], v26 offset:8192
  ds_read_b64_tr_b16 v[194:195], v26 offset:8704
  v_mfma_f32_16x16x32_bf16 v[140:143], v[164:167], v[68:71], v[140:143]
  ds_read_b64_tr_b16 v[196:197], v27 offset:8192
  v_mfma_f32_16x16x32_bf16 v[136:139], v[164:167], v[64:67], v[136:139]
  ds_read_b64_tr_b16 v[198:199], v27 offset:8704
  v_mfma_f32_16x16x32_bf16 v[144:147], v[168:171], v[64:67], v[144:147]
  ds_read_b64_tr_b16 v[200:201], v28 offset:8192
  v_mfma_f32_16x16x32_bf16 v[148:151], v[168:171], v[68:71], v[148:151]
  ds_read_b64_tr_b16 v[202:203], v28 offset:8704
  v_mfma_f32_16x16x32_bf16 v[156:159], v[172:175], v[68:71], v[156:159]
  ds_read_b64_tr_b16 v[204:205], v29 offset:8192
  v_mfma_f32_16x16x32_bf16 v[152:155], v[172:175], v[64:67], v[152:155]
  ds_read_b64_tr_b16 v[206:207], v29 offset:8704
  s_waitcnt vmcnt(17) lgkmcnt(8)
  v_mfma_f32_16x16x32_bf16 v[128:131], v[176:179], v[72:75], v[128:131]
  buffer_load_dwordx4 v[52:55], off, s[64:67], s49 offset:0
  v_mfma_f32_16x16x32_bf16 v[132:135], v[176:179], v[76:79], v[132:135]
  ds_read_b64_tr_b16 v[208:209], v26 offset:12288
  ds_read_b64_tr_b16 v[210:211], v26 offset:12800
  v_mfma_f32_16x16x32_bf16 v[140:143], v[180:183], v[76:79], v[140:143]
  ds_read_b64_tr_b16 v[212:213], v27 offset:12288
  v_mfma_f32_16x16x32_bf16 v[136:139], v[180:183], v[72:75], v[136:139]
  ds_read_b64_tr_b16 v[214:215], v27 offset:12800
  v_mfma_f32_16x16x32_bf16 v[144:147], v[184:187], v[72:75], v[144:147]
  ds_read_b64_tr_b16 v[216:217], v28 offset:12288
  v_mfma_f32_16x16x32_bf16 v[148:151], v[184:187], v[76:79], v[148:151]
  ds_read_b64_tr_b16 v[218:219], v28 offset:12800
  v_mfma_f32_16x16x32_bf16 v[156:159], v[188:191], v[76:79], v[156:159]
  ds_read_b64_tr_b16 v[220:221], v29 offset:12288
  v_mfma_f32_16x16x32_bf16 v[152:155], v[188:191], v[72:75], v[152:155]
  ds_read_b64_tr_b16 v[222:223], v29 offset:12800
  s_waitcnt lgkmcnt(8)
  v_mfma_f32_16x16x32_bf16 v[96:99], v[192:195], v[64:67], v[96:99]
  buffer_load_dwordx4 v[56:59], off, s[36:39], s49 offset:1024
  v_mfma_f32_16x16x32_bf16 v[100:103], v[192:195], v[68:71], v[100:103]
  ds_read_b64_tr_b16 v[160:161], v26 offset:16384
  ds_read_b64_tr_b16 v[162:163], v26 offset:16896
  v_mfma_f32_16x16x32_bf16 v[108:111], v[196:199], v[68:71], v[108:111]
  ds_read_b64_tr_b16 v[164:165], v27 offset:16384
  v_mfma_f32_16x16x32_bf16 v[104:107], v[196:199], v[64:67], v[104:107]
  ds_read_b64_tr_b16 v[166:167], v27 offset:16896
  v_mfma_f32_16x16x32_bf16 v[112:115], v[200:203], v[64:67], v[112:115]
  ds_read_b64_tr_b16 v[168:169], v28 offset:16384
  v_mfma_f32_16x16x32_bf16 v[116:119], v[200:203], v[68:71], v[116:119]
  ds_read_b64_tr_b16 v[170:171], v28 offset:16896
  v_mfma_f32_16x16x32_bf16 v[124:127], v[204:207], v[68:71], v[124:127]
  ds_read_b64_tr_b16 v[172:173], v29 offset:16384
  v_mfma_f32_16x16x32_bf16 v[120:123], v[204:207], v[64:67], v[120:123]
  ds_read_b64_tr_b16 v[174:175], v29 offset:16896
  s_waitcnt lgkmcnt(8)
  v_mfma_f32_16x16x32_bf16 v[96:99], v[208:211], v[72:75], v[96:99]
  buffer_load_dwordx4 v[60:63], off, s[64:67], s49 offset:1024
  v_mfma_f32_16x16x32_bf16 v[100:103], v[208:211], v[76:79], v[100:103]
  ds_read_b64_tr_b16 v[176:177], v26 offset:20480
  ds_read_b64_tr_b16 v[178:179], v26 offset:20992
  v_mfma_f32_16x16x32_bf16 v[108:111], v[212:215], v[76:79], v[108:111]
  ds_read_b64_tr_b16 v[180:181], v27 offset:20480
  v_mfma_f32_16x16x32_bf16 v[104:107], v[212:215], v[72:75], v[104:107]
  ds_read_b64_tr_b16 v[182:183], v27 offset:20992
  v_mfma_f32_16x16x32_bf16 v[112:115], v[216:219], v[72:75], v[112:115]
  ds_read_b64_tr_b16 v[184:185], v28 offset:20480
  v_mfma_f32_16x16x32_bf16 v[116:119], v[216:219], v[76:79], v[116:119]
  ds_read_b64_tr_b16 v[186:187], v28 offset:20992
  v_readlane_b32 s50, v15, 14
  v_mfma_f32_16x16x32_bf16 v[124:127], v[220:223], v[76:79], v[124:127]
  ds_read_b64_tr_b16 v[188:189], v29 offset:20480
  v_mfma_f32_16x16x32_bf16 v[120:123], v[220:223], v[72:75], v[120:123]
  ds_read_b64_tr_b16 v[190:191], v29 offset:20992
  s_waitcnt vmcnt(18) lgkmcnt(8)
  v_mfma_f32_16x16x32_bf16 v[128:131], v[160:163], v[80:83], v[128:131]
  buffer_load_dwordx4 v[64:67], off, s[36:39], s50 offset:0
  v_mfma_f32_16x16x32_bf16 v[132:135], v[160:163], v[84:87], v[132:135]
  ds_read_b64_tr_b16 v[192:193], v26 offset:24576
  ds_read_b64_tr_b16 v[194:195], v26 offset:25088
  v_mfma_f32_16x16x32_bf16 v[140:143], v[164:167], v[84:87], v[140:143]
  ds_read_b64_tr_b16 v[196:197], v27 offset:24576
  v_mfma_f32_16x16x32_bf16 v[136:139], v[164:167], v[80:83], v[136:139]
  ds_read_b64_tr_b16 v[198:199], v27 offset:25088
  v_mfma_f32_16x16x32_bf16 v[144:147], v[168:171], v[80:83], v[144:147]
  ds_read_b64_tr_b16 v[200:201], v28 offset:24576
  v_mfma_f32_16x16x32_bf16 v[148:151], v[168:171], v[84:87], v[148:151]
  ds_read_b64_tr_b16 v[202:203], v28 offset:25088
  v_mfma_f32_16x16x32_bf16 v[156:159], v[172:175], v[84:87], v[156:159]
  ds_read_b64_tr_b16 v[204:205], v29 offset:24576
  v_mfma_f32_16x16x32_bf16 v[152:155], v[172:175], v[80:83], v[152:155]
  ds_read_b64_tr_b16 v[206:207], v29 offset:25088
  s_waitcnt vmcnt(17) lgkmcnt(8)
  v_mfma_f32_16x16x32_bf16 v[128:131], v[176:179], v[88:91], v[128:131]
  buffer_load_dwordx4 v[68:71], off, s[64:67], s50 offset:0
  v_mfma_f32_16x16x32_bf16 v[132:135], v[176:179], v[92:95], v[132:135]
  ds_read_b64_tr_b16 v[208:209], v26 offset:28672
  ds_read_b64_tr_b16 v[210:211], v26 offset:29184
  v_mfma_f32_16x16x32_bf16 v[140:143], v[180:183], v[92:95], v[140:143]
  ds_read_b64_tr_b16 v[212:213], v27 offset:28672
  v_mfma_f32_16x16x32_bf16 v[136:139], v[180:183], v[88:91], v[136:139]
  ds_read_b64_tr_b16 v[214:215], v27 offset:29184
  v_mfma_f32_16x16x32_bf16 v[144:147], v[184:187], v[88:91], v[144:147]
  ds_read_b64_tr_b16 v[216:217], v28 offset:28672
  v_mfma_f32_16x16x32_bf16 v[148:151], v[184:187], v[92:95], v[148:151]
  ds_read_b64_tr_b16 v[218:219], v28 offset:29184
  v_mfma_f32_16x16x32_bf16 v[156:159], v[188:191], v[92:95], v[156:159]
  ds_read_b64_tr_b16 v[220:221], v29 offset:28672
  v_mfma_f32_16x16x32_bf16 v[152:155], v[188:191], v[88:91], v[152:155]
  ds_read_b64_tr_b16 v[222:223], v29 offset:29184
  s_waitcnt lgkmcnt(8)
  v_mfma_f32_16x16x32_bf16 v[96:99], v[192:195], v[80:83], v[96:99]
  buffer_load_dwordx4 v[72:75], off, s[36:39], s50 offset:1024
  v_mfma_f32_16x16x32_bf16 v[100:103], v[192:195], v[84:87], v[100:103]
  ds_read_b64_tr_b16 v[160:161], v6 offset:0
  ds_read_b64_tr_b16 v[162:163], v6 offset:512
  v_mfma_f32_16x16x32_bf16 v[108:111], v[196:199], v[84:87], v[108:111]
  ds_read_b64_tr_b16 v[164:165], v7 offset:0
  v_mfma_f32_16x16x32_bf16 v[104:107], v[196:199], v[80:83], v[104:107]
  ds_read_b64_tr_b16 v[166:167], v7 offset:512
  v_mfma_f32_16x16x32_bf16 v[112:115], v[200:203], v[80:83], v[112:115]
  ds_read_b64_tr_b16 v[168:169], v8 offset:0
  v_mfma_f32_16x16x32_bf16 v[116:119], v[200:203], v[84:87], v[116:119]
  ds_read_b64_tr_b16 v[170:171], v8 offset:512
  v_mfma_f32_16x16x32_bf16 v[124:127], v[204:207], v[84:87], v[124:127]
  ds_read_b64_tr_b16 v[172:173], v9 offset:0
  v_mfma_f32_16x16x32_bf16 v[120:123], v[204:207], v[80:83], v[120:123]
  ds_read_b64_tr_b16 v[174:175], v9 offset:512
  s_waitcnt lgkmcnt(8)
  s_barrier
  v_mfma_f32_16x16x32_bf16 v[96:99], v[208:211], v[88:91], v[96:99]
  buffer_load_dwordx4 v[76:79], off, s[64:67], s50 offset:1024
  v_mfma_f32_16x16x32_bf16 v[100:103], v[208:211], v[92:95], v[100:103]
  ds_read_b64_tr_b16 v[176:177], v6 offset:4096
  ds_read_b64_tr_b16 v[178:179], v6 offset:4608
  v_mfma_f32_16x16x32_bf16 v[108:111], v[212:215], v[92:95], v[108:111]
  ds_read_b64_tr_b16 v[180:181], v7 offset:4096
  v_mfma_f32_16x16x32_bf16 v[104:107], v[212:215], v[88:91], v[104:107]
  ds_read_b64_tr_b16 v[182:183], v7 offset:4608
  v_mfma_f32_16x16x32_bf16 v[112:115], v[216:219], v[88:91], v[112:115]
  ds_read_b64_tr_b16 v[184:185], v8 offset:4096
  v_mfma_f32_16x16x32_bf16 v[116:119], v[216:219], v[92:95], v[116:119]
  ds_read_b64_tr_b16 v[186:187], v8 offset:4608
  v_readlane_b32 s51, v15, 15
  v_mfma_f32_16x16x32_bf16 v[124:127], v[220:223], v[92:95], v[124:127]
  ds_read_b64_tr_b16 v[188:189], v9 offset:4096
  v_mfma_f32_16x16x32_bf16 v[120:123], v[220:223], v[88:91], v[120:123]
  ds_read_b64_tr_b16 v[190:191], v9 offset:4608
  s_waitcnt vmcnt(18) lgkmcnt(8)
  v_mfma_f32_16x16x32_bf16 v[128:131], v[160:163], v[224:227], v[128:131]
  buffer_load_dwordx4 v[80:83], off, s[36:39], s51 offset:0
  v_mfma_f32_16x16x32_bf16 v[132:135], v[160:163], v[228:231], v[132:135]
  ds_read_b64_tr_b16 v[192:193], v6 offset:8192
  ds_read_b64_tr_b16 v[194:195], v6 offset:8704
  v_mfma_f32_16x16x32_bf16 v[140:143], v[164:167], v[228:231], v[140:143]
  ds_read_b64_tr_b16 v[196:197], v7 offset:8192
  v_mfma_f32_16x16x32_bf16 v[136:139], v[164:167], v[224:227], v[136:139]
  ds_read_b64_tr_b16 v[198:199], v7 offset:8704
  v_mfma_f32_16x16x32_bf16 v[144:147], v[168:171], v[224:227], v[144:147]
  ds_read_b64_tr_b16 v[200:201], v8 offset:8192
  v_mfma_f32_16x16x32_bf16 v[148:151], v[168:171], v[228:231], v[148:151]
  ds_read_b64_tr_b16 v[202:203], v8 offset:8704
  v_mfma_f32_16x16x32_bf16 v[156:159], v[172:175], v[228:231], v[156:159]
  ds_read_b64_tr_b16 v[204:205], v9 offset:8192
  v_mfma_f32_16x16x32_bf16 v[152:155], v[172:175], v[224:227], v[152:155]
  ds_read_b64_tr_b16 v[206:207], v9 offset:8704
  s_waitcnt vmcnt(17) lgkmcnt(8)
  v_mfma_f32_16x16x32_bf16 v[128:131], v[176:179], v[232:235], v[128:131]
  buffer_load_dwordx4 v[84:87], off, s[64:67], s51 offset:0
  v_mfma_f32_16x16x32_bf16 v[132:135], v[176:179], v[236:239], v[132:135]
  ds_read_b64_tr_b16 v[208:209], v6 offset:12288
  ds_read_b64_tr_b16 v[210:211], v6 offset:12800
  v_mfma_f32_16x16x32_bf16 v[140:143], v[180:183], v[236:239], v[140:143]
  ds_read_b64_tr_b16 v[212:213], v7 offset:12288
  v_mfma_f32_16x16x32_bf16 v[136:139], v[180:183], v[232:235], v[136:139]
  ds_read_b64_tr_b16 v[214:215], v7 offset:12800
  v_mfma_f32_16x16x32_bf16 v[144:147], v[184:187], v[232:235], v[144:147]
  ds_read_b64_tr_b16 v[216:217], v8 offset:12288
  v_mfma_f32_16x16x32_bf16 v[148:151], v[184:187], v[236:239], v[148:151]
  ds_read_b64_tr_b16 v[218:219], v8 offset:12800
  v_mfma_f32_16x16x32_bf16 v[156:159], v[188:191], v[236:239], v[156:159]
  ds_read_b64_tr_b16 v[220:221], v9 offset:12288
  v_mfma_f32_16x16x32_bf16 v[152:155], v[188:191], v[232:235], v[152:155]
  ds_read_b64_tr_b16 v[222:223], v9 offset:12800
  s_waitcnt lgkmcnt(8)
  v_mfma_f32_16x16x32_bf16 v[96:99], v[192:195], v[224:227], v[96:99]
  buffer_load_dwordx4 v[88:91], off, s[36:39], s51 offset:1024
  v_mfma_f32_16x16x32_bf16 v[100:103], v[192:195], v[228:231], v[100:103]
  ds_read_b64_tr_b16 v[160:161], v6 offset:16384
  ds_read_b64_tr_b16 v[162:163], v6 offset:16896
  v_mfma_f32_16x16x32_bf16 v[108:111], v[196:199], v[228:231], v[108:111]
  ds_read_b64_tr_b16 v[164:165], v7 offset:16384
  v_mfma_f32_16x16x32_bf16 v[104:107], v[196:199], v[224:227], v[104:107]
  ds_read_b64_tr_b16 v[166:167], v7 offset:16896
  v_mfma_f32_16x16x32_bf16 v[112:115], v[200:203], v[224:227], v[112:115]
  ds_read_b64_tr_b16 v[168:169], v8 offset:16384
  v_mfma_f32_16x16x32_bf16 v[116:119], v[200:203], v[228:231], v[116:119]
  ds_read_b64_tr_b16 v[170:171], v8 offset:16896
  v_mfma_f32_16x16x32_bf16 v[124:127], v[204:207], v[228:231], v[124:127]
  ds_read_b64_tr_b16 v[172:173], v9 offset:16384
  v_mfma_f32_16x16x32_bf16 v[120:123], v[204:207], v[224:227], v[120:123]
  ds_read_b64_tr_b16 v[174:175], v9 offset:16896
  s_waitcnt lgkmcnt(8)
  v_mfma_f32_16x16x32_bf16 v[96:99], v[208:211], v[232:235], v[96:99]
  buffer_load_dwordx4 v[92:95], off, s[64:67], s51 offset:1024
  v_mfma_f32_16x16x32_bf16 v[100:103], v[208:211], v[236:239], v[100:103]
  ds_read_b64_tr_b16 v[176:177], v6 offset:20480
  ds_read_b64_tr_b16 v[178:179], v6 offset:20992
  v_mfma_f32_16x16x32_bf16 v[108:111], v[212:215], v[236:239], v[108:111]
  ds_read_b64_tr_b16 v[180:181], v7 offset:20480
  v_mfma_f32_16x16x32_bf16 v[104:107], v[212:215], v[232:235], v[104:107]
  ds_read_b64_tr_b16 v[182:183], v7 offset:20992
  v_mfma_f32_16x16x32_bf16 v[112:115], v[216:219], v[232:235], v[112:115]
  ds_read_b64_tr_b16 v[184:185], v8 offset:20480
  v_mfma_f32_16x16x32_bf16 v[116:119], v[216:219], v[236:239], v[116:119]
  ds_read_b64_tr_b16 v[186:187], v8 offset:20992
  v_readlane_b32 s48, v15, 16
  v_mfma_f32_16x16x32_bf16 v[124:127], v[220:223], v[236:239], v[124:127]
  ds_read_b64_tr_b16 v[188:189], v9 offset:20480
  v_mfma_f32_16x16x32_bf16 v[120:123], v[220:223], v[232:235], v[120:123]
  ds_read_b64_tr_b16 v[190:191], v9 offset:20992
  s_waitcnt vmcnt(18) lgkmcnt(8)
  v_mfma_f32_16x16x32_bf16 v[128:131], v[160:163], v[240:243], v[128:131]
  buffer_load_dwordx4 v[224:227], off, s[36:39], s48 offset:0
  v_mfma_f32_16x16x32_bf16 v[132:135], v[160:163], v[244:247], v[132:135]
  ds_read_b64_tr_b16 v[192:193], v6 offset:24576
  ds_read_b64_tr_b16 v[194:195], v6 offset:25088
  v_mfma_f32_16x16x32_bf16 v[140:143], v[164:167], v[244:247], v[140:143]
  ds_read_b64_tr_b16 v[196:197], v7 offset:24576
  v_mfma_f32_16x16x32_bf16 v[136:139], v[164:167], v[240:243], v[136:139]
  ds_read_b64_tr_b16 v[198:199], v7 offset:25088
  v_mfma_f32_16x16x32_bf16 v[144:147], v[168:171], v[240:243], v[144:147]
  ds_read_b64_tr_b16 v[200:201], v8 offset:24576
  v_mfma_f32_16x16x32_bf16 v[148:151], v[168:171], v[244:247], v[148:151]
  ds_read_b64_tr_b16 v[202:203], v8 offset:25088
  v_mfma_f32_16x16x32_bf16 v[156:159], v[172:175], v[244:247], v[156:159]
  ds_read_b64_tr_b16 v[204:205], v9 offset:24576
  v_mfma_f32_16x16x32_bf16 v[152:155], v[172:175], v[240:243], v[152:155]
  ds_read_b64_tr_b16 v[206:207], v9 offset:25088
  s_waitcnt vmcnt(17) lgkmcnt(8)
  v_mfma_f32_16x16x32_bf16 v[128:131], v[176:179], v[248:251], v[128:131]
  buffer_load_dwordx4 v[228:231], off, s[64:67], s48 offset:0
  v_mfma_f32_16x16x32_bf16 v[132:135], v[176:179], v[252:255], v[132:135]
  ds_read_b64_tr_b16 v[208:209], v6 offset:28672
  ds_read_b64_tr_b16 v[210:211], v6 offset:29184
  v_mfma_f32_16x16x32_bf16 v[140:143], v[180:183], v[252:255], v[140:143]
  ds_read_b64_tr_b16 v[212:213], v7 offset:28672
  v_mfma_f32_16x16x32_bf16 v[136:139], v[180:183], v[248:251], v[136:139]
  ds_read_b64_tr_b16 v[214:215], v7 offset:29184
  v_mfma_f32_16x16x32_bf16 v[144:147], v[184:187], v[248:251], v[144:147]
  ds_read_b64_tr_b16 v[216:217], v8 offset:28672
  v_mfma_f32_16x16x32_bf16 v[148:151], v[184:187], v[252:255], v[148:151]
  ds_read_b64_tr_b16 v[218:219], v8 offset:29184
  v_mfma_f32_16x16x32_bf16 v[156:159], v[188:191], v[252:255], v[156:159]
  ds_read_b64_tr_b16 v[220:221], v9 offset:28672
  v_mfma_f32_16x16x32_bf16 v[152:155], v[188:191], v[248:251], v[152:155]
  ds_read_b64_tr_b16 v[222:223], v9 offset:29184
  s_waitcnt lgkmcnt(8)
  v_mfma_f32_16x16x32_bf16 v[96:99], v[192:195], v[240:243], v[96:99]
  buffer_load_dwordx4 v[232:235], off, s[36:39], s48 offset:1024
  v_mfma_f32_16x16x32_bf16 v[100:103], v[192:195], v[244:247], v[100:103]
  ds_read_b64_tr_b16 v[160:161], v6 offset:32768
  ds_read_b64_tr_b16 v[162:163], v6 offset:33280
  v_mfma_f32_16x16x32_bf16 v[108:111], v[196:199], v[244:247], v[108:111]
  ds_read_b64_tr_b16 v[164:165], v7 offset:32768
  v_mfma_f32_16x16x32_bf16 v[104:107], v[196:199], v[240:243], v[104:107]
  ds_read_b64_tr_b16 v[166:167], v7 offset:33280
  v_mfma_f32_16x16x32_bf16 v[112:115], v[200:203], v[240:243], v[112:115]
  ds_read_b64_tr_b16 v[168:169], v8 offset:32768
  v_mfma_f32_16x16x32_bf16 v[116:119], v[200:203], v[244:247], v[116:119]
  ds_read_b64_tr_b16 v[170:171], v8 offset:33280
  v_mfma_f32_16x16x32_bf16 v[124:127], v[204:207], v[244:247], v[124:127]
  ds_read_b64_tr_b16 v[172:173], v9 offset:32768
  v_mfma_f32_16x16x32_bf16 v[120:123], v[204:207], v[240:243], v[120:123]
  ds_read_b64_tr_b16 v[174:175], v9 offset:33280
  s_waitcnt lgkmcnt(8)
  s_barrier
  v_mfma_f32_16x16x32_bf16 v[96:99], v[208:211], v[248:251], v[96:99]
  buffer_load_dwordx4 v[236:239], off, s[64:67], s48 offset:1024
  v_mfma_f32_16x16x32_bf16 v[100:103], v[208:211], v[252:255], v[100:103]
  ds_read_b64_tr_b16 v[176:177], v6 offset:36864
  ds_read_b64_tr_b16 v[178:179], v6 offset:37376
  v_mfma_f32_16x16x32_bf16 v[108:111], v[212:215], v[252:255], v[108:111]
  ds_read_b64_tr_b16 v[180:181], v7 offset:36864
  v_mfma_f32_16x16x32_bf16 v[104:107], v[212:215], v[248:251], v[104:107]
  ds_read_b64_tr_b16 v[182:183], v7 offset:37376
  v_mfma_f32_16x16x32_bf16 v[112:115], v[216:219], v[248:251], v[112:115]
  ds_read_b64_tr_b16 v[184:185], v8 offset:36864
  v_mfma_f32_16x16x32_bf16 v[116:119], v[216:219], v[252:255], v[116:119]
  ds_read_b64_tr_b16 v[186:187], v8 offset:37376
  v_readlane_b32 s49, v15, 17
  v_mfma_f32_16x16x32_bf16 v[124:127], v[220:223], v[252:255], v[124:127]
  ds_read_b64_tr_b16 v[188:189], v9 offset:36864
  v_mfma_f32_16x16x32_bf16 v[120:123], v[220:223], v[248:251], v[120:123]
  ds_read_b64_tr_b16 v[190:191], v9 offset:37376
  s_waitcnt vmcnt(18) lgkmcnt(8)
  v_mfma_f32_16x16x32_bf16 v[128:131], v[160:163], v[32:35], v[128:131]
  buffer_load_dwordx4 v[240:243], off, s[36:39], s49 offset:0
  v_mfma_f32_16x16x32_bf16 v[132:135], v[160:163], v[36:39], v[132:135]
  ds_read_b64_tr_b16 v[192:193], v6 offset:40960
  ds_read_b64_tr_b16 v[194:195], v6 offset:41472
  v_mfma_f32_16x16x32_bf16 v[140:143], v[164:167], v[36:39], v[140:143]
  ds_read_b64_tr_b16 v[196:197], v7 offset:40960
  v_mfma_f32_16x16x32_bf16 v[136:139], v[164:167], v[32:35], v[136:139]
  ds_read_b64_tr_b16 v[198:199], v7 offset:41472
  v_mfma_f32_16x16x32_bf16 v[144:147], v[168:171], v[32:35], v[144:147]
  ds_read_b64_tr_b16 v[200:201], v8 offset:40960
  v_mfma_f32_16x16x32_bf16 v[148:151], v[168:171], v[36:39], v[148:151]
  ds_read_b64_tr_b16 v[202:203], v8 offset:41472
  v_mfma_f32_16x16x32_bf16 v[156:159], v[172:175], v[36:39], v[156:159]
  ds_read_b64_tr_b16 v[204:205], v9 offset:40960
  v_mfma_f32_16x16x32_bf16 v[152:155], v[172:175], v[32:35], v[152:155]
  ds_read_b64_tr_b16 v[206:207], v9 offset:41472
  s_waitcnt vmcnt(17) lgkmcnt(8)
  v_mfma_f32_16x16x32_bf16 v[128:131], v[176:179], v[40:43], v[128:131]
  buffer_load_dwordx4 v[244:247], off, s[64:67], s49 offset:0
  v_mfma_f32_16x16x32_bf16 v[132:135], v[176:179], v[44:47], v[132:135]
  ds_read_b64_tr_b16 v[208:209], v6 offset:45056
  ds_read_b64_tr_b16 v[210:211], v6 offset:45568
  v_mfma_f32_16x16x32_bf16 v[140:143], v[180:183], v[44:47], v[140:143]
  ds_read_b64_tr_b16 v[212:213], v7 offset:45056
  v_mfma_f32_16x16x32_bf16 v[136:139], v[180:183], v[40:43], v[136:139]
  ds_read_b64_tr_b16 v[214:215], v7 offset:45568
  v_mfma_f32_16x16x32_bf16 v[144:147], v[184:187], v[40:43], v[144:147]
  ds_read_b64_tr_b16 v[216:217], v8 offset:45056
  v_mfma_f32_16x16x32_bf16 v[148:151], v[184:187], v[44:47], v[148:151]
  ds_read_b64_tr_b16 v[218:219], v8 offset:45568
  v_mfma_f32_16x16x32_bf16 v[156:159], v[188:191], v[44:47], v[156:159]
  ds_read_b64_tr_b16 v[220:221], v9 offset:45056
  v_mfma_f32_16x16x32_bf16 v[152:155], v[188:191], v[40:43], v[152:155]
  ds_read_b64_tr_b16 v[222:223], v9 offset:45568
  s_waitcnt lgkmcnt(8)
  v_mfma_f32_16x16x32_bf16 v[96:99], v[192:195], v[32:35], v[96:99]
  buffer_load_dwordx4 v[248:251], off, s[36:39], s49 offset:1024
  v_mfma_f32_16x16x32_bf16 v[100:103], v[192:195], v[36:39], v[100:103]
  ds_read_b64_tr_b16 v[160:161], v6 offset:49152
  ds_read_b64_tr_b16 v[162:163], v6 offset:49664
  v_mfma_f32_16x16x32_bf16 v[108:111], v[196:199], v[36:39], v[108:111]
  ds_read_b64_tr_b16 v[164:165], v7 offset:49152
  v_mfma_f32_16x16x32_bf16 v[104:107], v[196:199], v[32:35], v[104:107]
  ds_read_b64_tr_b16 v[166:167], v7 offset:49664
  v_mfma_f32_16x16x32_bf16 v[112:115], v[200:203], v[32:35], v[112:115]
  ds_read_b64_tr_b16 v[168:169], v8 offset:49152
  v_mfma_f32_16x16x32_bf16 v[116:119], v[200:203], v[36:39], v[116:119]
  ds_read_b64_tr_b16 v[170:171], v8 offset:49664
  v_mfma_f32_16x16x32_bf16 v[124:127], v[204:207], v[36:39], v[124:127]
  ds_read_b64_tr_b16 v[172:173], v9 offset:49152
  v_mfma_f32_16x16x32_bf16 v[120:123], v[204:207], v[32:35], v[120:123]
  ds_read_b64_tr_b16 v[174:175], v9 offset:49664
  s_waitcnt lgkmcnt(8)
  v_mfma_f32_16x16x32_bf16 v[96:99], v[208:211], v[40:43], v[96:99]
  buffer_load_dwordx4 v[252:255], off, s[64:67], s49 offset:1024
  v_mfma_f32_16x16x32_bf16 v[100:103], v[208:211], v[44:47], v[100:103]
  ds_read_b64_tr_b16 v[176:177], v6 offset:53248
  ds_read_b64_tr_b16 v[178:179], v6 offset:53760
  v_mfma_f32_16x16x32_bf16 v[108:111], v[212:215], v[44:47], v[108:111]
  ds_read_b64_tr_b16 v[180:181], v7 offset:53248
  v_mfma_f32_16x16x32_bf16 v[104:107], v[212:215], v[40:43], v[104:107]
  ds_read_b64_tr_b16 v[182:183], v7 offset:53760
  v_mfma_f32_16x16x32_bf16 v[112:115], v[216:219], v[40:43], v[112:115]
  ds_read_b64_tr_b16 v[184:185], v8 offset:53248
  v_mfma_f32_16x16x32_bf16 v[116:119], v[216:219], v[44:47], v[116:119]
  ds_read_b64_tr_b16 v[186:187], v8 offset:53760
  v_readlane_b32 s50, v15, 18
  v_mfma_f32_16x16x32_bf16 v[124:127], v[220:223], v[44:47], v[124:127]
  ds_read_b64_tr_b16 v[188:189], v9 offset:53248
  v_mfma_f32_16x16x32_bf16 v[120:123], v[220:223], v[40:43], v[120:123]
  ds_read_b64_tr_b16 v[190:191], v9 offset:53760
  s_waitcnt vmcnt(18) lgkmcnt(8)
  v_mfma_f32_16x16x32_bf16 v[128:131], v[160:163], v[48:51], v[128:131]
  buffer_load_dwordx4 v[32:35], off, s[36:39], s50 offset:0
  v_mfma_f32_16x16x32_bf16 v[132:135], v[160:163], v[52:55], v[132:135]
  ds_read_b64_tr_b16 v[192:193], v6 offset:57344
  ds_read_b64_tr_b16 v[194:195], v6 offset:57856
  v_mfma_f32_16x16x32_bf16 v[140:143], v[164:167], v[52:55], v[140:143]
  ds_read_b64_tr_b16 v[196:197], v7 offset:57344
  v_mfma_f32_16x16x32_bf16 v[136:139], v[164:167], v[48:51], v[136:139]
  ds_read_b64_tr_b16 v[198:199], v7 offset:57856
  v_mfma_f32_16x16x32_bf16 v[144:147], v[168:171], v[48:51], v[144:147]
  ds_read_b64_tr_b16 v[200:201], v8 offset:57344
  v_mfma_f32_16x16x32_bf16 v[148:151], v[168:171], v[52:55], v[148:151]
  ds_read_b64_tr_b16 v[202:203], v8 offset:57856
  v_mfma_f32_16x16x32_bf16 v[156:159], v[172:175], v[52:55], v[156:159]
  ds_read_b64_tr_b16 v[204:205], v9 offset:57344
  v_mfma_f32_16x16x32_bf16 v[152:155], v[172:175], v[48:51], v[152:155]
  ds_read_b64_tr_b16 v[206:207], v9 offset:57856
  s_waitcnt vmcnt(17) lgkmcnt(8)
  v_mfma_f32_16x16x32_bf16 v[128:131], v[176:179], v[56:59], v[128:131]
  buffer_load_dwordx4 v[36:39], off, s[64:67], s50 offset:0
  v_mfma_f32_16x16x32_bf16 v[132:135], v[176:179], v[60:63], v[132:135]
  ds_read_b64_tr_b16 v[208:209], v6 offset:61440
  ds_read_b64_tr_b16 v[210:211], v6 offset:61952
  v_mfma_f32_16x16x32_bf16 v[140:143], v[180:183], v[60:63], v[140:143]
  ds_read_b64_tr_b16 v[212:213], v7 offset:61440
  v_mfma_f32_16x16x32_bf16 v[136:139], v[180:183], v[56:59], v[136:139]
  ds_read_b64_tr_b16 v[214:215], v7 offset:61952
  v_mfma_f32_16x16x32_bf16 v[144:147], v[184:187], v[56:59], v[144:147]
  ds_read_b64_tr_b16 v[216:217], v8 offset:61440
  v_mfma_f32_16x16x32_bf16 v[148:151], v[184:187], v[60:63], v[148:151]
  ds_read_b64_tr_b16 v[218:219], v8 offset:61952
  v_mfma_f32_16x16x32_bf16 v[156:159], v[188:191], v[60:63], v[156:159]
  ds_read_b64_tr_b16 v[220:221], v9 offset:61440
  v_mfma_f32_16x16x32_bf16 v[152:155], v[188:191], v[56:59], v[152:155]
  ds_read_b64_tr_b16 v[222:223], v9 offset:61952
  s_waitcnt lgkmcnt(8)
  v_mfma_f32_16x16x32_bf16 v[96:99], v[192:195], v[48:51], v[96:99]
  buffer_load_dwordx4 v[40:43], off, s[36:39], s50 offset:1024
  v_mfma_f32_16x16x32_bf16 v[100:103], v[192:195], v[52:55], v[100:103]
  ds_read_b64_tr_b16 v[160:161], v20 offset:0
  ds_read_b64_tr_b16 v[162:163], v20 offset:512
  v_mfma_f32_16x16x32_bf16 v[108:111], v[196:199], v[52:55], v[108:111]
  ds_read_b64_tr_b16 v[164:165], v21 offset:0
  v_mfma_f32_16x16x32_bf16 v[104:107], v[196:199], v[48:51], v[104:107]
  ds_read_b64_tr_b16 v[166:167], v21 offset:512
  v_mfma_f32_16x16x32_bf16 v[112:115], v[200:203], v[48:51], v[112:115]
  ds_read_b64_tr_b16 v[168:169], v22 offset:0
  v_mfma_f32_16x16x32_bf16 v[116:119], v[200:203], v[52:55], v[116:119]
  ds_read_b64_tr_b16 v[170:171], v22 offset:512
  v_mfma_f32_16x16x32_bf16 v[124:127], v[204:207], v[52:55], v[124:127]
  ds_read_b64_tr_b16 v[172:173], v23 offset:0
  v_mfma_f32_16x16x32_bf16 v[120:123], v[204:207], v[48:51], v[120:123]
  ds_read_b64_tr_b16 v[174:175], v23 offset:512
  s_waitcnt lgkmcnt(8)
  s_barrier
  v_mfma_f32_16x16x32_bf16 v[96:99], v[208:211], v[56:59], v[96:99]
  buffer_load_dwordx4 v[44:47], off, s[64:67], s50 offset:1024
  v_mfma_f32_16x16x32_bf16 v[100:103], v[208:211], v[60:63], v[100:103]
  ds_read_b64_tr_b16 v[176:177], v20 offset:4096
  ds_read_b64_tr_b16 v[178:179], v20 offset:4608
  v_mfma_f32_16x16x32_bf16 v[108:111], v[212:215], v[60:63], v[108:111]
  ds_read_b64_tr_b16 v[180:181], v21 offset:4096
  v_mfma_f32_16x16x32_bf16 v[104:107], v[212:215], v[56:59], v[104:107]
  ds_read_b64_tr_b16 v[182:183], v21 offset:4608
  v_mfma_f32_16x16x32_bf16 v[112:115], v[216:219], v[56:59], v[112:115]
  ds_read_b64_tr_b16 v[184:185], v22 offset:4096
  v_mfma_f32_16x16x32_bf16 v[116:119], v[216:219], v[60:63], v[116:119]
  ds_read_b64_tr_b16 v[186:187], v22 offset:4608
  v_readlane_b32 s51, v15, 19
  v_mfma_f32_16x16x32_bf16 v[124:127], v[220:223], v[60:63], v[124:127]
  ds_read_b64_tr_b16 v[188:189], v23 offset:4096
  v_mfma_f32_16x16x32_bf16 v[120:123], v[220:223], v[56:59], v[120:123]
  ds_read_b64_tr_b16 v[190:191], v23 offset:4608
  s_waitcnt vmcnt(18) lgkmcnt(8)
  v_mfma_f32_16x16x32_bf16 v[128:131], v[160:163], v[64:67], v[128:131]
  buffer_load_dwordx4 v[48:51], off, s[36:39], s51 offset:0
  v_mfma_f32_16x16x32_bf16 v[132:135], v[160:163], v[68:71], v[132:135]
  ds_read_b64_tr_b16 v[192:193], v20 offset:8192
  ds_read_b64_tr_b16 v[194:195], v20 offset:8704
  v_mfma_f32_16x16x32_bf16 v[140:143], v[164:167], v[68:71], v[140:143]
  ds_read_b64_tr_b16 v[196:197], v21 offset:8192
  v_mfma_f32_16x16x32_bf16 v[136:139], v[164:167], v[64:67], v[136:139]
  ds_read_b64_tr_b16 v[198:199], v21 offset:8704
  v_mfma_f32_16x16x32_bf16 v[144:147], v[168:171], v[64:67], v[144:147]
  ds_read_b64_tr_b16 v[200:201], v22 offset:8192
  v_mfma_f32_16x16x32_bf16 v[148:151], v[168:171], v[68:71], v[148:151]
  ds_read_b64_tr_b16 v[202:203], v22 offset:8704
  v_mfma_f32_16x16x32_bf16 v[156:159], v[172:175], v[68:71], v[156:159]
  ds_read_b64_tr_b16 v[204:205], v23 offset:8192
  v_mfma_f32_16x16x32_bf16 v[152:155], v[172:175], v[64:67], v[152:155]
  ds_read_b64_tr_b16 v[206:207], v23 offset:8704
  s_waitcnt vmcnt(17) lgkmcnt(8)
  v_mfma_f32_16x16x32_bf16 v[128:131], v[176:179], v[72:75], v[128:131]
  buffer_load_dwordx4 v[52:55], off, s[64:67], s51 offset:0
  v_mfma_f32_16x16x32_bf16 v[132:135], v[176:179], v[76:79], v[132:135]
  ds_read_b64_tr_b16 v[208:209], v20 offset:12288
  ds_read_b64_tr_b16 v[210:211], v20 offset:12800
  v_mfma_f32_16x16x32_bf16 v[140:143], v[180:183], v[76:79], v[140:143]
  ds_read_b64_tr_b16 v[212:213], v21 offset:12288
  v_mfma_f32_16x16x32_bf16 v[136:139], v[180:183], v[72:75], v[136:139]
  ds_read_b64_tr_b16 v[214:215], v21 offset:12800
  v_mfma_f32_16x16x32_bf16 v[144:147], v[184:187], v[72:75], v[144:147]
  ds_read_b64_tr_b16 v[216:217], v22 offset:12288
  v_mfma_f32_16x16x32_bf16 v[148:151], v[184:187], v[76:79], v[148:151]
  ds_read_b64_tr_b16 v[218:219], v22 offset:12800
  v_mfma_f32_16x16x32_bf16 v[156:159], v[188:191], v[76:79], v[156:159]
  ds_read_b64_tr_b16 v[220:221], v23 offset:12288
  v_mfma_f32_16x16x32_bf16 v[152:155], v[188:191], v[72:75], v[152:155]
  ds_read_b64_tr_b16 v[222:223], v23 offset:12800
  s_waitcnt lgkmcnt(8)
  v_mfma_f32_16x16x32_bf16 v[96:99], v[192:195], v[64:67], v[96:99]
  buffer_load_dwordx4 v[56:59], off, s[36:39], s51 offset:1024
  v_mfma_f32_16x16x32_bf16 v[100:103], v[192:195], v[68:71], v[100:103]
  ds_read_b64_tr_b16 v[160:161], v20 offset:16384
  ds_read_b64_tr_b16 v[162:163], v20 offset:16896
  v_mfma_f32_16x16x32_bf16 v[108:111], v[196:199], v[68:71], v[108:111]
  ds_read_b64_tr_b16 v[164:165], v21 offset:16384
  v_mfma_f32_16x16x32_bf16 v[104:107], v[196:199], v[64:67], v[104:107]
  ds_read_b64_tr_b16 v[166:167], v21 offset:16896
  v_mfma_f32_16x16x32_bf16 v[112:115], v[200:203], v[64:67], v[112:115]
  ds_read_b64_tr_b16 v[168:169], v22 offset:16384
  v_mfma_f32_16x16x32_bf16 v[116:119], v[200:203], v[68:71], v[116:119]
  ds_read_b64_tr_b16 v[170:171], v22 offset:16896
  v_mfma_f32_16x16x32_bf16 v[124:127], v[204:207], v[68:71], v[124:127]
  ds_read_b64_tr_b16 v[172:173], v23 offset:16384
  v_mfma_f32_16x16x32_bf16 v[120:123], v[204:207], v[64:67], v[120:123]
  ds_read_b64_tr_b16 v[174:175], v23 offset:16896
  s_waitcnt lgkmcnt(8)
  v_mfma_f32_16x16x32_bf16 v[96:99], v[208:211], v[72:75], v[96:99]
  buffer_load_dwordx4 v[60:63], off, s[64:67], s51 offset:1024
  v_mfma_f32_16x16x32_bf16 v[100:103], v[208:211], v[76:79], v[100:103]
  ds_read_b64_tr_b16 v[176:177], v20 offset:20480
  ds_read_b64_tr_b16 v[178:179], v20 offset:20992
  v_mfma_f32_16x16x32_bf16 v[108:111], v[212:215], v[76:79], v[108:111]
  ds_read_b64_tr_b16 v[180:181], v21 offset:20480
  v_mfma_f32_16x16x32_bf16 v[104:107], v[212:215], v[72:75], v[104:107]
  ds_read_b64_tr_b16 v[182:183], v21 offset:20992
  v_mfma_f32_16x16x32_bf16 v[112:115], v[216:219], v[72:75], v[112:115]
  ds_read_b64_tr_b16 v[184:185], v22 offset:20480
  v_mfma_f32_16x16x32_bf16 v[116:119], v[216:219], v[76:79], v[116:119]
  ds_read_b64_tr_b16 v[186:187], v22 offset:20992
  v_readlane_b32 s48, v15, 20
  v_mfma_f32_16x16x32_bf16 v[124:127], v[220:223], v[76:79], v[124:127]
  ds_read_b64_tr_b16 v[188:189], v23 offset:20480
  v_mfma_f32_16x16x32_bf16 v[120:123], v[220:223], v[72:75], v[120:123]
  ds_read_b64_tr_b16 v[190:191], v23 offset:20992
  s_waitcnt vmcnt(18) lgkmcnt(8)
  v_mfma_f32_16x16x32_bf16 v[128:131], v[160:163], v[80:83], v[128:131]
  buffer_load_dwordx4 v[64:67], off, s[36:39], s48 offset:0
  v_mfma_f32_16x16x32_bf16 v[132:135], v[160:163], v[84:87], v[132:135]
  ds_read_b64_tr_b16 v[192:193], v20 offset:24576
  ds_read_b64_tr_b16 v[194:195], v20 offset:25088
  v_mfma_f32_16x16x32_bf16 v[140:143], v[164:167], v[84:87], v[140:143]
  ds_read_b64_tr_b16 v[196:197], v21 offset:24576
  v_mfma_f32_16x16x32_bf16 v[136:139], v[164:167], v[80:83], v[136:139]
  ds_read_b64_tr_b16 v[198:199], v21 offset:25088
  v_mfma_f32_16x16x32_bf16 v[144:147], v[168:171], v[80:83], v[144:147]
  ds_read_b64_tr_b16 v[200:201], v22 offset:24576
  v_mfma_f32_16x16x32_bf16 v[148:151], v[168:171], v[84:87], v[148:151]
  ds_read_b64_tr_b16 v[202:203], v22 offset:25088
  v_mfma_f32_16x16x32_bf16 v[156:159], v[172:175], v[84:87], v[156:159]
  ds_read_b64_tr_b16 v[204:205], v23 offset:24576
  v_mfma_f32_16x16x32_bf16 v[152:155], v[172:175], v[80:83], v[152:155]
  ds_read_b64_tr_b16 v[206:207], v23 offset:25088
  s_waitcnt vmcnt(17) lgkmcnt(8)
  v_mfma_f32_16x16x32_bf16 v[128:131], v[176:179], v[88:91], v[128:131]
  buffer_load_dwordx4 v[68:71], off, s[64:67], s48 offset:0
  v_mfma_f32_16x16x32_bf16 v[132:135], v[176:179], v[92:95], v[132:135]
  ds_read_b64_tr_b16 v[208:209], v20 offset:28672
  ds_read_b64_tr_b16 v[210:211], v20 offset:29184
  v_mfma_f32_16x16x32_bf16 v[140:143], v[180:183], v[92:95], v[140:143]
  ds_read_b64_tr_b16 v[212:213], v21 offset:28672
  v_mfma_f32_16x16x32_bf16 v[136:139], v[180:183], v[88:91], v[136:139]
  ds_read_b64_tr_b16 v[214:215], v21 offset:29184
  v_mfma_f32_16x16x32_bf16 v[144:147], v[184:187], v[88:91], v[144:147]
  ds_read_b64_tr_b16 v[216:217], v22 offset:28672
  v_mfma_f32_16x16x32_bf16 v[148:151], v[184:187], v[92:95], v[148:151]
  ds_read_b64_tr_b16 v[218:219], v22 offset:29184
  v_mfma_f32_16x16x32_bf16 v[156:159], v[188:191], v[92:95], v[156:159]
  ds_read_b64_tr_b16 v[220:221], v23 offset:28672
  v_mfma_f32_16x16x32_bf16 v[152:155], v[188:191], v[88:91], v[152:155]
  ds_read_b64_tr_b16 v[222:223], v23 offset:29184
  s_waitcnt lgkmcnt(8)
  v_mfma_f32_16x16x32_bf16 v[96:99], v[192:195], v[80:83], v[96:99]
  buffer_load_dwordx4 v[72:75], off, s[36:39], s48 offset:1024
  v_mfma_f32_16x16x32_bf16 v[100:103], v[192:195], v[84:87], v[100:103]
  ds_read_b64_tr_b16 v[160:161], v20 offset:32768
  ds_read_b64_tr_b16 v[162:163], v20 offset:33280
  v_mfma_f32_16x16x32_bf16 v[108:111], v[196:199], v[84:87], v[108:111]
  ds_read_b64_tr_b16 v[164:165], v21 offset:32768
  v_mfma_f32_16x16x32_bf16 v[104:107], v[196:199], v[80:83], v[104:107]
  ds_read_b64_tr_b16 v[166:167], v21 offset:33280
  v_mfma_f32_16x16x32_bf16 v[112:115], v[200:203], v[80:83], v[112:115]
  ds_read_b64_tr_b16 v[168:169], v22 offset:32768
  v_mfma_f32_16x16x32_bf16 v[116:119], v[200:203], v[84:87], v[116:119]
  ds_read_b64_tr_b16 v[170:171], v22 offset:33280
  v_mfma_f32_16x16x32_bf16 v[124:127], v[204:207], v[84:87], v[124:127]
  ds_read_b64_tr_b16 v[172:173], v23 offset:32768
  v_mfma_f32_16x16x32_bf16 v[120:123], v[204:207], v[80:83], v[120:123]
  ds_read_b64_tr_b16 v[174:175], v23 offset:33280
  s_waitcnt lgkmcnt(8)
  s_barrier
  v_mfma_f32_16x16x32_bf16 v[96:99], v[208:211], v[88:91], v[96:99]
  buffer_load_dwordx4 v[76:79], off, s[64:67], s48 offset:1024
  v_mfma_f32_16x16x32_bf16 v[100:103], v[208:211], v[92:95], v[100:103]
  ds_read_b64_tr_b16 v[176:177], v20 offset:36864
  ds_read_b64_tr_b16 v[178:179], v20 offset:37376
  v_mfma_f32_16x16x32_bf16 v[108:111], v[212:215], v[92:95], v[108:111]
  ds_read_b64_tr_b16 v[180:181], v21 offset:36864
  v_mfma_f32_16x16x32_bf16 v[104:107], v[212:215], v[88:91], v[104:107]
  ds_read_b64_tr_b16 v[182:183], v21 offset:37376
  v_mfma_f32_16x16x32_bf16 v[112:115], v[216:219], v[88:91], v[112:115]
  ds_read_b64_tr_b16 v[184:185], v22 offset:36864
  v_mfma_f32_16x16x32_bf16 v[116:119], v[216:219], v[92:95], v[116:119]
  ds_read_b64_tr_b16 v[186:187], v22 offset:37376
  v_readlane_b32 s49, v15, 21
  v_mfma_f32_16x16x32_bf16 v[124:127], v[220:223], v[92:95], v[124:127]
  ds_read_b64_tr_b16 v[188:189], v23 offset:36864
  v_mfma_f32_16x16x32_bf16 v[120:123], v[220:223], v[88:91], v[120:123]
  ds_read_b64_tr_b16 v[190:191], v23 offset:37376
  s_waitcnt vmcnt(18) lgkmcnt(8)
  v_mfma_f32_16x16x32_bf16 v[128:131], v[160:163], v[224:227], v[128:131]
  buffer_load_dwordx4 v[80:83], off, s[36:39], s49 offset:0
  v_mfma_f32_16x16x32_bf16 v[132:135], v[160:163], v[228:231], v[132:135]
  ds_read_b64_tr_b16 v[192:193], v20 offset:40960
  ds_read_b64_tr_b16 v[194:195], v20 offset:41472
  v_mfma_f32_16x16x32_bf16 v[140:143], v[164:167], v[228:231], v[140:143]
  ds_read_b64_tr_b16 v[196:197], v21 offset:40960
  v_mfma_f32_16x16x32_bf16 v[136:139], v[164:167], v[224:227], v[136:139]
  ds_read_b64_tr_b16 v[198:199], v21 offset:41472
  v_mfma_f32_16x16x32_bf16 v[144:147], v[168:171], v[224:227], v[144:147]
  ds_read_b64_tr_b16 v[200:201], v22 offset:40960
  v_mfma_f32_16x16x32_bf16 v[148:151], v[168:171], v[228:231], v[148:151]
  ds_read_b64_tr_b16 v[202:203], v22 offset:41472
  v_mfma_f32_16x16x32_bf16 v[156:159], v[172:175], v[228:231], v[156:159]
  ds_read_b64_tr_b16 v[204:205], v23 offset:40960
  v_mfma_f32_16x16x32_bf16 v[152:155], v[172:175], v[224:227], v[152:155]
  ds_read_b64_tr_b16 v[206:207], v23 offset:41472
  s_waitcnt vmcnt(17) lgkmcnt(8)
  v_mfma_f32_16x16x32_bf16 v[128:131], v[176:179], v[232:235], v[128:131]
  buffer_load_dwordx4 v[84:87], off, s[64:67], s49 offset:0
  v_mfma_f32_16x16x32_bf16 v[132:135], v[176:179], v[236:239], v[132:135]
  ds_read_b64_tr_b16 v[208:209], v20 offset:45056
  ds_read_b64_tr_b16 v[210:211], v20 offset:45568
  v_mfma_f32_16x16x32_bf16 v[140:143], v[180:183], v[236:239], v[140:143]
  ds_read_b64_tr_b16 v[212:213], v21 offset:45056
  v_mfma_f32_16x16x32_bf16 v[136:139], v[180:183], v[232:235], v[136:139]
  ds_read_b64_tr_b16 v[214:215], v21 offset:45568
  v_mfma_f32_16x16x32_bf16 v[144:147], v[184:187], v[232:235], v[144:147]
  ds_read_b64_tr_b16 v[216:217], v22 offset:45056
  v_mfma_f32_16x16x32_bf16 v[148:151], v[184:187], v[236:239], v[148:151]
  ds_read_b64_tr_b16 v[218:219], v22 offset:45568
  v_mfma_f32_16x16x32_bf16 v[156:159], v[188:191], v[236:239], v[156:159]
  ds_read_b64_tr_b16 v[220:221], v23 offset:45056
  v_mfma_f32_16x16x32_bf16 v[152:155], v[188:191], v[232:235], v[152:155]
  ds_read_b64_tr_b16 v[222:223], v23 offset:45568
  s_waitcnt lgkmcnt(8)
  v_mfma_f32_16x16x32_bf16 v[96:99], v[192:195], v[224:227], v[96:99]
  buffer_load_dwordx4 v[88:91], off, s[36:39], s49 offset:1024
  v_mfma_f32_16x16x32_bf16 v[100:103], v[192:195], v[228:231], v[100:103]
  ds_read_b64_tr_b16 v[160:161], v20 offset:49152
  ds_read_b64_tr_b16 v[162:163], v20 offset:49664
  v_mfma_f32_16x16x32_bf16 v[108:111], v[196:199], v[228:231], v[108:111]
  ds_read_b64_tr_b16 v[164:165], v21 offset:49152
  v_mfma_f32_16x16x32_bf16 v[104:107], v[196:199], v[224:227], v[104:107]
  ds_read_b64_tr_b16 v[166:167], v21 offset:49664
  v_mfma_f32_16x16x32_bf16 v[112:115], v[200:203], v[224:227], v[112:115]
  ds_read_b64_tr_b16 v[168:169], v22 offset:49152
  v_mfma_f32_16x16x32_bf16 v[116:119], v[200:203], v[228:231], v[116:119]
  ds_read_b64_tr_b16 v[170:171], v22 offset:49664
  v_mfma_f32_16x16x32_bf16 v[124:127], v[204:207], v[228:231], v[124:127]
  ds_read_b64_tr_b16 v[172:173], v23 offset:49152
  v_mfma_f32_16x16x32_bf16 v[120:123], v[204:207], v[224:227], v[120:123]
  ds_read_b64_tr_b16 v[174:175], v23 offset:49664
  s_waitcnt lgkmcnt(8)
  v_mfma_f32_16x16x32_bf16 v[96:99], v[208:211], v[232:235], v[96:99]
  buffer_load_dwordx4 v[92:95], off, s[64:67], s49 offset:1024
  v_mfma_f32_16x16x32_bf16 v[100:103], v[208:211], v[236:239], v[100:103]
  ds_read_b64_tr_b16 v[176:177], v20 offset:53248
  ds_read_b64_tr_b16 v[178:179], v20 offset:53760
  v_mfma_f32_16x16x32_bf16 v[108:111], v[212:215], v[236:239], v[108:111]
  ds_read_b64_tr_b16 v[180:181], v21 offset:53248
  v_mfma_f32_16x16x32_bf16 v[104:107], v[212:215], v[232:235], v[104:107]
  ds_read_b64_tr_b16 v[182:183], v21 offset:53760
  v_mfma_f32_16x16x32_bf16 v[112:115], v[216:219], v[232:235], v[112:115]
  ds_read_b64_tr_b16 v[184:185], v22 offset:53248
  v_mfma_f32_16x16x32_bf16 v[116:119], v[216:219], v[236:239], v[116:119]
  ds_read_b64_tr_b16 v[186:187], v22 offset:53760
  v_readlane_b32 s50, v15, 22
  v_mfma_f32_16x16x32_bf16 v[124:127], v[220:223], v[236:239], v[124:127]
  ds_read_b64_tr_b16 v[188:189], v23 offset:53248
  v_mfma_f32_16x16x32_bf16 v[120:123], v[220:223], v[232:235], v[120:123]
  ds_read_b64_tr_b16 v[190:191], v23 offset:53760
  s_waitcnt vmcnt(18) lgkmcnt(8)
  v_mfma_f32_16x16x32_bf16 v[128:131], v[160:163], v[240:243], v[128:131]
  buffer_load_dwordx4 v[224:227], off, s[36:39], s50 offset:0
  v_mfma_f32_16x16x32_bf16 v[132:135], v[160:163], v[244:247], v[132:135]
  ds_read_b64_tr_b16 v[192:193], v20 offset:57344
  ds_read_b64_tr_b16 v[194:195], v20 offset:57856
  v_mfma_f32_16x16x32_bf16 v[140:143], v[164:167], v[244:247], v[140:143]
  ds_read_b64_tr_b16 v[196:197], v21 offset:57344
  v_mfma_f32_16x16x32_bf16 v[136:139], v[164:167], v[240:243], v[136:139]
  ds_read_b64_tr_b16 v[198:199], v21 offset:57856
  v_mfma_f32_16x16x32_bf16 v[144:147], v[168:171], v[240:243], v[144:147]
  ds_read_b64_tr_b16 v[200:201], v22 offset:57344
  v_mfma_f32_16x16x32_bf16 v[148:151], v[168:171], v[244:247], v[148:151]
  ds_read_b64_tr_b16 v[202:203], v22 offset:57856
  v_mfma_f32_16x16x32_bf16 v[156:159], v[172:175], v[244:247], v[156:159]
  ds_read_b64_tr_b16 v[204:205], v23 offset:57344
  v_mfma_f32_16x16x32_bf16 v[152:155], v[172:175], v[240:243], v[152:155]
  ds_read_b64_tr_b16 v[206:207], v23 offset:57856
  s_waitcnt vmcnt(17) lgkmcnt(8)
  v_mfma_f32_16x16x32_bf16 v[128:131], v[176:179], v[248:251], v[128:131]
  buffer_load_dwordx4 v[228:231], off, s[64:67], s50 offset:0
  v_mfma_f32_16x16x32_bf16 v[132:135], v[176:179], v[252:255], v[132:135]
  ds_read_b64_tr_b16 v[208:209], v20 offset:61440
  ds_read_b64_tr_b16 v[210:211], v20 offset:61952
  v_mfma_f32_16x16x32_bf16 v[140:143], v[180:183], v[252:255], v[140:143]
  ds_read_b64_tr_b16 v[212:213], v21 offset:61440
  v_mfma_f32_16x16x32_bf16 v[136:139], v[180:183], v[248:251], v[136:139]
  ds_read_b64_tr_b16 v[214:215], v21 offset:61952
  v_mfma_f32_16x16x32_bf16 v[144:147], v[184:187], v[248:251], v[144:147]
  ds_read_b64_tr_b16 v[216:217], v22 offset:61440
  v_mfma_f32_16x16x32_bf16 v[148:151], v[184:187], v[252:255], v[148:151]
  ds_read_b64_tr_b16 v[218:219], v22 offset:61952
  v_mfma_f32_16x16x32_bf16 v[156:159], v[188:191], v[252:255], v[156:159]
  ds_read_b64_tr_b16 v[220:221], v23 offset:61440
  v_mfma_f32_16x16x32_bf16 v[152:155], v[188:191], v[248:251], v[152:155]
  ds_read_b64_tr_b16 v[222:223], v23 offset:61952
  s_waitcnt lgkmcnt(8)
  v_mfma_f32_16x16x32_bf16 v[96:99], v[192:195], v[240:243], v[96:99]
  buffer_load_dwordx4 v[232:235], off, s[36:39], s50 offset:1024
  v_mfma_f32_16x16x32_bf16 v[100:103], v[192:195], v[244:247], v[100:103]
  ds_read_b64_tr_b16 v[160:161], v26 offset:0
  ds_read_b64_tr_b16 v[162:163], v26 offset:512
  v_mfma_f32_16x16x32_bf16 v[108:111], v[196:199], v[244:247], v[108:111]
  ds_read_b64_tr_b16 v[164:165], v27 offset:0
  v_mfma_f32_16x16x32_bf16 v[104:107], v[196:199], v[240:243], v[104:107]
  ds_read_b64_tr_b16 v[166:167], v27 offset:512
  v_mfma_f32_16x16x32_bf16 v[112:115], v[200:203], v[240:243], v[112:115]
  ds_read_b64_tr_b16 v[168:169], v28 offset:0
  v_mfma_f32_16x16x32_bf16 v[116:119], v[200:203], v[244:247], v[116:119]
  ds_read_b64_tr_b16 v[170:171], v28 offset:512
  v_mfma_f32_16x16x32_bf16 v[124:127], v[204:207], v[244:247], v[124:127]
  ds_read_b64_tr_b16 v[172:173], v29 offset:0
  v_mfma_f32_16x16x32_bf16 v[120:123], v[204:207], v[240:243], v[120:123]
  ds_read_b64_tr_b16 v[174:175], v29 offset:512
  s_waitcnt lgkmcnt(8)
  s_barrier
  v_mfma_f32_16x16x32_bf16 v[96:99], v[208:211], v[248:251], v[96:99]
  buffer_load_dwordx4 v[236:239], off, s[64:67], s50 offset:1024
  v_mfma_f32_16x16x32_bf16 v[100:103], v[208:211], v[252:255], v[100:103]
  ds_read_b64_tr_b16 v[176:177], v26 offset:4096
  ds_read_b64_tr_b16 v[178:179], v26 offset:4608
  v_mfma_f32_16x16x32_bf16 v[108:111], v[212:215], v[252:255], v[108:111]
  ds_read_b64_tr_b16 v[180:181], v27 offset:4096
  v_mfma_f32_16x16x32_bf16 v[104:107], v[212:215], v[248:251], v[104:107]
  ds_read_b64_tr_b16 v[182:183], v27 offset:4608
  v_mfma_f32_16x16x32_bf16 v[112:115], v[216:219], v[248:251], v[112:115]
  ds_read_b64_tr_b16 v[184:185], v28 offset:4096
  v_mfma_f32_16x16x32_bf16 v[116:119], v[216:219], v[252:255], v[116:119]
  ds_read_b64_tr_b16 v[186:187], v28 offset:4608
  v_readlane_b32 s51, v15, 23
  v_mfma_f32_16x16x32_bf16 v[124:127], v[220:223], v[252:255], v[124:127]
  ds_read_b64_tr_b16 v[188:189], v29 offset:4096
  v_mfma_f32_16x16x32_bf16 v[120:123], v[220:223], v[248:251], v[120:123]
  ds_read_b64_tr_b16 v[190:191], v29 offset:4608
  s_waitcnt vmcnt(18) lgkmcnt(8)
  v_mfma_f32_16x16x32_bf16 v[128:131], v[160:163], v[32:35], v[128:131]
  buffer_load_dwordx4 v[240:243], off, s[36:39], s51 offset:0
  v_mfma_f32_16x16x32_bf16 v[132:135], v[160:163], v[36:39], v[132:135]
  ds_read_b64_tr_b16 v[192:193], v26 offset:8192
  ds_read_b64_tr_b16 v[194:195], v26 offset:8704
  v_mfma_f32_16x16x32_bf16 v[140:143], v[164:167], v[36:39], v[140:143]
  ds_read_b64_tr_b16 v[196:197], v27 offset:8192
  v_mfma_f32_16x16x32_bf16 v[136:139], v[164:167], v[32:35], v[136:139]
  ds_read_b64_tr_b16 v[198:199], v27 offset:8704
  v_mfma_f32_16x16x32_bf16 v[144:147], v[168:171], v[32:35], v[144:147]
  ds_read_b64_tr_b16 v[200:201], v28 offset:8192
  v_mfma_f32_16x16x32_bf16 v[148:151], v[168:171], v[36:39], v[148:151]
  ds_read_b64_tr_b16 v[202:203], v28 offset:8704
  v_mfma_f32_16x16x32_bf16 v[156:159], v[172:175], v[36:39], v[156:159]
  ds_read_b64_tr_b16 v[204:205], v29 offset:8192
  v_mfma_f32_16x16x32_bf16 v[152:155], v[172:175], v[32:35], v[152:155]
  ds_read_b64_tr_b16 v[206:207], v29 offset:8704
  s_waitcnt vmcnt(17) lgkmcnt(8)
  v_mfma_f32_16x16x32_bf16 v[128:131], v[176:179], v[40:43], v[128:131]
  buffer_load_dwordx4 v[244:247], off, s[64:67], s51 offset:0
  v_mfma_f32_16x16x32_bf16 v[132:135], v[176:179], v[44:47], v[132:135]
  ds_read_b64_tr_b16 v[208:209], v26 offset:12288
  ds_read_b64_tr_b16 v[210:211], v26 offset:12800
  v_mfma_f32_16x16x32_bf16 v[140:143], v[180:183], v[44:47], v[140:143]
  ds_read_b64_tr_b16 v[212:213], v27 offset:12288
  v_mfma_f32_16x16x32_bf16 v[136:139], v[180:183], v[40:43], v[136:139]
  ds_read_b64_tr_b16 v[214:215], v27 offset:12800
  v_mfma_f32_16x16x32_bf16 v[144:147], v[184:187], v[40:43], v[144:147]
  ds_read_b64_tr_b16 v[216:217], v28 offset:12288
  v_mfma_f32_16x16x32_bf16 v[148:151], v[184:187], v[44:47], v[148:151]
  ds_read_b64_tr_b16 v[218:219], v28 offset:12800
  v_mfma_f32_16x16x32_bf16 v[156:159], v[188:191], v[44:47], v[156:159]
  ds_read_b64_tr_b16 v[220:221], v29 offset:12288
  v_mfma_f32_16x16x32_bf16 v[152:155], v[188:191], v[40:43], v[152:155]
  ds_read_b64_tr_b16 v[222:223], v29 offset:12800
  s_waitcnt lgkmcnt(8)
  v_mfma_f32_16x16x32_bf16 v[96:99], v[192:195], v[32:35], v[96:99]
  buffer_load_dwordx4 v[248:251], off, s[36:39], s51 offset:1024
  v_mfma_f32_16x16x32_bf16 v[100:103], v[192:195], v[36:39], v[100:103]
  ds_read_b64_tr_b16 v[160:161], v26 offset:16384
  ds_read_b64_tr_b16 v[162:163], v26 offset:16896
  v_mfma_f32_16x16x32_bf16 v[108:111], v[196:199], v[36:39], v[108:111]
  ds_read_b64_tr_b16 v[164:165], v27 offset:16384
  v_mfma_f32_16x16x32_bf16 v[104:107], v[196:199], v[32:35], v[104:107]
  ds_read_b64_tr_b16 v[166:167], v27 offset:16896
  v_mfma_f32_16x16x32_bf16 v[112:115], v[200:203], v[32:35], v[112:115]
  ds_read_b64_tr_b16 v[168:169], v28 offset:16384
  v_mfma_f32_16x16x32_bf16 v[116:119], v[200:203], v[36:39], v[116:119]
  ds_read_b64_tr_b16 v[170:171], v28 offset:16896
  v_mfma_f32_16x16x32_bf16 v[124:127], v[204:207], v[36:39], v[124:127]
  ds_read_b64_tr_b16 v[172:173], v29 offset:16384
  v_mfma_f32_16x16x32_bf16 v[120:123], v[204:207], v[32:35], v[120:123]
  ds_read_b64_tr_b16 v[174:175], v29 offset:16896
  s_waitcnt lgkmcnt(8)
  v_mfma_f32_16x16x32_bf16 v[96:99], v[208:211], v[40:43], v[96:99]
  buffer_load_dwordx4 v[252:255], off, s[64:67], s51 offset:1024
  v_mfma_f32_16x16x32_bf16 v[100:103], v[208:211], v[44:47], v[100:103]
  ds_read_b64_tr_b16 v[176:177], v26 offset:20480
  ds_read_b64_tr_b16 v[178:179], v26 offset:20992
  v_mfma_f32_16x16x32_bf16 v[108:111], v[212:215], v[44:47], v[108:111]
  ds_read_b64_tr_b16 v[180:181], v27 offset:20480
  v_mfma_f32_16x16x32_bf16 v[104:107], v[212:215], v[40:43], v[104:107]
  ds_read_b64_tr_b16 v[182:183], v27 offset:20992
  v_mfma_f32_16x16x32_bf16 v[112:115], v[216:219], v[40:43], v[112:115]
  ds_read_b64_tr_b16 v[184:185], v28 offset:20480
  v_mfma_f32_16x16x32_bf16 v[116:119], v[216:219], v[44:47], v[116:119]
  ds_read_b64_tr_b16 v[186:187], v28 offset:20992
  v_readlane_b32 s48, v15, 24
  v_mfma_f32_16x16x32_bf16 v[124:127], v[220:223], v[44:47], v[124:127]
  ds_read_b64_tr_b16 v[188:189], v29 offset:20480
  v_mfma_f32_16x16x32_bf16 v[120:123], v[220:223], v[40:43], v[120:123]
  ds_read_b64_tr_b16 v[190:191], v29 offset:20992
  s_waitcnt vmcnt(18) lgkmcnt(8)
  v_mfma_f32_16x16x32_bf16 v[128:131], v[160:163], v[48:51], v[128:131]
  buffer_load_dwordx4 v[32:35], off, s[36:39], s48 offset:0
  v_mfma_f32_16x16x32_bf16 v[132:135], v[160:163], v[52:55], v[132:135]
  ds_read_b64_tr_b16 v[192:193], v26 offset:24576
  ds_read_b64_tr_b16 v[194:195], v26 offset:25088
  v_mfma_f32_16x16x32_bf16 v[140:143], v[164:167], v[52:55], v[140:143]
  ds_read_b64_tr_b16 v[196:197], v27 offset:24576
  v_mfma_f32_16x16x32_bf16 v[136:139], v[164:167], v[48:51], v[136:139]
  ds_read_b64_tr_b16 v[198:199], v27 offset:25088
  v_mfma_f32_16x16x32_bf16 v[144:147], v[168:171], v[48:51], v[144:147]
  ds_read_b64_tr_b16 v[200:201], v28 offset:24576
  v_mfma_f32_16x16x32_bf16 v[148:151], v[168:171], v[52:55], v[148:151]
  ds_read_b64_tr_b16 v[202:203], v28 offset:25088
  v_mfma_f32_16x16x32_bf16 v[156:159], v[172:175], v[52:55], v[156:159]
  ds_read_b64_tr_b16 v[204:205], v29 offset:24576
  v_mfma_f32_16x16x32_bf16 v[152:155], v[172:175], v[48:51], v[152:155]
  ds_read_b64_tr_b16 v[206:207], v29 offset:25088
  s_waitcnt vmcnt(17) lgkmcnt(8)
  v_mfma_f32_16x16x32_bf16 v[128:131], v[176:179], v[56:59], v[128:131]
  buffer_load_dwordx4 v[36:39], off, s[64:67], s48 offset:0
  v_mfma_f32_16x16x32_bf16 v[132:135], v[176:179], v[60:63], v[132:135]
  ds_read_b64_tr_b16 v[208:209], v26 offset:28672
  ds_read_b64_tr_b16 v[210:211], v26 offset:29184
  v_mfma_f32_16x16x32_bf16 v[140:143], v[180:183], v[60:63], v[140:143]
  ds_read_b64_tr_b16 v[212:213], v27 offset:28672
  v_mfma_f32_16x16x32_bf16 v[136:139], v[180:183], v[56:59], v[136:139]
  ds_read_b64_tr_b16 v[214:215], v27 offset:29184
  v_mfma_f32_16x16x32_bf16 v[144:147], v[184:187], v[56:59], v[144:147]
  ds_read_b64_tr_b16 v[216:217], v28 offset:28672
  v_mfma_f32_16x16x32_bf16 v[148:151], v[184:187], v[60:63], v[148:151]
  ds_read_b64_tr_b16 v[218:219], v28 offset:29184
  v_mfma_f32_16x16x32_bf16 v[156:159], v[188:191], v[60:63], v[156:159]
  ds_read_b64_tr_b16 v[220:221], v29 offset:28672
  v_mfma_f32_16x16x32_bf16 v[152:155], v[188:191], v[56:59], v[152:155]
  ds_read_b64_tr_b16 v[222:223], v29 offset:29184
  s_waitcnt lgkmcnt(8)
  v_mfma_f32_16x16x32_bf16 v[96:99], v[192:195], v[48:51], v[96:99]
  buffer_load_dwordx4 v[40:43], off, s[36:39], s48 offset:1024
  v_mfma_f32_16x16x32_bf16 v[100:103], v[192:195], v[52:55], v[100:103]
  ds_read_b64_tr_b16 v[160:161], v6 offset:0
  ds_read_b64_tr_b16 v[162:163], v6 offset:512
  v_mfma_f32_16x16x32_bf16 v[108:111], v[196:199], v[52:55], v[108:111]
  ds_read_b64_tr_b16 v[164:165], v7 offset:0
  v_cvt_pk_bf16_f32 v128, v128, v129
  v_mfma_f32_16x16x32_bf16 v[104:107], v[196:199], v[48:51], v[104:107]
  ds_read_b64_tr_b16 v[166:167], v7 offset:512
  v_cvt_pk_bf16_f32 v129, v130, v131
  v_mfma_f32_16x16x32_bf16 v[112:115], v[200:203], v[48:51], v[112:115]
  ds_read_b64_tr_b16 v[168:169], v8 offset:0
  v_cvt_pk_bf16_f32 v130, v132, v133
  v_mfma_f32_16x16x32_bf16 v[116:119], v[200:203], v[52:55], v[116:119]
  ds_read_b64_tr_b16 v[170:171], v8 offset:512
  v_cvt_pk_bf16_f32 v131, v134, v135
  v_mfma_f32_16x16x32_bf16 v[124:127], v[204:207], v[52:55], v[124:127]
  ds_read_b64_tr_b16 v[172:173], v9 offset:0
  buffer_store_dwordx4 v[128:131], off, s[60:63], s4 offset:0 sc1
  v_mfma_f32_16x16x32_bf16 v[120:123], v[204:207], v[48:51], v[120:123]
  ds_read_b64_tr_b16 v[174:175], v9 offset:512
  s_waitcnt lgkmcnt(8)
  s_barrier
  v_mfma_f32_16x16x32_bf16 v[96:99], v[208:211], v[56:59], v[96:99]
  ds_read_b64_tr_b16 v[176:177], v6 offset:4096
  buffer_load_dwordx4 v[44:47], off, s[64:67], s48 offset:1024
  v_mfma_f32_16x16x32_bf16 v[100:103], v[208:211], v[60:63], v[100:103]
  ds_read_b64_tr_b16 v[178:179], v6 offset:4608
  v_cvt_pk_bf16_f32 v132, v136, v137
  v_mfma_f32_16x16x32_bf16 v[108:111], v[212:215], v[60:63], v[108:111]
  ds_read_b64_tr_b16 v[180:181], v7 offset:4096
  v_cvt_pk_bf16_f32 v133, v138, v139
  v_mfma_f32_16x16x32_bf16 v[104:107], v[212:215], v[56:59], v[104:107]
  ds_read_b64_tr_b16 v[182:183], v7 offset:4608
  v_cvt_pk_bf16_f32 v134, v140, v141
  v_mfma_f32_16x16x32_bf16 v[112:115], v[216:219], v[56:59], v[112:115]
  ds_read_b64_tr_b16 v[184:185], v8 offset:4096
  v_cvt_pk_bf16_f32 v135, v142, v143
  v_mfma_f32_16x16x32_bf16 v[116:119], v[216:219], v[60:63], v[116:119]
  ds_read_b64_tr_b16 v[186:187], v8 offset:4608
  v_readlane_b32 s49, v15, 25
  v_mfma_f32_16x16x32_bf16 v[124:127], v[220:223], v[60:63], v[124:127]
  ds_read_b64_tr_b16 v[188:189], v9 offset:4096
  buffer_store_dwordx4 v[132:135], off, s[60:63], s4 offset:1024 sc1
  v_mfma_f32_16x16x32_bf16 v[120:123], v[220:223], v[56:59], v[120:123]
  ds_read_b64_tr_b16 v[190:191], v9 offset:4608
  s_waitcnt vmcnt(20) lgkmcnt(8)
  v_mfma_f32_16x16x32_bf16 v[96:99], v[160:163], v[64:67], v[96:99]
  ds_read_b64_tr_b16 v[192:193], v6 offset:8192
  buffer_load_dwordx4 v[48:51], off, s[36:39], s49 offset:0
  v_mfma_f32_16x16x32_bf16 v[100:103], v[160:163], v[68:71], v[100:103]
  ds_read_b64_tr_b16 v[194:195], v6 offset:8704
  v_cvt_pk_bf16_f32 v136, v144, v145
  v_mfma_f32_16x16x32_bf16 v[108:111], v[164:167], v[68:71], v[108:111]
  ds_read_b64_tr_b16 v[196:197], v7 offset:8192
  v_cvt_pk_bf16_f32 v137, v146, v147
  v_mfma_f32_16x16x32_bf16 v[104:107], v[164:167], v[64:67], v[104:107]
  ds_read_b64_tr_b16 v[198:199], v7 offset:8704
  v_cvt_pk_bf16_f32 v138, v148, v149
  v_mfma_f32_16x16x32_bf16 v[112:115], v[168:171], v[64:67], v[112:115]
  ds_read_b64_tr_b16 v[200:201], v8 offset:8192
  buffer_load_dwordx4 v[52:55], off, s[64:67], s49 offset:0
  v_mfma_f32_16x16x32_bf16 v[116:119], v[168:171], v[68:71], v[116:119]
  ds_read_b64_tr_b16 v[202:203], v8 offset:8704
  v_cvt_pk_bf16_f32 v139, v150, v151
  v_mfma_f32_16x16x32_bf16 v[124:127], v[172:175], v[68:71], v[124:127]
  ds_read_b64_tr_b16 v[204:205], v9 offset:8192
  buffer_store_dwordx4 v[136:139], off, s[60:63], s4 offset:2048 sc1
  v_mfma_f32_16x16x32_bf16 v[120:123], v[172:175], v[64:67], v[120:123]
  ds_read_b64_tr_b16 v[206:207], v9 offset:8704
  s_waitcnt vmcnt(21) lgkmcnt(8)
  v_mfma_f32_16x16x32_bf16 v[96:99], v[176:179], v[72:75], v[96:99]
  ds_read_b64_tr_b16 v[208:209], v6 offset:12288
  buffer_load_dwordx4 v[56:59], off, s[36:39], s49 offset:1024
  v_mfma_f32_16x16x32_bf16 v[100:103], v[176:179], v[76:79], v[100:103]
  ds_read_b64_tr_b16 v[210:211], v6 offset:12800
  v_cvt_pk_bf16_f32 v140, v152, v153
  v_mfma_f32_16x16x32_bf16 v[108:111], v[180:183], v[76:79], v[108:111]
  ds_read_b64_tr_b16 v[212:213], v7 offset:12288
  v_cvt_pk_bf16_f32 v141, v154, v155
  v_mfma_f32_16x16x32_bf16 v[104:107], v[180:183], v[72:75], v[104:107]
  ds_read_b64_tr_b16 v[214:215], v7 offset:12800
  v_cvt_pk_bf16_f32 v142, v156, v157
  v_mfma_f32_16x16x32_bf16 v[112:115], v[184:187], v[72:75], v[112:115]
  ds_read_b64_tr_b16 v[216:217], v8 offset:12288
  buffer_load_dwordx4 v[60:63], off, s[64:67], s49 offset:1024
  v_mfma_f32_16x16x32_bf16 v[116:119], v[184:187], v[76:79], v[116:119]
  ds_read_b64_tr_b16 v[218:219], v8 offset:12800
  v_cvt_pk_bf16_f32 v143, v158, v159
  v_mfma_f32_16x16x32_bf16 v[124:127], v[188:191], v[76:79], v[124:127]
  ds_read_b64_tr_b16 v[220:221], v9 offset:12288
  v_readlane_b32 s50, v15, 26
  v_mfma_f32_16x16x32_bf16 v[120:123], v[188:191], v[72:75], v[120:123]
  ds_read_b64_tr_b16 v[222:223], v9 offset:12800
  s_waitcnt vmcnt(21) lgkmcnt(8)
  v_mfma_f32_16x16x32_bf16 v[96:99], v[192:195], v[80:83], v[96:99]
  ds_read_b64_tr_b16 v[160:161], v6 offset:16384
  buffer_store_dwordx4 v[140:143], off, s[60:63], s4 offset:3072 sc1
  v_mfma_f32_16x16x32_bf16 v[100:103], v[192:195], v[84:87], v[100:103]
  buffer_load_dwordx4 v[64:67], off, s[36:39], s50 offset:0
  v_mfma_f32_16x16x32_bf16 v[108:111], v[196:199], v[84:87], v[108:111]
  ds_read_b64_tr_b16 v[162:163], v6 offset:16896
  ds_read_b64_tr_b16 v[164:165], v7 offset:16384
  v_mfma_f32_16x16x32_bf16 v[104:107], v[196:199], v[80:83], v[104:107]
  ds_read_b64_tr_b16 v[166:167], v7 offset:16896
  v_mfma_f32_16x16x32_bf16 v[112:115], v[200:203], v[80:83], v[112:115]
  ds_read_b64_tr_b16 v[168:169], v8 offset:16384
  v_mfma_f32_16x16x32_bf16 v[116:119], v[200:203], v[84:87], v[116:119]
  buffer_load_dwordx4 v[68:71], off, s[64:67], s50 offset:0
  v_mfma_f32_16x16x32_bf16 v[124:127], v[204:207], v[84:87], v[124:127]
  ds_read_b64_tr_b16 v[170:171], v8 offset:16896
  ds_read_b64_tr_b16 v[172:173], v9 offset:16384
  v_mfma_f32_16x16x32_bf16 v[120:123], v[204:207], v[80:83], v[120:123]
  ds_read_b64_tr_b16 v[174:175], v9 offset:16896
  s_waitcnt vmcnt(22) lgkmcnt(8)
  v_mfma_f32_16x16x32_bf16 v[96:99], v[208:211], v[88:91], v[96:99]
  ds_read_b64_tr_b16 v[176:177], v6 offset:20480
  v_mfma_f32_16x16x32_bf16 v[100:103], v[208:211], v[92:95], v[100:103]
  buffer_load_dwordx4 v[72:75], off, s[36:39], s50 offset:1024
  v_mfma_f32_16x16x32_bf16 v[108:111], v[212:215], v[92:95], v[108:111]
  ds_read_b64_tr_b16 v[178:179], v6 offset:20992
  ds_read_b64_tr_b16 v[180:181], v7 offset:20480
  v_mfma_f32_16x16x32_bf16 v[104:107], v[212:215], v[88:91], v[104:107]
  ds_read_b64_tr_b16 v[182:183], v7 offset:20992
  v_mfma_f32_16x16x32_bf16 v[112:115], v[216:219], v[88:91], v[112:115]
  ds_read_b64_tr_b16 v[184:185], v8 offset:20480
  v_mfma_f32_16x16x32_bf16 v[116:119], v[216:219], v[92:95], v[116:119]
  buffer_load_dwordx4 v[76:79], off, s[64:67], s50 offset:1024
  v_mfma_f32_16x16x32_bf16 v[124:127], v[220:223], v[92:95], v[124:127]
  ds_read_b64_tr_b16 v[186:187], v8 offset:20992
  ds_read_b64_tr_b16 v[188:189], v9 offset:20480
  v_mfma_f32_16x16x32_bf16 v[120:123], v[220:223], v[88:91], v[120:123]
  ds_read_b64_tr_b16 v[190:191], v9 offset:20992
  s_waitcnt vmcnt(22) lgkmcnt(8)
  v_mfma_f32_16x16x32_bf16 v[96:99], v[160:163], v[224:227], v[96:99]
  ds_read_b64_tr_b16 v[192:193], v6 offset:24576
  v_readlane_b32 s51, v15, 27
  v_mfma_f32_16x16x32_bf16 v[100:103], v[160:163], v[228:231], v[100:103]
  ds_read_b64_tr_b16 v[194:195], v6 offset:25088
  v_mfma_f32_16x16x32_bf16 v[108:111], v[164:167], v[228:231], v[108:111]
  ds_read_b64_tr_b16 v[196:197], v7 offset:24576
  v_mfma_f32_16x16x32_bf16 v[104:107], v[164:167], v[224:227], v[104:107]
  buffer_load_dwordx4 v[80:83], off, s[36:39], s51 offset:0
  v_mfma_f32_16x16x32_bf16 v[112:115], v[168:171], v[224:227], v[112:115]
  ds_read_b64_tr_b16 v[198:199], v7 offset:25088
  ds_read_b64_tr_b16 v[200:201], v8 offset:24576
  v_mfma_f32_16x16x32_bf16 v[116:119], v[168:171], v[228:231], v[116:119]
  ds_read_b64_tr_b16 v[202:203], v8 offset:25088
  v_mfma_f32_16x16x32_bf16 v[124:127], v[172:175], v[228:231], v[124:127]
  ds_read_b64_tr_b16 v[204:205], v9 offset:24576
  v_mfma_f32_16x16x32_bf16 v[120:123], v[172:175], v[224:227], v[120:123]
  ds_read_b64_tr_b16 v[206:207], v9 offset:25088
  s_waitcnt vmcnt(21) lgkmcnt(8)
  v_mfma_f32_16x16x32_bf16 v[96:99], v[176:179], v[232:235], v[96:99]
  buffer_load_dwordx4 v[84:87], off, s[64:67], s51 offset:0
  v_mfma_f32_16x16x32_bf16 v[100:103], v[176:179], v[236:239], v[100:103]
  ds_read_b64_tr_b16 v[208:209], v6 offset:28672
  ds_read_b64_tr_b16 v[210:211], v6 offset:29184
  v_mfma_f32_16x16x32_bf16 v[108:111], v[180:183], v[236:239], v[108:111]
  ds_read_b64_tr_b16 v[212:213], v7 offset:28672
  v_mfma_f32_16x16x32_bf16 v[104:107], v[180:183], v[232:235], v[104:107]
  ds_read_b64_tr_b16 v[214:215], v7 offset:29184
  v_mfma_f32_16x16x32_bf16 v[112:115], v[184:187], v[232:235], v[112:115]
  buffer_load_dwordx4 v[88:91], off, s[36:39], s51 offset:1024
  v_mfma_f32_16x16x32_bf16 v[116:119], v[184:187], v[236:239], v[116:119]
  ds_read_b64_tr_b16 v[216:217], v8 offset:28672
  ds_read_b64_tr_b16 v[218:219], v8 offset:29184
  v_mfma_f32_16x16x32_bf16 v[124:127], v[188:191], v[236:239], v[124:127]
  ds_read_b64_tr_b16 v[220:221], v9 offset:28672
  v_mfma_f32_16x16x32_bf16 v[120:123], v[188:191], v[232:235], v[120:123]
  ds_read_b64_tr_b16 v[222:223], v9 offset:29184
  s_waitcnt vmcnt(21) lgkmcnt(8)
  v_mfma_f32_16x16x32_bf16 v[96:99], v[192:195], v[240:243], v[96:99]
  ds_read_b64_tr_b16 v[160:161], v6 offset:32768
  buffer_load_dwordx4 v[92:95], off, s[64:67], s51 offset:1024
  v_mfma_f32_16x16x32_bf16 v[100:103], v[192:195], v[244:247], v[100:103]
  ds_read_b64_tr_b16 v[162:163], v6 offset:33280
  s_waitcnt vmcnt(8)
  v_mfma_f32_16x16x32_bf16 v[108:111], v[196:199], v[244:247], v[108:111]
  ds_read_b64_tr_b16 v[164:165], v7 offset:32768
  v_readlane_b32 s48, v15, 28
  v_mfma_f32_16x16x32_bf16 v[104:107], v[196:199], v[240:243], v[104:107]
  buffer_store_dword v19, off, s[52:55], s6 sc1
  v_mfma_f32_16x16x32_bf16 v[112:115], v[200:203], v[240:243], v[112:115]
  ds_read_b64_tr_b16 v[166:167], v7 offset:33280
  ds_read_b64_tr_b16 v[168:169], v8 offset:32768
  v_mfma_f32_16x16x32_bf16 v[116:119], v[200:203], v[244:247], v[116:119]
  buffer_load_dwordx4 v[224:227], off, s[36:39], s48 offset:0
  v_mfma_f32_16x16x32_bf16 v[124:127], v[204:207], v[244:247], v[124:127]
  ds_read_b64_tr_b16 v[170:171], v8 offset:33280
  ds_read_b64_tr_b16 v[172:173], v9 offset:32768
  v_mfma_f32_16x16x32_bf16 v[120:123], v[204:207], v[240:243], v[120:123]
  ds_read_b64_tr_b16 v[174:175], v9 offset:33280
  s_waitcnt lgkmcnt(8)
  v_mfma_f32_16x16x32_bf16 v[96:99], v[208:211], v[248:251], v[96:99]
  ds_read_b64_tr_b16 v[176:177], v6 offset:36864
  v_mfma_f32_16x16x32_bf16 v[100:103], v[208:211], v[252:255], v[100:103]
  buffer_load_dwordx4 v[228:231], off, s[64:67], s48 offset:0
  v_mfma_f32_16x16x32_bf16 v[108:111], v[212:215], v[252:255], v[108:111]
  ds_read_b64_tr_b16 v[178:179], v6 offset:37376
  ds_read_b64_tr_b16 v[180:181], v7 offset:36864
  v_mfma_f32_16x16x32_bf16 v[104:107], v[212:215], v[248:251], v[104:107]
  ds_read_b64_tr_b16 v[182:183], v7 offset:37376
  v_mfma_f32_16x16x32_bf16 v[112:115], v[216:219], v[248:251], v[112:115]
  ds_read_b64_tr_b16 v[184:185], v8 offset:36864
  v_mfma_f32_16x16x32_bf16 v[116:119], v[216:219], v[252:255], v[116:119]
  buffer_load_dwordx4 v[232:235], off, s[36:39], s48 offset:1024
  v_mfma_f32_16x16x32_bf16 v[124:127], v[220:223], v[252:255], v[124:127]
  ds_read_b64_tr_b16 v[186:187], v8 offset:37376
  ds_read_b64_tr_b16 v[188:189], v9 offset:36864
  v_mfma_f32_16x16x32_bf16 v[120:123], v[220:223], v[248:251], v[120:123]
  ds_read_b64_tr_b16 v[190:191], v9 offset:37376
  s_waitcnt lgkmcnt(8)
  v_mfma_f32_16x16x32_bf16 v[96:99], v[160:163], v[32:35], v[96:99]
  ds_read_b64_tr_b16 v[192:193], v6 offset:40960
  v_mfma_f32_16x16x32_bf16 v[100:103], v[160:163], v[36:39], v[100:103]
  buffer_load_dwordx4 v[236:239], off, s[64:67], s48 offset:1024
  v_mfma_f32_16x16x32_bf16 v[108:111], v[164:167], v[36:39], v[108:111]
  ds_read_b64_tr_b16 v[194:195], v6 offset:41472
  ds_read_b64_tr_b16 v[196:197], v7 offset:40960
  v_mfma_f32_16x16x32_bf16 v[104:107], v[164:167], v[32:35], v[104:107]
  ds_read_b64_tr_b16 v[198:199], v7 offset:41472
  v_readlane_b32 s49, v15, 29
  v_mfma_f32_16x16x32_bf16 v[112:115], v[168:171], v[32:35], v[112:115]
  ds_read_b64_tr_b16 v[200:201], v8 offset:40960
  v_mfma_f32_16x16x32_bf16 v[116:119], v[168:171], v[36:39], v[116:119]
  ds_read_b64_tr_b16 v[202:203], v8 offset:41472
  ds_read_b64_tr_b16 v[204:205], v9 offset:40960
  v_mfma_f32_16x16x32_bf16 v[124:127], v[172:175], v[36:39], v[124:127]
  buffer_load_dwordx4 v[240:243], off, s[36:39], s49 offset:0
  v_mfma_f32_16x16x32_bf16 v[120:123], v[172:175], v[32:35], v[120:123]
  ds_read_b64_tr_b16 v[206:207], v9 offset:41472
  s_waitcnt lgkmcnt(8)
  v_mfma_f32_16x16x32_bf16 v[96:99], v[176:179], v[40:43], v[96:99]
  ds_read_b64_tr_b16 v[208:209], v6 offset:45056
  v_mfma_f32_16x16x32_bf16 v[100:103], v[176:179], v[44:47], v[100:103]
  ds_read_b64_tr_b16 v[210:211], v6 offset:45568
  v_mfma_f32_16x16x32_bf16 v[108:111], v[180:183], v[44:47], v[108:111]
  buffer_load_dwordx4 v[244:247], off, s[64:67], s49 offset:0
  v_mfma_f32_16x16x32_bf16 v[104:107], v[180:183], v[40:43], v[104:107]
  ds_read_b64_tr_b16 v[212:213], v7 offset:45056
  ds_read_b64_tr_b16 v[214:215], v7 offset:45568
  v_mfma_f32_16x16x32_bf16 v[112:115], v[184:187], v[40:43], v[112:115]
  ds_read_b64_tr_b16 v[216:217], v8 offset:45056
  v_mfma_f32_16x16x32_bf16 v[116:119], v[184:187], v[44:47], v[116:119]
  ds_read_b64_tr_b16 v[218:219], v8 offset:45568
  ds_read_b64_tr_b16 v[220:221], v9 offset:45056
  v_mfma_f32_16x16x32_bf16 v[124:127], v[188:191], v[44:47], v[124:127]
  buffer_load_dwordx4 v[248:251], off, s[36:39], s49 offset:1024
  v_mfma_f32_16x16x32_bf16 v[120:123], v[188:191], v[40:43], v[120:123]
  ds_read_b64_tr_b16 v[222:223], v9 offset:45568
  s_waitcnt lgkmcnt(8)
  v_mfma_f32_16x16x32_bf16 v[96:99], v[192:195], v[48:51], v[96:99]
  ds_read_b64_tr_b16 v[160:161], v6 offset:49152
  v_mfma_f32_16x16x32_bf16 v[100:103], v[192:195], v[52:55], v[100:103]
  ds_read_b64_tr_b16 v[162:163], v6 offset:49664
  v_mfma_f32_16x16x32_bf16 v[108:111], v[196:199], v[52:55], v[108:111]
  buffer_load_dwordx4 v[252:255], off, s[64:67], s49 offset:1024
  v_mfma_f32_16x16x32_bf16 v[104:107], v[196:199], v[48:51], v[104:107]
  ds_read_b64_tr_b16 v[164:165], v7 offset:49152
  ds_read_b64_tr_b16 v[166:167], v7 offset:49664
  v_mfma_f32_16x16x32_bf16 v[112:115], v[200:203], v[48:51], v[112:115]
  ds_read_b64_tr_b16 v[168:169], v8 offset:49152
  v_readlane_b32 s50, v15, 30
  v_mfma_f32_16x16x32_bf16 v[116:119], v[200:203], v[52:55], v[116:119]
  ds_read_b64_tr_b16 v[170:171], v8 offset:49664
  v_mfma_f32_16x16x32_bf16 v[124:127], v[204:207], v[52:55], v[124:127]
  ds_read_b64_tr_b16 v[172:173], v9 offset:49152
  v_mfma_f32_16x16x32_bf16 v[120:123], v[204:207], v[48:51], v[120:123]
  ds_read_b64_tr_b16 v[174:175], v9 offset:49664
  s_waitcnt lgkmcnt(8)
  s_barrier
  v_mfma_f32_16x16x32_bf16 v[96:99], v[208:211], v[56:59], v[96:99]
  buffer_load_dwordx4 v[32:35], off, s[36:39], s50 offset:0
  v_mfma_f32_16x16x32_bf16 v[100:103], v[208:211], v[60:63], v[100:103]
  ds_read_b64_tr_b16 v[176:177], v6 offset:53248
  ds_read_b64_tr_b16 v[178:179], v6 offset:53760
  v_mfma_f32_16x16x32_bf16 v[108:111], v[212:215], v[60:63], v[108:111]
  ds_read_b64_tr_b16 v[180:181], v7 offset:53248
  v_mfma_f32_16x16x32_bf16 v[104:107], v[212:215], v[56:59], v[104:107]
  ds_read_b64_tr_b16 v[182:183], v7 offset:53760
  v_mfma_f32_16x16x32_bf16 v[112:115], v[216:219], v[56:59], v[112:115]
  buffer_load_dwordx4 v[36:39], off, s[64:67], s50 offset:0
  v_mfma_f32_16x16x32_bf16 v[116:119], v[216:219], v[60:63], v[116:119]
  ds_read_b64_tr_b16 v[184:185], v8 offset:53248
  ds_read_b64_tr_b16 v[186:187], v8 offset:53760
  v_mfma_f32_16x16x32_bf16 v[124:127], v[220:223], v[60:63], v[124:127]
  ds_read_b64_tr_b16 v[188:189], v9 offset:53248
  v_mfma_f32_16x16x32_bf16 v[120:123], v[220:223], v[56:59], v[120:123]
  ds_read_b64_tr_b16 v[190:191], v9 offset:53760
  s_waitcnt vmcnt(17) lgkmcnt(8)
  v_mfma_f32_16x16x32_bf16 v[96:99], v[160:163], v[64:67], v[96:99]
  buffer_load_dwordx4 v[40:43], off, s[36:39], s50 offset:1024
  v_mfma_f32_16x16x32_bf16 v[100:103], v[160:163], v[68:71], v[100:103]
  ds_read_b64_tr_b16 v[192:193], v6 offset:57344
  ds_read_b64_tr_b16 v[194:195], v6 offset:57856
  v_mfma_f32_16x16x32_bf16 v[108:111], v[164:167], v[68:71], v[108:111]
  ds_read_b64_tr_b16 v[196:197], v7 offset:57344
  v_mfma_f32_16x16x32_bf16 v[104:107], v[164:167], v[64:67], v[104:107]
  ds_read_b64_tr_b16 v[198:199], v7 offset:57856
  v_mfma_f32_16x16x32_bf16 v[112:115], v[168:171], v[64:67], v[112:115]
  buffer_load_dwordx4 v[44:47], off, s[64:67], s50 offset:1024
  v_mfma_f32_16x16x32_bf16 v[116:119], v[168:171], v[68:71], v[116:119]
  ds_read_b64_tr_b16 v[200:201], v8 offset:57344
  ds_read_b64_tr_b16 v[202:203], v8 offset:57856
  v_mfma_f32_16x16x32_bf16 v[124:127], v[172:175], v[68:71], v[124:127]
  ds_read_b64_tr_b16 v[204:205], v9 offset:57344
  v_readlane_b32 s51, v15, 31
  v_mfma_f32_16x16x32_bf16 v[120:123], v[172:175], v[64:67], v[120:123]
  ds_read_b64_tr_b16 v[206:207], v9 offset:57856
  s_waitcnt vmcnt(17) lgkmcnt(8)
  v_mfma_f32_16x16x32_bf16 v[96:99], v[176:179], v[72:75], v[96:99]
  ds_read_b64_tr_b16 v[208:209], v6 offset:61440
  v_mfma_f32_16x16x32_bf16 v[100:103], v[176:179], v[76:79], v[100:103]
  buffer_load_dwordx4 v[48:51], off, s[36:39], s51 offset:0
  v_mfma_f32_16x16x32_bf16 v[108:111], v[180:183], v[76:79], v[108:111]
  ds_read_b64_tr_b16 v[210:211], v6 offset:61952
  ds_read_b64_tr_b16 v[212:213], v7 offset:61440
  v_mfma_f32_16x16x32_bf16 v[104:107], v[180:183], v[72:75], v[104:107]
  ds_read_b64_tr_b16 v[214:215], v7 offset:61952
  v_mfma_f32_16x16x32_bf16 v[112:115], v[184:187], v[72:75], v[112:115]
  ds_read_b64_tr_b16 v[216:217], v8 offset:61440
  v_mfma_f32_16x16x32_bf16 v[116:119], v[184:187], v[76:79], v[116:119]
  buffer_load_dwordx4 v[52:55], off, s[64:67], s51 offset:0
  v_mfma_f32_16x16x32_bf16 v[124:127], v[188:191], v[76:79], v[124:127]
  ds_read_b64_tr_b16 v[218:219], v8 offset:61952
  ds_read_b64_tr_b16 v[220:221], v9 offset:61440
  v_mfma_f32_16x16x32_bf16 v[120:123], v[188:191], v[72:75], v[120:123]
  ds_read_b64_tr_b16 v[222:223], v9 offset:61952
  s_waitcnt vmcnt(17) lgkmcnt(8)
  v_mfma_f32_16x16x32_bf16 v[96:99], v[192:195], v[80:83], v[96:99]
  ds_read_b64_tr_b16 v[160:161], v20 offset:0
  v_mfma_f32_16x16x32_bf16 v[100:103], v[192:195], v[84:87], v[100:103]
  buffer_load_dwordx4 v[56:59], off, s[36:39], s51 offset:1024
  v_mfma_f32_16x16x32_bf16 v[108:111], v[196:199], v[84:87], v[108:111]
  ds_read_b64_tr_b16 v[162:163], v20 offset:512
  ds_read_b64_tr_b16 v[164:165], v21 offset:0
  v_mfma_f32_16x16x32_bf16 v[104:107], v[196:199], v[80:83], v[104:107]
  ds_read_b64_tr_b16 v[166:167], v21 offset:512
  v_mfma_f32_16x16x32_bf16 v[112:115], v[200:203], v[80:83], v[112:115]
  ds_read_b64_tr_b16 v[168:169], v22 offset:0
  v_mfma_f32_16x16x32_bf16 v[116:119], v[200:203], v[84:87], v[116:119]
  buffer_load_dwordx4 v[60:63], off, s[64:67], s51 offset:1024
  v_mfma_f32_16x16x32_bf16 v[124:127], v[204:207], v[84:87], v[124:127]
  ds_read_b64_tr_b16 v[170:171], v22 offset:512
  ds_read_b64_tr_b16 v[172:173], v23 offset:0
  v_mfma_f32_16x16x32_bf16 v[120:123], v[204:207], v[80:83], v[120:123]
  ds_read_b64_tr_b16 v[174:175], v23 offset:512
  s_waitcnt vmcnt(17) lgkmcnt(8)
  v_mfma_f32_16x16x32_bf16 v[96:99], v[208:211], v[88:91], v[96:99]
  ds_read_b64_tr_b16 v[176:177], v20 offset:4096
  v_readlane_b32 s48, v15, 32
  v_mfma_f32_16x16x32_bf16 v[100:103], v[208:211], v[92:95], v[100:103]
  ds_read_b64_tr_b16 v[178:179], v20 offset:4608
  v_mfma_f32_16x16x32_bf16 v[108:111], v[212:215], v[92:95], v[108:111]
  ds_read_b64_tr_b16 v[180:181], v21 offset:4096
  v_mfma_f32_16x16x32_bf16 v[104:107], v[212:215], v[88:91], v[104:107]
  buffer_load_dwordx4 v[64:67], off, s[36:39], s48 offset:0
  v_mfma_f32_16x16x32_bf16 v[112:115], v[216:219], v[88:91], v[112:115]
  ds_read_b64_tr_b16 v[182:183], v21 offset:4608
  ds_read_b64_tr_b16 v[184:185], v22 offset:4096
  v_mfma_f32_16x16x32_bf16 v[116:119], v[216:219], v[92:95], v[116:119]
  ds_read_b64_tr_b16 v[186:187], v22 offset:4608
  v_mfma_f32_16x16x32_bf16 v[124:127], v[220:223], v[92:95], v[124:127]
  ds_read_b64_tr_b16 v[188:189], v23 offset:4096
  v_mfma_f32_16x16x32_bf16 v[120:123], v[220:223], v[88:91], v[120:123]
  ds_read_b64_tr_b16 v[190:191], v23 offset:4608
  s_waitcnt vmcnt(15) lgkmcnt(8)
  v_mfma_f32_16x16x32_bf16 v[96:99], v[160:163], v[224:227], v[96:99]
  buffer_load_dwordx4 v[68:71], off, s[64:67], s48 offset:0
  v_mfma_f32_16x16x32_bf16 v[100:103], v[160:163], v[228:231], v[100:103]
  ds_read_b64_tr_b16 v[192:193], v20 offset:8192
  ds_read_b64_tr_b16 v[194:195], v20 offset:8704
  v_mfma_f32_16x16x32_bf16 v[108:111], v[164:167], v[228:231], v[108:111]
  ds_read_b64_tr_b16 v[196:197], v21 offset:8192
  v_mfma_f32_16x16x32_bf16 v[104:107], v[164:167], v[224:227], v[104:107]
  ds_read_b64_tr_b16 v[198:199], v21 offset:8704
  v_mfma_f32_16x16x32_bf16 v[112:115], v[168:171], v[224:227], v[112:115]
  buffer_load_dwordx4 v[72:75], off, s[36:39], s48 offset:1024
  v_mfma_f32_16x16x32_bf16 v[116:119], v[168:171], v[228:231], v[116:119]
  ds_read_b64_tr_b16 v[200:201], v22 offset:8192
  ds_read_b64_tr_b16 v[202:203], v22 offset:8704
  v_mfma_f32_16x16x32_bf16 v[124:127], v[172:175], v[228:231], v[124:127]
  ds_read_b64_tr_b16 v[204:205], v23 offset:8192
  v_mfma_f32_16x16x32_bf16 v[120:123], v[172:175], v[224:227], v[120:123]
  ds_read_b64_tr_b16 v[206:207], v23 offset:8704
  s_waitcnt vmcnt(15) lgkmcnt(8)
  v_mfma_f32_16x16x32_bf16 v[96:99], v[176:179], v[232:235], v[96:99]
  buffer_load_dwordx4 v[76:79], off, s[64:67], s48 offset:1024
  v_mfma_f32_16x16x32_bf16 v[100:103], v[176:179], v[236:239], v[100:103]
  ds_read_b64_tr_b16 v[208:209], v20 offset:12288
  ds_read_b64_tr_b16 v[210:211], v20 offset:12800
  v_mfma_f32_16x16x32_bf16 v[108:111], v[180:183], v[236:239], v[108:111]
  ds_read_b64_tr_b16 v[212:213], v21 offset:12288
  v_readlane_b32 s49, v15, 33
  v_mfma_f32_16x16x32_bf16 v[104:107], v[180:183], v[232:235], v[104:107]
  ds_read_b64_tr_b16 v[214:215], v21 offset:12800
  v_mfma_f32_16x16x32_bf16 v[112:115], v[184:187], v[232:235], v[112:115]
  ds_read_b64_tr_b16 v[216:217], v22 offset:12288
  v_mfma_f32_16x16x32_bf16 v[116:119], v[184:187], v[236:239], v[116:119]
  buffer_load_dwordx4 v[80:83], off, s[36:39], s49 offset:0
  v_mfma_f32_16x16x32_bf16 v[124:127], v[188:191], v[236:239], v[124:127]
  ds_read_b64_tr_b16 v[218:219], v22 offset:12800
  ds_read_b64_tr_b16 v[220:221], v23 offset:12288
  v_mfma_f32_16x16x32_bf16 v[120:123], v[188:191], v[232:235], v[120:123]
  ds_read_b64_tr_b16 v[222:223], v23 offset:12800
  s_waitcnt vmcnt(15) lgkmcnt(8)
  v_mfma_f32_16x16x32_bf16 v[96:99], v[192:195], v[240:243], v[96:99]
  ds_read_b64_tr_b16 v[160:161], v20 offset:16384
  v_mfma_f32_16x16x32_bf16 v[100:103], v[192:195], v[244:247], v[100:103]
  buffer_load_dwordx4 v[84:87], off, s[64:67], s49 offset:0
  v_mfma_f32_16x16x32_bf16 v[108:111], v[196:199], v[244:247], v[108:111]
  ds_read_b64_tr_b16 v[162:163], v20 offset:16896
  ds_read_b64_tr_b16 v[164:165], v21 offset:16384
  v_mfma_f32_16x16x32_bf16 v[104:107], v[196:199], v[240:243], v[104:107]
  ds_read_b64_tr_b16 v[166:167], v21 offset:16896
  v_mfma_f32_16x16x32_bf16 v[112:115], v[200:203], v[240:243], v[112:115]
  ds_read_b64_tr_b16 v[168:169], v22 offset:16384
  v_mfma_f32_16x16x32_bf16 v[116:119], v[200:203], v[244:247], v[116:119]
  buffer_load_dwordx4 v[88:91], off, s[36:39], s49 offset:1024
  v_mfma_f32_16x16x32_bf16 v[124:127], v[204:207], v[244:247], v[124:127]
  ds_read_b64_tr_b16 v[170:171], v22 offset:16896
  ds_read_b64_tr_b16 v[172:173], v23 offset:16384
  v_mfma_f32_16x16x32_bf16 v[120:123], v[204:207], v[240:243], v[120:123]
  ds_read_b64_tr_b16 v[174:175], v23 offset:16896
  s_waitcnt vmcnt(15) lgkmcnt(8)
  v_mfma_f32_16x16x32_bf16 v[96:99], v[208:211], v[248:251], v[96:99]
  ds_read_b64_tr_b16 v[176:177], v20 offset:20480
  v_mfma_f32_16x16x32_bf16 v[100:103], v[208:211], v[252:255], v[100:103]
  buffer_load_dwordx4 v[92:95], off, s[64:67], s49 offset:1024
  v_mfma_f32_16x16x32_bf16 v[108:111], v[212:215], v[252:255], v[108:111]
  ds_read_b64_tr_b16 v[178:179], v20 offset:20992
  ds_read_b64_tr_b16 v[180:181], v21 offset:20480
  v_mfma_f32_16x16x32_bf16 v[104:107], v[212:215], v[248:251], v[104:107]
  ds_read_b64_tr_b16 v[182:183], v21 offset:20992
  v_readlane_b32 s50, v15, 34
  v_mfma_f32_16x16x32_bf16 v[112:115], v[216:219], v[248:251], v[112:115]
  ds_read_b64_tr_b16 v[184:185], v22 offset:20480
  v_mfma_f32_16x16x32_bf16 v[116:119], v[216:219], v[252:255], v[116:119]
  ds_read_b64_tr_b16 v[186:187], v22 offset:20992
  ds_read_b64_tr_b16 v[188:189], v23 offset:20480
  v_mfma_f32_16x16x32_bf16 v[124:127], v[220:223], v[252:255], v[124:127]
  buffer_load_dwordx4 v[224:227], off, s[36:39], s50 offset:0
  v_mfma_f32_16x16x32_bf16 v[120:123], v[220:223], v[248:251], v[120:123]
  ds_read_b64_tr_b16 v[190:191], v23 offset:20992
  s_waitcnt vmcnt(15) lgkmcnt(8)
  v_mfma_f32_16x16x32_bf16 v[96:99], v[160:163], v[32:35], v[96:99]
  ds_read_b64_tr_b16 v[192:193], v20 offset:24576
  v_mfma_f32_16x16x32_bf16 v[100:103], v[160:163], v[36:39], v[100:103]
  ds_read_b64_tr_b16 v[194:195], v20 offset:25088
  v_mfma_f32_16x16x32_bf16 v[108:111], v[164:167], v[36:39], v[108:111]
  buffer_load_dwordx4 v[228:231], off, s[64:67], s50 offset:0
  v_mfma_f32_16x16x32_bf16 v[104:107], v[164:167], v[32:35], v[104:107]
  ds_read_b64_tr_b16 v[196:197], v21 offset:24576
  ds_read_b64_tr_b16 v[198:199], v21 offset:25088
  v_mfma_f32_16x16x32_bf16 v[112:115], v[168:171], v[32:35], v[112:115]
  ds_read_b64_tr_b16 v[200:201], v22 offset:24576
  v_mfma_f32_16x16x32_bf16 v[116:119], v[168:171], v[36:39], v[116:119]
  ds_read_b64_tr_b16 v[202:203], v22 offset:25088
  ds_read_b64_tr_b16 v[204:205], v23 offset:24576
  v_mfma_f32_16x16x32_bf16 v[124:127], v[172:175], v[36:39], v[124:127]
  buffer_load_dwordx4 v[232:235], off, s[36:39], s50 offset:1024
  v_mfma_f32_16x16x32_bf16 v[120:123], v[172:175], v[32:35], v[120:123]
  ds_read_b64_tr_b16 v[206:207], v23 offset:25088
  s_waitcnt vmcnt(15) lgkmcnt(8)
  s_barrier
  v_mfma_f32_16x16x32_bf16 v[96:99], v[176:179], v[40:43], v[96:99]
  buffer_load_dwordx4 v[144:147], off, s[60:63], s5 offset:0 sc1
  v_mfma_f32_16x16x32_bf16 v[100:103], v[176:179], v[44:47], v[100:103]
  ds_read_b64_tr_b16 v[208:209], v20 offset:28672
  ds_read_b64_tr_b16 v[210:211], v20 offset:29184
  v_mfma_f32_16x16x32_bf16 v[108:111], v[180:183], v[44:47], v[108:111]
  ds_read_b64_tr_b16 v[212:213], v21 offset:28672
  buffer_load_dwordx4 v[236:239], off, s[64:67], s50 offset:1024
  v_mfma_f32_16x16x32_bf16 v[104:107], v[180:183], v[40:43], v[104:107]
  ds_read_b64_tr_b16 v[214:215], v21 offset:29184
  buffer_load_dwordx4 v[148:151], off, s[60:63], s5 offset:1024 sc1
  v_mfma_f32_16x16x32_bf16 v[112:115], v[184:187], v[40:43], v[112:115]
  ds_read_b64_tr_b16 v[216:217], v22 offset:28672
  v_readlane_b32 s51, v15, 35
  v_mfma_f32_16x16x32_bf16 v[116:119], v[184:187], v[44:47], v[116:119]
  buffer_load_dwordx4 v[152:155], off, s[60:63], s5 offset:2048 sc1
  v_mfma_f32_16x16x32_bf16 v[124:127], v[188:191], v[44:47], v[124:127]
  ds_read_b64_tr_b16 v[218:219], v22 offset:29184
  ds_read_b64_tr_b16 v[220:221], v23 offset:28672
  v_mfma_f32_16x16x32_bf16 v[120:123], v[188:191], v[40:43], v[120:123]
  ds_read_b64_tr_b16 v[222:223], v23 offset:29184
  s_waitcnt vmcnt(17) lgkmcnt(8)
  v_mfma_f32_16x16x32_bf16 v[96:99], v[192:195], v[48:51], v[96:99]
  ds_read_b64_tr_b16 v[160:161], v20 offset:32768
  buffer_load_dwordx4 v[240:243], off, s[36:39], s51 offset:0
  v_mfma_f32_16x16x32_bf16 v[100:103], v[192:195], v[52:55], v[100:103]
  buffer_load_dwordx4 v[156:159], off, s[60:63], s5 offset:3072 sc1
  v_mfma_f32_16x16x32_bf16 v[108:111], v[196:199], v[52:55], v[108:111]
  ds_read_b64_tr_b16 v[162:163], v20 offset:33280
  ds_read_b64_tr_b16 v[164:165], v21 offset:32768
  v_mfma_f32_16x16x32_bf16 v[104:107], v[196:199], v[48:51], v[104:107]
  ds_read_b64_tr_b16 v[166:167], v21 offset:33280
  v_mfma_f32_16x16x32_bf16 v[112:115], v[200:203], v[48:51], v[112:115]
  buffer_load_dwordx4 v[244:247], off, s[64:67], s51 offset:0
  v_mfma_f32_16x16x32_bf16 v[116:119], v[200:203], v[52:55], v[116:119]
  ds_read_b64_tr_b16 v[168:169], v22 offset:32768
  ds_read_b64_tr_b16 v[170:171], v22 offset:33280
  v_mfma_f32_16x16x32_bf16 v[124:127], v[204:207], v[52:55], v[124:127]
  ds_read_b64_tr_b16 v[172:173], v23 offset:32768
  v_mfma_f32_16x16x32_bf16 v[120:123], v[204:207], v[48:51], v[120:123]
  ds_read_b64_tr_b16 v[174:175], v23 offset:33280
  s_waitcnt vmcnt(18) lgkmcnt(8)
  v_mfma_f32_16x16x32_bf16 v[96:99], v[208:211], v[56:59], v[96:99]
  buffer_load_dwordx4 v[248:251], off, s[36:39], s51 offset:1024
  v_mfma_f32_16x16x32_bf16 v[100:103], v[208:211], v[60:63], v[100:103]
  ds_read_b64_tr_b16 v[176:177], v20 offset:36864
  ds_read_b64_tr_b16 v[178:179], v20 offset:37376
  v_mfma_f32_16x16x32_bf16 v[108:111], v[212:215], v[60:63], v[108:111]
  ds_read_b64_tr_b16 v[180:181], v21 offset:36864
  v_mfma_f32_16x16x32_bf16 v[104:107], v[212:215], v[56:59], v[104:107]
  ds_read_b64_tr_b16 v[182:183], v21 offset:37376
  v_mfma_f32_16x16x32_bf16 v[112:115], v[216:219], v[56:59], v[112:115]
  buffer_load_dwordx4 v[252:255], off, s[64:67], s51 offset:1024
  v_mfma_f32_16x16x32_bf16 v[116:119], v[216:219], v[60:63], v[116:119]
  ds_read_b64_tr_b16 v[184:185], v22 offset:36864
  ds_read_b64_tr_b16 v[186:187], v22 offset:37376
  v_mfma_f32_16x16x32_bf16 v[124:127], v[220:223], v[60:63], v[124:127]
  ds_read_b64_tr_b16 v[188:189], v23 offset:36864
  v_mfma_f32_16x16x32_bf16 v[120:123], v[220:223], v[56:59], v[120:123]
  ds_read_b64_tr_b16 v[190:191], v23 offset:37376
  s_waitcnt vmcnt(18) lgkmcnt(8)
  v_mfma_f32_16x16x32_bf16 v[96:99], v[160:163], v[64:67], v[96:99]
  ds_read_b64_tr_b16 v[192:193], v20 offset:40960
  v_mfma_f32_16x16x32_bf16 v[100:103], v[160:163], v[68:71], v[100:103]
  ds_read_b64_tr_b16 v[194:195], v20 offset:41472
  v_mfma_f32_16x16x32_bf16 v[108:111], v[164:167], v[68:71], v[108:111]
  ds_read_b64_tr_b16 v[196:197], v21 offset:40960
  v_mfma_f32_16x16x32_bf16 v[104:107], v[164:167], v[64:67], v[104:107]
  ds_read_b64_tr_b16 v[198:199], v21 offset:41472
  v_mfma_f32_16x16x32_bf16 v[112:115], v[168:171], v[64:67], v[112:115]
  ds_read_b64_tr_b16 v[200:201], v22 offset:40960
  v_mfma_f32_16x16x32_bf16 v[116:119], v[168:171], v[68:71], v[116:119]
  ds_read_b64_tr_b16 v[202:203], v22 offset:41472
  v_mfma_f32_16x16x32_bf16 v[124:127], v[172:175], v[68:71], v[124:127]
  ds_read_b64_tr_b16 v[204:205], v23 offset:40960
  v_mfma_f32_16x16x32_bf16 v[120:123], v[172:175], v[64:67], v[120:123]
  ds_read_b64_tr_b16 v[206:207], v23 offset:41472
  s_waitcnt vmcnt(16) lgkmcnt(8)
  v_mfma_f32_16x16x32_bf16 v[96:99], v[176:179], v[72:75], v[96:99]
  ds_read_b64_tr_b16 v[208:209], v20 offset:45056
  v_mfma_f32_16x16x32_bf16 v[100:103], v[176:179], v[76:79], v[100:103]
  ds_read_b64_tr_b16 v[210:211], v20 offset:45568
  v_mfma_f32_16x16x32_bf16 v[108:111], v[180:183], v[76:79], v[108:111]
  ds_read_b64_tr_b16 v[212:213], v21 offset:45056
  v_mfma_f32_16x16x32_bf16 v[104:107], v[180:183], v[72:75], v[104:107]
  ds_read_b64_tr_b16 v[214:215], v21 offset:45568
  v_mfma_f32_16x16x32_bf16 v[112:115], v[184:187], v[72:75], v[112:115]
  ds_read_b64_tr_b16 v[216:217], v22 offset:45056
  v_mfma_f32_16x16x32_bf16 v[116:119], v[184:187], v[76:79], v[116:119]
  ds_read_b64_tr_b16 v[218:219], v22 offset:45568
  v_mfma_f32_16x16x32_bf16 v[124:127], v[188:191], v[76:79], v[124:127]
  ds_read_b64_tr_b16 v[220:221], v23 offset:45056
  v_mfma_f32_16x16x32_bf16 v[120:123], v[188:191], v[72:75], v[120:123]
  ds_read_b64_tr_b16 v[222:223], v23 offset:45568
  s_waitcnt vmcnt(14) lgkmcnt(8)
  v_mfma_f32_16x16x32_bf16 v[96:99], v[192:195], v[80:83], v[96:99]
  ds_read_b64_tr_b16 v[160:161], v20 offset:49152
  v_mfma_f32_16x16x32_bf16 v[100:103], v[192:195], v[84:87], v[100:103]
  ds_read_b64_tr_b16 v[162:163], v20 offset:49664
  v_mfma_f32_16x16x32_bf16 v[108:111], v[196:199], v[84:87], v[108:111]
  ds_read_b64_tr_b16 v[164:165], v21 offset:49152
  v_mfma_f32_16x16x32_bf16 v[104:107], v[196:199], v[80:83], v[104:107]
  ds_read_b64_tr_b16 v[166:167], v21 offset:49664
  v_mfma_f32_16x16x32_bf16 v[112:115], v[200:203], v[80:83], v[112:115]
  ds_read_b64_tr_b16 v[168:169], v22 offset:49152
  v_mfma_f32_16x16x32_bf16 v[116:119], v[200:203], v[84:87], v[116:119]
  ds_read_b64_tr_b16 v[170:171], v22 offset:49664
  v_mfma_f32_16x16x32_bf16 v[124:127], v[204:207], v[84:87], v[124:127]
  ds_read_b64_tr_b16 v[172:173], v23 offset:49152
  v_mfma_f32_16x16x32_bf16 v[120:123], v[204:207], v[80:83], v[120:123]
  ds_read_b64_tr_b16 v[174:175], v23 offset:49664
  s_waitcnt vmcnt(12) lgkmcnt(8)
  v_mfma_f32_16x16x32_bf16 v[96:99], v[208:211], v[88:91], v[96:99]
  ds_read_b64_tr_b16 v[176:177], v20 offset:53248
  v_mfma_f32_16x16x32_bf16 v[100:103], v[208:211], v[92:95], v[100:103]
  ds_read_b64_tr_b16 v[178:179], v20 offset:53760
  v_mfma_f32_16x16x32_bf16 v[108:111], v[212:215], v[92:95], v[108:111]
  ds_read_b64_tr_b16 v[180:181], v21 offset:53248
  v_mfma_f32_16x16x32_bf16 v[104:107], v[212:215], v[88:91], v[104:107]
  ds_read_b64_tr_b16 v[182:183], v21 offset:53760
  v_mfma_f32_16x16x32_bf16 v[112:115], v[216:219], v[88:91], v[112:115]
  ds_read_b64_tr_b16 v[184:185], v22 offset:53248
  v_mfma_f32_16x16x32_bf16 v[116:119], v[216:219], v[92:95], v[116:119]
  ds_read_b64_tr_b16 v[186:187], v22 offset:53760
  v_mfma_f32_16x16x32_bf16 v[124:127], v[220:223], v[92:95], v[124:127]
  ds_read_b64_tr_b16 v[188:189], v23 offset:53248
  v_mfma_f32_16x16x32_bf16 v[120:123], v[220:223], v[88:91], v[120:123]
  ds_read_b64_tr_b16 v[190:191], v23 offset:53760
  s_waitcnt vmcnt(10) lgkmcnt(8)
  v_mfma_f32_16x16x32_bf16 v[96:99], v[160:163], v[224:227], v[96:99]
  ds_read_b64_tr_b16 v[192:193], v20 offset:57344
  s_waitcnt vmcnt(3)
  v_mfma_f32_16x16x32_bf16 v[100:103], v[160:163], v[228:231], v[100:103]
  ds_read_b64_tr_b16 v[194:195], v20 offset:57856
  v_lshlrev_b32 v128, 16, v144
  v_mfma_f32_16x16x32_bf16 v[108:111], v[164:167], v[228:231], v[108:111]
  ds_read_b64_tr_b16 v[196:197], v21 offset:57344
  v_and_b32 v129, s11, v144
  v_mfma_f32_16x16x32_bf16 v[104:107], v[164:167], v[224:227], v[104:107]
  ds_read_b64_tr_b16 v[198:199], v21 offset:57856
  v_lshlrev_b32 v130, 16, v145
  v_mfma_f32_16x16x32_bf16 v[112:115], v[168:171], v[224:227], v[112:115]
  ds_read_b64_tr_b16 v[200:201], v22 offset:57344
  v_and_b32 v131, s11, v145
  v_mfma_f32_16x16x32_bf16 v[116:119], v[168:171], v[228:231], v[116:119]
  ds_read_b64_tr_b16 v[202:203], v22 offset:57856
  v_lshlrev_b32 v132, 16, v146
  v_mfma_f32_16x16x32_bf16 v[124:127], v[172:175], v[228:231], v[124:127]
  ds_read_b64_tr_b16 v[204:205], v23 offset:57344
  v_and_b32 v133, s11, v146
  v_mfma_f32_16x16x32_bf16 v[120:123], v[172:175], v[224:227], v[120:123]
  ds_read_b64_tr_b16 v[206:207], v23 offset:57856
  s_waitcnt lgkmcnt(8)
  v_mfma_f32_16x16x32_bf16 v[96:99], v[176:179], v[232:235], v[96:99]
  ds_read_b64_tr_b16 v[208:209], v20 offset:61440
  v_lshlrev_b32 v134, 16, v147
  v_mfma_f32_16x16x32_bf16 v[100:103], v[176:179], v[236:239], v[100:103]
  ds_read_b64_tr_b16 v[210:211], v20 offset:61952
  v_and_b32 v135, s11, v147
  v_mfma_f32_16x16x32_bf16 v[108:111], v[180:183], v[236:239], v[108:111]
  ds_read_b64_tr_b16 v[212:213], v21 offset:61440
  v_lshlrev_b32 v136, 16, v148
  v_mfma_f32_16x16x32_bf16 v[104:107], v[180:183], v[232:235], v[104:107]
  ds_read_b64_tr_b16 v[214:215], v21 offset:61952
  v_and_b32 v137, s11, v148
  v_mfma_f32_16x16x32_bf16 v[112:115], v[184:187], v[232:235], v[112:115]
  ds_read_b64_tr_b16 v[216:217], v22 offset:61440
  v_lshlrev_b32 v138, 16, v149
  v_mfma_f32_16x16x32_bf16 v[116:119], v[184:187], v[236:239], v[116:119]
  ds_read_b64_tr_b16 v[218:219], v22 offset:61952
  v_and_b32 v139, s11, v149
  v_mfma_f32_16x16x32_bf16 v[124:127], v[188:191], v[236:239], v[124:127]
  ds_read_b64_tr_b16 v[220:221], v23 offset:61440
  v_lshlrev_b32 v140, 16, v150
  v_mfma_f32_16x16x32_bf16 v[120:123], v[188:191], v[232:235], v[120:123]
  ds_read_b64_tr_b16 v[222:223], v23 offset:61952
  s_waitcnt vmcnt(2) lgkmcnt(8)
  v_mfma_f32_16x16x32_bf16 v[96:99], v[192:195], v[240:243], v[96:99]
  v_mov_b32 v20, 0
  v_mov_b32 v21, 0
  v_mfma_f32_16x16x32_bf16 v[100:103], v[192:195], v[244:247], v[100:103]
  v_mov_b32 v22, 0
  v_mov_b32 v23, 0
  v_mfma_f32_16x16x32_bf16 v[108:111], v[196:199], v[244:247], v[108:111]
  v_and_b32 v141, s11, v150
  v_lshlrev_b32 v142, 16, v151
  v_and_b32 v143, s11, v151
  v_mfma_f32_16x16x32_bf16 v[104:107], v[196:199], v[240:243], v[104:107]
  v_lshlrev_b32 v144, 16, v152
  v_and_b32 v145, s11, v152
  v_lshlrev_b32 v146, 16, v153
  v_mfma_f32_16x16x32_bf16 v[112:115], v[200:203], v[240:243], v[112:115]
  v_and_b32 v147, s11, v153
  v_lshlrev_b32 v148, 16, v154
  v_and_b32 v149, s11, v154
  v_mfma_f32_16x16x32_bf16 v[116:119], v[200:203], v[244:247], v[116:119]
  v_lshlrev_b32 v150, 16, v155
  v_and_b32 v151, s11, v155
  v_lshlrev_b32 v152, 16, v156
  v_mfma_f32_16x16x32_bf16 v[124:127], v[204:207], v[244:247], v[124:127]
  v_and_b32 v153, s11, v156
  v_lshlrev_b32 v154, 16, v157
  v_and_b32 v155, s11, v157
  v_mfma_f32_16x16x32_bf16 v[120:123], v[204:207], v[240:243], v[120:123]
  s_waitcnt vmcnt(0) lgkmcnt(0)
  v_lshlrev_b32 v156, 16, v158
  v_and_b32 v157, s11, v158
  v_mfma_f32_16x16x32_bf16 v[96:99], v[208:211], v[248:251], v[96:99]
  v_lshlrev_b32 v158, 16, v159
  v_and_b32 v159, s11, v159
  v_mfma_f32_16x16x32_bf16 v[100:103], v[208:211], v[252:255], v[100:103]
  v_mfma_f32_16x16x32_bf16 v[108:111], v[212:215], v[252:255], v[108:111]
  v_mfma_f32_16x16x32_bf16 v[104:107], v[212:215], v[248:251], v[104:107]
  v_mfma_f32_16x16x32_bf16 v[112:115], v[216:219], v[248:251], v[112:115]
  v_mfma_f32_16x16x32_bf16 v[116:119], v[216:219], v[252:255], v[116:119]
  v_mfma_f32_16x16x32_bf16 v[124:127], v[220:223], v[252:255], v[124:127]
  v_mfma_f32_16x16x32_bf16 v[120:123], v[220:223], v[248:251], v[120:123]
  s_lshl_b32 s3, s7, 4
  s_mov_b32 s10, 0x3f803f80
  s_nop 4
  v_pk_add_f32 v[96:97], v[96:97], v[128:129]
  v_pk_add_f32 v[98:99], v[98:99], v[130:131]
  v_cvt_pk_bf16_f32 v240, v96, v97
  v_cvt_pk_bf16_f32 v241, v98, v99
  v_pk_add_f32 v[104:105], v[104:105], v[136:137]
  v_pk_add_f32 v[106:107], v[106:107], v[138:139]
  v_cvt_pk_bf16_f32 v242, v104, v105
  v_cvt_pk_bf16_f32 v243, v106, v107
  s_nop 1
  v_permlane16_swap_b32 v240, v242
  v_permlane16_swap_b32 v241, v243
  buffer_store_dwordx4 v[240:243], v12, s[44:47], 0 offen offset:0 sc1
  ds_write_b128 v4, v[240:243] offset:0
  v_pk_add_f32 v[112:113], v[112:113], v[144:145]
  v_pk_add_f32 v[114:115], v[114:115], v[146:147]
  v_cvt_pk_bf16_f32 v244, v112, v113
  v_cvt_pk_bf16_f32 v245, v114, v115
  v_pk_add_f32 v[120:121], v[120:121], v[152:153]
  v_pk_add_f32 v[122:123], v[122:123], v[154:155]
  v_cvt_pk_bf16_f32 v246, v120, v121
  v_cvt_pk_bf16_f32 v247, v122, v123
  s_nop 1
  v_permlane16_swap_b32 v244, v246
  v_permlane16_swap_b32 v245, v247
  buffer_store_dwordx4 v[244:247], v12, s[44:47], 0 offen offset:64 sc1
  ds_write_b128 v5, v[244:247] offset:0
  v_pk_add_f32 v[100:101], v[100:101], v[132:133]
  v_pk_add_f32 v[102:103], v[102:103], v[134:135]
  v_cvt_pk_bf16_f32 v248, v100, v101
  v_cvt_pk_bf16_f32 v249, v102, v103
  v_pk_add_f32 v[108:109], v[108:109], v[140:141]
  v_pk_add_f32 v[110:111], v[110:111], v[142:143]
  v_cvt_pk_bf16_f32 v250, v108, v109
  v_cvt_pk_bf16_f32 v251, v110, v111
  s_nop 1
  v_permlane16_swap_b32 v248, v250
  v_permlane16_swap_b32 v249, v251
  buffer_store_dwordx4 v[248:251], v12, s[44:47], s3 offen offset:0 sc1
  ds_write_b128 v4, v[248:251] offset:2048
  v_pk_add_f32 v[116:117], v[116:117], v[148:149]
  v_pk_add_f32 v[118:119], v[118:119], v[150:151]
  v_cvt_pk_bf16_f32 v252, v116, v117
  v_cvt_pk_bf16_f32 v253, v118, v119
  v_pk_add_f32 v[124:125], v[124:125], v[156:157]
  v_pk_add_f32 v[126:127], v[126:127], v[158:159]
  v_cvt_pk_bf16_f32 v254, v124, v125
  v_cvt_pk_bf16_f32 v255, v126, v127
  s_nop 1
  v_permlane16_swap_b32 v252, v254
  v_permlane16_swap_b32 v253, v255
  buffer_store_dwordx4 v[252:255], v12, s[44:47], s3 offen offset:64 sc1
  ds_write_b128 v5, v[252:255] offset:2048
  v_dot2_f32_bf16 v20, v240, s10, v20
  v_dot2_f32_bf16 v22, v240, v240, v22
  v_dot2_f32_bf16 v20, v241, s10, v20
  v_dot2_f32_bf16 v22, v241, v241, v22
  v_dot2_f32_bf16 v20, v242, s10, v20
  v_dot2_f32_bf16 v22, v242, v242, v22
  v_dot2_f32_bf16 v20, v243, s10, v20
  v_dot2_f32_bf16 v22, v243, v243, v22
  v_dot2_f32_bf16 v20, v244, s10, v20
  v_dot2_f32_bf16 v22, v244, v244, v22
  v_dot2_f32_bf16 v20, v245, s10, v20
  v_dot2_f32_bf16 v22, v245, v245, v22
  v_dot2_f32_bf16 v20, v246, s10, v20
  v_dot2_f32_bf16 v22, v246, v246, v22
  v_dot2_f32_bf16 v20, v247, s10, v20
  v_dot2_f32_bf16 v22, v247, v247, v22
  v_dot2_f32_bf16 v21, v248, s10, v21
  v_dot2_f32_bf16 v23, v248, v248, v23
  v_dot2_f32_bf16 v21, v249, s10, v21
  v_dot2_f32_bf16 v23, v249, v249, v23
  v_dot2_f32_bf16 v21, v250, s10, v21
  v_dot2_f32_bf16 v23, v250, v250, v23
  v_dot2_f32_bf16 v21, v251, s10, v21
  v_dot2_f32_bf16 v23, v251, v251, v23
  v_dot2_f32_bf16 v21, v252, s10, v21
  v_dot2_f32_bf16 v23, v252, v252, v23
  v_dot2_f32_bf16 v21, v253, s10, v21
  v_dot2_f32_bf16 v23, v253, v253, v23
  v_dot2_f32_bf16 v21, v254, s10, v21
  v_dot2_f32_bf16 v23, v254, v254, v23
  v_dot2_f32_bf16 v21, v255, s10, v21
  v_dot2_f32_bf16 v23, v255, v255, v23
  s_nop 2
  v_permlane32_swap_b32 v20, v21
  v_permlane32_swap_b32 v22, v23
  v_add_f32 v20, v20, v21
  v_add_f32 v22, v22, v23
  s_nop 1
  v_permlane16_swap_b32 v20, v22
  v_add_f32 v20, v20, v22
  buffer_store_dword v20, v18, s[56:59], 0 offen sc1
  s_cmp_eq_u32 s96, 1
  s_cbranch_scc1 L_w2_end
  s_waitcnt vmcnt(0) lgkmcnt(0)
  s_barrier
  s_mov_b32 s96, 1
  s_add_u32 s12, s22, 33554432
  s_addc_u32 s13, s23, 0
  s_add_u32 s34, s22, 67108864
  s_addc_u32 s35, s23, 0
  s_add_u32 s97, s97, 1
  s_branch L_attn_body
L_w2_c1:
```

```asm
; @launch grid=(256,1,1) block=(512,1,1) lds=163840
.amdgcn_target "amdgcn-amd-amdhsa--gfx950"
L_attn_c0:
.text
.globl interleave_layers__sliding_local_dilated__dense_activation_gelu__prompt_kernel
.p2align 8
.type interleave_layers__sliding_local_dilated__dense_activation_gelu__prompt_kernel,@function
interleave_layers__sliding_local_dilated__dense_activation_gelu__prompt_kernel:
  s_load_dwordx4 s[16:19], s[0:1], 0
  s_load_dwordx2 s[20:21], s[0:1], 16
  s_load_dwordx2 s[22:23], s[0:1], 80
  s_load_dwordx8 s[24:31], s[0:1], 32
  s_load_dwordx2 s[32:33], s[0:1], 64
  s_load_dwordx2 s[34:35], s[0:1], 80
  s_load_dwordx2 s[12:13], s[0:1], 0
  s_load_dwordx2 s[64:65], s[0:1], 72
  s_mov_b32 s96, 0
  s_mov_b32 s97, 0
L_attn_body:
  s_cmp_ge_u32 s2, 256
  s_cbranch_scc1 L_attn_end
  v_lshrrev_b32 v2, 6, v0
  v_and_b32 v1, 63, v0
  v_readfirstlane_b32 s70, v2
  s_and_b32 s3, s2, 7
  s_lshr_b32 s99, s2, 3
  s_and_b32 s5, s3, 1
  s_lshl_b32 s5, s5, 3
  s_and_b32 s6, s99, 7
  s_add_u32 s68, s5, s6
  s_lshr_b32 s5, s3, 1
  s_lshl_b32 s5, s5, 2
  s_lshr_b32 s6, s99, 3
  s_add_u32 s69, s5, s6
  s_cmp_eq_u32 s96, 0
  s_cbranch_scc1 L_attn_map
  s_and_b32 s3, s2, 7
  s_and_b32 s5, s3, 3
  s_lshl_b32 s5, s5, 2
  s_and_b32 s6, s99, 3
  s_add_u32 s68, s5, s6
  s_lshr_b32 s5, s3, 2
  s_lshl_b32 s5, s5, 3
  s_lshr_b32 s6, s99, 2
  s_add_u32 s69, s5, s6
L_attn_map:
  s_cmp_lt_u32 s70, 4
  s_cbranch_scc1 L_attn_compute
L_attn_loader:
  s_add_u32 s8, s70, s69
  s_and_b32 s8, s8, 3
  s_add_u32 s9, s70, s68
  s_and_b32 s9, s9, 3
  s_lshl_b32 s76, s8, 12
  s_lshl_b32 s77, s9, 11
  s_add_u32 s77, s77, 16384
  s_lshl_b32 s11, s68, 7
  v_and_b32 v10, 7, v1
  v_lshrrev_b32 v3, 3, v1
  s_lshr_b32 s10, s76, 7
  s_lshl_b32 s3, s68, 7
  s_add_u32 s10, s10, s3
  v_add_u32 v3, s10, v3
  s_cmp_eq_u32 s96, 1
  s_cselect_b32 s5, 128, 0
  s_add_u32 s5, s5, 2048
  s_lshl_b32 s6, s5, 3
  v_mul_u32_u24 v3, s5, v3
  v_lshrrev_b32 v2, 4, v1
  v_xor_b32 v4, v2, v10
  v_lshl_add_u32 v4, v4, 4, v3
  v_add_u32 v3, s6, v3
  v_add_u32 v5, 4, v2
  v_xor_b32 v5, v5, v10
  v_lshl_add_u32 v5, v5, 4, v3
  v_add_u32 v3, s6, v3
  v_xor_b32 v6, v2, v10
  v_lshl_add_u32 v6, v6, 4, v3
  v_add_u32 v3, s6, v3
  v_add_u32 v7, 4, v2
  v_xor_b32 v7, v7, v10
  v_lshl_add_u32 v7, v7, 4, v3
  v_lshrrev_b32 v3, 3, v1
  s_lshl_b32 s10, s9, 4
  v_add_u32 v3, s10, v3
  v_mul_u32_u24 v3, 6144, v3
  v_lshrrev_b32 v2, 3, v1
  v_and_b32 v2, 2, v2
  v_xor_b32 v2, v2, v10
  s_mul_i32 s10, s69, 128
  v_add_u32 v3, s10, v3
  v_lshl_add_u32 v8, v2, 4, v3
  v_xor_b32 v2, 4, v2
  v_add_u32 v3, 49152, v3
  v_lshl_add_u32 v9, v2, 4, v3
  s_and_b32 s10, s70, 3
  s_lshl_b32 s78, s10, 9
  s_add_u32 s78, s78, 40960
  s_lshl_b32 s14, s10, 2
  s_add_u32 s14, s14, s11
  s_sub_u32 s14, s14, 16
  v_lshrrev_b32 v3, 3, v1
  v_add_u32 v3, s14, v3
  v_max_i32 v3, 0, v3
  v_mul_u32_u24 v3, s5, v3
  s_lshl_b32 s14, s10, 1
  v_lshrrev_b32 v2, 4, v1
  v_add_u32 v2, s14, v2
  v_and_b32 v2, 7, v2
  v_xor_b32 v2, v2, v10
  v_lshl_add_u32 v28, v2, 4, v3
  s_cmp_eq_u32 s10, 0
  s_cselect_b32 s14, 0xffffff00, -1
  s_mov_b32 s15, 0
  s_mov_b32 s75, 0
  s_add_u32 s100, s68, s69
  s_mov_b32 s101, -1
  s_add_u32 s3, s68, s69
  s_and_b32 s3, s3, 3
  s_mov_b32 s100, 0x75463102
  s_mov_b32 s101, 0xfdceb98a
  s_cmp_eq_u32 s3, 1
  s_cselect_b32 s100, 0x65742130, s100
  s_cselect_b32 s101, 0xedfca9b8, s101
  s_cmp_eq_u32 s3, 2
  s_cselect_b32 s100, 0x68532410, s100
  s_cselect_b32 s101, 0xfedbac97, s101
  s_cmp_eq_u32 s3, 3
  s_cselect_b32 s100, 0x96435210, s100
  s_cselect_b32 s101, 0xfecbda87, s101
  s_mov_b32 s91, s69
  s_and_b32 s92, s69, 3
  s_add_u32 s92, s92, 1
  s_and_b32 s73, s100, 15
  s_cmp_eq_u32 s73, s91
  s_cselect_b32 s74, 4, 0
  s_lshr_b64 s[100:101], s[100:101], s74
  s_and_b32 s73, s100, 15
  s_sub_u32 s92, s92, 1
  s_cselect_b32 s73, s91, s73
  s_cselect_b32 s74, 0, 4
  s_lshr_b64 s[100:101], s[100:101], s74
  s_mul_i32 s74, s73, 393216
  s_lshl_b32 s73, s73, 7
  s_waitcnt lgkmcnt(0)
  s_mov_b32 s36, s12
  s_and_b32 s37, s13, 0xffff
  s_mov_b32 s38, 4194304
  s_mov_b32 s39, 0x00020000
  s_cmp_eq_u32 s96, 1
  s_cselect_b32 s38, 128, 0
  s_add_u32 s38, s38, 2048
  s_lshl_b32 s38, s38, 11
  s_mov_b32 s40, s18
  s_and_b32 s41, s19, 0xffff
  s_mov_b32 s42, 6291456
  s_mov_b32 s43, 0x00020000
  s_cmp_lg_u32 s96, 0
  s_cbranch_scc1 L_attn_ld1
  s_mov_b32 s48, s28
  s_and_b32 s49, s29, 0xffff
  s_mov_b32 s50, 7340032
  s_mov_b32 s51, 0x00020000
  s_cmp_eq_u32 s96, 0
  s_cselect_b32 s50, s50, 0
  s_and_b32 s3, s70, 3
  s_lshl_b32 s4, s2, 2
  s_add_u32 s3, s3, s4
  s_mul_i32 s98, s3, 3584
  s_add_u32 s98, s98, 0
  s_add_u32 s3, s75, s76
  s_add_u32 m0, s3, 0
  s_nop 0
  buffer_load_dwordx4 v4, s[36:39], s73 offen lds
  s_add_u32 m0, s3, 1024
  s_nop 0
  buffer_load_dwordx4 v5, s[36:39], s73 offen lds
  s_add_u32 m0, s3, 2048
  s_nop 0
  buffer_load_dwordx4 v6, s[36:39], s73 offen lds
  s_add_u32 m0, s3, 3072
  s_nop 0
  buffer_load_dwordx4 v7, s[36:39], s73 offen lds
  s_add_u32 m0, s78, s75
  s_mov_b64 exec, s[14:15]
  buffer_load_dwordx4 v28, s[36:39], s73 offen lds
  s_mov_b64 exec, -1
  s_add_u32 s3, s75, s77
  s_add_u32 m0, s3, 0
  s_add_u32 s4, s74, 0
  buffer_load_dwordx4 v8, s[40:43], s4 offen lds
  s_add_u32 m0, s3, 1024
  s_nop 0
  buffer_load_dwordx4 v9, s[40:43], s4 offen lds
  s_add_u32 m0, s3, 8192
  s_add_u32 s4, s74, 2048
  buffer_load_dwordx4 v8, s[40:43], s4 offen lds
  s_add_u32 m0, s3, 9216
  s_nop 0
  buffer_load_dwordx4 v9, s[40:43], s4 offen lds
  s_add_u32 m0, s3, 16384
  s_add_u32 s4, s74, 4096
  buffer_load_dwordx4 v8, s[40:43], s4 offen lds
  s_add_u32 m0, s3, 17408
  s_nop 0
  buffer_load_dwordx4 v9, s[40:43], s4 offen lds
  s_and_b32 s73, s100, 15
  s_cmp_eq_u32 s73, s91
  s_cselect_b32 s74, 4, 0
  s_lshr_b64 s[100:101], s[100:101], s74
  s_and_b32 s73, s100, 15
  s_sub_u32 s92, s92, 1
  s_cselect_b32 s73, s91, s73
  s_cselect_b32 s74, 0, 4
  s_lshr_b64 s[100:101], s[100:101], s74
  s_mul_i32 s74, s73, 393216
  s_lshl_b32 s73, s73, 7
  s_add_u32 s75, s75, 43008
  s_cmp_eq_u32 s75, 129024
  s_cselect_b32 s75, 0, s75
  s_add_u32 s3, s75, s76
  s_add_u32 m0, s3, 0
  s_nop 0
  buffer_load_dwordx4 v4, s[36:39], s73 offen lds
  s_add_u32 m0, s3, 1024
  s_nop 0
  buffer_load_dwordx4 v5, s[36:39], s73 offen lds
  s_add_u32 m0, s3, 2048
  s_nop 0
  buffer_load_dwordx4 v6, s[36:39], s73 offen lds
  s_add_u32 m0, s3, 3072
  s_nop 0
  buffer_load_dwordx4 v7, s[36:39], s73 offen lds
  s_add_u32 m0, s78, s75
  s_mov_b64 exec, s[14:15]
  buffer_load_dwordx4 v28, s[36:39], s73 offen lds
  s_mov_b64 exec, -1
  s_add_u32 s3, s75, s77
  s_add_u32 m0, s3, 0
  s_add_u32 s4, s74, 0
  buffer_load_dwordx4 v8, s[40:43], s4 offen lds
  s_add_u32 m0, s3, 1024
  s_nop 0
  buffer_load_dwordx4 v9, s[40:43], s4 offen lds
  s_add_u32 m0, s3, 8192
  s_add_u32 s4, s74, 2048
  buffer_load_dwordx4 v8, s[40:43], s4 offen lds
  s_add_u32 m0, s3, 9216
  s_nop 0
  buffer_load_dwordx4 v9, s[40:43], s4 offen lds
  s_add_u32 m0, s3, 16384
  s_add_u32 s4, s74, 4096
  buffer_load_dwordx4 v8, s[40:43], s4 offen lds
  s_add_u32 m0, s3, 17408
  s_nop 0
  buffer_load_dwordx4 v9, s[40:43], s4 offen lds
  s_and_b32 s73, s100, 15
  s_cmp_eq_u32 s73, s91
  s_cselect_b32 s74, 4, 0
  s_lshr_b64 s[100:101], s[100:101], s74
  s_and_b32 s73, s100, 15
  s_sub_u32 s92, s92, 1
  s_cselect_b32 s73, s91, s73
  s_cselect_b32 s74, 0, 4
  s_lshr_b64 s[100:101], s[100:101], s74
  s_mul_i32 s74, s73, 393216
  s_lshl_b32 s73, s73, 7
  s_add_u32 s75, s75, 43008
  s_cmp_eq_u32 s75, 129024
  s_cselect_b32 s75, 0, s75
  s_mov_b32 s52, s24
  s_and_b32 s53, s25, 0xffff
  s_mov_b32 s54, 7340032
  s_mov_b32 s55, 0x00020000
  s_min_u32 s3, s2, 223
  s_mul_i32 s4, s3, 4682
  s_lshr_b32 s4, s4, 16
  s_mul_i32 s5, s4, 14
  s_sub_u32 s3, s3, s5
  s_lshl_b32 s3, s3, 2
  s_and_b32 s5, s70, 3
  s_add_u32 s3, s3, s5
  s_mul_i32 s5, s4, 458752
  s_lshl_b32 s8, s3, 7
  s_add_u32 s95, s5, s8
  s_lshl_b32 s9, s4, 14
  s_lshl_b32 s8, s3, 8
  s_add_u32 s94, s9, s8
  v_lshrrev_b32 v2, 3, v1
  v_mul_u32_u24 v2, 7168, v2
  v_and_b32 v3, 7, v1
  v_lshl_add_u32 v26, v3, 4, v2
  buffer_load_dwordx4 v[64:67], v26, s[52:55], s95 offen
  s_add_u32 s95, s95, 57344
  buffer_load_dwordx4 v[68:71], v26, s[52:55], s95 offen
  s_add_u32 s95, s95, 57344
  s_and_b32 s3, s70, 3
  s_lshl_b32 s4, s2, 2
  s_add_u32 s3, s3, s4
  s_sub_u32 s4, 384, s40
  s_and_b32 s4, s4, 0x380
  s_mul_i32 s5, s3, 6144
  s_add_u32 s5, s5, s4
  s_buffer_load_dword s84, s[40:43], s5 offset:0
  s_buffer_load_dword s84, s[40:43], s5 offset:64
  s_buffer_load_dword s84, s[40:43], s5 offset:1024
  s_buffer_load_dword s84, s[40:43], s5 offset:1088
  s_buffer_load_dword s84, s[40:43], s5 offset:2048
  s_buffer_load_dword s84, s[40:43], s5 offset:2112
  s_buffer_load_dword s84, s[40:43], s5 offset:3072
  s_buffer_load_dword s84, s[40:43], s5 offset:3136
  s_buffer_load_dword s84, s[40:43], s5 offset:4096
  s_buffer_load_dword s84, s[40:43], s5 offset:4160
  s_buffer_load_dword s84, s[40:43], s5 offset:5120
  s_buffer_load_dword s84, s[40:43], s5 offset:5184
  s_add_u32 s56, s22, 24903680
  s_addc_u32 s57, s23, 0
  s_and_b32 s57, s57, 0xffff
  s_mov_b32 s58, 262144
  s_mov_b32 s59, 0x00020000
  s_and_b32 s3, s70, 3
  s_lshl2_add_u32 s4, s68, s3
  s_lshl_b32 s4, s4, 8
  v_lshrrev_b32 v2, 4, v1
  v_and_b32 v3, 15, v1
  v_lshl_add_u32 v3, v3, 4, s4
  v_lshl_add_u32 v18, v2, 14, v3
  s_lshl_b32 s4, s68, 5
  s_add_u32 s4, s4, s3
  s_sub_u32 s4, s4, 4
  s_max_i32 s4, s4, 0
  s_lshl_b32 s4, s4, 5
  v_lshrrev_b32 v2, 2, v1
  v_and_b32 v3, 3, v1
  v_lshl_add_u32 v3, v3, 3, s4
  v_lshl_add_u32 v19, v2, 14, v3
  s_lshl_b32 s3, s68, 2
  s_sub_u32 s3, s3, 4
  v_and_b32 v20, 7, v1
  v_add_u32 v20, s3, v20
  v_max_i32 v20, 0, v20
  v_lshlrev_b32 v20, 2, v20
  s_and_b32 s65, s65, 0xffff
  s_mov_b32 s66, 256
  s_mov_b32 s67, 0x00020000
  s_waitcnt vmcnt(13)
  s_barrier
  s_add_u32 s3, s75, s76
  s_add_u32 m0, s3, 0
  s_nop 0
  buffer_load_dwordx4 v4, s[36:39], s73 offen lds
  s_add_u32 m0, s3, 1024
  s_nop 0
  buffer_load_dwordx4 v5, s[36:39], s73 offen lds
  s_add_u32 m0, s3, 2048
  s_nop 0
  buffer_load_dwordx4 v6, s[36:39], s73 offen lds
  s_add_u32 m0, s3, 3072
  s_nop 0
  buffer_load_dwordx4 v7, s[36:39], s73 offen lds
  s_add_u32 m0, s78, s75
  s_mov_b64 exec, s[14:15]
  buffer_load_dwordx4 v28, s[36:39], s73 offen lds
  s_mov_b64 exec, -1
  s_add_u32 s3, s75, s77
  s_add_u32 m0, s3, 0
  s_add_u32 s4, s74, 0
  buffer_load_dwordx4 v8, s[40:43], s4 offen lds
  s_add_u32 m0, s3, 1024
  s_nop 0
  buffer_load_dwordx4 v9, s[40:43], s4 offen lds
  s_add_u32 m0, s3, 8192
  s_add_u32 s4, s74, 2048
  buffer_load_dwordx4 v8, s[40:43], s4 offen lds
  s_add_u32 m0, s3, 9216
  s_nop 0
  buffer_load_dwordx4 v9, s[40:43], s4 offen lds
  s_add_u32 m0, s3, 16384
  s_add_u32 s4, s74, 4096
  buffer_load_dwordx4 v8, s[40:43], s4 offen lds
  s_add_u32 m0, s3, 17408
  s_nop 0
  buffer_load_dwordx4 v9, s[40:43], s4 offen lds
  s_and_b32 s73, s100, 15
  s_cmp_eq_u32 s73, s91
  s_cselect_b32 s74, 4, 0
  s_lshr_b64 s[100:101], s[100:101], s74
  s_and_b32 s73, s100, 15
  s_sub_u32 s92, s92, 1
  s_cselect_b32 s73, s91, s73
  s_cselect_b32 s74, 0, 4
  s_lshr_b64 s[100:101], s[100:101], s74
  s_mul_i32 s74, s73, 393216
  s_lshl_b32 s73, s73, 7
  s_add_u32 s75, s75, 43008
  s_cmp_eq_u32 s75, 129024
  s_cselect_b32 s75, 0, s75
  s_buffer_load_dword s84, s[48:51], s98 offset:0
  s_buffer_load_dword s84, s[48:51], s98 offset:64
  s_buffer_load_dword s84, s[48:51], s98 offset:128
  s_buffer_load_dword s84, s[48:51], s98 offset:192
  s_add_u32 s98, s98, 256
  buffer_load_dwordx4 v[72:75], v26, s[52:55], s95 offen
  s_add_u32 s95, s95, 57344
  buffer_load_dwordx4 v[76:79], v26, s[52:55], s95 offen
  s_add_u32 s95, s95, 57344
  s_waitcnt vmcnt(15)
  s_barrier
  s_add_u32 s3, s75, s76
  s_add_u32 m0, s3, 0
  s_nop 0
  buffer_load_dwordx4 v4, s[36:39], s73 offen lds
  s_add_u32 m0, s3, 1024
  s_nop 0
  buffer_load_dwordx4 v5, s[36:39], s73 offen lds
  s_add_u32 m0, s3, 2048
  s_nop 0
  buffer_load_dwordx4 v6, s[36:39], s73 offen lds
  s_add_u32 m0, s3, 3072
  s_nop 0
  buffer_load_dwordx4 v7, s[36:39], s73 offen lds
  s_add_u32 m0, s78, s75
  s_mov_b64 exec, s[14:15]
  buffer_load_dwordx4 v28, s[36:39], s73 offen lds
  s_mov_b64 exec, -1
  s_add_u32 s3, s75, s77
  s_add_u32 m0, s3, 0
  s_add_u32 s4, s74, 0
  buffer_load_dwordx4 v8, s[40:43], s4 offen lds
  s_add_u32 m0, s3, 1024
  s_nop 0
  buffer_load_dwordx4 v9, s[40:43], s4 offen lds
  s_add_u32 m0, s3, 8192
  s_add_u32 s4, s74, 2048
  buffer_load_dwordx4 v8, s[40:43], s4 offen lds
  s_add_u32 m0, s3, 9216
  s_nop 0
  buffer_load_dwordx4 v9, s[40:43], s4 offen lds
  s_add_u32 m0, s3, 16384
  s_add_u32 s4, s74, 4096
  buffer_load_dwordx4 v8, s[40:43], s4 offen lds
  s_add_u32 m0, s3, 17408
  s_nop 0
  buffer_load_dwordx4 v9, s[40:43], s4 offen lds
  s_and_b32 s73, s100, 15
  s_cmp_eq_u32 s73, s91
  s_cselect_b32 s74, 4, 0
  s_lshr_b64 s[100:101], s[100:101], s74
  s_and_b32 s73, s100, 15
  s_sub_u32 s92, s92, 1
  s_cselect_b32 s73, s91, s73
  s_cselect_b32 s74, 0, 4
  s_lshr_b64 s[100:101], s[100:101], s74
  s_mul_i32 s74, s73, 393216
  s_lshl_b32 s73, s73, 7
  s_add_u32 s75, s75, 43008
  s_cmp_eq_u32 s75, 129024
  s_cselect_b32 s75, 0, s75
  s_buffer_load_dword s84, s[48:51], s98 offset:0
  s_buffer_load_dword s84, s[48:51], s98 offset:64
  s_buffer_load_dword s84, s[48:51], s98 offset:128
  s_buffer_load_dword s84, s[48:51], s98 offset:192
  s_add_u32 s98, s98, 256
  buffer_load_dwordx4 v[80:83], v26, s[52:55], s95 offen
  s_add_u32 s95, s95, 57344
  buffer_load_dwordx4 v[84:87], v26, s[52:55], s95 offen
  s_add_u32 s95, s95, 57344
  s_waitcnt vmcnt(15)
  s_barrier
  s_add_u32 s3, s75, s76
  s_add_u32 m0, s3, 0
  s_nop 0
  buffer_load_dwordx4 v4, s[36:39], s73 offen lds
  s_add_u32 m0, s3, 1024
  s_nop 0
  buffer_load_dwordx4 v5, s[36:39], s73 offen lds
  s_add_u32 m0, s3, 2048
  s_nop 0
  buffer_load_dwordx4 v6, s[36:39], s73 offen lds
  s_add_u32 m0, s3, 3072
  s_nop 0
  buffer_load_dwordx4 v7, s[36:39], s73 offen lds
  s_add_u32 m0, s78, s75
  s_mov_b64 exec, s[14:15]
  buffer_load_dwordx4 v28, s[36:39], s73 offen lds
  s_mov_b64 exec, -1
  s_add_u32 s3, s75, s77
  s_add_u32 m0, s3, 0
  s_add_u32 s4, s74, 0
  buffer_load_dwordx4 v8, s[40:43], s4 offen lds
  s_add_u32 m0, s3, 1024
  s_nop 0
  buffer_load_dwordx4 v9, s[40:43], s4 offen lds
  s_add_u32 m0, s3, 8192
  s_add_u32 s4, s74, 2048
  buffer_load_dwordx4 v8, s[40:43], s4 offen lds
  s_add_u32 m0, s3, 9216
  s_nop 0
  buffer_load_dwordx4 v9, s[40:43], s4 offen lds
  s_add_u32 m0, s3, 16384
  s_add_u32 s4, s74, 4096
  buffer_load_dwordx4 v8, s[40:43], s4 offen lds
  s_add_u32 m0, s3, 17408
  s_nop 0
  buffer_load_dwordx4 v9, s[40:43], s4 offen lds
  s_and_b32 s73, s100, 15
  s_cmp_eq_u32 s73, s91
  s_cselect_b32 s74, 4, 0
  s_lshr_b64 s[100:101], s[100:101], s74
  s_and_b32 s73, s100, 15
  s_sub_u32 s92, s92, 1
  s_cselect_b32 s73, s91, s73
  s_cselect_b32 s74, 0, 4
  s_lshr_b64 s[100:101], s[100:101], s74
  s_mul_i32 s74, s73, 393216
  s_lshl_b32 s73, s73, 7
  s_add_u32 s75, s75, 43008
  s_cmp_eq_u32 s75, 129024
  s_cselect_b32 s75, 0, s75
  s_buffer_load_dword s84, s[48:51], s98 offset:0
  s_buffer_load_dword s84, s[48:51], s98 offset:64
  s_buffer_load_dword s84, s[48:51], s98 offset:128
  s_buffer_load_dword s84, s[48:51], s98 offset:192
  s_add_u32 s98, s98, 256
  buffer_load_dwordx4 v[88:91], v26, s[52:55], s95 offen
  s_add_u32 s95, s95, 57344
  buffer_load_dwordx4 v[92:95], v26, s[52:55], s95 offen
  s_waitcnt vmcnt(15)
  s_barrier
  s_add_u32 s3, s75, s76
  s_add_u32 m0, s3, 0
  s_nop 0
  buffer_load_dwordx4 v4, s[36:39], s73 offen lds
  s_add_u32 m0, s3, 1024
  s_nop 0
  buffer_load_dwordx4 v5, s[36:39], s73 offen lds
  s_add_u32 m0, s3, 2048
  s_nop 0
  buffer_load_dwordx4 v6, s[36:39], s73 offen lds
  s_add_u32 m0, s3, 3072
  s_nop 0
  buffer_load_dwordx4 v7, s[36:39], s73 offen lds
  s_add_u32 m0, s78, s75
  s_mov_b64 exec, s[14:15]
  buffer_load_dwordx4 v28, s[36:39], s73 offen lds
  s_mov_b64 exec, -1
  s_add_u32 s3, s75, s77
  s_add_u32 m0, s3, 0
  s_add_u32 s4, s74, 0
  buffer_load_dwordx4 v8, s[40:43], s4 offen lds
  s_add_u32 m0, s3, 1024
  s_nop 0
  buffer_load_dwordx4 v9, s[40:43], s4 offen lds
  s_add_u32 m0, s3, 8192
  s_add_u32 s4, s74, 2048
  buffer_load_dwordx4 v8, s[40:43], s4 offen lds
  s_add_u32 m0, s3, 9216
  s_nop 0
  buffer_load_dwordx4 v9, s[40:43], s4 offen lds
  s_add_u32 m0, s3, 16384
  s_add_u32 s4, s74, 4096
  buffer_load_dwordx4 v8, s[40:43], s4 offen lds
  s_add_u32 m0, s3, 17408
  s_nop 0
  buffer_load_dwordx4 v9, s[40:43], s4 offen lds
  s_and_b32 s73, s100, 15
  s_cmp_eq_u32 s73, s91
  s_cselect_b32 s74, 4, 0
  s_lshr_b64 s[100:101], s[100:101], s74
  s_and_b32 s73, s100, 15
  s_sub_u32 s92, s92, 1
  s_cselect_b32 s73, s91, s73
  s_cselect_b32 s74, 0, 4
  s_lshr_b64 s[100:101], s[100:101], s74
  s_mul_i32 s74, s73, 393216
  s_lshl_b32 s73, s73, 7
  s_add_u32 s75, s75, 43008
  s_cmp_eq_u32 s75, 129024
  s_cselect_b32 s75, 0, s75
  s_buffer_load_dword s84, s[48:51], s98 offset:0
  s_buffer_load_dword s84, s[48:51], s98 offset:64
  s_buffer_load_dword s84, s[48:51], s98 offset:128
  s_buffer_load_dword s84, s[48:51], s98 offset:192
  s_add_u32 s98, s98, 256
  s_waitcnt vmcnt(13)
  s_barrier
  s_mov_b32 s79, 7
L_attn0_ld1:
  s_add_u32 s3, s75, s76
  s_add_u32 m0, s3, 0
  s_nop 0
  buffer_load_dwordx4 v4, s[36:39], s73 offen lds
  s_add_u32 m0, s3, 1024
  s_nop 0
  buffer_load_dwordx4 v5, s[36:39], s73 offen lds
  s_add_u32 m0, s3, 2048
  s_nop 0
  buffer_load_dwordx4 v6, s[36:39], s73 offen lds
  s_add_u32 m0, s3, 3072
  s_nop 0
  buffer_load_dwordx4 v7, s[36:39], s73 offen lds
  s_add_u32 m0, s78, s75
  s_mov_b64 exec, s[14:15]
  buffer_load_dwordx4 v28, s[36:39], s73 offen lds
  s_mov_b64 exec, -1
  s_add_u32 s3, s75, s77
  s_add_u32 m0, s3, 0
  s_add_u32 s4, s74, 0
  buffer_load_dwordx4 v8, s[40:43], s4 offen lds
  s_add_u32 m0, s3, 1024
  s_nop 0
  buffer_load_dwordx4 v9, s[40:43], s4 offen lds
  s_add_u32 m0, s3, 8192
  s_add_u32 s4, s74, 2048
  buffer_load_dwordx4 v8, s[40:43], s4 offen lds
  s_add_u32 m0, s3, 9216
  s_nop 0
  buffer_load_dwordx4 v9, s[40:43], s4 offen lds
  s_add_u32 m0, s3, 16384
  s_add_u32 s4, s74, 4096
  buffer_load_dwordx4 v8, s[40:43], s4 offen lds
  s_add_u32 m0, s3, 17408
  s_nop 0
  buffer_load_dwordx4 v9, s[40:43], s4 offen lds
  s_and_b32 s73, s100, 15
  s_cmp_eq_u32 s73, s91
  s_cselect_b32 s74, 4, 0
  s_lshr_b64 s[100:101], s[100:101], s74
  s_and_b32 s73, s100, 15
  s_sub_u32 s92, s92, 1
  s_cselect_b32 s73, s91, s73
  s_cselect_b32 s74, 0, 4
  s_lshr_b64 s[100:101], s[100:101], s74
  s_mul_i32 s74, s73, 393216
  s_lshl_b32 s73, s73, 7
  s_add_u32 s75, s75, 43008
  s_cmp_eq_u32 s75, 129024
  s_cselect_b32 s75, 0, s75
  s_buffer_load_dword s84, s[48:51], s98 offset:0
  s_buffer_load_dword s84, s[48:51], s98 offset:64
  s_buffer_load_dword s84, s[48:51], s98 offset:128
  s_buffer_load_dword s84, s[48:51], s98 offset:192
  s_add_u32 s98, s98, 256
  s_waitcnt vmcnt(11)
  s_barrier
  s_sub_u32 s79, s79, 1
  s_cmp_lg_u32 s79, 0
  s_cbranch_scc1 L_attn0_ld1
  s_add_u32 s3, s75, s76
  s_add_u32 m0, s3, 0
  s_nop 0
  buffer_load_dwordx4 v4, s[36:39], s73 offen lds
  s_add_u32 m0, s3, 1024
  s_nop 0
  buffer_load_dwordx4 v5, s[36:39], s73 offen lds
  s_add_u32 m0, s3, 2048
  s_nop 0
  buffer_load_dwordx4 v6, s[36:39], s73 offen lds
  s_add_u32 m0, s3, 3072
  s_nop 0
  buffer_load_dwordx4 v7, s[36:39], s73 offen lds
  s_add_u32 m0, s78, s75
  s_mov_b64 exec, s[14:15]
  buffer_load_dwordx4 v28, s[36:39], s73 offen lds
  s_mov_b64 exec, -1
  s_add_u32 s3, s75, s77
  s_add_u32 m0, s3, 0
  s_add_u32 s4, s74, 0
  buffer_load_dwordx4 v8, s[40:43], s4 offen lds
  s_add_u32 m0, s3, 1024
  s_nop 0
  buffer_load_dwordx4 v9, s[40:43], s4 offen lds
  s_add_u32 m0, s3, 8192
  s_add_u32 s4, s74, 2048
  buffer_load_dwordx4 v8, s[40:43], s4 offen lds
  s_add_u32 m0, s3, 9216
  s_nop 0
  buffer_load_dwordx4 v9, s[40:43], s4 offen lds
  s_add_u32 m0, s3, 16384
  s_add_u32 s4, s74, 4096
  buffer_load_dwordx4 v8, s[40:43], s4 offen lds
  s_add_u32 m0, s3, 17408
  s_nop 0
  buffer_load_dwordx4 v9, s[40:43], s4 offen lds
  s_and_b32 s73, s100, 15
  s_cmp_eq_u32 s73, s91
  s_cselect_b32 s74, 4, 0
  s_lshr_b64 s[100:101], s[100:101], s74
  s_and_b32 s73, s100, 15
  s_sub_u32 s92, s92, 1
  s_cselect_b32 s73, s91, s73
  s_cselect_b32 s74, 0, 4
  s_lshr_b64 s[100:101], s[100:101], s74
  s_mul_i32 s74, s73, 393216
  s_lshl_b32 s73, s73, 7
  s_add_u32 s75, s75, 43008
  s_cmp_eq_u32 s75, 129024
  s_cselect_b32 s75, 0, s75
  s_buffer_load_dword s84, s[48:51], s98 offset:0
  s_buffer_load_dword s84, s[48:51], s98 offset:64
  s_buffer_load_dword s84, s[48:51], s98 offset:128
  s_buffer_load_dword s84, s[48:51], s98 offset:192
  s_add_u32 s98, s98, 256
  buffer_load_dword v21, v20, s[64:67], 0 offen sc1
  s_waitcnt vmcnt(12)
  s_barrier
  s_add_u32 s3, s75, s76
  s_add_u32 m0, s3, 0
  s_nop 0
  buffer_load_dwordx4 v4, s[36:39], s73 offen lds
  s_add_u32 m0, s3, 1024
  s_nop 0
  buffer_load_dwordx4 v5, s[36:39], s73 offen lds
  s_add_u32 m0, s3, 2048
  s_nop 0
  buffer_load_dwordx4 v6, s[36:39], s73 offen lds
  s_add_u32 m0, s3, 3072
  s_nop 0
  buffer_load_dwordx4 v7, s[36:39], s73 offen lds
  s_add_u32 m0, s78, s75
  s_mov_b64 exec, s[14:15]
  buffer_load_dwordx4 v28, s[36:39], s73 offen lds
  s_mov_b64 exec, -1
  s_add_u32 s3, s75, s77
  s_add_u32 m0, s3, 0
  s_add_u32 s4, s74, 0
  buffer_load_dwordx4 v8, s[40:43], s4 offen lds
  s_add_u32 m0, s3, 1024
  s_nop 0
  buffer_load_dwordx4 v9, s[40:43], s4 offen lds
  s_add_u32 m0, s3, 8192
  s_add_u32 s4, s74, 2048
  buffer_load_dwordx4 v8, s[40:43], s4 offen lds
  s_add_u32 m0, s3, 9216
  s_nop 0
  buffer_load_dwordx4 v9, s[40:43], s4 offen lds
  s_add_u32 m0, s3, 16384
  s_add_u32 s4, s74, 4096
  buffer_load_dwordx4 v8, s[40:43], s4 offen lds
  s_add_u32 m0, s3, 17408
  s_nop 0
  buffer_load_dwordx4 v9, s[40:43], s4 offen lds
  s_and_b32 s73, s100, 15
  s_cmp_eq_u32 s73, s91
  s_cselect_b32 s74, 4, 0
  s_lshr_b64 s[100:101], s[100:101], s74
  s_and_b32 s73, s100, 15
  s_sub_u32 s92, s92, 1
  s_cselect_b32 s73, s91, s73
  s_cselect_b32 s74, 0, 4
  s_lshr_b64 s[100:101], s[100:101], s74
  s_mul_i32 s74, s73, 393216
  s_lshl_b32 s73, s73, 7
  s_add_u32 s75, s75, 43008
  s_cmp_eq_u32 s75, 129024
  s_cselect_b32 s75, 0, s75
  s_buffer_load_dword s84, s[48:51], s98 offset:0
  s_buffer_load_dword s84, s[48:51], s98 offset:64
  s_buffer_load_dword s84, s[48:51], s98 offset:128
  s_buffer_load_dword s84, s[48:51], s98 offset:192
  s_add_u32 s98, s98, 256
  s_waitcnt vmcnt(12)
  s_barrier
  s_add_u32 s3, s75, s76
  s_add_u32 m0, s3, 0
  s_nop 0
  buffer_load_dwordx4 v4, s[36:39], s73 offen lds
  s_add_u32 m0, s3, 1024
  s_nop 0
  buffer_load_dwordx4 v5, s[36:39], s73 offen lds
  s_add_u32 m0, s3, 2048
  s_nop 0
  buffer_load_dwordx4 v6, s[36:39], s73 offen lds
  s_add_u32 m0, s3, 3072
  s_nop 0
  buffer_load_dwordx4 v7, s[36:39], s73 offen lds
  s_add_u32 m0, s78, s75
  s_mov_b64 exec, s[14:15]
  buffer_load_dwordx4 v28, s[36:39], s73 offen lds
  s_mov_b64 exec, -1
  s_add_u32 s3, s75, s77
  s_add_u32 m0, s3, 0
  s_add_u32 s4, s74, 0
  buffer_load_dwordx4 v8, s[40:43], s4 offen lds
  s_add_u32 m0, s3, 1024
  s_nop 0
  buffer_load_dwordx4 v9, s[40:43], s4 offen lds
  s_add_u32 m0, s3, 8192
  s_add_u32 s4, s74, 2048
  buffer_load_dwordx4 v8, s[40:43], s4 offen lds
  s_add_u32 m0, s3, 9216
  s_nop 0
  buffer_load_dwordx4 v9, s[40:43], s4 offen lds
  s_add_u32 m0, s3, 16384
  s_add_u32 s4, s74, 4096
  buffer_load_dwordx4 v8, s[40:43], s4 offen lds
  s_add_u32 m0, s3, 17408
  s_nop 0
  buffer_load_dwordx4 v9, s[40:43], s4 offen lds
  s_and_b32 s73, s100, 15
  s_cmp_eq_u32 s73, s91
  s_cselect_b32 s74, 4, 0
  s_lshr_b64 s[100:101], s[100:101], s74
  s_and_b32 s73, s100, 15
  s_sub_u32 s92, s92, 1
  s_cselect_b32 s73, s91, s73
  s_cselect_b32 s74, 0, 4
  s_lshr_b64 s[100:101], s[100:101], s74
  s_mul_i32 s74, s73, 393216
  s_lshl_b32 s73, s73, 7
  s_add_u32 s75, s75, 43008
  s_cmp_eq_u32 s75, 129024
  s_cselect_b32 s75, 0, s75
  s_buffer_load_dword s84, s[48:51], s98 offset:0
  s_buffer_load_dword s84, s[48:51], s98 offset:64
  s_buffer_load_dword s84, s[48:51], s98 offset:128
  s_buffer_load_dword s84, s[48:51], s98 offset:192
  s_add_u32 s98, s98, 256
  s_waitcnt vmcnt(11)
  s_barrier
  s_mov_b32 s5, 0x100000
  L_attn_dchk:
  v_cmp_ne_u32 vcc, 0x01010101, v21
  s_cbranch_vccz L_attn_dok
  s_sub_u32 s5, s5, 1
  buffer_load_dword v21, v20, s[64:67], 0 offen sc1
  s_waitcnt vmcnt(0)
  s_cbranch_scc0 L_attn_dchk
  L_attn_dok:
  buffer_load_dwordx4 v[32:35], v18, s[56:59], 0 offen
  s_mov_b32 s3, 65536
  buffer_load_dwordx4 v[36:39], v18, s[56:59], s3 offen
  s_mov_b32 s3, 131072
  buffer_load_dwordx4 v[40:43], v18, s[56:59], s3 offen
  s_mov_b32 s3, 196608
  buffer_load_dwordx4 v[44:47], v18, s[56:59], s3 offen
  buffer_load_dwordx2 v[48:49], v19, s[56:59], 0 offen
  s_mov_b32 s60, s20
  s_and_b32 s61, s21, 0xffff
  s_mov_b32 s62, 2097152
  s_mov_b32 s63, 0x00020000
  s_and_b32 s3, s70, 3
  s_mul_i32 s3, s3, 8
  s_mul_i32 s4, s99, 32
  s_add_u32 s3, s3, s4
  v_lshrrev_b32 v2, 3, v1
  v_add_u32 v2, s3, v2
  v_mul_u32_u24 v2, 2048, v2
  v_and_b32 v3, 7, v1
  v_lshl_add_u32 v2, v3, 8, v2
  s_and_b32 s3, s2, 7
  s_lshr_b32 s3, s3, 2
  s_mul_i32 s3, s3, 128
  buffer_load_dword v96, v2, s[60:63], s3 offen
  s_waitcnt vmcnt(6)
  s_barrier
  s_mov_b32 s79, 0x4000
  s_waitcnt vmcnt(1)
L_attn_schk:
  v_pk_add_f32 v[32:33], v[32:33], v[36:37]
  v_pk_add_f32 v[34:35], v[34:35], v[38:39]
  v_pk_add_f32 v[40:41], v[40:41], v[44:45]
  v_pk_add_f32 v[42:43], v[42:43], v[46:47]
  v_pk_add_f32 v[32:33], v[32:33], v[40:41]
  v_pk_add_f32 v[34:35], v[34:35], v[42:43]
  s_nop 1
  v_permlane32_swap_b32 v32, v34
  v_permlane32_swap_b32 v33, v35
  v_pk_add_f32 v[32:33], v[32:33], v[34:35]
  v_cmp_u_f32 vcc, v32, v33
  v_cmp_u_f32 s[4:5], v48, v49
  s_or_b64 s[4:5], vcc, s[4:5]
  s_cbranch_scc0 L_attn_sok
  s_sub_u32 s79, s79, 1
  s_cbranch_scc1 L_attn_sok
  buffer_load_dwordx4 v[32:35], v18, s[56:59], 0 offen sc1
  s_mov_b32 s3, 65536
  buffer_load_dwordx4 v[36:39], v18, s[56:59], s3 offen sc1
  s_mov_b32 s3, 131072
  buffer_load_dwordx4 v[40:43], v18, s[56:59], s3 offen sc1
  s_mov_b32 s3, 196608
  buffer_load_dwordx4 v[44:47], v18, s[56:59], s3 offen sc1
  buffer_load_dwordx2 v[48:49], v19, s[56:59], 0 offen sc1
  s_waitcnt vmcnt(0)
  s_branch L_attn_schk
L_attn_sok:
  v_mov_b32 v34, v32
  v_mov_b32 v35, v33
  s_nop 0
  v_permlane16_swap_b32 v32, v34
  v_permlane16_swap_b32 v33, v35
  v_pk_add_f32 v[32:33], v[32:33], v[34:35]
  v_mul_f32 v32, 0x3a800000, v32
  v_mul_f32 v33, 0x3a800000, v33
  v_fma_f32 v33, -v32, v32, v33
  v_max_f32 v33, 0, v33
  v_add_f32 v33, 0x3727c5ac, v33
  v_rsq_f32 v33, v33
  s_nop 0
  s_and_b32 s3, s70, 3
  s_lshl_b32 s5, s3, 7
  s_add_u32 s5, s5, 129088
  v_and_b32 v3, 15, v1
  v_lshrrev_b32 v2, 5, v1
  v_lshl_add_u32 v2, v3, 1, v2
  v_lshl_add_u32 v2, v2, 2, s5
  ds_write2_b32 v2, v32, v33 offset0:0 offset1:160
  v_mov_b32 v50, v48
  v_mov_b32 v51, v49
  s_nop 0
  v_permlane32_swap_b32 v48, v50
  v_permlane32_swap_b32 v49, v51
  v_pk_add_f32 v[48:49], v[48:49], v[50:51]
  v_mov_b32 v50, v48
  v_mov_b32 v51, v49
  s_nop 0
  v_permlane16_swap_b32 v48, v50
  v_permlane16_swap_b32 v49, v51
  v_pk_add_f32 v[48:49], v[48:49], v[50:51]
  s_nop 1
  v_add_f32_dpp v48, v48, v48 row_ror:8 row_mask:0xf bank_mask:0xf
  v_add_f32_dpp v49, v49, v49 row_ror:8 row_mask:0xf bank_mask:0xf
  s_nop 1
  v_add_f32_dpp v48, v48, v48 row_ror:4 row_mask:0xf bank_mask:0xf
  v_add_f32_dpp v49, v49, v49 row_ror:4 row_mask:0xf bank_mask:0xf
  v_mul_f32 v48, 0x3a800000, v48
  v_mul_f32 v49, 0x3a800000, v49
  v_fma_f32 v49, -v48, v48, v49
  v_max_f32 v49, 0, v49
  v_add_f32 v49, 0x3727c5ac, v49
  v_rsq_f32 v49, v49
  s_nop 0
  s_lshl_b32 s5, s3, 4
  s_add_u32 s5, s5, 129024
  v_and_b32 v3, 3, v1
  v_lshl_add_u32 v2, v3, 2, s5
  ds_write2_b32 v2, v48, v49 offset0:0 offset1:160
  s_waitcnt lgkmcnt(0)
  s_barrier
  s_barrier
  s_branch L_attn_ldend
L_attn_ld1:
  s_add_u32 s3, s68, s69
  s_and_b32 s3, s3, 3
  s_mov_b32 s100, 0x68532410
  s_mov_b32 s101, 0xfedbac97
  s_cmp_eq_u32 s3, 1
  s_cselect_b32 s100, 0x96435210, s100
  s_cselect_b32 s101, 0xfecbda87, s101
  s_cmp_eq_u32 s3, 2
  s_cselect_b32 s100, 0x75463210, s100
  s_cselect_b32 s101, 0xfdceb98a, s101
  s_cmp_eq_u32 s3, 3
  s_cselect_b32 s100, 0x65743210, s100
  s_cselect_b32 s101, 0xedfca9b8, s101
  s_add_u32 s56, s22, 24379392
  s_addc_u32 s57, s23, 0
  s_and_b32 s57, s57, 0xffff
  s_mov_b32 s58, 262144
  s_mov_b32 s59, 0x00020000
  s_and_b32 s3, s70, 3
  s_lshl2_add_u32 s4, s68, s3
  s_lshl_b32 s4, s4, 8
  v_lshrrev_b32 v2, 4, v1
  v_and_b32 v3, 15, v1
  v_lshl_add_u32 v3, v3, 4, s4
  v_lshl_add_u32 v18, v2, 14, v3
  s_lshl_b32 s4, s68, 5
  s_add_u32 s4, s4, s3
  s_sub_u32 s4, s4, 4
  s_max_i32 s4, s4, 0
  s_lshl_b32 s4, s4, 5
  v_lshrrev_b32 v2, 2, v1
  v_and_b32 v3, 3, v1
  v_lshl_add_u32 v3, v3, 3, s4
  v_lshl_add_u32 v19, v2, 14, v3
  s_lshr_b32 s3, s69, 3
  s_and_b32 s73, s69, 7
  s_lshl1_add_u32 s91, s73, s3
  s_mul_i32 s74, s91, 393216
  s_lshl_b32 s73, s91, 7
  s_mov_b32 s88, s73
  s_add_u32 m0, s77, 0
  s_add_u32 s4, s74, 0
  buffer_load_dwordx4 v8, s[40:43], s4 offen lds
  s_add_u32 m0, s77, 1024
  s_nop 0
  buffer_load_dwordx4 v9, s[40:43], s4 offen lds
  s_add_u32 m0, s77, 8192
  s_add_u32 s4, s74, 2048
  buffer_load_dwordx4 v8, s[40:43], s4 offen lds
  s_add_u32 m0, s77, 9216
  s_nop 0
  buffer_load_dwordx4 v9, s[40:43], s4 offen lds
  s_add_u32 m0, s77, 16384
  s_add_u32 s4, s74, 4096
  buffer_load_dwordx4 v8, s[40:43], s4 offen lds
  s_add_u32 m0, s77, 17408
  s_nop 0
  buffer_load_dwordx4 v9, s[40:43], s4 offen lds
  s_and_b32 s73, s100, 15
  s_cmp_eq_u32 s73, s91
  s_cselect_b32 s74, 4, 0
  s_lshr_b64 s[100:101], s[100:101], s74
  s_and_b32 s73, s100, 15
  s_lshr_b64 s[100:101], s[100:101], 4
  s_mul_i32 s74, s73, 393216
  s_lshl_b32 s73, s73, 7
  s_mov_b32 s75, 0
  s_add_u32 s44, s22, 41943040
  s_addc_u32 s45, s23, 0
  s_and_b32 s45, s45, 0xffff
  s_mov_b32 s46, 524288
  s_mov_b32 s47, 0x00020000
  s_lshl4_add_u32 s3, s97, s68
  s_and_b32 s4, s69, 15
  s_lshl4_add_u32 s3, s3, s4
  s_lshl_b32 s3, s3, 7
  s_sub_u32 s3, s3, 32768
  v_lshlrev_b32 v11, 7, v1
  s_cmp_eq_u32 s68, 0
  s_cselect_b32 s4, 15, 31
  v_and_b32 v2, 16, v1
  v_lshl_add_u32 v11, v2, 2, v11
  v_and_b32 v2, s4, v1
  v_lshlrev_b32 v2, 2, v2
  v_mov_b32 v3, 1
  s_mov_b32 s79, 0x100000
  s_waitcnt vmcnt(0)
  s_cmp_lg_u32 s70, 4
  s_barrier
  s_cbranch_scc1 L_attn_nofl
  s_mov_b32 exec_lo, 0xffffffff
  s_mov_b32 exec_hi, 0
  buffer_store_dword v3, v11, s[44:47], s87 offen sc1
  s_mov_b64 exec, -1
L_attn_nofl:
  s_mov_b32 s5, s3
  s_mov_b32 s89, s73
  s_add_u32 m0, s77, 43008
  s_add_u32 s4, s74, 0
  buffer_load_dwordx4 v8, s[40:43], s4 offen lds
  s_add_u32 m0, s77, 44032
  s_nop 0
  buffer_load_dwordx4 v9, s[40:43], s4 offen lds
  s_add_u32 m0, s77, 51200
  s_add_u32 s4, s74, 2048
  buffer_load_dwordx4 v8, s[40:43], s4 offen lds
  s_add_u32 m0, s77, 52224
  s_nop 0
  buffer_load_dwordx4 v9, s[40:43], s4 offen lds
  s_add_u32 m0, s77, 59392
  s_add_u32 s4, s74, 4096
  buffer_load_dwordx4 v8, s[40:43], s4 offen lds
  s_add_u32 m0, s77, 60416
  s_nop 0
  buffer_load_dwordx4 v9, s[40:43], s4 offen lds
  s_and_b32 s73, s100, 15
  s_cmp_eq_u32 s73, s91
  s_cselect_b32 s74, 4, 0
  s_lshr_b64 s[100:101], s[100:101], s74
  s_and_b32 s73, s100, 15
  s_lshr_b64 s[100:101], s[100:101], 4
  s_mul_i32 s74, s73, 393216
  s_lshl_b32 s73, s73, 7
  s_mov_b32 s90, s73
  s_add_u32 m0, s77, 86016
  s_add_u32 s4, s74, 0
  buffer_load_dwordx4 v8, s[40:43], s4 offen lds
  s_add_u32 m0, s77, 87040
  s_nop 0
  buffer_load_dwordx4 v9, s[40:43], s4 offen lds
  s_add_u32 m0, s77, 94208
  s_add_u32 s4, s74, 2048
  buffer_load_dwordx4 v8, s[40:43], s4 offen lds
  s_add_u32 m0, s77, 95232
  s_nop 0
  buffer_load_dwordx4 v9, s[40:43], s4 offen lds
  s_add_u32 m0, s77, 102400
  s_add_u32 s4, s74, 4096
  buffer_load_dwordx4 v8, s[40:43], s4 offen lds
  s_add_u32 m0, s77, 103424
  s_nop 0
  buffer_load_dwordx4 v9, s[40:43], s4 offen lds
  s_and_b32 s73, s100, 15
  s_cmp_eq_u32 s73, s91
  s_cselect_b32 s74, 4, 0
  s_lshr_b64 s[100:101], s[100:101], s74
  s_and_b32 s73, s100, 15
  s_lshr_b64 s[100:101], s[100:101], 4
  s_mul_i32 s74, s73, 393216
  s_lshl_b32 s73, s73, 7
  s_mov_b32 s3, s5
  s_cmp_lg_u32 s70, 4
  s_cbranch_scc1 L_attn_dep
L_attn_poll:
  buffer_load_dword v3, v2, s[44:47], s3 offen sc1
  s_sub_u32 s79, s79, 1
  s_cbranch_scc1 L_attn_dep
  s_waitcnt vmcnt(0)
  v_cmp_ne_u32 vcc, 1, v3
  s_cbranch_vccnz L_attn_poll
L_attn_dep:
  s_barrier
  s_add_u32 m0, s78, 89344
  s_mov_b64 exec, s[14:15]
  buffer_load_dwordx4 v28, s[36:39], s88 offen lds
  s_mov_b64 exec, -1
  s_add_u32 m0, s76, 43008
  s_nop 0
  buffer_load_dwordx4 v4, s[36:39], s89 offen lds
  s_add_u32 m0, s76, 44032
  s_nop 0
  buffer_load_dwordx4 v5, s[36:39], s89 offen lds
  s_add_u32 m0, s76, 45056
  s_nop 0
  buffer_load_dwordx4 v6, s[36:39], s89 offen lds
  s_add_u32 m0, s76, 46080
  s_nop 0
  buffer_load_dwordx4 v7, s[36:39], s89 offen lds
  s_add_u32 m0, s78, 43008
  s_mov_b64 exec, s[14:15]
  buffer_load_dwordx4 v28, s[36:39], s89 offen lds
  s_mov_b64 exec, -1
  s_add_u32 m0, s76, 86016
  s_nop 0
  buffer_load_dwordx4 v4, s[36:39], s90 offen lds
  s_add_u32 m0, s76, 87040
  s_nop 0
  buffer_load_dwordx4 v5, s[36:39], s90 offen lds
  s_add_u32 m0, s76, 88064
  s_nop 0
  buffer_load_dwordx4 v6, s[36:39], s90 offen lds
  s_add_u32 m0, s76, 89088
  s_nop 0
  buffer_load_dwordx4 v7, s[36:39], s90 offen lds
  s_add_u32 m0, s78, 86016
  s_mov_b64 exec, s[14:15]
  buffer_load_dwordx4 v28, s[36:39], s90 offen lds
  s_mov_b64 exec, -1
  s_waitcnt vmcnt(5)
  s_barrier
  s_mov_b32 s79, 12
L_attn1_ld1:
  s_add_u32 s3, s75, s76
  s_add_u32 m0, s3, 0
  s_nop 0
  buffer_load_dwordx4 v4, s[36:39], s73 offen lds
  s_add_u32 m0, s3, 1024
  s_nop 0
  buffer_load_dwordx4 v5, s[36:39], s73 offen lds
  s_add_u32 m0, s3, 2048
  s_nop 0
  buffer_load_dwordx4 v6, s[36:39], s73 offen lds
  s_add_u32 m0, s3, 3072
  s_nop 0
  buffer_load_dwordx4 v7, s[36:39], s73 offen lds
  s_add_u32 m0, s78, s75
  s_mov_b64 exec, s[14:15]
  buffer_load_dwordx4 v28, s[36:39], s73 offen lds
  s_mov_b64 exec, -1
  s_add_u32 s3, s75, s77
  s_add_u32 m0, s3, 0
  s_add_u32 s4, s74, 0
  buffer_load_dwordx4 v8, s[40:43], s4 offen lds
  s_add_u32 m0, s3, 1024
  s_nop 0
  buffer_load_dwordx4 v9, s[40:43], s4 offen lds
  s_add_u32 m0, s3, 8192
  s_add_u32 s4, s74, 2048
  buffer_load_dwordx4 v8, s[40:43], s4 offen lds
  s_add_u32 m0, s3, 9216
  s_nop 0
  buffer_load_dwordx4 v9, s[40:43], s4 offen lds
  s_add_u32 m0, s3, 16384
  s_add_u32 s4, s74, 4096
  buffer_load_dwordx4 v8, s[40:43], s4 offen lds
  s_add_u32 m0, s3, 17408
  s_nop 0
  buffer_load_dwordx4 v9, s[40:43], s4 offen lds
  s_and_b32 s73, s100, 15
  s_cmp_eq_u32 s73, s91
  s_cselect_b32 s74, 4, 0
  s_lshr_b64 s[100:101], s[100:101], s74
  s_and_b32 s73, s100, 15
  s_lshr_b64 s[100:101], s[100:101], 4
  s_mul_i32 s74, s73, 393216
  s_lshl_b32 s73, s73, 7
  s_add_u32 s75, s75, 43008
  s_cmp_eq_u32 s75, 129024
  s_cselect_b32 s75, 0, s75
  s_waitcnt vmcnt(11)
  s_barrier
  s_sub_u32 s79, s79, 1
  s_cmp_lg_u32 s79, 0
  s_cbranch_scc1 L_attn1_ld1
  s_add_u32 s3, s75, s76
  s_add_u32 m0, s3, 0
  s_nop 0
  buffer_load_dwordx4 v4, s[36:39], s73 offen lds
  s_add_u32 m0, s3, 1024
  s_nop 0
  buffer_load_dwordx4 v5, s[36:39], s73 offen lds
  s_add_u32 m0, s3, 2048
  s_nop 0
  buffer_load_dwordx4 v6, s[36:39], s73 offen lds
  s_add_u32 m0, s3, 3072
  s_nop 0
  buffer_load_dwordx4 v7, s[36:39], s73 offen lds
  s_add_u32 m0, s78, s75
  s_mov_b64 exec, s[14:15]
  buffer_load_dwordx4 v28, s[36:39], s73 offen lds
  s_mov_b64 exec, -1
  s_add_u32 s3, s75, s77
  s_add_u32 m0, s3, 0
  s_add_u32 s4, s74, 0
  buffer_load_dwordx4 v8, s[40:43], s4 offen lds
  s_add_u32 m0, s3, 1024
  s_nop 0
  buffer_load_dwordx4 v9, s[40:43], s4 offen lds
  s_add_u32 m0, s3, 8192
  s_add_u32 s4, s74, 2048
  buffer_load_dwordx4 v8, s[40:43], s4 offen lds
  s_add_u32 m0, s3, 9216
  s_nop 0
  buffer_load_dwordx4 v9, s[40:43], s4 offen lds
  s_add_u32 m0, s3, 16384
  s_add_u32 s4, s74, 4096
  buffer_load_dwordx4 v8, s[40:43], s4 offen lds
  s_add_u32 m0, s3, 17408
  s_nop 0
  buffer_load_dwordx4 v9, s[40:43], s4 offen lds
  s_and_b32 s73, s100, 15
  s_cmp_eq_u32 s73, s91
  s_cselect_b32 s74, 4, 0
  s_lshr_b64 s[100:101], s[100:101], s74
  s_and_b32 s73, s100, 15
  s_lshr_b64 s[100:101], s[100:101], 4
  s_mul_i32 s74, s73, 393216
  s_lshl_b32 s73, s73, 7
  s_add_u32 s75, s75, 43008
  s_cmp_eq_u32 s75, 129024
  s_cselect_b32 s75, 0, s75
  s_mov_b32 s60, s20
  s_and_b32 s61, s21, 0xffff
  s_mov_b32 s62, 2097152
  s_mov_b32 s63, 0x00020000
  s_and_b32 s3, s70, 3
  s_mul_i32 s3, s3, 8
  s_mul_i32 s4, s99, 32
  s_add_u32 s3, s3, s4
  v_lshrrev_b32 v2, 3, v1
  v_add_u32 v2, s3, v2
  v_mul_u32_u24 v2, 2048, v2
  v_and_b32 v3, 7, v1
  v_lshl_add_u32 v2, v3, 8, v2
  s_and_b32 s3, s2, 7
  s_lshr_b32 s3, s3, 2
  s_mul_i32 s3, s3, 128
  buffer_load_dword v96, v2, s[60:63], s3 offen
  s_waitcnt vmcnt(12)
  s_barrier
  buffer_load_dwordx4 v[32:35], v18, s[56:59], 0 offen
  s_mov_b32 s3, 65536
  buffer_load_dwordx4 v[36:39], v18, s[56:59], s3 offen
  s_mov_b32 s3, 131072
  buffer_load_dwordx4 v[40:43], v18, s[56:59], s3 offen
  s_mov_b32 s3, 196608
  buffer_load_dwordx4 v[44:47], v18, s[56:59], s3 offen
  buffer_load_dwordx2 v[48:49], v19, s[56:59], 0 offen
  s_waitcnt vmcnt(6)
  s_barrier
  s_waitcnt vmcnt(0)
  v_pk_add_f32 v[32:33], v[32:33], v[36:37]
  v_pk_add_f32 v[34:35], v[34:35], v[38:39]
  v_pk_add_f32 v[40:41], v[40:41], v[44:45]
  v_pk_add_f32 v[42:43], v[42:43], v[46:47]
  v_pk_add_f32 v[32:33], v[32:33], v[40:41]
  v_pk_add_f32 v[34:35], v[34:35], v[42:43]
  s_nop 1
  v_permlane32_swap_b32 v32, v34
  v_permlane32_swap_b32 v33, v35
  v_pk_add_f32 v[32:33], v[32:33], v[34:35]
  v_mov_b32 v34, v32
  v_mov_b32 v35, v33
  s_nop 0
  v_permlane16_swap_b32 v32, v34
  v_permlane16_swap_b32 v33, v35
  v_pk_add_f32 v[32:33], v[32:33], v[34:35]
  v_mul_f32 v32, 0x3a800000, v32
  v_mul_f32 v33, 0x3a800000, v33
  v_fma_f32 v33, -v32, v32, v33
  v_max_f32 v33, 0, v33
  v_add_f32 v33, 0x3727c5ac, v33
  v_rsq_f32 v33, v33
  s_nop 0
  s_and_b32 s3, s70, 3
  s_lshl_b32 s5, s3, 7
  s_add_u32 s5, s5, 129088
  v_and_b32 v3, 15, v1
  v_lshrrev_b32 v2, 5, v1
  v_lshl_add_u32 v2, v3, 1, v2
  v_lshl_add_u32 v2, v2, 2, s5
  ds_write2_b32 v2, v32, v33 offset0:0 offset1:160
  v_mov_b32 v50, v48
  v_mov_b32 v51, v49
  s_nop 0
  v_permlane32_swap_b32 v48, v50
  v_permlane32_swap_b32 v49, v51
  v_pk_add_f32 v[48:49], v[48:49], v[50:51]
  v_mov_b32 v50, v48
  v_mov_b32 v51, v49
  s_nop 0
  v_permlane16_swap_b32 v48, v50
  v_permlane16_swap_b32 v49, v51
  v_pk_add_f32 v[48:49], v[48:49], v[50:51]
  s_nop 1
  v_add_f32_dpp v48, v48, v48 row_ror:8 row_mask:0xf bank_mask:0xf
  v_add_f32_dpp v49, v49, v49 row_ror:8 row_mask:0xf bank_mask:0xf
  s_nop 1
  v_add_f32_dpp v48, v48, v48 row_ror:4 row_mask:0xf bank_mask:0xf
  v_add_f32_dpp v49, v49, v49 row_ror:4 row_mask:0xf bank_mask:0xf
  v_mul_f32 v48, 0x3a800000, v48
  v_mul_f32 v49, 0x3a800000, v49
  v_fma_f32 v49, -v48, v48, v49
  v_max_f32 v49, 0, v49
  v_add_f32 v49, 0x3727c5ac, v49
  v_rsq_f32 v49, v49
  s_nop 0
  s_lshl_b32 s5, s3, 4
  s_add_u32 s5, s5, 129024
  v_and_b32 v3, 3, v1
  v_lshl_add_u32 v2, v3, 2, s5
  ds_write2_b32 v2, v48, v49 offset0:0 offset1:160
  s_waitcnt lgkmcnt(0)
  s_barrier
  s_barrier
L_attn_ldend:
  s_lshl_b32 s87, s97, 15
  s_lshl_b32 s4, s68, 11
  s_add_u32 s87, s87, s4
  s_lshl_b32 s4, s69, 2
  s_add_u32 s87, s87, s4
  s_add_u32 s97, s97, 1
  s_branch L_wo_body
L_attn_end:
  s_endpgm
L_attn_compute:
  s_and_b32 s71, s70, 1
  s_lshr_b32 s72, s70, 1
  v_and_b32 v3, 31, v1
  v_lshlrev_b32 v3, 2, v3
  v_add_u32 v3, 40960, v3
  v_mov_b32 v236, 0x3f803f80
  v_mov_b32 v237, 0x3f803f80
  v_mov_b32 v238, 0x3f803f80
  v_mov_b32 v239, 0x3f803f80
  ds_write_b32 v3, v236
  ds_write_b32 v3, v236 offset:43008
  v_add_u32 v3, 86016, v3
  ds_write_b32 v3, v236
  ds_write_b32 v3, v236 offset:3328
  v_and_b32 v3, 15, v1
  v_lshrrev_b32 v2, 4, v1
  v_lshrrev_b32 v33, 1, v3
  s_lshl_b32 s8, s71, 13
  v_xor_b32 v4, v2, v33
  v_lshlrev_b32 v4, 4, v4
  v_lshl_add_u32 v4, v3, 7, v4
  v_add_u32 v8, 40960, v4
  v_add_u32 v4, s8, v4
  v_add_u32 v5, 4, v2
  v_xor_b32 v5, v5, v33
  v_lshlrev_b32 v5, 4, v5
  v_lshl_add_u32 v5, v3, 7, v5
  v_add_u32 v9, 40960, v5
  v_add_u32 v5, s8, v5
  v_bfe_u32 v34, v1, 2, 2
  v_lshl_add_u32 v34, v2, 3, v34
  v_lshlrev_b32 v34, 7, v34
  v_and_b32 v33, 3, v1
  v_lshl_add_u32 v34, v33, 3, v34
  v_bfe_u32 v33, v1, 3, 2
  v_lshl_add_u32 v34, v33, 5, v34
  s_lshl_b32 s8, s70, 5
  v_xor_b32 v34, s8, v34
  v_add_u32 v6, 16384, v34
  v_xor_b32 v7, 32, v6
  s_mov_b32 s75, 0
  v_add_u32_e64 v10, s75, v4
  v_add_u32_e64 v11, s75, v5
  v_add_u32_e64 v12, s75, v6
  v_add_u32_e64 v13, s75, v7
  v_add_u32_e64 v14, s75, v8
  v_add_u32_e64 v15, s75, v9
  s_add_u32 s75, s75, 43008
  s_cmp_eq_u32 s75, 129024
  s_cselect_b32 s75, 0, s75
  s_and_b32 s79, s69, 3
  s_add_u32 s79, s79, 1
  s_mul_i32 s98, s96, 3
  s_cmp_eq_u32 s96, 0
  s_cbranch_scc1 L_attn_nog
  s_mov_b32 s79, 15
  ds_read_b128 v[32:35], v10 offset:0
  ds_read_b128 v[36:39], v10 offset:2048
  ds_read_b128 v[40:43], v10 offset:4096
  ds_read_b128 v[44:47], v10 offset:6144
  ds_read_b64_tr_b16 v[52:53], v12 offset:0
  ds_read_b64_tr_b16 v[54:55], v12 offset:512
  ds_read_b64_tr_b16 v[56:57], v13 offset:0
  ds_read_b64_tr_b16 v[58:59], v13 offset:512
  ds_read_b64_tr_b16 v[60:61], v12 offset:8192
  ds_read_b64_tr_b16 v[62:63], v12 offset:8704
  ds_read_b64_tr_b16 v[64:65], v13 offset:8192
  ds_read_b64_tr_b16 v[66:67], v13 offset:8704
  ds_read_b64_tr_b16 v[68:69], v12 offset:16384
  ds_read_b64_tr_b16 v[70:71], v12 offset:16896
  ds_read_b64_tr_b16 v[72:73], v13 offset:16384
  ds_read_b64_tr_b16 v[74:75], v13 offset:16896
  s_waitcnt lgkmcnt(0)
  v_mfma_f32_16x16x32_bf16 v[128:131], v[52:55], v[32:35], 0
  ds_read_b128 v[76:79], v11 offset:0
  v_mfma_f32_16x16x32_bf16 v[132:135], v[52:55], v[36:39], 0
  ds_read_b128 v[80:83], v11 offset:2048
  v_mfma_f32_16x16x32_bf16 v[136:139], v[52:55], v[40:43], 0
  ds_read_b128 v[84:87], v11 offset:4096
  v_mfma_f32_16x16x32_bf16 v[140:143], v[52:55], v[44:47], 0
  ds_read_b128 v[88:91], v11 offset:6144
  v_mfma_f32_16x16x32_bf16 v[156:159], v[56:59], v[44:47], 0
  ds_read_b64_tr_b16 v[96:97], v12 offset:4096
  v_mfma_f32_16x16x32_bf16 v[152:155], v[56:59], v[40:43], 0
  ds_read_b64_tr_b16 v[98:99], v12 offset:4608
  v_mfma_f32_16x16x32_bf16 v[148:151], v[56:59], v[36:39], 0
  ds_read_b64_tr_b16 v[100:101], v13 offset:4096
  v_mfma_f32_16x16x32_bf16 v[144:147], v[56:59], v[32:35], 0
  ds_read_b64_tr_b16 v[102:103], v13 offset:4608
  v_mfma_f32_16x16x32_bf16 v[160:163], v[60:63], v[32:35], 0
  ds_read_b64_tr_b16 v[104:105], v12 offset:12288
  v_mfma_f32_16x16x32_bf16 v[164:167], v[60:63], v[36:39], 0
  ds_read_b64_tr_b16 v[106:107], v12 offset:12800
  v_mfma_f32_16x16x32_bf16 v[168:171], v[60:63], v[40:43], 0
  ds_read_b64_tr_b16 v[108:109], v13 offset:12288
  v_mfma_f32_16x16x32_bf16 v[172:175], v[60:63], v[44:47], 0
  ds_read_b64_tr_b16 v[110:111], v13 offset:12800
  v_mfma_f32_16x16x32_bf16 v[188:191], v[64:67], v[44:47], 0
  ds_read_b64_tr_b16 v[112:113], v12 offset:20480
  v_mfma_f32_16x16x32_bf16 v[184:187], v[64:67], v[40:43], 0
  ds_read_b64_tr_b16 v[114:115], v12 offset:20992
  v_mfma_f32_16x16x32_bf16 v[180:183], v[64:67], v[36:39], 0
  ds_read_b64_tr_b16 v[116:117], v13 offset:20480
  v_mfma_f32_16x16x32_bf16 v[176:179], v[64:67], v[32:35], 0
  ds_read_b64_tr_b16 v[118:119], v13 offset:20992
  v_mfma_f32_16x16x32_bf16 v[192:195], v[32:35], v[68:71], 0
  v_add_u32_e64 v10, s75, v4
  v_mfma_f32_16x16x32_bf16 v[196:199], v[36:39], v[68:71], 0
  v_add_u32_e64 v11, s75, v5
  v_mfma_f32_16x16x32_bf16 v[200:203], v[40:43], v[68:71], 0
  v_add_u32_e64 v12, s75, v6
  v_mfma_f32_16x16x32_bf16 v[204:207], v[44:47], v[68:71], 0
  v_add_u32_e64 v13, s75, v7
  v_mfma_f32_16x16x32_bf16 v[220:223], v[44:47], v[72:75], 0
  v_add_u32_e64 v14, s75, v8
  v_mfma_f32_16x16x32_bf16 v[216:219], v[40:43], v[72:75], 0
  v_add_u32_e64 v15, s75, v9
  v_mfma_f32_16x16x32_bf16 v[212:215], v[36:39], v[72:75], 0
  s_add_u32 s75, s75, 43008
  v_mfma_f32_16x16x32_bf16 v[208:211], v[32:35], v[72:75], 0
  s_cmp_eq_u32 s75, 129024
  s_cselect_b32 s75, 0, s75
  s_waitcnt lgkmcnt(0)
  v_mfma_f32_16x16x32_bf16 v[128:131], v[96:99], v[76:79], v[128:131]
  v_mfma_f32_16x16x32_bf16 v[132:135], v[96:99], v[80:83], v[132:135]
  v_mfma_f32_16x16x32_bf16 v[136:139], v[96:99], v[84:87], v[136:139]
  v_mfma_f32_16x16x32_bf16 v[140:143], v[96:99], v[88:91], v[140:143]
  v_mfma_f32_16x16x32_bf16 v[156:159], v[100:103], v[88:91], v[156:159]
  v_mfma_f32_16x16x32_bf16 v[152:155], v[100:103], v[84:87], v[152:155]
  v_mfma_f32_16x16x32_bf16 v[148:151], v[100:103], v[80:83], v[148:151]
  v_mfma_f32_16x16x32_bf16 v[144:147], v[100:103], v[76:79], v[144:147]
  v_mfma_f32_16x16x32_bf16 v[160:163], v[104:107], v[76:79], v[160:163]
  v_mfma_f32_16x16x32_bf16 v[164:167], v[104:107], v[80:83], v[164:167]
  v_mfma_f32_16x16x32_bf16 v[168:171], v[104:107], v[84:87], v[168:171]
  v_mfma_f32_16x16x32_bf16 v[172:175], v[104:107], v[88:91], v[172:175]
  v_mfma_f32_16x16x32_bf16 v[188:191], v[108:111], v[88:91], v[188:191]
  v_mfma_f32_16x16x32_bf16 v[184:187], v[108:111], v[84:87], v[184:187]
  v_mfma_f32_16x16x32_bf16 v[180:183], v[108:111], v[80:83], v[180:183]
  v_mfma_f32_16x16x32_bf16 v[176:179], v[108:111], v[76:79], v[176:179]
  v_mfma_f32_16x16x32_bf16 v[192:195], v[76:79], v[112:115], v[192:195]
  v_mfma_f32_16x16x32_bf16 v[196:199], v[80:83], v[112:115], v[196:199]
  v_mfma_f32_16x16x32_bf16 v[200:203], v[84:87], v[112:115], v[200:203]
  v_mfma_f32_16x16x32_bf16 v[204:207], v[88:91], v[112:115], v[204:207]
  v_mfma_f32_16x16x32_bf16 v[220:223], v[88:91], v[116:119], v[220:223]
  v_mfma_f32_16x16x32_bf16 v[216:219], v[84:87], v[116:119], v[216:219]
  v_mfma_f32_16x16x32_bf16 v[212:215], v[80:83], v[116:119], v[212:215]
  v_mfma_f32_16x16x32_bf16 v[208:211], v[76:79], v[116:119], v[208:211]
  s_barrier
  v_mov_b32 v76, v52
  v_mov_b32 v77, v53
  v_mov_b32 v78, v54
  v_mov_b32 v79, v55
  v_mov_b32 v80, v60
  v_mov_b32 v81, v61
  v_mov_b32 v82, v62
  v_mov_b32 v83, v63
  v_mov_b32 v84, v68
  v_mov_b32 v85, v69
  v_mov_b32 v86, v70
  v_mov_b32 v87, v71
L_attn_nog:
  v_and_b32 v35, 1, v2
  v_xor_b32 v35, s71, v35
  s_lshl_b32 s8, s68, 7
  s_lshl_b32 s9, s71, 6
  s_add_u32 s8, s8, s9
  s_add_u32 s10, s8, s69
  s_lshl_b32 s10, s10, 11
  s_lshl_b32 s11, s72, 10
  s_add_u32 s10, s10, s11
  v_lshl_add_u32 v33, v3, 4, s10
  v_lshl_add_u32 v33, v35, 9, v33
  v_lshrrev_b32 v34, 1, v2
  v_lshl_add_u32 v31, v34, 8, v33
  s_mul_i32 s10, s72, 14336
  s_add_u32 s10, s10, 1024
  s_lshl_b32 s11, s71, 10
  s_add_u32 s4, s10, s11
  s_sub_u32 s5, s10, s11
  s_mul_i32 s6, s71, 6144
  v_lshl_add_u32 v16, v1, 4, s4
  v_add_u32 v17, s6, v16
  v_lshl_add_u32 v18, v1, 4, s5
  v_add_u32 v18, s6, v18
  v_lshl_add_u32 v19, v2, 8, s4
  v_lshl_add_u32 v20, v2, 8, s5
  v_lshl_add_u32 v21, v3, 4, s4
  v_lshl_add_u32 v22, v3, 4, s5
  s_lshl_b32 s10, s71, 8
  s_add_u32 s10, s10, 129024
  v_lshl_add_u32 v23, v3, 2, s10
  v_lshl_add_u32 v24, v2, 4, s10
  v_and_b32 v33, 1, v3
  v_cmp_eq_u32 s[48:49], 1, v33
  v_lshl_add_u32 v34, v2, 2, v33
  v_add_u32 v35, 2, v34
  v_cmp_gt_u32 s[50:51], v34, v3
  v_cmp_gt_u32 s[52:53], v35, v3
  v_mov_b32 v36, 0xffff
  v_mov_b32 v37, 0xffff0000
  v_cndmask_b32 v36, v36, v37, s[48:49]
  s_add_u32 s10, s10, 704
  v_lshl_add_u32 v34, v34, 2, s10
  v_lshl_add_u32 v35, v35, 2, s10
  v_subrev_u32 v38, 64, v34
  v_subrev_u32 v39, 64, v35
  v_cndmask_b32 v25, v34, v38, s[50:51]
  v_cndmask_b32 v26, v35, v39, s[52:53]
  v_cndmask_b32 v27, 0, v36, s[50:51]
  v_cndmask_b32 v29, 0, v36, s[52:53]
  v_xor_b32 v28, v27, v36
  v_xor_b32 v30, v29, v36
  s_cmp_eq_u32 s8, 0
  s_cselect_b64 s[54:55], s[50:51], 0
  s_cselect_b64 s[14:15], s[52:53], 0
  s_cmp_lg_u32 s96, 0
  s_cbranch_scc1 L_attn_nozero
  v_mov_b32 v122, 0
  v_mov_b32 v123, 0
  v_mov_b32 v124, 0
  v_mov_b32 v125, 0
  v_mov_b32 v126, 0
  v_mov_b32 v127, 0
  v_mov_b32 v128, 0
  v_mov_b32 v129, 0
  v_mov_b32 v130, 0
  v_mov_b32 v131, 0
  v_mov_b32 v132, 0
  v_mov_b32 v133, 0
  v_mov_b32 v134, 0
  v_mov_b32 v135, 0
  v_mov_b32 v136, 0
  v_mov_b32 v137, 0
  v_mov_b32 v138, 0
  v_mov_b32 v139, 0
  v_mov_b32 v140, 0
  v_mov_b32 v141, 0
  v_mov_b32 v142, 0
  v_mov_b32 v143, 0
  v_mov_b32 v144, 0
  v_mov_b32 v145, 0
  v_mov_b32 v146, 0
  v_mov_b32 v147, 0
  v_mov_b32 v148, 0
  v_mov_b32 v149, 0
  v_mov_b32 v150, 0
  v_mov_b32 v151, 0
  v_mov_b32 v152, 0
  v_mov_b32 v153, 0
  v_mov_b32 v154, 0
  v_mov_b32 v155, 0
  v_mov_b32 v156, 0
  v_mov_b32 v157, 0
  v_mov_b32 v158, 0
  v_mov_b32 v159, 0
  v_mov_b32 v160, 0
  v_mov_b32 v161, 0
  v_mov_b32 v162, 0
  v_mov_b32 v163, 0
  v_mov_b32 v164, 0
  v_mov_b32 v165, 0
  v_mov_b32 v166, 0
  v_mov_b32 v167, 0
  v_mov_b32 v168, 0
  v_mov_b32 v169, 0
  v_mov_b32 v170, 0
  v_mov_b32 v171, 0
  v_mov_b32 v172, 0
  v_mov_b32 v173, 0
  v_mov_b32 v174, 0
  v_mov_b32 v175, 0
  v_mov_b32 v176, 0
  v_mov_b32 v177, 0
  v_mov_b32 v178, 0
  v_mov_b32 v179, 0
  v_mov_b32 v180, 0
  v_mov_b32 v181, 0
  v_mov_b32 v182, 0
  v_mov_b32 v183, 0
  v_mov_b32 v184, 0
  v_mov_b32 v185, 0
  v_mov_b32 v186, 0
  v_mov_b32 v187, 0
  v_mov_b32 v188, 0
  v_mov_b32 v189, 0
  v_mov_b32 v190, 0
  v_mov_b32 v191, 0
  v_mov_b32 v192, 0
  v_mov_b32 v193, 0
  v_mov_b32 v194, 0
  v_mov_b32 v195, 0
  v_mov_b32 v196, 0
  v_mov_b32 v197, 0
  v_mov_b32 v198, 0
  v_mov_b32 v199, 0
  v_mov_b32 v200, 0
  v_mov_b32 v201, 0
  v_mov_b32 v202, 0
  v_mov_b32 v203, 0
  v_mov_b32 v204, 0
  v_mov_b32 v205, 0
  v_mov_b32 v206, 0
  v_mov_b32 v207, 0
  v_mov_b32 v208, 0
  v_mov_b32 v209, 0
  v_mov_b32 v210, 0
  v_mov_b32 v211, 0
  v_mov_b32 v212, 0
  v_mov_b32 v213, 0
  v_mov_b32 v214, 0
  v_mov_b32 v215, 0
  v_mov_b32 v216, 0
  v_mov_b32 v217, 0
  v_mov_b32 v218, 0
  v_mov_b32 v219, 0
  v_mov_b32 v220, 0
  v_mov_b32 v221, 0
  v_mov_b32 v222, 0
  v_mov_b32 v223, 0
  v_mov_b32 v224, 0
  v_mov_b32 v225, 0
  v_mov_b32 v226, 0
  v_mov_b32 v227, 0
  v_mov_b32 v228, 0
  v_mov_b32 v229, 0
  v_mov_b32 v230, 0
  v_mov_b32 v231, 0
  v_mov_b32 v232, 0
  v_mov_b32 v233, 0
  v_mov_b32 v234, 0
  v_mov_b32 v235, 0
  s_waitcnt lgkmcnt(0)
  s_lshl_b32 s3, s72, 5
  s_add_u32 s3, s3, s8
  s_lshl_b32 s4, s69, 14
  s_lshl3_add_u32 s3, s3, s4
  v_lshrrev_b32 v121, 1, v2
  v_lshl_add_u32 v121, v121, 4, v3
  v_and_b32 v120, 1, v2
  v_lshl_add_u32 v121, v121, 1, v120
  v_lshl_add_u32 v120, v121, 2, s3
  s_add_u32 s56, s22, 24903680
  s_addc_u32 s57, s23, 0
  s_and_b32 s57, s57, 0xffff
  s_mov_b32 s58, 262144
  s_mov_b32 s59, 0x00020000
  s_add_u32 s60, s22, 41943040
  s_addc_u32 s61, s23, 0
  s_and_b32 s61, s61, 0xffff
  s_mov_b32 s62, 524288
  s_mov_b32 s63, 0x00020000
  s_lshl_b32 s3, s2, 11
  s_cmp_lg_u32 s70, 0
  s_cbranch_scc1 L_attn_noclr
  s_lshl_b32 s5, s68, 10
  s_add_u32 s4, s4, s5
  v_lshlrev_b32 v121, 4, v1
  v_mov_b32 v40, -1
  v_mov_b32 v41, -1
  v_mov_b32 v42, -1
  v_mov_b32 v43, -1
  buffer_store_dwordx4 v[40:43], v121, s[56:59], s4 offen sc1
  buffer_store_dwordx4 v[128:131], v121, s[60:63], s3 offen offset:0 sc1
  buffer_store_dwordx4 v[128:131], v121, s[60:63], s3 offen offset:1024 sc1
  v_mov_b32 v126, 1
L_attn_noclr:
  s_and_b32 s65, s65, 0xffff
  s_mov_b32 s66, 256
  s_mov_b32 s67, 0x00020000
  s_mov_b32 s7, 0x3f803f80
L_attn_nozero:
  s_waitcnt lgkmcnt(0)
  s_mov_b32 s44, s34
  s_and_b32 s45, s35, 0xffff
  s_mov_b32 s46, 4194304
  s_mov_b32 s47, 0x00020000
  s_cmp_lg_u32 s96, 0
  s_cbranch_scc1 L_pfc1_skip
  s_getpc_b64 s[4:5]
L_pfc1:
  s_lshl_b32 s3, s99, 2
  s_add_u32 s3, s3, s70
  s_mul_i32 s3, s3, 256
  s_min_u32 s3, s3, L_w2_c1-L_attn_c0-256
  s_add_i32 s3, s3, L_attn_c0-L_pfc1
  s_ashr_i32 s6, s3, 31
  s_add_u32 s4, s4, s3
  s_addc_u32 s5, s5, s6
  s_load_dword s36, s[4:5], 0
  s_load_dword s37, s[4:5], 64
  s_load_dword s38, s[4:5], 128
  s_load_dword s39, s[4:5], 192
L_pfc1_skip:
  s_cmp_eq_u32 s96, 0
  s_barrier
  s_cbranch_scc1 L_attn_first
  ds_read_b128 v[88:91], v14 offset:46336
  ds_read_b128 v[92:95], v15 offset:46336
  ds_read_b128 v[32:35], v10 offset:0
  ds_read_b128 v[36:39], v10 offset:2048
  ds_read_b128 v[40:43], v10 offset:4096
  ds_read_b128 v[44:47], v10 offset:6144
  ds_read_b128 v[48:51], v14
  ds_read_b64_tr_b16 v[52:53], v12 offset:0
  ds_read_b64_tr_b16 v[54:55], v12 offset:512
  ds_read_b64_tr_b16 v[56:57], v13 offset:0
  ds_read_b64_tr_b16 v[58:59], v13 offset:512
  ds_read_b64_tr_b16 v[60:61], v12 offset:8192
  ds_read_b64_tr_b16 v[62:63], v12 offset:8704
  ds_read_b64_tr_b16 v[64:65], v13 offset:8192
  ds_read_b64_tr_b16 v[66:67], v13 offset:8704
  ds_read_b64_tr_b16 v[68:69], v12 offset:16384
  ds_read_b64_tr_b16 v[70:71], v12 offset:16896
  ds_read_b64_tr_b16 v[72:73], v13 offset:16384
  ds_read_b64_tr_b16 v[74:75], v13 offset:16896
  s_waitcnt lgkmcnt(15)
  v_mfma_f32_16x16x32_bf16 v[224:227], v[76:79], v[88:91], 0
  v_mfma_f32_16x16x32_bf16 v[228:231], v[80:83], v[88:91], 0
  v_mfma_f32_16x16x32_bf16 v[232:235], v[88:91], v[84:87], 0
  v_mfma_f32_16x16x32_bf16 v[224:227], v[96:99], v[92:95], v[224:227]
  v_mfma_f32_16x16x32_bf16 v[228:231], v[104:107], v[92:95], v[228:231]
  v_mfma_f32_16x16x32_bf16 v[232:235], v[92:95], v[112:115], v[232:235]
  s_waitcnt lgkmcnt(0)
  s_branch L_attn_loop
L_attn_first:
  ds_read_b128 v[32:35], v10 offset:0
  ds_read_b128 v[36:39], v10 offset:2048
  ds_read_b128 v[40:43], v10 offset:4096
  ds_read_b128 v[44:47], v10 offset:6144
  ds_read_b128 v[48:51], v14
  ds_read_b64_tr_b16 v[52:53], v12 offset:0
  ds_read_b64_tr_b16 v[54:55], v12 offset:512
  ds_read_b64_tr_b16 v[56:57], v13 offset:0
  ds_read_b64_tr_b16 v[58:59], v13 offset:512
  ds_read_b64_tr_b16 v[60:61], v12 offset:8192
  ds_read_b64_tr_b16 v[62:63], v12 offset:8704
  ds_read_b64_tr_b16 v[64:65], v13 offset:8192
  ds_read_b64_tr_b16 v[66:67], v13 offset:8704
  ds_read_b64_tr_b16 v[68:69], v12 offset:16384
  ds_read_b64_tr_b16 v[70:71], v12 offset:16896
  ds_read_b64_tr_b16 v[72:73], v13 offset:16384
  ds_read_b64_tr_b16 v[74:75], v13 offset:16896
  s_waitcnt lgkmcnt(0)
  s_branch L_attn_loop
L_attn_hook:
  s_cmp_lg_u32 s98, 1
  s_cbranch_scc1 L_attn_hook0
  s_mov_b32 s79, 1
  s_cmp_lg_u32 s72, 0
  s_cbranch_scc1 L_attn_dot0
  v_dot2_f32_bf16 v122, v32, s7, v122
  v_dot2_f32_bf16 v124, v32, v32, v124
  v_dot2_f32_bf16 v123, v36, s7, v123
  v_dot2_f32_bf16 v125, v36, v36, v125
  v_dot2_f32_bf16 v122, v33, s7, v122
  v_dot2_f32_bf16 v124, v33, v33, v124
  v_dot2_f32_bf16 v123, v37, s7, v123
  v_dot2_f32_bf16 v125, v37, v37, v125
  v_dot2_f32_bf16 v122, v34, s7, v122
  v_dot2_f32_bf16 v124, v34, v34, v124
  v_dot2_f32_bf16 v123, v38, s7, v123
  v_dot2_f32_bf16 v125, v38, v38, v125
  v_dot2_f32_bf16 v122, v35, s7, v122
  v_dot2_f32_bf16 v124, v35, v35, v124
  v_dot2_f32_bf16 v123, v39, s7, v123
  v_dot2_f32_bf16 v125, v39, v39, v125
  s_branch L_attn_dote0
  L_attn_dot0:
  v_dot2_f32_bf16 v122, v40, s7, v122
  v_dot2_f32_bf16 v124, v40, v40, v124
  v_dot2_f32_bf16 v123, v44, s7, v123
  v_dot2_f32_bf16 v125, v44, v44, v125
  v_dot2_f32_bf16 v122, v41, s7, v122
  v_dot2_f32_bf16 v124, v41, v41, v124
  v_dot2_f32_bf16 v123, v45, s7, v123
  v_dot2_f32_bf16 v125, v45, v45, v125
  v_dot2_f32_bf16 v122, v42, s7, v122
  v_dot2_f32_bf16 v124, v42, v42, v124
  v_dot2_f32_bf16 v123, v46, s7, v123
  v_dot2_f32_bf16 v125, v46, v46, v125
  v_dot2_f32_bf16 v122, v43, s7, v122
  v_dot2_f32_bf16 v124, v43, v43, v124
  v_dot2_f32_bf16 v123, v47, s7, v123
  v_dot2_f32_bf16 v125, v47, v47, v125
  L_attn_dote0:
  s_cmp_lg_u32 s70, 0
  s_cbranch_scc1 L_attn_loop
  s_waitcnt vmcnt(0)
  s_lshl4_add_u32 s3, s68, s69
  s_mov_b64 exec, 1
  buffer_store_byte v126, off, s[64:67], s3 sc1
  s_mov_b64 exec, -1
  s_branch L_attn_loop
L_attn_hook0:
  s_cmp_lg_u32 s98, 2
  s_cbranch_scc1 L_attn_hook1
  s_and_b32 s79, s69, 3
  s_add_u32 s79, s79, 1
  s_sub_u32 s79, 13, s79
  s_cmp_lg_u32 s72, 0
  s_cbranch_scc1 L_attn_dot1
  v_dot2_f32_bf16 v122, v76, s7, v122
  v_dot2_f32_bf16 v124, v76, v76, v124
  v_dot2_f32_bf16 v123, v80, s7, v123
  v_dot2_f32_bf16 v125, v80, v80, v125
  v_dot2_f32_bf16 v122, v77, s7, v122
  v_dot2_f32_bf16 v124, v77, v77, v124
  v_dot2_f32_bf16 v123, v81, s7, v123
  v_dot2_f32_bf16 v125, v81, v81, v125
  v_dot2_f32_bf16 v122, v78, s7, v122
  v_dot2_f32_bf16 v124, v78, v78, v124
  v_dot2_f32_bf16 v123, v82, s7, v123
  v_dot2_f32_bf16 v125, v82, v82, v125
  v_dot2_f32_bf16 v122, v79, s7, v122
  v_dot2_f32_bf16 v124, v79, v79, v124
  v_dot2_f32_bf16 v123, v83, s7, v123
  v_dot2_f32_bf16 v125, v83, v83, v125
  s_branch L_attn_dote1
  L_attn_dot1:
  v_dot2_f32_bf16 v122, v84, s7, v122
  v_dot2_f32_bf16 v124, v84, v84, v124
  v_dot2_f32_bf16 v123, v88, s7, v123
  v_dot2_f32_bf16 v125, v88, v88, v125
  v_dot2_f32_bf16 v122, v85, s7, v122
  v_dot2_f32_bf16 v124, v85, v85, v124
  v_dot2_f32_bf16 v123, v89, s7, v123
  v_dot2_f32_bf16 v125, v89, v89, v125
  v_dot2_f32_bf16 v122, v86, s7, v122
  v_dot2_f32_bf16 v124, v86, v86, v124
  v_dot2_f32_bf16 v123, v90, s7, v123
  v_dot2_f32_bf16 v125, v90, v90, v125
  v_dot2_f32_bf16 v122, v87, s7, v122
  v_dot2_f32_bf16 v124, v87, v87, v124
  v_dot2_f32_bf16 v123, v91, s7, v123
  v_dot2_f32_bf16 v125, v91, v91, v125
  L_attn_dote1:
  s_nop 2
  v_permlane32_swap_b32 v122, v123
  v_permlane32_swap_b32 v124, v125
  v_add_f32 v122, v122, v123
  v_add_f32 v124, v124, v125
  s_nop 0
  s_nop 0
  v_permlane16_swap_b32 v122, v124
  v_add_f32 v122, v122, v124
  buffer_store_dword v122, v120, s[56:59], 0 offen sc1
  s_branch L_attn_loop
L_attn_hook1:
  s_mov_b32 s79, 2
  s_mov_b32 s36, s16
  s_and_b32 s37, s17, 0xffff
  s_mov_b32 s38, 4194304
  s_mov_b32 s39, 0x00020000
  s_and_b32 s3, s2, 3
  s_and_b32 s4, s99, 3
  s_lshl2_add_u32 s3, s3, s4
  s_lshl2_add_u32 s3, s3, s70
  s_lshl_b32 s3, s3, 16
  s_bfe_u32 s4, s2, 0x10002
  s_lshr_b32 s5, s99, 2
  s_lshl1_add_u32 s4, s5, s4
  s_lshl_b32 s4, s4, 7
  s_add_u32 s3, s3, s4
  s_add_u32 s4, s3, 32768
  v_and_b32 v122, 15, v1
  v_lshlrev_b32 v123, 1, v1
  v_and_b32 v123, 32, v123
  v_lshl_add_u32 v122, v122, 11, v123
  v_lshrrev_b32 v123, 1, v1
  v_and_b32 v123, 16, v123
  v_add_u32 v122, v122, v123
  buffer_load_dwordx4 v[240:243], v122, s[36:39], s3 offen offset:0
  buffer_load_dwordx4 v[244:247], v122, s[36:39], s3 offen offset:64
  buffer_load_dwordx4 v[248:251], v122, s[36:39], s4 offen offset:0
  buffer_load_dwordx4 v[252:255], v122, s[36:39], s4 offen offset:64
.p2align 3
L_attn_loop:
  v_mfma_f32_16x16x32_bf16 v[128:131], v[52:55], v[32:35], v[128:131]
  ds_read_b128 v[76:79], v11 offset:0
  v_mfma_f32_16x16x32_bf16 v[132:135], v[52:55], v[36:39], v[132:135]
  ds_read_b128 v[80:83], v11 offset:2048
  v_mfma_f32_16x16x32_bf16 v[136:139], v[52:55], v[40:43], v[136:139]
  ds_read_b128 v[84:87], v11 offset:4096
  v_mfma_f32_16x16x32_bf16 v[140:143], v[52:55], v[44:47], v[140:143]
  ds_read_b128 v[88:91], v11 offset:6144
  v_mfma_f32_16x16x32_bf16 v[224:227], v[52:55], v[48:51], v[224:227]
  ds_read_b128 v[92:95], v15
  v_mfma_f32_16x16x32_bf16 v[156:159], v[56:59], v[44:47], v[156:159]
  ds_read_b64_tr_b16 v[96:97], v12 offset:4096
  v_mfma_f32_16x16x32_bf16 v[152:155], v[56:59], v[40:43], v[152:155]
  ds_read_b64_tr_b16 v[98:99], v12 offset:4608
  v_mfma_f32_16x16x32_bf16 v[148:151], v[56:59], v[36:39], v[148:151]
  ds_read_b64_tr_b16 v[100:101], v13 offset:4096
  v_mfma_f32_16x16x32_bf16 v[144:147], v[56:59], v[32:35], v[144:147]
  ds_read_b64_tr_b16 v[102:103], v13 offset:4608
  v_mfma_f32_16x16x32_bf16 v[160:163], v[60:63], v[32:35], v[160:163]
  ds_read_b64_tr_b16 v[104:105], v12 offset:12288
  v_mfma_f32_16x16x32_bf16 v[164:167], v[60:63], v[36:39], v[164:167]
  ds_read_b64_tr_b16 v[106:107], v12 offset:12800
  v_mfma_f32_16x16x32_bf16 v[168:171], v[60:63], v[40:43], v[168:171]
  ds_read_b64_tr_b16 v[108:109], v13 offset:12288
  v_mfma_f32_16x16x32_bf16 v[172:175], v[60:63], v[44:47], v[172:175]
  ds_read_b64_tr_b16 v[110:111], v13 offset:12800
  v_mfma_f32_16x16x32_bf16 v[228:231], v[60:63], v[48:51], v[228:231]
  ds_read_b64_tr_b16 v[112:113], v12 offset:20480
  v_mfma_f32_16x16x32_bf16 v[188:191], v[64:67], v[44:47], v[188:191]
  ds_read_b64_tr_b16 v[114:115], v12 offset:20992
  v_mfma_f32_16x16x32_bf16 v[184:187], v[64:67], v[40:43], v[184:187]
  ds_read_b64_tr_b16 v[116:117], v13 offset:20480
  v_mfma_f32_16x16x32_bf16 v[180:183], v[64:67], v[36:39], v[180:183]
  ds_read_b64_tr_b16 v[118:119], v13 offset:20992
  v_mfma_f32_16x16x32_bf16 v[176:179], v[64:67], v[32:35], v[176:179]
  v_add_u32_e64 v10, s75, v4
  v_mfma_f32_16x16x32_bf16 v[192:195], v[32:35], v[68:71], v[192:195]
  v_add_u32_e64 v11, s75, v5
  v_mfma_f32_16x16x32_bf16 v[196:199], v[36:39], v[68:71], v[196:199]
  v_add_u32_e64 v12, s75, v6
  v_mfma_f32_16x16x32_bf16 v[200:203], v[40:43], v[68:71], v[200:203]
  v_add_u32_e64 v13, s75, v7
  v_mfma_f32_16x16x32_bf16 v[204:207], v[44:47], v[68:71], v[204:207]
  v_add_u32_e64 v14, s75, v8
  v_mfma_f32_16x16x32_bf16 v[232:235], v[48:51], v[68:71], v[232:235]
  v_add_u32_e64 v15, s75, v9
  v_mfma_f32_16x16x32_bf16 v[220:223], v[44:47], v[72:75], v[220:223]
  s_add_u32 s75, s75, 43008
  v_mfma_f32_16x16x32_bf16 v[216:219], v[40:43], v[72:75], v[216:219]
  s_cmp_eq_u32 s75, 129024
  v_mfma_f32_16x16x32_bf16 v[212:215], v[36:39], v[72:75], v[212:215]
  s_cselect_b32 s75, 0, s75
  s_sub_u32 s79, s79, 1
  v_mfma_f32_16x16x32_bf16 v[208:211], v[32:35], v[72:75], v[208:211]
  s_waitcnt lgkmcnt(0)
  s_barrier
  v_mfma_f32_16x16x32_bf16 v[128:131], v[96:99], v[76:79], v[128:131]
  ds_read_b128 v[32:35], v10 offset:0
  v_mfma_f32_16x16x32_bf16 v[132:135], v[96:99], v[80:83], v[132:135]
  ds_read_b128 v[36:39], v10 offset:2048
  v_mfma_f32_16x16x32_bf16 v[136:139], v[96:99], v[84:87], v[136:139]
  ds_read_b128 v[40:43], v10 offset:4096
  v_mfma_f32_16x16x32_bf16 v[140:143], v[96:99], v[88:91], v[140:143]
  ds_read_b128 v[44:47], v10 offset:6144
  v_mfma_f32_16x16x32_bf16 v[224:227], v[96:99], v[92:95], v[224:227]
  ds_read_b128 v[48:51], v14
  v_mfma_f32_16x16x32_bf16 v[156:159], v[100:103], v[88:91], v[156:159]
  ds_read_b64_tr_b16 v[52:53], v12 offset:0
  v_mfma_f32_16x16x32_bf16 v[152:155], v[100:103], v[84:87], v[152:155]
  ds_read_b64_tr_b16 v[54:55], v12 offset:512
  v_mfma_f32_16x16x32_bf16 v[148:151], v[100:103], v[80:83], v[148:151]
  ds_read_b64_tr_b16 v[56:57], v13 offset:0
  v_mfma_f32_16x16x32_bf16 v[144:147], v[100:103], v[76:79], v[144:147]
  ds_read_b64_tr_b16 v[58:59], v13 offset:512
  v_mfma_f32_16x16x32_bf16 v[160:163], v[104:107], v[76:79], v[160:163]
  ds_read_b64_tr_b16 v[60:61], v12 offset:8192
  v_mfma_f32_16x16x32_bf16 v[164:167], v[104:107], v[80:83], v[164:167]
  ds_read_b64_tr_b16 v[62:63], v12 offset:8704
  v_mfma_f32_16x16x32_bf16 v[168:171], v[104:107], v[84:87], v[168:171]
  ds_read_b64_tr_b16 v[64:65], v13 offset:8192
  v_mfma_f32_16x16x32_bf16 v[172:175], v[104:107], v[88:91], v[172:175]
  ds_read_b64_tr_b16 v[66:67], v13 offset:8704
  v_mfma_f32_16x16x32_bf16 v[228:231], v[104:107], v[92:95], v[228:231]
  ds_read_b64_tr_b16 v[68:69], v12 offset:16384
  v_mfma_f32_16x16x32_bf16 v[188:191], v[108:111], v[88:91], v[188:191]
  ds_read_b64_tr_b16 v[70:71], v12 offset:16896
  v_mfma_f32_16x16x32_bf16 v[184:187], v[108:111], v[84:87], v[184:187]
  ds_read_b64_tr_b16 v[72:73], v13 offset:16384
  v_mfma_f32_16x16x32_bf16 v[180:183], v[108:111], v[80:83], v[180:183]
  ds_read_b64_tr_b16 v[74:75], v13 offset:16896
  v_mfma_f32_16x16x32_bf16 v[176:179], v[108:111], v[76:79], v[176:179]
  s_cmp_lg_u32 s79, 0
  s_nop 0
  v_mfma_f32_16x16x32_bf16 v[192:195], v[76:79], v[112:115], v[192:195]
  v_mfma_f32_16x16x32_bf16 v[196:199], v[80:83], v[112:115], v[196:199]
  v_mfma_f32_16x16x32_bf16 v[200:203], v[84:87], v[112:115], v[200:203]
  v_mfma_f32_16x16x32_bf16 v[204:207], v[88:91], v[112:115], v[204:207]
  v_mfma_f32_16x16x32_bf16 v[232:235], v[92:95], v[112:115], v[232:235]
  v_mfma_f32_16x16x32_bf16 v[220:223], v[88:91], v[116:119], v[220:223]
  v_mfma_f32_16x16x32_bf16 v[216:219], v[84:87], v[116:119], v[216:219]
  v_mfma_f32_16x16x32_bf16 v[212:215], v[80:83], v[116:119], v[212:215]
  v_mfma_f32_16x16x32_bf16 v[208:211], v[76:79], v[116:119], v[208:211]
  s_waitcnt lgkmcnt(0)
  s_cbranch_scc1 L_attn_loop
  s_add_u32 s98, s98, 1
  s_cmp_le_u32 s98, 3
  s_cbranch_scc1 L_attn_hook
L_attn_exit:
  ds_read2_b32 v[66:67], v23 offset0:0 offset1:160
  ds_read2_b32 v[68:69], v23 offset0:16 offset1:176
  ds_read2_b32 v[70:71], v23 offset0:32 offset1:192
  ds_read2_b32 v[72:73], v23 offset0:48 offset1:208
  ds_read2_b32 v[74:75], v23 offset0:64 offset1:224
  ds_read2_b32 v[76:77], v25 offset0:0 offset1:16
  ds_read2_b32 v[80:81], v26 offset0:0 offset1:16
  ds_read2_b32 v[78:79], v25 offset0:32 offset1:48
  ds_read2_b32 v[82:83], v26 offset0:32 offset1:48
  ds_write_b128 v16, v[224:227] offset:0
  ds_write_b128 v16, v[228:231] offset:2048
  ds_write_b128 v16, v[232:235] offset:4096
  s_cmp_eq_u32 s71, 1
  s_cbranch_scc1 L_attn_nop3
  ds_write_b128 v16, v[172:175] offset:8192
  ds_write_b128 v16, v[188:191] offset:9216
  ds_write_b128 v16, v[204:207] offset:10240
  ds_write_b128 v16, v[220:223] offset:11264
L_attn_nop3:
  ds_read_b128 v[84:87], v24 offset:0
  ds_read_b128 v[104:107], v24 offset:640
  ds_read_b128 v[88:91], v24 offset:64
  ds_read_b128 v[108:111], v24 offset:704
  ds_read_b128 v[92:95], v24 offset:128
  ds_read_b128 v[112:115], v24 offset:768
  ds_read_b128 v[96:99], v24 offset:192
  ds_read_b128 v[116:119], v24 offset:832
  ds_read_b128 v[100:103], v24 offset:256
  ds_read_b128 v[120:123], v24 offset:896
  s_waitcnt lgkmcnt(10)
  s_barrier
  ds_read_b128 v[48:51], v19 offset:0
  ds_read_b128 v[52:55], v20 offset:1024
  ds_read_b128 v[56:59], v19 offset:2048
  ds_read_b128 v[60:63], v20 offset:3072
  ds_read_b32 v64, v21 offset:4096
  ds_read_b32 v65, v22 offset:5120
  ds_read_b128 v[32:35], v17 offset:2048
  ds_read_b128 v[36:39], v18 offset:3072
  ds_read_b128 v[40:43], v17 offset:4096
  ds_read_b128 v[44:47], v18 offset:5120
  v_mul_f32 v69, 0x3e8293ee, v69
  v_mul_f32 v71, 0x3e8293ee, v71
  v_mul_f32 v73, 0x3e8293ee, v73
  v_mul_f32 v75, 0x3e8293ee, v75
  v_mul_f32 v76, v76, v69
  v_mul_f32 v80, v80, v69
  v_mul_f32 v77, v77, v71
  v_mul_f32 v81, v81, v71
  v_mul_f32 v78, v78, v73
  v_mul_f32 v82, v82, v73
  v_mul_f32 v79, v79, v75
  v_mul_f32 v83, v83, v75
  s_waitcnt lgkmcnt(6)
  v_pk_fma_f32 v[128:129], v[48:49], v[68:69], v[128:129] op_sel:[0,0,0] op_sel_hi:[1,0,1] neg_lo:[0,1,0] neg_hi:[0,1,0]
  v_pk_fma_f32 v[130:131], v[50:51], v[68:69], v[130:131] op_sel:[0,0,0] op_sel_hi:[1,0,1] neg_lo:[0,1,0] neg_hi:[0,1,0]
  v_pk_fma_f32 v[144:145], v[52:53], v[68:69], v[144:145] op_sel:[0,0,0] op_sel_hi:[1,0,1] neg_lo:[0,1,0] neg_hi:[0,1,0]
  v_pk_fma_f32 v[146:147], v[54:55], v[68:69], v[146:147] op_sel:[0,0,0] op_sel_hi:[1,0,1] neg_lo:[0,1,0] neg_hi:[0,1,0]
  v_cvt_pk_bf16_f32 v128, v128, v129
  v_cvt_pk_bf16_f32 v129, v130, v131
  v_cvt_pk_bf16_f32 v130, v144, v145
  v_cvt_pk_bf16_f32 v131, v146, v147
  v_pk_fma_f32 v[160:161], v[56:57], v[68:69], v[160:161] op_sel:[0,0,0] op_sel_hi:[1,0,1] neg_lo:[0,1,0] neg_hi:[0,1,0]
  v_pk_fma_f32 v[162:163], v[58:59], v[68:69], v[162:163] op_sel:[0,0,0] op_sel_hi:[1,0,1] neg_lo:[0,1,0] neg_hi:[0,1,0]
  v_pk_fma_f32 v[176:177], v[60:61], v[68:69], v[176:177] op_sel:[0,0,0] op_sel_hi:[1,0,1] neg_lo:[0,1,0] neg_hi:[0,1,0]
  v_pk_fma_f32 v[178:179], v[62:63], v[68:69], v[178:179] op_sel:[0,0,0] op_sel_hi:[1,0,1] neg_lo:[0,1,0] neg_hi:[0,1,0]
  v_cvt_pk_bf16_f32 v160, v160, v161
  v_cvt_pk_bf16_f32 v161, v162, v163
  v_cvt_pk_bf16_f32 v162, v176, v177
  v_cvt_pk_bf16_f32 v163, v178, v179
  v_pk_fma_f32 v[132:133], v[48:49], v[70:71], v[132:133] op_sel:[0,0,0] op_sel_hi:[1,0,1] neg_lo:[0,1,0] neg_hi:[0,1,0]
  v_pk_fma_f32 v[134:135], v[50:51], v[70:71], v[134:135] op_sel:[0,0,0] op_sel_hi:[1,0,1] neg_lo:[0,1,0] neg_hi:[0,1,0]
  v_pk_fma_f32 v[148:149], v[52:53], v[70:71], v[148:149] op_sel:[0,0,0] op_sel_hi:[1,0,1] neg_lo:[0,1,0] neg_hi:[0,1,0]
  v_pk_fma_f32 v[150:151], v[54:55], v[70:71], v[150:151] op_sel:[0,0,0] op_sel_hi:[1,0,1] neg_lo:[0,1,0] neg_hi:[0,1,0]
  v_cvt_pk_bf16_f32 v132, v132, v133
  v_cvt_pk_bf16_f32 v133, v134, v135
  v_cvt_pk_bf16_f32 v134, v148, v149
  v_cvt_pk_bf16_f32 v135, v150, v151
  v_pk_fma_f32 v[164:165], v[56:57], v[70:71], v[164:165] op_sel:[0,0,0] op_sel_hi:[1,0,1] neg_lo:[0,1,0] neg_hi:[0,1,0]
  v_pk_fma_f32 v[166:167], v[58:59], v[70:71], v[166:167] op_sel:[0,0,0] op_sel_hi:[1,0,1] neg_lo:[0,1,0] neg_hi:[0,1,0]
  v_pk_fma_f32 v[180:181], v[60:61], v[70:71], v[180:181] op_sel:[0,0,0] op_sel_hi:[1,0,1] neg_lo:[0,1,0] neg_hi:[0,1,0]
  v_pk_fma_f32 v[182:183], v[62:63], v[70:71], v[182:183] op_sel:[0,0,0] op_sel_hi:[1,0,1] neg_lo:[0,1,0] neg_hi:[0,1,0]
  v_cvt_pk_bf16_f32 v164, v164, v165
  v_cvt_pk_bf16_f32 v165, v166, v167
  v_cvt_pk_bf16_f32 v166, v180, v181
  v_cvt_pk_bf16_f32 v167, v182, v183
  v_mfma_f32_16x16x32_bf16 v[144:147], v[160:163], v[128:131], 0
  v_pk_fma_f32 v[136:137], v[48:49], v[72:73], v[136:137] op_sel:[0,0,0] op_sel_hi:[1,0,1] neg_lo:[0,1,0] neg_hi:[0,1,0]
  v_pk_fma_f32 v[138:139], v[50:51], v[72:73], v[138:139] op_sel:[0,0,0] op_sel_hi:[1,0,1] neg_lo:[0,1,0] neg_hi:[0,1,0]
  v_pk_fma_f32 v[152:153], v[52:53], v[72:73], v[152:153] op_sel:[0,0,0] op_sel_hi:[1,0,1] neg_lo:[0,1,0] neg_hi:[0,1,0]
  v_pk_fma_f32 v[154:155], v[54:55], v[72:73], v[154:155] op_sel:[0,0,0] op_sel_hi:[1,0,1] neg_lo:[0,1,0] neg_hi:[0,1,0]
  v_cvt_pk_bf16_f32 v136, v136, v137
  v_cvt_pk_bf16_f32 v137, v138, v139
  v_cvt_pk_bf16_f32 v138, v152, v153
  v_cvt_pk_bf16_f32 v139, v154, v155
  v_pk_fma_f32 v[168:169], v[56:57], v[72:73], v[168:169] op_sel:[0,0,0] op_sel_hi:[1,0,1] neg_lo:[0,1,0] neg_hi:[0,1,0]
  v_pk_fma_f32 v[170:171], v[58:59], v[72:73], v[170:171] op_sel:[0,0,0] op_sel_hi:[1,0,1] neg_lo:[0,1,0] neg_hi:[0,1,0]
  v_pk_fma_f32 v[184:185], v[60:61], v[72:73], v[184:185] op_sel:[0,0,0] op_sel_hi:[1,0,1] neg_lo:[0,1,0] neg_hi:[0,1,0]
  v_pk_fma_f32 v[186:187], v[62:63], v[72:73], v[186:187] op_sel:[0,0,0] op_sel_hi:[1,0,1] neg_lo:[0,1,0] neg_hi:[0,1,0]
  v_cvt_pk_bf16_f32 v168, v168, v169
  v_cvt_pk_bf16_f32 v169, v170, v171
  v_cvt_pk_bf16_f32 v170, v184, v185
  v_cvt_pk_bf16_f32 v171, v186, v187
  v_mfma_f32_16x16x32_bf16 v[148:151], v[164:167], v[132:135], 0
  v_mfma_f32_16x16x32_bf16 v[180:183], v[160:163], v[132:135], 0
  v_pk_fma_f32 v[140:141], v[48:49], v[74:75], v[140:141] op_sel:[0,0,0] op_sel_hi:[1,0,1] neg_lo:[0,1,0] neg_hi:[0,1,0]
  v_pk_fma_f32 v[142:143], v[50:51], v[74:75], v[142:143] op_sel:[0,0,0] op_sel_hi:[1,0,1] neg_lo:[0,1,0] neg_hi:[0,1,0]
  v_pk_fma_f32 v[156:157], v[52:53], v[74:75], v[156:157] op_sel:[0,0,0] op_sel_hi:[1,0,1] neg_lo:[0,1,0] neg_hi:[0,1,0]
  v_pk_fma_f32 v[158:159], v[54:55], v[74:75], v[158:159] op_sel:[0,0,0] op_sel_hi:[1,0,1] neg_lo:[0,1,0] neg_hi:[0,1,0]
  v_cvt_pk_bf16_f32 v140, v140, v141
  v_cvt_pk_bf16_f32 v141, v142, v143
  v_cvt_pk_bf16_f32 v142, v156, v157
  v_cvt_pk_bf16_f32 v143, v158, v159
  v_pk_fma_f32 v[172:173], v[56:57], v[74:75], v[172:173] op_sel:[0,0,0] op_sel_hi:[1,0,1] neg_lo:[0,1,0] neg_hi:[0,1,0]
  v_pk_fma_f32 v[174:175], v[58:59], v[74:75], v[174:175] op_sel:[0,0,0] op_sel_hi:[1,0,1] neg_lo:[0,1,0] neg_hi:[0,1,0]
  v_pk_fma_f32 v[188:189], v[60:61], v[74:75], v[188:189] op_sel:[0,0,0] op_sel_hi:[1,0,1] neg_lo:[0,1,0] neg_hi:[0,1,0]
  v_pk_fma_f32 v[190:191], v[62:63], v[74:75], v[190:191] op_sel:[0,0,0] op_sel_hi:[1,0,1] neg_lo:[0,1,0] neg_hi:[0,1,0]
  v_cvt_pk_bf16_f32 v172, v172, v173
  v_cvt_pk_bf16_f32 v173, v174, v175
  v_cvt_pk_bf16_f32 v174, v188, v189
  v_cvt_pk_bf16_f32 v175, v190, v191
  s_waitcnt lgkmcnt(0)
  v_pk_fma_f32 v[32:33], v[56:57], v[66:67], v[32:33] op_sel:[0,0,0] op_sel_hi:[1,0,1] neg_lo:[0,1,0] neg_hi:[0,1,0]
  v_pk_fma_f32 v[34:35], v[58:59], v[66:67], v[34:35] op_sel:[0,0,0] op_sel_hi:[1,0,1] neg_lo:[0,1,0] neg_hi:[0,1,0]
  v_pk_fma_f32 v[36:37], v[60:61], v[66:67], v[36:37] op_sel:[0,0,0] op_sel_hi:[1,0,1] neg_lo:[0,1,0] neg_hi:[0,1,0]
  v_pk_fma_f32 v[38:39], v[62:63], v[66:67], v[38:39] op_sel:[0,0,0] op_sel_hi:[1,0,1] neg_lo:[0,1,0] neg_hi:[0,1,0]
  v_cvt_pk_bf16_f32 v32, v32, v33
  v_cvt_pk_bf16_f32 v33, v34, v35
  v_cvt_pk_bf16_f32 v34, v36, v37
  v_cvt_pk_bf16_f32 v35, v38, v39
  v_mfma_f32_16x16x32_bf16 v[152:155], v[168:171], v[136:139], 0
  v_mfma_f32_16x16x32_bf16 v[184:187], v[164:167], v[136:139], 0
  v_mfma_f32_16x16x32_bf16 v[156:159], v[172:175], v[140:143], 0
  v_mfma_f32_16x16x32_bf16 v[188:191], v[168:171], v[140:143], 0
  v_mfma_f32_16x16x32_bf16 v[176:179], v[32:35], v[128:131], 0
  v_pk_fma_f32 v[40:41], v[84:85], v[64:65], v[40:41] op_sel:[0,0,0] op_sel_hi:[1,0,1] neg_lo:[1,0,0] neg_hi:[1,0,0]
  v_pk_fma_f32 v[42:43], v[86:87], v[64:65], v[42:43] op_sel:[0,0,0] op_sel_hi:[1,0,1] neg_lo:[1,0,0] neg_hi:[1,0,0]
  v_pk_mul_f32 v[40:41], v[40:41], v[104:105]
  v_pk_mul_f32 v[42:43], v[42:43], v[106:107]
  v_cvt_pk_bf16_f32 v4, v40, v41
  v_cvt_pk_bf16_f32 v5, v42, v43
  v_pk_fma_f32 v[192:193], v[88:89], v[64:65], v[192:193] op_sel:[0,0,0] op_sel_hi:[1,0,1] neg_lo:[1,0,0] neg_hi:[1,0,0]
  v_pk_fma_f32 v[194:195], v[90:91], v[64:65], v[194:195] op_sel:[0,0,0] op_sel_hi:[1,0,1] neg_lo:[1,0,0] neg_hi:[1,0,0]
  v_pk_mul_f32 v[192:193], v[192:193], v[108:109]
  v_pk_mul_f32 v[194:195], v[194:195], v[110:111]
  v_cvt_pk_bf16_f32 v6, v192, v193
  v_cvt_pk_bf16_f32 v7, v194, v195
  v_pk_fma_f32 v[196:197], v[92:93], v[64:65], v[196:197] op_sel:[0,0,0] op_sel_hi:[1,0,1] neg_lo:[1,0,0] neg_hi:[1,0,0]
  v_pk_fma_f32 v[198:199], v[94:95], v[64:65], v[198:199] op_sel:[0,0,0] op_sel_hi:[1,0,1] neg_lo:[1,0,0] neg_hi:[1,0,0]
  v_pk_mul_f32 v[196:197], v[196:197], v[112:113]
  v_pk_mul_f32 v[198:199], v[198:199], v[114:115]
  v_cvt_pk_bf16_f32 v8, v196, v197
  v_cvt_pk_bf16_f32 v9, v198, v199
  v_pk_fma_f32 v[200:201], v[96:97], v[64:65], v[200:201] op_sel:[0,0,0] op_sel_hi:[1,0,1] neg_lo:[1,0,0] neg_hi:[1,0,0]
  v_pk_fma_f32 v[202:203], v[98:99], v[64:65], v[202:203] op_sel:[0,0,0] op_sel_hi:[1,0,1] neg_lo:[1,0,0] neg_hi:[1,0,0]
  v_pk_mul_f32 v[200:201], v[200:201], v[116:117]
  v_pk_mul_f32 v[202:203], v[202:203], v[118:119]
  v_cvt_pk_bf16_f32 v10, v200, v201
  v_cvt_pk_bf16_f32 v11, v202, v203
  v_pk_fma_f32 v[204:205], v[100:101], v[64:65], v[204:205] op_sel:[0,0,0] op_sel_hi:[1,0,1] neg_lo:[1,0,0] neg_hi:[1,0,0]
  v_pk_fma_f32 v[206:207], v[102:103], v[64:65], v[206:207] op_sel:[0,0,0] op_sel_hi:[1,0,1] neg_lo:[1,0,0] neg_hi:[1,0,0]
  v_pk_mul_f32 v[204:205], v[204:205], v[120:121]
  v_pk_mul_f32 v[206:207], v[206:207], v[122:123]
  v_cvt_pk_bf16_f32 v12, v204, v205
  v_cvt_pk_bf16_f32 v13, v206, v207
  v_pk_fma_f32 v[44:45], v[84:85], v[64:65], v[44:45] op_sel:[0,1,0] op_sel_hi:[1,1,1] neg_lo:[1,0,0] neg_hi:[1,0,0]
  v_pk_fma_f32 v[46:47], v[86:87], v[64:65], v[46:47] op_sel:[0,1,0] op_sel_hi:[1,1,1] neg_lo:[1,0,0] neg_hi:[1,0,0]
  v_pk_mul_f32 v[44:45], v[44:45], v[104:105]
  v_pk_mul_f32 v[46:47], v[46:47], v[106:107]
  v_cvt_pk_bf16_f32 v224, v44, v45
  v_cvt_pk_bf16_f32 v225, v46, v47
  v_pk_fma_f32 v[208:209], v[88:89], v[64:65], v[208:209] op_sel:[0,1,0] op_sel_hi:[1,1,1] neg_lo:[1,0,0] neg_hi:[1,0,0]
  v_pk_fma_f32 v[210:211], v[90:91], v[64:65], v[210:211] op_sel:[0,1,0] op_sel_hi:[1,1,1] neg_lo:[1,0,0] neg_hi:[1,0,0]
  v_pk_mul_f32 v[208:209], v[208:209], v[108:109]
  v_pk_mul_f32 v[210:211], v[210:211], v[110:111]
  v_cvt_pk_bf16_f32 v226, v208, v209
  v_cvt_pk_bf16_f32 v227, v210, v211
  v_pk_fma_f32 v[212:213], v[92:93], v[64:65], v[212:213] op_sel:[0,1,0] op_sel_hi:[1,1,1] neg_lo:[1,0,0] neg_hi:[1,0,0]
  v_pk_fma_f32 v[214:215], v[94:95], v[64:65], v[214:215] op_sel:[0,1,0] op_sel_hi:[1,1,1] neg_lo:[1,0,0] neg_hi:[1,0,0]
  v_pk_mul_f32 v[212:213], v[212:213], v[112:113]
  v_pk_mul_f32 v[214:215], v[214:215], v[114:115]
  v_cvt_pk_bf16_f32 v228, v212, v213
  v_cvt_pk_bf16_f32 v229, v214, v215
  v_pk_fma_f32 v[216:217], v[96:97], v[64:65], v[216:217] op_sel:[0,1,0] op_sel_hi:[1,1,1] neg_lo:[1,0,0] neg_hi:[1,0,0]
  v_pk_fma_f32 v[218:219], v[98:99], v[64:65], v[218:219] op_sel:[0,1,0] op_sel_hi:[1,1,1] neg_lo:[1,0,0] neg_hi:[1,0,0]
  v_pk_mul_f32 v[216:217], v[216:217], v[116:117]
  v_pk_mul_f32 v[218:219], v[218:219], v[118:119]
  v_cvt_pk_bf16_f32 v230, v216, v217
  v_cvt_pk_bf16_f32 v231, v218, v219
  v_pk_fma_f32 v[220:221], v[100:101], v[64:65], v[220:221] op_sel:[0,1,0] op_sel_hi:[1,1,1] neg_lo:[1,0,0] neg_hi:[1,0,0]
  v_pk_fma_f32 v[222:223], v[102:103], v[64:65], v[222:223] op_sel:[0,1,0] op_sel_hi:[1,1,1] neg_lo:[1,0,0] neg_hi:[1,0,0]
  v_pk_mul_f32 v[220:221], v[220:221], v[120:121]
  v_pk_mul_f32 v[222:223], v[222:223], v[122:123]
  v_cvt_pk_bf16_f32 v232, v220, v221
  v_cvt_pk_bf16_f32 v233, v222, v223
  v_cndmask_b32 v148, v148, v149, s[48:49]
  v_cndmask_b32 v180, v180, v181, s[48:49]
  v_cndmask_b32 v150, v150, v151, s[48:49]
  v_cndmask_b32 v182, v182, v183, s[48:49]
  v_cndmask_b32 v36, v148, v180, s[50:51]
  v_cndmask_b32 v37, v150, v182, s[52:53]
  v_mul_f32 v36, v36, v77
  v_mul_f32 v37, v37, v81
  v_cndmask_b32 v152, v152, v153, s[48:49]
  v_cndmask_b32 v184, v184, v185, s[48:49]
  v_cndmask_b32 v154, v154, v155, s[48:49]
  v_cndmask_b32 v186, v186, v187, s[48:49]
  v_cndmask_b32 v40, v152, v184, s[50:51]
  v_cndmask_b32 v41, v154, v186, s[52:53]
  v_mul_f32 v40, v40, v78
  v_mul_f32 v41, v41, v82
  v_cndmask_b32 v156, v156, v157, s[48:49]
  v_cndmask_b32 v188, v188, v189, s[48:49]
  v_cndmask_b32 v158, v158, v159, s[48:49]
  v_cndmask_b32 v190, v190, v191, s[48:49]
  v_cndmask_b32 v44, v156, v188, s[50:51]
  v_cndmask_b32 v45, v158, v190, s[52:53]
  v_mul_f32 v44, v44, v79
  v_mul_f32 v45, v45, v83
  v_cndmask_b32 v144, v144, v145, s[48:49]
  v_cndmask_b32 v176, v176, v177, s[48:49]
  v_cndmask_b32 v146, v146, v147, s[48:49]
  v_cndmask_b32 v178, v178, v179, s[48:49]
  v_cndmask_b32 v32, v144, v176, s[50:51]
  v_cndmask_b32 v33, v146, v178, s[52:53]
  v_mul_f32 v32, v32, v76
  v_mul_f32 v33, v33, v80
  v_mov_b32 v48, 0xceabfb8f
  v_cndmask_b32 v32, v32, v48, s[54:55]
  v_cndmask_b32 v33, v33, v48, s[14:15]
  v_max_f32 v34, v32, v33
  v_max_f32 v38, v36, v37
  v_max_f32 v42, v40, v41
  v_max_f32 v46, v44, v45
  v_mov_b32 v35, v34
  v_mov_b32 v39, v38
  v_mov_b32 v43, v42
  v_mov_b32 v47, v46
  v_permlane32_swap_b32 v34, v35
  v_permlane32_swap_b32 v38, v39
  v_permlane32_swap_b32 v42, v43
  v_permlane32_swap_b32 v46, v47
  v_max_f32 v34, v34, v35
  v_max_f32 v38, v38, v39
  v_max_f32 v42, v42, v43
  v_max_f32 v46, v46, v47
  v_mov_b32 v35, v34
  v_mov_b32 v39, v38
  v_mov_b32 v43, v42
  v_mov_b32 v47, v46
  v_permlane16_swap_b32 v34, v35
  v_permlane16_swap_b32 v38, v39
  v_permlane16_swap_b32 v42, v43
  v_permlane16_swap_b32 v46, v47
  v_max_f32 v34, v34, v35
  v_max_f32 v38, v38, v39
  v_max_f32 v42, v42, v43
  v_max_f32 v46, v46, v47
  v_sub_f32 v32, v32, v34
  v_sub_f32 v33, v33, v34
  v_sub_f32 v36, v36, v38
  v_sub_f32 v37, v37, v38
  v_sub_f32 v40, v40, v42
  v_sub_f32 v41, v41, v42
  v_sub_f32 v44, v44, v46
  v_sub_f32 v45, v45, v46
  v_exp_f32 v32, v32
  v_exp_f32 v33, v33
  v_exp_f32 v36, v36
  v_exp_f32 v37, v37
  v_exp_f32 v40, v40
  v_exp_f32 v41, v41
  v_exp_f32 v44, v44
  v_exp_f32 v45, v45
  v_cvt_pk_bf16_f32 v32, v32, v32
  v_cvt_pk_bf16_f32 v33, v33, v33
  v_and_b32 v128, v32, v27
  v_and_b32 v129, v33, v29
  v_and_b32 v130, v32, v28
  v_and_b32 v131, v33, v30
  v_cvt_pk_bf16_f32 v36, v36, v36
  v_cvt_pk_bf16_f32 v37, v37, v37
  v_and_b32 v132, v36, v27
  v_and_b32 v133, v37, v29
  v_and_b32 v134, v36, v28
  v_and_b32 v135, v37, v30
  v_mfma_f32_16x16x32_bf16 v[144:147], v[236:239], v[128:131], 0
  v_mfma_f32_16x16x32_bf16 v[192:195], v[4:7], v[128:131], 0
  v_mfma_f32_16x16x32_bf16 v[208:211], v[224:227], v[128:131], 0
  v_cvt_pk_bf16_f32 v40, v40, v40
  v_cvt_pk_bf16_f32 v41, v41, v41
  v_and_b32 v136, v40, v27
  v_and_b32 v137, v41, v29
  v_and_b32 v138, v40, v28
  v_and_b32 v139, v41, v30
  v_mfma_f32_16x16x32_bf16 v[148:151], v[236:239], v[132:135], 0
  v_mfma_f32_16x16x32_bf16 v[196:199], v[6:9], v[132:135], 0
  v_mfma_f32_16x16x32_bf16 v[212:215], v[226:229], v[132:135], 0
  v_cvt_pk_bf16_f32 v44, v44, v44
  v_cvt_pk_bf16_f32 v45, v45, v45
  v_and_b32 v140, v44, v27
  v_and_b32 v141, v45, v29
  v_and_b32 v142, v44, v28
  v_and_b32 v143, v45, v30
  v_mfma_f32_16x16x32_bf16 v[152:155], v[236:239], v[136:139], 0
  v_mfma_f32_16x16x32_bf16 v[200:203], v[8:11], v[136:139], 0
  v_mfma_f32_16x16x32_bf16 v[216:219], v[228:231], v[136:139], 0
  v_mfma_f32_16x16x32_bf16 v[156:159], v[236:239], v[140:143], 0
  v_mfma_f32_16x16x32_bf16 v[204:207], v[10:13], v[140:143], 0
  v_mfma_f32_16x16x32_bf16 v[220:223], v[230:233], v[140:143], 0
  v_rcp_f32 v144, v144
  s_mov_b32 s3, 0
  v_pk_mul_f32 v[192:193], v[192:193], v[144:145] op_sel_hi:[1,0]
  v_pk_mul_f32 v[194:195], v[194:195], v[144:145] op_sel_hi:[1,0]
  v_pk_mul_f32 v[208:209], v[208:209], v[144:145] op_sel_hi:[1,0]
  v_pk_mul_f32 v[210:211], v[210:211], v[144:145] op_sel_hi:[1,0]
  v_cvt_pk_bf16_f32 v48, v192, v193
  v_cvt_pk_bf16_f32 v49, v194, v195
  v_cvt_pk_bf16_f32 v50, v208, v209
  v_cvt_pk_bf16_f32 v51, v210, v211
  s_nop 1
  v_permlane16_swap_b32 v48, v50
  v_permlane16_swap_b32 v49, v51
  buffer_store_dwordx4 v[48:51], v31, s[44:47], s3 offen sc1
  v_rcp_f32 v148, v148
  s_mov_b32 s3, 32768
  v_pk_mul_f32 v[196:197], v[196:197], v[148:149] op_sel_hi:[1,0]
  v_pk_mul_f32 v[198:199], v[198:199], v[148:149] op_sel_hi:[1,0]
  v_pk_mul_f32 v[212:213], v[212:213], v[148:149] op_sel_hi:[1,0]
  v_pk_mul_f32 v[214:215], v[214:215], v[148:149] op_sel_hi:[1,0]
  v_cvt_pk_bf16_f32 v52, v196, v197
  v_cvt_pk_bf16_f32 v53, v198, v199
  v_cvt_pk_bf16_f32 v54, v212, v213
  v_cvt_pk_bf16_f32 v55, v214, v215
  s_nop 1
  v_permlane16_swap_b32 v52, v54
  v_permlane16_swap_b32 v53, v55
  buffer_store_dwordx4 v[52:55], v31, s[44:47], s3 offen sc1
  v_rcp_f32 v152, v152
  s_mov_b32 s3, 65536
  v_pk_mul_f32 v[200:201], v[200:201], v[152:153] op_sel_hi:[1,0]
  v_pk_mul_f32 v[202:203], v[202:203], v[152:153] op_sel_hi:[1,0]
  v_pk_mul_f32 v[216:217], v[216:217], v[152:153] op_sel_hi:[1,0]
  v_pk_mul_f32 v[218:219], v[218:219], v[152:153] op_sel_hi:[1,0]
  v_cvt_pk_bf16_f32 v56, v200, v201
  v_cvt_pk_bf16_f32 v57, v202, v203
  v_cvt_pk_bf16_f32 v58, v216, v217
  v_cvt_pk_bf16_f32 v59, v218, v219
  s_nop 1
  v_permlane16_swap_b32 v56, v58
  v_permlane16_swap_b32 v57, v59
  buffer_store_dwordx4 v[56:59], v31, s[44:47], s3 offen sc1
  v_rcp_f32 v156, v156
  s_mov_b32 s3, 98304
  v_pk_mul_f32 v[204:205], v[204:205], v[156:157] op_sel_hi:[1,0]
  v_pk_mul_f32 v[206:207], v[206:207], v[156:157] op_sel_hi:[1,0]
  v_pk_mul_f32 v[220:221], v[220:221], v[156:157] op_sel_hi:[1,0]
  v_pk_mul_f32 v[222:223], v[222:223], v[156:157] op_sel_hi:[1,0]
  v_cvt_pk_bf16_f32 v60, v204, v205
  v_cvt_pk_bf16_f32 v61, v206, v207
  v_cvt_pk_bf16_f32 v62, v220, v221
  v_cvt_pk_bf16_f32 v63, v222, v223
  s_nop 1
  v_permlane16_swap_b32 v60, v62
  v_permlane16_swap_b32 v61, v63
  buffer_store_dwordx4 v[60:63], v31, s[44:47], s3 offen sc1
  s_waitcnt vmcnt(0) lgkmcnt(0)
  s_barrier
  s_add_u32 s97, s97, 1
  s_branch L_wo_body
.section .rodata,"a"
.p2align 6
.amdhsa_kernel interleave_layers__sliding_local_dilated__dense_activation_gelu__prompt_kernel
  .amdhsa_next_free_vgpr 256
  .amdhsa_next_free_sgpr 102
  .amdhsa_accum_offset 256
  .amdhsa_group_segment_fixed_size 0
  .amdhsa_kernarg_size 88
  .amdhsa_user_sgpr_count 2
  .amdhsa_user_sgpr_kernarg_segment_ptr 1
  .amdhsa_system_sgpr_workgroup_id_x 1
  .amdhsa_float_denorm_mode_32 3
  .amdhsa_float_denorm_mode_16_64 3
.end_amdhsa_kernel
.text
L_attn_c1:
L_wo_c0:
L_wo_body:
  s_cmp_ge_u32 s2, 256
  s_cbranch_scc1 L_wo_end
  v_lshrrev_b32 v2, 6, v0
  v_and_b32 v1, 63, v0
  v_readfirstlane_b32 s70, v2
  s_and_b32 s3, s2, 7
  s_lshr_b32 s99, s2, 3
  s_and_b32 s5, s3, 3
  s_lshl_b32 s5, s5, 2
  s_and_b32 s6, s99, 3
  s_add_u32 s68, s5, s6
  s_lshr_b32 s5, s3, 2
  s_lshr_b32 s78, s99, 2
  s_lshl1_add_u32 s69, s78, s5
  s_add_u32 s3, s68, s78
  s_lshl_b32 s3, s3, 3
  s_lshl_b32 s85, 0xffff02, s3
  s_sub_u32 s3, 0, s3
  s_lshr_b32 s3, 0xffff02, s3
  s_or_b32 s85, s85, s3
  s_cmp_lt_u32 s70, 4
  s_cbranch_scc1 L_wo_compute
L_wo_loader:
  s_add_u32 s3, s96, s70
  s_cmp_lg_u32 s3, 4
  s_cbranch_scc1 L_wo_chk0
  s_load_dwordx2 s[64:65], s[0:1], 72
  s_waitcnt lgkmcnt(0)
  s_and_b32 s65, s65, 0xffff
  s_mov_b32 s66, 256
  s_mov_b32 s67, 0x00020000
  v_lshlrev_b32 v17, 2, v1
  buffer_load_dword v12, v17, s[64:67], 0 offen sc1
L_wo_chk0:
  s_cmp_lg_u32 s96, 0
  s_cbranch_scc1 L_wo_nofirst
  s_waitcnt vmcnt(1)
  s_mov_b32 s7, 0xffff0000
  v_lshlrev_b32 v32, 16, v64
  v_and_b32 v33, s7, v64
  v_lshlrev_b32 v34, 16, v65
  v_and_b32 v35, s7, v65
  v_lshlrev_b32 v36, 16, v66
  v_and_b32 v37, s7, v66
  v_lshlrev_b32 v38, 16, v67
  v_and_b32 v39, s7, v67
  v_lshlrev_b32 v40, 16, v68
  v_and_b32 v41, s7, v68
  v_pk_add_f32 v[32:33], v[32:33], v[40:41]
  v_lshlrev_b32 v40, 16, v69
  v_and_b32 v41, s7, v69
  v_pk_add_f32 v[34:35], v[34:35], v[40:41]
  v_lshlrev_b32 v40, 16, v70
  v_and_b32 v41, s7, v70
  v_pk_add_f32 v[36:37], v[36:37], v[40:41]
  v_lshlrev_b32 v40, 16, v71
  v_and_b32 v41, s7, v71
  v_pk_add_f32 v[38:39], v[38:39], v[40:41]
  v_lshlrev_b32 v40, 16, v72
  v_and_b32 v41, s7, v72
  v_pk_add_f32 v[32:33], v[32:33], v[40:41]
  v_lshlrev_b32 v40, 16, v73
  v_and_b32 v41, s7, v73
  v_pk_add_f32 v[34:35], v[34:35], v[40:41]
  v_lshlrev_b32 v40, 16, v74
  v_and_b32 v41, s7, v74
  v_pk_add_f32 v[36:37], v[36:37], v[40:41]
  v_lshlrev_b32 v40, 16, v75
  v_and_b32 v41, s7, v75
  v_pk_add_f32 v[38:39], v[38:39], v[40:41]
  v_lshlrev_b32 v40, 16, v76
  v_and_b32 v41, s7, v76
  v_pk_add_f32 v[32:33], v[32:33], v[40:41]
  v_lshlrev_b32 v40, 16, v77
  v_and_b32 v41, s7, v77
  v_pk_add_f32 v[34:35], v[34:35], v[40:41]
  v_lshlrev_b32 v40, 16, v78
  v_and_b32 v41, s7, v78
  v_pk_add_f32 v[36:37], v[36:37], v[40:41]
  v_lshlrev_b32 v40, 16, v79
  v_and_b32 v41, s7, v79
  v_pk_add_f32 v[38:39], v[38:39], v[40:41]
  v_lshlrev_b32 v40, 16, v80
  v_and_b32 v41, s7, v80
  v_pk_add_f32 v[32:33], v[32:33], v[40:41]
  v_lshlrev_b32 v40, 16, v81
  v_and_b32 v41, s7, v81
  v_pk_add_f32 v[34:35], v[34:35], v[40:41]
  v_lshlrev_b32 v40, 16, v82
  v_and_b32 v41, s7, v82
  v_pk_add_f32 v[36:37], v[36:37], v[40:41]
  v_lshlrev_b32 v40, 16, v83
  v_and_b32 v41, s7, v83
  v_pk_add_f32 v[38:39], v[38:39], v[40:41]
  v_lshlrev_b32 v40, 16, v84
  v_and_b32 v41, s7, v84
  v_pk_add_f32 v[32:33], v[32:33], v[40:41]
  v_lshlrev_b32 v40, 16, v85
  v_and_b32 v41, s7, v85
  v_pk_add_f32 v[34:35], v[34:35], v[40:41]
  v_lshlrev_b32 v40, 16, v86
  v_and_b32 v41, s7, v86
  v_pk_add_f32 v[36:37], v[36:37], v[40:41]
  v_lshlrev_b32 v40, 16, v87
  v_and_b32 v41, s7, v87
  v_pk_add_f32 v[38:39], v[38:39], v[40:41]
  v_lshlrev_b32 v40, 16, v88
  v_and_b32 v41, s7, v88
  v_pk_add_f32 v[32:33], v[32:33], v[40:41]
  v_lshlrev_b32 v40, 16, v89
  v_and_b32 v41, s7, v89
  v_pk_add_f32 v[34:35], v[34:35], v[40:41]
  v_lshlrev_b32 v40, 16, v90
  v_and_b32 v41, s7, v90
  v_pk_add_f32 v[36:37], v[36:37], v[40:41]
  v_lshlrev_b32 v40, 16, v91
  v_and_b32 v41, s7, v91
  v_pk_add_f32 v[38:39], v[38:39], v[40:41]
  v_lshlrev_b32 v40, 16, v92
  v_and_b32 v41, s7, v92
  v_pk_add_f32 v[32:33], v[32:33], v[40:41]
  v_lshlrev_b32 v40, 16, v93
  v_and_b32 v41, s7, v93
  v_pk_add_f32 v[34:35], v[34:35], v[40:41]
  v_lshlrev_b32 v40, 16, v94
  v_and_b32 v41, s7, v94
  v_pk_add_f32 v[36:37], v[36:37], v[40:41]
  v_lshlrev_b32 v40, 16, v95
  v_and_b32 v41, s7, v95
  v_pk_add_f32 v[38:39], v[38:39], v[40:41]
  s_add_u32 s52, s22, 24641536
  s_addc_u32 s53, s23, 0
  s_and_b32 s53, s53, 0xffff
  s_mov_b32 s54, 262144
  s_mov_b32 s55, 0x00020000
  v_permlane32_swap_b32 v32, v36
  v_permlane32_swap_b32 v33, v37
  v_permlane32_swap_b32 v34, v38
  v_permlane32_swap_b32 v35, v39
  v_add_f32 v32, v32, v36
  v_add_f32 v33, v33, v37
  v_add_f32 v34, v34, v38
  v_add_f32 v35, v35, v39
  v_and_b32 v2, 7, v1
  v_lshlrev_b32 v2, 5, v2
  v_permlane16_swap_b32 v32, v34
  v_permlane16_swap_b32 v33, v35
  v_add_f32 v32, v32, v34
  v_add_f32 v33, v33, v35
  v_lshrrev_b32 v3, 4, v1
  v_lshl_add_u32 v2, v3, 3, v2
  v_add_f32_dpp v32, v32, v32 row_ror:8 row_mask:0xf bank_mask:0xf
  v_add_f32_dpp v33, v33, v33 row_ror:8 row_mask:0xf bank_mask:0xf
  buffer_store_dwordx2 v[32:33], v2, s[52:55], s94 offen sc1
L_wo_nofirst:
  v_and_b32 v2, 3, v1
  v_lshlrev_b32 v2, 3, v2
  v_bfe_i32 v16, s85, v2, 8
  s_and_b32 s3, s68, 3
  s_mul_i32 s4, s3, 4
  v_add3_u32 v3, v16, v1, s4
  v_and_b32 v3, 15, v3
  v_lshlrev_b32 v16, 17, v3
  s_add_u32 s9, s70, s68
  s_and_b32 s9, s9, 3
  s_lshl_b32 s77, s9, 11
  v_and_b32 v10, 7, v1
  v_lshrrev_b32 v3, 3, v1
  s_lshl_b32 s10, s9, 4
  v_add_u32 v3, s10, v3
  v_mul_u32_u24 v3, 2048, v3
  v_lshrrev_b32 v2, 3, v1
  v_and_b32 v2, 2, v2
  v_xor_b32 v2, v2, v10
  s_lshl_b32 s10, s69, 7
  v_add_u32 v3, s10, v3
  v_lshl_add_u32 v8, v2, 4, v3
  v_xor_b32 v2, 4, v2
  v_add_u32 v3, 16384, v3
  v_lshl_add_u32 v9, v2, 4, v3
  s_mov_b32 s40, s20
  s_and_b32 s41, s21, 0xffff
  s_mov_b32 s42, 2097152
  s_mov_b32 s43, 0x00020000
  v_readlane_b32 s74, v16, 0
  s_add_u32 m0, s77, 28672
  s_add_u32 s4, s74, 0
  buffer_load_dwordx4 v8, s[40:43], s4 offen lds
  s_add_u32 m0, s77, 29696
  s_nop 0
  buffer_load_dwordx4 v9, s[40:43], s4 offen lds
  v_readlane_b32 s74, v16, 1
  s_add_u32 m0, s77, 36864
  s_add_u32 s4, s74, 0
  buffer_load_dwordx4 v8, s[40:43], s4 offen lds
  s_add_u32 m0, s77, 37888
  s_nop 0
  buffer_load_dwordx4 v9, s[40:43], s4 offen lds
  v_readlane_b32 s74, v16, 2
  s_add_u32 m0, s77, 45056
  s_add_u32 s4, s74, 0
  buffer_load_dwordx4 v8, s[40:43], s4 offen lds
  s_add_u32 m0, s77, 46080
  s_nop 0
  buffer_load_dwordx4 v9, s[40:43], s4 offen lds
  v_readlane_b32 s74, v16, 3
  s_add_u32 m0, s77, 53248
  s_add_u32 s4, s74, 0
  buffer_load_dwordx4 v8, s[40:43], s4 offen lds
  s_add_u32 m0, s77, 54272
  s_nop 0
  buffer_load_dwordx4 v9, s[40:43], s4 offen lds
  v_readlane_b32 s74, v16, 4
  s_add_u32 m0, s77, 61440
  s_add_u32 s4, s74, 0
  buffer_load_dwordx4 v8, s[40:43], s4 offen lds
  s_add_u32 m0, s77, 62464
  s_nop 0
  buffer_load_dwordx4 v9, s[40:43], s4 offen lds
  v_readlane_b32 s74, v16, 5
  s_add_u32 m0, s77, 69632
  s_add_u32 s4, s74, 0
  buffer_load_dwordx4 v8, s[40:43], s4 offen lds
  s_add_u32 m0, s77, 70656
  s_nop 0
  buffer_load_dwordx4 v9, s[40:43], s4 offen lds
  s_waitcnt vmcnt(12)
  s_add_u32 s3, s96, s70
  s_cmp_lg_u32 s3, 4
  s_cbranch_scc1 L_wo_chk1
  v_cmp_ne_u32 vcc, 0x01010101, v12
  s_cbranch_vccz L_wo_chk1
  s_load_dwordx2 s[64:65], s[0:1], 72
  s_waitcnt lgkmcnt(0)
  s_and_b32 s65, s65, 0xffff
  s_mov_b32 s66, 256
  s_mov_b32 s67, 0x00020000
  v_lshlrev_b32 v17, 2, v1
  s_mov_b32 s79, 0x100000
L_wo_chkl:
  buffer_load_dword v12, v17, s[64:67], 0 offen sc1
  s_sub_u32 s79, s79, 1
  s_cbranch_scc1 L_wo_chk1
  s_waitcnt vmcnt(0)
  v_cmp_ne_u32 vcc, 0x01010101, v12
  s_cbranch_vccnz L_wo_chkl
L_wo_chk1:
  s_add_u32 s44, s22, 41943040
  s_addc_u32 s45, s23, 0
  s_and_b32 s45, s45, 0xffff
  s_mov_b32 s46, 524288
  s_mov_b32 s47, 0x00020000
  s_lshl4_add_u32 s3, s97, s68
  s_and_b32 s4, s69, 15
  s_lshl4_add_u32 s3, s3, s4
  s_lshl_b32 s3, s3, 7
  s_sub_u32 s3, s3, 32768
  v_lshlrev_b32 v11, 7, v1
  v_and_b32 v2, 15, v1
  v_lshlrev_b32 v2, 2, v2
  v_mov_b32 v3, 1
  s_mov_b32 s79, 0x100000
  s_cmp_lg_u32 s70, 4
  s_barrier
  s_cbranch_scc1 L_wo_nofl
  s_mov_b32 exec_lo, 0xffff
  s_mov_b32 exec_hi, 0
  buffer_store_dword v3, v11, s[44:47], s87 offen sc1
  s_mov_b64 exec, -1
L_wo_nofl:
  s_mov_b32 s5, s3
  v_readlane_b32 s74, v16, 6
  s_add_u32 m0, s77, 77824
  s_add_u32 s4, s74, 0
  buffer_load_dwordx4 v8, s[40:43], s4 offen lds
  s_add_u32 m0, s77, 78848
  s_nop 0
  buffer_load_dwordx4 v9, s[40:43], s4 offen lds
  v_readlane_b32 s74, v16, 7
  s_add_u32 m0, s77, 86016
  s_add_u32 s4, s74, 0
  buffer_load_dwordx4 v8, s[40:43], s4 offen lds
  s_add_u32 m0, s77, 87040
  s_nop 0
  buffer_load_dwordx4 v9, s[40:43], s4 offen lds
  v_readlane_b32 s74, v16, 8
  s_add_u32 m0, s77, 94208
  s_add_u32 s4, s74, 0
  buffer_load_dwordx4 v8, s[40:43], s4 offen lds
  s_add_u32 m0, s77, 95232
  s_nop 0
  buffer_load_dwordx4 v9, s[40:43], s4 offen lds
  v_readlane_b32 s74, v16, 9
  s_add_u32 m0, s77, 102400
  s_add_u32 s4, s74, 0
  buffer_load_dwordx4 v8, s[40:43], s4 offen lds
  s_add_u32 m0, s77, 103424
  s_nop 0
  buffer_load_dwordx4 v9, s[40:43], s4 offen lds
  v_readlane_b32 s74, v16, 10
  s_add_u32 m0, s77, 110592
  s_add_u32 s4, s74, 0
  buffer_load_dwordx4 v8, s[40:43], s4 offen lds
  s_add_u32 m0, s77, 111616
  s_nop 0
  buffer_load_dwordx4 v9, s[40:43], s4 offen lds
  v_readlane_b32 s74, v16, 11
  s_add_u32 m0, s77, 118784
  s_add_u32 s4, s74, 0
  buffer_load_dwordx4 v8, s[40:43], s4 offen lds
  s_add_u32 m0, s77, 119808
  s_nop 0
  buffer_load_dwordx4 v9, s[40:43], s4 offen lds
  v_readlane_b32 s74, v16, 12
  s_add_u32 m0, s77, 131072
  s_add_u32 s4, s74, 0
  buffer_load_dwordx4 v8, s[40:43], s4 offen lds
  s_add_u32 m0, s77, 132096
  s_nop 0
  buffer_load_dwordx4 v9, s[40:43], s4 offen lds
  v_readlane_b32 s74, v16, 13
  s_add_u32 m0, s77, 139264
  s_add_u32 s4, s74, 0
  buffer_load_dwordx4 v8, s[40:43], s4 offen lds
  s_add_u32 m0, s77, 140288
  s_nop 0
  buffer_load_dwordx4 v9, s[40:43], s4 offen lds
  v_readlane_b32 s74, v16, 14
  s_add_u32 m0, s77, 147456
  s_add_u32 s4, s74, 0
  buffer_load_dwordx4 v8, s[40:43], s4 offen lds
  s_add_u32 m0, s77, 148480
  s_nop 0
  buffer_load_dwordx4 v9, s[40:43], s4 offen lds
  v_readlane_b32 s74, v16, 15
  s_add_u32 m0, s77, 155648
  s_add_u32 s4, s74, 0
  buffer_load_dwordx4 v8, s[40:43], s4 offen lds
  s_add_u32 m0, s77, 156672
  s_nop 0
  buffer_load_dwordx4 v9, s[40:43], s4 offen lds
  s_mov_b32 s3, s5
  s_cmp_lg_u32 s70, 4
  s_cbranch_scc1 L_wo_dep
L_wo_poll:
  buffer_load_dword v3, v2, s[44:47], s3 offen sc1
  s_sub_u32 s79, s79, 1
  s_cbranch_scc1 L_wo_dep
  s_waitcnt vmcnt(0)
  v_cmp_ne_u32 vcc, 1, v3
  s_cbranch_vccnz L_wo_poll
L_wo_dep:
  s_waitcnt vmcnt(22) lgkmcnt(0)
  s_barrier
  s_waitcnt vmcnt(8)
  s_barrier
  s_waitcnt vmcnt(0)
  s_barrier
  s_waitcnt vmcnt(0)
  s_lshl_b32 s87, s97, 15
  s_lshl_b32 s4, s68, 11
  s_add_u32 s87, s87, s4
  s_lshl_b32 s4, s69, 2
  s_add_u32 s87, s87, s4
  s_add_u32 s97, s97, 1
  s_branch L_w1_body
L_wo_end:
  s_endpgm
L_wo_compute:
  v_and_b32 v2, 3, v1
  v_lshlrev_b32 v2, 3, v2
  v_bfe_i32 v15, s85, v2, 8
  s_and_b32 s3, s68, 3
  s_mul_i32 s4, s3, 4
  v_add3_u32 v3, v15, v1, s4
  v_and_b32 v3, 15, v3
  v_lshlrev_b32 v15, 11, v3
  v_and_b32 v3, 15, v1
  v_lshrrev_b32 v2, 4, v1
  s_lshl_b32 s8, s68, 7
  s_lshl_b32 s9, s70, 5
  s_add_u32 s8, s8, s9
  s_mul_i32 s9, s8, 2048
  v_add_u32 v13, s8, v3
  s_lshl_b32 s10, s69, 7
  v_lshl_add_u32 v14, v2, 3, s10
  v_and_b32 v16, 1, v2
  v_lshrrev_b32 v17, 1, v2
  v_lshl_add_u32 v16, v16, 1, v17
  v_lshlrev_b32 v16, 8, v16
  v_lshl_add_u32 v16, v3, 4, v16
  s_add_u32 s9, s8, s69
  s_lshl_b32 s9, s9, 11
  v_add_u32 v12, s9, v16
  s_lshl_b32 s9, s70, 12
  v_add_u32 v19, s9, v16
  v_lshl_add_u32 v18, v17, 4, v13
  v_lshlrev_b32 v18, 3, v18
  v_and_b32 v16, 1, v2
  v_lshl_add_u32 v18, v16, 2, v18
  s_lshl_b32 s10, s69, 14
  v_add_u32 v18, s10, v18
  v_bfe_u32 v6, v1, 2, 2
  v_lshl_add_u32 v6, v2, 3, v6
  v_lshlrev_b32 v6, 7, v6
  v_and_b32 v17, 3, v1
  v_lshl_add_u32 v6, v17, 3, v6
  v_bfe_u32 v17, v1, 3, 2
  v_lshl_add_u32 v6, v17, 5, v6
  v_xor_b32 v7, 32, v6
  v_xor_b32 v8, 64, v6
  v_xor_b32 v9, 96, v6
  s_mov_b32 s11, 0xffff0000
  s_mov_b32 s36, s34
  s_and_b32 s37, s35, 0xffff
  s_mov_b32 s38, 4194304
  s_mov_b32 s39, 0x00020000
  s_add_u32 s44, s34, 4194304
  s_addc_u32 s45, s35, 0
  s_and_b32 s45, s45, 0xffff
  s_mov_b32 s46, 4194304
  s_mov_b32 s47, 0x00020000
  s_add_u32 s56, s34, 24117248
  s_addc_u32 s57, s35, 0
  s_and_b32 s57, s57, 0xffff
  s_mov_b32 s58, 262144
  s_mov_b32 s59, 0x00020000
  s_mul_i32 s9, s8, 2048
  s_add_u32 s36, s36, s9
  s_addc_u32 s37, s37, 0x100000
  s_add_u32 s64, s36, 32768
  s_addc_u32 s65, s37, 0
  s_mov_b32 s38, 32768
  s_mov_b32 s39, 0x00800000
  s_mov_b32 s66, 32768
  s_mov_b32 s67, 0x00800000
  s_cmp_lg_u32 s96, 0
  s_cbranch_scc1 L_pfc2_skip
  s_getpc_b64 s[4:5]
L_pfc2:
  s_lshl_b32 s3, s99, 2
  s_add_u32 s3, s3, s70
  s_mul_i32 s3, s3, 128
  s_min_u32 s3, s3, L_w1_c1-L_w1_c0-128
  s_add_i32 s3, s3, L_w1_c0-L_pfc2
  s_ashr_i32 s6, s3, 31
  s_add_u32 s4, s4, s3
  s_addc_u32 s5, s5, s6
  s_load_dword s40, s[4:5], 0
  s_load_dword s41, s[4:5], 64
L_pfc2_skip:
  v_add_u32 v26, 155648, v6
  v_add_u32 v27, 155648, v7
  v_add_u32 v28, 155648, v8
  v_add_u32 v29, 155648, v9
  v_add_u32 v20, 94208, v6
  v_add_u32 v21, 94208, v7
  v_add_u32 v22, 94208, v8
  v_add_u32 v23, 94208, v9
  v_add_u32 v6, 28672, v6
  v_add_u32 v7, 28672, v7
  v_add_u32 v8, 28672, v8
  v_add_u32 v9, 28672, v9
  v_readlane_b32 s48, v15, 0
  v_readlane_b32 s49, v15, 1
  v_readlane_b32 s50, v15, 2
  v_permlane16_swap_b32 v240, v242
  v_permlane16_swap_b32 v241, v243
  v_permlane16_swap_b32 v244, v246
  v_permlane16_swap_b32 v245, v247
  v_permlane16_swap_b32 v248, v250
  v_permlane16_swap_b32 v249, v251
  v_permlane16_swap_b32 v252, v254
  v_permlane16_swap_b32 v253, v255
  s_waitcnt lgkmcnt(0)
  s_barrier
  buffer_load_dwordx4 v[32:35], off, s[36:39], s48 offset:0
  buffer_load_dwordx4 v[36:39], off, s[64:67], s48 offset:0
  buffer_load_dwordx4 v[40:43], off, s[36:39], s48 offset:1024
  buffer_load_dwordx4 v[44:47], off, s[64:67], s48 offset:1024
  buffer_load_dwordx4 v[48:51], off, s[36:39], s49 offset:0
  buffer_load_dwordx4 v[52:55], off, s[64:67], s49 offset:0
  buffer_load_dwordx4 v[56:59], off, s[36:39], s49 offset:1024
  buffer_load_dwordx4 v[60:63], off, s[64:67], s49 offset:1024
  buffer_load_dwordx4 v[64:67], off, s[36:39], s50 offset:0
  buffer_load_dwordx4 v[68:71], off, s[64:67], s50 offset:0
  buffer_load_dwordx4 v[72:75], off, s[36:39], s50 offset:1024
  buffer_load_dwordx4 v[76:79], off, s[64:67], s50 offset:1024
  ds_read_b64_tr_b16 v[160:161], v6 offset:0
  ds_read_b64_tr_b16 v[162:163], v6 offset:512
  ds_read_b64_tr_b16 v[164:165], v7 offset:0
  ds_read_b64_tr_b16 v[166:167], v7 offset:512
  ds_read_b64_tr_b16 v[168:169], v8 offset:0
  ds_read_b64_tr_b16 v[170:171], v8 offset:512
  ds_read_b64_tr_b16 v[172:173], v9 offset:0
  ds_read_b64_tr_b16 v[174:175], v9 offset:512
  ds_read_b64_tr_b16 v[176:177], v6 offset:4096
  ds_read_b64_tr_b16 v[178:179], v6 offset:4608
  ds_read_b64_tr_b16 v[180:181], v7 offset:4096
  ds_read_b64_tr_b16 v[182:183], v7 offset:4608
  ds_read_b64_tr_b16 v[184:185], v8 offset:4096
  ds_read_b64_tr_b16 v[186:187], v8 offset:4608
  ds_read_b64_tr_b16 v[188:189], v9 offset:4096
  ds_read_b64_tr_b16 v[190:191], v9 offset:4608
  v_lshlrev_b32 v96, 16, v240
  v_and_b32 v97, s11, v240
  v_lshlrev_b32 v98, 16, v241
  v_and_b32 v99, s11, v241
  v_lshlrev_b32 v100, 16, v248
  v_and_b32 v101, s11, v248
  v_lshlrev_b32 v102, 16, v249
  v_and_b32 v103, s11, v249
  v_lshlrev_b32 v104, 16, v242
  v_and_b32 v105, s11, v242
  v_lshlrev_b32 v106, 16, v243
  v_and_b32 v107, s11, v243
  v_lshlrev_b32 v108, 16, v250
  v_and_b32 v109, s11, v250
  v_lshlrev_b32 v110, 16, v251
  v_and_b32 v111, s11, v251
  v_lshlrev_b32 v112, 16, v244
  v_and_b32 v113, s11, v244
  v_lshlrev_b32 v114, 16, v245
  v_and_b32 v115, s11, v245
  v_lshlrev_b32 v116, 16, v252
  v_and_b32 v117, s11, v252
  v_lshlrev_b32 v118, 16, v253
  v_and_b32 v119, s11, v253
  v_lshlrev_b32 v120, 16, v246
  v_and_b32 v121, s11, v246
  v_lshlrev_b32 v122, 16, v247
  v_and_b32 v123, s11, v247
  v_lshlrev_b32 v124, 16, v254
  v_and_b32 v125, s11, v254
  v_lshlrev_b32 v126, 16, v255
  v_and_b32 v127, s11, v255
  s_waitcnt vmcnt(10) lgkmcnt(8)
  v_mfma_f32_16x16x32_bf16 v[96:99], v[160:163], v[32:35], v[96:99]
  ds_read_b64_tr_b16 v[192:193], v6 offset:8192
  v_readlane_b32 s51, v15, 3
  v_mfma_f32_16x16x32_bf16 v[100:103], v[160:163], v[36:39], v[100:103]
  ds_read_b64_tr_b16 v[194:195], v6 offset:8704
  v_mfma_f32_16x16x32_bf16 v[108:111], v[164:167], v[36:39], v[108:111]
  ds_read_b64_tr_b16 v[196:197], v7 offset:8192
  v_mfma_f32_16x16x32_bf16 v[104:107], v[164:167], v[32:35], v[104:107]
  buffer_load_dwordx4 v[80:83], off, s[36:39], s51 offset:0
  v_mfma_f32_16x16x32_bf16 v[112:115], v[168:171], v[32:35], v[112:115]
  ds_read_b64_tr_b16 v[198:199], v7 offset:8704
  ds_read_b64_tr_b16 v[200:201], v8 offset:8192
  v_mfma_f32_16x16x32_bf16 v[116:119], v[168:171], v[36:39], v[116:119]
  ds_read_b64_tr_b16 v[202:203], v8 offset:8704
  ds_read_b64_tr_b16 v[204:205], v9 offset:8192
  v_mfma_f32_16x16x32_bf16 v[124:127], v[172:175], v[36:39], v[124:127]
  buffer_load_dwordx4 v[84:87], off, s[64:67], s51 offset:0
  v_mfma_f32_16x16x32_bf16 v[120:123], v[172:175], v[32:35], v[120:123]
  ds_read_b64_tr_b16 v[206:207], v9 offset:8704
  s_waitcnt vmcnt(10) lgkmcnt(8)
  v_mfma_f32_16x16x32_bf16 v[96:99], v[176:179], v[40:43], v[96:99]
  ds_read_b64_tr_b16 v[208:209], v6 offset:12288
  v_mfma_f32_16x16x32_bf16 v[100:103], v[176:179], v[44:47], v[100:103]
  buffer_load_dwordx4 v[88:91], off, s[36:39], s51 offset:1024
  v_mfma_f32_16x16x32_bf16 v[108:111], v[180:183], v[44:47], v[108:111]
  ds_read_b64_tr_b16 v[210:211], v6 offset:12800
  ds_read_b64_tr_b16 v[212:213], v7 offset:12288
  v_mfma_f32_16x16x32_bf16 v[104:107], v[180:183], v[40:43], v[104:107]
  ds_read_b64_tr_b16 v[214:215], v7 offset:12800
  ds_read_b64_tr_b16 v[216:217], v8 offset:12288
  v_mfma_f32_16x16x32_bf16 v[112:115], v[184:187], v[40:43], v[112:115]
  buffer_load_dwordx4 v[92:95], off, s[64:67], s51 offset:1024
  v_mfma_f32_16x16x32_bf16 v[116:119], v[184:187], v[44:47], v[116:119]
  ds_read_b64_tr_b16 v[218:219], v8 offset:12800
  v_readlane_b32 s48, v15, 4
  v_mfma_f32_16x16x32_bf16 v[124:127], v[188:191], v[44:47], v[124:127]
  ds_read_b64_tr_b16 v[220:221], v9 offset:12288
  v_mfma_f32_16x16x32_bf16 v[120:123], v[188:191], v[40:43], v[120:123]
  ds_read_b64_tr_b16 v[222:223], v9 offset:12800
  s_waitcnt vmcnt(10) lgkmcnt(8)
  v_mfma_f32_16x16x32_bf16 v[96:99], v[192:195], v[48:51], v[96:99]
  buffer_load_dwordx4 v[32:35], off, s[36:39], s48 offset:0
  v_mfma_f32_16x16x32_bf16 v[100:103], v[192:195], v[52:55], v[100:103]
  ds_read_b64_tr_b16 v[160:161], v6 offset:16384
  ds_read_b64_tr_b16 v[162:163], v6 offset:16896
  v_mfma_f32_16x16x32_bf16 v[108:111], v[196:199], v[52:55], v[108:111]
  ds_read_b64_tr_b16 v[164:165], v7 offset:16384
  v_mfma_f32_16x16x32_bf16 v[104:107], v[196:199], v[48:51], v[104:107]
  buffer_load_dwordx4 v[36:39], off, s[64:67], s48 offset:0
  v_mfma_f32_16x16x32_bf16 v[112:115], v[200:203], v[48:51], v[112:115]
  ds_read_b64_tr_b16 v[166:167], v7 offset:16896
  ds_read_b64_tr_b16 v[168:169], v8 offset:16384
  v_mfma_f32_16x16x32_bf16 v[116:119], v[200:203], v[52:55], v[116:119]
  ds_read_b64_tr_b16 v[170:171], v8 offset:16896
  ds_read_b64_tr_b16 v[172:173], v9 offset:16384
  v_mfma_f32_16x16x32_bf16 v[124:127], v[204:207], v[52:55], v[124:127]
  buffer_load_dwordx4 v[40:43], off, s[36:39], s48 offset:1024
  v_mfma_f32_16x16x32_bf16 v[120:123], v[204:207], v[48:51], v[120:123]
  ds_read_b64_tr_b16 v[174:175], v9 offset:16896
  s_waitcnt vmcnt(11) lgkmcnt(8)
  v_mfma_f32_16x16x32_bf16 v[96:99], v[208:211], v[56:59], v[96:99]
  ds_read_b64_tr_b16 v[176:177], v6 offset:20480
  v_mfma_f32_16x16x32_bf16 v[100:103], v[208:211], v[60:63], v[100:103]
  buffer_load_dwordx4 v[44:47], off, s[64:67], s48 offset:1024
  v_mfma_f32_16x16x32_bf16 v[108:111], v[212:215], v[60:63], v[108:111]
  ds_read_b64_tr_b16 v[178:179], v6 offset:20992
  ds_read_b64_tr_b16 v[180:181], v7 offset:20480
  v_mfma_f32_16x16x32_bf16 v[104:107], v[212:215], v[56:59], v[104:107]
  ds_read_b64_tr_b16 v[182:183], v7 offset:20992
  v_mfma_f32_16x16x32_bf16 v[112:115], v[216:219], v[56:59], v[112:115]
  ds_read_b64_tr_b16 v[184:185], v8 offset:20480
  v_mfma_f32_16x16x32_bf16 v[116:119], v[216:219], v[60:63], v[116:119]
  ds_read_b64_tr_b16 v[186:187], v8 offset:20992
  v_readlane_b32 s49, v15, 5
  v_mfma_f32_16x16x32_bf16 v[124:127], v[220:223], v[60:63], v[124:127]
  ds_read_b64_tr_b16 v[188:189], v9 offset:20480
  v_mfma_f32_16x16x32_bf16 v[120:123], v[220:223], v[56:59], v[120:123]
  ds_read_b64_tr_b16 v[190:191], v9 offset:20992
  s_waitcnt vmcnt(10) lgkmcnt(8)
  v_mfma_f32_16x16x32_bf16 v[96:99], v[160:163], v[64:67], v[96:99]
  buffer_load_dwordx4 v[48:51], off, s[36:39], s49 offset:0
  v_mfma_f32_16x16x32_bf16 v[100:103], v[160:163], v[68:71], v[100:103]
  ds_read_b64_tr_b16 v[192:193], v6 offset:24576
  ds_read_b64_tr_b16 v[194:195], v6 offset:25088
  v_mfma_f32_16x16x32_bf16 v[108:111], v[164:167], v[68:71], v[108:111]
  ds_read_b64_tr_b16 v[196:197], v7 offset:24576
  v_mfma_f32_16x16x32_bf16 v[104:107], v[164:167], v[64:67], v[104:107]
  buffer_load_dwordx4 v[52:55], off, s[64:67], s49 offset:0
  v_mfma_f32_16x16x32_bf16 v[112:115], v[168:171], v[64:67], v[112:115]
  ds_read_b64_tr_b16 v[198:199], v7 offset:25088
  ds_read_b64_tr_b16 v[200:201], v8 offset:24576
  v_mfma_f32_16x16x32_bf16 v[116:119], v[168:171], v[68:71], v[116:119]
  ds_read_b64_tr_b16 v[202:203], v8 offset:25088
  ds_read_b64_tr_b16 v[204:205], v9 offset:24576
  v_mfma_f32_16x16x32_bf16 v[124:127], v[172:175], v[68:71], v[124:127]
  buffer_load_dwordx4 v[56:59], off, s[36:39], s49 offset:1024
  v_mfma_f32_16x16x32_bf16 v[120:123], v[172:175], v[64:67], v[120:123]
  ds_read_b64_tr_b16 v[206:207], v9 offset:25088
  s_waitcnt vmcnt(11) lgkmcnt(8)
  v_mfma_f32_16x16x32_bf16 v[96:99], v[176:179], v[72:75], v[96:99]
  ds_read_b64_tr_b16 v[208:209], v6 offset:28672
  v_mfma_f32_16x16x32_bf16 v[100:103], v[176:179], v[76:79], v[100:103]
  buffer_load_dwordx4 v[60:63], off, s[64:67], s49 offset:1024
  v_mfma_f32_16x16x32_bf16 v[108:111], v[180:183], v[76:79], v[108:111]
  ds_read_b64_tr_b16 v[210:211], v6 offset:29184
  ds_read_b64_tr_b16 v[212:213], v7 offset:28672
  v_mfma_f32_16x16x32_bf16 v[104:107], v[180:183], v[72:75], v[104:107]
  ds_read_b64_tr_b16 v[214:215], v7 offset:29184
  v_mfma_f32_16x16x32_bf16 v[112:115], v[184:187], v[72:75], v[112:115]
  ds_read_b64_tr_b16 v[216:217], v8 offset:28672
  v_mfma_f32_16x16x32_bf16 v[116:119], v[184:187], v[76:79], v[116:119]
  ds_read_b64_tr_b16 v[218:219], v8 offset:29184
  v_readlane_b32 s50, v15, 6
  v_mfma_f32_16x16x32_bf16 v[124:127], v[188:191], v[76:79], v[124:127]
  ds_read_b64_tr_b16 v[220:221], v9 offset:28672
  v_mfma_f32_16x16x32_bf16 v[120:123], v[188:191], v[72:75], v[120:123]
  ds_read_b64_tr_b16 v[222:223], v9 offset:29184
  s_waitcnt vmcnt(10) lgkmcnt(8)
  v_mfma_f32_16x16x32_bf16 v[96:99], v[192:195], v[80:83], v[96:99]
  buffer_load_dwordx4 v[64:67], off, s[36:39], s50 offset:0
  v_mfma_f32_16x16x32_bf16 v[100:103], v[192:195], v[84:87], v[100:103]
  ds_read_b64_tr_b16 v[160:161], v6 offset:32768
  ds_read_b64_tr_b16 v[162:163], v6 offset:33280
  v_mfma_f32_16x16x32_bf16 v[108:111], v[196:199], v[84:87], v[108:111]
  ds_read_b64_tr_b16 v[164:165], v7 offset:32768
  v_mfma_f32_16x16x32_bf16 v[104:107], v[196:199], v[80:83], v[104:107]
  buffer_load_dwordx4 v[68:71], off, s[64:67], s50 offset:0
  v_mfma_f32_16x16x32_bf16 v[112:115], v[200:203], v[80:83], v[112:115]
  ds_read_b64_tr_b16 v[166:167], v7 offset:33280
  ds_read_b64_tr_b16 v[168:169], v8 offset:32768
  v_mfma_f32_16x16x32_bf16 v[116:119], v[200:203], v[84:87], v[116:119]
  ds_read_b64_tr_b16 v[170:171], v8 offset:33280
  ds_read_b64_tr_b16 v[172:173], v9 offset:32768
  v_mfma_f32_16x16x32_bf16 v[124:127], v[204:207], v[84:87], v[124:127]
  buffer_load_dwordx4 v[72:75], off, s[36:39], s50 offset:1024
  v_mfma_f32_16x16x32_bf16 v[120:123], v[204:207], v[80:83], v[120:123]
  ds_read_b64_tr_b16 v[174:175], v9 offset:33280
  s_waitcnt vmcnt(11) lgkmcnt(8)
  s_barrier
  v_mfma_f32_16x16x32_bf16 v[96:99], v[208:211], v[88:91], v[96:99]
  ds_read_b64_tr_b16 v[176:177], v6 offset:36864
  v_mfma_f32_16x16x32_bf16 v[100:103], v[208:211], v[92:95], v[100:103]
  buffer_load_dwordx4 v[76:79], off, s[64:67], s50 offset:1024
  v_mfma_f32_16x16x32_bf16 v[108:111], v[212:215], v[92:95], v[108:111]
  ds_read_b64_tr_b16 v[178:179], v6 offset:37376
  ds_read_b64_tr_b16 v[180:181], v7 offset:36864
  v_mfma_f32_16x16x32_bf16 v[104:107], v[212:215], v[88:91], v[104:107]
  ds_read_b64_tr_b16 v[182:183], v7 offset:37376
  v_mfma_f32_16x16x32_bf16 v[112:115], v[216:219], v[88:91], v[112:115]
  ds_read_b64_tr_b16 v[184:185], v8 offset:36864
  v_mfma_f32_16x16x32_bf16 v[116:119], v[216:219], v[92:95], v[116:119]
  ds_read_b64_tr_b16 v[186:187], v8 offset:37376
  v_readlane_b32 s51, v15, 7
  v_mfma_f32_16x16x32_bf16 v[124:127], v[220:223], v[92:95], v[124:127]
  ds_read_b64_tr_b16 v[188:189], v9 offset:36864
  v_mfma_f32_16x16x32_bf16 v[120:123], v[220:223], v[88:91], v[120:123]
  ds_read_b64_tr_b16 v[190:191], v9 offset:37376
  s_waitcnt vmcnt(10) lgkmcnt(8)
  v_mfma_f32_16x16x32_bf16 v[96:99], v[160:163], v[32:35], v[96:99]
  buffer_load_dwordx4 v[80:83], off, s[36:39], s51 offset:0
  v_mfma_f32_16x16x32_bf16 v[100:103], v[160:163], v[36:39], v[100:103]
  ds_read_b64_tr_b16 v[192:193], v6 offset:40960
  ds_read_b64_tr_b16 v[194:195], v6 offset:41472
  v_mfma_f32_16x16x32_bf16 v[108:111], v[164:167], v[36:39], v[108:111]
  ds_read_b64_tr_b16 v[196:197], v7 offset:40960
  v_mfma_f32_16x16x32_bf16 v[104:107], v[164:167], v[32:35], v[104:107]
  buffer_load_dwordx4 v[84:87], off, s[64:67], s51 offset:0
  v_mfma_f32_16x16x32_bf16 v[112:115], v[168:171], v[32:35], v[112:115]
  ds_read_b64_tr_b16 v[198:199], v7 offset:41472
  ds_read_b64_tr_b16 v[200:201], v8 offset:40960
  v_mfma_f32_16x16x32_bf16 v[116:119], v[168:171], v[36:39], v[116:119]
  ds_read_b64_tr_b16 v[202:203], v8 offset:41472
  ds_read_b64_tr_b16 v[204:205], v9 offset:40960
  v_mfma_f32_16x16x32_bf16 v[124:127], v[172:175], v[36:39], v[124:127]
  buffer_load_dwordx4 v[88:91], off, s[36:39], s51 offset:1024
  v_mfma_f32_16x16x32_bf16 v[120:123], v[172:175], v[32:35], v[120:123]
  ds_read_b64_tr_b16 v[206:207], v9 offset:41472
  s_waitcnt vmcnt(11) lgkmcnt(8)
  v_mfma_f32_16x16x32_bf16 v[96:99], v[176:179], v[40:43], v[96:99]
  ds_read_b64_tr_b16 v[208:209], v6 offset:45056
  v_mfma_f32_16x16x32_bf16 v[100:103], v[176:179], v[44:47], v[100:103]
  buffer_load_dwordx4 v[92:95], off, s[64:67], s51 offset:1024
  v_mfma_f32_16x16x32_bf16 v[108:111], v[180:183], v[44:47], v[108:111]
  ds_read_b64_tr_b16 v[210:211], v6 offset:45568
  ds_read_b64_tr_b16 v[212:213], v7 offset:45056
  v_mfma_f32_16x16x32_bf16 v[104:107], v[180:183], v[40:43], v[104:107]
  ds_read_b64_tr_b16 v[214:215], v7 offset:45568
  v_mfma_f32_16x16x32_bf16 v[112:115], v[184:187], v[40:43], v[112:115]
  ds_read_b64_tr_b16 v[216:217], v8 offset:45056
  v_mfma_f32_16x16x32_bf16 v[116:119], v[184:187], v[44:47], v[116:119]
  ds_read_b64_tr_b16 v[218:219], v8 offset:45568
  v_readlane_b32 s48, v15, 8
  v_mfma_f32_16x16x32_bf16 v[124:127], v[188:191], v[44:47], v[124:127]
  ds_read_b64_tr_b16 v[220:221], v9 offset:45056
  v_mfma_f32_16x16x32_bf16 v[120:123], v[188:191], v[40:43], v[120:123]
  ds_read_b64_tr_b16 v[222:223], v9 offset:45568
  s_waitcnt vmcnt(10) lgkmcnt(8)
  v_mfma_f32_16x16x32_bf16 v[96:99], v[192:195], v[48:51], v[96:99]
  buffer_load_dwordx4 v[32:35], off, s[36:39], s48 offset:0
  v_mfma_f32_16x16x32_bf16 v[100:103], v[192:195], v[52:55], v[100:103]
  ds_read_b64_tr_b16 v[160:161], v6 offset:49152
  ds_read_b64_tr_b16 v[162:163], v6 offset:49664
  v_mfma_f32_16x16x32_bf16 v[108:111], v[196:199], v[52:55], v[108:111]
  ds_read_b64_tr_b16 v[164:165], v7 offset:49152
  v_mfma_f32_16x16x32_bf16 v[104:107], v[196:199], v[48:51], v[104:107]
  buffer_load_dwordx4 v[36:39], off, s[64:67], s48 offset:0
  v_mfma_f32_16x16x32_bf16 v[112:115], v[200:203], v[48:51], v[112:115]
  ds_read_b64_tr_b16 v[166:167], v7 offset:49664
  ds_read_b64_tr_b16 v[168:169], v8 offset:49152
  v_mfma_f32_16x16x32_bf16 v[116:119], v[200:203], v[52:55], v[116:119]
  ds_read_b64_tr_b16 v[170:171], v8 offset:49664
  ds_read_b64_tr_b16 v[172:173], v9 offset:49152
  v_mfma_f32_16x16x32_bf16 v[124:127], v[204:207], v[52:55], v[124:127]
  buffer_load_dwordx4 v[40:43], off, s[36:39], s48 offset:1024
  v_mfma_f32_16x16x32_bf16 v[120:123], v[204:207], v[48:51], v[120:123]
  ds_read_b64_tr_b16 v[174:175], v9 offset:49664
  s_waitcnt vmcnt(11) lgkmcnt(8)
  v_mfma_f32_16x16x32_bf16 v[96:99], v[208:211], v[56:59], v[96:99]
  ds_read_b64_tr_b16 v[176:177], v6 offset:53248
  v_mfma_f32_16x16x32_bf16 v[100:103], v[208:211], v[60:63], v[100:103]
  buffer_load_dwordx4 v[44:47], off, s[64:67], s48 offset:1024
  v_mfma_f32_16x16x32_bf16 v[108:111], v[212:215], v[60:63], v[108:111]
  ds_read_b64_tr_b16 v[178:179], v6 offset:53760
  ds_read_b64_tr_b16 v[180:181], v7 offset:53248
  v_mfma_f32_16x16x32_bf16 v[104:107], v[212:215], v[56:59], v[104:107]
  ds_read_b64_tr_b16 v[182:183], v7 offset:53760
  v_mfma_f32_16x16x32_bf16 v[112:115], v[216:219], v[56:59], v[112:115]
  ds_read_b64_tr_b16 v[184:185], v8 offset:53248
  v_mfma_f32_16x16x32_bf16 v[116:119], v[216:219], v[60:63], v[116:119]
  ds_read_b64_tr_b16 v[186:187], v8 offset:53760
  v_readlane_b32 s49, v15, 9
  v_mfma_f32_16x16x32_bf16 v[124:127], v[220:223], v[60:63], v[124:127]
  ds_read_b64_tr_b16 v[188:189], v9 offset:53248
  v_mfma_f32_16x16x32_bf16 v[120:123], v[220:223], v[56:59], v[120:123]
  ds_read_b64_tr_b16 v[190:191], v9 offset:53760
  s_waitcnt vmcnt(10) lgkmcnt(8)
  v_mfma_f32_16x16x32_bf16 v[96:99], v[160:163], v[64:67], v[96:99]
  buffer_load_dwordx4 v[48:51], off, s[36:39], s49 offset:0
  v_mfma_f32_16x16x32_bf16 v[100:103], v[160:163], v[68:71], v[100:103]
  ds_read_b64_tr_b16 v[192:193], v6 offset:57344
  ds_read_b64_tr_b16 v[194:195], v6 offset:57856
  v_mfma_f32_16x16x32_bf16 v[108:111], v[164:167], v[68:71], v[108:111]
  ds_read_b64_tr_b16 v[196:197], v7 offset:57344
  v_mfma_f32_16x16x32_bf16 v[104:107], v[164:167], v[64:67], v[104:107]
  buffer_load_dwordx4 v[52:55], off, s[64:67], s49 offset:0
  v_mfma_f32_16x16x32_bf16 v[112:115], v[168:171], v[64:67], v[112:115]
  ds_read_b64_tr_b16 v[198:199], v7 offset:57856
  ds_read_b64_tr_b16 v[200:201], v8 offset:57344
  v_mfma_f32_16x16x32_bf16 v[116:119], v[168:171], v[68:71], v[116:119]
  ds_read_b64_tr_b16 v[202:203], v8 offset:57856
  ds_read_b64_tr_b16 v[204:205], v9 offset:57344
  v_mfma_f32_16x16x32_bf16 v[124:127], v[172:175], v[68:71], v[124:127]
  buffer_load_dwordx4 v[56:59], off, s[36:39], s49 offset:1024
  v_mfma_f32_16x16x32_bf16 v[120:123], v[172:175], v[64:67], v[120:123]
  ds_read_b64_tr_b16 v[206:207], v9 offset:57856
  s_waitcnt vmcnt(11) lgkmcnt(8)
  v_mfma_f32_16x16x32_bf16 v[96:99], v[176:179], v[72:75], v[96:99]
  ds_read_b64_tr_b16 v[208:209], v6 offset:61440
  v_mfma_f32_16x16x32_bf16 v[100:103], v[176:179], v[76:79], v[100:103]
  buffer_load_dwordx4 v[60:63], off, s[64:67], s49 offset:1024
  v_mfma_f32_16x16x32_bf16 v[108:111], v[180:183], v[76:79], v[108:111]
  ds_read_b64_tr_b16 v[210:211], v6 offset:61952
  ds_read_b64_tr_b16 v[212:213], v7 offset:61440
  v_mfma_f32_16x16x32_bf16 v[104:107], v[180:183], v[72:75], v[104:107]
  ds_read_b64_tr_b16 v[214:215], v7 offset:61952
  v_mfma_f32_16x16x32_bf16 v[112:115], v[184:187], v[72:75], v[112:115]
  ds_read_b64_tr_b16 v[216:217], v8 offset:61440
  v_mfma_f32_16x16x32_bf16 v[116:119], v[184:187], v[76:79], v[116:119]
  ds_read_b64_tr_b16 v[218:219], v8 offset:61952
  v_readlane_b32 s50, v15, 10
  v_mfma_f32_16x16x32_bf16 v[124:127], v[188:191], v[76:79], v[124:127]
  ds_read_b64_tr_b16 v[220:221], v9 offset:61440
  v_mfma_f32_16x16x32_bf16 v[120:123], v[188:191], v[72:75], v[120:123]
  ds_read_b64_tr_b16 v[222:223], v9 offset:61952
  s_waitcnt vmcnt(10) lgkmcnt(8)
  v_mfma_f32_16x16x32_bf16 v[96:99], v[192:195], v[80:83], v[96:99]
  buffer_load_dwordx4 v[64:67], off, s[36:39], s50 offset:0
  v_mfma_f32_16x16x32_bf16 v[100:103], v[192:195], v[84:87], v[100:103]
  ds_read_b64_tr_b16 v[160:161], v20 offset:0
  ds_read_b64_tr_b16 v[162:163], v20 offset:512
  v_mfma_f32_16x16x32_bf16 v[108:111], v[196:199], v[84:87], v[108:111]
  ds_read_b64_tr_b16 v[164:165], v21 offset:0
  v_mfma_f32_16x16x32_bf16 v[104:107], v[196:199], v[80:83], v[104:107]
  buffer_load_dwordx4 v[68:71], off, s[64:67], s50 offset:0
  v_mfma_f32_16x16x32_bf16 v[112:115], v[200:203], v[80:83], v[112:115]
  ds_read_b64_tr_b16 v[166:167], v21 offset:512
  ds_read_b64_tr_b16 v[168:169], v22 offset:0
  v_mfma_f32_16x16x32_bf16 v[116:119], v[200:203], v[84:87], v[116:119]
  ds_read_b64_tr_b16 v[170:171], v22 offset:512
  ds_read_b64_tr_b16 v[172:173], v23 offset:0
  v_mfma_f32_16x16x32_bf16 v[124:127], v[204:207], v[84:87], v[124:127]
  buffer_load_dwordx4 v[72:75], off, s[36:39], s50 offset:1024
  v_mfma_f32_16x16x32_bf16 v[120:123], v[204:207], v[80:83], v[120:123]
  ds_read_b64_tr_b16 v[174:175], v23 offset:512
  s_waitcnt vmcnt(11) lgkmcnt(8)
  v_mfma_f32_16x16x32_bf16 v[96:99], v[208:211], v[88:91], v[96:99]
  ds_read_b64_tr_b16 v[176:177], v20 offset:4096
  v_mfma_f32_16x16x32_bf16 v[100:103], v[208:211], v[92:95], v[100:103]
  buffer_load_dwordx4 v[76:79], off, s[64:67], s50 offset:1024
  v_mfma_f32_16x16x32_bf16 v[108:111], v[212:215], v[92:95], v[108:111]
  ds_read_b64_tr_b16 v[178:179], v20 offset:4608
  ds_read_b64_tr_b16 v[180:181], v21 offset:4096
  v_mfma_f32_16x16x32_bf16 v[104:107], v[212:215], v[88:91], v[104:107]
  ds_read_b64_tr_b16 v[182:183], v21 offset:4608
  v_mfma_f32_16x16x32_bf16 v[112:115], v[216:219], v[88:91], v[112:115]
  ds_read_b64_tr_b16 v[184:185], v22 offset:4096
  v_mfma_f32_16x16x32_bf16 v[116:119], v[216:219], v[92:95], v[116:119]
  ds_read_b64_tr_b16 v[186:187], v22 offset:4608
  v_readlane_b32 s51, v15, 11
  v_mfma_f32_16x16x32_bf16 v[124:127], v[220:223], v[92:95], v[124:127]
  ds_read_b64_tr_b16 v[188:189], v23 offset:4096
  v_mfma_f32_16x16x32_bf16 v[120:123], v[220:223], v[88:91], v[120:123]
  ds_read_b64_tr_b16 v[190:191], v23 offset:4608
  s_waitcnt vmcnt(10) lgkmcnt(8)
  v_mfma_f32_16x16x32_bf16 v[96:99], v[160:163], v[32:35], v[96:99]
  buffer_load_dwordx4 v[80:83], off, s[36:39], s51 offset:0
  v_mfma_f32_16x16x32_bf16 v[100:103], v[160:163], v[36:39], v[100:103]
  ds_read_b64_tr_b16 v[192:193], v20 offset:8192
  ds_read_b64_tr_b16 v[194:195], v20 offset:8704
  v_mfma_f32_16x16x32_bf16 v[108:111], v[164:167], v[36:39], v[108:111]
  ds_read_b64_tr_b16 v[196:197], v21 offset:8192
  v_mfma_f32_16x16x32_bf16 v[104:107], v[164:167], v[32:35], v[104:107]
  buffer_load_dwordx4 v[84:87], off, s[64:67], s51 offset:0
  v_mfma_f32_16x16x32_bf16 v[112:115], v[168:171], v[32:35], v[112:115]
  ds_read_b64_tr_b16 v[198:199], v21 offset:8704
  ds_read_b64_tr_b16 v[200:201], v22 offset:8192
  v_mfma_f32_16x16x32_bf16 v[116:119], v[168:171], v[36:39], v[116:119]
  ds_read_b64_tr_b16 v[202:203], v22 offset:8704
  ds_read_b64_tr_b16 v[204:205], v23 offset:8192
  v_mfma_f32_16x16x32_bf16 v[124:127], v[172:175], v[36:39], v[124:127]
  buffer_load_dwordx4 v[88:91], off, s[36:39], s51 offset:1024
  v_mfma_f32_16x16x32_bf16 v[120:123], v[172:175], v[32:35], v[120:123]
  ds_read_b64_tr_b16 v[206:207], v23 offset:8704
  s_waitcnt vmcnt(11) lgkmcnt(8)
  v_mfma_f32_16x16x32_bf16 v[96:99], v[176:179], v[40:43], v[96:99]
  ds_read_b64_tr_b16 v[208:209], v20 offset:12288
  v_mfma_f32_16x16x32_bf16 v[100:103], v[176:179], v[44:47], v[100:103]
  buffer_load_dwordx4 v[92:95], off, s[64:67], s51 offset:1024
  v_mfma_f32_16x16x32_bf16 v[108:111], v[180:183], v[44:47], v[108:111]
  ds_read_b64_tr_b16 v[210:211], v20 offset:12800
  ds_read_b64_tr_b16 v[212:213], v21 offset:12288
  v_mfma_f32_16x16x32_bf16 v[104:107], v[180:183], v[40:43], v[104:107]
  ds_read_b64_tr_b16 v[214:215], v21 offset:12800
  v_mfma_f32_16x16x32_bf16 v[112:115], v[184:187], v[40:43], v[112:115]
  ds_read_b64_tr_b16 v[216:217], v22 offset:12288
  v_mfma_f32_16x16x32_bf16 v[116:119], v[184:187], v[44:47], v[116:119]
  ds_read_b64_tr_b16 v[218:219], v22 offset:12800
  v_readlane_b32 s48, v15, 12
  v_mfma_f32_16x16x32_bf16 v[124:127], v[188:191], v[44:47], v[124:127]
  ds_read_b64_tr_b16 v[220:221], v23 offset:12288
  v_mfma_f32_16x16x32_bf16 v[120:123], v[188:191], v[40:43], v[120:123]
  ds_read_b64_tr_b16 v[222:223], v23 offset:12800
  s_waitcnt vmcnt(10) lgkmcnt(8)
  v_mfma_f32_16x16x32_bf16 v[96:99], v[192:195], v[48:51], v[96:99]
  buffer_load_dwordx4 v[32:35], off, s[36:39], s48 offset:0
  v_mfma_f32_16x16x32_bf16 v[100:103], v[192:195], v[52:55], v[100:103]
  ds_read_b64_tr_b16 v[160:161], v20 offset:16384
  ds_read_b64_tr_b16 v[162:163], v20 offset:16896
  v_mfma_f32_16x16x32_bf16 v[108:111], v[196:199], v[52:55], v[108:111]
  ds_read_b64_tr_b16 v[164:165], v21 offset:16384
  v_mfma_f32_16x16x32_bf16 v[104:107], v[196:199], v[48:51], v[104:107]
  buffer_load_dwordx4 v[36:39], off, s[64:67], s48 offset:0
  v_mfma_f32_16x16x32_bf16 v[112:115], v[200:203], v[48:51], v[112:115]
  ds_read_b64_tr_b16 v[166:167], v21 offset:16896
  ds_read_b64_tr_b16 v[168:169], v22 offset:16384
  v_mfma_f32_16x16x32_bf16 v[116:119], v[200:203], v[52:55], v[116:119]
  ds_read_b64_tr_b16 v[170:171], v22 offset:16896
  ds_read_b64_tr_b16 v[172:173], v23 offset:16384
  v_mfma_f32_16x16x32_bf16 v[124:127], v[204:207], v[52:55], v[124:127]
  buffer_load_dwordx4 v[40:43], off, s[36:39], s48 offset:1024
  v_mfma_f32_16x16x32_bf16 v[120:123], v[204:207], v[48:51], v[120:123]
  ds_read_b64_tr_b16 v[174:175], v23 offset:16896
  s_waitcnt vmcnt(11) lgkmcnt(8)
  v_mfma_f32_16x16x32_bf16 v[96:99], v[208:211], v[56:59], v[96:99]
  ds_read_b64_tr_b16 v[176:177], v20 offset:20480
  v_mfma_f32_16x16x32_bf16 v[100:103], v[208:211], v[60:63], v[100:103]
  buffer_load_dwordx4 v[44:47], off, s[64:67], s48 offset:1024
  v_mfma_f32_16x16x32_bf16 v[108:111], v[212:215], v[60:63], v[108:111]
  ds_read_b64_tr_b16 v[178:179], v20 offset:20992
  ds_read_b64_tr_b16 v[180:181], v21 offset:20480
  v_mfma_f32_16x16x32_bf16 v[104:107], v[212:215], v[56:59], v[104:107]
  ds_read_b64_tr_b16 v[182:183], v21 offset:20992
  v_mfma_f32_16x16x32_bf16 v[112:115], v[216:219], v[56:59], v[112:115]
  ds_read_b64_tr_b16 v[184:185], v22 offset:20480
  v_mfma_f32_16x16x32_bf16 v[116:119], v[216:219], v[60:63], v[116:119]
  ds_read_b64_tr_b16 v[186:187], v22 offset:20992
  v_readlane_b32 s49, v15, 13
  v_mfma_f32_16x16x32_bf16 v[124:127], v[220:223], v[60:63], v[124:127]
  ds_read_b64_tr_b16 v[188:189], v23 offset:20480
  v_mfma_f32_16x16x32_bf16 v[120:123], v[220:223], v[56:59], v[120:123]
  ds_read_b64_tr_b16 v[190:191], v23 offset:20992
  s_waitcnt vmcnt(10) lgkmcnt(8)
  v_mfma_f32_16x16x32_bf16 v[96:99], v[160:163], v[64:67], v[96:99]
  buffer_load_dwordx4 v[48:51], off, s[36:39], s49 offset:0
  v_mfma_f32_16x16x32_bf16 v[100:103], v[160:163], v[68:71], v[100:103]
  ds_read_b64_tr_b16 v[192:193], v20 offset:24576
  ds_read_b64_tr_b16 v[194:195], v20 offset:25088
  v_mfma_f32_16x16x32_bf16 v[108:111], v[164:167], v[68:71], v[108:111]
  ds_read_b64_tr_b16 v[196:197], v21 offset:24576
  v_mfma_f32_16x16x32_bf16 v[104:107], v[164:167], v[64:67], v[104:107]
  buffer_load_dwordx4 v[52:55], off, s[64:67], s49 offset:0
  v_mfma_f32_16x16x32_bf16 v[112:115], v[168:171], v[64:67], v[112:115]
  ds_read_b64_tr_b16 v[198:199], v21 offset:25088
  ds_read_b64_tr_b16 v[200:201], v22 offset:24576
  v_mfma_f32_16x16x32_bf16 v[116:119], v[168:171], v[68:71], v[116:119]
  ds_read_b64_tr_b16 v[202:203], v22 offset:25088
  ds_read_b64_tr_b16 v[204:205], v23 offset:24576
  v_mfma_f32_16x16x32_bf16 v[124:127], v[172:175], v[68:71], v[124:127]
  buffer_load_dwordx4 v[56:59], off, s[36:39], s49 offset:1024
  v_mfma_f32_16x16x32_bf16 v[120:123], v[172:175], v[64:67], v[120:123]
  ds_read_b64_tr_b16 v[206:207], v23 offset:25088
  s_waitcnt vmcnt(11) lgkmcnt(8)
  s_barrier
  v_mfma_f32_16x16x32_bf16 v[96:99], v[176:179], v[72:75], v[96:99]
  ds_read_b64_tr_b16 v[208:209], v20 offset:28672
  v_mfma_f32_16x16x32_bf16 v[100:103], v[176:179], v[76:79], v[100:103]
  buffer_load_dwordx4 v[60:63], off, s[64:67], s49 offset:1024
  v_mfma_f32_16x16x32_bf16 v[108:111], v[180:183], v[76:79], v[108:111]
  ds_read_b64_tr_b16 v[210:211], v20 offset:29184
  ds_read_b64_tr_b16 v[212:213], v21 offset:28672
  v_mfma_f32_16x16x32_bf16 v[104:107], v[180:183], v[72:75], v[104:107]
  ds_read_b64_tr_b16 v[214:215], v21 offset:29184
  v_mfma_f32_16x16x32_bf16 v[112:115], v[184:187], v[72:75], v[112:115]
  ds_read_b64_tr_b16 v[216:217], v22 offset:28672
  v_mfma_f32_16x16x32_bf16 v[116:119], v[184:187], v[76:79], v[116:119]
  ds_read_b64_tr_b16 v[218:219], v22 offset:29184
  v_readlane_b32 s50, v15, 14
  v_mfma_f32_16x16x32_bf16 v[124:127], v[188:191], v[76:79], v[124:127]
  ds_read_b64_tr_b16 v[220:221], v23 offset:28672
  v_mfma_f32_16x16x32_bf16 v[120:123], v[188:191], v[72:75], v[120:123]
  ds_read_b64_tr_b16 v[222:223], v23 offset:29184
  s_waitcnt vmcnt(10) lgkmcnt(8)
  v_mfma_f32_16x16x32_bf16 v[96:99], v[192:195], v[80:83], v[96:99]
  buffer_load_dwordx4 v[64:67], off, s[36:39], s50 offset:0
  v_mfma_f32_16x16x32_bf16 v[100:103], v[192:195], v[84:87], v[100:103]
  ds_read_b64_tr_b16 v[160:161], v20 offset:36864
  ds_read_b64_tr_b16 v[162:163], v20 offset:37376
  v_mfma_f32_16x16x32_bf16 v[108:111], v[196:199], v[84:87], v[108:111]
  ds_read_b64_tr_b16 v[164:165], v21 offset:36864
  v_mfma_f32_16x16x32_bf16 v[104:107], v[196:199], v[80:83], v[104:107]
  buffer_load_dwordx4 v[68:71], off, s[64:67], s50 offset:0
  v_mfma_f32_16x16x32_bf16 v[112:115], v[200:203], v[80:83], v[112:115]
  ds_read_b64_tr_b16 v[166:167], v21 offset:37376
  ds_read_b64_tr_b16 v[168:169], v22 offset:36864
  v_mfma_f32_16x16x32_bf16 v[116:119], v[200:203], v[84:87], v[116:119]
  ds_read_b64_tr_b16 v[170:171], v22 offset:37376
  ds_read_b64_tr_b16 v[172:173], v23 offset:36864
  v_mfma_f32_16x16x32_bf16 v[124:127], v[204:207], v[84:87], v[124:127]
  buffer_load_dwordx4 v[72:75], off, s[36:39], s50 offset:1024
  v_mfma_f32_16x16x32_bf16 v[120:123], v[204:207], v[80:83], v[120:123]
  ds_read_b64_tr_b16 v[174:175], v23 offset:37376
  s_waitcnt vmcnt(11) lgkmcnt(8)
  v_mfma_f32_16x16x32_bf16 v[96:99], v[208:211], v[88:91], v[96:99]
  ds_read_b64_tr_b16 v[176:177], v20 offset:40960
  v_mfma_f32_16x16x32_bf16 v[100:103], v[208:211], v[92:95], v[100:103]
  buffer_load_dwordx4 v[76:79], off, s[64:67], s50 offset:1024
  v_mfma_f32_16x16x32_bf16 v[108:111], v[212:215], v[92:95], v[108:111]
  ds_read_b64_tr_b16 v[178:179], v20 offset:41472
  ds_read_b64_tr_b16 v[180:181], v21 offset:40960
  v_mfma_f32_16x16x32_bf16 v[104:107], v[212:215], v[88:91], v[104:107]
  ds_read_b64_tr_b16 v[182:183], v21 offset:41472
  v_mfma_f32_16x16x32_bf16 v[112:115], v[216:219], v[88:91], v[112:115]
  ds_read_b64_tr_b16 v[184:185], v22 offset:40960
  v_mfma_f32_16x16x32_bf16 v[116:119], v[216:219], v[92:95], v[116:119]
  ds_read_b64_tr_b16 v[186:187], v22 offset:41472
  v_readlane_b32 s51, v15, 15
  v_mfma_f32_16x16x32_bf16 v[124:127], v[220:223], v[92:95], v[124:127]
  ds_read_b64_tr_b16 v[188:189], v23 offset:40960
  v_mfma_f32_16x16x32_bf16 v[120:123], v[220:223], v[88:91], v[120:123]
  ds_read_b64_tr_b16 v[190:191], v23 offset:41472
  s_waitcnt vmcnt(10) lgkmcnt(8)
  v_mfma_f32_16x16x32_bf16 v[96:99], v[160:163], v[32:35], v[96:99]
  buffer_load_dwordx4 v[80:83], off, s[36:39], s51 offset:0
  v_mfma_f32_16x16x32_bf16 v[100:103], v[160:163], v[36:39], v[100:103]
  ds_read_b64_tr_b16 v[192:193], v20 offset:45056
  ds_read_b64_tr_b16 v[194:195], v20 offset:45568
  v_mfma_f32_16x16x32_bf16 v[108:111], v[164:167], v[36:39], v[108:111]
  ds_read_b64_tr_b16 v[196:197], v21 offset:45056
  v_mfma_f32_16x16x32_bf16 v[104:107], v[164:167], v[32:35], v[104:107]
  buffer_load_dwordx4 v[84:87], off, s[64:67], s51 offset:0
  v_mfma_f32_16x16x32_bf16 v[112:115], v[168:171], v[32:35], v[112:115]
  ds_read_b64_tr_b16 v[198:199], v21 offset:45568
  ds_read_b64_tr_b16 v[200:201], v22 offset:45056
  v_mfma_f32_16x16x32_bf16 v[116:119], v[168:171], v[36:39], v[116:119]
  ds_read_b64_tr_b16 v[202:203], v22 offset:45568
  ds_read_b64_tr_b16 v[204:205], v23 offset:45056
  v_mfma_f32_16x16x32_bf16 v[124:127], v[172:175], v[36:39], v[124:127]
  buffer_load_dwordx4 v[88:91], off, s[36:39], s51 offset:1024
  v_mfma_f32_16x16x32_bf16 v[120:123], v[172:175], v[32:35], v[120:123]
  ds_read_b64_tr_b16 v[206:207], v23 offset:45568
  s_waitcnt vmcnt(11) lgkmcnt(8)
  v_mfma_f32_16x16x32_bf16 v[96:99], v[176:179], v[40:43], v[96:99]
  ds_read_b64_tr_b16 v[208:209], v20 offset:49152
  v_mfma_f32_16x16x32_bf16 v[100:103], v[176:179], v[44:47], v[100:103]
  buffer_load_dwordx4 v[92:95], off, s[64:67], s51 offset:1024
  v_mfma_f32_16x16x32_bf16 v[108:111], v[180:183], v[44:47], v[108:111]
  ds_read_b64_tr_b16 v[210:211], v20 offset:49664
  ds_read_b64_tr_b16 v[212:213], v21 offset:49152
  v_mfma_f32_16x16x32_bf16 v[104:107], v[180:183], v[40:43], v[104:107]
  ds_read_b64_tr_b16 v[214:215], v21 offset:49664
  v_mfma_f32_16x16x32_bf16 v[112:115], v[184:187], v[40:43], v[112:115]
  ds_read_b64_tr_b16 v[216:217], v22 offset:49152
  v_mfma_f32_16x16x32_bf16 v[116:119], v[184:187], v[44:47], v[116:119]
  ds_read_b64_tr_b16 v[218:219], v22 offset:49664
  v_mfma_f32_16x16x32_bf16 v[124:127], v[188:191], v[44:47], v[124:127]
  ds_read_b64_tr_b16 v[220:221], v23 offset:49152
  v_mfma_f32_16x16x32_bf16 v[120:123], v[188:191], v[40:43], v[120:123]
  ds_read_b64_tr_b16 v[222:223], v23 offset:49664
  s_waitcnt vmcnt(10) lgkmcnt(8)
  v_mfma_f32_16x16x32_bf16 v[96:99], v[192:195], v[48:51], v[96:99]
  ds_read_b64_tr_b16 v[160:161], v20 offset:53248
  v_mfma_f32_16x16x32_bf16 v[100:103], v[192:195], v[52:55], v[100:103]
  ds_read_b64_tr_b16 v[162:163], v20 offset:53760
  v_mfma_f32_16x16x32_bf16 v[108:111], v[196:199], v[52:55], v[108:111]
  ds_read_b64_tr_b16 v[164:165], v21 offset:53248
  v_mfma_f32_16x16x32_bf16 v[104:107], v[196:199], v[48:51], v[104:107]
  ds_read_b64_tr_b16 v[166:167], v21 offset:53760
  v_mfma_f32_16x16x32_bf16 v[112:115], v[200:203], v[48:51], v[112:115]
  ds_read_b64_tr_b16 v[168:169], v22 offset:53248
  v_mfma_f32_16x16x32_bf16 v[116:119], v[200:203], v[52:55], v[116:119]
  ds_read_b64_tr_b16 v[170:171], v22 offset:53760
  v_mfma_f32_16x16x32_bf16 v[124:127], v[204:207], v[52:55], v[124:127]
  ds_read_b64_tr_b16 v[172:173], v23 offset:53248
  v_mfma_f32_16x16x32_bf16 v[120:123], v[204:207], v[48:51], v[120:123]
  ds_read_b64_tr_b16 v[174:175], v23 offset:53760
  s_waitcnt vmcnt(8) lgkmcnt(8)
  v_mfma_f32_16x16x32_bf16 v[96:99], v[208:211], v[56:59], v[96:99]
  ds_read_b64_tr_b16 v[176:177], v20 offset:57344
  v_mfma_f32_16x16x32_bf16 v[100:103], v[208:211], v[60:63], v[100:103]
  ds_read_b64_tr_b16 v[178:179], v20 offset:57856
  v_mfma_f32_16x16x32_bf16 v[108:111], v[212:215], v[60:63], v[108:111]
  ds_read_b64_tr_b16 v[180:181], v21 offset:57344
  v_mfma_f32_16x16x32_bf16 v[104:107], v[212:215], v[56:59], v[104:107]
  ds_read_b64_tr_b16 v[182:183], v21 offset:57856
  v_mfma_f32_16x16x32_bf16 v[112:115], v[216:219], v[56:59], v[112:115]
  ds_read_b64_tr_b16 v[184:185], v22 offset:57344
  v_mfma_f32_16x16x32_bf16 v[116:119], v[216:219], v[60:63], v[116:119]
  ds_read_b64_tr_b16 v[186:187], v22 offset:57856
  v_mfma_f32_16x16x32_bf16 v[124:127], v[220:223], v[60:63], v[124:127]
  ds_read_b64_tr_b16 v[188:189], v23 offset:57344
  v_mfma_f32_16x16x32_bf16 v[120:123], v[220:223], v[56:59], v[120:123]
  ds_read_b64_tr_b16 v[190:191], v23 offset:57856
  s_waitcnt vmcnt(6) lgkmcnt(8)
  v_mfma_f32_16x16x32_bf16 v[96:99], v[160:163], v[64:67], v[96:99]
  ds_read_b64_tr_b16 v[192:193], v26 offset:0
  v_mfma_f32_16x16x32_bf16 v[100:103], v[160:163], v[68:71], v[100:103]
  ds_read_b64_tr_b16 v[194:195], v26 offset:512
  v_mfma_f32_16x16x32_bf16 v[108:111], v[164:167], v[68:71], v[108:111]
  ds_read_b64_tr_b16 v[196:197], v27 offset:0
  v_mfma_f32_16x16x32_bf16 v[104:107], v[164:167], v[64:67], v[104:107]
  ds_read_b64_tr_b16 v[198:199], v27 offset:512
  v_mfma_f32_16x16x32_bf16 v[112:115], v[168:171], v[64:67], v[112:115]
  ds_read_b64_tr_b16 v[200:201], v28 offset:0
  v_mfma_f32_16x16x32_bf16 v[116:119], v[168:171], v[68:71], v[116:119]
  ds_read_b64_tr_b16 v[202:203], v28 offset:512
  v_mfma_f32_16x16x32_bf16 v[124:127], v[172:175], v[68:71], v[124:127]
  ds_read_b64_tr_b16 v[204:205], v29 offset:0
  v_mfma_f32_16x16x32_bf16 v[120:123], v[172:175], v[64:67], v[120:123]
  ds_read_b64_tr_b16 v[206:207], v29 offset:512
  s_waitcnt vmcnt(4) lgkmcnt(8)
  v_mfma_f32_16x16x32_bf16 v[96:99], v[176:179], v[72:75], v[96:99]
  ds_read_b64_tr_b16 v[208:209], v26 offset:4096
  v_mfma_f32_16x16x32_bf16 v[100:103], v[176:179], v[76:79], v[100:103]
  ds_read_b64_tr_b16 v[210:211], v26 offset:4608
  v_mfma_f32_16x16x32_bf16 v[108:111], v[180:183], v[76:79], v[108:111]
  ds_read_b64_tr_b16 v[212:213], v27 offset:4096
  v_mfma_f32_16x16x32_bf16 v[104:107], v[180:183], v[72:75], v[104:107]
  ds_read_b64_tr_b16 v[214:215], v27 offset:4608
  v_mfma_f32_16x16x32_bf16 v[112:115], v[184:187], v[72:75], v[112:115]
  ds_read_b64_tr_b16 v[216:217], v28 offset:4096
  v_mfma_f32_16x16x32_bf16 v[116:119], v[184:187], v[76:79], v[116:119]
  ds_read_b64_tr_b16 v[218:219], v28 offset:4608
  v_mfma_f32_16x16x32_bf16 v[124:127], v[188:191], v[76:79], v[124:127]
  ds_read_b64_tr_b16 v[220:221], v29 offset:4096
  v_mfma_f32_16x16x32_bf16 v[120:123], v[188:191], v[72:75], v[120:123]
  ds_read_b64_tr_b16 v[222:223], v29 offset:4608
  s_waitcnt vmcnt(2) lgkmcnt(8)
  v_mfma_f32_16x16x32_bf16 v[96:99], v[192:195], v[80:83], v[96:99]
  v_mov_b32 v20, 0
  v_mov_b32 v21, 0
  v_mfma_f32_16x16x32_bf16 v[100:103], v[192:195], v[84:87], v[100:103]
  v_mov_b32 v22, 0
  v_mov_b32 v23, 0
  v_mfma_f32_16x16x32_bf16 v[108:111], v[196:199], v[84:87], v[108:111]
  v_mfma_f32_16x16x32_bf16 v[104:107], v[196:199], v[80:83], v[104:107]
  v_mfma_f32_16x16x32_bf16 v[112:115], v[200:203], v[80:83], v[112:115]
  v_mfma_f32_16x16x32_bf16 v[116:119], v[200:203], v[84:87], v[116:119]
  v_mfma_f32_16x16x32_bf16 v[124:127], v[204:207], v[84:87], v[124:127]
  v_mfma_f32_16x16x32_bf16 v[120:123], v[204:207], v[80:83], v[120:123]
  s_waitcnt vmcnt(0) lgkmcnt(0)
  v_mfma_f32_16x16x32_bf16 v[96:99], v[208:211], v[88:91], v[96:99]
  v_mfma_f32_16x16x32_bf16 v[100:103], v[208:211], v[92:95], v[100:103]
  v_mfma_f32_16x16x32_bf16 v[108:111], v[212:215], v[92:95], v[108:111]
  v_mfma_f32_16x16x32_bf16 v[104:107], v[212:215], v[88:91], v[104:107]
  v_mfma_f32_16x16x32_bf16 v[112:115], v[216:219], v[88:91], v[112:115]
  v_mfma_f32_16x16x32_bf16 v[116:119], v[216:219], v[92:95], v[116:119]
  v_mfma_f32_16x16x32_bf16 v[124:127], v[220:223], v[92:95], v[124:127]
  v_mfma_f32_16x16x32_bf16 v[120:123], v[220:223], v[88:91], v[120:123]
  s_mov_b32 s3, 32768
  s_mov_b32 s10, 0x3f803f80
  s_nop 4
  v_cvt_pk_bf16_f32 v240, v96, v97
  v_cvt_pk_bf16_f32 v241, v98, v99
  v_cvt_pk_bf16_f32 v242, v104, v105
  v_cvt_pk_bf16_f32 v243, v106, v107
  s_nop 1
  v_permlane16_swap_b32 v240, v242
  v_permlane16_swap_b32 v241, v243
  buffer_store_dwordx4 v[240:243], v12, s[44:47], 0 offen offset:0 sc1
  ds_write_b128 v19, v[240:243] offset:0
  v_cvt_pk_bf16_f32 v244, v112, v113
  v_cvt_pk_bf16_f32 v245, v114, v115
  v_cvt_pk_bf16_f32 v246, v120, v121
  v_cvt_pk_bf16_f32 v247, v122, v123
  s_nop 1
  v_permlane16_swap_b32 v244, v246
  v_permlane16_swap_b32 v245, v247
  buffer_store_dwordx4 v[244:247], v12, s[44:47], 0 offen offset:1024 sc1
  ds_write_b128 v19, v[244:247] offset:1024
  v_cvt_pk_bf16_f32 v248, v100, v101
  v_cvt_pk_bf16_f32 v249, v102, v103
  v_cvt_pk_bf16_f32 v250, v108, v109
  v_cvt_pk_bf16_f32 v251, v110, v111
  s_nop 1
  v_permlane16_swap_b32 v248, v250
  v_permlane16_swap_b32 v249, v251
  buffer_store_dwordx4 v[248:251], v12, s[44:47], s3 offen offset:0 sc1
  ds_write_b128 v19, v[248:251] offset:2048
  v_cvt_pk_bf16_f32 v252, v116, v117
  v_cvt_pk_bf16_f32 v253, v118, v119
  v_cvt_pk_bf16_f32 v254, v124, v125
  v_cvt_pk_bf16_f32 v255, v126, v127
  s_nop 1
  v_permlane16_swap_b32 v252, v254
  v_permlane16_swap_b32 v253, v255
  buffer_store_dwordx4 v[252:255], v12, s[44:47], s3 offen offset:1024 sc1
  ds_write_b128 v19, v[252:255] offset:3072
  v_dot2_f32_bf16 v20, v240, s10, v20
  v_dot2_f32_bf16 v22, v240, v240, v22
  v_dot2_f32_bf16 v20, v241, s10, v20
  v_dot2_f32_bf16 v22, v241, v241, v22
  v_dot2_f32_bf16 v20, v242, s10, v20
  v_dot2_f32_bf16 v22, v242, v242, v22
  v_dot2_f32_bf16 v20, v243, s10, v20
  v_dot2_f32_bf16 v22, v243, v243, v22
  v_dot2_f32_bf16 v20, v244, s10, v20
  v_dot2_f32_bf16 v22, v244, v244, v22
  v_dot2_f32_bf16 v20, v245, s10, v20
  v_dot2_f32_bf16 v22, v245, v245, v22
  v_dot2_f32_bf16 v20, v246, s10, v20
  v_dot2_f32_bf16 v22, v246, v246, v22
  v_dot2_f32_bf16 v20, v247, s10, v20
  v_dot2_f32_bf16 v22, v247, v247, v22
  v_dot2_f32_bf16 v21, v248, s10, v21
  v_dot2_f32_bf16 v23, v248, v248, v23
  v_dot2_f32_bf16 v21, v249, s10, v21
  v_dot2_f32_bf16 v23, v249, v249, v23
  v_dot2_f32_bf16 v21, v250, s10, v21
  v_dot2_f32_bf16 v23, v250, v250, v23
  v_dot2_f32_bf16 v21, v251, s10, v21
  v_dot2_f32_bf16 v23, v251, v251, v23
  v_dot2_f32_bf16 v21, v252, s10, v21
  v_dot2_f32_bf16 v23, v252, v252, v23
  v_dot2_f32_bf16 v21, v253, s10, v21
  v_dot2_f32_bf16 v23, v253, v253, v23
  v_dot2_f32_bf16 v21, v254, s10, v21
  v_dot2_f32_bf16 v23, v254, v254, v23
  v_dot2_f32_bf16 v21, v255, s10, v21
  v_dot2_f32_bf16 v23, v255, v255, v23
  s_nop 2
  v_permlane32_swap_b32 v20, v21
  v_permlane32_swap_b32 v22, v23
  v_add_f32 v20, v20, v21
  v_add_f32 v22, v22, v23
  s_nop 1
  v_permlane16_swap_b32 v20, v22
  v_add_f32 v20, v20, v22
  buffer_store_dword v20, v18, s[56:59], 0 offen sc1
  s_waitcnt vmcnt(0) lgkmcnt(0)
  s_barrier
  s_add_u32 s97, s97, 1
  s_branch L_w1_body
L_wo_c1:
L_w1_c0:
L_w1_body:
  s_cmp_ge_u32 s2, 256
  s_cbranch_scc1 L_w1_end
  v_lshrrev_b32 v2, 6, v0
  v_and_b32 v1, 63, v0
  v_readfirstlane_b32 s70, v2
  s_and_b32 s3, s2, 7
  s_lshr_b32 s99, s2, 3
  s_and_b32 s5, s3, 3
  s_lshl_b32 s5, s5, 2
  s_and_b32 s6, s99, 3
  s_add_u32 s68, s5, s6
  s_lshr_b32 s5, s3, 2
  s_lshl_b32 s5, s5, 3
  s_lshr_b32 s6, s99, 2
  s_add_u32 s69, s5, s6
  s_cmp_lt_u32 s70, 4
  s_cbranch_scc1 L_w1_compute
L_w1_loader:
  s_add_u32 s8, s70, s69
  s_and_b32 s8, s8, 3
  s_add_u32 s9, s70, s68
  s_and_b32 s9, s9, 3
  s_lshl_b32 s76, s8, 12
  s_lshl_b32 s77, s9, 11
  s_add_u32 s77, s77, 16384
  s_lshl_b32 s11, s68, 7
  v_and_b32 v10, 7, v1
  s_lshr_b32 s10, s76, 11
  s_lshl_b32 s3, s68, 3
  s_add_u32 s10, s10, s3
  s_mul_i32 s10, s10, 32768
  v_lshl_add_u32 v4, v1, 4, s10
  v_add_u32 v5, 32768, v4
  v_lshrrev_b32 v3, 3, v1
  s_lshl_b32 s10, s9, 4
  v_add_u32 v3, s10, v3
  v_mul_u32_u24 v3, 7168, v3
  v_lshrrev_b32 v2, 3, v1
  v_and_b32 v2, 2, v2
  v_xor_b32 v2, v2, v10
  s_mul_i32 s10, s69, 128
  v_add_u32 v3, s10, v3
  v_lshl_add_u32 v8, v2, 4, v3
  v_xor_b32 v2, 4, v2
  v_add_u32 v3, 57344, v3
  v_lshl_add_u32 v9, v2, 4, v3
  v_lshrrev_b32 v3, 2, v1
  s_lshl_b32 s10, s9, 4
  v_add_u32 v3, s10, v3
  v_mul_u32_u24 v3, 7168, v3
  v_lshrrev_b32 v2, 4, v1
  v_and_b32 v2, 2, v2
  v_xor_b32 v2, v2, v1
  v_and_b32 v2, 3, v2
  s_lshl_b32 s10, s69, 6
  s_add_u32 s10, s10, 2048
  v_add_u32 v3, s10, v3
  v_lshl_add_u32 v28, v2, 4, v3
  s_lshl_b32 s78, s69, 7
  s_add_u32 s78, s78, 3072
  s_mov_b32 s75, 0
  s_add_u32 s100, s68, s69
  s_mov_b32 s101, -1
  s_add_u32 s3, s68, s69
  s_and_b32 s3, s3, 3
  s_mov_b32 s100, 0x68532410
  s_mov_b32 s101, 0xfedbac97
  s_cmp_eq_u32 s3, 1
  s_cselect_b32 s100, 0x96435210, s100
  s_cselect_b32 s101, 0xfecbda87, s101
  s_cmp_eq_u32 s3, 2
  s_cselect_b32 s100, 0x75463210, s100
  s_cselect_b32 s101, 0xfdceb98a, s101
  s_cmp_eq_u32 s3, 3
  s_cselect_b32 s100, 0x65743210, s100
  s_cselect_b32 s101, 0xedfca9b8, s101
  s_waitcnt lgkmcnt(0)
  s_cmp_lg_u32 s96, 0
  s_cbranch_scc1 L_pfc3_skip
  s_getpc_b64 s[4:5]
L_pfc3:
  s_lshl_b32 s3, s99, 2
  s_add_u32 s3, s3, s70
  s_sub_u32 s3, s3, 4
  s_mul_i32 s3, s3, 192
  s_min_u32 s3, s3, L_w2_c1-L_w2_c0-192
  s_add_i32 s3, s3, L_w2_c0-L_pfc3
  s_ashr_i32 s6, s3, 31
  s_add_u32 s4, s4, s3
  s_addc_u32 s5, s5, s6
  s_load_dword s84, s[4:5], 0
  s_load_dword s84, s[4:5], 64
  s_load_dword s84, s[4:5], 128
L_pfc3_skip:
  s_add_u32 s36, s34, 4194304
  s_addc_u32 s37, s35, 0
  s_and_b32 s37, s37, 0xffff
  s_mov_b32 s38, 4194304
  s_mov_b32 s39, 0x00020000
  s_mov_b32 s40, s24
  s_and_b32 s41, s25, 0xffff
  s_mov_b32 s42, 7340032
  s_mov_b32 s43, 0x00020000
  s_add_u32 s56, s34, 24117248
  s_addc_u32 s57, s35, 0
  s_and_b32 s57, s57, 0xffff
  s_mov_b32 s58, 262144
  s_mov_b32 s59, 0x00020000
  s_add_u32 s64, s22, 24641536
  s_addc_u32 s65, s23, 0
  s_and_b32 s65, s65, 0xffff
  s_mov_b32 s66, 262144
  s_mov_b32 s67, 0x00020000
  s_mov_b32 s52, s26
  s_and_b32 s53, s27, 0xffff
  s_mov_b32 s54, 7168
  s_mov_b32 s55, 0x00020000
  s_and_b32 s3, s70, 3
  s_lshl2_add_u32 s4, s68, s3
  s_lshl_b32 s4, s4, 8
  v_lshrrev_b32 v2, 4, v1
  v_and_b32 v3, 15, v1
  v_lshl_add_u32 v3, v3, 4, s4
  v_lshl_add_u32 v18, v2, 14, v3
  s_lshl_b32 s4, s69, 7
  s_lshl_b32 s5, s70, 6
  s_add_u32 s4, s4, s5
  s_add_u32 s4, s4, 1216
  s_lshl_b32 s5, s69, 6
  s_cmp_eq_u32 s70, 4
  s_cselect_b32 s4, s5, s4
  s_lshr_b32 s5, s5, 1
  s_add_u32 s5, s5, 1024
  s_cmp_eq_u32 s70, 7
  s_cselect_b32 s4, s5, s4
  v_and_b32 v3, 15, v1
  v_lshl_add_u32 v3, v3, 2, s4
  v_lshrrev_b32 v2, 4, v1
  v_add_lshl_u32 v23, v3, v2, 1
  v_lshlrev_b32 v3, 2, v3
  v_lshl_add_u32 v22, v2, 14, v3
  s_mov_b32 s60, s28
  s_and_b32 s61, s29, 0xffff
  s_mov_b32 s62, 7340032
  s_mov_b32 s63, 0x00020000
  s_cmp_eq_u32 s96, 0
  s_cselect_b32 s62, s62, 0
  s_and_b32 s3, s70, 3
  s_lshl_b32 s4, s2, 2
  s_add_u32 s3, s3, s4
  s_mul_i32 s98, s3, 3584
  s_add_u32 s98, s98, 3670016
  s_buffer_load_dword s84, s[60:63], s98 offset:0
  s_buffer_load_dword s84, s[60:63], s98 offset:64
  s_buffer_load_dword s84, s[60:63], s98 offset:128
  s_buffer_load_dword s84, s[60:63], s98 offset:192
  s_lshr_b32 s3, s69, 3
  s_and_b32 s73, s69, 7
  s_lshl1_add_u32 s91, s73, s3
  s_mul_i32 s74, s91, 458752
  s_lshl_b32 s73, s91, 11
  s_mov_b32 s88, s73
  s_add_u32 m0, s77, 0
  s_add_u32 s4, s74, 0
  buffer_load_dwordx4 v8, s[40:43], s4 offen lds
  s_add_u32 m0, s77, 1024
  s_nop 0
  buffer_load_dwordx4 v9, s[40:43], s4 offen lds
  s_add_u32 m0, s77, 8192
  s_add_u32 s4, s74, s78
  buffer_load_dwordx4 v8, s[40:43], s4 offen lds
  s_add_u32 m0, s77, 9216
  s_nop 0
  buffer_load_dwordx4 v9, s[40:43], s4 offen lds
  s_add_u32 m0, s77, 16384
  s_add_u32 s4, s4, 128
  buffer_load_dwordx4 v8, s[40:43], s4 offen lds
  s_add_u32 m0, s77, 17408
  s_nop 0
  buffer_load_dwordx4 v9, s[40:43], s4 offen lds
  s_add_u32 m0, s77, 24576
  s_nop 0
  buffer_load_dwordx4 v28, s[40:43], s74 offen lds
  s_and_b32 s73, s100, 15
  s_cmp_eq_u32 s73, s91
  s_cselect_b32 s74, 4, 0
  s_lshr_b64 s[100:101], s[100:101], s74
  s_and_b32 s73, s100, 15
  s_lshr_b64 s[100:101], s[100:101], 4
  s_mul_i32 s74, s73, 458752
  s_lshl_b32 s73, s73, 11
  s_add_u32 s3, s96, s70
  s_cmp_lg_u32 s3, 4
  s_cbranch_scc1 L_w1_chkNone
  s_add_u32 s44, s22, 41943040
  s_addc_u32 s45, s23, 0
  s_and_b32 s45, s45, 0xffff
  s_mov_b32 s46, 524288
  s_mov_b32 s47, 0x00020000
  v_lshrrev_b32 v2, 2, v1
  v_and_b32 v3, 3, v1
  v_lshlrev_b32 v2, 11, v2
  v_lshl_add_u32 v17, v3, 4, v2
  s_and_b32 s3, s69, 15
  s_lshl_b32 s3, s3, 7
  s_mov_b32 s79, 0x100000
L_w1_chkl:
  buffer_load_dwordx4 v[12:15], v17, s[44:47], s3 offen sc1
  s_sub_u32 s79, s79, 1
  s_cbranch_scc1 L_w1_chkNone
  s_waitcnt vmcnt(0)
  v_and_b32 v12, v12, v13
  v_and_b32 v14, v14, v15
  v_and_b32 v12, v12, v14
  v_cmp_ne_u32 vcc, 1, v12
  s_cbranch_vccnz L_w1_chkl
L_w1_chkNone:
  s_mov_b32 s75, 0
  s_add_u32 s44, s22, 41943040
  s_addc_u32 s45, s23, 0
  s_and_b32 s45, s45, 0xffff
  s_mov_b32 s46, 524288
  s_mov_b32 s47, 0x00020000
  s_lshl4_add_u32 s3, s97, s68
  s_and_b32 s4, s69, 15
  s_lshl4_add_u32 s3, s3, s4
  s_lshl_b32 s3, s3, 7
  s_sub_u32 s3, s3, 32768
  v_lshlrev_b32 v11, 7, v1
  v_and_b32 v2, 15, v1
  v_lshlrev_b32 v2, 2, v2
  v_mov_b32 v3, 1
  s_mov_b32 s79, 0x100000
  s_waitcnt vmcnt(0)
  s_cmp_lg_u32 s70, 4
  s_barrier
  s_cbranch_scc1 L_w1_nofl
  s_mov_b32 exec_lo, 0xffff
  s_mov_b32 exec_hi, 0
  buffer_store_dword v3, v11, s[44:47], s87 offen sc1
  s_mov_b64 exec, -1
L_w1_nofl:
  s_mov_b32 s5, s3
  s_mov_b32 s89, s73
  s_add_u32 m0, s77, 49152
  s_add_u32 s4, s74, 0
  buffer_load_dwordx4 v8, s[40:43], s4 offen lds
  s_add_u32 m0, s77, 50176
  s_nop 0
  buffer_load_dwordx4 v9, s[40:43], s4 offen lds
  s_add_u32 m0, s77, 57344
  s_add_u32 s4, s74, s78
  buffer_load_dwordx4 v8, s[40:43], s4 offen lds
  s_add_u32 m0, s77, 58368
  s_nop 0
  buffer_load_dwordx4 v9, s[40:43], s4 offen lds
  s_add_u32 m0, s77, 65536
  s_add_u32 s4, s4, 128
  buffer_load_dwordx4 v8, s[40:43], s4 offen lds
  s_add_u32 m0, s77, 66560
  s_nop 0
  buffer_load_dwordx4 v9, s[40:43], s4 offen lds
  s_add_u32 m0, s77, 73728
  s_nop 0
  buffer_load_dwordx4 v28, s[40:43], s74 offen lds
  s_and_b32 s73, s100, 15
  s_cmp_eq_u32 s73, s91
  s_cselect_b32 s74, 4, 0
  s_lshr_b64 s[100:101], s[100:101], s74
  s_and_b32 s73, s100, 15
  s_lshr_b64 s[100:101], s[100:101], 4
  s_mul_i32 s74, s73, 458752
  s_lshl_b32 s73, s73, 11
  s_mov_b32 s90, s73
  s_add_u32 m0, s77, 98304
  s_add_u32 s4, s74, 0
  buffer_load_dwordx4 v8, s[40:43], s4 offen lds
  s_add_u32 m0, s77, 99328
  s_nop 0
  buffer_load_dwordx4 v9, s[40:43], s4 offen lds
  s_add_u32 m0, s77, 106496
  s_add_u32 s4, s74, s78
  buffer_load_dwordx4 v8, s[40:43], s4 offen lds
  s_add_u32 m0, s77, 107520
  s_nop 0
  buffer_load_dwordx4 v9, s[40:43], s4 offen lds
  s_add_u32 m0, s77, 114688
  s_add_u32 s4, s4, 128
  buffer_load_dwordx4 v8, s[40:43], s4 offen lds
  s_add_u32 m0, s77, 115712
  s_nop 0
  buffer_load_dwordx4 v9, s[40:43], s4 offen lds
  s_add_u32 m0, s77, 122880
  s_nop 0
  buffer_load_dwordx4 v28, s[40:43], s74 offen lds
  s_and_b32 s73, s100, 15
  s_cmp_eq_u32 s73, s91
  s_cselect_b32 s74, 4, 0
  s_lshr_b64 s[100:101], s[100:101], s74
  s_and_b32 s73, s100, 15
  s_lshr_b64 s[100:101], s[100:101], 4
  s_mul_i32 s74, s73, 458752
  s_lshl_b32 s73, s73, 11
  s_mov_b32 s3, s5
  s_cmp_lg_u32 s70, 4
  s_cbranch_scc1 L_w1_dep
L_w1_poll:
  buffer_load_dword v3, v2, s[44:47], s3 offen sc1
  s_sub_u32 s79, s79, 1
  s_cbranch_scc1 L_w1_dep
  s_waitcnt vmcnt(0)
  v_cmp_ne_u32 vcc, 1, v3
  s_cbranch_vccnz L_w1_poll
L_w1_dep:
  s_barrier
  s_add_u32 m0, s76, 49152
  s_nop 0
  buffer_load_dwordx4 v4, s[36:39], s89 offen offset:0 lds
  buffer_load_dwordx4 v4, s[36:39], s89 offen offset:1024 lds
  s_add_u32 m0, s76, 51200
  s_nop 0
  buffer_load_dwordx4 v5, s[36:39], s89 offen offset:0 lds
  buffer_load_dwordx4 v5, s[36:39], s89 offen offset:1024 lds
  s_add_u32 m0, s76, 98304
  s_nop 0
  buffer_load_dwordx4 v4, s[36:39], s90 offen offset:0 lds
  buffer_load_dwordx4 v4, s[36:39], s90 offen offset:1024 lds
  s_add_u32 m0, s76, 100352
  s_nop 0
  buffer_load_dwordx4 v5, s[36:39], s90 offen offset:0 lds
  buffer_load_dwordx4 v5, s[36:39], s90 offen offset:1024 lds
  s_waitcnt vmcnt(4)
  s_barrier
  s_mov_b32 s79, 13
L_w1_ld1:
  s_add_u32 s3, s75, s76
  s_add_u32 m0, s3, 0
  s_nop 0
  buffer_load_dwordx4 v4, s[36:39], s73 offen offset:0 lds
  buffer_load_dwordx4 v4, s[36:39], s73 offen offset:1024 lds
  s_add_u32 m0, s3, 2048
  s_nop 0
  buffer_load_dwordx4 v5, s[36:39], s73 offen offset:0 lds
  buffer_load_dwordx4 v5, s[36:39], s73 offen offset:1024 lds
  s_add_u32 s3, s75, s77
  s_add_u32 m0, s3, 0
  s_add_u32 s4, s74, 0
  buffer_load_dwordx4 v8, s[40:43], s4 offen lds
  s_add_u32 m0, s3, 1024
  s_nop 0
  buffer_load_dwordx4 v9, s[40:43], s4 offen lds
  s_add_u32 m0, s3, 8192
  s_add_u32 s4, s74, s78
  buffer_load_dwordx4 v8, s[40:43], s4 offen lds
  s_add_u32 m0, s3, 9216
  s_nop 0
  buffer_load_dwordx4 v9, s[40:43], s4 offen lds
  s_add_u32 m0, s3, 16384
  s_add_u32 s4, s4, 128
  buffer_load_dwordx4 v8, s[40:43], s4 offen lds
  s_add_u32 m0, s3, 17408
  s_nop 0
  buffer_load_dwordx4 v9, s[40:43], s4 offen lds
  s_add_u32 m0, s3, 24576
  s_nop 0
  buffer_load_dwordx4 v28, s[40:43], s74 offen lds
  s_and_b32 s73, s100, 15
  s_cmp_eq_u32 s73, s91
  s_cselect_b32 s74, 4, 0
  s_lshr_b64 s[100:101], s[100:101], s74
  s_and_b32 s73, s100, 15
  s_lshr_b64 s[100:101], s[100:101], 4
  s_mul_i32 s74, s73, 458752
  s_lshl_b32 s73, s73, 11
  s_add_u32 s75, s75, 49152
  s_cmp_eq_u32 s75, 147456
  s_cselect_b32 s75, 0, s75
  s_buffer_load_dword s84, s[60:63], s98 offset:256
  s_buffer_load_dword s84, s[60:63], s98 offset:320
  s_buffer_load_dword s84, s[60:63], s98 offset:384
  s_buffer_load_dword s84, s[60:63], s98 offset:448
  s_add_u32 s98, s98, 256
  s_waitcnt vmcnt(11)
  s_barrier
  s_sub_u32 s79, s79, 1
  s_cmp_lg_u32 s79, 0
  s_cbranch_scc1 L_w1_ld1
  buffer_load_dwordx4 v[64:67], v22, s[64:67], 0 offen
  s_mov_b32 s3, 65536
  buffer_load_dwordx4 v[68:71], v22, s[64:67], s3 offen
  s_mov_b32 s3, 131072
  buffer_load_dwordx4 v[72:75], v22, s[64:67], s3 offen
  s_mov_b32 s3, 196608
  buffer_load_dwordx4 v[76:79], v22, s[64:67], s3 offen
  buffer_load_ushort v80, v23, s[52:55], 0 offen
  buffer_load_dwordx4 v[32:35], v18, s[56:59], 0 offen
  s_mov_b32 s3, 65536
  buffer_load_dwordx4 v[36:39], v18, s[56:59], s3 offen
  s_mov_b32 s3, 131072
  buffer_load_dwordx4 v[40:43], v18, s[56:59], s3 offen
  s_mov_b32 s3, 196608
  buffer_load_dwordx4 v[44:47], v18, s[56:59], s3 offen
  s_waitcnt vmcnt(9)
  s_barrier
  s_waitcnt vmcnt(0)
  v_pk_add_f32 v[32:33], v[32:33], v[36:37]
  v_pk_add_f32 v[34:35], v[34:35], v[38:39]
  v_pk_add_f32 v[40:41], v[40:41], v[44:45]
  v_pk_add_f32 v[42:43], v[42:43], v[46:47]
  v_pk_add_f32 v[32:33], v[32:33], v[40:41]
  v_pk_add_f32 v[34:35], v[34:35], v[42:43]
  s_nop 1
  v_permlane32_swap_b32 v32, v34
  v_permlane32_swap_b32 v33, v35
  v_pk_add_f32 v[32:33], v[32:33], v[34:35]
  v_mov_b32 v34, v32
  v_mov_b32 v35, v33
  s_nop 0
  v_permlane16_swap_b32 v32, v34
  v_permlane16_swap_b32 v33, v35
  v_pk_add_f32 v[32:33], v[32:33], v[34:35]
  v_mul_f32 v32, 0x3a800000, v32
  v_mul_f32 v33, 0x3a800000, v33
  v_fma_f32 v33, -v32, v32, v33
  v_max_f32 v33, 0, v33
  v_add_f32 v33, 0x3727c5ac, v33
  v_rsq_f32 v33, v33
  s_nop 0
  s_and_b32 s3, s70, 3
  s_lshl_b32 s5, s3, 7
  s_add_u32 s5, s5, 110656
  v_and_b32 v3, 15, v1
  v_lshrrev_b32 v2, 5, v1
  v_lshl_add_u32 v2, v3, 1, v2
  v_lshl_add_u32 v2, v2, 2, s5
  ds_write2_b32 v2, v32, v33 offset0:0 offset1:160
  v_pk_add_f32 v[64:65], v[64:65], v[68:69]
  v_pk_add_f32 v[66:67], v[66:67], v[70:71]
  v_pk_add_f32 v[72:73], v[72:73], v[76:77]
  v_pk_add_f32 v[74:75], v[74:75], v[78:79]
  v_pk_add_f32 v[64:65], v[64:65], v[72:73]
  v_pk_add_f32 v[66:67], v[66:67], v[74:75]
  s_nop 1
  v_permlane32_swap_b32 v64, v66
  v_permlane32_swap_b32 v65, v67
  v_pk_add_f32 v[64:65], v[64:65], v[66:67]
  v_lshlrev_b32 v80, 16, v80
  s_lshl_b32 s5, s3, 8
  s_add_u32 s5, s5, 111872
  v_permlane16_swap_b32 v64, v65
  v_lshrrev_b32 v2, 4, v1
  v_lshl_add_u32 v2, v3, 2, v2
  v_lshl_add_u32 v2, v2, 2, s5
  v_add_f32 v64, v64, v65
  ds_write2st64_b32 v2, v64, v80 offset0:0 offset1:4
  s_waitcnt lgkmcnt(0)
  s_barrier
  s_lshl_b32 s87, s97, 15
  s_lshl_b32 s4, s68, 11
  s_add_u32 s87, s87, s4
  s_lshl_b32 s4, s69, 2
  s_add_u32 s87, s87, s4
  s_add_u32 s97, s97, 1
  s_branch L_w2_body
L_w1_end:
  s_endpgm
L_w1_compute:
  s_and_b32 s71, s70, 1
  s_lshr_b32 s72, s70, 1
  v_and_b32 v3, 15, v1
  v_lshrrev_b32 v2, 4, v1
  s_lshl_b32 s8, s71, 13
  v_lshl_add_u32 v4, v1, 4, s8
  v_bfe_u32 v13, v1, 2, 2
  v_lshl_add_u32 v13, v2, 3, v13
  v_lshlrev_b32 v13, 7, v13
  v_and_b32 v17, 3, v1
  v_lshl_add_u32 v13, v17, 3, v13
  v_bfe_u32 v17, v1, 3, 2
  v_lshl_add_u32 v13, v17, 5, v13
  s_lshl_b32 s9, s72, 6
  v_xor_b32 v13, s9, v13
  v_add_u32 v5, 16384, v13
  v_xor_b32 v6, 32, v5
  v_and_b32 v16, 1, v2
  v_lshrrev_b32 v17, 1, v2
  v_bfe_u32 v13, v1, 2, 2
  v_lshl_add_u32 v13, v16, 3, v13
  v_lshl_add_u32 v13, v17, 5, v13
  v_xor_b32 v14, s72, v16
  v_lshl_add_u32 v13, v13, 1, v14
  v_and_b32 v14, 3, v1
  v_lshl_add_u32 v13, v13, 2, v14
  v_lshlrev_b32 v13, 3, v13
  v_add_u32 v7, 40960, v13
  s_mov_b32 s75, 0
  v_add_u32_e64 v20, s75, v4
  v_add_u32_e64 v21, s75, v5
  v_add_u32_e64 v22, s75, v6
  v_add_u32_e64 v23, s75, v7
  s_add_u32 s75, s75, 49152
  s_cmp_eq_u32 s75, 147456
  s_cselect_b32 s75, 0, s75
  s_mov_b32 s79, 15
  ds_read_b128 v[32:35], v20 offset:0
  ds_read_b128 v[36:39], v20 offset:2048
  ds_read_b128 v[40:43], v20 offset:4096
  ds_read_b128 v[44:47], v20 offset:6144
  ds_read_b64_tr_b16 v[48:49], v21 offset:0
  ds_read_b64_tr_b16 v[50:51], v21 offset:512
  ds_read_b64_tr_b16 v[52:53], v22 offset:0
  ds_read_b64_tr_b16 v[54:55], v22 offset:512
  ds_read_b64_tr_b16 v[56:57], v21 offset:8192
  ds_read_b64_tr_b16 v[58:59], v21 offset:8704
  ds_read_b64_tr_b16 v[60:61], v22 offset:8192
  ds_read_b64_tr_b16 v[62:63], v22 offset:8704
  ds_read_b64_tr_b16 v[64:65], v21 offset:16384
  ds_read_b64_tr_b16 v[66:67], v21 offset:16896
  ds_read_b64_tr_b16 v[68:69], v22 offset:16384
  ds_read_b64_tr_b16 v[70:71], v22 offset:16896
  ds_read_b64_tr_b16 v[72:73], v23 offset:0
  ds_read_b64_tr_b16 v[74:75], v23 offset:256
  s_waitcnt lgkmcnt(0)
  v_mfma_f32_16x16x32_bf16 v[128:131], v[48:51], v[32:35], 0
  ds_read_b128 v[80:83], v20 offset:1024
  v_mfma_f32_16x16x32_bf16 v[132:135], v[48:51], v[36:39], 0
  ds_read_b128 v[84:87], v20 offset:3072
  v_mfma_f32_16x16x32_bf16 v[136:139], v[48:51], v[40:43], 0
  ds_read_b128 v[88:91], v20 offset:5120
  v_mfma_f32_16x16x32_bf16 v[140:143], v[48:51], v[44:47], 0
  ds_read_b128 v[92:95], v20 offset:7168
  v_mfma_f32_16x16x32_bf16 v[156:159], v[52:55], v[44:47], 0
  ds_read_b64_tr_b16 v[96:97], v21 offset:4096
  v_mfma_f32_16x16x32_bf16 v[152:155], v[52:55], v[40:43], 0
  ds_read_b64_tr_b16 v[98:99], v21 offset:4608
  v_mfma_f32_16x16x32_bf16 v[148:151], v[52:55], v[36:39], 0
  ds_read_b64_tr_b16 v[100:101], v22 offset:4096
  v_mfma_f32_16x16x32_bf16 v[144:147], v[52:55], v[32:35], 0
  ds_read_b64_tr_b16 v[102:103], v22 offset:4608
  v_mfma_f32_16x16x32_bf16 v[160:163], v[56:59], v[32:35], 0
  ds_read_b64_tr_b16 v[104:105], v21 offset:12288
  v_mfma_f32_16x16x32_bf16 v[164:167], v[56:59], v[36:39], 0
  ds_read_b64_tr_b16 v[106:107], v21 offset:12800
  v_mfma_f32_16x16x32_bf16 v[168:171], v[56:59], v[40:43], 0
  ds_read_b64_tr_b16 v[108:109], v22 offset:12288
  v_mfma_f32_16x16x32_bf16 v[172:175], v[56:59], v[44:47], 0
  ds_read_b64_tr_b16 v[110:111], v22 offset:12800
  v_mfma_f32_16x16x32_bf16 v[188:191], v[60:63], v[44:47], 0
  ds_read_b64_tr_b16 v[112:113], v21 offset:20480
  v_mfma_f32_16x16x32_bf16 v[184:187], v[60:63], v[40:43], 0
  ds_read_b64_tr_b16 v[114:115], v21 offset:20992
  v_mfma_f32_16x16x32_bf16 v[180:183], v[60:63], v[36:39], 0
  ds_read_b64_tr_b16 v[116:117], v22 offset:20480
  v_mfma_f32_16x16x32_bf16 v[176:179], v[60:63], v[32:35], 0
  ds_read_b64_tr_b16 v[118:119], v22 offset:20992
  v_mfma_f32_16x16x32_bf16 v[192:195], v[64:67], v[32:35], 0
  ds_read_b64_tr_b16 v[120:121], v23 offset:4096
  v_mfma_f32_16x16x32_bf16 v[196:199], v[64:67], v[36:39], 0
  ds_read_b64_tr_b16 v[122:123], v23 offset:4352
  v_mfma_f32_16x16x32_bf16 v[200:203], v[64:67], v[40:43], 0
  v_add_u32_e64 v20, s75, v4
  v_mfma_f32_16x16x32_bf16 v[204:207], v[64:67], v[44:47], 0
  v_add_u32_e64 v21, s75, v5
  v_mfma_f32_16x16x32_bf16 v[220:223], v[68:71], v[44:47], 0
  v_add_u32_e64 v22, s75, v6
  v_mfma_f32_16x16x32_bf16 v[216:219], v[68:71], v[40:43], 0
  v_add_u32_e64 v23, s75, v7
  v_mfma_f32_16x16x32_bf16 v[212:215], v[68:71], v[36:39], 0
  s_add_u32 s75, s75, 49152
  v_mfma_f32_16x16x32_bf16 v[208:211], v[68:71], v[32:35], 0
  s_cmp_eq_u32 s75, 147456
  v_mfma_f32_16x16x32_bf16 v[224:227], v[72:75], v[32:35], 0
  s_cselect_b32 s75, 0, s75
  v_mfma_f32_16x16x32_bf16 v[228:231], v[72:75], v[36:39], 0
  v_mfma_f32_16x16x32_bf16 v[232:235], v[72:75], v[40:43], 0
  v_mfma_f32_16x16x32_bf16 v[236:239], v[72:75], v[44:47], 0
  s_waitcnt lgkmcnt(0)
  v_mfma_f32_16x16x32_bf16 v[128:131], v[96:99], v[80:83], v[128:131]
  v_mfma_f32_16x16x32_bf16 v[132:135], v[96:99], v[84:87], v[132:135]
  v_mfma_f32_16x16x32_bf16 v[136:139], v[96:99], v[88:91], v[136:139]
  v_mfma_f32_16x16x32_bf16 v[140:143], v[96:99], v[92:95], v[140:143]
  v_mfma_f32_16x16x32_bf16 v[156:159], v[100:103], v[92:95], v[156:159]
  v_mfma_f32_16x16x32_bf16 v[152:155], v[100:103], v[88:91], v[152:155]
  v_mfma_f32_16x16x32_bf16 v[148:151], v[100:103], v[84:87], v[148:151]
  v_mfma_f32_16x16x32_bf16 v[144:147], v[100:103], v[80:83], v[144:147]
  v_mfma_f32_16x16x32_bf16 v[160:163], v[104:107], v[80:83], v[160:163]
  v_mfma_f32_16x16x32_bf16 v[164:167], v[104:107], v[84:87], v[164:167]
  v_mfma_f32_16x16x32_bf16 v[168:171], v[104:107], v[88:91], v[168:171]
  v_mfma_f32_16x16x32_bf16 v[172:175], v[104:107], v[92:95], v[172:175]
  v_mfma_f32_16x16x32_bf16 v[188:191], v[108:111], v[92:95], v[188:191]
  v_mfma_f32_16x16x32_bf16 v[184:187], v[108:111], v[88:91], v[184:187]
  v_mfma_f32_16x16x32_bf16 v[180:183], v[108:111], v[84:87], v[180:183]
  v_mfma_f32_16x16x32_bf16 v[176:179], v[108:111], v[80:83], v[176:179]
  v_mfma_f32_16x16x32_bf16 v[192:195], v[112:115], v[80:83], v[192:195]
  v_mfma_f32_16x16x32_bf16 v[196:199], v[112:115], v[84:87], v[196:199]
  v_mfma_f32_16x16x32_bf16 v[200:203], v[112:115], v[88:91], v[200:203]
  v_mfma_f32_16x16x32_bf16 v[204:207], v[112:115], v[92:95], v[204:207]
  v_mfma_f32_16x16x32_bf16 v[220:223], v[116:119], v[92:95], v[220:223]
  v_mfma_f32_16x16x32_bf16 v[216:219], v[116:119], v[88:91], v[216:219]
  v_mfma_f32_16x16x32_bf16 v[212:215], v[116:119], v[84:87], v[212:215]
  v_mfma_f32_16x16x32_bf16 v[208:211], v[116:119], v[80:83], v[208:211]
  v_mfma_f32_16x16x32_bf16 v[224:227], v[120:123], v[80:83], v[224:227]
  v_mfma_f32_16x16x32_bf16 v[228:231], v[120:123], v[84:87], v[228:231]
  v_mfma_f32_16x16x32_bf16 v[232:235], v[120:123], v[88:91], v[232:235]
  v_mfma_f32_16x16x32_bf16 v[236:239], v[120:123], v[92:95], v[236:239]
  s_barrier
  s_lshl_b32 s8, s68, 7
  s_lshl_b32 s9, s71, 6
  s_add_u32 s8, s8, s9
  s_mul_i32 s8, s8, 7168
  v_lshlrev_b32 v14, 8, v17
  v_lshl_add_u32 v14, v3, 4, v14
  s_lshl3_add_u32 s9, s71, s72
  s_lshl_b32 s9, s9, 10
  s_add_u32 s9, s9, 114688
  v_lshl_add_u32 v18, v16, 9, v14
  v_add_u32 v18, s9, v18
  s_mov_b32 s52, s30
  s_and_b32 s53, s31, 0xffff
  s_mov_b32 s54, 2048
  s_mov_b32 s55, 0x00020000
  s_lshr_b32 s9, s69, 3
  s_and_b32 s10, s69, 7
  s_lshl1_add_u32 s9, s10, s9
  s_lshl_b32 s9, s9, 7
  v_lshl_add_u32 v19, v2, 3, s9
  v_add_u32 v14, s8, v14
  s_lshl_b32 s10, s69, 11
  s_lshl_b32 s9, s72, 10
  s_add_u32 s9, s9, s10
  v_lshl_add_u32 v12, v16, 9, v14
  v_add_u32 v12, s9, v12
  v_mul_u32_u24 v16, 114688, v16
  s_lshr_b32 s9, s9, 1
  v_add3_u32 v13, v16, v14, s9
  s_lshl_b32 s9, s71, 8
  s_add_u32 s9, s9, 110656
  v_lshl_add_u32 v14, v3, 2, s9
  s_lshl_b32 s9, s72, 7
  s_add_u32 s9, s9, 111872
  v_lshl_add_u32 v15, v2, 4, s9
  s_lshl_b32 s9, s72, 6
  s_add_u32 s9, s9, 111872
  v_lshl_add_u32 v16, v2, 4, s9
  s_add_u32 s44, s34, 8388608
  s_addc_u32 s45, s35, 0
  s_and_b32 s45, s45, 0xffff
  s_mov_b32 s46, 14680064
  s_mov_b32 s47, 0x00020000
  s_barrier
  ds_read_b128 v[32:35], v20 offset:0
  ds_read_b128 v[36:39], v20 offset:2048
  ds_read_b128 v[40:43], v20 offset:4096
  ds_read_b128 v[44:47], v20 offset:6144
  ds_read_b64_tr_b16 v[48:49], v21 offset:0
  ds_read_b64_tr_b16 v[50:51], v21 offset:512
  ds_read_b64_tr_b16 v[52:53], v22 offset:0
  ds_read_b64_tr_b16 v[54:55], v22 offset:512
  ds_read_b64_tr_b16 v[56:57], v21 offset:8192
  ds_read_b64_tr_b16 v[58:59], v21 offset:8704
  ds_read_b64_tr_b16 v[60:61], v22 offset:8192
  ds_read_b64_tr_b16 v[62:63], v22 offset:8704
  ds_read_b64_tr_b16 v[64:65], v21 offset:16384
  ds_read_b64_tr_b16 v[66:67], v21 offset:16896
  ds_read_b64_tr_b16 v[68:69], v22 offset:16384
  ds_read_b64_tr_b16 v[70:71], v22 offset:16896
  ds_read_b64_tr_b16 v[72:73], v23 offset:0
  ds_read_b64_tr_b16 v[74:75], v23 offset:256
  s_waitcnt lgkmcnt(0)
.p2align 3
L_w1_loop:
  v_mfma_f32_16x16x32_bf16 v[128:131], v[48:51], v[32:35], v[128:131]
  ds_read_b128 v[80:83], v20 offset:1024
  v_mfma_f32_16x16x32_bf16 v[132:135], v[48:51], v[36:39], v[132:135]
  ds_read_b128 v[84:87], v20 offset:3072
  v_mfma_f32_16x16x32_bf16 v[136:139], v[48:51], v[40:43], v[136:139]
  ds_read_b128 v[88:91], v20 offset:5120
  v_mfma_f32_16x16x32_bf16 v[140:143], v[48:51], v[44:47], v[140:143]
  ds_read_b128 v[92:95], v20 offset:7168
  v_mfma_f32_16x16x32_bf16 v[156:159], v[52:55], v[44:47], v[156:159]
  ds_read_b64_tr_b16 v[96:97], v21 offset:4096
  v_mfma_f32_16x16x32_bf16 v[152:155], v[52:55], v[40:43], v[152:155]
  ds_read_b64_tr_b16 v[98:99], v21 offset:4608
  v_mfma_f32_16x16x32_bf16 v[148:151], v[52:55], v[36:39], v[148:151]
  ds_read_b64_tr_b16 v[100:101], v22 offset:4096
  v_mfma_f32_16x16x32_bf16 v[144:147], v[52:55], v[32:35], v[144:147]
  ds_read_b64_tr_b16 v[102:103], v22 offset:4608
  v_mfma_f32_16x16x32_bf16 v[160:163], v[56:59], v[32:35], v[160:163]
  ds_read_b64_tr_b16 v[104:105], v21 offset:12288
  v_mfma_f32_16x16x32_bf16 v[164:167], v[56:59], v[36:39], v[164:167]
  ds_read_b64_tr_b16 v[106:107], v21 offset:12800
  v_mfma_f32_16x16x32_bf16 v[168:171], v[56:59], v[40:43], v[168:171]
  ds_read_b64_tr_b16 v[108:109], v22 offset:12288
  v_mfma_f32_16x16x32_bf16 v[172:175], v[56:59], v[44:47], v[172:175]
  ds_read_b64_tr_b16 v[110:111], v22 offset:12800
  v_mfma_f32_16x16x32_bf16 v[188:191], v[60:63], v[44:47], v[188:191]
  ds_read_b64_tr_b16 v[112:113], v21 offset:20480
  v_mfma_f32_16x16x32_bf16 v[184:187], v[60:63], v[40:43], v[184:187]
  ds_read_b64_tr_b16 v[114:115], v21 offset:20992
  v_mfma_f32_16x16x32_bf16 v[180:183], v[60:63], v[36:39], v[180:183]
  ds_read_b64_tr_b16 v[116:117], v22 offset:20480
  v_mfma_f32_16x16x32_bf16 v[176:179], v[60:63], v[32:35], v[176:179]
  ds_read_b64_tr_b16 v[118:119], v22 offset:20992
  v_mfma_f32_16x16x32_bf16 v[192:195], v[64:67], v[32:35], v[192:195]
  ds_read_b64_tr_b16 v[120:121], v23 offset:4096
  v_mfma_f32_16x16x32_bf16 v[196:199], v[64:67], v[36:39], v[196:199]
  ds_read_b64_tr_b16 v[122:123], v23 offset:4352
  v_mfma_f32_16x16x32_bf16 v[200:203], v[64:67], v[40:43], v[200:203]
  v_add_u32_e64 v20, s75, v4
  v_mfma_f32_16x16x32_bf16 v[204:207], v[64:67], v[44:47], v[204:207]
  v_add_u32_e64 v21, s75, v5
  v_mfma_f32_16x16x32_bf16 v[220:223], v[68:71], v[44:47], v[220:223]
  v_add_u32_e64 v22, s75, v6
  v_mfma_f32_16x16x32_bf16 v[216:219], v[68:71], v[40:43], v[216:219]
  v_add_u32_e64 v23, s75, v7
  v_mfma_f32_16x16x32_bf16 v[212:215], v[68:71], v[36:39], v[212:215]
  s_add_u32 s75, s75, 49152
  v_mfma_f32_16x16x32_bf16 v[208:211], v[68:71], v[32:35], v[208:211]
  s_cmp_eq_u32 s75, 147456
  v_mfma_f32_16x16x32_bf16 v[224:227], v[72:75], v[32:35], v[224:227]
  s_cselect_b32 s75, 0, s75
  s_sub_u32 s79, s79, 1
  v_mfma_f32_16x16x32_bf16 v[228:231], v[72:75], v[36:39], v[228:231]
  v_mfma_f32_16x16x32_bf16 v[232:235], v[72:75], v[40:43], v[232:235]
  v_mfma_f32_16x16x32_bf16 v[236:239], v[72:75], v[44:47], v[236:239]
  s_waitcnt lgkmcnt(0)
  s_barrier
  v_mfma_f32_16x16x32_bf16 v[128:131], v[96:99], v[80:83], v[128:131]
  ds_read_b128 v[32:35], v20 offset:0
  v_mfma_f32_16x16x32_bf16 v[132:135], v[96:99], v[84:87], v[132:135]
  ds_read_b128 v[36:39], v20 offset:2048
  v_mfma_f32_16x16x32_bf16 v[136:139], v[96:99], v[88:91], v[136:139]
  ds_read_b128 v[40:43], v20 offset:4096
  v_mfma_f32_16x16x32_bf16 v[140:143], v[96:99], v[92:95], v[140:143]
  ds_read_b128 v[44:47], v20 offset:6144
  v_mfma_f32_16x16x32_bf16 v[156:159], v[100:103], v[92:95], v[156:159]
  ds_read_b64_tr_b16 v[48:49], v21 offset:0
  v_mfma_f32_16x16x32_bf16 v[152:155], v[100:103], v[88:91], v[152:155]
  ds_read_b64_tr_b16 v[50:51], v21 offset:512
  v_mfma_f32_16x16x32_bf16 v[148:151], v[100:103], v[84:87], v[148:151]
  ds_read_b64_tr_b16 v[52:53], v22 offset:0
  v_mfma_f32_16x16x32_bf16 v[144:147], v[100:103], v[80:83], v[144:147]
  ds_read_b64_tr_b16 v[54:55], v22 offset:512
  v_mfma_f32_16x16x32_bf16 v[160:163], v[104:107], v[80:83], v[160:163]
  ds_read_b64_tr_b16 v[56:57], v21 offset:8192
  v_mfma_f32_16x16x32_bf16 v[164:167], v[104:107], v[84:87], v[164:167]
  ds_read_b64_tr_b16 v[58:59], v21 offset:8704
  v_mfma_f32_16x16x32_bf16 v[168:171], v[104:107], v[88:91], v[168:171]
  ds_read_b64_tr_b16 v[60:61], v22 offset:8192
  v_mfma_f32_16x16x32_bf16 v[172:175], v[104:107], v[92:95], v[172:175]
  ds_read_b64_tr_b16 v[62:63], v22 offset:8704
  v_mfma_f32_16x16x32_bf16 v[188:191], v[108:111], v[92:95], v[188:191]
  ds_read_b64_tr_b16 v[64:65], v21 offset:16384
  v_mfma_f32_16x16x32_bf16 v[184:187], v[108:111], v[88:91], v[184:187]
  ds_read_b64_tr_b16 v[66:67], v21 offset:16896
  v_mfma_f32_16x16x32_bf16 v[180:183], v[108:111], v[84:87], v[180:183]
  ds_read_b64_tr_b16 v[68:69], v22 offset:16384
  v_mfma_f32_16x16x32_bf16 v[176:179], v[108:111], v[80:83], v[176:179]
  ds_read_b64_tr_b16 v[70:71], v22 offset:16896
  v_mfma_f32_16x16x32_bf16 v[192:195], v[112:115], v[80:83], v[192:195]
  ds_read_b64_tr_b16 v[72:73], v23 offset:0
  v_mfma_f32_16x16x32_bf16 v[196:199], v[112:115], v[84:87], v[196:199]
  ds_read_b64_tr_b16 v[74:75], v23 offset:256
  v_mfma_f32_16x16x32_bf16 v[200:203], v[112:115], v[88:91], v[200:203]
  s_cmp_lg_u32 s79, 0
  s_nop 0
  v_mfma_f32_16x16x32_bf16 v[204:207], v[112:115], v[92:95], v[204:207]
  v_mfma_f32_16x16x32_bf16 v[220:223], v[116:119], v[92:95], v[220:223]
  v_mfma_f32_16x16x32_bf16 v[216:219], v[116:119], v[88:91], v[216:219]
  v_mfma_f32_16x16x32_bf16 v[212:215], v[116:119], v[84:87], v[212:215]
  v_mfma_f32_16x16x32_bf16 v[208:211], v[116:119], v[80:83], v[208:211]
  v_mfma_f32_16x16x32_bf16 v[224:227], v[120:123], v[80:83], v[224:227]
  v_mfma_f32_16x16x32_bf16 v[228:231], v[120:123], v[84:87], v[228:231]
  v_mfma_f32_16x16x32_bf16 v[232:235], v[120:123], v[88:91], v[232:235]
  v_mfma_f32_16x16x32_bf16 v[236:239], v[120:123], v[92:95], v[236:239]
  s_waitcnt lgkmcnt(0)
  s_cbranch_scc1 L_w1_loop
L_w1_exit:
  ds_read2_b32 v[88:89], v14 offset0:0 offset1:160
  ds_read2_b32 v[90:91], v14 offset0:16 offset1:176
  ds_read2_b32 v[92:93], v14 offset0:32 offset1:192
  ds_read2_b32 v[94:95], v14 offset0:48 offset1:208
  ds_read_b128 v[32:35], v15 offset:0
  ds_read_b128 v[60:63], v15 offset:1024
  ds_read_b128 v[36:39], v15 offset:64
  ds_read_b128 v[64:67], v15 offset:1088
  ds_read_b128 v[40:43], v15 offset:256
  ds_read_b128 v[68:71], v15 offset:1280
  ds_read_b128 v[44:47], v15 offset:320
  ds_read_b128 v[72:75], v15 offset:1344
  ds_read_b128 v[48:51], v15 offset:512
  ds_read_b128 v[76:79], v15 offset:1536
  ds_read_b128 v[52:55], v15 offset:576
  ds_read_b128 v[80:83], v15 offset:1600
  ds_read_b128 v[56:59], v16 offset:768
  ds_read_b128 v[84:87], v16 offset:1792
  buffer_load_dwordx2 v[10:11], v19, s[52:55], 0 offen offset:0
  buffer_load_dwordx2 v[24:25], v19, s[52:55], 0 offen offset:32
  buffer_load_dwordx2 v[124:125], v19, s[52:55], 0 offen offset:64
  buffer_load_dwordx2 v[126:127], v19, s[52:55], 0 offen offset:96
  v_mov_b32 v96, 0xc0135761
  v_mov_b32 v97, 0xbdd2d3e8
  v_mov_b32 v98, 1.0
  s_waitcnt lgkmcnt(0)
  v_mul_f32 v88, v88, v89
  v_mul_f32 v90, v90, v91
  v_mul_f32 v92, v92, v93
  v_mul_f32 v94, v94, v95
  v_pk_fma_f32 v[100:101], v[32:33], v[88:89], v[60:61] op_sel:[0,0,0] op_sel_hi:[1,0,1] neg_lo:[0,1,0] neg_hi:[0,1,0]
  v_pk_fma_f32 v[102:103], v[34:35], v[88:89], v[62:63] op_sel:[0,0,0] op_sel_hi:[1,0,1] neg_lo:[0,1,0] neg_hi:[0,1,0]
  v_pk_fma_f32 v[128:129], v[128:129], v[88:89], v[100:101] op_sel:[0,1,0] op_sel_hi:[1,1,1]
  v_pk_fma_f32 v[130:131], v[130:131], v[88:89], v[102:103] op_sel:[0,1,0] op_sel_hi:[1,1,1]
  v_pk_mul_f32 v[100:101], v[128:129], v[128:129]
  v_pk_mul_f32 v[102:103], v[130:131], v[130:131]
  v_pk_fma_f32 v[100:101], v[100:101], v[96:97], v[96:97] op_sel:[0,1,0] op_sel_hi:[1,1,0]
  v_pk_fma_f32 v[102:103], v[102:103], v[96:97], v[96:97] op_sel:[0,1,0] op_sel_hi:[1,1,0]
  v_pk_mul_f32 v[100:101], v[100:101], v[128:129]
  v_pk_mul_f32 v[102:103], v[102:103], v[130:131]
  v_exp_f32 v100, v100
  v_exp_f32 v101, v101
  v_exp_f32 v102, v102
  v_exp_f32 v103, v103
  v_pk_add_f32 v[100:101], v[100:101], v[98:99] op_sel_hi:[1,0]
  v_pk_add_f32 v[102:103], v[102:103], v[98:99] op_sel_hi:[1,0]
  v_rcp_f32 v100, v100
  v_rcp_f32 v101, v101
  v_rcp_f32 v102, v102
  v_rcp_f32 v103, v103
  v_pk_mul_f32 v[128:129], v[128:129], v[100:101]
  v_pk_mul_f32 v[130:131], v[130:131], v[102:103]
  v_cvt_pk_bf16_f32 v108, v128, v129
  v_cvt_pk_bf16_f32 v109, v130, v131
  v_pk_fma_f32 v[104:105], v[36:37], v[88:89], v[64:65] op_sel:[0,0,0] op_sel_hi:[1,0,1] neg_lo:[0,1,0] neg_hi:[0,1,0]
  v_pk_fma_f32 v[106:107], v[38:39], v[88:89], v[66:67] op_sel:[0,0,0] op_sel_hi:[1,0,1] neg_lo:[0,1,0] neg_hi:[0,1,0]
  v_pk_fma_f32 v[144:145], v[144:145], v[88:89], v[104:105] op_sel:[0,1,0] op_sel_hi:[1,1,1]
  v_pk_fma_f32 v[146:147], v[146:147], v[88:89], v[106:107] op_sel:[0,1,0] op_sel_hi:[1,1,1]
  v_pk_mul_f32 v[104:105], v[144:145], v[144:145]
  v_pk_mul_f32 v[106:107], v[146:147], v[146:147]
  v_pk_fma_f32 v[104:105], v[104:105], v[96:97], v[96:97] op_sel:[0,1,0] op_sel_hi:[1,1,0]
  v_pk_fma_f32 v[106:107], v[106:107], v[96:97], v[96:97] op_sel:[0,1,0] op_sel_hi:[1,1,0]
  v_pk_mul_f32 v[104:105], v[104:105], v[144:145]
  v_pk_mul_f32 v[106:107], v[106:107], v[146:147]
  v_exp_f32 v104, v104
  v_exp_f32 v105, v105
  v_exp_f32 v106, v106
  v_exp_f32 v107, v107
  v_pk_add_f32 v[104:105], v[104:105], v[98:99] op_sel_hi:[1,0]
  v_pk_add_f32 v[106:107], v[106:107], v[98:99] op_sel_hi:[1,0]
  v_rcp_f32 v104, v104
  v_rcp_f32 v105, v105
  v_rcp_f32 v106, v106
  v_rcp_f32 v107, v107
  v_pk_mul_f32 v[144:145], v[144:145], v[104:105]
  v_pk_mul_f32 v[146:147], v[146:147], v[106:107]
  v_cvt_pk_bf16_f32 v110, v144, v145
  v_cvt_pk_bf16_f32 v111, v146, v147
  s_mov_b32 s3, 0
  s_nop 0
  v_permlane16_swap_b32 v108, v110
  v_permlane16_swap_b32 v109, v111
  buffer_store_dwordx4 v[108:111], v12, s[44:47], s3 offen sc1
  ds_write_b128 v18, v[108:111] offset:32768
  v_pk_fma_f32 v[100:101], v[32:33], v[90:91], v[60:61] op_sel:[0,0,0] op_sel_hi:[1,0,1] neg_lo:[0,1,0] neg_hi:[0,1,0]
  v_pk_fma_f32 v[102:103], v[34:35], v[90:91], v[62:63] op_sel:[0,0,0] op_sel_hi:[1,0,1] neg_lo:[0,1,0] neg_hi:[0,1,0]
  v_pk_fma_f32 v[132:133], v[132:133], v[90:91], v[100:101] op_sel:[0,1,0] op_sel_hi:[1,1,1]
  v_pk_fma_f32 v[134:135], v[134:135], v[90:91], v[102:103] op_sel:[0,1,0] op_sel_hi:[1,1,1]
  v_pk_mul_f32 v[100:101], v[132:133], v[132:133]
  v_pk_mul_f32 v[102:103], v[134:135], v[134:135]
  v_pk_fma_f32 v[100:101], v[100:101], v[96:97], v[96:97] op_sel:[0,1,0] op_sel_hi:[1,1,0]
  v_pk_fma_f32 v[102:103], v[102:103], v[96:97], v[96:97] op_sel:[0,1,0] op_sel_hi:[1,1,0]
  v_pk_mul_f32 v[100:101], v[100:101], v[132:133]
  v_pk_mul_f32 v[102:103], v[102:103], v[134:135]
  v_exp_f32 v100, v100
  v_exp_f32 v101, v101
  v_exp_f32 v102, v102
  v_exp_f32 v103, v103
  v_pk_add_f32 v[100:101], v[100:101], v[98:99] op_sel_hi:[1,0]
  v_pk_add_f32 v[102:103], v[102:103], v[98:99] op_sel_hi:[1,0]
  v_rcp_f32 v100, v100
  v_rcp_f32 v101, v101
  v_rcp_f32 v102, v102
  v_rcp_f32 v103, v103
  v_pk_mul_f32 v[132:133], v[132:133], v[100:101]
  v_pk_mul_f32 v[134:135], v[134:135], v[102:103]
  v_cvt_pk_bf16_f32 v112, v132, v133
  v_cvt_pk_bf16_f32 v113, v134, v135
  v_pk_fma_f32 v[104:105], v[36:37], v[90:91], v[64:65] op_sel:[0,0,0] op_sel_hi:[1,0,1] neg_lo:[0,1,0] neg_hi:[0,1,0]
  v_pk_fma_f32 v[106:107], v[38:39], v[90:91], v[66:67] op_sel:[0,0,0] op_sel_hi:[1,0,1] neg_lo:[0,1,0] neg_hi:[0,1,0]
  v_pk_fma_f32 v[148:149], v[148:149], v[90:91], v[104:105] op_sel:[0,1,0] op_sel_hi:[1,1,1]
  v_pk_fma_f32 v[150:151], v[150:151], v[90:91], v[106:107] op_sel:[0,1,0] op_sel_hi:[1,1,1]
  v_pk_mul_f32 v[104:105], v[148:149], v[148:149]
  v_pk_mul_f32 v[106:107], v[150:151], v[150:151]
  v_pk_fma_f32 v[104:105], v[104:105], v[96:97], v[96:97] op_sel:[0,1,0] op_sel_hi:[1,1,0]
  v_pk_fma_f32 v[106:107], v[106:107], v[96:97], v[96:97] op_sel:[0,1,0] op_sel_hi:[1,1,0]
  v_pk_mul_f32 v[104:105], v[104:105], v[148:149]
  v_pk_mul_f32 v[106:107], v[106:107], v[150:151]
  v_exp_f32 v104, v104
  v_exp_f32 v105, v105
  v_exp_f32 v106, v106
  v_exp_f32 v107, v107
  v_pk_add_f32 v[104:105], v[104:105], v[98:99] op_sel_hi:[1,0]
  v_pk_add_f32 v[106:107], v[106:107], v[98:99] op_sel_hi:[1,0]
  v_rcp_f32 v104, v104
  v_rcp_f32 v105, v105
  v_rcp_f32 v106, v106
  v_rcp_f32 v107, v107
  v_pk_mul_f32 v[148:149], v[148:149], v[104:105]
  v_pk_mul_f32 v[150:151], v[150:151], v[106:107]
  v_cvt_pk_bf16_f32 v114, v148, v149
  v_cvt_pk_bf16_f32 v115, v150, v151
  s_mov_b32 s3, 114688
  s_nop 0
  v_permlane16_swap_b32 v112, v114
  v_permlane16_swap_b32 v113, v115
  buffer_store_dwordx4 v[112:115], v12, s[44:47], s3 offen sc1
  ds_write_b128 v18, v[112:115] offset:34816
  v_pk_fma_f32 v[100:101], v[32:33], v[92:93], v[60:61] op_sel:[0,0,0] op_sel_hi:[1,0,1] neg_lo:[0,1,0] neg_hi:[0,1,0]
  v_pk_fma_f32 v[102:103], v[34:35], v[92:93], v[62:63] op_sel:[0,0,0] op_sel_hi:[1,0,1] neg_lo:[0,1,0] neg_hi:[0,1,0]
  v_pk_fma_f32 v[136:137], v[136:137], v[92:93], v[100:101] op_sel:[0,1,0] op_sel_hi:[1,1,1]
  v_pk_fma_f32 v[138:139], v[138:139], v[92:93], v[102:103] op_sel:[0,1,0] op_sel_hi:[1,1,1]
  v_pk_mul_f32 v[100:101], v[136:137], v[136:137]
  v_pk_mul_f32 v[102:103], v[138:139], v[138:139]
  v_pk_fma_f32 v[100:101], v[100:101], v[96:97], v[96:97] op_sel:[0,1,0] op_sel_hi:[1,1,0]
  v_pk_fma_f32 v[102:103], v[102:103], v[96:97], v[96:97] op_sel:[0,1,0] op_sel_hi:[1,1,0]
  v_pk_mul_f32 v[100:101], v[100:101], v[136:137]
  v_pk_mul_f32 v[102:103], v[102:103], v[138:139]
  v_exp_f32 v100, v100
  v_exp_f32 v101, v101
  v_exp_f32 v102, v102
  v_exp_f32 v103, v103
  v_pk_add_f32 v[100:101], v[100:101], v[98:99] op_sel_hi:[1,0]
  v_pk_add_f32 v[102:103], v[102:103], v[98:99] op_sel_hi:[1,0]
  v_rcp_f32 v100, v100
  v_rcp_f32 v101, v101
  v_rcp_f32 v102, v102
  v_rcp_f32 v103, v103
  v_pk_mul_f32 v[136:137], v[136:137], v[100:101]
  v_pk_mul_f32 v[138:139], v[138:139], v[102:103]
  v_cvt_pk_bf16_f32 v116, v136, v137
  v_cvt_pk_bf16_f32 v117, v138, v139
  v_pk_fma_f32 v[104:105], v[36:37], v[92:93], v[64:65] op_sel:[0,0,0] op_sel_hi:[1,0,1] neg_lo:[0,1,0] neg_hi:[0,1,0]
  v_pk_fma_f32 v[106:107], v[38:39], v[92:93], v[66:67] op_sel:[0,0,0] op_sel_hi:[1,0,1] neg_lo:[0,1,0] neg_hi:[0,1,0]
  v_pk_fma_f32 v[152:153], v[152:153], v[92:93], v[104:105] op_sel:[0,1,0] op_sel_hi:[1,1,1]
  v_pk_fma_f32 v[154:155], v[154:155], v[92:93], v[106:107] op_sel:[0,1,0] op_sel_hi:[1,1,1]
  v_pk_mul_f32 v[104:105], v[152:153], v[152:153]
  v_pk_mul_f32 v[106:107], v[154:155], v[154:155]
  v_pk_fma_f32 v[104:105], v[104:105], v[96:97], v[96:97] op_sel:[0,1,0] op_sel_hi:[1,1,0]
  v_pk_fma_f32 v[106:107], v[106:107], v[96:97], v[96:97] op_sel:[0,1,0] op_sel_hi:[1,1,0]
  v_pk_mul_f32 v[104:105], v[104:105], v[152:153]
  v_pk_mul_f32 v[106:107], v[106:107], v[154:155]
  v_exp_f32 v104, v104
  v_exp_f32 v105, v105
  v_exp_f32 v106, v106
  v_exp_f32 v107, v107
  v_pk_add_f32 v[104:105], v[104:105], v[98:99] op_sel_hi:[1,0]
  v_pk_add_f32 v[106:107], v[106:107], v[98:99] op_sel_hi:[1,0]
  v_rcp_f32 v104, v104
  v_rcp_f32 v105, v105
  v_rcp_f32 v106, v106
  v_rcp_f32 v107, v107
  v_pk_mul_f32 v[152:153], v[152:153], v[104:105]
  v_pk_mul_f32 v[154:155], v[154:155], v[106:107]
  v_cvt_pk_bf16_f32 v118, v152, v153
  v_cvt_pk_bf16_f32 v119, v154, v155
  s_mov_b32 s3, 229376
  s_nop 0
  v_permlane16_swap_b32 v116, v118
  v_permlane16_swap_b32 v117, v119
  buffer_store_dwordx4 v[116:119], v12, s[44:47], s3 offen sc1
  ds_write_b128 v18, v[116:119] offset:36864
  v_pk_fma_f32 v[100:101], v[32:33], v[94:95], v[60:61] op_sel:[0,0,0] op_sel_hi:[1,0,1] neg_lo:[0,1,0] neg_hi:[0,1,0]
  v_pk_fma_f32 v[102:103], v[34:35], v[94:95], v[62:63] op_sel:[0,0,0] op_sel_hi:[1,0,1] neg_lo:[0,1,0] neg_hi:[0,1,0]
  v_pk_fma_f32 v[140:141], v[140:141], v[94:95], v[100:101] op_sel:[0,1,0] op_sel_hi:[1,1,1]
  v_pk_fma_f32 v[142:143], v[142:143], v[94:95], v[102:103] op_sel:[0,1,0] op_sel_hi:[1,1,1]
  v_pk_mul_f32 v[100:101], v[140:141], v[140:141]
  v_pk_mul_f32 v[102:103], v[142:143], v[142:143]
  v_pk_fma_f32 v[100:101], v[100:101], v[96:97], v[96:97] op_sel:[0,1,0] op_sel_hi:[1,1,0]
  v_pk_fma_f32 v[102:103], v[102:103], v[96:97], v[96:97] op_sel:[0,1,0] op_sel_hi:[1,1,0]
  v_pk_mul_f32 v[100:101], v[100:101], v[140:141]
  v_pk_mul_f32 v[102:103], v[102:103], v[142:143]
  v_exp_f32 v100, v100
  v_exp_f32 v101, v101
  v_exp_f32 v102, v102
  v_exp_f32 v103, v103
  v_pk_add_f32 v[100:101], v[100:101], v[98:99] op_sel_hi:[1,0]
  v_pk_add_f32 v[102:103], v[102:103], v[98:99] op_sel_hi:[1,0]
  v_rcp_f32 v100, v100
  v_rcp_f32 v101, v101
  v_rcp_f32 v102, v102
  v_rcp_f32 v103, v103
  v_pk_mul_f32 v[140:141], v[140:141], v[100:101]
  v_pk_mul_f32 v[142:143], v[142:143], v[102:103]
  v_cvt_pk_bf16_f32 v120, v140, v141
  v_cvt_pk_bf16_f32 v121, v142, v143
  v_pk_fma_f32 v[104:105], v[36:37], v[94:95], v[64:65] op_sel:[0,0,0] op_sel_hi:[1,0,1] neg_lo:[0,1,0] neg_hi:[0,1,0]
  v_pk_fma_f32 v[106:107], v[38:39], v[94:95], v[66:67] op_sel:[0,0,0] op_sel_hi:[1,0,1] neg_lo:[0,1,0] neg_hi:[0,1,0]
  v_pk_fma_f32 v[156:157], v[156:157], v[94:95], v[104:105] op_sel:[0,1,0] op_sel_hi:[1,1,1]
  v_pk_fma_f32 v[158:159], v[158:159], v[94:95], v[106:107] op_sel:[0,1,0] op_sel_hi:[1,1,1]
  v_pk_mul_f32 v[104:105], v[156:157], v[156:157]
  v_pk_mul_f32 v[106:107], v[158:159], v[158:159]
  v_pk_fma_f32 v[104:105], v[104:105], v[96:97], v[96:97] op_sel:[0,1,0] op_sel_hi:[1,1,0]
  v_pk_fma_f32 v[106:107], v[106:107], v[96:97], v[96:97] op_sel:[0,1,0] op_sel_hi:[1,1,0]
  v_pk_mul_f32 v[104:105], v[104:105], v[156:157]
  v_pk_mul_f32 v[106:107], v[106:107], v[158:159]
  v_exp_f32 v104, v104
  v_exp_f32 v105, v105
  v_exp_f32 v106, v106
  v_exp_f32 v107, v107
  v_pk_add_f32 v[104:105], v[104:105], v[98:99] op_sel_hi:[1,0]
  v_pk_add_f32 v[106:107], v[106:107], v[98:99] op_sel_hi:[1,0]
  v_rcp_f32 v104, v104
  v_rcp_f32 v105, v105
  v_rcp_f32 v106, v106
  v_rcp_f32 v107, v107
  v_pk_mul_f32 v[156:157], v[156:157], v[104:105]
  v_pk_mul_f32 v[158:159], v[158:159], v[106:107]
  v_cvt_pk_bf16_f32 v122, v156, v157
  v_cvt_pk_bf16_f32 v123, v158, v159
  s_mov_b32 s3, 344064
  s_nop 0
  v_permlane16_swap_b32 v120, v122
  v_permlane16_swap_b32 v121, v123
  buffer_store_dwordx4 v[120:123], v12, s[44:47], s3 offen sc1
  ds_write_b128 v18, v[120:123] offset:38912
  v_pk_fma_f32 v[100:101], v[56:57], v[88:89], v[84:85] op_sel:[0,0,0] op_sel_hi:[1,0,1] neg_lo:[0,1,0] neg_hi:[0,1,0]
  v_pk_fma_f32 v[102:103], v[58:59], v[88:89], v[86:87] op_sel:[0,0,0] op_sel_hi:[1,0,1] neg_lo:[0,1,0] neg_hi:[0,1,0]
  v_pk_fma_f32 v[224:225], v[224:225], v[88:89], v[100:101] op_sel:[0,1,0] op_sel_hi:[1,1,1]
  v_pk_fma_f32 v[226:227], v[226:227], v[88:89], v[102:103] op_sel:[0,1,0] op_sel_hi:[1,1,1]
  v_pk_mul_f32 v[100:101], v[224:225], v[224:225]
  v_pk_mul_f32 v[102:103], v[226:227], v[226:227]
  v_pk_fma_f32 v[100:101], v[100:101], v[96:97], v[96:97] op_sel:[0,1,0] op_sel_hi:[1,1,0]
  v_pk_fma_f32 v[102:103], v[102:103], v[96:97], v[96:97] op_sel:[0,1,0] op_sel_hi:[1,1,0]
  v_pk_mul_f32 v[100:101], v[100:101], v[224:225]
  v_pk_mul_f32 v[102:103], v[102:103], v[226:227]
  v_exp_f32 v100, v100
  v_exp_f32 v101, v101
  v_exp_f32 v102, v102
  v_exp_f32 v103, v103
  v_pk_add_f32 v[100:101], v[100:101], v[98:99] op_sel_hi:[1,0]
  v_pk_add_f32 v[102:103], v[102:103], v[98:99] op_sel_hi:[1,0]
  v_rcp_f32 v100, v100
  v_rcp_f32 v101, v101
  v_rcp_f32 v102, v102
  v_rcp_f32 v103, v103
  v_pk_mul_f32 v[224:225], v[224:225], v[100:101]
  v_pk_mul_f32 v[226:227], v[226:227], v[102:103]
  v_cvt_pk_bf16_f32 v108, v224, v225
  v_cvt_pk_bf16_f32 v109, v226, v227
  v_pk_fma_f32 v[100:101], v[56:57], v[90:91], v[84:85] op_sel:[0,0,0] op_sel_hi:[1,0,1] neg_lo:[0,1,0] neg_hi:[0,1,0]
  v_pk_fma_f32 v[102:103], v[58:59], v[90:91], v[86:87] op_sel:[0,0,0] op_sel_hi:[1,0,1] neg_lo:[0,1,0] neg_hi:[0,1,0]
  v_pk_fma_f32 v[228:229], v[228:229], v[90:91], v[100:101] op_sel:[0,1,0] op_sel_hi:[1,1,1]
  v_pk_fma_f32 v[230:231], v[230:231], v[90:91], v[102:103] op_sel:[0,1,0] op_sel_hi:[1,1,1]
  v_pk_mul_f32 v[100:101], v[228:229], v[228:229]
  v_pk_mul_f32 v[102:103], v[230:231], v[230:231]
  v_pk_fma_f32 v[100:101], v[100:101], v[96:97], v[96:97] op_sel:[0,1,0] op_sel_hi:[1,1,0]
  v_pk_fma_f32 v[102:103], v[102:103], v[96:97], v[96:97] op_sel:[0,1,0] op_sel_hi:[1,1,0]
  v_pk_mul_f32 v[100:101], v[100:101], v[228:229]
  v_pk_mul_f32 v[102:103], v[102:103], v[230:231]
  v_exp_f32 v100, v100
  v_exp_f32 v101, v101
  v_exp_f32 v102, v102
  v_exp_f32 v103, v103
  v_pk_add_f32 v[100:101], v[100:101], v[98:99] op_sel_hi:[1,0]
  v_pk_add_f32 v[102:103], v[102:103], v[98:99] op_sel_hi:[1,0]
  v_rcp_f32 v100, v100
  v_rcp_f32 v101, v101
  v_rcp_f32 v102, v102
  v_rcp_f32 v103, v103
  v_pk_mul_f32 v[228:229], v[228:229], v[100:101]
  v_pk_mul_f32 v[230:231], v[230:231], v[102:103]
  v_cvt_pk_bf16_f32 v110, v228, v229
  v_cvt_pk_bf16_f32 v111, v230, v231
  s_mov_b32 s3, 32768
  s_nop 0
  v_permlane16_swap_b32 v108, v110
  v_permlane16_swap_b32 v109, v111
  buffer_store_dwordx4 v[108:111], v13, s[44:47], s3 offen sc1
  v_pk_fma_f32 v[100:101], v[56:57], v[92:93], v[84:85] op_sel:[0,0,0] op_sel_hi:[1,0,1] neg_lo:[0,1,0] neg_hi:[0,1,0]
  v_pk_fma_f32 v[102:103], v[58:59], v[92:93], v[86:87] op_sel:[0,0,0] op_sel_hi:[1,0,1] neg_lo:[0,1,0] neg_hi:[0,1,0]
  v_pk_fma_f32 v[232:233], v[232:233], v[92:93], v[100:101] op_sel:[0,1,0] op_sel_hi:[1,1,1]
  v_pk_fma_f32 v[234:235], v[234:235], v[92:93], v[102:103] op_sel:[0,1,0] op_sel_hi:[1,1,1]
  v_pk_mul_f32 v[100:101], v[232:233], v[232:233]
  v_pk_mul_f32 v[102:103], v[234:235], v[234:235]
  v_pk_fma_f32 v[100:101], v[100:101], v[96:97], v[96:97] op_sel:[0,1,0] op_sel_hi:[1,1,0]
  v_pk_fma_f32 v[102:103], v[102:103], v[96:97], v[96:97] op_sel:[0,1,0] op_sel_hi:[1,1,0]
  v_pk_mul_f32 v[100:101], v[100:101], v[232:233]
  v_pk_mul_f32 v[102:103], v[102:103], v[234:235]
  v_exp_f32 v100, v100
  v_exp_f32 v101, v101
  v_exp_f32 v102, v102
  v_exp_f32 v103, v103
  v_pk_add_f32 v[100:101], v[100:101], v[98:99] op_sel_hi:[1,0]
  v_pk_add_f32 v[102:103], v[102:103], v[98:99] op_sel_hi:[1,0]
  v_rcp_f32 v100, v100
  v_rcp_f32 v101, v101
  v_rcp_f32 v102, v102
  v_rcp_f32 v103, v103
  v_pk_mul_f32 v[232:233], v[232:233], v[100:101]
  v_pk_mul_f32 v[234:235], v[234:235], v[102:103]
  v_cvt_pk_bf16_f32 v112, v232, v233
  v_cvt_pk_bf16_f32 v113, v234, v235
  v_pk_fma_f32 v[100:101], v[56:57], v[94:95], v[84:85] op_sel:[0,0,0] op_sel_hi:[1,0,1] neg_lo:[0,1,0] neg_hi:[0,1,0]
  v_pk_fma_f32 v[102:103], v[58:59], v[94:95], v[86:87] op_sel:[0,0,0] op_sel_hi:[1,0,1] neg_lo:[0,1,0] neg_hi:[0,1,0]
  v_pk_fma_f32 v[236:237], v[236:237], v[94:95], v[100:101] op_sel:[0,1,0] op_sel_hi:[1,1,1]
  v_pk_fma_f32 v[238:239], v[238:239], v[94:95], v[102:103] op_sel:[0,1,0] op_sel_hi:[1,1,1]
  v_pk_mul_f32 v[100:101], v[236:237], v[236:237]
  v_pk_mul_f32 v[102:103], v[238:239], v[238:239]
  v_pk_fma_f32 v[100:101], v[100:101], v[96:97], v[96:97] op_sel:[0,1,0] op_sel_hi:[1,1,0]
  v_pk_fma_f32 v[102:103], v[102:103], v[96:97], v[96:97] op_sel:[0,1,0] op_sel_hi:[1,1,0]
  v_pk_mul_f32 v[100:101], v[100:101], v[236:237]
  v_pk_mul_f32 v[102:103], v[102:103], v[238:239]
  v_exp_f32 v100, v100
  v_exp_f32 v101, v101
  v_exp_f32 v102, v102
  v_exp_f32 v103, v103
  v_pk_add_f32 v[100:101], v[100:101], v[98:99] op_sel_hi:[1,0]
  v_pk_add_f32 v[102:103], v[102:103], v[98:99] op_sel_hi:[1,0]
  v_rcp_f32 v100, v100
  v_rcp_f32 v101, v101
  v_rcp_f32 v102, v102
  v_rcp_f32 v103, v103
  v_pk_mul_f32 v[236:237], v[236:237], v[100:101]
  v_pk_mul_f32 v[238:239], v[238:239], v[102:103]
  v_cvt_pk_bf16_f32 v114, v236, v237
  v_cvt_pk_bf16_f32 v115, v238, v239
  s_mov_b32 s3, 262144
  s_nop 0
  v_permlane16_swap_b32 v112, v114
  v_permlane16_swap_b32 v113, v115
  buffer_store_dwordx4 v[112:115], v13, s[44:47], s3 offen sc1
  v_pk_fma_f32 v[100:101], v[40:41], v[88:89], v[68:69] op_sel:[0,0,0] op_sel_hi:[1,0,1] neg_lo:[0,1,0] neg_hi:[0,1,0]
  v_pk_fma_f32 v[102:103], v[42:43], v[88:89], v[70:71] op_sel:[0,0,0] op_sel_hi:[1,0,1] neg_lo:[0,1,0] neg_hi:[0,1,0]
  v_pk_fma_f32 v[160:161], v[160:161], v[88:89], v[100:101] op_sel:[0,1,0] op_sel_hi:[1,1,1]
  v_pk_fma_f32 v[162:163], v[162:163], v[88:89], v[102:103] op_sel:[0,1,0] op_sel_hi:[1,1,1]
  v_pk_mul_f32 v[100:101], v[160:161], v[160:161]
  v_pk_mul_f32 v[102:103], v[162:163], v[162:163]
  v_pk_fma_f32 v[100:101], v[100:101], v[96:97], v[96:97] op_sel:[0,1,0] op_sel_hi:[1,1,0]
  v_pk_fma_f32 v[102:103], v[102:103], v[96:97], v[96:97] op_sel:[0,1,0] op_sel_hi:[1,1,0]
  v_pk_mul_f32 v[100:101], v[100:101], v[160:161]
  v_pk_mul_f32 v[102:103], v[102:103], v[162:163]
  v_exp_f32 v100, v100
  v_exp_f32 v101, v101
  v_exp_f32 v102, v102
  v_exp_f32 v103, v103
  v_pk_add_f32 v[100:101], v[100:101], v[98:99] op_sel_hi:[1,0]
  v_pk_add_f32 v[102:103], v[102:103], v[98:99] op_sel_hi:[1,0]
  v_rcp_f32 v100, v100
  v_rcp_f32 v101, v101
  v_rcp_f32 v102, v102
  v_rcp_f32 v103, v103
  v_pk_mul_f32 v[160:161], v[160:161], v[100:101]
  v_pk_mul_f32 v[162:163], v[162:163], v[102:103]
  v_cvt_pk_bf16_f32 v116, v160, v161
  v_cvt_pk_bf16_f32 v117, v162, v163
  v_pk_fma_f32 v[104:105], v[44:45], v[88:89], v[72:73] op_sel:[0,0,0] op_sel_hi:[1,0,1] neg_lo:[0,1,0] neg_hi:[0,1,0]
  v_pk_fma_f32 v[106:107], v[46:47], v[88:89], v[74:75] op_sel:[0,0,0] op_sel_hi:[1,0,1] neg_lo:[0,1,0] neg_hi:[0,1,0]
  v_pk_fma_f32 v[176:177], v[176:177], v[88:89], v[104:105] op_sel:[0,1,0] op_sel_hi:[1,1,1]
  v_pk_fma_f32 v[178:179], v[178:179], v[88:89], v[106:107] op_sel:[0,1,0] op_sel_hi:[1,1,1]
  v_pk_mul_f32 v[104:105], v[176:177], v[176:177]
  v_pk_mul_f32 v[106:107], v[178:179], v[178:179]
  v_pk_fma_f32 v[104:105], v[104:105], v[96:97], v[96:97] op_sel:[0,1,0] op_sel_hi:[1,1,0]
  v_pk_fma_f32 v[106:107], v[106:107], v[96:97], v[96:97] op_sel:[0,1,0] op_sel_hi:[1,1,0]
  v_pk_mul_f32 v[104:105], v[104:105], v[176:177]
  v_pk_mul_f32 v[106:107], v[106:107], v[178:179]
  v_exp_f32 v104, v104
  v_exp_f32 v105, v105
  v_exp_f32 v106, v106
  v_exp_f32 v107, v107
  v_pk_add_f32 v[104:105], v[104:105], v[98:99] op_sel_hi:[1,0]
  v_pk_add_f32 v[106:107], v[106:107], v[98:99] op_sel_hi:[1,0]
  v_rcp_f32 v104, v104
  v_rcp_f32 v105, v105
  v_rcp_f32 v106, v106
  v_rcp_f32 v107, v107
  v_pk_mul_f32 v[176:177], v[176:177], v[104:105]
  v_pk_mul_f32 v[178:179], v[178:179], v[106:107]
  v_cvt_pk_bf16_f32 v118, v176, v177
  v_cvt_pk_bf16_f32 v119, v178, v179
  s_add_u32 s3, s10, 49152
  s_nop 0
  v_permlane16_swap_b32 v116, v118
  v_permlane16_swap_b32 v117, v119
  buffer_store_dwordx4 v[116:119], v12, s[44:47], s3 offen sc1
  ds_write_b128 v18, v[116:119] offset:0
  v_pk_fma_f32 v[100:101], v[48:49], v[88:89], v[76:77] op_sel:[0,0,0] op_sel_hi:[1,0,1] neg_lo:[0,1,0] neg_hi:[0,1,0]
  v_pk_fma_f32 v[102:103], v[50:51], v[88:89], v[78:79] op_sel:[0,0,0] op_sel_hi:[1,0,1] neg_lo:[0,1,0] neg_hi:[0,1,0]
  v_pk_fma_f32 v[192:193], v[192:193], v[88:89], v[100:101] op_sel:[0,1,0] op_sel_hi:[1,1,1]
  v_pk_fma_f32 v[194:195], v[194:195], v[88:89], v[102:103] op_sel:[0,1,0] op_sel_hi:[1,1,1]
  v_pk_mul_f32 v[100:101], v[192:193], v[192:193]
  v_pk_mul_f32 v[102:103], v[194:195], v[194:195]
  v_pk_fma_f32 v[100:101], v[100:101], v[96:97], v[96:97] op_sel:[0,1,0] op_sel_hi:[1,1,0]
  v_pk_fma_f32 v[102:103], v[102:103], v[96:97], v[96:97] op_sel:[0,1,0] op_sel_hi:[1,1,0]
  v_pk_mul_f32 v[100:101], v[100:101], v[192:193]
  v_pk_mul_f32 v[102:103], v[102:103], v[194:195]
  v_exp_f32 v100, v100
  v_exp_f32 v101, v101
  v_exp_f32 v102, v102
  v_exp_f32 v103, v103
  v_pk_add_f32 v[100:101], v[100:101], v[98:99] op_sel_hi:[1,0]
  v_pk_add_f32 v[102:103], v[102:103], v[98:99] op_sel_hi:[1,0]
  v_rcp_f32 v100, v100
  v_rcp_f32 v101, v101
  v_rcp_f32 v102, v102
  v_rcp_f32 v103, v103
  v_pk_mul_f32 v[192:193], v[192:193], v[100:101]
  v_pk_mul_f32 v[194:195], v[194:195], v[102:103]
  v_cvt_pk_bf16_f32 v120, v192, v193
  v_cvt_pk_bf16_f32 v121, v194, v195
  v_pk_fma_f32 v[104:105], v[52:53], v[88:89], v[80:81] op_sel:[0,0,0] op_sel_hi:[1,0,1] neg_lo:[0,1,0] neg_hi:[0,1,0]
  v_pk_fma_f32 v[106:107], v[54:55], v[88:89], v[82:83] op_sel:[0,0,0] op_sel_hi:[1,0,1] neg_lo:[0,1,0] neg_hi:[0,1,0]
  v_pk_fma_f32 v[208:209], v[208:209], v[88:89], v[104:105] op_sel:[0,1,0] op_sel_hi:[1,1,1]
  v_pk_fma_f32 v[210:211], v[210:211], v[88:89], v[106:107] op_sel:[0,1,0] op_sel_hi:[1,1,1]
  v_pk_mul_f32 v[104:105], v[208:209], v[208:209]
  v_pk_mul_f32 v[106:107], v[210:211], v[210:211]
  v_pk_fma_f32 v[104:105], v[104:105], v[96:97], v[96:97] op_sel:[0,1,0] op_sel_hi:[1,1,0]
  v_pk_fma_f32 v[106:107], v[106:107], v[96:97], v[96:97] op_sel:[0,1,0] op_sel_hi:[1,1,0]
  v_pk_mul_f32 v[104:105], v[104:105], v[208:209]
  v_pk_mul_f32 v[106:107], v[106:107], v[210:211]
  v_exp_f32 v104, v104
  v_exp_f32 v105, v105
  v_exp_f32 v106, v106
  v_exp_f32 v107, v107
  v_pk_add_f32 v[104:105], v[104:105], v[98:99] op_sel_hi:[1,0]
  v_pk_add_f32 v[106:107], v[106:107], v[98:99] op_sel_hi:[1,0]
  v_rcp_f32 v104, v104
  v_rcp_f32 v105, v105
  v_rcp_f32 v106, v106
  v_rcp_f32 v107, v107
  v_pk_mul_f32 v[208:209], v[208:209], v[104:105]
  v_pk_mul_f32 v[210:211], v[210:211], v[106:107]
  v_cvt_pk_bf16_f32 v122, v208, v209
  v_cvt_pk_bf16_f32 v123, v210, v211
  s_add_u32 s3, s10, 51200
  s_nop 0
  v_permlane16_swap_b32 v120, v122
  v_permlane16_swap_b32 v121, v123
  buffer_store_dwordx4 v[120:123], v12, s[44:47], s3 offen sc1
  ds_write_b128 v18, v[120:123] offset:16384
  v_pk_fma_f32 v[100:101], v[40:41], v[90:91], v[68:69] op_sel:[0,0,0] op_sel_hi:[1,0,1] neg_lo:[0,1,0] neg_hi:[0,1,0]
  v_pk_fma_f32 v[102:103], v[42:43], v[90:91], v[70:71] op_sel:[0,0,0] op_sel_hi:[1,0,1] neg_lo:[0,1,0] neg_hi:[0,1,0]
  v_pk_fma_f32 v[164:165], v[164:165], v[90:91], v[100:101] op_sel:[0,1,0] op_sel_hi:[1,1,1]
  v_pk_fma_f32 v[166:167], v[166:167], v[90:91], v[102:103] op_sel:[0,1,0] op_sel_hi:[1,1,1]
  v_pk_mul_f32 v[100:101], v[164:165], v[164:165]
  v_pk_mul_f32 v[102:103], v[166:167], v[166:167]
  v_pk_fma_f32 v[100:101], v[100:101], v[96:97], v[96:97] op_sel:[0,1,0] op_sel_hi:[1,1,0]
  v_pk_fma_f32 v[102:103], v[102:103], v[96:97], v[96:97] op_sel:[0,1,0] op_sel_hi:[1,1,0]
  v_pk_mul_f32 v[100:101], v[100:101], v[164:165]
  v_pk_mul_f32 v[102:103], v[102:103], v[166:167]
  v_exp_f32 v100, v100
  v_exp_f32 v101, v101
  v_exp_f32 v102, v102
  v_exp_f32 v103, v103
  v_pk_add_f32 v[100:101], v[100:101], v[98:99] op_sel_hi:[1,0]
  v_pk_add_f32 v[102:103], v[102:103], v[98:99] op_sel_hi:[1,0]
  v_rcp_f32 v100, v100
  v_rcp_f32 v101, v101
  v_rcp_f32 v102, v102
  v_rcp_f32 v103, v103
  v_pk_mul_f32 v[164:165], v[164:165], v[100:101]
  v_pk_mul_f32 v[166:167], v[166:167], v[102:103]
  v_cvt_pk_bf16_f32 v108, v164, v165
  v_cvt_pk_bf16_f32 v109, v166, v167
  v_pk_fma_f32 v[104:105], v[44:45], v[90:91], v[72:73] op_sel:[0,0,0] op_sel_hi:[1,0,1] neg_lo:[0,1,0] neg_hi:[0,1,0]
  v_pk_fma_f32 v[106:107], v[46:47], v[90:91], v[74:75] op_sel:[0,0,0] op_sel_hi:[1,0,1] neg_lo:[0,1,0] neg_hi:[0,1,0]
  v_pk_fma_f32 v[180:181], v[180:181], v[90:91], v[104:105] op_sel:[0,1,0] op_sel_hi:[1,1,1]
  v_pk_fma_f32 v[182:183], v[182:183], v[90:91], v[106:107] op_sel:[0,1,0] op_sel_hi:[1,1,1]
  v_pk_mul_f32 v[104:105], v[180:181], v[180:181]
  v_pk_mul_f32 v[106:107], v[182:183], v[182:183]
  v_pk_fma_f32 v[104:105], v[104:105], v[96:97], v[96:97] op_sel:[0,1,0] op_sel_hi:[1,1,0]
  v_pk_fma_f32 v[106:107], v[106:107], v[96:97], v[96:97] op_sel:[0,1,0] op_sel_hi:[1,1,0]
  v_pk_mul_f32 v[104:105], v[104:105], v[180:181]
  v_pk_mul_f32 v[106:107], v[106:107], v[182:183]
  v_exp_f32 v104, v104
  v_exp_f32 v105, v105
  v_exp_f32 v106, v106
  v_exp_f32 v107, v107
  v_pk_add_f32 v[104:105], v[104:105], v[98:99] op_sel_hi:[1,0]
  v_pk_add_f32 v[106:107], v[106:107], v[98:99] op_sel_hi:[1,0]
  v_rcp_f32 v104, v104
  v_rcp_f32 v105, v105
  v_rcp_f32 v106, v106
  v_rcp_f32 v107, v107
  v_pk_mul_f32 v[180:181], v[180:181], v[104:105]
  v_pk_mul_f32 v[182:183], v[182:183], v[106:107]
  v_cvt_pk_bf16_f32 v110, v180, v181
  v_cvt_pk_bf16_f32 v111, v182, v183
  s_add_u32 s3, s10, 163840
  s_nop 0
  v_permlane16_swap_b32 v108, v110
  v_permlane16_swap_b32 v109, v111
  buffer_store_dwordx4 v[108:111], v12, s[44:47], s3 offen sc1
  ds_write_b128 v18, v[108:111] offset:2048
  v_pk_fma_f32 v[100:101], v[48:49], v[90:91], v[76:77] op_sel:[0,0,0] op_sel_hi:[1,0,1] neg_lo:[0,1,0] neg_hi:[0,1,0]
  v_pk_fma_f32 v[102:103], v[50:51], v[90:91], v[78:79] op_sel:[0,0,0] op_sel_hi:[1,0,1] neg_lo:[0,1,0] neg_hi:[0,1,0]
  v_pk_fma_f32 v[196:197], v[196:197], v[90:91], v[100:101] op_sel:[0,1,0] op_sel_hi:[1,1,1]
  v_pk_fma_f32 v[198:199], v[198:199], v[90:91], v[102:103] op_sel:[0,1,0] op_sel_hi:[1,1,1]
  v_pk_mul_f32 v[100:101], v[196:197], v[196:197]
  v_pk_mul_f32 v[102:103], v[198:199], v[198:199]
  v_pk_fma_f32 v[100:101], v[100:101], v[96:97], v[96:97] op_sel:[0,1,0] op_sel_hi:[1,1,0]
  v_pk_fma_f32 v[102:103], v[102:103], v[96:97], v[96:97] op_sel:[0,1,0] op_sel_hi:[1,1,0]
  v_pk_mul_f32 v[100:101], v[100:101], v[196:197]
  v_pk_mul_f32 v[102:103], v[102:103], v[198:199]
  v_exp_f32 v100, v100
  v_exp_f32 v101, v101
  v_exp_f32 v102, v102
  v_exp_f32 v103, v103
  v_pk_add_f32 v[100:101], v[100:101], v[98:99] op_sel_hi:[1,0]
  v_pk_add_f32 v[102:103], v[102:103], v[98:99] op_sel_hi:[1,0]
  v_rcp_f32 v100, v100
  v_rcp_f32 v101, v101
  v_rcp_f32 v102, v102
  v_rcp_f32 v103, v103
  v_pk_mul_f32 v[196:197], v[196:197], v[100:101]
  v_pk_mul_f32 v[198:199], v[198:199], v[102:103]
  v_cvt_pk_bf16_f32 v112, v196, v197
  v_cvt_pk_bf16_f32 v113, v198, v199
  v_pk_fma_f32 v[104:105], v[52:53], v[90:91], v[80:81] op_sel:[0,0,0] op_sel_hi:[1,0,1] neg_lo:[0,1,0] neg_hi:[0,1,0]
  v_pk_fma_f32 v[106:107], v[54:55], v[90:91], v[82:83] op_sel:[0,0,0] op_sel_hi:[1,0,1] neg_lo:[0,1,0] neg_hi:[0,1,0]
  v_pk_fma_f32 v[212:213], v[212:213], v[90:91], v[104:105] op_sel:[0,1,0] op_sel_hi:[1,1,1]
  v_pk_fma_f32 v[214:215], v[214:215], v[90:91], v[106:107] op_sel:[0,1,0] op_sel_hi:[1,1,1]
  v_pk_mul_f32 v[104:105], v[212:213], v[212:213]
  v_pk_mul_f32 v[106:107], v[214:215], v[214:215]
  v_pk_fma_f32 v[104:105], v[104:105], v[96:97], v[96:97] op_sel:[0,1,0] op_sel_hi:[1,1,0]
  v_pk_fma_f32 v[106:107], v[106:107], v[96:97], v[96:97] op_sel:[0,1,0] op_sel_hi:[1,1,0]
  v_pk_mul_f32 v[104:105], v[104:105], v[212:213]
  v_pk_mul_f32 v[106:107], v[106:107], v[214:215]
  v_exp_f32 v104, v104
  v_exp_f32 v105, v105
  v_exp_f32 v106, v106
  v_exp_f32 v107, v107
  v_pk_add_f32 v[104:105], v[104:105], v[98:99] op_sel_hi:[1,0]
  v_pk_add_f32 v[106:107], v[106:107], v[98:99] op_sel_hi:[1,0]
  v_rcp_f32 v104, v104
  v_rcp_f32 v105, v105
  v_rcp_f32 v106, v106
  v_rcp_f32 v107, v107
  v_pk_mul_f32 v[212:213], v[212:213], v[104:105]
  v_pk_mul_f32 v[214:215], v[214:215], v[106:107]
  v_cvt_pk_bf16_f32 v114, v212, v213
  v_cvt_pk_bf16_f32 v115, v214, v215
  s_add_u32 s3, s10, 165888
  s_nop 0
  v_permlane16_swap_b32 v112, v114
  v_permlane16_swap_b32 v113, v115
  buffer_store_dwordx4 v[112:115], v12, s[44:47], s3 offen sc1
  ds_write_b128 v18, v[112:115] offset:18432
  v_pk_fma_f32 v[100:101], v[40:41], v[92:93], v[68:69] op_sel:[0,0,0] op_sel_hi:[1,0,1] neg_lo:[0,1,0] neg_hi:[0,1,0]
  v_pk_fma_f32 v[102:103], v[42:43], v[92:93], v[70:71] op_sel:[0,0,0] op_sel_hi:[1,0,1] neg_lo:[0,1,0] neg_hi:[0,1,0]
  v_pk_fma_f32 v[168:169], v[168:169], v[92:93], v[100:101] op_sel:[0,1,0] op_sel_hi:[1,1,1]
  v_pk_fma_f32 v[170:171], v[170:171], v[92:93], v[102:103] op_sel:[0,1,0] op_sel_hi:[1,1,1]
  v_pk_mul_f32 v[100:101], v[168:169], v[168:169]
  v_pk_mul_f32 v[102:103], v[170:171], v[170:171]
  v_pk_fma_f32 v[100:101], v[100:101], v[96:97], v[96:97] op_sel:[0,1,0] op_sel_hi:[1,1,0]
  v_pk_fma_f32 v[102:103], v[102:103], v[96:97], v[96:97] op_sel:[0,1,0] op_sel_hi:[1,1,0]
  v_pk_mul_f32 v[100:101], v[100:101], v[168:169]
  v_pk_mul_f32 v[102:103], v[102:103], v[170:171]
  v_exp_f32 v100, v100
  v_exp_f32 v101, v101
  v_exp_f32 v102, v102
  v_exp_f32 v103, v103
  v_pk_add_f32 v[100:101], v[100:101], v[98:99] op_sel_hi:[1,0]
  v_pk_add_f32 v[102:103], v[102:103], v[98:99] op_sel_hi:[1,0]
  v_rcp_f32 v100, v100
  v_rcp_f32 v101, v101
  v_rcp_f32 v102, v102
  v_rcp_f32 v103, v103
  v_pk_mul_f32 v[168:169], v[168:169], v[100:101]
  v_pk_mul_f32 v[170:171], v[170:171], v[102:103]
  v_cvt_pk_bf16_f32 v116, v168, v169
  v_cvt_pk_bf16_f32 v117, v170, v171
  v_pk_fma_f32 v[104:105], v[44:45], v[92:93], v[72:73] op_sel:[0,0,0] op_sel_hi:[1,0,1] neg_lo:[0,1,0] neg_hi:[0,1,0]
  v_pk_fma_f32 v[106:107], v[46:47], v[92:93], v[74:75] op_sel:[0,0,0] op_sel_hi:[1,0,1] neg_lo:[0,1,0] neg_hi:[0,1,0]
  v_pk_fma_f32 v[184:185], v[184:185], v[92:93], v[104:105] op_sel:[0,1,0] op_sel_hi:[1,1,1]
  v_pk_fma_f32 v[186:187], v[186:187], v[92:93], v[106:107] op_sel:[0,1,0] op_sel_hi:[1,1,1]
  v_pk_mul_f32 v[104:105], v[184:185], v[184:185]
  v_pk_mul_f32 v[106:107], v[186:187], v[186:187]
  v_pk_fma_f32 v[104:105], v[104:105], v[96:97], v[96:97] op_sel:[0,1,0] op_sel_hi:[1,1,0]
  v_pk_fma_f32 v[106:107], v[106:107], v[96:97], v[96:97] op_sel:[0,1,0] op_sel_hi:[1,1,0]
  v_pk_mul_f32 v[104:105], v[104:105], v[184:185]
  v_pk_mul_f32 v[106:107], v[106:107], v[186:187]
  v_exp_f32 v104, v104
  v_exp_f32 v105, v105
  v_exp_f32 v106, v106
  v_exp_f32 v107, v107
  v_pk_add_f32 v[104:105], v[104:105], v[98:99] op_sel_hi:[1,0]
  v_pk_add_f32 v[106:107], v[106:107], v[98:99] op_sel_hi:[1,0]
  v_rcp_f32 v104, v104
  v_rcp_f32 v105, v105
  v_rcp_f32 v106, v106
  v_rcp_f32 v107, v107
  v_pk_mul_f32 v[184:185], v[184:185], v[104:105]
  v_pk_mul_f32 v[186:187], v[186:187], v[106:107]
  v_cvt_pk_bf16_f32 v118, v184, v185
  v_cvt_pk_bf16_f32 v119, v186, v187
  s_add_u32 s3, s10, 278528
  s_nop 0
  v_permlane16_swap_b32 v116, v118
  v_permlane16_swap_b32 v117, v119
  buffer_store_dwordx4 v[116:119], v12, s[44:47], s3 offen sc1
  ds_write_b128 v18, v[116:119] offset:4096
  v_pk_fma_f32 v[100:101], v[48:49], v[92:93], v[76:77] op_sel:[0,0,0] op_sel_hi:[1,0,1] neg_lo:[0,1,0] neg_hi:[0,1,0]
  v_pk_fma_f32 v[102:103], v[50:51], v[92:93], v[78:79] op_sel:[0,0,0] op_sel_hi:[1,0,1] neg_lo:[0,1,0] neg_hi:[0,1,0]
  v_pk_fma_f32 v[200:201], v[200:201], v[92:93], v[100:101] op_sel:[0,1,0] op_sel_hi:[1,1,1]
  v_pk_fma_f32 v[202:203], v[202:203], v[92:93], v[102:103] op_sel:[0,1,0] op_sel_hi:[1,1,1]
  v_pk_mul_f32 v[100:101], v[200:201], v[200:201]
  v_pk_mul_f32 v[102:103], v[202:203], v[202:203]
  v_pk_fma_f32 v[100:101], v[100:101], v[96:97], v[96:97] op_sel:[0,1,0] op_sel_hi:[1,1,0]
  v_pk_fma_f32 v[102:103], v[102:103], v[96:97], v[96:97] op_sel:[0,1,0] op_sel_hi:[1,1,0]
  v_pk_mul_f32 v[100:101], v[100:101], v[200:201]
  v_pk_mul_f32 v[102:103], v[102:103], v[202:203]
  v_exp_f32 v100, v100
  v_exp_f32 v101, v101
  v_exp_f32 v102, v102
  v_exp_f32 v103, v103
  v_pk_add_f32 v[100:101], v[100:101], v[98:99] op_sel_hi:[1,0]
  v_pk_add_f32 v[102:103], v[102:103], v[98:99] op_sel_hi:[1,0]
  v_rcp_f32 v100, v100
  v_rcp_f32 v101, v101
  v_rcp_f32 v102, v102
  v_rcp_f32 v103, v103
  v_pk_mul_f32 v[200:201], v[200:201], v[100:101]
  v_pk_mul_f32 v[202:203], v[202:203], v[102:103]
  v_cvt_pk_bf16_f32 v120, v200, v201
  v_cvt_pk_bf16_f32 v121, v202, v203
  v_pk_fma_f32 v[104:105], v[52:53], v[92:93], v[80:81] op_sel:[0,0,0] op_sel_hi:[1,0,1] neg_lo:[0,1,0] neg_hi:[0,1,0]
  v_pk_fma_f32 v[106:107], v[54:55], v[92:93], v[82:83] op_sel:[0,0,0] op_sel_hi:[1,0,1] neg_lo:[0,1,0] neg_hi:[0,1,0]
  v_pk_fma_f32 v[216:217], v[216:217], v[92:93], v[104:105] op_sel:[0,1,0] op_sel_hi:[1,1,1]
  v_pk_fma_f32 v[218:219], v[218:219], v[92:93], v[106:107] op_sel:[0,1,0] op_sel_hi:[1,1,1]
  v_pk_mul_f32 v[104:105], v[216:217], v[216:217]
  v_pk_mul_f32 v[106:107], v[218:219], v[218:219]
  v_pk_fma_f32 v[104:105], v[104:105], v[96:97], v[96:97] op_sel:[0,1,0] op_sel_hi:[1,1,0]
  v_pk_fma_f32 v[106:107], v[106:107], v[96:97], v[96:97] op_sel:[0,1,0] op_sel_hi:[1,1,0]
  v_pk_mul_f32 v[104:105], v[104:105], v[216:217]
  v_pk_mul_f32 v[106:107], v[106:107], v[218:219]
  v_exp_f32 v104, v104
  v_exp_f32 v105, v105
  v_exp_f32 v106, v106
  v_exp_f32 v107, v107
  v_pk_add_f32 v[104:105], v[104:105], v[98:99] op_sel_hi:[1,0]
  v_pk_add_f32 v[106:107], v[106:107], v[98:99] op_sel_hi:[1,0]
  v_rcp_f32 v104, v104
  v_rcp_f32 v105, v105
  v_rcp_f32 v106, v106
  v_rcp_f32 v107, v107
  v_pk_mul_f32 v[216:217], v[216:217], v[104:105]
  v_pk_mul_f32 v[218:219], v[218:219], v[106:107]
  v_cvt_pk_bf16_f32 v122, v216, v217
  v_cvt_pk_bf16_f32 v123, v218, v219
  s_add_u32 s3, s10, 280576
  s_nop 0
  v_permlane16_swap_b32 v120, v122
  v_permlane16_swap_b32 v121, v123
  buffer_store_dwordx4 v[120:123], v12, s[44:47], s3 offen sc1
  ds_write_b128 v18, v[120:123] offset:20480
  v_pk_fma_f32 v[100:101], v[40:41], v[94:95], v[68:69] op_sel:[0,0,0] op_sel_hi:[1,0,1] neg_lo:[0,1,0] neg_hi:[0,1,0]
  v_pk_fma_f32 v[102:103], v[42:43], v[94:95], v[70:71] op_sel:[0,0,0] op_sel_hi:[1,0,1] neg_lo:[0,1,0] neg_hi:[0,1,0]
  v_pk_fma_f32 v[172:173], v[172:173], v[94:95], v[100:101] op_sel:[0,1,0] op_sel_hi:[1,1,1]
  v_pk_fma_f32 v[174:175], v[174:175], v[94:95], v[102:103] op_sel:[0,1,0] op_sel_hi:[1,1,1]
  v_pk_mul_f32 v[100:101], v[172:173], v[172:173]
  v_pk_mul_f32 v[102:103], v[174:175], v[174:175]
  v_pk_fma_f32 v[100:101], v[100:101], v[96:97], v[96:97] op_sel:[0,1,0] op_sel_hi:[1,1,0]
  v_pk_fma_f32 v[102:103], v[102:103], v[96:97], v[96:97] op_sel:[0,1,0] op_sel_hi:[1,1,0]
  v_pk_mul_f32 v[100:101], v[100:101], v[172:173]
  v_pk_mul_f32 v[102:103], v[102:103], v[174:175]
  v_exp_f32 v100, v100
  v_exp_f32 v101, v101
  v_exp_f32 v102, v102
  v_exp_f32 v103, v103
  v_pk_add_f32 v[100:101], v[100:101], v[98:99] op_sel_hi:[1,0]
  v_pk_add_f32 v[102:103], v[102:103], v[98:99] op_sel_hi:[1,0]
  v_rcp_f32 v100, v100
  v_rcp_f32 v101, v101
  v_rcp_f32 v102, v102
  v_rcp_f32 v103, v103
  v_pk_mul_f32 v[172:173], v[172:173], v[100:101]
  v_pk_mul_f32 v[174:175], v[174:175], v[102:103]
  v_cvt_pk_bf16_f32 v108, v172, v173
  v_cvt_pk_bf16_f32 v109, v174, v175
  v_pk_fma_f32 v[104:105], v[44:45], v[94:95], v[72:73] op_sel:[0,0,0] op_sel_hi:[1,0,1] neg_lo:[0,1,0] neg_hi:[0,1,0]
  v_pk_fma_f32 v[106:107], v[46:47], v[94:95], v[74:75] op_sel:[0,0,0] op_sel_hi:[1,0,1] neg_lo:[0,1,0] neg_hi:[0,1,0]
  v_pk_fma_f32 v[188:189], v[188:189], v[94:95], v[104:105] op_sel:[0,1,0] op_sel_hi:[1,1,1]
  v_pk_fma_f32 v[190:191], v[190:191], v[94:95], v[106:107] op_sel:[0,1,0] op_sel_hi:[1,1,1]
  v_pk_mul_f32 v[104:105], v[188:189], v[188:189]
  v_pk_mul_f32 v[106:107], v[190:191], v[190:191]
  v_pk_fma_f32 v[104:105], v[104:105], v[96:97], v[96:97] op_sel:[0,1,0] op_sel_hi:[1,1,0]
  v_pk_fma_f32 v[106:107], v[106:107], v[96:97], v[96:97] op_sel:[0,1,0] op_sel_hi:[1,1,0]
  v_pk_mul_f32 v[104:105], v[104:105], v[188:189]
  v_pk_mul_f32 v[106:107], v[106:107], v[190:191]
  v_exp_f32 v104, v104
  v_exp_f32 v105, v105
  v_exp_f32 v106, v106
  v_exp_f32 v107, v107
  v_pk_add_f32 v[104:105], v[104:105], v[98:99] op_sel_hi:[1,0]
  v_pk_add_f32 v[106:107], v[106:107], v[98:99] op_sel_hi:[1,0]
  v_rcp_f32 v104, v104
  v_rcp_f32 v105, v105
  v_rcp_f32 v106, v106
  v_rcp_f32 v107, v107
  v_pk_mul_f32 v[188:189], v[188:189], v[104:105]
  v_pk_mul_f32 v[190:191], v[190:191], v[106:107]
  v_cvt_pk_bf16_f32 v110, v188, v189
  v_cvt_pk_bf16_f32 v111, v190, v191
  s_add_u32 s3, s10, 393216
  s_nop 0
  v_permlane16_swap_b32 v108, v110
  v_permlane16_swap_b32 v109, v111
  buffer_store_dwordx4 v[108:111], v12, s[44:47], s3 offen sc1
  ds_write_b128 v18, v[108:111] offset:6144
  v_pk_fma_f32 v[100:101], v[48:49], v[94:95], v[76:77] op_sel:[0,0,0] op_sel_hi:[1,0,1] neg_lo:[0,1,0] neg_hi:[0,1,0]
  v_pk_fma_f32 v[102:103], v[50:51], v[94:95], v[78:79] op_sel:[0,0,0] op_sel_hi:[1,0,1] neg_lo:[0,1,0] neg_hi:[0,1,0]
  v_pk_fma_f32 v[204:205], v[204:205], v[94:95], v[100:101] op_sel:[0,1,0] op_sel_hi:[1,1,1]
  v_pk_fma_f32 v[206:207], v[206:207], v[94:95], v[102:103] op_sel:[0,1,0] op_sel_hi:[1,1,1]
  v_pk_mul_f32 v[100:101], v[204:205], v[204:205]
  v_pk_mul_f32 v[102:103], v[206:207], v[206:207]
  v_pk_fma_f32 v[100:101], v[100:101], v[96:97], v[96:97] op_sel:[0,1,0] op_sel_hi:[1,1,0]
  v_pk_fma_f32 v[102:103], v[102:103], v[96:97], v[96:97] op_sel:[0,1,0] op_sel_hi:[1,1,0]
  v_pk_mul_f32 v[100:101], v[100:101], v[204:205]
  v_pk_mul_f32 v[102:103], v[102:103], v[206:207]
  v_exp_f32 v100, v100
  v_exp_f32 v101, v101
  v_exp_f32 v102, v102
  v_exp_f32 v103, v103
  v_pk_add_f32 v[100:101], v[100:101], v[98:99] op_sel_hi:[1,0]
  v_pk_add_f32 v[102:103], v[102:103], v[98:99] op_sel_hi:[1,0]
  v_rcp_f32 v100, v100
  v_rcp_f32 v101, v101
  v_rcp_f32 v102, v102
  v_rcp_f32 v103, v103
  v_pk_mul_f32 v[204:205], v[204:205], v[100:101]
  v_pk_mul_f32 v[206:207], v[206:207], v[102:103]
  v_cvt_pk_bf16_f32 v112, v204, v205
  v_cvt_pk_bf16_f32 v113, v206, v207
  v_pk_fma_f32 v[104:105], v[52:53], v[94:95], v[80:81] op_sel:[0,0,0] op_sel_hi:[1,0,1] neg_lo:[0,1,0] neg_hi:[0,1,0]
  v_pk_fma_f32 v[106:107], v[54:55], v[94:95], v[82:83] op_sel:[0,0,0] op_sel_hi:[1,0,1] neg_lo:[0,1,0] neg_hi:[0,1,0]
  v_pk_fma_f32 v[220:221], v[220:221], v[94:95], v[104:105] op_sel:[0,1,0] op_sel_hi:[1,1,1]
  v_pk_fma_f32 v[222:223], v[222:223], v[94:95], v[106:107] op_sel:[0,1,0] op_sel_hi:[1,1,1]
  v_pk_mul_f32 v[104:105], v[220:221], v[220:221]
  v_pk_mul_f32 v[106:107], v[222:223], v[222:223]
  v_pk_fma_f32 v[104:105], v[104:105], v[96:97], v[96:97] op_sel:[0,1,0] op_sel_hi:[1,1,0]
  v_pk_fma_f32 v[106:107], v[106:107], v[96:97], v[96:97] op_sel:[0,1,0] op_sel_hi:[1,1,0]
  v_pk_mul_f32 v[104:105], v[104:105], v[220:221]
  v_pk_mul_f32 v[106:107], v[106:107], v[222:223]
  v_exp_f32 v104, v104
  v_exp_f32 v105, v105
  v_exp_f32 v106, v106
  v_exp_f32 v107, v107
  v_pk_add_f32 v[104:105], v[104:105], v[98:99] op_sel_hi:[1,0]
  v_pk_add_f32 v[106:107], v[106:107], v[98:99] op_sel_hi:[1,0]
  v_rcp_f32 v104, v104
  v_rcp_f32 v105, v105
  v_rcp_f32 v106, v106
  v_rcp_f32 v107, v107
  v_pk_mul_f32 v[220:221], v[220:221], v[104:105]
  v_pk_mul_f32 v[222:223], v[222:223], v[106:107]
  v_cvt_pk_bf16_f32 v114, v220, v221
  v_cvt_pk_bf16_f32 v115, v222, v223
  s_add_u32 s3, s10, 395264
  s_nop 0
  v_permlane16_swap_b32 v112, v114
  v_permlane16_swap_b32 v113, v115
  buffer_store_dwordx4 v[112:115], v12, s[44:47], s3 offen sc1
  ds_write_b128 v18, v[112:115] offset:22528
  s_waitcnt vmcnt(0) lgkmcnt(0)
  s_barrier
  s_add_u32 s97, s97, 1
  s_branch L_w2_body
L_w1_c1:
L_w2_c0:
L_w2_body:
  s_cmp_ge_u32 s2, 256
  s_cbranch_scc1 L_w2_end
  v_lshrrev_b32 v2, 6, v0
  v_and_b32 v1, 63, v0
  v_readfirstlane_b32 s70, v2
  s_and_b32 s3, s2, 7
  s_lshr_b32 s99, s2, 3
  s_and_b32 s5, s3, 3
  s_lshl_b32 s5, s5, 2
  s_and_b32 s6, s99, 3
  s_add_u32 s68, s5, s6
  s_lshr_b32 s5, s3, 2
  s_lshr_b32 s78, s99, 2
  s_lshl1_add_u32 s69, s78, s5
  s_add_u32 s3, s68, s78
  s_lshl_b32 s3, s3, 3
  s_lshl_b32 s85, 0xffff02, s3
  s_sub_u32 s3, 0, s3
  s_lshr_b32 s3, 0xffff02, s3
  s_or_b32 s85, s85, s3
  s_cmp_lt_u32 s70, 4
  s_cbranch_scc1 L_w2_compute
L_w2_loader:
  s_add_u32 s3, s68, s78
  s_and_b32 s3, s3, 3
  s_mov_b32 s4, 0x58585858
  s_cmp_eq_u32 s3, 1
  s_cselect_b32 s4, 0x1616160, s4
  s_cmp_eq_u32 s3, 2
  s_cselect_b32 s4, 0x5858580, s4
  s_cmp_eq_u32 s3, 3
  s_cselect_b32 s4, 0x16161600, s4
  v_subrev_u32 v2, 3, v1
  v_lshlrev_b32 v3, 1, v2
  v_bfe_i32 v16, s4, v3, 2
  v_sub_u32 v16, v1, v16
  v_subrev_u32 v16, 6, v16
  v_ashrrev_i32 v3, 1, v16
  v_cmp_eq_u32 vcc, s78, v3
  s_and_b32 s3, s69, 1
  v_or_b32 v2, 14, v16
  v_cndmask_b32 v2, v16, v2, vcc
  v_cmp_gt_i32 vcc, 0, v16
  s_lshl2_add_u32 s4, s3, 19
  v_add_u32 v16, s4, v16
  s_lshl4_add_u32 s4, s3, 24
  v_add_u32 v2, s4, v2
  v_cndmask_b32 v16, v2, v16, vcc
  v_and_b32 v2, 3, v1
  v_lshlrev_b32 v2, 3, v2
  v_bfe_i32 v3, s85, v2, 8
  s_lshl2_add_u32 s5, s68, 12
  v_add3_u32 v3, v3, v1, s5
  v_and_b32 v2, 7, v3
  v_cmp_eq_u32 vcc, s78, v2
  v_bfe_u32 v2, v3, 3, 1
  v_lshl_add_u32 v2, v2, 2, 19
  v_and_b32 v3, 15, v3
  v_cndmask_b32 v3, v3, v2, vcc
  v_cmp_gt_u32 vcc, 20, v1
  s_lshl1_add_u32 s4, s78, s4
  s_lshl3_add_u32 s3, s3, s78
  v_cndmask_b32 v3, v3, v16, vcc
  v_writelane_b32 v3, s4, 0
  s_add_u32 s4, s4, 1
  v_writelane_b32 v3, s3, 2
  v_writelane_b32 v3, s4, 1
  v_lshlrev_b32 v16, 17, v3
  s_add_u32 s9, s70, s68
  s_and_b32 s9, s9, 3
  s_lshl_b32 s77, s9, 11
  v_and_b32 v10, 7, v1
  v_lshrrev_b32 v3, 3, v1
  s_lshl_b32 s10, s9, 4
  v_add_u32 v3, s10, v3
  v_mul_u32_u24 v3, 2048, v3
  v_lshrrev_b32 v2, 3, v1
  v_and_b32 v2, 2, v2
  v_xor_b32 v2, v2, v10
  s_lshl_b32 s10, s69, 7
  v_add_u32 v3, s10, v3
  v_lshl_add_u32 v8, v2, 4, v3
  v_xor_b32 v2, 4, v2
  v_add_u32 v3, 16384, v3
  v_lshl_add_u32 v9, v2, 4, v3
  s_mov_b32 s40, s28
  s_and_b32 s41, s29, 0xffff
  s_mov_b32 s42, 7340032
  s_mov_b32 s43, 0x00020000
  s_bitcmp1_b32 s69, 0
  s_mov_b32 s76, 128
  s_cselect_b32 s76, -128, s76
  v_readlane_b32 s74, v16, 0
  s_add_u32 m0, s77, 0
  s_add_u32 s4, s74, s76
  buffer_load_dwordx4 v8, s[40:43], s4 offen lds
  s_add_u32 m0, s77, 1024
  s_nop 0
  buffer_load_dwordx4 v9, s[40:43], s4 offen lds
  s_add_u32 m0, s77, 8192
  s_add_u32 s4, s74, 0
  buffer_load_dwordx4 v8, s[40:43], s4 offen lds
  s_add_u32 m0, s77, 9216
  s_nop 0
  buffer_load_dwordx4 v9, s[40:43], s4 offen lds
  v_readlane_b32 s74, v16, 1
  s_add_u32 m0, s77, 16384
  s_add_u32 s4, s74, s76
  buffer_load_dwordx4 v8, s[40:43], s4 offen lds
  s_add_u32 m0, s77, 17408
  s_nop 0
  buffer_load_dwordx4 v9, s[40:43], s4 offen lds
  s_add_u32 m0, s77, 24576
  s_add_u32 s4, s74, 0
  buffer_load_dwordx4 v8, s[40:43], s4 offen lds
  s_add_u32 m0, s77, 25600
  s_nop 0
  buffer_load_dwordx4 v9, s[40:43], s4 offen lds
  v_readlane_b32 s74, v16, 2
  s_add_u32 m0, s77, 32768
  s_add_u32 s4, s74, s76
  buffer_load_dwordx4 v8, s[40:43], s4 offen lds
  s_add_u32 m0, s77, 33792
  s_nop 0
  buffer_load_dwordx4 v9, s[40:43], s4 offen lds
  s_add_u32 m0, s77, 40960
  s_add_u32 s4, s74, 0
  buffer_load_dwordx4 v8, s[40:43], s4 offen lds
  s_add_u32 m0, s77, 41984
  s_nop 0
  buffer_load_dwordx4 v9, s[40:43], s4 offen lds
  v_readlane_b32 s74, v16, 3
  s_add_u32 m0, s77, 49152
  s_add_u32 s4, s74, s76
  buffer_load_dwordx4 v8, s[40:43], s4 offen lds
  s_add_u32 m0, s77, 50176
  s_nop 0
  buffer_load_dwordx4 v9, s[40:43], s4 offen lds
  s_add_u32 m0, s77, 57344
  s_add_u32 s4, s74, 0
  buffer_load_dwordx4 v8, s[40:43], s4 offen lds
  s_add_u32 m0, s77, 58368
  s_nop 0
  buffer_load_dwordx4 v9, s[40:43], s4 offen lds
  v_readlane_b32 s74, v16, 4
  s_add_u32 m0, s77, 65536
  s_add_u32 s4, s74, s76
  buffer_load_dwordx4 v8, s[40:43], s4 offen lds
  s_add_u32 m0, s77, 66560
  s_nop 0
  buffer_load_dwordx4 v9, s[40:43], s4 offen lds
  s_add_u32 m0, s77, 73728
  s_add_u32 s4, s74, 0
  buffer_load_dwordx4 v8, s[40:43], s4 offen lds
  s_add_u32 m0, s77, 74752
  s_nop 0
  buffer_load_dwordx4 v9, s[40:43], s4 offen lds
  s_add_u32 s44, s22, 41943040
  s_addc_u32 s45, s23, 0
  s_and_b32 s45, s45, 0xffff
  s_mov_b32 s46, 524288
  s_mov_b32 s47, 0x00020000
  s_lshl4_add_u32 s3, s97, s68
  s_and_b32 s4, s69, 15
  s_lshl4_add_u32 s3, s3, s4
  s_lshl_b32 s3, s3, 7
  s_sub_u32 s3, s3, 32768
  v_lshlrev_b32 v11, 7, v1
  v_and_b32 v2, 15, v1
  v_lshlrev_b32 v2, 2, v2
  v_mov_b32 v3, 1
  s_mov_b32 s79, 0x100000
  s_cmp_lg_u32 s70, 4
  s_barrier
  s_cbranch_scc1 L_w2_nofl
  s_mov_b32 exec_lo, 0xffff
  s_mov_b32 exec_hi, 0
  buffer_store_dword v3, v11, s[44:47], s87 offen sc1
  s_mov_b64 exec, -1
L_w2_nofl:
  s_mov_b32 s5, s3
  v_readlane_b32 s74, v16, 5
  s_add_u32 m0, s77, 81920
  s_add_u32 s4, s74, s76
  buffer_load_dwordx4 v8, s[40:43], s4 offen lds
  s_add_u32 m0, s77, 82944
  s_nop 0
  buffer_load_dwordx4 v9, s[40:43], s4 offen lds
  s_add_u32 m0, s77, 90112
  s_add_u32 s4, s74, 0
  buffer_load_dwordx4 v8, s[40:43], s4 offen lds
  s_add_u32 m0, s77, 91136
  s_nop 0
  buffer_load_dwordx4 v9, s[40:43], s4 offen lds
  v_readlane_b32 s74, v16, 6
  s_add_u32 m0, s77, 98304
  s_add_u32 s4, s74, s76
  buffer_load_dwordx4 v8, s[40:43], s4 offen lds
  s_add_u32 m0, s77, 99328
  s_nop 0
  buffer_load_dwordx4 v9, s[40:43], s4 offen lds
  s_add_u32 m0, s77, 106496
  s_add_u32 s4, s74, 0
  buffer_load_dwordx4 v8, s[40:43], s4 offen lds
  s_add_u32 m0, s77, 107520
  s_nop 0
  buffer_load_dwordx4 v9, s[40:43], s4 offen lds
  s_waitcnt vmcnt(20)
  s_barrier
  v_readlane_b32 s74, v16, 7
  s_add_u32 m0, s77, 114688
  s_add_u32 s4, s74, s76
  buffer_load_dwordx4 v8, s[40:43], s4 offen lds
  s_add_u32 m0, s77, 115712
  s_nop 0
  buffer_load_dwordx4 v9, s[40:43], s4 offen lds
  s_add_u32 m0, s77, 122880
  s_add_u32 s4, s74, 0
  buffer_load_dwordx4 v8, s[40:43], s4 offen lds
  s_add_u32 m0, s77, 123904
  s_nop 0
  buffer_load_dwordx4 v9, s[40:43], s4 offen lds
  v_readlane_b32 s74, v16, 8
  s_add_u32 m0, s77, 131072
  s_add_u32 s4, s74, s76
  buffer_load_dwordx4 v8, s[40:43], s4 offen lds
  s_add_u32 m0, s77, 132096
  s_nop 0
  buffer_load_dwordx4 v9, s[40:43], s4 offen lds
  s_add_u32 m0, s77, 139264
  s_add_u32 s4, s74, 0
  buffer_load_dwordx4 v8, s[40:43], s4 offen lds
  s_add_u32 m0, s77, 140288
  s_nop 0
  buffer_load_dwordx4 v9, s[40:43], s4 offen lds
  v_readlane_b32 s74, v16, 9
  s_add_u32 m0, s77, 147456
  s_add_u32 s4, s74, s76
  buffer_load_dwordx4 v8, s[40:43], s4 offen lds
  s_add_u32 m0, s77, 148480
  s_nop 0
  buffer_load_dwordx4 v9, s[40:43], s4 offen lds
  s_add_u32 m0, s77, 155648
  s_add_u32 s4, s74, 0
  buffer_load_dwordx4 v8, s[40:43], s4 offen lds
  s_add_u32 m0, s77, 156672
  s_nop 0
  buffer_load_dwordx4 v9, s[40:43], s4 offen lds
  s_mov_b32 s3, s5
  s_cmp_lg_u32 s70, 4
  s_cbranch_scc1 L_w2_dep
L_w2_poll:
  buffer_load_dword v3, v2, s[44:47], s3 offen sc1
  s_sub_u32 s79, s79, 1
  s_cbranch_scc1 L_w2_dep
  s_waitcnt vmcnt(0)
  v_cmp_ne_u32 vcc, 1, v3
  s_cbranch_vccnz L_w2_poll
L_w2_dep:
  s_waitcnt vmcnt(22) lgkmcnt(0)
  s_barrier
  v_readlane_b32 s74, v16, 10
  s_add_u32 m0, s77, 0
  s_add_u32 s4, s74, s76
  buffer_load_dwordx4 v8, s[40:43], s4 offen lds
  s_add_u32 m0, s77, 1024
  s_nop 0
  buffer_load_dwordx4 v9, s[40:43], s4 offen lds
  s_waitcnt vmcnt(4)
  s_add_u32 m0, s77, 8192
  s_add_u32 s4, s74, 0
  buffer_load_dwordx4 v8, s[40:43], s4 offen lds
  s_add_u32 m0, s77, 9216
  s_nop 0
  buffer_load_dwordx4 v9, s[40:43], s4 offen lds
  s_waitcnt vmcnt(4)
  v_readlane_b32 s74, v16, 11
  s_add_u32 m0, s77, 16384
  s_add_u32 s4, s74, s76
  buffer_load_dwordx4 v8, s[40:43], s4 offen lds
  s_add_u32 m0, s77, 17408
  s_nop 0
  buffer_load_dwordx4 v9, s[40:43], s4 offen lds
  s_waitcnt vmcnt(20)
  s_barrier
  s_add_u32 m0, s77, 24576
  s_add_u32 s4, s74, 0
  buffer_load_dwordx4 v8, s[40:43], s4 offen lds
  s_add_u32 m0, s77, 25600
  s_nop 0
  buffer_load_dwordx4 v9, s[40:43], s4 offen lds
  s_waitcnt vmcnt(4)
  v_readlane_b32 s74, v16, 12
  s_add_u32 m0, s77, 32768
  s_add_u32 s4, s74, s76
  buffer_load_dwordx4 v8, s[40:43], s4 offen lds
  s_add_u32 m0, s77, 33792
  s_nop 0
  buffer_load_dwordx4 v9, s[40:43], s4 offen lds
  s_waitcnt vmcnt(4)
  s_add_u32 m0, s77, 40960
  s_add_u32 s4, s74, 0
  buffer_load_dwordx4 v8, s[40:43], s4 offen lds
  s_add_u32 m0, s77, 41984
  s_nop 0
  buffer_load_dwordx4 v9, s[40:43], s4 offen lds
  s_waitcnt vmcnt(4)
  v_readlane_b32 s74, v16, 13
  s_add_u32 m0, s77, 49152
  s_add_u32 s4, s74, s76
  buffer_load_dwordx4 v8, s[40:43], s4 offen lds
  s_add_u32 m0, s77, 50176
  s_nop 0
  buffer_load_dwordx4 v9, s[40:43], s4 offen lds
  s_waitcnt vmcnt(4)
  s_add_u32 m0, s77, 57344
  s_add_u32 s4, s74, 0
  buffer_load_dwordx4 v8, s[40:43], s4 offen lds
  s_add_u32 m0, s77, 58368
  s_nop 0
  buffer_load_dwordx4 v9, s[40:43], s4 offen lds
  s_waitcnt vmcnt(22)
  s_barrier
  v_readlane_b32 s74, v16, 14
  s_add_u32 m0, s77, 65536
  s_add_u32 s4, s74, s76
  buffer_load_dwordx4 v8, s[40:43], s4 offen lds
  s_add_u32 m0, s77, 66560
  s_nop 0
  buffer_load_dwordx4 v9, s[40:43], s4 offen lds
  s_waitcnt vmcnt(4)
  s_add_u32 m0, s77, 73728
  s_add_u32 s4, s74, 0
  buffer_load_dwordx4 v8, s[40:43], s4 offen lds
  s_add_u32 m0, s77, 74752
  s_nop 0
  buffer_load_dwordx4 v9, s[40:43], s4 offen lds
  s_waitcnt vmcnt(4)
  v_readlane_b32 s74, v16, 15
  s_add_u32 m0, s77, 81920
  s_add_u32 s4, s74, s76
  buffer_load_dwordx4 v8, s[40:43], s4 offen lds
  s_add_u32 m0, s77, 82944
  s_nop 0
  buffer_load_dwordx4 v9, s[40:43], s4 offen lds
  s_waitcnt vmcnt(4)
  s_add_u32 m0, s77, 90112
  s_add_u32 s4, s74, 0
  buffer_load_dwordx4 v8, s[40:43], s4 offen lds
  s_add_u32 m0, s77, 91136
  s_nop 0
  buffer_load_dwordx4 v9, s[40:43], s4 offen lds
  s_waitcnt vmcnt(22)
  s_barrier
  v_readlane_b32 s74, v16, 16
  s_add_u32 m0, s77, 98304
  s_add_u32 s4, s74, s76
  buffer_load_dwordx4 v8, s[40:43], s4 offen lds
  s_add_u32 m0, s77, 99328
  s_nop 0
  buffer_load_dwordx4 v9, s[40:43], s4 offen lds
  s_waitcnt vmcnt(4)
  s_add_u32 m0, s77, 106496
  s_add_u32 s4, s74, 0
  buffer_load_dwordx4 v8, s[40:43], s4 offen lds
  s_add_u32 m0, s77, 107520
  s_nop 0
  buffer_load_dwordx4 v9, s[40:43], s4 offen lds
  s_waitcnt vmcnt(4)
  v_readlane_b32 s74, v16, 17
  s_add_u32 m0, s77, 114688
  s_add_u32 s4, s74, s76
  buffer_load_dwordx4 v8, s[40:43], s4 offen lds
  s_add_u32 m0, s77, 115712
  s_nop 0
  buffer_load_dwordx4 v9, s[40:43], s4 offen lds
  s_waitcnt vmcnt(4)
  s_add_u32 m0, s77, 122880
  s_add_u32 s4, s74, 0
  buffer_load_dwordx4 v8, s[40:43], s4 offen lds
  s_add_u32 m0, s77, 123904
  s_nop 0
  buffer_load_dwordx4 v9, s[40:43], s4 offen lds
  s_waitcnt vmcnt(22)
  s_barrier
  v_readlane_b32 s74, v16, 18
  s_add_u32 m0, s77, 131072
  s_add_u32 s4, s74, s76
  buffer_load_dwordx4 v8, s[40:43], s4 offen lds
  s_add_u32 m0, s77, 132096
  s_nop 0
  buffer_load_dwordx4 v9, s[40:43], s4 offen lds
  s_waitcnt vmcnt(4)
  s_add_u32 m0, s77, 139264
  s_add_u32 s4, s74, 0
  buffer_load_dwordx4 v8, s[40:43], s4 offen lds
  s_add_u32 m0, s77, 140288
  s_nop 0
  buffer_load_dwordx4 v9, s[40:43], s4 offen lds
  s_waitcnt vmcnt(4)
  v_readlane_b32 s74, v16, 19
  s_add_u32 m0, s77, 147456
  s_add_u32 s4, s74, s76
  buffer_load_dwordx4 v8, s[40:43], s4 offen lds
  s_add_u32 m0, s77, 148480
  s_nop 0
  buffer_load_dwordx4 v9, s[40:43], s4 offen lds
  s_waitcnt vmcnt(4)
  s_add_u32 m0, s77, 155648
  s_add_u32 s4, s74, 0
  buffer_load_dwordx4 v8, s[40:43], s4 offen lds
  s_add_u32 m0, s77, 156672
  s_nop 0
  buffer_load_dwordx4 v9, s[40:43], s4 offen lds
  s_waitcnt vmcnt(22)
  s_barrier
  v_readlane_b32 s74, v16, 20
  s_add_u32 m0, s77, 0
  s_add_u32 s4, s74, 0
  buffer_load_dwordx4 v8, s[40:43], s4 offen lds
  s_add_u32 m0, s77, 1024
  s_nop 0
  buffer_load_dwordx4 v9, s[40:43], s4 offen lds
  s_waitcnt vmcnt(4)
  v_readlane_b32 s74, v16, 21
  s_add_u32 m0, s77, 8192
  s_add_u32 s4, s74, 0
  buffer_load_dwordx4 v8, s[40:43], s4 offen lds
  s_add_u32 m0, s77, 9216
  s_nop 0
  buffer_load_dwordx4 v9, s[40:43], s4 offen lds
  s_waitcnt vmcnt(4)
  v_readlane_b32 s74, v16, 22
  s_add_u32 m0, s77, 16384
  s_add_u32 s4, s74, 0
  buffer_load_dwordx4 v8, s[40:43], s4 offen lds
  s_add_u32 m0, s77, 17408
  s_nop 0
  buffer_load_dwordx4 v9, s[40:43], s4 offen lds
  s_waitcnt vmcnt(4)
  v_readlane_b32 s74, v16, 23
  s_add_u32 m0, s77, 24576
  s_add_u32 s4, s74, 0
  buffer_load_dwordx4 v8, s[40:43], s4 offen lds
  s_add_u32 m0, s77, 25600
  s_nop 0
  buffer_load_dwordx4 v9, s[40:43], s4 offen lds
  s_waitcnt vmcnt(22)
  s_barrier
  v_readlane_b32 s74, v16, 24
  s_add_u32 m0, s77, 32768
  s_add_u32 s4, s74, 0
  buffer_load_dwordx4 v8, s[40:43], s4 offen lds
  s_add_u32 m0, s77, 33792
  s_nop 0
  buffer_load_dwordx4 v9, s[40:43], s4 offen lds
  s_waitcnt vmcnt(4)
  v_readlane_b32 s74, v16, 25
  s_add_u32 m0, s77, 40960
  s_add_u32 s4, s74, 0
  buffer_load_dwordx4 v8, s[40:43], s4 offen lds
  s_add_u32 m0, s77, 41984
  s_nop 0
  buffer_load_dwordx4 v9, s[40:43], s4 offen lds
  s_waitcnt vmcnt(4)
  v_readlane_b32 s74, v16, 26
  s_add_u32 m0, s77, 49152
  s_add_u32 s4, s74, 0
  buffer_load_dwordx4 v8, s[40:43], s4 offen lds
  s_add_u32 m0, s77, 50176
  s_nop 0
  buffer_load_dwordx4 v9, s[40:43], s4 offen lds
  s_waitcnt vmcnt(4)
  v_readlane_b32 s74, v16, 27
  s_add_u32 m0, s77, 57344
  s_add_u32 s4, s74, 0
  buffer_load_dwordx4 v8, s[40:43], s4 offen lds
  s_add_u32 m0, s77, 58368
  s_nop 0
  buffer_load_dwordx4 v9, s[40:43], s4 offen lds
  s_waitcnt vmcnt(22)
  s_barrier
  v_readlane_b32 s74, v16, 28
  s_add_u32 m0, s77, 65536
  s_add_u32 s4, s74, 0
  buffer_load_dwordx4 v8, s[40:43], s4 offen lds
  s_add_u32 m0, s77, 66560
  s_nop 0
  buffer_load_dwordx4 v9, s[40:43], s4 offen lds
  s_waitcnt vmcnt(4)
  v_readlane_b32 s74, v16, 29
  s_add_u32 m0, s77, 73728
  s_add_u32 s4, s74, 0
  buffer_load_dwordx4 v8, s[40:43], s4 offen lds
  s_add_u32 m0, s77, 74752
  s_nop 0
  buffer_load_dwordx4 v9, s[40:43], s4 offen lds
  s_waitcnt vmcnt(4)
  v_readlane_b32 s74, v16, 30
  s_add_u32 m0, s77, 81920
  s_add_u32 s4, s74, 0
  buffer_load_dwordx4 v8, s[40:43], s4 offen lds
  s_add_u32 m0, s77, 82944
  s_nop 0
  buffer_load_dwordx4 v9, s[40:43], s4 offen lds
  s_waitcnt vmcnt(4)
  v_readlane_b32 s74, v16, 31
  s_add_u32 m0, s77, 90112
  s_add_u32 s4, s74, 0
  buffer_load_dwordx4 v8, s[40:43], s4 offen lds
  s_add_u32 m0, s77, 91136
  s_nop 0
  buffer_load_dwordx4 v9, s[40:43], s4 offen lds
  s_waitcnt vmcnt(22)
  s_barrier
  v_readlane_b32 s74, v16, 32
  s_add_u32 m0, s77, 98304
  s_add_u32 s4, s74, 0
  buffer_load_dwordx4 v8, s[40:43], s4 offen lds
  s_add_u32 m0, s77, 99328
  s_nop 0
  buffer_load_dwordx4 v9, s[40:43], s4 offen lds
  s_waitcnt vmcnt(4)
  v_readlane_b32 s74, v16, 33
  s_add_u32 m0, s77, 106496
  s_add_u32 s4, s74, 0
  buffer_load_dwordx4 v8, s[40:43], s4 offen lds
  s_add_u32 m0, s77, 107520
  s_nop 0
  buffer_load_dwordx4 v9, s[40:43], s4 offen lds
  s_waitcnt vmcnt(4)
  v_readlane_b32 s74, v16, 34
  s_add_u32 m0, s77, 114688
  s_add_u32 s4, s74, 0
  buffer_load_dwordx4 v8, s[40:43], s4 offen lds
  s_add_u32 m0, s77, 115712
  s_nop 0
  buffer_load_dwordx4 v9, s[40:43], s4 offen lds
  s_waitcnt vmcnt(4)
  v_readlane_b32 s74, v16, 35
  s_add_u32 m0, s77, 122880
  s_add_u32 s4, s74, 0
  buffer_load_dwordx4 v8, s[40:43], s4 offen lds
  s_add_u32 m0, s77, 123904
  s_nop 0
  buffer_load_dwordx4 v9, s[40:43], s4 offen lds
  s_waitcnt vmcnt(18)
  s_barrier
  s_add_u32 s64, s22, 41943040
  s_addc_u32 s65, s23, 0
  s_and_b32 s65, s65, 0xffff
  s_mov_b32 s66, 524288
  s_mov_b32 s67, 0x00020000
  s_lshl4_add_u32 s6, s68, s69
  s_xor_b32 s6, s6, 1
  s_add_u32 s7, s96, 4
  s_lshl_b32 s7, s7, 8
  s_add_u32 s6, s6, s7
  s_lshl_b32 s6, s6, 8
  v_and_b32 v2, 3, v1
  v_lshlrev_b32 v2, 6, v2
  s_mov_b32 s79, 0x100000
  s_waitcnt vmcnt(8)
  s_barrier
  s_cmp_lg_u32 s70, 4
  s_cbranch_scc1 L_w2_xgo
  s_setprio 3
L_w2_xpoll:
  buffer_load_dword v5, v2, s[64:67], s6 offen sc1
  s_sub_u32 s79, s79, 1
  s_cbranch_scc1 L_w2_xgo
  s_waitcnt vmcnt(0)
  v_cmp_ne_u32 vcc, 1, v5
  s_cbranch_vccnz L_w2_xpoll
L_w2_xgo:
  s_setprio 0
  s_waitcnt vmcnt(0)
  s_barrier
  s_cmp_eq_u32 s96, 1
  s_cbranch_scc1 L_w2_end
  s_lshl_b32 s87, s97, 15
  s_lshl_b32 s4, s68, 11
  s_add_u32 s87, s87, s4
  s_lshl_b32 s4, s69, 2
  s_add_u32 s87, s87, s4
  s_mov_b32 s96, 1
  s_add_u32 s12, s22, 33554432
  s_addc_u32 s13, s23, 0
  s_add_u32 s34, s22, 67108864
  s_addc_u32 s35, s23, 0
  s_add_u32 s97, s97, 1
  s_branch L_attn_body
L_w2_end:
  s_endpgm
L_w2_compute:
  s_lshl_b32 s3, s70, 12
  s_add_u32 s3, s3, 114688
  v_lshl_add_u32 v2, v1, 4, s3
  ds_read_b128 v[32:35], v2 offset:0
  ds_read_b128 v[36:39], v2 offset:2048
  ds_read_b128 v[40:43], v2 offset:1024
  ds_read_b128 v[44:47], v2 offset:3072
  ds_read_b128 v[48:51], v2 offset:16384
  ds_read_b128 v[52:55], v2 offset:18432
  ds_read_b128 v[56:59], v2 offset:17408
  ds_read_b128 v[60:63], v2 offset:19456
  ds_read_b128 v[64:67], v2 offset:32768
  ds_read_b128 v[68:71], v2 offset:34816
  ds_read_b128 v[72:75], v2 offset:33792
  ds_read_b128 v[76:79], v2 offset:35840
  s_add_u32 s3, s68, s78
  s_and_b32 s3, s3, 3
  s_mov_b32 s4, 0x58585858
  s_cmp_eq_u32 s3, 1
  s_cselect_b32 s4, 0x1616160, s4
  s_cmp_eq_u32 s3, 2
  s_cselect_b32 s4, 0x5858580, s4
  s_cmp_eq_u32 s3, 3
  s_cselect_b32 s4, 0x16161600, s4
  v_subrev_u32 v2, 3, v1
  v_lshlrev_b32 v3, 1, v2
  v_bfe_i32 v15, s4, v3, 2
  v_sub_u32 v15, v1, v15
  v_subrev_u32 v15, 6, v15
  v_ashrrev_i32 v3, 1, v15
  v_cmp_eq_u32 vcc, s78, v3
  s_and_b32 s3, s69, 1
  v_or_b32 v2, 14, v15
  v_cndmask_b32 v2, v15, v2, vcc
  v_cmp_gt_i32 vcc, 0, v15
  s_lshl2_add_u32 s4, s3, 19
  v_add_u32 v15, s4, v15
  s_lshl4_add_u32 s4, s3, 24
  v_add_u32 v2, s4, v2
  v_cndmask_b32 v15, v2, v15, vcc
  v_and_b32 v2, 3, v1
  v_lshlrev_b32 v2, 3, v2
  v_bfe_i32 v3, s85, v2, 8
  s_lshl2_add_u32 s5, s68, 12
  v_add3_u32 v3, v3, v1, s5
  v_and_b32 v2, 7, v3
  v_cmp_eq_u32 vcc, s78, v2
  v_bfe_u32 v2, v3, 3, 1
  v_lshl_add_u32 v2, v2, 2, 19
  v_and_b32 v3, 15, v3
  v_cndmask_b32 v3, v3, v2, vcc
  v_cmp_gt_u32 vcc, 20, v1
  s_lshl1_add_u32 s4, s78, s4
  s_lshl3_add_u32 s3, s3, s78
  v_cndmask_b32 v3, v3, v15, vcc
  v_writelane_b32 v3, s4, 0
  s_add_u32 s4, s4, 1
  v_writelane_b32 v3, s3, 2
  v_writelane_b32 v3, s4, 1
  v_lshlrev_b32 v15, 11, v3
  s_waitcnt lgkmcnt(0)
  s_barrier
  v_and_b32 v3, 15, v1
  v_lshrrev_b32 v2, 4, v1
  s_lshl_b32 s8, s68, 7
  s_lshl_b32 s9, s70, 5
  s_add_u32 s8, s8, s9
  s_mul_i32 s9, s8, 7168
  v_add_u32 v13, s8, v3
  s_lshl_b32 s10, s69, 7
  v_lshl_add_u32 v14, v2, 3, s10
  v_and_b32 v16, 1, v2
  v_lshrrev_b32 v17, 1, v2
  v_lshlrev_b32 v16, 5, v16
  v_lshl_add_u32 v16, v17, 4, v16
  v_lshlrev_b32 v4, 3, v3
  v_and_b32 v4, 0x70, v4
  v_xor_b32 v4, v4, v16
  v_lshl_add_u32 v4, v3, 7, v4
  s_lshl_b32 s3, s70, 12
  v_add_u32 v4, s3, v4
  v_xor_b32 v5, 64, v4
  v_add_u32 v16, s10, v16
  s_cmp_eq_u32 s96, 0
  s_cselect_b32 s7, 128, 0
  s_add_u32 s7, s7, 2048
  v_mad_u32_u24 v12, v13, s7, v16
  v_lshl_add_u32 v18, v17, 4, v13
  v_lshlrev_b32 v18, 3, v18
  v_and_b32 v16, 1, v2
  v_lshl_add_u32 v18, v16, 2, v18
  s_lshl_b32 s10, s69, 14
  v_add_u32 v18, s10, v18
  v_bfe_u32 v6, v1, 2, 2
  v_lshl_add_u32 v6, v2, 3, v6
  v_lshlrev_b32 v6, 7, v6
  v_and_b32 v17, 3, v1
  v_lshl_add_u32 v6, v17, 3, v6
  v_bfe_u32 v17, v1, 3, 2
  v_lshl_add_u32 v6, v17, 5, v6
  v_xor_b32 v7, 32, v6
  v_xor_b32 v8, 64, v6
  v_xor_b32 v9, 96, v6
  s_mov_b32 s11, 0xffff0000
  s_add_u32 s36, s34, 8388608
  s_addc_u32 s37, s35, 0
  s_and_b32 s37, s37, 0xffff
  s_mov_b32 s38, 14680064
  s_mov_b32 s39, 0x00020000
  s_mov_b32 s44, s32
  s_and_b32 s45, s33, 0xffff
  s_mov_b32 s46, 4194304
  s_mov_b32 s47, 0x00020000
  s_add_u32 s48, s22, 33554432
  s_addc_u32 s49, s23, 0
  s_and_b32 s49, s49, 0xffff
  s_mov_b32 s50, 4194304
  s_mov_b32 s51, 0x00020000
  s_cmp_eq_u32 s96, 0
  s_cselect_b64 s[44:45], s[48:49], s[44:45]
  s_lshl_b32 s46, s7, 11
  s_add_u32 s56, s34, 24379392
  s_addc_u32 s57, s35, 0
  s_and_b32 s57, s57, 0xffff
  s_mov_b32 s58, 262144
  s_mov_b32 s59, 0x00020000
  s_mul_i32 s9, s8, 7168
  s_add_u32 s36, s36, s9
  s_addc_u32 s37, s37, 0x100000
  s_add_u32 s64, s36, 114688
  s_addc_u32 s65, s37, 0
  s_mov_b32 s38, 114688
  s_mov_b32 s39, 0x00800000
  s_mov_b32 s66, 114688
  s_mov_b32 s67, 0x00800000
  s_add_u32 s60, s34, 25165824
  s_addc_u32 s61, s35, 0
  s_and_b32 s61, s61, 0xffff
  s_mov_b32 s62, 4194304
  s_mov_b32 s63, 0x00020000
  s_or_b32 s61, s61, 0x100000
  s_mov_b32 s63, 0x00800000
  s_lshl4_add_u32 s4, s68, s69
  s_lshl2_add_u32 s4, s4, s70
  s_add_u32 s52, s22, 41943040
  s_addc_u32 s53, s23, 0
  s_and_b32 s53, s53, 0xffff
  s_mov_b32 s54, 524288
  s_mov_b32 s55, 0x00020000
  s_add_u32 s6, s96, 4
  s_lshl_b32 s6, s6, 10
  s_add_u32 s6, s6, s4
  s_lshl_b32 s6, s6, 6
  v_mov_b32 v19, 1
  s_lshl_b32 s4, s4, 12
  s_xor_b32 s5, s4, 16384
  v_add_u32 v26, 131072, v6
  v_add_u32 v27, 131072, v7
  v_add_u32 v28, 131072, v8
  v_add_u32 v29, 131072, v9
  v_add_u32 v20, 65536, v6
  v_add_u32 v21, 65536, v7
  v_add_u32 v22, 65536, v8
  v_add_u32 v23, 65536, v9
  v_readlane_b32 s51, v15, 3
  v_readlane_b32 s48, v15, 4
  v_readlane_b32 s49, v15, 5
  v_permlane16_swap_b32 v240, v242
  v_permlane16_swap_b32 v241, v243
  v_permlane16_swap_b32 v244, v246
  v_permlane16_swap_b32 v245, v247
  v_permlane16_swap_b32 v248, v250
  v_permlane16_swap_b32 v249, v251
  v_permlane16_swap_b32 v252, v254
  v_permlane16_swap_b32 v253, v255
  s_waitcnt lgkmcnt(0)
  ds_read_b64_tr_b16 v[160:161], v6 offset:0
  ds_read_b64_tr_b16 v[162:163], v6 offset:512
  ds_read_b64_tr_b16 v[164:165], v7 offset:0
  ds_read_b64_tr_b16 v[166:167], v7 offset:512
  ds_read_b64_tr_b16 v[168:169], v8 offset:0
  ds_read_b64_tr_b16 v[170:171], v8 offset:512
  ds_read_b64_tr_b16 v[172:173], v9 offset:0
  ds_read_b64_tr_b16 v[174:175], v9 offset:512
  ds_read_b64_tr_b16 v[176:177], v6 offset:4096
  ds_read_b64_tr_b16 v[178:179], v6 offset:4608
  ds_read_b64_tr_b16 v[180:181], v7 offset:4096
  ds_read_b64_tr_b16 v[182:183], v7 offset:4608
  ds_read_b64_tr_b16 v[184:185], v8 offset:4096
  ds_read_b64_tr_b16 v[186:187], v8 offset:4608
  ds_read_b64_tr_b16 v[188:189], v9 offset:4096
  ds_read_b64_tr_b16 v[190:191], v9 offset:4608
  v_lshlrev_b32 v216, 16, v10
  v_and_b32 v217, s11, v10
  v_lshlrev_b32 v218, 16, v11
  v_and_b32 v219, s11, v11
  v_lshlrev_b32 v96, 16, v240
  v_and_b32 v97, s11, v240
  v_pk_add_f32 v[96:97], v[96:97], v[216:217]
  v_lshlrev_b32 v98, 16, v241
  v_and_b32 v99, s11, v241
  v_pk_add_f32 v[98:99], v[98:99], v[218:219]
  v_lshlrev_b32 v100, 16, v248
  v_and_b32 v101, s11, v248
  v_pk_add_f32 v[100:101], v[100:101], v[216:217]
  v_lshlrev_b32 v102, 16, v249
  v_and_b32 v103, s11, v249
  v_pk_add_f32 v[102:103], v[102:103], v[218:219]
  v_lshlrev_b32 v216, 16, v24
  v_and_b32 v217, s11, v24
  v_lshlrev_b32 v218, 16, v25
  v_and_b32 v219, s11, v25
  v_lshlrev_b32 v104, 16, v242
  v_and_b32 v105, s11, v242
  v_pk_add_f32 v[104:105], v[104:105], v[216:217]
  v_lshlrev_b32 v106, 16, v243
  v_and_b32 v107, s11, v243
  v_pk_add_f32 v[106:107], v[106:107], v[218:219]
  v_lshlrev_b32 v108, 16, v250
  v_and_b32 v109, s11, v250
  v_pk_add_f32 v[108:109], v[108:109], v[216:217]
  v_lshlrev_b32 v110, 16, v251
  v_and_b32 v111, s11, v251
  v_pk_add_f32 v[110:111], v[110:111], v[218:219]
  v_lshlrev_b32 v216, 16, v124
  v_and_b32 v217, s11, v124
  v_lshlrev_b32 v218, 16, v125
  v_and_b32 v219, s11, v125
  v_lshlrev_b32 v112, 16, v244
  v_and_b32 v113, s11, v244
  v_pk_add_f32 v[112:113], v[112:113], v[216:217]
  v_lshlrev_b32 v114, 16, v245
  v_and_b32 v115, s11, v245
  v_pk_add_f32 v[114:115], v[114:115], v[218:219]
  v_lshlrev_b32 v116, 16, v252
  v_and_b32 v117, s11, v252
  v_pk_add_f32 v[116:117], v[116:117], v[216:217]
  v_lshlrev_b32 v118, 16, v253
  v_and_b32 v119, s11, v253
  v_pk_add_f32 v[118:119], v[118:119], v[218:219]
  v_lshlrev_b32 v216, 16, v126
  v_and_b32 v217, s11, v126
  v_lshlrev_b32 v218, 16, v127
  v_and_b32 v219, s11, v127
  v_lshlrev_b32 v120, 16, v246
  v_and_b32 v121, s11, v246
  v_pk_add_f32 v[120:121], v[120:121], v[216:217]
  v_lshlrev_b32 v122, 16, v247
  v_and_b32 v123, s11, v247
  v_pk_add_f32 v[122:123], v[122:123], v[218:219]
  v_lshlrev_b32 v124, 16, v254
  v_and_b32 v125, s11, v254
  v_pk_add_f32 v[124:125], v[124:125], v[216:217]
  v_lshlrev_b32 v126, 16, v255
  v_and_b32 v127, s11, v255
  v_pk_add_f32 v[126:127], v[126:127], v[218:219]
  s_waitcnt lgkmcnt(8)
  v_mfma_f32_16x16x32_bf16 v[128:131], v[160:163], v[32:35], 0
  ds_read_b64_tr_b16 v[192:193], v6 offset:8192
  v_mfma_f32_16x16x32_bf16 v[132:135], v[160:163], v[36:39], 0
  ds_read_b64_tr_b16 v[194:195], v6 offset:8704
  v_mfma_f32_16x16x32_bf16 v[140:143], v[164:167], v[36:39], 0
  ds_read_b64_tr_b16 v[196:197], v7 offset:8192
  v_mfma_f32_16x16x32_bf16 v[136:139], v[164:167], v[32:35], 0
  ds_read_b64_tr_b16 v[198:199], v7 offset:8704
  v_mfma_f32_16x16x32_bf16 v[144:147], v[168:171], v[32:35], 0
  ds_read_b64_tr_b16 v[200:201], v8 offset:8192
  v_mfma_f32_16x16x32_bf16 v[148:151], v[168:171], v[36:39], 0
  ds_read_b64_tr_b16 v[202:203], v8 offset:8704
  v_mfma_f32_16x16x32_bf16 v[156:159], v[172:175], v[36:39], 0
  ds_read_b64_tr_b16 v[204:205], v9 offset:8192
  v_mfma_f32_16x16x32_bf16 v[152:155], v[172:175], v[32:35], 0
  ds_read_b64_tr_b16 v[206:207], v9 offset:8704
  s_waitcnt lgkmcnt(8)
  v_mfma_f32_16x16x32_bf16 v[128:131], v[176:179], v[40:43], v[128:131]
  ds_read_b64_tr_b16 v[208:209], v6 offset:12288
  v_mfma_f32_16x16x32_bf16 v[132:135], v[176:179], v[44:47], v[132:135]
  ds_read_b64_tr_b16 v[210:211], v6 offset:12800
  v_mfma_f32_16x16x32_bf16 v[140:143], v[180:183], v[44:47], v[140:143]
  ds_read_b64_tr_b16 v[212:213], v7 offset:12288
  v_mfma_f32_16x16x32_bf16 v[136:139], v[180:183], v[40:43], v[136:139]
  ds_read_b64_tr_b16 v[214:215], v7 offset:12800
  v_mfma_f32_16x16x32_bf16 v[144:147], v[184:187], v[40:43], v[144:147]
  ds_read_b64_tr_b16 v[216:217], v8 offset:12288
  v_mfma_f32_16x16x32_bf16 v[148:151], v[184:187], v[44:47], v[148:151]
  ds_read_b64_tr_b16 v[218:219], v8 offset:12800
  v_mfma_f32_16x16x32_bf16 v[156:159], v[188:191], v[44:47], v[156:159]
  ds_read_b64_tr_b16 v[220:221], v9 offset:12288
  v_mfma_f32_16x16x32_bf16 v[152:155], v[188:191], v[40:43], v[152:155]
  ds_read_b64_tr_b16 v[222:223], v9 offset:12800
  s_waitcnt lgkmcnt(8)
  v_mfma_f32_16x16x32_bf16 v[96:99], v[192:195], v[32:35], v[96:99]
  ds_read_b64_tr_b16 v[160:161], v6 offset:16384
  v_mfma_f32_16x16x32_bf16 v[100:103], v[192:195], v[36:39], v[100:103]
  ds_read_b64_tr_b16 v[162:163], v6 offset:16896
  v_mfma_f32_16x16x32_bf16 v[108:111], v[196:199], v[36:39], v[108:111]
  ds_read_b64_tr_b16 v[164:165], v7 offset:16384
  v_mfma_f32_16x16x32_bf16 v[104:107], v[196:199], v[32:35], v[104:107]
  ds_read_b64_tr_b16 v[166:167], v7 offset:16896
  v_mfma_f32_16x16x32_bf16 v[112:115], v[200:203], v[32:35], v[112:115]
  ds_read_b64_tr_b16 v[168:169], v8 offset:16384
  v_mfma_f32_16x16x32_bf16 v[116:119], v[200:203], v[36:39], v[116:119]
  ds_read_b64_tr_b16 v[170:171], v8 offset:16896
  v_mfma_f32_16x16x32_bf16 v[124:127], v[204:207], v[36:39], v[124:127]
  ds_read_b64_tr_b16 v[172:173], v9 offset:16384
  v_mfma_f32_16x16x32_bf16 v[120:123], v[204:207], v[32:35], v[120:123]
  ds_read_b64_tr_b16 v[174:175], v9 offset:16896
  s_waitcnt lgkmcnt(8)
  v_mfma_f32_16x16x32_bf16 v[96:99], v[208:211], v[40:43], v[96:99]
  ds_read_b64_tr_b16 v[176:177], v6 offset:20480
  v_mfma_f32_16x16x32_bf16 v[100:103], v[208:211], v[44:47], v[100:103]
  ds_read_b64_tr_b16 v[178:179], v6 offset:20992
  v_mfma_f32_16x16x32_bf16 v[108:111], v[212:215], v[44:47], v[108:111]
  ds_read_b64_tr_b16 v[180:181], v7 offset:20480
  v_mfma_f32_16x16x32_bf16 v[104:107], v[212:215], v[40:43], v[104:107]
  ds_read_b64_tr_b16 v[182:183], v7 offset:20992
  v_mfma_f32_16x16x32_bf16 v[112:115], v[216:219], v[40:43], v[112:115]
  ds_read_b64_tr_b16 v[184:185], v8 offset:20480
  v_mfma_f32_16x16x32_bf16 v[116:119], v[216:219], v[44:47], v[116:119]
  ds_read_b64_tr_b16 v[186:187], v8 offset:20992
  v_mfma_f32_16x16x32_bf16 v[124:127], v[220:223], v[44:47], v[124:127]
  ds_read_b64_tr_b16 v[188:189], v9 offset:20480
  v_mfma_f32_16x16x32_bf16 v[120:123], v[220:223], v[40:43], v[120:123]
  ds_read_b64_tr_b16 v[190:191], v9 offset:20992
  s_waitcnt lgkmcnt(8)
  v_mfma_f32_16x16x32_bf16 v[128:131], v[160:163], v[48:51], v[128:131]
  ds_read_b64_tr_b16 v[192:193], v6 offset:24576
  v_mfma_f32_16x16x32_bf16 v[132:135], v[160:163], v[52:55], v[132:135]
  ds_read_b64_tr_b16 v[194:195], v6 offset:25088
  v_mfma_f32_16x16x32_bf16 v[140:143], v[164:167], v[52:55], v[140:143]
  ds_read_b64_tr_b16 v[196:197], v7 offset:24576
  v_mfma_f32_16x16x32_bf16 v[136:139], v[164:167], v[48:51], v[136:139]
  ds_read_b64_tr_b16 v[198:199], v7 offset:25088
  v_mfma_f32_16x16x32_bf16 v[144:147], v[168:171], v[48:51], v[144:147]
  ds_read_b64_tr_b16 v[200:201], v8 offset:24576
  v_mfma_f32_16x16x32_bf16 v[148:151], v[168:171], v[52:55], v[148:151]
  ds_read_b64_tr_b16 v[202:203], v8 offset:25088
  v_mfma_f32_16x16x32_bf16 v[156:159], v[172:175], v[52:55], v[156:159]
  ds_read_b64_tr_b16 v[204:205], v9 offset:24576
  v_mfma_f32_16x16x32_bf16 v[152:155], v[172:175], v[48:51], v[152:155]
  ds_read_b64_tr_b16 v[206:207], v9 offset:25088
  s_waitcnt lgkmcnt(8)
  s_barrier
  buffer_load_dwordx4 v[80:83], off, s[36:39], s51 offset:0
  buffer_load_dwordx4 v[84:87], off, s[64:67], s51 offset:0
  buffer_load_dwordx4 v[88:91], off, s[36:39], s51 offset:1024
  buffer_load_dwordx4 v[92:95], off, s[64:67], s51 offset:1024
  buffer_load_dwordx4 v[224:227], off, s[36:39], s48 offset:0
  buffer_load_dwordx4 v[228:231], off, s[64:67], s48 offset:0
  buffer_load_dwordx4 v[232:235], off, s[36:39], s48 offset:1024
  buffer_load_dwordx4 v[236:239], off, s[64:67], s48 offset:1024
  buffer_load_dwordx4 v[240:243], off, s[36:39], s49 offset:0
  buffer_load_dwordx4 v[244:247], off, s[64:67], s49 offset:0
  buffer_load_dwordx4 v[248:251], off, s[36:39], s49 offset:1024
  buffer_load_dwordx4 v[252:255], off, s[64:67], s49 offset:1024
  v_mfma_f32_16x16x32_bf16 v[128:131], v[176:179], v[56:59], v[128:131]
  ds_read_b64_tr_b16 v[208:209], v6 offset:28672
  v_readlane_b32 s50, v15, 6
  v_mfma_f32_16x16x32_bf16 v[132:135], v[176:179], v[60:63], v[132:135]
  ds_read_b64_tr_b16 v[210:211], v6 offset:29184
  v_mfma_f32_16x16x32_bf16 v[140:143], v[180:183], v[60:63], v[140:143]
  ds_read_b64_tr_b16 v[212:213], v7 offset:28672
  v_mfma_f32_16x16x32_bf16 v[136:139], v[180:183], v[56:59], v[136:139]
  buffer_load_dwordx4 v[32:35], off, s[36:39], s50 offset:0
  v_mfma_f32_16x16x32_bf16 v[144:147], v[184:187], v[56:59], v[144:147]
  ds_read_b64_tr_b16 v[214:215], v7 offset:29184
  ds_read_b64_tr_b16 v[216:217], v8 offset:28672
  v_mfma_f32_16x16x32_bf16 v[148:151], v[184:187], v[60:63], v[148:151]
  ds_read_b64_tr_b16 v[218:219], v8 offset:29184
  ds_read_b64_tr_b16 v[220:221], v9 offset:28672
  v_mfma_f32_16x16x32_bf16 v[156:159], v[188:191], v[60:63], v[156:159]
  buffer_load_dwordx4 v[36:39], off, s[64:67], s50 offset:0
  v_mfma_f32_16x16x32_bf16 v[152:155], v[188:191], v[56:59], v[152:155]
  ds_read_b64_tr_b16 v[222:223], v9 offset:29184
  s_waitcnt lgkmcnt(8)
  v_mfma_f32_16x16x32_bf16 v[96:99], v[192:195], v[48:51], v[96:99]
  ds_read_b64_tr_b16 v[160:161], v6 offset:32768
  v_mfma_f32_16x16x32_bf16 v[100:103], v[192:195], v[52:55], v[100:103]
  buffer_load_dwordx4 v[40:43], off, s[36:39], s50 offset:1024
  v_mfma_f32_16x16x32_bf16 v[108:111], v[196:199], v[52:55], v[108:111]
  ds_read_b64_tr_b16 v[162:163], v6 offset:33280
  ds_read_b64_tr_b16 v[164:165], v7 offset:32768
  v_mfma_f32_16x16x32_bf16 v[104:107], v[196:199], v[48:51], v[104:107]
  ds_read_b64_tr_b16 v[166:167], v7 offset:33280
  v_mfma_f32_16x16x32_bf16 v[112:115], v[200:203], v[48:51], v[112:115]
  buffer_load_dwordx4 v[44:47], off, s[64:67], s50 offset:1024
  v_mfma_f32_16x16x32_bf16 v[116:119], v[200:203], v[52:55], v[116:119]
  ds_read_b64_tr_b16 v[168:169], v8 offset:32768
  ds_read_b64_tr_b16 v[170:171], v8 offset:33280
  v_mfma_f32_16x16x32_bf16 v[124:127], v[204:207], v[52:55], v[124:127]
  ds_read_b64_tr_b16 v[172:173], v9 offset:32768
  v_mfma_f32_16x16x32_bf16 v[120:123], v[204:207], v[48:51], v[120:123]
  ds_read_b64_tr_b16 v[174:175], v9 offset:33280
  s_waitcnt lgkmcnt(8)
  v_mfma_f32_16x16x32_bf16 v[96:99], v[208:211], v[56:59], v[96:99]
  ds_read_b64_tr_b16 v[176:177], v6 offset:36864
  v_mfma_f32_16x16x32_bf16 v[100:103], v[208:211], v[60:63], v[100:103]
  ds_read_b64_tr_b16 v[178:179], v6 offset:37376
  v_mfma_f32_16x16x32_bf16 v[108:111], v[212:215], v[60:63], v[108:111]
  ds_read_b64_tr_b16 v[180:181], v7 offset:36864
  v_mfma_f32_16x16x32_bf16 v[104:107], v[212:215], v[56:59], v[104:107]
  ds_read_b64_tr_b16 v[182:183], v7 offset:37376
  v_mfma_f32_16x16x32_bf16 v[112:115], v[216:219], v[56:59], v[112:115]
  ds_read_b64_tr_b16 v[184:185], v8 offset:36864
  v_mfma_f32_16x16x32_bf16 v[116:119], v[216:219], v[60:63], v[116:119]
  ds_read_b64_tr_b16 v[186:187], v8 offset:37376
  v_readlane_b32 s51, v15, 7
  v_mfma_f32_16x16x32_bf16 v[124:127], v[220:223], v[60:63], v[124:127]
  ds_read_b64_tr_b16 v[188:189], v9 offset:36864
  v_mfma_f32_16x16x32_bf16 v[120:123], v[220:223], v[56:59], v[120:123]
  ds_read_b64_tr_b16 v[190:191], v9 offset:37376
  s_waitcnt lgkmcnt(8)
  v_mfma_f32_16x16x32_bf16 v[128:131], v[160:163], v[64:67], v[128:131]
  buffer_load_dwordx4 v[48:51], off, s[36:39], s51 offset:0
  v_mfma_f32_16x16x32_bf16 v[132:135], v[160:163], v[68:71], v[132:135]
  ds_read_b64_tr_b16 v[192:193], v6 offset:40960
  ds_read_b64_tr_b16 v[194:195], v6 offset:41472
  v_mfma_f32_16x16x32_bf16 v[140:143], v[164:167], v[68:71], v[140:143]
  ds_read_b64_tr_b16 v[196:197], v7 offset:40960
  v_mfma_f32_16x16x32_bf16 v[136:139], v[164:167], v[64:67], v[136:139]
  buffer_load_dwordx4 v[52:55], off, s[64:67], s51 offset:0
  v_mfma_f32_16x16x32_bf16 v[144:147], v[168:171], v[64:67], v[144:147]
  ds_read_b64_tr_b16 v[198:199], v7 offset:41472
  ds_read_b64_tr_b16 v[200:201], v8 offset:40960
  v_mfma_f32_16x16x32_bf16 v[148:151], v[168:171], v[68:71], v[148:151]
  ds_read_b64_tr_b16 v[202:203], v8 offset:41472
  ds_read_b64_tr_b16 v[204:205], v9 offset:40960
  v_mfma_f32_16x16x32_bf16 v[156:159], v[172:175], v[68:71], v[156:159]
  buffer_load_dwordx4 v[56:59], off, s[36:39], s51 offset:1024
  v_mfma_f32_16x16x32_bf16 v[152:155], v[172:175], v[64:67], v[152:155]
  ds_read_b64_tr_b16 v[206:207], v9 offset:41472
  s_waitcnt lgkmcnt(8)
  v_mfma_f32_16x16x32_bf16 v[128:131], v[176:179], v[72:75], v[128:131]
  ds_read_b64_tr_b16 v[208:209], v6 offset:45056
  v_mfma_f32_16x16x32_bf16 v[132:135], v[176:179], v[76:79], v[132:135]
  buffer_load_dwordx4 v[60:63], off, s[64:67], s51 offset:1024
  v_mfma_f32_16x16x32_bf16 v[140:143], v[180:183], v[76:79], v[140:143]
  ds_read_b64_tr_b16 v[210:211], v6 offset:45568
  ds_read_b64_tr_b16 v[212:213], v7 offset:45056
  v_mfma_f32_16x16x32_bf16 v[136:139], v[180:183], v[72:75], v[136:139]
  ds_read_b64_tr_b16 v[214:215], v7 offset:45568
  v_mfma_f32_16x16x32_bf16 v[144:147], v[184:187], v[72:75], v[144:147]
  ds_read_b64_tr_b16 v[216:217], v8 offset:45056
  v_mfma_f32_16x16x32_bf16 v[148:151], v[184:187], v[76:79], v[148:151]
  ds_read_b64_tr_b16 v[218:219], v8 offset:45568
  v_mfma_f32_16x16x32_bf16 v[156:159], v[188:191], v[76:79], v[156:159]
  ds_read_b64_tr_b16 v[220:221], v9 offset:45056
  v_mfma_f32_16x16x32_bf16 v[152:155], v[188:191], v[72:75], v[152:155]
  ds_read_b64_tr_b16 v[222:223], v9 offset:45568
  s_waitcnt lgkmcnt(8)
  v_mfma_f32_16x16x32_bf16 v[96:99], v[192:195], v[64:67], v[96:99]
  ds_read_b64_tr_b16 v[160:161], v6 offset:49152
  v_mfma_f32_16x16x32_bf16 v[100:103], v[192:195], v[68:71], v[100:103]
  ds_read_b64_tr_b16 v[162:163], v6 offset:49664
  v_mfma_f32_16x16x32_bf16 v[108:111], v[196:199], v[68:71], v[108:111]
  ds_read_b64_tr_b16 v[164:165], v7 offset:49152
  v_mfma_f32_16x16x32_bf16 v[104:107], v[196:199], v[64:67], v[104:107]
  ds_read_b64_tr_b16 v[166:167], v7 offset:49664
  v_mfma_f32_16x16x32_bf16 v[112:115], v[200:203], v[64:67], v[112:115]
  ds_read_b64_tr_b16 v[168:169], v8 offset:49152
  v_mfma_f32_16x16x32_bf16 v[116:119], v[200:203], v[68:71], v[116:119]
  ds_read_b64_tr_b16 v[170:171], v8 offset:49664
  v_mfma_f32_16x16x32_bf16 v[124:127], v[204:207], v[68:71], v[124:127]
  ds_read_b64_tr_b16 v[172:173], v9 offset:49152
  v_mfma_f32_16x16x32_bf16 v[120:123], v[204:207], v[64:67], v[120:123]
  ds_read_b64_tr_b16 v[174:175], v9 offset:49664
  s_waitcnt lgkmcnt(8)
  v_mfma_f32_16x16x32_bf16 v[96:99], v[208:211], v[72:75], v[96:99]
  ds_read_b64_tr_b16 v[176:177], v6 offset:53248
  v_mfma_f32_16x16x32_bf16 v[100:103], v[208:211], v[76:79], v[100:103]
  ds_read_b64_tr_b16 v[178:179], v6 offset:53760
  v_mfma_f32_16x16x32_bf16 v[108:111], v[212:215], v[76:79], v[108:111]
  ds_read_b64_tr_b16 v[180:181], v7 offset:53248
  v_mfma_f32_16x16x32_bf16 v[104:107], v[212:215], v[72:75], v[104:107]
  ds_read_b64_tr_b16 v[182:183], v7 offset:53760
  v_mfma_f32_16x16x32_bf16 v[112:115], v[216:219], v[72:75], v[112:115]
  ds_read_b64_tr_b16 v[184:185], v8 offset:53248
  v_mfma_f32_16x16x32_bf16 v[116:119], v[216:219], v[76:79], v[116:119]
  ds_read_b64_tr_b16 v[186:187], v8 offset:53760
  v_readlane_b32 s48, v15, 8
  v_mfma_f32_16x16x32_bf16 v[124:127], v[220:223], v[76:79], v[124:127]
  ds_read_b64_tr_b16 v[188:189], v9 offset:53248
  v_mfma_f32_16x16x32_bf16 v[120:123], v[220:223], v[72:75], v[120:123]
  ds_read_b64_tr_b16 v[190:191], v9 offset:53760
  s_waitcnt vmcnt(18) lgkmcnt(8)
  v_mfma_f32_16x16x32_bf16 v[128:131], v[160:163], v[80:83], v[128:131]
  buffer_load_dwordx4 v[64:67], off, s[36:39], s48 offset:0
  v_mfma_f32_16x16x32_bf16 v[132:135], v[160:163], v[84:87], v[132:135]
  ds_read_b64_tr_b16 v[192:193], v6 offset:57344
  ds_read_b64_tr_b16 v[194:195], v6 offset:57856
  v_mfma_f32_16x16x32_bf16 v[140:143], v[164:167], v[84:87], v[140:143]
  ds_read_b64_tr_b16 v[196:197], v7 offset:57344
  v_mfma_f32_16x16x32_bf16 v[136:139], v[164:167], v[80:83], v[136:139]
  ds_read_b64_tr_b16 v[198:199], v7 offset:57856
  v_mfma_f32_16x16x32_bf16 v[144:147], v[168:171], v[80:83], v[144:147]
  ds_read_b64_tr_b16 v[200:201], v8 offset:57344
  v_mfma_f32_16x16x32_bf16 v[148:151], v[168:171], v[84:87], v[148:151]
  ds_read_b64_tr_b16 v[202:203], v8 offset:57856
  v_mfma_f32_16x16x32_bf16 v[156:159], v[172:175], v[84:87], v[156:159]
  ds_read_b64_tr_b16 v[204:205], v9 offset:57344
  v_mfma_f32_16x16x32_bf16 v[152:155], v[172:175], v[80:83], v[152:155]
  ds_read_b64_tr_b16 v[206:207], v9 offset:57856
  s_waitcnt vmcnt(17) lgkmcnt(8)
  v_mfma_f32_16x16x32_bf16 v[128:131], v[176:179], v[88:91], v[128:131]
  buffer_load_dwordx4 v[68:71], off, s[64:67], s48 offset:0
  v_mfma_f32_16x16x32_bf16 v[132:135], v[176:179], v[92:95], v[132:135]
  ds_read_b64_tr_b16 v[208:209], v6 offset:61440
  ds_read_b64_tr_b16 v[210:211], v6 offset:61952
  v_mfma_f32_16x16x32_bf16 v[140:143], v[180:183], v[92:95], v[140:143]
  ds_read_b64_tr_b16 v[212:213], v7 offset:61440
  v_mfma_f32_16x16x32_bf16 v[136:139], v[180:183], v[88:91], v[136:139]
  ds_read_b64_tr_b16 v[214:215], v7 offset:61952
  v_mfma_f32_16x16x32_bf16 v[144:147], v[184:187], v[88:91], v[144:147]
  ds_read_b64_tr_b16 v[216:217], v8 offset:61440
  v_mfma_f32_16x16x32_bf16 v[148:151], v[184:187], v[92:95], v[148:151]
  ds_read_b64_tr_b16 v[218:219], v8 offset:61952
  v_mfma_f32_16x16x32_bf16 v[156:159], v[188:191], v[92:95], v[156:159]
  ds_read_b64_tr_b16 v[220:221], v9 offset:61440
  v_mfma_f32_16x16x32_bf16 v[152:155], v[188:191], v[88:91], v[152:155]
  ds_read_b64_tr_b16 v[222:223], v9 offset:61952
  s_waitcnt lgkmcnt(8)
  v_mfma_f32_16x16x32_bf16 v[96:99], v[192:195], v[80:83], v[96:99]
  buffer_load_dwordx4 v[72:75], off, s[36:39], s48 offset:1024
  v_mfma_f32_16x16x32_bf16 v[100:103], v[192:195], v[84:87], v[100:103]
  ds_read_b64_tr_b16 v[160:161], v20 offset:0
  ds_read_b64_tr_b16 v[162:163], v20 offset:512
  v_mfma_f32_16x16x32_bf16 v[108:111], v[196:199], v[84:87], v[108:111]
  ds_read_b64_tr_b16 v[164:165], v21 offset:0
  v_mfma_f32_16x16x32_bf16 v[104:107], v[196:199], v[80:83], v[104:107]
  ds_read_b64_tr_b16 v[166:167], v21 offset:512
  v_mfma_f32_16x16x32_bf16 v[112:115], v[200:203], v[80:83], v[112:115]
  ds_read_b64_tr_b16 v[168:169], v22 offset:0
  v_mfma_f32_16x16x32_bf16 v[116:119], v[200:203], v[84:87], v[116:119]
  ds_read_b64_tr_b16 v[170:171], v22 offset:512
  v_mfma_f32_16x16x32_bf16 v[124:127], v[204:207], v[84:87], v[124:127]
  ds_read_b64_tr_b16 v[172:173], v23 offset:0
  v_mfma_f32_16x16x32_bf16 v[120:123], v[204:207], v[80:83], v[120:123]
  ds_read_b64_tr_b16 v[174:175], v23 offset:512
  s_waitcnt lgkmcnt(8)
  s_barrier
  v_mfma_f32_16x16x32_bf16 v[96:99], v[208:211], v[88:91], v[96:99]
  buffer_load_dwordx4 v[76:79], off, s[64:67], s48 offset:1024
  v_mfma_f32_16x16x32_bf16 v[100:103], v[208:211], v[92:95], v[100:103]
  ds_read_b64_tr_b16 v[176:177], v20 offset:4096
  ds_read_b64_tr_b16 v[178:179], v20 offset:4608
  v_mfma_f32_16x16x32_bf16 v[108:111], v[212:215], v[92:95], v[108:111]
  ds_read_b64_tr_b16 v[180:181], v21 offset:4096
  v_mfma_f32_16x16x32_bf16 v[104:107], v[212:215], v[88:91], v[104:107]
  ds_read_b64_tr_b16 v[182:183], v21 offset:4608
  v_mfma_f32_16x16x32_bf16 v[112:115], v[216:219], v[88:91], v[112:115]
  ds_read_b64_tr_b16 v[184:185], v22 offset:4096
  v_mfma_f32_16x16x32_bf16 v[116:119], v[216:219], v[92:95], v[116:119]
  ds_read_b64_tr_b16 v[186:187], v22 offset:4608
  v_readlane_b32 s49, v15, 9
  v_mfma_f32_16x16x32_bf16 v[124:127], v[220:223], v[92:95], v[124:127]
  ds_read_b64_tr_b16 v[188:189], v23 offset:4096
  v_mfma_f32_16x16x32_bf16 v[120:123], v[220:223], v[88:91], v[120:123]
  ds_read_b64_tr_b16 v[190:191], v23 offset:4608
  s_waitcnt vmcnt(18) lgkmcnt(8)
  v_mfma_f32_16x16x32_bf16 v[128:131], v[160:163], v[224:227], v[128:131]
  buffer_load_dwordx4 v[80:83], off, s[36:39], s49 offset:0
  v_mfma_f32_16x16x32_bf16 v[132:135], v[160:163], v[228:231], v[132:135]
  ds_read_b64_tr_b16 v[192:193], v20 offset:8192
  ds_read_b64_tr_b16 v[194:195], v20 offset:8704
  v_mfma_f32_16x16x32_bf16 v[140:143], v[164:167], v[228:231], v[140:143]
  ds_read_b64_tr_b16 v[196:197], v21 offset:8192
  v_mfma_f32_16x16x32_bf16 v[136:139], v[164:167], v[224:227], v[136:139]
  ds_read_b64_tr_b16 v[198:199], v21 offset:8704
  v_mfma_f32_16x16x32_bf16 v[144:147], v[168:171], v[224:227], v[144:147]
  ds_read_b64_tr_b16 v[200:201], v22 offset:8192
  v_mfma_f32_16x16x32_bf16 v[148:151], v[168:171], v[228:231], v[148:151]
  ds_read_b64_tr_b16 v[202:203], v22 offset:8704
  v_mfma_f32_16x16x32_bf16 v[156:159], v[172:175], v[228:231], v[156:159]
  ds_read_b64_tr_b16 v[204:205], v23 offset:8192
  v_mfma_f32_16x16x32_bf16 v[152:155], v[172:175], v[224:227], v[152:155]
  ds_read_b64_tr_b16 v[206:207], v23 offset:8704
  s_waitcnt vmcnt(17) lgkmcnt(8)
  v_mfma_f32_16x16x32_bf16 v[128:131], v[176:179], v[232:235], v[128:131]
  buffer_load_dwordx4 v[84:87], off, s[64:67], s49 offset:0
  v_mfma_f32_16x16x32_bf16 v[132:135], v[176:179], v[236:239], v[132:135]
  ds_read_b64_tr_b16 v[208:209], v20 offset:12288
  ds_read_b64_tr_b16 v[210:211], v20 offset:12800
  v_mfma_f32_16x16x32_bf16 v[140:143], v[180:183], v[236:239], v[140:143]
  ds_read_b64_tr_b16 v[212:213], v21 offset:12288
  v_mfma_f32_16x16x32_bf16 v[136:139], v[180:183], v[232:235], v[136:139]
  ds_read_b64_tr_b16 v[214:215], v21 offset:12800
  v_mfma_f32_16x16x32_bf16 v[144:147], v[184:187], v[232:235], v[144:147]
  ds_read_b64_tr_b16 v[216:217], v22 offset:12288
  v_mfma_f32_16x16x32_bf16 v[148:151], v[184:187], v[236:239], v[148:151]
  ds_read_b64_tr_b16 v[218:219], v22 offset:12800
  v_mfma_f32_16x16x32_bf16 v[156:159], v[188:191], v[236:239], v[156:159]
  ds_read_b64_tr_b16 v[220:221], v23 offset:12288
  v_mfma_f32_16x16x32_bf16 v[152:155], v[188:191], v[232:235], v[152:155]
  ds_read_b64_tr_b16 v[222:223], v23 offset:12800
  s_waitcnt lgkmcnt(8)
  v_mfma_f32_16x16x32_bf16 v[96:99], v[192:195], v[224:227], v[96:99]
  buffer_load_dwordx4 v[88:91], off, s[36:39], s49 offset:1024
  v_mfma_f32_16x16x32_bf16 v[100:103], v[192:195], v[228:231], v[100:103]
  ds_read_b64_tr_b16 v[160:161], v20 offset:16384
  ds_read_b64_tr_b16 v[162:163], v20 offset:16896
  v_mfma_f32_16x16x32_bf16 v[108:111], v[196:199], v[228:231], v[108:111]
  ds_read_b64_tr_b16 v[164:165], v21 offset:16384
  v_mfma_f32_16x16x32_bf16 v[104:107], v[196:199], v[224:227], v[104:107]
  ds_read_b64_tr_b16 v[166:167], v21 offset:16896
  v_mfma_f32_16x16x32_bf16 v[112:115], v[200:203], v[224:227], v[112:115]
  ds_read_b64_tr_b16 v[168:169], v22 offset:16384
  v_mfma_f32_16x16x32_bf16 v[116:119], v[200:203], v[228:231], v[116:119]
  ds_read_b64_tr_b16 v[170:171], v22 offset:16896
  v_mfma_f32_16x16x32_bf16 v[124:127], v[204:207], v[228:231], v[124:127]
  ds_read_b64_tr_b16 v[172:173], v23 offset:16384
  v_mfma_f32_16x16x32_bf16 v[120:123], v[204:207], v[224:227], v[120:123]
  ds_read_b64_tr_b16 v[174:175], v23 offset:16896
  s_waitcnt lgkmcnt(8)
  v_mfma_f32_16x16x32_bf16 v[96:99], v[208:211], v[232:235], v[96:99]
  buffer_load_dwordx4 v[92:95], off, s[64:67], s49 offset:1024
  v_mfma_f32_16x16x32_bf16 v[100:103], v[208:211], v[236:239], v[100:103]
  ds_read_b64_tr_b16 v[176:177], v20 offset:20480
  ds_read_b64_tr_b16 v[178:179], v20 offset:20992
  v_mfma_f32_16x16x32_bf16 v[108:111], v[212:215], v[236:239], v[108:111]
  ds_read_b64_tr_b16 v[180:181], v21 offset:20480
  v_mfma_f32_16x16x32_bf16 v[104:107], v[212:215], v[232:235], v[104:107]
  ds_read_b64_tr_b16 v[182:183], v21 offset:20992
  v_mfma_f32_16x16x32_bf16 v[112:115], v[216:219], v[232:235], v[112:115]
  ds_read_b64_tr_b16 v[184:185], v22 offset:20480
  v_mfma_f32_16x16x32_bf16 v[116:119], v[216:219], v[236:239], v[116:119]
  ds_read_b64_tr_b16 v[186:187], v22 offset:20992
  v_readlane_b32 s50, v15, 10
  v_mfma_f32_16x16x32_bf16 v[124:127], v[220:223], v[236:239], v[124:127]
  ds_read_b64_tr_b16 v[188:189], v23 offset:20480
  v_mfma_f32_16x16x32_bf16 v[120:123], v[220:223], v[232:235], v[120:123]
  ds_read_b64_tr_b16 v[190:191], v23 offset:20992
  s_waitcnt vmcnt(18) lgkmcnt(8)
  v_mfma_f32_16x16x32_bf16 v[128:131], v[160:163], v[240:243], v[128:131]
  buffer_load_dwordx4 v[224:227], off, s[36:39], s50 offset:0
  v_mfma_f32_16x16x32_bf16 v[132:135], v[160:163], v[244:247], v[132:135]
  ds_read_b64_tr_b16 v[192:193], v20 offset:24576
  ds_read_b64_tr_b16 v[194:195], v20 offset:25088
  v_mfma_f32_16x16x32_bf16 v[140:143], v[164:167], v[244:247], v[140:143]
  ds_read_b64_tr_b16 v[196:197], v21 offset:24576
  v_mfma_f32_16x16x32_bf16 v[136:139], v[164:167], v[240:243], v[136:139]
  ds_read_b64_tr_b16 v[198:199], v21 offset:25088
  v_mfma_f32_16x16x32_bf16 v[144:147], v[168:171], v[240:243], v[144:147]
  ds_read_b64_tr_b16 v[200:201], v22 offset:24576
  v_mfma_f32_16x16x32_bf16 v[148:151], v[168:171], v[244:247], v[148:151]
  ds_read_b64_tr_b16 v[202:203], v22 offset:25088
  v_mfma_f32_16x16x32_bf16 v[156:159], v[172:175], v[244:247], v[156:159]
  ds_read_b64_tr_b16 v[204:205], v23 offset:24576
  v_mfma_f32_16x16x32_bf16 v[152:155], v[172:175], v[240:243], v[152:155]
  ds_read_b64_tr_b16 v[206:207], v23 offset:25088
  s_waitcnt vmcnt(17) lgkmcnt(8)
  v_mfma_f32_16x16x32_bf16 v[128:131], v[176:179], v[248:251], v[128:131]
  buffer_load_dwordx4 v[228:231], off, s[64:67], s50 offset:0
  v_mfma_f32_16x16x32_bf16 v[132:135], v[176:179], v[252:255], v[132:135]
  ds_read_b64_tr_b16 v[208:209], v20 offset:28672
  ds_read_b64_tr_b16 v[210:211], v20 offset:29184
  v_mfma_f32_16x16x32_bf16 v[140:143], v[180:183], v[252:255], v[140:143]
  ds_read_b64_tr_b16 v[212:213], v21 offset:28672
  v_mfma_f32_16x16x32_bf16 v[136:139], v[180:183], v[248:251], v[136:139]
  ds_read_b64_tr_b16 v[214:215], v21 offset:29184
  v_mfma_f32_16x16x32_bf16 v[144:147], v[184:187], v[248:251], v[144:147]
  ds_read_b64_tr_b16 v[216:217], v22 offset:28672
  v_mfma_f32_16x16x32_bf16 v[148:151], v[184:187], v[252:255], v[148:151]
  ds_read_b64_tr_b16 v[218:219], v22 offset:29184
  v_mfma_f32_16x16x32_bf16 v[156:159], v[188:191], v[252:255], v[156:159]
  ds_read_b64_tr_b16 v[220:221], v23 offset:28672
  v_mfma_f32_16x16x32_bf16 v[152:155], v[188:191], v[248:251], v[152:155]
  ds_read_b64_tr_b16 v[222:223], v23 offset:29184
  s_waitcnt lgkmcnt(8)
  v_mfma_f32_16x16x32_bf16 v[96:99], v[192:195], v[240:243], v[96:99]
  buffer_load_dwordx4 v[232:235], off, s[36:39], s50 offset:1024
  v_mfma_f32_16x16x32_bf16 v[100:103], v[192:195], v[244:247], v[100:103]
  ds_read_b64_tr_b16 v[160:161], v20 offset:32768
  ds_read_b64_tr_b16 v[162:163], v20 offset:33280
  v_mfma_f32_16x16x32_bf16 v[108:111], v[196:199], v[244:247], v[108:111]
  ds_read_b64_tr_b16 v[164:165], v21 offset:32768
  v_mfma_f32_16x16x32_bf16 v[104:107], v[196:199], v[240:243], v[104:107]
  ds_read_b64_tr_b16 v[166:167], v21 offset:33280
  v_mfma_f32_16x16x32_bf16 v[112:115], v[200:203], v[240:243], v[112:115]
  ds_read_b64_tr_b16 v[168:169], v22 offset:32768
  v_mfma_f32_16x16x32_bf16 v[116:119], v[200:203], v[244:247], v[116:119]
  ds_read_b64_tr_b16 v[170:171], v22 offset:33280
  v_mfma_f32_16x16x32_bf16 v[124:127], v[204:207], v[244:247], v[124:127]
  ds_read_b64_tr_b16 v[172:173], v23 offset:32768
  v_mfma_f32_16x16x32_bf16 v[120:123], v[204:207], v[240:243], v[120:123]
  ds_read_b64_tr_b16 v[174:175], v23 offset:33280
  s_waitcnt lgkmcnt(8)
  s_barrier
  v_mfma_f32_16x16x32_bf16 v[96:99], v[208:211], v[248:251], v[96:99]
  buffer_load_dwordx4 v[236:239], off, s[64:67], s50 offset:1024
  v_mfma_f32_16x16x32_bf16 v[100:103], v[208:211], v[252:255], v[100:103]
  ds_read_b64_tr_b16 v[176:177], v20 offset:36864
  ds_read_b64_tr_b16 v[178:179], v20 offset:37376
  v_mfma_f32_16x16x32_bf16 v[108:111], v[212:215], v[252:255], v[108:111]
  ds_read_b64_tr_b16 v[180:181], v21 offset:36864
  v_mfma_f32_16x16x32_bf16 v[104:107], v[212:215], v[248:251], v[104:107]
  ds_read_b64_tr_b16 v[182:183], v21 offset:37376
  v_mfma_f32_16x16x32_bf16 v[112:115], v[216:219], v[248:251], v[112:115]
  ds_read_b64_tr_b16 v[184:185], v22 offset:36864
  v_mfma_f32_16x16x32_bf16 v[116:119], v[216:219], v[252:255], v[116:119]
  ds_read_b64_tr_b16 v[186:187], v22 offset:37376
  v_readlane_b32 s51, v15, 11
  v_mfma_f32_16x16x32_bf16 v[124:127], v[220:223], v[252:255], v[124:127]
  ds_read_b64_tr_b16 v[188:189], v23 offset:36864
  v_mfma_f32_16x16x32_bf16 v[120:123], v[220:223], v[248:251], v[120:123]
  ds_read_b64_tr_b16 v[190:191], v23 offset:37376
  s_waitcnt vmcnt(18) lgkmcnt(8)
  v_mfma_f32_16x16x32_bf16 v[128:131], v[160:163], v[32:35], v[128:131]
  buffer_load_dwordx4 v[240:243], off, s[36:39], s51 offset:0
  v_mfma_f32_16x16x32_bf16 v[132:135], v[160:163], v[36:39], v[132:135]
  ds_read_b64_tr_b16 v[192:193], v20 offset:40960
  ds_read_b64_tr_b16 v[194:195], v20 offset:41472
  v_mfma_f32_16x16x32_bf16 v[140:143], v[164:167], v[36:39], v[140:143]
  ds_read_b64_tr_b16 v[196:197], v21 offset:40960
  v_mfma_f32_16x16x32_bf16 v[136:139], v[164:167], v[32:35], v[136:139]
  ds_read_b64_tr_b16 v[198:199], v21 offset:41472
  v_mfma_f32_16x16x32_bf16 v[144:147], v[168:171], v[32:35], v[144:147]
  ds_read_b64_tr_b16 v[200:201], v22 offset:40960
  v_mfma_f32_16x16x32_bf16 v[148:151], v[168:171], v[36:39], v[148:151]
  ds_read_b64_tr_b16 v[202:203], v22 offset:41472
  v_mfma_f32_16x16x32_bf16 v[156:159], v[172:175], v[36:39], v[156:159]
  ds_read_b64_tr_b16 v[204:205], v23 offset:40960
  v_mfma_f32_16x16x32_bf16 v[152:155], v[172:175], v[32:35], v[152:155]
  ds_read_b64_tr_b16 v[206:207], v23 offset:41472
  s_waitcnt vmcnt(17) lgkmcnt(8)
  v_mfma_f32_16x16x32_bf16 v[128:131], v[176:179], v[40:43], v[128:131]
  buffer_load_dwordx4 v[244:247], off, s[64:67], s51 offset:0
  v_mfma_f32_16x16x32_bf16 v[132:135], v[176:179], v[44:47], v[132:135]
  ds_read_b64_tr_b16 v[208:209], v20 offset:45056
  ds_read_b64_tr_b16 v[210:211], v20 offset:45568
  v_mfma_f32_16x16x32_bf16 v[140:143], v[180:183], v[44:47], v[140:143]
  ds_read_b64_tr_b16 v[212:213], v21 offset:45056
  v_mfma_f32_16x16x32_bf16 v[136:139], v[180:183], v[40:43], v[136:139]
  ds_read_b64_tr_b16 v[214:215], v21 offset:45568
  v_mfma_f32_16x16x32_bf16 v[144:147], v[184:187], v[40:43], v[144:147]
  ds_read_b64_tr_b16 v[216:217], v22 offset:45056
  v_mfma_f32_16x16x32_bf16 v[148:151], v[184:187], v[44:47], v[148:151]
  ds_read_b64_tr_b16 v[218:219], v22 offset:45568
  v_mfma_f32_16x16x32_bf16 v[156:159], v[188:191], v[44:47], v[156:159]
  ds_read_b64_tr_b16 v[220:221], v23 offset:45056
  v_mfma_f32_16x16x32_bf16 v[152:155], v[188:191], v[40:43], v[152:155]
  ds_read_b64_tr_b16 v[222:223], v23 offset:45568
  s_waitcnt lgkmcnt(8)
  v_mfma_f32_16x16x32_bf16 v[96:99], v[192:195], v[32:35], v[96:99]
  buffer_load_dwordx4 v[248:251], off, s[36:39], s51 offset:1024
  v_mfma_f32_16x16x32_bf16 v[100:103], v[192:195], v[36:39], v[100:103]
  ds_read_b64_tr_b16 v[160:161], v20 offset:49152
  ds_read_b64_tr_b16 v[162:163], v20 offset:49664
  v_mfma_f32_16x16x32_bf16 v[108:111], v[196:199], v[36:39], v[108:111]
  ds_read_b64_tr_b16 v[164:165], v21 offset:49152
  v_mfma_f32_16x16x32_bf16 v[104:107], v[196:199], v[32:35], v[104:107]
  ds_read_b64_tr_b16 v[166:167], v21 offset:49664
  v_mfma_f32_16x16x32_bf16 v[112:115], v[200:203], v[32:35], v[112:115]
  ds_read_b64_tr_b16 v[168:169], v22 offset:49152
  v_mfma_f32_16x16x32_bf16 v[116:119], v[200:203], v[36:39], v[116:119]
  ds_read_b64_tr_b16 v[170:171], v22 offset:49664
  v_mfma_f32_16x16x32_bf16 v[124:127], v[204:207], v[36:39], v[124:127]
  ds_read_b64_tr_b16 v[172:173], v23 offset:49152
  v_mfma_f32_16x16x32_bf16 v[120:123], v[204:207], v[32:35], v[120:123]
  ds_read_b64_tr_b16 v[174:175], v23 offset:49664
  s_waitcnt lgkmcnt(8)
  v_mfma_f32_16x16x32_bf16 v[96:99], v[208:211], v[40:43], v[96:99]
  buffer_load_dwordx4 v[252:255], off, s[64:67], s51 offset:1024
  v_mfma_f32_16x16x32_bf16 v[100:103], v[208:211], v[44:47], v[100:103]
  ds_read_b64_tr_b16 v[176:177], v20 offset:53248
  ds_read_b64_tr_b16 v[178:179], v20 offset:53760
  v_mfma_f32_16x16x32_bf16 v[108:111], v[212:215], v[44:47], v[108:111]
  ds_read_b64_tr_b16 v[180:181], v21 offset:53248
  v_mfma_f32_16x16x32_bf16 v[104:107], v[212:215], v[40:43], v[104:107]
  ds_read_b64_tr_b16 v[182:183], v21 offset:53760
  v_mfma_f32_16x16x32_bf16 v[112:115], v[216:219], v[40:43], v[112:115]
  ds_read_b64_tr_b16 v[184:185], v22 offset:53248
  v_mfma_f32_16x16x32_bf16 v[116:119], v[216:219], v[44:47], v[116:119]
  ds_read_b64_tr_b16 v[186:187], v22 offset:53760
  v_readlane_b32 s48, v15, 12
  v_mfma_f32_16x16x32_bf16 v[124:127], v[220:223], v[44:47], v[124:127]
  ds_read_b64_tr_b16 v[188:189], v23 offset:53248
  v_mfma_f32_16x16x32_bf16 v[120:123], v[220:223], v[40:43], v[120:123]
  ds_read_b64_tr_b16 v[190:191], v23 offset:53760
  s_waitcnt vmcnt(18) lgkmcnt(8)
  v_mfma_f32_16x16x32_bf16 v[128:131], v[160:163], v[48:51], v[128:131]
  buffer_load_dwordx4 v[32:35], off, s[36:39], s48 offset:0
  v_mfma_f32_16x16x32_bf16 v[132:135], v[160:163], v[52:55], v[132:135]
  ds_read_b64_tr_b16 v[192:193], v20 offset:57344
  ds_read_b64_tr_b16 v[194:195], v20 offset:57856
  v_mfma_f32_16x16x32_bf16 v[140:143], v[164:167], v[52:55], v[140:143]
  ds_read_b64_tr_b16 v[196:197], v21 offset:57344
  v_mfma_f32_16x16x32_bf16 v[136:139], v[164:167], v[48:51], v[136:139]
  ds_read_b64_tr_b16 v[198:199], v21 offset:57856
  v_mfma_f32_16x16x32_bf16 v[144:147], v[168:171], v[48:51], v[144:147]
  ds_read_b64_tr_b16 v[200:201], v22 offset:57344
  v_mfma_f32_16x16x32_bf16 v[148:151], v[168:171], v[52:55], v[148:151]
  ds_read_b64_tr_b16 v[202:203], v22 offset:57856
  v_mfma_f32_16x16x32_bf16 v[156:159], v[172:175], v[52:55], v[156:159]
  ds_read_b64_tr_b16 v[204:205], v23 offset:57344
  v_mfma_f32_16x16x32_bf16 v[152:155], v[172:175], v[48:51], v[152:155]
  ds_read_b64_tr_b16 v[206:207], v23 offset:57856
  s_waitcnt vmcnt(17) lgkmcnt(8)
  v_mfma_f32_16x16x32_bf16 v[128:131], v[176:179], v[56:59], v[128:131]
  buffer_load_dwordx4 v[36:39], off, s[64:67], s48 offset:0
  v_mfma_f32_16x16x32_bf16 v[132:135], v[176:179], v[60:63], v[132:135]
  ds_read_b64_tr_b16 v[208:209], v20 offset:61440
  ds_read_b64_tr_b16 v[210:211], v20 offset:61952
  v_mfma_f32_16x16x32_bf16 v[140:143], v[180:183], v[60:63], v[140:143]
  ds_read_b64_tr_b16 v[212:213], v21 offset:61440
  v_mfma_f32_16x16x32_bf16 v[136:139], v[180:183], v[56:59], v[136:139]
  ds_read_b64_tr_b16 v[214:215], v21 offset:61952
  v_mfma_f32_16x16x32_bf16 v[144:147], v[184:187], v[56:59], v[144:147]
  ds_read_b64_tr_b16 v[216:217], v22 offset:61440
  v_mfma_f32_16x16x32_bf16 v[148:151], v[184:187], v[60:63], v[148:151]
  ds_read_b64_tr_b16 v[218:219], v22 offset:61952
  v_mfma_f32_16x16x32_bf16 v[156:159], v[188:191], v[60:63], v[156:159]
  ds_read_b64_tr_b16 v[220:221], v23 offset:61440
  v_mfma_f32_16x16x32_bf16 v[152:155], v[188:191], v[56:59], v[152:155]
  ds_read_b64_tr_b16 v[222:223], v23 offset:61952
  s_waitcnt lgkmcnt(8)
  v_mfma_f32_16x16x32_bf16 v[96:99], v[192:195], v[48:51], v[96:99]
  buffer_load_dwordx4 v[40:43], off, s[36:39], s48 offset:1024
  v_mfma_f32_16x16x32_bf16 v[100:103], v[192:195], v[52:55], v[100:103]
  ds_read_b64_tr_b16 v[160:161], v26 offset:0
  ds_read_b64_tr_b16 v[162:163], v26 offset:512
  v_mfma_f32_16x16x32_bf16 v[108:111], v[196:199], v[52:55], v[108:111]
  ds_read_b64_tr_b16 v[164:165], v27 offset:0
  v_mfma_f32_16x16x32_bf16 v[104:107], v[196:199], v[48:51], v[104:107]
  ds_read_b64_tr_b16 v[166:167], v27 offset:512
  v_mfma_f32_16x16x32_bf16 v[112:115], v[200:203], v[48:51], v[112:115]
  ds_read_b64_tr_b16 v[168:169], v28 offset:0
  v_mfma_f32_16x16x32_bf16 v[116:119], v[200:203], v[52:55], v[116:119]
  ds_read_b64_tr_b16 v[170:171], v28 offset:512
  v_mfma_f32_16x16x32_bf16 v[124:127], v[204:207], v[52:55], v[124:127]
  ds_read_b64_tr_b16 v[172:173], v29 offset:0
  v_mfma_f32_16x16x32_bf16 v[120:123], v[204:207], v[48:51], v[120:123]
  ds_read_b64_tr_b16 v[174:175], v29 offset:512
  s_waitcnt lgkmcnt(8)
  s_barrier
  v_mfma_f32_16x16x32_bf16 v[96:99], v[208:211], v[56:59], v[96:99]
  buffer_load_dwordx4 v[44:47], off, s[64:67], s48 offset:1024
  v_mfma_f32_16x16x32_bf16 v[100:103], v[208:211], v[60:63], v[100:103]
  ds_read_b64_tr_b16 v[176:177], v26 offset:4096
  ds_read_b64_tr_b16 v[178:179], v26 offset:4608
  v_mfma_f32_16x16x32_bf16 v[108:111], v[212:215], v[60:63], v[108:111]
  ds_read_b64_tr_b16 v[180:181], v27 offset:4096
  v_mfma_f32_16x16x32_bf16 v[104:107], v[212:215], v[56:59], v[104:107]
  ds_read_b64_tr_b16 v[182:183], v27 offset:4608
  v_mfma_f32_16x16x32_bf16 v[112:115], v[216:219], v[56:59], v[112:115]
  ds_read_b64_tr_b16 v[184:185], v28 offset:4096
  v_mfma_f32_16x16x32_bf16 v[116:119], v[216:219], v[60:63], v[116:119]
  ds_read_b64_tr_b16 v[186:187], v28 offset:4608
  v_readlane_b32 s49, v15, 13
  v_mfma_f32_16x16x32_bf16 v[124:127], v[220:223], v[60:63], v[124:127]
  ds_read_b64_tr_b16 v[188:189], v29 offset:4096
  v_mfma_f32_16x16x32_bf16 v[120:123], v[220:223], v[56:59], v[120:123]
  ds_read_b64_tr_b16 v[190:191], v29 offset:4608
  s_waitcnt vmcnt(18) lgkmcnt(8)
  v_mfma_f32_16x16x32_bf16 v[128:131], v[160:163], v[64:67], v[128:131]
  buffer_load_dwordx4 v[48:51], off, s[36:39], s49 offset:0
  v_mfma_f32_16x16x32_bf16 v[132:135], v[160:163], v[68:71], v[132:135]
  ds_read_b64_tr_b16 v[192:193], v26 offset:8192
  ds_read_b64_tr_b16 v[194:195], v26 offset:8704
  v_mfma_f32_16x16x32_bf16 v[140:143], v[164:167], v[68:71], v[140:143]
  ds_read_b64_tr_b16 v[196:197], v27 offset:8192
  v_mfma_f32_16x16x32_bf16 v[136:139], v[164:167], v[64:67], v[136:139]
  ds_read_b64_tr_b16 v[198:199], v27 offset:8704
  v_mfma_f32_16x16x32_bf16 v[144:147], v[168:171], v[64:67], v[144:147]
  ds_read_b64_tr_b16 v[200:201], v28 offset:8192
  v_mfma_f32_16x16x32_bf16 v[148:151], v[168:171], v[68:71], v[148:151]
  ds_read_b64_tr_b16 v[202:203], v28 offset:8704
  v_mfma_f32_16x16x32_bf16 v[156:159], v[172:175], v[68:71], v[156:159]
  ds_read_b64_tr_b16 v[204:205], v29 offset:8192
  v_mfma_f32_16x16x32_bf16 v[152:155], v[172:175], v[64:67], v[152:155]
  ds_read_b64_tr_b16 v[206:207], v29 offset:8704
  s_waitcnt vmcnt(17) lgkmcnt(8)
  v_mfma_f32_16x16x32_bf16 v[128:131], v[176:179], v[72:75], v[128:131]
  buffer_load_dwordx4 v[52:55], off, s[64:67], s49 offset:0
  v_mfma_f32_16x16x32_bf16 v[132:135], v[176:179], v[76:79], v[132:135]
  ds_read_b64_tr_b16 v[208:209], v26 offset:12288
  ds_read_b64_tr_b16 v[210:211], v26 offset:12800
  v_mfma_f32_16x16x32_bf16 v[140:143], v[180:183], v[76:79], v[140:143]
  ds_read_b64_tr_b16 v[212:213], v27 offset:12288
  v_mfma_f32_16x16x32_bf16 v[136:139], v[180:183], v[72:75], v[136:139]
  ds_read_b64_tr_b16 v[214:215], v27 offset:12800
  v_mfma_f32_16x16x32_bf16 v[144:147], v[184:187], v[72:75], v[144:147]
  ds_read_b64_tr_b16 v[216:217], v28 offset:12288
  v_mfma_f32_16x16x32_bf16 v[148:151], v[184:187], v[76:79], v[148:151]
  ds_read_b64_tr_b16 v[218:219], v28 offset:12800
  v_mfma_f32_16x16x32_bf16 v[156:159], v[188:191], v[76:79], v[156:159]
  ds_read_b64_tr_b16 v[220:221], v29 offset:12288
  v_mfma_f32_16x16x32_bf16 v[152:155], v[188:191], v[72:75], v[152:155]
  ds_read_b64_tr_b16 v[222:223], v29 offset:12800
  s_waitcnt lgkmcnt(8)
  v_mfma_f32_16x16x32_bf16 v[96:99], v[192:195], v[64:67], v[96:99]
  buffer_load_dwordx4 v[56:59], off, s[36:39], s49 offset:1024
  v_mfma_f32_16x16x32_bf16 v[100:103], v[192:195], v[68:71], v[100:103]
  ds_read_b64_tr_b16 v[160:161], v26 offset:16384
  ds_read_b64_tr_b16 v[162:163], v26 offset:16896
  v_mfma_f32_16x16x32_bf16 v[108:111], v[196:199], v[68:71], v[108:111]
  ds_read_b64_tr_b16 v[164:165], v27 offset:16384
  v_mfma_f32_16x16x32_bf16 v[104:107], v[196:199], v[64:67], v[104:107]
  ds_read_b64_tr_b16 v[166:167], v27 offset:16896
  v_mfma_f32_16x16x32_bf16 v[112:115], v[200:203], v[64:67], v[112:115]
  ds_read_b64_tr_b16 v[168:169], v28 offset:16384
  v_mfma_f32_16x16x32_bf16 v[116:119], v[200:203], v[68:71], v[116:119]
  ds_read_b64_tr_b16 v[170:171], v28 offset:16896
  v_mfma_f32_16x16x32_bf16 v[124:127], v[204:207], v[68:71], v[124:127]
  ds_read_b64_tr_b16 v[172:173], v29 offset:16384
  v_mfma_f32_16x16x32_bf16 v[120:123], v[204:207], v[64:67], v[120:123]
  ds_read_b64_tr_b16 v[174:175], v29 offset:16896
  s_waitcnt lgkmcnt(8)
  v_mfma_f32_16x16x32_bf16 v[96:99], v[208:211], v[72:75], v[96:99]
  buffer_load_dwordx4 v[60:63], off, s[64:67], s49 offset:1024
  v_mfma_f32_16x16x32_bf16 v[100:103], v[208:211], v[76:79], v[100:103]
  ds_read_b64_tr_b16 v[176:177], v26 offset:20480
  ds_read_b64_tr_b16 v[178:179], v26 offset:20992
  v_mfma_f32_16x16x32_bf16 v[108:111], v[212:215], v[76:79], v[108:111]
  ds_read_b64_tr_b16 v[180:181], v27 offset:20480
  v_mfma_f32_16x16x32_bf16 v[104:107], v[212:215], v[72:75], v[104:107]
  ds_read_b64_tr_b16 v[182:183], v27 offset:20992
  v_mfma_f32_16x16x32_bf16 v[112:115], v[216:219], v[72:75], v[112:115]
  ds_read_b64_tr_b16 v[184:185], v28 offset:20480
  v_mfma_f32_16x16x32_bf16 v[116:119], v[216:219], v[76:79], v[116:119]
  ds_read_b64_tr_b16 v[186:187], v28 offset:20992
  v_readlane_b32 s50, v15, 14
  v_mfma_f32_16x16x32_bf16 v[124:127], v[220:223], v[76:79], v[124:127]
  ds_read_b64_tr_b16 v[188:189], v29 offset:20480
  v_mfma_f32_16x16x32_bf16 v[120:123], v[220:223], v[72:75], v[120:123]
  ds_read_b64_tr_b16 v[190:191], v29 offset:20992
  s_waitcnt vmcnt(18) lgkmcnt(8)
  v_mfma_f32_16x16x32_bf16 v[128:131], v[160:163], v[80:83], v[128:131]
  buffer_load_dwordx4 v[64:67], off, s[36:39], s50 offset:0
  v_mfma_f32_16x16x32_bf16 v[132:135], v[160:163], v[84:87], v[132:135]
  ds_read_b64_tr_b16 v[192:193], v26 offset:24576
  ds_read_b64_tr_b16 v[194:195], v26 offset:25088
  v_mfma_f32_16x16x32_bf16 v[140:143], v[164:167], v[84:87], v[140:143]
  ds_read_b64_tr_b16 v[196:197], v27 offset:24576
  v_mfma_f32_16x16x32_bf16 v[136:139], v[164:167], v[80:83], v[136:139]
  ds_read_b64_tr_b16 v[198:199], v27 offset:25088
  v_mfma_f32_16x16x32_bf16 v[144:147], v[168:171], v[80:83], v[144:147]
  ds_read_b64_tr_b16 v[200:201], v28 offset:24576
  v_mfma_f32_16x16x32_bf16 v[148:151], v[168:171], v[84:87], v[148:151]
  ds_read_b64_tr_b16 v[202:203], v28 offset:25088
  v_mfma_f32_16x16x32_bf16 v[156:159], v[172:175], v[84:87], v[156:159]
  ds_read_b64_tr_b16 v[204:205], v29 offset:24576
  v_mfma_f32_16x16x32_bf16 v[152:155], v[172:175], v[80:83], v[152:155]
  ds_read_b64_tr_b16 v[206:207], v29 offset:25088
  s_waitcnt vmcnt(17) lgkmcnt(8)
  v_mfma_f32_16x16x32_bf16 v[128:131], v[176:179], v[88:91], v[128:131]
  buffer_load_dwordx4 v[68:71], off, s[64:67], s50 offset:0
  v_mfma_f32_16x16x32_bf16 v[132:135], v[176:179], v[92:95], v[132:135]
  ds_read_b64_tr_b16 v[208:209], v26 offset:28672
  ds_read_b64_tr_b16 v[210:211], v26 offset:29184
  v_mfma_f32_16x16x32_bf16 v[140:143], v[180:183], v[92:95], v[140:143]
  ds_read_b64_tr_b16 v[212:213], v27 offset:28672
  v_mfma_f32_16x16x32_bf16 v[136:139], v[180:183], v[88:91], v[136:139]
  ds_read_b64_tr_b16 v[214:215], v27 offset:29184
  v_mfma_f32_16x16x32_bf16 v[144:147], v[184:187], v[88:91], v[144:147]
  ds_read_b64_tr_b16 v[216:217], v28 offset:28672
  v_mfma_f32_16x16x32_bf16 v[148:151], v[184:187], v[92:95], v[148:151]
  ds_read_b64_tr_b16 v[218:219], v28 offset:29184
  v_mfma_f32_16x16x32_bf16 v[156:159], v[188:191], v[92:95], v[156:159]
  ds_read_b64_tr_b16 v[220:221], v29 offset:28672
  v_mfma_f32_16x16x32_bf16 v[152:155], v[188:191], v[88:91], v[152:155]
  ds_read_b64_tr_b16 v[222:223], v29 offset:29184
  s_waitcnt lgkmcnt(8)
  v_mfma_f32_16x16x32_bf16 v[96:99], v[192:195], v[80:83], v[96:99]
  buffer_load_dwordx4 v[72:75], off, s[36:39], s50 offset:1024
  v_mfma_f32_16x16x32_bf16 v[100:103], v[192:195], v[84:87], v[100:103]
  ds_read_b64_tr_b16 v[160:161], v6 offset:0
  ds_read_b64_tr_b16 v[162:163], v6 offset:512
  v_mfma_f32_16x16x32_bf16 v[108:111], v[196:199], v[84:87], v[108:111]
  ds_read_b64_tr_b16 v[164:165], v7 offset:0
  v_mfma_f32_16x16x32_bf16 v[104:107], v[196:199], v[80:83], v[104:107]
  ds_read_b64_tr_b16 v[166:167], v7 offset:512
  v_mfma_f32_16x16x32_bf16 v[112:115], v[200:203], v[80:83], v[112:115]
  ds_read_b64_tr_b16 v[168:169], v8 offset:0
  v_mfma_f32_16x16x32_bf16 v[116:119], v[200:203], v[84:87], v[116:119]
  ds_read_b64_tr_b16 v[170:171], v8 offset:512
  v_mfma_f32_16x16x32_bf16 v[124:127], v[204:207], v[84:87], v[124:127]
  ds_read_b64_tr_b16 v[172:173], v9 offset:0
  v_mfma_f32_16x16x32_bf16 v[120:123], v[204:207], v[80:83], v[120:123]
  ds_read_b64_tr_b16 v[174:175], v9 offset:512
  s_waitcnt lgkmcnt(8)
  s_barrier
  v_mfma_f32_16x16x32_bf16 v[96:99], v[208:211], v[88:91], v[96:99]
  buffer_load_dwordx4 v[76:79], off, s[64:67], s50 offset:1024
  v_mfma_f32_16x16x32_bf16 v[100:103], v[208:211], v[92:95], v[100:103]
  ds_read_b64_tr_b16 v[176:177], v6 offset:4096
  ds_read_b64_tr_b16 v[178:179], v6 offset:4608
  v_mfma_f32_16x16x32_bf16 v[108:111], v[212:215], v[92:95], v[108:111]
  ds_read_b64_tr_b16 v[180:181], v7 offset:4096
  v_mfma_f32_16x16x32_bf16 v[104:107], v[212:215], v[88:91], v[104:107]
  ds_read_b64_tr_b16 v[182:183], v7 offset:4608
  v_mfma_f32_16x16x32_bf16 v[112:115], v[216:219], v[88:91], v[112:115]
  ds_read_b64_tr_b16 v[184:185], v8 offset:4096
  v_mfma_f32_16x16x32_bf16 v[116:119], v[216:219], v[92:95], v[116:119]
  ds_read_b64_tr_b16 v[186:187], v8 offset:4608
  v_readlane_b32 s51, v15, 15
  v_mfma_f32_16x16x32_bf16 v[124:127], v[220:223], v[92:95], v[124:127]
  ds_read_b64_tr_b16 v[188:189], v9 offset:4096
  v_mfma_f32_16x16x32_bf16 v[120:123], v[220:223], v[88:91], v[120:123]
  ds_read_b64_tr_b16 v[190:191], v9 offset:4608
  s_waitcnt vmcnt(18) lgkmcnt(8)
  v_mfma_f32_16x16x32_bf16 v[128:131], v[160:163], v[224:227], v[128:131]
  buffer_load_dwordx4 v[80:83], off, s[36:39], s51 offset:0
  v_mfma_f32_16x16x32_bf16 v[132:135], v[160:163], v[228:231], v[132:135]
  ds_read_b64_tr_b16 v[192:193], v6 offset:8192
  ds_read_b64_tr_b16 v[194:195], v6 offset:8704
  v_mfma_f32_16x16x32_bf16 v[140:143], v[164:167], v[228:231], v[140:143]
  ds_read_b64_tr_b16 v[196:197], v7 offset:8192
  v_mfma_f32_16x16x32_bf16 v[136:139], v[164:167], v[224:227], v[136:139]
  ds_read_b64_tr_b16 v[198:199], v7 offset:8704
  v_mfma_f32_16x16x32_bf16 v[144:147], v[168:171], v[224:227], v[144:147]
  ds_read_b64_tr_b16 v[200:201], v8 offset:8192
  v_mfma_f32_16x16x32_bf16 v[148:151], v[168:171], v[228:231], v[148:151]
  ds_read_b64_tr_b16 v[202:203], v8 offset:8704
  v_mfma_f32_16x16x32_bf16 v[156:159], v[172:175], v[228:231], v[156:159]
  ds_read_b64_tr_b16 v[204:205], v9 offset:8192
  v_mfma_f32_16x16x32_bf16 v[152:155], v[172:175], v[224:227], v[152:155]
  ds_read_b64_tr_b16 v[206:207], v9 offset:8704
  s_waitcnt vmcnt(17) lgkmcnt(8)
  v_mfma_f32_16x16x32_bf16 v[128:131], v[176:179], v[232:235], v[128:131]
  buffer_load_dwordx4 v[84:87], off, s[64:67], s51 offset:0
  v_mfma_f32_16x16x32_bf16 v[132:135], v[176:179], v[236:239], v[132:135]
  ds_read_b64_tr_b16 v[208:209], v6 offset:12288
  ds_read_b64_tr_b16 v[210:211], v6 offset:12800
  v_mfma_f32_16x16x32_bf16 v[140:143], v[180:183], v[236:239], v[140:143]
  ds_read_b64_tr_b16 v[212:213], v7 offset:12288
  v_mfma_f32_16x16x32_bf16 v[136:139], v[180:183], v[232:235], v[136:139]
  ds_read_b64_tr_b16 v[214:215], v7 offset:12800
  v_mfma_f32_16x16x32_bf16 v[144:147], v[184:187], v[232:235], v[144:147]
  ds_read_b64_tr_b16 v[216:217], v8 offset:12288
  v_mfma_f32_16x16x32_bf16 v[148:151], v[184:187], v[236:239], v[148:151]
  ds_read_b64_tr_b16 v[218:219], v8 offset:12800
  v_mfma_f32_16x16x32_bf16 v[156:159], v[188:191], v[236:239], v[156:159]
  ds_read_b64_tr_b16 v[220:221], v9 offset:12288
  v_mfma_f32_16x16x32_bf16 v[152:155], v[188:191], v[232:235], v[152:155]
  ds_read_b64_tr_b16 v[222:223], v9 offset:12800
  s_waitcnt lgkmcnt(8)
  v_mfma_f32_16x16x32_bf16 v[96:99], v[192:195], v[224:227], v[96:99]
  buffer_load_dwordx4 v[88:91], off, s[36:39], s51 offset:1024
  v_mfma_f32_16x16x32_bf16 v[100:103], v[192:195], v[228:231], v[100:103]
  ds_read_b64_tr_b16 v[160:161], v6 offset:16384
  ds_read_b64_tr_b16 v[162:163], v6 offset:16896
  v_mfma_f32_16x16x32_bf16 v[108:111], v[196:199], v[228:231], v[108:111]
  ds_read_b64_tr_b16 v[164:165], v7 offset:16384
  v_mfma_f32_16x16x32_bf16 v[104:107], v[196:199], v[224:227], v[104:107]
  ds_read_b64_tr_b16 v[166:167], v7 offset:16896
  v_mfma_f32_16x16x32_bf16 v[112:115], v[200:203], v[224:227], v[112:115]
  ds_read_b64_tr_b16 v[168:169], v8 offset:16384
  v_mfma_f32_16x16x32_bf16 v[116:119], v[200:203], v[228:231], v[116:119]
  ds_read_b64_tr_b16 v[170:171], v8 offset:16896
  v_mfma_f32_16x16x32_bf16 v[124:127], v[204:207], v[228:231], v[124:127]
  ds_read_b64_tr_b16 v[172:173], v9 offset:16384
  v_mfma_f32_16x16x32_bf16 v[120:123], v[204:207], v[224:227], v[120:123]
  ds_read_b64_tr_b16 v[174:175], v9 offset:16896
  s_waitcnt lgkmcnt(8)
  v_mfma_f32_16x16x32_bf16 v[96:99], v[208:211], v[232:235], v[96:99]
  buffer_load_dwordx4 v[92:95], off, s[64:67], s51 offset:1024
  v_mfma_f32_16x16x32_bf16 v[100:103], v[208:211], v[236:239], v[100:103]
  ds_read_b64_tr_b16 v[176:177], v6 offset:20480
  ds_read_b64_tr_b16 v[178:179], v6 offset:20992
  v_mfma_f32_16x16x32_bf16 v[108:111], v[212:215], v[236:239], v[108:111]
  ds_read_b64_tr_b16 v[180:181], v7 offset:20480
  v_mfma_f32_16x16x32_bf16 v[104:107], v[212:215], v[232:235], v[104:107]
  ds_read_b64_tr_b16 v[182:183], v7 offset:20992
  v_mfma_f32_16x16x32_bf16 v[112:115], v[216:219], v[232:235], v[112:115]
  ds_read_b64_tr_b16 v[184:185], v8 offset:20480
  v_mfma_f32_16x16x32_bf16 v[116:119], v[216:219], v[236:239], v[116:119]
  ds_read_b64_tr_b16 v[186:187], v8 offset:20992
  v_readlane_b32 s48, v15, 16
  v_mfma_f32_16x16x32_bf16 v[124:127], v[220:223], v[236:239], v[124:127]
  ds_read_b64_tr_b16 v[188:189], v9 offset:20480
  v_mfma_f32_16x16x32_bf16 v[120:123], v[220:223], v[232:235], v[120:123]
  ds_read_b64_tr_b16 v[190:191], v9 offset:20992
  s_waitcnt vmcnt(18) lgkmcnt(8)
  v_mfma_f32_16x16x32_bf16 v[128:131], v[160:163], v[240:243], v[128:131]
  buffer_load_dwordx4 v[224:227], off, s[36:39], s48 offset:0
  v_mfma_f32_16x16x32_bf16 v[132:135], v[160:163], v[244:247], v[132:135]
  ds_read_b64_tr_b16 v[192:193], v6 offset:24576
  ds_read_b64_tr_b16 v[194:195], v6 offset:25088
  v_mfma_f32_16x16x32_bf16 v[140:143], v[164:167], v[244:247], v[140:143]
  ds_read_b64_tr_b16 v[196:197], v7 offset:24576
  v_mfma_f32_16x16x32_bf16 v[136:139], v[164:167], v[240:243], v[136:139]
  ds_read_b64_tr_b16 v[198:199], v7 offset:25088
  v_mfma_f32_16x16x32_bf16 v[144:147], v[168:171], v[240:243], v[144:147]
  ds_read_b64_tr_b16 v[200:201], v8 offset:24576
  v_mfma_f32_16x16x32_bf16 v[148:151], v[168:171], v[244:247], v[148:151]
  ds_read_b64_tr_b16 v[202:203], v8 offset:25088
  v_mfma_f32_16x16x32_bf16 v[156:159], v[172:175], v[244:247], v[156:159]
  ds_read_b64_tr_b16 v[204:205], v9 offset:24576
  v_mfma_f32_16x16x32_bf16 v[152:155], v[172:175], v[240:243], v[152:155]
  ds_read_b64_tr_b16 v[206:207], v9 offset:25088
  s_waitcnt vmcnt(17) lgkmcnt(8)
  v_mfma_f32_16x16x32_bf16 v[128:131], v[176:179], v[248:251], v[128:131]
  buffer_load_dwordx4 v[228:231], off, s[64:67], s48 offset:0
  v_mfma_f32_16x16x32_bf16 v[132:135], v[176:179], v[252:255], v[132:135]
  ds_read_b64_tr_b16 v[208:209], v6 offset:28672
  ds_read_b64_tr_b16 v[210:211], v6 offset:29184
  v_mfma_f32_16x16x32_bf16 v[140:143], v[180:183], v[252:255], v[140:143]
  ds_read_b64_tr_b16 v[212:213], v7 offset:28672
  v_mfma_f32_16x16x32_bf16 v[136:139], v[180:183], v[248:251], v[136:139]
  ds_read_b64_tr_b16 v[214:215], v7 offset:29184
  v_mfma_f32_16x16x32_bf16 v[144:147], v[184:187], v[248:251], v[144:147]
  ds_read_b64_tr_b16 v[216:217], v8 offset:28672
  v_mfma_f32_16x16x32_bf16 v[148:151], v[184:187], v[252:255], v[148:151]
  ds_read_b64_tr_b16 v[218:219], v8 offset:29184
  v_mfma_f32_16x16x32_bf16 v[156:159], v[188:191], v[252:255], v[156:159]
  ds_read_b64_tr_b16 v[220:221], v9 offset:28672
  v_mfma_f32_16x16x32_bf16 v[152:155], v[188:191], v[248:251], v[152:155]
  ds_read_b64_tr_b16 v[222:223], v9 offset:29184
  s_waitcnt lgkmcnt(8)
  v_mfma_f32_16x16x32_bf16 v[96:99], v[192:195], v[240:243], v[96:99]
  buffer_load_dwordx4 v[232:235], off, s[36:39], s48 offset:1024
  v_mfma_f32_16x16x32_bf16 v[100:103], v[192:195], v[244:247], v[100:103]
  ds_read_b64_tr_b16 v[160:161], v6 offset:32768
  ds_read_b64_tr_b16 v[162:163], v6 offset:33280
  v_mfma_f32_16x16x32_bf16 v[108:111], v[196:199], v[244:247], v[108:111]
  ds_read_b64_tr_b16 v[164:165], v7 offset:32768
  v_mfma_f32_16x16x32_bf16 v[104:107], v[196:199], v[240:243], v[104:107]
  ds_read_b64_tr_b16 v[166:167], v7 offset:33280
  v_mfma_f32_16x16x32_bf16 v[112:115], v[200:203], v[240:243], v[112:115]
  ds_read_b64_tr_b16 v[168:169], v8 offset:32768
  v_mfma_f32_16x16x32_bf16 v[116:119], v[200:203], v[244:247], v[116:119]
  ds_read_b64_tr_b16 v[170:171], v8 offset:33280
  v_mfma_f32_16x16x32_bf16 v[124:127], v[204:207], v[244:247], v[124:127]
  ds_read_b64_tr_b16 v[172:173], v9 offset:32768
  v_mfma_f32_16x16x32_bf16 v[120:123], v[204:207], v[240:243], v[120:123]
  ds_read_b64_tr_b16 v[174:175], v9 offset:33280
  s_waitcnt lgkmcnt(8)
  s_barrier
  v_mfma_f32_16x16x32_bf16 v[96:99], v[208:211], v[248:251], v[96:99]
  buffer_load_dwordx4 v[236:239], off, s[64:67], s48 offset:1024
  v_mfma_f32_16x16x32_bf16 v[100:103], v[208:211], v[252:255], v[100:103]
  ds_read_b64_tr_b16 v[176:177], v6 offset:36864
  ds_read_b64_tr_b16 v[178:179], v6 offset:37376
  v_mfma_f32_16x16x32_bf16 v[108:111], v[212:215], v[252:255], v[108:111]
  ds_read_b64_tr_b16 v[180:181], v7 offset:36864
  v_mfma_f32_16x16x32_bf16 v[104:107], v[212:215], v[248:251], v[104:107]
  ds_read_b64_tr_b16 v[182:183], v7 offset:37376
  v_mfma_f32_16x16x32_bf16 v[112:115], v[216:219], v[248:251], v[112:115]
  ds_read_b64_tr_b16 v[184:185], v8 offset:36864
  v_mfma_f32_16x16x32_bf16 v[116:119], v[216:219], v[252:255], v[116:119]
  ds_read_b64_tr_b16 v[186:187], v8 offset:37376
  v_readlane_b32 s49, v15, 17
  v_mfma_f32_16x16x32_bf16 v[124:127], v[220:223], v[252:255], v[124:127]
  ds_read_b64_tr_b16 v[188:189], v9 offset:36864
  v_mfma_f32_16x16x32_bf16 v[120:123], v[220:223], v[248:251], v[120:123]
  ds_read_b64_tr_b16 v[190:191], v9 offset:37376
  s_waitcnt vmcnt(18) lgkmcnt(8)
  v_mfma_f32_16x16x32_bf16 v[128:131], v[160:163], v[32:35], v[128:131]
  buffer_load_dwordx4 v[240:243], off, s[36:39], s49 offset:0
  v_mfma_f32_16x16x32_bf16 v[132:135], v[160:163], v[36:39], v[132:135]
  ds_read_b64_tr_b16 v[192:193], v6 offset:40960
  ds_read_b64_tr_b16 v[194:195], v6 offset:41472
  v_mfma_f32_16x16x32_bf16 v[140:143], v[164:167], v[36:39], v[140:143]
  ds_read_b64_tr_b16 v[196:197], v7 offset:40960
  v_mfma_f32_16x16x32_bf16 v[136:139], v[164:167], v[32:35], v[136:139]
  ds_read_b64_tr_b16 v[198:199], v7 offset:41472
  v_mfma_f32_16x16x32_bf16 v[144:147], v[168:171], v[32:35], v[144:147]
  ds_read_b64_tr_b16 v[200:201], v8 offset:40960
  v_mfma_f32_16x16x32_bf16 v[148:151], v[168:171], v[36:39], v[148:151]
  ds_read_b64_tr_b16 v[202:203], v8 offset:41472
  v_mfma_f32_16x16x32_bf16 v[156:159], v[172:175], v[36:39], v[156:159]
  ds_read_b64_tr_b16 v[204:205], v9 offset:40960
  v_mfma_f32_16x16x32_bf16 v[152:155], v[172:175], v[32:35], v[152:155]
  ds_read_b64_tr_b16 v[206:207], v9 offset:41472
  s_waitcnt vmcnt(17) lgkmcnt(8)
  v_mfma_f32_16x16x32_bf16 v[128:131], v[176:179], v[40:43], v[128:131]
  buffer_load_dwordx4 v[244:247], off, s[64:67], s49 offset:0
  v_mfma_f32_16x16x32_bf16 v[132:135], v[176:179], v[44:47], v[132:135]
  ds_read_b64_tr_b16 v[208:209], v6 offset:45056
  ds_read_b64_tr_b16 v[210:211], v6 offset:45568
  v_mfma_f32_16x16x32_bf16 v[140:143], v[180:183], v[44:47], v[140:143]
  ds_read_b64_tr_b16 v[212:213], v7 offset:45056
  v_mfma_f32_16x16x32_bf16 v[136:139], v[180:183], v[40:43], v[136:139]
  ds_read_b64_tr_b16 v[214:215], v7 offset:45568
  v_mfma_f32_16x16x32_bf16 v[144:147], v[184:187], v[40:43], v[144:147]
  ds_read_b64_tr_b16 v[216:217], v8 offset:45056
  v_mfma_f32_16x16x32_bf16 v[148:151], v[184:187], v[44:47], v[148:151]
  ds_read_b64_tr_b16 v[218:219], v8 offset:45568
  v_mfma_f32_16x16x32_bf16 v[156:159], v[188:191], v[44:47], v[156:159]
  ds_read_b64_tr_b16 v[220:221], v9 offset:45056
  v_mfma_f32_16x16x32_bf16 v[152:155], v[188:191], v[40:43], v[152:155]
  ds_read_b64_tr_b16 v[222:223], v9 offset:45568
  s_waitcnt lgkmcnt(8)
  v_mfma_f32_16x16x32_bf16 v[96:99], v[192:195], v[32:35], v[96:99]
  buffer_load_dwordx4 v[248:251], off, s[36:39], s49 offset:1024
  v_mfma_f32_16x16x32_bf16 v[100:103], v[192:195], v[36:39], v[100:103]
  ds_read_b64_tr_b16 v[160:161], v6 offset:49152
  ds_read_b64_tr_b16 v[162:163], v6 offset:49664
  v_mfma_f32_16x16x32_bf16 v[108:111], v[196:199], v[36:39], v[108:111]
  ds_read_b64_tr_b16 v[164:165], v7 offset:49152
  v_mfma_f32_16x16x32_bf16 v[104:107], v[196:199], v[32:35], v[104:107]
  ds_read_b64_tr_b16 v[166:167], v7 offset:49664
  v_mfma_f32_16x16x32_bf16 v[112:115], v[200:203], v[32:35], v[112:115]
  ds_read_b64_tr_b16 v[168:169], v8 offset:49152
  v_mfma_f32_16x16x32_bf16 v[116:119], v[200:203], v[36:39], v[116:119]
  ds_read_b64_tr_b16 v[170:171], v8 offset:49664
  v_mfma_f32_16x16x32_bf16 v[124:127], v[204:207], v[36:39], v[124:127]
  ds_read_b64_tr_b16 v[172:173], v9 offset:49152
  v_mfma_f32_16x16x32_bf16 v[120:123], v[204:207], v[32:35], v[120:123]
  ds_read_b64_tr_b16 v[174:175], v9 offset:49664
  s_waitcnt lgkmcnt(8)
  v_mfma_f32_16x16x32_bf16 v[96:99], v[208:211], v[40:43], v[96:99]
  buffer_load_dwordx4 v[252:255], off, s[64:67], s49 offset:1024
  v_mfma_f32_16x16x32_bf16 v[100:103], v[208:211], v[44:47], v[100:103]
  ds_read_b64_tr_b16 v[176:177], v6 offset:53248
  ds_read_b64_tr_b16 v[178:179], v6 offset:53760
  v_mfma_f32_16x16x32_bf16 v[108:111], v[212:215], v[44:47], v[108:111]
  ds_read_b64_tr_b16 v[180:181], v7 offset:53248
  v_mfma_f32_16x16x32_bf16 v[104:107], v[212:215], v[40:43], v[104:107]
  ds_read_b64_tr_b16 v[182:183], v7 offset:53760
  v_mfma_f32_16x16x32_bf16 v[112:115], v[216:219], v[40:43], v[112:115]
  ds_read_b64_tr_b16 v[184:185], v8 offset:53248
  v_mfma_f32_16x16x32_bf16 v[116:119], v[216:219], v[44:47], v[116:119]
  ds_read_b64_tr_b16 v[186:187], v8 offset:53760
  v_readlane_b32 s50, v15, 18
  v_mfma_f32_16x16x32_bf16 v[124:127], v[220:223], v[44:47], v[124:127]
  ds_read_b64_tr_b16 v[188:189], v9 offset:53248
  v_mfma_f32_16x16x32_bf16 v[120:123], v[220:223], v[40:43], v[120:123]
  ds_read_b64_tr_b16 v[190:191], v9 offset:53760
  s_waitcnt vmcnt(18) lgkmcnt(8)
  v_mfma_f32_16x16x32_bf16 v[128:131], v[160:163], v[48:51], v[128:131]
  buffer_load_dwordx4 v[32:35], off, s[36:39], s50 offset:0
  v_mfma_f32_16x16x32_bf16 v[132:135], v[160:163], v[52:55], v[132:135]
  ds_read_b64_tr_b16 v[192:193], v6 offset:57344
  ds_read_b64_tr_b16 v[194:195], v6 offset:57856
  v_mfma_f32_16x16x32_bf16 v[140:143], v[164:167], v[52:55], v[140:143]
  ds_read_b64_tr_b16 v[196:197], v7 offset:57344
  v_mfma_f32_16x16x32_bf16 v[136:139], v[164:167], v[48:51], v[136:139]
  ds_read_b64_tr_b16 v[198:199], v7 offset:57856
  v_mfma_f32_16x16x32_bf16 v[144:147], v[168:171], v[48:51], v[144:147]
  ds_read_b64_tr_b16 v[200:201], v8 offset:57344
  v_mfma_f32_16x16x32_bf16 v[148:151], v[168:171], v[52:55], v[148:151]
  ds_read_b64_tr_b16 v[202:203], v8 offset:57856
  v_mfma_f32_16x16x32_bf16 v[156:159], v[172:175], v[52:55], v[156:159]
  ds_read_b64_tr_b16 v[204:205], v9 offset:57344
  v_mfma_f32_16x16x32_bf16 v[152:155], v[172:175], v[48:51], v[152:155]
  ds_read_b64_tr_b16 v[206:207], v9 offset:57856
  s_waitcnt vmcnt(17) lgkmcnt(8)
  v_mfma_f32_16x16x32_bf16 v[128:131], v[176:179], v[56:59], v[128:131]
  buffer_load_dwordx4 v[36:39], off, s[64:67], s50 offset:0
  v_mfma_f32_16x16x32_bf16 v[132:135], v[176:179], v[60:63], v[132:135]
  ds_read_b64_tr_b16 v[208:209], v6 offset:61440
  ds_read_b64_tr_b16 v[210:211], v6 offset:61952
  v_mfma_f32_16x16x32_bf16 v[140:143], v[180:183], v[60:63], v[140:143]
  ds_read_b64_tr_b16 v[212:213], v7 offset:61440
  v_mfma_f32_16x16x32_bf16 v[136:139], v[180:183], v[56:59], v[136:139]
  ds_read_b64_tr_b16 v[214:215], v7 offset:61952
  v_mfma_f32_16x16x32_bf16 v[144:147], v[184:187], v[56:59], v[144:147]
  ds_read_b64_tr_b16 v[216:217], v8 offset:61440
  v_mfma_f32_16x16x32_bf16 v[148:151], v[184:187], v[60:63], v[148:151]
  ds_read_b64_tr_b16 v[218:219], v8 offset:61952
  v_mfma_f32_16x16x32_bf16 v[156:159], v[188:191], v[60:63], v[156:159]
  ds_read_b64_tr_b16 v[220:221], v9 offset:61440
  v_mfma_f32_16x16x32_bf16 v[152:155], v[188:191], v[56:59], v[152:155]
  ds_read_b64_tr_b16 v[222:223], v9 offset:61952
  s_waitcnt lgkmcnt(8)
  v_mfma_f32_16x16x32_bf16 v[96:99], v[192:195], v[48:51], v[96:99]
  buffer_load_dwordx4 v[40:43], off, s[36:39], s50 offset:1024
  v_mfma_f32_16x16x32_bf16 v[100:103], v[192:195], v[52:55], v[100:103]
  ds_read_b64_tr_b16 v[160:161], v20 offset:0
  ds_read_b64_tr_b16 v[162:163], v20 offset:512
  v_mfma_f32_16x16x32_bf16 v[108:111], v[196:199], v[52:55], v[108:111]
  ds_read_b64_tr_b16 v[164:165], v21 offset:0
  v_mfma_f32_16x16x32_bf16 v[104:107], v[196:199], v[48:51], v[104:107]
  ds_read_b64_tr_b16 v[166:167], v21 offset:512
  v_mfma_f32_16x16x32_bf16 v[112:115], v[200:203], v[48:51], v[112:115]
  ds_read_b64_tr_b16 v[168:169], v22 offset:0
  v_mfma_f32_16x16x32_bf16 v[116:119], v[200:203], v[52:55], v[116:119]
  ds_read_b64_tr_b16 v[170:171], v22 offset:512
  v_mfma_f32_16x16x32_bf16 v[124:127], v[204:207], v[52:55], v[124:127]
  ds_read_b64_tr_b16 v[172:173], v23 offset:0
  v_mfma_f32_16x16x32_bf16 v[120:123], v[204:207], v[48:51], v[120:123]
  ds_read_b64_tr_b16 v[174:175], v23 offset:512
  s_waitcnt lgkmcnt(8)
  s_barrier
  v_mfma_f32_16x16x32_bf16 v[96:99], v[208:211], v[56:59], v[96:99]
  buffer_load_dwordx4 v[44:47], off, s[64:67], s50 offset:1024
  v_mfma_f32_16x16x32_bf16 v[100:103], v[208:211], v[60:63], v[100:103]
  ds_read_b64_tr_b16 v[176:177], v20 offset:4096
  ds_read_b64_tr_b16 v[178:179], v20 offset:4608
  v_mfma_f32_16x16x32_bf16 v[108:111], v[212:215], v[60:63], v[108:111]
  ds_read_b64_tr_b16 v[180:181], v21 offset:4096
  v_mfma_f32_16x16x32_bf16 v[104:107], v[212:215], v[56:59], v[104:107]
  ds_read_b64_tr_b16 v[182:183], v21 offset:4608
  v_mfma_f32_16x16x32_bf16 v[112:115], v[216:219], v[56:59], v[112:115]
  ds_read_b64_tr_b16 v[184:185], v22 offset:4096
  v_mfma_f32_16x16x32_bf16 v[116:119], v[216:219], v[60:63], v[116:119]
  ds_read_b64_tr_b16 v[186:187], v22 offset:4608
  v_readlane_b32 s51, v15, 19
  v_mfma_f32_16x16x32_bf16 v[124:127], v[220:223], v[60:63], v[124:127]
  ds_read_b64_tr_b16 v[188:189], v23 offset:4096
  v_mfma_f32_16x16x32_bf16 v[120:123], v[220:223], v[56:59], v[120:123]
  ds_read_b64_tr_b16 v[190:191], v23 offset:4608
  s_waitcnt vmcnt(18) lgkmcnt(8)
  v_mfma_f32_16x16x32_bf16 v[128:131], v[160:163], v[64:67], v[128:131]
  buffer_load_dwordx4 v[48:51], off, s[36:39], s51 offset:0
  v_mfma_f32_16x16x32_bf16 v[132:135], v[160:163], v[68:71], v[132:135]
  ds_read_b64_tr_b16 v[192:193], v20 offset:8192
  ds_read_b64_tr_b16 v[194:195], v20 offset:8704
  v_mfma_f32_16x16x32_bf16 v[140:143], v[164:167], v[68:71], v[140:143]
  ds_read_b64_tr_b16 v[196:197], v21 offset:8192
  v_mfma_f32_16x16x32_bf16 v[136:139], v[164:167], v[64:67], v[136:139]
  ds_read_b64_tr_b16 v[198:199], v21 offset:8704
  v_mfma_f32_16x16x32_bf16 v[144:147], v[168:171], v[64:67], v[144:147]
  ds_read_b64_tr_b16 v[200:201], v22 offset:8192
  v_mfma_f32_16x16x32_bf16 v[148:151], v[168:171], v[68:71], v[148:151]
  ds_read_b64_tr_b16 v[202:203], v22 offset:8704
  v_mfma_f32_16x16x32_bf16 v[156:159], v[172:175], v[68:71], v[156:159]
  ds_read_b64_tr_b16 v[204:205], v23 offset:8192
  v_mfma_f32_16x16x32_bf16 v[152:155], v[172:175], v[64:67], v[152:155]
  ds_read_b64_tr_b16 v[206:207], v23 offset:8704
  s_waitcnt vmcnt(17) lgkmcnt(8)
  v_mfma_f32_16x16x32_bf16 v[128:131], v[176:179], v[72:75], v[128:131]
  buffer_load_dwordx4 v[52:55], off, s[64:67], s51 offset:0
  v_mfma_f32_16x16x32_bf16 v[132:135], v[176:179], v[76:79], v[132:135]
  ds_read_b64_tr_b16 v[208:209], v20 offset:12288
  ds_read_b64_tr_b16 v[210:211], v20 offset:12800
  v_mfma_f32_16x16x32_bf16 v[140:143], v[180:183], v[76:79], v[140:143]
  ds_read_b64_tr_b16 v[212:213], v21 offset:12288
  v_mfma_f32_16x16x32_bf16 v[136:139], v[180:183], v[72:75], v[136:139]
  ds_read_b64_tr_b16 v[214:215], v21 offset:12800
  v_mfma_f32_16x16x32_bf16 v[144:147], v[184:187], v[72:75], v[144:147]
  ds_read_b64_tr_b16 v[216:217], v22 offset:12288
  v_mfma_f32_16x16x32_bf16 v[148:151], v[184:187], v[76:79], v[148:151]
  ds_read_b64_tr_b16 v[218:219], v22 offset:12800
  v_mfma_f32_16x16x32_bf16 v[156:159], v[188:191], v[76:79], v[156:159]
  ds_read_b64_tr_b16 v[220:221], v23 offset:12288
  v_mfma_f32_16x16x32_bf16 v[152:155], v[188:191], v[72:75], v[152:155]
  ds_read_b64_tr_b16 v[222:223], v23 offset:12800
  s_waitcnt lgkmcnt(8)
  v_mfma_f32_16x16x32_bf16 v[96:99], v[192:195], v[64:67], v[96:99]
  buffer_load_dwordx4 v[56:59], off, s[36:39], s51 offset:1024
  v_mfma_f32_16x16x32_bf16 v[100:103], v[192:195], v[68:71], v[100:103]
  ds_read_b64_tr_b16 v[160:161], v20 offset:16384
  ds_read_b64_tr_b16 v[162:163], v20 offset:16896
  v_mfma_f32_16x16x32_bf16 v[108:111], v[196:199], v[68:71], v[108:111]
  ds_read_b64_tr_b16 v[164:165], v21 offset:16384
  v_mfma_f32_16x16x32_bf16 v[104:107], v[196:199], v[64:67], v[104:107]
  ds_read_b64_tr_b16 v[166:167], v21 offset:16896
  v_mfma_f32_16x16x32_bf16 v[112:115], v[200:203], v[64:67], v[112:115]
  ds_read_b64_tr_b16 v[168:169], v22 offset:16384
  v_mfma_f32_16x16x32_bf16 v[116:119], v[200:203], v[68:71], v[116:119]
  ds_read_b64_tr_b16 v[170:171], v22 offset:16896
  v_mfma_f32_16x16x32_bf16 v[124:127], v[204:207], v[68:71], v[124:127]
  ds_read_b64_tr_b16 v[172:173], v23 offset:16384
  v_mfma_f32_16x16x32_bf16 v[120:123], v[204:207], v[64:67], v[120:123]
  ds_read_b64_tr_b16 v[174:175], v23 offset:16896
  s_waitcnt lgkmcnt(8)
  v_mfma_f32_16x16x32_bf16 v[96:99], v[208:211], v[72:75], v[96:99]
  buffer_load_dwordx4 v[60:63], off, s[64:67], s51 offset:1024
  v_mfma_f32_16x16x32_bf16 v[100:103], v[208:211], v[76:79], v[100:103]
  ds_read_b64_tr_b16 v[176:177], v20 offset:20480
  ds_read_b64_tr_b16 v[178:179], v20 offset:20992
  v_mfma_f32_16x16x32_bf16 v[108:111], v[212:215], v[76:79], v[108:111]
  ds_read_b64_tr_b16 v[180:181], v21 offset:20480
  v_mfma_f32_16x16x32_bf16 v[104:107], v[212:215], v[72:75], v[104:107]
  ds_read_b64_tr_b16 v[182:183], v21 offset:20992
  v_mfma_f32_16x16x32_bf16 v[112:115], v[216:219], v[72:75], v[112:115]
  ds_read_b64_tr_b16 v[184:185], v22 offset:20480
  v_mfma_f32_16x16x32_bf16 v[116:119], v[216:219], v[76:79], v[116:119]
  ds_read_b64_tr_b16 v[186:187], v22 offset:20992
  v_readlane_b32 s48, v15, 20
  v_mfma_f32_16x16x32_bf16 v[124:127], v[220:223], v[76:79], v[124:127]
  ds_read_b64_tr_b16 v[188:189], v23 offset:20480
  v_mfma_f32_16x16x32_bf16 v[120:123], v[220:223], v[72:75], v[120:123]
  ds_read_b64_tr_b16 v[190:191], v23 offset:20992
  s_waitcnt vmcnt(18) lgkmcnt(8)
  v_mfma_f32_16x16x32_bf16 v[128:131], v[160:163], v[80:83], v[128:131]
  buffer_load_dwordx4 v[64:67], off, s[36:39], s48 offset:0
  v_mfma_f32_16x16x32_bf16 v[132:135], v[160:163], v[84:87], v[132:135]
  ds_read_b64_tr_b16 v[192:193], v20 offset:24576
  ds_read_b64_tr_b16 v[194:195], v20 offset:25088
  v_mfma_f32_16x16x32_bf16 v[140:143], v[164:167], v[84:87], v[140:143]
  ds_read_b64_tr_b16 v[196:197], v21 offset:24576
  v_mfma_f32_16x16x32_bf16 v[136:139], v[164:167], v[80:83], v[136:139]
  ds_read_b64_tr_b16 v[198:199], v21 offset:25088
  v_mfma_f32_16x16x32_bf16 v[144:147], v[168:171], v[80:83], v[144:147]
  ds_read_b64_tr_b16 v[200:201], v22 offset:24576
  v_mfma_f32_16x16x32_bf16 v[148:151], v[168:171], v[84:87], v[148:151]
  ds_read_b64_tr_b16 v[202:203], v22 offset:25088
  v_mfma_f32_16x16x32_bf16 v[156:159], v[172:175], v[84:87], v[156:159]
  ds_read_b64_tr_b16 v[204:205], v23 offset:24576
  v_mfma_f32_16x16x32_bf16 v[152:155], v[172:175], v[80:83], v[152:155]
  ds_read_b64_tr_b16 v[206:207], v23 offset:25088
  s_waitcnt vmcnt(17) lgkmcnt(8)
  v_mfma_f32_16x16x32_bf16 v[128:131], v[176:179], v[88:91], v[128:131]
  buffer_load_dwordx4 v[68:71], off, s[64:67], s48 offset:0
  v_mfma_f32_16x16x32_bf16 v[132:135], v[176:179], v[92:95], v[132:135]
  ds_read_b64_tr_b16 v[208:209], v20 offset:28672
  ds_read_b64_tr_b16 v[210:211], v20 offset:29184
  v_mfma_f32_16x16x32_bf16 v[140:143], v[180:183], v[92:95], v[140:143]
  ds_read_b64_tr_b16 v[212:213], v21 offset:28672
  v_mfma_f32_16x16x32_bf16 v[136:139], v[180:183], v[88:91], v[136:139]
  ds_read_b64_tr_b16 v[214:215], v21 offset:29184
  v_mfma_f32_16x16x32_bf16 v[144:147], v[184:187], v[88:91], v[144:147]
  ds_read_b64_tr_b16 v[216:217], v22 offset:28672
  v_mfma_f32_16x16x32_bf16 v[148:151], v[184:187], v[92:95], v[148:151]
  ds_read_b64_tr_b16 v[218:219], v22 offset:29184
  v_mfma_f32_16x16x32_bf16 v[156:159], v[188:191], v[92:95], v[156:159]
  ds_read_b64_tr_b16 v[220:221], v23 offset:28672
  v_mfma_f32_16x16x32_bf16 v[152:155], v[188:191], v[88:91], v[152:155]
  ds_read_b64_tr_b16 v[222:223], v23 offset:29184
  s_waitcnt lgkmcnt(8)
  v_mfma_f32_16x16x32_bf16 v[96:99], v[192:195], v[80:83], v[96:99]
  buffer_load_dwordx4 v[72:75], off, s[36:39], s48 offset:1024
  v_mfma_f32_16x16x32_bf16 v[100:103], v[192:195], v[84:87], v[100:103]
  ds_read_b64_tr_b16 v[160:161], v20 offset:32768
  ds_read_b64_tr_b16 v[162:163], v20 offset:33280
  v_mfma_f32_16x16x32_bf16 v[108:111], v[196:199], v[84:87], v[108:111]
  ds_read_b64_tr_b16 v[164:165], v21 offset:32768
  v_mfma_f32_16x16x32_bf16 v[104:107], v[196:199], v[80:83], v[104:107]
  ds_read_b64_tr_b16 v[166:167], v21 offset:33280
  v_mfma_f32_16x16x32_bf16 v[112:115], v[200:203], v[80:83], v[112:115]
  ds_read_b64_tr_b16 v[168:169], v22 offset:32768
  v_mfma_f32_16x16x32_bf16 v[116:119], v[200:203], v[84:87], v[116:119]
  ds_read_b64_tr_b16 v[170:171], v22 offset:33280
  v_mfma_f32_16x16x32_bf16 v[124:127], v[204:207], v[84:87], v[124:127]
  ds_read_b64_tr_b16 v[172:173], v23 offset:32768
  v_mfma_f32_16x16x32_bf16 v[120:123], v[204:207], v[80:83], v[120:123]
  ds_read_b64_tr_b16 v[174:175], v23 offset:33280
  s_waitcnt lgkmcnt(8)
  s_barrier
  v_mfma_f32_16x16x32_bf16 v[96:99], v[208:211], v[88:91], v[96:99]
  buffer_load_dwordx4 v[76:79], off, s[64:67], s48 offset:1024
  v_mfma_f32_16x16x32_bf16 v[100:103], v[208:211], v[92:95], v[100:103]
  ds_read_b64_tr_b16 v[176:177], v20 offset:36864
  ds_read_b64_tr_b16 v[178:179], v20 offset:37376
  v_mfma_f32_16x16x32_bf16 v[108:111], v[212:215], v[92:95], v[108:111]
  ds_read_b64_tr_b16 v[180:181], v21 offset:36864
  v_mfma_f32_16x16x32_bf16 v[104:107], v[212:215], v[88:91], v[104:107]
  ds_read_b64_tr_b16 v[182:183], v21 offset:37376
  v_mfma_f32_16x16x32_bf16 v[112:115], v[216:219], v[88:91], v[112:115]
  ds_read_b64_tr_b16 v[184:185], v22 offset:36864
  v_mfma_f32_16x16x32_bf16 v[116:119], v[216:219], v[92:95], v[116:119]
  ds_read_b64_tr_b16 v[186:187], v22 offset:37376
  v_readlane_b32 s49, v15, 21
  v_mfma_f32_16x16x32_bf16 v[124:127], v[220:223], v[92:95], v[124:127]
  ds_read_b64_tr_b16 v[188:189], v23 offset:36864
  v_mfma_f32_16x16x32_bf16 v[120:123], v[220:223], v[88:91], v[120:123]
  ds_read_b64_tr_b16 v[190:191], v23 offset:37376
  s_waitcnt vmcnt(18) lgkmcnt(8)
  v_mfma_f32_16x16x32_bf16 v[128:131], v[160:163], v[224:227], v[128:131]
  buffer_load_dwordx4 v[80:83], off, s[36:39], s49 offset:0
  v_mfma_f32_16x16x32_bf16 v[132:135], v[160:163], v[228:231], v[132:135]
  ds_read_b64_tr_b16 v[192:193], v20 offset:40960
  ds_read_b64_tr_b16 v[194:195], v20 offset:41472
  v_mfma_f32_16x16x32_bf16 v[140:143], v[164:167], v[228:231], v[140:143]
  ds_read_b64_tr_b16 v[196:197], v21 offset:40960
  v_mfma_f32_16x16x32_bf16 v[136:139], v[164:167], v[224:227], v[136:139]
  ds_read_b64_tr_b16 v[198:199], v21 offset:41472
  v_mfma_f32_16x16x32_bf16 v[144:147], v[168:171], v[224:227], v[144:147]
  ds_read_b64_tr_b16 v[200:201], v22 offset:40960
  v_mfma_f32_16x16x32_bf16 v[148:151], v[168:171], v[228:231], v[148:151]
  ds_read_b64_tr_b16 v[202:203], v22 offset:41472
  v_mfma_f32_16x16x32_bf16 v[156:159], v[172:175], v[228:231], v[156:159]
  ds_read_b64_tr_b16 v[204:205], v23 offset:40960
  v_mfma_f32_16x16x32_bf16 v[152:155], v[172:175], v[224:227], v[152:155]
  ds_read_b64_tr_b16 v[206:207], v23 offset:41472
  s_waitcnt vmcnt(17) lgkmcnt(8)
  v_mfma_f32_16x16x32_bf16 v[128:131], v[176:179], v[232:235], v[128:131]
  buffer_load_dwordx4 v[84:87], off, s[64:67], s49 offset:0
  v_mfma_f32_16x16x32_bf16 v[132:135], v[176:179], v[236:239], v[132:135]
  ds_read_b64_tr_b16 v[208:209], v20 offset:45056
  ds_read_b64_tr_b16 v[210:211], v20 offset:45568
  v_mfma_f32_16x16x32_bf16 v[140:143], v[180:183], v[236:239], v[140:143]
  ds_read_b64_tr_b16 v[212:213], v21 offset:45056
  v_mfma_f32_16x16x32_bf16 v[136:139], v[180:183], v[232:235], v[136:139]
  ds_read_b64_tr_b16 v[214:215], v21 offset:45568
  v_mfma_f32_16x16x32_bf16 v[144:147], v[184:187], v[232:235], v[144:147]
  ds_read_b64_tr_b16 v[216:217], v22 offset:45056
  v_mfma_f32_16x16x32_bf16 v[148:151], v[184:187], v[236:239], v[148:151]
  ds_read_b64_tr_b16 v[218:219], v22 offset:45568
  v_mfma_f32_16x16x32_bf16 v[156:159], v[188:191], v[236:239], v[156:159]
  ds_read_b64_tr_b16 v[220:221], v23 offset:45056
  v_mfma_f32_16x16x32_bf16 v[152:155], v[188:191], v[232:235], v[152:155]
  ds_read_b64_tr_b16 v[222:223], v23 offset:45568
  s_waitcnt lgkmcnt(8)
  v_mfma_f32_16x16x32_bf16 v[96:99], v[192:195], v[224:227], v[96:99]
  buffer_load_dwordx4 v[88:91], off, s[36:39], s49 offset:1024
  v_mfma_f32_16x16x32_bf16 v[100:103], v[192:195], v[228:231], v[100:103]
  ds_read_b64_tr_b16 v[160:161], v20 offset:49152
  ds_read_b64_tr_b16 v[162:163], v20 offset:49664
  v_mfma_f32_16x16x32_bf16 v[108:111], v[196:199], v[228:231], v[108:111]
  ds_read_b64_tr_b16 v[164:165], v21 offset:49152
  v_mfma_f32_16x16x32_bf16 v[104:107], v[196:199], v[224:227], v[104:107]
  ds_read_b64_tr_b16 v[166:167], v21 offset:49664
  v_mfma_f32_16x16x32_bf16 v[112:115], v[200:203], v[224:227], v[112:115]
  ds_read_b64_tr_b16 v[168:169], v22 offset:49152
  v_mfma_f32_16x16x32_bf16 v[116:119], v[200:203], v[228:231], v[116:119]
  ds_read_b64_tr_b16 v[170:171], v22 offset:49664
  v_mfma_f32_16x16x32_bf16 v[124:127], v[204:207], v[228:231], v[124:127]
  ds_read_b64_tr_b16 v[172:173], v23 offset:49152
  v_mfma_f32_16x16x32_bf16 v[120:123], v[204:207], v[224:227], v[120:123]
  ds_read_b64_tr_b16 v[174:175], v23 offset:49664
  s_waitcnt lgkmcnt(8)
  v_mfma_f32_16x16x32_bf16 v[96:99], v[208:211], v[232:235], v[96:99]
  buffer_load_dwordx4 v[92:95], off, s[64:67], s49 offset:1024
  v_mfma_f32_16x16x32_bf16 v[100:103], v[208:211], v[236:239], v[100:103]
  ds_read_b64_tr_b16 v[176:177], v20 offset:53248
  ds_read_b64_tr_b16 v[178:179], v20 offset:53760
  v_mfma_f32_16x16x32_bf16 v[108:111], v[212:215], v[236:239], v[108:111]
  ds_read_b64_tr_b16 v[180:181], v21 offset:53248
  v_mfma_f32_16x16x32_bf16 v[104:107], v[212:215], v[232:235], v[104:107]
  ds_read_b64_tr_b16 v[182:183], v21 offset:53760
  v_mfma_f32_16x16x32_bf16 v[112:115], v[216:219], v[232:235], v[112:115]
  ds_read_b64_tr_b16 v[184:185], v22 offset:53248
  v_mfma_f32_16x16x32_bf16 v[116:119], v[216:219], v[236:239], v[116:119]
  ds_read_b64_tr_b16 v[186:187], v22 offset:53760
  v_readlane_b32 s50, v15, 22
  v_mfma_f32_16x16x32_bf16 v[124:127], v[220:223], v[236:239], v[124:127]
  ds_read_b64_tr_b16 v[188:189], v23 offset:53248
  v_mfma_f32_16x16x32_bf16 v[120:123], v[220:223], v[232:235], v[120:123]
  ds_read_b64_tr_b16 v[190:191], v23 offset:53760
  s_waitcnt vmcnt(18) lgkmcnt(8)
  v_mfma_f32_16x16x32_bf16 v[128:131], v[160:163], v[240:243], v[128:131]
  buffer_load_dwordx4 v[224:227], off, s[36:39], s50 offset:0
  v_mfma_f32_16x16x32_bf16 v[132:135], v[160:163], v[244:247], v[132:135]
  ds_read_b64_tr_b16 v[192:193], v20 offset:57344
  ds_read_b64_tr_b16 v[194:195], v20 offset:57856
  v_mfma_f32_16x16x32_bf16 v[140:143], v[164:167], v[244:247], v[140:143]
  ds_read_b64_tr_b16 v[196:197], v21 offset:57344
  v_mfma_f32_16x16x32_bf16 v[136:139], v[164:167], v[240:243], v[136:139]
  ds_read_b64_tr_b16 v[198:199], v21 offset:57856
  v_mfma_f32_16x16x32_bf16 v[144:147], v[168:171], v[240:243], v[144:147]
  ds_read_b64_tr_b16 v[200:201], v22 offset:57344
  v_mfma_f32_16x16x32_bf16 v[148:151], v[168:171], v[244:247], v[148:151]
  ds_read_b64_tr_b16 v[202:203], v22 offset:57856
  v_mfma_f32_16x16x32_bf16 v[156:159], v[172:175], v[244:247], v[156:159]
  ds_read_b64_tr_b16 v[204:205], v23 offset:57344
  v_mfma_f32_16x16x32_bf16 v[152:155], v[172:175], v[240:243], v[152:155]
  ds_read_b64_tr_b16 v[206:207], v23 offset:57856
  s_waitcnt vmcnt(17) lgkmcnt(8)
  v_mfma_f32_16x16x32_bf16 v[128:131], v[176:179], v[248:251], v[128:131]
  buffer_load_dwordx4 v[228:231], off, s[64:67], s50 offset:0
  v_mfma_f32_16x16x32_bf16 v[132:135], v[176:179], v[252:255], v[132:135]
  ds_read_b64_tr_b16 v[208:209], v20 offset:61440
  ds_read_b64_tr_b16 v[210:211], v20 offset:61952
  v_mfma_f32_16x16x32_bf16 v[140:143], v[180:183], v[252:255], v[140:143]
  ds_read_b64_tr_b16 v[212:213], v21 offset:61440
  v_mfma_f32_16x16x32_bf16 v[136:139], v[180:183], v[248:251], v[136:139]
  ds_read_b64_tr_b16 v[214:215], v21 offset:61952
  v_mfma_f32_16x16x32_bf16 v[144:147], v[184:187], v[248:251], v[144:147]
  ds_read_b64_tr_b16 v[216:217], v22 offset:61440
  v_mfma_f32_16x16x32_bf16 v[148:151], v[184:187], v[252:255], v[148:151]
  ds_read_b64_tr_b16 v[218:219], v22 offset:61952
  v_mfma_f32_16x16x32_bf16 v[156:159], v[188:191], v[252:255], v[156:159]
  ds_read_b64_tr_b16 v[220:221], v23 offset:61440
  v_mfma_f32_16x16x32_bf16 v[152:155], v[188:191], v[248:251], v[152:155]
  ds_read_b64_tr_b16 v[222:223], v23 offset:61952
  s_waitcnt lgkmcnt(8)
  v_mfma_f32_16x16x32_bf16 v[96:99], v[192:195], v[240:243], v[96:99]
  buffer_load_dwordx4 v[232:235], off, s[36:39], s50 offset:1024
  v_mfma_f32_16x16x32_bf16 v[100:103], v[192:195], v[244:247], v[100:103]
  ds_read_b64_tr_b16 v[160:161], v26 offset:0
  ds_read_b64_tr_b16 v[162:163], v26 offset:512
  v_mfma_f32_16x16x32_bf16 v[108:111], v[196:199], v[244:247], v[108:111]
  ds_read_b64_tr_b16 v[164:165], v27 offset:0
  v_mfma_f32_16x16x32_bf16 v[104:107], v[196:199], v[240:243], v[104:107]
  ds_read_b64_tr_b16 v[166:167], v27 offset:512
  v_mfma_f32_16x16x32_bf16 v[112:115], v[200:203], v[240:243], v[112:115]
  ds_read_b64_tr_b16 v[168:169], v28 offset:0
  v_mfma_f32_16x16x32_bf16 v[116:119], v[200:203], v[244:247], v[116:119]
  ds_read_b64_tr_b16 v[170:171], v28 offset:512
  v_mfma_f32_16x16x32_bf16 v[124:127], v[204:207], v[244:247], v[124:127]
  ds_read_b64_tr_b16 v[172:173], v29 offset:0
  v_mfma_f32_16x16x32_bf16 v[120:123], v[204:207], v[240:243], v[120:123]
  ds_read_b64_tr_b16 v[174:175], v29 offset:512
  s_waitcnt lgkmcnt(8)
  s_barrier
  v_mfma_f32_16x16x32_bf16 v[96:99], v[208:211], v[248:251], v[96:99]
  buffer_load_dwordx4 v[236:239], off, s[64:67], s50 offset:1024
  v_mfma_f32_16x16x32_bf16 v[100:103], v[208:211], v[252:255], v[100:103]
  ds_read_b64_tr_b16 v[176:177], v26 offset:4096
  ds_read_b64_tr_b16 v[178:179], v26 offset:4608
  v_mfma_f32_16x16x32_bf16 v[108:111], v[212:215], v[252:255], v[108:111]
  ds_read_b64_tr_b16 v[180:181], v27 offset:4096
  v_mfma_f32_16x16x32_bf16 v[104:107], v[212:215], v[248:251], v[104:107]
  ds_read_b64_tr_b16 v[182:183], v27 offset:4608
  v_mfma_f32_16x16x32_bf16 v[112:115], v[216:219], v[248:251], v[112:115]
  ds_read_b64_tr_b16 v[184:185], v28 offset:4096
  v_mfma_f32_16x16x32_bf16 v[116:119], v[216:219], v[252:255], v[116:119]
  ds_read_b64_tr_b16 v[186:187], v28 offset:4608
  v_readlane_b32 s51, v15, 23
  v_mfma_f32_16x16x32_bf16 v[124:127], v[220:223], v[252:255], v[124:127]
  ds_read_b64_tr_b16 v[188:189], v29 offset:4096
  v_mfma_f32_16x16x32_bf16 v[120:123], v[220:223], v[248:251], v[120:123]
  ds_read_b64_tr_b16 v[190:191], v29 offset:4608
  s_waitcnt vmcnt(18) lgkmcnt(8)
  v_mfma_f32_16x16x32_bf16 v[128:131], v[160:163], v[32:35], v[128:131]
  buffer_load_dwordx4 v[240:243], off, s[36:39], s51 offset:0
  v_mfma_f32_16x16x32_bf16 v[132:135], v[160:163], v[36:39], v[132:135]
  ds_read_b64_tr_b16 v[192:193], v26 offset:8192
  ds_read_b64_tr_b16 v[194:195], v26 offset:8704
  v_mfma_f32_16x16x32_bf16 v[140:143], v[164:167], v[36:39], v[140:143]
  ds_read_b64_tr_b16 v[196:197], v27 offset:8192
  v_mfma_f32_16x16x32_bf16 v[136:139], v[164:167], v[32:35], v[136:139]
  ds_read_b64_tr_b16 v[198:199], v27 offset:8704
  v_mfma_f32_16x16x32_bf16 v[144:147], v[168:171], v[32:35], v[144:147]
  ds_read_b64_tr_b16 v[200:201], v28 offset:8192
  v_mfma_f32_16x16x32_bf16 v[148:151], v[168:171], v[36:39], v[148:151]
  ds_read_b64_tr_b16 v[202:203], v28 offset:8704
  v_mfma_f32_16x16x32_bf16 v[156:159], v[172:175], v[36:39], v[156:159]
  ds_read_b64_tr_b16 v[204:205], v29 offset:8192
  v_mfma_f32_16x16x32_bf16 v[152:155], v[172:175], v[32:35], v[152:155]
  ds_read_b64_tr_b16 v[206:207], v29 offset:8704
  s_waitcnt vmcnt(17) lgkmcnt(8)
  v_mfma_f32_16x16x32_bf16 v[128:131], v[176:179], v[40:43], v[128:131]
  buffer_load_dwordx4 v[244:247], off, s[64:67], s51 offset:0
  v_mfma_f32_16x16x32_bf16 v[132:135], v[176:179], v[44:47], v[132:135]
  ds_read_b64_tr_b16 v[208:209], v26 offset:12288
  ds_read_b64_tr_b16 v[210:211], v26 offset:12800
  v_mfma_f32_16x16x32_bf16 v[140:143], v[180:183], v[44:47], v[140:143]
  ds_read_b64_tr_b16 v[212:213], v27 offset:12288
  v_mfma_f32_16x16x32_bf16 v[136:139], v[180:183], v[40:43], v[136:139]
  ds_read_b64_tr_b16 v[214:215], v27 offset:12800
  v_mfma_f32_16x16x32_bf16 v[144:147], v[184:187], v[40:43], v[144:147]
  ds_read_b64_tr_b16 v[216:217], v28 offset:12288
  v_mfma_f32_16x16x32_bf16 v[148:151], v[184:187], v[44:47], v[148:151]
  ds_read_b64_tr_b16 v[218:219], v28 offset:12800
  v_mfma_f32_16x16x32_bf16 v[156:159], v[188:191], v[44:47], v[156:159]
  ds_read_b64_tr_b16 v[220:221], v29 offset:12288
  v_mfma_f32_16x16x32_bf16 v[152:155], v[188:191], v[40:43], v[152:155]
  ds_read_b64_tr_b16 v[222:223], v29 offset:12800
  s_waitcnt lgkmcnt(8)
  v_mfma_f32_16x16x32_bf16 v[96:99], v[192:195], v[32:35], v[96:99]
  buffer_load_dwordx4 v[248:251], off, s[36:39], s51 offset:1024
  v_mfma_f32_16x16x32_bf16 v[100:103], v[192:195], v[36:39], v[100:103]
  ds_read_b64_tr_b16 v[160:161], v26 offset:16384
  ds_read_b64_tr_b16 v[162:163], v26 offset:16896
  v_mfma_f32_16x16x32_bf16 v[108:111], v[196:199], v[36:39], v[108:111]
  ds_read_b64_tr_b16 v[164:165], v27 offset:16384
  v_mfma_f32_16x16x32_bf16 v[104:107], v[196:199], v[32:35], v[104:107]
  ds_read_b64_tr_b16 v[166:167], v27 offset:16896
  v_mfma_f32_16x16x32_bf16 v[112:115], v[200:203], v[32:35], v[112:115]
  ds_read_b64_tr_b16 v[168:169], v28 offset:16384
  v_mfma_f32_16x16x32_bf16 v[116:119], v[200:203], v[36:39], v[116:119]
  ds_read_b64_tr_b16 v[170:171], v28 offset:16896
  v_mfma_f32_16x16x32_bf16 v[124:127], v[204:207], v[36:39], v[124:127]
  ds_read_b64_tr_b16 v[172:173], v29 offset:16384
  v_mfma_f32_16x16x32_bf16 v[120:123], v[204:207], v[32:35], v[120:123]
  ds_read_b64_tr_b16 v[174:175], v29 offset:16896
  s_waitcnt lgkmcnt(8)
  v_mfma_f32_16x16x32_bf16 v[96:99], v[208:211], v[40:43], v[96:99]
  buffer_load_dwordx4 v[252:255], off, s[64:67], s51 offset:1024
  v_mfma_f32_16x16x32_bf16 v[100:103], v[208:211], v[44:47], v[100:103]
  ds_read_b64_tr_b16 v[176:177], v26 offset:20480
  ds_read_b64_tr_b16 v[178:179], v26 offset:20992
  v_mfma_f32_16x16x32_bf16 v[108:111], v[212:215], v[44:47], v[108:111]
  ds_read_b64_tr_b16 v[180:181], v27 offset:20480
  v_mfma_f32_16x16x32_bf16 v[104:107], v[212:215], v[40:43], v[104:107]
  ds_read_b64_tr_b16 v[182:183], v27 offset:20992
  v_mfma_f32_16x16x32_bf16 v[112:115], v[216:219], v[40:43], v[112:115]
  ds_read_b64_tr_b16 v[184:185], v28 offset:20480
  v_mfma_f32_16x16x32_bf16 v[116:119], v[216:219], v[44:47], v[116:119]
  ds_read_b64_tr_b16 v[186:187], v28 offset:20992
  v_readlane_b32 s48, v15, 24
  v_mfma_f32_16x16x32_bf16 v[124:127], v[220:223], v[44:47], v[124:127]
  ds_read_b64_tr_b16 v[188:189], v29 offset:20480
  v_mfma_f32_16x16x32_bf16 v[120:123], v[220:223], v[40:43], v[120:123]
  ds_read_b64_tr_b16 v[190:191], v29 offset:20992
  s_waitcnt vmcnt(18) lgkmcnt(8)
  v_mfma_f32_16x16x32_bf16 v[128:131], v[160:163], v[48:51], v[128:131]
  buffer_load_dwordx4 v[32:35], off, s[36:39], s48 offset:0
  v_mfma_f32_16x16x32_bf16 v[132:135], v[160:163], v[52:55], v[132:135]
  ds_read_b64_tr_b16 v[192:193], v26 offset:24576
  ds_read_b64_tr_b16 v[194:195], v26 offset:25088
  v_mfma_f32_16x16x32_bf16 v[140:143], v[164:167], v[52:55], v[140:143]
  ds_read_b64_tr_b16 v[196:197], v27 offset:24576
  v_mfma_f32_16x16x32_bf16 v[136:139], v[164:167], v[48:51], v[136:139]
  ds_read_b64_tr_b16 v[198:199], v27 offset:25088
  v_mfma_f32_16x16x32_bf16 v[144:147], v[168:171], v[48:51], v[144:147]
  ds_read_b64_tr_b16 v[200:201], v28 offset:24576
  v_mfma_f32_16x16x32_bf16 v[148:151], v[168:171], v[52:55], v[148:151]
  ds_read_b64_tr_b16 v[202:203], v28 offset:25088
  v_mfma_f32_16x16x32_bf16 v[156:159], v[172:175], v[52:55], v[156:159]
  ds_read_b64_tr_b16 v[204:205], v29 offset:24576
  v_mfma_f32_16x16x32_bf16 v[152:155], v[172:175], v[48:51], v[152:155]
  ds_read_b64_tr_b16 v[206:207], v29 offset:25088
  s_waitcnt vmcnt(17) lgkmcnt(8)
  v_mfma_f32_16x16x32_bf16 v[128:131], v[176:179], v[56:59], v[128:131]
  buffer_load_dwordx4 v[36:39], off, s[64:67], s48 offset:0
  v_mfma_f32_16x16x32_bf16 v[132:135], v[176:179], v[60:63], v[132:135]
  ds_read_b64_tr_b16 v[208:209], v26 offset:28672
  ds_read_b64_tr_b16 v[210:211], v26 offset:29184
  v_mfma_f32_16x16x32_bf16 v[140:143], v[180:183], v[60:63], v[140:143]
  ds_read_b64_tr_b16 v[212:213], v27 offset:28672
  v_mfma_f32_16x16x32_bf16 v[136:139], v[180:183], v[56:59], v[136:139]
  ds_read_b64_tr_b16 v[214:215], v27 offset:29184
  v_mfma_f32_16x16x32_bf16 v[144:147], v[184:187], v[56:59], v[144:147]
  ds_read_b64_tr_b16 v[216:217], v28 offset:28672
  v_mfma_f32_16x16x32_bf16 v[148:151], v[184:187], v[60:63], v[148:151]
  ds_read_b64_tr_b16 v[218:219], v28 offset:29184
  v_mfma_f32_16x16x32_bf16 v[156:159], v[188:191], v[60:63], v[156:159]
  ds_read_b64_tr_b16 v[220:221], v29 offset:28672
  v_mfma_f32_16x16x32_bf16 v[152:155], v[188:191], v[56:59], v[152:155]
  ds_read_b64_tr_b16 v[222:223], v29 offset:29184
  s_waitcnt lgkmcnt(8)
  v_mfma_f32_16x16x32_bf16 v[96:99], v[192:195], v[48:51], v[96:99]
  buffer_load_dwordx4 v[40:43], off, s[36:39], s48 offset:1024
  v_mfma_f32_16x16x32_bf16 v[100:103], v[192:195], v[52:55], v[100:103]
  ds_read_b64_tr_b16 v[160:161], v6 offset:0
  ds_read_b64_tr_b16 v[162:163], v6 offset:512
  v_mfma_f32_16x16x32_bf16 v[108:111], v[196:199], v[52:55], v[108:111]
  ds_read_b64_tr_b16 v[164:165], v7 offset:0
  v_cvt_pk_bf16_f32 v128, v128, v129
  v_mfma_f32_16x16x32_bf16 v[104:107], v[196:199], v[48:51], v[104:107]
  ds_read_b64_tr_b16 v[166:167], v7 offset:512
  v_cvt_pk_bf16_f32 v129, v130, v131
  v_mfma_f32_16x16x32_bf16 v[112:115], v[200:203], v[48:51], v[112:115]
  ds_read_b64_tr_b16 v[168:169], v8 offset:0
  v_cvt_pk_bf16_f32 v130, v132, v133
  v_mfma_f32_16x16x32_bf16 v[116:119], v[200:203], v[52:55], v[116:119]
  ds_read_b64_tr_b16 v[170:171], v8 offset:512
  v_cvt_pk_bf16_f32 v131, v134, v135
  v_mfma_f32_16x16x32_bf16 v[124:127], v[204:207], v[52:55], v[124:127]
  ds_read_b64_tr_b16 v[172:173], v9 offset:0
  buffer_store_dwordx4 v[128:131], off, s[60:63], s4 offset:0 sc1
  v_mfma_f32_16x16x32_bf16 v[120:123], v[204:207], v[48:51], v[120:123]
  ds_read_b64_tr_b16 v[174:175], v9 offset:512
  s_waitcnt lgkmcnt(8)
  s_barrier
  v_mfma_f32_16x16x32_bf16 v[96:99], v[208:211], v[56:59], v[96:99]
  ds_read_b64_tr_b16 v[176:177], v6 offset:4096
  buffer_load_dwordx4 v[44:47], off, s[64:67], s48 offset:1024
  v_mfma_f32_16x16x32_bf16 v[100:103], v[208:211], v[60:63], v[100:103]
  ds_read_b64_tr_b16 v[178:179], v6 offset:4608
  v_cvt_pk_bf16_f32 v132, v136, v137
  v_mfma_f32_16x16x32_bf16 v[108:111], v[212:215], v[60:63], v[108:111]
  ds_read_b64_tr_b16 v[180:181], v7 offset:4096
  v_cvt_pk_bf16_f32 v133, v138, v139
  v_mfma_f32_16x16x32_bf16 v[104:107], v[212:215], v[56:59], v[104:107]
  ds_read_b64_tr_b16 v[182:183], v7 offset:4608
  v_cvt_pk_bf16_f32 v134, v140, v141
  v_mfma_f32_16x16x32_bf16 v[112:115], v[216:219], v[56:59], v[112:115]
  ds_read_b64_tr_b16 v[184:185], v8 offset:4096
  v_cvt_pk_bf16_f32 v135, v142, v143
  v_mfma_f32_16x16x32_bf16 v[116:119], v[216:219], v[60:63], v[116:119]
  ds_read_b64_tr_b16 v[186:187], v8 offset:4608
  v_readlane_b32 s49, v15, 25
  v_mfma_f32_16x16x32_bf16 v[124:127], v[220:223], v[60:63], v[124:127]
  ds_read_b64_tr_b16 v[188:189], v9 offset:4096
  buffer_store_dwordx4 v[132:135], off, s[60:63], s4 offset:1024 sc1
  v_mfma_f32_16x16x32_bf16 v[120:123], v[220:223], v[56:59], v[120:123]
  ds_read_b64_tr_b16 v[190:191], v9 offset:4608
  s_waitcnt vmcnt(20) lgkmcnt(8)
  v_mfma_f32_16x16x32_bf16 v[96:99], v[160:163], v[64:67], v[96:99]
  ds_read_b64_tr_b16 v[192:193], v6 offset:8192
  buffer_load_dwordx4 v[48:51], off, s[36:39], s49 offset:0
  v_mfma_f32_16x16x32_bf16 v[100:103], v[160:163], v[68:71], v[100:103]
  ds_read_b64_tr_b16 v[194:195], v6 offset:8704
  v_cvt_pk_bf16_f32 v136, v144, v145
  v_mfma_f32_16x16x32_bf16 v[108:111], v[164:167], v[68:71], v[108:111]
  ds_read_b64_tr_b16 v[196:197], v7 offset:8192
  v_cvt_pk_bf16_f32 v137, v146, v147
  v_mfma_f32_16x16x32_bf16 v[104:107], v[164:167], v[64:67], v[104:107]
  ds_read_b64_tr_b16 v[198:199], v7 offset:8704
  v_cvt_pk_bf16_f32 v138, v148, v149
  v_mfma_f32_16x16x32_bf16 v[112:115], v[168:171], v[64:67], v[112:115]
  ds_read_b64_tr_b16 v[200:201], v8 offset:8192
  buffer_load_dwordx4 v[52:55], off, s[64:67], s49 offset:0
  v_mfma_f32_16x16x32_bf16 v[116:119], v[168:171], v[68:71], v[116:119]
  ds_read_b64_tr_b16 v[202:203], v8 offset:8704
  v_cvt_pk_bf16_f32 v139, v150, v151
  v_mfma_f32_16x16x32_bf16 v[124:127], v[172:175], v[68:71], v[124:127]
  ds_read_b64_tr_b16 v[204:205], v9 offset:8192
  buffer_store_dwordx4 v[136:139], off, s[60:63], s4 offset:2048 sc1
  v_mfma_f32_16x16x32_bf16 v[120:123], v[172:175], v[64:67], v[120:123]
  ds_read_b64_tr_b16 v[206:207], v9 offset:8704
  s_waitcnt vmcnt(21) lgkmcnt(8)
  v_mfma_f32_16x16x32_bf16 v[96:99], v[176:179], v[72:75], v[96:99]
  ds_read_b64_tr_b16 v[208:209], v6 offset:12288
  buffer_load_dwordx4 v[56:59], off, s[36:39], s49 offset:1024
  v_mfma_f32_16x16x32_bf16 v[100:103], v[176:179], v[76:79], v[100:103]
  ds_read_b64_tr_b16 v[210:211], v6 offset:12800
  v_cvt_pk_bf16_f32 v140, v152, v153
  v_mfma_f32_16x16x32_bf16 v[108:111], v[180:183], v[76:79], v[108:111]
  ds_read_b64_tr_b16 v[212:213], v7 offset:12288
  v_cvt_pk_bf16_f32 v141, v154, v155
  v_mfma_f32_16x16x32_bf16 v[104:107], v[180:183], v[72:75], v[104:107]
  ds_read_b64_tr_b16 v[214:215], v7 offset:12800
  v_cvt_pk_bf16_f32 v142, v156, v157
  v_mfma_f32_16x16x32_bf16 v[112:115], v[184:187], v[72:75], v[112:115]
  ds_read_b64_tr_b16 v[216:217], v8 offset:12288
  buffer_load_dwordx4 v[60:63], off, s[64:67], s49 offset:1024
  v_mfma_f32_16x16x32_bf16 v[116:119], v[184:187], v[76:79], v[116:119]
  ds_read_b64_tr_b16 v[218:219], v8 offset:12800
  v_cvt_pk_bf16_f32 v143, v158, v159
  v_mfma_f32_16x16x32_bf16 v[124:127], v[188:191], v[76:79], v[124:127]
  ds_read_b64_tr_b16 v[220:221], v9 offset:12288
  v_readlane_b32 s50, v15, 26
  v_mfma_f32_16x16x32_bf16 v[120:123], v[188:191], v[72:75], v[120:123]
  ds_read_b64_tr_b16 v[222:223], v9 offset:12800
  s_waitcnt vmcnt(21) lgkmcnt(8)
  v_mfma_f32_16x16x32_bf16 v[96:99], v[192:195], v[80:83], v[96:99]
  ds_read_b64_tr_b16 v[160:161], v6 offset:16384
  buffer_store_dwordx4 v[140:143], off, s[60:63], s4 offset:3072 sc1
  v_mfma_f32_16x16x32_bf16 v[100:103], v[192:195], v[84:87], v[100:103]
  buffer_load_dwordx4 v[64:67], off, s[36:39], s50 offset:0
  v_mfma_f32_16x16x32_bf16 v[108:111], v[196:199], v[84:87], v[108:111]
  ds_read_b64_tr_b16 v[162:163], v6 offset:16896
  ds_read_b64_tr_b16 v[164:165], v7 offset:16384
  v_mfma_f32_16x16x32_bf16 v[104:107], v[196:199], v[80:83], v[104:107]
  ds_read_b64_tr_b16 v[166:167], v7 offset:16896
  v_mfma_f32_16x16x32_bf16 v[112:115], v[200:203], v[80:83], v[112:115]
  ds_read_b64_tr_b16 v[168:169], v8 offset:16384
  v_mfma_f32_16x16x32_bf16 v[116:119], v[200:203], v[84:87], v[116:119]
  buffer_load_dwordx4 v[68:71], off, s[64:67], s50 offset:0
  v_mfma_f32_16x16x32_bf16 v[124:127], v[204:207], v[84:87], v[124:127]
  ds_read_b64_tr_b16 v[170:171], v8 offset:16896
  ds_read_b64_tr_b16 v[172:173], v9 offset:16384
  v_mfma_f32_16x16x32_bf16 v[120:123], v[204:207], v[80:83], v[120:123]
  ds_read_b64_tr_b16 v[174:175], v9 offset:16896
  s_waitcnt vmcnt(22) lgkmcnt(8)
  v_mfma_f32_16x16x32_bf16 v[96:99], v[208:211], v[88:91], v[96:99]
  ds_read_b64_tr_b16 v[176:177], v6 offset:20480
  v_mfma_f32_16x16x32_bf16 v[100:103], v[208:211], v[92:95], v[100:103]
  buffer_load_dwordx4 v[72:75], off, s[36:39], s50 offset:1024
  v_mfma_f32_16x16x32_bf16 v[108:111], v[212:215], v[92:95], v[108:111]
  ds_read_b64_tr_b16 v[178:179], v6 offset:20992
  ds_read_b64_tr_b16 v[180:181], v7 offset:20480
  v_mfma_f32_16x16x32_bf16 v[104:107], v[212:215], v[88:91], v[104:107]
  ds_read_b64_tr_b16 v[182:183], v7 offset:20992
  v_mfma_f32_16x16x32_bf16 v[112:115], v[216:219], v[88:91], v[112:115]
  ds_read_b64_tr_b16 v[184:185], v8 offset:20480
  v_mfma_f32_16x16x32_bf16 v[116:119], v[216:219], v[92:95], v[116:119]
  buffer_load_dwordx4 v[76:79], off, s[64:67], s50 offset:1024
  v_mfma_f32_16x16x32_bf16 v[124:127], v[220:223], v[92:95], v[124:127]
  ds_read_b64_tr_b16 v[186:187], v8 offset:20992
  ds_read_b64_tr_b16 v[188:189], v9 offset:20480
  v_mfma_f32_16x16x32_bf16 v[120:123], v[220:223], v[88:91], v[120:123]
  ds_read_b64_tr_b16 v[190:191], v9 offset:20992
  s_waitcnt vmcnt(22) lgkmcnt(8)
  v_mfma_f32_16x16x32_bf16 v[96:99], v[160:163], v[224:227], v[96:99]
  ds_read_b64_tr_b16 v[192:193], v6 offset:24576
  v_readlane_b32 s51, v15, 27
  v_mfma_f32_16x16x32_bf16 v[100:103], v[160:163], v[228:231], v[100:103]
  ds_read_b64_tr_b16 v[194:195], v6 offset:25088
  v_mfma_f32_16x16x32_bf16 v[108:111], v[164:167], v[228:231], v[108:111]
  ds_read_b64_tr_b16 v[196:197], v7 offset:24576
  v_mfma_f32_16x16x32_bf16 v[104:107], v[164:167], v[224:227], v[104:107]
  buffer_load_dwordx4 v[80:83], off, s[36:39], s51 offset:0
  v_mfma_f32_16x16x32_bf16 v[112:115], v[168:171], v[224:227], v[112:115]
  ds_read_b64_tr_b16 v[198:199], v7 offset:25088
  ds_read_b64_tr_b16 v[200:201], v8 offset:24576
  v_mfma_f32_16x16x32_bf16 v[116:119], v[168:171], v[228:231], v[116:119]
  ds_read_b64_tr_b16 v[202:203], v8 offset:25088
  v_mfma_f32_16x16x32_bf16 v[124:127], v[172:175], v[228:231], v[124:127]
  ds_read_b64_tr_b16 v[204:205], v9 offset:24576
  v_mfma_f32_16x16x32_bf16 v[120:123], v[172:175], v[224:227], v[120:123]
  ds_read_b64_tr_b16 v[206:207], v9 offset:25088
  s_waitcnt vmcnt(21) lgkmcnt(8)
  v_mfma_f32_16x16x32_bf16 v[96:99], v[176:179], v[232:235], v[96:99]
  buffer_load_dwordx4 v[84:87], off, s[64:67], s51 offset:0
  v_mfma_f32_16x16x32_bf16 v[100:103], v[176:179], v[236:239], v[100:103]
  ds_read_b64_tr_b16 v[208:209], v6 offset:28672
  ds_read_b64_tr_b16 v[210:211], v6 offset:29184
  v_mfma_f32_16x16x32_bf16 v[108:111], v[180:183], v[236:239], v[108:111]
  ds_read_b64_tr_b16 v[212:213], v7 offset:28672
  v_mfma_f32_16x16x32_bf16 v[104:107], v[180:183], v[232:235], v[104:107]
  ds_read_b64_tr_b16 v[214:215], v7 offset:29184
  v_mfma_f32_16x16x32_bf16 v[112:115], v[184:187], v[232:235], v[112:115]
  buffer_load_dwordx4 v[88:91], off, s[36:39], s51 offset:1024
  v_mfma_f32_16x16x32_bf16 v[116:119], v[184:187], v[236:239], v[116:119]
  ds_read_b64_tr_b16 v[216:217], v8 offset:28672
  ds_read_b64_tr_b16 v[218:219], v8 offset:29184
  v_mfma_f32_16x16x32_bf16 v[124:127], v[188:191], v[236:239], v[124:127]
  ds_read_b64_tr_b16 v[220:221], v9 offset:28672
  v_mfma_f32_16x16x32_bf16 v[120:123], v[188:191], v[232:235], v[120:123]
  ds_read_b64_tr_b16 v[222:223], v9 offset:29184
  s_waitcnt vmcnt(21) lgkmcnt(8)
  v_mfma_f32_16x16x32_bf16 v[96:99], v[192:195], v[240:243], v[96:99]
  ds_read_b64_tr_b16 v[160:161], v6 offset:32768
  buffer_load_dwordx4 v[92:95], off, s[64:67], s51 offset:1024
  v_mfma_f32_16x16x32_bf16 v[100:103], v[192:195], v[244:247], v[100:103]
  ds_read_b64_tr_b16 v[162:163], v6 offset:33280
  s_waitcnt vmcnt(8)
  v_mfma_f32_16x16x32_bf16 v[108:111], v[196:199], v[244:247], v[108:111]
  ds_read_b64_tr_b16 v[164:165], v7 offset:32768
  v_readlane_b32 s48, v15, 28
  v_mfma_f32_16x16x32_bf16 v[104:107], v[196:199], v[240:243], v[104:107]
  buffer_store_dword v19, off, s[52:55], s6 sc1
  v_mfma_f32_16x16x32_bf16 v[112:115], v[200:203], v[240:243], v[112:115]
  ds_read_b64_tr_b16 v[166:167], v7 offset:33280
  ds_read_b64_tr_b16 v[168:169], v8 offset:32768
  v_mfma_f32_16x16x32_bf16 v[116:119], v[200:203], v[244:247], v[116:119]
  buffer_load_dwordx4 v[224:227], off, s[36:39], s48 offset:0
  v_mfma_f32_16x16x32_bf16 v[124:127], v[204:207], v[244:247], v[124:127]
  ds_read_b64_tr_b16 v[170:171], v8 offset:33280
  ds_read_b64_tr_b16 v[172:173], v9 offset:32768
  v_mfma_f32_16x16x32_bf16 v[120:123], v[204:207], v[240:243], v[120:123]
  ds_read_b64_tr_b16 v[174:175], v9 offset:33280
  s_waitcnt lgkmcnt(8)
  v_mfma_f32_16x16x32_bf16 v[96:99], v[208:211], v[248:251], v[96:99]
  ds_read_b64_tr_b16 v[176:177], v6 offset:36864
  v_mfma_f32_16x16x32_bf16 v[100:103], v[208:211], v[252:255], v[100:103]
  buffer_load_dwordx4 v[228:231], off, s[64:67], s48 offset:0
  v_mfma_f32_16x16x32_bf16 v[108:111], v[212:215], v[252:255], v[108:111]
  ds_read_b64_tr_b16 v[178:179], v6 offset:37376
  ds_read_b64_tr_b16 v[180:181], v7 offset:36864
  v_mfma_f32_16x16x32_bf16 v[104:107], v[212:215], v[248:251], v[104:107]
  ds_read_b64_tr_b16 v[182:183], v7 offset:37376
  v_mfma_f32_16x16x32_bf16 v[112:115], v[216:219], v[248:251], v[112:115]
  ds_read_b64_tr_b16 v[184:185], v8 offset:36864
  v_mfma_f32_16x16x32_bf16 v[116:119], v[216:219], v[252:255], v[116:119]
  buffer_load_dwordx4 v[232:235], off, s[36:39], s48 offset:1024
  v_mfma_f32_16x16x32_bf16 v[124:127], v[220:223], v[252:255], v[124:127]
  ds_read_b64_tr_b16 v[186:187], v8 offset:37376
  ds_read_b64_tr_b16 v[188:189], v9 offset:36864
  v_mfma_f32_16x16x32_bf16 v[120:123], v[220:223], v[248:251], v[120:123]
  ds_read_b64_tr_b16 v[190:191], v9 offset:37376
  s_waitcnt lgkmcnt(8)
  v_mfma_f32_16x16x32_bf16 v[96:99], v[160:163], v[32:35], v[96:99]
  ds_read_b64_tr_b16 v[192:193], v6 offset:40960
  v_mfma_f32_16x16x32_bf16 v[100:103], v[160:163], v[36:39], v[100:103]
  buffer_load_dwordx4 v[236:239], off, s[64:67], s48 offset:1024
  v_mfma_f32_16x16x32_bf16 v[108:111], v[164:167], v[36:39], v[108:111]
  ds_read_b64_tr_b16 v[194:195], v6 offset:41472
  ds_read_b64_tr_b16 v[196:197], v7 offset:40960
  v_mfma_f32_16x16x32_bf16 v[104:107], v[164:167], v[32:35], v[104:107]
  ds_read_b64_tr_b16 v[198:199], v7 offset:41472
  v_readlane_b32 s49, v15, 29
  v_mfma_f32_16x16x32_bf16 v[112:115], v[168:171], v[32:35], v[112:115]
  ds_read_b64_tr_b16 v[200:201], v8 offset:40960
  v_mfma_f32_16x16x32_bf16 v[116:119], v[168:171], v[36:39], v[116:119]
  ds_read_b64_tr_b16 v[202:203], v8 offset:41472
  ds_read_b64_tr_b16 v[204:205], v9 offset:40960
  v_mfma_f32_16x16x32_bf16 v[124:127], v[172:175], v[36:39], v[124:127]
  buffer_load_dwordx4 v[240:243], off, s[36:39], s49 offset:0
  v_mfma_f32_16x16x32_bf16 v[120:123], v[172:175], v[32:35], v[120:123]
  ds_read_b64_tr_b16 v[206:207], v9 offset:41472
  s_waitcnt lgkmcnt(8)
  v_mfma_f32_16x16x32_bf16 v[96:99], v[176:179], v[40:43], v[96:99]
  ds_read_b64_tr_b16 v[208:209], v6 offset:45056
  v_mfma_f32_16x16x32_bf16 v[100:103], v[176:179], v[44:47], v[100:103]
  ds_read_b64_tr_b16 v[210:211], v6 offset:45568
  v_mfma_f32_16x16x32_bf16 v[108:111], v[180:183], v[44:47], v[108:111]
  buffer_load_dwordx4 v[244:247], off, s[64:67], s49 offset:0
  v_mfma_f32_16x16x32_bf16 v[104:107], v[180:183], v[40:43], v[104:107]
  ds_read_b64_tr_b16 v[212:213], v7 offset:45056
  ds_read_b64_tr_b16 v[214:215], v7 offset:45568
  v_mfma_f32_16x16x32_bf16 v[112:115], v[184:187], v[40:43], v[112:115]
  ds_read_b64_tr_b16 v[216:217], v8 offset:45056
  v_mfma_f32_16x16x32_bf16 v[116:119], v[184:187], v[44:47], v[116:119]
  ds_read_b64_tr_b16 v[218:219], v8 offset:45568
  ds_read_b64_tr_b16 v[220:221], v9 offset:45056
  v_mfma_f32_16x16x32_bf16 v[124:127], v[188:191], v[44:47], v[124:127]
  buffer_load_dwordx4 v[248:251], off, s[36:39], s49 offset:1024
  v_mfma_f32_16x16x32_bf16 v[120:123], v[188:191], v[40:43], v[120:123]
  ds_read_b64_tr_b16 v[222:223], v9 offset:45568
  s_waitcnt lgkmcnt(8)
  v_mfma_f32_16x16x32_bf16 v[96:99], v[192:195], v[48:51], v[96:99]
  ds_read_b64_tr_b16 v[160:161], v6 offset:49152
  v_mfma_f32_16x16x32_bf16 v[100:103], v[192:195], v[52:55], v[100:103]
  ds_read_b64_tr_b16 v[162:163], v6 offset:49664
  v_mfma_f32_16x16x32_bf16 v[108:111], v[196:199], v[52:55], v[108:111]
  buffer_load_dwordx4 v[252:255], off, s[64:67], s49 offset:1024
  v_mfma_f32_16x16x32_bf16 v[104:107], v[196:199], v[48:51], v[104:107]
  ds_read_b64_tr_b16 v[164:165], v7 offset:49152
  ds_read_b64_tr_b16 v[166:167], v7 offset:49664
  v_mfma_f32_16x16x32_bf16 v[112:115], v[200:203], v[48:51], v[112:115]
  ds_read_b64_tr_b16 v[168:169], v8 offset:49152
  v_readlane_b32 s50, v15, 30
  v_mfma_f32_16x16x32_bf16 v[116:119], v[200:203], v[52:55], v[116:119]
  ds_read_b64_tr_b16 v[170:171], v8 offset:49664
  v_mfma_f32_16x16x32_bf16 v[124:127], v[204:207], v[52:55], v[124:127]
  ds_read_b64_tr_b16 v[172:173], v9 offset:49152
  v_mfma_f32_16x16x32_bf16 v[120:123], v[204:207], v[48:51], v[120:123]
  ds_read_b64_tr_b16 v[174:175], v9 offset:49664
  s_waitcnt lgkmcnt(8)
  s_barrier
  v_mfma_f32_16x16x32_bf16 v[96:99], v[208:211], v[56:59], v[96:99]
  buffer_load_dwordx4 v[32:35], off, s[36:39], s50 offset:0
  v_mfma_f32_16x16x32_bf16 v[100:103], v[208:211], v[60:63], v[100:103]
  ds_read_b64_tr_b16 v[176:177], v6 offset:53248
  ds_read_b64_tr_b16 v[178:179], v6 offset:53760
  v_mfma_f32_16x16x32_bf16 v[108:111], v[212:215], v[60:63], v[108:111]
  ds_read_b64_tr_b16 v[180:181], v7 offset:53248
  v_mfma_f32_16x16x32_bf16 v[104:107], v[212:215], v[56:59], v[104:107]
  ds_read_b64_tr_b16 v[182:183], v7 offset:53760
  v_mfma_f32_16x16x32_bf16 v[112:115], v[216:219], v[56:59], v[112:115]
  buffer_load_dwordx4 v[36:39], off, s[64:67], s50 offset:0
  v_mfma_f32_16x16x32_bf16 v[116:119], v[216:219], v[60:63], v[116:119]
  ds_read_b64_tr_b16 v[184:185], v8 offset:53248
  ds_read_b64_tr_b16 v[186:187], v8 offset:53760
  v_mfma_f32_16x16x32_bf16 v[124:127], v[220:223], v[60:63], v[124:127]
  ds_read_b64_tr_b16 v[188:189], v9 offset:53248
  v_mfma_f32_16x16x32_bf16 v[120:123], v[220:223], v[56:59], v[120:123]
  ds_read_b64_tr_b16 v[190:191], v9 offset:53760
  s_waitcnt vmcnt(17) lgkmcnt(8)
  v_mfma_f32_16x16x32_bf16 v[96:99], v[160:163], v[64:67], v[96:99]
  buffer_load_dwordx4 v[40:43], off, s[36:39], s50 offset:1024
  v_mfma_f32_16x16x32_bf16 v[100:103], v[160:163], v[68:71], v[100:103]
  ds_read_b64_tr_b16 v[192:193], v6 offset:57344
  ds_read_b64_tr_b16 v[194:195], v6 offset:57856
  v_mfma_f32_16x16x32_bf16 v[108:111], v[164:167], v[68:71], v[108:111]
  ds_read_b64_tr_b16 v[196:197], v7 offset:57344
  v_mfma_f32_16x16x32_bf16 v[104:107], v[164:167], v[64:67], v[104:107]
  ds_read_b64_tr_b16 v[198:199], v7 offset:57856
  v_mfma_f32_16x16x32_bf16 v[112:115], v[168:171], v[64:67], v[112:115]
  buffer_load_dwordx4 v[44:47], off, s[64:67], s50 offset:1024
  v_mfma_f32_16x16x32_bf16 v[116:119], v[168:171], v[68:71], v[116:119]
  ds_read_b64_tr_b16 v[200:201], v8 offset:57344
  ds_read_b64_tr_b16 v[202:203], v8 offset:57856
  v_mfma_f32_16x16x32_bf16 v[124:127], v[172:175], v[68:71], v[124:127]
  ds_read_b64_tr_b16 v[204:205], v9 offset:57344
  v_readlane_b32 s51, v15, 31
  v_mfma_f32_16x16x32_bf16 v[120:123], v[172:175], v[64:67], v[120:123]
  ds_read_b64_tr_b16 v[206:207], v9 offset:57856
  s_waitcnt vmcnt(17) lgkmcnt(8)
  v_mfma_f32_16x16x32_bf16 v[96:99], v[176:179], v[72:75], v[96:99]
  ds_read_b64_tr_b16 v[208:209], v6 offset:61440
  v_mfma_f32_16x16x32_bf16 v[100:103], v[176:179], v[76:79], v[100:103]
  buffer_load_dwordx4 v[48:51], off, s[36:39], s51 offset:0
  v_mfma_f32_16x16x32_bf16 v[108:111], v[180:183], v[76:79], v[108:111]
  ds_read_b64_tr_b16 v[210:211], v6 offset:61952
  ds_read_b64_tr_b16 v[212:213], v7 offset:61440
  v_mfma_f32_16x16x32_bf16 v[104:107], v[180:183], v[72:75], v[104:107]
  ds_read_b64_tr_b16 v[214:215], v7 offset:61952
  v_mfma_f32_16x16x32_bf16 v[112:115], v[184:187], v[72:75], v[112:115]
  ds_read_b64_tr_b16 v[216:217], v8 offset:61440
  v_mfma_f32_16x16x32_bf16 v[116:119], v[184:187], v[76:79], v[116:119]
  buffer_load_dwordx4 v[52:55], off, s[64:67], s51 offset:0
  v_mfma_f32_16x16x32_bf16 v[124:127], v[188:191], v[76:79], v[124:127]
  ds_read_b64_tr_b16 v[218:219], v8 offset:61952
  ds_read_b64_tr_b16 v[220:221], v9 offset:61440
  v_mfma_f32_16x16x32_bf16 v[120:123], v[188:191], v[72:75], v[120:123]
  ds_read_b64_tr_b16 v[222:223], v9 offset:61952
  s_waitcnt vmcnt(17) lgkmcnt(8)
  v_mfma_f32_16x16x32_bf16 v[96:99], v[192:195], v[80:83], v[96:99]
  ds_read_b64_tr_b16 v[160:161], v20 offset:0
  v_mfma_f32_16x16x32_bf16 v[100:103], v[192:195], v[84:87], v[100:103]
  buffer_load_dwordx4 v[56:59], off, s[36:39], s51 offset:1024
  v_mfma_f32_16x16x32_bf16 v[108:111], v[196:199], v[84:87], v[108:111]
  ds_read_b64_tr_b16 v[162:163], v20 offset:512
  ds_read_b64_tr_b16 v[164:165], v21 offset:0
  v_mfma_f32_16x16x32_bf16 v[104:107], v[196:199], v[80:83], v[104:107]
  ds_read_b64_tr_b16 v[166:167], v21 offset:512
  v_mfma_f32_16x16x32_bf16 v[112:115], v[200:203], v[80:83], v[112:115]
  ds_read_b64_tr_b16 v[168:169], v22 offset:0
  v_mfma_f32_16x16x32_bf16 v[116:119], v[200:203], v[84:87], v[116:119]
  buffer_load_dwordx4 v[60:63], off, s[64:67], s51 offset:1024
  v_mfma_f32_16x16x32_bf16 v[124:127], v[204:207], v[84:87], v[124:127]
  ds_read_b64_tr_b16 v[170:171], v22 offset:512
  ds_read_b64_tr_b16 v[172:173], v23 offset:0
  v_mfma_f32_16x16x32_bf16 v[120:123], v[204:207], v[80:83], v[120:123]
  ds_read_b64_tr_b16 v[174:175], v23 offset:512
  s_waitcnt vmcnt(17) lgkmcnt(8)
  v_mfma_f32_16x16x32_bf16 v[96:99], v[208:211], v[88:91], v[96:99]
  ds_read_b64_tr_b16 v[176:177], v20 offset:4096
  v_readlane_b32 s48, v15, 32
  v_mfma_f32_16x16x32_bf16 v[100:103], v[208:211], v[92:95], v[100:103]
  ds_read_b64_tr_b16 v[178:179], v20 offset:4608
  v_mfma_f32_16x16x32_bf16 v[108:111], v[212:215], v[92:95], v[108:111]
  ds_read_b64_tr_b16 v[180:181], v21 offset:4096
  v_mfma_f32_16x16x32_bf16 v[104:107], v[212:215], v[88:91], v[104:107]
  buffer_load_dwordx4 v[64:67], off, s[36:39], s48 offset:0
  v_mfma_f32_16x16x32_bf16 v[112:115], v[216:219], v[88:91], v[112:115]
  ds_read_b64_tr_b16 v[182:183], v21 offset:4608
  ds_read_b64_tr_b16 v[184:185], v22 offset:4096
  v_mfma_f32_16x16x32_bf16 v[116:119], v[216:219], v[92:95], v[116:119]
  ds_read_b64_tr_b16 v[186:187], v22 offset:4608
  v_mfma_f32_16x16x32_bf16 v[124:127], v[220:223], v[92:95], v[124:127]
  ds_read_b64_tr_b16 v[188:189], v23 offset:4096
  v_mfma_f32_16x16x32_bf16 v[120:123], v[220:223], v[88:91], v[120:123]
  ds_read_b64_tr_b16 v[190:191], v23 offset:4608
  s_waitcnt vmcnt(15) lgkmcnt(8)
  v_mfma_f32_16x16x32_bf16 v[96:99], v[160:163], v[224:227], v[96:99]
  buffer_load_dwordx4 v[68:71], off, s[64:67], s48 offset:0
  v_mfma_f32_16x16x32_bf16 v[100:103], v[160:163], v[228:231], v[100:103]
  ds_read_b64_tr_b16 v[192:193], v20 offset:8192
  ds_read_b64_tr_b16 v[194:195], v20 offset:8704
  v_mfma_f32_16x16x32_bf16 v[108:111], v[164:167], v[228:231], v[108:111]
  ds_read_b64_tr_b16 v[196:197], v21 offset:8192
  v_mfma_f32_16x16x32_bf16 v[104:107], v[164:167], v[224:227], v[104:107]
  ds_read_b64_tr_b16 v[198:199], v21 offset:8704
  v_mfma_f32_16x16x32_bf16 v[112:115], v[168:171], v[224:227], v[112:115]
  buffer_load_dwordx4 v[72:75], off, s[36:39], s48 offset:1024
  v_mfma_f32_16x16x32_bf16 v[116:119], v[168:171], v[228:231], v[116:119]
  ds_read_b64_tr_b16 v[200:201], v22 offset:8192
  ds_read_b64_tr_b16 v[202:203], v22 offset:8704
  v_mfma_f32_16x16x32_bf16 v[124:127], v[172:175], v[228:231], v[124:127]
  ds_read_b64_tr_b16 v[204:205], v23 offset:8192
  v_mfma_f32_16x16x32_bf16 v[120:123], v[172:175], v[224:227], v[120:123]
  ds_read_b64_tr_b16 v[206:207], v23 offset:8704
  s_waitcnt vmcnt(15) lgkmcnt(8)
  v_mfma_f32_16x16x32_bf16 v[96:99], v[176:179], v[232:235], v[96:99]
  buffer_load_dwordx4 v[76:79], off, s[64:67], s48 offset:1024
  v_mfma_f32_16x16x32_bf16 v[100:103], v[176:179], v[236:239], v[100:103]
  ds_read_b64_tr_b16 v[208:209], v20 offset:12288
  ds_read_b64_tr_b16 v[210:211], v20 offset:12800
  v_mfma_f32_16x16x32_bf16 v[108:111], v[180:183], v[236:239], v[108:111]
  ds_read_b64_tr_b16 v[212:213], v21 offset:12288
  v_readlane_b32 s49, v15, 33
  v_mfma_f32_16x16x32_bf16 v[104:107], v[180:183], v[232:235], v[104:107]
  ds_read_b64_tr_b16 v[214:215], v21 offset:12800
  v_mfma_f32_16x16x32_bf16 v[112:115], v[184:187], v[232:235], v[112:115]
  ds_read_b64_tr_b16 v[216:217], v22 offset:12288
  v_mfma_f32_16x16x32_bf16 v[116:119], v[184:187], v[236:239], v[116:119]
  buffer_load_dwordx4 v[80:83], off, s[36:39], s49 offset:0
  v_mfma_f32_16x16x32_bf16 v[124:127], v[188:191], v[236:239], v[124:127]
  ds_read_b64_tr_b16 v[218:219], v22 offset:12800
  ds_read_b64_tr_b16 v[220:221], v23 offset:12288
  v_mfma_f32_16x16x32_bf16 v[120:123], v[188:191], v[232:235], v[120:123]
  ds_read_b64_tr_b16 v[222:223], v23 offset:12800
  s_waitcnt vmcnt(15) lgkmcnt(8)
  v_mfma_f32_16x16x32_bf16 v[96:99], v[192:195], v[240:243], v[96:99]
  ds_read_b64_tr_b16 v[160:161], v20 offset:16384
  v_mfma_f32_16x16x32_bf16 v[100:103], v[192:195], v[244:247], v[100:103]
  buffer_load_dwordx4 v[84:87], off, s[64:67], s49 offset:0
  v_mfma_f32_16x16x32_bf16 v[108:111], v[196:199], v[244:247], v[108:111]
  ds_read_b64_tr_b16 v[162:163], v20 offset:16896
  ds_read_b64_tr_b16 v[164:165], v21 offset:16384
  v_mfma_f32_16x16x32_bf16 v[104:107], v[196:199], v[240:243], v[104:107]
  ds_read_b64_tr_b16 v[166:167], v21 offset:16896
  v_mfma_f32_16x16x32_bf16 v[112:115], v[200:203], v[240:243], v[112:115]
  ds_read_b64_tr_b16 v[168:169], v22 offset:16384
  v_mfma_f32_16x16x32_bf16 v[116:119], v[200:203], v[244:247], v[116:119]
  buffer_load_dwordx4 v[88:91], off, s[36:39], s49 offset:1024
  v_mfma_f32_16x16x32_bf16 v[124:127], v[204:207], v[244:247], v[124:127]
  ds_read_b64_tr_b16 v[170:171], v22 offset:16896
  ds_read_b64_tr_b16 v[172:173], v23 offset:16384
  v_mfma_f32_16x16x32_bf16 v[120:123], v[204:207], v[240:243], v[120:123]
  ds_read_b64_tr_b16 v[174:175], v23 offset:16896
  s_waitcnt vmcnt(15) lgkmcnt(8)
  v_mfma_f32_16x16x32_bf16 v[96:99], v[208:211], v[248:251], v[96:99]
  ds_read_b64_tr_b16 v[176:177], v20 offset:20480
  v_mfma_f32_16x16x32_bf16 v[100:103], v[208:211], v[252:255], v[100:103]
  buffer_load_dwordx4 v[92:95], off, s[64:67], s49 offset:1024
  v_mfma_f32_16x16x32_bf16 v[108:111], v[212:215], v[252:255], v[108:111]
  ds_read_b64_tr_b16 v[178:179], v20 offset:20992
  ds_read_b64_tr_b16 v[180:181], v21 offset:20480
  v_mfma_f32_16x16x32_bf16 v[104:107], v[212:215], v[248:251], v[104:107]
  ds_read_b64_tr_b16 v[182:183], v21 offset:20992
  v_readlane_b32 s50, v15, 34
  v_mfma_f32_16x16x32_bf16 v[112:115], v[216:219], v[248:251], v[112:115]
  ds_read_b64_tr_b16 v[184:185], v22 offset:20480
  v_mfma_f32_16x16x32_bf16 v[116:119], v[216:219], v[252:255], v[116:119]
  ds_read_b64_tr_b16 v[186:187], v22 offset:20992
  ds_read_b64_tr_b16 v[188:189], v23 offset:20480
  v_mfma_f32_16x16x32_bf16 v[124:127], v[220:223], v[252:255], v[124:127]
  buffer_load_dwordx4 v[224:227], off, s[36:39], s50 offset:0
  v_mfma_f32_16x16x32_bf16 v[120:123], v[220:223], v[248:251], v[120:123]
  ds_read_b64_tr_b16 v[190:191], v23 offset:20992
  s_waitcnt vmcnt(15) lgkmcnt(8)
  v_mfma_f32_16x16x32_bf16 v[96:99], v[160:163], v[32:35], v[96:99]
  ds_read_b64_tr_b16 v[192:193], v20 offset:24576
  v_mfma_f32_16x16x32_bf16 v[100:103], v[160:163], v[36:39], v[100:103]
  ds_read_b64_tr_b16 v[194:195], v20 offset:25088
  v_mfma_f32_16x16x32_bf16 v[108:111], v[164:167], v[36:39], v[108:111]
  buffer_load_dwordx4 v[228:231], off, s[64:67], s50 offset:0
  v_mfma_f32_16x16x32_bf16 v[104:107], v[164:167], v[32:35], v[104:107]
  ds_read_b64_tr_b16 v[196:197], v21 offset:24576
  ds_read_b64_tr_b16 v[198:199], v21 offset:25088
  v_mfma_f32_16x16x32_bf16 v[112:115], v[168:171], v[32:35], v[112:115]
  ds_read_b64_tr_b16 v[200:201], v22 offset:24576
  v_mfma_f32_16x16x32_bf16 v[116:119], v[168:171], v[36:39], v[116:119]
  ds_read_b64_tr_b16 v[202:203], v22 offset:25088
  ds_read_b64_tr_b16 v[204:205], v23 offset:24576
  v_mfma_f32_16x16x32_bf16 v[124:127], v[172:175], v[36:39], v[124:127]
  buffer_load_dwordx4 v[232:235], off, s[36:39], s50 offset:1024
  v_mfma_f32_16x16x32_bf16 v[120:123], v[172:175], v[32:35], v[120:123]
  ds_read_b64_tr_b16 v[206:207], v23 offset:25088
  s_waitcnt vmcnt(15) lgkmcnt(8)
  s_barrier
  v_mfma_f32_16x16x32_bf16 v[96:99], v[176:179], v[40:43], v[96:99]
  buffer_load_dwordx4 v[144:147], off, s[60:63], s5 offset:0 sc1
  v_mfma_f32_16x16x32_bf16 v[100:103], v[176:179], v[44:47], v[100:103]
  ds_read_b64_tr_b16 v[208:209], v20 offset:28672
  ds_read_b64_tr_b16 v[210:211], v20 offset:29184
  v_mfma_f32_16x16x32_bf16 v[108:111], v[180:183], v[44:47], v[108:111]
  ds_read_b64_tr_b16 v[212:213], v21 offset:28672
  buffer_load_dwordx4 v[236:239], off, s[64:67], s50 offset:1024
  v_mfma_f32_16x16x32_bf16 v[104:107], v[180:183], v[40:43], v[104:107]
  ds_read_b64_tr_b16 v[214:215], v21 offset:29184
  buffer_load_dwordx4 v[148:151], off, s[60:63], s5 offset:1024 sc1
  v_mfma_f32_16x16x32_bf16 v[112:115], v[184:187], v[40:43], v[112:115]
  ds_read_b64_tr_b16 v[216:217], v22 offset:28672
  v_readlane_b32 s51, v15, 35
  v_mfma_f32_16x16x32_bf16 v[116:119], v[184:187], v[44:47], v[116:119]
  buffer_load_dwordx4 v[152:155], off, s[60:63], s5 offset:2048 sc1
  v_mfma_f32_16x16x32_bf16 v[124:127], v[188:191], v[44:47], v[124:127]
  ds_read_b64_tr_b16 v[218:219], v22 offset:29184
  ds_read_b64_tr_b16 v[220:221], v23 offset:28672
  v_mfma_f32_16x16x32_bf16 v[120:123], v[188:191], v[40:43], v[120:123]
  ds_read_b64_tr_b16 v[222:223], v23 offset:29184
  s_waitcnt vmcnt(17) lgkmcnt(8)
  v_mfma_f32_16x16x32_bf16 v[96:99], v[192:195], v[48:51], v[96:99]
  ds_read_b64_tr_b16 v[160:161], v20 offset:32768
  buffer_load_dwordx4 v[240:243], off, s[36:39], s51 offset:0
  v_mfma_f32_16x16x32_bf16 v[100:103], v[192:195], v[52:55], v[100:103]
  buffer_load_dwordx4 v[156:159], off, s[60:63], s5 offset:3072 sc1
  v_mfma_f32_16x16x32_bf16 v[108:111], v[196:199], v[52:55], v[108:111]
  ds_read_b64_tr_b16 v[162:163], v20 offset:33280
  ds_read_b64_tr_b16 v[164:165], v21 offset:32768
  v_mfma_f32_16x16x32_bf16 v[104:107], v[196:199], v[48:51], v[104:107]
  ds_read_b64_tr_b16 v[166:167], v21 offset:33280
  v_mfma_f32_16x16x32_bf16 v[112:115], v[200:203], v[48:51], v[112:115]
  buffer_load_dwordx4 v[244:247], off, s[64:67], s51 offset:0
  v_mfma_f32_16x16x32_bf16 v[116:119], v[200:203], v[52:55], v[116:119]
  ds_read_b64_tr_b16 v[168:169], v22 offset:32768
  ds_read_b64_tr_b16 v[170:171], v22 offset:33280
  v_mfma_f32_16x16x32_bf16 v[124:127], v[204:207], v[52:55], v[124:127]
  ds_read_b64_tr_b16 v[172:173], v23 offset:32768
  v_mfma_f32_16x16x32_bf16 v[120:123], v[204:207], v[48:51], v[120:123]
  ds_read_b64_tr_b16 v[174:175], v23 offset:33280
  s_waitcnt vmcnt(18) lgkmcnt(8)
  v_mfma_f32_16x16x32_bf16 v[96:99], v[208:211], v[56:59], v[96:99]
  buffer_load_dwordx4 v[248:251], off, s[36:39], s51 offset:1024
  v_mfma_f32_16x16x32_bf16 v[100:103], v[208:211], v[60:63], v[100:103]
  ds_read_b64_tr_b16 v[176:177], v20 offset:36864
  ds_read_b64_tr_b16 v[178:179], v20 offset:37376
  v_mfma_f32_16x16x32_bf16 v[108:111], v[212:215], v[60:63], v[108:111]
  ds_read_b64_tr_b16 v[180:181], v21 offset:36864
  v_mfma_f32_16x16x32_bf16 v[104:107], v[212:215], v[56:59], v[104:107]
  ds_read_b64_tr_b16 v[182:183], v21 offset:37376
  v_mfma_f32_16x16x32_bf16 v[112:115], v[216:219], v[56:59], v[112:115]
  buffer_load_dwordx4 v[252:255], off, s[64:67], s51 offset:1024
  v_mfma_f32_16x16x32_bf16 v[116:119], v[216:219], v[60:63], v[116:119]
  ds_read_b64_tr_b16 v[184:185], v22 offset:36864
  ds_read_b64_tr_b16 v[186:187], v22 offset:37376
  v_mfma_f32_16x16x32_bf16 v[124:127], v[220:223], v[60:63], v[124:127]
  ds_read_b64_tr_b16 v[188:189], v23 offset:36864
  v_mfma_f32_16x16x32_bf16 v[120:123], v[220:223], v[56:59], v[120:123]
  ds_read_b64_tr_b16 v[190:191], v23 offset:37376
  s_waitcnt vmcnt(18) lgkmcnt(8)
  v_mfma_f32_16x16x32_bf16 v[96:99], v[160:163], v[64:67], v[96:99]
  ds_read_b64_tr_b16 v[192:193], v20 offset:40960
  v_mfma_f32_16x16x32_bf16 v[100:103], v[160:163], v[68:71], v[100:103]
  ds_read_b64_tr_b16 v[194:195], v20 offset:41472
  v_mfma_f32_16x16x32_bf16 v[108:111], v[164:167], v[68:71], v[108:111]
  ds_read_b64_tr_b16 v[196:197], v21 offset:40960
  v_mfma_f32_16x16x32_bf16 v[104:107], v[164:167], v[64:67], v[104:107]
  ds_read_b64_tr_b16 v[198:199], v21 offset:41472
  v_mfma_f32_16x16x32_bf16 v[112:115], v[168:171], v[64:67], v[112:115]
  ds_read_b64_tr_b16 v[200:201], v22 offset:40960
  v_mfma_f32_16x16x32_bf16 v[116:119], v[168:171], v[68:71], v[116:119]
  ds_read_b64_tr_b16 v[202:203], v22 offset:41472
  v_mfma_f32_16x16x32_bf16 v[124:127], v[172:175], v[68:71], v[124:127]
  ds_read_b64_tr_b16 v[204:205], v23 offset:40960
  v_mfma_f32_16x16x32_bf16 v[120:123], v[172:175], v[64:67], v[120:123]
  ds_read_b64_tr_b16 v[206:207], v23 offset:41472
  s_waitcnt vmcnt(16) lgkmcnt(8)
  v_mfma_f32_16x16x32_bf16 v[96:99], v[176:179], v[72:75], v[96:99]
  ds_read_b64_tr_b16 v[208:209], v20 offset:45056
  v_mfma_f32_16x16x32_bf16 v[100:103], v[176:179], v[76:79], v[100:103]
  ds_read_b64_tr_b16 v[210:211], v20 offset:45568
  v_mfma_f32_16x16x32_bf16 v[108:111], v[180:183], v[76:79], v[108:111]
  ds_read_b64_tr_b16 v[212:213], v21 offset:45056
  v_mfma_f32_16x16x32_bf16 v[104:107], v[180:183], v[72:75], v[104:107]
  ds_read_b64_tr_b16 v[214:215], v21 offset:45568
  v_mfma_f32_16x16x32_bf16 v[112:115], v[184:187], v[72:75], v[112:115]
  ds_read_b64_tr_b16 v[216:217], v22 offset:45056
  v_mfma_f32_16x16x32_bf16 v[116:119], v[184:187], v[76:79], v[116:119]
  ds_read_b64_tr_b16 v[218:219], v22 offset:45568
  v_mfma_f32_16x16x32_bf16 v[124:127], v[188:191], v[76:79], v[124:127]
  ds_read_b64_tr_b16 v[220:221], v23 offset:45056
  v_mfma_f32_16x16x32_bf16 v[120:123], v[188:191], v[72:75], v[120:123]
  ds_read_b64_tr_b16 v[222:223], v23 offset:45568
  s_waitcnt vmcnt(14) lgkmcnt(8)
  v_mfma_f32_16x16x32_bf16 v[96:99], v[192:195], v[80:83], v[96:99]
  ds_read_b64_tr_b16 v[160:161], v20 offset:49152
  v_mfma_f32_16x16x32_bf16 v[100:103], v[192:195], v[84:87], v[100:103]
  ds_read_b64_tr_b16 v[162:163], v20 offset:49664
  v_mfma_f32_16x16x32_bf16 v[108:111], v[196:199], v[84:87], v[108:111]
  ds_read_b64_tr_b16 v[164:165], v21 offset:49152
  v_mfma_f32_16x16x32_bf16 v[104:107], v[196:199], v[80:83], v[104:107]
  ds_read_b64_tr_b16 v[166:167], v21 offset:49664
  v_mfma_f32_16x16x32_bf16 v[112:115], v[200:203], v[80:83], v[112:115]
  ds_read_b64_tr_b16 v[168:169], v22 offset:49152
  v_mfma_f32_16x16x32_bf16 v[116:119], v[200:203], v[84:87], v[116:119]
  ds_read_b64_tr_b16 v[170:171], v22 offset:49664
  v_mfma_f32_16x16x32_bf16 v[124:127], v[204:207], v[84:87], v[124:127]
  ds_read_b64_tr_b16 v[172:173], v23 offset:49152
  v_mfma_f32_16x16x32_bf16 v[120:123], v[204:207], v[80:83], v[120:123]
  ds_read_b64_tr_b16 v[174:175], v23 offset:49664
  s_waitcnt vmcnt(12) lgkmcnt(8)
  v_mfma_f32_16x16x32_bf16 v[96:99], v[208:211], v[88:91], v[96:99]
  ds_read_b64_tr_b16 v[176:177], v20 offset:53248
  v_mfma_f32_16x16x32_bf16 v[100:103], v[208:211], v[92:95], v[100:103]
  ds_read_b64_tr_b16 v[178:179], v20 offset:53760
  v_mfma_f32_16x16x32_bf16 v[108:111], v[212:215], v[92:95], v[108:111]
  ds_read_b64_tr_b16 v[180:181], v21 offset:53248
  v_mfma_f32_16x16x32_bf16 v[104:107], v[212:215], v[88:91], v[104:107]
  ds_read_b64_tr_b16 v[182:183], v21 offset:53760
  v_mfma_f32_16x16x32_bf16 v[112:115], v[216:219], v[88:91], v[112:115]
  ds_read_b64_tr_b16 v[184:185], v22 offset:53248
  v_mfma_f32_16x16x32_bf16 v[116:119], v[216:219], v[92:95], v[116:119]
  ds_read_b64_tr_b16 v[186:187], v22 offset:53760
  v_mfma_f32_16x16x32_bf16 v[124:127], v[220:223], v[92:95], v[124:127]
  ds_read_b64_tr_b16 v[188:189], v23 offset:53248
  v_mfma_f32_16x16x32_bf16 v[120:123], v[220:223], v[88:91], v[120:123]
  ds_read_b64_tr_b16 v[190:191], v23 offset:53760
  s_waitcnt vmcnt(10) lgkmcnt(8)
  v_mfma_f32_16x16x32_bf16 v[96:99], v[160:163], v[224:227], v[96:99]
  ds_read_b64_tr_b16 v[192:193], v20 offset:57344
  s_waitcnt vmcnt(3)
  v_mfma_f32_16x16x32_bf16 v[100:103], v[160:163], v[228:231], v[100:103]
  ds_read_b64_tr_b16 v[194:195], v20 offset:57856
  v_lshlrev_b32 v128, 16, v144
  v_mfma_f32_16x16x32_bf16 v[108:111], v[164:167], v[228:231], v[108:111]
  ds_read_b64_tr_b16 v[196:197], v21 offset:57344
  v_and_b32 v129, s11, v144
  v_mfma_f32_16x16x32_bf16 v[104:107], v[164:167], v[224:227], v[104:107]
  ds_read_b64_tr_b16 v[198:199], v21 offset:57856
  v_lshlrev_b32 v130, 16, v145
  v_mfma_f32_16x16x32_bf16 v[112:115], v[168:171], v[224:227], v[112:115]
  ds_read_b64_tr_b16 v[200:201], v22 offset:57344
  v_and_b32 v131, s11, v145
  v_mfma_f32_16x16x32_bf16 v[116:119], v[168:171], v[228:231], v[116:119]
  ds_read_b64_tr_b16 v[202:203], v22 offset:57856
  v_lshlrev_b32 v132, 16, v146
  v_mfma_f32_16x16x32_bf16 v[124:127], v[172:175], v[228:231], v[124:127]
  ds_read_b64_tr_b16 v[204:205], v23 offset:57344
  v_and_b32 v133, s11, v146
  v_mfma_f32_16x16x32_bf16 v[120:123], v[172:175], v[224:227], v[120:123]
  ds_read_b64_tr_b16 v[206:207], v23 offset:57856
  s_waitcnt lgkmcnt(8)
  v_mfma_f32_16x16x32_bf16 v[96:99], v[176:179], v[232:235], v[96:99]
  ds_read_b64_tr_b16 v[208:209], v20 offset:61440
  v_lshlrev_b32 v134, 16, v147
  v_mfma_f32_16x16x32_bf16 v[100:103], v[176:179], v[236:239], v[100:103]
  ds_read_b64_tr_b16 v[210:211], v20 offset:61952
  v_and_b32 v135, s11, v147
  v_mfma_f32_16x16x32_bf16 v[108:111], v[180:183], v[236:239], v[108:111]
  ds_read_b64_tr_b16 v[212:213], v21 offset:61440
  v_lshlrev_b32 v136, 16, v148
  v_mfma_f32_16x16x32_bf16 v[104:107], v[180:183], v[232:235], v[104:107]
  ds_read_b64_tr_b16 v[214:215], v21 offset:61952
  v_and_b32 v137, s11, v148
  v_mfma_f32_16x16x32_bf16 v[112:115], v[184:187], v[232:235], v[112:115]
  ds_read_b64_tr_b16 v[216:217], v22 offset:61440
  v_lshlrev_b32 v138, 16, v149
  v_mfma_f32_16x16x32_bf16 v[116:119], v[184:187], v[236:239], v[116:119]
  ds_read_b64_tr_b16 v[218:219], v22 offset:61952
  v_and_b32 v139, s11, v149
  v_mfma_f32_16x16x32_bf16 v[124:127], v[188:191], v[236:239], v[124:127]
  ds_read_b64_tr_b16 v[220:221], v23 offset:61440
  v_lshlrev_b32 v140, 16, v150
  v_mfma_f32_16x16x32_bf16 v[120:123], v[188:191], v[232:235], v[120:123]
  ds_read_b64_tr_b16 v[222:223], v23 offset:61952
  s_waitcnt vmcnt(2) lgkmcnt(8)
  v_mfma_f32_16x16x32_bf16 v[96:99], v[192:195], v[240:243], v[96:99]
  v_mov_b32 v20, 0
  v_mov_b32 v21, 0
  v_mfma_f32_16x16x32_bf16 v[100:103], v[192:195], v[244:247], v[100:103]
  v_mov_b32 v22, 0
  v_mov_b32 v23, 0
  v_mfma_f32_16x16x32_bf16 v[108:111], v[196:199], v[244:247], v[108:111]
  v_and_b32 v141, s11, v150
  v_lshlrev_b32 v142, 16, v151
  v_and_b32 v143, s11, v151
  v_mfma_f32_16x16x32_bf16 v[104:107], v[196:199], v[240:243], v[104:107]
  v_lshlrev_b32 v144, 16, v152
  v_and_b32 v145, s11, v152
  v_lshlrev_b32 v146, 16, v153
  v_mfma_f32_16x16x32_bf16 v[112:115], v[200:203], v[240:243], v[112:115]
  v_and_b32 v147, s11, v153
  v_lshlrev_b32 v148, 16, v154
  v_and_b32 v149, s11, v154
  v_mfma_f32_16x16x32_bf16 v[116:119], v[200:203], v[244:247], v[116:119]
  v_lshlrev_b32 v150, 16, v155
  v_and_b32 v151, s11, v155
  v_lshlrev_b32 v152, 16, v156
  v_mfma_f32_16x16x32_bf16 v[124:127], v[204:207], v[244:247], v[124:127]
  v_and_b32 v153, s11, v156
  v_lshlrev_b32 v154, 16, v157
  v_and_b32 v155, s11, v157
  v_mfma_f32_16x16x32_bf16 v[120:123], v[204:207], v[240:243], v[120:123]
  s_waitcnt vmcnt(0) lgkmcnt(0)
  v_lshlrev_b32 v156, 16, v158
  v_and_b32 v157, s11, v158
  v_mfma_f32_16x16x32_bf16 v[96:99], v[208:211], v[248:251], v[96:99]
  v_lshlrev_b32 v158, 16, v159
  v_and_b32 v159, s11, v159
  v_mfma_f32_16x16x32_bf16 v[100:103], v[208:211], v[252:255], v[100:103]
  v_mfma_f32_16x16x32_bf16 v[108:111], v[212:215], v[252:255], v[108:111]
  v_mfma_f32_16x16x32_bf16 v[104:107], v[212:215], v[248:251], v[104:107]
  v_mfma_f32_16x16x32_bf16 v[112:115], v[216:219], v[248:251], v[112:115]
  v_mfma_f32_16x16x32_bf16 v[116:119], v[216:219], v[252:255], v[116:119]
  v_mfma_f32_16x16x32_bf16 v[124:127], v[220:223], v[252:255], v[124:127]
  v_mfma_f32_16x16x32_bf16 v[120:123], v[220:223], v[248:251], v[120:123]
  s_lshl_b32 s3, s7, 4
  s_mov_b32 s10, 0x3f803f80
  s_nop 4
  v_pk_add_f32 v[96:97], v[96:97], v[128:129]
  v_pk_add_f32 v[98:99], v[98:99], v[130:131]
  v_cvt_pk_bf16_f32 v240, v96, v97
  v_cvt_pk_bf16_f32 v241, v98, v99
  v_pk_add_f32 v[104:105], v[104:105], v[136:137]
  v_pk_add_f32 v[106:107], v[106:107], v[138:139]
  v_cvt_pk_bf16_f32 v242, v104, v105
  v_cvt_pk_bf16_f32 v243, v106, v107
  s_nop 1
  v_permlane16_swap_b32 v240, v242
  v_permlane16_swap_b32 v241, v243
  buffer_store_dwordx4 v[240:243], v12, s[44:47], 0 offen offset:0 sc1
  ds_write_b128 v4, v[240:243] offset:0
  v_pk_add_f32 v[112:113], v[112:113], v[144:145]
  v_pk_add_f32 v[114:115], v[114:115], v[146:147]
  v_cvt_pk_bf16_f32 v244, v112, v113
  v_cvt_pk_bf16_f32 v245, v114, v115
  v_pk_add_f32 v[120:121], v[120:121], v[152:153]
  v_pk_add_f32 v[122:123], v[122:123], v[154:155]
  v_cvt_pk_bf16_f32 v246, v120, v121
  v_cvt_pk_bf16_f32 v247, v122, v123
  s_nop 1
  v_permlane16_swap_b32 v244, v246
  v_permlane16_swap_b32 v245, v247
  buffer_store_dwordx4 v[244:247], v12, s[44:47], 0 offen offset:64 sc1
  ds_write_b128 v5, v[244:247] offset:0
  v_pk_add_f32 v[100:101], v[100:101], v[132:133]
  v_pk_add_f32 v[102:103], v[102:103], v[134:135]
  v_cvt_pk_bf16_f32 v248, v100, v101
  v_cvt_pk_bf16_f32 v249, v102, v103
  v_pk_add_f32 v[108:109], v[108:109], v[140:141]
  v_pk_add_f32 v[110:111], v[110:111], v[142:143]
  v_cvt_pk_bf16_f32 v250, v108, v109
  v_cvt_pk_bf16_f32 v251, v110, v111
  s_nop 1
  v_permlane16_swap_b32 v248, v250
  v_permlane16_swap_b32 v249, v251
  buffer_store_dwordx4 v[248:251], v12, s[44:47], s3 offen offset:0 sc1
  ds_write_b128 v4, v[248:251] offset:2048
  v_pk_add_f32 v[116:117], v[116:117], v[148:149]
  v_pk_add_f32 v[118:119], v[118:119], v[150:151]
  v_cvt_pk_bf16_f32 v252, v116, v117
  v_cvt_pk_bf16_f32 v253, v118, v119
  v_pk_add_f32 v[124:125], v[124:125], v[156:157]
  v_pk_add_f32 v[126:127], v[126:127], v[158:159]
  v_cvt_pk_bf16_f32 v254, v124, v125
  v_cvt_pk_bf16_f32 v255, v126, v127
  s_nop 1
  v_permlane16_swap_b32 v252, v254
  v_permlane16_swap_b32 v253, v255
  buffer_store_dwordx4 v[252:255], v12, s[44:47], s3 offen offset:64 sc1
  ds_write_b128 v5, v[252:255] offset:2048
  v_dot2_f32_bf16 v20, v240, s10, v20
  v_dot2_f32_bf16 v22, v240, v240, v22
  v_dot2_f32_bf16 v20, v241, s10, v20
  v_dot2_f32_bf16 v22, v241, v241, v22
  v_dot2_f32_bf16 v20, v242, s10, v20
  v_dot2_f32_bf16 v22, v242, v242, v22
  v_dot2_f32_bf16 v20, v243, s10, v20
  v_dot2_f32_bf16 v22, v243, v243, v22
  v_dot2_f32_bf16 v20, v244, s10, v20
  v_dot2_f32_bf16 v22, v244, v244, v22
  v_dot2_f32_bf16 v20, v245, s10, v20
  v_dot2_f32_bf16 v22, v245, v245, v22
  v_dot2_f32_bf16 v20, v246, s10, v20
  v_dot2_f32_bf16 v22, v246, v246, v22
  v_dot2_f32_bf16 v20, v247, s10, v20
  v_dot2_f32_bf16 v22, v247, v247, v22
  v_dot2_f32_bf16 v21, v248, s10, v21
  v_dot2_f32_bf16 v23, v248, v248, v23
  v_dot2_f32_bf16 v21, v249, s10, v21
  v_dot2_f32_bf16 v23, v249, v249, v23
  v_dot2_f32_bf16 v21, v250, s10, v21
  v_dot2_f32_bf16 v23, v250, v250, v23
  v_dot2_f32_bf16 v21, v251, s10, v21
  v_dot2_f32_bf16 v23, v251, v251, v23
  v_dot2_f32_bf16 v21, v252, s10, v21
  v_dot2_f32_bf16 v23, v252, v252, v23
  v_dot2_f32_bf16 v21, v253, s10, v21
  v_dot2_f32_bf16 v23, v253, v253, v23
  v_dot2_f32_bf16 v21, v254, s10, v21
  v_dot2_f32_bf16 v23, v254, v254, v23
  v_dot2_f32_bf16 v21, v255, s10, v21
  v_dot2_f32_bf16 v23, v255, v255, v23
  s_nop 2
  v_permlane32_swap_b32 v20, v21
  v_permlane32_swap_b32 v22, v23
  v_add_f32 v20, v20, v21
  v_add_f32 v22, v22, v23
  s_nop 1
  v_permlane16_swap_b32 v20, v22
  v_add_f32 v20, v20, v22
  buffer_store_dword v20, v18, s[56:59], 0 offen sc1
  s_cmp_eq_u32 s96, 1
  s_cbranch_scc1 L_w2_end
  s_waitcnt vmcnt(0) lgkmcnt(0)
  s_barrier
  s_mov_b32 s96, 1
  s_add_u32 s12, s22, 33554432
  s_addc_u32 s13, s23, 0
  s_add_u32 s34, s22, 67108864
  s_addc_u32 s35, s23, 0
  s_add_u32 s97, s97, 1
  s_branch L_attn_body
L_w2_c1:
```

```asm
; @launch grid=(256,1,1) block=(512,1,1) lds=163840
.amdgcn_target "amdgcn-amd-amdhsa--gfx950"
.text
.globl interleave_layers__sliding_local_dilated__dense_activation_gelu__prompt_kernel
.p2align 12
.fill 832, 4, 0xbf800000
.type interleave_layers__sliding_local_dilated__dense_activation_gelu__prompt_kernel,@function
interleave_layers__sliding_local_dilated__dense_activation_gelu__prompt_kernel:
L_attn_c0:
  s_load_dwordx4 s[16:19], s[0:1], 0
  s_load_dwordx2 s[20:21], s[0:1], 16
  s_load_dwordx2 s[22:23], s[0:1], 80
  s_load_dwordx8 s[24:31], s[0:1], 32
  s_load_dwordx2 s[32:33], s[0:1], 64
  s_load_dwordx2 s[34:35], s[0:1], 80
  s_load_dwordx2 s[12:13], s[0:1], 0
  s_load_dwordx2 s[64:65], s[0:1], 72
  s_mov_b32 s96, 0
  s_mov_b32 s97, 0
L_attn_body:
  s_cmp_ge_u32 s2, 256
  s_cbranch_scc1 L_attn_end
  v_lshrrev_b32 v2, 6, v0
  v_and_b32 v1, 63, v0
  v_readfirstlane_b32 s70, v2
  s_and_b32 s3, s2, 7
  s_lshr_b32 s99, s2, 3
  s_and_b32 s5, s3, 1
  s_lshl_b32 s5, s5, 3
  s_and_b32 s6, s99, 7
  s_add_u32 s68, s5, s6
  s_lshr_b32 s5, s3, 1
  s_lshl_b32 s5, s5, 2
  s_lshr_b32 s6, s99, 3
  s_add_u32 s69, s5, s6
  s_cmp_eq_u32 s96, 0
  s_cbranch_scc1 L_attn_map
  s_and_b32 s3, s2, 7
  s_and_b32 s5, s3, 3
  s_lshl_b32 s5, s5, 2
  s_and_b32 s6, s99, 3
  s_add_u32 s68, s5, s6
  s_lshr_b32 s5, s3, 2
  s_lshl_b32 s5, s5, 3
  s_lshr_b32 s6, s99, 2
  s_add_u32 s69, s5, s6
L_attn_map:
  s_cmp_lt_u32 s70, 4
  s_cbranch_scc1 L_attn_compute
L_attn_loader:
  s_add_u32 s8, s70, s69
  s_and_b32 s8, s8, 3
  s_add_u32 s9, s70, s68
  s_and_b32 s9, s9, 3
  s_lshl_b32 s76, s8, 12
  s_lshl_b32 s77, s9, 11
  s_add_u32 s77, s77, 16384
  s_lshl_b32 s11, s68, 7
  v_and_b32 v10, 7, v1
  v_lshrrev_b32 v3, 3, v1
  s_lshr_b32 s10, s76, 7
  s_lshl_b32 s3, s68, 7
  s_add_u32 s10, s10, s3
  v_add_u32 v3, s10, v3
  s_cmp_eq_u32 s96, 1
  s_cselect_b32 s5, 128, 0
  s_add_u32 s5, s5, 2048
  s_lshl_b32 s6, s5, 3
  v_mul_u32_u24 v3, s5, v3
  v_lshrrev_b32 v2, 4, v1
  v_xor_b32 v4, v2, v10
  v_lshl_add_u32 v4, v4, 4, v3
  v_add_u32 v3, s6, v3
  v_add_u32 v5, 4, v2
  v_xor_b32 v5, v5, v10
  v_lshl_add_u32 v5, v5, 4, v3
  v_add_u32 v3, s6, v3
  v_xor_b32 v6, v2, v10
  v_lshl_add_u32 v6, v6, 4, v3
  v_add_u32 v3, s6, v3
  v_add_u32 v7, 4, v2
  v_xor_b32 v7, v7, v10
  v_lshl_add_u32 v7, v7, 4, v3
  v_lshrrev_b32 v3, 3, v1
  s_lshl_b32 s10, s9, 4
  v_add_u32 v3, s10, v3
  v_mul_u32_u24 v3, 6144, v3
  v_lshrrev_b32 v2, 3, v1
  v_and_b32 v2, 2, v2
  v_xor_b32 v2, v2, v10
  s_mul_i32 s10, s69, 128
  v_add_u32 v3, s10, v3
  v_lshl_add_u32 v8, v2, 4, v3
  v_xor_b32 v2, 4, v2
  v_add_u32 v3, 49152, v3
  v_lshl_add_u32 v9, v2, 4, v3
  s_and_b32 s10, s70, 3
  s_lshl_b32 s78, s10, 9
  s_add_u32 s78, s78, 40960
  s_lshl_b32 s14, s10, 2
  s_add_u32 s14, s14, s11
  s_sub_u32 s14, s14, 16
  v_lshrrev_b32 v3, 3, v1
  v_add_u32 v3, s14, v3
  v_max_i32 v3, 0, v3
  v_mul_u32_u24 v3, s5, v3
  s_lshl_b32 s14, s10, 1
  v_lshrrev_b32 v2, 4, v1
  v_add_u32 v2, s14, v2
  v_and_b32 v2, 7, v2
  v_xor_b32 v2, v2, v10
  v_lshl_add_u32 v28, v2, 4, v3
  s_cmp_eq_u32 s10, 0
  s_cselect_b32 s14, 0xffffff00, -1
  s_mov_b32 s15, 0
  s_mov_b32 s75, 0
  s_add_u32 s100, s68, s69
  s_mov_b32 s101, -1
  s_add_u32 s3, s68, s69
  s_and_b32 s3, s3, 3
  s_mov_b32 s100, 0x75463102
  s_mov_b32 s101, 0xfdceb98a
  s_cmp_eq_u32 s3, 1
  s_cselect_b32 s100, 0x65742130, s100
  s_cselect_b32 s101, 0xedfca9b8, s101
  s_cmp_eq_u32 s3, 2
  s_cselect_b32 s100, 0x68532410, s100
  s_cselect_b32 s101, 0xfedbac97, s101
  s_cmp_eq_u32 s3, 3
  s_cselect_b32 s100, 0x96435210, s100
  s_cselect_b32 s101, 0xfecbda87, s101
  s_mov_b32 s91, s69
  s_and_b32 s92, s69, 3
  s_add_u32 s92, s92, 1
  s_and_b32 s73, s100, 15
  s_cmp_eq_u32 s73, s91
  s_cselect_b32 s74, 4, 0
  s_lshr_b64 s[100:101], s[100:101], s74
  s_and_b32 s73, s100, 15
  s_sub_u32 s92, s92, 1
  s_cselect_b32 s73, s91, s73
  s_cselect_b32 s74, 0, 4
  s_lshr_b64 s[100:101], s[100:101], s74
  s_mul_i32 s74, s73, 393216
  s_lshl_b32 s73, s73, 7
  s_waitcnt lgkmcnt(0)
  s_mov_b32 s36, s12
  s_and_b32 s37, s13, 0xffff
  s_mov_b32 s38, 4194304
  s_mov_b32 s39, 0x00020000
  s_cmp_eq_u32 s96, 1
  s_cselect_b32 s38, 128, 0
  s_add_u32 s38, s38, 2048
  s_lshl_b32 s38, s38, 11
  s_mov_b32 s40, s18
  s_and_b32 s41, s19, 0xffff
  s_mov_b32 s42, 6291456
  s_mov_b32 s43, 0x00020000
  s_cmp_lg_u32 s96, 0
  s_cbranch_scc1 L_attn_ld1
  s_mov_b32 s48, s28
  s_and_b32 s49, s29, 0xffff
  s_mov_b32 s50, 7340032
  s_mov_b32 s51, 0x00020000
  s_cmp_eq_u32 s96, 0
  s_cselect_b32 s50, s50, 0
  s_and_b32 s3, s70, 3
  s_lshl_b32 s4, s2, 2
  s_add_u32 s3, s3, s4
  s_mul_i32 s98, s3, 3584
  s_add_u32 s98, s98, 0
  s_add_u32 s3, s75, s76
  s_add_u32 m0, s3, 0
  s_nop 0
  buffer_load_dwordx4 v4, s[36:39], s73 offen lds
  s_add_u32 m0, s3, 1024
  s_nop 0
  buffer_load_dwordx4 v5, s[36:39], s73 offen lds
  s_add_u32 m0, s3, 2048
  s_nop 0
  buffer_load_dwordx4 v6, s[36:39], s73 offen lds
  s_add_u32 m0, s3, 3072
  s_nop 0
  buffer_load_dwordx4 v7, s[36:39], s73 offen lds
  s_add_u32 m0, s78, s75
  s_mov_b64 exec, s[14:15]
  buffer_load_dwordx4 v28, s[36:39], s73 offen lds
  s_mov_b64 exec, -1
  s_add_u32 s3, s75, s77
  s_add_u32 m0, s3, 0
  s_add_u32 s4, s74, 0
  buffer_load_dwordx4 v8, s[40:43], s4 offen lds
  s_add_u32 m0, s3, 1024
  s_nop 0
  buffer_load_dwordx4 v9, s[40:43], s4 offen lds
  s_add_u32 m0, s3, 8192
  s_add_u32 s4, s74, 2048
  buffer_load_dwordx4 v8, s[40:43], s4 offen lds
  s_add_u32 m0, s3, 9216
  s_nop 0
  buffer_load_dwordx4 v9, s[40:43], s4 offen lds
  s_add_u32 m0, s3, 16384
  s_add_u32 s4, s74, 4096
  buffer_load_dwordx4 v8, s[40:43], s4 offen lds
  s_add_u32 m0, s3, 17408
  s_nop 0
  buffer_load_dwordx4 v9, s[40:43], s4 offen lds
  s_and_b32 s73, s100, 15
  s_cmp_eq_u32 s73, s91
  s_cselect_b32 s74, 4, 0
  s_lshr_b64 s[100:101], s[100:101], s74
  s_and_b32 s73, s100, 15
  s_sub_u32 s92, s92, 1
  s_cselect_b32 s73, s91, s73
  s_cselect_b32 s74, 0, 4
  s_lshr_b64 s[100:101], s[100:101], s74
  s_mul_i32 s74, s73, 393216
  s_lshl_b32 s73, s73, 7
  s_add_u32 s75, s75, 43008
  s_cmp_eq_u32 s75, 129024
  s_cselect_b32 s75, 0, s75
  s_add_u32 s3, s75, s76
  s_add_u32 m0, s3, 0
  s_nop 0
  buffer_load_dwordx4 v4, s[36:39], s73 offen lds
  s_add_u32 m0, s3, 1024
  s_nop 0
  buffer_load_dwordx4 v5, s[36:39], s73 offen lds
  s_add_u32 m0, s3, 2048
  s_nop 0
  buffer_load_dwordx4 v6, s[36:39], s73 offen lds
  s_add_u32 m0, s3, 3072
  s_nop 0
  buffer_load_dwordx4 v7, s[36:39], s73 offen lds
  s_add_u32 m0, s78, s75
  s_mov_b64 exec, s[14:15]
  buffer_load_dwordx4 v28, s[36:39], s73 offen lds
  s_mov_b64 exec, -1
  s_add_u32 s3, s75, s77
  s_add_u32 m0, s3, 0
  s_add_u32 s4, s74, 0
  buffer_load_dwordx4 v8, s[40:43], s4 offen lds
  s_add_u32 m0, s3, 1024
  s_nop 0
  buffer_load_dwordx4 v9, s[40:43], s4 offen lds
  s_add_u32 m0, s3, 8192
  s_add_u32 s4, s74, 2048
  buffer_load_dwordx4 v8, s[40:43], s4 offen lds
  s_add_u32 m0, s3, 9216
  s_nop 0
  buffer_load_dwordx4 v9, s[40:43], s4 offen lds
  s_add_u32 m0, s3, 16384
  s_add_u32 s4, s74, 4096
  buffer_load_dwordx4 v8, s[40:43], s4 offen lds
  s_add_u32 m0, s3, 17408
  s_nop 0
  buffer_load_dwordx4 v9, s[40:43], s4 offen lds
  s_and_b32 s73, s100, 15
  s_cmp_eq_u32 s73, s91
  s_cselect_b32 s74, 4, 0
  s_lshr_b64 s[100:101], s[100:101], s74
  s_and_b32 s73, s100, 15
  s_sub_u32 s92, s92, 1
  s_cselect_b32 s73, s91, s73
  s_cselect_b32 s74, 0, 4
  s_lshr_b64 s[100:101], s[100:101], s74
  s_mul_i32 s74, s73, 393216
  s_lshl_b32 s73, s73, 7
  s_add_u32 s75, s75, 43008
  s_cmp_eq_u32 s75, 129024
  s_cselect_b32 s75, 0, s75
  s_mov_b32 s52, s24
  s_and_b32 s53, s25, 0xffff
  s_mov_b32 s54, 7340032
  s_mov_b32 s55, 0x00020000
  s_min_u32 s3, s2, 223
  s_mul_i32 s4, s3, 4682
  s_lshr_b32 s4, s4, 16
  s_mul_i32 s5, s4, 14
  s_sub_u32 s3, s3, s5
  s_lshl_b32 s3, s3, 2
  s_and_b32 s5, s70, 3
  s_add_u32 s3, s3, s5
  s_mul_i32 s5, s4, 458752
  s_lshl_b32 s8, s3, 7
  s_add_u32 s95, s5, s8
  s_lshl_b32 s9, s4, 14
  s_lshl_b32 s8, s3, 8
  s_add_u32 s94, s9, s8
  v_lshrrev_b32 v2, 3, v1
  v_mul_u32_u24 v2, 7168, v2
  v_and_b32 v3, 7, v1
  v_lshl_add_u32 v26, v3, 4, v2
  s_and_b32 s3, s70, 3
  s_lshl_b32 s4, s2, 2
  s_add_u32 s3, s3, s4
  s_sub_u32 s4, 384, s40
  s_and_b32 s4, s4, 0x380
  s_mul_i32 s5, s3, 6144
  s_add_u32 s5, s5, s4
  s_buffer_load_dword s84, s[40:43], s5 offset:0
  s_buffer_load_dword s84, s[40:43], s5 offset:64
  s_buffer_load_dword s84, s[40:43], s5 offset:1024
  s_buffer_load_dword s84, s[40:43], s5 offset:1088
  s_buffer_load_dword s84, s[40:43], s5 offset:2048
  s_buffer_load_dword s84, s[40:43], s5 offset:2112
  s_buffer_load_dword s84, s[40:43], s5 offset:3072
  s_buffer_load_dword s84, s[40:43], s5 offset:3136
  s_buffer_load_dword s84, s[40:43], s5 offset:4096
  s_buffer_load_dword s84, s[40:43], s5 offset:4160
  s_buffer_load_dword s84, s[40:43], s5 offset:5120
  s_buffer_load_dword s84, s[40:43], s5 offset:5184
  s_add_u32 s56, s22, 24903680
  s_addc_u32 s57, s23, 0
  s_and_b32 s57, s57, 0xffff
  s_mov_b32 s58, 262144
  s_mov_b32 s59, 0x00020000
  s_and_b32 s3, s70, 3
  s_lshl2_add_u32 s4, s68, s3
  s_lshl_b32 s4, s4, 8
  v_lshrrev_b32 v2, 4, v1
  v_and_b32 v3, 15, v1
  v_lshl_add_u32 v3, v3, 4, s4
  v_lshl_add_u32 v18, v2, 14, v3
  s_lshl_b32 s4, s68, 5
  s_add_u32 s4, s4, s3
  s_sub_u32 s4, s4, 4
  s_max_i32 s4, s4, 0
  s_lshl_b32 s4, s4, 5
  v_lshrrev_b32 v2, 2, v1
  v_and_b32 v3, 3, v1
  v_lshl_add_u32 v3, v3, 3, s4
  v_lshl_add_u32 v19, v2, 14, v3
  s_lshl_b32 s3, s68, 2
  s_sub_u32 s3, s3, 4
  v_and_b32 v20, 7, v1
  v_add_u32 v20, s3, v20
  v_max_i32 v20, 0, v20
  v_lshlrev_b32 v20, 2, v20
  s_and_b32 s65, s65, 0xffff
  s_mov_b32 s66, 256
  s_mov_b32 s67, 0x00020000
  s_waitcnt vmcnt(11)
  s_barrier
  s_add_u32 s3, s75, s76
  s_add_u32 m0, s3, 0
  s_nop 0
  buffer_load_dwordx4 v4, s[36:39], s73 offen lds
  s_add_u32 m0, s3, 1024
  s_nop 0
  buffer_load_dwordx4 v5, s[36:39], s73 offen lds
  s_add_u32 m0, s3, 2048
  s_nop 0
  buffer_load_dwordx4 v6, s[36:39], s73 offen lds
  s_add_u32 m0, s3, 3072
  s_nop 0
  buffer_load_dwordx4 v7, s[36:39], s73 offen lds
  s_add_u32 m0, s78, s75
  s_mov_b64 exec, s[14:15]
  buffer_load_dwordx4 v28, s[36:39], s73 offen lds
  s_mov_b64 exec, -1
  s_add_u32 s3, s75, s77
  s_add_u32 m0, s3, 0
  s_add_u32 s4, s74, 0
  buffer_load_dwordx4 v8, s[40:43], s4 offen lds
  s_add_u32 m0, s3, 1024
  s_nop 0
  buffer_load_dwordx4 v9, s[40:43], s4 offen lds
  s_add_u32 m0, s3, 8192
  s_add_u32 s4, s74, 2048
  buffer_load_dwordx4 v8, s[40:43], s4 offen lds
  s_add_u32 m0, s3, 9216
  s_nop 0
  buffer_load_dwordx4 v9, s[40:43], s4 offen lds
  s_add_u32 m0, s3, 16384
  s_add_u32 s4, s74, 4096
  buffer_load_dwordx4 v8, s[40:43], s4 offen lds
  s_add_u32 m0, s3, 17408
  s_nop 0
  buffer_load_dwordx4 v9, s[40:43], s4 offen lds
  s_and_b32 s73, s100, 15
  s_cmp_eq_u32 s73, s91
  s_cselect_b32 s74, 4, 0
  s_lshr_b64 s[100:101], s[100:101], s74
  s_and_b32 s73, s100, 15
  s_sub_u32 s92, s92, 1
  s_cselect_b32 s73, s91, s73
  s_cselect_b32 s74, 0, 4
  s_lshr_b64 s[100:101], s[100:101], s74
  s_mul_i32 s74, s73, 393216
  s_lshl_b32 s73, s73, 7
  s_add_u32 s75, s75, 43008
  s_cmp_eq_u32 s75, 129024
  s_cselect_b32 s75, 0, s75
  s_buffer_load_dword s84, s[48:51], s98 offset:0
  s_buffer_load_dword s84, s[48:51], s98 offset:64
  s_buffer_load_dword s84, s[48:51], s98 offset:128
  s_buffer_load_dword s84, s[48:51], s98 offset:192
  s_add_u32 s98, s98, 256
  buffer_load_dwordx4 v[64:67], v26, s[52:55], s95 offen
  s_add_u32 s95, s95, 57344
  buffer_load_dwordx4 v[68:71], v26, s[52:55], s95 offen
  s_add_u32 s95, s95, 57344
  s_waitcnt vmcnt(13)
  s_barrier
  s_add_u32 s3, s75, s76
  s_add_u32 m0, s3, 0
  s_nop 0
  buffer_load_dwordx4 v4, s[36:39], s73 offen lds
  s_add_u32 m0, s3, 1024
  s_nop 0
  buffer_load_dwordx4 v5, s[36:39], s73 offen lds
  s_add_u32 m0, s3, 2048
  s_nop 0
  buffer_load_dwordx4 v6, s[36:39], s73 offen lds
  s_add_u32 m0, s3, 3072
  s_nop 0
  buffer_load_dwordx4 v7, s[36:39], s73 offen lds
  s_add_u32 m0, s78, s75
  s_mov_b64 exec, s[14:15]
  buffer_load_dwordx4 v28, s[36:39], s73 offen lds
  s_mov_b64 exec, -1
  s_add_u32 s3, s75, s77
  s_add_u32 m0, s3, 0
  s_add_u32 s4, s74, 0
  buffer_load_dwordx4 v8, s[40:43], s4 offen lds
  s_add_u32 m0, s3, 1024
  s_nop 0
  buffer_load_dwordx4 v9, s[40:43], s4 offen lds
  s_add_u32 m0, s3, 8192
  s_add_u32 s4, s74, 2048
  buffer_load_dwordx4 v8, s[40:43], s4 offen lds
  s_add_u32 m0, s3, 9216
  s_nop 0
  buffer_load_dwordx4 v9, s[40:43], s4 offen lds
  s_add_u32 m0, s3, 16384
  s_add_u32 s4, s74, 4096
  buffer_load_dwordx4 v8, s[40:43], s4 offen lds
  s_add_u32 m0, s3, 17408
  s_nop 0
  buffer_load_dwordx4 v9, s[40:43], s4 offen lds
  s_and_b32 s73, s100, 15
  s_cmp_eq_u32 s73, s91
  s_cselect_b32 s74, 4, 0
  s_lshr_b64 s[100:101], s[100:101], s74
  s_and_b32 s73, s100, 15
  s_sub_u32 s92, s92, 1
  s_cselect_b32 s73, s91, s73
  s_cselect_b32 s74, 0, 4
  s_lshr_b64 s[100:101], s[100:101], s74
  s_mul_i32 s74, s73, 393216
  s_lshl_b32 s73, s73, 7
  s_add_u32 s75, s75, 43008
  s_cmp_eq_u32 s75, 129024
  s_cselect_b32 s75, 0, s75
  s_buffer_load_dword s84, s[48:51], s98 offset:0
  s_buffer_load_dword s84, s[48:51], s98 offset:64
  s_buffer_load_dword s84, s[48:51], s98 offset:128
  s_buffer_load_dword s84, s[48:51], s98 offset:192
  s_add_u32 s98, s98, 256
  buffer_load_dwordx4 v[72:75], v26, s[52:55], s95 offen
  s_add_u32 s95, s95, 57344
  buffer_load_dwordx4 v[76:79], v26, s[52:55], s95 offen
  s_add_u32 s95, s95, 57344
  s_waitcnt vmcnt(15)
  s_barrier
  s_add_u32 s3, s75, s76
  s_add_u32 m0, s3, 0
  s_nop 0
  buffer_load_dwordx4 v4, s[36:39], s73 offen lds
  s_add_u32 m0, s3, 1024
  s_nop 0
  buffer_load_dwordx4 v5, s[36:39], s73 offen lds
  s_add_u32 m0, s3, 2048
  s_nop 0
  buffer_load_dwordx4 v6, s[36:39], s73 offen lds
  s_add_u32 m0, s3, 3072
  s_nop 0
  buffer_load_dwordx4 v7, s[36:39], s73 offen lds
  s_add_u32 m0, s78, s75
  s_mov_b64 exec, s[14:15]
  buffer_load_dwordx4 v28, s[36:39], s73 offen lds
  s_mov_b64 exec, -1
  s_add_u32 s3, s75, s77
  s_add_u32 m0, s3, 0
  s_add_u32 s4, s74, 0
  buffer_load_dwordx4 v8, s[40:43], s4 offen lds
  s_add_u32 m0, s3, 1024
  s_nop 0
  buffer_load_dwordx4 v9, s[40:43], s4 offen lds
  s_add_u32 m0, s3, 8192
  s_add_u32 s4, s74, 2048
  buffer_load_dwordx4 v8, s[40:43], s4 offen lds
  s_add_u32 m0, s3, 9216
  s_nop 0
  buffer_load_dwordx4 v9, s[40:43], s4 offen lds
  s_add_u32 m0, s3, 16384
  s_add_u32 s4, s74, 4096
  buffer_load_dwordx4 v8, s[40:43], s4 offen lds
  s_add_u32 m0, s3, 17408
  s_nop 0
  buffer_load_dwordx4 v9, s[40:43], s4 offen lds
  s_and_b32 s73, s100, 15
  s_cmp_eq_u32 s73, s91
  s_cselect_b32 s74, 4, 0
  s_lshr_b64 s[100:101], s[100:101], s74
  s_and_b32 s73, s100, 15
  s_sub_u32 s92, s92, 1
  s_cselect_b32 s73, s91, s73
  s_cselect_b32 s74, 0, 4
  s_lshr_b64 s[100:101], s[100:101], s74
  s_mul_i32 s74, s73, 393216
  s_lshl_b32 s73, s73, 7
  s_add_u32 s75, s75, 43008
  s_cmp_eq_u32 s75, 129024
  s_cselect_b32 s75, 0, s75
  s_buffer_load_dword s84, s[48:51], s98 offset:0
  s_buffer_load_dword s84, s[48:51], s98 offset:64
  s_buffer_load_dword s84, s[48:51], s98 offset:128
  s_buffer_load_dword s84, s[48:51], s98 offset:192
  s_add_u32 s98, s98, 256
  buffer_load_dwordx4 v[80:83], v26, s[52:55], s95 offen
  s_add_u32 s95, s95, 57344
  buffer_load_dwordx4 v[84:87], v26, s[52:55], s95 offen
  s_add_u32 s95, s95, 57344
  s_waitcnt vmcnt(15)
  s_barrier
  s_add_u32 s3, s75, s76
  s_add_u32 m0, s3, 0
  s_nop 0
  buffer_load_dwordx4 v4, s[36:39], s73 offen lds
  s_add_u32 m0, s3, 1024
  s_nop 0
  buffer_load_dwordx4 v5, s[36:39], s73 offen lds
  s_add_u32 m0, s3, 2048
  s_nop 0
  buffer_load_dwordx4 v6, s[36:39], s73 offen lds
  s_add_u32 m0, s3, 3072
  s_nop 0
  buffer_load_dwordx4 v7, s[36:39], s73 offen lds
  s_add_u32 m0, s78, s75
  s_mov_b64 exec, s[14:15]
  buffer_load_dwordx4 v28, s[36:39], s73 offen lds
  s_mov_b64 exec, -1
  s_add_u32 s3, s75, s77
  s_add_u32 m0, s3, 0
  s_add_u32 s4, s74, 0
  buffer_load_dwordx4 v8, s[40:43], s4 offen lds
  s_add_u32 m0, s3, 1024
  s_nop 0
  buffer_load_dwordx4 v9, s[40:43], s4 offen lds
  s_add_u32 m0, s3, 8192
  s_add_u32 s4, s74, 2048
  buffer_load_dwordx4 v8, s[40:43], s4 offen lds
  s_add_u32 m0, s3, 9216
  s_nop 0
  buffer_load_dwordx4 v9, s[40:43], s4 offen lds
  s_add_u32 m0, s3, 16384
  s_add_u32 s4, s74, 4096
  buffer_load_dwordx4 v8, s[40:43], s4 offen lds
  s_add_u32 m0, s3, 17408
  s_nop 0
  buffer_load_dwordx4 v9, s[40:43], s4 offen lds
  s_and_b32 s73, s100, 15
  s_cmp_eq_u32 s73, s91
  s_cselect_b32 s74, 4, 0
  s_lshr_b64 s[100:101], s[100:101], s74
  s_and_b32 s73, s100, 15
  s_sub_u32 s92, s92, 1
  s_cselect_b32 s73, s91, s73
  s_cselect_b32 s74, 0, 4
  s_lshr_b64 s[100:101], s[100:101], s74
  s_mul_i32 s74, s73, 393216
  s_lshl_b32 s73, s73, 7
  s_add_u32 s75, s75, 43008
  s_cmp_eq_u32 s75, 129024
  s_cselect_b32 s75, 0, s75
  s_buffer_load_dword s84, s[48:51], s98 offset:0
  s_buffer_load_dword s84, s[48:51], s98 offset:64
  s_buffer_load_dword s84, s[48:51], s98 offset:128
  s_buffer_load_dword s84, s[48:51], s98 offset:192
  s_add_u32 s98, s98, 256
  buffer_load_dwordx4 v[88:91], v26, s[52:55], s95 offen
  s_add_u32 s95, s95, 57344
  buffer_load_dwordx4 v[92:95], v26, s[52:55], s95 offen
  s_waitcnt vmcnt(15)
  s_barrier
  s_add_u32 s3, s75, s76
  s_add_u32 m0, s3, 0
  s_nop 0
  buffer_load_dwordx4 v4, s[36:39], s73 offen lds
  s_add_u32 m0, s3, 1024
  s_nop 0
  buffer_load_dwordx4 v5, s[36:39], s73 offen lds
  s_add_u32 m0, s3, 2048
  s_nop 0
  buffer_load_dwordx4 v6, s[36:39], s73 offen lds
  s_add_u32 m0, s3, 3072
  s_nop 0
  buffer_load_dwordx4 v7, s[36:39], s73 offen lds
  s_add_u32 m0, s78, s75
  s_mov_b64 exec, s[14:15]
  buffer_load_dwordx4 v28, s[36:39], s73 offen lds
  s_mov_b64 exec, -1
  s_add_u32 s3, s75, s77
  s_add_u32 m0, s3, 0
  s_add_u32 s4, s74, 0
  buffer_load_dwordx4 v8, s[40:43], s4 offen lds
  s_add_u32 m0, s3, 1024
  s_nop 0
  buffer_load_dwordx4 v9, s[40:43], s4 offen lds
  s_add_u32 m0, s3, 8192
  s_add_u32 s4, s74, 2048
  buffer_load_dwordx4 v8, s[40:43], s4 offen lds
  s_add_u32 m0, s3, 9216
  s_nop 0
  buffer_load_dwordx4 v9, s[40:43], s4 offen lds
  s_add_u32 m0, s3, 16384
  s_add_u32 s4, s74, 4096
  buffer_load_dwordx4 v8, s[40:43], s4 offen lds
  s_add_u32 m0, s3, 17408
  s_nop 0
  buffer_load_dwordx4 v9, s[40:43], s4 offen lds
  s_and_b32 s73, s100, 15
  s_cmp_eq_u32 s73, s91
  s_cselect_b32 s74, 4, 0
  s_lshr_b64 s[100:101], s[100:101], s74
  s_and_b32 s73, s100, 15
  s_sub_u32 s92, s92, 1
  s_cselect_b32 s73, s91, s73
  s_cselect_b32 s74, 0, 4
  s_lshr_b64 s[100:101], s[100:101], s74
  s_mul_i32 s74, s73, 393216
  s_lshl_b32 s73, s73, 7
  s_add_u32 s75, s75, 43008
  s_cmp_eq_u32 s75, 129024
  s_cselect_b32 s75, 0, s75
  s_buffer_load_dword s84, s[48:51], s98 offset:0
  s_buffer_load_dword s84, s[48:51], s98 offset:64
  s_buffer_load_dword s84, s[48:51], s98 offset:128
  s_buffer_load_dword s84, s[48:51], s98 offset:192
  s_add_u32 s98, s98, 256
  s_waitcnt vmcnt(13)
  s_barrier
  s_mov_b32 s79, 6
L_attn0_ld1:
  s_add_u32 s3, s75, s76
  s_add_u32 m0, s3, 0
  s_nop 0
  buffer_load_dwordx4 v4, s[36:39], s73 offen lds
  s_add_u32 m0, s3, 1024
  s_nop 0
  buffer_load_dwordx4 v5, s[36:39], s73 offen lds
  s_add_u32 m0, s3, 2048
  s_nop 0
  buffer_load_dwordx4 v6, s[36:39], s73 offen lds
  s_add_u32 m0, s3, 3072
  s_nop 0
  buffer_load_dwordx4 v7, s[36:39], s73 offen lds
  s_add_u32 m0, s78, s75
  s_mov_b64 exec, s[14:15]
  buffer_load_dwordx4 v28, s[36:39], s73 offen lds
  s_mov_b64 exec, -1
  s_add_u32 s3, s75, s77
  s_add_u32 m0, s3, 0
  s_add_u32 s4, s74, 0
  buffer_load_dwordx4 v8, s[40:43], s4 offen lds
  s_add_u32 m0, s3, 1024
  s_nop 0
  buffer_load_dwordx4 v9, s[40:43], s4 offen lds
  s_add_u32 m0, s3, 8192
  s_add_u32 s4, s74, 2048
  buffer_load_dwordx4 v8, s[40:43], s4 offen lds
  s_add_u32 m0, s3, 9216
  s_nop 0
  buffer_load_dwordx4 v9, s[40:43], s4 offen lds
  s_add_u32 m0, s3, 16384
  s_add_u32 s4, s74, 4096
  buffer_load_dwordx4 v8, s[40:43], s4 offen lds
  s_add_u32 m0, s3, 17408
  s_nop 0
  buffer_load_dwordx4 v9, s[40:43], s4 offen lds
  s_and_b32 s73, s100, 15
  s_cmp_eq_u32 s73, s91
  s_cselect_b32 s74, 4, 0
  s_lshr_b64 s[100:101], s[100:101], s74
  s_and_b32 s73, s100, 15
  s_sub_u32 s92, s92, 1
  s_cselect_b32 s73, s91, s73
  s_cselect_b32 s74, 0, 4
  s_lshr_b64 s[100:101], s[100:101], s74
  s_mul_i32 s74, s73, 393216
  s_lshl_b32 s73, s73, 7
  s_add_u32 s75, s75, 43008
  s_cmp_eq_u32 s75, 129024
  s_cselect_b32 s75, 0, s75
  s_buffer_load_dword s84, s[48:51], s98 offset:0
  s_buffer_load_dword s84, s[48:51], s98 offset:64
  s_buffer_load_dword s84, s[48:51], s98 offset:128
  s_buffer_load_dword s84, s[48:51], s98 offset:192
  s_add_u32 s98, s98, 256
  s_waitcnt vmcnt(11)
  s_barrier
  s_sub_u32 s79, s79, 1
  s_cmp_lg_u32 s79, 0
  s_cbranch_scc1 L_attn0_ld1
  s_add_u32 s3, s75, s76
  s_add_u32 m0, s3, 0
  s_nop 0
  buffer_load_dwordx4 v4, s[36:39], s73 offen lds
  s_add_u32 m0, s3, 1024
  s_nop 0
  buffer_load_dwordx4 v5, s[36:39], s73 offen lds
  s_add_u32 m0, s3, 2048
  s_nop 0
  buffer_load_dwordx4 v6, s[36:39], s73 offen lds
  s_add_u32 m0, s3, 3072
  s_nop 0
  buffer_load_dwordx4 v7, s[36:39], s73 offen lds
  s_add_u32 m0, s78, s75
  s_mov_b64 exec, s[14:15]
  buffer_load_dwordx4 v28, s[36:39], s73 offen lds
  s_mov_b64 exec, -1
  s_add_u32 s3, s75, s77
  s_add_u32 m0, s3, 0
  s_add_u32 s4, s74, 0
  buffer_load_dwordx4 v8, s[40:43], s4 offen lds
  s_add_u32 m0, s3, 1024
  s_nop 0
  buffer_load_dwordx4 v9, s[40:43], s4 offen lds
  s_add_u32 m0, s3, 8192
  s_add_u32 s4, s74, 2048
  buffer_load_dwordx4 v8, s[40:43], s4 offen lds
  s_add_u32 m0, s3, 9216
  s_nop 0
  buffer_load_dwordx4 v9, s[40:43], s4 offen lds
  s_add_u32 m0, s3, 16384
  s_add_u32 s4, s74, 4096
  buffer_load_dwordx4 v8, s[40:43], s4 offen lds
  s_add_u32 m0, s3, 17408
  s_nop 0
  buffer_load_dwordx4 v9, s[40:43], s4 offen lds
  s_and_b32 s73, s100, 15
  s_cmp_eq_u32 s73, s91
  s_cselect_b32 s74, 4, 0
  s_lshr_b64 s[100:101], s[100:101], s74
  s_and_b32 s73, s100, 15
  s_sub_u32 s92, s92, 1
  s_cselect_b32 s73, s91, s73
  s_cselect_b32 s74, 0, 4
  s_lshr_b64 s[100:101], s[100:101], s74
  s_mul_i32 s74, s73, 393216
  s_lshl_b32 s73, s73, 7
  s_add_u32 s75, s75, 43008
  s_cmp_eq_u32 s75, 129024
  s_cselect_b32 s75, 0, s75
  s_buffer_load_dword s84, s[48:51], s98 offset:0
  s_buffer_load_dword s84, s[48:51], s98 offset:64
  s_buffer_load_dword s84, s[48:51], s98 offset:128
  s_buffer_load_dword s84, s[48:51], s98 offset:192
  s_add_u32 s98, s98, 256
  buffer_load_dword v21, v20, s[64:67], 0 offen sc1
  s_waitcnt vmcnt(12)
  s_barrier
  s_add_u32 s3, s75, s76
  s_add_u32 m0, s3, 0
  s_nop 0
  buffer_load_dwordx4 v4, s[36:39], s73 offen lds
  s_add_u32 m0, s3, 1024
  s_nop 0
  buffer_load_dwordx4 v5, s[36:39], s73 offen lds
  s_add_u32 m0, s3, 2048
  s_nop 0
  buffer_load_dwordx4 v6, s[36:39], s73 offen lds
  s_add_u32 m0, s3, 3072
  s_nop 0
  buffer_load_dwordx4 v7, s[36:39], s73 offen lds
  s_add_u32 m0, s78, s75
  s_mov_b64 exec, s[14:15]
  buffer_load_dwordx4 v28, s[36:39], s73 offen lds
  s_mov_b64 exec, -1
  s_add_u32 s3, s75, s77
  s_add_u32 m0, s3, 0
  s_add_u32 s4, s74, 0
  buffer_load_dwordx4 v8, s[40:43], s4 offen lds
  s_add_u32 m0, s3, 1024
  s_nop 0
  buffer_load_dwordx4 v9, s[40:43], s4 offen lds
  s_add_u32 m0, s3, 8192
  s_add_u32 s4, s74, 2048
  buffer_load_dwordx4 v8, s[40:43], s4 offen lds
  s_add_u32 m0, s3, 9216
  s_nop 0
  buffer_load_dwordx4 v9, s[40:43], s4 offen lds
  s_add_u32 m0, s3, 16384
  s_add_u32 s4, s74, 4096
  buffer_load_dwordx4 v8, s[40:43], s4 offen lds
  s_add_u32 m0, s3, 17408
  s_nop 0
  buffer_load_dwordx4 v9, s[40:43], s4 offen lds
  s_and_b32 s73, s100, 15
  s_cmp_eq_u32 s73, s91
  s_cselect_b32 s74, 4, 0
  s_lshr_b64 s[100:101], s[100:101], s74
  s_and_b32 s73, s100, 15
  s_sub_u32 s92, s92, 1
  s_cselect_b32 s73, s91, s73
  s_cselect_b32 s74, 0, 4
  s_lshr_b64 s[100:101], s[100:101], s74
  s_mul_i32 s74, s73, 393216
  s_lshl_b32 s73, s73, 7
  s_add_u32 s75, s75, 43008
  s_cmp_eq_u32 s75, 129024
  s_cselect_b32 s75, 0, s75
  s_buffer_load_dword s84, s[48:51], s98 offset:0
  s_buffer_load_dword s84, s[48:51], s98 offset:64
  s_buffer_load_dword s84, s[48:51], s98 offset:128
  s_buffer_load_dword s84, s[48:51], s98 offset:192
  s_add_u32 s98, s98, 256
  s_waitcnt vmcnt(12)
  s_barrier
  s_add_u32 s3, s75, s76
  s_add_u32 m0, s3, 0
  s_nop 0
  buffer_load_dwordx4 v4, s[36:39], s73 offen lds
  s_add_u32 m0, s3, 1024
  s_nop 0
  buffer_load_dwordx4 v5, s[36:39], s73 offen lds
  s_add_u32 m0, s3, 2048
  s_nop 0
  buffer_load_dwordx4 v6, s[36:39], s73 offen lds
  s_add_u32 m0, s3, 3072
  s_nop 0
  buffer_load_dwordx4 v7, s[36:39], s73 offen lds
  s_add_u32 m0, s78, s75
  s_mov_b64 exec, s[14:15]
  buffer_load_dwordx4 v28, s[36:39], s73 offen lds
  s_mov_b64 exec, -1
  s_add_u32 s3, s75, s77
  s_add_u32 m0, s3, 0
  s_add_u32 s4, s74, 0
  buffer_load_dwordx4 v8, s[40:43], s4 offen lds
  s_add_u32 m0, s3, 1024
  s_nop 0
  buffer_load_dwordx4 v9, s[40:43], s4 offen lds
  s_add_u32 m0, s3, 8192
  s_add_u32 s4, s74, 2048
  buffer_load_dwordx4 v8, s[40:43], s4 offen lds
  s_add_u32 m0, s3, 9216
  s_nop 0
  buffer_load_dwordx4 v9, s[40:43], s4 offen lds
  s_add_u32 m0, s3, 16384
  s_add_u32 s4, s74, 4096
  buffer_load_dwordx4 v8, s[40:43], s4 offen lds
  s_add_u32 m0, s3, 17408
  s_nop 0
  buffer_load_dwordx4 v9, s[40:43], s4 offen lds
  s_and_b32 s73, s100, 15
  s_cmp_eq_u32 s73, s91
  s_cselect_b32 s74, 4, 0
  s_lshr_b64 s[100:101], s[100:101], s74
  s_and_b32 s73, s100, 15
  s_sub_u32 s92, s92, 1
  s_cselect_b32 s73, s91, s73
  s_cselect_b32 s74, 0, 4
  s_lshr_b64 s[100:101], s[100:101], s74
  s_mul_i32 s74, s73, 393216
  s_lshl_b32 s73, s73, 7
  s_add_u32 s75, s75, 43008
  s_cmp_eq_u32 s75, 129024
  s_cselect_b32 s75, 0, s75
  s_buffer_load_dword s84, s[48:51], s98 offset:0
  s_buffer_load_dword s84, s[48:51], s98 offset:64
  s_buffer_load_dword s84, s[48:51], s98 offset:128
  s_buffer_load_dword s84, s[48:51], s98 offset:192
  s_add_u32 s98, s98, 256
  s_waitcnt vmcnt(11)
  s_barrier
  s_mov_b32 s5, 0x100000
  L_attn_dchk:
  v_cmp_ne_u32 vcc, 0x01010101, v21
  s_cbranch_vccz L_attn_dok
  s_sub_u32 s5, s5, 1
  buffer_load_dword v21, v20, s[64:67], 0 offen sc1
  s_waitcnt vmcnt(0)
  s_cbranch_scc0 L_attn_dchk
  L_attn_dok:
  buffer_load_dwordx4 v[32:35], v18, s[56:59], 0 offen
  s_mov_b32 s3, 65536
  buffer_load_dwordx4 v[36:39], v18, s[56:59], s3 offen
  s_mov_b32 s3, 131072
  buffer_load_dwordx4 v[40:43], v18, s[56:59], s3 offen
  s_mov_b32 s3, 196608
  buffer_load_dwordx4 v[44:47], v18, s[56:59], s3 offen
  buffer_load_dwordx2 v[48:49], v19, s[56:59], 0 offen
  s_mov_b32 s60, s20
  s_and_b32 s61, s21, 0xffff
  s_mov_b32 s62, 2097152
  s_mov_b32 s63, 0x00020000
  s_and_b32 s3, s70, 3
  s_mul_i32 s3, s3, 8
  s_mul_i32 s4, s99, 32
  s_add_u32 s3, s3, s4
  v_lshrrev_b32 v2, 3, v1
  v_add_u32 v2, s3, v2
  v_mul_u32_u24 v2, 2048, v2
  v_and_b32 v3, 7, v1
  v_lshl_add_u32 v2, v3, 8, v2
  s_and_b32 s3, s2, 7
  s_lshr_b32 s3, s3, 2
  s_mul_i32 s3, s3, 128
  buffer_load_dword v96, v2, s[60:63], s3 offen
  s_waitcnt vmcnt(6)
  s_barrier
  s_mov_b32 s79, 0x4000
  s_waitcnt vmcnt(1)
L_attn_schk:
  v_pk_add_f32 v[32:33], v[32:33], v[36:37]
  v_pk_add_f32 v[34:35], v[34:35], v[38:39]
  v_pk_add_f32 v[40:41], v[40:41], v[44:45]
  v_pk_add_f32 v[42:43], v[42:43], v[46:47]
  v_pk_add_f32 v[32:33], v[32:33], v[40:41]
  v_pk_add_f32 v[34:35], v[34:35], v[42:43]
  s_nop 1
  v_permlane32_swap_b32 v32, v34
  v_permlane32_swap_b32 v33, v35
  v_pk_add_f32 v[32:33], v[32:33], v[34:35]
  v_cmp_u_f32 vcc, v32, v33
  v_cmp_u_f32 s[4:5], v48, v49
  s_or_b64 s[4:5], vcc, s[4:5]
  s_cbranch_scc0 L_attn_sok
  s_sub_u32 s79, s79, 1
  s_cbranch_scc1 L_attn_sok
  buffer_load_dwordx4 v[32:35], v18, s[56:59], 0 offen sc1
  s_mov_b32 s3, 65536
  buffer_load_dwordx4 v[36:39], v18, s[56:59], s3 offen sc1
  s_mov_b32 s3, 131072
  buffer_load_dwordx4 v[40:43], v18, s[56:59], s3 offen sc1
  s_mov_b32 s3, 196608
  buffer_load_dwordx4 v[44:47], v18, s[56:59], s3 offen sc1
  buffer_load_dwordx2 v[48:49], v19, s[56:59], 0 offen sc1
  s_waitcnt vmcnt(0)
  s_branch L_attn_schk
L_attn_sok:
  v_mov_b32 v34, v32
  v_mov_b32 v35, v33
  s_nop 0
  v_permlane16_swap_b32 v32, v34
  v_permlane16_swap_b32 v33, v35
  v_pk_add_f32 v[32:33], v[32:33], v[34:35]
  v_mul_f32 v32, 0x3a800000, v32
  v_mul_f32 v33, 0x3a800000, v33
  v_fma_f32 v33, -v32, v32, v33
  v_max_f32 v33, 0, v33
  v_add_f32 v33, 0x3727c5ac, v33
  v_rsq_f32 v33, v33
  s_nop 0
  s_and_b32 s3, s70, 3
  s_lshl_b32 s5, s3, 7
  s_add_u32 s5, s5, 129088
  v_and_b32 v3, 15, v1
  v_lshrrev_b32 v2, 5, v1
  v_lshl_add_u32 v2, v3, 1, v2
  v_lshl_add_u32 v2, v2, 2, s5
  ds_write2_b32 v2, v32, v33 offset0:0 offset1:160
  v_mov_b32 v50, v48
  v_mov_b32 v51, v49
  s_nop 0
  v_permlane32_swap_b32 v48, v50
  v_permlane32_swap_b32 v49, v51
  v_pk_add_f32 v[48:49], v[48:49], v[50:51]
  v_mov_b32 v50, v48
  v_mov_b32 v51, v49
  s_nop 0
  v_permlane16_swap_b32 v48, v50
  v_permlane16_swap_b32 v49, v51
  v_pk_add_f32 v[48:49], v[48:49], v[50:51]
  s_nop 1
  v_add_f32_dpp v48, v48, v48 row_ror:8 row_mask:0xf bank_mask:0xf
  v_add_f32_dpp v49, v49, v49 row_ror:8 row_mask:0xf bank_mask:0xf
  s_nop 1
  v_add_f32_dpp v48, v48, v48 row_ror:4 row_mask:0xf bank_mask:0xf
  v_add_f32_dpp v49, v49, v49 row_ror:4 row_mask:0xf bank_mask:0xf
  v_mul_f32 v48, 0x3a800000, v48
  v_mul_f32 v49, 0x3a800000, v49
  v_fma_f32 v49, -v48, v48, v49
  v_max_f32 v49, 0, v49
  v_add_f32 v49, 0x3727c5ac, v49
  v_rsq_f32 v49, v49
  s_nop 0
  s_lshl_b32 s5, s3, 4
  s_add_u32 s5, s5, 129024
  v_and_b32 v3, 3, v1
  v_lshl_add_u32 v2, v3, 2, s5
  ds_write2_b32 v2, v48, v49 offset0:0 offset1:160
  s_waitcnt lgkmcnt(0)
  s_barrier
  s_barrier
  s_branch L_attn_ldend
L_attn_ld1:
  s_add_u32 s3, s68, s69
  s_and_b32 s3, s3, 3
  s_mov_b32 s100, 0x68532410
  s_mov_b32 s101, 0xfedbac97
  s_cmp_eq_u32 s3, 1
  s_cselect_b32 s100, 0x96435210, s100
  s_cselect_b32 s101, 0xfecbda87, s101
  s_cmp_eq_u32 s3, 2
  s_cselect_b32 s100, 0x75463210, s100
  s_cselect_b32 s101, 0xfdceb98a, s101
  s_cmp_eq_u32 s3, 3
  s_cselect_b32 s100, 0x65743210, s100
  s_cselect_b32 s101, 0xedfca9b8, s101
  s_add_u32 s56, s22, 24379392
  s_addc_u32 s57, s23, 0
  s_and_b32 s57, s57, 0xffff
  s_mov_b32 s58, 262144
  s_mov_b32 s59, 0x00020000
  s_and_b32 s3, s70, 3
  s_lshl2_add_u32 s4, s68, s3
  s_lshl_b32 s4, s4, 8
  v_lshrrev_b32 v2, 4, v1
  v_and_b32 v3, 15, v1
  v_lshl_add_u32 v3, v3, 4, s4
  v_lshl_add_u32 v18, v2, 14, v3
  s_lshl_b32 s4, s68, 5
  s_add_u32 s4, s4, s3
  s_sub_u32 s4, s4, 4
  s_max_i32 s4, s4, 0
  s_lshl_b32 s4, s4, 5
  v_lshrrev_b32 v2, 2, v1
  v_and_b32 v3, 3, v1
  v_lshl_add_u32 v3, v3, 3, s4
  v_lshl_add_u32 v19, v2, 14, v3
  s_lshr_b32 s3, s69, 3
  s_and_b32 s73, s69, 7
  s_lshl1_add_u32 s91, s73, s3
  s_mul_i32 s74, s91, 393216
  s_lshl_b32 s73, s91, 7
  s_mov_b32 s88, s73
  s_add_u32 m0, s77, 0
  s_add_u32 s4, s74, 0
  buffer_load_dwordx4 v8, s[40:43], s4 offen lds
  s_add_u32 m0, s77, 1024
  s_nop 0
  buffer_load_dwordx4 v9, s[40:43], s4 offen lds
  s_add_u32 m0, s77, 8192
  s_add_u32 s4, s74, 2048
  buffer_load_dwordx4 v8, s[40:43], s4 offen lds
  s_add_u32 m0, s77, 9216
  s_nop 0
  buffer_load_dwordx4 v9, s[40:43], s4 offen lds
  s_add_u32 m0, s77, 16384
  s_add_u32 s4, s74, 4096
  buffer_load_dwordx4 v8, s[40:43], s4 offen lds
  s_add_u32 m0, s77, 17408
  s_nop 0
  buffer_load_dwordx4 v9, s[40:43], s4 offen lds
  s_and_b32 s73, s100, 15
  s_cmp_eq_u32 s73, s91
  s_cselect_b32 s74, 4, 0
  s_lshr_b64 s[100:101], s[100:101], s74
  s_and_b32 s73, s100, 15
  s_lshr_b64 s[100:101], s[100:101], 4
  s_mul_i32 s74, s73, 393216
  s_lshl_b32 s73, s73, 7
  s_mov_b32 s75, 0
  s_add_u32 s44, s22, 41943040
  s_addc_u32 s45, s23, 0
  s_and_b32 s45, s45, 0xffff
  s_mov_b32 s46, 524288
  s_mov_b32 s47, 0x00020000
  s_lshl4_add_u32 s3, s97, s68
  s_and_b32 s4, s69, 15
  s_lshl4_add_u32 s3, s3, s4
  s_lshl_b32 s3, s3, 7
  s_sub_u32 s3, s3, 32768
  v_lshlrev_b32 v11, 7, v1
  s_cmp_eq_u32 s68, 0
  s_cselect_b32 s4, 15, 31
  v_and_b32 v2, 16, v1
  v_lshl_add_u32 v11, v2, 2, v11
  v_and_b32 v2, s4, v1
  v_lshlrev_b32 v2, 2, v2
  v_mov_b32 v3, 1
  s_mov_b32 s79, 0x100000
  s_waitcnt vmcnt(0)
  s_cmp_lg_u32 s70, 4
  s_barrier
  s_cbranch_scc1 L_attn_nofl
  s_mov_b32 exec_lo, 0xffffffff
  s_mov_b32 exec_hi, 0
  buffer_store_dword v3, v11, s[44:47], s87 offen sc1
  s_mov_b64 exec, -1
L_attn_nofl:
  s_mov_b32 s5, s3
  s_mov_b32 s89, s73
  s_add_u32 m0, s77, 43008
  s_add_u32 s4, s74, 0
  buffer_load_dwordx4 v8, s[40:43], s4 offen lds
  s_add_u32 m0, s77, 44032
  s_nop 0
  buffer_load_dwordx4 v9, s[40:43], s4 offen lds
  s_add_u32 m0, s77, 51200
  s_add_u32 s4, s74, 2048
  buffer_load_dwordx4 v8, s[40:43], s4 offen lds
  s_add_u32 m0, s77, 52224
  s_nop 0
  buffer_load_dwordx4 v9, s[40:43], s4 offen lds
  s_add_u32 m0, s77, 59392
  s_add_u32 s4, s74, 4096
  buffer_load_dwordx4 v8, s[40:43], s4 offen lds
  s_add_u32 m0, s77, 60416
  s_nop 0
  buffer_load_dwordx4 v9, s[40:43], s4 offen lds
  s_and_b32 s73, s100, 15
  s_cmp_eq_u32 s73, s91
  s_cselect_b32 s74, 4, 0
  s_lshr_b64 s[100:101], s[100:101], s74
  s_and_b32 s73, s100, 15
  s_lshr_b64 s[100:101], s[100:101], 4
  s_mul_i32 s74, s73, 393216
  s_lshl_b32 s73, s73, 7
  s_mov_b32 s90, s73
  s_add_u32 m0, s77, 86016
  s_add_u32 s4, s74, 0
  buffer_load_dwordx4 v8, s[40:43], s4 offen lds
  s_add_u32 m0, s77, 87040
  s_nop 0
  buffer_load_dwordx4 v9, s[40:43], s4 offen lds
  s_add_u32 m0, s77, 94208
  s_add_u32 s4, s74, 2048
  buffer_load_dwordx4 v8, s[40:43], s4 offen lds
  s_add_u32 m0, s77, 95232
  s_nop 0
  buffer_load_dwordx4 v9, s[40:43], s4 offen lds
  s_add_u32 m0, s77, 102400
  s_add_u32 s4, s74, 4096
  buffer_load_dwordx4 v8, s[40:43], s4 offen lds
  s_add_u32 m0, s77, 103424
  s_nop 0
  buffer_load_dwordx4 v9, s[40:43], s4 offen lds
  s_and_b32 s73, s100, 15
  s_cmp_eq_u32 s73, s91
  s_cselect_b32 s74, 4, 0
  s_lshr_b64 s[100:101], s[100:101], s74
  s_and_b32 s73, s100, 15
  s_lshr_b64 s[100:101], s[100:101], 4
  s_mul_i32 s74, s73, 393216
  s_lshl_b32 s73, s73, 7
  s_mov_b32 s3, s5
  s_cmp_lg_u32 s70, 4
  s_cbranch_scc1 L_attn_dep
L_attn_poll:
  buffer_load_dword v3, v2, s[44:47], s3 offen sc1
  s_sub_u32 s79, s79, 1
  s_cbranch_scc1 L_attn_dep
  s_waitcnt vmcnt(0)
  v_cmp_ne_u32 vcc, 1, v3
  s_cbranch_vccnz L_attn_poll
L_attn_dep:
  s_barrier
  s_add_u32 m0, s78, 89344
  s_mov_b64 exec, s[14:15]
  buffer_load_dwordx4 v28, s[36:39], s88 offen lds
  s_mov_b64 exec, -1
  s_add_u32 m0, s76, 43008
  s_nop 0
  buffer_load_dwordx4 v4, s[36:39], s89 offen lds
  s_add_u32 m0, s76, 44032
  s_nop 0
  buffer_load_dwordx4 v5, s[36:39], s89 offen lds
  s_add_u32 m0, s76, 45056
  s_nop 0
  buffer_load_dwordx4 v6, s[36:39], s89 offen lds
  s_add_u32 m0, s76, 46080
  s_nop 0
  buffer_load_dwordx4 v7, s[36:39], s89 offen lds
  s_add_u32 m0, s78, 43008
  s_mov_b64 exec, s[14:15]
  buffer_load_dwordx4 v28, s[36:39], s89 offen lds
  s_mov_b64 exec, -1
  s_add_u32 m0, s76, 86016
  s_nop 0
  buffer_load_dwordx4 v4, s[36:39], s90 offen lds
  s_add_u32 m0, s76, 87040
  s_nop 0
  buffer_load_dwordx4 v5, s[36:39], s90 offen lds
  s_add_u32 m0, s76, 88064
  s_nop 0
  buffer_load_dwordx4 v6, s[36:39], s90 offen lds
  s_add_u32 m0, s76, 89088
  s_nop 0
  buffer_load_dwordx4 v7, s[36:39], s90 offen lds
  s_add_u32 m0, s78, 86016
  s_mov_b64 exec, s[14:15]
  buffer_load_dwordx4 v28, s[36:39], s90 offen lds
  s_mov_b64 exec, -1
  s_waitcnt vmcnt(5)
  s_barrier
  s_mov_b32 s79, 12
L_attn1_ld1:
  s_add_u32 s3, s75, s76
  s_add_u32 m0, s3, 0
  s_nop 0
  buffer_load_dwordx4 v4, s[36:39], s73 offen lds
  s_add_u32 m0, s3, 1024
  s_nop 0
  buffer_load_dwordx4 v5, s[36:39], s73 offen lds
  s_add_u32 m0, s3, 2048
  s_nop 0
  buffer_load_dwordx4 v6, s[36:39], s73 offen lds
  s_add_u32 m0, s3, 3072
  s_nop 0
  buffer_load_dwordx4 v7, s[36:39], s73 offen lds
  s_add_u32 m0, s78, s75
  s_mov_b64 exec, s[14:15]
  buffer_load_dwordx4 v28, s[36:39], s73 offen lds
  s_mov_b64 exec, -1
  s_add_u32 s3, s75, s77
  s_add_u32 m0, s3, 0
  s_add_u32 s4, s74, 0
  buffer_load_dwordx4 v8, s[40:43], s4 offen lds
  s_add_u32 m0, s3, 1024
  s_nop 0
  buffer_load_dwordx4 v9, s[40:43], s4 offen lds
  s_add_u32 m0, s3, 8192
  s_add_u32 s4, s74, 2048
  buffer_load_dwordx4 v8, s[40:43], s4 offen lds
  s_add_u32 m0, s3, 9216
  s_nop 0
  buffer_load_dwordx4 v9, s[40:43], s4 offen lds
  s_add_u32 m0, s3, 16384
  s_add_u32 s4, s74, 4096
  buffer_load_dwordx4 v8, s[40:43], s4 offen lds
  s_add_u32 m0, s3, 17408
  s_nop 0
  buffer_load_dwordx4 v9, s[40:43], s4 offen lds
  s_and_b32 s73, s100, 15
  s_cmp_eq_u32 s73, s91
  s_cselect_b32 s74, 4, 0
  s_lshr_b64 s[100:101], s[100:101], s74
  s_and_b32 s73, s100, 15
  s_lshr_b64 s[100:101], s[100:101], 4
  s_mul_i32 s74, s73, 393216
  s_lshl_b32 s73, s73, 7
  s_add_u32 s75, s75, 43008
  s_cmp_eq_u32 s75, 129024
  s_cselect_b32 s75, 0, s75
  s_waitcnt vmcnt(11)
  s_barrier
  s_sub_u32 s79, s79, 1
  s_cmp_lg_u32 s79, 0
  s_cbranch_scc1 L_attn1_ld1
  s_add_u32 s3, s75, s76
  s_add_u32 m0, s3, 0
  s_nop 0
  buffer_load_dwordx4 v4, s[36:39], s73 offen lds
  s_add_u32 m0, s3, 1024
  s_nop 0
  buffer_load_dwordx4 v5, s[36:39], s73 offen lds
  s_add_u32 m0, s3, 2048
  s_nop 0
  buffer_load_dwordx4 v6, s[36:39], s73 offen lds
  s_add_u32 m0, s3, 3072
  s_nop 0
  buffer_load_dwordx4 v7, s[36:39], s73 offen lds
  s_add_u32 m0, s78, s75
  s_mov_b64 exec, s[14:15]
  buffer_load_dwordx4 v28, s[36:39], s73 offen lds
  s_mov_b64 exec, -1
  s_add_u32 s3, s75, s77
  s_add_u32 m0, s3, 0
  s_add_u32 s4, s74, 0
  buffer_load_dwordx4 v8, s[40:43], s4 offen lds
  s_add_u32 m0, s3, 1024
  s_nop 0
  buffer_load_dwordx4 v9, s[40:43], s4 offen lds
  s_add_u32 m0, s3, 8192
  s_add_u32 s4, s74, 2048
  buffer_load_dwordx4 v8, s[40:43], s4 offen lds
  s_add_u32 m0, s3, 9216
  s_nop 0
  buffer_load_dwordx4 v9, s[40:43], s4 offen lds
  s_add_u32 m0, s3, 16384
  s_add_u32 s4, s74, 4096
  buffer_load_dwordx4 v8, s[40:43], s4 offen lds
  s_add_u32 m0, s3, 17408
  s_nop 0
  buffer_load_dwordx4 v9, s[40:43], s4 offen lds
  s_and_b32 s73, s100, 15
  s_cmp_eq_u32 s73, s91
  s_cselect_b32 s74, 4, 0
  s_lshr_b64 s[100:101], s[100:101], s74
  s_and_b32 s73, s100, 15
  s_lshr_b64 s[100:101], s[100:101], 4
  s_mul_i32 s74, s73, 393216
  s_lshl_b32 s73, s73, 7
  s_add_u32 s75, s75, 43008
  s_cmp_eq_u32 s75, 129024
  s_cselect_b32 s75, 0, s75
  s_mov_b32 s60, s20
  s_and_b32 s61, s21, 0xffff
  s_mov_b32 s62, 2097152
  s_mov_b32 s63, 0x00020000
  s_and_b32 s3, s70, 3
  s_mul_i32 s3, s3, 8
  s_mul_i32 s4, s99, 32
  s_add_u32 s3, s3, s4
  v_lshrrev_b32 v2, 3, v1
  v_add_u32 v2, s3, v2
  v_mul_u32_u24 v2, 2048, v2
  v_and_b32 v3, 7, v1
  v_lshl_add_u32 v2, v3, 8, v2
  s_and_b32 s3, s2, 7
  s_lshr_b32 s3, s3, 2
  s_mul_i32 s3, s3, 128
  buffer_load_dword v96, v2, s[60:63], s3 offen
  s_waitcnt vmcnt(12)
  s_barrier
  buffer_load_dwordx4 v[32:35], v18, s[56:59], 0 offen
  s_mov_b32 s3, 65536
  buffer_load_dwordx4 v[36:39], v18, s[56:59], s3 offen
  s_mov_b32 s3, 131072
  buffer_load_dwordx4 v[40:43], v18, s[56:59], s3 offen
  s_mov_b32 s3, 196608
  buffer_load_dwordx4 v[44:47], v18, s[56:59], s3 offen
  buffer_load_dwordx2 v[48:49], v19, s[56:59], 0 offen
  s_waitcnt vmcnt(6)
  s_barrier
  s_waitcnt vmcnt(0)
  v_pk_add_f32 v[32:33], v[32:33], v[36:37]
  v_pk_add_f32 v[34:35], v[34:35], v[38:39]
  v_pk_add_f32 v[40:41], v[40:41], v[44:45]
  v_pk_add_f32 v[42:43], v[42:43], v[46:47]
  v_pk_add_f32 v[32:33], v[32:33], v[40:41]
  v_pk_add_f32 v[34:35], v[34:35], v[42:43]
  s_nop 1
  v_permlane32_swap_b32 v32, v34
  v_permlane32_swap_b32 v33, v35
  v_pk_add_f32 v[32:33], v[32:33], v[34:35]
  v_mov_b32 v34, v32
  v_mov_b32 v35, v33
  s_nop 0
  v_permlane16_swap_b32 v32, v34
  v_permlane16_swap_b32 v33, v35
  v_pk_add_f32 v[32:33], v[32:33], v[34:35]
  v_mul_f32 v32, 0x3a800000, v32
  v_mul_f32 v33, 0x3a800000, v33
  v_fma_f32 v33, -v32, v32, v33
  v_max_f32 v33, 0, v33
  v_add_f32 v33, 0x3727c5ac, v33
  v_rsq_f32 v33, v33
  s_nop 0
  s_and_b32 s3, s70, 3
  s_lshl_b32 s5, s3, 7
  s_add_u32 s5, s5, 129088
  v_and_b32 v3, 15, v1
  v_lshrrev_b32 v2, 5, v1
  v_lshl_add_u32 v2, v3, 1, v2
  v_lshl_add_u32 v2, v2, 2, s5
  ds_write2_b32 v2, v32, v33 offset0:0 offset1:160
  v_mov_b32 v50, v48
  v_mov_b32 v51, v49
  s_nop 0
  v_permlane32_swap_b32 v48, v50
  v_permlane32_swap_b32 v49, v51
  v_pk_add_f32 v[48:49], v[48:49], v[50:51]
  v_mov_b32 v50, v48
  v_mov_b32 v51, v49
  s_nop 0
  v_permlane16_swap_b32 v48, v50
  v_permlane16_swap_b32 v49, v51
  v_pk_add_f32 v[48:49], v[48:49], v[50:51]
  s_nop 1
  v_add_f32_dpp v48, v48, v48 row_ror:8 row_mask:0xf bank_mask:0xf
  v_add_f32_dpp v49, v49, v49 row_ror:8 row_mask:0xf bank_mask:0xf
  s_nop 1
  v_add_f32_dpp v48, v48, v48 row_ror:4 row_mask:0xf bank_mask:0xf
  v_add_f32_dpp v49, v49, v49 row_ror:4 row_mask:0xf bank_mask:0xf
  v_mul_f32 v48, 0x3a800000, v48
  v_mul_f32 v49, 0x3a800000, v49
  v_fma_f32 v49, -v48, v48, v49
  v_max_f32 v49, 0, v49
  v_add_f32 v49, 0x3727c5ac, v49
  v_rsq_f32 v49, v49
  s_nop 0
  s_lshl_b32 s5, s3, 4
  s_add_u32 s5, s5, 129024
  v_and_b32 v3, 3, v1
  v_lshl_add_u32 v2, v3, 2, s5
  ds_write2_b32 v2, v48, v49 offset0:0 offset1:160
  s_waitcnt lgkmcnt(0)
  s_barrier
  s_barrier
L_attn_ldend:
  s_lshl_b32 s87, s97, 15
  s_lshl_b32 s4, s68, 11
  s_add_u32 s87, s87, s4
  s_lshl_b32 s4, s69, 2
  s_add_u32 s87, s87, s4
  s_add_u32 s97, s97, 1
  s_branch L_wo_body
L_attn_end:
  s_endpgm
.fill 22, 4, 0xbf800000
L_attn_compute:
  s_cmp_lg_u32 s96, 0
  s_cbranch_scc1 L_pfc1_skip
  s_getpc_b64 s[4:5]
L_pfc1:
  s_lshl_b32 s3, s99, 2
  s_add_u32 s3, s3, s70
  s_mul_i32 s3, s3, 320
  s_min_u32 s3, s3, L_w2_c1-L_attn_c0-320
  s_add_i32 s3, s3, L_attn_c0-L_pfc1
  s_ashr_i32 s6, s3, 31
  s_add_u32 s4, s4, s3
  s_addc_u32 s5, s5, s6
  s_load_dword s40, s[4:5], 0
  s_load_dword s40, s[4:5], 64
  s_load_dword s40, s[4:5], 128
  s_load_dword s40, s[4:5], 192
  s_load_dword s40, s[4:5], 256
L_pfc1_skip:
  s_and_b32 s71, s70, 1
  s_lshr_b32 s72, s70, 1
  v_and_b32 v3, 31, v1
  v_lshlrev_b32 v3, 2, v3
  v_add_u32 v3, 40960, v3
  v_mov_b32 v236, 0x3f803f80
  v_mov_b32 v237, 0x3f803f80
  v_mov_b32 v238, 0x3f803f80
  v_mov_b32 v239, 0x3f803f80
  ds_write_b32 v3, v236
  ds_write_b32 v3, v236 offset:43008
  v_add_u32 v3, 86016, v3
  ds_write_b32 v3, v236
  ds_write_b32 v3, v236 offset:3328
  v_and_b32 v3, 15, v1
  v_lshrrev_b32 v2, 4, v1
  v_lshrrev_b32 v33, 1, v3
  s_lshl_b32 s8, s71, 13
  v_xor_b32 v4, v2, v33
  v_lshlrev_b32 v4, 4, v4
  v_lshl_add_u32 v4, v3, 7, v4
  v_add_u32 v8, 40960, v4
  v_add_u32 v4, s8, v4
  v_add_u32 v5, 4, v2
  v_xor_b32 v5, v5, v33
  v_lshlrev_b32 v5, 4, v5
  v_lshl_add_u32 v5, v3, 7, v5
  v_add_u32 v9, 40960, v5
  v_add_u32 v5, s8, v5
  v_bfe_u32 v34, v1, 2, 2
  v_lshl_add_u32 v34, v2, 3, v34
  v_lshlrev_b32 v34, 7, v34
  v_and_b32 v33, 3, v1
  v_lshl_add_u32 v34, v33, 3, v34
  v_bfe_u32 v33, v1, 3, 2
  v_lshl_add_u32 v34, v33, 5, v34
  s_lshl_b32 s8, s70, 5
  v_xor_b32 v34, s8, v34
  v_add_u32 v6, 16384, v34
  v_xor_b32 v7, 32, v6
  s_mov_b32 s75, 0
  v_add_u32_e64 v10, s75, v4
  v_add_u32_e64 v11, s75, v5
  v_add_u32_e64 v12, s75, v6
  v_add_u32_e64 v13, s75, v7
  v_add_u32_e64 v14, s75, v8
  v_add_u32_e64 v15, s75, v9
  s_add_u32 s75, s75, 43008
  s_cmp_eq_u32 s75, 129024
  s_cselect_b32 s75, 0, s75
  s_and_b32 s79, s69, 3
  s_add_u32 s79, s79, 1
  s_mul_i32 s98, s96, 3
  s_cmp_eq_u32 s96, 0
  s_cbranch_scc1 L_attn_nog
  s_mov_b32 s79, 15
  ds_read_b128 v[32:35], v10 offset:0
  ds_read_b128 v[36:39], v10 offset:2048
  ds_read_b128 v[40:43], v10 offset:4096
  ds_read_b128 v[44:47], v10 offset:6144
  ds_read_b64_tr_b16 v[52:53], v12 offset:0
  ds_read_b64_tr_b16 v[54:55], v12 offset:512
  ds_read_b64_tr_b16 v[56:57], v13 offset:0
  ds_read_b64_tr_b16 v[58:59], v13 offset:512
  ds_read_b64_tr_b16 v[60:61], v12 offset:8192
  ds_read_b64_tr_b16 v[62:63], v12 offset:8704
  ds_read_b64_tr_b16 v[64:65], v13 offset:8192
  ds_read_b64_tr_b16 v[66:67], v13 offset:8704
  ds_read_b64_tr_b16 v[68:69], v12 offset:16384
  ds_read_b64_tr_b16 v[70:71], v12 offset:16896
  ds_read_b64_tr_b16 v[72:73], v13 offset:16384
  ds_read_b64_tr_b16 v[74:75], v13 offset:16896
  s_waitcnt lgkmcnt(0)
  v_mfma_f32_16x16x32_bf16 v[128:131], v[52:55], v[32:35], 0
  ds_read_b128 v[76:79], v11 offset:0
  v_mfma_f32_16x16x32_bf16 v[132:135], v[52:55], v[36:39], 0
  ds_read_b128 v[80:83], v11 offset:2048
  v_mfma_f32_16x16x32_bf16 v[136:139], v[52:55], v[40:43], 0
  ds_read_b128 v[84:87], v11 offset:4096
  v_mfma_f32_16x16x32_bf16 v[140:143], v[52:55], v[44:47], 0
  ds_read_b128 v[88:91], v11 offset:6144
  v_mfma_f32_16x16x32_bf16 v[156:159], v[56:59], v[44:47], 0
  ds_read_b64_tr_b16 v[96:97], v12 offset:4096
  v_mfma_f32_16x16x32_bf16 v[152:155], v[56:59], v[40:43], 0
  ds_read_b64_tr_b16 v[98:99], v12 offset:4608
  v_mfma_f32_16x16x32_bf16 v[148:151], v[56:59], v[36:39], 0
  ds_read_b64_tr_b16 v[100:101], v13 offset:4096
  v_mfma_f32_16x16x32_bf16 v[144:147], v[56:59], v[32:35], 0
  ds_read_b64_tr_b16 v[102:103], v13 offset:4608
  v_mfma_f32_16x16x32_bf16 v[160:163], v[60:63], v[32:35], 0
  ds_read_b64_tr_b16 v[104:105], v12 offset:12288
  v_mfma_f32_16x16x32_bf16 v[164:167], v[60:63], v[36:39], 0
  ds_read_b64_tr_b16 v[106:107], v12 offset:12800
  v_mfma_f32_16x16x32_bf16 v[168:171], v[60:63], v[40:43], 0
  ds_read_b64_tr_b16 v[108:109], v13 offset:12288
  v_mfma_f32_16x16x32_bf16 v[172:175], v[60:63], v[44:47], 0
  ds_read_b64_tr_b16 v[110:111], v13 offset:12800
  v_mfma_f32_16x16x32_bf16 v[188:191], v[64:67], v[44:47], 0
  ds_read_b64_tr_b16 v[112:113], v12 offset:20480
  v_mfma_f32_16x16x32_bf16 v[184:187], v[64:67], v[40:43], 0
  ds_read_b64_tr_b16 v[114:115], v12 offset:20992
  v_mfma_f32_16x16x32_bf16 v[180:183], v[64:67], v[36:39], 0
  ds_read_b64_tr_b16 v[116:117], v13 offset:20480
  v_mfma_f32_16x16x32_bf16 v[176:179], v[64:67], v[32:35], 0
  ds_read_b64_tr_b16 v[118:119], v13 offset:20992
  v_mfma_f32_16x16x32_bf16 v[192:195], v[32:35], v[68:71], 0
  v_add_u32_e64 v10, s75, v4
  v_mfma_f32_16x16x32_bf16 v[196:199], v[36:39], v[68:71], 0
  v_add_u32_e64 v11, s75, v5
  v_mfma_f32_16x16x32_bf16 v[200:203], v[40:43], v[68:71], 0
  v_add_u32_e64 v12, s75, v6
  v_mfma_f32_16x16x32_bf16 v[204:207], v[44:47], v[68:71], 0
  v_add_u32_e64 v13, s75, v7
  v_mfma_f32_16x16x32_bf16 v[220:223], v[44:47], v[72:75], 0
  v_add_u32_e64 v14, s75, v8
  v_mfma_f32_16x16x32_bf16 v[216:219], v[40:43], v[72:75], 0
  v_add_u32_e64 v15, s75, v9
  v_mfma_f32_16x16x32_bf16 v[212:215], v[36:39], v[72:75], 0
  s_add_u32 s75, s75, 43008
  v_mfma_f32_16x16x32_bf16 v[208:211], v[32:35], v[72:75], 0
  s_cmp_eq_u32 s75, 129024
  s_cselect_b32 s75, 0, s75
  s_waitcnt lgkmcnt(0)
  v_mfma_f32_16x16x32_bf16 v[128:131], v[96:99], v[76:79], v[128:131]
  v_mfma_f32_16x16x32_bf16 v[132:135], v[96:99], v[80:83], v[132:135]
  v_mfma_f32_16x16x32_bf16 v[136:139], v[96:99], v[84:87], v[136:139]
  v_mfma_f32_16x16x32_bf16 v[140:143], v[96:99], v[88:91], v[140:143]
  v_mfma_f32_16x16x32_bf16 v[156:159], v[100:103], v[88:91], v[156:159]
  v_mfma_f32_16x16x32_bf16 v[152:155], v[100:103], v[84:87], v[152:155]
  v_mfma_f32_16x16x32_bf16 v[148:151], v[100:103], v[80:83], v[148:151]
  v_mfma_f32_16x16x32_bf16 v[144:147], v[100:103], v[76:79], v[144:147]
  v_mfma_f32_16x16x32_bf16 v[160:163], v[104:107], v[76:79], v[160:163]
  v_mfma_f32_16x16x32_bf16 v[164:167], v[104:107], v[80:83], v[164:167]
  v_mfma_f32_16x16x32_bf16 v[168:171], v[104:107], v[84:87], v[168:171]
  v_mfma_f32_16x16x32_bf16 v[172:175], v[104:107], v[88:91], v[172:175]
  v_mfma_f32_16x16x32_bf16 v[188:191], v[108:111], v[88:91], v[188:191]
  v_mfma_f32_16x16x32_bf16 v[184:187], v[108:111], v[84:87], v[184:187]
  v_mfma_f32_16x16x32_bf16 v[180:183], v[108:111], v[80:83], v[180:183]
  v_mfma_f32_16x16x32_bf16 v[176:179], v[108:111], v[76:79], v[176:179]
  v_mfma_f32_16x16x32_bf16 v[192:195], v[76:79], v[112:115], v[192:195]
  v_mfma_f32_16x16x32_bf16 v[196:199], v[80:83], v[112:115], v[196:199]
  v_mfma_f32_16x16x32_bf16 v[200:203], v[84:87], v[112:115], v[200:203]
  v_mfma_f32_16x16x32_bf16 v[204:207], v[88:91], v[112:115], v[204:207]
  v_mfma_f32_16x16x32_bf16 v[220:223], v[88:91], v[116:119], v[220:223]
  v_mfma_f32_16x16x32_bf16 v[216:219], v[84:87], v[116:119], v[216:219]
  v_mfma_f32_16x16x32_bf16 v[212:215], v[80:83], v[116:119], v[212:215]
  v_mfma_f32_16x16x32_bf16 v[208:211], v[76:79], v[116:119], v[208:211]
  s_barrier
  v_mov_b32 v76, v52
  v_mov_b32 v77, v53
  v_mov_b32 v78, v54
  v_mov_b32 v79, v55
  v_mov_b32 v80, v60
  v_mov_b32 v81, v61
  v_mov_b32 v82, v62
  v_mov_b32 v83, v63
  v_mov_b32 v84, v68
  v_mov_b32 v85, v69
  v_mov_b32 v86, v70
  v_mov_b32 v87, v71
L_attn_nog:
  v_and_b32 v35, 1, v2
  v_xor_b32 v35, s71, v35
  s_lshl_b32 s8, s68, 7
  s_lshl_b32 s9, s71, 6
  s_add_u32 s8, s8, s9
  s_add_u32 s10, s8, s69
  s_lshl_b32 s10, s10, 11
  s_lshl_b32 s11, s72, 10
  s_add_u32 s10, s10, s11
  v_lshl_add_u32 v33, v3, 4, s10
  v_lshl_add_u32 v33, v35, 9, v33
  v_lshrrev_b32 v34, 1, v2
  v_lshl_add_u32 v31, v34, 8, v33
  s_mul_i32 s10, s72, 14336
  s_add_u32 s10, s10, 1024
  s_lshl_b32 s11, s71, 10
  s_add_u32 s4, s10, s11
  s_sub_u32 s5, s10, s11
  s_mul_i32 s6, s71, 6144
  v_lshl_add_u32 v16, v1, 4, s4
  v_add_u32 v17, s6, v16
  v_lshl_add_u32 v18, v1, 4, s5
  v_add_u32 v18, s6, v18
  v_lshl_add_u32 v19, v2, 8, s4
  v_lshl_add_u32 v20, v2, 8, s5
  v_lshl_add_u32 v21, v3, 4, s4
  v_lshl_add_u32 v22, v3, 4, s5
  s_lshl_b32 s10, s71, 8
  s_add_u32 s10, s10, 129024
  v_lshl_add_u32 v23, v3, 2, s10
  v_lshl_add_u32 v24, v2, 4, s10
  v_and_b32 v33, 1, v3
  v_cmp_eq_u32 s[48:49], 1, v33
  v_lshl_add_u32 v34, v2, 2, v33
  v_add_u32 v35, 2, v34
  v_cmp_gt_u32 s[50:51], v34, v3
  v_cmp_gt_u32 s[52:53], v35, v3
  v_mov_b32 v36, 0xffff
  v_mov_b32 v37, 0xffff0000
  v_cndmask_b32 v36, v36, v37, s[48:49]
  s_add_u32 s10, s10, 704
  v_lshl_add_u32 v34, v34, 2, s10
  v_lshl_add_u32 v35, v35, 2, s10
  v_subrev_u32 v38, 64, v34
  v_subrev_u32 v39, 64, v35
  v_cndmask_b32 v25, v34, v38, s[50:51]
  v_cndmask_b32 v26, v35, v39, s[52:53]
  v_cndmask_b32 v27, 0, v36, s[50:51]
  v_cndmask_b32 v29, 0, v36, s[52:53]
  v_xor_b32 v28, v27, v36
  v_xor_b32 v30, v29, v36
  s_cmp_eq_u32 s8, 0
  s_cselect_b64 s[54:55], s[50:51], 0
  s_cselect_b64 s[14:15], s[52:53], 0
  s_cmp_lg_u32 s96, 0
  s_cbranch_scc1 L_attn_nozero
  v_mov_b32 v122, 0
  v_mov_b32 v123, 0
  v_mov_b32 v124, 0
  v_mov_b32 v125, 0
  v_mov_b32 v126, 0
  v_mov_b32 v127, 0
  v_mov_b32 v128, 0
  v_mov_b32 v129, 0
  v_mov_b32 v130, 0
  v_mov_b32 v131, 0
  v_mov_b32 v132, 0
  v_mov_b32 v133, 0
  v_mov_b32 v134, 0
  v_mov_b32 v135, 0
  v_mov_b32 v136, 0
  v_mov_b32 v137, 0
  v_mov_b32 v138, 0
  v_mov_b32 v139, 0
  v_mov_b32 v140, 0
  v_mov_b32 v141, 0
  v_mov_b32 v142, 0
  v_mov_b32 v143, 0
  v_mov_b32 v144, 0
  v_mov_b32 v145, 0
  v_mov_b32 v146, 0
  v_mov_b32 v147, 0
  v_mov_b32 v148, 0
  v_mov_b32 v149, 0
  v_mov_b32 v150, 0
  v_mov_b32 v151, 0
  v_mov_b32 v152, 0
  v_mov_b32 v153, 0
  v_mov_b32 v154, 0
  v_mov_b32 v155, 0
  v_mov_b32 v156, 0
  v_mov_b32 v157, 0
  v_mov_b32 v158, 0
  v_mov_b32 v159, 0
  v_mov_b32 v160, 0
  v_mov_b32 v161, 0
  v_mov_b32 v162, 0
  v_mov_b32 v163, 0
  v_mov_b32 v164, 0
  v_mov_b32 v165, 0
  v_mov_b32 v166, 0
  v_mov_b32 v167, 0
  v_mov_b32 v168, 0
  v_mov_b32 v169, 0
  v_mov_b32 v170, 0
  v_mov_b32 v171, 0
  v_mov_b32 v172, 0
  v_mov_b32 v173, 0
  v_mov_b32 v174, 0
  v_mov_b32 v175, 0
  v_mov_b32 v176, 0
  v_mov_b32 v177, 0
  v_mov_b32 v178, 0
  v_mov_b32 v179, 0
  v_mov_b32 v180, 0
  v_mov_b32 v181, 0
  v_mov_b32 v182, 0
  v_mov_b32 v183, 0
  v_mov_b32 v184, 0
  v_mov_b32 v185, 0
  v_mov_b32 v186, 0
  v_mov_b32 v187, 0
  v_mov_b32 v188, 0
  v_mov_b32 v189, 0
  v_mov_b32 v190, 0
  v_mov_b32 v191, 0
  v_mov_b32 v192, 0
  v_mov_b32 v193, 0
  v_mov_b32 v194, 0
  v_mov_b32 v195, 0
  v_mov_b32 v196, 0
  v_mov_b32 v197, 0
  v_mov_b32 v198, 0
  v_mov_b32 v199, 0
  v_mov_b32 v200, 0
  v_mov_b32 v201, 0
  v_mov_b32 v202, 0
  v_mov_b32 v203, 0
  v_mov_b32 v204, 0
  v_mov_b32 v205, 0
  v_mov_b32 v206, 0
  v_mov_b32 v207, 0
  v_mov_b32 v208, 0
  v_mov_b32 v209, 0
  v_mov_b32 v210, 0
  v_mov_b32 v211, 0
  v_mov_b32 v212, 0
  v_mov_b32 v213, 0
  v_mov_b32 v214, 0
  v_mov_b32 v215, 0
  v_mov_b32 v216, 0
  v_mov_b32 v217, 0
  v_mov_b32 v218, 0
  v_mov_b32 v219, 0
  v_mov_b32 v220, 0
  v_mov_b32 v221, 0
  v_mov_b32 v222, 0
  v_mov_b32 v223, 0
  v_mov_b32 v224, 0
  v_mov_b32 v225, 0
  v_mov_b32 v226, 0
  v_mov_b32 v227, 0
  v_mov_b32 v228, 0
  v_mov_b32 v229, 0
  v_mov_b32 v230, 0
  v_mov_b32 v231, 0
  v_mov_b32 v232, 0
  v_mov_b32 v233, 0
  v_mov_b32 v234, 0
  v_mov_b32 v235, 0
  s_waitcnt lgkmcnt(0)
  s_lshl_b32 s3, s72, 5
  s_add_u32 s3, s3, s8
  s_lshl_b32 s4, s69, 14
  s_lshl3_add_u32 s3, s3, s4
  v_lshrrev_b32 v121, 1, v2
  v_lshl_add_u32 v121, v121, 4, v3
  v_and_b32 v120, 1, v2
  v_lshl_add_u32 v121, v121, 1, v120
  v_lshl_add_u32 v120, v121, 2, s3
  s_add_u32 s56, s22, 24903680
  s_addc_u32 s57, s23, 0
  s_and_b32 s57, s57, 0xffff
  s_mov_b32 s58, 262144
  s_mov_b32 s59, 0x00020000
  s_add_u32 s60, s22, 41943040
  s_addc_u32 s61, s23, 0
  s_and_b32 s61, s61, 0xffff
  s_mov_b32 s62, 524288
  s_mov_b32 s63, 0x00020000
  s_lshl_b32 s3, s2, 11
  s_cmp_lg_u32 s70, 0
  s_cbranch_scc1 L_attn_noclr
  s_lshl_b32 s5, s68, 10
  s_add_u32 s4, s4, s5
  v_lshlrev_b32 v121, 4, v1
  v_mov_b32 v40, -1
  v_mov_b32 v41, -1
  v_mov_b32 v42, -1
  v_mov_b32 v43, -1
  buffer_store_dwordx4 v[40:43], v121, s[56:59], s4 offen sc1
  buffer_store_dwordx4 v[128:131], v121, s[60:63], s3 offen offset:0 sc1
  buffer_store_dwordx4 v[128:131], v121, s[60:63], s3 offen offset:1024 sc1
  v_mov_b32 v126, 1
L_attn_noclr:
  s_and_b32 s65, s65, 0xffff
  s_mov_b32 s66, 256
  s_mov_b32 s67, 0x00020000
  s_mov_b32 s7, 0x3f803f80
L_attn_nozero:
  s_waitcnt lgkmcnt(0)
  s_mov_b32 s44, s34
  s_and_b32 s45, s35, 0xffff
  s_mov_b32 s46, 4194304
  s_mov_b32 s47, 0x00020000
  s_cmp_eq_u32 s96, 0
  s_barrier
  s_cbranch_scc1 L_attn_first
  ds_read_b128 v[88:91], v14 offset:46336
  ds_read_b128 v[92:95], v15 offset:46336
  ds_read_b128 v[32:35], v10 offset:0
  ds_read_b128 v[36:39], v10 offset:2048
  ds_read_b128 v[40:43], v10 offset:4096
  ds_read_b128 v[44:47], v10 offset:6144
  ds_read_b128 v[48:51], v14
  ds_read_b64_tr_b16 v[52:53], v12 offset:0
  ds_read_b64_tr_b16 v[54:55], v12 offset:512
  ds_read_b64_tr_b16 v[56:57], v13 offset:0
  ds_read_b64_tr_b16 v[58:59], v13 offset:512
  ds_read_b64_tr_b16 v[60:61], v12 offset:8192
  ds_read_b64_tr_b16 v[62:63], v12 offset:8704
  ds_read_b64_tr_b16 v[64:65], v13 offset:8192
  ds_read_b64_tr_b16 v[66:67], v13 offset:8704
  ds_read_b64_tr_b16 v[68:69], v12 offset:16384
  ds_read_b64_tr_b16 v[70:71], v12 offset:16896
  ds_read_b64_tr_b16 v[72:73], v13 offset:16384
  ds_read_b64_tr_b16 v[74:75], v13 offset:16896
  s_waitcnt lgkmcnt(15)
  v_mfma_f32_16x16x32_bf16 v[224:227], v[76:79], v[88:91], 0
  v_mfma_f32_16x16x32_bf16 v[228:231], v[80:83], v[88:91], 0
  v_mfma_f32_16x16x32_bf16 v[232:235], v[88:91], v[84:87], 0
  v_mfma_f32_16x16x32_bf16 v[224:227], v[96:99], v[92:95], v[224:227]
  v_mfma_f32_16x16x32_bf16 v[228:231], v[104:107], v[92:95], v[228:231]
  v_mfma_f32_16x16x32_bf16 v[232:235], v[92:95], v[112:115], v[232:235]
  s_waitcnt lgkmcnt(0)
  s_branch L_attn_loop
L_attn_first:
  ds_read_b128 v[32:35], v10 offset:0
  ds_read_b128 v[36:39], v10 offset:2048
  ds_read_b128 v[40:43], v10 offset:4096
  ds_read_b128 v[44:47], v10 offset:6144
  ds_read_b128 v[48:51], v14
  ds_read_b64_tr_b16 v[52:53], v12 offset:0
  ds_read_b64_tr_b16 v[54:55], v12 offset:512
  ds_read_b64_tr_b16 v[56:57], v13 offset:0
  ds_read_b64_tr_b16 v[58:59], v13 offset:512
  ds_read_b64_tr_b16 v[60:61], v12 offset:8192
  ds_read_b64_tr_b16 v[62:63], v12 offset:8704
  ds_read_b64_tr_b16 v[64:65], v13 offset:8192
  ds_read_b64_tr_b16 v[66:67], v13 offset:8704
  ds_read_b64_tr_b16 v[68:69], v12 offset:16384
  ds_read_b64_tr_b16 v[70:71], v12 offset:16896
  ds_read_b64_tr_b16 v[72:73], v13 offset:16384
  ds_read_b64_tr_b16 v[74:75], v13 offset:16896
.p2align 5
  s_nop 0
  s_nop 0
  s_nop 0
  s_waitcnt lgkmcnt(0)
L_attn_loop:
  v_mfma_f32_16x16x32_bf16 v[128:131], v[52:55], v[32:35], v[128:131]
  ds_read_b128 v[76:79], v11 offset:0
  v_mfma_f32_16x16x32_bf16 v[132:135], v[52:55], v[36:39], v[132:135]
  ds_read_b128 v[80:83], v11 offset:2048
  v_mfma_f32_16x16x32_bf16 v[136:139], v[52:55], v[40:43], v[136:139]
  ds_read_b128 v[84:87], v11 offset:4096
  v_mfma_f32_16x16x32_bf16 v[140:143], v[52:55], v[44:47], v[140:143]
  ds_read_b128 v[88:91], v11 offset:6144
  v_mfma_f32_16x16x32_bf16 v[224:227], v[52:55], v[48:51], v[224:227]
  ds_read_b128 v[92:95], v15
  v_mfma_f32_16x16x32_bf16 v[156:159], v[56:59], v[44:47], v[156:159]
  ds_read_b64_tr_b16 v[96:97], v12 offset:4096
  v_mfma_f32_16x16x32_bf16 v[152:155], v[56:59], v[40:43], v[152:155]
  ds_read_b64_tr_b16 v[98:99], v12 offset:4608
  v_mfma_f32_16x16x32_bf16 v[148:151], v[56:59], v[36:39], v[148:151]
  ds_read_b64_tr_b16 v[100:101], v13 offset:4096
  v_mfma_f32_16x16x32_bf16 v[144:147], v[56:59], v[32:35], v[144:147]
  ds_read_b64_tr_b16 v[102:103], v13 offset:4608
  v_mfma_f32_16x16x32_bf16 v[160:163], v[60:63], v[32:35], v[160:163]
  ds_read_b64_tr_b16 v[104:105], v12 offset:12288
  v_mfma_f32_16x16x32_bf16 v[164:167], v[60:63], v[36:39], v[164:167]
  ds_read_b64_tr_b16 v[106:107], v12 offset:12800
  v_mfma_f32_16x16x32_bf16 v[168:171], v[60:63], v[40:43], v[168:171]
  ds_read_b64_tr_b16 v[108:109], v13 offset:12288
  v_mfma_f32_16x16x32_bf16 v[172:175], v[60:63], v[44:47], v[172:175]
  ds_read_b64_tr_b16 v[110:111], v13 offset:12800
  v_mfma_f32_16x16x32_bf16 v[228:231], v[60:63], v[48:51], v[228:231]
  ds_read_b64_tr_b16 v[112:113], v12 offset:20480
  v_mfma_f32_16x16x32_bf16 v[188:191], v[64:67], v[44:47], v[188:191]
  ds_read_b64_tr_b16 v[114:115], v12 offset:20992
  v_mfma_f32_16x16x32_bf16 v[184:187], v[64:67], v[40:43], v[184:187]
  ds_read_b64_tr_b16 v[116:117], v13 offset:20480
  v_mfma_f32_16x16x32_bf16 v[180:183], v[64:67], v[36:39], v[180:183]
  ds_read_b64_tr_b16 v[118:119], v13 offset:20992
  v_mfma_f32_16x16x32_bf16 v[176:179], v[64:67], v[32:35], v[176:179]
  v_add_u32_e64 v10, s75, v4
  v_mfma_f32_16x16x32_bf16 v[192:195], v[32:35], v[68:71], v[192:195]
  v_add_u32_e64 v11, s75, v5
  v_mfma_f32_16x16x32_bf16 v[196:199], v[36:39], v[68:71], v[196:199]
  v_add_u32_e64 v12, s75, v6
  v_mfma_f32_16x16x32_bf16 v[200:203], v[40:43], v[68:71], v[200:203]
  v_add_u32_e64 v13, s75, v7
  v_mfma_f32_16x16x32_bf16 v[204:207], v[44:47], v[68:71], v[204:207]
  v_add_u32_e64 v14, s75, v8
  v_mfma_f32_16x16x32_bf16 v[232:235], v[48:51], v[68:71], v[232:235]
  v_add_u32_e64 v15, s75, v9
  v_mfma_f32_16x16x32_bf16 v[220:223], v[44:47], v[72:75], v[220:223]
  s_add_u32 s75, s75, 43008
  v_mfma_f32_16x16x32_bf16 v[216:219], v[40:43], v[72:75], v[216:219]
  s_cmp_eq_u32 s75, 129024
  v_mfma_f32_16x16x32_bf16 v[212:215], v[36:39], v[72:75], v[212:215]
  s_cselect_b32 s75, 0, s75
  s_sub_u32 s79, s79, 1
  v_mfma_f32_16x16x32_bf16 v[208:211], v[32:35], v[72:75], v[208:211]
  s_waitcnt lgkmcnt(0)
  s_barrier
  v_mfma_f32_16x16x32_bf16 v[128:131], v[96:99], v[76:79], v[128:131]
  ds_read_b128 v[32:35], v10 offset:0
  v_mfma_f32_16x16x32_bf16 v[132:135], v[96:99], v[80:83], v[132:135]
  ds_read_b128 v[36:39], v10 offset:2048
  v_mfma_f32_16x16x32_bf16 v[136:139], v[96:99], v[84:87], v[136:139]
  ds_read_b128 v[40:43], v10 offset:4096
  v_mfma_f32_16x16x32_bf16 v[140:143], v[96:99], v[88:91], v[140:143]
  ds_read_b128 v[44:47], v10 offset:6144
  v_mfma_f32_16x16x32_bf16 v[224:227], v[96:99], v[92:95], v[224:227]
  ds_read_b128 v[48:51], v14
  v_mfma_f32_16x16x32_bf16 v[156:159], v[100:103], v[88:91], v[156:159]
  ds_read_b64_tr_b16 v[52:53], v12 offset:0
  v_mfma_f32_16x16x32_bf16 v[152:155], v[100:103], v[84:87], v[152:155]
  ds_read_b64_tr_b16 v[54:55], v12 offset:512
  v_mfma_f32_16x16x32_bf16 v[148:151], v[100:103], v[80:83], v[148:151]
  ds_read_b64_tr_b16 v[56:57], v13 offset:0
  v_mfma_f32_16x16x32_bf16 v[144:147], v[100:103], v[76:79], v[144:147]
  ds_read_b64_tr_b16 v[58:59], v13 offset:512
  v_mfma_f32_16x16x32_bf16 v[160:163], v[104:107], v[76:79], v[160:163]
  ds_read_b64_tr_b16 v[60:61], v12 offset:8192
  v_mfma_f32_16x16x32_bf16 v[164:167], v[104:107], v[80:83], v[164:167]
  ds_read_b64_tr_b16 v[62:63], v12 offset:8704
  v_mfma_f32_16x16x32_bf16 v[168:171], v[104:107], v[84:87], v[168:171]
  ds_read_b64_tr_b16 v[64:65], v13 offset:8192
  v_mfma_f32_16x16x32_bf16 v[172:175], v[104:107], v[88:91], v[172:175]
  ds_read_b64_tr_b16 v[66:67], v13 offset:8704
  v_mfma_f32_16x16x32_bf16 v[228:231], v[104:107], v[92:95], v[228:231]
  ds_read_b64_tr_b16 v[68:69], v12 offset:16384
  v_mfma_f32_16x16x32_bf16 v[188:191], v[108:111], v[88:91], v[188:191]
  ds_read_b64_tr_b16 v[70:71], v12 offset:16896
  v_mfma_f32_16x16x32_bf16 v[184:187], v[108:111], v[84:87], v[184:187]
  ds_read_b64_tr_b16 v[72:73], v13 offset:16384
  v_mfma_f32_16x16x32_bf16 v[180:183], v[108:111], v[80:83], v[180:183]
  ds_read_b64_tr_b16 v[74:75], v13 offset:16896
  v_mfma_f32_16x16x32_bf16 v[176:179], v[108:111], v[76:79], v[176:179]
  s_cmp_lg_u32 s79, 0
  s_nop 0
  v_mfma_f32_16x16x32_bf16 v[192:195], v[76:79], v[112:115], v[192:195]
  v_mfma_f32_16x16x32_bf16 v[196:199], v[80:83], v[112:115], v[196:199]
  v_mfma_f32_16x16x32_bf16 v[200:203], v[84:87], v[112:115], v[200:203]
  v_mfma_f32_16x16x32_bf16 v[204:207], v[88:91], v[112:115], v[204:207]
  v_mfma_f32_16x16x32_bf16 v[232:235], v[92:95], v[112:115], v[232:235]
  v_mfma_f32_16x16x32_bf16 v[220:223], v[88:91], v[116:119], v[220:223]
  v_mfma_f32_16x16x32_bf16 v[216:219], v[84:87], v[116:119], v[216:219]
  v_mfma_f32_16x16x32_bf16 v[212:215], v[80:83], v[116:119], v[212:215]
  v_mfma_f32_16x16x32_bf16 v[208:211], v[76:79], v[116:119], v[208:211]
  s_waitcnt lgkmcnt(0)
  s_cbranch_scc1 L_attn_loop
L_attn_lend:
  s_add_u32 s98, s98, 1
  s_cmp_gt_u32 s98, 3
  s_cbranch_scc1 L_attn_exit
  s_cmp_lg_u32 s98, 1
  s_cbranch_scc1 L_attn_hook0
  s_mov_b32 s79, 1
  s_cmp_lg_u32 s72, 0
  s_cbranch_scc1 L_attn_dot0
  v_dot2_f32_bf16 v122, v32, s7, v122
  v_dot2_f32_bf16 v124, v32, v32, v124
  v_dot2_f32_bf16 v123, v36, s7, v123
  v_dot2_f32_bf16 v125, v36, v36, v125
  v_dot2_f32_bf16 v122, v33, s7, v122
  v_dot2_f32_bf16 v124, v33, v33, v124
  v_dot2_f32_bf16 v123, v37, s7, v123
  v_dot2_f32_bf16 v125, v37, v37, v125
  v_dot2_f32_bf16 v122, v34, s7, v122
  v_dot2_f32_bf16 v124, v34, v34, v124
  v_dot2_f32_bf16 v123, v38, s7, v123
  v_dot2_f32_bf16 v125, v38, v38, v125
  v_dot2_f32_bf16 v122, v35, s7, v122
  v_dot2_f32_bf16 v124, v35, v35, v124
  v_dot2_f32_bf16 v123, v39, s7, v123
  v_dot2_f32_bf16 v125, v39, v39, v125
  s_branch L_attn_dote0
  L_attn_dot0:
  v_dot2_f32_bf16 v122, v40, s7, v122
  v_dot2_f32_bf16 v124, v40, v40, v124
  v_dot2_f32_bf16 v123, v44, s7, v123
  v_dot2_f32_bf16 v125, v44, v44, v125
  v_dot2_f32_bf16 v122, v41, s7, v122
  v_dot2_f32_bf16 v124, v41, v41, v124
  v_dot2_f32_bf16 v123, v45, s7, v123
  v_dot2_f32_bf16 v125, v45, v45, v125
  v_dot2_f32_bf16 v122, v42, s7, v122
  v_dot2_f32_bf16 v124, v42, v42, v124
  v_dot2_f32_bf16 v123, v46, s7, v123
  v_dot2_f32_bf16 v125, v46, v46, v125
  v_dot2_f32_bf16 v122, v43, s7, v122
  v_dot2_f32_bf16 v124, v43, v43, v124
  v_dot2_f32_bf16 v123, v47, s7, v123
  v_dot2_f32_bf16 v125, v47, v47, v125
  L_attn_dote0:
  s_cmp_lg_u32 s70, 0
  s_cbranch_scc1 L_attn_loop
  s_waitcnt vmcnt(0)
  s_lshl4_add_u32 s3, s68, s69
  s_mov_b64 exec, 1
  buffer_store_byte v126, off, s[64:67], s3 sc1
  s_mov_b64 exec, -1
  s_branch L_attn_loop
L_attn_hook0:
  s_cmp_lg_u32 s98, 2
  s_cbranch_scc1 L_attn_hook1
  s_and_b32 s79, s69, 3
  s_add_u32 s79, s79, 1
  s_sub_u32 s79, 13, s79
  s_cmp_lg_u32 s72, 0
  s_cbranch_scc1 L_attn_dot1
  v_dot2_f32_bf16 v122, v76, s7, v122
  v_dot2_f32_bf16 v124, v76, v76, v124
  v_dot2_f32_bf16 v123, v80, s7, v123
  v_dot2_f32_bf16 v125, v80, v80, v125
  v_dot2_f32_bf16 v122, v77, s7, v122
  v_dot2_f32_bf16 v124, v77, v77, v124
  v_dot2_f32_bf16 v123, v81, s7, v123
  v_dot2_f32_bf16 v125, v81, v81, v125
  v_dot2_f32_bf16 v122, v78, s7, v122
  v_dot2_f32_bf16 v124, v78, v78, v124
  v_dot2_f32_bf16 v123, v82, s7, v123
  v_dot2_f32_bf16 v125, v82, v82, v125
  v_dot2_f32_bf16 v122, v79, s7, v122
  v_dot2_f32_bf16 v124, v79, v79, v124
  v_dot2_f32_bf16 v123, v83, s7, v123
  v_dot2_f32_bf16 v125, v83, v83, v125
  s_branch L_attn_dote1
  L_attn_dot1:
  v_dot2_f32_bf16 v122, v84, s7, v122
  v_dot2_f32_bf16 v124, v84, v84, v124
  v_dot2_f32_bf16 v123, v88, s7, v123
  v_dot2_f32_bf16 v125, v88, v88, v125
  v_dot2_f32_bf16 v122, v85, s7, v122
  v_dot2_f32_bf16 v124, v85, v85, v124
  v_dot2_f32_bf16 v123, v89, s7, v123
  v_dot2_f32_bf16 v125, v89, v89, v125
  v_dot2_f32_bf16 v122, v86, s7, v122
  v_dot2_f32_bf16 v124, v86, v86, v124
  v_dot2_f32_bf16 v123, v90, s7, v123
  v_dot2_f32_bf16 v125, v90, v90, v125
  v_dot2_f32_bf16 v122, v87, s7, v122
  v_dot2_f32_bf16 v124, v87, v87, v124
  v_dot2_f32_bf16 v123, v91, s7, v123
  v_dot2_f32_bf16 v125, v91, v91, v125
  L_attn_dote1:
  s_nop 2
  v_permlane32_swap_b32 v122, v123
  v_permlane32_swap_b32 v124, v125
  v_add_f32 v122, v122, v123
  v_add_f32 v124, v124, v125
  s_nop 0
  s_nop 0
  v_permlane16_swap_b32 v122, v124
  v_add_f32 v122, v122, v124
  buffer_store_dword v122, v120, s[56:59], 0 offen sc1
  s_branch L_attn_loop
L_attn_hook1:
  s_mov_b32 s79, 2
  s_mov_b32 s36, s16
  s_and_b32 s37, s17, 0xffff
  s_mov_b32 s38, 4194304
  s_mov_b32 s39, 0x00020000
  s_and_b32 s3, s2, 3
  s_and_b32 s4, s99, 3
  s_lshl2_add_u32 s3, s3, s4
  s_lshl2_add_u32 s3, s3, s70
  s_lshl_b32 s3, s3, 16
  s_bfe_u32 s4, s2, 0x10002
  s_lshr_b32 s5, s99, 2
  s_lshl1_add_u32 s4, s5, s4
  s_lshl_b32 s4, s4, 7
  s_add_u32 s3, s3, s4
  s_add_u32 s4, s3, 32768
  v_and_b32 v122, 15, v1
  v_lshlrev_b32 v123, 1, v1
  v_and_b32 v123, 32, v123
  v_lshl_add_u32 v122, v122, 11, v123
  v_lshrrev_b32 v123, 1, v1
  v_and_b32 v123, 16, v123
  v_add_u32 v122, v122, v123
  buffer_load_dwordx4 v[240:243], v122, s[36:39], s3 offen offset:0
  buffer_load_dwordx4 v[244:247], v122, s[36:39], s3 offen offset:64
  buffer_load_dwordx4 v[248:251], v122, s[36:39], s4 offen offset:0
  buffer_load_dwordx4 v[252:255], v122, s[36:39], s4 offen offset:64
  s_branch L_attn_loop
L_attn_exit:
  ds_read2_b32 v[66:67], v23 offset0:0 offset1:160
  ds_read2_b32 v[68:69], v23 offset0:16 offset1:176
  ds_read2_b32 v[70:71], v23 offset0:32 offset1:192
  ds_read2_b32 v[72:73], v23 offset0:48 offset1:208
  ds_read2_b32 v[74:75], v23 offset0:64 offset1:224
  ds_read2_b32 v[76:77], v25 offset0:0 offset1:16
  ds_read2_b32 v[80:81], v26 offset0:0 offset1:16
  ds_read2_b32 v[78:79], v25 offset0:32 offset1:48
  ds_read2_b32 v[82:83], v26 offset0:32 offset1:48
  ds_write_b128 v16, v[224:227] offset:0
  ds_write_b128 v16, v[228:231] offset:2048
  ds_write_b128 v16, v[232:235] offset:4096
  s_cmp_eq_u32 s71, 1
  s_cbranch_scc1 L_attn_nop3
  ds_write_b128 v16, v[172:175] offset:8192
  ds_write_b128 v16, v[188:191] offset:9216
  ds_write_b128 v16, v[204:207] offset:10240
  ds_write_b128 v16, v[220:223] offset:11264
L_attn_nop3:
  ds_read_b128 v[84:87], v24 offset:0
  ds_read_b128 v[104:107], v24 offset:640
  ds_read_b128 v[88:91], v24 offset:64
  ds_read_b128 v[108:111], v24 offset:704
  ds_read_b128 v[92:95], v24 offset:128
  ds_read_b128 v[112:115], v24 offset:768
  ds_read_b128 v[96:99], v24 offset:192
  ds_read_b128 v[116:119], v24 offset:832
  ds_read_b128 v[100:103], v24 offset:256
  ds_read_b128 v[120:123], v24 offset:896
  s_waitcnt lgkmcnt(10)
  s_barrier
  ds_read_b128 v[48:51], v19 offset:0
  ds_read_b128 v[52:55], v20 offset:1024
  ds_read_b128 v[56:59], v19 offset:2048
  ds_read_b128 v[60:63], v20 offset:3072
  ds_read_b32 v64, v21 offset:4096
  ds_read_b32 v65, v22 offset:5120
  ds_read_b128 v[32:35], v17 offset:2048
  ds_read_b128 v[36:39], v18 offset:3072
  ds_read_b128 v[40:43], v17 offset:4096
  ds_read_b128 v[44:47], v18 offset:5120
  v_mul_f32 v69, 0x3e8293ee, v69
  v_mul_f32 v71, 0x3e8293ee, v71
  v_mul_f32 v73, 0x3e8293ee, v73
  v_mul_f32 v75, 0x3e8293ee, v75
  v_mul_f32 v76, v76, v69
  v_mul_f32 v80, v80, v69
  v_mul_f32 v77, v77, v71
  v_mul_f32 v81, v81, v71
  v_mul_f32 v78, v78, v73
  v_mul_f32 v82, v82, v73
  v_mul_f32 v79, v79, v75
  v_mul_f32 v83, v83, v75
  s_waitcnt lgkmcnt(6)
  v_pk_fma_f32 v[128:129], v[48:49], v[68:69], v[128:129] op_sel:[0,0,0] op_sel_hi:[1,0,1] neg_lo:[0,1,0] neg_hi:[0,1,0]
  v_pk_fma_f32 v[130:131], v[50:51], v[68:69], v[130:131] op_sel:[0,0,0] op_sel_hi:[1,0,1] neg_lo:[0,1,0] neg_hi:[0,1,0]
  v_pk_fma_f32 v[144:145], v[52:53], v[68:69], v[144:145] op_sel:[0,0,0] op_sel_hi:[1,0,1] neg_lo:[0,1,0] neg_hi:[0,1,0]
  v_pk_fma_f32 v[146:147], v[54:55], v[68:69], v[146:147] op_sel:[0,0,0] op_sel_hi:[1,0,1] neg_lo:[0,1,0] neg_hi:[0,1,0]
  v_cvt_pk_bf16_f32 v128, v128, v129
  v_cvt_pk_bf16_f32 v129, v130, v131
  v_cvt_pk_bf16_f32 v130, v144, v145
  v_cvt_pk_bf16_f32 v131, v146, v147
  v_pk_fma_f32 v[160:161], v[56:57], v[68:69], v[160:161] op_sel:[0,0,0] op_sel_hi:[1,0,1] neg_lo:[0,1,0] neg_hi:[0,1,0]
  v_pk_fma_f32 v[162:163], v[58:59], v[68:69], v[162:163] op_sel:[0,0,0] op_sel_hi:[1,0,1] neg_lo:[0,1,0] neg_hi:[0,1,0]
  v_pk_fma_f32 v[176:177], v[60:61], v[68:69], v[176:177] op_sel:[0,0,0] op_sel_hi:[1,0,1] neg_lo:[0,1,0] neg_hi:[0,1,0]
  v_pk_fma_f32 v[178:179], v[62:63], v[68:69], v[178:179] op_sel:[0,0,0] op_sel_hi:[1,0,1] neg_lo:[0,1,0] neg_hi:[0,1,0]
  v_cvt_pk_bf16_f32 v160, v160, v161
  v_cvt_pk_bf16_f32 v161, v162, v163
  v_cvt_pk_bf16_f32 v162, v176, v177
  v_cvt_pk_bf16_f32 v163, v178, v179
  v_pk_fma_f32 v[132:133], v[48:49], v[70:71], v[132:133] op_sel:[0,0,0] op_sel_hi:[1,0,1] neg_lo:[0,1,0] neg_hi:[0,1,0]
  v_pk_fma_f32 v[134:135], v[50:51], v[70:71], v[134:135] op_sel:[0,0,0] op_sel_hi:[1,0,1] neg_lo:[0,1,0] neg_hi:[0,1,0]
  v_pk_fma_f32 v[148:149], v[52:53], v[70:71], v[148:149] op_sel:[0,0,0] op_sel_hi:[1,0,1] neg_lo:[0,1,0] neg_hi:[0,1,0]
  v_pk_fma_f32 v[150:151], v[54:55], v[70:71], v[150:151] op_sel:[0,0,0] op_sel_hi:[1,0,1] neg_lo:[0,1,0] neg_hi:[0,1,0]
  v_cvt_pk_bf16_f32 v132, v132, v133
  v_cvt_pk_bf16_f32 v133, v134, v135
  v_cvt_pk_bf16_f32 v134, v148, v149
  v_cvt_pk_bf16_f32 v135, v150, v151
  v_pk_fma_f32 v[164:165], v[56:57], v[70:71], v[164:165] op_sel:[0,0,0] op_sel_hi:[1,0,1] neg_lo:[0,1,0] neg_hi:[0,1,0]
  v_pk_fma_f32 v[166:167], v[58:59], v[70:71], v[166:167] op_sel:[0,0,0] op_sel_hi:[1,0,1] neg_lo:[0,1,0] neg_hi:[0,1,0]
  v_pk_fma_f32 v[180:181], v[60:61], v[70:71], v[180:181] op_sel:[0,0,0] op_sel_hi:[1,0,1] neg_lo:[0,1,0] neg_hi:[0,1,0]
  v_pk_fma_f32 v[182:183], v[62:63], v[70:71], v[182:183] op_sel:[0,0,0] op_sel_hi:[1,0,1] neg_lo:[0,1,0] neg_hi:[0,1,0]
  v_cvt_pk_bf16_f32 v164, v164, v165
  v_cvt_pk_bf16_f32 v165, v166, v167
  v_cvt_pk_bf16_f32 v166, v180, v181
  v_cvt_pk_bf16_f32 v167, v182, v183
  v_mfma_f32_16x16x32_bf16 v[144:147], v[160:163], v[128:131], 0
  v_pk_fma_f32 v[136:137], v[48:49], v[72:73], v[136:137] op_sel:[0,0,0] op_sel_hi:[1,0,1] neg_lo:[0,1,0] neg_hi:[0,1,0]
  v_pk_fma_f32 v[138:139], v[50:51], v[72:73], v[138:139] op_sel:[0,0,0] op_sel_hi:[1,0,1] neg_lo:[0,1,0] neg_hi:[0,1,0]
  v_pk_fma_f32 v[152:153], v[52:53], v[72:73], v[152:153] op_sel:[0,0,0] op_sel_hi:[1,0,1] neg_lo:[0,1,0] neg_hi:[0,1,0]
  v_pk_fma_f32 v[154:155], v[54:55], v[72:73], v[154:155] op_sel:[0,0,0] op_sel_hi:[1,0,1] neg_lo:[0,1,0] neg_hi:[0,1,0]
  v_cvt_pk_bf16_f32 v136, v136, v137
  v_cvt_pk_bf16_f32 v137, v138, v139
  v_cvt_pk_bf16_f32 v138, v152, v153
  v_cvt_pk_bf16_f32 v139, v154, v155
  v_pk_fma_f32 v[168:169], v[56:57], v[72:73], v[168:169] op_sel:[0,0,0] op_sel_hi:[1,0,1] neg_lo:[0,1,0] neg_hi:[0,1,0]
  v_pk_fma_f32 v[170:171], v[58:59], v[72:73], v[170:171] op_sel:[0,0,0] op_sel_hi:[1,0,1] neg_lo:[0,1,0] neg_hi:[0,1,0]
  v_pk_fma_f32 v[184:185], v[60:61], v[72:73], v[184:185] op_sel:[0,0,0] op_sel_hi:[1,0,1] neg_lo:[0,1,0] neg_hi:[0,1,0]
  v_pk_fma_f32 v[186:187], v[62:63], v[72:73], v[186:187] op_sel:[0,0,0] op_sel_hi:[1,0,1] neg_lo:[0,1,0] neg_hi:[0,1,0]
  v_cvt_pk_bf16_f32 v168, v168, v169
  v_cvt_pk_bf16_f32 v169, v170, v171
  v_cvt_pk_bf16_f32 v170, v184, v185
  v_cvt_pk_bf16_f32 v171, v186, v187
  v_mfma_f32_16x16x32_bf16 v[148:151], v[164:167], v[132:135], 0
  v_mfma_f32_16x16x32_bf16 v[180:183], v[160:163], v[132:135], 0
  v_pk_fma_f32 v[140:141], v[48:49], v[74:75], v[140:141] op_sel:[0,0,0] op_sel_hi:[1,0,1] neg_lo:[0,1,0] neg_hi:[0,1,0]
  v_pk_fma_f32 v[142:143], v[50:51], v[74:75], v[142:143] op_sel:[0,0,0] op_sel_hi:[1,0,1] neg_lo:[0,1,0] neg_hi:[0,1,0]
  v_pk_fma_f32 v[156:157], v[52:53], v[74:75], v[156:157] op_sel:[0,0,0] op_sel_hi:[1,0,1] neg_lo:[0,1,0] neg_hi:[0,1,0]
  v_pk_fma_f32 v[158:159], v[54:55], v[74:75], v[158:159] op_sel:[0,0,0] op_sel_hi:[1,0,1] neg_lo:[0,1,0] neg_hi:[0,1,0]
  v_cvt_pk_bf16_f32 v140, v140, v141
  v_cvt_pk_bf16_f32 v141, v142, v143
  v_cvt_pk_bf16_f32 v142, v156, v157
  v_cvt_pk_bf16_f32 v143, v158, v159
  v_pk_fma_f32 v[172:173], v[56:57], v[74:75], v[172:173] op_sel:[0,0,0] op_sel_hi:[1,0,1] neg_lo:[0,1,0] neg_hi:[0,1,0]
  v_pk_fma_f32 v[174:175], v[58:59], v[74:75], v[174:175] op_sel:[0,0,0] op_sel_hi:[1,0,1] neg_lo:[0,1,0] neg_hi:[0,1,0]
  v_pk_fma_f32 v[188:189], v[60:61], v[74:75], v[188:189] op_sel:[0,0,0] op_sel_hi:[1,0,1] neg_lo:[0,1,0] neg_hi:[0,1,0]
  v_pk_fma_f32 v[190:191], v[62:63], v[74:75], v[190:191] op_sel:[0,0,0] op_sel_hi:[1,0,1] neg_lo:[0,1,0] neg_hi:[0,1,0]
  v_cvt_pk_bf16_f32 v172, v172, v173
  v_cvt_pk_bf16_f32 v173, v174, v175
  v_cvt_pk_bf16_f32 v174, v188, v189
  v_cvt_pk_bf16_f32 v175, v190, v191
  s_waitcnt lgkmcnt(0)
  v_pk_fma_f32 v[32:33], v[56:57], v[66:67], v[32:33] op_sel:[0,0,0] op_sel_hi:[1,0,1] neg_lo:[0,1,0] neg_hi:[0,1,0]
  v_pk_fma_f32 v[34:35], v[58:59], v[66:67], v[34:35] op_sel:[0,0,0] op_sel_hi:[1,0,1] neg_lo:[0,1,0] neg_hi:[0,1,0]
  v_pk_fma_f32 v[36:37], v[60:61], v[66:67], v[36:37] op_sel:[0,0,0] op_sel_hi:[1,0,1] neg_lo:[0,1,0] neg_hi:[0,1,0]
  v_pk_fma_f32 v[38:39], v[62:63], v[66:67], v[38:39] op_sel:[0,0,0] op_sel_hi:[1,0,1] neg_lo:[0,1,0] neg_hi:[0,1,0]
  v_cvt_pk_bf16_f32 v32, v32, v33
  v_cvt_pk_bf16_f32 v33, v34, v35
  v_cvt_pk_bf16_f32 v34, v36, v37
  v_cvt_pk_bf16_f32 v35, v38, v39
  v_mfma_f32_16x16x32_bf16 v[152:155], v[168:171], v[136:139], 0
  v_mfma_f32_16x16x32_bf16 v[184:187], v[164:167], v[136:139], 0
  v_mfma_f32_16x16x32_bf16 v[156:159], v[172:175], v[140:143], 0
  v_mfma_f32_16x16x32_bf16 v[188:191], v[168:171], v[140:143], 0
  v_mfma_f32_16x16x32_bf16 v[176:179], v[32:35], v[128:131], 0
  v_pk_fma_f32 v[40:41], v[84:85], v[64:65], v[40:41] op_sel:[0,0,0] op_sel_hi:[1,0,1] neg_lo:[1,0,0] neg_hi:[1,0,0]
  v_pk_fma_f32 v[42:43], v[86:87], v[64:65], v[42:43] op_sel:[0,0,0] op_sel_hi:[1,0,1] neg_lo:[1,0,0] neg_hi:[1,0,0]
  v_pk_mul_f32 v[40:41], v[40:41], v[104:105]
  v_pk_mul_f32 v[42:43], v[42:43], v[106:107]
  v_cvt_pk_bf16_f32 v4, v40, v41
  v_cvt_pk_bf16_f32 v5, v42, v43
  v_pk_fma_f32 v[192:193], v[88:89], v[64:65], v[192:193] op_sel:[0,0,0] op_sel_hi:[1,0,1] neg_lo:[1,0,0] neg_hi:[1,0,0]
  v_pk_fma_f32 v[194:195], v[90:91], v[64:65], v[194:195] op_sel:[0,0,0] op_sel_hi:[1,0,1] neg_lo:[1,0,0] neg_hi:[1,0,0]
  v_pk_mul_f32 v[192:193], v[192:193], v[108:109]
  v_pk_mul_f32 v[194:195], v[194:195], v[110:111]
  v_cvt_pk_bf16_f32 v6, v192, v193
  v_cvt_pk_bf16_f32 v7, v194, v195
  v_pk_fma_f32 v[196:197], v[92:93], v[64:65], v[196:197] op_sel:[0,0,0] op_sel_hi:[1,0,1] neg_lo:[1,0,0] neg_hi:[1,0,0]
  v_pk_fma_f32 v[198:199], v[94:95], v[64:65], v[198:199] op_sel:[0,0,0] op_sel_hi:[1,0,1] neg_lo:[1,0,0] neg_hi:[1,0,0]
  v_pk_mul_f32 v[196:197], v[196:197], v[112:113]
  v_pk_mul_f32 v[198:199], v[198:199], v[114:115]
  v_cvt_pk_bf16_f32 v8, v196, v197
  v_cvt_pk_bf16_f32 v9, v198, v199
  v_pk_fma_f32 v[200:201], v[96:97], v[64:65], v[200:201] op_sel:[0,0,0] op_sel_hi:[1,0,1] neg_lo:[1,0,0] neg_hi:[1,0,0]
  v_pk_fma_f32 v[202:203], v[98:99], v[64:65], v[202:203] op_sel:[0,0,0] op_sel_hi:[1,0,1] neg_lo:[1,0,0] neg_hi:[1,0,0]
  v_pk_mul_f32 v[200:201], v[200:201], v[116:117]
  v_pk_mul_f32 v[202:203], v[202:203], v[118:119]
  v_cvt_pk_bf16_f32 v10, v200, v201
  v_cvt_pk_bf16_f32 v11, v202, v203
  v_pk_fma_f32 v[204:205], v[100:101], v[64:65], v[204:205] op_sel:[0,0,0] op_sel_hi:[1,0,1] neg_lo:[1,0,0] neg_hi:[1,0,0]
  v_pk_fma_f32 v[206:207], v[102:103], v[64:65], v[206:207] op_sel:[0,0,0] op_sel_hi:[1,0,1] neg_lo:[1,0,0] neg_hi:[1,0,0]
  v_pk_mul_f32 v[204:205], v[204:205], v[120:121]
  v_pk_mul_f32 v[206:207], v[206:207], v[122:123]
  v_cvt_pk_bf16_f32 v12, v204, v205
  v_cvt_pk_bf16_f32 v13, v206, v207
  v_pk_fma_f32 v[44:45], v[84:85], v[64:65], v[44:45] op_sel:[0,1,0] op_sel_hi:[1,1,1] neg_lo:[1,0,0] neg_hi:[1,0,0]
  v_pk_fma_f32 v[46:47], v[86:87], v[64:65], v[46:47] op_sel:[0,1,0] op_sel_hi:[1,1,1] neg_lo:[1,0,0] neg_hi:[1,0,0]
  v_pk_mul_f32 v[44:45], v[44:45], v[104:105]
  v_pk_mul_f32 v[46:47], v[46:47], v[106:107]
  v_cvt_pk_bf16_f32 v224, v44, v45
  v_cvt_pk_bf16_f32 v225, v46, v47
  v_pk_fma_f32 v[208:209], v[88:89], v[64:65], v[208:209] op_sel:[0,1,0] op_sel_hi:[1,1,1] neg_lo:[1,0,0] neg_hi:[1,0,0]
  v_pk_fma_f32 v[210:211], v[90:91], v[64:65], v[210:211] op_sel:[0,1,0] op_sel_hi:[1,1,1] neg_lo:[1,0,0] neg_hi:[1,0,0]
  v_pk_mul_f32 v[208:209], v[208:209], v[108:109]
  v_pk_mul_f32 v[210:211], v[210:211], v[110:111]
  v_cvt_pk_bf16_f32 v226, v208, v209
  v_cvt_pk_bf16_f32 v227, v210, v211
  v_pk_fma_f32 v[212:213], v[92:93], v[64:65], v[212:213] op_sel:[0,1,0] op_sel_hi:[1,1,1] neg_lo:[1,0,0] neg_hi:[1,0,0]
  v_pk_fma_f32 v[214:215], v[94:95], v[64:65], v[214:215] op_sel:[0,1,0] op_sel_hi:[1,1,1] neg_lo:[1,0,0] neg_hi:[1,0,0]
  v_pk_mul_f32 v[212:213], v[212:213], v[112:113]
  v_pk_mul_f32 v[214:215], v[214:215], v[114:115]
  v_cvt_pk_bf16_f32 v228, v212, v213
  v_cvt_pk_bf16_f32 v229, v214, v215
  v_pk_fma_f32 v[216:217], v[96:97], v[64:65], v[216:217] op_sel:[0,1,0] op_sel_hi:[1,1,1] neg_lo:[1,0,0] neg_hi:[1,0,0]
  v_pk_fma_f32 v[218:219], v[98:99], v[64:65], v[218:219] op_sel:[0,1,0] op_sel_hi:[1,1,1] neg_lo:[1,0,0] neg_hi:[1,0,0]
  v_pk_mul_f32 v[216:217], v[216:217], v[116:117]
  v_pk_mul_f32 v[218:219], v[218:219], v[118:119]
  v_cvt_pk_bf16_f32 v230, v216, v217
  v_cvt_pk_bf16_f32 v231, v218, v219
  v_pk_fma_f32 v[220:221], v[100:101], v[64:65], v[220:221] op_sel:[0,1,0] op_sel_hi:[1,1,1] neg_lo:[1,0,0] neg_hi:[1,0,0]
  v_pk_fma_f32 v[222:223], v[102:103], v[64:65], v[222:223] op_sel:[0,1,0] op_sel_hi:[1,1,1] neg_lo:[1,0,0] neg_hi:[1,0,0]
  v_pk_mul_f32 v[220:221], v[220:221], v[120:121]
  v_pk_mul_f32 v[222:223], v[222:223], v[122:123]
  v_cvt_pk_bf16_f32 v232, v220, v221
  v_cvt_pk_bf16_f32 v233, v222, v223
  v_cndmask_b32 v148, v148, v149, s[48:49]
  v_cndmask_b32 v180, v180, v181, s[48:49]
  v_cndmask_b32 v150, v150, v151, s[48:49]
  v_cndmask_b32 v182, v182, v183, s[48:49]
  v_cndmask_b32 v36, v148, v180, s[50:51]
  v_cndmask_b32 v37, v150, v182, s[52:53]
  v_mul_f32 v36, v36, v77
  v_mul_f32 v37, v37, v81
  v_cndmask_b32 v152, v152, v153, s[48:49]
  v_cndmask_b32 v184, v184, v185, s[48:49]
  v_cndmask_b32 v154, v154, v155, s[48:49]
  v_cndmask_b32 v186, v186, v187, s[48:49]
  v_cndmask_b32 v40, v152, v184, s[50:51]
  v_cndmask_b32 v41, v154, v186, s[52:53]
  v_mul_f32 v40, v40, v78
  v_mul_f32 v41, v41, v82
  v_cndmask_b32 v156, v156, v157, s[48:49]
  v_cndmask_b32 v188, v188, v189, s[48:49]
  v_cndmask_b32 v158, v158, v159, s[48:49]
  v_cndmask_b32 v190, v190, v191, s[48:49]
  v_cndmask_b32 v44, v156, v188, s[50:51]
  v_cndmask_b32 v45, v158, v190, s[52:53]
  v_mul_f32 v44, v44, v79
  v_mul_f32 v45, v45, v83
  v_cndmask_b32 v144, v144, v145, s[48:49]
  v_cndmask_b32 v176, v176, v177, s[48:49]
  v_cndmask_b32 v146, v146, v147, s[48:49]
  v_cndmask_b32 v178, v178, v179, s[48:49]
  v_cndmask_b32 v32, v144, v176, s[50:51]
  v_cndmask_b32 v33, v146, v178, s[52:53]
  v_mul_f32 v32, v32, v76
  v_mul_f32 v33, v33, v80
  v_mov_b32 v48, 0xceabfb8f
  v_cndmask_b32 v32, v32, v48, s[54:55]
  v_cndmask_b32 v33, v33, v48, s[14:15]
  v_max_f32 v34, v32, v33
  v_max_f32 v38, v36, v37
  v_max_f32 v42, v40, v41
  v_max_f32 v46, v44, v45
  v_mov_b32 v35, v34
  v_mov_b32 v39, v38
  v_mov_b32 v43, v42
  v_mov_b32 v47, v46
  v_permlane32_swap_b32 v34, v35
  v_permlane32_swap_b32 v38, v39
  v_permlane32_swap_b32 v42, v43
  v_permlane32_swap_b32 v46, v47
  v_max_f32 v34, v34, v35
  v_max_f32 v38, v38, v39
  v_max_f32 v42, v42, v43
  v_max_f32 v46, v46, v47
  v_mov_b32 v35, v34
  v_mov_b32 v39, v38
  v_mov_b32 v43, v42
  v_mov_b32 v47, v46
  v_permlane16_swap_b32 v34, v35
  v_permlane16_swap_b32 v38, v39
  v_permlane16_swap_b32 v42, v43
  v_permlane16_swap_b32 v46, v47
  v_max_f32 v34, v34, v35
  v_max_f32 v38, v38, v39
  v_max_f32 v42, v42, v43
  v_max_f32 v46, v46, v47
  v_sub_f32 v32, v32, v34
  v_sub_f32 v33, v33, v34
  v_sub_f32 v36, v36, v38
  v_sub_f32 v37, v37, v38
  v_sub_f32 v40, v40, v42
  v_sub_f32 v41, v41, v42
  v_sub_f32 v44, v44, v46
  v_sub_f32 v45, v45, v46
  v_exp_f32 v32, v32
  v_exp_f32 v33, v33
  v_exp_f32 v36, v36
  v_exp_f32 v37, v37
  v_exp_f32 v40, v40
  v_exp_f32 v41, v41
  v_exp_f32 v44, v44
  v_exp_f32 v45, v45
  v_cvt_pk_bf16_f32 v32, v32, v32
  v_cvt_pk_bf16_f32 v33, v33, v33
  v_and_b32 v128, v32, v27
  v_and_b32 v129, v33, v29
  v_and_b32 v130, v32, v28
  v_and_b32 v131, v33, v30
  v_cvt_pk_bf16_f32 v36, v36, v36
  v_cvt_pk_bf16_f32 v37, v37, v37
  v_and_b32 v132, v36, v27
  v_and_b32 v133, v37, v29
  v_and_b32 v134, v36, v28
  v_and_b32 v135, v37, v30
  v_mfma_f32_16x16x32_bf16 v[144:147], v[236:239], v[128:131], 0
  v_mfma_f32_16x16x32_bf16 v[192:195], v[4:7], v[128:131], 0
  v_mfma_f32_16x16x32_bf16 v[208:211], v[224:227], v[128:131], 0
  v_cvt_pk_bf16_f32 v40, v40, v40
  v_cvt_pk_bf16_f32 v41, v41, v41
  v_and_b32 v136, v40, v27
  v_and_b32 v137, v41, v29
  v_and_b32 v138, v40, v28
  v_and_b32 v139, v41, v30
  v_mfma_f32_16x16x32_bf16 v[148:151], v[236:239], v[132:135], 0
  v_mfma_f32_16x16x32_bf16 v[196:199], v[6:9], v[132:135], 0
  v_mfma_f32_16x16x32_bf16 v[212:215], v[226:229], v[132:135], 0
  v_cvt_pk_bf16_f32 v44, v44, v44
  v_cvt_pk_bf16_f32 v45, v45, v45
  v_and_b32 v140, v44, v27
  v_and_b32 v141, v45, v29
  v_and_b32 v142, v44, v28
  v_and_b32 v143, v45, v30
  v_mfma_f32_16x16x32_bf16 v[152:155], v[236:239], v[136:139], 0
  v_mfma_f32_16x16x32_bf16 v[200:203], v[8:11], v[136:139], 0
  v_mfma_f32_16x16x32_bf16 v[216:219], v[228:231], v[136:139], 0
  v_mfma_f32_16x16x32_bf16 v[156:159], v[236:239], v[140:143], 0
  v_mfma_f32_16x16x32_bf16 v[204:207], v[10:13], v[140:143], 0
  v_mfma_f32_16x16x32_bf16 v[220:223], v[230:233], v[140:143], 0
  v_rcp_f32 v144, v144
  s_mov_b32 s3, 0
  v_pk_mul_f32 v[192:193], v[192:193], v[144:145] op_sel_hi:[1,0]
  v_pk_mul_f32 v[194:195], v[194:195], v[144:145] op_sel_hi:[1,0]
  v_pk_mul_f32 v[208:209], v[208:209], v[144:145] op_sel_hi:[1,0]
  v_pk_mul_f32 v[210:211], v[210:211], v[144:145] op_sel_hi:[1,0]
  v_cvt_pk_bf16_f32 v48, v192, v193
  v_cvt_pk_bf16_f32 v49, v194, v195
  v_cvt_pk_bf16_f32 v50, v208, v209
  v_cvt_pk_bf16_f32 v51, v210, v211
  s_nop 1
  v_permlane16_swap_b32 v48, v50
  v_permlane16_swap_b32 v49, v51
  buffer_store_dwordx4 v[48:51], v31, s[44:47], s3 offen sc1
  v_rcp_f32 v148, v148
  s_mov_b32 s3, 32768
  v_pk_mul_f32 v[196:197], v[196:197], v[148:149] op_sel_hi:[1,0]
  v_pk_mul_f32 v[198:199], v[198:199], v[148:149] op_sel_hi:[1,0]
  v_pk_mul_f32 v[212:213], v[212:213], v[148:149] op_sel_hi:[1,0]
  v_pk_mul_f32 v[214:215], v[214:215], v[148:149] op_sel_hi:[1,0]
  v_cvt_pk_bf16_f32 v52, v196, v197
  v_cvt_pk_bf16_f32 v53, v198, v199
  v_cvt_pk_bf16_f32 v54, v212, v213
  v_cvt_pk_bf16_f32 v55, v214, v215
  s_nop 1
  v_permlane16_swap_b32 v52, v54
  v_permlane16_swap_b32 v53, v55
  buffer_store_dwordx4 v[52:55], v31, s[44:47], s3 offen sc1
  v_rcp_f32 v152, v152
  s_mov_b32 s3, 65536
  v_pk_mul_f32 v[200:201], v[200:201], v[152:153] op_sel_hi:[1,0]
  v_pk_mul_f32 v[202:203], v[202:203], v[152:153] op_sel_hi:[1,0]
  v_pk_mul_f32 v[216:217], v[216:217], v[152:153] op_sel_hi:[1,0]
  v_pk_mul_f32 v[218:219], v[218:219], v[152:153] op_sel_hi:[1,0]
  v_cvt_pk_bf16_f32 v56, v200, v201
  v_cvt_pk_bf16_f32 v57, v202, v203
  v_cvt_pk_bf16_f32 v58, v216, v217
  v_cvt_pk_bf16_f32 v59, v218, v219
  s_nop 1
  v_permlane16_swap_b32 v56, v58
  v_permlane16_swap_b32 v57, v59
  buffer_store_dwordx4 v[56:59], v31, s[44:47], s3 offen sc1
  v_rcp_f32 v156, v156
  s_mov_b32 s3, 98304
  v_pk_mul_f32 v[204:205], v[204:205], v[156:157] op_sel_hi:[1,0]
  v_pk_mul_f32 v[206:207], v[206:207], v[156:157] op_sel_hi:[1,0]
  v_pk_mul_f32 v[220:221], v[220:221], v[156:157] op_sel_hi:[1,0]
  v_pk_mul_f32 v[222:223], v[222:223], v[156:157] op_sel_hi:[1,0]
  v_cvt_pk_bf16_f32 v60, v204, v205
  v_cvt_pk_bf16_f32 v61, v206, v207
  v_cvt_pk_bf16_f32 v62, v220, v221
  v_cvt_pk_bf16_f32 v63, v222, v223
  s_nop 1
  v_permlane16_swap_b32 v60, v62
  v_permlane16_swap_b32 v61, v63
  buffer_store_dwordx4 v[60:63], v31, s[44:47], s3 offen sc1
  s_waitcnt vmcnt(0) lgkmcnt(0)
  s_barrier
  s_add_u32 s97, s97, 1
  s_branch L_wo_body
.section .rodata,"a"
.p2align 6
.amdhsa_kernel interleave_layers__sliding_local_dilated__dense_activation_gelu__prompt_kernel
  .amdhsa_next_free_vgpr 256
  .amdhsa_next_free_sgpr 102
  .amdhsa_accum_offset 256
  .amdhsa_group_segment_fixed_size 0
  .amdhsa_kernarg_size 88
  .amdhsa_user_sgpr_count 2
  .amdhsa_user_sgpr_kernarg_segment_ptr 1
  .amdhsa_system_sgpr_workgroup_id_x 1
  .amdhsa_float_denorm_mode_32 3
  .amdhsa_float_denorm_mode_16_64 3
.end_amdhsa_kernel
.text
L_attn_c1:
L_wo_c0:
L_wo_body:
  s_cmp_ge_u32 s2, 256
  s_cbranch_scc1 L_wo_end
  v_lshrrev_b32 v2, 6, v0
  v_and_b32 v1, 63, v0
  v_readfirstlane_b32 s70, v2
  s_and_b32 s3, s2, 7
  s_lshr_b32 s99, s2, 3
  s_and_b32 s5, s3, 3
  s_lshl_b32 s5, s5, 2
  s_and_b32 s6, s99, 3
  s_add_u32 s68, s5, s6
  s_lshr_b32 s5, s3, 2
  s_lshr_b32 s78, s99, 2
  s_lshl1_add_u32 s69, s78, s5
  s_add_u32 s3, s68, s78
  s_lshl_b32 s3, s3, 3
  s_lshl_b32 s85, 0xffff02, s3
  s_sub_u32 s3, 0, s3
  s_lshr_b32 s3, 0xffff02, s3
  s_or_b32 s85, s85, s3
  s_cmp_lt_u32 s70, 4
  s_cbranch_scc1 L_wo_compute
L_wo_loader:
  s_add_u32 s3, s96, s70
  s_cmp_lg_u32 s3, 4
  s_cbranch_scc1 L_wo_chk0
  s_load_dwordx2 s[64:65], s[0:1], 72
  s_waitcnt lgkmcnt(0)
  s_and_b32 s65, s65, 0xffff
  s_mov_b32 s66, 256
  s_mov_b32 s67, 0x00020000
  v_lshlrev_b32 v17, 2, v1
  buffer_load_dword v12, v17, s[64:67], 0 offen sc1
L_wo_chk0:
  s_cmp_lg_u32 s96, 0
  s_cbranch_scc1 L_wo_nofirst
  s_waitcnt vmcnt(1)
  s_mov_b32 s7, 0xffff0000
  v_lshlrev_b32 v32, 16, v64
  v_and_b32 v33, s7, v64
  v_lshlrev_b32 v34, 16, v65
  v_and_b32 v35, s7, v65
  v_lshlrev_b32 v36, 16, v66
  v_and_b32 v37, s7, v66
  v_lshlrev_b32 v38, 16, v67
  v_and_b32 v39, s7, v67
  v_lshlrev_b32 v40, 16, v68
  v_and_b32 v41, s7, v68
  v_pk_add_f32 v[32:33], v[32:33], v[40:41]
  v_lshlrev_b32 v40, 16, v69
  v_and_b32 v41, s7, v69
  v_pk_add_f32 v[34:35], v[34:35], v[40:41]
  v_lshlrev_b32 v40, 16, v70
  v_and_b32 v41, s7, v70
  v_pk_add_f32 v[36:37], v[36:37], v[40:41]
  v_lshlrev_b32 v40, 16, v71
  v_and_b32 v41, s7, v71
  v_pk_add_f32 v[38:39], v[38:39], v[40:41]
  v_lshlrev_b32 v40, 16, v72
  v_and_b32 v41, s7, v72
  v_pk_add_f32 v[32:33], v[32:33], v[40:41]
  v_lshlrev_b32 v40, 16, v73
  v_and_b32 v41, s7, v73
  v_pk_add_f32 v[34:35], v[34:35], v[40:41]
  v_lshlrev_b32 v40, 16, v74
  v_and_b32 v41, s7, v74
  v_pk_add_f32 v[36:37], v[36:37], v[40:41]
  v_lshlrev_b32 v40, 16, v75
  v_and_b32 v41, s7, v75
  v_pk_add_f32 v[38:39], v[38:39], v[40:41]
  v_lshlrev_b32 v40, 16, v76
  v_and_b32 v41, s7, v76
  v_pk_add_f32 v[32:33], v[32:33], v[40:41]
  v_lshlrev_b32 v40, 16, v77
  v_and_b32 v41, s7, v77
  v_pk_add_f32 v[34:35], v[34:35], v[40:41]
  v_lshlrev_b32 v40, 16, v78
  v_and_b32 v41, s7, v78
  v_pk_add_f32 v[36:37], v[36:37], v[40:41]
  v_lshlrev_b32 v40, 16, v79
  v_and_b32 v41, s7, v79
  v_pk_add_f32 v[38:39], v[38:39], v[40:41]
  v_lshlrev_b32 v40, 16, v80
  v_and_b32 v41, s7, v80
  v_pk_add_f32 v[32:33], v[32:33], v[40:41]
  v_lshlrev_b32 v40, 16, v81
  v_and_b32 v41, s7, v81
  v_pk_add_f32 v[34:35], v[34:35], v[40:41]
  v_lshlrev_b32 v40, 16, v82
  v_and_b32 v41, s7, v82
  v_pk_add_f32 v[36:37], v[36:37], v[40:41]
  v_lshlrev_b32 v40, 16, v83
  v_and_b32 v41, s7, v83
  v_pk_add_f32 v[38:39], v[38:39], v[40:41]
  v_lshlrev_b32 v40, 16, v84
  v_and_b32 v41, s7, v84
  v_pk_add_f32 v[32:33], v[32:33], v[40:41]
  v_lshlrev_b32 v40, 16, v85
  v_and_b32 v41, s7, v85
  v_pk_add_f32 v[34:35], v[34:35], v[40:41]
  v_lshlrev_b32 v40, 16, v86
  v_and_b32 v41, s7, v86
  v_pk_add_f32 v[36:37], v[36:37], v[40:41]
  v_lshlrev_b32 v40, 16, v87
  v_and_b32 v41, s7, v87
  v_pk_add_f32 v[38:39], v[38:39], v[40:41]
  v_lshlrev_b32 v40, 16, v88
  v_and_b32 v41, s7, v88
  v_pk_add_f32 v[32:33], v[32:33], v[40:41]
  v_lshlrev_b32 v40, 16, v89
  v_and_b32 v41, s7, v89
  v_pk_add_f32 v[34:35], v[34:35], v[40:41]
  v_lshlrev_b32 v40, 16, v90
  v_and_b32 v41, s7, v90
  v_pk_add_f32 v[36:37], v[36:37], v[40:41]
  v_lshlrev_b32 v40, 16, v91
  v_and_b32 v41, s7, v91
  v_pk_add_f32 v[38:39], v[38:39], v[40:41]
  v_lshlrev_b32 v40, 16, v92
  v_and_b32 v41, s7, v92
  v_pk_add_f32 v[32:33], v[32:33], v[40:41]
  v_lshlrev_b32 v40, 16, v93
  v_and_b32 v41, s7, v93
  v_pk_add_f32 v[34:35], v[34:35], v[40:41]
  v_lshlrev_b32 v40, 16, v94
  v_and_b32 v41, s7, v94
  v_pk_add_f32 v[36:37], v[36:37], v[40:41]
  v_lshlrev_b32 v40, 16, v95
  v_and_b32 v41, s7, v95
  v_pk_add_f32 v[38:39], v[38:39], v[40:41]
  s_add_u32 s52, s22, 24641536
  s_addc_u32 s53, s23, 0
  s_and_b32 s53, s53, 0xffff
  s_mov_b32 s54, 262144
  s_mov_b32 s55, 0x00020000
  v_permlane32_swap_b32 v32, v36
  v_permlane32_swap_b32 v33, v37
  v_permlane32_swap_b32 v34, v38
  v_permlane32_swap_b32 v35, v39
  v_add_f32 v32, v32, v36
  v_add_f32 v33, v33, v37
  v_add_f32 v34, v34, v38
  v_add_f32 v35, v35, v39
  v_and_b32 v2, 7, v1
  v_lshlrev_b32 v2, 5, v2
  v_permlane16_swap_b32 v32, v34
  v_permlane16_swap_b32 v33, v35
  v_add_f32 v32, v32, v34
  v_add_f32 v33, v33, v35
  v_lshrrev_b32 v3, 4, v1
  v_lshl_add_u32 v2, v3, 3, v2
  v_add_f32_dpp v32, v32, v32 row_ror:8 row_mask:0xf bank_mask:0xf
  v_add_f32_dpp v33, v33, v33 row_ror:8 row_mask:0xf bank_mask:0xf
  buffer_store_dwordx2 v[32:33], v2, s[52:55], s94 offen sc1
L_wo_nofirst:
  v_and_b32 v2, 3, v1
  v_lshlrev_b32 v2, 3, v2
  v_bfe_i32 v16, s85, v2, 8
  s_and_b32 s3, s68, 3
  s_mul_i32 s4, s3, 4
  v_add3_u32 v3, v16, v1, s4
  v_and_b32 v3, 15, v3
  v_lshlrev_b32 v16, 17, v3
  s_add_u32 s9, s70, s68
  s_and_b32 s9, s9, 3
  s_lshl_b32 s77, s9, 11
  v_and_b32 v10, 7, v1
  v_lshrrev_b32 v3, 3, v1
  s_lshl_b32 s10, s9, 4
  v_add_u32 v3, s10, v3
  v_mul_u32_u24 v3, 2048, v3
  v_lshrrev_b32 v2, 3, v1
  v_and_b32 v2, 2, v2
  v_xor_b32 v2, v2, v10
  s_lshl_b32 s10, s69, 7
  v_add_u32 v3, s10, v3
  v_lshl_add_u32 v8, v2, 4, v3
  v_xor_b32 v2, 4, v2
  v_add_u32 v3, 16384, v3
  v_lshl_add_u32 v9, v2, 4, v3
  s_mov_b32 s40, s20
  s_and_b32 s41, s21, 0xffff
  s_mov_b32 s42, 2097152
  s_mov_b32 s43, 0x00020000
  v_readlane_b32 s74, v16, 0
  s_add_u32 m0, s77, 28672
  s_add_u32 s4, s74, 0
  buffer_load_dwordx4 v8, s[40:43], s4 offen lds
  s_add_u32 m0, s77, 29696
  s_nop 0
  buffer_load_dwordx4 v9, s[40:43], s4 offen lds
  v_readlane_b32 s74, v16, 1
  s_add_u32 m0, s77, 36864
  s_add_u32 s4, s74, 0
  buffer_load_dwordx4 v8, s[40:43], s4 offen lds
  s_add_u32 m0, s77, 37888
  s_nop 0
  buffer_load_dwordx4 v9, s[40:43], s4 offen lds
  v_readlane_b32 s74, v16, 2
  s_add_u32 m0, s77, 45056
  s_add_u32 s4, s74, 0
  buffer_load_dwordx4 v8, s[40:43], s4 offen lds
  s_add_u32 m0, s77, 46080
  s_nop 0
  buffer_load_dwordx4 v9, s[40:43], s4 offen lds
  v_readlane_b32 s74, v16, 3
  s_add_u32 m0, s77, 53248
  s_add_u32 s4, s74, 0
  buffer_load_dwordx4 v8, s[40:43], s4 offen lds
  s_add_u32 m0, s77, 54272
  s_nop 0
  buffer_load_dwordx4 v9, s[40:43], s4 offen lds
  v_readlane_b32 s74, v16, 4
  s_add_u32 m0, s77, 61440
  s_add_u32 s4, s74, 0
  buffer_load_dwordx4 v8, s[40:43], s4 offen lds
  s_add_u32 m0, s77, 62464
  s_nop 0
  buffer_load_dwordx4 v9, s[40:43], s4 offen lds
  v_readlane_b32 s74, v16, 5
  s_add_u32 m0, s77, 69632
  s_add_u32 s4, s74, 0
  buffer_load_dwordx4 v8, s[40:43], s4 offen lds
  s_add_u32 m0, s77, 70656
  s_nop 0
  buffer_load_dwordx4 v9, s[40:43], s4 offen lds
  s_waitcnt vmcnt(12)
  s_add_u32 s3, s96, s70
  s_cmp_lg_u32 s3, 4
  s_cbranch_scc1 L_wo_chk1
  v_cmp_ne_u32 vcc, 0x01010101, v12
  s_cbranch_vccz L_wo_chk1
  s_load_dwordx2 s[64:65], s[0:1], 72
  s_waitcnt lgkmcnt(0)
  s_and_b32 s65, s65, 0xffff
  s_mov_b32 s66, 256
  s_mov_b32 s67, 0x00020000
  v_lshlrev_b32 v17, 2, v1
  s_mov_b32 s79, 0x100000
L_wo_chkl:
  buffer_load_dword v12, v17, s[64:67], 0 offen sc1
  s_sub_u32 s79, s79, 1
  s_cbranch_scc1 L_wo_chk1
  s_waitcnt vmcnt(0)
  v_cmp_ne_u32 vcc, 0x01010101, v12
  s_cbranch_vccnz L_wo_chkl
L_wo_chk1:
  s_add_u32 s44, s22, 41943040
  s_addc_u32 s45, s23, 0
  s_and_b32 s45, s45, 0xffff
  s_mov_b32 s46, 524288
  s_mov_b32 s47, 0x00020000
  s_lshl4_add_u32 s3, s97, s68
  s_and_b32 s4, s69, 15
  s_lshl4_add_u32 s3, s3, s4
  s_lshl_b32 s3, s3, 7
  s_sub_u32 s3, s3, 32768
  v_lshlrev_b32 v11, 7, v1
  v_and_b32 v2, 15, v1
  v_lshlrev_b32 v2, 2, v2
  v_mov_b32 v3, 1
  s_mov_b32 s79, 0x100000
  s_cmp_lg_u32 s70, 4
  s_barrier
  s_cbranch_scc1 L_wo_nofl
  s_mov_b32 exec_lo, 0xffff
  s_mov_b32 exec_hi, 0
  buffer_store_dword v3, v11, s[44:47], s87 offen sc1
  s_mov_b64 exec, -1
L_wo_nofl:
  s_mov_b32 s5, s3
  v_readlane_b32 s74, v16, 6
  s_add_u32 m0, s77, 77824
  s_add_u32 s4, s74, 0
  buffer_load_dwordx4 v8, s[40:43], s4 offen lds
  s_add_u32 m0, s77, 78848
  s_nop 0
  buffer_load_dwordx4 v9, s[40:43], s4 offen lds
  v_readlane_b32 s74, v16, 7
  s_add_u32 m0, s77, 86016
  s_add_u32 s4, s74, 0
  buffer_load_dwordx4 v8, s[40:43], s4 offen lds
  s_add_u32 m0, s77, 87040
  s_nop 0
  buffer_load_dwordx4 v9, s[40:43], s4 offen lds
  v_readlane_b32 s74, v16, 8
  s_add_u32 m0, s77, 94208
  s_add_u32 s4, s74, 0
  buffer_load_dwordx4 v8, s[40:43], s4 offen lds
  s_add_u32 m0, s77, 95232
  s_nop 0
  buffer_load_dwordx4 v9, s[40:43], s4 offen lds
  v_readlane_b32 s74, v16, 9
  s_add_u32 m0, s77, 102400
  s_add_u32 s4, s74, 0
  buffer_load_dwordx4 v8, s[40:43], s4 offen lds
  s_add_u32 m0, s77, 103424
  s_nop 0
  buffer_load_dwordx4 v9, s[40:43], s4 offen lds
  v_readlane_b32 s74, v16, 10
  s_add_u32 m0, s77, 110592
  s_add_u32 s4, s74, 0
  buffer_load_dwordx4 v8, s[40:43], s4 offen lds
  s_add_u32 m0, s77, 111616
  s_nop 0
  buffer_load_dwordx4 v9, s[40:43], s4 offen lds
  v_readlane_b32 s74, v16, 11
  s_add_u32 m0, s77, 118784
  s_add_u32 s4, s74, 0
  buffer_load_dwordx4 v8, s[40:43], s4 offen lds
  s_add_u32 m0, s77, 119808
  s_nop 0
  buffer_load_dwordx4 v9, s[40:43], s4 offen lds
  v_readlane_b32 s74, v16, 12
  s_add_u32 m0, s77, 131072
  s_add_u32 s4, s74, 0
  buffer_load_dwordx4 v8, s[40:43], s4 offen lds
  s_add_u32 m0, s77, 132096
  s_nop 0
  buffer_load_dwordx4 v9, s[40:43], s4 offen lds
  v_readlane_b32 s74, v16, 13
  s_add_u32 m0, s77, 139264
  s_add_u32 s4, s74, 0
  buffer_load_dwordx4 v8, s[40:43], s4 offen lds
  s_add_u32 m0, s77, 140288
  s_nop 0
  buffer_load_dwordx4 v9, s[40:43], s4 offen lds
  v_readlane_b32 s74, v16, 14
  s_add_u32 m0, s77, 147456
  s_add_u32 s4, s74, 0
  buffer_load_dwordx4 v8, s[40:43], s4 offen lds
  s_add_u32 m0, s77, 148480
  s_nop 0
  buffer_load_dwordx4 v9, s[40:43], s4 offen lds
  v_readlane_b32 s74, v16, 15
  s_add_u32 m0, s77, 155648
  s_add_u32 s4, s74, 0
  buffer_load_dwordx4 v8, s[40:43], s4 offen lds
  s_add_u32 m0, s77, 156672
  s_nop 0
  buffer_load_dwordx4 v9, s[40:43], s4 offen lds
  s_mov_b32 s3, s5
  s_cmp_lg_u32 s70, 4
  s_cbranch_scc1 L_wo_dep
L_wo_poll:
  buffer_load_dword v3, v2, s[44:47], s3 offen sc1
  s_sub_u32 s79, s79, 1
  s_cbranch_scc1 L_wo_dep
  s_waitcnt vmcnt(0)
  v_cmp_ne_u32 vcc, 1, v3
  s_cbranch_vccnz L_wo_poll
L_wo_dep:
  s_waitcnt vmcnt(22) lgkmcnt(0)
  s_barrier
  s_waitcnt vmcnt(8)
  s_barrier
  s_waitcnt vmcnt(0)
  s_barrier
  s_waitcnt vmcnt(0)
  s_lshl_b32 s87, s97, 15
  s_lshl_b32 s4, s68, 11
  s_add_u32 s87, s87, s4
  s_lshl_b32 s4, s69, 2
  s_add_u32 s87, s87, s4
  s_add_u32 s97, s97, 1
  s_branch L_w1_body
L_wo_end:
  s_endpgm
L_wo_compute:
  v_and_b32 v2, 3, v1
  v_lshlrev_b32 v2, 3, v2
  v_bfe_i32 v15, s85, v2, 8
  s_and_b32 s3, s68, 3
  s_mul_i32 s4, s3, 4
  v_add3_u32 v3, v15, v1, s4
  v_and_b32 v3, 15, v3
  v_lshlrev_b32 v15, 11, v3
  v_and_b32 v3, 15, v1
  v_lshrrev_b32 v2, 4, v1
  s_lshl_b32 s8, s68, 7
  s_lshl_b32 s9, s70, 5
  s_add_u32 s8, s8, s9
  s_mul_i32 s9, s8, 2048
  v_add_u32 v13, s8, v3
  s_lshl_b32 s10, s69, 7
  v_lshl_add_u32 v14, v2, 3, s10
  v_and_b32 v16, 1, v2
  v_lshrrev_b32 v17, 1, v2
  v_lshl_add_u32 v16, v16, 1, v17
  v_lshlrev_b32 v16, 8, v16
  v_lshl_add_u32 v16, v3, 4, v16
  s_add_u32 s9, s8, s69
  s_lshl_b32 s9, s9, 11
  v_add_u32 v12, s9, v16
  s_lshl_b32 s9, s70, 12
  v_add_u32 v19, s9, v16
  v_lshl_add_u32 v18, v17, 4, v13
  v_lshlrev_b32 v18, 3, v18
  v_and_b32 v16, 1, v2
  v_lshl_add_u32 v18, v16, 2, v18
  s_lshl_b32 s10, s69, 14
  v_add_u32 v18, s10, v18
  v_bfe_u32 v6, v1, 2, 2
  v_lshl_add_u32 v6, v2, 3, v6
  v_lshlrev_b32 v6, 7, v6
  v_and_b32 v17, 3, v1
  v_lshl_add_u32 v6, v17, 3, v6
  v_bfe_u32 v17, v1, 3, 2
  v_lshl_add_u32 v6, v17, 5, v6
  v_xor_b32 v7, 32, v6
  v_xor_b32 v8, 64, v6
  v_xor_b32 v9, 96, v6
  s_mov_b32 s11, 0xffff0000
  s_mov_b32 s36, s34
  s_and_b32 s37, s35, 0xffff
  s_mov_b32 s38, 4194304
  s_mov_b32 s39, 0x00020000
  s_add_u32 s44, s34, 4194304
  s_addc_u32 s45, s35, 0
  s_and_b32 s45, s45, 0xffff
  s_mov_b32 s46, 4194304
  s_mov_b32 s47, 0x00020000
  s_add_u32 s56, s34, 24117248
  s_addc_u32 s57, s35, 0
  s_and_b32 s57, s57, 0xffff
  s_mov_b32 s58, 262144
  s_mov_b32 s59, 0x00020000
  s_mul_i32 s9, s8, 2048
  s_add_u32 s36, s36, s9
  s_addc_u32 s37, s37, 0x100000
  s_add_u32 s64, s36, 32768
  s_addc_u32 s65, s37, 0
  s_mov_b32 s38, 32768
  s_mov_b32 s39, 0x00800000
  s_mov_b32 s66, 32768
  s_mov_b32 s67, 0x00800000
  s_cmp_lg_u32 s96, 0
  s_cbranch_scc1 L_pfc2_skip
  s_getpc_b64 s[4:5]
L_pfc2:
  s_lshl_b32 s3, s99, 2
  s_add_u32 s3, s3, s70
  s_mul_i32 s3, s3, 128
  s_min_u32 s3, s3, L_w1_c1-L_w1_c0-128
  s_add_i32 s3, s3, L_w1_c0-L_pfc2
  s_ashr_i32 s6, s3, 31
  s_add_u32 s4, s4, s3
  s_addc_u32 s5, s5, s6
  s_load_dword s40, s[4:5], 0
  s_load_dword s40, s[4:5], 64
L_pfc2_skip:
  v_add_u32 v26, 155648, v6
  v_add_u32 v27, 155648, v7
  v_add_u32 v28, 155648, v8
  v_add_u32 v29, 155648, v9
  v_add_u32 v20, 94208, v6
  v_add_u32 v21, 94208, v7
  v_add_u32 v22, 94208, v8
  v_add_u32 v23, 94208, v9
  v_add_u32 v6, 28672, v6
  v_add_u32 v7, 28672, v7
  v_add_u32 v8, 28672, v8
  v_add_u32 v9, 28672, v9
  v_readlane_b32 s48, v15, 0
  v_readlane_b32 s49, v15, 1
  v_readlane_b32 s50, v15, 2
  v_permlane16_swap_b32 v240, v242
  v_permlane16_swap_b32 v241, v243
  v_permlane16_swap_b32 v244, v246
  v_permlane16_swap_b32 v245, v247
  v_permlane16_swap_b32 v248, v250
  v_permlane16_swap_b32 v249, v251
  v_permlane16_swap_b32 v252, v254
  v_permlane16_swap_b32 v253, v255
  s_waitcnt lgkmcnt(0)
  s_barrier
  buffer_load_dwordx4 v[32:35], off, s[36:39], s48 offset:0
  buffer_load_dwordx4 v[36:39], off, s[64:67], s48 offset:0
  buffer_load_dwordx4 v[40:43], off, s[36:39], s48 offset:1024
  buffer_load_dwordx4 v[44:47], off, s[64:67], s48 offset:1024
  buffer_load_dwordx4 v[48:51], off, s[36:39], s49 offset:0
  buffer_load_dwordx4 v[52:55], off, s[64:67], s49 offset:0
  buffer_load_dwordx4 v[56:59], off, s[36:39], s49 offset:1024
  buffer_load_dwordx4 v[60:63], off, s[64:67], s49 offset:1024
  buffer_load_dwordx4 v[64:67], off, s[36:39], s50 offset:0
  buffer_load_dwordx4 v[68:71], off, s[64:67], s50 offset:0
  buffer_load_dwordx4 v[72:75], off, s[36:39], s50 offset:1024
  buffer_load_dwordx4 v[76:79], off, s[64:67], s50 offset:1024
  ds_read_b64_tr_b16 v[160:161], v6 offset:0
  ds_read_b64_tr_b16 v[162:163], v6 offset:512
  ds_read_b64_tr_b16 v[164:165], v7 offset:0
  ds_read_b64_tr_b16 v[166:167], v7 offset:512
  ds_read_b64_tr_b16 v[168:169], v8 offset:0
  ds_read_b64_tr_b16 v[170:171], v8 offset:512
  ds_read_b64_tr_b16 v[172:173], v9 offset:0
  ds_read_b64_tr_b16 v[174:175], v9 offset:512
  ds_read_b64_tr_b16 v[176:177], v6 offset:4096
  ds_read_b64_tr_b16 v[178:179], v6 offset:4608
  ds_read_b64_tr_b16 v[180:181], v7 offset:4096
  ds_read_b64_tr_b16 v[182:183], v7 offset:4608
  ds_read_b64_tr_b16 v[184:185], v8 offset:4096
  ds_read_b64_tr_b16 v[186:187], v8 offset:4608
  ds_read_b64_tr_b16 v[188:189], v9 offset:4096
  ds_read_b64_tr_b16 v[190:191], v9 offset:4608
  v_lshlrev_b32 v96, 16, v240
  v_and_b32 v97, s11, v240
  v_lshlrev_b32 v98, 16, v241
  v_and_b32 v99, s11, v241
  v_lshlrev_b32 v100, 16, v248
  v_and_b32 v101, s11, v248
  v_lshlrev_b32 v102, 16, v249
  v_and_b32 v103, s11, v249
  v_lshlrev_b32 v104, 16, v242
  v_and_b32 v105, s11, v242
  v_lshlrev_b32 v106, 16, v243
  v_and_b32 v107, s11, v243
  v_lshlrev_b32 v108, 16, v250
  v_and_b32 v109, s11, v250
  v_lshlrev_b32 v110, 16, v251
  v_and_b32 v111, s11, v251
  v_lshlrev_b32 v112, 16, v244
  v_and_b32 v113, s11, v244
  v_lshlrev_b32 v114, 16, v245
  v_and_b32 v115, s11, v245
  v_lshlrev_b32 v116, 16, v252
  v_and_b32 v117, s11, v252
  v_lshlrev_b32 v118, 16, v253
  v_and_b32 v119, s11, v253
  v_lshlrev_b32 v120, 16, v246
  v_and_b32 v121, s11, v246
  v_lshlrev_b32 v122, 16, v247
  v_and_b32 v123, s11, v247
  v_lshlrev_b32 v124, 16, v254
  v_and_b32 v125, s11, v254
  v_lshlrev_b32 v126, 16, v255
  v_and_b32 v127, s11, v255
  s_waitcnt vmcnt(10) lgkmcnt(8)
  v_mfma_f32_16x16x32_bf16 v[96:99], v[160:163], v[32:35], v[96:99]
  ds_read_b64_tr_b16 v[192:193], v6 offset:8192
  v_readlane_b32 s51, v15, 3
  v_mfma_f32_16x16x32_bf16 v[100:103], v[160:163], v[36:39], v[100:103]
  ds_read_b64_tr_b16 v[194:195], v6 offset:8704
  v_mfma_f32_16x16x32_bf16 v[108:111], v[164:167], v[36:39], v[108:111]
  ds_read_b64_tr_b16 v[196:197], v7 offset:8192
  v_mfma_f32_16x16x32_bf16 v[104:107], v[164:167], v[32:35], v[104:107]
  buffer_load_dwordx4 v[80:83], off, s[36:39], s51 offset:0
  v_mfma_f32_16x16x32_bf16 v[112:115], v[168:171], v[32:35], v[112:115]
  ds_read_b64_tr_b16 v[198:199], v7 offset:8704
  ds_read_b64_tr_b16 v[200:201], v8 offset:8192
  v_mfma_f32_16x16x32_bf16 v[116:119], v[168:171], v[36:39], v[116:119]
  ds_read_b64_tr_b16 v[202:203], v8 offset:8704
  ds_read_b64_tr_b16 v[204:205], v9 offset:8192
  v_mfma_f32_16x16x32_bf16 v[124:127], v[172:175], v[36:39], v[124:127]
  buffer_load_dwordx4 v[84:87], off, s[64:67], s51 offset:0
  v_mfma_f32_16x16x32_bf16 v[120:123], v[172:175], v[32:35], v[120:123]
  ds_read_b64_tr_b16 v[206:207], v9 offset:8704
  s_waitcnt vmcnt(10) lgkmcnt(8)
  v_mfma_f32_16x16x32_bf16 v[96:99], v[176:179], v[40:43], v[96:99]
  ds_read_b64_tr_b16 v[208:209], v6 offset:12288
  v_mfma_f32_16x16x32_bf16 v[100:103], v[176:179], v[44:47], v[100:103]
  buffer_load_dwordx4 v[88:91], off, s[36:39], s51 offset:1024
  v_mfma_f32_16x16x32_bf16 v[108:111], v[180:183], v[44:47], v[108:111]
  ds_read_b64_tr_b16 v[210:211], v6 offset:12800
  ds_read_b64_tr_b16 v[212:213], v7 offset:12288
  v_mfma_f32_16x16x32_bf16 v[104:107], v[180:183], v[40:43], v[104:107]
  ds_read_b64_tr_b16 v[214:215], v7 offset:12800
  ds_read_b64_tr_b16 v[216:217], v8 offset:12288
  v_mfma_f32_16x16x32_bf16 v[112:115], v[184:187], v[40:43], v[112:115]
  buffer_load_dwordx4 v[92:95], off, s[64:67], s51 offset:1024
  v_mfma_f32_16x16x32_bf16 v[116:119], v[184:187], v[44:47], v[116:119]
  ds_read_b64_tr_b16 v[218:219], v8 offset:12800
  v_readlane_b32 s48, v15, 4
  v_mfma_f32_16x16x32_bf16 v[124:127], v[188:191], v[44:47], v[124:127]
  ds_read_b64_tr_b16 v[220:221], v9 offset:12288
  v_mfma_f32_16x16x32_bf16 v[120:123], v[188:191], v[40:43], v[120:123]
  ds_read_b64_tr_b16 v[222:223], v9 offset:12800
  s_waitcnt vmcnt(10) lgkmcnt(8)
  v_mfma_f32_16x16x32_bf16 v[96:99], v[192:195], v[48:51], v[96:99]
  buffer_load_dwordx4 v[32:35], off, s[36:39], s48 offset:0
  v_mfma_f32_16x16x32_bf16 v[100:103], v[192:195], v[52:55], v[100:103]
  ds_read_b64_tr_b16 v[160:161], v6 offset:16384
  ds_read_b64_tr_b16 v[162:163], v6 offset:16896
  v_mfma_f32_16x16x32_bf16 v[108:111], v[196:199], v[52:55], v[108:111]
  ds_read_b64_tr_b16 v[164:165], v7 offset:16384
  v_mfma_f32_16x16x32_bf16 v[104:107], v[196:199], v[48:51], v[104:107]
  buffer_load_dwordx4 v[36:39], off, s[64:67], s48 offset:0
  v_mfma_f32_16x16x32_bf16 v[112:115], v[200:203], v[48:51], v[112:115]
  ds_read_b64_tr_b16 v[166:167], v7 offset:16896
  ds_read_b64_tr_b16 v[168:169], v8 offset:16384
  v_mfma_f32_16x16x32_bf16 v[116:119], v[200:203], v[52:55], v[116:119]
  ds_read_b64_tr_b16 v[170:171], v8 offset:16896
  ds_read_b64_tr_b16 v[172:173], v9 offset:16384
  v_mfma_f32_16x16x32_bf16 v[124:127], v[204:207], v[52:55], v[124:127]
  buffer_load_dwordx4 v[40:43], off, s[36:39], s48 offset:1024
  v_mfma_f32_16x16x32_bf16 v[120:123], v[204:207], v[48:51], v[120:123]
  ds_read_b64_tr_b16 v[174:175], v9 offset:16896
  s_waitcnt vmcnt(11) lgkmcnt(8)
  v_mfma_f32_16x16x32_bf16 v[96:99], v[208:211], v[56:59], v[96:99]
  ds_read_b64_tr_b16 v[176:177], v6 offset:20480
  v_mfma_f32_16x16x32_bf16 v[100:103], v[208:211], v[60:63], v[100:103]
  buffer_load_dwordx4 v[44:47], off, s[64:67], s48 offset:1024
  v_mfma_f32_16x16x32_bf16 v[108:111], v[212:215], v[60:63], v[108:111]
  ds_read_b64_tr_b16 v[178:179], v6 offset:20992
  ds_read_b64_tr_b16 v[180:181], v7 offset:20480
  v_mfma_f32_16x16x32_bf16 v[104:107], v[212:215], v[56:59], v[104:107]
  ds_read_b64_tr_b16 v[182:183], v7 offset:20992
  v_mfma_f32_16x16x32_bf16 v[112:115], v[216:219], v[56:59], v[112:115]
  ds_read_b64_tr_b16 v[184:185], v8 offset:20480
  v_mfma_f32_16x16x32_bf16 v[116:119], v[216:219], v[60:63], v[116:119]
  ds_read_b64_tr_b16 v[186:187], v8 offset:20992
  v_readlane_b32 s49, v15, 5
  v_mfma_f32_16x16x32_bf16 v[124:127], v[220:223], v[60:63], v[124:127]
  ds_read_b64_tr_b16 v[188:189], v9 offset:20480
  v_mfma_f32_16x16x32_bf16 v[120:123], v[220:223], v[56:59], v[120:123]
  ds_read_b64_tr_b16 v[190:191], v9 offset:20992
  s_waitcnt vmcnt(10) lgkmcnt(8)
  v_mfma_f32_16x16x32_bf16 v[96:99], v[160:163], v[64:67], v[96:99]
  buffer_load_dwordx4 v[48:51], off, s[36:39], s49 offset:0
  v_mfma_f32_16x16x32_bf16 v[100:103], v[160:163], v[68:71], v[100:103]
  ds_read_b64_tr_b16 v[192:193], v6 offset:24576
  ds_read_b64_tr_b16 v[194:195], v6 offset:25088
  v_mfma_f32_16x16x32_bf16 v[108:111], v[164:167], v[68:71], v[108:111]
  ds_read_b64_tr_b16 v[196:197], v7 offset:24576
  v_mfma_f32_16x16x32_bf16 v[104:107], v[164:167], v[64:67], v[104:107]
  buffer_load_dwordx4 v[52:55], off, s[64:67], s49 offset:0
  v_mfma_f32_16x16x32_bf16 v[112:115], v[168:171], v[64:67], v[112:115]
  ds_read_b64_tr_b16 v[198:199], v7 offset:25088
  ds_read_b64_tr_b16 v[200:201], v8 offset:24576
  v_mfma_f32_16x16x32_bf16 v[116:119], v[168:171], v[68:71], v[116:119]
  ds_read_b64_tr_b16 v[202:203], v8 offset:25088
  ds_read_b64_tr_b16 v[204:205], v9 offset:24576
  v_mfma_f32_16x16x32_bf16 v[124:127], v[172:175], v[68:71], v[124:127]
  buffer_load_dwordx4 v[56:59], off, s[36:39], s49 offset:1024
  v_mfma_f32_16x16x32_bf16 v[120:123], v[172:175], v[64:67], v[120:123]
  ds_read_b64_tr_b16 v[206:207], v9 offset:25088
  s_waitcnt vmcnt(11) lgkmcnt(8)
  v_mfma_f32_16x16x32_bf16 v[96:99], v[176:179], v[72:75], v[96:99]
  ds_read_b64_tr_b16 v[208:209], v6 offset:28672
  v_mfma_f32_16x16x32_bf16 v[100:103], v[176:179], v[76:79], v[100:103]
  buffer_load_dwordx4 v[60:63], off, s[64:67], s49 offset:1024
  v_mfma_f32_16x16x32_bf16 v[108:111], v[180:183], v[76:79], v[108:111]
  ds_read_b64_tr_b16 v[210:211], v6 offset:29184
  ds_read_b64_tr_b16 v[212:213], v7 offset:28672
  v_mfma_f32_16x16x32_bf16 v[104:107], v[180:183], v[72:75], v[104:107]
  ds_read_b64_tr_b16 v[214:215], v7 offset:29184
  v_mfma_f32_16x16x32_bf16 v[112:115], v[184:187], v[72:75], v[112:115]
  ds_read_b64_tr_b16 v[216:217], v8 offset:28672
  v_mfma_f32_16x16x32_bf16 v[116:119], v[184:187], v[76:79], v[116:119]
  ds_read_b64_tr_b16 v[218:219], v8 offset:29184
  v_readlane_b32 s50, v15, 6
  v_mfma_f32_16x16x32_bf16 v[124:127], v[188:191], v[76:79], v[124:127]
  ds_read_b64_tr_b16 v[220:221], v9 offset:28672
  v_mfma_f32_16x16x32_bf16 v[120:123], v[188:191], v[72:75], v[120:123]
  ds_read_b64_tr_b16 v[222:223], v9 offset:29184
  s_waitcnt vmcnt(10) lgkmcnt(8)
  v_mfma_f32_16x16x32_bf16 v[96:99], v[192:195], v[80:83], v[96:99]
  buffer_load_dwordx4 v[64:67], off, s[36:39], s50 offset:0
  v_mfma_f32_16x16x32_bf16 v[100:103], v[192:195], v[84:87], v[100:103]
  ds_read_b64_tr_b16 v[160:161], v6 offset:32768
  ds_read_b64_tr_b16 v[162:163], v6 offset:33280
  v_mfma_f32_16x16x32_bf16 v[108:111], v[196:199], v[84:87], v[108:111]
  ds_read_b64_tr_b16 v[164:165], v7 offset:32768
  v_mfma_f32_16x16x32_bf16 v[104:107], v[196:199], v[80:83], v[104:107]
  buffer_load_dwordx4 v[68:71], off, s[64:67], s50 offset:0
  v_mfma_f32_16x16x32_bf16 v[112:115], v[200:203], v[80:83], v[112:115]
  ds_read_b64_tr_b16 v[166:167], v7 offset:33280
  ds_read_b64_tr_b16 v[168:169], v8 offset:32768
  v_mfma_f32_16x16x32_bf16 v[116:119], v[200:203], v[84:87], v[116:119]
  ds_read_b64_tr_b16 v[170:171], v8 offset:33280
  ds_read_b64_tr_b16 v[172:173], v9 offset:32768
  v_mfma_f32_16x16x32_bf16 v[124:127], v[204:207], v[84:87], v[124:127]
  buffer_load_dwordx4 v[72:75], off, s[36:39], s50 offset:1024
  v_mfma_f32_16x16x32_bf16 v[120:123], v[204:207], v[80:83], v[120:123]
  ds_read_b64_tr_b16 v[174:175], v9 offset:33280
  s_waitcnt vmcnt(11) lgkmcnt(8)
  s_barrier
  v_mfma_f32_16x16x32_bf16 v[96:99], v[208:211], v[88:91], v[96:99]
  ds_read_b64_tr_b16 v[176:177], v6 offset:36864
  v_mfma_f32_16x16x32_bf16 v[100:103], v[208:211], v[92:95], v[100:103]
  buffer_load_dwordx4 v[76:79], off, s[64:67], s50 offset:1024
  v_mfma_f32_16x16x32_bf16 v[108:111], v[212:215], v[92:95], v[108:111]
  ds_read_b64_tr_b16 v[178:179], v6 offset:37376
  ds_read_b64_tr_b16 v[180:181], v7 offset:36864
  v_mfma_f32_16x16x32_bf16 v[104:107], v[212:215], v[88:91], v[104:107]
  ds_read_b64_tr_b16 v[182:183], v7 offset:37376
  v_mfma_f32_16x16x32_bf16 v[112:115], v[216:219], v[88:91], v[112:115]
  ds_read_b64_tr_b16 v[184:185], v8 offset:36864
  v_mfma_f32_16x16x32_bf16 v[116:119], v[216:219], v[92:95], v[116:119]
  ds_read_b64_tr_b16 v[186:187], v8 offset:37376
  v_readlane_b32 s51, v15, 7
  v_mfma_f32_16x16x32_bf16 v[124:127], v[220:223], v[92:95], v[124:127]
  ds_read_b64_tr_b16 v[188:189], v9 offset:36864
  v_mfma_f32_16x16x32_bf16 v[120:123], v[220:223], v[88:91], v[120:123]
  ds_read_b64_tr_b16 v[190:191], v9 offset:37376
  s_waitcnt vmcnt(10) lgkmcnt(8)
  v_mfma_f32_16x16x32_bf16 v[96:99], v[160:163], v[32:35], v[96:99]
  buffer_load_dwordx4 v[80:83], off, s[36:39], s51 offset:0
  v_mfma_f32_16x16x32_bf16 v[100:103], v[160:163], v[36:39], v[100:103]
  ds_read_b64_tr_b16 v[192:193], v6 offset:40960
  ds_read_b64_tr_b16 v[194:195], v6 offset:41472
  v_mfma_f32_16x16x32_bf16 v[108:111], v[164:167], v[36:39], v[108:111]
  ds_read_b64_tr_b16 v[196:197], v7 offset:40960
  v_mfma_f32_16x16x32_bf16 v[104:107], v[164:167], v[32:35], v[104:107]
  buffer_load_dwordx4 v[84:87], off, s[64:67], s51 offset:0
  v_mfma_f32_16x16x32_bf16 v[112:115], v[168:171], v[32:35], v[112:115]
  ds_read_b64_tr_b16 v[198:199], v7 offset:41472
  ds_read_b64_tr_b16 v[200:201], v8 offset:40960
  v_mfma_f32_16x16x32_bf16 v[116:119], v[168:171], v[36:39], v[116:119]
  ds_read_b64_tr_b16 v[202:203], v8 offset:41472
  ds_read_b64_tr_b16 v[204:205], v9 offset:40960
  v_mfma_f32_16x16x32_bf16 v[124:127], v[172:175], v[36:39], v[124:127]
  buffer_load_dwordx4 v[88:91], off, s[36:39], s51 offset:1024
  v_mfma_f32_16x16x32_bf16 v[120:123], v[172:175], v[32:35], v[120:123]
  ds_read_b64_tr_b16 v[206:207], v9 offset:41472
  s_waitcnt vmcnt(11) lgkmcnt(8)
  v_mfma_f32_16x16x32_bf16 v[96:99], v[176:179], v[40:43], v[96:99]
  ds_read_b64_tr_b16 v[208:209], v6 offset:45056
  v_mfma_f32_16x16x32_bf16 v[100:103], v[176:179], v[44:47], v[100:103]
  buffer_load_dwordx4 v[92:95], off, s[64:67], s51 offset:1024
  v_mfma_f32_16x16x32_bf16 v[108:111], v[180:183], v[44:47], v[108:111]
  ds_read_b64_tr_b16 v[210:211], v6 offset:45568
  ds_read_b64_tr_b16 v[212:213], v7 offset:45056
  v_mfma_f32_16x16x32_bf16 v[104:107], v[180:183], v[40:43], v[104:107]
  ds_read_b64_tr_b16 v[214:215], v7 offset:45568
  v_mfma_f32_16x16x32_bf16 v[112:115], v[184:187], v[40:43], v[112:115]
  ds_read_b64_tr_b16 v[216:217], v8 offset:45056
  v_mfma_f32_16x16x32_bf16 v[116:119], v[184:187], v[44:47], v[116:119]
  ds_read_b64_tr_b16 v[218:219], v8 offset:45568
  v_readlane_b32 s48, v15, 8
  v_mfma_f32_16x16x32_bf16 v[124:127], v[188:191], v[44:47], v[124:127]
  ds_read_b64_tr_b16 v[220:221], v9 offset:45056
  v_mfma_f32_16x16x32_bf16 v[120:123], v[188:191], v[40:43], v[120:123]
  ds_read_b64_tr_b16 v[222:223], v9 offset:45568
  s_waitcnt vmcnt(10) lgkmcnt(8)
  v_mfma_f32_16x16x32_bf16 v[96:99], v[192:195], v[48:51], v[96:99]
  buffer_load_dwordx4 v[32:35], off, s[36:39], s48 offset:0
  v_mfma_f32_16x16x32_bf16 v[100:103], v[192:195], v[52:55], v[100:103]
  ds_read_b64_tr_b16 v[160:161], v6 offset:49152
  ds_read_b64_tr_b16 v[162:163], v6 offset:49664
  v_mfma_f32_16x16x32_bf16 v[108:111], v[196:199], v[52:55], v[108:111]
  ds_read_b64_tr_b16 v[164:165], v7 offset:49152
  v_mfma_f32_16x16x32_bf16 v[104:107], v[196:199], v[48:51], v[104:107]
  buffer_load_dwordx4 v[36:39], off, s[64:67], s48 offset:0
  v_mfma_f32_16x16x32_bf16 v[112:115], v[200:203], v[48:51], v[112:115]
  ds_read_b64_tr_b16 v[166:167], v7 offset:49664
  ds_read_b64_tr_b16 v[168:169], v8 offset:49152
  v_mfma_f32_16x16x32_bf16 v[116:119], v[200:203], v[52:55], v[116:119]
  ds_read_b64_tr_b16 v[170:171], v8 offset:49664
  ds_read_b64_tr_b16 v[172:173], v9 offset:49152
  v_mfma_f32_16x16x32_bf16 v[124:127], v[204:207], v[52:55], v[124:127]
  buffer_load_dwordx4 v[40:43], off, s[36:39], s48 offset:1024
  v_mfma_f32_16x16x32_bf16 v[120:123], v[204:207], v[48:51], v[120:123]
  ds_read_b64_tr_b16 v[174:175], v9 offset:49664
  s_waitcnt vmcnt(11) lgkmcnt(8)
  v_mfma_f32_16x16x32_bf16 v[96:99], v[208:211], v[56:59], v[96:99]
  ds_read_b64_tr_b16 v[176:177], v6 offset:53248
  v_mfma_f32_16x16x32_bf16 v[100:103], v[208:211], v[60:63], v[100:103]
  buffer_load_dwordx4 v[44:47], off, s[64:67], s48 offset:1024
  v_mfma_f32_16x16x32_bf16 v[108:111], v[212:215], v[60:63], v[108:111]
  ds_read_b64_tr_b16 v[178:179], v6 offset:53760
  ds_read_b64_tr_b16 v[180:181], v7 offset:53248
  v_mfma_f32_16x16x32_bf16 v[104:107], v[212:215], v[56:59], v[104:107]
  ds_read_b64_tr_b16 v[182:183], v7 offset:53760
  v_mfma_f32_16x16x32_bf16 v[112:115], v[216:219], v[56:59], v[112:115]
  ds_read_b64_tr_b16 v[184:185], v8 offset:53248
  v_mfma_f32_16x16x32_bf16 v[116:119], v[216:219], v[60:63], v[116:119]
  ds_read_b64_tr_b16 v[186:187], v8 offset:53760
  v_readlane_b32 s49, v15, 9
  v_mfma_f32_16x16x32_bf16 v[124:127], v[220:223], v[60:63], v[124:127]
  ds_read_b64_tr_b16 v[188:189], v9 offset:53248
  v_mfma_f32_16x16x32_bf16 v[120:123], v[220:223], v[56:59], v[120:123]
  ds_read_b64_tr_b16 v[190:191], v9 offset:53760
  s_waitcnt vmcnt(10) lgkmcnt(8)
  v_mfma_f32_16x16x32_bf16 v[96:99], v[160:163], v[64:67], v[96:99]
  buffer_load_dwordx4 v[48:51], off, s[36:39], s49 offset:0
  v_mfma_f32_16x16x32_bf16 v[100:103], v[160:163], v[68:71], v[100:103]
  ds_read_b64_tr_b16 v[192:193], v6 offset:57344
  ds_read_b64_tr_b16 v[194:195], v6 offset:57856
  v_mfma_f32_16x16x32_bf16 v[108:111], v[164:167], v[68:71], v[108:111]
  ds_read_b64_tr_b16 v[196:197], v7 offset:57344
  v_mfma_f32_16x16x32_bf16 v[104:107], v[164:167], v[64:67], v[104:107]
  buffer_load_dwordx4 v[52:55], off, s[64:67], s49 offset:0
  v_mfma_f32_16x16x32_bf16 v[112:115], v[168:171], v[64:67], v[112:115]
  ds_read_b64_tr_b16 v[198:199], v7 offset:57856
  ds_read_b64_tr_b16 v[200:201], v8 offset:57344
  v_mfma_f32_16x16x32_bf16 v[116:119], v[168:171], v[68:71], v[116:119]
  ds_read_b64_tr_b16 v[202:203], v8 offset:57856
  ds_read_b64_tr_b16 v[204:205], v9 offset:57344
  v_mfma_f32_16x16x32_bf16 v[124:127], v[172:175], v[68:71], v[124:127]
  buffer_load_dwordx4 v[56:59], off, s[36:39], s49 offset:1024
  v_mfma_f32_16x16x32_bf16 v[120:123], v[172:175], v[64:67], v[120:123]
  ds_read_b64_tr_b16 v[206:207], v9 offset:57856
  s_waitcnt vmcnt(11) lgkmcnt(8)
  v_mfma_f32_16x16x32_bf16 v[96:99], v[176:179], v[72:75], v[96:99]
  ds_read_b64_tr_b16 v[208:209], v6 offset:61440
  v_mfma_f32_16x16x32_bf16 v[100:103], v[176:179], v[76:79], v[100:103]
  buffer_load_dwordx4 v[60:63], off, s[64:67], s49 offset:1024
  v_mfma_f32_16x16x32_bf16 v[108:111], v[180:183], v[76:79], v[108:111]
  ds_read_b64_tr_b16 v[210:211], v6 offset:61952
  ds_read_b64_tr_b16 v[212:213], v7 offset:61440
  v_mfma_f32_16x16x32_bf16 v[104:107], v[180:183], v[72:75], v[104:107]
  ds_read_b64_tr_b16 v[214:215], v7 offset:61952
  v_mfma_f32_16x16x32_bf16 v[112:115], v[184:187], v[72:75], v[112:115]
  ds_read_b64_tr_b16 v[216:217], v8 offset:61440
  v_mfma_f32_16x16x32_bf16 v[116:119], v[184:187], v[76:79], v[116:119]
  ds_read_b64_tr_b16 v[218:219], v8 offset:61952
  v_readlane_b32 s50, v15, 10
  v_mfma_f32_16x16x32_bf16 v[124:127], v[188:191], v[76:79], v[124:127]
  ds_read_b64_tr_b16 v[220:221], v9 offset:61440
  v_mfma_f32_16x16x32_bf16 v[120:123], v[188:191], v[72:75], v[120:123]
  ds_read_b64_tr_b16 v[222:223], v9 offset:61952
  s_waitcnt vmcnt(10) lgkmcnt(8)
  v_mfma_f32_16x16x32_bf16 v[96:99], v[192:195], v[80:83], v[96:99]
  buffer_load_dwordx4 v[64:67], off, s[36:39], s50 offset:0
  v_mfma_f32_16x16x32_bf16 v[100:103], v[192:195], v[84:87], v[100:103]
  ds_read_b64_tr_b16 v[160:161], v20 offset:0
  ds_read_b64_tr_b16 v[162:163], v20 offset:512
  v_mfma_f32_16x16x32_bf16 v[108:111], v[196:199], v[84:87], v[108:111]
  ds_read_b64_tr_b16 v[164:165], v21 offset:0
  v_mfma_f32_16x16x32_bf16 v[104:107], v[196:199], v[80:83], v[104:107]
  buffer_load_dwordx4 v[68:71], off, s[64:67], s50 offset:0
  v_mfma_f32_16x16x32_bf16 v[112:115], v[200:203], v[80:83], v[112:115]
  ds_read_b64_tr_b16 v[166:167], v21 offset:512
  ds_read_b64_tr_b16 v[168:169], v22 offset:0
  v_mfma_f32_16x16x32_bf16 v[116:119], v[200:203], v[84:87], v[116:119]
  ds_read_b64_tr_b16 v[170:171], v22 offset:512
  ds_read_b64_tr_b16 v[172:173], v23 offset:0
  v_mfma_f32_16x16x32_bf16 v[124:127], v[204:207], v[84:87], v[124:127]
  buffer_load_dwordx4 v[72:75], off, s[36:39], s50 offset:1024
  v_mfma_f32_16x16x32_bf16 v[120:123], v[204:207], v[80:83], v[120:123]
  ds_read_b64_tr_b16 v[174:175], v23 offset:512
  s_waitcnt vmcnt(11) lgkmcnt(8)
  v_mfma_f32_16x16x32_bf16 v[96:99], v[208:211], v[88:91], v[96:99]
  ds_read_b64_tr_b16 v[176:177], v20 offset:4096
  v_mfma_f32_16x16x32_bf16 v[100:103], v[208:211], v[92:95], v[100:103]
  buffer_load_dwordx4 v[76:79], off, s[64:67], s50 offset:1024
  v_mfma_f32_16x16x32_bf16 v[108:111], v[212:215], v[92:95], v[108:111]
  ds_read_b64_tr_b16 v[178:179], v20 offset:4608
  ds_read_b64_tr_b16 v[180:181], v21 offset:4096
  v_mfma_f32_16x16x32_bf16 v[104:107], v[212:215], v[88:91], v[104:107]
  ds_read_b64_tr_b16 v[182:183], v21 offset:4608
  v_mfma_f32_16x16x32_bf16 v[112:115], v[216:219], v[88:91], v[112:115]
  ds_read_b64_tr_b16 v[184:185], v22 offset:4096
  v_mfma_f32_16x16x32_bf16 v[116:119], v[216:219], v[92:95], v[116:119]
  ds_read_b64_tr_b16 v[186:187], v22 offset:4608
  v_readlane_b32 s51, v15, 11
  v_mfma_f32_16x16x32_bf16 v[124:127], v[220:223], v[92:95], v[124:127]
  ds_read_b64_tr_b16 v[188:189], v23 offset:4096
  v_mfma_f32_16x16x32_bf16 v[120:123], v[220:223], v[88:91], v[120:123]
  ds_read_b64_tr_b16 v[190:191], v23 offset:4608
  s_waitcnt vmcnt(10) lgkmcnt(8)
  v_mfma_f32_16x16x32_bf16 v[96:99], v[160:163], v[32:35], v[96:99]
  buffer_load_dwordx4 v[80:83], off, s[36:39], s51 offset:0
  v_mfma_f32_16x16x32_bf16 v[100:103], v[160:163], v[36:39], v[100:103]
  ds_read_b64_tr_b16 v[192:193], v20 offset:8192
  ds_read_b64_tr_b16 v[194:195], v20 offset:8704
  v_mfma_f32_16x16x32_bf16 v[108:111], v[164:167], v[36:39], v[108:111]
  ds_read_b64_tr_b16 v[196:197], v21 offset:8192
  v_mfma_f32_16x16x32_bf16 v[104:107], v[164:167], v[32:35], v[104:107]
  buffer_load_dwordx4 v[84:87], off, s[64:67], s51 offset:0
  v_mfma_f32_16x16x32_bf16 v[112:115], v[168:171], v[32:35], v[112:115]
  ds_read_b64_tr_b16 v[198:199], v21 offset:8704
  ds_read_b64_tr_b16 v[200:201], v22 offset:8192
  v_mfma_f32_16x16x32_bf16 v[116:119], v[168:171], v[36:39], v[116:119]
  ds_read_b64_tr_b16 v[202:203], v22 offset:8704
  ds_read_b64_tr_b16 v[204:205], v23 offset:8192
  v_mfma_f32_16x16x32_bf16 v[124:127], v[172:175], v[36:39], v[124:127]
  buffer_load_dwordx4 v[88:91], off, s[36:39], s51 offset:1024
  v_mfma_f32_16x16x32_bf16 v[120:123], v[172:175], v[32:35], v[120:123]
  ds_read_b64_tr_b16 v[206:207], v23 offset:8704
  s_waitcnt vmcnt(11) lgkmcnt(8)
  v_mfma_f32_16x16x32_bf16 v[96:99], v[176:179], v[40:43], v[96:99]
  ds_read_b64_tr_b16 v[208:209], v20 offset:12288
  v_mfma_f32_16x16x32_bf16 v[100:103], v[176:179], v[44:47], v[100:103]
  buffer_load_dwordx4 v[92:95], off, s[64:67], s51 offset:1024
  v_mfma_f32_16x16x32_bf16 v[108:111], v[180:183], v[44:47], v[108:111]
  ds_read_b64_tr_b16 v[210:211], v20 offset:12800
  ds_read_b64_tr_b16 v[212:213], v21 offset:12288
  v_mfma_f32_16x16x32_bf16 v[104:107], v[180:183], v[40:43], v[104:107]
  ds_read_b64_tr_b16 v[214:215], v21 offset:12800
  v_mfma_f32_16x16x32_bf16 v[112:115], v[184:187], v[40:43], v[112:115]
  ds_read_b64_tr_b16 v[216:217], v22 offset:12288
  v_mfma_f32_16x16x32_bf16 v[116:119], v[184:187], v[44:47], v[116:119]
  ds_read_b64_tr_b16 v[218:219], v22 offset:12800
  v_readlane_b32 s48, v15, 12
  v_mfma_f32_16x16x32_bf16 v[124:127], v[188:191], v[44:47], v[124:127]
  ds_read_b64_tr_b16 v[220:221], v23 offset:12288
  v_mfma_f32_16x16x32_bf16 v[120:123], v[188:191], v[40:43], v[120:123]
  ds_read_b64_tr_b16 v[222:223], v23 offset:12800
  s_waitcnt vmcnt(10) lgkmcnt(8)
  v_mfma_f32_16x16x32_bf16 v[96:99], v[192:195], v[48:51], v[96:99]
  buffer_load_dwordx4 v[32:35], off, s[36:39], s48 offset:0
  v_mfma_f32_16x16x32_bf16 v[100:103], v[192:195], v[52:55], v[100:103]
  ds_read_b64_tr_b16 v[160:161], v20 offset:16384
  ds_read_b64_tr_b16 v[162:163], v20 offset:16896
  v_mfma_f32_16x16x32_bf16 v[108:111], v[196:199], v[52:55], v[108:111]
  ds_read_b64_tr_b16 v[164:165], v21 offset:16384
  v_mfma_f32_16x16x32_bf16 v[104:107], v[196:199], v[48:51], v[104:107]
  buffer_load_dwordx4 v[36:39], off, s[64:67], s48 offset:0
  v_mfma_f32_16x16x32_bf16 v[112:115], v[200:203], v[48:51], v[112:115]
  ds_read_b64_tr_b16 v[166:167], v21 offset:16896
  ds_read_b64_tr_b16 v[168:169], v22 offset:16384
  v_mfma_f32_16x16x32_bf16 v[116:119], v[200:203], v[52:55], v[116:119]
  ds_read_b64_tr_b16 v[170:171], v22 offset:16896
  ds_read_b64_tr_b16 v[172:173], v23 offset:16384
  v_mfma_f32_16x16x32_bf16 v[124:127], v[204:207], v[52:55], v[124:127]
  buffer_load_dwordx4 v[40:43], off, s[36:39], s48 offset:1024
  v_mfma_f32_16x16x32_bf16 v[120:123], v[204:207], v[48:51], v[120:123]
  ds_read_b64_tr_b16 v[174:175], v23 offset:16896
  s_waitcnt vmcnt(11) lgkmcnt(8)
  v_mfma_f32_16x16x32_bf16 v[96:99], v[208:211], v[56:59], v[96:99]
  ds_read_b64_tr_b16 v[176:177], v20 offset:20480
  v_mfma_f32_16x16x32_bf16 v[100:103], v[208:211], v[60:63], v[100:103]
  buffer_load_dwordx4 v[44:47], off, s[64:67], s48 offset:1024
  v_mfma_f32_16x16x32_bf16 v[108:111], v[212:215], v[60:63], v[108:111]
  ds_read_b64_tr_b16 v[178:179], v20 offset:20992
  ds_read_b64_tr_b16 v[180:181], v21 offset:20480
  v_mfma_f32_16x16x32_bf16 v[104:107], v[212:215], v[56:59], v[104:107]
  ds_read_b64_tr_b16 v[182:183], v21 offset:20992
  v_mfma_f32_16x16x32_bf16 v[112:115], v[216:219], v[56:59], v[112:115]
  ds_read_b64_tr_b16 v[184:185], v22 offset:20480
  v_mfma_f32_16x16x32_bf16 v[116:119], v[216:219], v[60:63], v[116:119]
  ds_read_b64_tr_b16 v[186:187], v22 offset:20992
  v_readlane_b32 s49, v15, 13
  v_mfma_f32_16x16x32_bf16 v[124:127], v[220:223], v[60:63], v[124:127]
  ds_read_b64_tr_b16 v[188:189], v23 offset:20480
  v_mfma_f32_16x16x32_bf16 v[120:123], v[220:223], v[56:59], v[120:123]
  ds_read_b64_tr_b16 v[190:191], v23 offset:20992
  s_waitcnt vmcnt(10) lgkmcnt(8)
  v_mfma_f32_16x16x32_bf16 v[96:99], v[160:163], v[64:67], v[96:99]
  buffer_load_dwordx4 v[48:51], off, s[36:39], s49 offset:0
  v_mfma_f32_16x16x32_bf16 v[100:103], v[160:163], v[68:71], v[100:103]
  ds_read_b64_tr_b16 v[192:193], v20 offset:24576
  ds_read_b64_tr_b16 v[194:195], v20 offset:25088
  v_mfma_f32_16x16x32_bf16 v[108:111], v[164:167], v[68:71], v[108:111]
  ds_read_b64_tr_b16 v[196:197], v21 offset:24576
  v_mfma_f32_16x16x32_bf16 v[104:107], v[164:167], v[64:67], v[104:107]
  buffer_load_dwordx4 v[52:55], off, s[64:67], s49 offset:0
  v_mfma_f32_16x16x32_bf16 v[112:115], v[168:171], v[64:67], v[112:115]
  ds_read_b64_tr_b16 v[198:199], v21 offset:25088
  ds_read_b64_tr_b16 v[200:201], v22 offset:24576
  v_mfma_f32_16x16x32_bf16 v[116:119], v[168:171], v[68:71], v[116:119]
  ds_read_b64_tr_b16 v[202:203], v22 offset:25088
  ds_read_b64_tr_b16 v[204:205], v23 offset:24576
  v_mfma_f32_16x16x32_bf16 v[124:127], v[172:175], v[68:71], v[124:127]
  buffer_load_dwordx4 v[56:59], off, s[36:39], s49 offset:1024
  v_mfma_f32_16x16x32_bf16 v[120:123], v[172:175], v[64:67], v[120:123]
  ds_read_b64_tr_b16 v[206:207], v23 offset:25088
  s_waitcnt vmcnt(11) lgkmcnt(8)
  s_barrier
  v_mfma_f32_16x16x32_bf16 v[96:99], v[176:179], v[72:75], v[96:99]
  ds_read_b64_tr_b16 v[208:209], v20 offset:28672
  v_mfma_f32_16x16x32_bf16 v[100:103], v[176:179], v[76:79], v[100:103]
  buffer_load_dwordx4 v[60:63], off, s[64:67], s49 offset:1024
  v_mfma_f32_16x16x32_bf16 v[108:111], v[180:183], v[76:79], v[108:111]
  ds_read_b64_tr_b16 v[210:211], v20 offset:29184
  ds_read_b64_tr_b16 v[212:213], v21 offset:28672
  v_mfma_f32_16x16x32_bf16 v[104:107], v[180:183], v[72:75], v[104:107]
  ds_read_b64_tr_b16 v[214:215], v21 offset:29184
  v_mfma_f32_16x16x32_bf16 v[112:115], v[184:187], v[72:75], v[112:115]
  ds_read_b64_tr_b16 v[216:217], v22 offset:28672
  v_mfma_f32_16x16x32_bf16 v[116:119], v[184:187], v[76:79], v[116:119]
  ds_read_b64_tr_b16 v[218:219], v22 offset:29184
  v_readlane_b32 s50, v15, 14
  v_mfma_f32_16x16x32_bf16 v[124:127], v[188:191], v[76:79], v[124:127]
  ds_read_b64_tr_b16 v[220:221], v23 offset:28672
  v_mfma_f32_16x16x32_bf16 v[120:123], v[188:191], v[72:75], v[120:123]
  ds_read_b64_tr_b16 v[222:223], v23 offset:29184
  s_waitcnt vmcnt(10) lgkmcnt(8)
  v_mfma_f32_16x16x32_bf16 v[96:99], v[192:195], v[80:83], v[96:99]
  buffer_load_dwordx4 v[64:67], off, s[36:39], s50 offset:0
  v_mfma_f32_16x16x32_bf16 v[100:103], v[192:195], v[84:87], v[100:103]
  ds_read_b64_tr_b16 v[160:161], v20 offset:36864
  ds_read_b64_tr_b16 v[162:163], v20 offset:37376
  v_mfma_f32_16x16x32_bf16 v[108:111], v[196:199], v[84:87], v[108:111]
  ds_read_b64_tr_b16 v[164:165], v21 offset:36864
  v_mfma_f32_16x16x32_bf16 v[104:107], v[196:199], v[80:83], v[104:107]
  buffer_load_dwordx4 v[68:71], off, s[64:67], s50 offset:0
  v_mfma_f32_16x16x32_bf16 v[112:115], v[200:203], v[80:83], v[112:115]
  ds_read_b64_tr_b16 v[166:167], v21 offset:37376
  ds_read_b64_tr_b16 v[168:169], v22 offset:36864
  v_mfma_f32_16x16x32_bf16 v[116:119], v[200:203], v[84:87], v[116:119]
  ds_read_b64_tr_b16 v[170:171], v22 offset:37376
  ds_read_b64_tr_b16 v[172:173], v23 offset:36864
  v_mfma_f32_16x16x32_bf16 v[124:127], v[204:207], v[84:87], v[124:127]
  buffer_load_dwordx4 v[72:75], off, s[36:39], s50 offset:1024
  v_mfma_f32_16x16x32_bf16 v[120:123], v[204:207], v[80:83], v[120:123]
  ds_read_b64_tr_b16 v[174:175], v23 offset:37376
  s_waitcnt vmcnt(11) lgkmcnt(8)
  v_mfma_f32_16x16x32_bf16 v[96:99], v[208:211], v[88:91], v[96:99]
  ds_read_b64_tr_b16 v[176:177], v20 offset:40960
  v_mfma_f32_16x16x32_bf16 v[100:103], v[208:211], v[92:95], v[100:103]
  buffer_load_dwordx4 v[76:79], off, s[64:67], s50 offset:1024
  v_mfma_f32_16x16x32_bf16 v[108:111], v[212:215], v[92:95], v[108:111]
  ds_read_b64_tr_b16 v[178:179], v20 offset:41472
  ds_read_b64_tr_b16 v[180:181], v21 offset:40960
  v_mfma_f32_16x16x32_bf16 v[104:107], v[212:215], v[88:91], v[104:107]
  ds_read_b64_tr_b16 v[182:183], v21 offset:41472
  v_mfma_f32_16x16x32_bf16 v[112:115], v[216:219], v[88:91], v[112:115]
  ds_read_b64_tr_b16 v[184:185], v22 offset:40960
  v_mfma_f32_16x16x32_bf16 v[116:119], v[216:219], v[92:95], v[116:119]
  ds_read_b64_tr_b16 v[186:187], v22 offset:41472
  v_readlane_b32 s51, v15, 15
  v_mfma_f32_16x16x32_bf16 v[124:127], v[220:223], v[92:95], v[124:127]
  ds_read_b64_tr_b16 v[188:189], v23 offset:40960
  v_mfma_f32_16x16x32_bf16 v[120:123], v[220:223], v[88:91], v[120:123]
  ds_read_b64_tr_b16 v[190:191], v23 offset:41472
  s_waitcnt vmcnt(10) lgkmcnt(8)
  v_mfma_f32_16x16x32_bf16 v[96:99], v[160:163], v[32:35], v[96:99]
  buffer_load_dwordx4 v[80:83], off, s[36:39], s51 offset:0
  v_mfma_f32_16x16x32_bf16 v[100:103], v[160:163], v[36:39], v[100:103]
  ds_read_b64_tr_b16 v[192:193], v20 offset:45056
  ds_read_b64_tr_b16 v[194:195], v20 offset:45568
  v_mfma_f32_16x16x32_bf16 v[108:111], v[164:167], v[36:39], v[108:111]
  ds_read_b64_tr_b16 v[196:197], v21 offset:45056
  v_mfma_f32_16x16x32_bf16 v[104:107], v[164:167], v[32:35], v[104:107]
  buffer_load_dwordx4 v[84:87], off, s[64:67], s51 offset:0
  v_mfma_f32_16x16x32_bf16 v[112:115], v[168:171], v[32:35], v[112:115]
  ds_read_b64_tr_b16 v[198:199], v21 offset:45568
  ds_read_b64_tr_b16 v[200:201], v22 offset:45056
  v_mfma_f32_16x16x32_bf16 v[116:119], v[168:171], v[36:39], v[116:119]
  ds_read_b64_tr_b16 v[202:203], v22 offset:45568
  ds_read_b64_tr_b16 v[204:205], v23 offset:45056
  v_mfma_f32_16x16x32_bf16 v[124:127], v[172:175], v[36:39], v[124:127]
  buffer_load_dwordx4 v[88:91], off, s[36:39], s51 offset:1024
  v_mfma_f32_16x16x32_bf16 v[120:123], v[172:175], v[32:35], v[120:123]
  ds_read_b64_tr_b16 v[206:207], v23 offset:45568
  s_waitcnt vmcnt(11) lgkmcnt(8)
  v_mfma_f32_16x16x32_bf16 v[96:99], v[176:179], v[40:43], v[96:99]
  ds_read_b64_tr_b16 v[208:209], v20 offset:49152
  v_mfma_f32_16x16x32_bf16 v[100:103], v[176:179], v[44:47], v[100:103]
  buffer_load_dwordx4 v[92:95], off, s[64:67], s51 offset:1024
  v_mfma_f32_16x16x32_bf16 v[108:111], v[180:183], v[44:47], v[108:111]
  ds_read_b64_tr_b16 v[210:211], v20 offset:49664
  ds_read_b64_tr_b16 v[212:213], v21 offset:49152
  v_mfma_f32_16x16x32_bf16 v[104:107], v[180:183], v[40:43], v[104:107]
  ds_read_b64_tr_b16 v[214:215], v21 offset:49664
  v_mfma_f32_16x16x32_bf16 v[112:115], v[184:187], v[40:43], v[112:115]
  ds_read_b64_tr_b16 v[216:217], v22 offset:49152
  v_mfma_f32_16x16x32_bf16 v[116:119], v[184:187], v[44:47], v[116:119]
  ds_read_b64_tr_b16 v[218:219], v22 offset:49664
  v_mfma_f32_16x16x32_bf16 v[124:127], v[188:191], v[44:47], v[124:127]
  ds_read_b64_tr_b16 v[220:221], v23 offset:49152
  v_mfma_f32_16x16x32_bf16 v[120:123], v[188:191], v[40:43], v[120:123]
  ds_read_b64_tr_b16 v[222:223], v23 offset:49664
  s_waitcnt vmcnt(10) lgkmcnt(8)
  v_mfma_f32_16x16x32_bf16 v[96:99], v[192:195], v[48:51], v[96:99]
  ds_read_b64_tr_b16 v[160:161], v20 offset:53248
  v_mfma_f32_16x16x32_bf16 v[100:103], v[192:195], v[52:55], v[100:103]
  ds_read_b64_tr_b16 v[162:163], v20 offset:53760
  v_mfma_f32_16x16x32_bf16 v[108:111], v[196:199], v[52:55], v[108:111]
  ds_read_b64_tr_b16 v[164:165], v21 offset:53248
  v_mfma_f32_16x16x32_bf16 v[104:107], v[196:199], v[48:51], v[104:107]
  ds_read_b64_tr_b16 v[166:167], v21 offset:53760
  v_mfma_f32_16x16x32_bf16 v[112:115], v[200:203], v[48:51], v[112:115]
  ds_read_b64_tr_b16 v[168:169], v22 offset:53248
  v_mfma_f32_16x16x32_bf16 v[116:119], v[200:203], v[52:55], v[116:119]
  ds_read_b64_tr_b16 v[170:171], v22 offset:53760
  v_mfma_f32_16x16x32_bf16 v[124:127], v[204:207], v[52:55], v[124:127]
  ds_read_b64_tr_b16 v[172:173], v23 offset:53248
  v_mfma_f32_16x16x32_bf16 v[120:123], v[204:207], v[48:51], v[120:123]
  ds_read_b64_tr_b16 v[174:175], v23 offset:53760
  s_waitcnt vmcnt(8) lgkmcnt(8)
  v_mfma_f32_16x16x32_bf16 v[96:99], v[208:211], v[56:59], v[96:99]
  ds_read_b64_tr_b16 v[176:177], v20 offset:57344
  v_mfma_f32_16x16x32_bf16 v[100:103], v[208:211], v[60:63], v[100:103]
  ds_read_b64_tr_b16 v[178:179], v20 offset:57856
  v_mfma_f32_16x16x32_bf16 v[108:111], v[212:215], v[60:63], v[108:111]
  ds_read_b64_tr_b16 v[180:181], v21 offset:57344
  v_mfma_f32_16x16x32_bf16 v[104:107], v[212:215], v[56:59], v[104:107]
  ds_read_b64_tr_b16 v[182:183], v21 offset:57856
  v_mfma_f32_16x16x32_bf16 v[112:115], v[216:219], v[56:59], v[112:115]
  ds_read_b64_tr_b16 v[184:185], v22 offset:57344
  v_mfma_f32_16x16x32_bf16 v[116:119], v[216:219], v[60:63], v[116:119]
  ds_read_b64_tr_b16 v[186:187], v22 offset:57856
  v_mfma_f32_16x16x32_bf16 v[124:127], v[220:223], v[60:63], v[124:127]
  ds_read_b64_tr_b16 v[188:189], v23 offset:57344
  v_mfma_f32_16x16x32_bf16 v[120:123], v[220:223], v[56:59], v[120:123]
  ds_read_b64_tr_b16 v[190:191], v23 offset:57856
  s_waitcnt vmcnt(6) lgkmcnt(8)
  v_mfma_f32_16x16x32_bf16 v[96:99], v[160:163], v[64:67], v[96:99]
  ds_read_b64_tr_b16 v[192:193], v26 offset:0
  v_mfma_f32_16x16x32_bf16 v[100:103], v[160:163], v[68:71], v[100:103]
  ds_read_b64_tr_b16 v[194:195], v26 offset:512
  v_mfma_f32_16x16x32_bf16 v[108:111], v[164:167], v[68:71], v[108:111]
  ds_read_b64_tr_b16 v[196:197], v27 offset:0
  v_mfma_f32_16x16x32_bf16 v[104:107], v[164:167], v[64:67], v[104:107]
  ds_read_b64_tr_b16 v[198:199], v27 offset:512
  v_mfma_f32_16x16x32_bf16 v[112:115], v[168:171], v[64:67], v[112:115]
  ds_read_b64_tr_b16 v[200:201], v28 offset:0
  v_mfma_f32_16x16x32_bf16 v[116:119], v[168:171], v[68:71], v[116:119]
  ds_read_b64_tr_b16 v[202:203], v28 offset:512
  v_mfma_f32_16x16x32_bf16 v[124:127], v[172:175], v[68:71], v[124:127]
  ds_read_b64_tr_b16 v[204:205], v29 offset:0
  v_mfma_f32_16x16x32_bf16 v[120:123], v[172:175], v[64:67], v[120:123]
  ds_read_b64_tr_b16 v[206:207], v29 offset:512
  s_waitcnt vmcnt(4) lgkmcnt(8)
  v_mfma_f32_16x16x32_bf16 v[96:99], v[176:179], v[72:75], v[96:99]
  ds_read_b64_tr_b16 v[208:209], v26 offset:4096
  v_mfma_f32_16x16x32_bf16 v[100:103], v[176:179], v[76:79], v[100:103]
  ds_read_b64_tr_b16 v[210:211], v26 offset:4608
  v_mfma_f32_16x16x32_bf16 v[108:111], v[180:183], v[76:79], v[108:111]
  ds_read_b64_tr_b16 v[212:213], v27 offset:4096
  v_mfma_f32_16x16x32_bf16 v[104:107], v[180:183], v[72:75], v[104:107]
  ds_read_b64_tr_b16 v[214:215], v27 offset:4608
  v_mfma_f32_16x16x32_bf16 v[112:115], v[184:187], v[72:75], v[112:115]
  ds_read_b64_tr_b16 v[216:217], v28 offset:4096
  v_mfma_f32_16x16x32_bf16 v[116:119], v[184:187], v[76:79], v[116:119]
  ds_read_b64_tr_b16 v[218:219], v28 offset:4608
  v_mfma_f32_16x16x32_bf16 v[124:127], v[188:191], v[76:79], v[124:127]
  ds_read_b64_tr_b16 v[220:221], v29 offset:4096
  v_mfma_f32_16x16x32_bf16 v[120:123], v[188:191], v[72:75], v[120:123]
  ds_read_b64_tr_b16 v[222:223], v29 offset:4608
  s_waitcnt vmcnt(2) lgkmcnt(8)
  v_mfma_f32_16x16x32_bf16 v[96:99], v[192:195], v[80:83], v[96:99]
  v_mov_b32 v20, 0
  v_mov_b32 v21, 0
  v_mfma_f32_16x16x32_bf16 v[100:103], v[192:195], v[84:87], v[100:103]
  v_mov_b32 v22, 0
  v_mov_b32 v23, 0
  v_mfma_f32_16x16x32_bf16 v[108:111], v[196:199], v[84:87], v[108:111]
  v_mfma_f32_16x16x32_bf16 v[104:107], v[196:199], v[80:83], v[104:107]
  v_mfma_f32_16x16x32_bf16 v[112:115], v[200:203], v[80:83], v[112:115]
  v_mfma_f32_16x16x32_bf16 v[116:119], v[200:203], v[84:87], v[116:119]
  v_mfma_f32_16x16x32_bf16 v[124:127], v[204:207], v[84:87], v[124:127]
  v_mfma_f32_16x16x32_bf16 v[120:123], v[204:207], v[80:83], v[120:123]
  s_waitcnt vmcnt(0) lgkmcnt(0)
  v_mfma_f32_16x16x32_bf16 v[96:99], v[208:211], v[88:91], v[96:99]
  v_mfma_f32_16x16x32_bf16 v[100:103], v[208:211], v[92:95], v[100:103]
  v_mfma_f32_16x16x32_bf16 v[108:111], v[212:215], v[92:95], v[108:111]
  v_mfma_f32_16x16x32_bf16 v[104:107], v[212:215], v[88:91], v[104:107]
  v_mfma_f32_16x16x32_bf16 v[112:115], v[216:219], v[88:91], v[112:115]
  v_mfma_f32_16x16x32_bf16 v[116:119], v[216:219], v[92:95], v[116:119]
  v_mfma_f32_16x16x32_bf16 v[124:127], v[220:223], v[92:95], v[124:127]
  v_mfma_f32_16x16x32_bf16 v[120:123], v[220:223], v[88:91], v[120:123]
  s_mov_b32 s3, 32768
  s_mov_b32 s10, 0x3f803f80
  s_nop 4
  v_cvt_pk_bf16_f32 v240, v96, v97
  v_cvt_pk_bf16_f32 v241, v98, v99
  v_cvt_pk_bf16_f32 v242, v104, v105
  v_cvt_pk_bf16_f32 v243, v106, v107
  s_nop 1
  v_permlane16_swap_b32 v240, v242
  v_permlane16_swap_b32 v241, v243
  buffer_store_dwordx4 v[240:243], v12, s[44:47], 0 offen offset:0 sc1
  ds_write_b128 v19, v[240:243] offset:0
  v_cvt_pk_bf16_f32 v244, v112, v113
  v_cvt_pk_bf16_f32 v245, v114, v115
  v_cvt_pk_bf16_f32 v246, v120, v121
  v_cvt_pk_bf16_f32 v247, v122, v123
  s_nop 1
  v_permlane16_swap_b32 v244, v246
  v_permlane16_swap_b32 v245, v247
  buffer_store_dwordx4 v[244:247], v12, s[44:47], 0 offen offset:1024 sc1
  ds_write_b128 v19, v[244:247] offset:1024
  v_cvt_pk_bf16_f32 v248, v100, v101
  v_cvt_pk_bf16_f32 v249, v102, v103
  v_cvt_pk_bf16_f32 v250, v108, v109
  v_cvt_pk_bf16_f32 v251, v110, v111
  s_nop 1
  v_permlane16_swap_b32 v248, v250
  v_permlane16_swap_b32 v249, v251
  buffer_store_dwordx4 v[248:251], v12, s[44:47], s3 offen offset:0 sc1
  ds_write_b128 v19, v[248:251] offset:2048
  v_cvt_pk_bf16_f32 v252, v116, v117
  v_cvt_pk_bf16_f32 v253, v118, v119
  v_cvt_pk_bf16_f32 v254, v124, v125
  v_cvt_pk_bf16_f32 v255, v126, v127
  s_nop 1
  v_permlane16_swap_b32 v252, v254
  v_permlane16_swap_b32 v253, v255
  buffer_store_dwordx4 v[252:255], v12, s[44:47], s3 offen offset:1024 sc1
  ds_write_b128 v19, v[252:255] offset:3072
  v_dot2_f32_bf16 v20, v240, s10, v20
  v_dot2_f32_bf16 v22, v240, v240, v22
  v_dot2_f32_bf16 v20, v241, s10, v20
  v_dot2_f32_bf16 v22, v241, v241, v22
  v_dot2_f32_bf16 v20, v242, s10, v20
  v_dot2_f32_bf16 v22, v242, v242, v22
  v_dot2_f32_bf16 v20, v243, s10, v20
  v_dot2_f32_bf16 v22, v243, v243, v22
  v_dot2_f32_bf16 v20, v244, s10, v20
  v_dot2_f32_bf16 v22, v244, v244, v22
  v_dot2_f32_bf16 v20, v245, s10, v20
  v_dot2_f32_bf16 v22, v245, v245, v22
  v_dot2_f32_bf16 v20, v246, s10, v20
  v_dot2_f32_bf16 v22, v246, v246, v22
  v_dot2_f32_bf16 v20, v247, s10, v20
  v_dot2_f32_bf16 v22, v247, v247, v22
  v_dot2_f32_bf16 v21, v248, s10, v21
  v_dot2_f32_bf16 v23, v248, v248, v23
  v_dot2_f32_bf16 v21, v249, s10, v21
  v_dot2_f32_bf16 v23, v249, v249, v23
  v_dot2_f32_bf16 v21, v250, s10, v21
  v_dot2_f32_bf16 v23, v250, v250, v23
  v_dot2_f32_bf16 v21, v251, s10, v21
  v_dot2_f32_bf16 v23, v251, v251, v23
  v_dot2_f32_bf16 v21, v252, s10, v21
  v_dot2_f32_bf16 v23, v252, v252, v23
  v_dot2_f32_bf16 v21, v253, s10, v21
  v_dot2_f32_bf16 v23, v253, v253, v23
  v_dot2_f32_bf16 v21, v254, s10, v21
  v_dot2_f32_bf16 v23, v254, v254, v23
  v_dot2_f32_bf16 v21, v255, s10, v21
  v_dot2_f32_bf16 v23, v255, v255, v23
  s_nop 2
  v_permlane32_swap_b32 v20, v21
  v_permlane32_swap_b32 v22, v23
  v_add_f32 v20, v20, v21
  v_add_f32 v22, v22, v23
  s_nop 1
  v_permlane16_swap_b32 v20, v22
  v_add_f32 v20, v20, v22
  buffer_store_dword v20, v18, s[56:59], 0 offen sc1
  s_waitcnt vmcnt(0) lgkmcnt(0)
  s_barrier
  s_add_u32 s97, s97, 1
  s_branch L_w1_body
L_wo_c1:
L_w1_c0:
L_w1_body:
  s_cmp_ge_u32 s2, 256
  s_cbranch_scc1 L_w1_end
  v_lshrrev_b32 v2, 6, v0
  v_and_b32 v1, 63, v0
  v_readfirstlane_b32 s70, v2
  s_and_b32 s3, s2, 7
  s_lshr_b32 s99, s2, 3
  s_and_b32 s5, s3, 3
  s_lshl_b32 s5, s5, 2
  s_and_b32 s6, s99, 3
  s_add_u32 s68, s5, s6
  s_lshr_b32 s5, s3, 2
  s_lshl_b32 s5, s5, 3
  s_lshr_b32 s6, s99, 2
  s_add_u32 s69, s5, s6
  s_cmp_lt_u32 s70, 4
  s_cbranch_scc1 L_w1_compute
L_w1_loader:
  s_add_u32 s8, s70, s69
  s_and_b32 s8, s8, 3
  s_add_u32 s9, s70, s68
  s_and_b32 s9, s9, 3
  s_lshl_b32 s76, s8, 12
  s_lshl_b32 s77, s9, 11
  s_add_u32 s77, s77, 16384
  s_lshl_b32 s11, s68, 7
  v_and_b32 v10, 7, v1
  s_lshr_b32 s10, s76, 11
  s_lshl_b32 s3, s68, 3
  s_add_u32 s10, s10, s3
  s_mul_i32 s10, s10, 32768
  v_lshl_add_u32 v4, v1, 4, s10
  v_add_u32 v5, 32768, v4
  v_lshrrev_b32 v3, 3, v1
  s_lshl_b32 s10, s9, 4
  v_add_u32 v3, s10, v3
  v_mul_u32_u24 v3, 7168, v3
  v_lshrrev_b32 v2, 3, v1
  v_and_b32 v2, 2, v2
  v_xor_b32 v2, v2, v10
  s_mul_i32 s10, s69, 128
  v_add_u32 v3, s10, v3
  v_lshl_add_u32 v8, v2, 4, v3
  v_xor_b32 v2, 4, v2
  v_add_u32 v3, 57344, v3
  v_lshl_add_u32 v9, v2, 4, v3
  v_lshrrev_b32 v3, 2, v1
  s_lshl_b32 s10, s9, 4
  v_add_u32 v3, s10, v3
  v_mul_u32_u24 v3, 7168, v3
  v_lshrrev_b32 v2, 4, v1
  v_and_b32 v2, 2, v2
  v_xor_b32 v2, v2, v1
  v_and_b32 v2, 3, v2
  s_lshl_b32 s10, s69, 6
  s_add_u32 s10, s10, 2048
  v_add_u32 v3, s10, v3
  v_lshl_add_u32 v28, v2, 4, v3
  s_lshl_b32 s78, s69, 7
  s_add_u32 s78, s78, 3072
  s_mov_b32 s75, 0
  s_add_u32 s100, s68, s69
  s_mov_b32 s101, -1
  s_add_u32 s3, s68, s69
  s_and_b32 s3, s3, 3
  s_mov_b32 s100, 0x68532410
  s_mov_b32 s101, 0xfedbac97
  s_cmp_eq_u32 s3, 1
  s_cselect_b32 s100, 0x96435210, s100
  s_cselect_b32 s101, 0xfecbda87, s101
  s_cmp_eq_u32 s3, 2
  s_cselect_b32 s100, 0x75463210, s100
  s_cselect_b32 s101, 0xfdceb98a, s101
  s_cmp_eq_u32 s3, 3
  s_cselect_b32 s100, 0x65743210, s100
  s_cselect_b32 s101, 0xedfca9b8, s101
  s_waitcnt lgkmcnt(0)
  s_cmp_lg_u32 s96, 0
  s_cbranch_scc1 L_pfc3_skip
  s_getpc_b64 s[4:5]
L_pfc3:
  s_lshl_b32 s3, s99, 2
  s_add_u32 s3, s3, s70
  s_sub_u32 s3, s3, 4
  s_mul_i32 s3, s3, 192
  s_min_u32 s3, s3, L_w2_c1-L_w2_c0-192
  s_add_i32 s3, s3, L_w2_c0-L_pfc3
  s_ashr_i32 s6, s3, 31
  s_add_u32 s4, s4, s3
  s_addc_u32 s5, s5, s6
  s_load_dword s84, s[4:5], 0
  s_load_dword s84, s[4:5], 64
  s_load_dword s84, s[4:5], 128
L_pfc3_skip:
  s_add_u32 s36, s34, 4194304
  s_addc_u32 s37, s35, 0
  s_and_b32 s37, s37, 0xffff
  s_mov_b32 s38, 4194304
  s_mov_b32 s39, 0x00020000
  s_mov_b32 s40, s24
  s_and_b32 s41, s25, 0xffff
  s_mov_b32 s42, 7340032
  s_mov_b32 s43, 0x00020000
  s_add_u32 s56, s34, 24117248
  s_addc_u32 s57, s35, 0
  s_and_b32 s57, s57, 0xffff
  s_mov_b32 s58, 262144
  s_mov_b32 s59, 0x00020000
  s_add_u32 s64, s22, 24641536
  s_addc_u32 s65, s23, 0
  s_and_b32 s65, s65, 0xffff
  s_mov_b32 s66, 262144
  s_mov_b32 s67, 0x00020000
  s_mov_b32 s52, s26
  s_and_b32 s53, s27, 0xffff
  s_mov_b32 s54, 7168
  s_mov_b32 s55, 0x00020000
  s_and_b32 s3, s70, 3
  s_lshl2_add_u32 s4, s68, s3
  s_lshl_b32 s4, s4, 8
  v_lshrrev_b32 v2, 4, v1
  v_and_b32 v3, 15, v1
  v_lshl_add_u32 v3, v3, 4, s4
  v_lshl_add_u32 v18, v2, 14, v3
  s_lshl_b32 s4, s69, 7
  s_lshl_b32 s5, s70, 6
  s_add_u32 s4, s4, s5
  s_add_u32 s4, s4, 1216
  s_lshl_b32 s5, s69, 6
  s_cmp_eq_u32 s70, 4
  s_cselect_b32 s4, s5, s4
  s_lshr_b32 s5, s5, 1
  s_add_u32 s5, s5, 1024
  s_cmp_eq_u32 s70, 7
  s_cselect_b32 s4, s5, s4
  v_and_b32 v3, 15, v1
  v_lshl_add_u32 v3, v3, 2, s4
  v_lshrrev_b32 v2, 4, v1
  v_add_lshl_u32 v23, v3, v2, 1
  v_lshlrev_b32 v3, 2, v3
  v_lshl_add_u32 v22, v2, 14, v3
  s_mov_b32 s60, s28
  s_and_b32 s61, s29, 0xffff
  s_mov_b32 s62, 7340032
  s_mov_b32 s63, 0x00020000
  s_cmp_eq_u32 s96, 0
  s_cselect_b32 s62, s62, 0
  s_and_b32 s3, s70, 3
  s_lshl_b32 s4, s2, 2
  s_add_u32 s3, s3, s4
  s_mul_i32 s98, s3, 3584
  s_add_u32 s98, s98, 3670016
  s_buffer_load_dword s84, s[60:63], s98 offset:0
  s_buffer_load_dword s84, s[60:63], s98 offset:64
  s_buffer_load_dword s84, s[60:63], s98 offset:128
  s_buffer_load_dword s84, s[60:63], s98 offset:192
  s_lshr_b32 s3, s69, 3
  s_and_b32 s73, s69, 7
  s_lshl1_add_u32 s91, s73, s3
  s_mul_i32 s74, s91, 458752
  s_lshl_b32 s73, s91, 11
  s_mov_b32 s88, s73
  s_add_u32 m0, s77, 0
  s_add_u32 s4, s74, 0
  buffer_load_dwordx4 v8, s[40:43], s4 offen lds
  s_add_u32 m0, s77, 1024
  s_nop 0
  buffer_load_dwordx4 v9, s[40:43], s4 offen lds
  s_add_u32 m0, s77, 8192
  s_add_u32 s4, s74, s78
  buffer_load_dwordx4 v8, s[40:43], s4 offen lds
  s_add_u32 m0, s77, 9216
  s_nop 0
  buffer_load_dwordx4 v9, s[40:43], s4 offen lds
  s_add_u32 m0, s77, 16384
  s_add_u32 s4, s4, 128
  buffer_load_dwordx4 v8, s[40:43], s4 offen lds
  s_add_u32 m0, s77, 17408
  s_nop 0
  buffer_load_dwordx4 v9, s[40:43], s4 offen lds
  s_add_u32 m0, s77, 24576
  s_nop 0
  buffer_load_dwordx4 v28, s[40:43], s74 offen lds
  s_and_b32 s73, s100, 15
  s_cmp_eq_u32 s73, s91
  s_cselect_b32 s74, 4, 0
  s_lshr_b64 s[100:101], s[100:101], s74
  s_and_b32 s73, s100, 15
  s_lshr_b64 s[100:101], s[100:101], 4
  s_mul_i32 s74, s73, 458752
  s_lshl_b32 s73, s73, 11
  s_add_u32 s3, s96, s70
  s_cmp_lg_u32 s3, 4
  s_cbranch_scc1 L_w1_chkNone
  s_add_u32 s44, s22, 41943040
  s_addc_u32 s45, s23, 0
  s_and_b32 s45, s45, 0xffff
  s_mov_b32 s46, 524288
  s_mov_b32 s47, 0x00020000
  v_lshrrev_b32 v2, 2, v1
  v_and_b32 v3, 3, v1
  v_lshlrev_b32 v2, 11, v2
  v_lshl_add_u32 v17, v3, 4, v2
  s_and_b32 s3, s69, 15
  s_lshl_b32 s3, s3, 7
  s_mov_b32 s79, 0x100000
L_w1_chkl:
  buffer_load_dwordx4 v[12:15], v17, s[44:47], s3 offen sc1
  s_sub_u32 s79, s79, 1
  s_cbranch_scc1 L_w1_chkNone
  s_waitcnt vmcnt(0)
  v_and_b32 v12, v12, v13
  v_and_b32 v14, v14, v15
  v_and_b32 v12, v12, v14
  v_cmp_ne_u32 vcc, 1, v12
  s_cbranch_vccnz L_w1_chkl
L_w1_chkNone:
  s_mov_b32 s75, 0
  s_add_u32 s44, s22, 41943040
  s_addc_u32 s45, s23, 0
  s_and_b32 s45, s45, 0xffff
  s_mov_b32 s46, 524288
  s_mov_b32 s47, 0x00020000
  s_lshl4_add_u32 s3, s97, s68
  s_and_b32 s4, s69, 15
  s_lshl4_add_u32 s3, s3, s4
  s_lshl_b32 s3, s3, 7
  s_sub_u32 s3, s3, 32768
  v_lshlrev_b32 v11, 7, v1
  v_and_b32 v2, 15, v1
  v_lshlrev_b32 v2, 2, v2
  v_mov_b32 v3, 1
  s_mov_b32 s79, 0x100000
  s_waitcnt vmcnt(0)
  s_cmp_lg_u32 s70, 4
  s_barrier
  s_cbranch_scc1 L_w1_nofl
  s_mov_b32 exec_lo, 0xffff
  s_mov_b32 exec_hi, 0
  buffer_store_dword v3, v11, s[44:47], s87 offen sc1
  s_mov_b64 exec, -1
L_w1_nofl:
  s_mov_b32 s5, s3
  s_mov_b32 s89, s73
  s_add_u32 m0, s77, 49152
  s_add_u32 s4, s74, 0
  buffer_load_dwordx4 v8, s[40:43], s4 offen lds
  s_add_u32 m0, s77, 50176
  s_nop 0
  buffer_load_dwordx4 v9, s[40:43], s4 offen lds
  s_add_u32 m0, s77, 57344
  s_add_u32 s4, s74, s78
  buffer_load_dwordx4 v8, s[40:43], s4 offen lds
  s_add_u32 m0, s77, 58368
  s_nop 0
  buffer_load_dwordx4 v9, s[40:43], s4 offen lds
  s_add_u32 m0, s77, 65536
  s_add_u32 s4, s4, 128
  buffer_load_dwordx4 v8, s[40:43], s4 offen lds
  s_add_u32 m0, s77, 66560
  s_nop 0
  buffer_load_dwordx4 v9, s[40:43], s4 offen lds
  s_add_u32 m0, s77, 73728
  s_nop 0
  buffer_load_dwordx4 v28, s[40:43], s74 offen lds
  s_and_b32 s73, s100, 15
  s_cmp_eq_u32 s73, s91
  s_cselect_b32 s74, 4, 0
  s_lshr_b64 s[100:101], s[100:101], s74
  s_and_b32 s73, s100, 15
  s_lshr_b64 s[100:101], s[100:101], 4
  s_mul_i32 s74, s73, 458752
  s_lshl_b32 s73, s73, 11
  s_mov_b32 s90, s73
  s_add_u32 m0, s77, 98304
  s_add_u32 s4, s74, 0
  buffer_load_dwordx4 v8, s[40:43], s4 offen lds
  s_add_u32 m0, s77, 99328
  s_nop 0
  buffer_load_dwordx4 v9, s[40:43], s4 offen lds
  s_add_u32 m0, s77, 106496
  s_add_u32 s4, s74, s78
  buffer_load_dwordx4 v8, s[40:43], s4 offen lds
  s_add_u32 m0, s77, 107520
  s_nop 0
  buffer_load_dwordx4 v9, s[40:43], s4 offen lds
  s_add_u32 m0, s77, 114688
  s_add_u32 s4, s4, 128
  buffer_load_dwordx4 v8, s[40:43], s4 offen lds
  s_add_u32 m0, s77, 115712
  s_nop 0
  buffer_load_dwordx4 v9, s[40:43], s4 offen lds
  s_add_u32 m0, s77, 122880
  s_nop 0
  buffer_load_dwordx4 v28, s[40:43], s74 offen lds
  s_and_b32 s73, s100, 15
  s_cmp_eq_u32 s73, s91
  s_cselect_b32 s74, 4, 0
  s_lshr_b64 s[100:101], s[100:101], s74
  s_and_b32 s73, s100, 15
  s_lshr_b64 s[100:101], s[100:101], 4
  s_mul_i32 s74, s73, 458752
  s_lshl_b32 s73, s73, 11
  s_mov_b32 s3, s5
  s_cmp_lg_u32 s70, 4
  s_cbranch_scc1 L_w1_dep
L_w1_poll:
  buffer_load_dword v3, v2, s[44:47], s3 offen sc1
  s_sub_u32 s79, s79, 1
  s_cbranch_scc1 L_w1_dep
  s_waitcnt vmcnt(0)
  v_cmp_ne_u32 vcc, 1, v3
  s_cbranch_vccnz L_w1_poll
L_w1_dep:
  s_barrier
  s_add_u32 m0, s76, 49152
  s_nop 0
  buffer_load_dwordx4 v4, s[36:39], s89 offen offset:0 lds
  buffer_load_dwordx4 v4, s[36:39], s89 offen offset:1024 lds
  s_add_u32 m0, s76, 51200
  s_nop 0
  buffer_load_dwordx4 v5, s[36:39], s89 offen offset:0 lds
  buffer_load_dwordx4 v5, s[36:39], s89 offen offset:1024 lds
  s_add_u32 m0, s76, 98304
  s_nop 0
  buffer_load_dwordx4 v4, s[36:39], s90 offen offset:0 lds
  buffer_load_dwordx4 v4, s[36:39], s90 offen offset:1024 lds
  s_add_u32 m0, s76, 100352
  s_nop 0
  buffer_load_dwordx4 v5, s[36:39], s90 offen offset:0 lds
  buffer_load_dwordx4 v5, s[36:39], s90 offen offset:1024 lds
  s_waitcnt vmcnt(4)
  s_barrier
  s_mov_b32 s79, 13
L_w1_ld1:
  s_add_u32 s3, s75, s76
  s_add_u32 m0, s3, 0
  s_nop 0
  buffer_load_dwordx4 v4, s[36:39], s73 offen offset:0 lds
  buffer_load_dwordx4 v4, s[36:39], s73 offen offset:1024 lds
  s_add_u32 m0, s3, 2048
  s_nop 0
  buffer_load_dwordx4 v5, s[36:39], s73 offen offset:0 lds
  buffer_load_dwordx4 v5, s[36:39], s73 offen offset:1024 lds
  s_add_u32 s3, s75, s77
  s_add_u32 m0, s3, 0
  s_add_u32 s4, s74, 0
  buffer_load_dwordx4 v8, s[40:43], s4 offen lds
  s_add_u32 m0, s3, 1024
  s_nop 0
  buffer_load_dwordx4 v9, s[40:43], s4 offen lds
  s_add_u32 m0, s3, 8192
  s_add_u32 s4, s74, s78
  buffer_load_dwordx4 v8, s[40:43], s4 offen lds
  s_add_u32 m0, s3, 9216
  s_nop 0
  buffer_load_dwordx4 v9, s[40:43], s4 offen lds
  s_add_u32 m0, s3, 16384
  s_add_u32 s4, s4, 128
  buffer_load_dwordx4 v8, s[40:43], s4 offen lds
  s_add_u32 m0, s3, 17408
  s_nop 0
  buffer_load_dwordx4 v9, s[40:43], s4 offen lds
  s_add_u32 m0, s3, 24576
  s_nop 0
  buffer_load_dwordx4 v28, s[40:43], s74 offen lds
  s_and_b32 s73, s100, 15
  s_cmp_eq_u32 s73, s91
  s_cselect_b32 s74, 4, 0
  s_lshr_b64 s[100:101], s[100:101], s74
  s_and_b32 s73, s100, 15
  s_lshr_b64 s[100:101], s[100:101], 4
  s_mul_i32 s74, s73, 458752
  s_lshl_b32 s73, s73, 11
  s_add_u32 s75, s75, 49152
  s_cmp_eq_u32 s75, 147456
  s_cselect_b32 s75, 0, s75
  s_buffer_load_dword s84, s[60:63], s98 offset:256
  s_buffer_load_dword s84, s[60:63], s98 offset:320
  s_buffer_load_dword s84, s[60:63], s98 offset:384
  s_buffer_load_dword s84, s[60:63], s98 offset:448
  s_add_u32 s98, s98, 256
  s_waitcnt vmcnt(11)
  s_barrier
  s_sub_u32 s79, s79, 1
  s_cmp_lg_u32 s79, 0
  s_cbranch_scc1 L_w1_ld1
  buffer_load_dwordx4 v[64:67], v22, s[64:67], 0 offen
  s_mov_b32 s3, 65536
  buffer_load_dwordx4 v[68:71], v22, s[64:67], s3 offen
  s_mov_b32 s3, 131072
  buffer_load_dwordx4 v[72:75], v22, s[64:67], s3 offen
  s_mov_b32 s3, 196608
  buffer_load_dwordx4 v[76:79], v22, s[64:67], s3 offen
  buffer_load_ushort v80, v23, s[52:55], 0 offen
  buffer_load_dwordx4 v[32:35], v18, s[56:59], 0 offen
  s_mov_b32 s3, 65536
  buffer_load_dwordx4 v[36:39], v18, s[56:59], s3 offen
  s_mov_b32 s3, 131072
  buffer_load_dwordx4 v[40:43], v18, s[56:59], s3 offen
  s_mov_b32 s3, 196608
  buffer_load_dwordx4 v[44:47], v18, s[56:59], s3 offen
  s_waitcnt vmcnt(9)
  s_barrier
  s_waitcnt vmcnt(0)
  v_pk_add_f32 v[32:33], v[32:33], v[36:37]
  v_pk_add_f32 v[34:35], v[34:35], v[38:39]
  v_pk_add_f32 v[40:41], v[40:41], v[44:45]
  v_pk_add_f32 v[42:43], v[42:43], v[46:47]
  v_pk_add_f32 v[32:33], v[32:33], v[40:41]
  v_pk_add_f32 v[34:35], v[34:35], v[42:43]
  s_nop 1
  v_permlane32_swap_b32 v32, v34
  v_permlane32_swap_b32 v33, v35
  v_pk_add_f32 v[32:33], v[32:33], v[34:35]
  v_mov_b32 v34, v32
  v_mov_b32 v35, v33
  s_nop 0
  v_permlane16_swap_b32 v32, v34
  v_permlane16_swap_b32 v33, v35
  v_pk_add_f32 v[32:33], v[32:33], v[34:35]
  v_mul_f32 v32, 0x3a800000, v32
  v_mul_f32 v33, 0x3a800000, v33
  v_fma_f32 v33, -v32, v32, v33
  v_max_f32 v33, 0, v33
  v_add_f32 v33, 0x3727c5ac, v33
  v_rsq_f32 v33, v33
  s_nop 0
  s_and_b32 s3, s70, 3
  s_lshl_b32 s5, s3, 7
  s_add_u32 s5, s5, 110656
  v_and_b32 v3, 15, v1
  v_lshrrev_b32 v2, 5, v1
  v_lshl_add_u32 v2, v3, 1, v2
  v_lshl_add_u32 v2, v2, 2, s5
  ds_write2_b32 v2, v32, v33 offset0:0 offset1:160
  v_pk_add_f32 v[64:65], v[64:65], v[68:69]
  v_pk_add_f32 v[66:67], v[66:67], v[70:71]
  v_pk_add_f32 v[72:73], v[72:73], v[76:77]
  v_pk_add_f32 v[74:75], v[74:75], v[78:79]
  v_pk_add_f32 v[64:65], v[64:65], v[72:73]
  v_pk_add_f32 v[66:67], v[66:67], v[74:75]
  s_nop 1
  v_permlane32_swap_b32 v64, v66
  v_permlane32_swap_b32 v65, v67
  v_pk_add_f32 v[64:65], v[64:65], v[66:67]
  v_lshlrev_b32 v80, 16, v80
  s_lshl_b32 s5, s3, 8
  s_add_u32 s5, s5, 111872
  v_permlane16_swap_b32 v64, v65
  v_lshrrev_b32 v2, 4, v1
  v_lshl_add_u32 v2, v3, 2, v2
  v_lshl_add_u32 v2, v2, 2, s5
  v_add_f32 v64, v64, v65
  ds_write2st64_b32 v2, v64, v80 offset0:0 offset1:4
  s_waitcnt lgkmcnt(0)
  s_barrier
  s_lshl_b32 s87, s97, 15
  s_lshl_b32 s4, s68, 11
  s_add_u32 s87, s87, s4
  s_lshl_b32 s4, s69, 2
  s_add_u32 s87, s87, s4
  s_add_u32 s97, s97, 1
  s_branch L_w2_body
L_w1_end:
  s_endpgm
L_w1_compute:
  s_and_b32 s71, s70, 1
  s_lshr_b32 s72, s70, 1
  v_and_b32 v3, 15, v1
  v_lshrrev_b32 v2, 4, v1
  s_lshl_b32 s8, s71, 13
  v_lshl_add_u32 v4, v1, 4, s8
  v_bfe_u32 v13, v1, 2, 2
  v_lshl_add_u32 v13, v2, 3, v13
  v_lshlrev_b32 v13, 7, v13
  v_and_b32 v17, 3, v1
  v_lshl_add_u32 v13, v17, 3, v13
  v_bfe_u32 v17, v1, 3, 2
  v_lshl_add_u32 v13, v17, 5, v13
  s_lshl_b32 s9, s72, 6
  v_xor_b32 v13, s9, v13
  v_add_u32 v5, 16384, v13
  v_xor_b32 v6, 32, v5
  v_and_b32 v16, 1, v2
  v_lshrrev_b32 v17, 1, v2
  v_bfe_u32 v13, v1, 2, 2
  v_lshl_add_u32 v13, v16, 3, v13
  v_lshl_add_u32 v13, v17, 5, v13
  v_xor_b32 v14, s72, v16
  v_lshl_add_u32 v13, v13, 1, v14
  v_and_b32 v14, 3, v1
  v_lshl_add_u32 v13, v13, 2, v14
  v_lshlrev_b32 v13, 3, v13
  v_add_u32 v7, 40960, v13
  s_mov_b32 s75, 0
  v_add_u32_e64 v20, s75, v4
  v_add_u32_e64 v21, s75, v5
  v_add_u32_e64 v22, s75, v6
  v_add_u32_e64 v23, s75, v7
  s_add_u32 s75, s75, 49152
  s_cmp_eq_u32 s75, 147456
  s_cselect_b32 s75, 0, s75
  s_mov_b32 s79, 15
  ds_read_b128 v[32:35], v20 offset:0
  ds_read_b128 v[36:39], v20 offset:2048
  ds_read_b128 v[40:43], v20 offset:4096
  ds_read_b128 v[44:47], v20 offset:6144
  ds_read_b64_tr_b16 v[48:49], v21 offset:0
  ds_read_b64_tr_b16 v[50:51], v21 offset:512
  ds_read_b64_tr_b16 v[52:53], v22 offset:0
  ds_read_b64_tr_b16 v[54:55], v22 offset:512
  ds_read_b64_tr_b16 v[56:57], v21 offset:8192
  ds_read_b64_tr_b16 v[58:59], v21 offset:8704
  ds_read_b64_tr_b16 v[60:61], v22 offset:8192
  ds_read_b64_tr_b16 v[62:63], v22 offset:8704
  ds_read_b64_tr_b16 v[64:65], v21 offset:16384
  ds_read_b64_tr_b16 v[66:67], v21 offset:16896
  ds_read_b64_tr_b16 v[68:69], v22 offset:16384
  ds_read_b64_tr_b16 v[70:71], v22 offset:16896
  ds_read_b64_tr_b16 v[72:73], v23 offset:0
  ds_read_b64_tr_b16 v[74:75], v23 offset:256
  s_waitcnt lgkmcnt(0)
  v_mfma_f32_16x16x32_bf16 v[128:131], v[48:51], v[32:35], 0
  ds_read_b128 v[80:83], v20 offset:1024
  v_mfma_f32_16x16x32_bf16 v[132:135], v[48:51], v[36:39], 0
  ds_read_b128 v[84:87], v20 offset:3072
  v_mfma_f32_16x16x32_bf16 v[136:139], v[48:51], v[40:43], 0
  ds_read_b128 v[88:91], v20 offset:5120
  v_mfma_f32_16x16x32_bf16 v[140:143], v[48:51], v[44:47], 0
  ds_read_b128 v[92:95], v20 offset:7168
  v_mfma_f32_16x16x32_bf16 v[156:159], v[52:55], v[44:47], 0
  ds_read_b64_tr_b16 v[96:97], v21 offset:4096
  v_mfma_f32_16x16x32_bf16 v[152:155], v[52:55], v[40:43], 0
  ds_read_b64_tr_b16 v[98:99], v21 offset:4608
  v_mfma_f32_16x16x32_bf16 v[148:151], v[52:55], v[36:39], 0
  ds_read_b64_tr_b16 v[100:101], v22 offset:4096
  v_mfma_f32_16x16x32_bf16 v[144:147], v[52:55], v[32:35], 0
  ds_read_b64_tr_b16 v[102:103], v22 offset:4608
  v_mfma_f32_16x16x32_bf16 v[160:163], v[56:59], v[32:35], 0
  ds_read_b64_tr_b16 v[104:105], v21 offset:12288
  v_mfma_f32_16x16x32_bf16 v[164:167], v[56:59], v[36:39], 0
  ds_read_b64_tr_b16 v[106:107], v21 offset:12800
  v_mfma_f32_16x16x32_bf16 v[168:171], v[56:59], v[40:43], 0
  ds_read_b64_tr_b16 v[108:109], v22 offset:12288
  v_mfma_f32_16x16x32_bf16 v[172:175], v[56:59], v[44:47], 0
  ds_read_b64_tr_b16 v[110:111], v22 offset:12800
  v_mfma_f32_16x16x32_bf16 v[188:191], v[60:63], v[44:47], 0
  ds_read_b64_tr_b16 v[112:113], v21 offset:20480
  v_mfma_f32_16x16x32_bf16 v[184:187], v[60:63], v[40:43], 0
  ds_read_b64_tr_b16 v[114:115], v21 offset:20992
  v_mfma_f32_16x16x32_bf16 v[180:183], v[60:63], v[36:39], 0
  ds_read_b64_tr_b16 v[116:117], v22 offset:20480
  v_mfma_f32_16x16x32_bf16 v[176:179], v[60:63], v[32:35], 0
  ds_read_b64_tr_b16 v[118:119], v22 offset:20992
  v_mfma_f32_16x16x32_bf16 v[192:195], v[64:67], v[32:35], 0
  ds_read_b64_tr_b16 v[120:121], v23 offset:4096
  v_mfma_f32_16x16x32_bf16 v[196:199], v[64:67], v[36:39], 0
  ds_read_b64_tr_b16 v[122:123], v23 offset:4352
  v_mfma_f32_16x16x32_bf16 v[200:203], v[64:67], v[40:43], 0
  v_add_u32_e64 v20, s75, v4
  v_mfma_f32_16x16x32_bf16 v[204:207], v[64:67], v[44:47], 0
  v_add_u32_e64 v21, s75, v5
  v_mfma_f32_16x16x32_bf16 v[220:223], v[68:71], v[44:47], 0
  v_add_u32_e64 v22, s75, v6
  v_mfma_f32_16x16x32_bf16 v[216:219], v[68:71], v[40:43], 0
  v_add_u32_e64 v23, s75, v7
  v_mfma_f32_16x16x32_bf16 v[212:215], v[68:71], v[36:39], 0
  s_add_u32 s75, s75, 49152
  v_mfma_f32_16x16x32_bf16 v[208:211], v[68:71], v[32:35], 0
  s_cmp_eq_u32 s75, 147456
  v_mfma_f32_16x16x32_bf16 v[224:227], v[72:75], v[32:35], 0
  s_cselect_b32 s75, 0, s75
  v_mfma_f32_16x16x32_bf16 v[228:231], v[72:75], v[36:39], 0
  v_mfma_f32_16x16x32_bf16 v[232:235], v[72:75], v[40:43], 0
  v_mfma_f32_16x16x32_bf16 v[236:239], v[72:75], v[44:47], 0
  s_waitcnt lgkmcnt(0)
  v_mfma_f32_16x16x32_bf16 v[128:131], v[96:99], v[80:83], v[128:131]
  v_mfma_f32_16x16x32_bf16 v[132:135], v[96:99], v[84:87], v[132:135]
  v_mfma_f32_16x16x32_bf16 v[136:139], v[96:99], v[88:91], v[136:139]
  v_mfma_f32_16x16x32_bf16 v[140:143], v[96:99], v[92:95], v[140:143]
  v_mfma_f32_16x16x32_bf16 v[156:159], v[100:103], v[92:95], v[156:159]
  v_mfma_f32_16x16x32_bf16 v[152:155], v[100:103], v[88:91], v[152:155]
  v_mfma_f32_16x16x32_bf16 v[148:151], v[100:103], v[84:87], v[148:151]
  v_mfma_f32_16x16x32_bf16 v[144:147], v[100:103], v[80:83], v[144:147]
  v_mfma_f32_16x16x32_bf16 v[160:163], v[104:107], v[80:83], v[160:163]
  v_mfma_f32_16x16x32_bf16 v[164:167], v[104:107], v[84:87], v[164:167]
  v_mfma_f32_16x16x32_bf16 v[168:171], v[104:107], v[88:91], v[168:171]
  v_mfma_f32_16x16x32_bf16 v[172:175], v[104:107], v[92:95], v[172:175]
  v_mfma_f32_16x16x32_bf16 v[188:191], v[108:111], v[92:95], v[188:191]
  v_mfma_f32_16x16x32_bf16 v[184:187], v[108:111], v[88:91], v[184:187]
  v_mfma_f32_16x16x32_bf16 v[180:183], v[108:111], v[84:87], v[180:183]
  v_mfma_f32_16x16x32_bf16 v[176:179], v[108:111], v[80:83], v[176:179]
  v_mfma_f32_16x16x32_bf16 v[192:195], v[112:115], v[80:83], v[192:195]
  v_mfma_f32_16x16x32_bf16 v[196:199], v[112:115], v[84:87], v[196:199]
  v_mfma_f32_16x16x32_bf16 v[200:203], v[112:115], v[88:91], v[200:203]
  v_mfma_f32_16x16x32_bf16 v[204:207], v[112:115], v[92:95], v[204:207]
  v_mfma_f32_16x16x32_bf16 v[220:223], v[116:119], v[92:95], v[220:223]
  v_mfma_f32_16x16x32_bf16 v[216:219], v[116:119], v[88:91], v[216:219]
  v_mfma_f32_16x16x32_bf16 v[212:215], v[116:119], v[84:87], v[212:215]
  v_mfma_f32_16x16x32_bf16 v[208:211], v[116:119], v[80:83], v[208:211]
  v_mfma_f32_16x16x32_bf16 v[224:227], v[120:123], v[80:83], v[224:227]
  v_mfma_f32_16x16x32_bf16 v[228:231], v[120:123], v[84:87], v[228:231]
  v_mfma_f32_16x16x32_bf16 v[232:235], v[120:123], v[88:91], v[232:235]
  v_mfma_f32_16x16x32_bf16 v[236:239], v[120:123], v[92:95], v[236:239]
  s_barrier
  s_lshl_b32 s8, s68, 7
  s_lshl_b32 s9, s71, 6
  s_add_u32 s8, s8, s9
  s_mul_i32 s8, s8, 7168
  v_lshlrev_b32 v14, 8, v17
  v_lshl_add_u32 v14, v3, 4, v14
  s_lshl3_add_u32 s9, s71, s72
  s_lshl_b32 s9, s9, 10
  s_add_u32 s9, s9, 114688
  v_lshl_add_u32 v18, v16, 9, v14
  v_add_u32 v18, s9, v18
  s_mov_b32 s52, s30
  s_and_b32 s53, s31, 0xffff
  s_mov_b32 s54, 2048
  s_mov_b32 s55, 0x00020000
  s_lshr_b32 s9, s69, 3
  s_and_b32 s10, s69, 7
  s_lshl1_add_u32 s9, s10, s9
  s_lshl_b32 s9, s9, 7
  v_lshl_add_u32 v19, v2, 3, s9
  v_add_u32 v14, s8, v14
  s_lshl_b32 s10, s69, 11
  s_lshl_b32 s9, s72, 10
  s_add_u32 s9, s9, s10
  v_lshl_add_u32 v12, v16, 9, v14
  v_add_u32 v12, s9, v12
  v_mul_u32_u24 v16, 114688, v16
  s_lshr_b32 s9, s9, 1
  v_add3_u32 v13, v16, v14, s9
  s_lshl_b32 s9, s71, 8
  s_add_u32 s9, s9, 110656
  v_lshl_add_u32 v14, v3, 2, s9
  s_lshl_b32 s9, s72, 7
  s_add_u32 s9, s9, 111872
  v_lshl_add_u32 v15, v2, 4, s9
  s_lshl_b32 s9, s72, 6
  s_add_u32 s9, s9, 111872
  v_lshl_add_u32 v16, v2, 4, s9
  s_add_u32 s44, s34, 8388608
  s_addc_u32 s45, s35, 0
  s_and_b32 s45, s45, 0xffff
  s_mov_b32 s46, 14680064
  s_mov_b32 s47, 0x00020000
  s_barrier
  ds_read_b128 v[32:35], v20 offset:0
  ds_read_b128 v[36:39], v20 offset:2048
  ds_read_b128 v[40:43], v20 offset:4096
  ds_read_b128 v[44:47], v20 offset:6144
  ds_read_b64_tr_b16 v[48:49], v21 offset:0
  ds_read_b64_tr_b16 v[50:51], v21 offset:512
  ds_read_b64_tr_b16 v[52:53], v22 offset:0
  ds_read_b64_tr_b16 v[54:55], v22 offset:512
  ds_read_b64_tr_b16 v[56:57], v21 offset:8192
  ds_read_b64_tr_b16 v[58:59], v21 offset:8704
  ds_read_b64_tr_b16 v[60:61], v22 offset:8192
  ds_read_b64_tr_b16 v[62:63], v22 offset:8704
  ds_read_b64_tr_b16 v[64:65], v21 offset:16384
  ds_read_b64_tr_b16 v[66:67], v21 offset:16896
  ds_read_b64_tr_b16 v[68:69], v22 offset:16384
  ds_read_b64_tr_b16 v[70:71], v22 offset:16896
  ds_read_b64_tr_b16 v[72:73], v23 offset:0
  ds_read_b64_tr_b16 v[74:75], v23 offset:256
.p2align 5
  s_nop 0
  s_nop 0
  s_nop 0
  s_waitcnt lgkmcnt(0)
L_w1_loop:
  v_mfma_f32_16x16x32_bf16 v[128:131], v[48:51], v[32:35], v[128:131]
  ds_read_b128 v[80:83], v20 offset:1024
  v_mfma_f32_16x16x32_bf16 v[132:135], v[48:51], v[36:39], v[132:135]
  ds_read_b128 v[84:87], v20 offset:3072
  v_mfma_f32_16x16x32_bf16 v[136:139], v[48:51], v[40:43], v[136:139]
  ds_read_b128 v[88:91], v20 offset:5120
  v_mfma_f32_16x16x32_bf16 v[140:143], v[48:51], v[44:47], v[140:143]
  ds_read_b128 v[92:95], v20 offset:7168
  v_mfma_f32_16x16x32_bf16 v[156:159], v[52:55], v[44:47], v[156:159]
  ds_read_b64_tr_b16 v[96:97], v21 offset:4096
  v_mfma_f32_16x16x32_bf16 v[152:155], v[52:55], v[40:43], v[152:155]
  ds_read_b64_tr_b16 v[98:99], v21 offset:4608
  v_mfma_f32_16x16x32_bf16 v[148:151], v[52:55], v[36:39], v[148:151]
  ds_read_b64_tr_b16 v[100:101], v22 offset:4096
  v_mfma_f32_16x16x32_bf16 v[144:147], v[52:55], v[32:35], v[144:147]
  ds_read_b64_tr_b16 v[102:103], v22 offset:4608
  v_mfma_f32_16x16x32_bf16 v[160:163], v[56:59], v[32:35], v[160:163]
  ds_read_b64_tr_b16 v[104:105], v21 offset:12288
  v_mfma_f32_16x16x32_bf16 v[164:167], v[56:59], v[36:39], v[164:167]
  ds_read_b64_tr_b16 v[106:107], v21 offset:12800
  v_mfma_f32_16x16x32_bf16 v[168:171], v[56:59], v[40:43], v[168:171]
  ds_read_b64_tr_b16 v[108:109], v22 offset:12288
  v_mfma_f32_16x16x32_bf16 v[172:175], v[56:59], v[44:47], v[172:175]
  ds_read_b64_tr_b16 v[110:111], v22 offset:12800
  v_mfma_f32_16x16x32_bf16 v[188:191], v[60:63], v[44:47], v[188:191]
  ds_read_b64_tr_b16 v[112:113], v21 offset:20480
  v_mfma_f32_16x16x32_bf16 v[184:187], v[60:63], v[40:43], v[184:187]
  ds_read_b64_tr_b16 v[114:115], v21 offset:20992
  v_mfma_f32_16x16x32_bf16 v[180:183], v[60:63], v[36:39], v[180:183]
  ds_read_b64_tr_b16 v[116:117], v22 offset:20480
  v_mfma_f32_16x16x32_bf16 v[176:179], v[60:63], v[32:35], v[176:179]
  ds_read_b64_tr_b16 v[118:119], v22 offset:20992
  v_mfma_f32_16x16x32_bf16 v[192:195], v[64:67], v[32:35], v[192:195]
  ds_read_b64_tr_b16 v[120:121], v23 offset:4096
  v_mfma_f32_16x16x32_bf16 v[196:199], v[64:67], v[36:39], v[196:199]
  ds_read_b64_tr_b16 v[122:123], v23 offset:4352
  v_mfma_f32_16x16x32_bf16 v[200:203], v[64:67], v[40:43], v[200:203]
  v_add_u32_e64 v20, s75, v4
  v_mfma_f32_16x16x32_bf16 v[204:207], v[64:67], v[44:47], v[204:207]
  v_add_u32_e64 v21, s75, v5
  v_mfma_f32_16x16x32_bf16 v[220:223], v[68:71], v[44:47], v[220:223]
  v_add_u32_e64 v22, s75, v6
  v_mfma_f32_16x16x32_bf16 v[216:219], v[68:71], v[40:43], v[216:219]
  v_add_u32_e64 v23, s75, v7
  v_mfma_f32_16x16x32_bf16 v[212:215], v[68:71], v[36:39], v[212:215]
  s_add_u32 s75, s75, 49152
  v_mfma_f32_16x16x32_bf16 v[208:211], v[68:71], v[32:35], v[208:211]
  s_cmp_eq_u32 s75, 147456
  v_mfma_f32_16x16x32_bf16 v[224:227], v[72:75], v[32:35], v[224:227]
  s_cselect_b32 s75, 0, s75
  s_sub_u32 s79, s79, 1
  v_mfma_f32_16x16x32_bf16 v[228:231], v[72:75], v[36:39], v[228:231]
  v_mfma_f32_16x16x32_bf16 v[232:235], v[72:75], v[40:43], v[232:235]
  v_mfma_f32_16x16x32_bf16 v[236:239], v[72:75], v[44:47], v[236:239]
  s_waitcnt lgkmcnt(0)
  s_barrier
  v_mfma_f32_16x16x32_bf16 v[128:131], v[96:99], v[80:83], v[128:131]
  ds_read_b128 v[32:35], v20 offset:0
  v_mfma_f32_16x16x32_bf16 v[132:135], v[96:99], v[84:87], v[132:135]
  ds_read_b128 v[36:39], v20 offset:2048
  v_mfma_f32_16x16x32_bf16 v[136:139], v[96:99], v[88:91], v[136:139]
  ds_read_b128 v[40:43], v20 offset:4096
  v_mfma_f32_16x16x32_bf16 v[140:143], v[96:99], v[92:95], v[140:143]
  ds_read_b128 v[44:47], v20 offset:6144
  v_mfma_f32_16x16x32_bf16 v[156:159], v[100:103], v[92:95], v[156:159]
  ds_read_b64_tr_b16 v[48:49], v21 offset:0
  v_mfma_f32_16x16x32_bf16 v[152:155], v[100:103], v[88:91], v[152:155]
  ds_read_b64_tr_b16 v[50:51], v21 offset:512
  v_mfma_f32_16x16x32_bf16 v[148:151], v[100:103], v[84:87], v[148:151]
  ds_read_b64_tr_b16 v[52:53], v22 offset:0
  v_mfma_f32_16x16x32_bf16 v[144:147], v[100:103], v[80:83], v[144:147]
  ds_read_b64_tr_b16 v[54:55], v22 offset:512
  v_mfma_f32_16x16x32_bf16 v[160:163], v[104:107], v[80:83], v[160:163]
  ds_read_b64_tr_b16 v[56:57], v21 offset:8192
  v_mfma_f32_16x16x32_bf16 v[164:167], v[104:107], v[84:87], v[164:167]
  ds_read_b64_tr_b16 v[58:59], v21 offset:8704
  v_mfma_f32_16x16x32_bf16 v[168:171], v[104:107], v[88:91], v[168:171]
  ds_read_b64_tr_b16 v[60:61], v22 offset:8192
  v_mfma_f32_16x16x32_bf16 v[172:175], v[104:107], v[92:95], v[172:175]
  ds_read_b64_tr_b16 v[62:63], v22 offset:8704
  v_mfma_f32_16x16x32_bf16 v[188:191], v[108:111], v[92:95], v[188:191]
  ds_read_b64_tr_b16 v[64:65], v21 offset:16384
  v_mfma_f32_16x16x32_bf16 v[184:187], v[108:111], v[88:91], v[184:187]
  ds_read_b64_tr_b16 v[66:67], v21 offset:16896
  v_mfma_f32_16x16x32_bf16 v[180:183], v[108:111], v[84:87], v[180:183]
  ds_read_b64_tr_b16 v[68:69], v22 offset:16384
  v_mfma_f32_16x16x32_bf16 v[176:179], v[108:111], v[80:83], v[176:179]
  ds_read_b64_tr_b16 v[70:71], v22 offset:16896
  v_mfma_f32_16x16x32_bf16 v[192:195], v[112:115], v[80:83], v[192:195]
  ds_read_b64_tr_b16 v[72:73], v23 offset:0
  v_mfma_f32_16x16x32_bf16 v[196:199], v[112:115], v[84:87], v[196:199]
  ds_read_b64_tr_b16 v[74:75], v23 offset:256
  v_mfma_f32_16x16x32_bf16 v[200:203], v[112:115], v[88:91], v[200:203]
  s_cmp_lg_u32 s79, 0
  s_nop 0
  v_mfma_f32_16x16x32_bf16 v[204:207], v[112:115], v[92:95], v[204:207]
  v_mfma_f32_16x16x32_bf16 v[220:223], v[116:119], v[92:95], v[220:223]
  v_mfma_f32_16x16x32_bf16 v[216:219], v[116:119], v[88:91], v[216:219]
  v_mfma_f32_16x16x32_bf16 v[212:215], v[116:119], v[84:87], v[212:215]
  v_mfma_f32_16x16x32_bf16 v[208:211], v[116:119], v[80:83], v[208:211]
  v_mfma_f32_16x16x32_bf16 v[224:227], v[120:123], v[80:83], v[224:227]
  v_mfma_f32_16x16x32_bf16 v[228:231], v[120:123], v[84:87], v[228:231]
  v_mfma_f32_16x16x32_bf16 v[232:235], v[120:123], v[88:91], v[232:235]
  v_mfma_f32_16x16x32_bf16 v[236:239], v[120:123], v[92:95], v[236:239]
  s_waitcnt lgkmcnt(0)
  s_cbranch_scc1 L_w1_loop
L_w1_lend:
L_w1_exit:
  ds_read2_b32 v[88:89], v14 offset0:0 offset1:160
  ds_read2_b32 v[90:91], v14 offset0:16 offset1:176
  ds_read2_b32 v[92:93], v14 offset0:32 offset1:192
  ds_read2_b32 v[94:95], v14 offset0:48 offset1:208
  ds_read_b128 v[32:35], v15 offset:0
  ds_read_b128 v[60:63], v15 offset:1024
  ds_read_b128 v[36:39], v15 offset:64
  ds_read_b128 v[64:67], v15 offset:1088
  ds_read_b128 v[40:43], v15 offset:256
  ds_read_b128 v[68:71], v15 offset:1280
  ds_read_b128 v[44:47], v15 offset:320
  ds_read_b128 v[72:75], v15 offset:1344
  ds_read_b128 v[48:51], v15 offset:512
  ds_read_b128 v[76:79], v15 offset:1536
  ds_read_b128 v[52:55], v15 offset:576
  ds_read_b128 v[80:83], v15 offset:1600
  ds_read_b128 v[56:59], v16 offset:768
  ds_read_b128 v[84:87], v16 offset:1792
  buffer_load_dwordx2 v[10:11], v19, s[52:55], 0 offen offset:0
  buffer_load_dwordx2 v[24:25], v19, s[52:55], 0 offen offset:32
  buffer_load_dwordx2 v[124:125], v19, s[52:55], 0 offen offset:64
  buffer_load_dwordx2 v[126:127], v19, s[52:55], 0 offen offset:96
  v_mov_b32 v96, 0xc0135761
  v_mov_b32 v97, 0xbdd2d3e8
  v_mov_b32 v98, 1.0
  s_waitcnt lgkmcnt(0)
  v_mul_f32 v88, v88, v89
  v_mul_f32 v90, v90, v91
  v_mul_f32 v92, v92, v93
  v_mul_f32 v94, v94, v95
  v_pk_fma_f32 v[100:101], v[32:33], v[88:89], v[60:61] op_sel:[0,0,0] op_sel_hi:[1,0,1] neg_lo:[0,1,0] neg_hi:[0,1,0]
  v_pk_fma_f32 v[102:103], v[34:35], v[88:89], v[62:63] op_sel:[0,0,0] op_sel_hi:[1,0,1] neg_lo:[0,1,0] neg_hi:[0,1,0]
  v_pk_fma_f32 v[128:129], v[128:129], v[88:89], v[100:101] op_sel:[0,1,0] op_sel_hi:[1,1,1]
  v_pk_fma_f32 v[130:131], v[130:131], v[88:89], v[102:103] op_sel:[0,1,0] op_sel_hi:[1,1,1]
  v_pk_mul_f32 v[100:101], v[128:129], v[128:129]
  v_pk_mul_f32 v[102:103], v[130:131], v[130:131]
  v_pk_fma_f32 v[100:101], v[100:101], v[96:97], v[96:97] op_sel:[0,1,0] op_sel_hi:[1,1,0]
  v_pk_fma_f32 v[102:103], v[102:103], v[96:97], v[96:97] op_sel:[0,1,0] op_sel_hi:[1,1,0]
  v_pk_mul_f32 v[100:101], v[100:101], v[128:129]
  v_pk_mul_f32 v[102:103], v[102:103], v[130:131]
  v_exp_f32 v100, v100
  v_exp_f32 v101, v101
  v_exp_f32 v102, v102
  v_exp_f32 v103, v103
  v_pk_add_f32 v[100:101], v[100:101], v[98:99] op_sel_hi:[1,0]
  v_pk_add_f32 v[102:103], v[102:103], v[98:99] op_sel_hi:[1,0]
  v_rcp_f32 v100, v100
  v_rcp_f32 v101, v101
  v_rcp_f32 v102, v102
  v_rcp_f32 v103, v103
  v_pk_mul_f32 v[128:129], v[128:129], v[100:101]
  v_pk_mul_f32 v[130:131], v[130:131], v[102:103]
  v_cvt_pk_bf16_f32 v108, v128, v129
  v_cvt_pk_bf16_f32 v109, v130, v131
  v_pk_fma_f32 v[104:105], v[36:37], v[88:89], v[64:65] op_sel:[0,0,0] op_sel_hi:[1,0,1] neg_lo:[0,1,0] neg_hi:[0,1,0]
  v_pk_fma_f32 v[106:107], v[38:39], v[88:89], v[66:67] op_sel:[0,0,0] op_sel_hi:[1,0,1] neg_lo:[0,1,0] neg_hi:[0,1,0]
  v_pk_fma_f32 v[144:145], v[144:145], v[88:89], v[104:105] op_sel:[0,1,0] op_sel_hi:[1,1,1]
  v_pk_fma_f32 v[146:147], v[146:147], v[88:89], v[106:107] op_sel:[0,1,0] op_sel_hi:[1,1,1]
  v_pk_mul_f32 v[104:105], v[144:145], v[144:145]
  v_pk_mul_f32 v[106:107], v[146:147], v[146:147]
  v_pk_fma_f32 v[104:105], v[104:105], v[96:97], v[96:97] op_sel:[0,1,0] op_sel_hi:[1,1,0]
  v_pk_fma_f32 v[106:107], v[106:107], v[96:97], v[96:97] op_sel:[0,1,0] op_sel_hi:[1,1,0]
  v_pk_mul_f32 v[104:105], v[104:105], v[144:145]
  v_pk_mul_f32 v[106:107], v[106:107], v[146:147]
  v_exp_f32 v104, v104
  v_exp_f32 v105, v105
  v_exp_f32 v106, v106
  v_exp_f32 v107, v107
  v_pk_add_f32 v[104:105], v[104:105], v[98:99] op_sel_hi:[1,0]
  v_pk_add_f32 v[106:107], v[106:107], v[98:99] op_sel_hi:[1,0]
  v_rcp_f32 v104, v104
  v_rcp_f32 v105, v105
  v_rcp_f32 v106, v106
  v_rcp_f32 v107, v107
  v_pk_mul_f32 v[144:145], v[144:145], v[104:105]
  v_pk_mul_f32 v[146:147], v[146:147], v[106:107]
  v_cvt_pk_bf16_f32 v110, v144, v145
  v_cvt_pk_bf16_f32 v111, v146, v147
  s_mov_b32 s3, 0
  s_nop 0
  v_permlane16_swap_b32 v108, v110
  v_permlane16_swap_b32 v109, v111
  buffer_store_dwordx4 v[108:111], v12, s[44:47], s3 offen sc1
  ds_write_b128 v18, v[108:111] offset:32768
  v_pk_fma_f32 v[100:101], v[32:33], v[90:91], v[60:61] op_sel:[0,0,0] op_sel_hi:[1,0,1] neg_lo:[0,1,0] neg_hi:[0,1,0]
  v_pk_fma_f32 v[102:103], v[34:35], v[90:91], v[62:63] op_sel:[0,0,0] op_sel_hi:[1,0,1] neg_lo:[0,1,0] neg_hi:[0,1,0]
  v_pk_fma_f32 v[132:133], v[132:133], v[90:91], v[100:101] op_sel:[0,1,0] op_sel_hi:[1,1,1]
  v_pk_fma_f32 v[134:135], v[134:135], v[90:91], v[102:103] op_sel:[0,1,0] op_sel_hi:[1,1,1]
  v_pk_mul_f32 v[100:101], v[132:133], v[132:133]
  v_pk_mul_f32 v[102:103], v[134:135], v[134:135]
  v_pk_fma_f32 v[100:101], v[100:101], v[96:97], v[96:97] op_sel:[0,1,0] op_sel_hi:[1,1,0]
  v_pk_fma_f32 v[102:103], v[102:103], v[96:97], v[96:97] op_sel:[0,1,0] op_sel_hi:[1,1,0]
  v_pk_mul_f32 v[100:101], v[100:101], v[132:133]
  v_pk_mul_f32 v[102:103], v[102:103], v[134:135]
  v_exp_f32 v100, v100
  v_exp_f32 v101, v101
  v_exp_f32 v102, v102
  v_exp_f32 v103, v103
  v_pk_add_f32 v[100:101], v[100:101], v[98:99] op_sel_hi:[1,0]
  v_pk_add_f32 v[102:103], v[102:103], v[98:99] op_sel_hi:[1,0]
  v_rcp_f32 v100, v100
  v_rcp_f32 v101, v101
  v_rcp_f32 v102, v102
  v_rcp_f32 v103, v103
  v_pk_mul_f32 v[132:133], v[132:133], v[100:101]
  v_pk_mul_f32 v[134:135], v[134:135], v[102:103]
  v_cvt_pk_bf16_f32 v112, v132, v133
  v_cvt_pk_bf16_f32 v113, v134, v135
  v_pk_fma_f32 v[104:105], v[36:37], v[90:91], v[64:65] op_sel:[0,0,0] op_sel_hi:[1,0,1] neg_lo:[0,1,0] neg_hi:[0,1,0]
  v_pk_fma_f32 v[106:107], v[38:39], v[90:91], v[66:67] op_sel:[0,0,0] op_sel_hi:[1,0,1] neg_lo:[0,1,0] neg_hi:[0,1,0]
  v_pk_fma_f32 v[148:149], v[148:149], v[90:91], v[104:105] op_sel:[0,1,0] op_sel_hi:[1,1,1]
  v_pk_fma_f32 v[150:151], v[150:151], v[90:91], v[106:107] op_sel:[0,1,0] op_sel_hi:[1,1,1]
  v_pk_mul_f32 v[104:105], v[148:149], v[148:149]
  v_pk_mul_f32 v[106:107], v[150:151], v[150:151]
  v_pk_fma_f32 v[104:105], v[104:105], v[96:97], v[96:97] op_sel:[0,1,0] op_sel_hi:[1,1,0]
  v_pk_fma_f32 v[106:107], v[106:107], v[96:97], v[96:97] op_sel:[0,1,0] op_sel_hi:[1,1,0]
  v_pk_mul_f32 v[104:105], v[104:105], v[148:149]
  v_pk_mul_f32 v[106:107], v[106:107], v[150:151]
  v_exp_f32 v104, v104
  v_exp_f32 v105, v105
  v_exp_f32 v106, v106
  v_exp_f32 v107, v107
  v_pk_add_f32 v[104:105], v[104:105], v[98:99] op_sel_hi:[1,0]
  v_pk_add_f32 v[106:107], v[106:107], v[98:99] op_sel_hi:[1,0]
  v_rcp_f32 v104, v104
  v_rcp_f32 v105, v105
  v_rcp_f32 v106, v106
  v_rcp_f32 v107, v107
  v_pk_mul_f32 v[148:149], v[148:149], v[104:105]
  v_pk_mul_f32 v[150:151], v[150:151], v[106:107]
  v_cvt_pk_bf16_f32 v114, v148, v149
  v_cvt_pk_bf16_f32 v115, v150, v151
  s_mov_b32 s3, 114688
  s_nop 0
  v_permlane16_swap_b32 v112, v114
  v_permlane16_swap_b32 v113, v115
  buffer_store_dwordx4 v[112:115], v12, s[44:47], s3 offen sc1
  ds_write_b128 v18, v[112:115] offset:34816
  v_pk_fma_f32 v[100:101], v[32:33], v[92:93], v[60:61] op_sel:[0,0,0] op_sel_hi:[1,0,1] neg_lo:[0,1,0] neg_hi:[0,1,0]
  v_pk_fma_f32 v[102:103], v[34:35], v[92:93], v[62:63] op_sel:[0,0,0] op_sel_hi:[1,0,1] neg_lo:[0,1,0] neg_hi:[0,1,0]
  v_pk_fma_f32 v[136:137], v[136:137], v[92:93], v[100:101] op_sel:[0,1,0] op_sel_hi:[1,1,1]
  v_pk_fma_f32 v[138:139], v[138:139], v[92:93], v[102:103] op_sel:[0,1,0] op_sel_hi:[1,1,1]
  v_pk_mul_f32 v[100:101], v[136:137], v[136:137]
  v_pk_mul_f32 v[102:103], v[138:139], v[138:139]
  v_pk_fma_f32 v[100:101], v[100:101], v[96:97], v[96:97] op_sel:[0,1,0] op_sel_hi:[1,1,0]
  v_pk_fma_f32 v[102:103], v[102:103], v[96:97], v[96:97] op_sel:[0,1,0] op_sel_hi:[1,1,0]
  v_pk_mul_f32 v[100:101], v[100:101], v[136:137]
  v_pk_mul_f32 v[102:103], v[102:103], v[138:139]
  v_exp_f32 v100, v100
  v_exp_f32 v101, v101
  v_exp_f32 v102, v102
  v_exp_f32 v103, v103
  v_pk_add_f32 v[100:101], v[100:101], v[98:99] op_sel_hi:[1,0]
  v_pk_add_f32 v[102:103], v[102:103], v[98:99] op_sel_hi:[1,0]
  v_rcp_f32 v100, v100
  v_rcp_f32 v101, v101
  v_rcp_f32 v102, v102
  v_rcp_f32 v103, v103
  v_pk_mul_f32 v[136:137], v[136:137], v[100:101]
  v_pk_mul_f32 v[138:139], v[138:139], v[102:103]
  v_cvt_pk_bf16_f32 v116, v136, v137
  v_cvt_pk_bf16_f32 v117, v138, v139
  v_pk_fma_f32 v[104:105], v[36:37], v[92:93], v[64:65] op_sel:[0,0,0] op_sel_hi:[1,0,1] neg_lo:[0,1,0] neg_hi:[0,1,0]
  v_pk_fma_f32 v[106:107], v[38:39], v[92:93], v[66:67] op_sel:[0,0,0] op_sel_hi:[1,0,1] neg_lo:[0,1,0] neg_hi:[0,1,0]
  v_pk_fma_f32 v[152:153], v[152:153], v[92:93], v[104:105] op_sel:[0,1,0] op_sel_hi:[1,1,1]
  v_pk_fma_f32 v[154:155], v[154:155], v[92:93], v[106:107] op_sel:[0,1,0] op_sel_hi:[1,1,1]
  v_pk_mul_f32 v[104:105], v[152:153], v[152:153]
  v_pk_mul_f32 v[106:107], v[154:155], v[154:155]
  v_pk_fma_f32 v[104:105], v[104:105], v[96:97], v[96:97] op_sel:[0,1,0] op_sel_hi:[1,1,0]
  v_pk_fma_f32 v[106:107], v[106:107], v[96:97], v[96:97] op_sel:[0,1,0] op_sel_hi:[1,1,0]
  v_pk_mul_f32 v[104:105], v[104:105], v[152:153]
  v_pk_mul_f32 v[106:107], v[106:107], v[154:155]
  v_exp_f32 v104, v104
  v_exp_f32 v105, v105
  v_exp_f32 v106, v106
  v_exp_f32 v107, v107
  v_pk_add_f32 v[104:105], v[104:105], v[98:99] op_sel_hi:[1,0]
  v_pk_add_f32 v[106:107], v[106:107], v[98:99] op_sel_hi:[1,0]
  v_rcp_f32 v104, v104
  v_rcp_f32 v105, v105
  v_rcp_f32 v106, v106
  v_rcp_f32 v107, v107
  v_pk_mul_f32 v[152:153], v[152:153], v[104:105]
  v_pk_mul_f32 v[154:155], v[154:155], v[106:107]
  v_cvt_pk_bf16_f32 v118, v152, v153
  v_cvt_pk_bf16_f32 v119, v154, v155
  s_mov_b32 s3, 229376
  s_nop 0
  v_permlane16_swap_b32 v116, v118
  v_permlane16_swap_b32 v117, v119
  buffer_store_dwordx4 v[116:119], v12, s[44:47], s3 offen sc1
  ds_write_b128 v18, v[116:119] offset:36864
  v_pk_fma_f32 v[100:101], v[32:33], v[94:95], v[60:61] op_sel:[0,0,0] op_sel_hi:[1,0,1] neg_lo:[0,1,0] neg_hi:[0,1,0]
  v_pk_fma_f32 v[102:103], v[34:35], v[94:95], v[62:63] op_sel:[0,0,0] op_sel_hi:[1,0,1] neg_lo:[0,1,0] neg_hi:[0,1,0]
  v_pk_fma_f32 v[140:141], v[140:141], v[94:95], v[100:101] op_sel:[0,1,0] op_sel_hi:[1,1,1]
  v_pk_fma_f32 v[142:143], v[142:143], v[94:95], v[102:103] op_sel:[0,1,0] op_sel_hi:[1,1,1]
  v_pk_mul_f32 v[100:101], v[140:141], v[140:141]
  v_pk_mul_f32 v[102:103], v[142:143], v[142:143]
  v_pk_fma_f32 v[100:101], v[100:101], v[96:97], v[96:97] op_sel:[0,1,0] op_sel_hi:[1,1,0]
  v_pk_fma_f32 v[102:103], v[102:103], v[96:97], v[96:97] op_sel:[0,1,0] op_sel_hi:[1,1,0]
  v_pk_mul_f32 v[100:101], v[100:101], v[140:141]
  v_pk_mul_f32 v[102:103], v[102:103], v[142:143]
  v_exp_f32 v100, v100
  v_exp_f32 v101, v101
  v_exp_f32 v102, v102
  v_exp_f32 v103, v103
  v_pk_add_f32 v[100:101], v[100:101], v[98:99] op_sel_hi:[1,0]
  v_pk_add_f32 v[102:103], v[102:103], v[98:99] op_sel_hi:[1,0]
  v_rcp_f32 v100, v100
  v_rcp_f32 v101, v101
  v_rcp_f32 v102, v102
  v_rcp_f32 v103, v103
  v_pk_mul_f32 v[140:141], v[140:141], v[100:101]
  v_pk_mul_f32 v[142:143], v[142:143], v[102:103]
  v_cvt_pk_bf16_f32 v120, v140, v141
  v_cvt_pk_bf16_f32 v121, v142, v143
  v_pk_fma_f32 v[104:105], v[36:37], v[94:95], v[64:65] op_sel:[0,0,0] op_sel_hi:[1,0,1] neg_lo:[0,1,0] neg_hi:[0,1,0]
  v_pk_fma_f32 v[106:107], v[38:39], v[94:95], v[66:67] op_sel:[0,0,0] op_sel_hi:[1,0,1] neg_lo:[0,1,0] neg_hi:[0,1,0]
  v_pk_fma_f32 v[156:157], v[156:157], v[94:95], v[104:105] op_sel:[0,1,0] op_sel_hi:[1,1,1]
  v_pk_fma_f32 v[158:159], v[158:159], v[94:95], v[106:107] op_sel:[0,1,0] op_sel_hi:[1,1,1]
  v_pk_mul_f32 v[104:105], v[156:157], v[156:157]
  v_pk_mul_f32 v[106:107], v[158:159], v[158:159]
  v_pk_fma_f32 v[104:105], v[104:105], v[96:97], v[96:97] op_sel:[0,1,0] op_sel_hi:[1,1,0]
  v_pk_fma_f32 v[106:107], v[106:107], v[96:97], v[96:97] op_sel:[0,1,0] op_sel_hi:[1,1,0]
  v_pk_mul_f32 v[104:105], v[104:105], v[156:157]
  v_pk_mul_f32 v[106:107], v[106:107], v[158:159]
  v_exp_f32 v104, v104
  v_exp_f32 v105, v105
  v_exp_f32 v106, v106
  v_exp_f32 v107, v107
  v_pk_add_f32 v[104:105], v[104:105], v[98:99] op_sel_hi:[1,0]
  v_pk_add_f32 v[106:107], v[106:107], v[98:99] op_sel_hi:[1,0]
  v_rcp_f32 v104, v104
  v_rcp_f32 v105, v105
  v_rcp_f32 v106, v106
  v_rcp_f32 v107, v107
  v_pk_mul_f32 v[156:157], v[156:157], v[104:105]
  v_pk_mul_f32 v[158:159], v[158:159], v[106:107]
  v_cvt_pk_bf16_f32 v122, v156, v157
  v_cvt_pk_bf16_f32 v123, v158, v159
  s_mov_b32 s3, 344064
  s_nop 0
  v_permlane16_swap_b32 v120, v122
  v_permlane16_swap_b32 v121, v123
  buffer_store_dwordx4 v[120:123], v12, s[44:47], s3 offen sc1
  ds_write_b128 v18, v[120:123] offset:38912
  v_pk_fma_f32 v[100:101], v[56:57], v[88:89], v[84:85] op_sel:[0,0,0] op_sel_hi:[1,0,1] neg_lo:[0,1,0] neg_hi:[0,1,0]
  v_pk_fma_f32 v[102:103], v[58:59], v[88:89], v[86:87] op_sel:[0,0,0] op_sel_hi:[1,0,1] neg_lo:[0,1,0] neg_hi:[0,1,0]
  v_pk_fma_f32 v[224:225], v[224:225], v[88:89], v[100:101] op_sel:[0,1,0] op_sel_hi:[1,1,1]
  v_pk_fma_f32 v[226:227], v[226:227], v[88:89], v[102:103] op_sel:[0,1,0] op_sel_hi:[1,1,1]
  v_pk_mul_f32 v[100:101], v[224:225], v[224:225]
  v_pk_mul_f32 v[102:103], v[226:227], v[226:227]
  v_pk_fma_f32 v[100:101], v[100:101], v[96:97], v[96:97] op_sel:[0,1,0] op_sel_hi:[1,1,0]
  v_pk_fma_f32 v[102:103], v[102:103], v[96:97], v[96:97] op_sel:[0,1,0] op_sel_hi:[1,1,0]
  v_pk_mul_f32 v[100:101], v[100:101], v[224:225]
  v_pk_mul_f32 v[102:103], v[102:103], v[226:227]
  v_exp_f32 v100, v100
  v_exp_f32 v101, v101
  v_exp_f32 v102, v102
  v_exp_f32 v103, v103
  v_pk_add_f32 v[100:101], v[100:101], v[98:99] op_sel_hi:[1,0]
  v_pk_add_f32 v[102:103], v[102:103], v[98:99] op_sel_hi:[1,0]
  v_rcp_f32 v100, v100
  v_rcp_f32 v101, v101
  v_rcp_f32 v102, v102
  v_rcp_f32 v103, v103
  v_pk_mul_f32 v[224:225], v[224:225], v[100:101]
  v_pk_mul_f32 v[226:227], v[226:227], v[102:103]
  v_cvt_pk_bf16_f32 v108, v224, v225
  v_cvt_pk_bf16_f32 v109, v226, v227
  v_pk_fma_f32 v[100:101], v[56:57], v[90:91], v[84:85] op_sel:[0,0,0] op_sel_hi:[1,0,1] neg_lo:[0,1,0] neg_hi:[0,1,0]
  v_pk_fma_f32 v[102:103], v[58:59], v[90:91], v[86:87] op_sel:[0,0,0] op_sel_hi:[1,0,1] neg_lo:[0,1,0] neg_hi:[0,1,0]
  v_pk_fma_f32 v[228:229], v[228:229], v[90:91], v[100:101] op_sel:[0,1,0] op_sel_hi:[1,1,1]
  v_pk_fma_f32 v[230:231], v[230:231], v[90:91], v[102:103] op_sel:[0,1,0] op_sel_hi:[1,1,1]
  v_pk_mul_f32 v[100:101], v[228:229], v[228:229]
  v_pk_mul_f32 v[102:103], v[230:231], v[230:231]
  v_pk_fma_f32 v[100:101], v[100:101], v[96:97], v[96:97] op_sel:[0,1,0] op_sel_hi:[1,1,0]
  v_pk_fma_f32 v[102:103], v[102:103], v[96:97], v[96:97] op_sel:[0,1,0] op_sel_hi:[1,1,0]
  v_pk_mul_f32 v[100:101], v[100:101], v[228:229]
  v_pk_mul_f32 v[102:103], v[102:103], v[230:231]
  v_exp_f32 v100, v100
  v_exp_f32 v101, v101
  v_exp_f32 v102, v102
  v_exp_f32 v103, v103
  v_pk_add_f32 v[100:101], v[100:101], v[98:99] op_sel_hi:[1,0]
  v_pk_add_f32 v[102:103], v[102:103], v[98:99] op_sel_hi:[1,0]
  v_rcp_f32 v100, v100
  v_rcp_f32 v101, v101
  v_rcp_f32 v102, v102
  v_rcp_f32 v103, v103
  v_pk_mul_f32 v[228:229], v[228:229], v[100:101]
  v_pk_mul_f32 v[230:231], v[230:231], v[102:103]
  v_cvt_pk_bf16_f32 v110, v228, v229
  v_cvt_pk_bf16_f32 v111, v230, v231
  s_mov_b32 s3, 32768
  s_nop 0
  v_permlane16_swap_b32 v108, v110
  v_permlane16_swap_b32 v109, v111
  buffer_store_dwordx4 v[108:111], v13, s[44:47], s3 offen sc1
  v_pk_fma_f32 v[100:101], v[56:57], v[92:93], v[84:85] op_sel:[0,0,0] op_sel_hi:[1,0,1] neg_lo:[0,1,0] neg_hi:[0,1,0]
  v_pk_fma_f32 v[102:103], v[58:59], v[92:93], v[86:87] op_sel:[0,0,0] op_sel_hi:[1,0,1] neg_lo:[0,1,0] neg_hi:[0,1,0]
  v_pk_fma_f32 v[232:233], v[232:233], v[92:93], v[100:101] op_sel:[0,1,0] op_sel_hi:[1,1,1]
  v_pk_fma_f32 v[234:235], v[234:235], v[92:93], v[102:103] op_sel:[0,1,0] op_sel_hi:[1,1,1]
  v_pk_mul_f32 v[100:101], v[232:233], v[232:233]
  v_pk_mul_f32 v[102:103], v[234:235], v[234:235]
  v_pk_fma_f32 v[100:101], v[100:101], v[96:97], v[96:97] op_sel:[0,1,0] op_sel_hi:[1,1,0]
  v_pk_fma_f32 v[102:103], v[102:103], v[96:97], v[96:97] op_sel:[0,1,0] op_sel_hi:[1,1,0]
  v_pk_mul_f32 v[100:101], v[100:101], v[232:233]
  v_pk_mul_f32 v[102:103], v[102:103], v[234:235]
  v_exp_f32 v100, v100
  v_exp_f32 v101, v101
  v_exp_f32 v102, v102
  v_exp_f32 v103, v103
  v_pk_add_f32 v[100:101], v[100:101], v[98:99] op_sel_hi:[1,0]
  v_pk_add_f32 v[102:103], v[102:103], v[98:99] op_sel_hi:[1,0]
  v_rcp_f32 v100, v100
  v_rcp_f32 v101, v101
  v_rcp_f32 v102, v102
  v_rcp_f32 v103, v103
  v_pk_mul_f32 v[232:233], v[232:233], v[100:101]
  v_pk_mul_f32 v[234:235], v[234:235], v[102:103]
  v_cvt_pk_bf16_f32 v112, v232, v233
  v_cvt_pk_bf16_f32 v113, v234, v235
  v_pk_fma_f32 v[100:101], v[56:57], v[94:95], v[84:85] op_sel:[0,0,0] op_sel_hi:[1,0,1] neg_lo:[0,1,0] neg_hi:[0,1,0]
  v_pk_fma_f32 v[102:103], v[58:59], v[94:95], v[86:87] op_sel:[0,0,0] op_sel_hi:[1,0,1] neg_lo:[0,1,0] neg_hi:[0,1,0]
  v_pk_fma_f32 v[236:237], v[236:237], v[94:95], v[100:101] op_sel:[0,1,0] op_sel_hi:[1,1,1]
  v_pk_fma_f32 v[238:239], v[238:239], v[94:95], v[102:103] op_sel:[0,1,0] op_sel_hi:[1,1,1]
  v_pk_mul_f32 v[100:101], v[236:237], v[236:237]
  v_pk_mul_f32 v[102:103], v[238:239], v[238:239]
  v_pk_fma_f32 v[100:101], v[100:101], v[96:97], v[96:97] op_sel:[0,1,0] op_sel_hi:[1,1,0]
  v_pk_fma_f32 v[102:103], v[102:103], v[96:97], v[96:97] op_sel:[0,1,0] op_sel_hi:[1,1,0]
  v_pk_mul_f32 v[100:101], v[100:101], v[236:237]
  v_pk_mul_f32 v[102:103], v[102:103], v[238:239]
  v_exp_f32 v100, v100
  v_exp_f32 v101, v101
  v_exp_f32 v102, v102
  v_exp_f32 v103, v103
  v_pk_add_f32 v[100:101], v[100:101], v[98:99] op_sel_hi:[1,0]
  v_pk_add_f32 v[102:103], v[102:103], v[98:99] op_sel_hi:[1,0]
  v_rcp_f32 v100, v100
  v_rcp_f32 v101, v101
  v_rcp_f32 v102, v102
  v_rcp_f32 v103, v103
  v_pk_mul_f32 v[236:237], v[236:237], v[100:101]
  v_pk_mul_f32 v[238:239], v[238:239], v[102:103]
  v_cvt_pk_bf16_f32 v114, v236, v237
  v_cvt_pk_bf16_f32 v115, v238, v239
  s_mov_b32 s3, 262144
  s_nop 0
  v_permlane16_swap_b32 v112, v114
  v_permlane16_swap_b32 v113, v115
  buffer_store_dwordx4 v[112:115], v13, s[44:47], s3 offen sc1
  v_pk_fma_f32 v[100:101], v[40:41], v[88:89], v[68:69] op_sel:[0,0,0] op_sel_hi:[1,0,1] neg_lo:[0,1,0] neg_hi:[0,1,0]
  v_pk_fma_f32 v[102:103], v[42:43], v[88:89], v[70:71] op_sel:[0,0,0] op_sel_hi:[1,0,1] neg_lo:[0,1,0] neg_hi:[0,1,0]
  v_pk_fma_f32 v[160:161], v[160:161], v[88:89], v[100:101] op_sel:[0,1,0] op_sel_hi:[1,1,1]
  v_pk_fma_f32 v[162:163], v[162:163], v[88:89], v[102:103] op_sel:[0,1,0] op_sel_hi:[1,1,1]
  v_pk_mul_f32 v[100:101], v[160:161], v[160:161]
  v_pk_mul_f32 v[102:103], v[162:163], v[162:163]
  v_pk_fma_f32 v[100:101], v[100:101], v[96:97], v[96:97] op_sel:[0,1,0] op_sel_hi:[1,1,0]
  v_pk_fma_f32 v[102:103], v[102:103], v[96:97], v[96:97] op_sel:[0,1,0] op_sel_hi:[1,1,0]
  v_pk_mul_f32 v[100:101], v[100:101], v[160:161]
  v_pk_mul_f32 v[102:103], v[102:103], v[162:163]
  v_exp_f32 v100, v100
  v_exp_f32 v101, v101
  v_exp_f32 v102, v102
  v_exp_f32 v103, v103
  v_pk_add_f32 v[100:101], v[100:101], v[98:99] op_sel_hi:[1,0]
  v_pk_add_f32 v[102:103], v[102:103], v[98:99] op_sel_hi:[1,0]
  v_rcp_f32 v100, v100
  v_rcp_f32 v101, v101
  v_rcp_f32 v102, v102
  v_rcp_f32 v103, v103
  v_pk_mul_f32 v[160:161], v[160:161], v[100:101]
  v_pk_mul_f32 v[162:163], v[162:163], v[102:103]
  v_cvt_pk_bf16_f32 v116, v160, v161
  v_cvt_pk_bf16_f32 v117, v162, v163
  v_pk_fma_f32 v[104:105], v[44:45], v[88:89], v[72:73] op_sel:[0,0,0] op_sel_hi:[1,0,1] neg_lo:[0,1,0] neg_hi:[0,1,0]
  v_pk_fma_f32 v[106:107], v[46:47], v[88:89], v[74:75] op_sel:[0,0,0] op_sel_hi:[1,0,1] neg_lo:[0,1,0] neg_hi:[0,1,0]
  v_pk_fma_f32 v[176:177], v[176:177], v[88:89], v[104:105] op_sel:[0,1,0] op_sel_hi:[1,1,1]
  v_pk_fma_f32 v[178:179], v[178:179], v[88:89], v[106:107] op_sel:[0,1,0] op_sel_hi:[1,1,1]
  v_pk_mul_f32 v[104:105], v[176:177], v[176:177]
  v_pk_mul_f32 v[106:107], v[178:179], v[178:179]
  v_pk_fma_f32 v[104:105], v[104:105], v[96:97], v[96:97] op_sel:[0,1,0] op_sel_hi:[1,1,0]
  v_pk_fma_f32 v[106:107], v[106:107], v[96:97], v[96:97] op_sel:[0,1,0] op_sel_hi:[1,1,0]
  v_pk_mul_f32 v[104:105], v[104:105], v[176:177]
  v_pk_mul_f32 v[106:107], v[106:107], v[178:179]
  v_exp_f32 v104, v104
  v_exp_f32 v105, v105
  v_exp_f32 v106, v106
  v_exp_f32 v107, v107
  v_pk_add_f32 v[104:105], v[104:105], v[98:99] op_sel_hi:[1,0]
  v_pk_add_f32 v[106:107], v[106:107], v[98:99] op_sel_hi:[1,0]
  v_rcp_f32 v104, v104
  v_rcp_f32 v105, v105
  v_rcp_f32 v106, v106
  v_rcp_f32 v107, v107
  v_pk_mul_f32 v[176:177], v[176:177], v[104:105]
  v_pk_mul_f32 v[178:179], v[178:179], v[106:107]
  v_cvt_pk_bf16_f32 v118, v176, v177
  v_cvt_pk_bf16_f32 v119, v178, v179
  s_add_u32 s3, s10, 49152
  s_nop 0
  v_permlane16_swap_b32 v116, v118
  v_permlane16_swap_b32 v117, v119
  buffer_store_dwordx4 v[116:119], v12, s[44:47], s3 offen sc1
  ds_write_b128 v18, v[116:119] offset:0
  v_pk_fma_f32 v[100:101], v[48:49], v[88:89], v[76:77] op_sel:[0,0,0] op_sel_hi:[1,0,1] neg_lo:[0,1,0] neg_hi:[0,1,0]
  v_pk_fma_f32 v[102:103], v[50:51], v[88:89], v[78:79] op_sel:[0,0,0] op_sel_hi:[1,0,1] neg_lo:[0,1,0] neg_hi:[0,1,0]
  v_pk_fma_f32 v[192:193], v[192:193], v[88:89], v[100:101] op_sel:[0,1,0] op_sel_hi:[1,1,1]
  v_pk_fma_f32 v[194:195], v[194:195], v[88:89], v[102:103] op_sel:[0,1,0] op_sel_hi:[1,1,1]
  v_pk_mul_f32 v[100:101], v[192:193], v[192:193]
  v_pk_mul_f32 v[102:103], v[194:195], v[194:195]
  v_pk_fma_f32 v[100:101], v[100:101], v[96:97], v[96:97] op_sel:[0,1,0] op_sel_hi:[1,1,0]
  v_pk_fma_f32 v[102:103], v[102:103], v[96:97], v[96:97] op_sel:[0,1,0] op_sel_hi:[1,1,0]
  v_pk_mul_f32 v[100:101], v[100:101], v[192:193]
  v_pk_mul_f32 v[102:103], v[102:103], v[194:195]
  v_exp_f32 v100, v100
  v_exp_f32 v101, v101
  v_exp_f32 v102, v102
  v_exp_f32 v103, v103
  v_pk_add_f32 v[100:101], v[100:101], v[98:99] op_sel_hi:[1,0]
  v_pk_add_f32 v[102:103], v[102:103], v[98:99] op_sel_hi:[1,0]
  v_rcp_f32 v100, v100
  v_rcp_f32 v101, v101
  v_rcp_f32 v102, v102
  v_rcp_f32 v103, v103
  v_pk_mul_f32 v[192:193], v[192:193], v[100:101]
  v_pk_mul_f32 v[194:195], v[194:195], v[102:103]
  v_cvt_pk_bf16_f32 v120, v192, v193
  v_cvt_pk_bf16_f32 v121, v194, v195
  v_pk_fma_f32 v[104:105], v[52:53], v[88:89], v[80:81] op_sel:[0,0,0] op_sel_hi:[1,0,1] neg_lo:[0,1,0] neg_hi:[0,1,0]
  v_pk_fma_f32 v[106:107], v[54:55], v[88:89], v[82:83] op_sel:[0,0,0] op_sel_hi:[1,0,1] neg_lo:[0,1,0] neg_hi:[0,1,0]
  v_pk_fma_f32 v[208:209], v[208:209], v[88:89], v[104:105] op_sel:[0,1,0] op_sel_hi:[1,1,1]
  v_pk_fma_f32 v[210:211], v[210:211], v[88:89], v[106:107] op_sel:[0,1,0] op_sel_hi:[1,1,1]
  v_pk_mul_f32 v[104:105], v[208:209], v[208:209]
  v_pk_mul_f32 v[106:107], v[210:211], v[210:211]
  v_pk_fma_f32 v[104:105], v[104:105], v[96:97], v[96:97] op_sel:[0,1,0] op_sel_hi:[1,1,0]
  v_pk_fma_f32 v[106:107], v[106:107], v[96:97], v[96:97] op_sel:[0,1,0] op_sel_hi:[1,1,0]
  v_pk_mul_f32 v[104:105], v[104:105], v[208:209]
  v_pk_mul_f32 v[106:107], v[106:107], v[210:211]
  v_exp_f32 v104, v104
  v_exp_f32 v105, v105
  v_exp_f32 v106, v106
  v_exp_f32 v107, v107
  v_pk_add_f32 v[104:105], v[104:105], v[98:99] op_sel_hi:[1,0]
  v_pk_add_f32 v[106:107], v[106:107], v[98:99] op_sel_hi:[1,0]
  v_rcp_f32 v104, v104
  v_rcp_f32 v105, v105
  v_rcp_f32 v106, v106
  v_rcp_f32 v107, v107
  v_pk_mul_f32 v[208:209], v[208:209], v[104:105]
  v_pk_mul_f32 v[210:211], v[210:211], v[106:107]
  v_cvt_pk_bf16_f32 v122, v208, v209
  v_cvt_pk_bf16_f32 v123, v210, v211
  s_add_u32 s3, s10, 51200
  s_nop 0
  v_permlane16_swap_b32 v120, v122
  v_permlane16_swap_b32 v121, v123
  buffer_store_dwordx4 v[120:123], v12, s[44:47], s3 offen sc1
  ds_write_b128 v18, v[120:123] offset:16384
  v_pk_fma_f32 v[100:101], v[40:41], v[90:91], v[68:69] op_sel:[0,0,0] op_sel_hi:[1,0,1] neg_lo:[0,1,0] neg_hi:[0,1,0]
  v_pk_fma_f32 v[102:103], v[42:43], v[90:91], v[70:71] op_sel:[0,0,0] op_sel_hi:[1,0,1] neg_lo:[0,1,0] neg_hi:[0,1,0]
  v_pk_fma_f32 v[164:165], v[164:165], v[90:91], v[100:101] op_sel:[0,1,0] op_sel_hi:[1,1,1]
  v_pk_fma_f32 v[166:167], v[166:167], v[90:91], v[102:103] op_sel:[0,1,0] op_sel_hi:[1,1,1]
  v_pk_mul_f32 v[100:101], v[164:165], v[164:165]
  v_pk_mul_f32 v[102:103], v[166:167], v[166:167]
  v_pk_fma_f32 v[100:101], v[100:101], v[96:97], v[96:97] op_sel:[0,1,0] op_sel_hi:[1,1,0]
  v_pk_fma_f32 v[102:103], v[102:103], v[96:97], v[96:97] op_sel:[0,1,0] op_sel_hi:[1,1,0]
  v_pk_mul_f32 v[100:101], v[100:101], v[164:165]
  v_pk_mul_f32 v[102:103], v[102:103], v[166:167]
  v_exp_f32 v100, v100
  v_exp_f32 v101, v101
  v_exp_f32 v102, v102
  v_exp_f32 v103, v103
  v_pk_add_f32 v[100:101], v[100:101], v[98:99] op_sel_hi:[1,0]
  v_pk_add_f32 v[102:103], v[102:103], v[98:99] op_sel_hi:[1,0]
  v_rcp_f32 v100, v100
  v_rcp_f32 v101, v101
  v_rcp_f32 v102, v102
  v_rcp_f32 v103, v103
  v_pk_mul_f32 v[164:165], v[164:165], v[100:101]
  v_pk_mul_f32 v[166:167], v[166:167], v[102:103]
  v_cvt_pk_bf16_f32 v108, v164, v165
  v_cvt_pk_bf16_f32 v109, v166, v167
  v_pk_fma_f32 v[104:105], v[44:45], v[90:91], v[72:73] op_sel:[0,0,0] op_sel_hi:[1,0,1] neg_lo:[0,1,0] neg_hi:[0,1,0]
  v_pk_fma_f32 v[106:107], v[46:47], v[90:91], v[74:75] op_sel:[0,0,0] op_sel_hi:[1,0,1] neg_lo:[0,1,0] neg_hi:[0,1,0]
  v_pk_fma_f32 v[180:181], v[180:181], v[90:91], v[104:105] op_sel:[0,1,0] op_sel_hi:[1,1,1]
  v_pk_fma_f32 v[182:183], v[182:183], v[90:91], v[106:107] op_sel:[0,1,0] op_sel_hi:[1,1,1]
  v_pk_mul_f32 v[104:105], v[180:181], v[180:181]
  v_pk_mul_f32 v[106:107], v[182:183], v[182:183]
  v_pk_fma_f32 v[104:105], v[104:105], v[96:97], v[96:97] op_sel:[0,1,0] op_sel_hi:[1,1,0]
  v_pk_fma_f32 v[106:107], v[106:107], v[96:97], v[96:97] op_sel:[0,1,0] op_sel_hi:[1,1,0]
  v_pk_mul_f32 v[104:105], v[104:105], v[180:181]
  v_pk_mul_f32 v[106:107], v[106:107], v[182:183]
  v_exp_f32 v104, v104
  v_exp_f32 v105, v105
  v_exp_f32 v106, v106
  v_exp_f32 v107, v107
  v_pk_add_f32 v[104:105], v[104:105], v[98:99] op_sel_hi:[1,0]
  v_pk_add_f32 v[106:107], v[106:107], v[98:99] op_sel_hi:[1,0]
  v_rcp_f32 v104, v104
  v_rcp_f32 v105, v105
  v_rcp_f32 v106, v106
  v_rcp_f32 v107, v107
  v_pk_mul_f32 v[180:181], v[180:181], v[104:105]
  v_pk_mul_f32 v[182:183], v[182:183], v[106:107]
  v_cvt_pk_bf16_f32 v110, v180, v181
  v_cvt_pk_bf16_f32 v111, v182, v183
  s_add_u32 s3, s10, 163840
  s_nop 0
  v_permlane16_swap_b32 v108, v110
  v_permlane16_swap_b32 v109, v111
  buffer_store_dwordx4 v[108:111], v12, s[44:47], s3 offen sc1
  ds_write_b128 v18, v[108:111] offset:2048
  v_pk_fma_f32 v[100:101], v[48:49], v[90:91], v[76:77] op_sel:[0,0,0] op_sel_hi:[1,0,1] neg_lo:[0,1,0] neg_hi:[0,1,0]
  v_pk_fma_f32 v[102:103], v[50:51], v[90:91], v[78:79] op_sel:[0,0,0] op_sel_hi:[1,0,1] neg_lo:[0,1,0] neg_hi:[0,1,0]
  v_pk_fma_f32 v[196:197], v[196:197], v[90:91], v[100:101] op_sel:[0,1,0] op_sel_hi:[1,1,1]
  v_pk_fma_f32 v[198:199], v[198:199], v[90:91], v[102:103] op_sel:[0,1,0] op_sel_hi:[1,1,1]
  v_pk_mul_f32 v[100:101], v[196:197], v[196:197]
  v_pk_mul_f32 v[102:103], v[198:199], v[198:199]
  v_pk_fma_f32 v[100:101], v[100:101], v[96:97], v[96:97] op_sel:[0,1,0] op_sel_hi:[1,1,0]
  v_pk_fma_f32 v[102:103], v[102:103], v[96:97], v[96:97] op_sel:[0,1,0] op_sel_hi:[1,1,0]
  v_pk_mul_f32 v[100:101], v[100:101], v[196:197]
  v_pk_mul_f32 v[102:103], v[102:103], v[198:199]
  v_exp_f32 v100, v100
  v_exp_f32 v101, v101
  v_exp_f32 v102, v102
  v_exp_f32 v103, v103
  v_pk_add_f32 v[100:101], v[100:101], v[98:99] op_sel_hi:[1,0]
  v_pk_add_f32 v[102:103], v[102:103], v[98:99] op_sel_hi:[1,0]
  v_rcp_f32 v100, v100
  v_rcp_f32 v101, v101
  v_rcp_f32 v102, v102
  v_rcp_f32 v103, v103
  v_pk_mul_f32 v[196:197], v[196:197], v[100:101]
  v_pk_mul_f32 v[198:199], v[198:199], v[102:103]
  v_cvt_pk_bf16_f32 v112, v196, v197
  v_cvt_pk_bf16_f32 v113, v198, v199
  v_pk_fma_f32 v[104:105], v[52:53], v[90:91], v[80:81] op_sel:[0,0,0] op_sel_hi:[1,0,1] neg_lo:[0,1,0] neg_hi:[0,1,0]
  v_pk_fma_f32 v[106:107], v[54:55], v[90:91], v[82:83] op_sel:[0,0,0] op_sel_hi:[1,0,1] neg_lo:[0,1,0] neg_hi:[0,1,0]
  v_pk_fma_f32 v[212:213], v[212:213], v[90:91], v[104:105] op_sel:[0,1,0] op_sel_hi:[1,1,1]
  v_pk_fma_f32 v[214:215], v[214:215], v[90:91], v[106:107] op_sel:[0,1,0] op_sel_hi:[1,1,1]
  v_pk_mul_f32 v[104:105], v[212:213], v[212:213]
  v_pk_mul_f32 v[106:107], v[214:215], v[214:215]
  v_pk_fma_f32 v[104:105], v[104:105], v[96:97], v[96:97] op_sel:[0,1,0] op_sel_hi:[1,1,0]
  v_pk_fma_f32 v[106:107], v[106:107], v[96:97], v[96:97] op_sel:[0,1,0] op_sel_hi:[1,1,0]
  v_pk_mul_f32 v[104:105], v[104:105], v[212:213]
  v_pk_mul_f32 v[106:107], v[106:107], v[214:215]
  v_exp_f32 v104, v104
  v_exp_f32 v105, v105
  v_exp_f32 v106, v106
  v_exp_f32 v107, v107
  v_pk_add_f32 v[104:105], v[104:105], v[98:99] op_sel_hi:[1,0]
  v_pk_add_f32 v[106:107], v[106:107], v[98:99] op_sel_hi:[1,0]
  v_rcp_f32 v104, v104
  v_rcp_f32 v105, v105
  v_rcp_f32 v106, v106
  v_rcp_f32 v107, v107
  v_pk_mul_f32 v[212:213], v[212:213], v[104:105]
  v_pk_mul_f32 v[214:215], v[214:215], v[106:107]
  v_cvt_pk_bf16_f32 v114, v212, v213
  v_cvt_pk_bf16_f32 v115, v214, v215
  s_add_u32 s3, s10, 165888
  s_nop 0
  v_permlane16_swap_b32 v112, v114
  v_permlane16_swap_b32 v113, v115
  buffer_store_dwordx4 v[112:115], v12, s[44:47], s3 offen sc1
  ds_write_b128 v18, v[112:115] offset:18432
  v_pk_fma_f32 v[100:101], v[40:41], v[92:93], v[68:69] op_sel:[0,0,0] op_sel_hi:[1,0,1] neg_lo:[0,1,0] neg_hi:[0,1,0]
  v_pk_fma_f32 v[102:103], v[42:43], v[92:93], v[70:71] op_sel:[0,0,0] op_sel_hi:[1,0,1] neg_lo:[0,1,0] neg_hi:[0,1,0]
  v_pk_fma_f32 v[168:169], v[168:169], v[92:93], v[100:101] op_sel:[0,1,0] op_sel_hi:[1,1,1]
  v_pk_fma_f32 v[170:171], v[170:171], v[92:93], v[102:103] op_sel:[0,1,0] op_sel_hi:[1,1,1]
  v_pk_mul_f32 v[100:101], v[168:169], v[168:169]
  v_pk_mul_f32 v[102:103], v[170:171], v[170:171]
  v_pk_fma_f32 v[100:101], v[100:101], v[96:97], v[96:97] op_sel:[0,1,0] op_sel_hi:[1,1,0]
  v_pk_fma_f32 v[102:103], v[102:103], v[96:97], v[96:97] op_sel:[0,1,0] op_sel_hi:[1,1,0]
  v_pk_mul_f32 v[100:101], v[100:101], v[168:169]
  v_pk_mul_f32 v[102:103], v[102:103], v[170:171]
  v_exp_f32 v100, v100
  v_exp_f32 v101, v101
  v_exp_f32 v102, v102
  v_exp_f32 v103, v103
  v_pk_add_f32 v[100:101], v[100:101], v[98:99] op_sel_hi:[1,0]
  v_pk_add_f32 v[102:103], v[102:103], v[98:99] op_sel_hi:[1,0]
  v_rcp_f32 v100, v100
  v_rcp_f32 v101, v101
  v_rcp_f32 v102, v102
  v_rcp_f32 v103, v103
  v_pk_mul_f32 v[168:169], v[168:169], v[100:101]
  v_pk_mul_f32 v[170:171], v[170:171], v[102:103]
  v_cvt_pk_bf16_f32 v116, v168, v169
  v_cvt_pk_bf16_f32 v117, v170, v171
  v_pk_fma_f32 v[104:105], v[44:45], v[92:93], v[72:73] op_sel:[0,0,0] op_sel_hi:[1,0,1] neg_lo:[0,1,0] neg_hi:[0,1,0]
  v_pk_fma_f32 v[106:107], v[46:47], v[92:93], v[74:75] op_sel:[0,0,0] op_sel_hi:[1,0,1] neg_lo:[0,1,0] neg_hi:[0,1,0]
  v_pk_fma_f32 v[184:185], v[184:185], v[92:93], v[104:105] op_sel:[0,1,0] op_sel_hi:[1,1,1]
  v_pk_fma_f32 v[186:187], v[186:187], v[92:93], v[106:107] op_sel:[0,1,0] op_sel_hi:[1,1,1]
  v_pk_mul_f32 v[104:105], v[184:185], v[184:185]
  v_pk_mul_f32 v[106:107], v[186:187], v[186:187]
  v_pk_fma_f32 v[104:105], v[104:105], v[96:97], v[96:97] op_sel:[0,1,0] op_sel_hi:[1,1,0]
  v_pk_fma_f32 v[106:107], v[106:107], v[96:97], v[96:97] op_sel:[0,1,0] op_sel_hi:[1,1,0]
  v_pk_mul_f32 v[104:105], v[104:105], v[184:185]
  v_pk_mul_f32 v[106:107], v[106:107], v[186:187]
  v_exp_f32 v104, v104
  v_exp_f32 v105, v105
  v_exp_f32 v106, v106
  v_exp_f32 v107, v107
  v_pk_add_f32 v[104:105], v[104:105], v[98:99] op_sel_hi:[1,0]
  v_pk_add_f32 v[106:107], v[106:107], v[98:99] op_sel_hi:[1,0]
  v_rcp_f32 v104, v104
  v_rcp_f32 v105, v105
  v_rcp_f32 v106, v106
  v_rcp_f32 v107, v107
  v_pk_mul_f32 v[184:185], v[184:185], v[104:105]
  v_pk_mul_f32 v[186:187], v[186:187], v[106:107]
  v_cvt_pk_bf16_f32 v118, v184, v185
  v_cvt_pk_bf16_f32 v119, v186, v187
  s_add_u32 s3, s10, 278528
  s_nop 0
  v_permlane16_swap_b32 v116, v118
  v_permlane16_swap_b32 v117, v119
  buffer_store_dwordx4 v[116:119], v12, s[44:47], s3 offen sc1
  ds_write_b128 v18, v[116:119] offset:4096
  v_pk_fma_f32 v[100:101], v[48:49], v[92:93], v[76:77] op_sel:[0,0,0] op_sel_hi:[1,0,1] neg_lo:[0,1,0] neg_hi:[0,1,0]
  v_pk_fma_f32 v[102:103], v[50:51], v[92:93], v[78:79] op_sel:[0,0,0] op_sel_hi:[1,0,1] neg_lo:[0,1,0] neg_hi:[0,1,0]
  v_pk_fma_f32 v[200:201], v[200:201], v[92:93], v[100:101] op_sel:[0,1,0] op_sel_hi:[1,1,1]
  v_pk_fma_f32 v[202:203], v[202:203], v[92:93], v[102:103] op_sel:[0,1,0] op_sel_hi:[1,1,1]
  v_pk_mul_f32 v[100:101], v[200:201], v[200:201]
  v_pk_mul_f32 v[102:103], v[202:203], v[202:203]
  v_pk_fma_f32 v[100:101], v[100:101], v[96:97], v[96:97] op_sel:[0,1,0] op_sel_hi:[1,1,0]
  v_pk_fma_f32 v[102:103], v[102:103], v[96:97], v[96:97] op_sel:[0,1,0] op_sel_hi:[1,1,0]
  v_pk_mul_f32 v[100:101], v[100:101], v[200:201]
  v_pk_mul_f32 v[102:103], v[102:103], v[202:203]
  v_exp_f32 v100, v100
  v_exp_f32 v101, v101
  v_exp_f32 v102, v102
  v_exp_f32 v103, v103
  v_pk_add_f32 v[100:101], v[100:101], v[98:99] op_sel_hi:[1,0]
  v_pk_add_f32 v[102:103], v[102:103], v[98:99] op_sel_hi:[1,0]
  v_rcp_f32 v100, v100
  v_rcp_f32 v101, v101
  v_rcp_f32 v102, v102
  v_rcp_f32 v103, v103
  v_pk_mul_f32 v[200:201], v[200:201], v[100:101]
  v_pk_mul_f32 v[202:203], v[202:203], v[102:103]
  v_cvt_pk_bf16_f32 v120, v200, v201
  v_cvt_pk_bf16_f32 v121, v202, v203
  v_pk_fma_f32 v[104:105], v[52:53], v[92:93], v[80:81] op_sel:[0,0,0] op_sel_hi:[1,0,1] neg_lo:[0,1,0] neg_hi:[0,1,0]
  v_pk_fma_f32 v[106:107], v[54:55], v[92:93], v[82:83] op_sel:[0,0,0] op_sel_hi:[1,0,1] neg_lo:[0,1,0] neg_hi:[0,1,0]
  v_pk_fma_f32 v[216:217], v[216:217], v[92:93], v[104:105] op_sel:[0,1,0] op_sel_hi:[1,1,1]
  v_pk_fma_f32 v[218:219], v[218:219], v[92:93], v[106:107] op_sel:[0,1,0] op_sel_hi:[1,1,1]
  v_pk_mul_f32 v[104:105], v[216:217], v[216:217]
  v_pk_mul_f32 v[106:107], v[218:219], v[218:219]
  v_pk_fma_f32 v[104:105], v[104:105], v[96:97], v[96:97] op_sel:[0,1,0] op_sel_hi:[1,1,0]
  v_pk_fma_f32 v[106:107], v[106:107], v[96:97], v[96:97] op_sel:[0,1,0] op_sel_hi:[1,1,0]
  v_pk_mul_f32 v[104:105], v[104:105], v[216:217]
  v_pk_mul_f32 v[106:107], v[106:107], v[218:219]
  v_exp_f32 v104, v104
  v_exp_f32 v105, v105
  v_exp_f32 v106, v106
  v_exp_f32 v107, v107
  v_pk_add_f32 v[104:105], v[104:105], v[98:99] op_sel_hi:[1,0]
  v_pk_add_f32 v[106:107], v[106:107], v[98:99] op_sel_hi:[1,0]
  v_rcp_f32 v104, v104
  v_rcp_f32 v105, v105
  v_rcp_f32 v106, v106
  v_rcp_f32 v107, v107
  v_pk_mul_f32 v[216:217], v[216:217], v[104:105]
  v_pk_mul_f32 v[218:219], v[218:219], v[106:107]
  v_cvt_pk_bf16_f32 v122, v216, v217
  v_cvt_pk_bf16_f32 v123, v218, v219
  s_add_u32 s3, s10, 280576
  s_nop 0
  v_permlane16_swap_b32 v120, v122
  v_permlane16_swap_b32 v121, v123
  buffer_store_dwordx4 v[120:123], v12, s[44:47], s3 offen sc1
  ds_write_b128 v18, v[120:123] offset:20480
  v_pk_fma_f32 v[100:101], v[40:41], v[94:95], v[68:69] op_sel:[0,0,0] op_sel_hi:[1,0,1] neg_lo:[0,1,0] neg_hi:[0,1,0]
  v_pk_fma_f32 v[102:103], v[42:43], v[94:95], v[70:71] op_sel:[0,0,0] op_sel_hi:[1,0,1] neg_lo:[0,1,0] neg_hi:[0,1,0]
  v_pk_fma_f32 v[172:173], v[172:173], v[94:95], v[100:101] op_sel:[0,1,0] op_sel_hi:[1,1,1]
  v_pk_fma_f32 v[174:175], v[174:175], v[94:95], v[102:103] op_sel:[0,1,0] op_sel_hi:[1,1,1]
  v_pk_mul_f32 v[100:101], v[172:173], v[172:173]
  v_pk_mul_f32 v[102:103], v[174:175], v[174:175]
  v_pk_fma_f32 v[100:101], v[100:101], v[96:97], v[96:97] op_sel:[0,1,0] op_sel_hi:[1,1,0]
  v_pk_fma_f32 v[102:103], v[102:103], v[96:97], v[96:97] op_sel:[0,1,0] op_sel_hi:[1,1,0]
  v_pk_mul_f32 v[100:101], v[100:101], v[172:173]
  v_pk_mul_f32 v[102:103], v[102:103], v[174:175]
  v_exp_f32 v100, v100
  v_exp_f32 v101, v101
  v_exp_f32 v102, v102
  v_exp_f32 v103, v103
  v_pk_add_f32 v[100:101], v[100:101], v[98:99] op_sel_hi:[1,0]
  v_pk_add_f32 v[102:103], v[102:103], v[98:99] op_sel_hi:[1,0]
  v_rcp_f32 v100, v100
  v_rcp_f32 v101, v101
  v_rcp_f32 v102, v102
  v_rcp_f32 v103, v103
  v_pk_mul_f32 v[172:173], v[172:173], v[100:101]
  v_pk_mul_f32 v[174:175], v[174:175], v[102:103]
  v_cvt_pk_bf16_f32 v108, v172, v173
  v_cvt_pk_bf16_f32 v109, v174, v175
  v_pk_fma_f32 v[104:105], v[44:45], v[94:95], v[72:73] op_sel:[0,0,0] op_sel_hi:[1,0,1] neg_lo:[0,1,0] neg_hi:[0,1,0]
  v_pk_fma_f32 v[106:107], v[46:47], v[94:95], v[74:75] op_sel:[0,0,0] op_sel_hi:[1,0,1] neg_lo:[0,1,0] neg_hi:[0,1,0]
  v_pk_fma_f32 v[188:189], v[188:189], v[94:95], v[104:105] op_sel:[0,1,0] op_sel_hi:[1,1,1]
  v_pk_fma_f32 v[190:191], v[190:191], v[94:95], v[106:107] op_sel:[0,1,0] op_sel_hi:[1,1,1]
  v_pk_mul_f32 v[104:105], v[188:189], v[188:189]
  v_pk_mul_f32 v[106:107], v[190:191], v[190:191]
  v_pk_fma_f32 v[104:105], v[104:105], v[96:97], v[96:97] op_sel:[0,1,0] op_sel_hi:[1,1,0]
  v_pk_fma_f32 v[106:107], v[106:107], v[96:97], v[96:97] op_sel:[0,1,0] op_sel_hi:[1,1,0]
  v_pk_mul_f32 v[104:105], v[104:105], v[188:189]
  v_pk_mul_f32 v[106:107], v[106:107], v[190:191]
  v_exp_f32 v104, v104
  v_exp_f32 v105, v105
  v_exp_f32 v106, v106
  v_exp_f32 v107, v107
  v_pk_add_f32 v[104:105], v[104:105], v[98:99] op_sel_hi:[1,0]
  v_pk_add_f32 v[106:107], v[106:107], v[98:99] op_sel_hi:[1,0]
  v_rcp_f32 v104, v104
  v_rcp_f32 v105, v105
  v_rcp_f32 v106, v106
  v_rcp_f32 v107, v107
  v_pk_mul_f32 v[188:189], v[188:189], v[104:105]
  v_pk_mul_f32 v[190:191], v[190:191], v[106:107]
  v_cvt_pk_bf16_f32 v110, v188, v189
  v_cvt_pk_bf16_f32 v111, v190, v191
  s_add_u32 s3, s10, 393216
  s_nop 0
  v_permlane16_swap_b32 v108, v110
  v_permlane16_swap_b32 v109, v111
  buffer_store_dwordx4 v[108:111], v12, s[44:47], s3 offen sc1
  ds_write_b128 v18, v[108:111] offset:6144
  v_pk_fma_f32 v[100:101], v[48:49], v[94:95], v[76:77] op_sel:[0,0,0] op_sel_hi:[1,0,1] neg_lo:[0,1,0] neg_hi:[0,1,0]
  v_pk_fma_f32 v[102:103], v[50:51], v[94:95], v[78:79] op_sel:[0,0,0] op_sel_hi:[1,0,1] neg_lo:[0,1,0] neg_hi:[0,1,0]
  v_pk_fma_f32 v[204:205], v[204:205], v[94:95], v[100:101] op_sel:[0,1,0] op_sel_hi:[1,1,1]
  v_pk_fma_f32 v[206:207], v[206:207], v[94:95], v[102:103] op_sel:[0,1,0] op_sel_hi:[1,1,1]
  v_pk_mul_f32 v[100:101], v[204:205], v[204:205]
  v_pk_mul_f32 v[102:103], v[206:207], v[206:207]
  v_pk_fma_f32 v[100:101], v[100:101], v[96:97], v[96:97] op_sel:[0,1,0] op_sel_hi:[1,1,0]
  v_pk_fma_f32 v[102:103], v[102:103], v[96:97], v[96:97] op_sel:[0,1,0] op_sel_hi:[1,1,0]
  v_pk_mul_f32 v[100:101], v[100:101], v[204:205]
  v_pk_mul_f32 v[102:103], v[102:103], v[206:207]
  v_exp_f32 v100, v100
  v_exp_f32 v101, v101
  v_exp_f32 v102, v102
  v_exp_f32 v103, v103
  v_pk_add_f32 v[100:101], v[100:101], v[98:99] op_sel_hi:[1,0]
  v_pk_add_f32 v[102:103], v[102:103], v[98:99] op_sel_hi:[1,0]
  v_rcp_f32 v100, v100
  v_rcp_f32 v101, v101
  v_rcp_f32 v102, v102
  v_rcp_f32 v103, v103
  v_pk_mul_f32 v[204:205], v[204:205], v[100:101]
  v_pk_mul_f32 v[206:207], v[206:207], v[102:103]
  v_cvt_pk_bf16_f32 v112, v204, v205
  v_cvt_pk_bf16_f32 v113, v206, v207
  v_pk_fma_f32 v[104:105], v[52:53], v[94:95], v[80:81] op_sel:[0,0,0] op_sel_hi:[1,0,1] neg_lo:[0,1,0] neg_hi:[0,1,0]
  v_pk_fma_f32 v[106:107], v[54:55], v[94:95], v[82:83] op_sel:[0,0,0] op_sel_hi:[1,0,1] neg_lo:[0,1,0] neg_hi:[0,1,0]
  v_pk_fma_f32 v[220:221], v[220:221], v[94:95], v[104:105] op_sel:[0,1,0] op_sel_hi:[1,1,1]
  v_pk_fma_f32 v[222:223], v[222:223], v[94:95], v[106:107] op_sel:[0,1,0] op_sel_hi:[1,1,1]
  v_pk_mul_f32 v[104:105], v[220:221], v[220:221]
  v_pk_mul_f32 v[106:107], v[222:223], v[222:223]
  v_pk_fma_f32 v[104:105], v[104:105], v[96:97], v[96:97] op_sel:[0,1,0] op_sel_hi:[1,1,0]
  v_pk_fma_f32 v[106:107], v[106:107], v[96:97], v[96:97] op_sel:[0,1,0] op_sel_hi:[1,1,0]
  v_pk_mul_f32 v[104:105], v[104:105], v[220:221]
  v_pk_mul_f32 v[106:107], v[106:107], v[222:223]
  v_exp_f32 v104, v104
  v_exp_f32 v105, v105
  v_exp_f32 v106, v106
  v_exp_f32 v107, v107
  v_pk_add_f32 v[104:105], v[104:105], v[98:99] op_sel_hi:[1,0]
  v_pk_add_f32 v[106:107], v[106:107], v[98:99] op_sel_hi:[1,0]
  v_rcp_f32 v104, v104
  v_rcp_f32 v105, v105
  v_rcp_f32 v106, v106
  v_rcp_f32 v107, v107
  v_pk_mul_f32 v[220:221], v[220:221], v[104:105]
  v_pk_mul_f32 v[222:223], v[222:223], v[106:107]
  v_cvt_pk_bf16_f32 v114, v220, v221
  v_cvt_pk_bf16_f32 v115, v222, v223
  s_add_u32 s3, s10, 395264
  s_nop 0
  v_permlane16_swap_b32 v112, v114
  v_permlane16_swap_b32 v113, v115
  buffer_store_dwordx4 v[112:115], v12, s[44:47], s3 offen sc1
  ds_write_b128 v18, v[112:115] offset:22528
  s_waitcnt vmcnt(0) lgkmcnt(0)
  s_barrier
  s_add_u32 s97, s97, 1
  s_branch L_w2_body
L_w1_c1:
L_w2_c0:
L_w2_body:
  s_cmp_ge_u32 s2, 256
  s_cbranch_scc1 L_w2_end
  v_lshrrev_b32 v2, 6, v0
  v_and_b32 v1, 63, v0
  v_readfirstlane_b32 s70, v2
  s_and_b32 s3, s2, 7
  s_lshr_b32 s99, s2, 3
  s_and_b32 s5, s3, 3
  s_lshl_b32 s5, s5, 2
  s_and_b32 s6, s99, 3
  s_add_u32 s68, s5, s6
  s_lshr_b32 s5, s3, 2
  s_lshr_b32 s78, s99, 2
  s_lshl1_add_u32 s69, s78, s5
  s_add_u32 s3, s68, s78
  s_lshl_b32 s3, s3, 3
  s_lshl_b32 s85, 0xffff02, s3
  s_sub_u32 s3, 0, s3
  s_lshr_b32 s3, 0xffff02, s3
  s_or_b32 s85, s85, s3
  s_cmp_lt_u32 s70, 4
  s_cbranch_scc1 L_w2_compute
L_w2_loader:
  s_add_u32 s3, s68, s78
  s_and_b32 s3, s3, 3
  s_mov_b32 s4, 0x58585858
  s_cmp_eq_u32 s3, 1
  s_cselect_b32 s4, 0x1616160, s4
  s_cmp_eq_u32 s3, 2
  s_cselect_b32 s4, 0x5858580, s4
  s_cmp_eq_u32 s3, 3
  s_cselect_b32 s4, 0x16161600, s4
  v_subrev_u32 v2, 3, v1
  v_lshlrev_b32 v3, 1, v2
  v_bfe_i32 v16, s4, v3, 2
  v_sub_u32 v16, v1, v16
  v_subrev_u32 v16, 6, v16
  v_ashrrev_i32 v3, 1, v16
  v_cmp_eq_u32 vcc, s78, v3
  s_and_b32 s3, s69, 1
  v_or_b32 v2, 14, v16
  v_cndmask_b32 v2, v16, v2, vcc
  v_cmp_gt_i32 vcc, 0, v16
  s_lshl2_add_u32 s4, s3, 19
  v_add_u32 v16, s4, v16
  s_lshl4_add_u32 s4, s3, 24
  v_add_u32 v2, s4, v2
  v_cndmask_b32 v16, v2, v16, vcc
  v_and_b32 v2, 3, v1
  v_lshlrev_b32 v2, 3, v2
  v_bfe_i32 v3, s85, v2, 8
  s_lshl2_add_u32 s5, s68, 12
  v_add3_u32 v3, v3, v1, s5
  v_and_b32 v2, 7, v3
  v_cmp_eq_u32 vcc, s78, v2
  v_bfe_u32 v2, v3, 3, 1
  v_lshl_add_u32 v2, v2, 2, 19
  v_and_b32 v3, 15, v3
  v_cndmask_b32 v3, v3, v2, vcc
  v_cmp_gt_u32 vcc, 20, v1
  s_lshl1_add_u32 s4, s78, s4
  s_lshl3_add_u32 s3, s3, s78
  v_cndmask_b32 v3, v3, v16, vcc
  v_writelane_b32 v3, s4, 0
  s_add_u32 s4, s4, 1
  v_writelane_b32 v3, s3, 2
  v_writelane_b32 v3, s4, 1
  v_lshlrev_b32 v16, 17, v3
  s_add_u32 s9, s70, s68
  s_and_b32 s9, s9, 3
  s_lshl_b32 s77, s9, 11
  v_and_b32 v10, 7, v1
  v_lshrrev_b32 v3, 3, v1
  s_lshl_b32 s10, s9, 4
  v_add_u32 v3, s10, v3
  v_mul_u32_u24 v3, 2048, v3
  v_lshrrev_b32 v2, 3, v1
  v_and_b32 v2, 2, v2
  v_xor_b32 v2, v2, v10
  s_lshl_b32 s10, s69, 7
  v_add_u32 v3, s10, v3
  v_lshl_add_u32 v8, v2, 4, v3
  v_xor_b32 v2, 4, v2
  v_add_u32 v3, 16384, v3
  v_lshl_add_u32 v9, v2, 4, v3
  s_mov_b32 s40, s28
  s_and_b32 s41, s29, 0xffff
  s_mov_b32 s42, 7340032
  s_mov_b32 s43, 0x00020000
  s_bitcmp1_b32 s69, 0
  s_mov_b32 s76, 128
  s_cselect_b32 s76, -128, s76
  v_readlane_b32 s74, v16, 0
  s_add_u32 m0, s77, 0
  s_add_u32 s4, s74, s76
  buffer_load_dwordx4 v8, s[40:43], s4 offen lds
  s_add_u32 m0, s77, 1024
  s_nop 0
  buffer_load_dwordx4 v9, s[40:43], s4 offen lds
  s_add_u32 m0, s77, 8192
  s_add_u32 s4, s74, 0
  buffer_load_dwordx4 v8, s[40:43], s4 offen lds
  s_add_u32 m0, s77, 9216
  s_nop 0
  buffer_load_dwordx4 v9, s[40:43], s4 offen lds
  v_readlane_b32 s74, v16, 1
  s_add_u32 m0, s77, 16384
  s_add_u32 s4, s74, s76
  buffer_load_dwordx4 v8, s[40:43], s4 offen lds
  s_add_u32 m0, s77, 17408
  s_nop 0
  buffer_load_dwordx4 v9, s[40:43], s4 offen lds
  s_add_u32 m0, s77, 24576
  s_add_u32 s4, s74, 0
  buffer_load_dwordx4 v8, s[40:43], s4 offen lds
  s_add_u32 m0, s77, 25600
  s_nop 0
  buffer_load_dwordx4 v9, s[40:43], s4 offen lds
  v_readlane_b32 s74, v16, 2
  s_add_u32 m0, s77, 32768
  s_add_u32 s4, s74, s76
  buffer_load_dwordx4 v8, s[40:43], s4 offen lds
  s_add_u32 m0, s77, 33792
  s_nop 0
  buffer_load_dwordx4 v9, s[40:43], s4 offen lds
  s_add_u32 m0, s77, 40960
  s_add_u32 s4, s74, 0
  buffer_load_dwordx4 v8, s[40:43], s4 offen lds
  s_add_u32 m0, s77, 41984
  s_nop 0
  buffer_load_dwordx4 v9, s[40:43], s4 offen lds
  v_readlane_b32 s74, v16, 3
  s_add_u32 m0, s77, 49152
  s_add_u32 s4, s74, s76
  buffer_load_dwordx4 v8, s[40:43], s4 offen lds
  s_add_u32 m0, s77, 50176
  s_nop 0
  buffer_load_dwordx4 v9, s[40:43], s4 offen lds
  s_add_u32 m0, s77, 57344
  s_add_u32 s4, s74, 0
  buffer_load_dwordx4 v8, s[40:43], s4 offen lds
  s_add_u32 m0, s77, 58368
  s_nop 0
  buffer_load_dwordx4 v9, s[40:43], s4 offen lds
  v_readlane_b32 s74, v16, 4
  s_add_u32 m0, s77, 65536
  s_add_u32 s4, s74, s76
  buffer_load_dwordx4 v8, s[40:43], s4 offen lds
  s_add_u32 m0, s77, 66560
  s_nop 0
  buffer_load_dwordx4 v9, s[40:43], s4 offen lds
  s_add_u32 m0, s77, 73728
  s_add_u32 s4, s74, 0
  buffer_load_dwordx4 v8, s[40:43], s4 offen lds
  s_add_u32 m0, s77, 74752
  s_nop 0
  buffer_load_dwordx4 v9, s[40:43], s4 offen lds
  s_add_u32 s44, s22, 41943040
  s_addc_u32 s45, s23, 0
  s_and_b32 s45, s45, 0xffff
  s_mov_b32 s46, 524288
  s_mov_b32 s47, 0x00020000
  s_lshl4_add_u32 s3, s97, s68
  s_and_b32 s4, s69, 15
  s_lshl4_add_u32 s3, s3, s4
  s_lshl_b32 s3, s3, 7
  s_sub_u32 s3, s3, 32768
  v_lshlrev_b32 v11, 7, v1
  v_and_b32 v2, 15, v1
  v_lshlrev_b32 v2, 2, v2
  v_mov_b32 v3, 1
  s_mov_b32 s79, 0x100000
  s_cmp_lg_u32 s70, 4
  s_barrier
  s_cbranch_scc1 L_w2_nofl
  s_mov_b32 exec_lo, 0xffff
  s_mov_b32 exec_hi, 0
  buffer_store_dword v3, v11, s[44:47], s87 offen sc1
  s_mov_b64 exec, -1
L_w2_nofl:
  s_mov_b32 s5, s3
  v_readlane_b32 s74, v16, 5
  s_add_u32 m0, s77, 81920
  s_add_u32 s4, s74, s76
  buffer_load_dwordx4 v8, s[40:43], s4 offen lds
  s_add_u32 m0, s77, 82944
  s_nop 0
  buffer_load_dwordx4 v9, s[40:43], s4 offen lds
  s_add_u32 m0, s77, 90112
  s_add_u32 s4, s74, 0
  buffer_load_dwordx4 v8, s[40:43], s4 offen lds
  s_add_u32 m0, s77, 91136
  s_nop 0
  buffer_load_dwordx4 v9, s[40:43], s4 offen lds
  v_readlane_b32 s74, v16, 6
  s_add_u32 m0, s77, 98304
  s_add_u32 s4, s74, s76
  buffer_load_dwordx4 v8, s[40:43], s4 offen lds
  s_add_u32 m0, s77, 99328
  s_nop 0
  buffer_load_dwordx4 v9, s[40:43], s4 offen lds
  s_add_u32 m0, s77, 106496
  s_add_u32 s4, s74, 0
  buffer_load_dwordx4 v8, s[40:43], s4 offen lds
  s_add_u32 m0, s77, 107520
  s_nop 0
  buffer_load_dwordx4 v9, s[40:43], s4 offen lds
  s_waitcnt vmcnt(20)
  s_barrier
  v_readlane_b32 s74, v16, 7
  s_add_u32 m0, s77, 114688
  s_add_u32 s4, s74, s76
  buffer_load_dwordx4 v8, s[40:43], s4 offen lds
  s_add_u32 m0, s77, 115712
  s_nop 0
  buffer_load_dwordx4 v9, s[40:43], s4 offen lds
  s_add_u32 m0, s77, 122880
  s_add_u32 s4, s74, 0
  buffer_load_dwordx4 v8, s[40:43], s4 offen lds
  s_add_u32 m0, s77, 123904
  s_nop 0
  buffer_load_dwordx4 v9, s[40:43], s4 offen lds
  v_readlane_b32 s74, v16, 8
  s_add_u32 m0, s77, 131072
  s_add_u32 s4, s74, s76
  buffer_load_dwordx4 v8, s[40:43], s4 offen lds
  s_add_u32 m0, s77, 132096
  s_nop 0
  buffer_load_dwordx4 v9, s[40:43], s4 offen lds
  s_add_u32 m0, s77, 139264
  s_add_u32 s4, s74, 0
  buffer_load_dwordx4 v8, s[40:43], s4 offen lds
  s_add_u32 m0, s77, 140288
  s_nop 0
  buffer_load_dwordx4 v9, s[40:43], s4 offen lds
  v_readlane_b32 s74, v16, 9
  s_add_u32 m0, s77, 147456
  s_add_u32 s4, s74, s76
  buffer_load_dwordx4 v8, s[40:43], s4 offen lds
  s_add_u32 m0, s77, 148480
  s_nop 0
  buffer_load_dwordx4 v9, s[40:43], s4 offen lds
  s_add_u32 m0, s77, 155648
  s_add_u32 s4, s74, 0
  buffer_load_dwordx4 v8, s[40:43], s4 offen lds
  s_add_u32 m0, s77, 156672
  s_nop 0
  buffer_load_dwordx4 v9, s[40:43], s4 offen lds
  s_mov_b32 s3, s5
  s_cmp_lg_u32 s70, 4
  s_cbranch_scc1 L_w2_dep
L_w2_poll:
  buffer_load_dword v3, v2, s[44:47], s3 offen sc1
  s_sub_u32 s79, s79, 1
  s_cbranch_scc1 L_w2_dep
  s_waitcnt vmcnt(0)
  v_cmp_ne_u32 vcc, 1, v3
  s_cbranch_vccnz L_w2_poll
L_w2_dep:
  s_waitcnt vmcnt(22) lgkmcnt(0)
  s_barrier
  v_readlane_b32 s74, v16, 10
  s_add_u32 m0, s77, 0
  s_add_u32 s4, s74, s76
  buffer_load_dwordx4 v8, s[40:43], s4 offen lds
  s_add_u32 m0, s77, 1024
  s_nop 0
  buffer_load_dwordx4 v9, s[40:43], s4 offen lds
  s_waitcnt vmcnt(4)
  s_add_u32 m0, s77, 8192
  s_add_u32 s4, s74, 0
  buffer_load_dwordx4 v8, s[40:43], s4 offen lds
  s_add_u32 m0, s77, 9216
  s_nop 0
  buffer_load_dwordx4 v9, s[40:43], s4 offen lds
  s_waitcnt vmcnt(4)
  v_readlane_b32 s74, v16, 11
  s_add_u32 m0, s77, 16384
  s_add_u32 s4, s74, s76
  buffer_load_dwordx4 v8, s[40:43], s4 offen lds
  s_add_u32 m0, s77, 17408
  s_nop 0
  buffer_load_dwordx4 v9, s[40:43], s4 offen lds
  s_waitcnt vmcnt(20)
  s_barrier
  s_add_u32 m0, s77, 24576
  s_add_u32 s4, s74, 0
  buffer_load_dwordx4 v8, s[40:43], s4 offen lds
  s_add_u32 m0, s77, 25600
  s_nop 0
  buffer_load_dwordx4 v9, s[40:43], s4 offen lds
  s_waitcnt vmcnt(4)
  v_readlane_b32 s74, v16, 12
  s_add_u32 m0, s77, 32768
  s_add_u32 s4, s74, s76
  buffer_load_dwordx4 v8, s[40:43], s4 offen lds
  s_add_u32 m0, s77, 33792
  s_nop 0
  buffer_load_dwordx4 v9, s[40:43], s4 offen lds
  s_waitcnt vmcnt(4)
  s_add_u32 m0, s77, 40960
  s_add_u32 s4, s74, 0
  buffer_load_dwordx4 v8, s[40:43], s4 offen lds
  s_add_u32 m0, s77, 41984
  s_nop 0
  buffer_load_dwordx4 v9, s[40:43], s4 offen lds
  s_waitcnt vmcnt(4)
  v_readlane_b32 s74, v16, 13
  s_add_u32 m0, s77, 49152
  s_add_u32 s4, s74, s76
  buffer_load_dwordx4 v8, s[40:43], s4 offen lds
  s_add_u32 m0, s77, 50176
  s_nop 0
  buffer_load_dwordx4 v9, s[40:43], s4 offen lds
  s_waitcnt vmcnt(4)
  s_add_u32 m0, s77, 57344
  s_add_u32 s4, s74, 0
  buffer_load_dwordx4 v8, s[40:43], s4 offen lds
  s_add_u32 m0, s77, 58368
  s_nop 0
  buffer_load_dwordx4 v9, s[40:43], s4 offen lds
  s_waitcnt vmcnt(22)
  s_barrier
  v_readlane_b32 s74, v16, 14
  s_add_u32 m0, s77, 65536
  s_add_u32 s4, s74, s76
  buffer_load_dwordx4 v8, s[40:43], s4 offen lds
  s_add_u32 m0, s77, 66560
  s_nop 0
  buffer_load_dwordx4 v9, s[40:43], s4 offen lds
  s_waitcnt vmcnt(4)
  s_add_u32 m0, s77, 73728
  s_add_u32 s4, s74, 0
  buffer_load_dwordx4 v8, s[40:43], s4 offen lds
  s_add_u32 m0, s77, 74752
  s_nop 0
  buffer_load_dwordx4 v9, s[40:43], s4 offen lds
  s_waitcnt vmcnt(4)
  v_readlane_b32 s74, v16, 15
  s_add_u32 m0, s77, 81920
  s_add_u32 s4, s74, s76
  buffer_load_dwordx4 v8, s[40:43], s4 offen lds
  s_add_u32 m0, s77, 82944
  s_nop 0
  buffer_load_dwordx4 v9, s[40:43], s4 offen lds
  s_waitcnt vmcnt(4)
  s_add_u32 m0, s77, 90112
  s_add_u32 s4, s74, 0
  buffer_load_dwordx4 v8, s[40:43], s4 offen lds
  s_add_u32 m0, s77, 91136
  s_nop 0
  buffer_load_dwordx4 v9, s[40:43], s4 offen lds
  s_waitcnt vmcnt(22)
  s_barrier
  v_readlane_b32 s74, v16, 16
  s_add_u32 m0, s77, 98304
  s_add_u32 s4, s74, s76
  buffer_load_dwordx4 v8, s[40:43], s4 offen lds
  s_add_u32 m0, s77, 99328
  s_nop 0
  buffer_load_dwordx4 v9, s[40:43], s4 offen lds
  s_waitcnt vmcnt(4)
  s_add_u32 m0, s77, 106496
  s_add_u32 s4, s74, 0
  buffer_load_dwordx4 v8, s[40:43], s4 offen lds
  s_add_u32 m0, s77, 107520
  s_nop 0
  buffer_load_dwordx4 v9, s[40:43], s4 offen lds
  s_waitcnt vmcnt(4)
  v_readlane_b32 s74, v16, 17
  s_add_u32 m0, s77, 114688
  s_add_u32 s4, s74, s76
  buffer_load_dwordx4 v8, s[40:43], s4 offen lds
  s_add_u32 m0, s77, 115712
  s_nop 0
  buffer_load_dwordx4 v9, s[40:43], s4 offen lds
  s_waitcnt vmcnt(4)
  s_add_u32 m0, s77, 122880
  s_add_u32 s4, s74, 0
  buffer_load_dwordx4 v8, s[40:43], s4 offen lds
  s_add_u32 m0, s77, 123904
  s_nop 0
  buffer_load_dwordx4 v9, s[40:43], s4 offen lds
  s_waitcnt vmcnt(22)
  s_barrier
  v_readlane_b32 s74, v16, 18
  s_add_u32 m0, s77, 131072
  s_add_u32 s4, s74, s76
  buffer_load_dwordx4 v8, s[40:43], s4 offen lds
  s_add_u32 m0, s77, 132096
  s_nop 0
  buffer_load_dwordx4 v9, s[40:43], s4 offen lds
  s_waitcnt vmcnt(4)
  s_add_u32 m0, s77, 139264
  s_add_u32 s4, s74, 0
  buffer_load_dwordx4 v8, s[40:43], s4 offen lds
  s_add_u32 m0, s77, 140288
  s_nop 0
  buffer_load_dwordx4 v9, s[40:43], s4 offen lds
  s_waitcnt vmcnt(4)
  v_readlane_b32 s74, v16, 19
  s_add_u32 m0, s77, 147456
  s_add_u32 s4, s74, s76
  buffer_load_dwordx4 v8, s[40:43], s4 offen lds
  s_add_u32 m0, s77, 148480
  s_nop 0
  buffer_load_dwordx4 v9, s[40:43], s4 offen lds
  s_waitcnt vmcnt(4)
  s_add_u32 m0, s77, 155648
  s_add_u32 s4, s74, 0
  buffer_load_dwordx4 v8, s[40:43], s4 offen lds
  s_add_u32 m0, s77, 156672
  s_nop 0
  buffer_load_dwordx4 v9, s[40:43], s4 offen lds
  s_waitcnt vmcnt(22)
  s_barrier
  v_readlane_b32 s74, v16, 20
  s_add_u32 m0, s77, 0
  s_add_u32 s4, s74, 0
  buffer_load_dwordx4 v8, s[40:43], s4 offen lds
  s_add_u32 m0, s77, 1024
  s_nop 0
  buffer_load_dwordx4 v9, s[40:43], s4 offen lds
  s_waitcnt vmcnt(4)
  v_readlane_b32 s74, v16, 21
  s_add_u32 m0, s77, 8192
  s_add_u32 s4, s74, 0
  buffer_load_dwordx4 v8, s[40:43], s4 offen lds
  s_add_u32 m0, s77, 9216
  s_nop 0
  buffer_load_dwordx4 v9, s[40:43], s4 offen lds
  s_waitcnt vmcnt(4)
  v_readlane_b32 s74, v16, 22
  s_add_u32 m0, s77, 16384
  s_add_u32 s4, s74, 0
  buffer_load_dwordx4 v8, s[40:43], s4 offen lds
  s_add_u32 m0, s77, 17408
  s_nop 0
  buffer_load_dwordx4 v9, s[40:43], s4 offen lds
  s_waitcnt vmcnt(4)
  v_readlane_b32 s74, v16, 23
  s_add_u32 m0, s77, 24576
  s_add_u32 s4, s74, 0
  buffer_load_dwordx4 v8, s[40:43], s4 offen lds
  s_add_u32 m0, s77, 25600
  s_nop 0
  buffer_load_dwordx4 v9, s[40:43], s4 offen lds
  s_waitcnt vmcnt(22)
  s_barrier
  v_readlane_b32 s74, v16, 24
  s_add_u32 m0, s77, 32768
  s_add_u32 s4, s74, 0
  buffer_load_dwordx4 v8, s[40:43], s4 offen lds
  s_add_u32 m0, s77, 33792
  s_nop 0
  buffer_load_dwordx4 v9, s[40:43], s4 offen lds
  s_waitcnt vmcnt(4)
  v_readlane_b32 s74, v16, 25
  s_add_u32 m0, s77, 40960
  s_add_u32 s4, s74, 0
  buffer_load_dwordx4 v8, s[40:43], s4 offen lds
  s_add_u32 m0, s77, 41984
  s_nop 0
  buffer_load_dwordx4 v9, s[40:43], s4 offen lds
  s_waitcnt vmcnt(4)
  v_readlane_b32 s74, v16, 26
  s_add_u32 m0, s77, 49152
  s_add_u32 s4, s74, 0
  buffer_load_dwordx4 v8, s[40:43], s4 offen lds
  s_add_u32 m0, s77, 50176
  s_nop 0
  buffer_load_dwordx4 v9, s[40:43], s4 offen lds
  s_waitcnt vmcnt(4)
  v_readlane_b32 s74, v16, 27
  s_add_u32 m0, s77, 57344
  s_add_u32 s4, s74, 0
  buffer_load_dwordx4 v8, s[40:43], s4 offen lds
  s_add_u32 m0, s77, 58368
  s_nop 0
  buffer_load_dwordx4 v9, s[40:43], s4 offen lds
  s_waitcnt vmcnt(22)
  s_barrier
  v_readlane_b32 s74, v16, 28
  s_add_u32 m0, s77, 65536
  s_add_u32 s4, s74, 0
  buffer_load_dwordx4 v8, s[40:43], s4 offen lds
  s_add_u32 m0, s77, 66560
  s_nop 0
  buffer_load_dwordx4 v9, s[40:43], s4 offen lds
  s_waitcnt vmcnt(4)
  v_readlane_b32 s74, v16, 29
  s_add_u32 m0, s77, 73728
  s_add_u32 s4, s74, 0
  buffer_load_dwordx4 v8, s[40:43], s4 offen lds
  s_add_u32 m0, s77, 74752
  s_nop 0
  buffer_load_dwordx4 v9, s[40:43], s4 offen lds
  s_waitcnt vmcnt(4)
  v_readlane_b32 s74, v16, 30
  s_add_u32 m0, s77, 81920
  s_add_u32 s4, s74, 0
  buffer_load_dwordx4 v8, s[40:43], s4 offen lds
  s_add_u32 m0, s77, 82944
  s_nop 0
  buffer_load_dwordx4 v9, s[40:43], s4 offen lds
  s_waitcnt vmcnt(4)
  v_readlane_b32 s74, v16, 31
  s_add_u32 m0, s77, 90112
  s_add_u32 s4, s74, 0
  buffer_load_dwordx4 v8, s[40:43], s4 offen lds
  s_add_u32 m0, s77, 91136
  s_nop 0
  buffer_load_dwordx4 v9, s[40:43], s4 offen lds
  s_waitcnt vmcnt(22)
  s_barrier
  v_readlane_b32 s74, v16, 32
  s_add_u32 m0, s77, 98304
  s_add_u32 s4, s74, 0
  buffer_load_dwordx4 v8, s[40:43], s4 offen lds
  s_add_u32 m0, s77, 99328
  s_nop 0
  buffer_load_dwordx4 v9, s[40:43], s4 offen lds
  s_waitcnt vmcnt(4)
  v_readlane_b32 s74, v16, 33
  s_add_u32 m0, s77, 106496
  s_add_u32 s4, s74, 0
  buffer_load_dwordx4 v8, s[40:43], s4 offen lds
  s_add_u32 m0, s77, 107520
  s_nop 0
  buffer_load_dwordx4 v9, s[40:43], s4 offen lds
  s_waitcnt vmcnt(4)
  v_readlane_b32 s74, v16, 34
  s_add_u32 m0, s77, 114688
  s_add_u32 s4, s74, 0
  buffer_load_dwordx4 v8, s[40:43], s4 offen lds
  s_add_u32 m0, s77, 115712
  s_nop 0
  buffer_load_dwordx4 v9, s[40:43], s4 offen lds
  s_waitcnt vmcnt(4)
  v_readlane_b32 s74, v16, 35
  s_add_u32 m0, s77, 122880
  s_add_u32 s4, s74, 0
  buffer_load_dwordx4 v8, s[40:43], s4 offen lds
  s_add_u32 m0, s77, 123904
  s_nop 0
  buffer_load_dwordx4 v9, s[40:43], s4 offen lds
  s_waitcnt vmcnt(18)
  s_barrier
  s_add_u32 s64, s22, 41943040
  s_addc_u32 s65, s23, 0
  s_and_b32 s65, s65, 0xffff
  s_mov_b32 s66, 524288
  s_mov_b32 s67, 0x00020000
  s_lshl4_add_u32 s6, s68, s69
  s_xor_b32 s6, s6, 1
  s_add_u32 s7, s96, 4
  s_lshl_b32 s7, s7, 8
  s_add_u32 s6, s6, s7
  s_lshl_b32 s6, s6, 8
  v_and_b32 v2, 3, v1
  v_lshlrev_b32 v2, 6, v2
  s_mov_b32 s79, 0x100000
  s_waitcnt vmcnt(8)
  s_barrier
  s_cmp_lg_u32 s70, 4
  s_cbranch_scc1 L_w2_xgo
  s_setprio 3
L_w2_xpoll:
  buffer_load_dword v5, v2, s[64:67], s6 offen sc1
  s_sub_u32 s79, s79, 1
  s_cbranch_scc1 L_w2_xgo
  s_waitcnt vmcnt(0)
  v_cmp_ne_u32 vcc, 1, v5
  s_cbranch_vccnz L_w2_xpoll
L_w2_xgo:
  s_setprio 0
  s_waitcnt vmcnt(0)
  s_barrier
  s_cmp_eq_u32 s96, 1
  s_cbranch_scc1 L_w2_end
  s_lshl_b32 s87, s97, 15
  s_lshl_b32 s4, s68, 11
  s_add_u32 s87, s87, s4
  s_lshl_b32 s4, s69, 2
  s_add_u32 s87, s87, s4
  s_mov_b32 s96, 1
  s_add_u32 s12, s22, 33554432
  s_addc_u32 s13, s23, 0
  s_add_u32 s34, s22, 67108864
  s_addc_u32 s35, s23, 0
  s_add_u32 s97, s97, 1
  s_branch L_attn_body
L_w2_end:
  s_endpgm
L_w2_compute:
  s_lshl_b32 s3, s70, 12
  s_add_u32 s3, s3, 114688
  v_lshl_add_u32 v2, v1, 4, s3
  ds_read_b128 v[32:35], v2 offset:0
  ds_read_b128 v[36:39], v2 offset:2048
  ds_read_b128 v[40:43], v2 offset:1024
  ds_read_b128 v[44:47], v2 offset:3072
  ds_read_b128 v[48:51], v2 offset:16384
  ds_read_b128 v[52:55], v2 offset:18432
  ds_read_b128 v[56:59], v2 offset:17408
  ds_read_b128 v[60:63], v2 offset:19456
  ds_read_b128 v[64:67], v2 offset:32768
  ds_read_b128 v[68:71], v2 offset:34816
  ds_read_b128 v[72:75], v2 offset:33792
  ds_read_b128 v[76:79], v2 offset:35840
  s_add_u32 s3, s68, s78
  s_and_b32 s3, s3, 3
  s_mov_b32 s4, 0x58585858
  s_cmp_eq_u32 s3, 1
  s_cselect_b32 s4, 0x1616160, s4
  s_cmp_eq_u32 s3, 2
  s_cselect_b32 s4, 0x5858580, s4
  s_cmp_eq_u32 s3, 3
  s_cselect_b32 s4, 0x16161600, s4
  v_subrev_u32 v2, 3, v1
  v_lshlrev_b32 v3, 1, v2
  v_bfe_i32 v15, s4, v3, 2
  v_sub_u32 v15, v1, v15
  v_subrev_u32 v15, 6, v15
  v_ashrrev_i32 v3, 1, v15
  v_cmp_eq_u32 vcc, s78, v3
  s_and_b32 s3, s69, 1
  v_or_b32 v2, 14, v15
  v_cndmask_b32 v2, v15, v2, vcc
  v_cmp_gt_i32 vcc, 0, v15
  s_lshl2_add_u32 s4, s3, 19
  v_add_u32 v15, s4, v15
  s_lshl4_add_u32 s4, s3, 24
  v_add_u32 v2, s4, v2
  v_cndmask_b32 v15, v2, v15, vcc
  v_and_b32 v2, 3, v1
  v_lshlrev_b32 v2, 3, v2
  v_bfe_i32 v3, s85, v2, 8
  s_lshl2_add_u32 s5, s68, 12
  v_add3_u32 v3, v3, v1, s5
  v_and_b32 v2, 7, v3
  v_cmp_eq_u32 vcc, s78, v2
  v_bfe_u32 v2, v3, 3, 1
  v_lshl_add_u32 v2, v2, 2, 19
  v_and_b32 v3, 15, v3
  v_cndmask_b32 v3, v3, v2, vcc
  v_cmp_gt_u32 vcc, 20, v1
  s_lshl1_add_u32 s4, s78, s4
  s_lshl3_add_u32 s3, s3, s78
  v_cndmask_b32 v3, v3, v15, vcc
  v_writelane_b32 v3, s4, 0
  s_add_u32 s4, s4, 1
  v_writelane_b32 v3, s3, 2
  v_writelane_b32 v3, s4, 1
  v_lshlrev_b32 v15, 11, v3
  s_waitcnt lgkmcnt(0)
  s_barrier
  v_and_b32 v3, 15, v1
  v_lshrrev_b32 v2, 4, v1
  s_lshl_b32 s8, s68, 7
  s_lshl_b32 s9, s70, 5
  s_add_u32 s8, s8, s9
  s_mul_i32 s9, s8, 7168
  v_add_u32 v13, s8, v3
  s_lshl_b32 s10, s69, 7
  v_lshl_add_u32 v14, v2, 3, s10
  v_and_b32 v16, 1, v2
  v_lshrrev_b32 v17, 1, v2
  v_lshlrev_b32 v16, 5, v16
  v_lshl_add_u32 v16, v17, 4, v16
  v_lshlrev_b32 v4, 3, v3
  v_and_b32 v4, 0x70, v4
  v_xor_b32 v4, v4, v16
  v_lshl_add_u32 v4, v3, 7, v4
  s_lshl_b32 s3, s70, 12
  v_add_u32 v4, s3, v4
  v_xor_b32 v5, 64, v4
  v_add_u32 v16, s10, v16
  s_cmp_eq_u32 s96, 0
  s_cselect_b32 s7, 128, 0
  s_add_u32 s7, s7, 2048
  v_mad_u32_u24 v12, v13, s7, v16
  v_lshl_add_u32 v18, v17, 4, v13
  v_lshlrev_b32 v18, 3, v18
  v_and_b32 v16, 1, v2
  v_lshl_add_u32 v18, v16, 2, v18
  s_lshl_b32 s10, s69, 14
  v_add_u32 v18, s10, v18
  v_bfe_u32 v6, v1, 2, 2
  v_lshl_add_u32 v6, v2, 3, v6
  v_lshlrev_b32 v6, 7, v6
  v_and_b32 v17, 3, v1
  v_lshl_add_u32 v6, v17, 3, v6
  v_bfe_u32 v17, v1, 3, 2
  v_lshl_add_u32 v6, v17, 5, v6
  v_xor_b32 v7, 32, v6
  v_xor_b32 v8, 64, v6
  v_xor_b32 v9, 96, v6
  s_mov_b32 s11, 0xffff0000
  s_add_u32 s36, s34, 8388608
  s_addc_u32 s37, s35, 0
  s_and_b32 s37, s37, 0xffff
  s_mov_b32 s38, 14680064
  s_mov_b32 s39, 0x00020000
  s_mov_b32 s44, s32
  s_and_b32 s45, s33, 0xffff
  s_mov_b32 s46, 4194304
  s_mov_b32 s47, 0x00020000
  s_add_u32 s48, s22, 33554432
  s_addc_u32 s49, s23, 0
  s_and_b32 s49, s49, 0xffff
  s_mov_b32 s50, 4194304
  s_mov_b32 s51, 0x00020000
  s_cmp_eq_u32 s96, 0
  s_cselect_b64 s[44:45], s[48:49], s[44:45]
  s_lshl_b32 s46, s7, 11
  s_add_u32 s56, s34, 24379392
  s_addc_u32 s57, s35, 0
  s_and_b32 s57, s57, 0xffff
  s_mov_b32 s58, 262144
  s_mov_b32 s59, 0x00020000
  s_mul_i32 s9, s8, 7168
  s_add_u32 s36, s36, s9
  s_addc_u32 s37, s37, 0x100000
  s_add_u32 s64, s36, 114688
  s_addc_u32 s65, s37, 0
  s_mov_b32 s38, 114688
  s_mov_b32 s39, 0x00800000
  s_mov_b32 s66, 114688
  s_mov_b32 s67, 0x00800000
  s_add_u32 s60, s34, 25165824
  s_addc_u32 s61, s35, 0
  s_and_b32 s61, s61, 0xffff
  s_mov_b32 s62, 4194304
  s_mov_b32 s63, 0x00020000
  s_or_b32 s61, s61, 0x100000
  s_mov_b32 s63, 0x00800000
  s_lshl4_add_u32 s4, s68, s69
  s_lshl2_add_u32 s4, s4, s70
  s_add_u32 s52, s22, 41943040
  s_addc_u32 s53, s23, 0
  s_and_b32 s53, s53, 0xffff
  s_mov_b32 s54, 524288
  s_mov_b32 s55, 0x00020000
  s_add_u32 s6, s96, 4
  s_lshl_b32 s6, s6, 10
  s_add_u32 s6, s6, s4
  s_lshl_b32 s6, s6, 6
  v_mov_b32 v19, 1
  s_lshl_b32 s4, s4, 12
  s_xor_b32 s5, s4, 16384
  v_add_u32 v26, 131072, v6
  v_add_u32 v27, 131072, v7
  v_add_u32 v28, 131072, v8
  v_add_u32 v29, 131072, v9
  v_add_u32 v20, 65536, v6
  v_add_u32 v21, 65536, v7
  v_add_u32 v22, 65536, v8
  v_add_u32 v23, 65536, v9
  v_readlane_b32 s51, v15, 3
  v_readlane_b32 s48, v15, 4
  v_readlane_b32 s49, v15, 5
  v_permlane16_swap_b32 v240, v242
  v_permlane16_swap_b32 v241, v243
  v_permlane16_swap_b32 v244, v246
  v_permlane16_swap_b32 v245, v247
  v_permlane16_swap_b32 v248, v250
  v_permlane16_swap_b32 v249, v251
  v_permlane16_swap_b32 v252, v254
  v_permlane16_swap_b32 v253, v255
  s_waitcnt lgkmcnt(0)
  ds_read_b64_tr_b16 v[160:161], v6 offset:0
  ds_read_b64_tr_b16 v[162:163], v6 offset:512
  ds_read_b64_tr_b16 v[164:165], v7 offset:0
  ds_read_b64_tr_b16 v[166:167], v7 offset:512
  ds_read_b64_tr_b16 v[168:169], v8 offset:0
  ds_read_b64_tr_b16 v[170:171], v8 offset:512
  ds_read_b64_tr_b16 v[172:173], v9 offset:0
  ds_read_b64_tr_b16 v[174:175], v9 offset:512
  ds_read_b64_tr_b16 v[176:177], v6 offset:4096
  ds_read_b64_tr_b16 v[178:179], v6 offset:4608
  ds_read_b64_tr_b16 v[180:181], v7 offset:4096
  ds_read_b64_tr_b16 v[182:183], v7 offset:4608
  ds_read_b64_tr_b16 v[184:185], v8 offset:4096
  ds_read_b64_tr_b16 v[186:187], v8 offset:4608
  ds_read_b64_tr_b16 v[188:189], v9 offset:4096
  ds_read_b64_tr_b16 v[190:191], v9 offset:4608
  v_lshlrev_b32 v216, 16, v10
  v_and_b32 v217, s11, v10
  v_lshlrev_b32 v218, 16, v11
  v_and_b32 v219, s11, v11
  v_lshlrev_b32 v96, 16, v240
  v_and_b32 v97, s11, v240
  v_pk_add_f32 v[96:97], v[96:97], v[216:217]
  v_lshlrev_b32 v98, 16, v241
  v_and_b32 v99, s11, v241
  v_pk_add_f32 v[98:99], v[98:99], v[218:219]
  v_lshlrev_b32 v100, 16, v248
  v_and_b32 v101, s11, v248
  v_pk_add_f32 v[100:101], v[100:101], v[216:217]
  v_lshlrev_b32 v102, 16, v249
  v_and_b32 v103, s11, v249
  v_pk_add_f32 v[102:103], v[102:103], v[218:219]
  v_lshlrev_b32 v216, 16, v24
  v_and_b32 v217, s11, v24
  v_lshlrev_b32 v218, 16, v25
  v_and_b32 v219, s11, v25
  v_lshlrev_b32 v104, 16, v242
  v_and_b32 v105, s11, v242
  v_pk_add_f32 v[104:105], v[104:105], v[216:217]
  v_lshlrev_b32 v106, 16, v243
  v_and_b32 v107, s11, v243
  v_pk_add_f32 v[106:107], v[106:107], v[218:219]
  v_lshlrev_b32 v108, 16, v250
  v_and_b32 v109, s11, v250
  v_pk_add_f32 v[108:109], v[108:109], v[216:217]
  v_lshlrev_b32 v110, 16, v251
  v_and_b32 v111, s11, v251
  v_pk_add_f32 v[110:111], v[110:111], v[218:219]
  v_lshlrev_b32 v216, 16, v124
  v_and_b32 v217, s11, v124
  v_lshlrev_b32 v218, 16, v125
  v_and_b32 v219, s11, v125
  v_lshlrev_b32 v112, 16, v244
  v_and_b32 v113, s11, v244
  v_pk_add_f32 v[112:113], v[112:113], v[216:217]
  v_lshlrev_b32 v114, 16, v245
  v_and_b32 v115, s11, v245
  v_pk_add_f32 v[114:115], v[114:115], v[218:219]
  v_lshlrev_b32 v116, 16, v252
  v_and_b32 v117, s11, v252
  v_pk_add_f32 v[116:117], v[116:117], v[216:217]
  v_lshlrev_b32 v118, 16, v253
  v_and_b32 v119, s11, v253
  v_pk_add_f32 v[118:119], v[118:119], v[218:219]
  v_lshlrev_b32 v216, 16, v126
  v_and_b32 v217, s11, v126
  v_lshlrev_b32 v218, 16, v127
  v_and_b32 v219, s11, v127
  v_lshlrev_b32 v120, 16, v246
  v_and_b32 v121, s11, v246
  v_pk_add_f32 v[120:121], v[120:121], v[216:217]
  v_lshlrev_b32 v122, 16, v247
  v_and_b32 v123, s11, v247
  v_pk_add_f32 v[122:123], v[122:123], v[218:219]
  v_lshlrev_b32 v124, 16, v254
  v_and_b32 v125, s11, v254
  v_pk_add_f32 v[124:125], v[124:125], v[216:217]
  v_lshlrev_b32 v126, 16, v255
  v_and_b32 v127, s11, v255
  v_pk_add_f32 v[126:127], v[126:127], v[218:219]
  s_waitcnt lgkmcnt(8)
  v_mfma_f32_16x16x32_bf16 v[128:131], v[160:163], v[32:35], 0
  ds_read_b64_tr_b16 v[192:193], v6 offset:8192
  v_mfma_f32_16x16x32_bf16 v[132:135], v[160:163], v[36:39], 0
  ds_read_b64_tr_b16 v[194:195], v6 offset:8704
  v_mfma_f32_16x16x32_bf16 v[140:143], v[164:167], v[36:39], 0
  ds_read_b64_tr_b16 v[196:197], v7 offset:8192
  v_mfma_f32_16x16x32_bf16 v[136:139], v[164:167], v[32:35], 0
  ds_read_b64_tr_b16 v[198:199], v7 offset:8704
  v_mfma_f32_16x16x32_bf16 v[144:147], v[168:171], v[32:35], 0
  ds_read_b64_tr_b16 v[200:201], v8 offset:8192
  v_mfma_f32_16x16x32_bf16 v[148:151], v[168:171], v[36:39], 0
  ds_read_b64_tr_b16 v[202:203], v8 offset:8704
  v_mfma_f32_16x16x32_bf16 v[156:159], v[172:175], v[36:39], 0
  ds_read_b64_tr_b16 v[204:205], v9 offset:8192
  v_mfma_f32_16x16x32_bf16 v[152:155], v[172:175], v[32:35], 0
  ds_read_b64_tr_b16 v[206:207], v9 offset:8704
  s_waitcnt lgkmcnt(8)
  v_mfma_f32_16x16x32_bf16 v[128:131], v[176:179], v[40:43], v[128:131]
  ds_read_b64_tr_b16 v[208:209], v6 offset:12288
  v_mfma_f32_16x16x32_bf16 v[132:135], v[176:179], v[44:47], v[132:135]
  ds_read_b64_tr_b16 v[210:211], v6 offset:12800
  v_mfma_f32_16x16x32_bf16 v[140:143], v[180:183], v[44:47], v[140:143]
  ds_read_b64_tr_b16 v[212:213], v7 offset:12288
  v_mfma_f32_16x16x32_bf16 v[136:139], v[180:183], v[40:43], v[136:139]
  ds_read_b64_tr_b16 v[214:215], v7 offset:12800
  v_mfma_f32_16x16x32_bf16 v[144:147], v[184:187], v[40:43], v[144:147]
  ds_read_b64_tr_b16 v[216:217], v8 offset:12288
  v_mfma_f32_16x16x32_bf16 v[148:151], v[184:187], v[44:47], v[148:151]
  ds_read_b64_tr_b16 v[218:219], v8 offset:12800
  v_mfma_f32_16x16x32_bf16 v[156:159], v[188:191], v[44:47], v[156:159]
  ds_read_b64_tr_b16 v[220:221], v9 offset:12288
  v_mfma_f32_16x16x32_bf16 v[152:155], v[188:191], v[40:43], v[152:155]
  ds_read_b64_tr_b16 v[222:223], v9 offset:12800
  s_waitcnt lgkmcnt(8)
  v_mfma_f32_16x16x32_bf16 v[96:99], v[192:195], v[32:35], v[96:99]
  ds_read_b64_tr_b16 v[160:161], v6 offset:16384
  v_mfma_f32_16x16x32_bf16 v[100:103], v[192:195], v[36:39], v[100:103]
  ds_read_b64_tr_b16 v[162:163], v6 offset:16896
  v_mfma_f32_16x16x32_bf16 v[108:111], v[196:199], v[36:39], v[108:111]
  ds_read_b64_tr_b16 v[164:165], v7 offset:16384
  v_mfma_f32_16x16x32_bf16 v[104:107], v[196:199], v[32:35], v[104:107]
  ds_read_b64_tr_b16 v[166:167], v7 offset:16896
  v_mfma_f32_16x16x32_bf16 v[112:115], v[200:203], v[32:35], v[112:115]
  ds_read_b64_tr_b16 v[168:169], v8 offset:16384
  v_mfma_f32_16x16x32_bf16 v[116:119], v[200:203], v[36:39], v[116:119]
  ds_read_b64_tr_b16 v[170:171], v8 offset:16896
  v_mfma_f32_16x16x32_bf16 v[124:127], v[204:207], v[36:39], v[124:127]
  ds_read_b64_tr_b16 v[172:173], v9 offset:16384
  v_mfma_f32_16x16x32_bf16 v[120:123], v[204:207], v[32:35], v[120:123]
  ds_read_b64_tr_b16 v[174:175], v9 offset:16896
  s_waitcnt lgkmcnt(8)
  v_mfma_f32_16x16x32_bf16 v[96:99], v[208:211], v[40:43], v[96:99]
  ds_read_b64_tr_b16 v[176:177], v6 offset:20480
  v_mfma_f32_16x16x32_bf16 v[100:103], v[208:211], v[44:47], v[100:103]
  ds_read_b64_tr_b16 v[178:179], v6 offset:20992
  v_mfma_f32_16x16x32_bf16 v[108:111], v[212:215], v[44:47], v[108:111]
  ds_read_b64_tr_b16 v[180:181], v7 offset:20480
  v_mfma_f32_16x16x32_bf16 v[104:107], v[212:215], v[40:43], v[104:107]
  ds_read_b64_tr_b16 v[182:183], v7 offset:20992
  v_mfma_f32_16x16x32_bf16 v[112:115], v[216:219], v[40:43], v[112:115]
  ds_read_b64_tr_b16 v[184:185], v8 offset:20480
  v_mfma_f32_16x16x32_bf16 v[116:119], v[216:219], v[44:47], v[116:119]
  ds_read_b64_tr_b16 v[186:187], v8 offset:20992
  v_mfma_f32_16x16x32_bf16 v[124:127], v[220:223], v[44:47], v[124:127]
  ds_read_b64_tr_b16 v[188:189], v9 offset:20480
  v_mfma_f32_16x16x32_bf16 v[120:123], v[220:223], v[40:43], v[120:123]
  ds_read_b64_tr_b16 v[190:191], v9 offset:20992
  s_waitcnt lgkmcnt(8)
  v_mfma_f32_16x16x32_bf16 v[128:131], v[160:163], v[48:51], v[128:131]
  ds_read_b64_tr_b16 v[192:193], v6 offset:24576
  v_mfma_f32_16x16x32_bf16 v[132:135], v[160:163], v[52:55], v[132:135]
  ds_read_b64_tr_b16 v[194:195], v6 offset:25088
  v_mfma_f32_16x16x32_bf16 v[140:143], v[164:167], v[52:55], v[140:143]
  ds_read_b64_tr_b16 v[196:197], v7 offset:24576
  v_mfma_f32_16x16x32_bf16 v[136:139], v[164:167], v[48:51], v[136:139]
  ds_read_b64_tr_b16 v[198:199], v7 offset:25088
  v_mfma_f32_16x16x32_bf16 v[144:147], v[168:171], v[48:51], v[144:147]
  ds_read_b64_tr_b16 v[200:201], v8 offset:24576
  v_mfma_f32_16x16x32_bf16 v[148:151], v[168:171], v[52:55], v[148:151]
  ds_read_b64_tr_b16 v[202:203], v8 offset:25088
  v_mfma_f32_16x16x32_bf16 v[156:159], v[172:175], v[52:55], v[156:159]
  ds_read_b64_tr_b16 v[204:205], v9 offset:24576
  v_mfma_f32_16x16x32_bf16 v[152:155], v[172:175], v[48:51], v[152:155]
  ds_read_b64_tr_b16 v[206:207], v9 offset:25088
  s_waitcnt lgkmcnt(8)
  s_barrier
  buffer_load_dwordx4 v[80:83], off, s[36:39], s51 offset:0
  buffer_load_dwordx4 v[84:87], off, s[64:67], s51 offset:0
  buffer_load_dwordx4 v[88:91], off, s[36:39], s51 offset:1024
  buffer_load_dwordx4 v[92:95], off, s[64:67], s51 offset:1024
  buffer_load_dwordx4 v[224:227], off, s[36:39], s48 offset:0
  buffer_load_dwordx4 v[228:231], off, s[64:67], s48 offset:0
  buffer_load_dwordx4 v[232:235], off, s[36:39], s48 offset:1024
  buffer_load_dwordx4 v[236:239], off, s[64:67], s48 offset:1024
  buffer_load_dwordx4 v[240:243], off, s[36:39], s49 offset:0
  buffer_load_dwordx4 v[244:247], off, s[64:67], s49 offset:0
  buffer_load_dwordx4 v[248:251], off, s[36:39], s49 offset:1024
  buffer_load_dwordx4 v[252:255], off, s[64:67], s49 offset:1024
  v_mfma_f32_16x16x32_bf16 v[128:131], v[176:179], v[56:59], v[128:131]
  ds_read_b64_tr_b16 v[208:209], v6 offset:28672
  v_readlane_b32 s50, v15, 6
  v_mfma_f32_16x16x32_bf16 v[132:135], v[176:179], v[60:63], v[132:135]
  ds_read_b64_tr_b16 v[210:211], v6 offset:29184
  v_mfma_f32_16x16x32_bf16 v[140:143], v[180:183], v[60:63], v[140:143]
  ds_read_b64_tr_b16 v[212:213], v7 offset:28672
  v_mfma_f32_16x16x32_bf16 v[136:139], v[180:183], v[56:59], v[136:139]
  buffer_load_dwordx4 v[32:35], off, s[36:39], s50 offset:0
  v_mfma_f32_16x16x32_bf16 v[144:147], v[184:187], v[56:59], v[144:147]
  ds_read_b64_tr_b16 v[214:215], v7 offset:29184
  ds_read_b64_tr_b16 v[216:217], v8 offset:28672
  v_mfma_f32_16x16x32_bf16 v[148:151], v[184:187], v[60:63], v[148:151]
  ds_read_b64_tr_b16 v[218:219], v8 offset:29184
  ds_read_b64_tr_b16 v[220:221], v9 offset:28672
  v_mfma_f32_16x16x32_bf16 v[156:159], v[188:191], v[60:63], v[156:159]
  buffer_load_dwordx4 v[36:39], off, s[64:67], s50 offset:0
  v_mfma_f32_16x16x32_bf16 v[152:155], v[188:191], v[56:59], v[152:155]
  ds_read_b64_tr_b16 v[222:223], v9 offset:29184
  s_waitcnt lgkmcnt(8)
  v_mfma_f32_16x16x32_bf16 v[96:99], v[192:195], v[48:51], v[96:99]
  ds_read_b64_tr_b16 v[160:161], v6 offset:32768
  v_mfma_f32_16x16x32_bf16 v[100:103], v[192:195], v[52:55], v[100:103]
  buffer_load_dwordx4 v[40:43], off, s[36:39], s50 offset:1024
  v_mfma_f32_16x16x32_bf16 v[108:111], v[196:199], v[52:55], v[108:111]
  ds_read_b64_tr_b16 v[162:163], v6 offset:33280
  ds_read_b64_tr_b16 v[164:165], v7 offset:32768
  v_mfma_f32_16x16x32_bf16 v[104:107], v[196:199], v[48:51], v[104:107]
  ds_read_b64_tr_b16 v[166:167], v7 offset:33280
  v_mfma_f32_16x16x32_bf16 v[112:115], v[200:203], v[48:51], v[112:115]
  buffer_load_dwordx4 v[44:47], off, s[64:67], s50 offset:1024
  v_mfma_f32_16x16x32_bf16 v[116:119], v[200:203], v[52:55], v[116:119]
  ds_read_b64_tr_b16 v[168:169], v8 offset:32768
  ds_read_b64_tr_b16 v[170:171], v8 offset:33280
  v_mfma_f32_16x16x32_bf16 v[124:127], v[204:207], v[52:55], v[124:127]
  ds_read_b64_tr_b16 v[172:173], v9 offset:32768
  v_mfma_f32_16x16x32_bf16 v[120:123], v[204:207], v[48:51], v[120:123]
  ds_read_b64_tr_b16 v[174:175], v9 offset:33280
  s_waitcnt lgkmcnt(8)
  v_mfma_f32_16x16x32_bf16 v[96:99], v[208:211], v[56:59], v[96:99]
  ds_read_b64_tr_b16 v[176:177], v6 offset:36864
  v_mfma_f32_16x16x32_bf16 v[100:103], v[208:211], v[60:63], v[100:103]
  ds_read_b64_tr_b16 v[178:179], v6 offset:37376
  v_mfma_f32_16x16x32_bf16 v[108:111], v[212:215], v[60:63], v[108:111]
  ds_read_b64_tr_b16 v[180:181], v7 offset:36864
  v_mfma_f32_16x16x32_bf16 v[104:107], v[212:215], v[56:59], v[104:107]
  ds_read_b64_tr_b16 v[182:183], v7 offset:37376
  v_mfma_f32_16x16x32_bf16 v[112:115], v[216:219], v[56:59], v[112:115]
  ds_read_b64_tr_b16 v[184:185], v8 offset:36864
  v_mfma_f32_16x16x32_bf16 v[116:119], v[216:219], v[60:63], v[116:119]
  ds_read_b64_tr_b16 v[186:187], v8 offset:37376
  v_readlane_b32 s51, v15, 7
  v_mfma_f32_16x16x32_bf16 v[124:127], v[220:223], v[60:63], v[124:127]
  ds_read_b64_tr_b16 v[188:189], v9 offset:36864
  v_mfma_f32_16x16x32_bf16 v[120:123], v[220:223], v[56:59], v[120:123]
  ds_read_b64_tr_b16 v[190:191], v9 offset:37376
  s_waitcnt lgkmcnt(8)
  v_mfma_f32_16x16x32_bf16 v[128:131], v[160:163], v[64:67], v[128:131]
  buffer_load_dwordx4 v[48:51], off, s[36:39], s51 offset:0
  v_mfma_f32_16x16x32_bf16 v[132:135], v[160:163], v[68:71], v[132:135]
  ds_read_b64_tr_b16 v[192:193], v6 offset:40960
  ds_read_b64_tr_b16 v[194:195], v6 offset:41472
  v_mfma_f32_16x16x32_bf16 v[140:143], v[164:167], v[68:71], v[140:143]
  ds_read_b64_tr_b16 v[196:197], v7 offset:40960
  v_mfma_f32_16x16x32_bf16 v[136:139], v[164:167], v[64:67], v[136:139]
  buffer_load_dwordx4 v[52:55], off, s[64:67], s51 offset:0
  v_mfma_f32_16x16x32_bf16 v[144:147], v[168:171], v[64:67], v[144:147]
  ds_read_b64_tr_b16 v[198:199], v7 offset:41472
  ds_read_b64_tr_b16 v[200:201], v8 offset:40960
  v_mfma_f32_16x16x32_bf16 v[148:151], v[168:171], v[68:71], v[148:151]
  ds_read_b64_tr_b16 v[202:203], v8 offset:41472
  ds_read_b64_tr_b16 v[204:205], v9 offset:40960
  v_mfma_f32_16x16x32_bf16 v[156:159], v[172:175], v[68:71], v[156:159]
  buffer_load_dwordx4 v[56:59], off, s[36:39], s51 offset:1024
  v_mfma_f32_16x16x32_bf16 v[152:155], v[172:175], v[64:67], v[152:155]
  ds_read_b64_tr_b16 v[206:207], v9 offset:41472
  s_waitcnt lgkmcnt(8)
  v_mfma_f32_16x16x32_bf16 v[128:131], v[176:179], v[72:75], v[128:131]
  ds_read_b64_tr_b16 v[208:209], v6 offset:45056
  v_mfma_f32_16x16x32_bf16 v[132:135], v[176:179], v[76:79], v[132:135]
  buffer_load_dwordx4 v[60:63], off, s[64:67], s51 offset:1024
  v_mfma_f32_16x16x32_bf16 v[140:143], v[180:183], v[76:79], v[140:143]
  ds_read_b64_tr_b16 v[210:211], v6 offset:45568
  ds_read_b64_tr_b16 v[212:213], v7 offset:45056
  v_mfma_f32_16x16x32_bf16 v[136:139], v[180:183], v[72:75], v[136:139]
  ds_read_b64_tr_b16 v[214:215], v7 offset:45568
  v_mfma_f32_16x16x32_bf16 v[144:147], v[184:187], v[72:75], v[144:147]
  ds_read_b64_tr_b16 v[216:217], v8 offset:45056
  v_mfma_f32_16x16x32_bf16 v[148:151], v[184:187], v[76:79], v[148:151]
  ds_read_b64_tr_b16 v[218:219], v8 offset:45568
  v_mfma_f32_16x16x32_bf16 v[156:159], v[188:191], v[76:79], v[156:159]
  ds_read_b64_tr_b16 v[220:221], v9 offset:45056
  v_mfma_f32_16x16x32_bf16 v[152:155], v[188:191], v[72:75], v[152:155]
  ds_read_b64_tr_b16 v[222:223], v9 offset:45568
  s_waitcnt lgkmcnt(8)
  v_mfma_f32_16x16x32_bf16 v[96:99], v[192:195], v[64:67], v[96:99]
  ds_read_b64_tr_b16 v[160:161], v6 offset:49152
  v_mfma_f32_16x16x32_bf16 v[100:103], v[192:195], v[68:71], v[100:103]
  ds_read_b64_tr_b16 v[162:163], v6 offset:49664
  v_mfma_f32_16x16x32_bf16 v[108:111], v[196:199], v[68:71], v[108:111]
  ds_read_b64_tr_b16 v[164:165], v7 offset:49152
  v_mfma_f32_16x16x32_bf16 v[104:107], v[196:199], v[64:67], v[104:107]
  ds_read_b64_tr_b16 v[166:167], v7 offset:49664
  v_mfma_f32_16x16x32_bf16 v[112:115], v[200:203], v[64:67], v[112:115]
  ds_read_b64_tr_b16 v[168:169], v8 offset:49152
  v_mfma_f32_16x16x32_bf16 v[116:119], v[200:203], v[68:71], v[116:119]
  ds_read_b64_tr_b16 v[170:171], v8 offset:49664
  v_mfma_f32_16x16x32_bf16 v[124:127], v[204:207], v[68:71], v[124:127]
  ds_read_b64_tr_b16 v[172:173], v9 offset:49152
  v_mfma_f32_16x16x32_bf16 v[120:123], v[204:207], v[64:67], v[120:123]
  ds_read_b64_tr_b16 v[174:175], v9 offset:49664
  s_waitcnt lgkmcnt(8)
  v_mfma_f32_16x16x32_bf16 v[96:99], v[208:211], v[72:75], v[96:99]
  ds_read_b64_tr_b16 v[176:177], v6 offset:53248
  v_mfma_f32_16x16x32_bf16 v[100:103], v[208:211], v[76:79], v[100:103]
  ds_read_b64_tr_b16 v[178:179], v6 offset:53760
  v_mfma_f32_16x16x32_bf16 v[108:111], v[212:215], v[76:79], v[108:111]
  ds_read_b64_tr_b16 v[180:181], v7 offset:53248
  v_mfma_f32_16x16x32_bf16 v[104:107], v[212:215], v[72:75], v[104:107]
  ds_read_b64_tr_b16 v[182:183], v7 offset:53760
  v_mfma_f32_16x16x32_bf16 v[112:115], v[216:219], v[72:75], v[112:115]
  ds_read_b64_tr_b16 v[184:185], v8 offset:53248
  v_mfma_f32_16x16x32_bf16 v[116:119], v[216:219], v[76:79], v[116:119]
  ds_read_b64_tr_b16 v[186:187], v8 offset:53760
  v_readlane_b32 s48, v15, 8
  v_mfma_f32_16x16x32_bf16 v[124:127], v[220:223], v[76:79], v[124:127]
  ds_read_b64_tr_b16 v[188:189], v9 offset:53248
  v_mfma_f32_16x16x32_bf16 v[120:123], v[220:223], v[72:75], v[120:123]
  ds_read_b64_tr_b16 v[190:191], v9 offset:53760
  s_waitcnt vmcnt(18) lgkmcnt(8)
  v_mfma_f32_16x16x32_bf16 v[128:131], v[160:163], v[80:83], v[128:131]
  buffer_load_dwordx4 v[64:67], off, s[36:39], s48 offset:0
  v_mfma_f32_16x16x32_bf16 v[132:135], v[160:163], v[84:87], v[132:135]
  ds_read_b64_tr_b16 v[192:193], v6 offset:57344
  ds_read_b64_tr_b16 v[194:195], v6 offset:57856
  v_mfma_f32_16x16x32_bf16 v[140:143], v[164:167], v[84:87], v[140:143]
  ds_read_b64_tr_b16 v[196:197], v7 offset:57344
  v_mfma_f32_16x16x32_bf16 v[136:139], v[164:167], v[80:83], v[136:139]
  ds_read_b64_tr_b16 v[198:199], v7 offset:57856
  v_mfma_f32_16x16x32_bf16 v[144:147], v[168:171], v[80:83], v[144:147]
  ds_read_b64_tr_b16 v[200:201], v8 offset:57344
  v_mfma_f32_16x16x32_bf16 v[148:151], v[168:171], v[84:87], v[148:151]
  ds_read_b64_tr_b16 v[202:203], v8 offset:57856
  v_mfma_f32_16x16x32_bf16 v[156:159], v[172:175], v[84:87], v[156:159]
  ds_read_b64_tr_b16 v[204:205], v9 offset:57344
  v_mfma_f32_16x16x32_bf16 v[152:155], v[172:175], v[80:83], v[152:155]
  ds_read_b64_tr_b16 v[206:207], v9 offset:57856
  s_waitcnt vmcnt(17) lgkmcnt(8)
  v_mfma_f32_16x16x32_bf16 v[128:131], v[176:179], v[88:91], v[128:131]
  buffer_load_dwordx4 v[68:71], off, s[64:67], s48 offset:0
  v_mfma_f32_16x16x32_bf16 v[132:135], v[176:179], v[92:95], v[132:135]
  ds_read_b64_tr_b16 v[208:209], v6 offset:61440
  ds_read_b64_tr_b16 v[210:211], v6 offset:61952
  v_mfma_f32_16x16x32_bf16 v[140:143], v[180:183], v[92:95], v[140:143]
  ds_read_b64_tr_b16 v[212:213], v7 offset:61440
  v_mfma_f32_16x16x32_bf16 v[136:139], v[180:183], v[88:91], v[136:139]
  ds_read_b64_tr_b16 v[214:215], v7 offset:61952
  v_mfma_f32_16x16x32_bf16 v[144:147], v[184:187], v[88:91], v[144:147]
  ds_read_b64_tr_b16 v[216:217], v8 offset:61440
  v_mfma_f32_16x16x32_bf16 v[148:151], v[184:187], v[92:95], v[148:151]
  ds_read_b64_tr_b16 v[218:219], v8 offset:61952
  v_mfma_f32_16x16x32_bf16 v[156:159], v[188:191], v[92:95], v[156:159]
  ds_read_b64_tr_b16 v[220:221], v9 offset:61440
  v_mfma_f32_16x16x32_bf16 v[152:155], v[188:191], v[88:91], v[152:155]
  ds_read_b64_tr_b16 v[222:223], v9 offset:61952
  s_waitcnt lgkmcnt(8)
  v_mfma_f32_16x16x32_bf16 v[96:99], v[192:195], v[80:83], v[96:99]
  buffer_load_dwordx4 v[72:75], off, s[36:39], s48 offset:1024
  v_mfma_f32_16x16x32_bf16 v[100:103], v[192:195], v[84:87], v[100:103]
  ds_read_b64_tr_b16 v[160:161], v20 offset:0
  ds_read_b64_tr_b16 v[162:163], v20 offset:512
  v_mfma_f32_16x16x32_bf16 v[108:111], v[196:199], v[84:87], v[108:111]
  ds_read_b64_tr_b16 v[164:165], v21 offset:0
  v_mfma_f32_16x16x32_bf16 v[104:107], v[196:199], v[80:83], v[104:107]
  ds_read_b64_tr_b16 v[166:167], v21 offset:512
  v_mfma_f32_16x16x32_bf16 v[112:115], v[200:203], v[80:83], v[112:115]
  ds_read_b64_tr_b16 v[168:169], v22 offset:0
  v_mfma_f32_16x16x32_bf16 v[116:119], v[200:203], v[84:87], v[116:119]
  ds_read_b64_tr_b16 v[170:171], v22 offset:512
  v_mfma_f32_16x16x32_bf16 v[124:127], v[204:207], v[84:87], v[124:127]
  ds_read_b64_tr_b16 v[172:173], v23 offset:0
  v_mfma_f32_16x16x32_bf16 v[120:123], v[204:207], v[80:83], v[120:123]
  ds_read_b64_tr_b16 v[174:175], v23 offset:512
  s_waitcnt lgkmcnt(8)
  s_barrier
  v_mfma_f32_16x16x32_bf16 v[96:99], v[208:211], v[88:91], v[96:99]
  buffer_load_dwordx4 v[76:79], off, s[64:67], s48 offset:1024
  v_mfma_f32_16x16x32_bf16 v[100:103], v[208:211], v[92:95], v[100:103]
  ds_read_b64_tr_b16 v[176:177], v20 offset:4096
  ds_read_b64_tr_b16 v[178:179], v20 offset:4608
  v_mfma_f32_16x16x32_bf16 v[108:111], v[212:215], v[92:95], v[108:111]
  ds_read_b64_tr_b16 v[180:181], v21 offset:4096
  v_mfma_f32_16x16x32_bf16 v[104:107], v[212:215], v[88:91], v[104:107]
  ds_read_b64_tr_b16 v[182:183], v21 offset:4608
  v_mfma_f32_16x16x32_bf16 v[112:115], v[216:219], v[88:91], v[112:115]
  ds_read_b64_tr_b16 v[184:185], v22 offset:4096
  v_mfma_f32_16x16x32_bf16 v[116:119], v[216:219], v[92:95], v[116:119]
  ds_read_b64_tr_b16 v[186:187], v22 offset:4608
  v_readlane_b32 s49, v15, 9
  v_mfma_f32_16x16x32_bf16 v[124:127], v[220:223], v[92:95], v[124:127]
  ds_read_b64_tr_b16 v[188:189], v23 offset:4096
  v_mfma_f32_16x16x32_bf16 v[120:123], v[220:223], v[88:91], v[120:123]
  ds_read_b64_tr_b16 v[190:191], v23 offset:4608
  s_waitcnt vmcnt(18) lgkmcnt(8)
  v_mfma_f32_16x16x32_bf16 v[128:131], v[160:163], v[224:227], v[128:131]
  buffer_load_dwordx4 v[80:83], off, s[36:39], s49 offset:0
  v_mfma_f32_16x16x32_bf16 v[132:135], v[160:163], v[228:231], v[132:135]
  ds_read_b64_tr_b16 v[192:193], v20 offset:8192
  ds_read_b64_tr_b16 v[194:195], v20 offset:8704
  v_mfma_f32_16x16x32_bf16 v[140:143], v[164:167], v[228:231], v[140:143]
  ds_read_b64_tr_b16 v[196:197], v21 offset:8192
  v_mfma_f32_16x16x32_bf16 v[136:139], v[164:167], v[224:227], v[136:139]
  ds_read_b64_tr_b16 v[198:199], v21 offset:8704
  v_mfma_f32_16x16x32_bf16 v[144:147], v[168:171], v[224:227], v[144:147]
  ds_read_b64_tr_b16 v[200:201], v22 offset:8192
  v_mfma_f32_16x16x32_bf16 v[148:151], v[168:171], v[228:231], v[148:151]
  ds_read_b64_tr_b16 v[202:203], v22 offset:8704
  v_mfma_f32_16x16x32_bf16 v[156:159], v[172:175], v[228:231], v[156:159]
  ds_read_b64_tr_b16 v[204:205], v23 offset:8192
  v_mfma_f32_16x16x32_bf16 v[152:155], v[172:175], v[224:227], v[152:155]
  ds_read_b64_tr_b16 v[206:207], v23 offset:8704
  s_waitcnt vmcnt(17) lgkmcnt(8)
  v_mfma_f32_16x16x32_bf16 v[128:131], v[176:179], v[232:235], v[128:131]
  buffer_load_dwordx4 v[84:87], off, s[64:67], s49 offset:0
  v_mfma_f32_16x16x32_bf16 v[132:135], v[176:179], v[236:239], v[132:135]
  ds_read_b64_tr_b16 v[208:209], v20 offset:12288
  ds_read_b64_tr_b16 v[210:211], v20 offset:12800
  v_mfma_f32_16x16x32_bf16 v[140:143], v[180:183], v[236:239], v[140:143]
  ds_read_b64_tr_b16 v[212:213], v21 offset:12288
  v_mfma_f32_16x16x32_bf16 v[136:139], v[180:183], v[232:235], v[136:139]
  ds_read_b64_tr_b16 v[214:215], v21 offset:12800
  v_mfma_f32_16x16x32_bf16 v[144:147], v[184:187], v[232:235], v[144:147]
  ds_read_b64_tr_b16 v[216:217], v22 offset:12288
  v_mfma_f32_16x16x32_bf16 v[148:151], v[184:187], v[236:239], v[148:151]
  ds_read_b64_tr_b16 v[218:219], v22 offset:12800
  v_mfma_f32_16x16x32_bf16 v[156:159], v[188:191], v[236:239], v[156:159]
  ds_read_b64_tr_b16 v[220:221], v23 offset:12288
  v_mfma_f32_16x16x32_bf16 v[152:155], v[188:191], v[232:235], v[152:155]
  ds_read_b64_tr_b16 v[222:223], v23 offset:12800
  s_waitcnt lgkmcnt(8)
  v_mfma_f32_16x16x32_bf16 v[96:99], v[192:195], v[224:227], v[96:99]
  buffer_load_dwordx4 v[88:91], off, s[36:39], s49 offset:1024
  v_mfma_f32_16x16x32_bf16 v[100:103], v[192:195], v[228:231], v[100:103]
  ds_read_b64_tr_b16 v[160:161], v20 offset:16384
  ds_read_b64_tr_b16 v[162:163], v20 offset:16896
  v_mfma_f32_16x16x32_bf16 v[108:111], v[196:199], v[228:231], v[108:111]
  ds_read_b64_tr_b16 v[164:165], v21 offset:16384
  v_mfma_f32_16x16x32_bf16 v[104:107], v[196:199], v[224:227], v[104:107]
  ds_read_b64_tr_b16 v[166:167], v21 offset:16896
  v_mfma_f32_16x16x32_bf16 v[112:115], v[200:203], v[224:227], v[112:115]
  ds_read_b64_tr_b16 v[168:169], v22 offset:16384
  v_mfma_f32_16x16x32_bf16 v[116:119], v[200:203], v[228:231], v[116:119]
  ds_read_b64_tr_b16 v[170:171], v22 offset:16896
  v_mfma_f32_16x16x32_bf16 v[124:127], v[204:207], v[228:231], v[124:127]
  ds_read_b64_tr_b16 v[172:173], v23 offset:16384
  v_mfma_f32_16x16x32_bf16 v[120:123], v[204:207], v[224:227], v[120:123]
  ds_read_b64_tr_b16 v[174:175], v23 offset:16896
  s_waitcnt lgkmcnt(8)
  v_mfma_f32_16x16x32_bf16 v[96:99], v[208:211], v[232:235], v[96:99]
  buffer_load_dwordx4 v[92:95], off, s[64:67], s49 offset:1024
  v_mfma_f32_16x16x32_bf16 v[100:103], v[208:211], v[236:239], v[100:103]
  ds_read_b64_tr_b16 v[176:177], v20 offset:20480
  ds_read_b64_tr_b16 v[178:179], v20 offset:20992
  v_mfma_f32_16x16x32_bf16 v[108:111], v[212:215], v[236:239], v[108:111]
  ds_read_b64_tr_b16 v[180:181], v21 offset:20480
  v_mfma_f32_16x16x32_bf16 v[104:107], v[212:215], v[232:235], v[104:107]
  ds_read_b64_tr_b16 v[182:183], v21 offset:20992
  v_mfma_f32_16x16x32_bf16 v[112:115], v[216:219], v[232:235], v[112:115]
  ds_read_b64_tr_b16 v[184:185], v22 offset:20480
  v_mfma_f32_16x16x32_bf16 v[116:119], v[216:219], v[236:239], v[116:119]
  ds_read_b64_tr_b16 v[186:187], v22 offset:20992
  v_readlane_b32 s50, v15, 10
  v_mfma_f32_16x16x32_bf16 v[124:127], v[220:223], v[236:239], v[124:127]
  ds_read_b64_tr_b16 v[188:189], v23 offset:20480
  v_mfma_f32_16x16x32_bf16 v[120:123], v[220:223], v[232:235], v[120:123]
  ds_read_b64_tr_b16 v[190:191], v23 offset:20992
  s_waitcnt vmcnt(18) lgkmcnt(8)
  v_mfma_f32_16x16x32_bf16 v[128:131], v[160:163], v[240:243], v[128:131]
  buffer_load_dwordx4 v[224:227], off, s[36:39], s50 offset:0
  v_mfma_f32_16x16x32_bf16 v[132:135], v[160:163], v[244:247], v[132:135]
  ds_read_b64_tr_b16 v[192:193], v20 offset:24576
  ds_read_b64_tr_b16 v[194:195], v20 offset:25088
  v_mfma_f32_16x16x32_bf16 v[140:143], v[164:167], v[244:247], v[140:143]
  ds_read_b64_tr_b16 v[196:197], v21 offset:24576
  v_mfma_f32_16x16x32_bf16 v[136:139], v[164:167], v[240:243], v[136:139]
  ds_read_b64_tr_b16 v[198:199], v21 offset:25088
  v_mfma_f32_16x16x32_bf16 v[144:147], v[168:171], v[240:243], v[144:147]
  ds_read_b64_tr_b16 v[200:201], v22 offset:24576
  v_mfma_f32_16x16x32_bf16 v[148:151], v[168:171], v[244:247], v[148:151]
  ds_read_b64_tr_b16 v[202:203], v22 offset:25088
  v_mfma_f32_16x16x32_bf16 v[156:159], v[172:175], v[244:247], v[156:159]
  ds_read_b64_tr_b16 v[204:205], v23 offset:24576
  v_mfma_f32_16x16x32_bf16 v[152:155], v[172:175], v[240:243], v[152:155]
  ds_read_b64_tr_b16 v[206:207], v23 offset:25088
  s_waitcnt vmcnt(17) lgkmcnt(8)
  v_mfma_f32_16x16x32_bf16 v[128:131], v[176:179], v[248:251], v[128:131]
  buffer_load_dwordx4 v[228:231], off, s[64:67], s50 offset:0
  v_mfma_f32_16x16x32_bf16 v[132:135], v[176:179], v[252:255], v[132:135]
  ds_read_b64_tr_b16 v[208:209], v20 offset:28672
  ds_read_b64_tr_b16 v[210:211], v20 offset:29184
  v_mfma_f32_16x16x32_bf16 v[140:143], v[180:183], v[252:255], v[140:143]
  ds_read_b64_tr_b16 v[212:213], v21 offset:28672
  v_mfma_f32_16x16x32_bf16 v[136:139], v[180:183], v[248:251], v[136:139]
  ds_read_b64_tr_b16 v[214:215], v21 offset:29184
  v_mfma_f32_16x16x32_bf16 v[144:147], v[184:187], v[248:251], v[144:147]
  ds_read_b64_tr_b16 v[216:217], v22 offset:28672
  v_mfma_f32_16x16x32_bf16 v[148:151], v[184:187], v[252:255], v[148:151]
  ds_read_b64_tr_b16 v[218:219], v22 offset:29184
  v_mfma_f32_16x16x32_bf16 v[156:159], v[188:191], v[252:255], v[156:159]
  ds_read_b64_tr_b16 v[220:221], v23 offset:28672
  v_mfma_f32_16x16x32_bf16 v[152:155], v[188:191], v[248:251], v[152:155]
  ds_read_b64_tr_b16 v[222:223], v23 offset:29184
  s_waitcnt lgkmcnt(8)
  v_mfma_f32_16x16x32_bf16 v[96:99], v[192:195], v[240:243], v[96:99]
  buffer_load_dwordx4 v[232:235], off, s[36:39], s50 offset:1024
  v_mfma_f32_16x16x32_bf16 v[100:103], v[192:195], v[244:247], v[100:103]
  ds_read_b64_tr_b16 v[160:161], v20 offset:32768
  ds_read_b64_tr_b16 v[162:163], v20 offset:33280
  v_mfma_f32_16x16x32_bf16 v[108:111], v[196:199], v[244:247], v[108:111]
  ds_read_b64_tr_b16 v[164:165], v21 offset:32768
  v_mfma_f32_16x16x32_bf16 v[104:107], v[196:199], v[240:243], v[104:107]
  ds_read_b64_tr_b16 v[166:167], v21 offset:33280
  v_mfma_f32_16x16x32_bf16 v[112:115], v[200:203], v[240:243], v[112:115]
  ds_read_b64_tr_b16 v[168:169], v22 offset:32768
  v_mfma_f32_16x16x32_bf16 v[116:119], v[200:203], v[244:247], v[116:119]
  ds_read_b64_tr_b16 v[170:171], v22 offset:33280
  v_mfma_f32_16x16x32_bf16 v[124:127], v[204:207], v[244:247], v[124:127]
  ds_read_b64_tr_b16 v[172:173], v23 offset:32768
  v_mfma_f32_16x16x32_bf16 v[120:123], v[204:207], v[240:243], v[120:123]
  ds_read_b64_tr_b16 v[174:175], v23 offset:33280
  s_waitcnt lgkmcnt(8)
  s_barrier
  v_mfma_f32_16x16x32_bf16 v[96:99], v[208:211], v[248:251], v[96:99]
  buffer_load_dwordx4 v[236:239], off, s[64:67], s50 offset:1024
  v_mfma_f32_16x16x32_bf16 v[100:103], v[208:211], v[252:255], v[100:103]
  ds_read_b64_tr_b16 v[176:177], v20 offset:36864
  ds_read_b64_tr_b16 v[178:179], v20 offset:37376
  v_mfma_f32_16x16x32_bf16 v[108:111], v[212:215], v[252:255], v[108:111]
  ds_read_b64_tr_b16 v[180:181], v21 offset:36864
  v_mfma_f32_16x16x32_bf16 v[104:107], v[212:215], v[248:251], v[104:107]
  ds_read_b64_tr_b16 v[182:183], v21 offset:37376
  v_mfma_f32_16x16x32_bf16 v[112:115], v[216:219], v[248:251], v[112:115]
  ds_read_b64_tr_b16 v[184:185], v22 offset:36864
  v_mfma_f32_16x16x32_bf16 v[116:119], v[216:219], v[252:255], v[116:119]
  ds_read_b64_tr_b16 v[186:187], v22 offset:37376
  v_readlane_b32 s51, v15, 11
  v_mfma_f32_16x16x32_bf16 v[124:127], v[220:223], v[252:255], v[124:127]
  ds_read_b64_tr_b16 v[188:189], v23 offset:36864
  v_mfma_f32_16x16x32_bf16 v[120:123], v[220:223], v[248:251], v[120:123]
  ds_read_b64_tr_b16 v[190:191], v23 offset:37376
  s_waitcnt vmcnt(18) lgkmcnt(8)
  v_mfma_f32_16x16x32_bf16 v[128:131], v[160:163], v[32:35], v[128:131]
  buffer_load_dwordx4 v[240:243], off, s[36:39], s51 offset:0
  v_mfma_f32_16x16x32_bf16 v[132:135], v[160:163], v[36:39], v[132:135]
  ds_read_b64_tr_b16 v[192:193], v20 offset:40960
  ds_read_b64_tr_b16 v[194:195], v20 offset:41472
  v_mfma_f32_16x16x32_bf16 v[140:143], v[164:167], v[36:39], v[140:143]
  ds_read_b64_tr_b16 v[196:197], v21 offset:40960
  v_mfma_f32_16x16x32_bf16 v[136:139], v[164:167], v[32:35], v[136:139]
  ds_read_b64_tr_b16 v[198:199], v21 offset:41472
  v_mfma_f32_16x16x32_bf16 v[144:147], v[168:171], v[32:35], v[144:147]
  ds_read_b64_tr_b16 v[200:201], v22 offset:40960
  v_mfma_f32_16x16x32_bf16 v[148:151], v[168:171], v[36:39], v[148:151]
  ds_read_b64_tr_b16 v[202:203], v22 offset:41472
  v_mfma_f32_16x16x32_bf16 v[156:159], v[172:175], v[36:39], v[156:159]
  ds_read_b64_tr_b16 v[204:205], v23 offset:40960
  v_mfma_f32_16x16x32_bf16 v[152:155], v[172:175], v[32:35], v[152:155]
  ds_read_b64_tr_b16 v[206:207], v23 offset:41472
  s_waitcnt vmcnt(17) lgkmcnt(8)
  v_mfma_f32_16x16x32_bf16 v[128:131], v[176:179], v[40:43], v[128:131]
  buffer_load_dwordx4 v[244:247], off, s[64:67], s51 offset:0
  v_mfma_f32_16x16x32_bf16 v[132:135], v[176:179], v[44:47], v[132:135]
  ds_read_b64_tr_b16 v[208:209], v20 offset:45056
  ds_read_b64_tr_b16 v[210:211], v20 offset:45568
  v_mfma_f32_16x16x32_bf16 v[140:143], v[180:183], v[44:47], v[140:143]
  ds_read_b64_tr_b16 v[212:213], v21 offset:45056
  v_mfma_f32_16x16x32_bf16 v[136:139], v[180:183], v[40:43], v[136:139]
  ds_read_b64_tr_b16 v[214:215], v21 offset:45568
  v_mfma_f32_16x16x32_bf16 v[144:147], v[184:187], v[40:43], v[144:147]
  ds_read_b64_tr_b16 v[216:217], v22 offset:45056
  v_mfma_f32_16x16x32_bf16 v[148:151], v[184:187], v[44:47], v[148:151]
  ds_read_b64_tr_b16 v[218:219], v22 offset:45568
  v_mfma_f32_16x16x32_bf16 v[156:159], v[188:191], v[44:47], v[156:159]
  ds_read_b64_tr_b16 v[220:221], v23 offset:45056
  v_mfma_f32_16x16x32_bf16 v[152:155], v[188:191], v[40:43], v[152:155]
  ds_read_b64_tr_b16 v[222:223], v23 offset:45568
  s_waitcnt lgkmcnt(8)
  v_mfma_f32_16x16x32_bf16 v[96:99], v[192:195], v[32:35], v[96:99]
  buffer_load_dwordx4 v[248:251], off, s[36:39], s51 offset:1024
  v_mfma_f32_16x16x32_bf16 v[100:103], v[192:195], v[36:39], v[100:103]
  ds_read_b64_tr_b16 v[160:161], v20 offset:49152
  ds_read_b64_tr_b16 v[162:163], v20 offset:49664
  v_mfma_f32_16x16x32_bf16 v[108:111], v[196:199], v[36:39], v[108:111]
  ds_read_b64_tr_b16 v[164:165], v21 offset:49152
  v_mfma_f32_16x16x32_bf16 v[104:107], v[196:199], v[32:35], v[104:107]
  ds_read_b64_tr_b16 v[166:167], v21 offset:49664
  v_mfma_f32_16x16x32_bf16 v[112:115], v[200:203], v[32:35], v[112:115]
  ds_read_b64_tr_b16 v[168:169], v22 offset:49152
  v_mfma_f32_16x16x32_bf16 v[116:119], v[200:203], v[36:39], v[116:119]
  ds_read_b64_tr_b16 v[170:171], v22 offset:49664
  v_mfma_f32_16x16x32_bf16 v[124:127], v[204:207], v[36:39], v[124:127]
  ds_read_b64_tr_b16 v[172:173], v23 offset:49152
  v_mfma_f32_16x16x32_bf16 v[120:123], v[204:207], v[32:35], v[120:123]
  ds_read_b64_tr_b16 v[174:175], v23 offset:49664
  s_waitcnt lgkmcnt(8)
  v_mfma_f32_16x16x32_bf16 v[96:99], v[208:211], v[40:43], v[96:99]
  buffer_load_dwordx4 v[252:255], off, s[64:67], s51 offset:1024
  v_mfma_f32_16x16x32_bf16 v[100:103], v[208:211], v[44:47], v[100:103]
  ds_read_b64_tr_b16 v[176:177], v20 offset:53248
  ds_read_b64_tr_b16 v[178:179], v20 offset:53760
  v_mfma_f32_16x16x32_bf16 v[108:111], v[212:215], v[44:47], v[108:111]
  ds_read_b64_tr_b16 v[180:181], v21 offset:53248
  v_mfma_f32_16x16x32_bf16 v[104:107], v[212:215], v[40:43], v[104:107]
  ds_read_b64_tr_b16 v[182:183], v21 offset:53760
  v_mfma_f32_16x16x32_bf16 v[112:115], v[216:219], v[40:43], v[112:115]
  ds_read_b64_tr_b16 v[184:185], v22 offset:53248
  v_mfma_f32_16x16x32_bf16 v[116:119], v[216:219], v[44:47], v[116:119]
  ds_read_b64_tr_b16 v[186:187], v22 offset:53760
  v_readlane_b32 s48, v15, 12
  v_mfma_f32_16x16x32_bf16 v[124:127], v[220:223], v[44:47], v[124:127]
  ds_read_b64_tr_b16 v[188:189], v23 offset:53248
  v_mfma_f32_16x16x32_bf16 v[120:123], v[220:223], v[40:43], v[120:123]
  ds_read_b64_tr_b16 v[190:191], v23 offset:53760
  s_waitcnt vmcnt(18) lgkmcnt(8)
  v_mfma_f32_16x16x32_bf16 v[128:131], v[160:163], v[48:51], v[128:131]
  buffer_load_dwordx4 v[32:35], off, s[36:39], s48 offset:0
  v_mfma_f32_16x16x32_bf16 v[132:135], v[160:163], v[52:55], v[132:135]
  ds_read_b64_tr_b16 v[192:193], v20 offset:57344
  ds_read_b64_tr_b16 v[194:195], v20 offset:57856
  v_mfma_f32_16x16x32_bf16 v[140:143], v[164:167], v[52:55], v[140:143]
  ds_read_b64_tr_b16 v[196:197], v21 offset:57344
  v_mfma_f32_16x16x32_bf16 v[136:139], v[164:167], v[48:51], v[136:139]
  ds_read_b64_tr_b16 v[198:199], v21 offset:57856
  v_mfma_f32_16x16x32_bf16 v[144:147], v[168:171], v[48:51], v[144:147]
  ds_read_b64_tr_b16 v[200:201], v22 offset:57344
  v_mfma_f32_16x16x32_bf16 v[148:151], v[168:171], v[52:55], v[148:151]
  ds_read_b64_tr_b16 v[202:203], v22 offset:57856
  v_mfma_f32_16x16x32_bf16 v[156:159], v[172:175], v[52:55], v[156:159]
  ds_read_b64_tr_b16 v[204:205], v23 offset:57344
  v_mfma_f32_16x16x32_bf16 v[152:155], v[172:175], v[48:51], v[152:155]
  ds_read_b64_tr_b16 v[206:207], v23 offset:57856
  s_waitcnt vmcnt(17) lgkmcnt(8)
  v_mfma_f32_16x16x32_bf16 v[128:131], v[176:179], v[56:59], v[128:131]
  buffer_load_dwordx4 v[36:39], off, s[64:67], s48 offset:0
  v_mfma_f32_16x16x32_bf16 v[132:135], v[176:179], v[60:63], v[132:135]
  ds_read_b64_tr_b16 v[208:209], v20 offset:61440
  ds_read_b64_tr_b16 v[210:211], v20 offset:61952
  v_mfma_f32_16x16x32_bf16 v[140:143], v[180:183], v[60:63], v[140:143]
  ds_read_b64_tr_b16 v[212:213], v21 offset:61440
  v_mfma_f32_16x16x32_bf16 v[136:139], v[180:183], v[56:59], v[136:139]
  ds_read_b64_tr_b16 v[214:215], v21 offset:61952
  v_mfma_f32_16x16x32_bf16 v[144:147], v[184:187], v[56:59], v[144:147]
  ds_read_b64_tr_b16 v[216:217], v22 offset:61440
  v_mfma_f32_16x16x32_bf16 v[148:151], v[184:187], v[60:63], v[148:151]
  ds_read_b64_tr_b16 v[218:219], v22 offset:61952
  v_mfma_f32_16x16x32_bf16 v[156:159], v[188:191], v[60:63], v[156:159]
  ds_read_b64_tr_b16 v[220:221], v23 offset:61440
  v_mfma_f32_16x16x32_bf16 v[152:155], v[188:191], v[56:59], v[152:155]
  ds_read_b64_tr_b16 v[222:223], v23 offset:61952
  s_waitcnt lgkmcnt(8)
  v_mfma_f32_16x16x32_bf16 v[96:99], v[192:195], v[48:51], v[96:99]
  buffer_load_dwordx4 v[40:43], off, s[36:39], s48 offset:1024
  v_mfma_f32_16x16x32_bf16 v[100:103], v[192:195], v[52:55], v[100:103]
  ds_read_b64_tr_b16 v[160:161], v26 offset:0
  ds_read_b64_tr_b16 v[162:163], v26 offset:512
  v_mfma_f32_16x16x32_bf16 v[108:111], v[196:199], v[52:55], v[108:111]
  ds_read_b64_tr_b16 v[164:165], v27 offset:0
  v_mfma_f32_16x16x32_bf16 v[104:107], v[196:199], v[48:51], v[104:107]
  ds_read_b64_tr_b16 v[166:167], v27 offset:512
  v_mfma_f32_16x16x32_bf16 v[112:115], v[200:203], v[48:51], v[112:115]
  ds_read_b64_tr_b16 v[168:169], v28 offset:0
  v_mfma_f32_16x16x32_bf16 v[116:119], v[200:203], v[52:55], v[116:119]
  ds_read_b64_tr_b16 v[170:171], v28 offset:512
  v_mfma_f32_16x16x32_bf16 v[124:127], v[204:207], v[52:55], v[124:127]
  ds_read_b64_tr_b16 v[172:173], v29 offset:0
  v_mfma_f32_16x16x32_bf16 v[120:123], v[204:207], v[48:51], v[120:123]
  ds_read_b64_tr_b16 v[174:175], v29 offset:512
  s_waitcnt lgkmcnt(8)
  s_barrier
  v_mfma_f32_16x16x32_bf16 v[96:99], v[208:211], v[56:59], v[96:99]
  buffer_load_dwordx4 v[44:47], off, s[64:67], s48 offset:1024
  v_mfma_f32_16x16x32_bf16 v[100:103], v[208:211], v[60:63], v[100:103]
  ds_read_b64_tr_b16 v[176:177], v26 offset:4096
  ds_read_b64_tr_b16 v[178:179], v26 offset:4608
  v_mfma_f32_16x16x32_bf16 v[108:111], v[212:215], v[60:63], v[108:111]
  ds_read_b64_tr_b16 v[180:181], v27 offset:4096
  v_mfma_f32_16x16x32_bf16 v[104:107], v[212:215], v[56:59], v[104:107]
  ds_read_b64_tr_b16 v[182:183], v27 offset:4608
  v_mfma_f32_16x16x32_bf16 v[112:115], v[216:219], v[56:59], v[112:115]
  ds_read_b64_tr_b16 v[184:185], v28 offset:4096
  v_mfma_f32_16x16x32_bf16 v[116:119], v[216:219], v[60:63], v[116:119]
  ds_read_b64_tr_b16 v[186:187], v28 offset:4608
  v_readlane_b32 s49, v15, 13
  v_mfma_f32_16x16x32_bf16 v[124:127], v[220:223], v[60:63], v[124:127]
  ds_read_b64_tr_b16 v[188:189], v29 offset:4096
  v_mfma_f32_16x16x32_bf16 v[120:123], v[220:223], v[56:59], v[120:123]
  ds_read_b64_tr_b16 v[190:191], v29 offset:4608
  s_waitcnt vmcnt(18) lgkmcnt(8)
  v_mfma_f32_16x16x32_bf16 v[128:131], v[160:163], v[64:67], v[128:131]
  buffer_load_dwordx4 v[48:51], off, s[36:39], s49 offset:0
  v_mfma_f32_16x16x32_bf16 v[132:135], v[160:163], v[68:71], v[132:135]
  ds_read_b64_tr_b16 v[192:193], v26 offset:8192
  ds_read_b64_tr_b16 v[194:195], v26 offset:8704
  v_mfma_f32_16x16x32_bf16 v[140:143], v[164:167], v[68:71], v[140:143]
  ds_read_b64_tr_b16 v[196:197], v27 offset:8192
  v_mfma_f32_16x16x32_bf16 v[136:139], v[164:167], v[64:67], v[136:139]
  ds_read_b64_tr_b16 v[198:199], v27 offset:8704
  v_mfma_f32_16x16x32_bf16 v[144:147], v[168:171], v[64:67], v[144:147]
  ds_read_b64_tr_b16 v[200:201], v28 offset:8192
  v_mfma_f32_16x16x32_bf16 v[148:151], v[168:171], v[68:71], v[148:151]
  ds_read_b64_tr_b16 v[202:203], v28 offset:8704
  v_mfma_f32_16x16x32_bf16 v[156:159], v[172:175], v[68:71], v[156:159]
  ds_read_b64_tr_b16 v[204:205], v29 offset:8192
  v_mfma_f32_16x16x32_bf16 v[152:155], v[172:175], v[64:67], v[152:155]
  ds_read_b64_tr_b16 v[206:207], v29 offset:8704
  s_waitcnt vmcnt(17) lgkmcnt(8)
  v_mfma_f32_16x16x32_bf16 v[128:131], v[176:179], v[72:75], v[128:131]
  buffer_load_dwordx4 v[52:55], off, s[64:67], s49 offset:0
  v_mfma_f32_16x16x32_bf16 v[132:135], v[176:179], v[76:79], v[132:135]
  ds_read_b64_tr_b16 v[208:209], v26 offset:12288
  ds_read_b64_tr_b16 v[210:211], v26 offset:12800
  v_mfma_f32_16x16x32_bf16 v[140:143], v[180:183], v[76:79], v[140:143]
  ds_read_b64_tr_b16 v[212:213], v27 offset:12288
  v_mfma_f32_16x16x32_bf16 v[136:139], v[180:183], v[72:75], v[136:139]
  ds_read_b64_tr_b16 v[214:215], v27 offset:12800
  v_mfma_f32_16x16x32_bf16 v[144:147], v[184:187], v[72:75], v[144:147]
  ds_read_b64_tr_b16 v[216:217], v28 offset:12288
  v_mfma_f32_16x16x32_bf16 v[148:151], v[184:187], v[76:79], v[148:151]
  ds_read_b64_tr_b16 v[218:219], v28 offset:12800
  v_mfma_f32_16x16x32_bf16 v[156:159], v[188:191], v[76:79], v[156:159]
  ds_read_b64_tr_b16 v[220:221], v29 offset:12288
  v_mfma_f32_16x16x32_bf16 v[152:155], v[188:191], v[72:75], v[152:155]
  ds_read_b64_tr_b16 v[222:223], v29 offset:12800
  s_waitcnt lgkmcnt(8)
  v_mfma_f32_16x16x32_bf16 v[96:99], v[192:195], v[64:67], v[96:99]
  buffer_load_dwordx4 v[56:59], off, s[36:39], s49 offset:1024
  v_mfma_f32_16x16x32_bf16 v[100:103], v[192:195], v[68:71], v[100:103]
  ds_read_b64_tr_b16 v[160:161], v26 offset:16384
  ds_read_b64_tr_b16 v[162:163], v26 offset:16896
  v_mfma_f32_16x16x32_bf16 v[108:111], v[196:199], v[68:71], v[108:111]
  ds_read_b64_tr_b16 v[164:165], v27 offset:16384
  v_mfma_f32_16x16x32_bf16 v[104:107], v[196:199], v[64:67], v[104:107]
  ds_read_b64_tr_b16 v[166:167], v27 offset:16896
  v_mfma_f32_16x16x32_bf16 v[112:115], v[200:203], v[64:67], v[112:115]
  ds_read_b64_tr_b16 v[168:169], v28 offset:16384
  v_mfma_f32_16x16x32_bf16 v[116:119], v[200:203], v[68:71], v[116:119]
  ds_read_b64_tr_b16 v[170:171], v28 offset:16896
  v_mfma_f32_16x16x32_bf16 v[124:127], v[204:207], v[68:71], v[124:127]
  ds_read_b64_tr_b16 v[172:173], v29 offset:16384
  v_mfma_f32_16x16x32_bf16 v[120:123], v[204:207], v[64:67], v[120:123]
  ds_read_b64_tr_b16 v[174:175], v29 offset:16896
  s_waitcnt lgkmcnt(8)
  v_mfma_f32_16x16x32_bf16 v[96:99], v[208:211], v[72:75], v[96:99]
  buffer_load_dwordx4 v[60:63], off, s[64:67], s49 offset:1024
  v_mfma_f32_16x16x32_bf16 v[100:103], v[208:211], v[76:79], v[100:103]
  ds_read_b64_tr_b16 v[176:177], v26 offset:20480
  ds_read_b64_tr_b16 v[178:179], v26 offset:20992
  v_mfma_f32_16x16x32_bf16 v[108:111], v[212:215], v[76:79], v[108:111]
  ds_read_b64_tr_b16 v[180:181], v27 offset:20480
  v_mfma_f32_16x16x32_bf16 v[104:107], v[212:215], v[72:75], v[104:107]
  ds_read_b64_tr_b16 v[182:183], v27 offset:20992
  v_mfma_f32_16x16x32_bf16 v[112:115], v[216:219], v[72:75], v[112:115]
  ds_read_b64_tr_b16 v[184:185], v28 offset:20480
  v_mfma_f32_16x16x32_bf16 v[116:119], v[216:219], v[76:79], v[116:119]
  ds_read_b64_tr_b16 v[186:187], v28 offset:20992
  v_readlane_b32 s50, v15, 14
  v_mfma_f32_16x16x32_bf16 v[124:127], v[220:223], v[76:79], v[124:127]
  ds_read_b64_tr_b16 v[188:189], v29 offset:20480
  v_mfma_f32_16x16x32_bf16 v[120:123], v[220:223], v[72:75], v[120:123]
  ds_read_b64_tr_b16 v[190:191], v29 offset:20992
  s_waitcnt vmcnt(18) lgkmcnt(8)
  v_mfma_f32_16x16x32_bf16 v[128:131], v[160:163], v[80:83], v[128:131]
  buffer_load_dwordx4 v[64:67], off, s[36:39], s50 offset:0
  v_mfma_f32_16x16x32_bf16 v[132:135], v[160:163], v[84:87], v[132:135]
  ds_read_b64_tr_b16 v[192:193], v26 offset:24576
  ds_read_b64_tr_b16 v[194:195], v26 offset:25088
  v_mfma_f32_16x16x32_bf16 v[140:143], v[164:167], v[84:87], v[140:143]
  ds_read_b64_tr_b16 v[196:197], v27 offset:24576
  v_mfma_f32_16x16x32_bf16 v[136:139], v[164:167], v[80:83], v[136:139]
  ds_read_b64_tr_b16 v[198:199], v27 offset:25088
  v_mfma_f32_16x16x32_bf16 v[144:147], v[168:171], v[80:83], v[144:147]
  ds_read_b64_tr_b16 v[200:201], v28 offset:24576
  v_mfma_f32_16x16x32_bf16 v[148:151], v[168:171], v[84:87], v[148:151]
  ds_read_b64_tr_b16 v[202:203], v28 offset:25088
  v_mfma_f32_16x16x32_bf16 v[156:159], v[172:175], v[84:87], v[156:159]
  ds_read_b64_tr_b16 v[204:205], v29 offset:24576
  v_mfma_f32_16x16x32_bf16 v[152:155], v[172:175], v[80:83], v[152:155]
  ds_read_b64_tr_b16 v[206:207], v29 offset:25088
  s_waitcnt vmcnt(17) lgkmcnt(8)
  v_mfma_f32_16x16x32_bf16 v[128:131], v[176:179], v[88:91], v[128:131]
  buffer_load_dwordx4 v[68:71], off, s[64:67], s50 offset:0
  v_mfma_f32_16x16x32_bf16 v[132:135], v[176:179], v[92:95], v[132:135]
  ds_read_b64_tr_b16 v[208:209], v26 offset:28672
  ds_read_b64_tr_b16 v[210:211], v26 offset:29184
  v_mfma_f32_16x16x32_bf16 v[140:143], v[180:183], v[92:95], v[140:143]
  ds_read_b64_tr_b16 v[212:213], v27 offset:28672
  v_mfma_f32_16x16x32_bf16 v[136:139], v[180:183], v[88:91], v[136:139]
  ds_read_b64_tr_b16 v[214:215], v27 offset:29184
  v_mfma_f32_16x16x32_bf16 v[144:147], v[184:187], v[88:91], v[144:147]
  ds_read_b64_tr_b16 v[216:217], v28 offset:28672
  v_mfma_f32_16x16x32_bf16 v[148:151], v[184:187], v[92:95], v[148:151]
  ds_read_b64_tr_b16 v[218:219], v28 offset:29184
  v_mfma_f32_16x16x32_bf16 v[156:159], v[188:191], v[92:95], v[156:159]
  ds_read_b64_tr_b16 v[220:221], v29 offset:28672
  v_mfma_f32_16x16x32_bf16 v[152:155], v[188:191], v[88:91], v[152:155]
  ds_read_b64_tr_b16 v[222:223], v29 offset:29184
  s_waitcnt lgkmcnt(8)
  v_mfma_f32_16x16x32_bf16 v[96:99], v[192:195], v[80:83], v[96:99]
  buffer_load_dwordx4 v[72:75], off, s[36:39], s50 offset:1024
  v_mfma_f32_16x16x32_bf16 v[100:103], v[192:195], v[84:87], v[100:103]
  ds_read_b64_tr_b16 v[160:161], v6 offset:0
  ds_read_b64_tr_b16 v[162:163], v6 offset:512
  v_mfma_f32_16x16x32_bf16 v[108:111], v[196:199], v[84:87], v[108:111]
  ds_read_b64_tr_b16 v[164:165], v7 offset:0
  v_mfma_f32_16x16x32_bf16 v[104:107], v[196:199], v[80:83], v[104:107]
  ds_read_b64_tr_b16 v[166:167], v7 offset:512
  v_mfma_f32_16x16x32_bf16 v[112:115], v[200:203], v[80:83], v[112:115]
  ds_read_b64_tr_b16 v[168:169], v8 offset:0
  v_mfma_f32_16x16x32_bf16 v[116:119], v[200:203], v[84:87], v[116:119]
  ds_read_b64_tr_b16 v[170:171], v8 offset:512
  v_mfma_f32_16x16x32_bf16 v[124:127], v[204:207], v[84:87], v[124:127]
  ds_read_b64_tr_b16 v[172:173], v9 offset:0
  v_mfma_f32_16x16x32_bf16 v[120:123], v[204:207], v[80:83], v[120:123]
  ds_read_b64_tr_b16 v[174:175], v9 offset:512
  s_waitcnt lgkmcnt(8)
  s_barrier
  v_mfma_f32_16x16x32_bf16 v[96:99], v[208:211], v[88:91], v[96:99]
  buffer_load_dwordx4 v[76:79], off, s[64:67], s50 offset:1024
  v_mfma_f32_16x16x32_bf16 v[100:103], v[208:211], v[92:95], v[100:103]
  ds_read_b64_tr_b16 v[176:177], v6 offset:4096
  ds_read_b64_tr_b16 v[178:179], v6 offset:4608
  v_mfma_f32_16x16x32_bf16 v[108:111], v[212:215], v[92:95], v[108:111]
  ds_read_b64_tr_b16 v[180:181], v7 offset:4096
  v_mfma_f32_16x16x32_bf16 v[104:107], v[212:215], v[88:91], v[104:107]
  ds_read_b64_tr_b16 v[182:183], v7 offset:4608
  v_mfma_f32_16x16x32_bf16 v[112:115], v[216:219], v[88:91], v[112:115]
  ds_read_b64_tr_b16 v[184:185], v8 offset:4096
  v_mfma_f32_16x16x32_bf16 v[116:119], v[216:219], v[92:95], v[116:119]
  ds_read_b64_tr_b16 v[186:187], v8 offset:4608
  v_readlane_b32 s51, v15, 15
  v_mfma_f32_16x16x32_bf16 v[124:127], v[220:223], v[92:95], v[124:127]
  ds_read_b64_tr_b16 v[188:189], v9 offset:4096
  v_mfma_f32_16x16x32_bf16 v[120:123], v[220:223], v[88:91], v[120:123]
  ds_read_b64_tr_b16 v[190:191], v9 offset:4608
  s_waitcnt vmcnt(18) lgkmcnt(8)
  v_mfma_f32_16x16x32_bf16 v[128:131], v[160:163], v[224:227], v[128:131]
  buffer_load_dwordx4 v[80:83], off, s[36:39], s51 offset:0
  v_mfma_f32_16x16x32_bf16 v[132:135], v[160:163], v[228:231], v[132:135]
  ds_read_b64_tr_b16 v[192:193], v6 offset:8192
  ds_read_b64_tr_b16 v[194:195], v6 offset:8704
  v_mfma_f32_16x16x32_bf16 v[140:143], v[164:167], v[228:231], v[140:143]
  ds_read_b64_tr_b16 v[196:197], v7 offset:8192
  v_mfma_f32_16x16x32_bf16 v[136:139], v[164:167], v[224:227], v[136:139]
  ds_read_b64_tr_b16 v[198:199], v7 offset:8704
  v_mfma_f32_16x16x32_bf16 v[144:147], v[168:171], v[224:227], v[144:147]
  ds_read_b64_tr_b16 v[200:201], v8 offset:8192
  v_mfma_f32_16x16x32_bf16 v[148:151], v[168:171], v[228:231], v[148:151]
  ds_read_b64_tr_b16 v[202:203], v8 offset:8704
  v_mfma_f32_16x16x32_bf16 v[156:159], v[172:175], v[228:231], v[156:159]
  ds_read_b64_tr_b16 v[204:205], v9 offset:8192
  v_mfma_f32_16x16x32_bf16 v[152:155], v[172:175], v[224:227], v[152:155]
  ds_read_b64_tr_b16 v[206:207], v9 offset:8704
  s_waitcnt vmcnt(17) lgkmcnt(8)
  v_mfma_f32_16x16x32_bf16 v[128:131], v[176:179], v[232:235], v[128:131]
  buffer_load_dwordx4 v[84:87], off, s[64:67], s51 offset:0
  v_mfma_f32_16x16x32_bf16 v[132:135], v[176:179], v[236:239], v[132:135]
  ds_read_b64_tr_b16 v[208:209], v6 offset:12288
  ds_read_b64_tr_b16 v[210:211], v6 offset:12800
  v_mfma_f32_16x16x32_bf16 v[140:143], v[180:183], v[236:239], v[140:143]
  ds_read_b64_tr_b16 v[212:213], v7 offset:12288
  v_mfma_f32_16x16x32_bf16 v[136:139], v[180:183], v[232:235], v[136:139]
  ds_read_b64_tr_b16 v[214:215], v7 offset:12800
  v_mfma_f32_16x16x32_bf16 v[144:147], v[184:187], v[232:235], v[144:147]
  ds_read_b64_tr_b16 v[216:217], v8 offset:12288
  v_mfma_f32_16x16x32_bf16 v[148:151], v[184:187], v[236:239], v[148:151]
  ds_read_b64_tr_b16 v[218:219], v8 offset:12800
  v_mfma_f32_16x16x32_bf16 v[156:159], v[188:191], v[236:239], v[156:159]
  ds_read_b64_tr_b16 v[220:221], v9 offset:12288
  v_mfma_f32_16x16x32_bf16 v[152:155], v[188:191], v[232:235], v[152:155]
  ds_read_b64_tr_b16 v[222:223], v9 offset:12800
  s_waitcnt lgkmcnt(8)
  v_mfma_f32_16x16x32_bf16 v[96:99], v[192:195], v[224:227], v[96:99]
  buffer_load_dwordx4 v[88:91], off, s[36:39], s51 offset:1024
  v_mfma_f32_16x16x32_bf16 v[100:103], v[192:195], v[228:231], v[100:103]
  ds_read_b64_tr_b16 v[160:161], v6 offset:16384
  ds_read_b64_tr_b16 v[162:163], v6 offset:16896
  v_mfma_f32_16x16x32_bf16 v[108:111], v[196:199], v[228:231], v[108:111]
  ds_read_b64_tr_b16 v[164:165], v7 offset:16384
  v_mfma_f32_16x16x32_bf16 v[104:107], v[196:199], v[224:227], v[104:107]
  ds_read_b64_tr_b16 v[166:167], v7 offset:16896
  v_mfma_f32_16x16x32_bf16 v[112:115], v[200:203], v[224:227], v[112:115]
  ds_read_b64_tr_b16 v[168:169], v8 offset:16384
  v_mfma_f32_16x16x32_bf16 v[116:119], v[200:203], v[228:231], v[116:119]
  ds_read_b64_tr_b16 v[170:171], v8 offset:16896
  v_mfma_f32_16x16x32_bf16 v[124:127], v[204:207], v[228:231], v[124:127]
  ds_read_b64_tr_b16 v[172:173], v9 offset:16384
  v_mfma_f32_16x16x32_bf16 v[120:123], v[204:207], v[224:227], v[120:123]
  ds_read_b64_tr_b16 v[174:175], v9 offset:16896
  s_waitcnt lgkmcnt(8)
  v_mfma_f32_16x16x32_bf16 v[96:99], v[208:211], v[232:235], v[96:99]
  buffer_load_dwordx4 v[92:95], off, s[64:67], s51 offset:1024
  v_mfma_f32_16x16x32_bf16 v[100:103], v[208:211], v[236:239], v[100:103]
  ds_read_b64_tr_b16 v[176:177], v6 offset:20480
  ds_read_b64_tr_b16 v[178:179], v6 offset:20992
  v_mfma_f32_16x16x32_bf16 v[108:111], v[212:215], v[236:239], v[108:111]
  ds_read_b64_tr_b16 v[180:181], v7 offset:20480
  v_mfma_f32_16x16x32_bf16 v[104:107], v[212:215], v[232:235], v[104:107]
  ds_read_b64_tr_b16 v[182:183], v7 offset:20992
  v_mfma_f32_16x16x32_bf16 v[112:115], v[216:219], v[232:235], v[112:115]
  ds_read_b64_tr_b16 v[184:185], v8 offset:20480
  v_mfma_f32_16x16x32_bf16 v[116:119], v[216:219], v[236:239], v[116:119]
  ds_read_b64_tr_b16 v[186:187], v8 offset:20992
  v_readlane_b32 s48, v15, 16
  v_mfma_f32_16x16x32_bf16 v[124:127], v[220:223], v[236:239], v[124:127]
  ds_read_b64_tr_b16 v[188:189], v9 offset:20480
  v_mfma_f32_16x16x32_bf16 v[120:123], v[220:223], v[232:235], v[120:123]
  ds_read_b64_tr_b16 v[190:191], v9 offset:20992
  s_waitcnt vmcnt(18) lgkmcnt(8)
  v_mfma_f32_16x16x32_bf16 v[128:131], v[160:163], v[240:243], v[128:131]
  buffer_load_dwordx4 v[224:227], off, s[36:39], s48 offset:0
  v_mfma_f32_16x16x32_bf16 v[132:135], v[160:163], v[244:247], v[132:135]
  ds_read_b64_tr_b16 v[192:193], v6 offset:24576
  ds_read_b64_tr_b16 v[194:195], v6 offset:25088
  v_mfma_f32_16x16x32_bf16 v[140:143], v[164:167], v[244:247], v[140:143]
  ds_read_b64_tr_b16 v[196:197], v7 offset:24576
  v_mfma_f32_16x16x32_bf16 v[136:139], v[164:167], v[240:243], v[136:139]
  ds_read_b64_tr_b16 v[198:199], v7 offset:25088
  v_mfma_f32_16x16x32_bf16 v[144:147], v[168:171], v[240:243], v[144:147]
  ds_read_b64_tr_b16 v[200:201], v8 offset:24576
  v_mfma_f32_16x16x32_bf16 v[148:151], v[168:171], v[244:247], v[148:151]
  ds_read_b64_tr_b16 v[202:203], v8 offset:25088
  v_mfma_f32_16x16x32_bf16 v[156:159], v[172:175], v[244:247], v[156:159]
  ds_read_b64_tr_b16 v[204:205], v9 offset:24576
  v_mfma_f32_16x16x32_bf16 v[152:155], v[172:175], v[240:243], v[152:155]
  ds_read_b64_tr_b16 v[206:207], v9 offset:25088
  s_waitcnt vmcnt(17) lgkmcnt(8)
  v_mfma_f32_16x16x32_bf16 v[128:131], v[176:179], v[248:251], v[128:131]
  buffer_load_dwordx4 v[228:231], off, s[64:67], s48 offset:0
  v_mfma_f32_16x16x32_bf16 v[132:135], v[176:179], v[252:255], v[132:135]
  ds_read_b64_tr_b16 v[208:209], v6 offset:28672
  ds_read_b64_tr_b16 v[210:211], v6 offset:29184
  v_mfma_f32_16x16x32_bf16 v[140:143], v[180:183], v[252:255], v[140:143]
  ds_read_b64_tr_b16 v[212:213], v7 offset:28672
  v_mfma_f32_16x16x32_bf16 v[136:139], v[180:183], v[248:251], v[136:139]
  ds_read_b64_tr_b16 v[214:215], v7 offset:29184
  v_mfma_f32_16x16x32_bf16 v[144:147], v[184:187], v[248:251], v[144:147]
  ds_read_b64_tr_b16 v[216:217], v8 offset:28672
  v_mfma_f32_16x16x32_bf16 v[148:151], v[184:187], v[252:255], v[148:151]
  ds_read_b64_tr_b16 v[218:219], v8 offset:29184
  v_mfma_f32_16x16x32_bf16 v[156:159], v[188:191], v[252:255], v[156:159]
  ds_read_b64_tr_b16 v[220:221], v9 offset:28672
  v_mfma_f32_16x16x32_bf16 v[152:155], v[188:191], v[248:251], v[152:155]
  ds_read_b64_tr_b16 v[222:223], v9 offset:29184
  s_waitcnt lgkmcnt(8)
  v_mfma_f32_16x16x32_bf16 v[96:99], v[192:195], v[240:243], v[96:99]
  buffer_load_dwordx4 v[232:235], off, s[36:39], s48 offset:1024
  v_mfma_f32_16x16x32_bf16 v[100:103], v[192:195], v[244:247], v[100:103]
  ds_read_b64_tr_b16 v[160:161], v6 offset:32768
  ds_read_b64_tr_b16 v[162:163], v6 offset:33280
  v_mfma_f32_16x16x32_bf16 v[108:111], v[196:199], v[244:247], v[108:111]
  ds_read_b64_tr_b16 v[164:165], v7 offset:32768
  v_mfma_f32_16x16x32_bf16 v[104:107], v[196:199], v[240:243], v[104:107]
  ds_read_b64_tr_b16 v[166:167], v7 offset:33280
  v_mfma_f32_16x16x32_bf16 v[112:115], v[200:203], v[240:243], v[112:115]
  ds_read_b64_tr_b16 v[168:169], v8 offset:32768
  v_mfma_f32_16x16x32_bf16 v[116:119], v[200:203], v[244:247], v[116:119]
  ds_read_b64_tr_b16 v[170:171], v8 offset:33280
  v_mfma_f32_16x16x32_bf16 v[124:127], v[204:207], v[244:247], v[124:127]
  ds_read_b64_tr_b16 v[172:173], v9 offset:32768
  v_mfma_f32_16x16x32_bf16 v[120:123], v[204:207], v[240:243], v[120:123]
  ds_read_b64_tr_b16 v[174:175], v9 offset:33280
  s_waitcnt lgkmcnt(8)
  s_barrier
  v_mfma_f32_16x16x32_bf16 v[96:99], v[208:211], v[248:251], v[96:99]
  buffer_load_dwordx4 v[236:239], off, s[64:67], s48 offset:1024
  v_mfma_f32_16x16x32_bf16 v[100:103], v[208:211], v[252:255], v[100:103]
  ds_read_b64_tr_b16 v[176:177], v6 offset:36864
  ds_read_b64_tr_b16 v[178:179], v6 offset:37376
  v_mfma_f32_16x16x32_bf16 v[108:111], v[212:215], v[252:255], v[108:111]
  ds_read_b64_tr_b16 v[180:181], v7 offset:36864
  v_mfma_f32_16x16x32_bf16 v[104:107], v[212:215], v[248:251], v[104:107]
  ds_read_b64_tr_b16 v[182:183], v7 offset:37376
  v_mfma_f32_16x16x32_bf16 v[112:115], v[216:219], v[248:251], v[112:115]
  ds_read_b64_tr_b16 v[184:185], v8 offset:36864
  v_mfma_f32_16x16x32_bf16 v[116:119], v[216:219], v[252:255], v[116:119]
  ds_read_b64_tr_b16 v[186:187], v8 offset:37376
  v_readlane_b32 s49, v15, 17
  v_mfma_f32_16x16x32_bf16 v[124:127], v[220:223], v[252:255], v[124:127]
  ds_read_b64_tr_b16 v[188:189], v9 offset:36864
  v_mfma_f32_16x16x32_bf16 v[120:123], v[220:223], v[248:251], v[120:123]
  ds_read_b64_tr_b16 v[190:191], v9 offset:37376
  s_waitcnt vmcnt(18) lgkmcnt(8)
  v_mfma_f32_16x16x32_bf16 v[128:131], v[160:163], v[32:35], v[128:131]
  buffer_load_dwordx4 v[240:243], off, s[36:39], s49 offset:0
  v_mfma_f32_16x16x32_bf16 v[132:135], v[160:163], v[36:39], v[132:135]
  ds_read_b64_tr_b16 v[192:193], v6 offset:40960
  ds_read_b64_tr_b16 v[194:195], v6 offset:41472
  v_mfma_f32_16x16x32_bf16 v[140:143], v[164:167], v[36:39], v[140:143]
  ds_read_b64_tr_b16 v[196:197], v7 offset:40960
  v_mfma_f32_16x16x32_bf16 v[136:139], v[164:167], v[32:35], v[136:139]
  ds_read_b64_tr_b16 v[198:199], v7 offset:41472
  v_mfma_f32_16x16x32_bf16 v[144:147], v[168:171], v[32:35], v[144:147]
  ds_read_b64_tr_b16 v[200:201], v8 offset:40960
  v_mfma_f32_16x16x32_bf16 v[148:151], v[168:171], v[36:39], v[148:151]
  ds_read_b64_tr_b16 v[202:203], v8 offset:41472
  v_mfma_f32_16x16x32_bf16 v[156:159], v[172:175], v[36:39], v[156:159]
  ds_read_b64_tr_b16 v[204:205], v9 offset:40960
  v_mfma_f32_16x16x32_bf16 v[152:155], v[172:175], v[32:35], v[152:155]
  ds_read_b64_tr_b16 v[206:207], v9 offset:41472
  s_waitcnt vmcnt(17) lgkmcnt(8)
  v_mfma_f32_16x16x32_bf16 v[128:131], v[176:179], v[40:43], v[128:131]
  buffer_load_dwordx4 v[244:247], off, s[64:67], s49 offset:0
  v_mfma_f32_16x16x32_bf16 v[132:135], v[176:179], v[44:47], v[132:135]
  ds_read_b64_tr_b16 v[208:209], v6 offset:45056
  ds_read_b64_tr_b16 v[210:211], v6 offset:45568
  v_mfma_f32_16x16x32_bf16 v[140:143], v[180:183], v[44:47], v[140:143]
  ds_read_b64_tr_b16 v[212:213], v7 offset:45056
  v_mfma_f32_16x16x32_bf16 v[136:139], v[180:183], v[40:43], v[136:139]
  ds_read_b64_tr_b16 v[214:215], v7 offset:45568
  v_mfma_f32_16x16x32_bf16 v[144:147], v[184:187], v[40:43], v[144:147]
  ds_read_b64_tr_b16 v[216:217], v8 offset:45056
  v_mfma_f32_16x16x32_bf16 v[148:151], v[184:187], v[44:47], v[148:151]
  ds_read_b64_tr_b16 v[218:219], v8 offset:45568
  v_mfma_f32_16x16x32_bf16 v[156:159], v[188:191], v[44:47], v[156:159]
  ds_read_b64_tr_b16 v[220:221], v9 offset:45056
  v_mfma_f32_16x16x32_bf16 v[152:155], v[188:191], v[40:43], v[152:155]
  ds_read_b64_tr_b16 v[222:223], v9 offset:45568
  s_waitcnt lgkmcnt(8)
  v_mfma_f32_16x16x32_bf16 v[96:99], v[192:195], v[32:35], v[96:99]
  buffer_load_dwordx4 v[248:251], off, s[36:39], s49 offset:1024
  v_mfma_f32_16x16x32_bf16 v[100:103], v[192:195], v[36:39], v[100:103]
  ds_read_b64_tr_b16 v[160:161], v6 offset:49152
  ds_read_b64_tr_b16 v[162:163], v6 offset:49664
  v_mfma_f32_16x16x32_bf16 v[108:111], v[196:199], v[36:39], v[108:111]
  ds_read_b64_tr_b16 v[164:165], v7 offset:49152
  v_mfma_f32_16x16x32_bf16 v[104:107], v[196:199], v[32:35], v[104:107]
  ds_read_b64_tr_b16 v[166:167], v7 offset:49664
  v_mfma_f32_16x16x32_bf16 v[112:115], v[200:203], v[32:35], v[112:115]
  ds_read_b64_tr_b16 v[168:169], v8 offset:49152
  v_mfma_f32_16x16x32_bf16 v[116:119], v[200:203], v[36:39], v[116:119]
  ds_read_b64_tr_b16 v[170:171], v8 offset:49664
  v_mfma_f32_16x16x32_bf16 v[124:127], v[204:207], v[36:39], v[124:127]
  ds_read_b64_tr_b16 v[172:173], v9 offset:49152
  v_mfma_f32_16x16x32_bf16 v[120:123], v[204:207], v[32:35], v[120:123]
  ds_read_b64_tr_b16 v[174:175], v9 offset:49664
  s_waitcnt lgkmcnt(8)
  v_mfma_f32_16x16x32_bf16 v[96:99], v[208:211], v[40:43], v[96:99]
  buffer_load_dwordx4 v[252:255], off, s[64:67], s49 offset:1024
  v_mfma_f32_16x16x32_bf16 v[100:103], v[208:211], v[44:47], v[100:103]
  ds_read_b64_tr_b16 v[176:177], v6 offset:53248
  ds_read_b64_tr_b16 v[178:179], v6 offset:53760
  v_mfma_f32_16x16x32_bf16 v[108:111], v[212:215], v[44:47], v[108:111]
  ds_read_b64_tr_b16 v[180:181], v7 offset:53248
  v_mfma_f32_16x16x32_bf16 v[104:107], v[212:215], v[40:43], v[104:107]
  ds_read_b64_tr_b16 v[182:183], v7 offset:53760
  v_mfma_f32_16x16x32_bf16 v[112:115], v[216:219], v[40:43], v[112:115]
  ds_read_b64_tr_b16 v[184:185], v8 offset:53248
  v_mfma_f32_16x16x32_bf16 v[116:119], v[216:219], v[44:47], v[116:119]
  ds_read_b64_tr_b16 v[186:187], v8 offset:53760
  v_readlane_b32 s50, v15, 18
  v_mfma_f32_16x16x32_bf16 v[124:127], v[220:223], v[44:47], v[124:127]
  ds_read_b64_tr_b16 v[188:189], v9 offset:53248
  v_mfma_f32_16x16x32_bf16 v[120:123], v[220:223], v[40:43], v[120:123]
  ds_read_b64_tr_b16 v[190:191], v9 offset:53760
  s_waitcnt vmcnt(18) lgkmcnt(8)
  v_mfma_f32_16x16x32_bf16 v[128:131], v[160:163], v[48:51], v[128:131]
  buffer_load_dwordx4 v[32:35], off, s[36:39], s50 offset:0
  v_mfma_f32_16x16x32_bf16 v[132:135], v[160:163], v[52:55], v[132:135]
  ds_read_b64_tr_b16 v[192:193], v6 offset:57344
  ds_read_b64_tr_b16 v[194:195], v6 offset:57856
  v_mfma_f32_16x16x32_bf16 v[140:143], v[164:167], v[52:55], v[140:143]
  ds_read_b64_tr_b16 v[196:197], v7 offset:57344
  v_mfma_f32_16x16x32_bf16 v[136:139], v[164:167], v[48:51], v[136:139]
  ds_read_b64_tr_b16 v[198:199], v7 offset:57856
  v_mfma_f32_16x16x32_bf16 v[144:147], v[168:171], v[48:51], v[144:147]
  ds_read_b64_tr_b16 v[200:201], v8 offset:57344
  v_mfma_f32_16x16x32_bf16 v[148:151], v[168:171], v[52:55], v[148:151]
  ds_read_b64_tr_b16 v[202:203], v8 offset:57856
  v_mfma_f32_16x16x32_bf16 v[156:159], v[172:175], v[52:55], v[156:159]
  ds_read_b64_tr_b16 v[204:205], v9 offset:57344
  v_mfma_f32_16x16x32_bf16 v[152:155], v[172:175], v[48:51], v[152:155]
  ds_read_b64_tr_b16 v[206:207], v9 offset:57856
  s_waitcnt vmcnt(17) lgkmcnt(8)
  v_mfma_f32_16x16x32_bf16 v[128:131], v[176:179], v[56:59], v[128:131]
  buffer_load_dwordx4 v[36:39], off, s[64:67], s50 offset:0
  v_mfma_f32_16x16x32_bf16 v[132:135], v[176:179], v[60:63], v[132:135]
  ds_read_b64_tr_b16 v[208:209], v6 offset:61440
  ds_read_b64_tr_b16 v[210:211], v6 offset:61952
  v_mfma_f32_16x16x32_bf16 v[140:143], v[180:183], v[60:63], v[140:143]
  ds_read_b64_tr_b16 v[212:213], v7 offset:61440
  v_mfma_f32_16x16x32_bf16 v[136:139], v[180:183], v[56:59], v[136:139]
  ds_read_b64_tr_b16 v[214:215], v7 offset:61952
  v_mfma_f32_16x16x32_bf16 v[144:147], v[184:187], v[56:59], v[144:147]
  ds_read_b64_tr_b16 v[216:217], v8 offset:61440
  v_mfma_f32_16x16x32_bf16 v[148:151], v[184:187], v[60:63], v[148:151]
  ds_read_b64_tr_b16 v[218:219], v8 offset:61952
  v_mfma_f32_16x16x32_bf16 v[156:159], v[188:191], v[60:63], v[156:159]
  ds_read_b64_tr_b16 v[220:221], v9 offset:61440
  v_mfma_f32_16x16x32_bf16 v[152:155], v[188:191], v[56:59], v[152:155]
  ds_read_b64_tr_b16 v[222:223], v9 offset:61952
  s_waitcnt lgkmcnt(8)
  v_mfma_f32_16x16x32_bf16 v[96:99], v[192:195], v[48:51], v[96:99]
  buffer_load_dwordx4 v[40:43], off, s[36:39], s50 offset:1024
  v_mfma_f32_16x16x32_bf16 v[100:103], v[192:195], v[52:55], v[100:103]
  ds_read_b64_tr_b16 v[160:161], v20 offset:0
  ds_read_b64_tr_b16 v[162:163], v20 offset:512
  v_mfma_f32_16x16x32_bf16 v[108:111], v[196:199], v[52:55], v[108:111]
  ds_read_b64_tr_b16 v[164:165], v21 offset:0
  v_mfma_f32_16x16x32_bf16 v[104:107], v[196:199], v[48:51], v[104:107]
  ds_read_b64_tr_b16 v[166:167], v21 offset:512
  v_mfma_f32_16x16x32_bf16 v[112:115], v[200:203], v[48:51], v[112:115]
  ds_read_b64_tr_b16 v[168:169], v22 offset:0
  v_mfma_f32_16x16x32_bf16 v[116:119], v[200:203], v[52:55], v[116:119]
  ds_read_b64_tr_b16 v[170:171], v22 offset:512
  v_mfma_f32_16x16x32_bf16 v[124:127], v[204:207], v[52:55], v[124:127]
  ds_read_b64_tr_b16 v[172:173], v23 offset:0
  v_mfma_f32_16x16x32_bf16 v[120:123], v[204:207], v[48:51], v[120:123]
  ds_read_b64_tr_b16 v[174:175], v23 offset:512
  s_waitcnt lgkmcnt(8)
  s_barrier
  v_mfma_f32_16x16x32_bf16 v[96:99], v[208:211], v[56:59], v[96:99]
  buffer_load_dwordx4 v[44:47], off, s[64:67], s50 offset:1024
  v_mfma_f32_16x16x32_bf16 v[100:103], v[208:211], v[60:63], v[100:103]
  ds_read_b64_tr_b16 v[176:177], v20 offset:4096
  ds_read_b64_tr_b16 v[178:179], v20 offset:4608
  v_mfma_f32_16x16x32_bf16 v[108:111], v[212:215], v[60:63], v[108:111]
  ds_read_b64_tr_b16 v[180:181], v21 offset:4096
  v_mfma_f32_16x16x32_bf16 v[104:107], v[212:215], v[56:59], v[104:107]
  ds_read_b64_tr_b16 v[182:183], v21 offset:4608
  v_mfma_f32_16x16x32_bf16 v[112:115], v[216:219], v[56:59], v[112:115]
  ds_read_b64_tr_b16 v[184:185], v22 offset:4096
  v_mfma_f32_16x16x32_bf16 v[116:119], v[216:219], v[60:63], v[116:119]
  ds_read_b64_tr_b16 v[186:187], v22 offset:4608
  v_readlane_b32 s51, v15, 19
  v_mfma_f32_16x16x32_bf16 v[124:127], v[220:223], v[60:63], v[124:127]
  ds_read_b64_tr_b16 v[188:189], v23 offset:4096
  v_mfma_f32_16x16x32_bf16 v[120:123], v[220:223], v[56:59], v[120:123]
  ds_read_b64_tr_b16 v[190:191], v23 offset:4608
  s_waitcnt vmcnt(18) lgkmcnt(8)
  v_mfma_f32_16x16x32_bf16 v[128:131], v[160:163], v[64:67], v[128:131]
  buffer_load_dwordx4 v[48:51], off, s[36:39], s51 offset:0
  v_mfma_f32_16x16x32_bf16 v[132:135], v[160:163], v[68:71], v[132:135]
  ds_read_b64_tr_b16 v[192:193], v20 offset:8192
  ds_read_b64_tr_b16 v[194:195], v20 offset:8704
  v_mfma_f32_16x16x32_bf16 v[140:143], v[164:167], v[68:71], v[140:143]
  ds_read_b64_tr_b16 v[196:197], v21 offset:8192
  v_mfma_f32_16x16x32_bf16 v[136:139], v[164:167], v[64:67], v[136:139]
  ds_read_b64_tr_b16 v[198:199], v21 offset:8704
  v_mfma_f32_16x16x32_bf16 v[144:147], v[168:171], v[64:67], v[144:147]
  ds_read_b64_tr_b16 v[200:201], v22 offset:8192
  v_mfma_f32_16x16x32_bf16 v[148:151], v[168:171], v[68:71], v[148:151]
  ds_read_b64_tr_b16 v[202:203], v22 offset:8704
  v_mfma_f32_16x16x32_bf16 v[156:159], v[172:175], v[68:71], v[156:159]
  ds_read_b64_tr_b16 v[204:205], v23 offset:8192
  v_mfma_f32_16x16x32_bf16 v[152:155], v[172:175], v[64:67], v[152:155]
  ds_read_b64_tr_b16 v[206:207], v23 offset:8704
  s_waitcnt vmcnt(17) lgkmcnt(8)
  v_mfma_f32_16x16x32_bf16 v[128:131], v[176:179], v[72:75], v[128:131]
  buffer_load_dwordx4 v[52:55], off, s[64:67], s51 offset:0
  v_mfma_f32_16x16x32_bf16 v[132:135], v[176:179], v[76:79], v[132:135]
  ds_read_b64_tr_b16 v[208:209], v20 offset:12288
  ds_read_b64_tr_b16 v[210:211], v20 offset:12800
  v_mfma_f32_16x16x32_bf16 v[140:143], v[180:183], v[76:79], v[140:143]
  ds_read_b64_tr_b16 v[212:213], v21 offset:12288
  v_mfma_f32_16x16x32_bf16 v[136:139], v[180:183], v[72:75], v[136:139]
  ds_read_b64_tr_b16 v[214:215], v21 offset:12800
  v_mfma_f32_16x16x32_bf16 v[144:147], v[184:187], v[72:75], v[144:147]
  ds_read_b64_tr_b16 v[216:217], v22 offset:12288
  v_mfma_f32_16x16x32_bf16 v[148:151], v[184:187], v[76:79], v[148:151]
  ds_read_b64_tr_b16 v[218:219], v22 offset:12800
  v_mfma_f32_16x16x32_bf16 v[156:159], v[188:191], v[76:79], v[156:159]
  ds_read_b64_tr_b16 v[220:221], v23 offset:12288
  v_mfma_f32_16x16x32_bf16 v[152:155], v[188:191], v[72:75], v[152:155]
  ds_read_b64_tr_b16 v[222:223], v23 offset:12800
  s_waitcnt lgkmcnt(8)
  v_mfma_f32_16x16x32_bf16 v[96:99], v[192:195], v[64:67], v[96:99]
  buffer_load_dwordx4 v[56:59], off, s[36:39], s51 offset:1024
  v_mfma_f32_16x16x32_bf16 v[100:103], v[192:195], v[68:71], v[100:103]
  ds_read_b64_tr_b16 v[160:161], v20 offset:16384
  ds_read_b64_tr_b16 v[162:163], v20 offset:16896
  v_mfma_f32_16x16x32_bf16 v[108:111], v[196:199], v[68:71], v[108:111]
  ds_read_b64_tr_b16 v[164:165], v21 offset:16384
  v_mfma_f32_16x16x32_bf16 v[104:107], v[196:199], v[64:67], v[104:107]
  ds_read_b64_tr_b16 v[166:167], v21 offset:16896
  v_mfma_f32_16x16x32_bf16 v[112:115], v[200:203], v[64:67], v[112:115]
  ds_read_b64_tr_b16 v[168:169], v22 offset:16384
  v_mfma_f32_16x16x32_bf16 v[116:119], v[200:203], v[68:71], v[116:119]
  ds_read_b64_tr_b16 v[170:171], v22 offset:16896
  v_mfma_f32_16x16x32_bf16 v[124:127], v[204:207], v[68:71], v[124:127]
  ds_read_b64_tr_b16 v[172:173], v23 offset:16384
  v_mfma_f32_16x16x32_bf16 v[120:123], v[204:207], v[64:67], v[120:123]
  ds_read_b64_tr_b16 v[174:175], v23 offset:16896
  s_waitcnt lgkmcnt(8)
  v_mfma_f32_16x16x32_bf16 v[96:99], v[208:211], v[72:75], v[96:99]
  buffer_load_dwordx4 v[60:63], off, s[64:67], s51 offset:1024
  v_mfma_f32_16x16x32_bf16 v[100:103], v[208:211], v[76:79], v[100:103]
  ds_read_b64_tr_b16 v[176:177], v20 offset:20480
  ds_read_b64_tr_b16 v[178:179], v20 offset:20992
  v_mfma_f32_16x16x32_bf16 v[108:111], v[212:215], v[76:79], v[108:111]
  ds_read_b64_tr_b16 v[180:181], v21 offset:20480
  v_mfma_f32_16x16x32_bf16 v[104:107], v[212:215], v[72:75], v[104:107]
  ds_read_b64_tr_b16 v[182:183], v21 offset:20992
  v_mfma_f32_16x16x32_bf16 v[112:115], v[216:219], v[72:75], v[112:115]
  ds_read_b64_tr_b16 v[184:185], v22 offset:20480
  v_mfma_f32_16x16x32_bf16 v[116:119], v[216:219], v[76:79], v[116:119]
  ds_read_b64_tr_b16 v[186:187], v22 offset:20992
  v_readlane_b32 s48, v15, 20
  v_mfma_f32_16x16x32_bf16 v[124:127], v[220:223], v[76:79], v[124:127]
  ds_read_b64_tr_b16 v[188:189], v23 offset:20480
  v_mfma_f32_16x16x32_bf16 v[120:123], v[220:223], v[72:75], v[120:123]
  ds_read_b64_tr_b16 v[190:191], v23 offset:20992
  s_waitcnt vmcnt(18) lgkmcnt(8)
  v_mfma_f32_16x16x32_bf16 v[128:131], v[160:163], v[80:83], v[128:131]
  buffer_load_dwordx4 v[64:67], off, s[36:39], s48 offset:0
  v_mfma_f32_16x16x32_bf16 v[132:135], v[160:163], v[84:87], v[132:135]
  ds_read_b64_tr_b16 v[192:193], v20 offset:24576
  ds_read_b64_tr_b16 v[194:195], v20 offset:25088
  v_mfma_f32_16x16x32_bf16 v[140:143], v[164:167], v[84:87], v[140:143]
  ds_read_b64_tr_b16 v[196:197], v21 offset:24576
  v_mfma_f32_16x16x32_bf16 v[136:139], v[164:167], v[80:83], v[136:139]
  ds_read_b64_tr_b16 v[198:199], v21 offset:25088
  v_mfma_f32_16x16x32_bf16 v[144:147], v[168:171], v[80:83], v[144:147]
  ds_read_b64_tr_b16 v[200:201], v22 offset:24576
  v_mfma_f32_16x16x32_bf16 v[148:151], v[168:171], v[84:87], v[148:151]
  ds_read_b64_tr_b16 v[202:203], v22 offset:25088
  v_mfma_f32_16x16x32_bf16 v[156:159], v[172:175], v[84:87], v[156:159]
  ds_read_b64_tr_b16 v[204:205], v23 offset:24576
  v_mfma_f32_16x16x32_bf16 v[152:155], v[172:175], v[80:83], v[152:155]
  ds_read_b64_tr_b16 v[206:207], v23 offset:25088
  s_waitcnt vmcnt(17) lgkmcnt(8)
  v_mfma_f32_16x16x32_bf16 v[128:131], v[176:179], v[88:91], v[128:131]
  buffer_load_dwordx4 v[68:71], off, s[64:67], s48 offset:0
  v_mfma_f32_16x16x32_bf16 v[132:135], v[176:179], v[92:95], v[132:135]
  ds_read_b64_tr_b16 v[208:209], v20 offset:28672
  ds_read_b64_tr_b16 v[210:211], v20 offset:29184
  v_mfma_f32_16x16x32_bf16 v[140:143], v[180:183], v[92:95], v[140:143]
  ds_read_b64_tr_b16 v[212:213], v21 offset:28672
  v_mfma_f32_16x16x32_bf16 v[136:139], v[180:183], v[88:91], v[136:139]
  ds_read_b64_tr_b16 v[214:215], v21 offset:29184
  v_mfma_f32_16x16x32_bf16 v[144:147], v[184:187], v[88:91], v[144:147]
  ds_read_b64_tr_b16 v[216:217], v22 offset:28672
  v_mfma_f32_16x16x32_bf16 v[148:151], v[184:187], v[92:95], v[148:151]
  ds_read_b64_tr_b16 v[218:219], v22 offset:29184
  v_mfma_f32_16x16x32_bf16 v[156:159], v[188:191], v[92:95], v[156:159]
  ds_read_b64_tr_b16 v[220:221], v23 offset:28672
  v_mfma_f32_16x16x32_bf16 v[152:155], v[188:191], v[88:91], v[152:155]
  ds_read_b64_tr_b16 v[222:223], v23 offset:29184
  s_waitcnt lgkmcnt(8)
  v_mfma_f32_16x16x32_bf16 v[96:99], v[192:195], v[80:83], v[96:99]
  buffer_load_dwordx4 v[72:75], off, s[36:39], s48 offset:1024
  v_mfma_f32_16x16x32_bf16 v[100:103], v[192:195], v[84:87], v[100:103]
  ds_read_b64_tr_b16 v[160:161], v20 offset:32768
  ds_read_b64_tr_b16 v[162:163], v20 offset:33280
  v_mfma_f32_16x16x32_bf16 v[108:111], v[196:199], v[84:87], v[108:111]
  ds_read_b64_tr_b16 v[164:165], v21 offset:32768
  v_mfma_f32_16x16x32_bf16 v[104:107], v[196:199], v[80:83], v[104:107]
  ds_read_b64_tr_b16 v[166:167], v21 offset:33280
  v_mfma_f32_16x16x32_bf16 v[112:115], v[200:203], v[80:83], v[112:115]
  ds_read_b64_tr_b16 v[168:169], v22 offset:32768
  v_mfma_f32_16x16x32_bf16 v[116:119], v[200:203], v[84:87], v[116:119]
  ds_read_b64_tr_b16 v[170:171], v22 offset:33280
  v_mfma_f32_16x16x32_bf16 v[124:127], v[204:207], v[84:87], v[124:127]
  ds_read_b64_tr_b16 v[172:173], v23 offset:32768
  v_mfma_f32_16x16x32_bf16 v[120:123], v[204:207], v[80:83], v[120:123]
  ds_read_b64_tr_b16 v[174:175], v23 offset:33280
  s_waitcnt lgkmcnt(8)
  s_barrier
  v_mfma_f32_16x16x32_bf16 v[96:99], v[208:211], v[88:91], v[96:99]
  buffer_load_dwordx4 v[76:79], off, s[64:67], s48 offset:1024
  v_mfma_f32_16x16x32_bf16 v[100:103], v[208:211], v[92:95], v[100:103]
  ds_read_b64_tr_b16 v[176:177], v20 offset:36864
  ds_read_b64_tr_b16 v[178:179], v20 offset:37376
  v_mfma_f32_16x16x32_bf16 v[108:111], v[212:215], v[92:95], v[108:111]
  ds_read_b64_tr_b16 v[180:181], v21 offset:36864
  v_mfma_f32_16x16x32_bf16 v[104:107], v[212:215], v[88:91], v[104:107]
  ds_read_b64_tr_b16 v[182:183], v21 offset:37376
  v_mfma_f32_16x16x32_bf16 v[112:115], v[216:219], v[88:91], v[112:115]
  ds_read_b64_tr_b16 v[184:185], v22 offset:36864
  v_mfma_f32_16x16x32_bf16 v[116:119], v[216:219], v[92:95], v[116:119]
  ds_read_b64_tr_b16 v[186:187], v22 offset:37376
  v_readlane_b32 s49, v15, 21
  v_mfma_f32_16x16x32_bf16 v[124:127], v[220:223], v[92:95], v[124:127]
  ds_read_b64_tr_b16 v[188:189], v23 offset:36864
  v_mfma_f32_16x16x32_bf16 v[120:123], v[220:223], v[88:91], v[120:123]
  ds_read_b64_tr_b16 v[190:191], v23 offset:37376
  s_waitcnt vmcnt(18) lgkmcnt(8)
  v_mfma_f32_16x16x32_bf16 v[128:131], v[160:163], v[224:227], v[128:131]
  buffer_load_dwordx4 v[80:83], off, s[36:39], s49 offset:0
  v_mfma_f32_16x16x32_bf16 v[132:135], v[160:163], v[228:231], v[132:135]
  ds_read_b64_tr_b16 v[192:193], v20 offset:40960
  ds_read_b64_tr_b16 v[194:195], v20 offset:41472
  v_mfma_f32_16x16x32_bf16 v[140:143], v[164:167], v[228:231], v[140:143]
  ds_read_b64_tr_b16 v[196:197], v21 offset:40960
  v_mfma_f32_16x16x32_bf16 v[136:139], v[164:167], v[224:227], v[136:139]
  ds_read_b64_tr_b16 v[198:199], v21 offset:41472
  v_mfma_f32_16x16x32_bf16 v[144:147], v[168:171], v[224:227], v[144:147]
  ds_read_b64_tr_b16 v[200:201], v22 offset:40960
  v_mfma_f32_16x16x32_bf16 v[148:151], v[168:171], v[228:231], v[148:151]
  ds_read_b64_tr_b16 v[202:203], v22 offset:41472
  v_mfma_f32_16x16x32_bf16 v[156:159], v[172:175], v[228:231], v[156:159]
  ds_read_b64_tr_b16 v[204:205], v23 offset:40960
  v_mfma_f32_16x16x32_bf16 v[152:155], v[172:175], v[224:227], v[152:155]
  ds_read_b64_tr_b16 v[206:207], v23 offset:41472
  s_waitcnt vmcnt(17) lgkmcnt(8)
  v_mfma_f32_16x16x32_bf16 v[128:131], v[176:179], v[232:235], v[128:131]
  buffer_load_dwordx4 v[84:87], off, s[64:67], s49 offset:0
  v_mfma_f32_16x16x32_bf16 v[132:135], v[176:179], v[236:239], v[132:135]
  ds_read_b64_tr_b16 v[208:209], v20 offset:45056
  ds_read_b64_tr_b16 v[210:211], v20 offset:45568
  v_mfma_f32_16x16x32_bf16 v[140:143], v[180:183], v[236:239], v[140:143]
  ds_read_b64_tr_b16 v[212:213], v21 offset:45056
  v_mfma_f32_16x16x32_bf16 v[136:139], v[180:183], v[232:235], v[136:139]
  ds_read_b64_tr_b16 v[214:215], v21 offset:45568
  v_mfma_f32_16x16x32_bf16 v[144:147], v[184:187], v[232:235], v[144:147]
  ds_read_b64_tr_b16 v[216:217], v22 offset:45056
  v_mfma_f32_16x16x32_bf16 v[148:151], v[184:187], v[236:239], v[148:151]
  ds_read_b64_tr_b16 v[218:219], v22 offset:45568
  v_mfma_f32_16x16x32_bf16 v[156:159], v[188:191], v[236:239], v[156:159]
  ds_read_b64_tr_b16 v[220:221], v23 offset:45056
  v_mfma_f32_16x16x32_bf16 v[152:155], v[188:191], v[232:235], v[152:155]
  ds_read_b64_tr_b16 v[222:223], v23 offset:45568
  s_waitcnt lgkmcnt(8)
  v_mfma_f32_16x16x32_bf16 v[96:99], v[192:195], v[224:227], v[96:99]
  buffer_load_dwordx4 v[88:91], off, s[36:39], s49 offset:1024
  v_mfma_f32_16x16x32_bf16 v[100:103], v[192:195], v[228:231], v[100:103]
  ds_read_b64_tr_b16 v[160:161], v20 offset:49152
  ds_read_b64_tr_b16 v[162:163], v20 offset:49664
  v_mfma_f32_16x16x32_bf16 v[108:111], v[196:199], v[228:231], v[108:111]
  ds_read_b64_tr_b16 v[164:165], v21 offset:49152
  v_mfma_f32_16x16x32_bf16 v[104:107], v[196:199], v[224:227], v[104:107]
  ds_read_b64_tr_b16 v[166:167], v21 offset:49664
  v_mfma_f32_16x16x32_bf16 v[112:115], v[200:203], v[224:227], v[112:115]
  ds_read_b64_tr_b16 v[168:169], v22 offset:49152
  v_mfma_f32_16x16x32_bf16 v[116:119], v[200:203], v[228:231], v[116:119]
  ds_read_b64_tr_b16 v[170:171], v22 offset:49664
  v_mfma_f32_16x16x32_bf16 v[124:127], v[204:207], v[228:231], v[124:127]
  ds_read_b64_tr_b16 v[172:173], v23 offset:49152
  v_mfma_f32_16x16x32_bf16 v[120:123], v[204:207], v[224:227], v[120:123]
  ds_read_b64_tr_b16 v[174:175], v23 offset:49664
  s_waitcnt lgkmcnt(8)
  v_mfma_f32_16x16x32_bf16 v[96:99], v[208:211], v[232:235], v[96:99]
  buffer_load_dwordx4 v[92:95], off, s[64:67], s49 offset:1024
  v_mfma_f32_16x16x32_bf16 v[100:103], v[208:211], v[236:239], v[100:103]
  ds_read_b64_tr_b16 v[176:177], v20 offset:53248
  ds_read_b64_tr_b16 v[178:179], v20 offset:53760
  v_mfma_f32_16x16x32_bf16 v[108:111], v[212:215], v[236:239], v[108:111]
  ds_read_b64_tr_b16 v[180:181], v21 offset:53248
  v_mfma_f32_16x16x32_bf16 v[104:107], v[212:215], v[232:235], v[104:107]
  ds_read_b64_tr_b16 v[182:183], v21 offset:53760
  v_mfma_f32_16x16x32_bf16 v[112:115], v[216:219], v[232:235], v[112:115]
  ds_read_b64_tr_b16 v[184:185], v22 offset:53248
  v_mfma_f32_16x16x32_bf16 v[116:119], v[216:219], v[236:239], v[116:119]
  ds_read_b64_tr_b16 v[186:187], v22 offset:53760
  v_readlane_b32 s50, v15, 22
  v_mfma_f32_16x16x32_bf16 v[124:127], v[220:223], v[236:239], v[124:127]
  ds_read_b64_tr_b16 v[188:189], v23 offset:53248
  v_mfma_f32_16x16x32_bf16 v[120:123], v[220:223], v[232:235], v[120:123]
  ds_read_b64_tr_b16 v[190:191], v23 offset:53760
  s_waitcnt vmcnt(18) lgkmcnt(8)
  v_mfma_f32_16x16x32_bf16 v[128:131], v[160:163], v[240:243], v[128:131]
  buffer_load_dwordx4 v[224:227], off, s[36:39], s50 offset:0
  v_mfma_f32_16x16x32_bf16 v[132:135], v[160:163], v[244:247], v[132:135]
  ds_read_b64_tr_b16 v[192:193], v20 offset:57344
  ds_read_b64_tr_b16 v[194:195], v20 offset:57856
  v_mfma_f32_16x16x32_bf16 v[140:143], v[164:167], v[244:247], v[140:143]
  ds_read_b64_tr_b16 v[196:197], v21 offset:57344
  v_mfma_f32_16x16x32_bf16 v[136:139], v[164:167], v[240:243], v[136:139]
  ds_read_b64_tr_b16 v[198:199], v21 offset:57856
  v_mfma_f32_16x16x32_bf16 v[144:147], v[168:171], v[240:243], v[144:147]
  ds_read_b64_tr_b16 v[200:201], v22 offset:57344
  v_mfma_f32_16x16x32_bf16 v[148:151], v[168:171], v[244:247], v[148:151]
  ds_read_b64_tr_b16 v[202:203], v22 offset:57856
  v_mfma_f32_16x16x32_bf16 v[156:159], v[172:175], v[244:247], v[156:159]
  ds_read_b64_tr_b16 v[204:205], v23 offset:57344
  v_mfma_f32_16x16x32_bf16 v[152:155], v[172:175], v[240:243], v[152:155]
  ds_read_b64_tr_b16 v[206:207], v23 offset:57856
  s_waitcnt vmcnt(17) lgkmcnt(8)
  v_mfma_f32_16x16x32_bf16 v[128:131], v[176:179], v[248:251], v[128:131]
  buffer_load_dwordx4 v[228:231], off, s[64:67], s50 offset:0
  v_mfma_f32_16x16x32_bf16 v[132:135], v[176:179], v[252:255], v[132:135]
  ds_read_b64_tr_b16 v[208:209], v20 offset:61440
  ds_read_b64_tr_b16 v[210:211], v20 offset:61952
  v_mfma_f32_16x16x32_bf16 v[140:143], v[180:183], v[252:255], v[140:143]
  ds_read_b64_tr_b16 v[212:213], v21 offset:61440
  v_mfma_f32_16x16x32_bf16 v[136:139], v[180:183], v[248:251], v[136:139]
  ds_read_b64_tr_b16 v[214:215], v21 offset:61952
  v_mfma_f32_16x16x32_bf16 v[144:147], v[184:187], v[248:251], v[144:147]
  ds_read_b64_tr_b16 v[216:217], v22 offset:61440
  v_mfma_f32_16x16x32_bf16 v[148:151], v[184:187], v[252:255], v[148:151]
  ds_read_b64_tr_b16 v[218:219], v22 offset:61952
  v_mfma_f32_16x16x32_bf16 v[156:159], v[188:191], v[252:255], v[156:159]
  ds_read_b64_tr_b16 v[220:221], v23 offset:61440
  v_mfma_f32_16x16x32_bf16 v[152:155], v[188:191], v[248:251], v[152:155]
  ds_read_b64_tr_b16 v[222:223], v23 offset:61952
  s_waitcnt lgkmcnt(8)
  v_mfma_f32_16x16x32_bf16 v[96:99], v[192:195], v[240:243], v[96:99]
  buffer_load_dwordx4 v[232:235], off, s[36:39], s50 offset:1024
  v_mfma_f32_16x16x32_bf16 v[100:103], v[192:195], v[244:247], v[100:103]
  ds_read_b64_tr_b16 v[160:161], v26 offset:0
  ds_read_b64_tr_b16 v[162:163], v26 offset:512
  v_mfma_f32_16x16x32_bf16 v[108:111], v[196:199], v[244:247], v[108:111]
  ds_read_b64_tr_b16 v[164:165], v27 offset:0
  v_mfma_f32_16x16x32_bf16 v[104:107], v[196:199], v[240:243], v[104:107]
  ds_read_b64_tr_b16 v[166:167], v27 offset:512
  v_mfma_f32_16x16x32_bf16 v[112:115], v[200:203], v[240:243], v[112:115]
  ds_read_b64_tr_b16 v[168:169], v28 offset:0
  v_mfma_f32_16x16x32_bf16 v[116:119], v[200:203], v[244:247], v[116:119]
  ds_read_b64_tr_b16 v[170:171], v28 offset:512
  v_mfma_f32_16x16x32_bf16 v[124:127], v[204:207], v[244:247], v[124:127]
  ds_read_b64_tr_b16 v[172:173], v29 offset:0
  v_mfma_f32_16x16x32_bf16 v[120:123], v[204:207], v[240:243], v[120:123]
  ds_read_b64_tr_b16 v[174:175], v29 offset:512
  s_waitcnt lgkmcnt(8)
  s_barrier
  v_mfma_f32_16x16x32_bf16 v[96:99], v[208:211], v[248:251], v[96:99]
  buffer_load_dwordx4 v[236:239], off, s[64:67], s50 offset:1024
  v_mfma_f32_16x16x32_bf16 v[100:103], v[208:211], v[252:255], v[100:103]
  ds_read_b64_tr_b16 v[176:177], v26 offset:4096
  ds_read_b64_tr_b16 v[178:179], v26 offset:4608
  v_mfma_f32_16x16x32_bf16 v[108:111], v[212:215], v[252:255], v[108:111]
  ds_read_b64_tr_b16 v[180:181], v27 offset:4096
  v_mfma_f32_16x16x32_bf16 v[104:107], v[212:215], v[248:251], v[104:107]
  ds_read_b64_tr_b16 v[182:183], v27 offset:4608
  v_mfma_f32_16x16x32_bf16 v[112:115], v[216:219], v[248:251], v[112:115]
  ds_read_b64_tr_b16 v[184:185], v28 offset:4096
  v_mfma_f32_16x16x32_bf16 v[116:119], v[216:219], v[252:255], v[116:119]
  ds_read_b64_tr_b16 v[186:187], v28 offset:4608
  v_readlane_b32 s51, v15, 23
  v_mfma_f32_16x16x32_bf16 v[124:127], v[220:223], v[252:255], v[124:127]
  ds_read_b64_tr_b16 v[188:189], v29 offset:4096
  v_mfma_f32_16x16x32_bf16 v[120:123], v[220:223], v[248:251], v[120:123]
  ds_read_b64_tr_b16 v[190:191], v29 offset:4608
  s_waitcnt vmcnt(18) lgkmcnt(8)
  v_mfma_f32_16x16x32_bf16 v[128:131], v[160:163], v[32:35], v[128:131]
  buffer_load_dwordx4 v[240:243], off, s[36:39], s51 offset:0
  v_mfma_f32_16x16x32_bf16 v[132:135], v[160:163], v[36:39], v[132:135]
  ds_read_b64_tr_b16 v[192:193], v26 offset:8192
  ds_read_b64_tr_b16 v[194:195], v26 offset:8704
  v_mfma_f32_16x16x32_bf16 v[140:143], v[164:167], v[36:39], v[140:143]
  ds_read_b64_tr_b16 v[196:197], v27 offset:8192
  v_mfma_f32_16x16x32_bf16 v[136:139], v[164:167], v[32:35], v[136:139]
  ds_read_b64_tr_b16 v[198:199], v27 offset:8704
  v_mfma_f32_16x16x32_bf16 v[144:147], v[168:171], v[32:35], v[144:147]
  ds_read_b64_tr_b16 v[200:201], v28 offset:8192
  v_mfma_f32_16x16x32_bf16 v[148:151], v[168:171], v[36:39], v[148:151]
  ds_read_b64_tr_b16 v[202:203], v28 offset:8704
  v_mfma_f32_16x16x32_bf16 v[156:159], v[172:175], v[36:39], v[156:159]
  ds_read_b64_tr_b16 v[204:205], v29 offset:8192
  v_mfma_f32_16x16x32_bf16 v[152:155], v[172:175], v[32:35], v[152:155]
  ds_read_b64_tr_b16 v[206:207], v29 offset:8704
  s_waitcnt vmcnt(17) lgkmcnt(8)
  v_mfma_f32_16x16x32_bf16 v[128:131], v[176:179], v[40:43], v[128:131]
  buffer_load_dwordx4 v[244:247], off, s[64:67], s51 offset:0
  v_mfma_f32_16x16x32_bf16 v[132:135], v[176:179], v[44:47], v[132:135]
  ds_read_b64_tr_b16 v[208:209], v26 offset:12288
  ds_read_b64_tr_b16 v[210:211], v26 offset:12800
  v_mfma_f32_16x16x32_bf16 v[140:143], v[180:183], v[44:47], v[140:143]
  ds_read_b64_tr_b16 v[212:213], v27 offset:12288
  v_mfma_f32_16x16x32_bf16 v[136:139], v[180:183], v[40:43], v[136:139]
  ds_read_b64_tr_b16 v[214:215], v27 offset:12800
  v_mfma_f32_16x16x32_bf16 v[144:147], v[184:187], v[40:43], v[144:147]
  ds_read_b64_tr_b16 v[216:217], v28 offset:12288
  v_mfma_f32_16x16x32_bf16 v[148:151], v[184:187], v[44:47], v[148:151]
  ds_read_b64_tr_b16 v[218:219], v28 offset:12800
  v_mfma_f32_16x16x32_bf16 v[156:159], v[188:191], v[44:47], v[156:159]
  ds_read_b64_tr_b16 v[220:221], v29 offset:12288
  v_mfma_f32_16x16x32_bf16 v[152:155], v[188:191], v[40:43], v[152:155]
  ds_read_b64_tr_b16 v[222:223], v29 offset:12800
  s_waitcnt lgkmcnt(8)
  v_mfma_f32_16x16x32_bf16 v[96:99], v[192:195], v[32:35], v[96:99]
  buffer_load_dwordx4 v[248:251], off, s[36:39], s51 offset:1024
  v_mfma_f32_16x16x32_bf16 v[100:103], v[192:195], v[36:39], v[100:103]
  ds_read_b64_tr_b16 v[160:161], v26 offset:16384
  ds_read_b64_tr_b16 v[162:163], v26 offset:16896
  v_mfma_f32_16x16x32_bf16 v[108:111], v[196:199], v[36:39], v[108:111]
  ds_read_b64_tr_b16 v[164:165], v27 offset:16384
  v_mfma_f32_16x16x32_bf16 v[104:107], v[196:199], v[32:35], v[104:107]
  ds_read_b64_tr_b16 v[166:167], v27 offset:16896
  v_mfma_f32_16x16x32_bf16 v[112:115], v[200:203], v[32:35], v[112:115]
  ds_read_b64_tr_b16 v[168:169], v28 offset:16384
  v_mfma_f32_16x16x32_bf16 v[116:119], v[200:203], v[36:39], v[116:119]
  ds_read_b64_tr_b16 v[170:171], v28 offset:16896
  v_mfma_f32_16x16x32_bf16 v[124:127], v[204:207], v[36:39], v[124:127]
  ds_read_b64_tr_b16 v[172:173], v29 offset:16384
  v_mfma_f32_16x16x32_bf16 v[120:123], v[204:207], v[32:35], v[120:123]
  ds_read_b64_tr_b16 v[174:175], v29 offset:16896
  s_waitcnt lgkmcnt(8)
  v_mfma_f32_16x16x32_bf16 v[96:99], v[208:211], v[40:43], v[96:99]
  buffer_load_dwordx4 v[252:255], off, s[64:67], s51 offset:1024
  v_mfma_f32_16x16x32_bf16 v[100:103], v[208:211], v[44:47], v[100:103]
  ds_read_b64_tr_b16 v[176:177], v26 offset:20480
  ds_read_b64_tr_b16 v[178:179], v26 offset:20992
  v_mfma_f32_16x16x32_bf16 v[108:111], v[212:215], v[44:47], v[108:111]
  ds_read_b64_tr_b16 v[180:181], v27 offset:20480
  v_mfma_f32_16x16x32_bf16 v[104:107], v[212:215], v[40:43], v[104:107]
  ds_read_b64_tr_b16 v[182:183], v27 offset:20992
  v_mfma_f32_16x16x32_bf16 v[112:115], v[216:219], v[40:43], v[112:115]
  ds_read_b64_tr_b16 v[184:185], v28 offset:20480
  v_mfma_f32_16x16x32_bf16 v[116:119], v[216:219], v[44:47], v[116:119]
  ds_read_b64_tr_b16 v[186:187], v28 offset:20992
  v_readlane_b32 s48, v15, 24
  v_mfma_f32_16x16x32_bf16 v[124:127], v[220:223], v[44:47], v[124:127]
  ds_read_b64_tr_b16 v[188:189], v29 offset:20480
  v_mfma_f32_16x16x32_bf16 v[120:123], v[220:223], v[40:43], v[120:123]
  ds_read_b64_tr_b16 v[190:191], v29 offset:20992
  s_waitcnt vmcnt(18) lgkmcnt(8)
  v_mfma_f32_16x16x32_bf16 v[128:131], v[160:163], v[48:51], v[128:131]
  buffer_load_dwordx4 v[32:35], off, s[36:39], s48 offset:0
  v_mfma_f32_16x16x32_bf16 v[132:135], v[160:163], v[52:55], v[132:135]
  ds_read_b64_tr_b16 v[192:193], v26 offset:24576
  ds_read_b64_tr_b16 v[194:195], v26 offset:25088
  v_mfma_f32_16x16x32_bf16 v[140:143], v[164:167], v[52:55], v[140:143]
  ds_read_b64_tr_b16 v[196:197], v27 offset:24576
  v_mfma_f32_16x16x32_bf16 v[136:139], v[164:167], v[48:51], v[136:139]
  ds_read_b64_tr_b16 v[198:199], v27 offset:25088
  v_mfma_f32_16x16x32_bf16 v[144:147], v[168:171], v[48:51], v[144:147]
  ds_read_b64_tr_b16 v[200:201], v28 offset:24576
  v_mfma_f32_16x16x32_bf16 v[148:151], v[168:171], v[52:55], v[148:151]
  ds_read_b64_tr_b16 v[202:203], v28 offset:25088
  v_mfma_f32_16x16x32_bf16 v[156:159], v[172:175], v[52:55], v[156:159]
  ds_read_b64_tr_b16 v[204:205], v29 offset:24576
  v_mfma_f32_16x16x32_bf16 v[152:155], v[172:175], v[48:51], v[152:155]
  ds_read_b64_tr_b16 v[206:207], v29 offset:25088
  s_waitcnt vmcnt(17) lgkmcnt(8)
  v_mfma_f32_16x16x32_bf16 v[128:131], v[176:179], v[56:59], v[128:131]
  buffer_load_dwordx4 v[36:39], off, s[64:67], s48 offset:0
  v_mfma_f32_16x16x32_bf16 v[132:135], v[176:179], v[60:63], v[132:135]
  ds_read_b64_tr_b16 v[208:209], v26 offset:28672
  ds_read_b64_tr_b16 v[210:211], v26 offset:29184
  v_mfma_f32_16x16x32_bf16 v[140:143], v[180:183], v[60:63], v[140:143]
  ds_read_b64_tr_b16 v[212:213], v27 offset:28672
  v_mfma_f32_16x16x32_bf16 v[136:139], v[180:183], v[56:59], v[136:139]
  ds_read_b64_tr_b16 v[214:215], v27 offset:29184
  v_mfma_f32_16x16x32_bf16 v[144:147], v[184:187], v[56:59], v[144:147]
  ds_read_b64_tr_b16 v[216:217], v28 offset:28672
  v_mfma_f32_16x16x32_bf16 v[148:151], v[184:187], v[60:63], v[148:151]
  ds_read_b64_tr_b16 v[218:219], v28 offset:29184
  v_mfma_f32_16x16x32_bf16 v[156:159], v[188:191], v[60:63], v[156:159]
  ds_read_b64_tr_b16 v[220:221], v29 offset:28672
  v_mfma_f32_16x16x32_bf16 v[152:155], v[188:191], v[56:59], v[152:155]
  ds_read_b64_tr_b16 v[222:223], v29 offset:29184
  s_waitcnt lgkmcnt(8)
  v_mfma_f32_16x16x32_bf16 v[96:99], v[192:195], v[48:51], v[96:99]
  buffer_load_dwordx4 v[40:43], off, s[36:39], s48 offset:1024
  v_mfma_f32_16x16x32_bf16 v[100:103], v[192:195], v[52:55], v[100:103]
  ds_read_b64_tr_b16 v[160:161], v6 offset:0
  ds_read_b64_tr_b16 v[162:163], v6 offset:512
  v_mfma_f32_16x16x32_bf16 v[108:111], v[196:199], v[52:55], v[108:111]
  ds_read_b64_tr_b16 v[164:165], v7 offset:0
  v_cvt_pk_bf16_f32 v128, v128, v129
  v_mfma_f32_16x16x32_bf16 v[104:107], v[196:199], v[48:51], v[104:107]
  ds_read_b64_tr_b16 v[166:167], v7 offset:512
  v_cvt_pk_bf16_f32 v129, v130, v131
  v_mfma_f32_16x16x32_bf16 v[112:115], v[200:203], v[48:51], v[112:115]
  ds_read_b64_tr_b16 v[168:169], v8 offset:0
  v_cvt_pk_bf16_f32 v130, v132, v133
  v_mfma_f32_16x16x32_bf16 v[116:119], v[200:203], v[52:55], v[116:119]
  ds_read_b64_tr_b16 v[170:171], v8 offset:512
  v_cvt_pk_bf16_f32 v131, v134, v135
  v_mfma_f32_16x16x32_bf16 v[124:127], v[204:207], v[52:55], v[124:127]
  ds_read_b64_tr_b16 v[172:173], v9 offset:0
  buffer_store_dwordx4 v[128:131], off, s[60:63], s4 offset:0 sc1
  v_mfma_f32_16x16x32_bf16 v[120:123], v[204:207], v[48:51], v[120:123]
  ds_read_b64_tr_b16 v[174:175], v9 offset:512
  s_waitcnt lgkmcnt(8)
  s_barrier
  v_mfma_f32_16x16x32_bf16 v[96:99], v[208:211], v[56:59], v[96:99]
  ds_read_b64_tr_b16 v[176:177], v6 offset:4096
  buffer_load_dwordx4 v[44:47], off, s[64:67], s48 offset:1024
  v_mfma_f32_16x16x32_bf16 v[100:103], v[208:211], v[60:63], v[100:103]
  ds_read_b64_tr_b16 v[178:179], v6 offset:4608
  v_cvt_pk_bf16_f32 v132, v136, v137
  v_mfma_f32_16x16x32_bf16 v[108:111], v[212:215], v[60:63], v[108:111]
  ds_read_b64_tr_b16 v[180:181], v7 offset:4096
  v_cvt_pk_bf16_f32 v133, v138, v139
  v_mfma_f32_16x16x32_bf16 v[104:107], v[212:215], v[56:59], v[104:107]
  ds_read_b64_tr_b16 v[182:183], v7 offset:4608
  v_cvt_pk_bf16_f32 v134, v140, v141
  v_mfma_f32_16x16x32_bf16 v[112:115], v[216:219], v[56:59], v[112:115]
  ds_read_b64_tr_b16 v[184:185], v8 offset:4096
  v_cvt_pk_bf16_f32 v135, v142, v143
  v_mfma_f32_16x16x32_bf16 v[116:119], v[216:219], v[60:63], v[116:119]
  ds_read_b64_tr_b16 v[186:187], v8 offset:4608
  v_readlane_b32 s49, v15, 25
  v_mfma_f32_16x16x32_bf16 v[124:127], v[220:223], v[60:63], v[124:127]
  ds_read_b64_tr_b16 v[188:189], v9 offset:4096
  buffer_store_dwordx4 v[132:135], off, s[60:63], s4 offset:1024 sc1
  v_mfma_f32_16x16x32_bf16 v[120:123], v[220:223], v[56:59], v[120:123]
  ds_read_b64_tr_b16 v[190:191], v9 offset:4608
  s_waitcnt vmcnt(20) lgkmcnt(8)
  v_mfma_f32_16x16x32_bf16 v[96:99], v[160:163], v[64:67], v[96:99]
  ds_read_b64_tr_b16 v[192:193], v6 offset:8192
  buffer_load_dwordx4 v[48:51], off, s[36:39], s49 offset:0
  v_mfma_f32_16x16x32_bf16 v[100:103], v[160:163], v[68:71], v[100:103]
  ds_read_b64_tr_b16 v[194:195], v6 offset:8704
  v_cvt_pk_bf16_f32 v136, v144, v145
  v_mfma_f32_16x16x32_bf16 v[108:111], v[164:167], v[68:71], v[108:111]
  ds_read_b64_tr_b16 v[196:197], v7 offset:8192
  v_cvt_pk_bf16_f32 v137, v146, v147
  v_mfma_f32_16x16x32_bf16 v[104:107], v[164:167], v[64:67], v[104:107]
  ds_read_b64_tr_b16 v[198:199], v7 offset:8704
  v_cvt_pk_bf16_f32 v138, v148, v149
  v_mfma_f32_16x16x32_bf16 v[112:115], v[168:171], v[64:67], v[112:115]
  ds_read_b64_tr_b16 v[200:201], v8 offset:8192
  buffer_load_dwordx4 v[52:55], off, s[64:67], s49 offset:0
  v_mfma_f32_16x16x32_bf16 v[116:119], v[168:171], v[68:71], v[116:119]
  ds_read_b64_tr_b16 v[202:203], v8 offset:8704
  v_cvt_pk_bf16_f32 v139, v150, v151
  v_mfma_f32_16x16x32_bf16 v[124:127], v[172:175], v[68:71], v[124:127]
  ds_read_b64_tr_b16 v[204:205], v9 offset:8192
  buffer_store_dwordx4 v[136:139], off, s[60:63], s4 offset:2048 sc1
  v_mfma_f32_16x16x32_bf16 v[120:123], v[172:175], v[64:67], v[120:123]
  ds_read_b64_tr_b16 v[206:207], v9 offset:8704
  s_waitcnt vmcnt(21) lgkmcnt(8)
  v_mfma_f32_16x16x32_bf16 v[96:99], v[176:179], v[72:75], v[96:99]
  ds_read_b64_tr_b16 v[208:209], v6 offset:12288
  buffer_load_dwordx4 v[56:59], off, s[36:39], s49 offset:1024
  v_mfma_f32_16x16x32_bf16 v[100:103], v[176:179], v[76:79], v[100:103]
  ds_read_b64_tr_b16 v[210:211], v6 offset:12800
  v_cvt_pk_bf16_f32 v140, v152, v153
  v_mfma_f32_16x16x32_bf16 v[108:111], v[180:183], v[76:79], v[108:111]
  ds_read_b64_tr_b16 v[212:213], v7 offset:12288
  v_cvt_pk_bf16_f32 v141, v154, v155
  v_mfma_f32_16x16x32_bf16 v[104:107], v[180:183], v[72:75], v[104:107]
  ds_read_b64_tr_b16 v[214:215], v7 offset:12800
  v_cvt_pk_bf16_f32 v142, v156, v157
  v_mfma_f32_16x16x32_bf16 v[112:115], v[184:187], v[72:75], v[112:115]
  ds_read_b64_tr_b16 v[216:217], v8 offset:12288
  buffer_load_dwordx4 v[60:63], off, s[64:67], s49 offset:1024
  v_mfma_f32_16x16x32_bf16 v[116:119], v[184:187], v[76:79], v[116:119]
  ds_read_b64_tr_b16 v[218:219], v8 offset:12800
  v_cvt_pk_bf16_f32 v143, v158, v159
  v_mfma_f32_16x16x32_bf16 v[124:127], v[188:191], v[76:79], v[124:127]
  ds_read_b64_tr_b16 v[220:221], v9 offset:12288
  v_readlane_b32 s50, v15, 26
  v_mfma_f32_16x16x32_bf16 v[120:123], v[188:191], v[72:75], v[120:123]
  ds_read_b64_tr_b16 v[222:223], v9 offset:12800
  s_waitcnt vmcnt(21) lgkmcnt(8)
  v_mfma_f32_16x16x32_bf16 v[96:99], v[192:195], v[80:83], v[96:99]
  ds_read_b64_tr_b16 v[160:161], v6 offset:16384
  buffer_store_dwordx4 v[140:143], off, s[60:63], s4 offset:3072 sc1
  v_mfma_f32_16x16x32_bf16 v[100:103], v[192:195], v[84:87], v[100:103]
  buffer_load_dwordx4 v[64:67], off, s[36:39], s50 offset:0
  v_mfma_f32_16x16x32_bf16 v[108:111], v[196:199], v[84:87], v[108:111]
  ds_read_b64_tr_b16 v[162:163], v6 offset:16896
  ds_read_b64_tr_b16 v[164:165], v7 offset:16384
  v_mfma_f32_16x16x32_bf16 v[104:107], v[196:199], v[80:83], v[104:107]
  ds_read_b64_tr_b16 v[166:167], v7 offset:16896
  v_mfma_f32_16x16x32_bf16 v[112:115], v[200:203], v[80:83], v[112:115]
  ds_read_b64_tr_b16 v[168:169], v8 offset:16384
  v_mfma_f32_16x16x32_bf16 v[116:119], v[200:203], v[84:87], v[116:119]
  buffer_load_dwordx4 v[68:71], off, s[64:67], s50 offset:0
  v_mfma_f32_16x16x32_bf16 v[124:127], v[204:207], v[84:87], v[124:127]
  ds_read_b64_tr_b16 v[170:171], v8 offset:16896
  ds_read_b64_tr_b16 v[172:173], v9 offset:16384
  v_mfma_f32_16x16x32_bf16 v[120:123], v[204:207], v[80:83], v[120:123]
  ds_read_b64_tr_b16 v[174:175], v9 offset:16896
  s_waitcnt vmcnt(22) lgkmcnt(8)
  v_mfma_f32_16x16x32_bf16 v[96:99], v[208:211], v[88:91], v[96:99]
  ds_read_b64_tr_b16 v[176:177], v6 offset:20480
  v_mfma_f32_16x16x32_bf16 v[100:103], v[208:211], v[92:95], v[100:103]
  buffer_load_dwordx4 v[72:75], off, s[36:39], s50 offset:1024
  v_mfma_f32_16x16x32_bf16 v[108:111], v[212:215], v[92:95], v[108:111]
  ds_read_b64_tr_b16 v[178:179], v6 offset:20992
  ds_read_b64_tr_b16 v[180:181], v7 offset:20480
  v_mfma_f32_16x16x32_bf16 v[104:107], v[212:215], v[88:91], v[104:107]
  ds_read_b64_tr_b16 v[182:183], v7 offset:20992
  v_mfma_f32_16x16x32_bf16 v[112:115], v[216:219], v[88:91], v[112:115]
  ds_read_b64_tr_b16 v[184:185], v8 offset:20480
  v_mfma_f32_16x16x32_bf16 v[116:119], v[216:219], v[92:95], v[116:119]
  buffer_load_dwordx4 v[76:79], off, s[64:67], s50 offset:1024
  v_mfma_f32_16x16x32_bf16 v[124:127], v[220:223], v[92:95], v[124:127]
  ds_read_b64_tr_b16 v[186:187], v8 offset:20992
  ds_read_b64_tr_b16 v[188:189], v9 offset:20480
  v_mfma_f32_16x16x32_bf16 v[120:123], v[220:223], v[88:91], v[120:123]
  ds_read_b64_tr_b16 v[190:191], v9 offset:20992
  s_waitcnt vmcnt(22) lgkmcnt(8)
  v_mfma_f32_16x16x32_bf16 v[96:99], v[160:163], v[224:227], v[96:99]
  ds_read_b64_tr_b16 v[192:193], v6 offset:24576
  v_readlane_b32 s51, v15, 27
  v_mfma_f32_16x16x32_bf16 v[100:103], v[160:163], v[228:231], v[100:103]
  ds_read_b64_tr_b16 v[194:195], v6 offset:25088
  v_mfma_f32_16x16x32_bf16 v[108:111], v[164:167], v[228:231], v[108:111]
  ds_read_b64_tr_b16 v[196:197], v7 offset:24576
  v_mfma_f32_16x16x32_bf16 v[104:107], v[164:167], v[224:227], v[104:107]
  buffer_load_dwordx4 v[80:83], off, s[36:39], s51 offset:0
  v_mfma_f32_16x16x32_bf16 v[112:115], v[168:171], v[224:227], v[112:115]
  ds_read_b64_tr_b16 v[198:199], v7 offset:25088
  ds_read_b64_tr_b16 v[200:201], v8 offset:24576
  v_mfma_f32_16x16x32_bf16 v[116:119], v[168:171], v[228:231], v[116:119]
  ds_read_b64_tr_b16 v[202:203], v8 offset:25088
  v_mfma_f32_16x16x32_bf16 v[124:127], v[172:175], v[228:231], v[124:127]
  ds_read_b64_tr_b16 v[204:205], v9 offset:24576
  v_mfma_f32_16x16x32_bf16 v[120:123], v[172:175], v[224:227], v[120:123]
  ds_read_b64_tr_b16 v[206:207], v9 offset:25088
  s_waitcnt vmcnt(21) lgkmcnt(8)
  v_mfma_f32_16x16x32_bf16 v[96:99], v[176:179], v[232:235], v[96:99]
  buffer_load_dwordx4 v[84:87], off, s[64:67], s51 offset:0
  v_mfma_f32_16x16x32_bf16 v[100:103], v[176:179], v[236:239], v[100:103]
  ds_read_b64_tr_b16 v[208:209], v6 offset:28672
  ds_read_b64_tr_b16 v[210:211], v6 offset:29184
  v_mfma_f32_16x16x32_bf16 v[108:111], v[180:183], v[236:239], v[108:111]
  ds_read_b64_tr_b16 v[212:213], v7 offset:28672
  v_mfma_f32_16x16x32_bf16 v[104:107], v[180:183], v[232:235], v[104:107]
  ds_read_b64_tr_b16 v[214:215], v7 offset:29184
  v_mfma_f32_16x16x32_bf16 v[112:115], v[184:187], v[232:235], v[112:115]
  buffer_load_dwordx4 v[88:91], off, s[36:39], s51 offset:1024
  v_mfma_f32_16x16x32_bf16 v[116:119], v[184:187], v[236:239], v[116:119]
  ds_read_b64_tr_b16 v[216:217], v8 offset:28672
  ds_read_b64_tr_b16 v[218:219], v8 offset:29184
  v_mfma_f32_16x16x32_bf16 v[124:127], v[188:191], v[236:239], v[124:127]
  ds_read_b64_tr_b16 v[220:221], v9 offset:28672
  v_mfma_f32_16x16x32_bf16 v[120:123], v[188:191], v[232:235], v[120:123]
  ds_read_b64_tr_b16 v[222:223], v9 offset:29184
  s_waitcnt vmcnt(21) lgkmcnt(8)
  v_mfma_f32_16x16x32_bf16 v[96:99], v[192:195], v[240:243], v[96:99]
  ds_read_b64_tr_b16 v[160:161], v6 offset:32768
  buffer_load_dwordx4 v[92:95], off, s[64:67], s51 offset:1024
  v_mfma_f32_16x16x32_bf16 v[100:103], v[192:195], v[244:247], v[100:103]
  ds_read_b64_tr_b16 v[162:163], v6 offset:33280
  s_waitcnt vmcnt(8)
  v_mfma_f32_16x16x32_bf16 v[108:111], v[196:199], v[244:247], v[108:111]
  ds_read_b64_tr_b16 v[164:165], v7 offset:32768
  v_readlane_b32 s48, v15, 28
  v_mfma_f32_16x16x32_bf16 v[104:107], v[196:199], v[240:243], v[104:107]
  buffer_store_dword v19, off, s[52:55], s6 sc1
  v_mfma_f32_16x16x32_bf16 v[112:115], v[200:203], v[240:243], v[112:115]
  ds_read_b64_tr_b16 v[166:167], v7 offset:33280
  ds_read_b64_tr_b16 v[168:169], v8 offset:32768
  v_mfma_f32_16x16x32_bf16 v[116:119], v[200:203], v[244:247], v[116:119]
  buffer_load_dwordx4 v[224:227], off, s[36:39], s48 offset:0
  v_mfma_f32_16x16x32_bf16 v[124:127], v[204:207], v[244:247], v[124:127]
  ds_read_b64_tr_b16 v[170:171], v8 offset:33280
  ds_read_b64_tr_b16 v[172:173], v9 offset:32768
  v_mfma_f32_16x16x32_bf16 v[120:123], v[204:207], v[240:243], v[120:123]
  ds_read_b64_tr_b16 v[174:175], v9 offset:33280
  s_waitcnt lgkmcnt(8)
  v_mfma_f32_16x16x32_bf16 v[96:99], v[208:211], v[248:251], v[96:99]
  ds_read_b64_tr_b16 v[176:177], v6 offset:36864
  v_mfma_f32_16x16x32_bf16 v[100:103], v[208:211], v[252:255], v[100:103]
  buffer_load_dwordx4 v[228:231], off, s[64:67], s48 offset:0
  v_mfma_f32_16x16x32_bf16 v[108:111], v[212:215], v[252:255], v[108:111]
  ds_read_b64_tr_b16 v[178:179], v6 offset:37376
  ds_read_b64_tr_b16 v[180:181], v7 offset:36864
  v_mfma_f32_16x16x32_bf16 v[104:107], v[212:215], v[248:251], v[104:107]
  ds_read_b64_tr_b16 v[182:183], v7 offset:37376
  v_mfma_f32_16x16x32_bf16 v[112:115], v[216:219], v[248:251], v[112:115]
  ds_read_b64_tr_b16 v[184:185], v8 offset:36864
  v_mfma_f32_16x16x32_bf16 v[116:119], v[216:219], v[252:255], v[116:119]
  buffer_load_dwordx4 v[232:235], off, s[36:39], s48 offset:1024
  v_mfma_f32_16x16x32_bf16 v[124:127], v[220:223], v[252:255], v[124:127]
  ds_read_b64_tr_b16 v[186:187], v8 offset:37376
  ds_read_b64_tr_b16 v[188:189], v9 offset:36864
  v_mfma_f32_16x16x32_bf16 v[120:123], v[220:223], v[248:251], v[120:123]
  ds_read_b64_tr_b16 v[190:191], v9 offset:37376
  s_waitcnt lgkmcnt(8)
  v_mfma_f32_16x16x32_bf16 v[96:99], v[160:163], v[32:35], v[96:99]
  ds_read_b64_tr_b16 v[192:193], v6 offset:40960
  v_mfma_f32_16x16x32_bf16 v[100:103], v[160:163], v[36:39], v[100:103]
  buffer_load_dwordx4 v[236:239], off, s[64:67], s48 offset:1024
  v_mfma_f32_16x16x32_bf16 v[108:111], v[164:167], v[36:39], v[108:111]
  ds_read_b64_tr_b16 v[194:195], v6 offset:41472
  ds_read_b64_tr_b16 v[196:197], v7 offset:40960
  v_mfma_f32_16x16x32_bf16 v[104:107], v[164:167], v[32:35], v[104:107]
  ds_read_b64_tr_b16 v[198:199], v7 offset:41472
  v_readlane_b32 s49, v15, 29
  v_mfma_f32_16x16x32_bf16 v[112:115], v[168:171], v[32:35], v[112:115]
  ds_read_b64_tr_b16 v[200:201], v8 offset:40960
  v_mfma_f32_16x16x32_bf16 v[116:119], v[168:171], v[36:39], v[116:119]
  ds_read_b64_tr_b16 v[202:203], v8 offset:41472
  ds_read_b64_tr_b16 v[204:205], v9 offset:40960
  v_mfma_f32_16x16x32_bf16 v[124:127], v[172:175], v[36:39], v[124:127]
  buffer_load_dwordx4 v[240:243], off, s[36:39], s49 offset:0
  v_mfma_f32_16x16x32_bf16 v[120:123], v[172:175], v[32:35], v[120:123]
  ds_read_b64_tr_b16 v[206:207], v9 offset:41472
  s_waitcnt lgkmcnt(8)
  v_mfma_f32_16x16x32_bf16 v[96:99], v[176:179], v[40:43], v[96:99]
  ds_read_b64_tr_b16 v[208:209], v6 offset:45056
  v_mfma_f32_16x16x32_bf16 v[100:103], v[176:179], v[44:47], v[100:103]
  ds_read_b64_tr_b16 v[210:211], v6 offset:45568
  v_mfma_f32_16x16x32_bf16 v[108:111], v[180:183], v[44:47], v[108:111]
  buffer_load_dwordx4 v[244:247], off, s[64:67], s49 offset:0
  v_mfma_f32_16x16x32_bf16 v[104:107], v[180:183], v[40:43], v[104:107]
  ds_read_b64_tr_b16 v[212:213], v7 offset:45056
  ds_read_b64_tr_b16 v[214:215], v7 offset:45568
  v_mfma_f32_16x16x32_bf16 v[112:115], v[184:187], v[40:43], v[112:115]
  ds_read_b64_tr_b16 v[216:217], v8 offset:45056
  v_mfma_f32_16x16x32_bf16 v[116:119], v[184:187], v[44:47], v[116:119]
  ds_read_b64_tr_b16 v[218:219], v8 offset:45568
  ds_read_b64_tr_b16 v[220:221], v9 offset:45056
  v_mfma_f32_16x16x32_bf16 v[124:127], v[188:191], v[44:47], v[124:127]
  buffer_load_dwordx4 v[248:251], off, s[36:39], s49 offset:1024
  v_mfma_f32_16x16x32_bf16 v[120:123], v[188:191], v[40:43], v[120:123]
  ds_read_b64_tr_b16 v[222:223], v9 offset:45568
  s_waitcnt lgkmcnt(8)
  v_mfma_f32_16x16x32_bf16 v[96:99], v[192:195], v[48:51], v[96:99]
  ds_read_b64_tr_b16 v[160:161], v6 offset:49152
  v_mfma_f32_16x16x32_bf16 v[100:103], v[192:195], v[52:55], v[100:103]
  ds_read_b64_tr_b16 v[162:163], v6 offset:49664
  v_mfma_f32_16x16x32_bf16 v[108:111], v[196:199], v[52:55], v[108:111]
  buffer_load_dwordx4 v[252:255], off, s[64:67], s49 offset:1024
  v_mfma_f32_16x16x32_bf16 v[104:107], v[196:199], v[48:51], v[104:107]
  ds_read_b64_tr_b16 v[164:165], v7 offset:49152
  ds_read_b64_tr_b16 v[166:167], v7 offset:49664
  v_mfma_f32_16x16x32_bf16 v[112:115], v[200:203], v[48:51], v[112:115]
  ds_read_b64_tr_b16 v[168:169], v8 offset:49152
  v_readlane_b32 s50, v15, 30
  v_mfma_f32_16x16x32_bf16 v[116:119], v[200:203], v[52:55], v[116:119]
  ds_read_b64_tr_b16 v[170:171], v8 offset:49664
  v_mfma_f32_16x16x32_bf16 v[124:127], v[204:207], v[52:55], v[124:127]
  ds_read_b64_tr_b16 v[172:173], v9 offset:49152
  v_mfma_f32_16x16x32_bf16 v[120:123], v[204:207], v[48:51], v[120:123]
  ds_read_b64_tr_b16 v[174:175], v9 offset:49664
  s_waitcnt lgkmcnt(8)
  s_barrier
  v_mfma_f32_16x16x32_bf16 v[96:99], v[208:211], v[56:59], v[96:99]
  buffer_load_dwordx4 v[32:35], off, s[36:39], s50 offset:0
  v_mfma_f32_16x16x32_bf16 v[100:103], v[208:211], v[60:63], v[100:103]
  ds_read_b64_tr_b16 v[176:177], v6 offset:53248
  ds_read_b64_tr_b16 v[178:179], v6 offset:53760
  v_mfma_f32_16x16x32_bf16 v[108:111], v[212:215], v[60:63], v[108:111]
  ds_read_b64_tr_b16 v[180:181], v7 offset:53248
  v_mfma_f32_16x16x32_bf16 v[104:107], v[212:215], v[56:59], v[104:107]
  ds_read_b64_tr_b16 v[182:183], v7 offset:53760
  v_mfma_f32_16x16x32_bf16 v[112:115], v[216:219], v[56:59], v[112:115]
  buffer_load_dwordx4 v[36:39], off, s[64:67], s50 offset:0
  v_mfma_f32_16x16x32_bf16 v[116:119], v[216:219], v[60:63], v[116:119]
  ds_read_b64_tr_b16 v[184:185], v8 offset:53248
  ds_read_b64_tr_b16 v[186:187], v8 offset:53760
  v_mfma_f32_16x16x32_bf16 v[124:127], v[220:223], v[60:63], v[124:127]
  ds_read_b64_tr_b16 v[188:189], v9 offset:53248
  v_mfma_f32_16x16x32_bf16 v[120:123], v[220:223], v[56:59], v[120:123]
  ds_read_b64_tr_b16 v[190:191], v9 offset:53760
  s_waitcnt vmcnt(17) lgkmcnt(8)
  v_mfma_f32_16x16x32_bf16 v[96:99], v[160:163], v[64:67], v[96:99]
  buffer_load_dwordx4 v[40:43], off, s[36:39], s50 offset:1024
  v_mfma_f32_16x16x32_bf16 v[100:103], v[160:163], v[68:71], v[100:103]
  ds_read_b64_tr_b16 v[192:193], v6 offset:57344
  ds_read_b64_tr_b16 v[194:195], v6 offset:57856
  v_mfma_f32_16x16x32_bf16 v[108:111], v[164:167], v[68:71], v[108:111]
  ds_read_b64_tr_b16 v[196:197], v7 offset:57344
  v_mfma_f32_16x16x32_bf16 v[104:107], v[164:167], v[64:67], v[104:107]
  ds_read_b64_tr_b16 v[198:199], v7 offset:57856
  v_mfma_f32_16x16x32_bf16 v[112:115], v[168:171], v[64:67], v[112:115]
  buffer_load_dwordx4 v[44:47], off, s[64:67], s50 offset:1024
  v_mfma_f32_16x16x32_bf16 v[116:119], v[168:171], v[68:71], v[116:119]
  ds_read_b64_tr_b16 v[200:201], v8 offset:57344
  ds_read_b64_tr_b16 v[202:203], v8 offset:57856
  v_mfma_f32_16x16x32_bf16 v[124:127], v[172:175], v[68:71], v[124:127]
  ds_read_b64_tr_b16 v[204:205], v9 offset:57344
  v_readlane_b32 s51, v15, 31
  v_mfma_f32_16x16x32_bf16 v[120:123], v[172:175], v[64:67], v[120:123]
  ds_read_b64_tr_b16 v[206:207], v9 offset:57856
  s_waitcnt vmcnt(17) lgkmcnt(8)
  v_mfma_f32_16x16x32_bf16 v[96:99], v[176:179], v[72:75], v[96:99]
  ds_read_b64_tr_b16 v[208:209], v6 offset:61440
  v_mfma_f32_16x16x32_bf16 v[100:103], v[176:179], v[76:79], v[100:103]
  buffer_load_dwordx4 v[48:51], off, s[36:39], s51 offset:0
  v_mfma_f32_16x16x32_bf16 v[108:111], v[180:183], v[76:79], v[108:111]
  ds_read_b64_tr_b16 v[210:211], v6 offset:61952
  ds_read_b64_tr_b16 v[212:213], v7 offset:61440
  v_mfma_f32_16x16x32_bf16 v[104:107], v[180:183], v[72:75], v[104:107]
  ds_read_b64_tr_b16 v[214:215], v7 offset:61952
  v_mfma_f32_16x16x32_bf16 v[112:115], v[184:187], v[72:75], v[112:115]
  ds_read_b64_tr_b16 v[216:217], v8 offset:61440
  v_mfma_f32_16x16x32_bf16 v[116:119], v[184:187], v[76:79], v[116:119]
  buffer_load_dwordx4 v[52:55], off, s[64:67], s51 offset:0
  v_mfma_f32_16x16x32_bf16 v[124:127], v[188:191], v[76:79], v[124:127]
  ds_read_b64_tr_b16 v[218:219], v8 offset:61952
  ds_read_b64_tr_b16 v[220:221], v9 offset:61440
  v_mfma_f32_16x16x32_bf16 v[120:123], v[188:191], v[72:75], v[120:123]
  ds_read_b64_tr_b16 v[222:223], v9 offset:61952
  s_waitcnt vmcnt(17) lgkmcnt(8)
  v_mfma_f32_16x16x32_bf16 v[96:99], v[192:195], v[80:83], v[96:99]
  ds_read_b64_tr_b16 v[160:161], v20 offset:0
  v_mfma_f32_16x16x32_bf16 v[100:103], v[192:195], v[84:87], v[100:103]
  buffer_load_dwordx4 v[56:59], off, s[36:39], s51 offset:1024
  v_mfma_f32_16x16x32_bf16 v[108:111], v[196:199], v[84:87], v[108:111]
  ds_read_b64_tr_b16 v[162:163], v20 offset:512
  ds_read_b64_tr_b16 v[164:165], v21 offset:0
  v_mfma_f32_16x16x32_bf16 v[104:107], v[196:199], v[80:83], v[104:107]
  ds_read_b64_tr_b16 v[166:167], v21 offset:512
  v_mfma_f32_16x16x32_bf16 v[112:115], v[200:203], v[80:83], v[112:115]
  ds_read_b64_tr_b16 v[168:169], v22 offset:0
  v_mfma_f32_16x16x32_bf16 v[116:119], v[200:203], v[84:87], v[116:119]
  buffer_load_dwordx4 v[60:63], off, s[64:67], s51 offset:1024
  v_mfma_f32_16x16x32_bf16 v[124:127], v[204:207], v[84:87], v[124:127]
  ds_read_b64_tr_b16 v[170:171], v22 offset:512
  ds_read_b64_tr_b16 v[172:173], v23 offset:0
  v_mfma_f32_16x16x32_bf16 v[120:123], v[204:207], v[80:83], v[120:123]
  ds_read_b64_tr_b16 v[174:175], v23 offset:512
  s_waitcnt vmcnt(17) lgkmcnt(8)
  v_mfma_f32_16x16x32_bf16 v[96:99], v[208:211], v[88:91], v[96:99]
  ds_read_b64_tr_b16 v[176:177], v20 offset:4096
  v_readlane_b32 s48, v15, 32
  v_mfma_f32_16x16x32_bf16 v[100:103], v[208:211], v[92:95], v[100:103]
  ds_read_b64_tr_b16 v[178:179], v20 offset:4608
  v_mfma_f32_16x16x32_bf16 v[108:111], v[212:215], v[92:95], v[108:111]
  ds_read_b64_tr_b16 v[180:181], v21 offset:4096
  v_mfma_f32_16x16x32_bf16 v[104:107], v[212:215], v[88:91], v[104:107]
  buffer_load_dwordx4 v[64:67], off, s[36:39], s48 offset:0
  v_mfma_f32_16x16x32_bf16 v[112:115], v[216:219], v[88:91], v[112:115]
  ds_read_b64_tr_b16 v[182:183], v21 offset:4608
  ds_read_b64_tr_b16 v[184:185], v22 offset:4096
  v_mfma_f32_16x16x32_bf16 v[116:119], v[216:219], v[92:95], v[116:119]
  ds_read_b64_tr_b16 v[186:187], v22 offset:4608
  v_mfma_f32_16x16x32_bf16 v[124:127], v[220:223], v[92:95], v[124:127]
  ds_read_b64_tr_b16 v[188:189], v23 offset:4096
  v_mfma_f32_16x16x32_bf16 v[120:123], v[220:223], v[88:91], v[120:123]
  ds_read_b64_tr_b16 v[190:191], v23 offset:4608
  s_waitcnt vmcnt(15) lgkmcnt(8)
  v_mfma_f32_16x16x32_bf16 v[96:99], v[160:163], v[224:227], v[96:99]
  buffer_load_dwordx4 v[68:71], off, s[64:67], s48 offset:0
  v_mfma_f32_16x16x32_bf16 v[100:103], v[160:163], v[228:231], v[100:103]
  ds_read_b64_tr_b16 v[192:193], v20 offset:8192
  ds_read_b64_tr_b16 v[194:195], v20 offset:8704
  v_mfma_f32_16x16x32_bf16 v[108:111], v[164:167], v[228:231], v[108:111]
  ds_read_b64_tr_b16 v[196:197], v21 offset:8192
  v_mfma_f32_16x16x32_bf16 v[104:107], v[164:167], v[224:227], v[104:107]
  ds_read_b64_tr_b16 v[198:199], v21 offset:8704
  v_mfma_f32_16x16x32_bf16 v[112:115], v[168:171], v[224:227], v[112:115]
  buffer_load_dwordx4 v[72:75], off, s[36:39], s48 offset:1024
  v_mfma_f32_16x16x32_bf16 v[116:119], v[168:171], v[228:231], v[116:119]
  ds_read_b64_tr_b16 v[200:201], v22 offset:8192
  ds_read_b64_tr_b16 v[202:203], v22 offset:8704
  v_mfma_f32_16x16x32_bf16 v[124:127], v[172:175], v[228:231], v[124:127]
  ds_read_b64_tr_b16 v[204:205], v23 offset:8192
  v_mfma_f32_16x16x32_bf16 v[120:123], v[172:175], v[224:227], v[120:123]
  ds_read_b64_tr_b16 v[206:207], v23 offset:8704
  s_waitcnt vmcnt(15) lgkmcnt(8)
  v_mfma_f32_16x16x32_bf16 v[96:99], v[176:179], v[232:235], v[96:99]
  buffer_load_dwordx4 v[76:79], off, s[64:67], s48 offset:1024
  v_mfma_f32_16x16x32_bf16 v[100:103], v[176:179], v[236:239], v[100:103]
  ds_read_b64_tr_b16 v[208:209], v20 offset:12288
  ds_read_b64_tr_b16 v[210:211], v20 offset:12800
  v_mfma_f32_16x16x32_bf16 v[108:111], v[180:183], v[236:239], v[108:111]
  ds_read_b64_tr_b16 v[212:213], v21 offset:12288
  v_readlane_b32 s49, v15, 33
  v_mfma_f32_16x16x32_bf16 v[104:107], v[180:183], v[232:235], v[104:107]
  ds_read_b64_tr_b16 v[214:215], v21 offset:12800
  v_mfma_f32_16x16x32_bf16 v[112:115], v[184:187], v[232:235], v[112:115]
  ds_read_b64_tr_b16 v[216:217], v22 offset:12288
  v_mfma_f32_16x16x32_bf16 v[116:119], v[184:187], v[236:239], v[116:119]
  buffer_load_dwordx4 v[80:83], off, s[36:39], s49 offset:0
  v_mfma_f32_16x16x32_bf16 v[124:127], v[188:191], v[236:239], v[124:127]
  ds_read_b64_tr_b16 v[218:219], v22 offset:12800
  ds_read_b64_tr_b16 v[220:221], v23 offset:12288
  v_mfma_f32_16x16x32_bf16 v[120:123], v[188:191], v[232:235], v[120:123]
  ds_read_b64_tr_b16 v[222:223], v23 offset:12800
  s_waitcnt vmcnt(15) lgkmcnt(8)
  v_mfma_f32_16x16x32_bf16 v[96:99], v[192:195], v[240:243], v[96:99]
  ds_read_b64_tr_b16 v[160:161], v20 offset:16384
  v_mfma_f32_16x16x32_bf16 v[100:103], v[192:195], v[244:247], v[100:103]
  buffer_load_dwordx4 v[84:87], off, s[64:67], s49 offset:0
  v_mfma_f32_16x16x32_bf16 v[108:111], v[196:199], v[244:247], v[108:111]
  ds_read_b64_tr_b16 v[162:163], v20 offset:16896
  ds_read_b64_tr_b16 v[164:165], v21 offset:16384
  v_mfma_f32_16x16x32_bf16 v[104:107], v[196:199], v[240:243], v[104:107]
  ds_read_b64_tr_b16 v[166:167], v21 offset:16896
  v_mfma_f32_16x16x32_bf16 v[112:115], v[200:203], v[240:243], v[112:115]
  ds_read_b64_tr_b16 v[168:169], v22 offset:16384
  v_mfma_f32_16x16x32_bf16 v[116:119], v[200:203], v[244:247], v[116:119]
  buffer_load_dwordx4 v[88:91], off, s[36:39], s49 offset:1024
  v_mfma_f32_16x16x32_bf16 v[124:127], v[204:207], v[244:247], v[124:127]
  ds_read_b64_tr_b16 v[170:171], v22 offset:16896
  ds_read_b64_tr_b16 v[172:173], v23 offset:16384
  v_mfma_f32_16x16x32_bf16 v[120:123], v[204:207], v[240:243], v[120:123]
  ds_read_b64_tr_b16 v[174:175], v23 offset:16896
  s_waitcnt vmcnt(15) lgkmcnt(8)
  v_mfma_f32_16x16x32_bf16 v[96:99], v[208:211], v[248:251], v[96:99]
  ds_read_b64_tr_b16 v[176:177], v20 offset:20480
  v_mfma_f32_16x16x32_bf16 v[100:103], v[208:211], v[252:255], v[100:103]
  buffer_load_dwordx4 v[92:95], off, s[64:67], s49 offset:1024
  v_mfma_f32_16x16x32_bf16 v[108:111], v[212:215], v[252:255], v[108:111]
  ds_read_b64_tr_b16 v[178:179], v20 offset:20992
  ds_read_b64_tr_b16 v[180:181], v21 offset:20480
  v_mfma_f32_16x16x32_bf16 v[104:107], v[212:215], v[248:251], v[104:107]
  ds_read_b64_tr_b16 v[182:183], v21 offset:20992
  v_readlane_b32 s50, v15, 34
  v_mfma_f32_16x16x32_bf16 v[112:115], v[216:219], v[248:251], v[112:115]
  ds_read_b64_tr_b16 v[184:185], v22 offset:20480
  v_mfma_f32_16x16x32_bf16 v[116:119], v[216:219], v[252:255], v[116:119]
  ds_read_b64_tr_b16 v[186:187], v22 offset:20992
  ds_read_b64_tr_b16 v[188:189], v23 offset:20480
  v_mfma_f32_16x16x32_bf16 v[124:127], v[220:223], v[252:255], v[124:127]
  buffer_load_dwordx4 v[224:227], off, s[36:39], s50 offset:0
  v_mfma_f32_16x16x32_bf16 v[120:123], v[220:223], v[248:251], v[120:123]
  ds_read_b64_tr_b16 v[190:191], v23 offset:20992
  s_waitcnt vmcnt(15) lgkmcnt(8)
  v_mfma_f32_16x16x32_bf16 v[96:99], v[160:163], v[32:35], v[96:99]
  ds_read_b64_tr_b16 v[192:193], v20 offset:24576
  v_mfma_f32_16x16x32_bf16 v[100:103], v[160:163], v[36:39], v[100:103]
  ds_read_b64_tr_b16 v[194:195], v20 offset:25088
  v_mfma_f32_16x16x32_bf16 v[108:111], v[164:167], v[36:39], v[108:111]
  buffer_load_dwordx4 v[228:231], off, s[64:67], s50 offset:0
  v_mfma_f32_16x16x32_bf16 v[104:107], v[164:167], v[32:35], v[104:107]
  ds_read_b64_tr_b16 v[196:197], v21 offset:24576
  ds_read_b64_tr_b16 v[198:199], v21 offset:25088
  v_mfma_f32_16x16x32_bf16 v[112:115], v[168:171], v[32:35], v[112:115]
  ds_read_b64_tr_b16 v[200:201], v22 offset:24576
  v_mfma_f32_16x16x32_bf16 v[116:119], v[168:171], v[36:39], v[116:119]
  ds_read_b64_tr_b16 v[202:203], v22 offset:25088
  ds_read_b64_tr_b16 v[204:205], v23 offset:24576
  v_mfma_f32_16x16x32_bf16 v[124:127], v[172:175], v[36:39], v[124:127]
  buffer_load_dwordx4 v[232:235], off, s[36:39], s50 offset:1024
  v_mfma_f32_16x16x32_bf16 v[120:123], v[172:175], v[32:35], v[120:123]
  ds_read_b64_tr_b16 v[206:207], v23 offset:25088
  s_waitcnt vmcnt(15) lgkmcnt(8)
  s_barrier
  v_mfma_f32_16x16x32_bf16 v[96:99], v[176:179], v[40:43], v[96:99]
  buffer_load_dwordx4 v[144:147], off, s[60:63], s5 offset:0 sc1
  v_mfma_f32_16x16x32_bf16 v[100:103], v[176:179], v[44:47], v[100:103]
  ds_read_b64_tr_b16 v[208:209], v20 offset:28672
  ds_read_b64_tr_b16 v[210:211], v20 offset:29184
  v_mfma_f32_16x16x32_bf16 v[108:111], v[180:183], v[44:47], v[108:111]
  ds_read_b64_tr_b16 v[212:213], v21 offset:28672
  buffer_load_dwordx4 v[236:239], off, s[64:67], s50 offset:1024
  v_mfma_f32_16x16x32_bf16 v[104:107], v[180:183], v[40:43], v[104:107]
  ds_read_b64_tr_b16 v[214:215], v21 offset:29184
  buffer_load_dwordx4 v[148:151], off, s[60:63], s5 offset:1024 sc1
  v_mfma_f32_16x16x32_bf16 v[112:115], v[184:187], v[40:43], v[112:115]
  ds_read_b64_tr_b16 v[216:217], v22 offset:28672
  v_readlane_b32 s51, v15, 35
  v_mfma_f32_16x16x32_bf16 v[116:119], v[184:187], v[44:47], v[116:119]
  buffer_load_dwordx4 v[152:155], off, s[60:63], s5 offset:2048 sc1
  v_mfma_f32_16x16x32_bf16 v[124:127], v[188:191], v[44:47], v[124:127]
  ds_read_b64_tr_b16 v[218:219], v22 offset:29184
  ds_read_b64_tr_b16 v[220:221], v23 offset:28672
  v_mfma_f32_16x16x32_bf16 v[120:123], v[188:191], v[40:43], v[120:123]
  ds_read_b64_tr_b16 v[222:223], v23 offset:29184
  s_waitcnt vmcnt(17) lgkmcnt(8)
  v_mfma_f32_16x16x32_bf16 v[96:99], v[192:195], v[48:51], v[96:99]
  ds_read_b64_tr_b16 v[160:161], v20 offset:32768
  buffer_load_dwordx4 v[240:243], off, s[36:39], s51 offset:0
  v_mfma_f32_16x16x32_bf16 v[100:103], v[192:195], v[52:55], v[100:103]
  buffer_load_dwordx4 v[156:159], off, s[60:63], s5 offset:3072 sc1
  v_mfma_f32_16x16x32_bf16 v[108:111], v[196:199], v[52:55], v[108:111]
  ds_read_b64_tr_b16 v[162:163], v20 offset:33280
  ds_read_b64_tr_b16 v[164:165], v21 offset:32768
  v_mfma_f32_16x16x32_bf16 v[104:107], v[196:199], v[48:51], v[104:107]
  ds_read_b64_tr_b16 v[166:167], v21 offset:33280
  v_mfma_f32_16x16x32_bf16 v[112:115], v[200:203], v[48:51], v[112:115]
  buffer_load_dwordx4 v[244:247], off, s[64:67], s51 offset:0
  v_mfma_f32_16x16x32_bf16 v[116:119], v[200:203], v[52:55], v[116:119]
  ds_read_b64_tr_b16 v[168:169], v22 offset:32768
  ds_read_b64_tr_b16 v[170:171], v22 offset:33280
  v_mfma_f32_16x16x32_bf16 v[124:127], v[204:207], v[52:55], v[124:127]
  ds_read_b64_tr_b16 v[172:173], v23 offset:32768
  v_mfma_f32_16x16x32_bf16 v[120:123], v[204:207], v[48:51], v[120:123]
  ds_read_b64_tr_b16 v[174:175], v23 offset:33280
  s_waitcnt vmcnt(18) lgkmcnt(8)
  v_mfma_f32_16x16x32_bf16 v[96:99], v[208:211], v[56:59], v[96:99]
  buffer_load_dwordx4 v[248:251], off, s[36:39], s51 offset:1024
  v_mfma_f32_16x16x32_bf16 v[100:103], v[208:211], v[60:63], v[100:103]
  ds_read_b64_tr_b16 v[176:177], v20 offset:36864
  ds_read_b64_tr_b16 v[178:179], v20 offset:37376
  v_mfma_f32_16x16x32_bf16 v[108:111], v[212:215], v[60:63], v[108:111]
  ds_read_b64_tr_b16 v[180:181], v21 offset:36864
  v_mfma_f32_16x16x32_bf16 v[104:107], v[212:215], v[56:59], v[104:107]
  ds_read_b64_tr_b16 v[182:183], v21 offset:37376
  v_mfma_f32_16x16x32_bf16 v[112:115], v[216:219], v[56:59], v[112:115]
  buffer_load_dwordx4 v[252:255], off, s[64:67], s51 offset:1024
  v_mfma_f32_16x16x32_bf16 v[116:119], v[216:219], v[60:63], v[116:119]
  ds_read_b64_tr_b16 v[184:185], v22 offset:36864
  ds_read_b64_tr_b16 v[186:187], v22 offset:37376
  v_mfma_f32_16x16x32_bf16 v[124:127], v[220:223], v[60:63], v[124:127]
  ds_read_b64_tr_b16 v[188:189], v23 offset:36864
  v_mfma_f32_16x16x32_bf16 v[120:123], v[220:223], v[56:59], v[120:123]
  ds_read_b64_tr_b16 v[190:191], v23 offset:37376
  s_waitcnt vmcnt(18) lgkmcnt(8)
  v_mfma_f32_16x16x32_bf16 v[96:99], v[160:163], v[64:67], v[96:99]
  ds_read_b64_tr_b16 v[192:193], v20 offset:40960
  v_mfma_f32_16x16x32_bf16 v[100:103], v[160:163], v[68:71], v[100:103]
  ds_read_b64_tr_b16 v[194:195], v20 offset:41472
  v_mfma_f32_16x16x32_bf16 v[108:111], v[164:167], v[68:71], v[108:111]
  ds_read_b64_tr_b16 v[196:197], v21 offset:40960
  v_mfma_f32_16x16x32_bf16 v[104:107], v[164:167], v[64:67], v[104:107]
  ds_read_b64_tr_b16 v[198:199], v21 offset:41472
  v_mfma_f32_16x16x32_bf16 v[112:115], v[168:171], v[64:67], v[112:115]
  ds_read_b64_tr_b16 v[200:201], v22 offset:40960
  v_mfma_f32_16x16x32_bf16 v[116:119], v[168:171], v[68:71], v[116:119]
  ds_read_b64_tr_b16 v[202:203], v22 offset:41472
  v_mfma_f32_16x16x32_bf16 v[124:127], v[172:175], v[68:71], v[124:127]
  ds_read_b64_tr_b16 v[204:205], v23 offset:40960
  v_mfma_f32_16x16x32_bf16 v[120:123], v[172:175], v[64:67], v[120:123]
  ds_read_b64_tr_b16 v[206:207], v23 offset:41472
  s_waitcnt vmcnt(16) lgkmcnt(8)
  v_mfma_f32_16x16x32_bf16 v[96:99], v[176:179], v[72:75], v[96:99]
  ds_read_b64_tr_b16 v[208:209], v20 offset:45056
  v_mfma_f32_16x16x32_bf16 v[100:103], v[176:179], v[76:79], v[100:103]
  ds_read_b64_tr_b16 v[210:211], v20 offset:45568
  v_mfma_f32_16x16x32_bf16 v[108:111], v[180:183], v[76:79], v[108:111]
  ds_read_b64_tr_b16 v[212:213], v21 offset:45056
  v_mfma_f32_16x16x32_bf16 v[104:107], v[180:183], v[72:75], v[104:107]
  ds_read_b64_tr_b16 v[214:215], v21 offset:45568
  v_mfma_f32_16x16x32_bf16 v[112:115], v[184:187], v[72:75], v[112:115]
  ds_read_b64_tr_b16 v[216:217], v22 offset:45056
  v_mfma_f32_16x16x32_bf16 v[116:119], v[184:187], v[76:79], v[116:119]
  ds_read_b64_tr_b16 v[218:219], v22 offset:45568
  v_mfma_f32_16x16x32_bf16 v[124:127], v[188:191], v[76:79], v[124:127]
  ds_read_b64_tr_b16 v[220:221], v23 offset:45056
  v_mfma_f32_16x16x32_bf16 v[120:123], v[188:191], v[72:75], v[120:123]
  ds_read_b64_tr_b16 v[222:223], v23 offset:45568
  s_waitcnt vmcnt(14) lgkmcnt(8)
  v_mfma_f32_16x16x32_bf16 v[96:99], v[192:195], v[80:83], v[96:99]
  ds_read_b64_tr_b16 v[160:161], v20 offset:49152
  v_mfma_f32_16x16x32_bf16 v[100:103], v[192:195], v[84:87], v[100:103]
  ds_read_b64_tr_b16 v[162:163], v20 offset:49664
  v_mfma_f32_16x16x32_bf16 v[108:111], v[196:199], v[84:87], v[108:111]
  ds_read_b64_tr_b16 v[164:165], v21 offset:49152
  v_mfma_f32_16x16x32_bf16 v[104:107], v[196:199], v[80:83], v[104:107]
  ds_read_b64_tr_b16 v[166:167], v21 offset:49664
  v_mfma_f32_16x16x32_bf16 v[112:115], v[200:203], v[80:83], v[112:115]
  ds_read_b64_tr_b16 v[168:169], v22 offset:49152
  v_mfma_f32_16x16x32_bf16 v[116:119], v[200:203], v[84:87], v[116:119]
  ds_read_b64_tr_b16 v[170:171], v22 offset:49664
  v_mfma_f32_16x16x32_bf16 v[124:127], v[204:207], v[84:87], v[124:127]
  ds_read_b64_tr_b16 v[172:173], v23 offset:49152
  v_mfma_f32_16x16x32_bf16 v[120:123], v[204:207], v[80:83], v[120:123]
  ds_read_b64_tr_b16 v[174:175], v23 offset:49664
  s_waitcnt vmcnt(12) lgkmcnt(8)
  v_mfma_f32_16x16x32_bf16 v[96:99], v[208:211], v[88:91], v[96:99]
  ds_read_b64_tr_b16 v[176:177], v20 offset:53248
  v_mfma_f32_16x16x32_bf16 v[100:103], v[208:211], v[92:95], v[100:103]
  ds_read_b64_tr_b16 v[178:179], v20 offset:53760
  v_mfma_f32_16x16x32_bf16 v[108:111], v[212:215], v[92:95], v[108:111]
  ds_read_b64_tr_b16 v[180:181], v21 offset:53248
  v_mfma_f32_16x16x32_bf16 v[104:107], v[212:215], v[88:91], v[104:107]
  ds_read_b64_tr_b16 v[182:183], v21 offset:53760
  v_mfma_f32_16x16x32_bf16 v[112:115], v[216:219], v[88:91], v[112:115]
  ds_read_b64_tr_b16 v[184:185], v22 offset:53248
  v_mfma_f32_16x16x32_bf16 v[116:119], v[216:219], v[92:95], v[116:119]
  ds_read_b64_tr_b16 v[186:187], v22 offset:53760
  v_mfma_f32_16x16x32_bf16 v[124:127], v[220:223], v[92:95], v[124:127]
  ds_read_b64_tr_b16 v[188:189], v23 offset:53248
  v_mfma_f32_16x16x32_bf16 v[120:123], v[220:223], v[88:91], v[120:123]
  ds_read_b64_tr_b16 v[190:191], v23 offset:53760
  s_waitcnt vmcnt(10) lgkmcnt(8)
  v_mfma_f32_16x16x32_bf16 v[96:99], v[160:163], v[224:227], v[96:99]
  ds_read_b64_tr_b16 v[192:193], v20 offset:57344
  s_waitcnt vmcnt(3)
  v_mfma_f32_16x16x32_bf16 v[100:103], v[160:163], v[228:231], v[100:103]
  ds_read_b64_tr_b16 v[194:195], v20 offset:57856
  v_lshlrev_b32 v128, 16, v144
  v_mfma_f32_16x16x32_bf16 v[108:111], v[164:167], v[228:231], v[108:111]
  ds_read_b64_tr_b16 v[196:197], v21 offset:57344
  v_and_b32 v129, s11, v144
  v_mfma_f32_16x16x32_bf16 v[104:107], v[164:167], v[224:227], v[104:107]
  ds_read_b64_tr_b16 v[198:199], v21 offset:57856
  v_lshlrev_b32 v130, 16, v145
  v_mfma_f32_16x16x32_bf16 v[112:115], v[168:171], v[224:227], v[112:115]
  ds_read_b64_tr_b16 v[200:201], v22 offset:57344
  v_and_b32 v131, s11, v145
  v_mfma_f32_16x16x32_bf16 v[116:119], v[168:171], v[228:231], v[116:119]
  ds_read_b64_tr_b16 v[202:203], v22 offset:57856
  v_lshlrev_b32 v132, 16, v146
  v_mfma_f32_16x16x32_bf16 v[124:127], v[172:175], v[228:231], v[124:127]
  ds_read_b64_tr_b16 v[204:205], v23 offset:57344
  v_and_b32 v133, s11, v146
  v_mfma_f32_16x16x32_bf16 v[120:123], v[172:175], v[224:227], v[120:123]
  ds_read_b64_tr_b16 v[206:207], v23 offset:57856
  s_waitcnt lgkmcnt(8)
  v_mfma_f32_16x16x32_bf16 v[96:99], v[176:179], v[232:235], v[96:99]
  ds_read_b64_tr_b16 v[208:209], v20 offset:61440
  v_lshlrev_b32 v134, 16, v147
  v_mfma_f32_16x16x32_bf16 v[100:103], v[176:179], v[236:239], v[100:103]
  ds_read_b64_tr_b16 v[210:211], v20 offset:61952
  v_and_b32 v135, s11, v147
  v_mfma_f32_16x16x32_bf16 v[108:111], v[180:183], v[236:239], v[108:111]
  ds_read_b64_tr_b16 v[212:213], v21 offset:61440
  v_lshlrev_b32 v136, 16, v148
  v_mfma_f32_16x16x32_bf16 v[104:107], v[180:183], v[232:235], v[104:107]
  ds_read_b64_tr_b16 v[214:215], v21 offset:61952
  v_and_b32 v137, s11, v148
  v_mfma_f32_16x16x32_bf16 v[112:115], v[184:187], v[232:235], v[112:115]
  ds_read_b64_tr_b16 v[216:217], v22 offset:61440
  v_lshlrev_b32 v138, 16, v149
  v_mfma_f32_16x16x32_bf16 v[116:119], v[184:187], v[236:239], v[116:119]
  ds_read_b64_tr_b16 v[218:219], v22 offset:61952
  v_and_b32 v139, s11, v149
  v_mfma_f32_16x16x32_bf16 v[124:127], v[188:191], v[236:239], v[124:127]
  ds_read_b64_tr_b16 v[220:221], v23 offset:61440
  v_lshlrev_b32 v140, 16, v150
  v_mfma_f32_16x16x32_bf16 v[120:123], v[188:191], v[232:235], v[120:123]
  ds_read_b64_tr_b16 v[222:223], v23 offset:61952
  s_waitcnt vmcnt(2) lgkmcnt(8)
  v_mfma_f32_16x16x32_bf16 v[96:99], v[192:195], v[240:243], v[96:99]
  v_mov_b32 v20, 0
  v_mov_b32 v21, 0
  v_mfma_f32_16x16x32_bf16 v[100:103], v[192:195], v[244:247], v[100:103]
  v_mov_b32 v22, 0
  v_mov_b32 v23, 0
  v_mfma_f32_16x16x32_bf16 v[108:111], v[196:199], v[244:247], v[108:111]
  v_and_b32 v141, s11, v150
  v_lshlrev_b32 v142, 16, v151
  v_and_b32 v143, s11, v151
  v_mfma_f32_16x16x32_bf16 v[104:107], v[196:199], v[240:243], v[104:107]
  v_lshlrev_b32 v144, 16, v152
  v_and_b32 v145, s11, v152
  v_lshlrev_b32 v146, 16, v153
  v_mfma_f32_16x16x32_bf16 v[112:115], v[200:203], v[240:243], v[112:115]
  v_and_b32 v147, s11, v153
  v_lshlrev_b32 v148, 16, v154
  v_and_b32 v149, s11, v154
  v_mfma_f32_16x16x32_bf16 v[116:119], v[200:203], v[244:247], v[116:119]
  v_lshlrev_b32 v150, 16, v155
  v_and_b32 v151, s11, v155
  v_lshlrev_b32 v152, 16, v156
  v_mfma_f32_16x16x32_bf16 v[124:127], v[204:207], v[244:247], v[124:127]
  v_and_b32 v153, s11, v156
  v_lshlrev_b32 v154, 16, v157
  v_and_b32 v155, s11, v157
  v_mfma_f32_16x16x32_bf16 v[120:123], v[204:207], v[240:243], v[120:123]
  s_waitcnt vmcnt(0) lgkmcnt(0)
  v_lshlrev_b32 v156, 16, v158
  v_and_b32 v157, s11, v158
  v_mfma_f32_16x16x32_bf16 v[96:99], v[208:211], v[248:251], v[96:99]
  v_lshlrev_b32 v158, 16, v159
  v_and_b32 v159, s11, v159
  v_mfma_f32_16x16x32_bf16 v[100:103], v[208:211], v[252:255], v[100:103]
  v_mfma_f32_16x16x32_bf16 v[108:111], v[212:215], v[252:255], v[108:111]
  v_mfma_f32_16x16x32_bf16 v[104:107], v[212:215], v[248:251], v[104:107]
  v_mfma_f32_16x16x32_bf16 v[112:115], v[216:219], v[248:251], v[112:115]
  v_mfma_f32_16x16x32_bf16 v[116:119], v[216:219], v[252:255], v[116:119]
  v_mfma_f32_16x16x32_bf16 v[124:127], v[220:223], v[252:255], v[124:127]
  v_mfma_f32_16x16x32_bf16 v[120:123], v[220:223], v[248:251], v[120:123]
  s_lshl_b32 s3, s7, 4
  s_mov_b32 s10, 0x3f803f80
  s_nop 4
  v_pk_add_f32 v[96:97], v[96:97], v[128:129]
  v_pk_add_f32 v[98:99], v[98:99], v[130:131]
  v_cvt_pk_bf16_f32 v240, v96, v97
  v_cvt_pk_bf16_f32 v241, v98, v99
  v_pk_add_f32 v[104:105], v[104:105], v[136:137]
  v_pk_add_f32 v[106:107], v[106:107], v[138:139]
  v_cvt_pk_bf16_f32 v242, v104, v105
  v_cvt_pk_bf16_f32 v243, v106, v107
  s_nop 1
  v_permlane16_swap_b32 v240, v242
  v_permlane16_swap_b32 v241, v243
  buffer_store_dwordx4 v[240:243], v12, s[44:47], 0 offen offset:0 sc1
  ds_write_b128 v4, v[240:243] offset:0
  v_pk_add_f32 v[112:113], v[112:113], v[144:145]
  v_pk_add_f32 v[114:115], v[114:115], v[146:147]
  v_cvt_pk_bf16_f32 v244, v112, v113
  v_cvt_pk_bf16_f32 v245, v114, v115
  v_pk_add_f32 v[120:121], v[120:121], v[152:153]
  v_pk_add_f32 v[122:123], v[122:123], v[154:155]
  v_cvt_pk_bf16_f32 v246, v120, v121
  v_cvt_pk_bf16_f32 v247, v122, v123
  s_nop 1
  v_permlane16_swap_b32 v244, v246
  v_permlane16_swap_b32 v245, v247
  buffer_store_dwordx4 v[244:247], v12, s[44:47], 0 offen offset:64 sc1
  ds_write_b128 v5, v[244:247] offset:0
  v_pk_add_f32 v[100:101], v[100:101], v[132:133]
  v_pk_add_f32 v[102:103], v[102:103], v[134:135]
  v_cvt_pk_bf16_f32 v248, v100, v101
  v_cvt_pk_bf16_f32 v249, v102, v103
  v_pk_add_f32 v[108:109], v[108:109], v[140:141]
  v_pk_add_f32 v[110:111], v[110:111], v[142:143]
  v_cvt_pk_bf16_f32 v250, v108, v109
  v_cvt_pk_bf16_f32 v251, v110, v111
  s_nop 1
  v_permlane16_swap_b32 v248, v250
  v_permlane16_swap_b32 v249, v251
  buffer_store_dwordx4 v[248:251], v12, s[44:47], s3 offen offset:0 sc1
  ds_write_b128 v4, v[248:251] offset:2048
  v_pk_add_f32 v[116:117], v[116:117], v[148:149]
  v_pk_add_f32 v[118:119], v[118:119], v[150:151]
  v_cvt_pk_bf16_f32 v252, v116, v117
  v_cvt_pk_bf16_f32 v253, v118, v119
  v_pk_add_f32 v[124:125], v[124:125], v[156:157]
  v_pk_add_f32 v[126:127], v[126:127], v[158:159]
  v_cvt_pk_bf16_f32 v254, v124, v125
  v_cvt_pk_bf16_f32 v255, v126, v127
  s_nop 1
  v_permlane16_swap_b32 v252, v254
  v_permlane16_swap_b32 v253, v255
  buffer_store_dwordx4 v[252:255], v12, s[44:47], s3 offen offset:64 sc1
  ds_write_b128 v5, v[252:255] offset:2048
  v_dot2_f32_bf16 v20, v240, s10, v20
  v_dot2_f32_bf16 v22, v240, v240, v22
  v_dot2_f32_bf16 v20, v241, s10, v20
  v_dot2_f32_bf16 v22, v241, v241, v22
  v_dot2_f32_bf16 v20, v242, s10, v20
  v_dot2_f32_bf16 v22, v242, v242, v22
  v_dot2_f32_bf16 v20, v243, s10, v20
  v_dot2_f32_bf16 v22, v243, v243, v22
  v_dot2_f32_bf16 v20, v244, s10, v20
  v_dot2_f32_bf16 v22, v244, v244, v22
  v_dot2_f32_bf16 v20, v245, s10, v20
  v_dot2_f32_bf16 v22, v245, v245, v22
  v_dot2_f32_bf16 v20, v246, s10, v20
  v_dot2_f32_bf16 v22, v246, v246, v22
  v_dot2_f32_bf16 v20, v247, s10, v20
  v_dot2_f32_bf16 v22, v247, v247, v22
  v_dot2_f32_bf16 v21, v248, s10, v21
  v_dot2_f32_bf16 v23, v248, v248, v23
  v_dot2_f32_bf16 v21, v249, s10, v21
  v_dot2_f32_bf16 v23, v249, v249, v23
  v_dot2_f32_bf16 v21, v250, s10, v21
  v_dot2_f32_bf16 v23, v250, v250, v23
  v_dot2_f32_bf16 v21, v251, s10, v21
  v_dot2_f32_bf16 v23, v251, v251, v23
  v_dot2_f32_bf16 v21, v252, s10, v21
  v_dot2_f32_bf16 v23, v252, v252, v23
  v_dot2_f32_bf16 v21, v253, s10, v21
  v_dot2_f32_bf16 v23, v253, v253, v23
  v_dot2_f32_bf16 v21, v254, s10, v21
  v_dot2_f32_bf16 v23, v254, v254, v23
  v_dot2_f32_bf16 v21, v255, s10, v21
  v_dot2_f32_bf16 v23, v255, v255, v23
  s_nop 2
  v_permlane32_swap_b32 v20, v21
  v_permlane32_swap_b32 v22, v23
  v_add_f32 v20, v20, v21
  v_add_f32 v22, v22, v23
  s_nop 1
  v_permlane16_swap_b32 v20, v22
  v_add_f32 v20, v20, v22
  buffer_store_dword v20, v18, s[56:59], 0 offen sc1
  s_cmp_eq_u32 s96, 1
  s_cbranch_scc1 L_w2_end
  s_waitcnt vmcnt(0) lgkmcnt(0)
  s_barrier
  s_mov_b32 s96, 1
  s_add_u32 s12, s22, 33554432
  s_addc_u32 s13, s23, 0
  s_add_u32 s34, s22, 67108864
  s_addc_u32 s35, s23, 0
  s_add_u32 s97, s97, 1
  s_branch L_attn_body
L_w2_c1:
```

```asm
; @launch grid=(256,1,1) block=(512,1,1) lds=163840
.amdgcn_target "amdgcn-amd-amdhsa--gfx950"
.text
.globl interleave_layers__sliding_local_dilated__dense_activation_gelu__prompt_kernel
.p2align 12
.fill 832, 4, 0xbf800000
.type interleave_layers__sliding_local_dilated__dense_activation_gelu__prompt_kernel,@function
interleave_layers__sliding_local_dilated__dense_activation_gelu__prompt_kernel:
L_attn_c0:
  s_load_dwordx4 s[16:19], s[0:1], 0
  s_load_dwordx2 s[20:21], s[0:1], 16
  s_load_dwordx2 s[22:23], s[0:1], 80
  s_load_dwordx8 s[24:31], s[0:1], 32
  s_load_dwordx2 s[32:33], s[0:1], 64
  s_load_dwordx2 s[34:35], s[0:1], 80
  s_load_dwordx2 s[12:13], s[0:1], 0
  s_load_dwordx2 s[64:65], s[0:1], 72
  s_mov_b32 s96, 0
  s_mov_b32 s97, 0
L_attn_body:
  s_cmp_ge_u32 s2, 256
  s_cbranch_scc1 L_attn_end
  v_lshrrev_b32 v2, 6, v0
  v_and_b32 v1, 63, v0
  v_readfirstlane_b32 s70, v2
  s_and_b32 s3, s2, 7
  s_lshr_b32 s99, s2, 3
  s_and_b32 s5, s3, 1
  s_lshl_b32 s5, s5, 3
  s_and_b32 s6, s99, 7
  s_add_u32 s68, s5, s6
  s_lshr_b32 s5, s3, 1
  s_lshl_b32 s5, s5, 2
  s_lshr_b32 s6, s99, 3
  s_add_u32 s69, s5, s6
  s_cmp_eq_u32 s96, 0
  s_cbranch_scc1 L_attn_map
  s_and_b32 s3, s2, 7
  s_and_b32 s5, s3, 3
  s_lshl_b32 s5, s5, 2
  s_and_b32 s6, s99, 3
  s_add_u32 s68, s5, s6
  s_lshr_b32 s5, s3, 2
  s_lshl_b32 s5, s5, 3
  s_lshr_b32 s6, s99, 2
  s_add_u32 s69, s5, s6
L_attn_map:
  s_cmp_lt_u32 s70, 4
  s_cbranch_scc1 L_attn_compute
L_attn_loader:
  s_add_u32 s8, s70, s69
  s_and_b32 s8, s8, 3
  s_add_u32 s9, s70, s68
  s_and_b32 s9, s9, 3
  s_lshl_b32 s76, s8, 12
  s_lshl_b32 s77, s9, 11
  s_add_u32 s77, s77, 16384
  s_lshl_b32 s11, s68, 7
  v_and_b32 v10, 7, v1
  v_lshrrev_b32 v3, 3, v1
  s_lshr_b32 s10, s76, 7
  s_lshl_b32 s3, s68, 7
  s_add_u32 s10, s10, s3
  v_add_u32 v3, s10, v3
  s_cmp_eq_u32 s96, 1
  s_cselect_b32 s5, 128, 0
  s_add_u32 s5, s5, 2048
  s_lshl_b32 s6, s5, 3
  v_mul_u32_u24 v3, s5, v3
  v_lshrrev_b32 v2, 4, v1
  v_xor_b32 v4, v2, v10
  v_lshl_add_u32 v4, v4, 4, v3
  v_add_u32 v3, s6, v3
  v_add_u32 v5, 4, v2
  v_xor_b32 v5, v5, v10
  v_lshl_add_u32 v5, v5, 4, v3
  v_add_u32 v3, s6, v3
  v_xor_b32 v6, v2, v10
  v_lshl_add_u32 v6, v6, 4, v3
  v_add_u32 v3, s6, v3
  v_add_u32 v7, 4, v2
  v_xor_b32 v7, v7, v10
  v_lshl_add_u32 v7, v7, 4, v3
  v_lshrrev_b32 v3, 3, v1
  s_lshl_b32 s10, s9, 4
  v_add_u32 v3, s10, v3
  v_mul_u32_u24 v3, 6144, v3
  v_lshrrev_b32 v2, 3, v1
  v_and_b32 v2, 2, v2
  v_xor_b32 v2, v2, v10
  s_mul_i32 s10, s69, 128
  v_add_u32 v3, s10, v3
  v_lshl_add_u32 v8, v2, 4, v3
  v_xor_b32 v2, 4, v2
  v_add_u32 v3, 49152, v3
  v_lshl_add_u32 v9, v2, 4, v3
  s_and_b32 s10, s70, 3
  s_lshl_b32 s78, s10, 9
  s_add_u32 s78, s78, 40960
  s_lshl_b32 s14, s10, 2
  s_add_u32 s14, s14, s11
  s_sub_u32 s14, s14, 16
  v_lshrrev_b32 v3, 3, v1
  v_add_u32 v3, s14, v3
  v_max_i32 v3, 0, v3
  v_mul_u32_u24 v3, s5, v3
  s_lshl_b32 s14, s10, 1
  v_lshrrev_b32 v2, 4, v1
  v_add_u32 v2, s14, v2
  v_and_b32 v2, 7, v2
  v_xor_b32 v2, v2, v10
  v_lshl_add_u32 v28, v2, 4, v3
  s_cmp_eq_u32 s10, 0
  s_cselect_b32 s14, 0xffffff00, -1
  s_mov_b32 s15, 0
  s_mov_b32 s75, 0
  s_add_u32 s100, s68, s69
  s_mov_b32 s101, -1
  s_add_u32 s3, s68, s69
  s_and_b32 s3, s3, 3
  s_mov_b32 s100, 0x75463102
  s_mov_b32 s101, 0xfdceb98a
  s_cmp_eq_u32 s3, 1
  s_cselect_b32 s100, 0x65742130, s100
  s_cselect_b32 s101, 0xedfca9b8, s101
  s_cmp_eq_u32 s3, 2
  s_cselect_b32 s100, 0x68532410, s100
  s_cselect_b32 s101, 0xfedbac97, s101
  s_cmp_eq_u32 s3, 3
  s_cselect_b32 s100, 0x96435210, s100
  s_cselect_b32 s101, 0xfecbda87, s101
  s_mov_b32 s91, s69
  s_and_b32 s92, s69, 3
  s_add_u32 s92, s92, 1
  s_and_b32 s73, s100, 15
  s_cmp_eq_u32 s73, s91
  s_cselect_b32 s74, 4, 0
  s_lshr_b64 s[100:101], s[100:101], s74
  s_and_b32 s73, s100, 15
  s_sub_u32 s92, s92, 1
  s_cselect_b32 s73, s91, s73
  s_cselect_b32 s74, 0, 4
  s_lshr_b64 s[100:101], s[100:101], s74
  s_mul_i32 s74, s73, 393216
  s_lshl_b32 s73, s73, 7
  s_waitcnt lgkmcnt(0)
  s_mov_b32 s36, s12
  s_and_b32 s37, s13, 0xffff
  s_mov_b32 s38, 4194304
  s_mov_b32 s39, 0x00020000
  s_cmp_eq_u32 s96, 1
  s_cselect_b32 s38, 128, 0
  s_add_u32 s38, s38, 2048
  s_lshl_b32 s38, s38, 11
  s_mov_b32 s40, s18
  s_and_b32 s41, s19, 0xffff
  s_mov_b32 s42, 6291456
  s_mov_b32 s43, 0x00020000
  s_cmp_lg_u32 s96, 0
  s_cbranch_scc1 L_attn_ld1
  s_mov_b32 s48, s28
  s_and_b32 s49, s29, 0xffff
  s_mov_b32 s50, 7340032
  s_mov_b32 s51, 0x00020000
  s_cmp_eq_u32 s96, 0
  s_cselect_b32 s50, s50, 0
  s_and_b32 s3, s70, 3
  s_lshl_b32 s4, s2, 2
  s_add_u32 s3, s3, s4
  s_mul_i32 s98, s3, 3584
  s_add_u32 s98, s98, 0
  s_add_u32 s3, s75, s76
  s_add_u32 m0, s3, 0
  s_nop 0
  buffer_load_dwordx4 v4, s[36:39], s73 offen lds
  s_add_u32 m0, s3, 1024
  s_nop 0
  buffer_load_dwordx4 v5, s[36:39], s73 offen lds
  s_add_u32 m0, s3, 2048
  s_nop 0
  buffer_load_dwordx4 v6, s[36:39], s73 offen lds
  s_add_u32 m0, s3, 3072
  s_nop 0
  buffer_load_dwordx4 v7, s[36:39], s73 offen lds
  s_add_u32 m0, s78, s75
  s_mov_b64 exec, s[14:15]
  buffer_load_dwordx4 v28, s[36:39], s73 offen lds
  s_mov_b64 exec, -1
  s_add_u32 s3, s75, s77
  s_add_u32 m0, s3, 0
  s_add_u32 s4, s74, 0
  buffer_load_dwordx4 v8, s[40:43], s4 offen lds
  s_add_u32 m0, s3, 1024
  s_nop 0
  buffer_load_dwordx4 v9, s[40:43], s4 offen lds
  s_add_u32 m0, s3, 8192
  s_add_u32 s4, s74, 2048
  buffer_load_dwordx4 v8, s[40:43], s4 offen lds
  s_add_u32 m0, s3, 9216
  s_nop 0
  buffer_load_dwordx4 v9, s[40:43], s4 offen lds
  s_add_u32 m0, s3, 16384
  s_add_u32 s4, s74, 4096
  buffer_load_dwordx4 v8, s[40:43], s4 offen lds
  s_add_u32 m0, s3, 17408
  s_nop 0
  buffer_load_dwordx4 v9, s[40:43], s4 offen lds
  s_and_b32 s73, s100, 15
  s_cmp_eq_u32 s73, s91
  s_cselect_b32 s74, 4, 0
  s_lshr_b64 s[100:101], s[100:101], s74
  s_and_b32 s73, s100, 15
  s_sub_u32 s92, s92, 1
  s_cselect_b32 s73, s91, s73
  s_cselect_b32 s74, 0, 4
  s_lshr_b64 s[100:101], s[100:101], s74
  s_mul_i32 s74, s73, 393216
  s_lshl_b32 s73, s73, 7
  s_add_u32 s75, s75, 43008
  s_cmp_eq_u32 s75, 129024
  s_cselect_b32 s75, 0, s75
  s_add_u32 s3, s75, s76
  s_add_u32 m0, s3, 0
  s_nop 0
  buffer_load_dwordx4 v4, s[36:39], s73 offen lds
  s_add_u32 m0, s3, 1024
  s_nop 0
  buffer_load_dwordx4 v5, s[36:39], s73 offen lds
  s_add_u32 m0, s3, 2048
  s_nop 0
  buffer_load_dwordx4 v6, s[36:39], s73 offen lds
  s_add_u32 m0, s3, 3072
  s_nop 0
  buffer_load_dwordx4 v7, s[36:39], s73 offen lds
  s_add_u32 m0, s78, s75
  s_mov_b64 exec, s[14:15]
  buffer_load_dwordx4 v28, s[36:39], s73 offen lds
  s_mov_b64 exec, -1
  s_add_u32 s3, s75, s77
  s_add_u32 m0, s3, 0
  s_add_u32 s4, s74, 0
  buffer_load_dwordx4 v8, s[40:43], s4 offen lds
  s_add_u32 m0, s3, 1024
  s_nop 0
  buffer_load_dwordx4 v9, s[40:43], s4 offen lds
  s_add_u32 m0, s3, 8192
  s_add_u32 s4, s74, 2048
  buffer_load_dwordx4 v8, s[40:43], s4 offen lds
  s_add_u32 m0, s3, 9216
  s_nop 0
  buffer_load_dwordx4 v9, s[40:43], s4 offen lds
  s_add_u32 m0, s3, 16384
  s_add_u32 s4, s74, 4096
  buffer_load_dwordx4 v8, s[40:43], s4 offen lds
  s_add_u32 m0, s3, 17408
  s_nop 0
  buffer_load_dwordx4 v9, s[40:43], s4 offen lds
  s_and_b32 s73, s100, 15
  s_cmp_eq_u32 s73, s91
  s_cselect_b32 s74, 4, 0
  s_lshr_b64 s[100:101], s[100:101], s74
  s_and_b32 s73, s100, 15
  s_sub_u32 s92, s92, 1
  s_cselect_b32 s73, s91, s73
  s_cselect_b32 s74, 0, 4
  s_lshr_b64 s[100:101], s[100:101], s74
  s_mul_i32 s74, s73, 393216
  s_lshl_b32 s73, s73, 7
  s_add_u32 s75, s75, 43008
  s_cmp_eq_u32 s75, 129024
  s_cselect_b32 s75, 0, s75
  s_mov_b32 s52, s24
  s_and_b32 s53, s25, 0xffff
  s_mov_b32 s54, 7340032
  s_mov_b32 s55, 0x00020000
  s_min_u32 s3, s2, 223
  s_mul_i32 s4, s3, 4682
  s_lshr_b32 s4, s4, 16
  s_mul_i32 s5, s4, 14
  s_sub_u32 s3, s3, s5
  s_lshl_b32 s3, s3, 2
  s_and_b32 s5, s70, 3
  s_add_u32 s3, s3, s5
  s_mul_i32 s5, s4, 458752
  s_lshl_b32 s8, s3, 7
  s_add_u32 s95, s5, s8
  s_lshl_b32 s9, s4, 14
  s_lshl_b32 s8, s3, 8
  s_add_u32 s94, s9, s8
  v_lshrrev_b32 v2, 3, v1
  v_mul_u32_u24 v2, 7168, v2
  v_and_b32 v3, 7, v1
  v_lshl_add_u32 v26, v3, 4, v2
  s_and_b32 s3, s70, 3
  s_lshl_b32 s4, s2, 2
  s_add_u32 s3, s3, s4
  s_sub_u32 s4, 384, s40
  s_and_b32 s4, s4, 0x380
  s_mul_i32 s5, s3, 6144
  s_add_u32 s5, s5, s4
  s_buffer_load_dword s84, s[40:43], s5 offset:0
  s_buffer_load_dword s84, s[40:43], s5 offset:64
  s_buffer_load_dword s84, s[40:43], s5 offset:1024
  s_buffer_load_dword s84, s[40:43], s5 offset:1088
  s_buffer_load_dword s84, s[40:43], s5 offset:2048
  s_buffer_load_dword s84, s[40:43], s5 offset:2112
  s_buffer_load_dword s84, s[40:43], s5 offset:3072
  s_buffer_load_dword s84, s[40:43], s5 offset:3136
  s_buffer_load_dword s84, s[40:43], s5 offset:4096
  s_buffer_load_dword s84, s[40:43], s5 offset:4160
  s_buffer_load_dword s84, s[40:43], s5 offset:5120
  s_buffer_load_dword s84, s[40:43], s5 offset:5184
  s_add_u32 s56, s22, 24903680
  s_addc_u32 s57, s23, 0
  s_and_b32 s57, s57, 0xffff
  s_mov_b32 s58, 262144
  s_mov_b32 s59, 0x00020000
  s_and_b32 s3, s70, 3
  s_lshl2_add_u32 s4, s68, s3
  s_lshl_b32 s4, s4, 8
  v_lshrrev_b32 v2, 4, v1
  v_and_b32 v3, 15, v1
  v_lshl_add_u32 v3, v3, 4, s4
  v_lshl_add_u32 v18, v2, 14, v3
  s_lshl_b32 s4, s68, 5
  s_add_u32 s4, s4, s3
  s_sub_u32 s4, s4, 4
  s_max_i32 s4, s4, 0
  s_lshl_b32 s4, s4, 5
  v_lshrrev_b32 v2, 2, v1
  v_and_b32 v3, 3, v1
  v_lshl_add_u32 v3, v3, 3, s4
  v_lshl_add_u32 v19, v2, 14, v3
  s_lshl_b32 s3, s68, 2
  s_sub_u32 s3, s3, 4
  v_and_b32 v20, 7, v1
  v_add_u32 v20, s3, v20
  v_max_i32 v20, 0, v20
  v_lshlrev_b32 v20, 2, v20
  s_and_b32 s65, s65, 0xffff
  s_mov_b32 s66, 256
  s_mov_b32 s67, 0x00020000
  s_waitcnt vmcnt(11)
  s_barrier
  s_add_u32 s3, s75, s76
  s_add_u32 m0, s3, 0
  s_nop 0
  buffer_load_dwordx4 v4, s[36:39], s73 offen lds
  s_add_u32 m0, s3, 1024
  s_nop 0
  buffer_load_dwordx4 v5, s[36:39], s73 offen lds
  s_add_u32 m0, s3, 2048
  s_nop 0
  buffer_load_dwordx4 v6, s[36:39], s73 offen lds
  s_add_u32 m0, s3, 3072
  s_nop 0
  buffer_load_dwordx4 v7, s[36:39], s73 offen lds
  s_add_u32 m0, s78, s75
  s_mov_b64 exec, s[14:15]
  buffer_load_dwordx4 v28, s[36:39], s73 offen lds
  s_mov_b64 exec, -1
  s_add_u32 s3, s75, s77
  s_add_u32 m0, s3, 0
  s_add_u32 s4, s74, 0
  buffer_load_dwordx4 v8, s[40:43], s4 offen lds
  s_add_u32 m0, s3, 1024
  s_nop 0
  buffer_load_dwordx4 v9, s[40:43], s4 offen lds
  s_add_u32 m0, s3, 8192
  s_add_u32 s4, s74, 2048
  buffer_load_dwordx4 v8, s[40:43], s4 offen lds
  s_add_u32 m0, s3, 9216
  s_nop 0
  buffer_load_dwordx4 v9, s[40:43], s4 offen lds
  s_add_u32 m0, s3, 16384
  s_add_u32 s4, s74, 4096
  buffer_load_dwordx4 v8, s[40:43], s4 offen lds
  s_add_u32 m0, s3, 17408
  s_nop 0
  buffer_load_dwordx4 v9, s[40:43], s4 offen lds
  s_and_b32 s73, s100, 15
  s_cmp_eq_u32 s73, s91
  s_cselect_b32 s74, 4, 0
  s_lshr_b64 s[100:101], s[100:101], s74
  s_and_b32 s73, s100, 15
  s_sub_u32 s92, s92, 1
  s_cselect_b32 s73, s91, s73
  s_cselect_b32 s74, 0, 4
  s_lshr_b64 s[100:101], s[100:101], s74
  s_mul_i32 s74, s73, 393216
  s_lshl_b32 s73, s73, 7
  s_add_u32 s75, s75, 43008
  s_cmp_eq_u32 s75, 129024
  s_cselect_b32 s75, 0, s75
  s_buffer_load_dword s84, s[48:51], s98 offset:0
  s_buffer_load_dword s84, s[48:51], s98 offset:64
  s_buffer_load_dword s84, s[48:51], s98 offset:128
  s_buffer_load_dword s84, s[48:51], s98 offset:192
  s_add_u32 s98, s98, 256
  buffer_load_dwordx4 v[64:67], v26, s[52:55], s95 offen
  s_add_u32 s95, s95, 57344
  buffer_load_dwordx4 v[68:71], v26, s[52:55], s95 offen
  s_add_u32 s95, s95, 57344
  s_waitcnt vmcnt(13)
  s_barrier
  s_add_u32 s3, s75, s76
  s_add_u32 m0, s3, 0
  s_nop 0
  buffer_load_dwordx4 v4, s[36:39], s73 offen lds
  s_add_u32 m0, s3, 1024
  s_nop 0
  buffer_load_dwordx4 v5, s[36:39], s73 offen lds
  s_add_u32 m0, s3, 2048
  s_nop 0
  buffer_load_dwordx4 v6, s[36:39], s73 offen lds
  s_add_u32 m0, s3, 3072
  s_nop 0
  buffer_load_dwordx4 v7, s[36:39], s73 offen lds
  s_add_u32 m0, s78, s75
  s_mov_b64 exec, s[14:15]
  buffer_load_dwordx4 v28, s[36:39], s73 offen lds
  s_mov_b64 exec, -1
  s_add_u32 s3, s75, s77
  s_add_u32 m0, s3, 0
  s_add_u32 s4, s74, 0
  buffer_load_dwordx4 v8, s[40:43], s4 offen lds
  s_add_u32 m0, s3, 1024
  s_nop 0
  buffer_load_dwordx4 v9, s[40:43], s4 offen lds
  s_add_u32 m0, s3, 8192
  s_add_u32 s4, s74, 2048
  buffer_load_dwordx4 v8, s[40:43], s4 offen lds
  s_add_u32 m0, s3, 9216
  s_nop 0
  buffer_load_dwordx4 v9, s[40:43], s4 offen lds
  s_add_u32 m0, s3, 16384
  s_add_u32 s4, s74, 4096
  buffer_load_dwordx4 v8, s[40:43], s4 offen lds
  s_add_u32 m0, s3, 17408
  s_nop 0
  buffer_load_dwordx4 v9, s[40:43], s4 offen lds
  s_and_b32 s73, s100, 15
  s_cmp_eq_u32 s73, s91
  s_cselect_b32 s74, 4, 0
  s_lshr_b64 s[100:101], s[100:101], s74
  s_and_b32 s73, s100, 15
  s_sub_u32 s92, s92, 1
  s_cselect_b32 s73, s91, s73
  s_cselect_b32 s74, 0, 4
  s_lshr_b64 s[100:101], s[100:101], s74
  s_mul_i32 s74, s73, 393216
  s_lshl_b32 s73, s73, 7
  s_add_u32 s75, s75, 43008
  s_cmp_eq_u32 s75, 129024
  s_cselect_b32 s75, 0, s75
  s_buffer_load_dword s84, s[48:51], s98 offset:0
  s_buffer_load_dword s84, s[48:51], s98 offset:64
  s_buffer_load_dword s84, s[48:51], s98 offset:128
  s_buffer_load_dword s84, s[48:51], s98 offset:192
  s_add_u32 s98, s98, 256
  buffer_load_dwordx4 v[72:75], v26, s[52:55], s95 offen
  s_add_u32 s95, s95, 57344
  buffer_load_dwordx4 v[76:79], v26, s[52:55], s95 offen
  s_add_u32 s95, s95, 57344
  s_waitcnt vmcnt(15)
  s_barrier
  s_add_u32 s3, s75, s76
  s_add_u32 m0, s3, 0
  s_nop 0
  buffer_load_dwordx4 v4, s[36:39], s73 offen lds
  s_add_u32 m0, s3, 1024
  s_nop 0
  buffer_load_dwordx4 v5, s[36:39], s73 offen lds
  s_add_u32 m0, s3, 2048
  s_nop 0
  buffer_load_dwordx4 v6, s[36:39], s73 offen lds
  s_add_u32 m0, s3, 3072
  s_nop 0
  buffer_load_dwordx4 v7, s[36:39], s73 offen lds
  s_add_u32 m0, s78, s75
  s_mov_b64 exec, s[14:15]
  buffer_load_dwordx4 v28, s[36:39], s73 offen lds
  s_mov_b64 exec, -1
  s_add_u32 s3, s75, s77
  s_add_u32 m0, s3, 0
  s_add_u32 s4, s74, 0
  buffer_load_dwordx4 v8, s[40:43], s4 offen lds
  s_add_u32 m0, s3, 1024
  s_nop 0
  buffer_load_dwordx4 v9, s[40:43], s4 offen lds
  s_add_u32 m0, s3, 8192
  s_add_u32 s4, s74, 2048
  buffer_load_dwordx4 v8, s[40:43], s4 offen lds
  s_add_u32 m0, s3, 9216
  s_nop 0
  buffer_load_dwordx4 v9, s[40:43], s4 offen lds
  s_add_u32 m0, s3, 16384
  s_add_u32 s4, s74, 4096
  buffer_load_dwordx4 v8, s[40:43], s4 offen lds
  s_add_u32 m0, s3, 17408
  s_nop 0
  buffer_load_dwordx4 v9, s[40:43], s4 offen lds
  s_and_b32 s73, s100, 15
  s_cmp_eq_u32 s73, s91
  s_cselect_b32 s74, 4, 0
  s_lshr_b64 s[100:101], s[100:101], s74
  s_and_b32 s73, s100, 15
  s_sub_u32 s92, s92, 1
  s_cselect_b32 s73, s91, s73
  s_cselect_b32 s74, 0, 4
  s_lshr_b64 s[100:101], s[100:101], s74
  s_mul_i32 s74, s73, 393216
  s_lshl_b32 s73, s73, 7
  s_add_u32 s75, s75, 43008
  s_cmp_eq_u32 s75, 129024
  s_cselect_b32 s75, 0, s75
  s_buffer_load_dword s84, s[48:51], s98 offset:0
  s_buffer_load_dword s84, s[48:51], s98 offset:64
  s_buffer_load_dword s84, s[48:51], s98 offset:128
  s_buffer_load_dword s84, s[48:51], s98 offset:192
  s_add_u32 s98, s98, 256
  buffer_load_dwordx4 v[80:83], v26, s[52:55], s95 offen
  s_add_u32 s95, s95, 57344
  buffer_load_dwordx4 v[84:87], v26, s[52:55], s95 offen
  s_add_u32 s95, s95, 57344
  s_waitcnt vmcnt(15)
  s_barrier
  s_add_u32 s3, s75, s76
  s_add_u32 m0, s3, 0
  s_nop 0
  buffer_load_dwordx4 v4, s[36:39], s73 offen lds
  s_add_u32 m0, s3, 1024
  s_nop 0
  buffer_load_dwordx4 v5, s[36:39], s73 offen lds
  s_add_u32 m0, s3, 2048
  s_nop 0
  buffer_load_dwordx4 v6, s[36:39], s73 offen lds
  s_add_u32 m0, s3, 3072
  s_nop 0
  buffer_load_dwordx4 v7, s[36:39], s73 offen lds
  s_add_u32 m0, s78, s75
  s_mov_b64 exec, s[14:15]
  buffer_load_dwordx4 v28, s[36:39], s73 offen lds
  s_mov_b64 exec, -1
  s_add_u32 s3, s75, s77
  s_add_u32 m0, s3, 0
  s_add_u32 s4, s74, 0
  buffer_load_dwordx4 v8, s[40:43], s4 offen lds
  s_add_u32 m0, s3, 1024
  s_nop 0
  buffer_load_dwordx4 v9, s[40:43], s4 offen lds
  s_add_u32 m0, s3, 8192
  s_add_u32 s4, s74, 2048
  buffer_load_dwordx4 v8, s[40:43], s4 offen lds
  s_add_u32 m0, s3, 9216
  s_nop 0
  buffer_load_dwordx4 v9, s[40:43], s4 offen lds
  s_add_u32 m0, s3, 16384
  s_add_u32 s4, s74, 4096
  buffer_load_dwordx4 v8, s[40:43], s4 offen lds
  s_add_u32 m0, s3, 17408
  s_nop 0
  buffer_load_dwordx4 v9, s[40:43], s4 offen lds
  s_and_b32 s73, s100, 15
  s_cmp_eq_u32 s73, s91
  s_cselect_b32 s74, 4, 0
  s_lshr_b64 s[100:101], s[100:101], s74
  s_and_b32 s73, s100, 15
  s_sub_u32 s92, s92, 1
  s_cselect_b32 s73, s91, s73
  s_cselect_b32 s74, 0, 4
  s_lshr_b64 s[100:101], s[100:101], s74
  s_mul_i32 s74, s73, 393216
  s_lshl_b32 s73, s73, 7
  s_add_u32 s75, s75, 43008
  s_cmp_eq_u32 s75, 129024
  s_cselect_b32 s75, 0, s75
  s_buffer_load_dword s84, s[48:51], s98 offset:0
  s_buffer_load_dword s84, s[48:51], s98 offset:64
  s_buffer_load_dword s84, s[48:51], s98 offset:128
  s_buffer_load_dword s84, s[48:51], s98 offset:192
  s_add_u32 s98, s98, 256
  buffer_load_dwordx4 v[88:91], v26, s[52:55], s95 offen
  s_add_u32 s95, s95, 57344
  buffer_load_dwordx4 v[92:95], v26, s[52:55], s95 offen
  s_waitcnt vmcnt(15)
  s_barrier
  s_add_u32 s3, s75, s76
  s_add_u32 m0, s3, 0
  s_nop 0
  buffer_load_dwordx4 v4, s[36:39], s73 offen lds
  s_add_u32 m0, s3, 1024
  s_nop 0
  buffer_load_dwordx4 v5, s[36:39], s73 offen lds
  s_add_u32 m0, s3, 2048
  s_nop 0
  buffer_load_dwordx4 v6, s[36:39], s73 offen lds
  s_add_u32 m0, s3, 3072
  s_nop 0
  buffer_load_dwordx4 v7, s[36:39], s73 offen lds
  s_add_u32 m0, s78, s75
  s_mov_b64 exec, s[14:15]
  buffer_load_dwordx4 v28, s[36:39], s73 offen lds
  s_mov_b64 exec, -1
  s_add_u32 s3, s75, s77
  s_add_u32 m0, s3, 0
  s_add_u32 s4, s74, 0
  buffer_load_dwordx4 v8, s[40:43], s4 offen lds
  s_add_u32 m0, s3, 1024
  s_nop 0
  buffer_load_dwordx4 v9, s[40:43], s4 offen lds
  s_add_u32 m0, s3, 8192
  s_add_u32 s4, s74, 2048
  buffer_load_dwordx4 v8, s[40:43], s4 offen lds
  s_add_u32 m0, s3, 9216
  s_nop 0
  buffer_load_dwordx4 v9, s[40:43], s4 offen lds
  s_add_u32 m0, s3, 16384
  s_add_u32 s4, s74, 4096
  buffer_load_dwordx4 v8, s[40:43], s4 offen lds
  s_add_u32 m0, s3, 17408
  s_nop 0
  buffer_load_dwordx4 v9, s[40:43], s4 offen lds
  s_and_b32 s73, s100, 15
  s_cmp_eq_u32 s73, s91
  s_cselect_b32 s74, 4, 0
  s_lshr_b64 s[100:101], s[100:101], s74
  s_and_b32 s73, s100, 15
  s_sub_u32 s92, s92, 1
  s_cselect_b32 s73, s91, s73
  s_cselect_b32 s74, 0, 4
  s_lshr_b64 s[100:101], s[100:101], s74
  s_mul_i32 s74, s73, 393216
  s_lshl_b32 s73, s73, 7
  s_add_u32 s75, s75, 43008
  s_cmp_eq_u32 s75, 129024
  s_cselect_b32 s75, 0, s75
  s_buffer_load_dword s84, s[48:51], s98 offset:0
  s_buffer_load_dword s84, s[48:51], s98 offset:64
  s_buffer_load_dword s84, s[48:51], s98 offset:128
  s_buffer_load_dword s84, s[48:51], s98 offset:192
  s_add_u32 s98, s98, 256
  s_waitcnt vmcnt(13)
  s_barrier
  s_mov_b32 s79, 6
L_attn0_ld1:
  s_add_u32 s3, s75, s76
  s_add_u32 m0, s3, 0
  s_nop 0
  buffer_load_dwordx4 v4, s[36:39], s73 offen lds
  s_add_u32 m0, s3, 1024
  s_nop 0
  buffer_load_dwordx4 v5, s[36:39], s73 offen lds
  s_add_u32 m0, s3, 2048
  s_nop 0
  buffer_load_dwordx4 v6, s[36:39], s73 offen lds
  s_add_u32 m0, s3, 3072
  s_nop 0
  buffer_load_dwordx4 v7, s[36:39], s73 offen lds
  s_add_u32 m0, s78, s75
  s_mov_b64 exec, s[14:15]
  buffer_load_dwordx4 v28, s[36:39], s73 offen lds
  s_mov_b64 exec, -1
  s_add_u32 s3, s75, s77
  s_add_u32 m0, s3, 0
  s_add_u32 s4, s74, 0
  buffer_load_dwordx4 v8, s[40:43], s4 offen lds
  s_add_u32 m0, s3, 1024
  s_nop 0
  buffer_load_dwordx4 v9, s[40:43], s4 offen lds
  s_add_u32 m0, s3, 8192
  s_add_u32 s4, s74, 2048
  buffer_load_dwordx4 v8, s[40:43], s4 offen lds
  s_add_u32 m0, s3, 9216
  s_nop 0
  buffer_load_dwordx4 v9, s[40:43], s4 offen lds
  s_add_u32 m0, s3, 16384
  s_add_u32 s4, s74, 4096
  buffer_load_dwordx4 v8, s[40:43], s4 offen lds
  s_add_u32 m0, s3, 17408
  s_nop 0
  buffer_load_dwordx4 v9, s[40:43], s4 offen lds
  s_and_b32 s73, s100, 15
  s_cmp_eq_u32 s73, s91
  s_cselect_b32 s74, 4, 0
  s_lshr_b64 s[100:101], s[100:101], s74
  s_and_b32 s73, s100, 15
  s_sub_u32 s92, s92, 1
  s_cselect_b32 s73, s91, s73
  s_cselect_b32 s74, 0, 4
  s_lshr_b64 s[100:101], s[100:101], s74
  s_mul_i32 s74, s73, 393216
  s_lshl_b32 s73, s73, 7
  s_add_u32 s75, s75, 43008
  s_cmp_eq_u32 s75, 129024
  s_cselect_b32 s75, 0, s75
  s_buffer_load_dword s84, s[48:51], s98 offset:0
  s_buffer_load_dword s84, s[48:51], s98 offset:64
  s_buffer_load_dword s84, s[48:51], s98 offset:128
  s_buffer_load_dword s84, s[48:51], s98 offset:192
  s_add_u32 s98, s98, 256
  s_waitcnt vmcnt(11)
  s_barrier
  s_sub_u32 s79, s79, 1
  s_cmp_lg_u32 s79, 0
  s_cbranch_scc1 L_attn0_ld1
  s_add_u32 s3, s75, s76
  s_add_u32 m0, s3, 0
  s_nop 0
  buffer_load_dwordx4 v4, s[36:39], s73 offen lds
  s_add_u32 m0, s3, 1024
  s_nop 0
  buffer_load_dwordx4 v5, s[36:39], s73 offen lds
  s_add_u32 m0, s3, 2048
  s_nop 0
  buffer_load_dwordx4 v6, s[36:39], s73 offen lds
  s_add_u32 m0, s3, 3072
  s_nop 0
  buffer_load_dwordx4 v7, s[36:39], s73 offen lds
  s_add_u32 m0, s78, s75
  s_mov_b64 exec, s[14:15]
  buffer_load_dwordx4 v28, s[36:39], s73 offen lds
  s_mov_b64 exec, -1
  s_add_u32 s3, s75, s77
  s_add_u32 m0, s3, 0
  s_add_u32 s4, s74, 0
  buffer_load_dwordx4 v8, s[40:43], s4 offen lds
  s_add_u32 m0, s3, 1024
  s_nop 0
  buffer_load_dwordx4 v9, s[40:43], s4 offen lds
  s_add_u32 m0, s3, 8192
  s_add_u32 s4, s74, 2048
  buffer_load_dwordx4 v8, s[40:43], s4 offen lds
  s_add_u32 m0, s3, 9216
  s_nop 0
  buffer_load_dwordx4 v9, s[40:43], s4 offen lds
  s_add_u32 m0, s3, 16384
  s_add_u32 s4, s74, 4096
  buffer_load_dwordx4 v8, s[40:43], s4 offen lds
  s_add_u32 m0, s3, 17408
  s_nop 0
  buffer_load_dwordx4 v9, s[40:43], s4 offen lds
  s_and_b32 s73, s100, 15
  s_cmp_eq_u32 s73, s91
  s_cselect_b32 s74, 4, 0
  s_lshr_b64 s[100:101], s[100:101], s74
  s_and_b32 s73, s100, 15
  s_sub_u32 s92, s92, 1
  s_cselect_b32 s73, s91, s73
  s_cselect_b32 s74, 0, 4
  s_lshr_b64 s[100:101], s[100:101], s74
  s_mul_i32 s74, s73, 393216
  s_lshl_b32 s73, s73, 7
  s_add_u32 s75, s75, 43008
  s_cmp_eq_u32 s75, 129024
  s_cselect_b32 s75, 0, s75
  s_buffer_load_dword s84, s[48:51], s98 offset:0
  s_buffer_load_dword s84, s[48:51], s98 offset:64
  s_buffer_load_dword s84, s[48:51], s98 offset:128
  s_buffer_load_dword s84, s[48:51], s98 offset:192
  s_add_u32 s98, s98, 256
  buffer_load_dword v21, v20, s[64:67], 0 offen sc1
  s_waitcnt vmcnt(12)
  s_barrier
  s_add_u32 s3, s75, s76
  s_add_u32 m0, s3, 0
  s_nop 0
  buffer_load_dwordx4 v4, s[36:39], s73 offen lds
  s_add_u32 m0, s3, 1024
  s_nop 0
  buffer_load_dwordx4 v5, s[36:39], s73 offen lds
  s_add_u32 m0, s3, 2048
  s_nop 0
  buffer_load_dwordx4 v6, s[36:39], s73 offen lds
  s_add_u32 m0, s3, 3072
  s_nop 0
  buffer_load_dwordx4 v7, s[36:39], s73 offen lds
  s_add_u32 m0, s78, s75
  s_mov_b64 exec, s[14:15]
  buffer_load_dwordx4 v28, s[36:39], s73 offen lds
  s_mov_b64 exec, -1
  s_add_u32 s3, s75, s77
  s_add_u32 m0, s3, 0
  s_add_u32 s4, s74, 0
  buffer_load_dwordx4 v8, s[40:43], s4 offen lds
  s_add_u32 m0, s3, 1024
  s_nop 0
  buffer_load_dwordx4 v9, s[40:43], s4 offen lds
  s_add_u32 m0, s3, 8192
  s_add_u32 s4, s74, 2048
  buffer_load_dwordx4 v8, s[40:43], s4 offen lds
  s_add_u32 m0, s3, 9216
  s_nop 0
  buffer_load_dwordx4 v9, s[40:43], s4 offen lds
  s_add_u32 m0, s3, 16384
  s_add_u32 s4, s74, 4096
  buffer_load_dwordx4 v8, s[40:43], s4 offen lds
  s_add_u32 m0, s3, 17408
  s_nop 0
  buffer_load_dwordx4 v9, s[40:43], s4 offen lds
  s_and_b32 s73, s100, 15
  s_cmp_eq_u32 s73, s91
  s_cselect_b32 s74, 4, 0
  s_lshr_b64 s[100:101], s[100:101], s74
  s_and_b32 s73, s100, 15
  s_sub_u32 s92, s92, 1
  s_cselect_b32 s73, s91, s73
  s_cselect_b32 s74, 0, 4
  s_lshr_b64 s[100:101], s[100:101], s74
  s_mul_i32 s74, s73, 393216
  s_lshl_b32 s73, s73, 7
  s_add_u32 s75, s75, 43008
  s_cmp_eq_u32 s75, 129024
  s_cselect_b32 s75, 0, s75
  s_buffer_load_dword s84, s[48:51], s98 offset:0
  s_buffer_load_dword s84, s[48:51], s98 offset:64
  s_buffer_load_dword s84, s[48:51], s98 offset:128
  s_buffer_load_dword s84, s[48:51], s98 offset:192
  s_add_u32 s98, s98, 256
  s_waitcnt vmcnt(12)
  s_barrier
  s_add_u32 s3, s75, s76
  s_add_u32 m0, s3, 0
  s_nop 0
  buffer_load_dwordx4 v4, s[36:39], s73 offen lds
  s_add_u32 m0, s3, 1024
  s_nop 0
  buffer_load_dwordx4 v5, s[36:39], s73 offen lds
  s_add_u32 m0, s3, 2048
  s_nop 0
  buffer_load_dwordx4 v6, s[36:39], s73 offen lds
  s_add_u32 m0, s3, 3072
  s_nop 0
  buffer_load_dwordx4 v7, s[36:39], s73 offen lds
  s_add_u32 m0, s78, s75
  s_mov_b64 exec, s[14:15]
  buffer_load_dwordx4 v28, s[36:39], s73 offen lds
  s_mov_b64 exec, -1
  s_add_u32 s3, s75, s77
  s_add_u32 m0, s3, 0
  s_add_u32 s4, s74, 0
  buffer_load_dwordx4 v8, s[40:43], s4 offen lds
  s_add_u32 m0, s3, 1024
  s_nop 0
  buffer_load_dwordx4 v9, s[40:43], s4 offen lds
  s_add_u32 m0, s3, 8192
  s_add_u32 s4, s74, 2048
  buffer_load_dwordx4 v8, s[40:43], s4 offen lds
  s_add_u32 m0, s3, 9216
  s_nop 0
  buffer_load_dwordx4 v9, s[40:43], s4 offen lds
  s_add_u32 m0, s3, 16384
  s_add_u32 s4, s74, 4096
  buffer_load_dwordx4 v8, s[40:43], s4 offen lds
  s_add_u32 m0, s3, 17408
  s_nop 0
  buffer_load_dwordx4 v9, s[40:43], s4 offen lds
  s_and_b32 s73, s100, 15
  s_cmp_eq_u32 s73, s91
  s_cselect_b32 s74, 4, 0
  s_lshr_b64 s[100:101], s[100:101], s74
  s_and_b32 s73, s100, 15
  s_sub_u32 s92, s92, 1
  s_cselect_b32 s73, s91, s73
  s_cselect_b32 s74, 0, 4
  s_lshr_b64 s[100:101], s[100:101], s74
  s_mul_i32 s74, s73, 393216
  s_lshl_b32 s73, s73, 7
  s_add_u32 s75, s75, 43008
  s_cmp_eq_u32 s75, 129024
  s_cselect_b32 s75, 0, s75
  s_buffer_load_dword s84, s[48:51], s98 offset:0
  s_buffer_load_dword s84, s[48:51], s98 offset:64
  s_buffer_load_dword s84, s[48:51], s98 offset:128
  s_buffer_load_dword s84, s[48:51], s98 offset:192
  s_add_u32 s98, s98, 256
  s_waitcnt vmcnt(11)
  s_barrier
  s_mov_b32 s5, 0x100000
  L_attn_dchk:
  v_cmp_ne_u32 vcc, 0x01010101, v21
  s_cbranch_vccz L_attn_dok
  s_sub_u32 s5, s5, 1
  buffer_load_dword v21, v20, s[64:67], 0 offen sc1
  s_waitcnt vmcnt(0)
  s_cbranch_scc0 L_attn_dchk
  L_attn_dok:
  buffer_load_dwordx4 v[32:35], v18, s[56:59], 0 offen
  s_mov_b32 s3, 65536
  buffer_load_dwordx4 v[36:39], v18, s[56:59], s3 offen
  s_mov_b32 s3, 131072
  buffer_load_dwordx4 v[40:43], v18, s[56:59], s3 offen
  s_mov_b32 s3, 196608
  buffer_load_dwordx4 v[44:47], v18, s[56:59], s3 offen
  buffer_load_dwordx2 v[48:49], v19, s[56:59], 0 offen
  s_mov_b32 s60, s20
  s_and_b32 s61, s21, 0xffff
  s_mov_b32 s62, 2097152
  s_mov_b32 s63, 0x00020000
  s_and_b32 s3, s70, 3
  s_mul_i32 s3, s3, 8
  s_mul_i32 s4, s99, 32
  s_add_u32 s3, s3, s4
  v_lshrrev_b32 v2, 3, v1
  v_add_u32 v2, s3, v2
  v_mul_u32_u24 v2, 2048, v2
  v_and_b32 v3, 7, v1
  v_lshl_add_u32 v2, v3, 8, v2
  s_and_b32 s3, s2, 7
  s_lshr_b32 s3, s3, 2
  s_mul_i32 s3, s3, 128
  buffer_load_dword v96, v2, s[60:63], s3 offen
  s_waitcnt vmcnt(6)
  s_barrier
  s_mov_b32 s79, 0x4000
  s_waitcnt vmcnt(1)
L_attn_schk:
  v_pk_add_f32 v[32:33], v[32:33], v[36:37]
  v_pk_add_f32 v[34:35], v[34:35], v[38:39]
  v_pk_add_f32 v[40:41], v[40:41], v[44:45]
  v_pk_add_f32 v[42:43], v[42:43], v[46:47]
  v_pk_add_f32 v[32:33], v[32:33], v[40:41]
  v_pk_add_f32 v[34:35], v[34:35], v[42:43]
  s_nop 1
  v_permlane32_swap_b32 v32, v34
  v_permlane32_swap_b32 v33, v35
  v_pk_add_f32 v[32:33], v[32:33], v[34:35]
  v_cmp_u_f32 vcc, v32, v33
  v_cmp_u_f32 s[4:5], v48, v49
  s_or_b64 s[4:5], vcc, s[4:5]
  s_cbranch_scc0 L_attn_sok
  s_sub_u32 s79, s79, 1
  s_cbranch_scc1 L_attn_sok
  buffer_load_dwordx4 v[32:35], v18, s[56:59], 0 offen sc1
  s_mov_b32 s3, 65536
  buffer_load_dwordx4 v[36:39], v18, s[56:59], s3 offen sc1
  s_mov_b32 s3, 131072
  buffer_load_dwordx4 v[40:43], v18, s[56:59], s3 offen sc1
  s_mov_b32 s3, 196608
  buffer_load_dwordx4 v[44:47], v18, s[56:59], s3 offen sc1
  buffer_load_dwordx2 v[48:49], v19, s[56:59], 0 offen sc1
  s_waitcnt vmcnt(0)
  s_branch L_attn_schk
L_attn_sok:
  v_mov_b32 v34, v32
  v_mov_b32 v35, v33
  s_nop 0
  v_permlane16_swap_b32 v32, v34
  v_permlane16_swap_b32 v33, v35
  v_pk_add_f32 v[32:33], v[32:33], v[34:35]
  v_mul_f32 v32, 0x3a800000, v32
  v_mul_f32 v33, 0x3a800000, v33
  v_fma_f32 v33, -v32, v32, v33
  v_max_f32 v33, 0, v33
  v_add_f32 v33, 0x3727c5ac, v33
  v_rsq_f32 v33, v33
  s_nop 0
  s_and_b32 s3, s70, 3
  s_lshl_b32 s5, s3, 7
  s_add_u32 s5, s5, 129088
  v_and_b32 v3, 15, v1
  v_lshrrev_b32 v2, 5, v1
  v_lshl_add_u32 v2, v3, 1, v2
  v_lshl_add_u32 v2, v2, 2, s5
  ds_write2_b32 v2, v32, v33 offset0:0 offset1:160
  v_mov_b32 v50, v48
  v_mov_b32 v51, v49
  s_nop 0
  v_permlane32_swap_b32 v48, v50
  v_permlane32_swap_b32 v49, v51
  v_pk_add_f32 v[48:49], v[48:49], v[50:51]
  v_mov_b32 v50, v48
  v_mov_b32 v51, v49
  s_nop 0
  v_permlane16_swap_b32 v48, v50
  v_permlane16_swap_b32 v49, v51
  v_pk_add_f32 v[48:49], v[48:49], v[50:51]
  s_nop 1
  v_add_f32_dpp v48, v48, v48 row_ror:8 row_mask:0xf bank_mask:0xf
  v_add_f32_dpp v49, v49, v49 row_ror:8 row_mask:0xf bank_mask:0xf
  s_nop 1
  v_add_f32_dpp v48, v48, v48 row_ror:4 row_mask:0xf bank_mask:0xf
  v_add_f32_dpp v49, v49, v49 row_ror:4 row_mask:0xf bank_mask:0xf
  v_mul_f32 v48, 0x3a800000, v48
  v_mul_f32 v49, 0x3a800000, v49
  v_fma_f32 v49, -v48, v48, v49
  v_max_f32 v49, 0, v49
  v_add_f32 v49, 0x3727c5ac, v49
  v_rsq_f32 v49, v49
  s_nop 0
  s_lshl_b32 s5, s3, 4
  s_add_u32 s5, s5, 129024
  v_and_b32 v3, 3, v1
  v_lshl_add_u32 v2, v3, 2, s5
  ds_write2_b32 v2, v48, v49 offset0:0 offset1:160
  s_waitcnt lgkmcnt(0)
  s_barrier
  s_barrier
  s_branch L_attn_ldend
L_attn_ld1:
  s_add_u32 s3, s68, s69
  s_and_b32 s3, s3, 3
  s_mov_b32 s100, 0x68532410
  s_mov_b32 s101, 0xfedbac97
  s_cmp_eq_u32 s3, 1
  s_cselect_b32 s100, 0x96435210, s100
  s_cselect_b32 s101, 0xfecbda87, s101
  s_cmp_eq_u32 s3, 2
  s_cselect_b32 s100, 0x75463210, s100
  s_cselect_b32 s101, 0xfdceb98a, s101
  s_cmp_eq_u32 s3, 3
  s_cselect_b32 s100, 0x65743210, s100
  s_cselect_b32 s101, 0xedfca9b8, s101
  s_add_u32 s56, s22, 24379392
  s_addc_u32 s57, s23, 0
  s_and_b32 s57, s57, 0xffff
  s_mov_b32 s58, 262144
  s_mov_b32 s59, 0x00020000
  s_and_b32 s3, s70, 3
  s_lshl2_add_u32 s4, s68, s3
  s_lshl_b32 s4, s4, 8
  v_lshrrev_b32 v2, 4, v1
  v_and_b32 v3, 15, v1
  v_lshl_add_u32 v3, v3, 4, s4
  v_lshl_add_u32 v18, v2, 14, v3
  s_lshl_b32 s4, s68, 5
  s_add_u32 s4, s4, s3
  s_sub_u32 s4, s4, 4
  s_max_i32 s4, s4, 0
  s_lshl_b32 s4, s4, 5
  v_lshrrev_b32 v2, 2, v1
  v_and_b32 v3, 3, v1
  v_lshl_add_u32 v3, v3, 3, s4
  v_lshl_add_u32 v19, v2, 14, v3
  s_lshr_b32 s3, s69, 3
  s_and_b32 s73, s69, 7
  s_lshl1_add_u32 s91, s73, s3
  s_mul_i32 s74, s91, 393216
  s_lshl_b32 s73, s91, 7
  s_mov_b32 s88, s73
  s_add_u32 m0, s77, 0
  s_add_u32 s4, s74, 0
  buffer_load_dwordx4 v8, s[40:43], s4 offen lds
  s_add_u32 m0, s77, 1024
  s_nop 0
  buffer_load_dwordx4 v9, s[40:43], s4 offen lds
  s_add_u32 m0, s77, 8192
  s_add_u32 s4, s74, 2048
  buffer_load_dwordx4 v8, s[40:43], s4 offen lds
  s_add_u32 m0, s77, 9216
  s_nop 0
  buffer_load_dwordx4 v9, s[40:43], s4 offen lds
  s_add_u32 m0, s77, 16384
  s_add_u32 s4, s74, 4096
  buffer_load_dwordx4 v8, s[40:43], s4 offen lds
  s_add_u32 m0, s77, 17408
  s_nop 0
  buffer_load_dwordx4 v9, s[40:43], s4 offen lds
  s_and_b32 s73, s100, 15
  s_cmp_eq_u32 s73, s91
  s_cselect_b32 s74, 4, 0
  s_lshr_b64 s[100:101], s[100:101], s74
  s_and_b32 s73, s100, 15
  s_lshr_b64 s[100:101], s[100:101], 4
  s_mul_i32 s74, s73, 393216
  s_lshl_b32 s73, s73, 7
  s_mov_b32 s75, 0
  s_add_u32 s44, s22, 41943040
  s_addc_u32 s45, s23, 0
  s_and_b32 s45, s45, 0xffff
  s_mov_b32 s46, 524288
  s_mov_b32 s47, 0x00020000
  s_lshl4_add_u32 s3, s97, s68
  s_and_b32 s4, s69, 15
  s_lshl4_add_u32 s3, s3, s4
  s_lshl_b32 s3, s3, 7
  s_sub_u32 s3, s3, 32768
  v_lshlrev_b32 v11, 7, v1
  s_cmp_eq_u32 s68, 0
  s_cselect_b32 s4, 15, 31
  v_and_b32 v2, 16, v1
  v_lshl_add_u32 v11, v2, 2, v11
  v_and_b32 v2, s4, v1
  v_lshlrev_b32 v2, 2, v2
  v_mov_b32 v3, 1
  s_mov_b32 s79, 0x100000
  s_waitcnt vmcnt(0)
  s_cmp_lg_u32 s70, 4
  s_barrier
  s_cbranch_scc1 L_attn_nofl
  s_mov_b32 exec_lo, 0xffffffff
  s_mov_b32 exec_hi, 0
  buffer_store_dword v3, v11, s[44:47], s87 offen sc1
  s_mov_b64 exec, -1
L_attn_nofl:
  s_mov_b32 s5, s3
  s_mov_b32 s89, s73
  s_add_u32 m0, s77, 43008
  s_add_u32 s4, s74, 0
  buffer_load_dwordx4 v8, s[40:43], s4 offen lds
  s_add_u32 m0, s77, 44032
  s_nop 0
  buffer_load_dwordx4 v9, s[40:43], s4 offen lds
  s_add_u32 m0, s77, 51200
  s_add_u32 s4, s74, 2048
  buffer_load_dwordx4 v8, s[40:43], s4 offen lds
  s_add_u32 m0, s77, 52224
  s_nop 0
  buffer_load_dwordx4 v9, s[40:43], s4 offen lds
  s_add_u32 m0, s77, 59392
  s_add_u32 s4, s74, 4096
  buffer_load_dwordx4 v8, s[40:43], s4 offen lds
  s_add_u32 m0, s77, 60416
  s_nop 0
  buffer_load_dwordx4 v9, s[40:43], s4 offen lds
  s_and_b32 s73, s100, 15
  s_cmp_eq_u32 s73, s91
  s_cselect_b32 s74, 4, 0
  s_lshr_b64 s[100:101], s[100:101], s74
  s_and_b32 s73, s100, 15
  s_lshr_b64 s[100:101], s[100:101], 4
  s_mul_i32 s74, s73, 393216
  s_lshl_b32 s73, s73, 7
  s_mov_b32 s90, s73
  s_add_u32 m0, s77, 86016
  s_add_u32 s4, s74, 0
  buffer_load_dwordx4 v8, s[40:43], s4 offen lds
  s_add_u32 m0, s77, 87040
  s_nop 0
  buffer_load_dwordx4 v9, s[40:43], s4 offen lds
  s_add_u32 m0, s77, 94208
  s_add_u32 s4, s74, 2048
  buffer_load_dwordx4 v8, s[40:43], s4 offen lds
  s_add_u32 m0, s77, 95232
  s_nop 0
  buffer_load_dwordx4 v9, s[40:43], s4 offen lds
  s_add_u32 m0, s77, 102400
  s_add_u32 s4, s74, 4096
  buffer_load_dwordx4 v8, s[40:43], s4 offen lds
  s_add_u32 m0, s77, 103424
  s_nop 0
  buffer_load_dwordx4 v9, s[40:43], s4 offen lds
  s_and_b32 s73, s100, 15
  s_cmp_eq_u32 s73, s91
  s_cselect_b32 s74, 4, 0
  s_lshr_b64 s[100:101], s[100:101], s74
  s_and_b32 s73, s100, 15
  s_lshr_b64 s[100:101], s[100:101], 4
  s_mul_i32 s74, s73, 393216
  s_lshl_b32 s73, s73, 7
  s_mov_b32 s3, s5
  s_cmp_lg_u32 s70, 4
  s_cbranch_scc1 L_attn_dep
L_attn_poll:
  buffer_load_dword v3, v2, s[44:47], s3 offen sc1
  s_sub_u32 s79, s79, 1
  s_cbranch_scc1 L_attn_dep
  s_waitcnt vmcnt(0)
  v_cmp_ne_u32 vcc, 1, v3
  s_cbranch_vccnz L_attn_poll
L_attn_dep:
  s_barrier
  s_add_u32 m0, s78, 89344
  s_mov_b64 exec, s[14:15]
  buffer_load_dwordx4 v28, s[36:39], s88 offen lds
  s_mov_b64 exec, -1
  s_add_u32 m0, s76, 43008
  s_nop 0
  buffer_load_dwordx4 v4, s[36:39], s89 offen lds
  s_add_u32 m0, s76, 44032
  s_nop 0
  buffer_load_dwordx4 v5, s[36:39], s89 offen lds
  s_add_u32 m0, s76, 45056
  s_nop 0
  buffer_load_dwordx4 v6, s[36:39], s89 offen lds
  s_add_u32 m0, s76, 46080
  s_nop 0
  buffer_load_dwordx4 v7, s[36:39], s89 offen lds
  s_add_u32 m0, s78, 43008
  s_mov_b64 exec, s[14:15]
  buffer_load_dwordx4 v28, s[36:39], s89 offen lds
  s_mov_b64 exec, -1
  s_add_u32 m0, s76, 86016
  s_nop 0
  buffer_load_dwordx4 v4, s[36:39], s90 offen lds
  s_add_u32 m0, s76, 87040
  s_nop 0
  buffer_load_dwordx4 v5, s[36:39], s90 offen lds
  s_add_u32 m0, s76, 88064
  s_nop 0
  buffer_load_dwordx4 v6, s[36:39], s90 offen lds
  s_add_u32 m0, s76, 89088
  s_nop 0
  buffer_load_dwordx4 v7, s[36:39], s90 offen lds
  s_add_u32 m0, s78, 86016
  s_mov_b64 exec, s[14:15]
  buffer_load_dwordx4 v28, s[36:39], s90 offen lds
  s_mov_b64 exec, -1
  s_waitcnt vmcnt(5)
  s_barrier
  s_mov_b32 s79, 12
L_attn1_ld1:
  s_add_u32 s3, s75, s76
  s_add_u32 m0, s3, 0
  s_nop 0
  buffer_load_dwordx4 v4, s[36:39], s73 offen lds
  s_add_u32 m0, s3, 1024
  s_nop 0
  buffer_load_dwordx4 v5, s[36:39], s73 offen lds
  s_add_u32 m0, s3, 2048
  s_nop 0
  buffer_load_dwordx4 v6, s[36:39], s73 offen lds
  s_add_u32 m0, s3, 3072
  s_nop 0
  buffer_load_dwordx4 v7, s[36:39], s73 offen lds
  s_add_u32 m0, s78, s75
  s_mov_b64 exec, s[14:15]
  buffer_load_dwordx4 v28, s[36:39], s73 offen lds
  s_mov_b64 exec, -1
  s_add_u32 s3, s75, s77
  s_add_u32 m0, s3, 0
  s_add_u32 s4, s74, 0
  buffer_load_dwordx4 v8, s[40:43], s4 offen lds
  s_add_u32 m0, s3, 1024
  s_nop 0
  buffer_load_dwordx4 v9, s[40:43], s4 offen lds
  s_add_u32 m0, s3, 8192
  s_add_u32 s4, s74, 2048
  buffer_load_dwordx4 v8, s[40:43], s4 offen lds
  s_add_u32 m0, s3, 9216
  s_nop 0
  buffer_load_dwordx4 v9, s[40:43], s4 offen lds
  s_add_u32 m0, s3, 16384
  s_add_u32 s4, s74, 4096
  buffer_load_dwordx4 v8, s[40:43], s4 offen lds
  s_add_u32 m0, s3, 17408
  s_nop 0
  buffer_load_dwordx4 v9, s[40:43], s4 offen lds
  s_and_b32 s73, s100, 15
  s_cmp_eq_u32 s73, s91
  s_cselect_b32 s74, 4, 0
  s_lshr_b64 s[100:101], s[100:101], s74
  s_and_b32 s73, s100, 15
  s_lshr_b64 s[100:101], s[100:101], 4
  s_mul_i32 s74, s73, 393216
  s_lshl_b32 s73, s73, 7
  s_add_u32 s75, s75, 43008
  s_cmp_eq_u32 s75, 129024
  s_cselect_b32 s75, 0, s75
  s_waitcnt vmcnt(11)
  s_barrier
  s_sub_u32 s79, s79, 1
  s_cmp_lg_u32 s79, 0
  s_cbranch_scc1 L_attn1_ld1
  s_add_u32 s3, s75, s76
  s_add_u32 m0, s3, 0
  s_nop 0
  buffer_load_dwordx4 v4, s[36:39], s73 offen lds
  s_add_u32 m0, s3, 1024
  s_nop 0
  buffer_load_dwordx4 v5, s[36:39], s73 offen lds
  s_add_u32 m0, s3, 2048
  s_nop 0
  buffer_load_dwordx4 v6, s[36:39], s73 offen lds
  s_add_u32 m0, s3, 3072
  s_nop 0
  buffer_load_dwordx4 v7, s[36:39], s73 offen lds
  s_add_u32 m0, s78, s75
  s_mov_b64 exec, s[14:15]
  buffer_load_dwordx4 v28, s[36:39], s73 offen lds
  s_mov_b64 exec, -1
  s_add_u32 s3, s75, s77
  s_add_u32 m0, s3, 0
  s_add_u32 s4, s74, 0
  buffer_load_dwordx4 v8, s[40:43], s4 offen lds
  s_add_u32 m0, s3, 1024
  s_nop 0
  buffer_load_dwordx4 v9, s[40:43], s4 offen lds
  s_add_u32 m0, s3, 8192
  s_add_u32 s4, s74, 2048
  buffer_load_dwordx4 v8, s[40:43], s4 offen lds
  s_add_u32 m0, s3, 9216
  s_nop 0
  buffer_load_dwordx4 v9, s[40:43], s4 offen lds
  s_add_u32 m0, s3, 16384
  s_add_u32 s4, s74, 4096
  buffer_load_dwordx4 v8, s[40:43], s4 offen lds
  s_add_u32 m0, s3, 17408
  s_nop 0
  buffer_load_dwordx4 v9, s[40:43], s4 offen lds
  s_and_b32 s73, s100, 15
  s_cmp_eq_u32 s73, s91
  s_cselect_b32 s74, 4, 0
  s_lshr_b64 s[100:101], s[100:101], s74
  s_and_b32 s73, s100, 15
  s_lshr_b64 s[100:101], s[100:101], 4
  s_mul_i32 s74, s73, 393216
  s_lshl_b32 s73, s73, 7
  s_add_u32 s75, s75, 43008
  s_cmp_eq_u32 s75, 129024
  s_cselect_b32 s75, 0, s75
  s_mov_b32 s60, s20
  s_and_b32 s61, s21, 0xffff
  s_mov_b32 s62, 2097152
  s_mov_b32 s63, 0x00020000
  s_and_b32 s3, s70, 3
  s_mul_i32 s3, s3, 8
  s_mul_i32 s4, s99, 32
  s_add_u32 s3, s3, s4
  v_lshrrev_b32 v2, 3, v1
  v_add_u32 v2, s3, v2
  v_mul_u32_u24 v2, 2048, v2
  v_and_b32 v3, 7, v1
  v_lshl_add_u32 v2, v3, 8, v2
  s_and_b32 s3, s2, 7
  s_lshr_b32 s3, s3, 2
  s_mul_i32 s3, s3, 128
  buffer_load_dword v96, v2, s[60:63], s3 offen
  s_waitcnt vmcnt(12)
  s_barrier
  buffer_load_dwordx4 v[32:35], v18, s[56:59], 0 offen
  s_mov_b32 s3, 65536
  buffer_load_dwordx4 v[36:39], v18, s[56:59], s3 offen
  s_mov_b32 s3, 131072
  buffer_load_dwordx4 v[40:43], v18, s[56:59], s3 offen
  s_mov_b32 s3, 196608
  buffer_load_dwordx4 v[44:47], v18, s[56:59], s3 offen
  buffer_load_dwordx2 v[48:49], v19, s[56:59], 0 offen
  s_waitcnt vmcnt(6)
  s_barrier
  s_waitcnt vmcnt(0)
  v_pk_add_f32 v[32:33], v[32:33], v[36:37]
  v_pk_add_f32 v[34:35], v[34:35], v[38:39]
  v_pk_add_f32 v[40:41], v[40:41], v[44:45]
  v_pk_add_f32 v[42:43], v[42:43], v[46:47]
  v_pk_add_f32 v[32:33], v[32:33], v[40:41]
  v_pk_add_f32 v[34:35], v[34:35], v[42:43]
  s_nop 1
  v_permlane32_swap_b32 v32, v34
  v_permlane32_swap_b32 v33, v35
  v_pk_add_f32 v[32:33], v[32:33], v[34:35]
  v_mov_b32 v34, v32
  v_mov_b32 v35, v33
  s_nop 0
  v_permlane16_swap_b32 v32, v34
  v_permlane16_swap_b32 v33, v35
  v_pk_add_f32 v[32:33], v[32:33], v[34:35]
  v_mul_f32 v32, 0x3a800000, v32
  v_mul_f32 v33, 0x3a800000, v33
  v_fma_f32 v33, -v32, v32, v33
  v_max_f32 v33, 0, v33
  v_add_f32 v33, 0x3727c5ac, v33
  v_rsq_f32 v33, v33
  s_nop 0
  s_and_b32 s3, s70, 3
  s_lshl_b32 s5, s3, 7
  s_add_u32 s5, s5, 129088
  v_and_b32 v3, 15, v1
  v_lshrrev_b32 v2, 5, v1
  v_lshl_add_u32 v2, v3, 1, v2
  v_lshl_add_u32 v2, v2, 2, s5
  ds_write2_b32 v2, v32, v33 offset0:0 offset1:160
  v_mov_b32 v50, v48
  v_mov_b32 v51, v49
  s_nop 0
  v_permlane32_swap_b32 v48, v50
  v_permlane32_swap_b32 v49, v51
  v_pk_add_f32 v[48:49], v[48:49], v[50:51]
  v_mov_b32 v50, v48
  v_mov_b32 v51, v49
  s_nop 0
  v_permlane16_swap_b32 v48, v50
  v_permlane16_swap_b32 v49, v51
  v_pk_add_f32 v[48:49], v[48:49], v[50:51]
  s_nop 1
  v_add_f32_dpp v48, v48, v48 row_ror:8 row_mask:0xf bank_mask:0xf
  v_add_f32_dpp v49, v49, v49 row_ror:8 row_mask:0xf bank_mask:0xf
  s_nop 1
  v_add_f32_dpp v48, v48, v48 row_ror:4 row_mask:0xf bank_mask:0xf
  v_add_f32_dpp v49, v49, v49 row_ror:4 row_mask:0xf bank_mask:0xf
  v_mul_f32 v48, 0x3a800000, v48
  v_mul_f32 v49, 0x3a800000, v49
  v_fma_f32 v49, -v48, v48, v49
  v_max_f32 v49, 0, v49
  v_add_f32 v49, 0x3727c5ac, v49
  v_rsq_f32 v49, v49
  s_nop 0
  s_lshl_b32 s5, s3, 4
  s_add_u32 s5, s5, 129024
  v_and_b32 v3, 3, v1
  v_lshl_add_u32 v2, v3, 2, s5
  ds_write2_b32 v2, v48, v49 offset0:0 offset1:160
  s_waitcnt lgkmcnt(0)
  s_barrier
  s_barrier
L_attn_ldend:
  s_lshl_b32 s87, s97, 15
  s_lshl_b32 s4, s68, 11
  s_add_u32 s87, s87, s4
  s_lshl_b32 s4, s69, 2
  s_add_u32 s87, s87, s4
  s_add_u32 s97, s97, 1
  s_branch L_wo_body
L_attn_end:
  s_endpgm
.fill 22, 4, 0xbf800000
L_attn_compute:
  s_cmp_lg_u32 s96, 0
  s_cbranch_scc1 L_pfc1_skip
  s_getpc_b64 s[4:5]
L_pfc1:
  s_lshl_b32 s3, s99, 2
  s_add_u32 s3, s3, s70
  s_mul_i32 s3, s3, 320
  s_min_u32 s3, s3, L_w2_c1-L_attn_c0-320
  s_add_i32 s3, s3, L_attn_c0-L_pfc1
  s_ashr_i32 s6, s3, 31
  s_add_u32 s4, s4, s3
  s_addc_u32 s5, s5, s6
  s_load_dword s40, s[4:5], 0
  s_load_dword s40, s[4:5], 64
  s_load_dword s40, s[4:5], 128
  s_load_dword s40, s[4:5], 192
  s_load_dword s40, s[4:5], 256
L_pfc1_skip:
  s_and_b32 s71, s70, 1
  s_lshr_b32 s72, s70, 1
  v_and_b32 v3, 31, v1
  v_lshlrev_b32 v3, 2, v3
  v_add_u32 v3, 40960, v3
  v_mov_b32 v236, 0x3f803f80
  v_mov_b32 v237, 0x3f803f80
  v_mov_b32 v238, 0x3f803f80
  v_mov_b32 v239, 0x3f803f80
  ds_write_b32 v3, v236
  ds_write_b32 v3, v236 offset:43008
  v_add_u32 v3, 86016, v3
  ds_write_b32 v3, v236
  ds_write_b32 v3, v236 offset:3328
  v_and_b32 v3, 15, v1
  v_lshrrev_b32 v2, 4, v1
  v_lshrrev_b32 v33, 1, v3
  s_lshl_b32 s8, s71, 13
  v_xor_b32 v4, v2, v33
  v_lshlrev_b32 v4, 4, v4
  v_lshl_add_u32 v4, v3, 7, v4
  v_add_u32 v8, 40960, v4
  v_add_u32 v4, s8, v4
  v_add_u32 v5, 4, v2
  v_xor_b32 v5, v5, v33
  v_lshlrev_b32 v5, 4, v5
  v_lshl_add_u32 v5, v3, 7, v5
  v_add_u32 v9, 40960, v5
  v_add_u32 v5, s8, v5
  v_bfe_u32 v34, v1, 2, 2
  v_lshl_add_u32 v34, v2, 3, v34
  v_lshlrev_b32 v34, 7, v34
  v_and_b32 v33, 3, v1
  v_lshl_add_u32 v34, v33, 3, v34
  v_bfe_u32 v33, v1, 3, 2
  v_lshl_add_u32 v34, v33, 5, v34
  s_lshl_b32 s8, s70, 5
  v_xor_b32 v34, s8, v34
  v_add_u32 v6, 16384, v34
  v_xor_b32 v7, 32, v6
  s_mov_b32 s75, 0
  v_add_u32_e64 v10, s75, v4
  v_add_u32_e64 v11, s75, v5
  v_add_u32_e64 v12, s75, v6
  v_add_u32_e64 v13, s75, v7
  v_add_u32_e64 v14, s75, v8
  v_add_u32_e64 v15, s75, v9
  s_add_u32 s75, s75, 43008
  s_cmp_eq_u32 s75, 129024
  s_cselect_b32 s75, 0, s75
  s_and_b32 s79, s69, 3
  s_add_u32 s79, s79, 1
  s_mul_i32 s98, s96, 3
  s_cmp_eq_u32 s96, 0
  s_cbranch_scc1 L_attn_nog
  s_mov_b32 s79, 15
  ds_read_b128 v[32:35], v10 offset:0
  ds_read_b128 v[36:39], v10 offset:2048
  ds_read_b128 v[40:43], v10 offset:4096
  ds_read_b128 v[44:47], v10 offset:6144
  ds_read_b64_tr_b16 v[52:53], v12 offset:0
  ds_read_b64_tr_b16 v[54:55], v12 offset:512
  ds_read_b64_tr_b16 v[56:57], v13 offset:0
  ds_read_b64_tr_b16 v[58:59], v13 offset:512
  ds_read_b64_tr_b16 v[60:61], v12 offset:8192
  ds_read_b64_tr_b16 v[62:63], v12 offset:8704
  ds_read_b64_tr_b16 v[64:65], v13 offset:8192
  ds_read_b64_tr_b16 v[66:67], v13 offset:8704
  ds_read_b64_tr_b16 v[68:69], v12 offset:16384
  ds_read_b64_tr_b16 v[70:71], v12 offset:16896
  ds_read_b64_tr_b16 v[72:73], v13 offset:16384
  ds_read_b64_tr_b16 v[74:75], v13 offset:16896
  s_waitcnt lgkmcnt(0)
  v_mfma_f32_16x16x32_bf16 v[128:131], v[52:55], v[32:35], 0
  ds_read_b128 v[76:79], v11 offset:0
  v_mfma_f32_16x16x32_bf16 v[132:135], v[52:55], v[36:39], 0
  ds_read_b128 v[80:83], v11 offset:2048
  v_mfma_f32_16x16x32_bf16 v[136:139], v[52:55], v[40:43], 0
  ds_read_b128 v[84:87], v11 offset:4096
  v_mfma_f32_16x16x32_bf16 v[140:143], v[52:55], v[44:47], 0
  ds_read_b128 v[88:91], v11 offset:6144
  v_mfma_f32_16x16x32_bf16 v[156:159], v[56:59], v[44:47], 0
  ds_read_b64_tr_b16 v[96:97], v12 offset:4096
  v_mfma_f32_16x16x32_bf16 v[152:155], v[56:59], v[40:43], 0
  ds_read_b64_tr_b16 v[98:99], v12 offset:4608
  v_mfma_f32_16x16x32_bf16 v[148:151], v[56:59], v[36:39], 0
  ds_read_b64_tr_b16 v[100:101], v13 offset:4096
  v_mfma_f32_16x16x32_bf16 v[144:147], v[56:59], v[32:35], 0
  ds_read_b64_tr_b16 v[102:103], v13 offset:4608
  v_mfma_f32_16x16x32_bf16 v[160:163], v[60:63], v[32:35], 0
  ds_read_b64_tr_b16 v[104:105], v12 offset:12288
  v_mfma_f32_16x16x32_bf16 v[164:167], v[60:63], v[36:39], 0
  ds_read_b64_tr_b16 v[106:107], v12 offset:12800
  v_mfma_f32_16x16x32_bf16 v[168:171], v[60:63], v[40:43], 0
  ds_read_b64_tr_b16 v[108:109], v13 offset:12288
  v_mfma_f32_16x16x32_bf16 v[172:175], v[60:63], v[44:47], 0
  ds_read_b64_tr_b16 v[110:111], v13 offset:12800
  v_mfma_f32_16x16x32_bf16 v[188:191], v[64:67], v[44:47], 0
  ds_read_b64_tr_b16 v[112:113], v12 offset:20480
  v_mfma_f32_16x16x32_bf16 v[184:187], v[64:67], v[40:43], 0
  ds_read_b64_tr_b16 v[114:115], v12 offset:20992
  v_mfma_f32_16x16x32_bf16 v[180:183], v[64:67], v[36:39], 0
  ds_read_b64_tr_b16 v[116:117], v13 offset:20480
  v_mfma_f32_16x16x32_bf16 v[176:179], v[64:67], v[32:35], 0
  ds_read_b64_tr_b16 v[118:119], v13 offset:20992
  v_mfma_f32_16x16x32_bf16 v[192:195], v[32:35], v[68:71], 0
  v_add_u32_e64 v10, s75, v4
  v_mfma_f32_16x16x32_bf16 v[196:199], v[36:39], v[68:71], 0
  v_add_u32_e64 v11, s75, v5
  v_mfma_f32_16x16x32_bf16 v[200:203], v[40:43], v[68:71], 0
  v_add_u32_e64 v12, s75, v6
  v_mfma_f32_16x16x32_bf16 v[204:207], v[44:47], v[68:71], 0
  v_add_u32_e64 v13, s75, v7
  v_mfma_f32_16x16x32_bf16 v[220:223], v[44:47], v[72:75], 0
  v_add_u32_e64 v14, s75, v8
  v_mfma_f32_16x16x32_bf16 v[216:219], v[40:43], v[72:75], 0
  v_add_u32_e64 v15, s75, v9
  v_mfma_f32_16x16x32_bf16 v[212:215], v[36:39], v[72:75], 0
  s_add_u32 s75, s75, 43008
  v_mfma_f32_16x16x32_bf16 v[208:211], v[32:35], v[72:75], 0
  s_cmp_eq_u32 s75, 129024
  s_cselect_b32 s75, 0, s75
  s_waitcnt lgkmcnt(0)
  v_mfma_f32_16x16x32_bf16 v[128:131], v[96:99], v[76:79], v[128:131]
  v_mfma_f32_16x16x32_bf16 v[132:135], v[96:99], v[80:83], v[132:135]
  v_mfma_f32_16x16x32_bf16 v[136:139], v[96:99], v[84:87], v[136:139]
  v_mfma_f32_16x16x32_bf16 v[140:143], v[96:99], v[88:91], v[140:143]
  v_mfma_f32_16x16x32_bf16 v[156:159], v[100:103], v[88:91], v[156:159]
  v_mfma_f32_16x16x32_bf16 v[152:155], v[100:103], v[84:87], v[152:155]
  v_mfma_f32_16x16x32_bf16 v[148:151], v[100:103], v[80:83], v[148:151]
  v_mfma_f32_16x16x32_bf16 v[144:147], v[100:103], v[76:79], v[144:147]
  v_mfma_f32_16x16x32_bf16 v[160:163], v[104:107], v[76:79], v[160:163]
  v_mfma_f32_16x16x32_bf16 v[164:167], v[104:107], v[80:83], v[164:167]
  v_mfma_f32_16x16x32_bf16 v[168:171], v[104:107], v[84:87], v[168:171]
  v_mfma_f32_16x16x32_bf16 v[172:175], v[104:107], v[88:91], v[172:175]
  v_mfma_f32_16x16x32_bf16 v[188:191], v[108:111], v[88:91], v[188:191]
  v_mfma_f32_16x16x32_bf16 v[184:187], v[108:111], v[84:87], v[184:187]
  v_mfma_f32_16x16x32_bf16 v[180:183], v[108:111], v[80:83], v[180:183]
  v_mfma_f32_16x16x32_bf16 v[176:179], v[108:111], v[76:79], v[176:179]
  v_mfma_f32_16x16x32_bf16 v[192:195], v[76:79], v[112:115], v[192:195]
  v_mfma_f32_16x16x32_bf16 v[196:199], v[80:83], v[112:115], v[196:199]
  v_mfma_f32_16x16x32_bf16 v[200:203], v[84:87], v[112:115], v[200:203]
  v_mfma_f32_16x16x32_bf16 v[204:207], v[88:91], v[112:115], v[204:207]
  v_mfma_f32_16x16x32_bf16 v[220:223], v[88:91], v[116:119], v[220:223]
  v_mfma_f32_16x16x32_bf16 v[216:219], v[84:87], v[116:119], v[216:219]
  v_mfma_f32_16x16x32_bf16 v[212:215], v[80:83], v[116:119], v[212:215]
  v_mfma_f32_16x16x32_bf16 v[208:211], v[76:79], v[116:119], v[208:211]
  s_barrier
  v_mov_b32 v76, v52
  v_mov_b32 v77, v53
  v_mov_b32 v78, v54
  v_mov_b32 v79, v55
  v_mov_b32 v80, v60
  v_mov_b32 v81, v61
  v_mov_b32 v82, v62
  v_mov_b32 v83, v63
  v_mov_b32 v84, v68
  v_mov_b32 v85, v69
  v_mov_b32 v86, v70
  v_mov_b32 v87, v71
L_attn_nog:
  v_and_b32 v35, 1, v2
  v_xor_b32 v35, s71, v35
  s_lshl_b32 s8, s68, 7
  s_lshl_b32 s9, s71, 6
  s_add_u32 s8, s8, s9
  s_add_u32 s10, s8, s69
  s_lshl_b32 s10, s10, 11
  s_lshl_b32 s11, s72, 10
  s_add_u32 s10, s10, s11
  v_lshl_add_u32 v31, v1, 4, s10
  s_mul_i32 s10, s72, 14336
  s_add_u32 s10, s10, 1024
  s_lshl_b32 s11, s71, 10
  s_add_u32 s4, s10, s11
  s_sub_u32 s5, s10, s11
  s_mul_i32 s6, s71, 6144
  v_lshl_add_u32 v16, v1, 4, s4
  v_add_u32 v17, s6, v16
  v_lshl_add_u32 v18, v1, 4, s5
  v_add_u32 v18, s6, v18
  v_lshl_add_u32 v19, v2, 8, s4
  v_lshl_add_u32 v20, v2, 8, s5
  v_lshl_add_u32 v21, v3, 4, s4
  v_lshl_add_u32 v22, v3, 4, s5
  s_lshl_b32 s10, s71, 8
  s_add_u32 s10, s10, 129024
  v_lshl_add_u32 v23, v3, 2, s10
  v_lshl_add_u32 v24, v2, 4, s10
  v_and_b32 v33, 1, v3
  v_cmp_eq_u32 s[48:49], 1, v33
  v_lshl_add_u32 v34, v2, 2, v33
  v_add_u32 v35, 2, v34
  v_cmp_gt_u32 s[50:51], v34, v3
  v_cmp_gt_u32 s[52:53], v35, v3
  v_mov_b32 v36, 0xffff
  v_mov_b32 v37, 0xffff0000
  v_cndmask_b32 v36, v36, v37, s[48:49]
  s_add_u32 s10, s10, 704
  v_lshl_add_u32 v34, v34, 2, s10
  v_lshl_add_u32 v35, v35, 2, s10
  v_subrev_u32 v38, 64, v34
  v_subrev_u32 v39, 64, v35
  v_cndmask_b32 v25, v34, v38, s[50:51]
  v_cndmask_b32 v26, v35, v39, s[52:53]
  v_cndmask_b32 v27, 0, v36, s[50:51]
  v_cndmask_b32 v29, 0, v36, s[52:53]
  v_xor_b32 v28, v27, v36
  v_xor_b32 v30, v29, v36
  s_cmp_eq_u32 s8, 0
  s_cselect_b64 s[54:55], s[50:51], 0
  s_cselect_b64 s[14:15], s[52:53], 0
  s_cmp_lg_u32 s96, 0
  s_cbranch_scc1 L_attn_nozero
  v_mov_b32 v122, 0
  v_mov_b32 v123, 0
  v_mov_b32 v124, 0
  v_mov_b32 v125, 0
  v_mov_b32 v126, 0
  v_mov_b32 v127, 0
  v_mov_b32 v128, 0
  v_mov_b32 v129, 0
  v_mov_b32 v130, 0
  v_mov_b32 v131, 0
  v_mov_b32 v132, 0
  v_mov_b32 v133, 0
  v_mov_b32 v134, 0
  v_mov_b32 v135, 0
  v_mov_b32 v136, 0
  v_mov_b32 v137, 0
  v_mov_b32 v138, 0
  v_mov_b32 v139, 0
  v_mov_b32 v140, 0
  v_mov_b32 v141, 0
  v_mov_b32 v142, 0
  v_mov_b32 v143, 0
  v_mov_b32 v144, 0
  v_mov_b32 v145, 0
  v_mov_b32 v146, 0
  v_mov_b32 v147, 0
  v_mov_b32 v148, 0
  v_mov_b32 v149, 0
  v_mov_b32 v150, 0
  v_mov_b32 v151, 0
  v_mov_b32 v152, 0
  v_mov_b32 v153, 0
  v_mov_b32 v154, 0
  v_mov_b32 v155, 0
  v_mov_b32 v156, 0
  v_mov_b32 v157, 0
  v_mov_b32 v158, 0
  v_mov_b32 v159, 0
  v_mov_b32 v160, 0
  v_mov_b32 v161, 0
  v_mov_b32 v162, 0
  v_mov_b32 v163, 0
  v_mov_b32 v164, 0
  v_mov_b32 v165, 0
  v_mov_b32 v166, 0
  v_mov_b32 v167, 0
  v_mov_b32 v168, 0
  v_mov_b32 v169, 0
  v_mov_b32 v170, 0
  v_mov_b32 v171, 0
  v_mov_b32 v172, 0
  v_mov_b32 v173, 0
  v_mov_b32 v174, 0
  v_mov_b32 v175, 0
  v_mov_b32 v176, 0
  v_mov_b32 v177, 0
  v_mov_b32 v178, 0
  v_mov_b32 v179, 0
  v_mov_b32 v180, 0
  v_mov_b32 v181, 0
  v_mov_b32 v182, 0
  v_mov_b32 v183, 0
  v_mov_b32 v184, 0
  v_mov_b32 v185, 0
  v_mov_b32 v186, 0
  v_mov_b32 v187, 0
  v_mov_b32 v188, 0
  v_mov_b32 v189, 0
  v_mov_b32 v190, 0
  v_mov_b32 v191, 0
  v_mov_b32 v192, 0
  v_mov_b32 v193, 0
  v_mov_b32 v194, 0
  v_mov_b32 v195, 0
  v_mov_b32 v196, 0
  v_mov_b32 v197, 0
  v_mov_b32 v198, 0
  v_mov_b32 v199, 0
  v_mov_b32 v200, 0
  v_mov_b32 v201, 0
  v_mov_b32 v202, 0
  v_mov_b32 v203, 0
  v_mov_b32 v204, 0
  v_mov_b32 v205, 0
  v_mov_b32 v206, 0
  v_mov_b32 v207, 0
  v_mov_b32 v208, 0
  v_mov_b32 v209, 0
  v_mov_b32 v210, 0
  v_mov_b32 v211, 0
  v_mov_b32 v212, 0
  v_mov_b32 v213, 0
  v_mov_b32 v214, 0
  v_mov_b32 v215, 0
  v_mov_b32 v216, 0
  v_mov_b32 v217, 0
  v_mov_b32 v218, 0
  v_mov_b32 v219, 0
  v_mov_b32 v220, 0
  v_mov_b32 v221, 0
  v_mov_b32 v222, 0
  v_mov_b32 v223, 0
  v_mov_b32 v224, 0
  v_mov_b32 v225, 0
  v_mov_b32 v226, 0
  v_mov_b32 v227, 0
  v_mov_b32 v228, 0
  v_mov_b32 v229, 0
  v_mov_b32 v230, 0
  v_mov_b32 v231, 0
  v_mov_b32 v232, 0
  v_mov_b32 v233, 0
  v_mov_b32 v234, 0
  v_mov_b32 v235, 0
  s_waitcnt lgkmcnt(0)
  s_lshl_b32 s3, s72, 5
  s_add_u32 s3, s3, s8
  s_lshl_b32 s4, s69, 14
  s_lshl3_add_u32 s3, s3, s4
  v_lshrrev_b32 v121, 1, v2
  v_lshl_add_u32 v121, v121, 4, v3
  v_and_b32 v120, 1, v2
  v_lshl_add_u32 v121, v121, 1, v120
  v_lshl_add_u32 v120, v121, 2, s3
  s_add_u32 s56, s22, 24903680
  s_addc_u32 s57, s23, 0
  s_and_b32 s57, s57, 0xffff
  s_mov_b32 s58, 262144
  s_mov_b32 s59, 0x00020000
  s_add_u32 s60, s22, 41943040
  s_addc_u32 s61, s23, 0
  s_and_b32 s61, s61, 0xffff
  s_mov_b32 s62, 524288
  s_mov_b32 s63, 0x00020000
  s_lshl_b32 s3, s2, 11
  s_cmp_lg_u32 s70, 0
  s_cbranch_scc1 L_attn_noclr
  s_lshl_b32 s5, s68, 10
  s_add_u32 s4, s4, s5
  v_lshlrev_b32 v121, 4, v1
  v_mov_b32 v40, -1
  v_mov_b32 v41, -1
  v_mov_b32 v42, -1
  v_mov_b32 v43, -1
  buffer_store_dwordx4 v[40:43], v121, s[56:59], s4 offen sc1
  buffer_store_dwordx4 v[128:131], v121, s[60:63], s3 offen offset:0 sc1
  buffer_store_dwordx4 v[128:131], v121, s[60:63], s3 offen offset:1024 sc1
  v_mov_b32 v126, 1
L_attn_noclr:
  s_and_b32 s65, s65, 0xffff
  s_mov_b32 s66, 256
  s_mov_b32 s67, 0x00020000
  s_mov_b32 s7, 0x3f803f80
L_attn_nozero:
  s_waitcnt lgkmcnt(0)
  s_mov_b32 s44, s34
  s_and_b32 s45, s35, 0xffff
  s_mov_b32 s46, 4194304
  s_mov_b32 s47, 0x00020000
  s_cmp_eq_u32 s96, 0
  s_barrier
  s_cbranch_scc1 L_attn_first
  ds_read_b128 v[88:91], v14 offset:46336
  ds_read_b128 v[92:95], v15 offset:46336
  ds_read_b128 v[32:35], v10 offset:0
  ds_read_b128 v[36:39], v10 offset:2048
  ds_read_b128 v[40:43], v10 offset:4096
  ds_read_b128 v[44:47], v10 offset:6144
  ds_read_b128 v[48:51], v14
  ds_read_b64_tr_b16 v[52:53], v12 offset:0
  ds_read_b64_tr_b16 v[54:55], v12 offset:512
  ds_read_b64_tr_b16 v[56:57], v13 offset:0
  ds_read_b64_tr_b16 v[58:59], v13 offset:512
  ds_read_b64_tr_b16 v[60:61], v12 offset:8192
  ds_read_b64_tr_b16 v[62:63], v12 offset:8704
  ds_read_b64_tr_b16 v[64:65], v13 offset:8192
  ds_read_b64_tr_b16 v[66:67], v13 offset:8704
  ds_read_b64_tr_b16 v[68:69], v12 offset:16384
  ds_read_b64_tr_b16 v[70:71], v12 offset:16896
  ds_read_b64_tr_b16 v[72:73], v13 offset:16384
  ds_read_b64_tr_b16 v[74:75], v13 offset:16896
  s_waitcnt lgkmcnt(15)
  v_mfma_f32_16x16x32_bf16 v[224:227], v[76:79], v[88:91], 0
  v_mfma_f32_16x16x32_bf16 v[228:231], v[80:83], v[88:91], 0
  v_mfma_f32_16x16x32_bf16 v[232:235], v[88:91], v[84:87], 0
  v_mfma_f32_16x16x32_bf16 v[224:227], v[96:99], v[92:95], v[224:227]
  v_mfma_f32_16x16x32_bf16 v[228:231], v[104:107], v[92:95], v[228:231]
  v_mfma_f32_16x16x32_bf16 v[232:235], v[92:95], v[112:115], v[232:235]
  s_waitcnt lgkmcnt(0)
  s_branch L_attn_loop
L_attn_first:
  ds_read_b128 v[32:35], v10 offset:0
  ds_read_b128 v[36:39], v10 offset:2048
  ds_read_b128 v[40:43], v10 offset:4096
  ds_read_b128 v[44:47], v10 offset:6144
  ds_read_b128 v[48:51], v14
  ds_read_b64_tr_b16 v[52:53], v12 offset:0
  ds_read_b64_tr_b16 v[54:55], v12 offset:512
  ds_read_b64_tr_b16 v[56:57], v13 offset:0
  ds_read_b64_tr_b16 v[58:59], v13 offset:512
  ds_read_b64_tr_b16 v[60:61], v12 offset:8192
  ds_read_b64_tr_b16 v[62:63], v12 offset:8704
  ds_read_b64_tr_b16 v[64:65], v13 offset:8192
  ds_read_b64_tr_b16 v[66:67], v13 offset:8704
  ds_read_b64_tr_b16 v[68:69], v12 offset:16384
  ds_read_b64_tr_b16 v[70:71], v12 offset:16896
  ds_read_b64_tr_b16 v[72:73], v13 offset:16384
  ds_read_b64_tr_b16 v[74:75], v13 offset:16896
.p2align 5
  s_nop 0
  s_nop 0
  s_nop 0
  s_waitcnt lgkmcnt(0)
L_attn_loop:
  v_mfma_f32_16x16x32_bf16 v[128:131], v[52:55], v[32:35], v[128:131]
  ds_read_b128 v[76:79], v11 offset:0
  v_mfma_f32_16x16x32_bf16 v[132:135], v[52:55], v[36:39], v[132:135]
  ds_read_b128 v[80:83], v11 offset:2048
  v_mfma_f32_16x16x32_bf16 v[136:139], v[52:55], v[40:43], v[136:139]
  ds_read_b128 v[84:87], v11 offset:4096
  v_mfma_f32_16x16x32_bf16 v[140:143], v[52:55], v[44:47], v[140:143]
  ds_read_b128 v[88:91], v11 offset:6144
  v_mfma_f32_16x16x32_bf16 v[224:227], v[52:55], v[48:51], v[224:227]
  ds_read_b128 v[92:95], v15
  v_mfma_f32_16x16x32_bf16 v[156:159], v[56:59], v[44:47], v[156:159]
  ds_read_b64_tr_b16 v[96:97], v12 offset:4096
  v_mfma_f32_16x16x32_bf16 v[152:155], v[56:59], v[40:43], v[152:155]
  ds_read_b64_tr_b16 v[98:99], v12 offset:4608
  v_mfma_f32_16x16x32_bf16 v[148:151], v[56:59], v[36:39], v[148:151]
  ds_read_b64_tr_b16 v[100:101], v13 offset:4096
  v_mfma_f32_16x16x32_bf16 v[144:147], v[56:59], v[32:35], v[144:147]
  ds_read_b64_tr_b16 v[102:103], v13 offset:4608
  v_mfma_f32_16x16x32_bf16 v[160:163], v[60:63], v[32:35], v[160:163]
  ds_read_b64_tr_b16 v[104:105], v12 offset:12288
  v_mfma_f32_16x16x32_bf16 v[164:167], v[60:63], v[36:39], v[164:167]
  ds_read_b64_tr_b16 v[106:107], v12 offset:12800
  v_mfma_f32_16x16x32_bf16 v[168:171], v[60:63], v[40:43], v[168:171]
  ds_read_b64_tr_b16 v[108:109], v13 offset:12288
  v_mfma_f32_16x16x32_bf16 v[172:175], v[60:63], v[44:47], v[172:175]
  ds_read_b64_tr_b16 v[110:111], v13 offset:12800
  v_mfma_f32_16x16x32_bf16 v[228:231], v[60:63], v[48:51], v[228:231]
  ds_read_b64_tr_b16 v[112:113], v12 offset:20480
  v_mfma_f32_16x16x32_bf16 v[188:191], v[64:67], v[44:47], v[188:191]
  ds_read_b64_tr_b16 v[114:115], v12 offset:20992
  v_mfma_f32_16x16x32_bf16 v[184:187], v[64:67], v[40:43], v[184:187]
  ds_read_b64_tr_b16 v[116:117], v13 offset:20480
  v_mfma_f32_16x16x32_bf16 v[180:183], v[64:67], v[36:39], v[180:183]
  ds_read_b64_tr_b16 v[118:119], v13 offset:20992
  v_mfma_f32_16x16x32_bf16 v[176:179], v[64:67], v[32:35], v[176:179]
  v_add_u32_e64 v10, s75, v4
  v_mfma_f32_16x16x32_bf16 v[192:195], v[32:35], v[68:71], v[192:195]
  v_add_u32_e64 v11, s75, v5
  v_mfma_f32_16x16x32_bf16 v[196:199], v[36:39], v[68:71], v[196:199]
  v_add_u32_e64 v12, s75, v6
  v_mfma_f32_16x16x32_bf16 v[200:203], v[40:43], v[68:71], v[200:203]
  v_add_u32_e64 v13, s75, v7
  v_mfma_f32_16x16x32_bf16 v[204:207], v[44:47], v[68:71], v[204:207]
  v_add_u32_e64 v14, s75, v8
  v_mfma_f32_16x16x32_bf16 v[232:235], v[48:51], v[68:71], v[232:235]
  v_add_u32_e64 v15, s75, v9
  v_mfma_f32_16x16x32_bf16 v[220:223], v[44:47], v[72:75], v[220:223]
  s_add_u32 s75, s75, 43008
  v_mfma_f32_16x16x32_bf16 v[216:219], v[40:43], v[72:75], v[216:219]
  s_cmp_eq_u32 s75, 129024
  v_mfma_f32_16x16x32_bf16 v[212:215], v[36:39], v[72:75], v[212:215]
  s_cselect_b32 s75, 0, s75
  s_sub_u32 s79, s79, 1
  v_mfma_f32_16x16x32_bf16 v[208:211], v[32:35], v[72:75], v[208:211]
  s_waitcnt lgkmcnt(0)
  s_barrier
  v_mfma_f32_16x16x32_bf16 v[128:131], v[96:99], v[76:79], v[128:131]
  ds_read_b128 v[32:35], v10 offset:0
  v_mfma_f32_16x16x32_bf16 v[132:135], v[96:99], v[80:83], v[132:135]
  ds_read_b128 v[36:39], v10 offset:2048
  v_mfma_f32_16x16x32_bf16 v[136:139], v[96:99], v[84:87], v[136:139]
  ds_read_b128 v[40:43], v10 offset:4096
  v_mfma_f32_16x16x32_bf16 v[140:143], v[96:99], v[88:91], v[140:143]
  ds_read_b128 v[44:47], v10 offset:6144
  v_mfma_f32_16x16x32_bf16 v[224:227], v[96:99], v[92:95], v[224:227]
  ds_read_b128 v[48:51], v14
  v_mfma_f32_16x16x32_bf16 v[156:159], v[100:103], v[88:91], v[156:159]
  ds_read_b64_tr_b16 v[52:53], v12 offset:0
  v_mfma_f32_16x16x32_bf16 v[152:155], v[100:103], v[84:87], v[152:155]
  ds_read_b64_tr_b16 v[54:55], v12 offset:512
  v_mfma_f32_16x16x32_bf16 v[148:151], v[100:103], v[80:83], v[148:151]
  ds_read_b64_tr_b16 v[56:57], v13 offset:0
  v_mfma_f32_16x16x32_bf16 v[144:147], v[100:103], v[76:79], v[144:147]
  ds_read_b64_tr_b16 v[58:59], v13 offset:512
  v_mfma_f32_16x16x32_bf16 v[160:163], v[104:107], v[76:79], v[160:163]
  ds_read_b64_tr_b16 v[60:61], v12 offset:8192
  v_mfma_f32_16x16x32_bf16 v[164:167], v[104:107], v[80:83], v[164:167]
  ds_read_b64_tr_b16 v[62:63], v12 offset:8704
  v_mfma_f32_16x16x32_bf16 v[168:171], v[104:107], v[84:87], v[168:171]
  ds_read_b64_tr_b16 v[64:65], v13 offset:8192
  v_mfma_f32_16x16x32_bf16 v[172:175], v[104:107], v[88:91], v[172:175]
  ds_read_b64_tr_b16 v[66:67], v13 offset:8704
  v_mfma_f32_16x16x32_bf16 v[228:231], v[104:107], v[92:95], v[228:231]
  ds_read_b64_tr_b16 v[68:69], v12 offset:16384
  v_mfma_f32_16x16x32_bf16 v[188:191], v[108:111], v[88:91], v[188:191]
  ds_read_b64_tr_b16 v[70:71], v12 offset:16896
  v_mfma_f32_16x16x32_bf16 v[184:187], v[108:111], v[84:87], v[184:187]
  ds_read_b64_tr_b16 v[72:73], v13 offset:16384
  v_mfma_f32_16x16x32_bf16 v[180:183], v[108:111], v[80:83], v[180:183]
  ds_read_b64_tr_b16 v[74:75], v13 offset:16896
  v_mfma_f32_16x16x32_bf16 v[176:179], v[108:111], v[76:79], v[176:179]
  s_cmp_lg_u32 s79, 0
  s_nop 0
  v_mfma_f32_16x16x32_bf16 v[192:195], v[76:79], v[112:115], v[192:195]
  v_mfma_f32_16x16x32_bf16 v[196:199], v[80:83], v[112:115], v[196:199]
  v_mfma_f32_16x16x32_bf16 v[200:203], v[84:87], v[112:115], v[200:203]
  v_mfma_f32_16x16x32_bf16 v[204:207], v[88:91], v[112:115], v[204:207]
  v_mfma_f32_16x16x32_bf16 v[232:235], v[92:95], v[112:115], v[232:235]
  v_mfma_f32_16x16x32_bf16 v[220:223], v[88:91], v[116:119], v[220:223]
  v_mfma_f32_16x16x32_bf16 v[216:219], v[84:87], v[116:119], v[216:219]
  v_mfma_f32_16x16x32_bf16 v[212:215], v[80:83], v[116:119], v[212:215]
  v_mfma_f32_16x16x32_bf16 v[208:211], v[76:79], v[116:119], v[208:211]
  s_waitcnt lgkmcnt(0)
  s_cbranch_scc1 L_attn_loop
L_attn_lend:
  s_add_u32 s98, s98, 1
  s_cmp_gt_u32 s98, 3
  s_cbranch_scc1 L_attn_exit
  s_cmp_lg_u32 s98, 1
  s_cbranch_scc1 L_attn_hook0
  s_mov_b32 s79, 1
  s_cmp_lg_u32 s72, 0
  s_cbranch_scc1 L_attn_dot0
  v_dot2_f32_bf16 v122, v32, s7, v122
  v_dot2_f32_bf16 v124, v32, v32, v124
  v_dot2_f32_bf16 v123, v36, s7, v123
  v_dot2_f32_bf16 v125, v36, v36, v125
  v_dot2_f32_bf16 v122, v33, s7, v122
  v_dot2_f32_bf16 v124, v33, v33, v124
  v_dot2_f32_bf16 v123, v37, s7, v123
  v_dot2_f32_bf16 v125, v37, v37, v125
  v_dot2_f32_bf16 v122, v34, s7, v122
  v_dot2_f32_bf16 v124, v34, v34, v124
  v_dot2_f32_bf16 v123, v38, s7, v123
  v_dot2_f32_bf16 v125, v38, v38, v125
  v_dot2_f32_bf16 v122, v35, s7, v122
  v_dot2_f32_bf16 v124, v35, v35, v124
  v_dot2_f32_bf16 v123, v39, s7, v123
  v_dot2_f32_bf16 v125, v39, v39, v125
  s_branch L_attn_dote0
  L_attn_dot0:
  v_dot2_f32_bf16 v122, v40, s7, v122
  v_dot2_f32_bf16 v124, v40, v40, v124
  v_dot2_f32_bf16 v123, v44, s7, v123
  v_dot2_f32_bf16 v125, v44, v44, v125
  v_dot2_f32_bf16 v122, v41, s7, v122
  v_dot2_f32_bf16 v124, v41, v41, v124
  v_dot2_f32_bf16 v123, v45, s7, v123
  v_dot2_f32_bf16 v125, v45, v45, v125
  v_dot2_f32_bf16 v122, v42, s7, v122
  v_dot2_f32_bf16 v124, v42, v42, v124
  v_dot2_f32_bf16 v123, v46, s7, v123
  v_dot2_f32_bf16 v125, v46, v46, v125
  v_dot2_f32_bf16 v122, v43, s7, v122
  v_dot2_f32_bf16 v124, v43, v43, v124
  v_dot2_f32_bf16 v123, v47, s7, v123
  v_dot2_f32_bf16 v125, v47, v47, v125
  L_attn_dote0:
  s_cmp_lg_u32 s70, 0
  s_cbranch_scc1 L_attn_loop
  s_waitcnt vmcnt(0)
  s_lshl4_add_u32 s3, s68, s69
  s_mov_b64 exec, 1
  buffer_store_byte v126, off, s[64:67], s3 sc1
  s_mov_b64 exec, -1
  s_branch L_attn_loop
L_attn_hook0:
  s_cmp_lg_u32 s98, 2
  s_cbranch_scc1 L_attn_hook1
  s_and_b32 s79, s69, 3
  s_add_u32 s79, s79, 1
  s_sub_u32 s79, 13, s79
  s_cmp_lg_u32 s72, 0
  s_cbranch_scc1 L_attn_dot1
  v_dot2_f32_bf16 v122, v76, s7, v122
  v_dot2_f32_bf16 v124, v76, v76, v124
  v_dot2_f32_bf16 v123, v80, s7, v123
  v_dot2_f32_bf16 v125, v80, v80, v125
  v_dot2_f32_bf16 v122, v77, s7, v122
  v_dot2_f32_bf16 v124, v77, v77, v124
  v_dot2_f32_bf16 v123, v81, s7, v123
  v_dot2_f32_bf16 v125, v81, v81, v125
  v_dot2_f32_bf16 v122, v78, s7, v122
  v_dot2_f32_bf16 v124, v78, v78, v124
  v_dot2_f32_bf16 v123, v82, s7, v123
  v_dot2_f32_bf16 v125, v82, v82, v125
  v_dot2_f32_bf16 v122, v79, s7, v122
  v_dot2_f32_bf16 v124, v79, v79, v124
  v_dot2_f32_bf16 v123, v83, s7, v123
  v_dot2_f32_bf16 v125, v83, v83, v125
  s_branch L_attn_dote1
  L_attn_dot1:
  v_dot2_f32_bf16 v122, v84, s7, v122
  v_dot2_f32_bf16 v124, v84, v84, v124
  v_dot2_f32_bf16 v123, v88, s7, v123
  v_dot2_f32_bf16 v125, v88, v88, v125
  v_dot2_f32_bf16 v122, v85, s7, v122
  v_dot2_f32_bf16 v124, v85, v85, v124
  v_dot2_f32_bf16 v123, v89, s7, v123
  v_dot2_f32_bf16 v125, v89, v89, v125
  v_dot2_f32_bf16 v122, v86, s7, v122
  v_dot2_f32_bf16 v124, v86, v86, v124
  v_dot2_f32_bf16 v123, v90, s7, v123
  v_dot2_f32_bf16 v125, v90, v90, v125
  v_dot2_f32_bf16 v122, v87, s7, v122
  v_dot2_f32_bf16 v124, v87, v87, v124
  v_dot2_f32_bf16 v123, v91, s7, v123
  v_dot2_f32_bf16 v125, v91, v91, v125
  L_attn_dote1:
  s_nop 2
  v_permlane32_swap_b32 v122, v123
  v_permlane32_swap_b32 v124, v125
  v_add_f32 v122, v122, v123
  v_add_f32 v124, v124, v125
  s_nop 0
  s_nop 0
  v_permlane16_swap_b32 v122, v124
  v_add_f32 v122, v122, v124
  buffer_store_dword v122, v120, s[56:59], 0 offen sc1
  s_branch L_attn_loop
L_attn_hook1:
  s_mov_b32 s79, 2
  s_mov_b32 s36, s16
  s_and_b32 s37, s17, 0xffff
  s_mov_b32 s38, 4194304
  s_mov_b32 s39, 0x00020000
  s_and_b32 s3, s2, 3
  s_and_b32 s4, s99, 3
  s_lshl2_add_u32 s3, s3, s4
  s_lshl2_add_u32 s3, s3, s70
  s_lshl_b32 s3, s3, 16
  s_bfe_u32 s4, s2, 0x10002
  s_lshr_b32 s5, s99, 2
  s_lshl1_add_u32 s4, s5, s4
  s_lshl_b32 s4, s4, 7
  s_add_u32 s3, s3, s4
  s_add_u32 s4, s3, 32768
  v_and_b32 v122, 15, v1
  v_lshlrev_b32 v123, 1, v1
  v_and_b32 v123, 32, v123
  v_lshl_add_u32 v122, v122, 11, v123
  v_lshrrev_b32 v123, 1, v1
  v_and_b32 v123, 16, v123
  v_add_u32 v122, v122, v123
  buffer_load_dwordx4 v[240:243], v122, s[36:39], s3 offen offset:0
  buffer_load_dwordx4 v[244:247], v122, s[36:39], s3 offen offset:64
  buffer_load_dwordx4 v[248:251], v122, s[36:39], s4 offen offset:0
  buffer_load_dwordx4 v[252:255], v122, s[36:39], s4 offen offset:64
  s_branch L_attn_loop
L_attn_exit:
  ds_read2_b32 v[66:67], v23 offset0:0 offset1:160
  ds_read2_b32 v[68:69], v23 offset0:16 offset1:176
  ds_read2_b32 v[70:71], v23 offset0:32 offset1:192
  ds_read2_b32 v[72:73], v23 offset0:48 offset1:208
  ds_read2_b32 v[74:75], v23 offset0:64 offset1:224
  ds_read2_b32 v[76:77], v25 offset0:0 offset1:16
  ds_read2_b32 v[80:81], v26 offset0:0 offset1:16
  ds_read2_b32 v[78:79], v25 offset0:32 offset1:48
  ds_read2_b32 v[82:83], v26 offset0:32 offset1:48
  ds_write_b128 v16, v[224:227] offset:0
  ds_write_b128 v16, v[228:231] offset:2048
  ds_write_b128 v16, v[232:235] offset:4096
  s_cmp_eq_u32 s71, 1
  s_cbranch_scc1 L_attn_nop3
  ds_write_b128 v16, v[172:175] offset:8192
  ds_write_b128 v16, v[188:191] offset:9216
  ds_write_b128 v16, v[204:207] offset:10240
  ds_write_b128 v16, v[220:223] offset:11264
L_attn_nop3:
  ds_read_b128 v[84:87], v24 offset:0
  ds_read_b128 v[104:107], v24 offset:640
  ds_read_b128 v[88:91], v24 offset:64
  ds_read_b128 v[108:111], v24 offset:704
  ds_read_b128 v[92:95], v24 offset:128
  ds_read_b128 v[112:115], v24 offset:768
  ds_read_b128 v[96:99], v24 offset:192
  ds_read_b128 v[116:119], v24 offset:832
  ds_read_b128 v[100:103], v24 offset:256
  ds_read_b128 v[120:123], v24 offset:896
  s_waitcnt lgkmcnt(10)
  s_barrier
  ds_read_b128 v[48:51], v19 offset:0
  ds_read_b128 v[52:55], v20 offset:1024
  ds_read_b128 v[56:59], v19 offset:2048
  ds_read_b128 v[60:63], v20 offset:3072
  ds_read_b32 v64, v21 offset:4096
  ds_read_b32 v65, v22 offset:5120
  ds_read_b128 v[32:35], v17 offset:2048
  ds_read_b128 v[36:39], v18 offset:3072
  ds_read_b128 v[40:43], v17 offset:4096
  ds_read_b128 v[44:47], v18 offset:5120
  v_mul_f32 v69, 0x3e8293ee, v69
  v_mul_f32 v71, 0x3e8293ee, v71
  v_mul_f32 v73, 0x3e8293ee, v73
  v_mul_f32 v75, 0x3e8293ee, v75
  v_mul_f32 v76, v76, v69
  v_mul_f32 v80, v80, v69
  v_mul_f32 v77, v77, v71
  v_mul_f32 v81, v81, v71
  v_mul_f32 v78, v78, v73
  v_mul_f32 v82, v82, v73
  v_mul_f32 v79, v79, v75
  v_mul_f32 v83, v83, v75
  s_waitcnt lgkmcnt(6)
  v_pk_fma_f32 v[128:129], v[48:49], v[68:69], v[128:129] op_sel:[0,0,0] op_sel_hi:[1,0,1] neg_lo:[0,1,0] neg_hi:[0,1,0]
  v_pk_fma_f32 v[130:131], v[50:51], v[68:69], v[130:131] op_sel:[0,0,0] op_sel_hi:[1,0,1] neg_lo:[0,1,0] neg_hi:[0,1,0]
  v_pk_fma_f32 v[144:145], v[52:53], v[68:69], v[144:145] op_sel:[0,0,0] op_sel_hi:[1,0,1] neg_lo:[0,1,0] neg_hi:[0,1,0]
  v_pk_fma_f32 v[146:147], v[54:55], v[68:69], v[146:147] op_sel:[0,0,0] op_sel_hi:[1,0,1] neg_lo:[0,1,0] neg_hi:[0,1,0]
  v_cvt_pk_bf16_f32 v128, v128, v129
  v_cvt_pk_bf16_f32 v129, v130, v131
  v_cvt_pk_bf16_f32 v130, v144, v145
  v_cvt_pk_bf16_f32 v131, v146, v147
  v_pk_fma_f32 v[160:161], v[56:57], v[68:69], v[160:161] op_sel:[0,0,0] op_sel_hi:[1,0,1] neg_lo:[0,1,0] neg_hi:[0,1,0]
  v_pk_fma_f32 v[162:163], v[58:59], v[68:69], v[162:163] op_sel:[0,0,0] op_sel_hi:[1,0,1] neg_lo:[0,1,0] neg_hi:[0,1,0]
  v_pk_fma_f32 v[176:177], v[60:61], v[68:69], v[176:177] op_sel:[0,0,0] op_sel_hi:[1,0,1] neg_lo:[0,1,0] neg_hi:[0,1,0]
  v_pk_fma_f32 v[178:179], v[62:63], v[68:69], v[178:179] op_sel:[0,0,0] op_sel_hi:[1,0,1] neg_lo:[0,1,0] neg_hi:[0,1,0]
  v_cvt_pk_bf16_f32 v160, v160, v161
  v_cvt_pk_bf16_f32 v161, v162, v163
  v_cvt_pk_bf16_f32 v162, v176, v177
  v_cvt_pk_bf16_f32 v163, v178, v179
  v_pk_fma_f32 v[132:133], v[48:49], v[70:71], v[132:133] op_sel:[0,0,0] op_sel_hi:[1,0,1] neg_lo:[0,1,0] neg_hi:[0,1,0]
  v_pk_fma_f32 v[134:135], v[50:51], v[70:71], v[134:135] op_sel:[0,0,0] op_sel_hi:[1,0,1] neg_lo:[0,1,0] neg_hi:[0,1,0]
  v_pk_fma_f32 v[148:149], v[52:53], v[70:71], v[148:149] op_sel:[0,0,0] op_sel_hi:[1,0,1] neg_lo:[0,1,0] neg_hi:[0,1,0]
  v_pk_fma_f32 v[150:151], v[54:55], v[70:71], v[150:151] op_sel:[0,0,0] op_sel_hi:[1,0,1] neg_lo:[0,1,0] neg_hi:[0,1,0]
  v_cvt_pk_bf16_f32 v132, v132, v133
  v_cvt_pk_bf16_f32 v133, v134, v135
  v_cvt_pk_bf16_f32 v134, v148, v149
  v_cvt_pk_bf16_f32 v135, v150, v151
  v_pk_fma_f32 v[164:165], v[56:57], v[70:71], v[164:165] op_sel:[0,0,0] op_sel_hi:[1,0,1] neg_lo:[0,1,0] neg_hi:[0,1,0]
  v_pk_fma_f32 v[166:167], v[58:59], v[70:71], v[166:167] op_sel:[0,0,0] op_sel_hi:[1,0,1] neg_lo:[0,1,0] neg_hi:[0,1,0]
  v_pk_fma_f32 v[180:181], v[60:61], v[70:71], v[180:181] op_sel:[0,0,0] op_sel_hi:[1,0,1] neg_lo:[0,1,0] neg_hi:[0,1,0]
  v_pk_fma_f32 v[182:183], v[62:63], v[70:71], v[182:183] op_sel:[0,0,0] op_sel_hi:[1,0,1] neg_lo:[0,1,0] neg_hi:[0,1,0]
  v_cvt_pk_bf16_f32 v164, v164, v165
  v_cvt_pk_bf16_f32 v165, v166, v167
  v_cvt_pk_bf16_f32 v166, v180, v181
  v_cvt_pk_bf16_f32 v167, v182, v183
  v_mfma_f32_16x16x32_bf16 v[144:147], v[160:163], v[128:131], 0
  v_pk_fma_f32 v[136:137], v[48:49], v[72:73], v[136:137] op_sel:[0,0,0] op_sel_hi:[1,0,1] neg_lo:[0,1,0] neg_hi:[0,1,0]
  v_pk_fma_f32 v[138:139], v[50:51], v[72:73], v[138:139] op_sel:[0,0,0] op_sel_hi:[1,0,1] neg_lo:[0,1,0] neg_hi:[0,1,0]
  v_pk_fma_f32 v[152:153], v[52:53], v[72:73], v[152:153] op_sel:[0,0,0] op_sel_hi:[1,0,1] neg_lo:[0,1,0] neg_hi:[0,1,0]
  v_pk_fma_f32 v[154:155], v[54:55], v[72:73], v[154:155] op_sel:[0,0,0] op_sel_hi:[1,0,1] neg_lo:[0,1,0] neg_hi:[0,1,0]
  v_cvt_pk_bf16_f32 v136, v136, v137
  v_cvt_pk_bf16_f32 v137, v138, v139
  v_cvt_pk_bf16_f32 v138, v152, v153
  v_cvt_pk_bf16_f32 v139, v154, v155
  v_pk_fma_f32 v[168:169], v[56:57], v[72:73], v[168:169] op_sel:[0,0,0] op_sel_hi:[1,0,1] neg_lo:[0,1,0] neg_hi:[0,1,0]
  v_pk_fma_f32 v[170:171], v[58:59], v[72:73], v[170:171] op_sel:[0,0,0] op_sel_hi:[1,0,1] neg_lo:[0,1,0] neg_hi:[0,1,0]
  v_pk_fma_f32 v[184:185], v[60:61], v[72:73], v[184:185] op_sel:[0,0,0] op_sel_hi:[1,0,1] neg_lo:[0,1,0] neg_hi:[0,1,0]
  v_pk_fma_f32 v[186:187], v[62:63], v[72:73], v[186:187] op_sel:[0,0,0] op_sel_hi:[1,0,1] neg_lo:[0,1,0] neg_hi:[0,1,0]
  v_cvt_pk_bf16_f32 v168, v168, v169
  v_cvt_pk_bf16_f32 v169, v170, v171
  v_cvt_pk_bf16_f32 v170, v184, v185
  v_cvt_pk_bf16_f32 v171, v186, v187
  v_mfma_f32_16x16x32_bf16 v[148:151], v[164:167], v[132:135], 0
  v_mfma_f32_16x16x32_bf16 v[180:183], v[160:163], v[132:135], 0
  v_pk_fma_f32 v[140:141], v[48:49], v[74:75], v[140:141] op_sel:[0,0,0] op_sel_hi:[1,0,1] neg_lo:[0,1,0] neg_hi:[0,1,0]
  v_pk_fma_f32 v[142:143], v[50:51], v[74:75], v[142:143] op_sel:[0,0,0] op_sel_hi:[1,0,1] neg_lo:[0,1,0] neg_hi:[0,1,0]
  v_pk_fma_f32 v[156:157], v[52:53], v[74:75], v[156:157] op_sel:[0,0,0] op_sel_hi:[1,0,1] neg_lo:[0,1,0] neg_hi:[0,1,0]
  v_pk_fma_f32 v[158:159], v[54:55], v[74:75], v[158:159] op_sel:[0,0,0] op_sel_hi:[1,0,1] neg_lo:[0,1,0] neg_hi:[0,1,0]
  v_cvt_pk_bf16_f32 v140, v140, v141
  v_cvt_pk_bf16_f32 v141, v142, v143
  v_cvt_pk_bf16_f32 v142, v156, v157
  v_cvt_pk_bf16_f32 v143, v158, v159
  v_pk_fma_f32 v[172:173], v[56:57], v[74:75], v[172:173] op_sel:[0,0,0] op_sel_hi:[1,0,1] neg_lo:[0,1,0] neg_hi:[0,1,0]
  v_pk_fma_f32 v[174:175], v[58:59], v[74:75], v[174:175] op_sel:[0,0,0] op_sel_hi:[1,0,1] neg_lo:[0,1,0] neg_hi:[0,1,0]
  v_pk_fma_f32 v[188:189], v[60:61], v[74:75], v[188:189] op_sel:[0,0,0] op_sel_hi:[1,0,1] neg_lo:[0,1,0] neg_hi:[0,1,0]
  v_pk_fma_f32 v[190:191], v[62:63], v[74:75], v[190:191] op_sel:[0,0,0] op_sel_hi:[1,0,1] neg_lo:[0,1,0] neg_hi:[0,1,0]
  v_cvt_pk_bf16_f32 v172, v172, v173
  v_cvt_pk_bf16_f32 v173, v174, v175
  v_cvt_pk_bf16_f32 v174, v188, v189
  v_cvt_pk_bf16_f32 v175, v190, v191
  s_waitcnt lgkmcnt(0)
  v_pk_fma_f32 v[32:33], v[56:57], v[66:67], v[32:33] op_sel:[0,0,0] op_sel_hi:[1,0,1] neg_lo:[0,1,0] neg_hi:[0,1,0]
  v_pk_fma_f32 v[34:35], v[58:59], v[66:67], v[34:35] op_sel:[0,0,0] op_sel_hi:[1,0,1] neg_lo:[0,1,0] neg_hi:[0,1,0]
  v_pk_fma_f32 v[36:37], v[60:61], v[66:67], v[36:37] op_sel:[0,0,0] op_sel_hi:[1,0,1] neg_lo:[0,1,0] neg_hi:[0,1,0]
  v_pk_fma_f32 v[38:39], v[62:63], v[66:67], v[38:39] op_sel:[0,0,0] op_sel_hi:[1,0,1] neg_lo:[0,1,0] neg_hi:[0,1,0]
  v_cvt_pk_bf16_f32 v32, v32, v33
  v_cvt_pk_bf16_f32 v33, v34, v35
  v_cvt_pk_bf16_f32 v34, v36, v37
  v_cvt_pk_bf16_f32 v35, v38, v39
  v_mfma_f32_16x16x32_bf16 v[152:155], v[168:171], v[136:139], 0
  v_mfma_f32_16x16x32_bf16 v[184:187], v[164:167], v[136:139], 0
  v_mfma_f32_16x16x32_bf16 v[156:159], v[172:175], v[140:143], 0
  v_mfma_f32_16x16x32_bf16 v[188:191], v[168:171], v[140:143], 0
  v_mfma_f32_16x16x32_bf16 v[176:179], v[32:35], v[128:131], 0
  v_pk_fma_f32 v[40:41], v[84:85], v[64:65], v[40:41] op_sel:[0,0,0] op_sel_hi:[1,0,1] neg_lo:[1,0,0] neg_hi:[1,0,0]
  v_pk_fma_f32 v[42:43], v[86:87], v[64:65], v[42:43] op_sel:[0,0,0] op_sel_hi:[1,0,1] neg_lo:[1,0,0] neg_hi:[1,0,0]
  v_pk_mul_f32 v[40:41], v[40:41], v[104:105]
  v_pk_mul_f32 v[42:43], v[42:43], v[106:107]
  v_cvt_pk_bf16_f32 v4, v40, v41
  v_cvt_pk_bf16_f32 v5, v42, v43
  v_pk_fma_f32 v[192:193], v[88:89], v[64:65], v[192:193] op_sel:[0,0,0] op_sel_hi:[1,0,1] neg_lo:[1,0,0] neg_hi:[1,0,0]
  v_pk_fma_f32 v[194:195], v[90:91], v[64:65], v[194:195] op_sel:[0,0,0] op_sel_hi:[1,0,1] neg_lo:[1,0,0] neg_hi:[1,0,0]
  v_pk_mul_f32 v[192:193], v[192:193], v[108:109]
  v_pk_mul_f32 v[194:195], v[194:195], v[110:111]
  v_cvt_pk_bf16_f32 v6, v192, v193
  v_cvt_pk_bf16_f32 v7, v194, v195
  v_pk_fma_f32 v[196:197], v[92:93], v[64:65], v[196:197] op_sel:[0,0,0] op_sel_hi:[1,0,1] neg_lo:[1,0,0] neg_hi:[1,0,0]
  v_pk_fma_f32 v[198:199], v[94:95], v[64:65], v[198:199] op_sel:[0,0,0] op_sel_hi:[1,0,1] neg_lo:[1,0,0] neg_hi:[1,0,0]
  v_pk_mul_f32 v[196:197], v[196:197], v[112:113]
  v_pk_mul_f32 v[198:199], v[198:199], v[114:115]
  v_cvt_pk_bf16_f32 v8, v196, v197
  v_cvt_pk_bf16_f32 v9, v198, v199
  v_pk_fma_f32 v[200:201], v[96:97], v[64:65], v[200:201] op_sel:[0,0,0] op_sel_hi:[1,0,1] neg_lo:[1,0,0] neg_hi:[1,0,0]
  v_pk_fma_f32 v[202:203], v[98:99], v[64:65], v[202:203] op_sel:[0,0,0] op_sel_hi:[1,0,1] neg_lo:[1,0,0] neg_hi:[1,0,0]
  v_pk_mul_f32 v[200:201], v[200:201], v[116:117]
  v_pk_mul_f32 v[202:203], v[202:203], v[118:119]
  v_cvt_pk_bf16_f32 v10, v200, v201
  v_cvt_pk_bf16_f32 v11, v202, v203
  v_pk_fma_f32 v[204:205], v[100:101], v[64:65], v[204:205] op_sel:[0,0,0] op_sel_hi:[1,0,1] neg_lo:[1,0,0] neg_hi:[1,0,0]
  v_pk_fma_f32 v[206:207], v[102:103], v[64:65], v[206:207] op_sel:[0,0,0] op_sel_hi:[1,0,1] neg_lo:[1,0,0] neg_hi:[1,0,0]
  v_pk_mul_f32 v[204:205], v[204:205], v[120:121]
  v_pk_mul_f32 v[206:207], v[206:207], v[122:123]
  v_cvt_pk_bf16_f32 v12, v204, v205
  v_cvt_pk_bf16_f32 v13, v206, v207
  v_pk_fma_f32 v[44:45], v[84:85], v[64:65], v[44:45] op_sel:[0,1,0] op_sel_hi:[1,1,1] neg_lo:[1,0,0] neg_hi:[1,0,0]
  v_pk_fma_f32 v[46:47], v[86:87], v[64:65], v[46:47] op_sel:[0,1,0] op_sel_hi:[1,1,1] neg_lo:[1,0,0] neg_hi:[1,0,0]
  v_pk_mul_f32 v[44:45], v[44:45], v[104:105]
  v_pk_mul_f32 v[46:47], v[46:47], v[106:107]
  v_cvt_pk_bf16_f32 v224, v44, v45
  v_cvt_pk_bf16_f32 v225, v46, v47
  v_pk_fma_f32 v[208:209], v[88:89], v[64:65], v[208:209] op_sel:[0,1,0] op_sel_hi:[1,1,1] neg_lo:[1,0,0] neg_hi:[1,0,0]
  v_pk_fma_f32 v[210:211], v[90:91], v[64:65], v[210:211] op_sel:[0,1,0] op_sel_hi:[1,1,1] neg_lo:[1,0,0] neg_hi:[1,0,0]
  v_pk_mul_f32 v[208:209], v[208:209], v[108:109]
  v_pk_mul_f32 v[210:211], v[210:211], v[110:111]
  v_cvt_pk_bf16_f32 v226, v208, v209
  v_cvt_pk_bf16_f32 v227, v210, v211
  v_pk_fma_f32 v[212:213], v[92:93], v[64:65], v[212:213] op_sel:[0,1,0] op_sel_hi:[1,1,1] neg_lo:[1,0,0] neg_hi:[1,0,0]
  v_pk_fma_f32 v[214:215], v[94:95], v[64:65], v[214:215] op_sel:[0,1,0] op_sel_hi:[1,1,1] neg_lo:[1,0,0] neg_hi:[1,0,0]
  v_pk_mul_f32 v[212:213], v[212:213], v[112:113]
  v_pk_mul_f32 v[214:215], v[214:215], v[114:115]
  v_cvt_pk_bf16_f32 v228, v212, v213
  v_cvt_pk_bf16_f32 v229, v214, v215
  v_pk_fma_f32 v[216:217], v[96:97], v[64:65], v[216:217] op_sel:[0,1,0] op_sel_hi:[1,1,1] neg_lo:[1,0,0] neg_hi:[1,0,0]
  v_pk_fma_f32 v[218:219], v[98:99], v[64:65], v[218:219] op_sel:[0,1,0] op_sel_hi:[1,1,1] neg_lo:[1,0,0] neg_hi:[1,0,0]
  v_pk_mul_f32 v[216:217], v[216:217], v[116:117]
  v_pk_mul_f32 v[218:219], v[218:219], v[118:119]
  v_cvt_pk_bf16_f32 v230, v216, v217
  v_cvt_pk_bf16_f32 v231, v218, v219
  v_pk_fma_f32 v[220:221], v[100:101], v[64:65], v[220:221] op_sel:[0,1,0] op_sel_hi:[1,1,1] neg_lo:[1,0,0] neg_hi:[1,0,0]
  v_pk_fma_f32 v[222:223], v[102:103], v[64:65], v[222:223] op_sel:[0,1,0] op_sel_hi:[1,1,1] neg_lo:[1,0,0] neg_hi:[1,0,0]
  v_pk_mul_f32 v[220:221], v[220:221], v[120:121]
  v_pk_mul_f32 v[222:223], v[222:223], v[122:123]
  v_cvt_pk_bf16_f32 v232, v220, v221
  v_cvt_pk_bf16_f32 v233, v222, v223
  v_cndmask_b32 v148, v148, v149, s[48:49]
  v_cndmask_b32 v180, v180, v181, s[48:49]
  v_cndmask_b32 v150, v150, v151, s[48:49]
  v_cndmask_b32 v182, v182, v183, s[48:49]
  v_cndmask_b32 v36, v148, v180, s[50:51]
  v_cndmask_b32 v37, v150, v182, s[52:53]
  v_mul_f32 v36, v36, v77
  v_mul_f32 v37, v37, v81
  v_cndmask_b32 v152, v152, v153, s[48:49]
  v_cndmask_b32 v184, v184, v185, s[48:49]
  v_cndmask_b32 v154, v154, v155, s[48:49]
  v_cndmask_b32 v186, v186, v187, s[48:49]
  v_cndmask_b32 v40, v152, v184, s[50:51]
  v_cndmask_b32 v41, v154, v186, s[52:53]
  v_mul_f32 v40, v40, v78
  v_mul_f32 v41, v41, v82
  v_cndmask_b32 v156, v156, v157, s[48:49]
  v_cndmask_b32 v188, v188, v189, s[48:49]
  v_cndmask_b32 v158, v158, v159, s[48:49]
  v_cndmask_b32 v190, v190, v191, s[48:49]
  v_cndmask_b32 v44, v156, v188, s[50:51]
  v_cndmask_b32 v45, v158, v190, s[52:53]
  v_mul_f32 v44, v44, v79
  v_mul_f32 v45, v45, v83
  v_cndmask_b32 v144, v144, v145, s[48:49]
  v_cndmask_b32 v176, v176, v177, s[48:49]
  v_cndmask_b32 v146, v146, v147, s[48:49]
  v_cndmask_b32 v178, v178, v179, s[48:49]
  v_cndmask_b32 v32, v144, v176, s[50:51]
  v_cndmask_b32 v33, v146, v178, s[52:53]
  v_mul_f32 v32, v32, v76
  v_mul_f32 v33, v33, v80
  v_mov_b32 v48, 0xceabfb8f
  v_cndmask_b32 v32, v32, v48, s[54:55]
  v_cndmask_b32 v33, v33, v48, s[14:15]
  v_max_f32 v34, v32, v33
  v_max_f32 v38, v36, v37
  v_max_f32 v42, v40, v41
  v_max_f32 v46, v44, v45
  v_mov_b32 v35, v34
  v_mov_b32 v39, v38
  v_mov_b32 v43, v42
  v_mov_b32 v47, v46
  v_permlane32_swap_b32 v34, v35
  v_permlane32_swap_b32 v38, v39
  v_permlane32_swap_b32 v42, v43
  v_permlane32_swap_b32 v46, v47
  v_max_f32 v34, v34, v35
  v_max_f32 v38, v38, v39
  v_max_f32 v42, v42, v43
  v_max_f32 v46, v46, v47
  v_mov_b32 v35, v34
  v_mov_b32 v39, v38
  v_mov_b32 v43, v42
  v_mov_b32 v47, v46
  v_permlane16_swap_b32 v34, v35
  v_permlane16_swap_b32 v38, v39
  v_permlane16_swap_b32 v42, v43
  v_permlane16_swap_b32 v46, v47
  v_max_f32 v34, v34, v35
  v_max_f32 v38, v38, v39
  v_max_f32 v42, v42, v43
  v_max_f32 v46, v46, v47
  v_sub_f32 v32, v32, v34
  v_sub_f32 v33, v33, v34
  v_sub_f32 v36, v36, v38
  v_sub_f32 v37, v37, v38
  v_sub_f32 v40, v40, v42
  v_sub_f32 v41, v41, v42
  v_sub_f32 v44, v44, v46
  v_sub_f32 v45, v45, v46
  v_exp_f32 v32, v32
  v_exp_f32 v33, v33
  v_exp_f32 v36, v36
  v_exp_f32 v37, v37
  v_exp_f32 v40, v40
  v_exp_f32 v41, v41
  v_exp_f32 v44, v44
  v_exp_f32 v45, v45
  v_cvt_pk_bf16_f32 v32, v32, v32
  v_cvt_pk_bf16_f32 v33, v33, v33
  v_and_b32 v128, v32, v27
  v_and_b32 v129, v33, v29
  v_and_b32 v130, v32, v28
  v_and_b32 v131, v33, v30
  v_cvt_pk_bf16_f32 v36, v36, v36
  v_cvt_pk_bf16_f32 v37, v37, v37
  v_and_b32 v132, v36, v27
  v_and_b32 v133, v37, v29
  v_and_b32 v134, v36, v28
  v_and_b32 v135, v37, v30
  v_mfma_f32_16x16x32_bf16 v[144:147], v[236:239], v[128:131], 0
  v_mfma_f32_16x16x32_bf16 v[192:195], v[4:7], v[128:131], 0
  v_mfma_f32_16x16x32_bf16 v[208:211], v[224:227], v[128:131], 0
  v_cvt_pk_bf16_f32 v40, v40, v40
  v_cvt_pk_bf16_f32 v41, v41, v41
  v_and_b32 v136, v40, v27
  v_and_b32 v137, v41, v29
  v_and_b32 v138, v40, v28
  v_and_b32 v139, v41, v30
  v_mfma_f32_16x16x32_bf16 v[148:151], v[236:239], v[132:135], 0
  v_mfma_f32_16x16x32_bf16 v[196:199], v[6:9], v[132:135], 0
  v_mfma_f32_16x16x32_bf16 v[212:215], v[226:229], v[132:135], 0
  v_cvt_pk_bf16_f32 v44, v44, v44
  v_cvt_pk_bf16_f32 v45, v45, v45
  v_and_b32 v140, v44, v27
  v_and_b32 v141, v45, v29
  v_and_b32 v142, v44, v28
  v_and_b32 v143, v45, v30
  v_mfma_f32_16x16x32_bf16 v[152:155], v[236:239], v[136:139], 0
  v_mfma_f32_16x16x32_bf16 v[200:203], v[8:11], v[136:139], 0
  v_mfma_f32_16x16x32_bf16 v[216:219], v[228:231], v[136:139], 0
  v_mfma_f32_16x16x32_bf16 v[156:159], v[236:239], v[140:143], 0
  v_mfma_f32_16x16x32_bf16 v[204:207], v[10:13], v[140:143], 0
  v_mfma_f32_16x16x32_bf16 v[220:223], v[230:233], v[140:143], 0
  s_cmp_eq_u32 s71, 1
  s_cbranch_scc1 L_attn_out1
  v_rcp_f32 v144, v144
  s_mov_b32 s3, 0
  v_pk_mul_f32 v[192:193], v[192:193], v[144:145] op_sel_hi:[1,0]
  v_pk_mul_f32 v[194:195], v[194:195], v[144:145] op_sel_hi:[1,0]
  v_pk_mul_f32 v[208:209], v[208:209], v[144:145] op_sel_hi:[1,0]
  v_pk_mul_f32 v[210:211], v[210:211], v[144:145] op_sel_hi:[1,0]
  v_cvt_pk_bf16_f32 v48, v192, v193
  v_cvt_pk_bf16_f32 v49, v194, v195
  v_cvt_pk_bf16_f32 v50, v208, v209
  v_cvt_pk_bf16_f32 v51, v210, v211
  buffer_store_dwordx4 v[48:51], v31, s[44:47], s3 offen sc1
  v_rcp_f32 v148, v148
  s_mov_b32 s3, 32768
  v_pk_mul_f32 v[196:197], v[196:197], v[148:149] op_sel_hi:[1,0]
  v_pk_mul_f32 v[198:199], v[198:199], v[148:149] op_sel_hi:[1,0]
  v_pk_mul_f32 v[212:213], v[212:213], v[148:149] op_sel_hi:[1,0]
  v_pk_mul_f32 v[214:215], v[214:215], v[148:149] op_sel_hi:[1,0]
  v_cvt_pk_bf16_f32 v52, v196, v197
  v_cvt_pk_bf16_f32 v53, v198, v199
  v_cvt_pk_bf16_f32 v54, v212, v213
  v_cvt_pk_bf16_f32 v55, v214, v215
  buffer_store_dwordx4 v[52:55], v31, s[44:47], s3 offen sc1
  v_rcp_f32 v152, v152
  s_mov_b32 s3, 65536
  v_pk_mul_f32 v[200:201], v[200:201], v[152:153] op_sel_hi:[1,0]
  v_pk_mul_f32 v[202:203], v[202:203], v[152:153] op_sel_hi:[1,0]
  v_pk_mul_f32 v[216:217], v[216:217], v[152:153] op_sel_hi:[1,0]
  v_pk_mul_f32 v[218:219], v[218:219], v[152:153] op_sel_hi:[1,0]
  v_cvt_pk_bf16_f32 v56, v200, v201
  v_cvt_pk_bf16_f32 v57, v202, v203
  v_cvt_pk_bf16_f32 v58, v216, v217
  v_cvt_pk_bf16_f32 v59, v218, v219
  buffer_store_dwordx4 v[56:59], v31, s[44:47], s3 offen sc1
  v_rcp_f32 v156, v156
  s_mov_b32 s3, 98304
  v_pk_mul_f32 v[204:205], v[204:205], v[156:157] op_sel_hi:[1,0]
  v_pk_mul_f32 v[206:207], v[206:207], v[156:157] op_sel_hi:[1,0]
  v_pk_mul_f32 v[220:221], v[220:221], v[156:157] op_sel_hi:[1,0]
  v_pk_mul_f32 v[222:223], v[222:223], v[156:157] op_sel_hi:[1,0]
  v_cvt_pk_bf16_f32 v60, v204, v205
  v_cvt_pk_bf16_f32 v61, v206, v207
  v_cvt_pk_bf16_f32 v62, v220, v221
  v_cvt_pk_bf16_f32 v63, v222, v223
  buffer_store_dwordx4 v[60:63], v31, s[44:47], s3 offen sc1
  s_branch L_attn_out2
L_attn_out1:
  v_rcp_f32 v144, v144
  s_mov_b32 s3, 0
  v_pk_mul_f32 v[192:193], v[192:193], v[144:145] op_sel_hi:[1,0]
  v_pk_mul_f32 v[194:195], v[194:195], v[144:145] op_sel_hi:[1,0]
  v_pk_mul_f32 v[208:209], v[208:209], v[144:145] op_sel_hi:[1,0]
  v_pk_mul_f32 v[210:211], v[210:211], v[144:145] op_sel_hi:[1,0]
  v_cvt_pk_bf16_f32 v50, v192, v193
  v_cvt_pk_bf16_f32 v51, v194, v195
  v_cvt_pk_bf16_f32 v48, v208, v209
  v_cvt_pk_bf16_f32 v49, v210, v211
  buffer_store_dwordx4 v[48:51], v31, s[44:47], s3 offen sc1
  v_rcp_f32 v148, v148
  s_mov_b32 s3, 32768
  v_pk_mul_f32 v[196:197], v[196:197], v[148:149] op_sel_hi:[1,0]
  v_pk_mul_f32 v[198:199], v[198:199], v[148:149] op_sel_hi:[1,0]
  v_pk_mul_f32 v[212:213], v[212:213], v[148:149] op_sel_hi:[1,0]
  v_pk_mul_f32 v[214:215], v[214:215], v[148:149] op_sel_hi:[1,0]
  v_cvt_pk_bf16_f32 v54, v196, v197
  v_cvt_pk_bf16_f32 v55, v198, v199
  v_cvt_pk_bf16_f32 v52, v212, v213
  v_cvt_pk_bf16_f32 v53, v214, v215
  buffer_store_dwordx4 v[52:55], v31, s[44:47], s3 offen sc1
  v_rcp_f32 v152, v152
  s_mov_b32 s3, 65536
  v_pk_mul_f32 v[200:201], v[200:201], v[152:153] op_sel_hi:[1,0]
  v_pk_mul_f32 v[202:203], v[202:203], v[152:153] op_sel_hi:[1,0]
  v_pk_mul_f32 v[216:217], v[216:217], v[152:153] op_sel_hi:[1,0]
  v_pk_mul_f32 v[218:219], v[218:219], v[152:153] op_sel_hi:[1,0]
  v_cvt_pk_bf16_f32 v58, v200, v201
  v_cvt_pk_bf16_f32 v59, v202, v203
  v_cvt_pk_bf16_f32 v56, v216, v217
  v_cvt_pk_bf16_f32 v57, v218, v219
  buffer_store_dwordx4 v[56:59], v31, s[44:47], s3 offen sc1
  v_rcp_f32 v156, v156
  s_mov_b32 s3, 98304
  v_pk_mul_f32 v[204:205], v[204:205], v[156:157] op_sel_hi:[1,0]
  v_pk_mul_f32 v[206:207], v[206:207], v[156:157] op_sel_hi:[1,0]
  v_pk_mul_f32 v[220:221], v[220:221], v[156:157] op_sel_hi:[1,0]
  v_pk_mul_f32 v[222:223], v[222:223], v[156:157] op_sel_hi:[1,0]
  v_cvt_pk_bf16_f32 v62, v204, v205
  v_cvt_pk_bf16_f32 v63, v206, v207
  v_cvt_pk_bf16_f32 v60, v220, v221
  v_cvt_pk_bf16_f32 v61, v222, v223
  buffer_store_dwordx4 v[60:63], v31, s[44:47], s3 offen sc1
L_attn_out2:
  s_waitcnt vmcnt(0) lgkmcnt(0)
  s_barrier
  s_add_u32 s97, s97, 1
  s_branch L_wo_body
.section .rodata,"a"
.p2align 6
.amdhsa_kernel interleave_layers__sliding_local_dilated__dense_activation_gelu__prompt_kernel
  .amdhsa_next_free_vgpr 256
  .amdhsa_next_free_sgpr 102
  .amdhsa_accum_offset 256
  .amdhsa_group_segment_fixed_size 0
  .amdhsa_kernarg_size 88
  .amdhsa_user_sgpr_count 2
  .amdhsa_user_sgpr_kernarg_segment_ptr 1
  .amdhsa_system_sgpr_workgroup_id_x 1
  .amdhsa_float_denorm_mode_32 3
  .amdhsa_float_denorm_mode_16_64 3
.end_amdhsa_kernel
.text
L_attn_c1:
L_wo_c0:
L_wo_body:
  s_cmp_ge_u32 s2, 256
  s_cbranch_scc1 L_wo_end
  v_lshrrev_b32 v2, 6, v0
  v_and_b32 v1, 63, v0
  v_readfirstlane_b32 s70, v2
  s_and_b32 s3, s2, 7
  s_lshr_b32 s99, s2, 3
  s_and_b32 s5, s3, 3
  s_lshl_b32 s5, s5, 2
  s_and_b32 s6, s99, 3
  s_add_u32 s68, s5, s6
  s_lshr_b32 s5, s3, 2
  s_lshr_b32 s78, s99, 2
  s_lshl1_add_u32 s69, s78, s5
  s_add_u32 s3, s68, s78
  s_lshl_b32 s3, s3, 3
  s_lshl_b32 s85, 0xffff02, s3
  s_sub_u32 s3, 0, s3
  s_lshr_b32 s3, 0xffff02, s3
  s_or_b32 s85, s85, s3
  s_cmp_lt_u32 s70, 4
  s_cbranch_scc1 L_wo_compute
L_wo_loader:
  s_add_u32 s3, s96, s70
  s_cmp_lg_u32 s3, 4
  s_cbranch_scc1 L_wo_chk0
  s_load_dwordx2 s[64:65], s[0:1], 72
  s_waitcnt lgkmcnt(0)
  s_and_b32 s65, s65, 0xffff
  s_mov_b32 s66, 256
  s_mov_b32 s67, 0x00020000
  v_lshlrev_b32 v17, 2, v1
  buffer_load_dword v12, v17, s[64:67], 0 offen sc1
L_wo_chk0:
  s_cmp_lg_u32 s96, 0
  s_cbranch_scc1 L_wo_nofirst
  s_waitcnt vmcnt(1)
  s_mov_b32 s7, 0xffff0000
  v_lshlrev_b32 v32, 16, v64
  v_and_b32 v33, s7, v64
  v_lshlrev_b32 v34, 16, v65
  v_and_b32 v35, s7, v65
  v_lshlrev_b32 v36, 16, v66
  v_and_b32 v37, s7, v66
  v_lshlrev_b32 v38, 16, v67
  v_and_b32 v39, s7, v67
  v_lshlrev_b32 v40, 16, v68
  v_and_b32 v41, s7, v68
  v_pk_add_f32 v[32:33], v[32:33], v[40:41]
  v_lshlrev_b32 v40, 16, v69
  v_and_b32 v41, s7, v69
  v_pk_add_f32 v[34:35], v[34:35], v[40:41]
  v_lshlrev_b32 v40, 16, v70
  v_and_b32 v41, s7, v70
  v_pk_add_f32 v[36:37], v[36:37], v[40:41]
  v_lshlrev_b32 v40, 16, v71
  v_and_b32 v41, s7, v71
  v_pk_add_f32 v[38:39], v[38:39], v[40:41]
  v_lshlrev_b32 v40, 16, v72
  v_and_b32 v41, s7, v72
  v_pk_add_f32 v[32:33], v[32:33], v[40:41]
  v_lshlrev_b32 v40, 16, v73
  v_and_b32 v41, s7, v73
  v_pk_add_f32 v[34:35], v[34:35], v[40:41]
  v_lshlrev_b32 v40, 16, v74
  v_and_b32 v41, s7, v74
  v_pk_add_f32 v[36:37], v[36:37], v[40:41]
  v_lshlrev_b32 v40, 16, v75
  v_and_b32 v41, s7, v75
  v_pk_add_f32 v[38:39], v[38:39], v[40:41]
  v_lshlrev_b32 v40, 16, v76
  v_and_b32 v41, s7, v76
  v_pk_add_f32 v[32:33], v[32:33], v[40:41]
  v_lshlrev_b32 v40, 16, v77
  v_and_b32 v41, s7, v77
  v_pk_add_f32 v[34:35], v[34:35], v[40:41]
  v_lshlrev_b32 v40, 16, v78
  v_and_b32 v41, s7, v78
  v_pk_add_f32 v[36:37], v[36:37], v[40:41]
  v_lshlrev_b32 v40, 16, v79
  v_and_b32 v41, s7, v79
  v_pk_add_f32 v[38:39], v[38:39], v[40:41]
  v_lshlrev_b32 v40, 16, v80
  v_and_b32 v41, s7, v80
  v_pk_add_f32 v[32:33], v[32:33], v[40:41]
  v_lshlrev_b32 v40, 16, v81
  v_and_b32 v41, s7, v81
  v_pk_add_f32 v[34:35], v[34:35], v[40:41]
  v_lshlrev_b32 v40, 16, v82
  v_and_b32 v41, s7, v82
  v_pk_add_f32 v[36:37], v[36:37], v[40:41]
  v_lshlrev_b32 v40, 16, v83
  v_and_b32 v41, s7, v83
  v_pk_add_f32 v[38:39], v[38:39], v[40:41]
  v_lshlrev_b32 v40, 16, v84
  v_and_b32 v41, s7, v84
  v_pk_add_f32 v[32:33], v[32:33], v[40:41]
  v_lshlrev_b32 v40, 16, v85
  v_and_b32 v41, s7, v85
  v_pk_add_f32 v[34:35], v[34:35], v[40:41]
  v_lshlrev_b32 v40, 16, v86
  v_and_b32 v41, s7, v86
  v_pk_add_f32 v[36:37], v[36:37], v[40:41]
  v_lshlrev_b32 v40, 16, v87
  v_and_b32 v41, s7, v87
  v_pk_add_f32 v[38:39], v[38:39], v[40:41]
  v_lshlrev_b32 v40, 16, v88
  v_and_b32 v41, s7, v88
  v_pk_add_f32 v[32:33], v[32:33], v[40:41]
  v_lshlrev_b32 v40, 16, v89
  v_and_b32 v41, s7, v89
  v_pk_add_f32 v[34:35], v[34:35], v[40:41]
  v_lshlrev_b32 v40, 16, v90
  v_and_b32 v41, s7, v90
  v_pk_add_f32 v[36:37], v[36:37], v[40:41]
  v_lshlrev_b32 v40, 16, v91
  v_and_b32 v41, s7, v91
  v_pk_add_f32 v[38:39], v[38:39], v[40:41]
  v_lshlrev_b32 v40, 16, v92
  v_and_b32 v41, s7, v92
  v_pk_add_f32 v[32:33], v[32:33], v[40:41]
  v_lshlrev_b32 v40, 16, v93
  v_and_b32 v41, s7, v93
  v_pk_add_f32 v[34:35], v[34:35], v[40:41]
  v_lshlrev_b32 v40, 16, v94
  v_and_b32 v41, s7, v94
  v_pk_add_f32 v[36:37], v[36:37], v[40:41]
  v_lshlrev_b32 v40, 16, v95
  v_and_b32 v41, s7, v95
  v_pk_add_f32 v[38:39], v[38:39], v[40:41]
  s_add_u32 s52, s22, 24641536
  s_addc_u32 s53, s23, 0
  s_and_b32 s53, s53, 0xffff
  s_mov_b32 s54, 262144
  s_mov_b32 s55, 0x00020000
  v_permlane32_swap_b32 v32, v36
  v_permlane32_swap_b32 v33, v37
  v_permlane32_swap_b32 v34, v38
  v_permlane32_swap_b32 v35, v39
  v_add_f32 v32, v32, v36
  v_add_f32 v33, v33, v37
  v_add_f32 v34, v34, v38
  v_add_f32 v35, v35, v39
  v_and_b32 v2, 7, v1
  v_lshlrev_b32 v2, 5, v2
  v_permlane16_swap_b32 v32, v34
  v_permlane16_swap_b32 v33, v35
  v_add_f32 v32, v32, v34
  v_add_f32 v33, v33, v35
  v_lshrrev_b32 v3, 4, v1
  v_lshl_add_u32 v2, v3, 3, v2
  v_add_f32_dpp v32, v32, v32 row_ror:8 row_mask:0xf bank_mask:0xf
  v_add_f32_dpp v33, v33, v33 row_ror:8 row_mask:0xf bank_mask:0xf
  buffer_store_dwordx2 v[32:33], v2, s[52:55], s94 offen sc1
L_wo_nofirst:
  v_and_b32 v2, 3, v1
  v_lshlrev_b32 v2, 3, v2
  v_bfe_i32 v16, s85, v2, 8
  s_and_b32 s3, s68, 3
  s_mul_i32 s4, s3, 4
  v_add3_u32 v3, v16, v1, s4
  v_and_b32 v3, 15, v3
  v_lshlrev_b32 v16, 17, v3
  s_add_u32 s9, s70, s68
  s_and_b32 s9, s9, 3
  s_lshl_b32 s77, s9, 11
  v_and_b32 v10, 7, v1
  v_lshrrev_b32 v3, 3, v1
  s_lshl_b32 s10, s9, 4
  v_add_u32 v3, s10, v3
  v_mul_u32_u24 v3, 2048, v3
  v_lshrrev_b32 v2, 3, v1
  v_and_b32 v2, 6, v2
  v_xor_b32 v2, v2, v10
  s_lshl_b32 s10, s69, 7
  v_add_u32 v3, s10, v3
  v_lshl_add_u32 v8, v2, 4, v3
  v_add_u32 v3, 16384, v3
  v_lshl_add_u32 v9, v2, 4, v3
  s_mov_b32 s40, s20
  s_and_b32 s41, s21, 0xffff
  s_mov_b32 s42, 2097152
  s_mov_b32 s43, 0x00020000
  v_readlane_b32 s74, v16, 0
  s_add_u32 m0, s77, 28672
  s_add_u32 s4, s74, 0
  buffer_load_dwordx4 v8, s[40:43], s4 offen lds
  s_add_u32 m0, s77, 29696
  s_nop 0
  buffer_load_dwordx4 v9, s[40:43], s4 offen lds
  v_readlane_b32 s74, v16, 1
  s_add_u32 m0, s77, 36864
  s_add_u32 s4, s74, 0
  buffer_load_dwordx4 v8, s[40:43], s4 offen lds
  s_add_u32 m0, s77, 37888
  s_nop 0
  buffer_load_dwordx4 v9, s[40:43], s4 offen lds
  v_readlane_b32 s74, v16, 2
  s_add_u32 m0, s77, 45056
  s_add_u32 s4, s74, 0
  buffer_load_dwordx4 v8, s[40:43], s4 offen lds
  s_add_u32 m0, s77, 46080
  s_nop 0
  buffer_load_dwordx4 v9, s[40:43], s4 offen lds
  v_readlane_b32 s74, v16, 3
  s_add_u32 m0, s77, 53248
  s_add_u32 s4, s74, 0
  buffer_load_dwordx4 v8, s[40:43], s4 offen lds
  s_add_u32 m0, s77, 54272
  s_nop 0
  buffer_load_dwordx4 v9, s[40:43], s4 offen lds
  v_readlane_b32 s74, v16, 4
  s_add_u32 m0, s77, 61440
  s_add_u32 s4, s74, 0
  buffer_load_dwordx4 v8, s[40:43], s4 offen lds
  s_add_u32 m0, s77, 62464
  s_nop 0
  buffer_load_dwordx4 v9, s[40:43], s4 offen lds
  v_readlane_b32 s74, v16, 5
  s_add_u32 m0, s77, 69632
  s_add_u32 s4, s74, 0
  buffer_load_dwordx4 v8, s[40:43], s4 offen lds
  s_add_u32 m0, s77, 70656
  s_nop 0
  buffer_load_dwordx4 v9, s[40:43], s4 offen lds
  s_waitcnt vmcnt(12)
  s_add_u32 s3, s96, s70
  s_cmp_lg_u32 s3, 4
  s_cbranch_scc1 L_wo_chk1
  v_cmp_ne_u32 vcc, 0x01010101, v12
  s_cbranch_vccz L_wo_chk1
  s_load_dwordx2 s[64:65], s[0:1], 72
  s_waitcnt lgkmcnt(0)
  s_and_b32 s65, s65, 0xffff
  s_mov_b32 s66, 256
  s_mov_b32 s67, 0x00020000
  v_lshlrev_b32 v17, 2, v1
  s_mov_b32 s79, 0x100000
L_wo_chkl:
  buffer_load_dword v12, v17, s[64:67], 0 offen sc1
  s_sub_u32 s79, s79, 1
  s_cbranch_scc1 L_wo_chk1
  s_waitcnt vmcnt(0)
  v_cmp_ne_u32 vcc, 0x01010101, v12
  s_cbranch_vccnz L_wo_chkl
L_wo_chk1:
  s_add_u32 s44, s22, 41943040
  s_addc_u32 s45, s23, 0
  s_and_b32 s45, s45, 0xffff
  s_mov_b32 s46, 524288
  s_mov_b32 s47, 0x00020000
  s_lshl4_add_u32 s3, s97, s68
  s_and_b32 s4, s69, 15
  s_lshl4_add_u32 s3, s3, s4
  s_lshl_b32 s3, s3, 7
  s_sub_u32 s3, s3, 32768
  v_lshlrev_b32 v11, 7, v1
  v_and_b32 v2, 15, v1
  v_lshlrev_b32 v2, 2, v2
  v_mov_b32 v3, 1
  s_mov_b32 s79, 0x100000
  s_cmp_lg_u32 s70, 4
  s_barrier
  s_cbranch_scc1 L_wo_nofl
  s_mov_b32 exec_lo, 0xffff
  s_mov_b32 exec_hi, 0
  buffer_store_dword v3, v11, s[44:47], s87 offen sc1
  s_mov_b64 exec, -1
L_wo_nofl:
  s_mov_b32 s5, s3
  v_readlane_b32 s74, v16, 6
  s_add_u32 m0, s77, 77824
  s_add_u32 s4, s74, 0
  buffer_load_dwordx4 v8, s[40:43], s4 offen lds
  s_add_u32 m0, s77, 78848
  s_nop 0
  buffer_load_dwordx4 v9, s[40:43], s4 offen lds
  v_readlane_b32 s74, v16, 7
  s_add_u32 m0, s77, 86016
  s_add_u32 s4, s74, 0
  buffer_load_dwordx4 v8, s[40:43], s4 offen lds
  s_add_u32 m0, s77, 87040
  s_nop 0
  buffer_load_dwordx4 v9, s[40:43], s4 offen lds
  v_readlane_b32 s74, v16, 8
  s_add_u32 m0, s77, 94208
  s_add_u32 s4, s74, 0
  buffer_load_dwordx4 v8, s[40:43], s4 offen lds
  s_add_u32 m0, s77, 95232
  s_nop 0
  buffer_load_dwordx4 v9, s[40:43], s4 offen lds
  v_readlane_b32 s74, v16, 9
  s_add_u32 m0, s77, 102400
  s_add_u32 s4, s74, 0
  buffer_load_dwordx4 v8, s[40:43], s4 offen lds
  s_add_u32 m0, s77, 103424
  s_nop 0
  buffer_load_dwordx4 v9, s[40:43], s4 offen lds
  v_readlane_b32 s74, v16, 10
  s_add_u32 m0, s77, 110592
  s_add_u32 s4, s74, 0
  buffer_load_dwordx4 v8, s[40:43], s4 offen lds
  s_add_u32 m0, s77, 111616
  s_nop 0
  buffer_load_dwordx4 v9, s[40:43], s4 offen lds
  v_readlane_b32 s74, v16, 11
  s_add_u32 m0, s77, 118784
  s_add_u32 s4, s74, 0
  buffer_load_dwordx4 v8, s[40:43], s4 offen lds
  s_add_u32 m0, s77, 119808
  s_nop 0
  buffer_load_dwordx4 v9, s[40:43], s4 offen lds
  v_readlane_b32 s74, v16, 12
  s_add_u32 m0, s77, 131072
  s_add_u32 s4, s74, 0
  buffer_load_dwordx4 v8, s[40:43], s4 offen lds
  s_add_u32 m0, s77, 132096
  s_nop 0
  buffer_load_dwordx4 v9, s[40:43], s4 offen lds
  v_readlane_b32 s74, v16, 13
  s_add_u32 m0, s77, 139264
  s_add_u32 s4, s74, 0
  buffer_load_dwordx4 v8, s[40:43], s4 offen lds
  s_add_u32 m0, s77, 140288
  s_nop 0
  buffer_load_dwordx4 v9, s[40:43], s4 offen lds
  v_readlane_b32 s74, v16, 14
  s_add_u32 m0, s77, 147456
  s_add_u32 s4, s74, 0
  buffer_load_dwordx4 v8, s[40:43], s4 offen lds
  s_add_u32 m0, s77, 148480
  s_nop 0
  buffer_load_dwordx4 v9, s[40:43], s4 offen lds
  v_readlane_b32 s74, v16, 15
  s_add_u32 m0, s77, 155648
  s_add_u32 s4, s74, 0
  buffer_load_dwordx4 v8, s[40:43], s4 offen lds
  s_add_u32 m0, s77, 156672
  s_nop 0
  buffer_load_dwordx4 v9, s[40:43], s4 offen lds
  s_mov_b32 s3, s5
  s_cmp_lg_u32 s70, 4
  s_cbranch_scc1 L_wo_dep
L_wo_poll:
  buffer_load_dword v3, v2, s[44:47], s3 offen sc1
  s_sub_u32 s79, s79, 1
  s_cbranch_scc1 L_wo_dep
  s_waitcnt vmcnt(0)
  v_cmp_ne_u32 vcc, 1, v3
  s_cbranch_vccnz L_wo_poll
L_wo_dep:
  s_waitcnt vmcnt(22) lgkmcnt(0)
  s_barrier
  s_waitcnt vmcnt(8)
  s_barrier
  s_waitcnt vmcnt(0)
  s_barrier
  s_waitcnt vmcnt(0)
  s_lshl_b32 s87, s97, 15
  s_lshl_b32 s4, s68, 11
  s_add_u32 s87, s87, s4
  s_lshl_b32 s4, s69, 2
  s_add_u32 s87, s87, s4
  s_add_u32 s97, s97, 1
  s_branch L_w1_body
L_wo_end:
  s_endpgm
L_wo_compute:
  v_and_b32 v2, 3, v1
  v_lshlrev_b32 v2, 3, v2
  v_bfe_i32 v15, s85, v2, 8
  s_and_b32 s3, s68, 3
  s_mul_i32 s4, s3, 4
  v_add3_u32 v3, v15, v1, s4
  v_and_b32 v3, 15, v3
  v_lshlrev_b32 v15, 11, v3
  v_and_b32 v3, 15, v1
  v_lshrrev_b32 v2, 4, v1
  s_lshl_b32 s8, s68, 7
  s_lshl_b32 s9, s70, 5
  s_add_u32 s8, s8, s9
  s_mul_i32 s9, s8, 2048
  v_add_u32 v13, s8, v3
  s_lshl_b32 s10, s69, 7
  v_lshl_add_u32 v14, v2, 3, s10
  v_and_b32 v16, 1, v2
  v_lshrrev_b32 v17, 1, v2
  v_lshlrev_b32 v16, 4, v1
  s_add_u32 s9, s8, s69
  s_lshl_b32 s9, s9, 11
  v_add_u32 v12, s9, v16
  s_lshl_b32 s9, s70, 12
  v_add_u32 v19, s9, v16
  v_lshl_add_u32 v18, v17, 4, v13
  v_lshlrev_b32 v18, 3, v18
  v_and_b32 v16, 1, v2
  v_lshl_add_u32 v18, v16, 2, v18
  s_lshl_b32 s10, s69, 14
  v_add_u32 v18, s10, v18
  v_lshrrev_b32 v6, 2, v1
  v_lshlrev_b32 v6, 7, v6
  v_and_b32 v17, 3, v1
  v_lshl_add_u32 v6, v17, 3, v6
  v_bfe_u32 v17, v1, 3, 2
  v_lshl_add_u32 v6, v17, 5, v6
  v_xor_b32 v7, 32, v6
  v_xor_b32 v8, 64, v6
  v_xor_b32 v9, 96, v6
  s_mov_b32 s11, 0xffff0000
  s_mov_b32 s36, s34
  s_and_b32 s37, s35, 0xffff
  s_mov_b32 s38, 4194304
  s_mov_b32 s39, 0x00020000
  s_add_u32 s44, s34, 4194304
  s_addc_u32 s45, s35, 0
  s_and_b32 s45, s45, 0xffff
  s_mov_b32 s46, 4194304
  s_mov_b32 s47, 0x00020000
  s_add_u32 s56, s34, 24117248
  s_addc_u32 s57, s35, 0
  s_and_b32 s57, s57, 0xffff
  s_mov_b32 s58, 262144
  s_mov_b32 s59, 0x00020000
  s_mul_i32 s9, s8, 2048
  s_add_u32 s36, s36, s9
  s_addc_u32 s37, s37, 0x100000
  s_add_u32 s64, s36, 32768
  s_addc_u32 s65, s37, 0
  s_mov_b32 s38, 32768
  s_mov_b32 s39, 0x00800000
  s_mov_b32 s66, 32768
  s_mov_b32 s67, 0x00800000
  s_cmp_lg_u32 s96, 0
  s_cbranch_scc1 L_pfc2_skip
  s_getpc_b64 s[4:5]
L_pfc2:
  s_lshl_b32 s3, s99, 2
  s_add_u32 s3, s3, s70
  s_mul_i32 s3, s3, 128
  s_min_u32 s3, s3, L_w1_c1-L_w1_c0-128
  s_add_i32 s3, s3, L_w1_c0-L_pfc2
  s_ashr_i32 s6, s3, 31
  s_add_u32 s4, s4, s3
  s_addc_u32 s5, s5, s6
  s_load_dword s40, s[4:5], 0
  s_load_dword s40, s[4:5], 64
L_pfc2_skip:
  v_add_u32 v26, 155648, v6
  v_add_u32 v27, 155648, v7
  v_add_u32 v28, 155648, v8
  v_add_u32 v29, 155648, v9
  v_add_u32 v20, 94208, v6
  v_add_u32 v21, 94208, v7
  v_add_u32 v22, 94208, v8
  v_add_u32 v23, 94208, v9
  v_add_u32 v6, 28672, v6
  v_add_u32 v7, 28672, v7
  v_add_u32 v8, 28672, v8
  v_add_u32 v9, 28672, v9
  v_readlane_b32 s48, v15, 0
  v_readlane_b32 s49, v15, 1
  v_readlane_b32 s50, v15, 2
  v_permlane16_swap_b32 v240, v242
  v_permlane16_swap_b32 v241, v243
  v_permlane16_swap_b32 v244, v246
  v_permlane16_swap_b32 v245, v247
  v_permlane16_swap_b32 v248, v250
  v_permlane16_swap_b32 v249, v251
  v_permlane16_swap_b32 v252, v254
  v_permlane16_swap_b32 v253, v255
  s_waitcnt lgkmcnt(0)
  s_barrier
  buffer_load_dwordx4 v[32:35], off, s[36:39], s48 offset:0
  buffer_load_dwordx4 v[36:39], off, s[64:67], s48 offset:0
  buffer_load_dwordx4 v[40:43], off, s[36:39], s48 offset:1024
  buffer_load_dwordx4 v[44:47], off, s[64:67], s48 offset:1024
  buffer_load_dwordx4 v[48:51], off, s[36:39], s49 offset:0
  buffer_load_dwordx4 v[52:55], off, s[64:67], s49 offset:0
  buffer_load_dwordx4 v[56:59], off, s[36:39], s49 offset:1024
  buffer_load_dwordx4 v[60:63], off, s[64:67], s49 offset:1024
  buffer_load_dwordx4 v[64:67], off, s[36:39], s50 offset:0
  buffer_load_dwordx4 v[68:71], off, s[64:67], s50 offset:0
  buffer_load_dwordx4 v[72:75], off, s[36:39], s50 offset:1024
  buffer_load_dwordx4 v[76:79], off, s[64:67], s50 offset:1024
  ds_read_b64_tr_b16 v[160:161], v6 offset:0
  ds_read_b64_tr_b16 v[162:163], v6 offset:2048
  ds_read_b64_tr_b16 v[164:165], v7 offset:0
  ds_read_b64_tr_b16 v[166:167], v7 offset:2048
  ds_read_b64_tr_b16 v[168:169], v8 offset:0
  ds_read_b64_tr_b16 v[170:171], v8 offset:2048
  ds_read_b64_tr_b16 v[172:173], v9 offset:0
  ds_read_b64_tr_b16 v[174:175], v9 offset:2048
  ds_read_b64_tr_b16 v[176:177], v6 offset:4096
  ds_read_b64_tr_b16 v[178:179], v6 offset:6144
  ds_read_b64_tr_b16 v[180:181], v7 offset:4096
  ds_read_b64_tr_b16 v[182:183], v7 offset:6144
  ds_read_b64_tr_b16 v[184:185], v8 offset:4096
  ds_read_b64_tr_b16 v[186:187], v8 offset:6144
  ds_read_b64_tr_b16 v[188:189], v9 offset:4096
  ds_read_b64_tr_b16 v[190:191], v9 offset:6144
  v_lshlrev_b32 v96, 16, v240
  v_and_b32 v97, s11, v240
  v_lshlrev_b32 v98, 16, v241
  v_and_b32 v99, s11, v241
  v_lshlrev_b32 v100, 16, v248
  v_and_b32 v101, s11, v248
  v_lshlrev_b32 v102, 16, v249
  v_and_b32 v103, s11, v249
  v_lshlrev_b32 v104, 16, v242
  v_and_b32 v105, s11, v242
  v_lshlrev_b32 v106, 16, v243
  v_and_b32 v107, s11, v243
  v_lshlrev_b32 v108, 16, v250
  v_and_b32 v109, s11, v250
  v_lshlrev_b32 v110, 16, v251
  v_and_b32 v111, s11, v251
  v_lshlrev_b32 v112, 16, v244
  v_and_b32 v113, s11, v244
  v_lshlrev_b32 v114, 16, v245
  v_and_b32 v115, s11, v245
  v_lshlrev_b32 v116, 16, v252
  v_and_b32 v117, s11, v252
  v_lshlrev_b32 v118, 16, v253
  v_and_b32 v119, s11, v253
  v_lshlrev_b32 v120, 16, v246
  v_and_b32 v121, s11, v246
  v_lshlrev_b32 v122, 16, v247
  v_and_b32 v123, s11, v247
  v_lshlrev_b32 v124, 16, v254
  v_and_b32 v125, s11, v254
  v_lshlrev_b32 v126, 16, v255
  v_and_b32 v127, s11, v255
  s_waitcnt vmcnt(10) lgkmcnt(8)
  v_mfma_f32_16x16x32_bf16 v[96:99], v[160:163], v[32:35], v[96:99]
  ds_read_b64_tr_b16 v[192:193], v6 offset:8192
  v_readlane_b32 s51, v15, 3
  v_mfma_f32_16x16x32_bf16 v[100:103], v[160:163], v[36:39], v[100:103]
  ds_read_b64_tr_b16 v[194:195], v6 offset:10240
  v_mfma_f32_16x16x32_bf16 v[108:111], v[164:167], v[36:39], v[108:111]
  ds_read_b64_tr_b16 v[196:197], v7 offset:8192
  v_mfma_f32_16x16x32_bf16 v[104:107], v[164:167], v[32:35], v[104:107]
  buffer_load_dwordx4 v[80:83], off, s[36:39], s51 offset:0
  v_mfma_f32_16x16x32_bf16 v[112:115], v[168:171], v[32:35], v[112:115]
  ds_read_b64_tr_b16 v[198:199], v7 offset:10240
  ds_read_b64_tr_b16 v[200:201], v8 offset:8192
  v_mfma_f32_16x16x32_bf16 v[116:119], v[168:171], v[36:39], v[116:119]
  ds_read_b64_tr_b16 v[202:203], v8 offset:10240
  ds_read_b64_tr_b16 v[204:205], v9 offset:8192
  v_mfma_f32_16x16x32_bf16 v[124:127], v[172:175], v[36:39], v[124:127]
  buffer_load_dwordx4 v[84:87], off, s[64:67], s51 offset:0
  v_mfma_f32_16x16x32_bf16 v[120:123], v[172:175], v[32:35], v[120:123]
  ds_read_b64_tr_b16 v[206:207], v9 offset:10240
  s_waitcnt vmcnt(10) lgkmcnt(8)
  v_mfma_f32_16x16x32_bf16 v[96:99], v[176:179], v[40:43], v[96:99]
  ds_read_b64_tr_b16 v[208:209], v6 offset:12288
  v_mfma_f32_16x16x32_bf16 v[100:103], v[176:179], v[44:47], v[100:103]
  buffer_load_dwordx4 v[88:91], off, s[36:39], s51 offset:1024
  v_mfma_f32_16x16x32_bf16 v[108:111], v[180:183], v[44:47], v[108:111]
  ds_read_b64_tr_b16 v[210:211], v6 offset:14336
  ds_read_b64_tr_b16 v[212:213], v7 offset:12288
  v_mfma_f32_16x16x32_bf16 v[104:107], v[180:183], v[40:43], v[104:107]
  ds_read_b64_tr_b16 v[214:215], v7 offset:14336
  ds_read_b64_tr_b16 v[216:217], v8 offset:12288
  v_mfma_f32_16x16x32_bf16 v[112:115], v[184:187], v[40:43], v[112:115]
  buffer_load_dwordx4 v[92:95], off, s[64:67], s51 offset:1024
  v_mfma_f32_16x16x32_bf16 v[116:119], v[184:187], v[44:47], v[116:119]
  ds_read_b64_tr_b16 v[218:219], v8 offset:14336
  v_readlane_b32 s48, v15, 4
  v_mfma_f32_16x16x32_bf16 v[124:127], v[188:191], v[44:47], v[124:127]
  ds_read_b64_tr_b16 v[220:221], v9 offset:12288
  v_mfma_f32_16x16x32_bf16 v[120:123], v[188:191], v[40:43], v[120:123]
  ds_read_b64_tr_b16 v[222:223], v9 offset:14336
  s_waitcnt vmcnt(10) lgkmcnt(8)
  v_mfma_f32_16x16x32_bf16 v[96:99], v[192:195], v[48:51], v[96:99]
  buffer_load_dwordx4 v[32:35], off, s[36:39], s48 offset:0
  v_mfma_f32_16x16x32_bf16 v[100:103], v[192:195], v[52:55], v[100:103]
  ds_read_b64_tr_b16 v[160:161], v6 offset:16384
  ds_read_b64_tr_b16 v[162:163], v6 offset:18432
  v_mfma_f32_16x16x32_bf16 v[108:111], v[196:199], v[52:55], v[108:111]
  ds_read_b64_tr_b16 v[164:165], v7 offset:16384
  v_mfma_f32_16x16x32_bf16 v[104:107], v[196:199], v[48:51], v[104:107]
  buffer_load_dwordx4 v[36:39], off, s[64:67], s48 offset:0
  v_mfma_f32_16x16x32_bf16 v[112:115], v[200:203], v[48:51], v[112:115]
  ds_read_b64_tr_b16 v[166:167], v7 offset:18432
  ds_read_b64_tr_b16 v[168:169], v8 offset:16384
  v_mfma_f32_16x16x32_bf16 v[116:119], v[200:203], v[52:55], v[116:119]
  ds_read_b64_tr_b16 v[170:171], v8 offset:18432
  ds_read_b64_tr_b16 v[172:173], v9 offset:16384
  v_mfma_f32_16x16x32_bf16 v[124:127], v[204:207], v[52:55], v[124:127]
  buffer_load_dwordx4 v[40:43], off, s[36:39], s48 offset:1024
  v_mfma_f32_16x16x32_bf16 v[120:123], v[204:207], v[48:51], v[120:123]
  ds_read_b64_tr_b16 v[174:175], v9 offset:18432
  s_waitcnt vmcnt(11) lgkmcnt(8)
  v_mfma_f32_16x16x32_bf16 v[96:99], v[208:211], v[56:59], v[96:99]
  ds_read_b64_tr_b16 v[176:177], v6 offset:20480
  v_mfma_f32_16x16x32_bf16 v[100:103], v[208:211], v[60:63], v[100:103]
  buffer_load_dwordx4 v[44:47], off, s[64:67], s48 offset:1024
  v_mfma_f32_16x16x32_bf16 v[108:111], v[212:215], v[60:63], v[108:111]
  ds_read_b64_tr_b16 v[178:179], v6 offset:22528
  ds_read_b64_tr_b16 v[180:181], v7 offset:20480
  v_mfma_f32_16x16x32_bf16 v[104:107], v[212:215], v[56:59], v[104:107]
  ds_read_b64_tr_b16 v[182:183], v7 offset:22528
  v_mfma_f32_16x16x32_bf16 v[112:115], v[216:219], v[56:59], v[112:115]
  ds_read_b64_tr_b16 v[184:185], v8 offset:20480
  v_mfma_f32_16x16x32_bf16 v[116:119], v[216:219], v[60:63], v[116:119]
  ds_read_b64_tr_b16 v[186:187], v8 offset:22528
  v_readlane_b32 s49, v15, 5
  v_mfma_f32_16x16x32_bf16 v[124:127], v[220:223], v[60:63], v[124:127]
  ds_read_b64_tr_b16 v[188:189], v9 offset:20480
  v_mfma_f32_16x16x32_bf16 v[120:123], v[220:223], v[56:59], v[120:123]
  ds_read_b64_tr_b16 v[190:191], v9 offset:22528
  s_waitcnt vmcnt(10) lgkmcnt(8)
  v_mfma_f32_16x16x32_bf16 v[96:99], v[160:163], v[64:67], v[96:99]
  buffer_load_dwordx4 v[48:51], off, s[36:39], s49 offset:0
  v_mfma_f32_16x16x32_bf16 v[100:103], v[160:163], v[68:71], v[100:103]
  ds_read_b64_tr_b16 v[192:193], v6 offset:24576
  ds_read_b64_tr_b16 v[194:195], v6 offset:26624
  v_mfma_f32_16x16x32_bf16 v[108:111], v[164:167], v[68:71], v[108:111]
  ds_read_b64_tr_b16 v[196:197], v7 offset:24576
  v_mfma_f32_16x16x32_bf16 v[104:107], v[164:167], v[64:67], v[104:107]
  buffer_load_dwordx4 v[52:55], off, s[64:67], s49 offset:0
  v_mfma_f32_16x16x32_bf16 v[112:115], v[168:171], v[64:67], v[112:115]
  ds_read_b64_tr_b16 v[198:199], v7 offset:26624
  ds_read_b64_tr_b16 v[200:201], v8 offset:24576
  v_mfma_f32_16x16x32_bf16 v[116:119], v[168:171], v[68:71], v[116:119]
  ds_read_b64_tr_b16 v[202:203], v8 offset:26624
  ds_read_b64_tr_b16 v[204:205], v9 offset:24576
  v_mfma_f32_16x16x32_bf16 v[124:127], v[172:175], v[68:71], v[124:127]
  buffer_load_dwordx4 v[56:59], off, s[36:39], s49 offset:1024
  v_mfma_f32_16x16x32_bf16 v[120:123], v[172:175], v[64:67], v[120:123]
  ds_read_b64_tr_b16 v[206:207], v9 offset:26624
  s_waitcnt vmcnt(11) lgkmcnt(8)
  v_mfma_f32_16x16x32_bf16 v[96:99], v[176:179], v[72:75], v[96:99]
  ds_read_b64_tr_b16 v[208:209], v6 offset:28672
  v_mfma_f32_16x16x32_bf16 v[100:103], v[176:179], v[76:79], v[100:103]
  buffer_load_dwordx4 v[60:63], off, s[64:67], s49 offset:1024
  v_mfma_f32_16x16x32_bf16 v[108:111], v[180:183], v[76:79], v[108:111]
  ds_read_b64_tr_b16 v[210:211], v6 offset:30720
  ds_read_b64_tr_b16 v[212:213], v7 offset:28672
  v_mfma_f32_16x16x32_bf16 v[104:107], v[180:183], v[72:75], v[104:107]
  ds_read_b64_tr_b16 v[214:215], v7 offset:30720
  v_mfma_f32_16x16x32_bf16 v[112:115], v[184:187], v[72:75], v[112:115]
  ds_read_b64_tr_b16 v[216:217], v8 offset:28672
  v_mfma_f32_16x16x32_bf16 v[116:119], v[184:187], v[76:79], v[116:119]
  ds_read_b64_tr_b16 v[218:219], v8 offset:30720
  v_readlane_b32 s50, v15, 6
  v_mfma_f32_16x16x32_bf16 v[124:127], v[188:191], v[76:79], v[124:127]
  ds_read_b64_tr_b16 v[220:221], v9 offset:28672
  v_mfma_f32_16x16x32_bf16 v[120:123], v[188:191], v[72:75], v[120:123]
  ds_read_b64_tr_b16 v[222:223], v9 offset:30720
  s_waitcnt vmcnt(10) lgkmcnt(8)
  v_mfma_f32_16x16x32_bf16 v[96:99], v[192:195], v[80:83], v[96:99]
  buffer_load_dwordx4 v[64:67], off, s[36:39], s50 offset:0
  v_mfma_f32_16x16x32_bf16 v[100:103], v[192:195], v[84:87], v[100:103]
  ds_read_b64_tr_b16 v[160:161], v6 offset:32768
  ds_read_b64_tr_b16 v[162:163], v6 offset:34816
  v_mfma_f32_16x16x32_bf16 v[108:111], v[196:199], v[84:87], v[108:111]
  ds_read_b64_tr_b16 v[164:165], v7 offset:32768
  v_mfma_f32_16x16x32_bf16 v[104:107], v[196:199], v[80:83], v[104:107]
  buffer_load_dwordx4 v[68:71], off, s[64:67], s50 offset:0
  v_mfma_f32_16x16x32_bf16 v[112:115], v[200:203], v[80:83], v[112:115]
  ds_read_b64_tr_b16 v[166:167], v7 offset:34816
  ds_read_b64_tr_b16 v[168:169], v8 offset:32768
  v_mfma_f32_16x16x32_bf16 v[116:119], v[200:203], v[84:87], v[116:119]
  ds_read_b64_tr_b16 v[170:171], v8 offset:34816
  ds_read_b64_tr_b16 v[172:173], v9 offset:32768
  v_mfma_f32_16x16x32_bf16 v[124:127], v[204:207], v[84:87], v[124:127]
  buffer_load_dwordx4 v[72:75], off, s[36:39], s50 offset:1024
  v_mfma_f32_16x16x32_bf16 v[120:123], v[204:207], v[80:83], v[120:123]
  ds_read_b64_tr_b16 v[174:175], v9 offset:34816
  s_waitcnt vmcnt(11) lgkmcnt(8)
  s_barrier
  v_mfma_f32_16x16x32_bf16 v[96:99], v[208:211], v[88:91], v[96:99]
  ds_read_b64_tr_b16 v[176:177], v6 offset:36864
  v_mfma_f32_16x16x32_bf16 v[100:103], v[208:211], v[92:95], v[100:103]
  buffer_load_dwordx4 v[76:79], off, s[64:67], s50 offset:1024
  v_mfma_f32_16x16x32_bf16 v[108:111], v[212:215], v[92:95], v[108:111]
  ds_read_b64_tr_b16 v[178:179], v6 offset:38912
  ds_read_b64_tr_b16 v[180:181], v7 offset:36864
  v_mfma_f32_16x16x32_bf16 v[104:107], v[212:215], v[88:91], v[104:107]
  ds_read_b64_tr_b16 v[182:183], v7 offset:38912
  v_mfma_f32_16x16x32_bf16 v[112:115], v[216:219], v[88:91], v[112:115]
  ds_read_b64_tr_b16 v[184:185], v8 offset:36864
  v_mfma_f32_16x16x32_bf16 v[116:119], v[216:219], v[92:95], v[116:119]
  ds_read_b64_tr_b16 v[186:187], v8 offset:38912
  v_readlane_b32 s51, v15, 7
  v_mfma_f32_16x16x32_bf16 v[124:127], v[220:223], v[92:95], v[124:127]
  ds_read_b64_tr_b16 v[188:189], v9 offset:36864
  v_mfma_f32_16x16x32_bf16 v[120:123], v[220:223], v[88:91], v[120:123]
  ds_read_b64_tr_b16 v[190:191], v9 offset:38912
  s_waitcnt vmcnt(10) lgkmcnt(8)
  v_mfma_f32_16x16x32_bf16 v[96:99], v[160:163], v[32:35], v[96:99]
  buffer_load_dwordx4 v[80:83], off, s[36:39], s51 offset:0
  v_mfma_f32_16x16x32_bf16 v[100:103], v[160:163], v[36:39], v[100:103]
  ds_read_b64_tr_b16 v[192:193], v6 offset:40960
  ds_read_b64_tr_b16 v[194:195], v6 offset:43008
  v_mfma_f32_16x16x32_bf16 v[108:111], v[164:167], v[36:39], v[108:111]
  ds_read_b64_tr_b16 v[196:197], v7 offset:40960
  v_mfma_f32_16x16x32_bf16 v[104:107], v[164:167], v[32:35], v[104:107]
  buffer_load_dwordx4 v[84:87], off, s[64:67], s51 offset:0
  v_mfma_f32_16x16x32_bf16 v[112:115], v[168:171], v[32:35], v[112:115]
  ds_read_b64_tr_b16 v[198:199], v7 offset:43008
  ds_read_b64_tr_b16 v[200:201], v8 offset:40960
  v_mfma_f32_16x16x32_bf16 v[116:119], v[168:171], v[36:39], v[116:119]
  ds_read_b64_tr_b16 v[202:203], v8 offset:43008
  ds_read_b64_tr_b16 v[204:205], v9 offset:40960
  v_mfma_f32_16x16x32_bf16 v[124:127], v[172:175], v[36:39], v[124:127]
  buffer_load_dwordx4 v[88:91], off, s[36:39], s51 offset:1024
  v_mfma_f32_16x16x32_bf16 v[120:123], v[172:175], v[32:35], v[120:123]
  ds_read_b64_tr_b16 v[206:207], v9 offset:43008
  s_waitcnt vmcnt(11) lgkmcnt(8)
  v_mfma_f32_16x16x32_bf16 v[96:99], v[176:179], v[40:43], v[96:99]
  ds_read_b64_tr_b16 v[208:209], v6 offset:45056
  v_mfma_f32_16x16x32_bf16 v[100:103], v[176:179], v[44:47], v[100:103]
  buffer_load_dwordx4 v[92:95], off, s[64:67], s51 offset:1024
  v_mfma_f32_16x16x32_bf16 v[108:111], v[180:183], v[44:47], v[108:111]
  ds_read_b64_tr_b16 v[210:211], v6 offset:47104
  ds_read_b64_tr_b16 v[212:213], v7 offset:45056
  v_mfma_f32_16x16x32_bf16 v[104:107], v[180:183], v[40:43], v[104:107]
  ds_read_b64_tr_b16 v[214:215], v7 offset:47104
  v_mfma_f32_16x16x32_bf16 v[112:115], v[184:187], v[40:43], v[112:115]
  ds_read_b64_tr_b16 v[216:217], v8 offset:45056
  v_mfma_f32_16x16x32_bf16 v[116:119], v[184:187], v[44:47], v[116:119]
  ds_read_b64_tr_b16 v[218:219], v8 offset:47104
  v_readlane_b32 s48, v15, 8
  v_mfma_f32_16x16x32_bf16 v[124:127], v[188:191], v[44:47], v[124:127]
  ds_read_b64_tr_b16 v[220:221], v9 offset:45056
  v_mfma_f32_16x16x32_bf16 v[120:123], v[188:191], v[40:43], v[120:123]
  ds_read_b64_tr_b16 v[222:223], v9 offset:47104
  s_waitcnt vmcnt(10) lgkmcnt(8)
  v_mfma_f32_16x16x32_bf16 v[96:99], v[192:195], v[48:51], v[96:99]
  buffer_load_dwordx4 v[32:35], off, s[36:39], s48 offset:0
  v_mfma_f32_16x16x32_bf16 v[100:103], v[192:195], v[52:55], v[100:103]
  ds_read_b64_tr_b16 v[160:161], v6 offset:49152
  ds_read_b64_tr_b16 v[162:163], v6 offset:51200
  v_mfma_f32_16x16x32_bf16 v[108:111], v[196:199], v[52:55], v[108:111]
  ds_read_b64_tr_b16 v[164:165], v7 offset:49152
  v_mfma_f32_16x16x32_bf16 v[104:107], v[196:199], v[48:51], v[104:107]
  buffer_load_dwordx4 v[36:39], off, s[64:67], s48 offset:0
  v_mfma_f32_16x16x32_bf16 v[112:115], v[200:203], v[48:51], v[112:115]
  ds_read_b64_tr_b16 v[166:167], v7 offset:51200
  ds_read_b64_tr_b16 v[168:169], v8 offset:49152
  v_mfma_f32_16x16x32_bf16 v[116:119], v[200:203], v[52:55], v[116:119]
  ds_read_b64_tr_b16 v[170:171], v8 offset:51200
  ds_read_b64_tr_b16 v[172:173], v9 offset:49152
  v_mfma_f32_16x16x32_bf16 v[124:127], v[204:207], v[52:55], v[124:127]
  buffer_load_dwordx4 v[40:43], off, s[36:39], s48 offset:1024
  v_mfma_f32_16x16x32_bf16 v[120:123], v[204:207], v[48:51], v[120:123]
  ds_read_b64_tr_b16 v[174:175], v9 offset:51200
  s_waitcnt vmcnt(11) lgkmcnt(8)
  v_mfma_f32_16x16x32_bf16 v[96:99], v[208:211], v[56:59], v[96:99]
  ds_read_b64_tr_b16 v[176:177], v6 offset:53248
  v_mfma_f32_16x16x32_bf16 v[100:103], v[208:211], v[60:63], v[100:103]
  buffer_load_dwordx4 v[44:47], off, s[64:67], s48 offset:1024
  v_mfma_f32_16x16x32_bf16 v[108:111], v[212:215], v[60:63], v[108:111]
  ds_read_b64_tr_b16 v[178:179], v6 offset:55296
  ds_read_b64_tr_b16 v[180:181], v7 offset:53248
  v_mfma_f32_16x16x32_bf16 v[104:107], v[212:215], v[56:59], v[104:107]
  ds_read_b64_tr_b16 v[182:183], v7 offset:55296
  v_mfma_f32_16x16x32_bf16 v[112:115], v[216:219], v[56:59], v[112:115]
  ds_read_b64_tr_b16 v[184:185], v8 offset:53248
  v_mfma_f32_16x16x32_bf16 v[116:119], v[216:219], v[60:63], v[116:119]
  ds_read_b64_tr_b16 v[186:187], v8 offset:55296
  v_readlane_b32 s49, v15, 9
  v_mfma_f32_16x16x32_bf16 v[124:127], v[220:223], v[60:63], v[124:127]
  ds_read_b64_tr_b16 v[188:189], v9 offset:53248
  v_mfma_f32_16x16x32_bf16 v[120:123], v[220:223], v[56:59], v[120:123]
  ds_read_b64_tr_b16 v[190:191], v9 offset:55296
  s_waitcnt vmcnt(10) lgkmcnt(8)
  v_mfma_f32_16x16x32_bf16 v[96:99], v[160:163], v[64:67], v[96:99]
  buffer_load_dwordx4 v[48:51], off, s[36:39], s49 offset:0
  v_mfma_f32_16x16x32_bf16 v[100:103], v[160:163], v[68:71], v[100:103]
  ds_read_b64_tr_b16 v[192:193], v6 offset:57344
  ds_read_b64_tr_b16 v[194:195], v6 offset:59392
  v_mfma_f32_16x16x32_bf16 v[108:111], v[164:167], v[68:71], v[108:111]
  ds_read_b64_tr_b16 v[196:197], v7 offset:57344
  v_mfma_f32_16x16x32_bf16 v[104:107], v[164:167], v[64:67], v[104:107]
  buffer_load_dwordx4 v[52:55], off, s[64:67], s49 offset:0
  v_mfma_f32_16x16x32_bf16 v[112:115], v[168:171], v[64:67], v[112:115]
  ds_read_b64_tr_b16 v[198:199], v7 offset:59392
  ds_read_b64_tr_b16 v[200:201], v8 offset:57344
  v_mfma_f32_16x16x32_bf16 v[116:119], v[168:171], v[68:71], v[116:119]
  ds_read_b64_tr_b16 v[202:203], v8 offset:59392
  ds_read_b64_tr_b16 v[204:205], v9 offset:57344
  v_mfma_f32_16x16x32_bf16 v[124:127], v[172:175], v[68:71], v[124:127]
  buffer_load_dwordx4 v[56:59], off, s[36:39], s49 offset:1024
  v_mfma_f32_16x16x32_bf16 v[120:123], v[172:175], v[64:67], v[120:123]
  ds_read_b64_tr_b16 v[206:207], v9 offset:59392
  s_waitcnt vmcnt(11) lgkmcnt(8)
  v_mfma_f32_16x16x32_bf16 v[96:99], v[176:179], v[72:75], v[96:99]
  ds_read_b64_tr_b16 v[208:209], v6 offset:61440
  v_mfma_f32_16x16x32_bf16 v[100:103], v[176:179], v[76:79], v[100:103]
  buffer_load_dwordx4 v[60:63], off, s[64:67], s49 offset:1024
  v_mfma_f32_16x16x32_bf16 v[108:111], v[180:183], v[76:79], v[108:111]
  ds_read_b64_tr_b16 v[210:211], v6 offset:63488
  ds_read_b64_tr_b16 v[212:213], v7 offset:61440
  v_mfma_f32_16x16x32_bf16 v[104:107], v[180:183], v[72:75], v[104:107]
  ds_read_b64_tr_b16 v[214:215], v7 offset:63488
  v_mfma_f32_16x16x32_bf16 v[112:115], v[184:187], v[72:75], v[112:115]
  ds_read_b64_tr_b16 v[216:217], v8 offset:61440
  v_mfma_f32_16x16x32_bf16 v[116:119], v[184:187], v[76:79], v[116:119]
  ds_read_b64_tr_b16 v[218:219], v8 offset:63488
  v_readlane_b32 s50, v15, 10
  v_mfma_f32_16x16x32_bf16 v[124:127], v[188:191], v[76:79], v[124:127]
  ds_read_b64_tr_b16 v[220:221], v9 offset:61440
  v_mfma_f32_16x16x32_bf16 v[120:123], v[188:191], v[72:75], v[120:123]
  ds_read_b64_tr_b16 v[222:223], v9 offset:63488
  s_waitcnt vmcnt(10) lgkmcnt(8)
  v_mfma_f32_16x16x32_bf16 v[96:99], v[192:195], v[80:83], v[96:99]
  buffer_load_dwordx4 v[64:67], off, s[36:39], s50 offset:0
  v_mfma_f32_16x16x32_bf16 v[100:103], v[192:195], v[84:87], v[100:103]
  ds_read_b64_tr_b16 v[160:161], v20 offset:0
  ds_read_b64_tr_b16 v[162:163], v20 offset:2048
  v_mfma_f32_16x16x32_bf16 v[108:111], v[196:199], v[84:87], v[108:111]
  ds_read_b64_tr_b16 v[164:165], v21 offset:0
  v_mfma_f32_16x16x32_bf16 v[104:107], v[196:199], v[80:83], v[104:107]
  buffer_load_dwordx4 v[68:71], off, s[64:67], s50 offset:0
  v_mfma_f32_16x16x32_bf16 v[112:115], v[200:203], v[80:83], v[112:115]
  ds_read_b64_tr_b16 v[166:167], v21 offset:2048
  ds_read_b64_tr_b16 v[168:169], v22 offset:0
  v_mfma_f32_16x16x32_bf16 v[116:119], v[200:203], v[84:87], v[116:119]
  ds_read_b64_tr_b16 v[170:171], v22 offset:2048
  ds_read_b64_tr_b16 v[172:173], v23 offset:0
  v_mfma_f32_16x16x32_bf16 v[124:127], v[204:207], v[84:87], v[124:127]
  buffer_load_dwordx4 v[72:75], off, s[36:39], s50 offset:1024
  v_mfma_f32_16x16x32_bf16 v[120:123], v[204:207], v[80:83], v[120:123]
  ds_read_b64_tr_b16 v[174:175], v23 offset:2048
  s_waitcnt vmcnt(11) lgkmcnt(8)
  v_mfma_f32_16x16x32_bf16 v[96:99], v[208:211], v[88:91], v[96:99]
  ds_read_b64_tr_b16 v[176:177], v20 offset:4096
  v_mfma_f32_16x16x32_bf16 v[100:103], v[208:211], v[92:95], v[100:103]
  buffer_load_dwordx4 v[76:79], off, s[64:67], s50 offset:1024
  v_mfma_f32_16x16x32_bf16 v[108:111], v[212:215], v[92:95], v[108:111]
  ds_read_b64_tr_b16 v[178:179], v20 offset:6144
  ds_read_b64_tr_b16 v[180:181], v21 offset:4096
  v_mfma_f32_16x16x32_bf16 v[104:107], v[212:215], v[88:91], v[104:107]
  ds_read_b64_tr_b16 v[182:183], v21 offset:6144
  v_mfma_f32_16x16x32_bf16 v[112:115], v[216:219], v[88:91], v[112:115]
  ds_read_b64_tr_b16 v[184:185], v22 offset:4096
  v_mfma_f32_16x16x32_bf16 v[116:119], v[216:219], v[92:95], v[116:119]
  ds_read_b64_tr_b16 v[186:187], v22 offset:6144
  v_readlane_b32 s51, v15, 11
  v_mfma_f32_16x16x32_bf16 v[124:127], v[220:223], v[92:95], v[124:127]
  ds_read_b64_tr_b16 v[188:189], v23 offset:4096
  v_mfma_f32_16x16x32_bf16 v[120:123], v[220:223], v[88:91], v[120:123]
  ds_read_b64_tr_b16 v[190:191], v23 offset:6144
  s_waitcnt vmcnt(10) lgkmcnt(8)
  v_mfma_f32_16x16x32_bf16 v[96:99], v[160:163], v[32:35], v[96:99]
  buffer_load_dwordx4 v[80:83], off, s[36:39], s51 offset:0
  v_mfma_f32_16x16x32_bf16 v[100:103], v[160:163], v[36:39], v[100:103]
  ds_read_b64_tr_b16 v[192:193], v20 offset:8192
  ds_read_b64_tr_b16 v[194:195], v20 offset:10240
  v_mfma_f32_16x16x32_bf16 v[108:111], v[164:167], v[36:39], v[108:111]
  ds_read_b64_tr_b16 v[196:197], v21 offset:8192
  v_mfma_f32_16x16x32_bf16 v[104:107], v[164:167], v[32:35], v[104:107]
  buffer_load_dwordx4 v[84:87], off, s[64:67], s51 offset:0
  v_mfma_f32_16x16x32_bf16 v[112:115], v[168:171], v[32:35], v[112:115]
  ds_read_b64_tr_b16 v[198:199], v21 offset:10240
  ds_read_b64_tr_b16 v[200:201], v22 offset:8192
  v_mfma_f32_16x16x32_bf16 v[116:119], v[168:171], v[36:39], v[116:119]
  ds_read_b64_tr_b16 v[202:203], v22 offset:10240
  ds_read_b64_tr_b16 v[204:205], v23 offset:8192
  v_mfma_f32_16x16x32_bf16 v[124:127], v[172:175], v[36:39], v[124:127]
  buffer_load_dwordx4 v[88:91], off, s[36:39], s51 offset:1024
  v_mfma_f32_16x16x32_bf16 v[120:123], v[172:175], v[32:35], v[120:123]
  ds_read_b64_tr_b16 v[206:207], v23 offset:10240
  s_waitcnt vmcnt(11) lgkmcnt(8)
  v_mfma_f32_16x16x32_bf16 v[96:99], v[176:179], v[40:43], v[96:99]
  ds_read_b64_tr_b16 v[208:209], v20 offset:12288
  v_mfma_f32_16x16x32_bf16 v[100:103], v[176:179], v[44:47], v[100:103]
  buffer_load_dwordx4 v[92:95], off, s[64:67], s51 offset:1024
  v_mfma_f32_16x16x32_bf16 v[108:111], v[180:183], v[44:47], v[108:111]
  ds_read_b64_tr_b16 v[210:211], v20 offset:14336
  ds_read_b64_tr_b16 v[212:213], v21 offset:12288
  v_mfma_f32_16x16x32_bf16 v[104:107], v[180:183], v[40:43], v[104:107]
  ds_read_b64_tr_b16 v[214:215], v21 offset:14336
  v_mfma_f32_16x16x32_bf16 v[112:115], v[184:187], v[40:43], v[112:115]
  ds_read_b64_tr_b16 v[216:217], v22 offset:12288
  v_mfma_f32_16x16x32_bf16 v[116:119], v[184:187], v[44:47], v[116:119]
  ds_read_b64_tr_b16 v[218:219], v22 offset:14336
  v_readlane_b32 s48, v15, 12
  v_mfma_f32_16x16x32_bf16 v[124:127], v[188:191], v[44:47], v[124:127]
  ds_read_b64_tr_b16 v[220:221], v23 offset:12288
  v_mfma_f32_16x16x32_bf16 v[120:123], v[188:191], v[40:43], v[120:123]
  ds_read_b64_tr_b16 v[222:223], v23 offset:14336
  s_waitcnt vmcnt(10) lgkmcnt(8)
  v_mfma_f32_16x16x32_bf16 v[96:99], v[192:195], v[48:51], v[96:99]
  buffer_load_dwordx4 v[32:35], off, s[36:39], s48 offset:0
  v_mfma_f32_16x16x32_bf16 v[100:103], v[192:195], v[52:55], v[100:103]
  ds_read_b64_tr_b16 v[160:161], v20 offset:16384
  ds_read_b64_tr_b16 v[162:163], v20 offset:18432
  v_mfma_f32_16x16x32_bf16 v[108:111], v[196:199], v[52:55], v[108:111]
  ds_read_b64_tr_b16 v[164:165], v21 offset:16384
  v_mfma_f32_16x16x32_bf16 v[104:107], v[196:199], v[48:51], v[104:107]
  buffer_load_dwordx4 v[36:39], off, s[64:67], s48 offset:0
  v_mfma_f32_16x16x32_bf16 v[112:115], v[200:203], v[48:51], v[112:115]
  ds_read_b64_tr_b16 v[166:167], v21 offset:18432
  ds_read_b64_tr_b16 v[168:169], v22 offset:16384
  v_mfma_f32_16x16x32_bf16 v[116:119], v[200:203], v[52:55], v[116:119]
  ds_read_b64_tr_b16 v[170:171], v22 offset:18432
  ds_read_b64_tr_b16 v[172:173], v23 offset:16384
  v_mfma_f32_16x16x32_bf16 v[124:127], v[204:207], v[52:55], v[124:127]
  buffer_load_dwordx4 v[40:43], off, s[36:39], s48 offset:1024
  v_mfma_f32_16x16x32_bf16 v[120:123], v[204:207], v[48:51], v[120:123]
  ds_read_b64_tr_b16 v[174:175], v23 offset:18432
  s_waitcnt vmcnt(11) lgkmcnt(8)
  v_mfma_f32_16x16x32_bf16 v[96:99], v[208:211], v[56:59], v[96:99]
  ds_read_b64_tr_b16 v[176:177], v20 offset:20480
  v_mfma_f32_16x16x32_bf16 v[100:103], v[208:211], v[60:63], v[100:103]
  buffer_load_dwordx4 v[44:47], off, s[64:67], s48 offset:1024
  v_mfma_f32_16x16x32_bf16 v[108:111], v[212:215], v[60:63], v[108:111]
  ds_read_b64_tr_b16 v[178:179], v20 offset:22528
  ds_read_b64_tr_b16 v[180:181], v21 offset:20480
  v_mfma_f32_16x16x32_bf16 v[104:107], v[212:215], v[56:59], v[104:107]
  ds_read_b64_tr_b16 v[182:183], v21 offset:22528
  v_mfma_f32_16x16x32_bf16 v[112:115], v[216:219], v[56:59], v[112:115]
  ds_read_b64_tr_b16 v[184:185], v22 offset:20480
  v_mfma_f32_16x16x32_bf16 v[116:119], v[216:219], v[60:63], v[116:119]
  ds_read_b64_tr_b16 v[186:187], v22 offset:22528
  v_readlane_b32 s49, v15, 13
  v_mfma_f32_16x16x32_bf16 v[124:127], v[220:223], v[60:63], v[124:127]
  ds_read_b64_tr_b16 v[188:189], v23 offset:20480
  v_mfma_f32_16x16x32_bf16 v[120:123], v[220:223], v[56:59], v[120:123]
  ds_read_b64_tr_b16 v[190:191], v23 offset:22528
  s_waitcnt vmcnt(10) lgkmcnt(8)
  v_mfma_f32_16x16x32_bf16 v[96:99], v[160:163], v[64:67], v[96:99]
  buffer_load_dwordx4 v[48:51], off, s[36:39], s49 offset:0
  v_mfma_f32_16x16x32_bf16 v[100:103], v[160:163], v[68:71], v[100:103]
  ds_read_b64_tr_b16 v[192:193], v20 offset:24576
  ds_read_b64_tr_b16 v[194:195], v20 offset:26624
  v_mfma_f32_16x16x32_bf16 v[108:111], v[164:167], v[68:71], v[108:111]
  ds_read_b64_tr_b16 v[196:197], v21 offset:24576
  v_mfma_f32_16x16x32_bf16 v[104:107], v[164:167], v[64:67], v[104:107]
  buffer_load_dwordx4 v[52:55], off, s[64:67], s49 offset:0
  v_mfma_f32_16x16x32_bf16 v[112:115], v[168:171], v[64:67], v[112:115]
  ds_read_b64_tr_b16 v[198:199], v21 offset:26624
  ds_read_b64_tr_b16 v[200:201], v22 offset:24576
  v_mfma_f32_16x16x32_bf16 v[116:119], v[168:171], v[68:71], v[116:119]
  ds_read_b64_tr_b16 v[202:203], v22 offset:26624
  ds_read_b64_tr_b16 v[204:205], v23 offset:24576
  v_mfma_f32_16x16x32_bf16 v[124:127], v[172:175], v[68:71], v[124:127]
  buffer_load_dwordx4 v[56:59], off, s[36:39], s49 offset:1024
  v_mfma_f32_16x16x32_bf16 v[120:123], v[172:175], v[64:67], v[120:123]
  ds_read_b64_tr_b16 v[206:207], v23 offset:26624
  s_waitcnt vmcnt(11) lgkmcnt(8)
  s_barrier
  v_mfma_f32_16x16x32_bf16 v[96:99], v[176:179], v[72:75], v[96:99]
  ds_read_b64_tr_b16 v[208:209], v20 offset:28672
  v_mfma_f32_16x16x32_bf16 v[100:103], v[176:179], v[76:79], v[100:103]
  buffer_load_dwordx4 v[60:63], off, s[64:67], s49 offset:1024
  v_mfma_f32_16x16x32_bf16 v[108:111], v[180:183], v[76:79], v[108:111]
  ds_read_b64_tr_b16 v[210:211], v20 offset:30720
  ds_read_b64_tr_b16 v[212:213], v21 offset:28672
  v_mfma_f32_16x16x32_bf16 v[104:107], v[180:183], v[72:75], v[104:107]
  ds_read_b64_tr_b16 v[214:215], v21 offset:30720
  v_mfma_f32_16x16x32_bf16 v[112:115], v[184:187], v[72:75], v[112:115]
  ds_read_b64_tr_b16 v[216:217], v22 offset:28672
  v_mfma_f32_16x16x32_bf16 v[116:119], v[184:187], v[76:79], v[116:119]
  ds_read_b64_tr_b16 v[218:219], v22 offset:30720
  v_readlane_b32 s50, v15, 14
  v_mfma_f32_16x16x32_bf16 v[124:127], v[188:191], v[76:79], v[124:127]
  ds_read_b64_tr_b16 v[220:221], v23 offset:28672
  v_mfma_f32_16x16x32_bf16 v[120:123], v[188:191], v[72:75], v[120:123]
  ds_read_b64_tr_b16 v[222:223], v23 offset:30720
  s_waitcnt vmcnt(10) lgkmcnt(8)
  v_mfma_f32_16x16x32_bf16 v[96:99], v[192:195], v[80:83], v[96:99]
  buffer_load_dwordx4 v[64:67], off, s[36:39], s50 offset:0
  v_mfma_f32_16x16x32_bf16 v[100:103], v[192:195], v[84:87], v[100:103]
  ds_read_b64_tr_b16 v[160:161], v20 offset:36864
  ds_read_b64_tr_b16 v[162:163], v20 offset:38912
  v_mfma_f32_16x16x32_bf16 v[108:111], v[196:199], v[84:87], v[108:111]
  ds_read_b64_tr_b16 v[164:165], v21 offset:36864
  v_mfma_f32_16x16x32_bf16 v[104:107], v[196:199], v[80:83], v[104:107]
  buffer_load_dwordx4 v[68:71], off, s[64:67], s50 offset:0
  v_mfma_f32_16x16x32_bf16 v[112:115], v[200:203], v[80:83], v[112:115]
  ds_read_b64_tr_b16 v[166:167], v21 offset:38912
  ds_read_b64_tr_b16 v[168:169], v22 offset:36864
  v_mfma_f32_16x16x32_bf16 v[116:119], v[200:203], v[84:87], v[116:119]
  ds_read_b64_tr_b16 v[170:171], v22 offset:38912
  ds_read_b64_tr_b16 v[172:173], v23 offset:36864
  v_mfma_f32_16x16x32_bf16 v[124:127], v[204:207], v[84:87], v[124:127]
  buffer_load_dwordx4 v[72:75], off, s[36:39], s50 offset:1024
  v_mfma_f32_16x16x32_bf16 v[120:123], v[204:207], v[80:83], v[120:123]
  ds_read_b64_tr_b16 v[174:175], v23 offset:38912
  s_waitcnt vmcnt(11) lgkmcnt(8)
  v_mfma_f32_16x16x32_bf16 v[96:99], v[208:211], v[88:91], v[96:99]
  ds_read_b64_tr_b16 v[176:177], v20 offset:40960
  v_mfma_f32_16x16x32_bf16 v[100:103], v[208:211], v[92:95], v[100:103]
  buffer_load_dwordx4 v[76:79], off, s[64:67], s50 offset:1024
  v_mfma_f32_16x16x32_bf16 v[108:111], v[212:215], v[92:95], v[108:111]
  ds_read_b64_tr_b16 v[178:179], v20 offset:43008
  ds_read_b64_tr_b16 v[180:181], v21 offset:40960
  v_mfma_f32_16x16x32_bf16 v[104:107], v[212:215], v[88:91], v[104:107]
  ds_read_b64_tr_b16 v[182:183], v21 offset:43008
  v_mfma_f32_16x16x32_bf16 v[112:115], v[216:219], v[88:91], v[112:115]
  ds_read_b64_tr_b16 v[184:185], v22 offset:40960
  v_mfma_f32_16x16x32_bf16 v[116:119], v[216:219], v[92:95], v[116:119]
  ds_read_b64_tr_b16 v[186:187], v22 offset:43008
  v_readlane_b32 s51, v15, 15
  v_mfma_f32_16x16x32_bf16 v[124:127], v[220:223], v[92:95], v[124:127]
  ds_read_b64_tr_b16 v[188:189], v23 offset:40960
  v_mfma_f32_16x16x32_bf16 v[120:123], v[220:223], v[88:91], v[120:123]
  ds_read_b64_tr_b16 v[190:191], v23 offset:43008
  s_waitcnt vmcnt(10) lgkmcnt(8)
  v_mfma_f32_16x16x32_bf16 v[96:99], v[160:163], v[32:35], v[96:99]
  buffer_load_dwordx4 v[80:83], off, s[36:39], s51 offset:0
  v_mfma_f32_16x16x32_bf16 v[100:103], v[160:163], v[36:39], v[100:103]
  ds_read_b64_tr_b16 v[192:193], v20 offset:45056
  ds_read_b64_tr_b16 v[194:195], v20 offset:47104
  v_mfma_f32_16x16x32_bf16 v[108:111], v[164:167], v[36:39], v[108:111]
  ds_read_b64_tr_b16 v[196:197], v21 offset:45056
  v_mfma_f32_16x16x32_bf16 v[104:107], v[164:167], v[32:35], v[104:107]
  buffer_load_dwordx4 v[84:87], off, s[64:67], s51 offset:0
  v_mfma_f32_16x16x32_bf16 v[112:115], v[168:171], v[32:35], v[112:115]
  ds_read_b64_tr_b16 v[198:199], v21 offset:47104
  ds_read_b64_tr_b16 v[200:201], v22 offset:45056
  v_mfma_f32_16x16x32_bf16 v[116:119], v[168:171], v[36:39], v[116:119]
  ds_read_b64_tr_b16 v[202:203], v22 offset:47104
  ds_read_b64_tr_b16 v[204:205], v23 offset:45056
  v_mfma_f32_16x16x32_bf16 v[124:127], v[172:175], v[36:39], v[124:127]
  buffer_load_dwordx4 v[88:91], off, s[36:39], s51 offset:1024
  v_mfma_f32_16x16x32_bf16 v[120:123], v[172:175], v[32:35], v[120:123]
  ds_read_b64_tr_b16 v[206:207], v23 offset:47104
  s_waitcnt vmcnt(11) lgkmcnt(8)
  v_mfma_f32_16x16x32_bf16 v[96:99], v[176:179], v[40:43], v[96:99]
  ds_read_b64_tr_b16 v[208:209], v20 offset:49152
  v_mfma_f32_16x16x32_bf16 v[100:103], v[176:179], v[44:47], v[100:103]
  buffer_load_dwordx4 v[92:95], off, s[64:67], s51 offset:1024
  v_mfma_f32_16x16x32_bf16 v[108:111], v[180:183], v[44:47], v[108:111]
  ds_read_b64_tr_b16 v[210:211], v20 offset:51200
  ds_read_b64_tr_b16 v[212:213], v21 offset:49152
  v_mfma_f32_16x16x32_bf16 v[104:107], v[180:183], v[40:43], v[104:107]
  ds_read_b64_tr_b16 v[214:215], v21 offset:51200
  v_mfma_f32_16x16x32_bf16 v[112:115], v[184:187], v[40:43], v[112:115]
  ds_read_b64_tr_b16 v[216:217], v22 offset:49152
  v_mfma_f32_16x16x32_bf16 v[116:119], v[184:187], v[44:47], v[116:119]
  ds_read_b64_tr_b16 v[218:219], v22 offset:51200
  v_mfma_f32_16x16x32_bf16 v[124:127], v[188:191], v[44:47], v[124:127]
  ds_read_b64_tr_b16 v[220:221], v23 offset:49152
  v_mfma_f32_16x16x32_bf16 v[120:123], v[188:191], v[40:43], v[120:123]
  ds_read_b64_tr_b16 v[222:223], v23 offset:51200
  s_waitcnt vmcnt(10) lgkmcnt(8)
  v_mfma_f32_16x16x32_bf16 v[96:99], v[192:195], v[48:51], v[96:99]
  ds_read_b64_tr_b16 v[160:161], v20 offset:53248
  v_mfma_f32_16x16x32_bf16 v[100:103], v[192:195], v[52:55], v[100:103]
  ds_read_b64_tr_b16 v[162:163], v20 offset:55296
  v_mfma_f32_16x16x32_bf16 v[108:111], v[196:199], v[52:55], v[108:111]
  ds_read_b64_tr_b16 v[164:165], v21 offset:53248
  v_mfma_f32_16x16x32_bf16 v[104:107], v[196:199], v[48:51], v[104:107]
  ds_read_b64_tr_b16 v[166:167], v21 offset:55296
  v_mfma_f32_16x16x32_bf16 v[112:115], v[200:203], v[48:51], v[112:115]
  ds_read_b64_tr_b16 v[168:169], v22 offset:53248
  v_mfma_f32_16x16x32_bf16 v[116:119], v[200:203], v[52:55], v[116:119]
  ds_read_b64_tr_b16 v[170:171], v22 offset:55296
  v_mfma_f32_16x16x32_bf16 v[124:127], v[204:207], v[52:55], v[124:127]
  ds_read_b64_tr_b16 v[172:173], v23 offset:53248
  v_mfma_f32_16x16x32_bf16 v[120:123], v[204:207], v[48:51], v[120:123]
  ds_read_b64_tr_b16 v[174:175], v23 offset:55296
  s_waitcnt vmcnt(8) lgkmcnt(8)
  v_mfma_f32_16x16x32_bf16 v[96:99], v[208:211], v[56:59], v[96:99]
  ds_read_b64_tr_b16 v[176:177], v20 offset:57344
  v_mfma_f32_16x16x32_bf16 v[100:103], v[208:211], v[60:63], v[100:103]
  ds_read_b64_tr_b16 v[178:179], v20 offset:59392
  v_mfma_f32_16x16x32_bf16 v[108:111], v[212:215], v[60:63], v[108:111]
  ds_read_b64_tr_b16 v[180:181], v21 offset:57344
  v_mfma_f32_16x16x32_bf16 v[104:107], v[212:215], v[56:59], v[104:107]
  ds_read_b64_tr_b16 v[182:183], v21 offset:59392
  v_mfma_f32_16x16x32_bf16 v[112:115], v[216:219], v[56:59], v[112:115]
  ds_read_b64_tr_b16 v[184:185], v22 offset:57344
  v_mfma_f32_16x16x32_bf16 v[116:119], v[216:219], v[60:63], v[116:119]
  ds_read_b64_tr_b16 v[186:187], v22 offset:59392
  v_mfma_f32_16x16x32_bf16 v[124:127], v[220:223], v[60:63], v[124:127]
  ds_read_b64_tr_b16 v[188:189], v23 offset:57344
  v_mfma_f32_16x16x32_bf16 v[120:123], v[220:223], v[56:59], v[120:123]
  ds_read_b64_tr_b16 v[190:191], v23 offset:59392
  s_waitcnt vmcnt(6) lgkmcnt(8)
  v_mfma_f32_16x16x32_bf16 v[96:99], v[160:163], v[64:67], v[96:99]
  ds_read_b64_tr_b16 v[192:193], v26 offset:0
  v_mfma_f32_16x16x32_bf16 v[100:103], v[160:163], v[68:71], v[100:103]
  ds_read_b64_tr_b16 v[194:195], v26 offset:2048
  v_mfma_f32_16x16x32_bf16 v[108:111], v[164:167], v[68:71], v[108:111]
  ds_read_b64_tr_b16 v[196:197], v27 offset:0
  v_mfma_f32_16x16x32_bf16 v[104:107], v[164:167], v[64:67], v[104:107]
  ds_read_b64_tr_b16 v[198:199], v27 offset:2048
  v_mfma_f32_16x16x32_bf16 v[112:115], v[168:171], v[64:67], v[112:115]
  ds_read_b64_tr_b16 v[200:201], v28 offset:0
  v_mfma_f32_16x16x32_bf16 v[116:119], v[168:171], v[68:71], v[116:119]
  ds_read_b64_tr_b16 v[202:203], v28 offset:2048
  v_mfma_f32_16x16x32_bf16 v[124:127], v[172:175], v[68:71], v[124:127]
  ds_read_b64_tr_b16 v[204:205], v29 offset:0
  v_mfma_f32_16x16x32_bf16 v[120:123], v[172:175], v[64:67], v[120:123]
  ds_read_b64_tr_b16 v[206:207], v29 offset:2048
  s_waitcnt vmcnt(4) lgkmcnt(8)
  v_mfma_f32_16x16x32_bf16 v[96:99], v[176:179], v[72:75], v[96:99]
  ds_read_b64_tr_b16 v[208:209], v26 offset:4096
  v_mfma_f32_16x16x32_bf16 v[100:103], v[176:179], v[76:79], v[100:103]
  ds_read_b64_tr_b16 v[210:211], v26 offset:6144
  v_mfma_f32_16x16x32_bf16 v[108:111], v[180:183], v[76:79], v[108:111]
  ds_read_b64_tr_b16 v[212:213], v27 offset:4096
  v_mfma_f32_16x16x32_bf16 v[104:107], v[180:183], v[72:75], v[104:107]
  ds_read_b64_tr_b16 v[214:215], v27 offset:6144
  v_mfma_f32_16x16x32_bf16 v[112:115], v[184:187], v[72:75], v[112:115]
  ds_read_b64_tr_b16 v[216:217], v28 offset:4096
  v_mfma_f32_16x16x32_bf16 v[116:119], v[184:187], v[76:79], v[116:119]
  ds_read_b64_tr_b16 v[218:219], v28 offset:6144
  v_mfma_f32_16x16x32_bf16 v[124:127], v[188:191], v[76:79], v[124:127]
  ds_read_b64_tr_b16 v[220:221], v29 offset:4096
  v_mfma_f32_16x16x32_bf16 v[120:123], v[188:191], v[72:75], v[120:123]
  ds_read_b64_tr_b16 v[222:223], v29 offset:6144
  s_waitcnt vmcnt(2) lgkmcnt(8)
  v_mfma_f32_16x16x32_bf16 v[96:99], v[192:195], v[80:83], v[96:99]
  v_mov_b32 v20, 0
  v_mov_b32 v21, 0
  v_mfma_f32_16x16x32_bf16 v[100:103], v[192:195], v[84:87], v[100:103]
  v_mov_b32 v22, 0
  v_mov_b32 v23, 0
  v_mfma_f32_16x16x32_bf16 v[108:111], v[196:199], v[84:87], v[108:111]
  v_mfma_f32_16x16x32_bf16 v[104:107], v[196:199], v[80:83], v[104:107]
  v_mfma_f32_16x16x32_bf16 v[112:115], v[200:203], v[80:83], v[112:115]
  v_mfma_f32_16x16x32_bf16 v[116:119], v[200:203], v[84:87], v[116:119]
  v_mfma_f32_16x16x32_bf16 v[124:127], v[204:207], v[84:87], v[124:127]
  v_mfma_f32_16x16x32_bf16 v[120:123], v[204:207], v[80:83], v[120:123]
  s_waitcnt vmcnt(0) lgkmcnt(0)
  v_mfma_f32_16x16x32_bf16 v[96:99], v[208:211], v[88:91], v[96:99]
  v_mfma_f32_16x16x32_bf16 v[100:103], v[208:211], v[92:95], v[100:103]
  v_mfma_f32_16x16x32_bf16 v[108:111], v[212:215], v[92:95], v[108:111]
  v_mfma_f32_16x16x32_bf16 v[104:107], v[212:215], v[88:91], v[104:107]
  v_mfma_f32_16x16x32_bf16 v[112:115], v[216:219], v[88:91], v[112:115]
  v_mfma_f32_16x16x32_bf16 v[116:119], v[216:219], v[92:95], v[116:119]
  v_mfma_f32_16x16x32_bf16 v[124:127], v[220:223], v[92:95], v[124:127]
  v_mfma_f32_16x16x32_bf16 v[120:123], v[220:223], v[88:91], v[120:123]
  s_mov_b32 s3, 32768
  s_mov_b32 s10, 0x3f803f80
  s_nop 4
  v_cvt_pk_bf16_f32 v240, v96, v97
  v_cvt_pk_bf16_f32 v241, v98, v99
  v_cvt_pk_bf16_f32 v242, v104, v105
  v_cvt_pk_bf16_f32 v243, v106, v107
  buffer_store_dwordx4 v[240:243], v12, s[44:47], 0 offen offset:0 sc1
  ds_write_b128 v19, v[240:243] offset:0
  v_cvt_pk_bf16_f32 v244, v112, v113
  v_cvt_pk_bf16_f32 v245, v114, v115
  v_cvt_pk_bf16_f32 v246, v120, v121
  v_cvt_pk_bf16_f32 v247, v122, v123
  buffer_store_dwordx4 v[244:247], v12, s[44:47], 0 offen offset:1024 sc1
  ds_write_b128 v19, v[244:247] offset:1024
  v_cvt_pk_bf16_f32 v248, v100, v101
  v_cvt_pk_bf16_f32 v249, v102, v103
  v_cvt_pk_bf16_f32 v250, v108, v109
  v_cvt_pk_bf16_f32 v251, v110, v111
  buffer_store_dwordx4 v[248:251], v12, s[44:47], s3 offen offset:0 sc1
  ds_write_b128 v19, v[248:251] offset:2048
  v_cvt_pk_bf16_f32 v252, v116, v117
  v_cvt_pk_bf16_f32 v253, v118, v119
  v_cvt_pk_bf16_f32 v254, v124, v125
  v_cvt_pk_bf16_f32 v255, v126, v127
  buffer_store_dwordx4 v[252:255], v12, s[44:47], s3 offen offset:1024 sc1
  ds_write_b128 v19, v[252:255] offset:3072
  v_dot2_f32_bf16 v20, v240, s10, v20
  v_dot2_f32_bf16 v22, v240, v240, v22
  v_dot2_f32_bf16 v20, v241, s10, v20
  v_dot2_f32_bf16 v22, v241, v241, v22
  v_dot2_f32_bf16 v20, v242, s10, v20
  v_dot2_f32_bf16 v22, v242, v242, v22
  v_dot2_f32_bf16 v20, v243, s10, v20
  v_dot2_f32_bf16 v22, v243, v243, v22
  v_dot2_f32_bf16 v20, v244, s10, v20
  v_dot2_f32_bf16 v22, v244, v244, v22
  v_dot2_f32_bf16 v20, v245, s10, v20
  v_dot2_f32_bf16 v22, v245, v245, v22
  v_dot2_f32_bf16 v20, v246, s10, v20
  v_dot2_f32_bf16 v22, v246, v246, v22
  v_dot2_f32_bf16 v20, v247, s10, v20
  v_dot2_f32_bf16 v22, v247, v247, v22
  v_dot2_f32_bf16 v21, v248, s10, v21
  v_dot2_f32_bf16 v23, v248, v248, v23
  v_dot2_f32_bf16 v21, v249, s10, v21
  v_dot2_f32_bf16 v23, v249, v249, v23
  v_dot2_f32_bf16 v21, v250, s10, v21
  v_dot2_f32_bf16 v23, v250, v250, v23
  v_dot2_f32_bf16 v21, v251, s10, v21
  v_dot2_f32_bf16 v23, v251, v251, v23
  v_dot2_f32_bf16 v21, v252, s10, v21
  v_dot2_f32_bf16 v23, v252, v252, v23
  v_dot2_f32_bf16 v21, v253, s10, v21
  v_dot2_f32_bf16 v23, v253, v253, v23
  v_dot2_f32_bf16 v21, v254, s10, v21
  v_dot2_f32_bf16 v23, v254, v254, v23
  v_dot2_f32_bf16 v21, v255, s10, v21
  v_dot2_f32_bf16 v23, v255, v255, v23
  s_nop 2
  v_permlane32_swap_b32 v20, v21
  v_permlane32_swap_b32 v22, v23
  v_add_f32 v20, v20, v21
  v_add_f32 v22, v22, v23
  s_nop 1
  v_permlane16_swap_b32 v20, v22
  v_add_f32 v20, v20, v22
  buffer_store_dword v20, v18, s[56:59], 0 offen sc1
  s_waitcnt vmcnt(0) lgkmcnt(0)
  s_barrier
  s_add_u32 s97, s97, 1
  s_branch L_w1_body
L_wo_c1:
L_w1_c0:
L_w1_body:
  s_cmp_ge_u32 s2, 256
  s_cbranch_scc1 L_w1_end
  v_lshrrev_b32 v2, 6, v0
  v_and_b32 v1, 63, v0
  v_readfirstlane_b32 s70, v2
  s_and_b32 s3, s2, 7
  s_lshr_b32 s99, s2, 3
  s_and_b32 s5, s3, 3
  s_lshl_b32 s5, s5, 2
  s_and_b32 s6, s99, 3
  s_add_u32 s68, s5, s6
  s_lshr_b32 s5, s3, 2
  s_lshl_b32 s5, s5, 3
  s_lshr_b32 s6, s99, 2
  s_add_u32 s69, s5, s6
  s_cmp_lt_u32 s70, 4
  s_cbranch_scc1 L_w1_compute
L_w1_loader:
  s_add_u32 s8, s70, s69
  s_and_b32 s8, s8, 3
  s_add_u32 s9, s70, s68
  s_and_b32 s9, s9, 3
  s_lshl_b32 s76, s8, 12
  s_lshl_b32 s77, s9, 11
  s_add_u32 s77, s77, 16384
  s_lshl_b32 s11, s68, 7
  v_and_b32 v10, 7, v1
  s_lshr_b32 s10, s76, 11
  s_lshl_b32 s3, s68, 3
  s_add_u32 s10, s10, s3
  s_mul_i32 s10, s10, 32768
  v_lshl_add_u32 v4, v1, 4, s10
  v_add_u32 v5, 32768, v4
  v_lshrrev_b32 v3, 3, v1
  s_lshl_b32 s10, s9, 4
  v_add_u32 v3, s10, v3
  v_mul_u32_u24 v3, 7168, v3
  v_lshrrev_b32 v2, 3, v1
  v_and_b32 v2, 6, v2
  v_xor_b32 v2, v2, v10
  s_mul_i32 s10, s69, 128
  v_add_u32 v3, s10, v3
  v_lshl_add_u32 v8, v2, 4, v3
  v_add_u32 v3, 57344, v3
  v_lshl_add_u32 v9, v2, 4, v3
  v_lshrrev_b32 v3, 2, v1
  s_lshl_b32 s10, s9, 4
  v_add_u32 v3, s10, v3
  v_mul_u32_u24 v3, 7168, v3
  v_bfe_u32 v2, v1, 4, 1
  v_xor_b32 v2, v2, v1
  v_and_b32 v2, 3, v2
  s_lshl_b32 s10, s69, 6
  s_add_u32 s10, s10, 2048
  v_add_u32 v3, s10, v3
  v_lshl_add_u32 v28, v2, 4, v3
  s_lshl_b32 s78, s69, 7
  s_add_u32 s78, s78, 3072
  s_mov_b32 s75, 0
  s_add_u32 s100, s68, s69
  s_mov_b32 s101, -1
  s_add_u32 s3, s68, s69
  s_and_b32 s3, s3, 3
  s_mov_b32 s100, 0x68532410
  s_mov_b32 s101, 0xfedbac97
  s_cmp_eq_u32 s3, 1
  s_cselect_b32 s100, 0x96435210, s100
  s_cselect_b32 s101, 0xfecbda87, s101
  s_cmp_eq_u32 s3, 2
  s_cselect_b32 s100, 0x75463210, s100
  s_cselect_b32 s101, 0xfdceb98a, s101
  s_cmp_eq_u32 s3, 3
  s_cselect_b32 s100, 0x65743210, s100
  s_cselect_b32 s101, 0xedfca9b8, s101
  s_waitcnt lgkmcnt(0)
  s_cmp_lg_u32 s96, 0
  s_cbranch_scc1 L_pfc3_skip
  s_getpc_b64 s[4:5]
L_pfc3:
  s_lshl_b32 s3, s99, 2
  s_add_u32 s3, s3, s70
  s_sub_u32 s3, s3, 4
  s_mul_i32 s3, s3, 192
  s_min_u32 s3, s3, L_w2_c1-L_w2_c0-192
  s_add_i32 s3, s3, L_w2_c0-L_pfc3
  s_ashr_i32 s6, s3, 31
  s_add_u32 s4, s4, s3
  s_addc_u32 s5, s5, s6
  s_load_dword s84, s[4:5], 0
  s_load_dword s84, s[4:5], 64
  s_load_dword s84, s[4:5], 128
L_pfc3_skip:
  s_add_u32 s36, s34, 4194304
  s_addc_u32 s37, s35, 0
  s_and_b32 s37, s37, 0xffff
  s_mov_b32 s38, 4194304
  s_mov_b32 s39, 0x00020000
  s_mov_b32 s40, s24
  s_and_b32 s41, s25, 0xffff
  s_mov_b32 s42, 7340032
  s_mov_b32 s43, 0x00020000
  s_add_u32 s56, s34, 24117248
  s_addc_u32 s57, s35, 0
  s_and_b32 s57, s57, 0xffff
  s_mov_b32 s58, 262144
  s_mov_b32 s59, 0x00020000
  s_add_u32 s64, s22, 24641536
  s_addc_u32 s65, s23, 0
  s_and_b32 s65, s65, 0xffff
  s_mov_b32 s66, 262144
  s_mov_b32 s67, 0x00020000
  s_mov_b32 s52, s26
  s_and_b32 s53, s27, 0xffff
  s_mov_b32 s54, 7168
  s_mov_b32 s55, 0x00020000
  s_and_b32 s3, s70, 3
  s_lshl2_add_u32 s4, s68, s3
  s_lshl_b32 s4, s4, 8
  v_lshrrev_b32 v2, 4, v1
  v_and_b32 v3, 15, v1
  v_lshl_add_u32 v3, v3, 4, s4
  v_lshl_add_u32 v18, v2, 14, v3
  s_lshl_b32 s4, s69, 7
  s_lshl_b32 s5, s70, 6
  s_add_u32 s4, s4, s5
  s_add_u32 s4, s4, 1216
  s_lshl_b32 s5, s69, 6
  s_cmp_eq_u32 s70, 4
  s_cselect_b32 s4, s5, s4
  s_lshr_b32 s5, s5, 1
  s_add_u32 s5, s5, 1024
  s_cmp_eq_u32 s70, 7
  s_cselect_b32 s4, s5, s4
  v_and_b32 v3, 15, v1
  v_lshl_add_u32 v3, v3, 2, s4
  v_lshrrev_b32 v2, 4, v1
  v_add_lshl_u32 v23, v3, v2, 1
  v_lshlrev_b32 v3, 2, v3
  v_lshl_add_u32 v22, v2, 14, v3
  s_mov_b32 s60, s28
  s_and_b32 s61, s29, 0xffff
  s_mov_b32 s62, 7340032
  s_mov_b32 s63, 0x00020000
  s_cmp_eq_u32 s96, 0
  s_cselect_b32 s62, s62, 0
  s_and_b32 s3, s70, 3
  s_lshl_b32 s4, s2, 2
  s_add_u32 s3, s3, s4
  s_mul_i32 s98, s3, 3584
  s_add_u32 s98, s98, 3670016
  s_buffer_load_dword s84, s[60:63], s98 offset:0
  s_buffer_load_dword s84, s[60:63], s98 offset:64
  s_buffer_load_dword s84, s[60:63], s98 offset:128
  s_buffer_load_dword s84, s[60:63], s98 offset:192
  s_lshr_b32 s3, s69, 3
  s_and_b32 s73, s69, 7
  s_lshl1_add_u32 s91, s73, s3
  s_mul_i32 s74, s91, 458752
  s_lshl_b32 s73, s91, 11
  s_mov_b32 s88, s73
  s_add_u32 m0, s77, 0
  s_add_u32 s4, s74, 0
  buffer_load_dwordx4 v8, s[40:43], s4 offen lds
  s_add_u32 m0, s77, 1024
  s_nop 0
  buffer_load_dwordx4 v9, s[40:43], s4 offen lds
  s_add_u32 m0, s77, 8192
  s_add_u32 s4, s74, s78
  buffer_load_dwordx4 v8, s[40:43], s4 offen lds
  s_add_u32 m0, s77, 9216
  s_nop 0
  buffer_load_dwordx4 v9, s[40:43], s4 offen lds
  s_add_u32 m0, s77, 16384
  s_add_u32 s4, s4, 128
  buffer_load_dwordx4 v8, s[40:43], s4 offen lds
  s_add_u32 m0, s77, 17408
  s_nop 0
  buffer_load_dwordx4 v9, s[40:43], s4 offen lds
  s_add_u32 m0, s77, 24576
  s_nop 0
  buffer_load_dwordx4 v28, s[40:43], s74 offen lds
  s_and_b32 s73, s100, 15
  s_cmp_eq_u32 s73, s91
  s_cselect_b32 s74, 4, 0
  s_lshr_b64 s[100:101], s[100:101], s74
  s_and_b32 s73, s100, 15
  s_lshr_b64 s[100:101], s[100:101], 4
  s_mul_i32 s74, s73, 458752
  s_lshl_b32 s73, s73, 11
  s_add_u32 s3, s96, s70
  s_cmp_lg_u32 s3, 4
  s_cbranch_scc1 L_w1_chkNone
  s_add_u32 s44, s22, 41943040
  s_addc_u32 s45, s23, 0
  s_and_b32 s45, s45, 0xffff
  s_mov_b32 s46, 524288
  s_mov_b32 s47, 0x00020000
  v_lshrrev_b32 v2, 2, v1
  v_and_b32 v3, 3, v1
  v_lshlrev_b32 v2, 11, v2
  v_lshl_add_u32 v17, v3, 4, v2
  s_and_b32 s3, s69, 15
  s_lshl_b32 s3, s3, 7
  s_mov_b32 s79, 0x100000
L_w1_chkl:
  buffer_load_dwordx4 v[12:15], v17, s[44:47], s3 offen sc1
  s_sub_u32 s79, s79, 1
  s_cbranch_scc1 L_w1_chkNone
  s_waitcnt vmcnt(0)
  v_and_b32 v12, v12, v13
  v_and_b32 v14, v14, v15
  v_and_b32 v12, v12, v14
  v_cmp_ne_u32 vcc, 1, v12
  s_cbranch_vccnz L_w1_chkl
L_w1_chkNone:
  s_mov_b32 s75, 0
  s_add_u32 s44, s22, 41943040
  s_addc_u32 s45, s23, 0
  s_and_b32 s45, s45, 0xffff
  s_mov_b32 s46, 524288
  s_mov_b32 s47, 0x00020000
  s_lshl4_add_u32 s3, s97, s68
  s_and_b32 s4, s69, 15
  s_lshl4_add_u32 s3, s3, s4
  s_lshl_b32 s3, s3, 7
  s_sub_u32 s3, s3, 32768
  v_lshlrev_b32 v11, 7, v1
  v_and_b32 v2, 15, v1
  v_lshlrev_b32 v2, 2, v2
  v_mov_b32 v3, 1
  s_mov_b32 s79, 0x100000
  s_waitcnt vmcnt(0)
  s_cmp_lg_u32 s70, 4
  s_barrier
  s_cbranch_scc1 L_w1_nofl
  s_mov_b32 exec_lo, 0xffff
  s_mov_b32 exec_hi, 0
  buffer_store_dword v3, v11, s[44:47], s87 offen sc1
  s_mov_b64 exec, -1
L_w1_nofl:
  s_mov_b32 s5, s3
  s_mov_b32 s89, s73
  s_add_u32 m0, s77, 49152
  s_add_u32 s4, s74, 0
  buffer_load_dwordx4 v8, s[40:43], s4 offen lds
  s_add_u32 m0, s77, 50176
  s_nop 0
  buffer_load_dwordx4 v9, s[40:43], s4 offen lds
  s_add_u32 m0, s77, 57344
  s_add_u32 s4, s74, s78
  buffer_load_dwordx4 v8, s[40:43], s4 offen lds
  s_add_u32 m0, s77, 58368
  s_nop 0
  buffer_load_dwordx4 v9, s[40:43], s4 offen lds
  s_add_u32 m0, s77, 65536
  s_add_u32 s4, s4, 128
  buffer_load_dwordx4 v8, s[40:43], s4 offen lds
  s_add_u32 m0, s77, 66560
  s_nop 0
  buffer_load_dwordx4 v9, s[40:43], s4 offen lds
  s_add_u32 m0, s77, 73728
  s_nop 0
  buffer_load_dwordx4 v28, s[40:43], s74 offen lds
  s_and_b32 s73, s100, 15
  s_cmp_eq_u32 s73, s91
  s_cselect_b32 s74, 4, 0
  s_lshr_b64 s[100:101], s[100:101], s74
  s_and_b32 s73, s100, 15
  s_lshr_b64 s[100:101], s[100:101], 4
  s_mul_i32 s74, s73, 458752
  s_lshl_b32 s73, s73, 11
  s_mov_b32 s90, s73
  s_add_u32 m0, s77, 98304
  s_add_u32 s4, s74, 0
  buffer_load_dwordx4 v8, s[40:43], s4 offen lds
  s_add_u32 m0, s77, 99328
  s_nop 0
  buffer_load_dwordx4 v9, s[40:43], s4 offen lds
  s_add_u32 m0, s77, 106496
  s_add_u32 s4, s74, s78
  buffer_load_dwordx4 v8, s[40:43], s4 offen lds
  s_add_u32 m0, s77, 107520
  s_nop 0
  buffer_load_dwordx4 v9, s[40:43], s4 offen lds
  s_add_u32 m0, s77, 114688
  s_add_u32 s4, s4, 128
  buffer_load_dwordx4 v8, s[40:43], s4 offen lds
  s_add_u32 m0, s77, 115712
  s_nop 0
  buffer_load_dwordx4 v9, s[40:43], s4 offen lds
  s_add_u32 m0, s77, 122880
  s_nop 0
  buffer_load_dwordx4 v28, s[40:43], s74 offen lds
  s_and_b32 s73, s100, 15
  s_cmp_eq_u32 s73, s91
  s_cselect_b32 s74, 4, 0
  s_lshr_b64 s[100:101], s[100:101], s74
  s_and_b32 s73, s100, 15
  s_lshr_b64 s[100:101], s[100:101], 4
  s_mul_i32 s74, s73, 458752
  s_lshl_b32 s73, s73, 11
  s_mov_b32 s3, s5
  s_cmp_lg_u32 s70, 4
  s_cbranch_scc1 L_w1_dep
L_w1_poll:
  buffer_load_dword v3, v2, s[44:47], s3 offen sc1
  s_sub_u32 s79, s79, 1
  s_cbranch_scc1 L_w1_dep
  s_waitcnt vmcnt(0)
  v_cmp_ne_u32 vcc, 1, v3
  s_cbranch_vccnz L_w1_poll
L_w1_dep:
  s_barrier
  s_add_u32 m0, s76, 49152
  s_nop 0
  buffer_load_dwordx4 v4, s[36:39], s89 offen offset:0 lds
  buffer_load_dwordx4 v4, s[36:39], s89 offen offset:1024 lds
  s_add_u32 m0, s76, 51200
  s_nop 0
  buffer_load_dwordx4 v5, s[36:39], s89 offen offset:0 lds
  buffer_load_dwordx4 v5, s[36:39], s89 offen offset:1024 lds
  s_add_u32 m0, s76, 98304
  s_nop 0
  buffer_load_dwordx4 v4, s[36:39], s90 offen offset:0 lds
  buffer_load_dwordx4 v4, s[36:39], s90 offen offset:1024 lds
  s_add_u32 m0, s76, 100352
  s_nop 0
  buffer_load_dwordx4 v5, s[36:39], s90 offen offset:0 lds
  buffer_load_dwordx4 v5, s[36:39], s90 offen offset:1024 lds
  s_waitcnt vmcnt(4)
  s_barrier
  s_mov_b32 s79, 13
L_w1_ld1:
  s_add_u32 s3, s75, s76
  s_add_u32 m0, s3, 0
  s_nop 0
  buffer_load_dwordx4 v4, s[36:39], s73 offen offset:0 lds
  buffer_load_dwordx4 v4, s[36:39], s73 offen offset:1024 lds
  s_add_u32 m0, s3, 2048
  s_nop 0
  buffer_load_dwordx4 v5, s[36:39], s73 offen offset:0 lds
  buffer_load_dwordx4 v5, s[36:39], s73 offen offset:1024 lds
  s_add_u32 s3, s75, s77
  s_add_u32 m0, s3, 0
  s_add_u32 s4, s74, 0
  buffer_load_dwordx4 v8, s[40:43], s4 offen lds
  s_add_u32 m0, s3, 1024
  s_nop 0
  buffer_load_dwordx4 v9, s[40:43], s4 offen lds
  s_add_u32 m0, s3, 8192
  s_add_u32 s4, s74, s78
  buffer_load_dwordx4 v8, s[40:43], s4 offen lds
  s_add_u32 m0, s3, 9216
  s_nop 0
  buffer_load_dwordx4 v9, s[40:43], s4 offen lds
  s_add_u32 m0, s3, 16384
  s_add_u32 s4, s4, 128
  buffer_load_dwordx4 v8, s[40:43], s4 offen lds
  s_add_u32 m0, s3, 17408
  s_nop 0
  buffer_load_dwordx4 v9, s[40:43], s4 offen lds
  s_add_u32 m0, s3, 24576
  s_nop 0
  buffer_load_dwordx4 v28, s[40:43], s74 offen lds
  s_and_b32 s73, s100, 15
  s_cmp_eq_u32 s73, s91
  s_cselect_b32 s74, 4, 0
  s_lshr_b64 s[100:101], s[100:101], s74
  s_and_b32 s73, s100, 15
  s_lshr_b64 s[100:101], s[100:101], 4
  s_mul_i32 s74, s73, 458752
  s_lshl_b32 s73, s73, 11
  s_add_u32 s75, s75, 49152
  s_cmp_eq_u32 s75, 147456
  s_cselect_b32 s75, 0, s75
  s_buffer_load_dword s84, s[60:63], s98 offset:256
  s_buffer_load_dword s84, s[60:63], s98 offset:320
  s_buffer_load_dword s84, s[60:63], s98 offset:384
  s_buffer_load_dword s84, s[60:63], s98 offset:448
  s_add_u32 s98, s98, 256
  s_waitcnt vmcnt(11)
  s_barrier
  s_sub_u32 s79, s79, 1
  s_cmp_lg_u32 s79, 0
  s_cbranch_scc1 L_w1_ld1
  buffer_load_dwordx4 v[64:67], v22, s[64:67], 0 offen
  s_mov_b32 s3, 65536
  buffer_load_dwordx4 v[68:71], v22, s[64:67], s3 offen
  s_mov_b32 s3, 131072
  buffer_load_dwordx4 v[72:75], v22, s[64:67], s3 offen
  s_mov_b32 s3, 196608
  buffer_load_dwordx4 v[76:79], v22, s[64:67], s3 offen
  buffer_load_ushort v80, v23, s[52:55], 0 offen
  buffer_load_dwordx4 v[32:35], v18, s[56:59], 0 offen
  s_mov_b32 s3, 65536
  buffer_load_dwordx4 v[36:39], v18, s[56:59], s3 offen
  s_mov_b32 s3, 131072
  buffer_load_dwordx4 v[40:43], v18, s[56:59], s3 offen
  s_mov_b32 s3, 196608
  buffer_load_dwordx4 v[44:47], v18, s[56:59], s3 offen
  s_waitcnt vmcnt(9)
  s_barrier
  s_waitcnt vmcnt(0)
  v_pk_add_f32 v[32:33], v[32:33], v[36:37]
  v_pk_add_f32 v[34:35], v[34:35], v[38:39]
  v_pk_add_f32 v[40:41], v[40:41], v[44:45]
  v_pk_add_f32 v[42:43], v[42:43], v[46:47]
  v_pk_add_f32 v[32:33], v[32:33], v[40:41]
  v_pk_add_f32 v[34:35], v[34:35], v[42:43]
  s_nop 1
  v_permlane32_swap_b32 v32, v34
  v_permlane32_swap_b32 v33, v35
  v_pk_add_f32 v[32:33], v[32:33], v[34:35]
  v_mov_b32 v34, v32
  v_mov_b32 v35, v33
  s_nop 0
  v_permlane16_swap_b32 v32, v34
  v_permlane16_swap_b32 v33, v35
  v_pk_add_f32 v[32:33], v[32:33], v[34:35]
  v_mul_f32 v32, 0x3a800000, v32
  v_mul_f32 v33, 0x3a800000, v33
  v_fma_f32 v33, -v32, v32, v33
  v_max_f32 v33, 0, v33
  v_add_f32 v33, 0x3727c5ac, v33
  v_rsq_f32 v33, v33
  s_nop 0
  s_and_b32 s3, s70, 3
  s_lshl_b32 s5, s3, 7
  s_add_u32 s5, s5, 110656
  v_and_b32 v3, 15, v1
  v_lshrrev_b32 v2, 5, v1
  v_lshl_add_u32 v2, v3, 1, v2
  v_lshl_add_u32 v2, v2, 2, s5
  ds_write2_b32 v2, v32, v33 offset0:0 offset1:160
  v_pk_add_f32 v[64:65], v[64:65], v[68:69]
  v_pk_add_f32 v[66:67], v[66:67], v[70:71]
  v_pk_add_f32 v[72:73], v[72:73], v[76:77]
  v_pk_add_f32 v[74:75], v[74:75], v[78:79]
  v_pk_add_f32 v[64:65], v[64:65], v[72:73]
  v_pk_add_f32 v[66:67], v[66:67], v[74:75]
  s_nop 1
  v_permlane32_swap_b32 v64, v66
  v_permlane32_swap_b32 v65, v67
  v_pk_add_f32 v[64:65], v[64:65], v[66:67]
  v_lshlrev_b32 v80, 16, v80
  s_lshl_b32 s5, s3, 8
  s_add_u32 s5, s5, 111872
  v_permlane16_swap_b32 v64, v65
  v_lshrrev_b32 v2, 4, v1
  v_lshl_add_u32 v2, v3, 2, v2
  v_lshl_add_u32 v2, v2, 2, s5
  v_add_f32 v64, v64, v65
  ds_write2st64_b32 v2, v64, v80 offset0:0 offset1:4
  s_waitcnt lgkmcnt(0)
  s_barrier
  s_lshl_b32 s87, s97, 15
  s_lshl_b32 s4, s68, 11
  s_add_u32 s87, s87, s4
  s_lshl_b32 s4, s69, 2
  s_add_u32 s87, s87, s4
  s_add_u32 s97, s97, 1
  s_branch L_w2_body
L_w1_end:
  s_endpgm
L_w1_compute:
  s_and_b32 s71, s70, 1
  s_lshr_b32 s72, s70, 1
  v_and_b32 v3, 15, v1
  v_lshrrev_b32 v2, 4, v1
  s_lshl_b32 s8, s71, 13
  v_lshl_add_u32 v4, v1, 4, s8
  v_lshrrev_b32 v13, 2, v1
  v_lshlrev_b32 v13, 7, v13
  v_and_b32 v17, 3, v1
  v_lshl_add_u32 v13, v17, 3, v13
  v_bfe_u32 v17, v1, 3, 2
  v_lshl_add_u32 v13, v17, 5, v13
  s_lshl_b32 s9, s72, 6
  v_xor_b32 v13, s9, v13
  v_add_u32 v5, 16384, v13
  v_xor_b32 v6, 32, v5
  v_and_b32 v16, 1, v2
  v_lshrrev_b32 v17, 1, v2
  v_lshrrev_b32 v13, 2, v1
  v_and_b32 v14, 1, v1
  v_lshl_add_u32 v13, v13, 1, v14
  v_xor_b32 v14, s72, v16
  v_lshl_add_u32 v13, v13, 1, v14
  v_bfe_u32 v14, v1, 1, 1
  v_lshl_add_u32 v13, v13, 1, v14
  v_lshlrev_b32 v13, 3, v13
  v_add_u32 v7, 40960, v13
  s_mov_b32 s75, 0
  v_add_u32_e64 v20, s75, v4
  v_add_u32_e64 v21, s75, v5
  v_add_u32_e64 v22, s75, v6
  v_add_u32_e64 v23, s75, v7
  s_add_u32 s75, s75, 49152
  s_cmp_eq_u32 s75, 147456
  s_cselect_b32 s75, 0, s75
  s_mov_b32 s79, 15
  ds_read_b128 v[32:35], v20 offset:0
  ds_read_b128 v[36:39], v20 offset:2048
  ds_read_b128 v[40:43], v20 offset:4096
  ds_read_b128 v[44:47], v20 offset:6144
  ds_read_b64_tr_b16 v[48:49], v21 offset:0
  ds_read_b64_tr_b16 v[50:51], v21 offset:2048
  ds_read_b64_tr_b16 v[52:53], v22 offset:0
  ds_read_b64_tr_b16 v[54:55], v22 offset:2048
  ds_read_b64_tr_b16 v[56:57], v21 offset:8192
  ds_read_b64_tr_b16 v[58:59], v21 offset:10240
  ds_read_b64_tr_b16 v[60:61], v22 offset:8192
  ds_read_b64_tr_b16 v[62:63], v22 offset:10240
  ds_read_b64_tr_b16 v[64:65], v21 offset:16384
  ds_read_b64_tr_b16 v[66:67], v21 offset:18432
  ds_read_b64_tr_b16 v[68:69], v22 offset:16384
  ds_read_b64_tr_b16 v[70:71], v22 offset:18432
  ds_read_b64_tr_b16 v[72:73], v23 offset:0
  ds_read_b64_tr_b16 v[74:75], v23 offset:2048
  s_waitcnt lgkmcnt(0)
  v_mfma_f32_16x16x32_bf16 v[128:131], v[48:51], v[32:35], 0
  ds_read_b128 v[80:83], v20 offset:1024
  v_mfma_f32_16x16x32_bf16 v[132:135], v[48:51], v[36:39], 0
  ds_read_b128 v[84:87], v20 offset:3072
  v_mfma_f32_16x16x32_bf16 v[136:139], v[48:51], v[40:43], 0
  ds_read_b128 v[88:91], v20 offset:5120
  v_mfma_f32_16x16x32_bf16 v[140:143], v[48:51], v[44:47], 0
  ds_read_b128 v[92:95], v20 offset:7168
  v_mfma_f32_16x16x32_bf16 v[156:159], v[52:55], v[44:47], 0
  ds_read_b64_tr_b16 v[96:97], v21 offset:4096
  v_mfma_f32_16x16x32_bf16 v[152:155], v[52:55], v[40:43], 0
  ds_read_b64_tr_b16 v[98:99], v21 offset:6144
  v_mfma_f32_16x16x32_bf16 v[148:151], v[52:55], v[36:39], 0
  ds_read_b64_tr_b16 v[100:101], v22 offset:4096
  v_mfma_f32_16x16x32_bf16 v[144:147], v[52:55], v[32:35], 0
  ds_read_b64_tr_b16 v[102:103], v22 offset:6144
  v_mfma_f32_16x16x32_bf16 v[160:163], v[56:59], v[32:35], 0
  ds_read_b64_tr_b16 v[104:105], v21 offset:12288
  v_mfma_f32_16x16x32_bf16 v[164:167], v[56:59], v[36:39], 0
  ds_read_b64_tr_b16 v[106:107], v21 offset:14336
  v_mfma_f32_16x16x32_bf16 v[168:171], v[56:59], v[40:43], 0
  ds_read_b64_tr_b16 v[108:109], v22 offset:12288
  v_mfma_f32_16x16x32_bf16 v[172:175], v[56:59], v[44:47], 0
  ds_read_b64_tr_b16 v[110:111], v22 offset:14336
  v_mfma_f32_16x16x32_bf16 v[188:191], v[60:63], v[44:47], 0
  ds_read_b64_tr_b16 v[112:113], v21 offset:20480
  v_mfma_f32_16x16x32_bf16 v[184:187], v[60:63], v[40:43], 0
  ds_read_b64_tr_b16 v[114:115], v21 offset:22528
  v_mfma_f32_16x16x32_bf16 v[180:183], v[60:63], v[36:39], 0
  ds_read_b64_tr_b16 v[116:117], v22 offset:20480
  v_mfma_f32_16x16x32_bf16 v[176:179], v[60:63], v[32:35], 0
  ds_read_b64_tr_b16 v[118:119], v22 offset:22528
  v_mfma_f32_16x16x32_bf16 v[192:195], v[64:67], v[32:35], 0
  ds_read_b64_tr_b16 v[120:121], v23 offset:4096
  v_mfma_f32_16x16x32_bf16 v[196:199], v[64:67], v[36:39], 0
  ds_read_b64_tr_b16 v[122:123], v23 offset:6144
  v_mfma_f32_16x16x32_bf16 v[200:203], v[64:67], v[40:43], 0
  v_add_u32_e64 v20, s75, v4
  v_mfma_f32_16x16x32_bf16 v[204:207], v[64:67], v[44:47], 0
  v_add_u32_e64 v21, s75, v5
  v_mfma_f32_16x16x32_bf16 v[220:223], v[68:71], v[44:47], 0
  v_add_u32_e64 v22, s75, v6
  v_mfma_f32_16x16x32_bf16 v[216:219], v[68:71], v[40:43], 0
  v_add_u32_e64 v23, s75, v7
  v_mfma_f32_16x16x32_bf16 v[212:215], v[68:71], v[36:39], 0
  s_add_u32 s75, s75, 49152
  v_mfma_f32_16x16x32_bf16 v[208:211], v[68:71], v[32:35], 0
  s_cmp_eq_u32 s75, 147456
  v_mfma_f32_16x16x32_bf16 v[224:227], v[72:75], v[32:35], 0
  s_cselect_b32 s75, 0, s75
  v_mfma_f32_16x16x32_bf16 v[228:231], v[72:75], v[36:39], 0
  v_mfma_f32_16x16x32_bf16 v[232:235], v[72:75], v[40:43], 0
  v_mfma_f32_16x16x32_bf16 v[236:239], v[72:75], v[44:47], 0
  s_waitcnt lgkmcnt(0)
  v_mfma_f32_16x16x32_bf16 v[128:131], v[96:99], v[80:83], v[128:131]
  v_mfma_f32_16x16x32_bf16 v[132:135], v[96:99], v[84:87], v[132:135]
  v_mfma_f32_16x16x32_bf16 v[136:139], v[96:99], v[88:91], v[136:139]
  v_mfma_f32_16x16x32_bf16 v[140:143], v[96:99], v[92:95], v[140:143]
  v_mfma_f32_16x16x32_bf16 v[156:159], v[100:103], v[92:95], v[156:159]
  v_mfma_f32_16x16x32_bf16 v[152:155], v[100:103], v[88:91], v[152:155]
  v_mfma_f32_16x16x32_bf16 v[148:151], v[100:103], v[84:87], v[148:151]
  v_mfma_f32_16x16x32_bf16 v[144:147], v[100:103], v[80:83], v[144:147]
  v_mfma_f32_16x16x32_bf16 v[160:163], v[104:107], v[80:83], v[160:163]
  v_mfma_f32_16x16x32_bf16 v[164:167], v[104:107], v[84:87], v[164:167]
  v_mfma_f32_16x16x32_bf16 v[168:171], v[104:107], v[88:91], v[168:171]
  v_mfma_f32_16x16x32_bf16 v[172:175], v[104:107], v[92:95], v[172:175]
  v_mfma_f32_16x16x32_bf16 v[188:191], v[108:111], v[92:95], v[188:191]
  v_mfma_f32_16x16x32_bf16 v[184:187], v[108:111], v[88:91], v[184:187]
  v_mfma_f32_16x16x32_bf16 v[180:183], v[108:111], v[84:87], v[180:183]
  v_mfma_f32_16x16x32_bf16 v[176:179], v[108:111], v[80:83], v[176:179]
  v_mfma_f32_16x16x32_bf16 v[192:195], v[112:115], v[80:83], v[192:195]
  v_mfma_f32_16x16x32_bf16 v[196:199], v[112:115], v[84:87], v[196:199]
  v_mfma_f32_16x16x32_bf16 v[200:203], v[112:115], v[88:91], v[200:203]
  v_mfma_f32_16x16x32_bf16 v[204:207], v[112:115], v[92:95], v[204:207]
  v_mfma_f32_16x16x32_bf16 v[220:223], v[116:119], v[92:95], v[220:223]
  v_mfma_f32_16x16x32_bf16 v[216:219], v[116:119], v[88:91], v[216:219]
  v_mfma_f32_16x16x32_bf16 v[212:215], v[116:119], v[84:87], v[212:215]
  v_mfma_f32_16x16x32_bf16 v[208:211], v[116:119], v[80:83], v[208:211]
  v_mfma_f32_16x16x32_bf16 v[224:227], v[120:123], v[80:83], v[224:227]
  v_mfma_f32_16x16x32_bf16 v[228:231], v[120:123], v[84:87], v[228:231]
  v_mfma_f32_16x16x32_bf16 v[232:235], v[120:123], v[88:91], v[232:235]
  v_mfma_f32_16x16x32_bf16 v[236:239], v[120:123], v[92:95], v[236:239]
  s_barrier
  s_lshl_b32 s8, s68, 7
  s_lshl_b32 s9, s71, 6
  s_add_u32 s8, s8, s9
  s_mul_i32 s8, s8, 7168
  v_lshlrev_b32 v14, 8, v17
  v_lshl_add_u32 v14, v3, 4, v14
  s_lshl3_add_u32 s9, s71, s72
  s_lshl_b32 s9, s9, 10
  s_add_u32 s9, s9, 114688
  v_lshl_add_u32 v18, v1, 4, s9
  s_mov_b32 s52, s30
  s_and_b32 s53, s31, 0xffff
  s_mov_b32 s54, 2048
  s_mov_b32 s55, 0x00020000
  s_lshr_b32 s9, s69, 3
  s_and_b32 s10, s69, 7
  s_lshl1_add_u32 s9, s10, s9
  s_lshl_b32 s9, s9, 7
  v_lshl_add_u32 v19, v2, 3, s9
  v_add_u32 v14, s8, v14
  s_lshl_b32 s10, s69, 11
  s_lshl_b32 s9, s72, 10
  s_add_u32 s9, s9, s10
  v_lshl_add_u32 v12, v1, 4, s8
  v_add_u32 v12, s9, v12
  v_lshl_add_u32 v17, v16, 2, v17
  v_mul_u32_u24 v16, 114688, v16
  s_lshr_b32 s9, s9, 1
  v_add3_u32 v13, v16, v14, s9
  s_lshl_b32 s9, s71, 8
  s_add_u32 s9, s9, 110656
  v_lshl_add_u32 v14, v3, 2, s9
  s_lshl_b32 s9, s72, 7
  s_add_u32 s9, s9, 111872
  v_lshl_add_u32 v15, v2, 4, s9
  s_lshl_b32 s9, s72, 5
  s_add_u32 s9, s9, 111872
  v_lshl_add_u32 v16, v17, 4, s9
  s_add_u32 s44, s34, 8388608
  s_addc_u32 s45, s35, 0
  s_and_b32 s45, s45, 0xffff
  s_mov_b32 s46, 14680064
  s_mov_b32 s47, 0x00020000
  s_barrier
  ds_read_b128 v[32:35], v20 offset:0
  ds_read_b128 v[36:39], v20 offset:2048
  ds_read_b128 v[40:43], v20 offset:4096
  ds_read_b128 v[44:47], v20 offset:6144
  ds_read_b64_tr_b16 v[48:49], v21 offset:0
  ds_read_b64_tr_b16 v[50:51], v21 offset:2048
  ds_read_b64_tr_b16 v[52:53], v22 offset:0
  ds_read_b64_tr_b16 v[54:55], v22 offset:2048
  ds_read_b64_tr_b16 v[56:57], v21 offset:8192
  ds_read_b64_tr_b16 v[58:59], v21 offset:10240
  ds_read_b64_tr_b16 v[60:61], v22 offset:8192
  ds_read_b64_tr_b16 v[62:63], v22 offset:10240
  ds_read_b64_tr_b16 v[64:65], v21 offset:16384
  ds_read_b64_tr_b16 v[66:67], v21 offset:18432
  ds_read_b64_tr_b16 v[68:69], v22 offset:16384
  ds_read_b64_tr_b16 v[70:71], v22 offset:18432
  ds_read_b64_tr_b16 v[72:73], v23 offset:0
  ds_read_b64_tr_b16 v[74:75], v23 offset:2048
.p2align 5
  s_nop 0
  s_nop 0
  s_nop 0
  s_waitcnt lgkmcnt(0)
L_w1_loop:
  v_mfma_f32_16x16x32_bf16 v[128:131], v[48:51], v[32:35], v[128:131]
  ds_read_b128 v[80:83], v20 offset:1024
  v_mfma_f32_16x16x32_bf16 v[132:135], v[48:51], v[36:39], v[132:135]
  ds_read_b128 v[84:87], v20 offset:3072
  v_mfma_f32_16x16x32_bf16 v[136:139], v[48:51], v[40:43], v[136:139]
  ds_read_b128 v[88:91], v20 offset:5120
  v_mfma_f32_16x16x32_bf16 v[140:143], v[48:51], v[44:47], v[140:143]
  ds_read_b128 v[92:95], v20 offset:7168
  v_mfma_f32_16x16x32_bf16 v[156:159], v[52:55], v[44:47], v[156:159]
  ds_read_b64_tr_b16 v[96:97], v21 offset:4096
  v_mfma_f32_16x16x32_bf16 v[152:155], v[52:55], v[40:43], v[152:155]
  ds_read_b64_tr_b16 v[98:99], v21 offset:6144
  v_mfma_f32_16x16x32_bf16 v[148:151], v[52:55], v[36:39], v[148:151]
  ds_read_b64_tr_b16 v[100:101], v22 offset:4096
  v_mfma_f32_16x16x32_bf16 v[144:147], v[52:55], v[32:35], v[144:147]
  ds_read_b64_tr_b16 v[102:103], v22 offset:6144
  v_mfma_f32_16x16x32_bf16 v[160:163], v[56:59], v[32:35], v[160:163]
  ds_read_b64_tr_b16 v[104:105], v21 offset:12288
  v_mfma_f32_16x16x32_bf16 v[164:167], v[56:59], v[36:39], v[164:167]
  ds_read_b64_tr_b16 v[106:107], v21 offset:14336
  v_mfma_f32_16x16x32_bf16 v[168:171], v[56:59], v[40:43], v[168:171]
  ds_read_b64_tr_b16 v[108:109], v22 offset:12288
  v_mfma_f32_16x16x32_bf16 v[172:175], v[56:59], v[44:47], v[172:175]
  ds_read_b64_tr_b16 v[110:111], v22 offset:14336
  v_mfma_f32_16x16x32_bf16 v[188:191], v[60:63], v[44:47], v[188:191]
  ds_read_b64_tr_b16 v[112:113], v21 offset:20480
  v_mfma_f32_16x16x32_bf16 v[184:187], v[60:63], v[40:43], v[184:187]
  ds_read_b64_tr_b16 v[114:115], v21 offset:22528
  v_mfma_f32_16x16x32_bf16 v[180:183], v[60:63], v[36:39], v[180:183]
  ds_read_b64_tr_b16 v[116:117], v22 offset:20480
  v_mfma_f32_16x16x32_bf16 v[176:179], v[60:63], v[32:35], v[176:179]
  ds_read_b64_tr_b16 v[118:119], v22 offset:22528
  v_mfma_f32_16x16x32_bf16 v[192:195], v[64:67], v[32:35], v[192:195]
  ds_read_b64_tr_b16 v[120:121], v23 offset:4096
  v_mfma_f32_16x16x32_bf16 v[196:199], v[64:67], v[36:39], v[196:199]
  ds_read_b64_tr_b16 v[122:123], v23 offset:6144
  v_mfma_f32_16x16x32_bf16 v[200:203], v[64:67], v[40:43], v[200:203]
  v_add_u32_e64 v20, s75, v4
  v_mfma_f32_16x16x32_bf16 v[204:207], v[64:67], v[44:47], v[204:207]
  v_add_u32_e64 v21, s75, v5
  v_mfma_f32_16x16x32_bf16 v[220:223], v[68:71], v[44:47], v[220:223]
  v_add_u32_e64 v22, s75, v6
  v_mfma_f32_16x16x32_bf16 v[216:219], v[68:71], v[40:43], v[216:219]
  v_add_u32_e64 v23, s75, v7
  v_mfma_f32_16x16x32_bf16 v[212:215], v[68:71], v[36:39], v[212:215]
  s_add_u32 s75, s75, 49152
  v_mfma_f32_16x16x32_bf16 v[208:211], v[68:71], v[32:35], v[208:211]
  s_cmp_eq_u32 s75, 147456
  v_mfma_f32_16x16x32_bf16 v[224:227], v[72:75], v[32:35], v[224:227]
  s_cselect_b32 s75, 0, s75
  s_sub_u32 s79, s79, 1
  v_mfma_f32_16x16x32_bf16 v[228:231], v[72:75], v[36:39], v[228:231]
  v_mfma_f32_16x16x32_bf16 v[232:235], v[72:75], v[40:43], v[232:235]
  v_mfma_f32_16x16x32_bf16 v[236:239], v[72:75], v[44:47], v[236:239]
  s_waitcnt lgkmcnt(0)
  s_barrier
  v_mfma_f32_16x16x32_bf16 v[128:131], v[96:99], v[80:83], v[128:131]
  ds_read_b128 v[32:35], v20 offset:0
  v_mfma_f32_16x16x32_bf16 v[132:135], v[96:99], v[84:87], v[132:135]
  ds_read_b128 v[36:39], v20 offset:2048
  v_mfma_f32_16x16x32_bf16 v[136:139], v[96:99], v[88:91], v[136:139]
  ds_read_b128 v[40:43], v20 offset:4096
  v_mfma_f32_16x16x32_bf16 v[140:143], v[96:99], v[92:95], v[140:143]
  ds_read_b128 v[44:47], v20 offset:6144
  v_mfma_f32_16x16x32_bf16 v[156:159], v[100:103], v[92:95], v[156:159]
  ds_read_b64_tr_b16 v[48:49], v21 offset:0
  v_mfma_f32_16x16x32_bf16 v[152:155], v[100:103], v[88:91], v[152:155]
  ds_read_b64_tr_b16 v[50:51], v21 offset:2048
  v_mfma_f32_16x16x32_bf16 v[148:151], v[100:103], v[84:87], v[148:151]
  ds_read_b64_tr_b16 v[52:53], v22 offset:0
  v_mfma_f32_16x16x32_bf16 v[144:147], v[100:103], v[80:83], v[144:147]
  ds_read_b64_tr_b16 v[54:55], v22 offset:2048
  v_mfma_f32_16x16x32_bf16 v[160:163], v[104:107], v[80:83], v[160:163]
  ds_read_b64_tr_b16 v[56:57], v21 offset:8192
  v_mfma_f32_16x16x32_bf16 v[164:167], v[104:107], v[84:87], v[164:167]
  ds_read_b64_tr_b16 v[58:59], v21 offset:10240
  v_mfma_f32_16x16x32_bf16 v[168:171], v[104:107], v[88:91], v[168:171]
  ds_read_b64_tr_b16 v[60:61], v22 offset:8192
  v_mfma_f32_16x16x32_bf16 v[172:175], v[104:107], v[92:95], v[172:175]
  ds_read_b64_tr_b16 v[62:63], v22 offset:10240
  v_mfma_f32_16x16x32_bf16 v[188:191], v[108:111], v[92:95], v[188:191]
  ds_read_b64_tr_b16 v[64:65], v21 offset:16384
  v_mfma_f32_16x16x32_bf16 v[184:187], v[108:111], v[88:91], v[184:187]
  ds_read_b64_tr_b16 v[66:67], v21 offset:18432
  v_mfma_f32_16x16x32_bf16 v[180:183], v[108:111], v[84:87], v[180:183]
  ds_read_b64_tr_b16 v[68:69], v22 offset:16384
  v_mfma_f32_16x16x32_bf16 v[176:179], v[108:111], v[80:83], v[176:179]
  ds_read_b64_tr_b16 v[70:71], v22 offset:18432
  v_mfma_f32_16x16x32_bf16 v[192:195], v[112:115], v[80:83], v[192:195]
  ds_read_b64_tr_b16 v[72:73], v23 offset:0
  v_mfma_f32_16x16x32_bf16 v[196:199], v[112:115], v[84:87], v[196:199]
  ds_read_b64_tr_b16 v[74:75], v23 offset:2048
  v_mfma_f32_16x16x32_bf16 v[200:203], v[112:115], v[88:91], v[200:203]
  s_cmp_lg_u32 s79, 0
  s_nop 0
  v_mfma_f32_16x16x32_bf16 v[204:207], v[112:115], v[92:95], v[204:207]
  v_mfma_f32_16x16x32_bf16 v[220:223], v[116:119], v[92:95], v[220:223]
  v_mfma_f32_16x16x32_bf16 v[216:219], v[116:119], v[88:91], v[216:219]
  v_mfma_f32_16x16x32_bf16 v[212:215], v[116:119], v[84:87], v[212:215]
  v_mfma_f32_16x16x32_bf16 v[208:211], v[116:119], v[80:83], v[208:211]
  v_mfma_f32_16x16x32_bf16 v[224:227], v[120:123], v[80:83], v[224:227]
  v_mfma_f32_16x16x32_bf16 v[228:231], v[120:123], v[84:87], v[228:231]
  v_mfma_f32_16x16x32_bf16 v[232:235], v[120:123], v[88:91], v[232:235]
  v_mfma_f32_16x16x32_bf16 v[236:239], v[120:123], v[92:95], v[236:239]
  s_waitcnt lgkmcnt(0)
  s_cbranch_scc1 L_w1_loop
L_w1_lend:
L_w1_exit:
  ds_read2_b32 v[88:89], v14 offset0:0 offset1:160
  ds_read2_b32 v[90:91], v14 offset0:16 offset1:176
  ds_read2_b32 v[92:93], v14 offset0:32 offset1:192
  ds_read2_b32 v[94:95], v14 offset0:48 offset1:208
  ds_read_b128 v[32:35], v15 offset:0
  ds_read_b128 v[60:63], v15 offset:1024
  ds_read_b128 v[36:39], v15 offset:64
  ds_read_b128 v[64:67], v15 offset:1088
  ds_read_b128 v[40:43], v15 offset:256
  ds_read_b128 v[68:71], v15 offset:1280
  ds_read_b128 v[44:47], v15 offset:320
  ds_read_b128 v[72:75], v15 offset:1344
  ds_read_b128 v[48:51], v15 offset:512
  ds_read_b128 v[76:79], v15 offset:1536
  ds_read_b128 v[52:55], v15 offset:576
  ds_read_b128 v[80:83], v15 offset:1600
  ds_read_b128 v[56:59], v16 offset:768
  ds_read_b128 v[84:87], v16 offset:1792
  buffer_load_dwordx2 v[10:11], v19, s[52:55], 0 offen offset:0
  buffer_load_dwordx2 v[24:25], v19, s[52:55], 0 offen offset:32
  buffer_load_dwordx2 v[124:125], v19, s[52:55], 0 offen offset:64
  buffer_load_dwordx2 v[126:127], v19, s[52:55], 0 offen offset:96
  v_mov_b32 v96, 0xc0135761
  v_mov_b32 v97, 0xbdd2d3e8
  v_mov_b32 v98, 1.0
  s_waitcnt lgkmcnt(0)
  v_mul_f32 v88, v88, v89
  v_mul_f32 v90, v90, v91
  v_mul_f32 v92, v92, v93
  v_mul_f32 v94, v94, v95
  v_pk_fma_f32 v[100:101], v[32:33], v[88:89], v[60:61] op_sel:[0,0,0] op_sel_hi:[1,0,1] neg_lo:[0,1,0] neg_hi:[0,1,0]
  v_pk_fma_f32 v[102:103], v[34:35], v[88:89], v[62:63] op_sel:[0,0,0] op_sel_hi:[1,0,1] neg_lo:[0,1,0] neg_hi:[0,1,0]
  v_pk_fma_f32 v[128:129], v[128:129], v[88:89], v[100:101] op_sel:[0,1,0] op_sel_hi:[1,1,1]
  v_pk_fma_f32 v[130:131], v[130:131], v[88:89], v[102:103] op_sel:[0,1,0] op_sel_hi:[1,1,1]
  v_pk_mul_f32 v[100:101], v[128:129], v[128:129]
  v_pk_mul_f32 v[102:103], v[130:131], v[130:131]
  v_pk_fma_f32 v[100:101], v[100:101], v[96:97], v[96:97] op_sel:[0,1,0] op_sel_hi:[1,1,0]
  v_pk_fma_f32 v[102:103], v[102:103], v[96:97], v[96:97] op_sel:[0,1,0] op_sel_hi:[1,1,0]
  v_pk_mul_f32 v[100:101], v[100:101], v[128:129]
  v_pk_mul_f32 v[102:103], v[102:103], v[130:131]
  v_exp_f32 v100, v100
  v_exp_f32 v101, v101
  v_exp_f32 v102, v102
  v_exp_f32 v103, v103
  v_pk_add_f32 v[100:101], v[100:101], v[98:99] op_sel_hi:[1,0]
  v_pk_add_f32 v[102:103], v[102:103], v[98:99] op_sel_hi:[1,0]
  v_rcp_f32 v100, v100
  v_rcp_f32 v101, v101
  v_rcp_f32 v102, v102
  v_rcp_f32 v103, v103
  v_pk_mul_f32 v[128:129], v[128:129], v[100:101]
  v_pk_mul_f32 v[130:131], v[130:131], v[102:103]
  v_cvt_pk_bf16_f32 v108, v128, v129
  v_cvt_pk_bf16_f32 v109, v130, v131
  v_pk_fma_f32 v[104:105], v[36:37], v[88:89], v[64:65] op_sel:[0,0,0] op_sel_hi:[1,0,1] neg_lo:[0,1,0] neg_hi:[0,1,0]
  v_pk_fma_f32 v[106:107], v[38:39], v[88:89], v[66:67] op_sel:[0,0,0] op_sel_hi:[1,0,1] neg_lo:[0,1,0] neg_hi:[0,1,0]
  v_pk_fma_f32 v[144:145], v[144:145], v[88:89], v[104:105] op_sel:[0,1,0] op_sel_hi:[1,1,1]
  v_pk_fma_f32 v[146:147], v[146:147], v[88:89], v[106:107] op_sel:[0,1,0] op_sel_hi:[1,1,1]
  v_pk_mul_f32 v[104:105], v[144:145], v[144:145]
  v_pk_mul_f32 v[106:107], v[146:147], v[146:147]
  v_pk_fma_f32 v[104:105], v[104:105], v[96:97], v[96:97] op_sel:[0,1,0] op_sel_hi:[1,1,0]
  v_pk_fma_f32 v[106:107], v[106:107], v[96:97], v[96:97] op_sel:[0,1,0] op_sel_hi:[1,1,0]
  v_pk_mul_f32 v[104:105], v[104:105], v[144:145]
  v_pk_mul_f32 v[106:107], v[106:107], v[146:147]
  v_exp_f32 v104, v104
  v_exp_f32 v105, v105
  v_exp_f32 v106, v106
  v_exp_f32 v107, v107
  v_pk_add_f32 v[104:105], v[104:105], v[98:99] op_sel_hi:[1,0]
  v_pk_add_f32 v[106:107], v[106:107], v[98:99] op_sel_hi:[1,0]
  v_rcp_f32 v104, v104
  v_rcp_f32 v105, v105
  v_rcp_f32 v106, v106
  v_rcp_f32 v107, v107
  v_pk_mul_f32 v[144:145], v[144:145], v[104:105]
  v_pk_mul_f32 v[146:147], v[146:147], v[106:107]
  v_cvt_pk_bf16_f32 v110, v144, v145
  v_cvt_pk_bf16_f32 v111, v146, v147
  s_mov_b32 s3, 0
  buffer_store_dwordx4 v[108:111], v12, s[44:47], s3 offen sc1
  ds_write_b128 v18, v[108:111] offset:32768
  v_pk_fma_f32 v[100:101], v[32:33], v[90:91], v[60:61] op_sel:[0,0,0] op_sel_hi:[1,0,1] neg_lo:[0,1,0] neg_hi:[0,1,0]
  v_pk_fma_f32 v[102:103], v[34:35], v[90:91], v[62:63] op_sel:[0,0,0] op_sel_hi:[1,0,1] neg_lo:[0,1,0] neg_hi:[0,1,0]
  v_pk_fma_f32 v[132:133], v[132:133], v[90:91], v[100:101] op_sel:[0,1,0] op_sel_hi:[1,1,1]
  v_pk_fma_f32 v[134:135], v[134:135], v[90:91], v[102:103] op_sel:[0,1,0] op_sel_hi:[1,1,1]
  v_pk_mul_f32 v[100:101], v[132:133], v[132:133]
  v_pk_mul_f32 v[102:103], v[134:135], v[134:135]
  v_pk_fma_f32 v[100:101], v[100:101], v[96:97], v[96:97] op_sel:[0,1,0] op_sel_hi:[1,1,0]
  v_pk_fma_f32 v[102:103], v[102:103], v[96:97], v[96:97] op_sel:[0,1,0] op_sel_hi:[1,1,0]
  v_pk_mul_f32 v[100:101], v[100:101], v[132:133]
  v_pk_mul_f32 v[102:103], v[102:103], v[134:135]
  v_exp_f32 v100, v100
  v_exp_f32 v101, v101
  v_exp_f32 v102, v102
  v_exp_f32 v103, v103
  v_pk_add_f32 v[100:101], v[100:101], v[98:99] op_sel_hi:[1,0]
  v_pk_add_f32 v[102:103], v[102:103], v[98:99] op_sel_hi:[1,0]
  v_rcp_f32 v100, v100
  v_rcp_f32 v101, v101
  v_rcp_f32 v102, v102
  v_rcp_f32 v103, v103
  v_pk_mul_f32 v[132:133], v[132:133], v[100:101]
  v_pk_mul_f32 v[134:135], v[134:135], v[102:103]
  v_cvt_pk_bf16_f32 v112, v132, v133
  v_cvt_pk_bf16_f32 v113, v134, v135
  v_pk_fma_f32 v[104:105], v[36:37], v[90:91], v[64:65] op_sel:[0,0,0] op_sel_hi:[1,0,1] neg_lo:[0,1,0] neg_hi:[0,1,0]
  v_pk_fma_f32 v[106:107], v[38:39], v[90:91], v[66:67] op_sel:[0,0,0] op_sel_hi:[1,0,1] neg_lo:[0,1,0] neg_hi:[0,1,0]
  v_pk_fma_f32 v[148:149], v[148:149], v[90:91], v[104:105] op_sel:[0,1,0] op_sel_hi:[1,1,1]
  v_pk_fma_f32 v[150:151], v[150:151], v[90:91], v[106:107] op_sel:[0,1,0] op_sel_hi:[1,1,1]
  v_pk_mul_f32 v[104:105], v[148:149], v[148:149]
  v_pk_mul_f32 v[106:107], v[150:151], v[150:151]
  v_pk_fma_f32 v[104:105], v[104:105], v[96:97], v[96:97] op_sel:[0,1,0] op_sel_hi:[1,1,0]
  v_pk_fma_f32 v[106:107], v[106:107], v[96:97], v[96:97] op_sel:[0,1,0] op_sel_hi:[1,1,0]
  v_pk_mul_f32 v[104:105], v[104:105], v[148:149]
  v_pk_mul_f32 v[106:107], v[106:107], v[150:151]
  v_exp_f32 v104, v104
  v_exp_f32 v105, v105
  v_exp_f32 v106, v106
  v_exp_f32 v107, v107
  v_pk_add_f32 v[104:105], v[104:105], v[98:99] op_sel_hi:[1,0]
  v_pk_add_f32 v[106:107], v[106:107], v[98:99] op_sel_hi:[1,0]
  v_rcp_f32 v104, v104
  v_rcp_f32 v105, v105
  v_rcp_f32 v106, v106
  v_rcp_f32 v107, v107
  v_pk_mul_f32 v[148:149], v[148:149], v[104:105]
  v_pk_mul_f32 v[150:151], v[150:151], v[106:107]
  v_cvt_pk_bf16_f32 v114, v148, v149
  v_cvt_pk_bf16_f32 v115, v150, v151
  s_mov_b32 s3, 114688
  buffer_store_dwordx4 v[112:115], v12, s[44:47], s3 offen sc1
  ds_write_b128 v18, v[112:115] offset:34816
  v_pk_fma_f32 v[100:101], v[32:33], v[92:93], v[60:61] op_sel:[0,0,0] op_sel_hi:[1,0,1] neg_lo:[0,1,0] neg_hi:[0,1,0]
  v_pk_fma_f32 v[102:103], v[34:35], v[92:93], v[62:63] op_sel:[0,0,0] op_sel_hi:[1,0,1] neg_lo:[0,1,0] neg_hi:[0,1,0]
  v_pk_fma_f32 v[136:137], v[136:137], v[92:93], v[100:101] op_sel:[0,1,0] op_sel_hi:[1,1,1]
  v_pk_fma_f32 v[138:139], v[138:139], v[92:93], v[102:103] op_sel:[0,1,0] op_sel_hi:[1,1,1]
  v_pk_mul_f32 v[100:101], v[136:137], v[136:137]
  v_pk_mul_f32 v[102:103], v[138:139], v[138:139]
  v_pk_fma_f32 v[100:101], v[100:101], v[96:97], v[96:97] op_sel:[0,1,0] op_sel_hi:[1,1,0]
  v_pk_fma_f32 v[102:103], v[102:103], v[96:97], v[96:97] op_sel:[0,1,0] op_sel_hi:[1,1,0]
  v_pk_mul_f32 v[100:101], v[100:101], v[136:137]
  v_pk_mul_f32 v[102:103], v[102:103], v[138:139]
  v_exp_f32 v100, v100
  v_exp_f32 v101, v101
  v_exp_f32 v102, v102
  v_exp_f32 v103, v103
  v_pk_add_f32 v[100:101], v[100:101], v[98:99] op_sel_hi:[1,0]
  v_pk_add_f32 v[102:103], v[102:103], v[98:99] op_sel_hi:[1,0]
  v_rcp_f32 v100, v100
  v_rcp_f32 v101, v101
  v_rcp_f32 v102, v102
  v_rcp_f32 v103, v103
  v_pk_mul_f32 v[136:137], v[136:137], v[100:101]
  v_pk_mul_f32 v[138:139], v[138:139], v[102:103]
  v_cvt_pk_bf16_f32 v116, v136, v137
  v_cvt_pk_bf16_f32 v117, v138, v139
  v_pk_fma_f32 v[104:105], v[36:37], v[92:93], v[64:65] op_sel:[0,0,0] op_sel_hi:[1,0,1] neg_lo:[0,1,0] neg_hi:[0,1,0]
  v_pk_fma_f32 v[106:107], v[38:39], v[92:93], v[66:67] op_sel:[0,0,0] op_sel_hi:[1,0,1] neg_lo:[0,1,0] neg_hi:[0,1,0]
  v_pk_fma_f32 v[152:153], v[152:153], v[92:93], v[104:105] op_sel:[0,1,0] op_sel_hi:[1,1,1]
  v_pk_fma_f32 v[154:155], v[154:155], v[92:93], v[106:107] op_sel:[0,1,0] op_sel_hi:[1,1,1]
  v_pk_mul_f32 v[104:105], v[152:153], v[152:153]
  v_pk_mul_f32 v[106:107], v[154:155], v[154:155]
  v_pk_fma_f32 v[104:105], v[104:105], v[96:97], v[96:97] op_sel:[0,1,0] op_sel_hi:[1,1,0]
  v_pk_fma_f32 v[106:107], v[106:107], v[96:97], v[96:97] op_sel:[0,1,0] op_sel_hi:[1,1,0]
  v_pk_mul_f32 v[104:105], v[104:105], v[152:153]
  v_pk_mul_f32 v[106:107], v[106:107], v[154:155]
  v_exp_f32 v104, v104
  v_exp_f32 v105, v105
  v_exp_f32 v106, v106
  v_exp_f32 v107, v107
  v_pk_add_f32 v[104:105], v[104:105], v[98:99] op_sel_hi:[1,0]
  v_pk_add_f32 v[106:107], v[106:107], v[98:99] op_sel_hi:[1,0]
  v_rcp_f32 v104, v104
  v_rcp_f32 v105, v105
  v_rcp_f32 v106, v106
  v_rcp_f32 v107, v107
  v_pk_mul_f32 v[152:153], v[152:153], v[104:105]
  v_pk_mul_f32 v[154:155], v[154:155], v[106:107]
  v_cvt_pk_bf16_f32 v118, v152, v153
  v_cvt_pk_bf16_f32 v119, v154, v155
  s_mov_b32 s3, 229376
  buffer_store_dwordx4 v[116:119], v12, s[44:47], s3 offen sc1
  ds_write_b128 v18, v[116:119] offset:36864
  v_pk_fma_f32 v[100:101], v[32:33], v[94:95], v[60:61] op_sel:[0,0,0] op_sel_hi:[1,0,1] neg_lo:[0,1,0] neg_hi:[0,1,0]
  v_pk_fma_f32 v[102:103], v[34:35], v[94:95], v[62:63] op_sel:[0,0,0] op_sel_hi:[1,0,1] neg_lo:[0,1,0] neg_hi:[0,1,0]
  v_pk_fma_f32 v[140:141], v[140:141], v[94:95], v[100:101] op_sel:[0,1,0] op_sel_hi:[1,1,1]
  v_pk_fma_f32 v[142:143], v[142:143], v[94:95], v[102:103] op_sel:[0,1,0] op_sel_hi:[1,1,1]
  v_pk_mul_f32 v[100:101], v[140:141], v[140:141]
  v_pk_mul_f32 v[102:103], v[142:143], v[142:143]
  v_pk_fma_f32 v[100:101], v[100:101], v[96:97], v[96:97] op_sel:[0,1,0] op_sel_hi:[1,1,0]
  v_pk_fma_f32 v[102:103], v[102:103], v[96:97], v[96:97] op_sel:[0,1,0] op_sel_hi:[1,1,0]
  v_pk_mul_f32 v[100:101], v[100:101], v[140:141]
  v_pk_mul_f32 v[102:103], v[102:103], v[142:143]
  v_exp_f32 v100, v100
  v_exp_f32 v101, v101
  v_exp_f32 v102, v102
  v_exp_f32 v103, v103
  v_pk_add_f32 v[100:101], v[100:101], v[98:99] op_sel_hi:[1,0]
  v_pk_add_f32 v[102:103], v[102:103], v[98:99] op_sel_hi:[1,0]
  v_rcp_f32 v100, v100
  v_rcp_f32 v101, v101
  v_rcp_f32 v102, v102
  v_rcp_f32 v103, v103
  v_pk_mul_f32 v[140:141], v[140:141], v[100:101]
  v_pk_mul_f32 v[142:143], v[142:143], v[102:103]
  v_cvt_pk_bf16_f32 v120, v140, v141
  v_cvt_pk_bf16_f32 v121, v142, v143
  v_pk_fma_f32 v[104:105], v[36:37], v[94:95], v[64:65] op_sel:[0,0,0] op_sel_hi:[1,0,1] neg_lo:[0,1,0] neg_hi:[0,1,0]
  v_pk_fma_f32 v[106:107], v[38:39], v[94:95], v[66:67] op_sel:[0,0,0] op_sel_hi:[1,0,1] neg_lo:[0,1,0] neg_hi:[0,1,0]
  v_pk_fma_f32 v[156:157], v[156:157], v[94:95], v[104:105] op_sel:[0,1,0] op_sel_hi:[1,1,1]
  v_pk_fma_f32 v[158:159], v[158:159], v[94:95], v[106:107] op_sel:[0,1,0] op_sel_hi:[1,1,1]
  v_pk_mul_f32 v[104:105], v[156:157], v[156:157]
  v_pk_mul_f32 v[106:107], v[158:159], v[158:159]
  v_pk_fma_f32 v[104:105], v[104:105], v[96:97], v[96:97] op_sel:[0,1,0] op_sel_hi:[1,1,0]
  v_pk_fma_f32 v[106:107], v[106:107], v[96:97], v[96:97] op_sel:[0,1,0] op_sel_hi:[1,1,0]
  v_pk_mul_f32 v[104:105], v[104:105], v[156:157]
  v_pk_mul_f32 v[106:107], v[106:107], v[158:159]
  v_exp_f32 v104, v104
  v_exp_f32 v105, v105
  v_exp_f32 v106, v106
  v_exp_f32 v107, v107
  v_pk_add_f32 v[104:105], v[104:105], v[98:99] op_sel_hi:[1,0]
  v_pk_add_f32 v[106:107], v[106:107], v[98:99] op_sel_hi:[1,0]
  v_rcp_f32 v104, v104
  v_rcp_f32 v105, v105
  v_rcp_f32 v106, v106
  v_rcp_f32 v107, v107
  v_pk_mul_f32 v[156:157], v[156:157], v[104:105]
  v_pk_mul_f32 v[158:159], v[158:159], v[106:107]
  v_cvt_pk_bf16_f32 v122, v156, v157
  v_cvt_pk_bf16_f32 v123, v158, v159
  s_mov_b32 s3, 344064
  buffer_store_dwordx4 v[120:123], v12, s[44:47], s3 offen sc1
  ds_write_b128 v18, v[120:123] offset:38912
  v_pk_fma_f32 v[100:101], v[56:57], v[88:89], v[84:85] op_sel:[0,0,0] op_sel_hi:[1,0,1] neg_lo:[0,1,0] neg_hi:[0,1,0]
  v_pk_fma_f32 v[102:103], v[58:59], v[88:89], v[86:87] op_sel:[0,0,0] op_sel_hi:[1,0,1] neg_lo:[0,1,0] neg_hi:[0,1,0]
  v_pk_fma_f32 v[224:225], v[224:225], v[88:89], v[100:101] op_sel:[0,1,0] op_sel_hi:[1,1,1]
  v_pk_fma_f32 v[226:227], v[226:227], v[88:89], v[102:103] op_sel:[0,1,0] op_sel_hi:[1,1,1]
  v_pk_mul_f32 v[100:101], v[224:225], v[224:225]
  v_pk_mul_f32 v[102:103], v[226:227], v[226:227]
  v_pk_fma_f32 v[100:101], v[100:101], v[96:97], v[96:97] op_sel:[0,1,0] op_sel_hi:[1,1,0]
  v_pk_fma_f32 v[102:103], v[102:103], v[96:97], v[96:97] op_sel:[0,1,0] op_sel_hi:[1,1,0]
  v_pk_mul_f32 v[100:101], v[100:101], v[224:225]
  v_pk_mul_f32 v[102:103], v[102:103], v[226:227]
  v_exp_f32 v100, v100
  v_exp_f32 v101, v101
  v_exp_f32 v102, v102
  v_exp_f32 v103, v103
  v_pk_add_f32 v[100:101], v[100:101], v[98:99] op_sel_hi:[1,0]
  v_pk_add_f32 v[102:103], v[102:103], v[98:99] op_sel_hi:[1,0]
  v_rcp_f32 v100, v100
  v_rcp_f32 v101, v101
  v_rcp_f32 v102, v102
  v_rcp_f32 v103, v103
  v_pk_mul_f32 v[224:225], v[224:225], v[100:101]
  v_pk_mul_f32 v[226:227], v[226:227], v[102:103]
  v_cvt_pk_bf16_f32 v108, v224, v225
  v_cvt_pk_bf16_f32 v109, v226, v227
  v_pk_fma_f32 v[100:101], v[56:57], v[90:91], v[84:85] op_sel:[0,0,0] op_sel_hi:[1,0,1] neg_lo:[0,1,0] neg_hi:[0,1,0]
  v_pk_fma_f32 v[102:103], v[58:59], v[90:91], v[86:87] op_sel:[0,0,0] op_sel_hi:[1,0,1] neg_lo:[0,1,0] neg_hi:[0,1,0]
  v_pk_fma_f32 v[228:229], v[228:229], v[90:91], v[100:101] op_sel:[0,1,0] op_sel_hi:[1,1,1]
  v_pk_fma_f32 v[230:231], v[230:231], v[90:91], v[102:103] op_sel:[0,1,0] op_sel_hi:[1,1,1]
  v_pk_mul_f32 v[100:101], v[228:229], v[228:229]
  v_pk_mul_f32 v[102:103], v[230:231], v[230:231]
  v_pk_fma_f32 v[100:101], v[100:101], v[96:97], v[96:97] op_sel:[0,1,0] op_sel_hi:[1,1,0]
  v_pk_fma_f32 v[102:103], v[102:103], v[96:97], v[96:97] op_sel:[0,1,0] op_sel_hi:[1,1,0]
  v_pk_mul_f32 v[100:101], v[100:101], v[228:229]
  v_pk_mul_f32 v[102:103], v[102:103], v[230:231]
  v_exp_f32 v100, v100
  v_exp_f32 v101, v101
  v_exp_f32 v102, v102
  v_exp_f32 v103, v103
  v_pk_add_f32 v[100:101], v[100:101], v[98:99] op_sel_hi:[1,0]
  v_pk_add_f32 v[102:103], v[102:103], v[98:99] op_sel_hi:[1,0]
  v_rcp_f32 v100, v100
  v_rcp_f32 v101, v101
  v_rcp_f32 v102, v102
  v_rcp_f32 v103, v103
  v_pk_mul_f32 v[228:229], v[228:229], v[100:101]
  v_pk_mul_f32 v[230:231], v[230:231], v[102:103]
  v_cvt_pk_bf16_f32 v110, v228, v229
  v_cvt_pk_bf16_f32 v111, v230, v231
  s_mov_b32 s3, 32768
  s_nop 0
  v_permlane16_swap_b32 v108, v110
  v_permlane16_swap_b32 v109, v111
  buffer_store_dwordx4 v[108:111], v13, s[44:47], s3 offen sc1
  v_pk_fma_f32 v[100:101], v[56:57], v[92:93], v[84:85] op_sel:[0,0,0] op_sel_hi:[1,0,1] neg_lo:[0,1,0] neg_hi:[0,1,0]
  v_pk_fma_f32 v[102:103], v[58:59], v[92:93], v[86:87] op_sel:[0,0,0] op_sel_hi:[1,0,1] neg_lo:[0,1,0] neg_hi:[0,1,0]
  v_pk_fma_f32 v[232:233], v[232:233], v[92:93], v[100:101] op_sel:[0,1,0] op_sel_hi:[1,1,1]
  v_pk_fma_f32 v[234:235], v[234:235], v[92:93], v[102:103] op_sel:[0,1,0] op_sel_hi:[1,1,1]
  v_pk_mul_f32 v[100:101], v[232:233], v[232:233]
  v_pk_mul_f32 v[102:103], v[234:235], v[234:235]
  v_pk_fma_f32 v[100:101], v[100:101], v[96:97], v[96:97] op_sel:[0,1,0] op_sel_hi:[1,1,0]
  v_pk_fma_f32 v[102:103], v[102:103], v[96:97], v[96:97] op_sel:[0,1,0] op_sel_hi:[1,1,0]
  v_pk_mul_f32 v[100:101], v[100:101], v[232:233]
  v_pk_mul_f32 v[102:103], v[102:103], v[234:235]
  v_exp_f32 v100, v100
  v_exp_f32 v101, v101
  v_exp_f32 v102, v102
  v_exp_f32 v103, v103
  v_pk_add_f32 v[100:101], v[100:101], v[98:99] op_sel_hi:[1,0]
  v_pk_add_f32 v[102:103], v[102:103], v[98:99] op_sel_hi:[1,0]
  v_rcp_f32 v100, v100
  v_rcp_f32 v101, v101
  v_rcp_f32 v102, v102
  v_rcp_f32 v103, v103
  v_pk_mul_f32 v[232:233], v[232:233], v[100:101]
  v_pk_mul_f32 v[234:235], v[234:235], v[102:103]
  v_cvt_pk_bf16_f32 v112, v232, v233
  v_cvt_pk_bf16_f32 v113, v234, v235
  v_pk_fma_f32 v[100:101], v[56:57], v[94:95], v[84:85] op_sel:[0,0,0] op_sel_hi:[1,0,1] neg_lo:[0,1,0] neg_hi:[0,1,0]
  v_pk_fma_f32 v[102:103], v[58:59], v[94:95], v[86:87] op_sel:[0,0,0] op_sel_hi:[1,0,1] neg_lo:[0,1,0] neg_hi:[0,1,0]
  v_pk_fma_f32 v[236:237], v[236:237], v[94:95], v[100:101] op_sel:[0,1,0] op_sel_hi:[1,1,1]
  v_pk_fma_f32 v[238:239], v[238:239], v[94:95], v[102:103] op_sel:[0,1,0] op_sel_hi:[1,1,1]
  v_pk_mul_f32 v[100:101], v[236:237], v[236:237]
  v_pk_mul_f32 v[102:103], v[238:239], v[238:239]
  v_pk_fma_f32 v[100:101], v[100:101], v[96:97], v[96:97] op_sel:[0,1,0] op_sel_hi:[1,1,0]
  v_pk_fma_f32 v[102:103], v[102:103], v[96:97], v[96:97] op_sel:[0,1,0] op_sel_hi:[1,1,0]
  v_pk_mul_f32 v[100:101], v[100:101], v[236:237]
  v_pk_mul_f32 v[102:103], v[102:103], v[238:239]
  v_exp_f32 v100, v100
  v_exp_f32 v101, v101
  v_exp_f32 v102, v102
  v_exp_f32 v103, v103
  v_pk_add_f32 v[100:101], v[100:101], v[98:99] op_sel_hi:[1,0]
  v_pk_add_f32 v[102:103], v[102:103], v[98:99] op_sel_hi:[1,0]
  v_rcp_f32 v100, v100
  v_rcp_f32 v101, v101
  v_rcp_f32 v102, v102
  v_rcp_f32 v103, v103
  v_pk_mul_f32 v[236:237], v[236:237], v[100:101]
  v_pk_mul_f32 v[238:239], v[238:239], v[102:103]
  v_cvt_pk_bf16_f32 v114, v236, v237
  v_cvt_pk_bf16_f32 v115, v238, v239
  s_mov_b32 s3, 262144
  s_nop 0
  v_permlane16_swap_b32 v112, v114
  v_permlane16_swap_b32 v113, v115
  buffer_store_dwordx4 v[112:115], v13, s[44:47], s3 offen sc1
  v_pk_fma_f32 v[100:101], v[40:41], v[88:89], v[68:69] op_sel:[0,0,0] op_sel_hi:[1,0,1] neg_lo:[0,1,0] neg_hi:[0,1,0]
  v_pk_fma_f32 v[102:103], v[42:43], v[88:89], v[70:71] op_sel:[0,0,0] op_sel_hi:[1,0,1] neg_lo:[0,1,0] neg_hi:[0,1,0]
  v_pk_fma_f32 v[160:161], v[160:161], v[88:89], v[100:101] op_sel:[0,1,0] op_sel_hi:[1,1,1]
  v_pk_fma_f32 v[162:163], v[162:163], v[88:89], v[102:103] op_sel:[0,1,0] op_sel_hi:[1,1,1]
  v_pk_mul_f32 v[100:101], v[160:161], v[160:161]
  v_pk_mul_f32 v[102:103], v[162:163], v[162:163]
  v_pk_fma_f32 v[100:101], v[100:101], v[96:97], v[96:97] op_sel:[0,1,0] op_sel_hi:[1,1,0]
  v_pk_fma_f32 v[102:103], v[102:103], v[96:97], v[96:97] op_sel:[0,1,0] op_sel_hi:[1,1,0]
  v_pk_mul_f32 v[100:101], v[100:101], v[160:161]
  v_pk_mul_f32 v[102:103], v[102:103], v[162:163]
  v_exp_f32 v100, v100
  v_exp_f32 v101, v101
  v_exp_f32 v102, v102
  v_exp_f32 v103, v103
  v_pk_add_f32 v[100:101], v[100:101], v[98:99] op_sel_hi:[1,0]
  v_pk_add_f32 v[102:103], v[102:103], v[98:99] op_sel_hi:[1,0]
  v_rcp_f32 v100, v100
  v_rcp_f32 v101, v101
  v_rcp_f32 v102, v102
  v_rcp_f32 v103, v103
  v_pk_mul_f32 v[160:161], v[160:161], v[100:101]
  v_pk_mul_f32 v[162:163], v[162:163], v[102:103]
  v_cvt_pk_bf16_f32 v116, v160, v161
  v_cvt_pk_bf16_f32 v117, v162, v163
  v_pk_fma_f32 v[104:105], v[44:45], v[88:89], v[72:73] op_sel:[0,0,0] op_sel_hi:[1,0,1] neg_lo:[0,1,0] neg_hi:[0,1,0]
  v_pk_fma_f32 v[106:107], v[46:47], v[88:89], v[74:75] op_sel:[0,0,0] op_sel_hi:[1,0,1] neg_lo:[0,1,0] neg_hi:[0,1,0]
  v_pk_fma_f32 v[176:177], v[176:177], v[88:89], v[104:105] op_sel:[0,1,0] op_sel_hi:[1,1,1]
  v_pk_fma_f32 v[178:179], v[178:179], v[88:89], v[106:107] op_sel:[0,1,0] op_sel_hi:[1,1,1]
  v_pk_mul_f32 v[104:105], v[176:177], v[176:177]
  v_pk_mul_f32 v[106:107], v[178:179], v[178:179]
  v_pk_fma_f32 v[104:105], v[104:105], v[96:97], v[96:97] op_sel:[0,1,0] op_sel_hi:[1,1,0]
  v_pk_fma_f32 v[106:107], v[106:107], v[96:97], v[96:97] op_sel:[0,1,0] op_sel_hi:[1,1,0]
  v_pk_mul_f32 v[104:105], v[104:105], v[176:177]
  v_pk_mul_f32 v[106:107], v[106:107], v[178:179]
  v_exp_f32 v104, v104
  v_exp_f32 v105, v105
  v_exp_f32 v106, v106
  v_exp_f32 v107, v107
  v_pk_add_f32 v[104:105], v[104:105], v[98:99] op_sel_hi:[1,0]
  v_pk_add_f32 v[106:107], v[106:107], v[98:99] op_sel_hi:[1,0]
  v_rcp_f32 v104, v104
  v_rcp_f32 v105, v105
  v_rcp_f32 v106, v106
  v_rcp_f32 v107, v107
  v_pk_mul_f32 v[176:177], v[176:177], v[104:105]
  v_pk_mul_f32 v[178:179], v[178:179], v[106:107]
  v_cvt_pk_bf16_f32 v118, v176, v177
  v_cvt_pk_bf16_f32 v119, v178, v179
  s_add_u32 s3, s10, 49152
  buffer_store_dwordx4 v[116:119], v12, s[44:47], s3 offen sc1
  ds_write_b128 v18, v[116:119] offset:0
  v_pk_fma_f32 v[100:101], v[48:49], v[88:89], v[76:77] op_sel:[0,0,0] op_sel_hi:[1,0,1] neg_lo:[0,1,0] neg_hi:[0,1,0]
  v_pk_fma_f32 v[102:103], v[50:51], v[88:89], v[78:79] op_sel:[0,0,0] op_sel_hi:[1,0,1] neg_lo:[0,1,0] neg_hi:[0,1,0]
  v_pk_fma_f32 v[192:193], v[192:193], v[88:89], v[100:101] op_sel:[0,1,0] op_sel_hi:[1,1,1]
  v_pk_fma_f32 v[194:195], v[194:195], v[88:89], v[102:103] op_sel:[0,1,0] op_sel_hi:[1,1,1]
  v_pk_mul_f32 v[100:101], v[192:193], v[192:193]
  v_pk_mul_f32 v[102:103], v[194:195], v[194:195]
  v_pk_fma_f32 v[100:101], v[100:101], v[96:97], v[96:97] op_sel:[0,1,0] op_sel_hi:[1,1,0]
  v_pk_fma_f32 v[102:103], v[102:103], v[96:97], v[96:97] op_sel:[0,1,0] op_sel_hi:[1,1,0]
  v_pk_mul_f32 v[100:101], v[100:101], v[192:193]
  v_pk_mul_f32 v[102:103], v[102:103], v[194:195]
  v_exp_f32 v100, v100
  v_exp_f32 v101, v101
  v_exp_f32 v102, v102
  v_exp_f32 v103, v103
  v_pk_add_f32 v[100:101], v[100:101], v[98:99] op_sel_hi:[1,0]
  v_pk_add_f32 v[102:103], v[102:103], v[98:99] op_sel_hi:[1,0]
  v_rcp_f32 v100, v100
  v_rcp_f32 v101, v101
  v_rcp_f32 v102, v102
  v_rcp_f32 v103, v103
  v_pk_mul_f32 v[192:193], v[192:193], v[100:101]
  v_pk_mul_f32 v[194:195], v[194:195], v[102:103]
  v_cvt_pk_bf16_f32 v120, v192, v193
  v_cvt_pk_bf16_f32 v121, v194, v195
  v_pk_fma_f32 v[104:105], v[52:53], v[88:89], v[80:81] op_sel:[0,0,0] op_sel_hi:[1,0,1] neg_lo:[0,1,0] neg_hi:[0,1,0]
  v_pk_fma_f32 v[106:107], v[54:55], v[88:89], v[82:83] op_sel:[0,0,0] op_sel_hi:[1,0,1] neg_lo:[0,1,0] neg_hi:[0,1,0]
  v_pk_fma_f32 v[208:209], v[208:209], v[88:89], v[104:105] op_sel:[0,1,0] op_sel_hi:[1,1,1]
  v_pk_fma_f32 v[210:211], v[210:211], v[88:89], v[106:107] op_sel:[0,1,0] op_sel_hi:[1,1,1]
  v_pk_mul_f32 v[104:105], v[208:209], v[208:209]
  v_pk_mul_f32 v[106:107], v[210:211], v[210:211]
  v_pk_fma_f32 v[104:105], v[104:105], v[96:97], v[96:97] op_sel:[0,1,0] op_sel_hi:[1,1,0]
  v_pk_fma_f32 v[106:107], v[106:107], v[96:97], v[96:97] op_sel:[0,1,0] op_sel_hi:[1,1,0]
  v_pk_mul_f32 v[104:105], v[104:105], v[208:209]
  v_pk_mul_f32 v[106:107], v[106:107], v[210:211]
  v_exp_f32 v104, v104
  v_exp_f32 v105, v105
  v_exp_f32 v106, v106
  v_exp_f32 v107, v107
  v_pk_add_f32 v[104:105], v[104:105], v[98:99] op_sel_hi:[1,0]
  v_pk_add_f32 v[106:107], v[106:107], v[98:99] op_sel_hi:[1,0]
  v_rcp_f32 v104, v104
  v_rcp_f32 v105, v105
  v_rcp_f32 v106, v106
  v_rcp_f32 v107, v107
  v_pk_mul_f32 v[208:209], v[208:209], v[104:105]
  v_pk_mul_f32 v[210:211], v[210:211], v[106:107]
  v_cvt_pk_bf16_f32 v122, v208, v209
  v_cvt_pk_bf16_f32 v123, v210, v211
  s_add_u32 s3, s10, 51200
  buffer_store_dwordx4 v[120:123], v12, s[44:47], s3 offen sc1
  ds_write_b128 v18, v[120:123] offset:16384
  v_pk_fma_f32 v[100:101], v[40:41], v[90:91], v[68:69] op_sel:[0,0,0] op_sel_hi:[1,0,1] neg_lo:[0,1,0] neg_hi:[0,1,0]
  v_pk_fma_f32 v[102:103], v[42:43], v[90:91], v[70:71] op_sel:[0,0,0] op_sel_hi:[1,0,1] neg_lo:[0,1,0] neg_hi:[0,1,0]
  v_pk_fma_f32 v[164:165], v[164:165], v[90:91], v[100:101] op_sel:[0,1,0] op_sel_hi:[1,1,1]
  v_pk_fma_f32 v[166:167], v[166:167], v[90:91], v[102:103] op_sel:[0,1,0] op_sel_hi:[1,1,1]
  v_pk_mul_f32 v[100:101], v[164:165], v[164:165]
  v_pk_mul_f32 v[102:103], v[166:167], v[166:167]
  v_pk_fma_f32 v[100:101], v[100:101], v[96:97], v[96:97] op_sel:[0,1,0] op_sel_hi:[1,1,0]
  v_pk_fma_f32 v[102:103], v[102:103], v[96:97], v[96:97] op_sel:[0,1,0] op_sel_hi:[1,1,0]
  v_pk_mul_f32 v[100:101], v[100:101], v[164:165]
  v_pk_mul_f32 v[102:103], v[102:103], v[166:167]
  v_exp_f32 v100, v100
  v_exp_f32 v101, v101
  v_exp_f32 v102, v102
  v_exp_f32 v103, v103
  v_pk_add_f32 v[100:101], v[100:101], v[98:99] op_sel_hi:[1,0]
  v_pk_add_f32 v[102:103], v[102:103], v[98:99] op_sel_hi:[1,0]
  v_rcp_f32 v100, v100
  v_rcp_f32 v101, v101
  v_rcp_f32 v102, v102
  v_rcp_f32 v103, v103
  v_pk_mul_f32 v[164:165], v[164:165], v[100:101]
  v_pk_mul_f32 v[166:167], v[166:167], v[102:103]
  v_cvt_pk_bf16_f32 v108, v164, v165
  v_cvt_pk_bf16_f32 v109, v166, v167
  v_pk_fma_f32 v[104:105], v[44:45], v[90:91], v[72:73] op_sel:[0,0,0] op_sel_hi:[1,0,1] neg_lo:[0,1,0] neg_hi:[0,1,0]
  v_pk_fma_f32 v[106:107], v[46:47], v[90:91], v[74:75] op_sel:[0,0,0] op_sel_hi:[1,0,1] neg_lo:[0,1,0] neg_hi:[0,1,0]
  v_pk_fma_f32 v[180:181], v[180:181], v[90:91], v[104:105] op_sel:[0,1,0] op_sel_hi:[1,1,1]
  v_pk_fma_f32 v[182:183], v[182:183], v[90:91], v[106:107] op_sel:[0,1,0] op_sel_hi:[1,1,1]
  v_pk_mul_f32 v[104:105], v[180:181], v[180:181]
  v_pk_mul_f32 v[106:107], v[182:183], v[182:183]
  v_pk_fma_f32 v[104:105], v[104:105], v[96:97], v[96:97] op_sel:[0,1,0] op_sel_hi:[1,1,0]
  v_pk_fma_f32 v[106:107], v[106:107], v[96:97], v[96:97] op_sel:[0,1,0] op_sel_hi:[1,1,0]
  v_pk_mul_f32 v[104:105], v[104:105], v[180:181]
  v_pk_mul_f32 v[106:107], v[106:107], v[182:183]
  v_exp_f32 v104, v104
  v_exp_f32 v105, v105
  v_exp_f32 v106, v106
  v_exp_f32 v107, v107
  v_pk_add_f32 v[104:105], v[104:105], v[98:99] op_sel_hi:[1,0]
  v_pk_add_f32 v[106:107], v[106:107], v[98:99] op_sel_hi:[1,0]
  v_rcp_f32 v104, v104
  v_rcp_f32 v105, v105
  v_rcp_f32 v106, v106
  v_rcp_f32 v107, v107
  v_pk_mul_f32 v[180:181], v[180:181], v[104:105]
  v_pk_mul_f32 v[182:183], v[182:183], v[106:107]
  v_cvt_pk_bf16_f32 v110, v180, v181
  v_cvt_pk_bf16_f32 v111, v182, v183
  s_add_u32 s3, s10, 163840
  buffer_store_dwordx4 v[108:111], v12, s[44:47], s3 offen sc1
  ds_write_b128 v18, v[108:111] offset:2048
  v_pk_fma_f32 v[100:101], v[48:49], v[90:91], v[76:77] op_sel:[0,0,0] op_sel_hi:[1,0,1] neg_lo:[0,1,0] neg_hi:[0,1,0]
  v_pk_fma_f32 v[102:103], v[50:51], v[90:91], v[78:79] op_sel:[0,0,0] op_sel_hi:[1,0,1] neg_lo:[0,1,0] neg_hi:[0,1,0]
  v_pk_fma_f32 v[196:197], v[196:197], v[90:91], v[100:101] op_sel:[0,1,0] op_sel_hi:[1,1,1]
  v_pk_fma_f32 v[198:199], v[198:199], v[90:91], v[102:103] op_sel:[0,1,0] op_sel_hi:[1,1,1]
  v_pk_mul_f32 v[100:101], v[196:197], v[196:197]
  v_pk_mul_f32 v[102:103], v[198:199], v[198:199]
  v_pk_fma_f32 v[100:101], v[100:101], v[96:97], v[96:97] op_sel:[0,1,0] op_sel_hi:[1,1,0]
  v_pk_fma_f32 v[102:103], v[102:103], v[96:97], v[96:97] op_sel:[0,1,0] op_sel_hi:[1,1,0]
  v_pk_mul_f32 v[100:101], v[100:101], v[196:197]
  v_pk_mul_f32 v[102:103], v[102:103], v[198:199]
  v_exp_f32 v100, v100
  v_exp_f32 v101, v101
  v_exp_f32 v102, v102
  v_exp_f32 v103, v103
  v_pk_add_f32 v[100:101], v[100:101], v[98:99] op_sel_hi:[1,0]
  v_pk_add_f32 v[102:103], v[102:103], v[98:99] op_sel_hi:[1,0]
  v_rcp_f32 v100, v100
  v_rcp_f32 v101, v101
  v_rcp_f32 v102, v102
  v_rcp_f32 v103, v103
  v_pk_mul_f32 v[196:197], v[196:197], v[100:101]
  v_pk_mul_f32 v[198:199], v[198:199], v[102:103]
  v_cvt_pk_bf16_f32 v112, v196, v197
  v_cvt_pk_bf16_f32 v113, v198, v199
  v_pk_fma_f32 v[104:105], v[52:53], v[90:91], v[80:81] op_sel:[0,0,0] op_sel_hi:[1,0,1] neg_lo:[0,1,0] neg_hi:[0,1,0]
  v_pk_fma_f32 v[106:107], v[54:55], v[90:91], v[82:83] op_sel:[0,0,0] op_sel_hi:[1,0,1] neg_lo:[0,1,0] neg_hi:[0,1,0]
  v_pk_fma_f32 v[212:213], v[212:213], v[90:91], v[104:105] op_sel:[0,1,0] op_sel_hi:[1,1,1]
  v_pk_fma_f32 v[214:215], v[214:215], v[90:91], v[106:107] op_sel:[0,1,0] op_sel_hi:[1,1,1]
  v_pk_mul_f32 v[104:105], v[212:213], v[212:213]
  v_pk_mul_f32 v[106:107], v[214:215], v[214:215]
  v_pk_fma_f32 v[104:105], v[104:105], v[96:97], v[96:97] op_sel:[0,1,0] op_sel_hi:[1,1,0]
  v_pk_fma_f32 v[106:107], v[106:107], v[96:97], v[96:97] op_sel:[0,1,0] op_sel_hi:[1,1,0]
  v_pk_mul_f32 v[104:105], v[104:105], v[212:213]
  v_pk_mul_f32 v[106:107], v[106:107], v[214:215]
  v_exp_f32 v104, v104
  v_exp_f32 v105, v105
  v_exp_f32 v106, v106
  v_exp_f32 v107, v107
  v_pk_add_f32 v[104:105], v[104:105], v[98:99] op_sel_hi:[1,0]
  v_pk_add_f32 v[106:107], v[106:107], v[98:99] op_sel_hi:[1,0]
  v_rcp_f32 v104, v104
  v_rcp_f32 v105, v105
  v_rcp_f32 v106, v106
  v_rcp_f32 v107, v107
  v_pk_mul_f32 v[212:213], v[212:213], v[104:105]
  v_pk_mul_f32 v[214:215], v[214:215], v[106:107]
  v_cvt_pk_bf16_f32 v114, v212, v213
  v_cvt_pk_bf16_f32 v115, v214, v215
  s_add_u32 s3, s10, 165888
  buffer_store_dwordx4 v[112:115], v12, s[44:47], s3 offen sc1
  ds_write_b128 v18, v[112:115] offset:18432
  v_pk_fma_f32 v[100:101], v[40:41], v[92:93], v[68:69] op_sel:[0,0,0] op_sel_hi:[1,0,1] neg_lo:[0,1,0] neg_hi:[0,1,0]
  v_pk_fma_f32 v[102:103], v[42:43], v[92:93], v[70:71] op_sel:[0,0,0] op_sel_hi:[1,0,1] neg_lo:[0,1,0] neg_hi:[0,1,0]
  v_pk_fma_f32 v[168:169], v[168:169], v[92:93], v[100:101] op_sel:[0,1,0] op_sel_hi:[1,1,1]
  v_pk_fma_f32 v[170:171], v[170:171], v[92:93], v[102:103] op_sel:[0,1,0] op_sel_hi:[1,1,1]
  v_pk_mul_f32 v[100:101], v[168:169], v[168:169]
  v_pk_mul_f32 v[102:103], v[170:171], v[170:171]
  v_pk_fma_f32 v[100:101], v[100:101], v[96:97], v[96:97] op_sel:[0,1,0] op_sel_hi:[1,1,0]
  v_pk_fma_f32 v[102:103], v[102:103], v[96:97], v[96:97] op_sel:[0,1,0] op_sel_hi:[1,1,0]
  v_pk_mul_f32 v[100:101], v[100:101], v[168:169]
  v_pk_mul_f32 v[102:103], v[102:103], v[170:171]
  v_exp_f32 v100, v100
  v_exp_f32 v101, v101
  v_exp_f32 v102, v102
  v_exp_f32 v103, v103
  v_pk_add_f32 v[100:101], v[100:101], v[98:99] op_sel_hi:[1,0]
  v_pk_add_f32 v[102:103], v[102:103], v[98:99] op_sel_hi:[1,0]
  v_rcp_f32 v100, v100
  v_rcp_f32 v101, v101
  v_rcp_f32 v102, v102
  v_rcp_f32 v103, v103
  v_pk_mul_f32 v[168:169], v[168:169], v[100:101]
  v_pk_mul_f32 v[170:171], v[170:171], v[102:103]
  v_cvt_pk_bf16_f32 v116, v168, v169
  v_cvt_pk_bf16_f32 v117, v170, v171
  v_pk_fma_f32 v[104:105], v[44:45], v[92:93], v[72:73] op_sel:[0,0,0] op_sel_hi:[1,0,1] neg_lo:[0,1,0] neg_hi:[0,1,0]
  v_pk_fma_f32 v[106:107], v[46:47], v[92:93], v[74:75] op_sel:[0,0,0] op_sel_hi:[1,0,1] neg_lo:[0,1,0] neg_hi:[0,1,0]
  v_pk_fma_f32 v[184:185], v[184:185], v[92:93], v[104:105] op_sel:[0,1,0] op_sel_hi:[1,1,1]
  v_pk_fma_f32 v[186:187], v[186:187], v[92:93], v[106:107] op_sel:[0,1,0] op_sel_hi:[1,1,1]
  v_pk_mul_f32 v[104:105], v[184:185], v[184:185]
  v_pk_mul_f32 v[106:107], v[186:187], v[186:187]
  v_pk_fma_f32 v[104:105], v[104:105], v[96:97], v[96:97] op_sel:[0,1,0] op_sel_hi:[1,1,0]
  v_pk_fma_f32 v[106:107], v[106:107], v[96:97], v[96:97] op_sel:[0,1,0] op_sel_hi:[1,1,0]
  v_pk_mul_f32 v[104:105], v[104:105], v[184:185]
  v_pk_mul_f32 v[106:107], v[106:107], v[186:187]
  v_exp_f32 v104, v104
  v_exp_f32 v105, v105
  v_exp_f32 v106, v106
  v_exp_f32 v107, v107
  v_pk_add_f32 v[104:105], v[104:105], v[98:99] op_sel_hi:[1,0]
  v_pk_add_f32 v[106:107], v[106:107], v[98:99] op_sel_hi:[1,0]
  v_rcp_f32 v104, v104
  v_rcp_f32 v105, v105
  v_rcp_f32 v106, v106
  v_rcp_f32 v107, v107
  v_pk_mul_f32 v[184:185], v[184:185], v[104:105]
  v_pk_mul_f32 v[186:187], v[186:187], v[106:107]
  v_cvt_pk_bf16_f32 v118, v184, v185
  v_cvt_pk_bf16_f32 v119, v186, v187
  s_add_u32 s3, s10, 278528
  buffer_store_dwordx4 v[116:119], v12, s[44:47], s3 offen sc1
  ds_write_b128 v18, v[116:119] offset:4096
  v_pk_fma_f32 v[100:101], v[48:49], v[92:93], v[76:77] op_sel:[0,0,0] op_sel_hi:[1,0,1] neg_lo:[0,1,0] neg_hi:[0,1,0]
  v_pk_fma_f32 v[102:103], v[50:51], v[92:93], v[78:79] op_sel:[0,0,0] op_sel_hi:[1,0,1] neg_lo:[0,1,0] neg_hi:[0,1,0]
  v_pk_fma_f32 v[200:201], v[200:201], v[92:93], v[100:101] op_sel:[0,1,0] op_sel_hi:[1,1,1]
  v_pk_fma_f32 v[202:203], v[202:203], v[92:93], v[102:103] op_sel:[0,1,0] op_sel_hi:[1,1,1]
  v_pk_mul_f32 v[100:101], v[200:201], v[200:201]
  v_pk_mul_f32 v[102:103], v[202:203], v[202:203]
  v_pk_fma_f32 v[100:101], v[100:101], v[96:97], v[96:97] op_sel:[0,1,0] op_sel_hi:[1,1,0]
  v_pk_fma_f32 v[102:103], v[102:103], v[96:97], v[96:97] op_sel:[0,1,0] op_sel_hi:[1,1,0]
  v_pk_mul_f32 v[100:101], v[100:101], v[200:201]
  v_pk_mul_f32 v[102:103], v[102:103], v[202:203]
  v_exp_f32 v100, v100
  v_exp_f32 v101, v101
  v_exp_f32 v102, v102
  v_exp_f32 v103, v103
  v_pk_add_f32 v[100:101], v[100:101], v[98:99] op_sel_hi:[1,0]
  v_pk_add_f32 v[102:103], v[102:103], v[98:99] op_sel_hi:[1,0]
  v_rcp_f32 v100, v100
  v_rcp_f32 v101, v101
  v_rcp_f32 v102, v102
  v_rcp_f32 v103, v103
  v_pk_mul_f32 v[200:201], v[200:201], v[100:101]
  v_pk_mul_f32 v[202:203], v[202:203], v[102:103]
  v_cvt_pk_bf16_f32 v120, v200, v201
  v_cvt_pk_bf16_f32 v121, v202, v203
  v_pk_fma_f32 v[104:105], v[52:53], v[92:93], v[80:81] op_sel:[0,0,0] op_sel_hi:[1,0,1] neg_lo:[0,1,0] neg_hi:[0,1,0]
  v_pk_fma_f32 v[106:107], v[54:55], v[92:93], v[82:83] op_sel:[0,0,0] op_sel_hi:[1,0,1] neg_lo:[0,1,0] neg_hi:[0,1,0]
  v_pk_fma_f32 v[216:217], v[216:217], v[92:93], v[104:105] op_sel:[0,1,0] op_sel_hi:[1,1,1]
  v_pk_fma_f32 v[218:219], v[218:219], v[92:93], v[106:107] op_sel:[0,1,0] op_sel_hi:[1,1,1]
  v_pk_mul_f32 v[104:105], v[216:217], v[216:217]
  v_pk_mul_f32 v[106:107], v[218:219], v[218:219]
  v_pk_fma_f32 v[104:105], v[104:105], v[96:97], v[96:97] op_sel:[0,1,0] op_sel_hi:[1,1,0]
  v_pk_fma_f32 v[106:107], v[106:107], v[96:97], v[96:97] op_sel:[0,1,0] op_sel_hi:[1,1,0]
  v_pk_mul_f32 v[104:105], v[104:105], v[216:217]
  v_pk_mul_f32 v[106:107], v[106:107], v[218:219]
  v_exp_f32 v104, v104
  v_exp_f32 v105, v105
  v_exp_f32 v106, v106
  v_exp_f32 v107, v107
  v_pk_add_f32 v[104:105], v[104:105], v[98:99] op_sel_hi:[1,0]
  v_pk_add_f32 v[106:107], v[106:107], v[98:99] op_sel_hi:[1,0]
  v_rcp_f32 v104, v104
  v_rcp_f32 v105, v105
  v_rcp_f32 v106, v106
  v_rcp_f32 v107, v107
  v_pk_mul_f32 v[216:217], v[216:217], v[104:105]
  v_pk_mul_f32 v[218:219], v[218:219], v[106:107]
  v_cvt_pk_bf16_f32 v122, v216, v217
  v_cvt_pk_bf16_f32 v123, v218, v219
  s_add_u32 s3, s10, 280576
  buffer_store_dwordx4 v[120:123], v12, s[44:47], s3 offen sc1
  ds_write_b128 v18, v[120:123] offset:20480
  v_pk_fma_f32 v[100:101], v[40:41], v[94:95], v[68:69] op_sel:[0,0,0] op_sel_hi:[1,0,1] neg_lo:[0,1,0] neg_hi:[0,1,0]
  v_pk_fma_f32 v[102:103], v[42:43], v[94:95], v[70:71] op_sel:[0,0,0] op_sel_hi:[1,0,1] neg_lo:[0,1,0] neg_hi:[0,1,0]
  v_pk_fma_f32 v[172:173], v[172:173], v[94:95], v[100:101] op_sel:[0,1,0] op_sel_hi:[1,1,1]
  v_pk_fma_f32 v[174:175], v[174:175], v[94:95], v[102:103] op_sel:[0,1,0] op_sel_hi:[1,1,1]
  v_pk_mul_f32 v[100:101], v[172:173], v[172:173]
  v_pk_mul_f32 v[102:103], v[174:175], v[174:175]
  v_pk_fma_f32 v[100:101], v[100:101], v[96:97], v[96:97] op_sel:[0,1,0] op_sel_hi:[1,1,0]
  v_pk_fma_f32 v[102:103], v[102:103], v[96:97], v[96:97] op_sel:[0,1,0] op_sel_hi:[1,1,0]
  v_pk_mul_f32 v[100:101], v[100:101], v[172:173]
  v_pk_mul_f32 v[102:103], v[102:103], v[174:175]
  v_exp_f32 v100, v100
  v_exp_f32 v101, v101
  v_exp_f32 v102, v102
  v_exp_f32 v103, v103
  v_pk_add_f32 v[100:101], v[100:101], v[98:99] op_sel_hi:[1,0]
  v_pk_add_f32 v[102:103], v[102:103], v[98:99] op_sel_hi:[1,0]
  v_rcp_f32 v100, v100
  v_rcp_f32 v101, v101
  v_rcp_f32 v102, v102
  v_rcp_f32 v103, v103
  v_pk_mul_f32 v[172:173], v[172:173], v[100:101]
  v_pk_mul_f32 v[174:175], v[174:175], v[102:103]
  v_cvt_pk_bf16_f32 v108, v172, v173
  v_cvt_pk_bf16_f32 v109, v174, v175
  v_pk_fma_f32 v[104:105], v[44:45], v[94:95], v[72:73] op_sel:[0,0,0] op_sel_hi:[1,0,1] neg_lo:[0,1,0] neg_hi:[0,1,0]
  v_pk_fma_f32 v[106:107], v[46:47], v[94:95], v[74:75] op_sel:[0,0,0] op_sel_hi:[1,0,1] neg_lo:[0,1,0] neg_hi:[0,1,0]
  v_pk_fma_f32 v[188:189], v[188:189], v[94:95], v[104:105] op_sel:[0,1,0] op_sel_hi:[1,1,1]
  v_pk_fma_f32 v[190:191], v[190:191], v[94:95], v[106:107] op_sel:[0,1,0] op_sel_hi:[1,1,1]
  v_pk_mul_f32 v[104:105], v[188:189], v[188:189]
  v_pk_mul_f32 v[106:107], v[190:191], v[190:191]
  v_pk_fma_f32 v[104:105], v[104:105], v[96:97], v[96:97] op_sel:[0,1,0] op_sel_hi:[1,1,0]
  v_pk_fma_f32 v[106:107], v[106:107], v[96:97], v[96:97] op_sel:[0,1,0] op_sel_hi:[1,1,0]
  v_pk_mul_f32 v[104:105], v[104:105], v[188:189]
  v_pk_mul_f32 v[106:107], v[106:107], v[190:191]
  v_exp_f32 v104, v104
  v_exp_f32 v105, v105
  v_exp_f32 v106, v106
  v_exp_f32 v107, v107
  v_pk_add_f32 v[104:105], v[104:105], v[98:99] op_sel_hi:[1,0]
  v_pk_add_f32 v[106:107], v[106:107], v[98:99] op_sel_hi:[1,0]
  v_rcp_f32 v104, v104
  v_rcp_f32 v105, v105
  v_rcp_f32 v106, v106
  v_rcp_f32 v107, v107
  v_pk_mul_f32 v[188:189], v[188:189], v[104:105]
  v_pk_mul_f32 v[190:191], v[190:191], v[106:107]
  v_cvt_pk_bf16_f32 v110, v188, v189
  v_cvt_pk_bf16_f32 v111, v190, v191
  s_add_u32 s3, s10, 393216
  buffer_store_dwordx4 v[108:111], v12, s[44:47], s3 offen sc1
  ds_write_b128 v18, v[108:111] offset:6144
  v_pk_fma_f32 v[100:101], v[48:49], v[94:95], v[76:77] op_sel:[0,0,0] op_sel_hi:[1,0,1] neg_lo:[0,1,0] neg_hi:[0,1,0]
  v_pk_fma_f32 v[102:103], v[50:51], v[94:95], v[78:79] op_sel:[0,0,0] op_sel_hi:[1,0,1] neg_lo:[0,1,0] neg_hi:[0,1,0]
  v_pk_fma_f32 v[204:205], v[204:205], v[94:95], v[100:101] op_sel:[0,1,0] op_sel_hi:[1,1,1]
  v_pk_fma_f32 v[206:207], v[206:207], v[94:95], v[102:103] op_sel:[0,1,0] op_sel_hi:[1,1,1]
  v_pk_mul_f32 v[100:101], v[204:205], v[204:205]
  v_pk_mul_f32 v[102:103], v[206:207], v[206:207]
  v_pk_fma_f32 v[100:101], v[100:101], v[96:97], v[96:97] op_sel:[0,1,0] op_sel_hi:[1,1,0]
  v_pk_fma_f32 v[102:103], v[102:103], v[96:97], v[96:97] op_sel:[0,1,0] op_sel_hi:[1,1,0]
  v_pk_mul_f32 v[100:101], v[100:101], v[204:205]
  v_pk_mul_f32 v[102:103], v[102:103], v[206:207]
  v_exp_f32 v100, v100
  v_exp_f32 v101, v101
  v_exp_f32 v102, v102
  v_exp_f32 v103, v103
  v_pk_add_f32 v[100:101], v[100:101], v[98:99] op_sel_hi:[1,0]
  v_pk_add_f32 v[102:103], v[102:103], v[98:99] op_sel_hi:[1,0]
  v_rcp_f32 v100, v100
  v_rcp_f32 v101, v101
  v_rcp_f32 v102, v102
  v_rcp_f32 v103, v103
  v_pk_mul_f32 v[204:205], v[204:205], v[100:101]
  v_pk_mul_f32 v[206:207], v[206:207], v[102:103]
  v_cvt_pk_bf16_f32 v112, v204, v205
  v_cvt_pk_bf16_f32 v113, v206, v207
  v_pk_fma_f32 v[104:105], v[52:53], v[94:95], v[80:81] op_sel:[0,0,0] op_sel_hi:[1,0,1] neg_lo:[0,1,0] neg_hi:[0,1,0]
  v_pk_fma_f32 v[106:107], v[54:55], v[94:95], v[82:83] op_sel:[0,0,0] op_sel_hi:[1,0,1] neg_lo:[0,1,0] neg_hi:[0,1,0]
  v_pk_fma_f32 v[220:221], v[220:221], v[94:95], v[104:105] op_sel:[0,1,0] op_sel_hi:[1,1,1]
  v_pk_fma_f32 v[222:223], v[222:223], v[94:95], v[106:107] op_sel:[0,1,0] op_sel_hi:[1,1,1]
  v_pk_mul_f32 v[104:105], v[220:221], v[220:221]
  v_pk_mul_f32 v[106:107], v[222:223], v[222:223]
  v_pk_fma_f32 v[104:105], v[104:105], v[96:97], v[96:97] op_sel:[0,1,0] op_sel_hi:[1,1,0]
  v_pk_fma_f32 v[106:107], v[106:107], v[96:97], v[96:97] op_sel:[0,1,0] op_sel_hi:[1,1,0]
  v_pk_mul_f32 v[104:105], v[104:105], v[220:221]
  v_pk_mul_f32 v[106:107], v[106:107], v[222:223]
  v_exp_f32 v104, v104
  v_exp_f32 v105, v105
  v_exp_f32 v106, v106
  v_exp_f32 v107, v107
  v_pk_add_f32 v[104:105], v[104:105], v[98:99] op_sel_hi:[1,0]
  v_pk_add_f32 v[106:107], v[106:107], v[98:99] op_sel_hi:[1,0]
  v_rcp_f32 v104, v104
  v_rcp_f32 v105, v105
  v_rcp_f32 v106, v106
  v_rcp_f32 v107, v107
  v_pk_mul_f32 v[220:221], v[220:221], v[104:105]
  v_pk_mul_f32 v[222:223], v[222:223], v[106:107]
  v_cvt_pk_bf16_f32 v114, v220, v221
  v_cvt_pk_bf16_f32 v115, v222, v223
  s_add_u32 s3, s10, 395264
  buffer_store_dwordx4 v[112:115], v12, s[44:47], s3 offen sc1
  ds_write_b128 v18, v[112:115] offset:22528
  s_waitcnt vmcnt(0) lgkmcnt(0)
  s_barrier
  s_add_u32 s97, s97, 1
  s_branch L_w2_body
L_w1_c1:
L_w2_c0:
L_w2_body:
  s_cmp_ge_u32 s2, 256
  s_cbranch_scc1 L_w2_end
  v_lshrrev_b32 v2, 6, v0
  v_and_b32 v1, 63, v0
  v_readfirstlane_b32 s70, v2
  s_and_b32 s3, s2, 7
  s_lshr_b32 s99, s2, 3
  s_and_b32 s5, s3, 3
  s_lshl_b32 s5, s5, 2
  s_and_b32 s6, s99, 3
  s_add_u32 s68, s5, s6
  s_lshr_b32 s5, s3, 2
  s_lshr_b32 s78, s99, 2
  s_lshl1_add_u32 s69, s78, s5
  s_add_u32 s3, s68, s78
  s_lshl_b32 s3, s3, 3
  s_lshl_b32 s85, 0xffff02, s3
  s_sub_u32 s3, 0, s3
  s_lshr_b32 s3, 0xffff02, s3
  s_or_b32 s85, s85, s3
  s_cmp_lt_u32 s70, 4
  s_cbranch_scc1 L_w2_compute
L_w2_loader:
  s_add_u32 s3, s68, s78
  s_and_b32 s3, s3, 3
  s_mov_b32 s4, 0x1616160
  s_cmp_eq_u32 s3, 1
  s_cselect_b32 s4, 0x5858580, s4
  s_cmp_eq_u32 s3, 2
  s_cselect_b32 s4, 0x16161600, s4
  s_cmp_eq_u32 s3, 3
  s_cselect_b32 s4, 0x58585800, s4
  v_subrev_u32 v2, 3, v1
  v_min_u32 v2, 16, v2
  v_lshlrev_b32 v3, 1, v2
  v_bfe_i32 v16, s4, v3, 2
  v_sub_u32 v16, v1, v16
  v_subrev_u32 v16, 7, v16
  v_ashrrev_i32 v3, 1, v16
  v_cmp_eq_u32 vcc, s78, v3
  s_and_b32 s3, s69, 1
  v_or_b32 v2, 14, v16
  v_cndmask_b32 v2, v16, v2, vcc
  v_cmp_gt_i32 vcc, 0, v16
  s_lshl2_add_u32 s4, s3, 20
  v_add_u32 v16, s4, v16
  s_lshl4_add_u32 s4, s3, 24
  v_add_u32 v2, s4, v2
  v_cndmask_b32 v16, v2, v16, vcc
  s_and_b32 s5, s68, 3
  s_mul_i32 s5, s5, 3
  s_sub_u32 s5, s5, 23
  v_add_u32 v3, s5, v1
  v_subrev_u32 v2, 10, v3
  v_min_u32 v3, v3, v2
  v_subrev_u32 v2, 10, v3
  v_min_u32 v3, v3, v2
  v_cmp_gt_u32 vcc, 23, v1
  s_sub_u32 s5, s3, 46
  v_lshl_add_u32 v2, v1, 1, s5
  v_cndmask_b32 v3, v3, v2, vcc
  s_add_u32 s5, s78, 3
  v_ashrrev_i32 v2, 1, v3
  v_add_u32 v2, s5, v2
  v_and_b32 v2, 7, v2
  v_and_b32 v3, 1, v3
  v_cmp_gt_u32 vcc, 21, v1
  v_lshl_add_u32 v3, v3, 3, v2
  s_lshl1_add_u32 s4, s78, s4
  s_lshl3_add_u32 s3, s3, s78
  v_cndmask_b32 v3, v3, v16, vcc
  v_writelane_b32 v3, s4, 0
  s_add_u32 s4, s4, 1
  v_writelane_b32 v3, s3, 2
  v_writelane_b32 v3, s4, 1
  v_lshlrev_b32 v16, 17, v3
  s_add_u32 s9, s70, s68
  s_and_b32 s9, s9, 3
  s_lshl_b32 s77, s9, 11
  v_and_b32 v10, 7, v1
  v_lshrrev_b32 v3, 3, v1
  s_lshl_b32 s10, s9, 4
  v_add_u32 v3, s10, v3
  v_mul_u32_u24 v3, 2048, v3
  v_lshrrev_b32 v2, 3, v1
  v_and_b32 v2, 6, v2
  v_xor_b32 v2, v2, v10
  s_lshl_b32 s10, s69, 7
  v_add_u32 v3, s10, v3
  v_lshl_add_u32 v8, v2, 4, v3
  v_add_u32 v3, 16384, v3
  v_lshl_add_u32 v9, v2, 4, v3
  s_mov_b32 s40, s28
  s_and_b32 s41, s29, 0xffff
  s_mov_b32 s42, 7340032
  s_mov_b32 s43, 0x00020000
  s_bitcmp1_b32 s69, 0
  s_mov_b32 s76, 128
  s_cselect_b32 s76, -128, s76
  v_readlane_b32 s74, v16, 0
  s_add_u32 m0, s77, 0
  s_add_u32 s4, s74, s76
  buffer_load_dwordx4 v8, s[40:43], s4 offen lds
  s_add_u32 m0, s77, 1024
  s_nop 0
  buffer_load_dwordx4 v9, s[40:43], s4 offen lds
  s_add_u32 m0, s77, 8192
  s_add_u32 s4, s74, 0
  buffer_load_dwordx4 v8, s[40:43], s4 offen lds
  s_add_u32 m0, s77, 9216
  s_nop 0
  buffer_load_dwordx4 v9, s[40:43], s4 offen lds
  v_readlane_b32 s74, v16, 1
  s_add_u32 m0, s77, 16384
  s_add_u32 s4, s74, s76
  buffer_load_dwordx4 v8, s[40:43], s4 offen lds
  s_add_u32 m0, s77, 17408
  s_nop 0
  buffer_load_dwordx4 v9, s[40:43], s4 offen lds
  s_add_u32 m0, s77, 24576
  s_add_u32 s4, s74, 0
  buffer_load_dwordx4 v8, s[40:43], s4 offen lds
  s_add_u32 m0, s77, 25600
  s_nop 0
  buffer_load_dwordx4 v9, s[40:43], s4 offen lds
  v_readlane_b32 s74, v16, 2
  s_add_u32 m0, s77, 32768
  s_add_u32 s4, s74, s76
  buffer_load_dwordx4 v8, s[40:43], s4 offen lds
  s_add_u32 m0, s77, 33792
  s_nop 0
  buffer_load_dwordx4 v9, s[40:43], s4 offen lds
  s_add_u32 m0, s77, 40960
  s_add_u32 s4, s74, 0
  buffer_load_dwordx4 v8, s[40:43], s4 offen lds
  s_add_u32 m0, s77, 41984
  s_nop 0
  buffer_load_dwordx4 v9, s[40:43], s4 offen lds
  v_readlane_b32 s74, v16, 3
  s_add_u32 m0, s77, 49152
  s_add_u32 s4, s74, s76
  buffer_load_dwordx4 v8, s[40:43], s4 offen lds
  s_add_u32 m0, s77, 50176
  s_nop 0
  buffer_load_dwordx4 v9, s[40:43], s4 offen lds
  s_add_u32 m0, s77, 57344
  s_add_u32 s4, s74, 0
  buffer_load_dwordx4 v8, s[40:43], s4 offen lds
  s_add_u32 m0, s77, 58368
  s_nop 0
  buffer_load_dwordx4 v9, s[40:43], s4 offen lds
  v_readlane_b32 s74, v16, 4
  s_add_u32 m0, s77, 65536
  s_add_u32 s4, s74, s76
  buffer_load_dwordx4 v8, s[40:43], s4 offen lds
  s_add_u32 m0, s77, 66560
  s_nop 0
  buffer_load_dwordx4 v9, s[40:43], s4 offen lds
  s_add_u32 m0, s77, 73728
  s_add_u32 s4, s74, 0
  buffer_load_dwordx4 v8, s[40:43], s4 offen lds
  s_add_u32 m0, s77, 74752
  s_nop 0
  buffer_load_dwordx4 v9, s[40:43], s4 offen lds
  s_add_u32 s44, s22, 41943040
  s_addc_u32 s45, s23, 0
  s_and_b32 s45, s45, 0xffff
  s_mov_b32 s46, 524288
  s_mov_b32 s47, 0x00020000
  s_lshl4_add_u32 s3, s97, s68
  s_and_b32 s4, s69, 15
  s_lshl4_add_u32 s3, s3, s4
  s_lshl_b32 s3, s3, 7
  s_sub_u32 s3, s3, 32768
  v_lshlrev_b32 v11, 7, v1
  v_and_b32 v2, 15, v1
  v_lshlrev_b32 v2, 2, v2
  v_mov_b32 v3, 1
  s_mov_b32 s79, 0x100000
  s_cmp_lg_u32 s70, 4
  s_barrier
  s_cbranch_scc1 L_w2_nofl
  s_mov_b32 exec_lo, 0xffff
  s_mov_b32 exec_hi, 0
  buffer_store_dword v3, v11, s[44:47], s87 offen sc1
  s_mov_b64 exec, -1
L_w2_nofl:
  s_mov_b32 s5, s3
  v_readlane_b32 s74, v16, 5
  s_add_u32 m0, s77, 81920
  s_add_u32 s4, s74, s76
  buffer_load_dwordx4 v8, s[40:43], s4 offen lds
  s_add_u32 m0, s77, 82944
  s_nop 0
  buffer_load_dwordx4 v9, s[40:43], s4 offen lds
  s_add_u32 m0, s77, 90112
  s_add_u32 s4, s74, 0
  buffer_load_dwordx4 v8, s[40:43], s4 offen lds
  s_add_u32 m0, s77, 91136
  s_nop 0
  buffer_load_dwordx4 v9, s[40:43], s4 offen lds
  v_readlane_b32 s74, v16, 6
  s_add_u32 m0, s77, 98304
  s_add_u32 s4, s74, s76
  buffer_load_dwordx4 v8, s[40:43], s4 offen lds
  s_add_u32 m0, s77, 99328
  s_nop 0
  buffer_load_dwordx4 v9, s[40:43], s4 offen lds
  s_add_u32 m0, s77, 106496
  s_add_u32 s4, s74, 0
  buffer_load_dwordx4 v8, s[40:43], s4 offen lds
  s_add_u32 m0, s77, 107520
  s_nop 0
  buffer_load_dwordx4 v9, s[40:43], s4 offen lds
  s_waitcnt vmcnt(20)
  s_barrier
  v_readlane_b32 s74, v16, 7
  s_add_u32 m0, s77, 114688
  s_add_u32 s4, s74, s76
  buffer_load_dwordx4 v8, s[40:43], s4 offen lds
  s_add_u32 m0, s77, 115712
  s_nop 0
  buffer_load_dwordx4 v9, s[40:43], s4 offen lds
  s_add_u32 m0, s77, 122880
  s_add_u32 s4, s74, 0
  buffer_load_dwordx4 v8, s[40:43], s4 offen lds
  s_add_u32 m0, s77, 123904
  s_nop 0
  buffer_load_dwordx4 v9, s[40:43], s4 offen lds
  v_readlane_b32 s74, v16, 8
  s_add_u32 m0, s77, 131072
  s_add_u32 s4, s74, s76
  buffer_load_dwordx4 v8, s[40:43], s4 offen lds
  s_add_u32 m0, s77, 132096
  s_nop 0
  buffer_load_dwordx4 v9, s[40:43], s4 offen lds
  s_add_u32 m0, s77, 139264
  s_add_u32 s4, s74, 0
  buffer_load_dwordx4 v8, s[40:43], s4 offen lds
  s_add_u32 m0, s77, 140288
  s_nop 0
  buffer_load_dwordx4 v9, s[40:43], s4 offen lds
  v_readlane_b32 s74, v16, 9
  s_add_u32 m0, s77, 147456
  s_add_u32 s4, s74, s76
  buffer_load_dwordx4 v8, s[40:43], s4 offen lds
  s_add_u32 m0, s77, 148480
  s_nop 0
  buffer_load_dwordx4 v9, s[40:43], s4 offen lds
  s_add_u32 m0, s77, 155648
  s_add_u32 s4, s74, 0
  buffer_load_dwordx4 v8, s[40:43], s4 offen lds
  s_add_u32 m0, s77, 156672
  s_nop 0
  buffer_load_dwordx4 v9, s[40:43], s4 offen lds
  s_mov_b32 s3, s5
  s_cmp_lg_u32 s70, 4
  s_cbranch_scc1 L_w2_dep
L_w2_poll:
  buffer_load_dword v3, v2, s[44:47], s3 offen sc1
  s_sub_u32 s79, s79, 1
  s_cbranch_scc1 L_w2_dep
  s_waitcnt vmcnt(0)
  v_cmp_ne_u32 vcc, 1, v3
  s_cbranch_vccnz L_w2_poll
L_w2_dep:
  s_waitcnt vmcnt(22) lgkmcnt(0)
  s_barrier
  v_readlane_b32 s74, v16, 10
  s_add_u32 m0, s77, 0
  s_add_u32 s4, s74, s76
  buffer_load_dwordx4 v8, s[40:43], s4 offen lds
  s_add_u32 m0, s77, 1024
  s_nop 0
  buffer_load_dwordx4 v9, s[40:43], s4 offen lds
  s_waitcnt vmcnt(4)
  s_add_u32 m0, s77, 8192
  s_add_u32 s4, s74, 0
  buffer_load_dwordx4 v8, s[40:43], s4 offen lds
  s_add_u32 m0, s77, 9216
  s_nop 0
  buffer_load_dwordx4 v9, s[40:43], s4 offen lds
  s_waitcnt vmcnt(4)
  v_readlane_b32 s74, v16, 11
  s_add_u32 m0, s77, 16384
  s_add_u32 s4, s74, s76
  buffer_load_dwordx4 v8, s[40:43], s4 offen lds
  s_add_u32 m0, s77, 17408
  s_nop 0
  buffer_load_dwordx4 v9, s[40:43], s4 offen lds
  s_waitcnt vmcnt(20)
  s_barrier
  s_add_u32 m0, s77, 24576
  s_add_u32 s4, s74, 0
  buffer_load_dwordx4 v8, s[40:43], s4 offen lds
  s_add_u32 m0, s77, 25600
  s_nop 0
  buffer_load_dwordx4 v9, s[40:43], s4 offen lds
  s_waitcnt vmcnt(4)
  v_readlane_b32 s74, v16, 12
  s_add_u32 m0, s77, 32768
  s_add_u32 s4, s74, s76
  buffer_load_dwordx4 v8, s[40:43], s4 offen lds
  s_add_u32 m0, s77, 33792
  s_nop 0
  buffer_load_dwordx4 v9, s[40:43], s4 offen lds
  s_waitcnt vmcnt(4)
  s_add_u32 m0, s77, 40960
  s_add_u32 s4, s74, 0
  buffer_load_dwordx4 v8, s[40:43], s4 offen lds
  s_add_u32 m0, s77, 41984
  s_nop 0
  buffer_load_dwordx4 v9, s[40:43], s4 offen lds
  s_waitcnt vmcnt(4)
  v_readlane_b32 s74, v16, 13
  s_add_u32 m0, s77, 49152
  s_add_u32 s4, s74, s76
  buffer_load_dwordx4 v8, s[40:43], s4 offen lds
  s_add_u32 m0, s77, 50176
  s_nop 0
  buffer_load_dwordx4 v9, s[40:43], s4 offen lds
  s_waitcnt vmcnt(4)
  s_add_u32 m0, s77, 57344
  s_add_u32 s4, s74, 0
  buffer_load_dwordx4 v8, s[40:43], s4 offen lds
  s_add_u32 m0, s77, 58368
  s_nop 0
  buffer_load_dwordx4 v9, s[40:43], s4 offen lds
  s_waitcnt vmcnt(22)
  s_barrier
  v_readlane_b32 s74, v16, 14
  s_add_u32 m0, s77, 65536
  s_add_u32 s4, s74, s76
  buffer_load_dwordx4 v8, s[40:43], s4 offen lds
  s_add_u32 m0, s77, 66560
  s_nop 0
  buffer_load_dwordx4 v9, s[40:43], s4 offen lds
  s_waitcnt vmcnt(4)
  s_add_u32 m0, s77, 73728
  s_add_u32 s4, s74, 0
  buffer_load_dwordx4 v8, s[40:43], s4 offen lds
  s_add_u32 m0, s77, 74752
  s_nop 0
  buffer_load_dwordx4 v9, s[40:43], s4 offen lds
  s_waitcnt vmcnt(4)
  v_readlane_b32 s74, v16, 15
  s_add_u32 m0, s77, 81920
  s_add_u32 s4, s74, s76
  buffer_load_dwordx4 v8, s[40:43], s4 offen lds
  s_add_u32 m0, s77, 82944
  s_nop 0
  buffer_load_dwordx4 v9, s[40:43], s4 offen lds
  s_waitcnt vmcnt(4)
  s_add_u32 m0, s77, 90112
  s_add_u32 s4, s74, 0
  buffer_load_dwordx4 v8, s[40:43], s4 offen lds
  s_add_u32 m0, s77, 91136
  s_nop 0
  buffer_load_dwordx4 v9, s[40:43], s4 offen lds
  s_waitcnt vmcnt(22)
  s_barrier
  v_readlane_b32 s74, v16, 16
  s_add_u32 m0, s77, 98304
  s_add_u32 s4, s74, s76
  buffer_load_dwordx4 v8, s[40:43], s4 offen lds
  s_add_u32 m0, s77, 99328
  s_nop 0
  buffer_load_dwordx4 v9, s[40:43], s4 offen lds
  s_waitcnt vmcnt(4)
  s_add_u32 m0, s77, 106496
  s_add_u32 s4, s74, 0
  buffer_load_dwordx4 v8, s[40:43], s4 offen lds
  s_add_u32 m0, s77, 107520
  s_nop 0
  buffer_load_dwordx4 v9, s[40:43], s4 offen lds
  s_waitcnt vmcnt(4)
  v_readlane_b32 s74, v16, 17
  s_add_u32 m0, s77, 114688
  s_add_u32 s4, s74, s76
  buffer_load_dwordx4 v8, s[40:43], s4 offen lds
  s_add_u32 m0, s77, 115712
  s_nop 0
  buffer_load_dwordx4 v9, s[40:43], s4 offen lds
  s_waitcnt vmcnt(4)
  v_readlane_b32 s74, v16, 18
  s_add_u32 m0, s77, 122880
  s_add_u32 s4, s74, s76
  buffer_load_dwordx4 v8, s[40:43], s4 offen lds
  s_add_u32 m0, s77, 123904
  s_nop 0
  buffer_load_dwordx4 v9, s[40:43], s4 offen lds
  s_waitcnt vmcnt(22)
  s_barrier
  v_readlane_b32 s74, v16, 19
  s_add_u32 m0, s77, 131072
  s_add_u32 s4, s74, s76
  buffer_load_dwordx4 v8, s[40:43], s4 offen lds
  s_add_u32 m0, s77, 132096
  s_nop 0
  buffer_load_dwordx4 v9, s[40:43], s4 offen lds
  s_waitcnt vmcnt(4)
  v_readlane_b32 s74, v16, 20
  s_add_u32 m0, s77, 139264
  s_add_u32 s4, s74, s76
  buffer_load_dwordx4 v8, s[40:43], s4 offen lds
  s_add_u32 m0, s77, 140288
  s_nop 0
  buffer_load_dwordx4 v9, s[40:43], s4 offen lds
  s_waitcnt vmcnt(4)
  v_readlane_b32 s74, v16, 21
  s_add_u32 m0, s77, 147456
  s_add_u32 s4, s74, s76
  buffer_load_dwordx4 v8, s[40:43], s4 offen lds
  s_add_u32 m0, s77, 148480
  s_nop 0
  buffer_load_dwordx4 v9, s[40:43], s4 offen lds
  s_waitcnt vmcnt(4)
  v_readlane_b32 s74, v16, 22
  s_add_u32 m0, s77, 155648
  s_add_u32 s4, s74, s76
  buffer_load_dwordx4 v8, s[40:43], s4 offen lds
  s_add_u32 m0, s77, 156672
  s_nop 0
  buffer_load_dwordx4 v9, s[40:43], s4 offen lds
  s_waitcnt vmcnt(22)
  s_barrier
  v_readlane_b32 s74, v16, 17
  s_add_u32 m0, s77, 0
  s_add_u32 s4, s74, 0
  buffer_load_dwordx4 v8, s[40:43], s4 offen lds
  s_add_u32 m0, s77, 1024
  s_nop 0
  buffer_load_dwordx4 v9, s[40:43], s4 offen lds
  s_waitcnt vmcnt(4)
  v_readlane_b32 s74, v16, 18
  s_add_u32 m0, s77, 8192
  s_add_u32 s4, s74, 0
  buffer_load_dwordx4 v8, s[40:43], s4 offen lds
  s_add_u32 m0, s77, 9216
  s_nop 0
  buffer_load_dwordx4 v9, s[40:43], s4 offen lds
  s_waitcnt vmcnt(4)
  v_readlane_b32 s74, v16, 19
  s_add_u32 m0, s77, 16384
  s_add_u32 s4, s74, 0
  buffer_load_dwordx4 v8, s[40:43], s4 offen lds
  s_add_u32 m0, s77, 17408
  s_nop 0
  buffer_load_dwordx4 v9, s[40:43], s4 offen lds
  s_waitcnt vmcnt(4)
  v_readlane_b32 s74, v16, 20
  s_add_u32 m0, s77, 24576
  s_add_u32 s4, s74, 0
  buffer_load_dwordx4 v8, s[40:43], s4 offen lds
  s_add_u32 m0, s77, 25600
  s_nop 0
  buffer_load_dwordx4 v9, s[40:43], s4 offen lds
  s_waitcnt vmcnt(22)
  s_barrier
  v_readlane_b32 s74, v16, 21
  s_add_u32 m0, s77, 32768
  s_add_u32 s4, s74, 0
  buffer_load_dwordx4 v8, s[40:43], s4 offen lds
  s_add_u32 m0, s77, 33792
  s_nop 0
  buffer_load_dwordx4 v9, s[40:43], s4 offen lds
  s_waitcnt vmcnt(4)
  v_readlane_b32 s74, v16, 22
  s_add_u32 m0, s77, 40960
  s_add_u32 s4, s74, 0
  buffer_load_dwordx4 v8, s[40:43], s4 offen lds
  s_add_u32 m0, s77, 41984
  s_nop 0
  buffer_load_dwordx4 v9, s[40:43], s4 offen lds
  s_waitcnt vmcnt(4)
  v_readlane_b32 s74, v16, 23
  s_add_u32 m0, s77, 49152
  s_add_u32 s4, s74, 0
  buffer_load_dwordx4 v8, s[40:43], s4 offen lds
  s_add_u32 m0, s77, 50176
  s_nop 0
  buffer_load_dwordx4 v9, s[40:43], s4 offen lds
  s_waitcnt vmcnt(4)
  v_readlane_b32 s74, v16, 24
  s_add_u32 m0, s77, 57344
  s_add_u32 s4, s74, 0
  buffer_load_dwordx4 v8, s[40:43], s4 offen lds
  s_add_u32 m0, s77, 58368
  s_nop 0
  buffer_load_dwordx4 v9, s[40:43], s4 offen lds
  s_waitcnt vmcnt(22)
  s_barrier
  v_readlane_b32 s74, v16, 25
  s_add_u32 m0, s77, 65536
  s_add_u32 s4, s74, 0
  buffer_load_dwordx4 v8, s[40:43], s4 offen lds
  s_add_u32 m0, s77, 66560
  s_nop 0
  buffer_load_dwordx4 v9, s[40:43], s4 offen lds
  s_waitcnt vmcnt(4)
  v_readlane_b32 s74, v16, 26
  s_add_u32 m0, s77, 73728
  s_add_u32 s4, s74, 0
  buffer_load_dwordx4 v8, s[40:43], s4 offen lds
  s_add_u32 m0, s77, 74752
  s_nop 0
  buffer_load_dwordx4 v9, s[40:43], s4 offen lds
  s_waitcnt vmcnt(4)
  v_readlane_b32 s74, v16, 27
  s_add_u32 m0, s77, 81920
  s_add_u32 s4, s74, 0
  buffer_load_dwordx4 v8, s[40:43], s4 offen lds
  s_add_u32 m0, s77, 82944
  s_nop 0
  buffer_load_dwordx4 v9, s[40:43], s4 offen lds
  s_waitcnt vmcnt(4)
  v_readlane_b32 s74, v16, 28
  s_add_u32 m0, s77, 90112
  s_add_u32 s4, s74, 0
  buffer_load_dwordx4 v8, s[40:43], s4 offen lds
  s_add_u32 m0, s77, 91136
  s_nop 0
  buffer_load_dwordx4 v9, s[40:43], s4 offen lds
  s_waitcnt vmcnt(22)
  s_barrier
  v_readlane_b32 s74, v16, 29
  s_add_u32 m0, s77, 98304
  s_add_u32 s4, s74, 0
  buffer_load_dwordx4 v8, s[40:43], s4 offen lds
  s_add_u32 m0, s77, 99328
  s_nop 0
  buffer_load_dwordx4 v9, s[40:43], s4 offen lds
  s_waitcnt vmcnt(4)
  v_readlane_b32 s74, v16, 30
  s_add_u32 m0, s77, 106496
  s_add_u32 s4, s74, 0
  buffer_load_dwordx4 v8, s[40:43], s4 offen lds
  s_add_u32 m0, s77, 107520
  s_nop 0
  buffer_load_dwordx4 v9, s[40:43], s4 offen lds
  s_waitcnt vmcnt(4)
  v_readlane_b32 s74, v16, 31
  s_add_u32 m0, s77, 114688
  s_add_u32 s4, s74, 0
  buffer_load_dwordx4 v8, s[40:43], s4 offen lds
  s_add_u32 m0, s77, 115712
  s_nop 0
  buffer_load_dwordx4 v9, s[40:43], s4 offen lds
  s_waitcnt vmcnt(4)
  v_readlane_b32 s74, v16, 32
  s_add_u32 m0, s77, 122880
  s_add_u32 s4, s74, 0
  buffer_load_dwordx4 v8, s[40:43], s4 offen lds
  s_add_u32 m0, s77, 123904
  s_nop 0
  buffer_load_dwordx4 v9, s[40:43], s4 offen lds
  s_waitcnt vmcnt(22)
  s_barrier
  s_add_u32 s64, s22, 41943040
  s_addc_u32 s65, s23, 0
  s_and_b32 s65, s65, 0xffff
  s_mov_b32 s66, 524288
  s_mov_b32 s67, 0x00020000
  s_lshl4_add_u32 s6, s68, s69
  s_xor_b32 s6, s6, 1
  s_add_u32 s7, s96, 4
  s_lshl_b32 s7, s7, 8
  s_add_u32 s6, s6, s7
  s_lshl_b32 s6, s6, 8
  v_and_b32 v2, 3, v1
  v_lshlrev_b32 v2, 6, v2
  s_mov_b32 s79, 0x100000
  s_waitcnt vmcnt(8)
  s_barrier
  s_cmp_lg_u32 s70, 4
  s_cbranch_scc1 L_w2_xgo
  s_setprio 3
L_w2_xpoll:
  buffer_load_dword v5, v2, s[64:67], s6 offen sc1
  s_sub_u32 s79, s79, 1
  s_cbranch_scc1 L_w2_xgo
  s_waitcnt vmcnt(0)
  v_cmp_ne_u32 vcc, 1, v5
  s_cbranch_vccnz L_w2_xpoll
L_w2_xgo:
  s_setprio 0
  s_waitcnt vmcnt(0)
  s_barrier
  s_cmp_eq_u32 s96, 1
  s_cbranch_scc1 L_w2_end
  s_lshl_b32 s87, s97, 15
  s_lshl_b32 s4, s68, 11
  s_add_u32 s87, s87, s4
  s_lshl_b32 s4, s69, 2
  s_add_u32 s87, s87, s4
  s_mov_b32 s96, 1
  s_add_u32 s12, s22, 33554432
  s_addc_u32 s13, s23, 0
  s_add_u32 s34, s22, 67108864
  s_addc_u32 s35, s23, 0
  s_add_u32 s97, s97, 1
  s_branch L_attn_body
L_w2_end:
  s_endpgm
L_w2_compute:
  s_lshl_b32 s3, s70, 12
  s_add_u32 s3, s3, 114688
  v_lshl_add_u32 v2, v1, 4, s3
  ds_read_b128 v[32:35], v2 offset:0
  ds_read_b128 v[36:39], v2 offset:2048
  ds_read_b128 v[40:43], v2 offset:1024
  ds_read_b128 v[44:47], v2 offset:3072
  ds_read_b128 v[48:51], v2 offset:16384
  ds_read_b128 v[52:55], v2 offset:18432
  ds_read_b128 v[56:59], v2 offset:17408
  ds_read_b128 v[60:63], v2 offset:19456
  ds_read_b128 v[64:67], v2 offset:32768
  ds_read_b128 v[68:71], v2 offset:34816
  ds_read_b128 v[72:75], v2 offset:33792
  ds_read_b128 v[76:79], v2 offset:35840
  s_add_u32 s3, s68, s78
  s_and_b32 s3, s3, 3
  s_mov_b32 s4, 0x1616160
  s_cmp_eq_u32 s3, 1
  s_cselect_b32 s4, 0x5858580, s4
  s_cmp_eq_u32 s3, 2
  s_cselect_b32 s4, 0x16161600, s4
  s_cmp_eq_u32 s3, 3
  s_cselect_b32 s4, 0x58585800, s4
  v_subrev_u32 v2, 3, v1
  v_min_u32 v2, 16, v2
  v_lshlrev_b32 v3, 1, v2
  v_bfe_i32 v15, s4, v3, 2
  v_sub_u32 v15, v1, v15
  v_subrev_u32 v15, 7, v15
  v_ashrrev_i32 v3, 1, v15
  v_cmp_eq_u32 vcc, s78, v3
  s_and_b32 s3, s69, 1
  v_or_b32 v2, 14, v15
  v_cndmask_b32 v2, v15, v2, vcc
  v_cmp_gt_i32 vcc, 0, v15
  s_lshl2_add_u32 s4, s3, 20
  v_add_u32 v15, s4, v15
  s_lshl4_add_u32 s4, s3, 24
  v_add_u32 v2, s4, v2
  v_cndmask_b32 v15, v2, v15, vcc
  s_and_b32 s5, s68, 3
  s_mul_i32 s5, s5, 3
  s_sub_u32 s5, s5, 23
  v_add_u32 v3, s5, v1
  v_subrev_u32 v2, 10, v3
  v_min_u32 v3, v3, v2
  v_subrev_u32 v2, 10, v3
  v_min_u32 v3, v3, v2
  v_cmp_gt_u32 vcc, 23, v1
  s_sub_u32 s5, s3, 46
  v_lshl_add_u32 v2, v1, 1, s5
  v_cndmask_b32 v3, v3, v2, vcc
  s_add_u32 s5, s78, 3
  v_ashrrev_i32 v2, 1, v3
  v_add_u32 v2, s5, v2
  v_and_b32 v2, 7, v2
  v_and_b32 v3, 1, v3
  v_cmp_gt_u32 vcc, 21, v1
  v_lshl_add_u32 v3, v3, 3, v2
  s_lshl1_add_u32 s4, s78, s4
  s_lshl3_add_u32 s3, s3, s78
  v_cndmask_b32 v3, v3, v15, vcc
  v_writelane_b32 v3, s4, 0
  s_add_u32 s4, s4, 1
  v_writelane_b32 v3, s3, 2
  v_writelane_b32 v3, s4, 1
  v_lshlrev_b32 v15, 11, v3
  s_waitcnt lgkmcnt(0)
  s_barrier
  v_and_b32 v3, 15, v1
  v_lshrrev_b32 v2, 4, v1
  s_lshl_b32 s8, s68, 7
  s_lshl_b32 s9, s70, 5
  s_add_u32 s8, s8, s9
  s_mul_i32 s9, s8, 7168
  v_add_u32 v13, s8, v3
  s_lshl_b32 s10, s69, 7
  v_lshl_add_u32 v14, v2, 3, s10
  v_and_b32 v16, 1, v2
  v_lshrrev_b32 v17, 1, v2
  v_lshlrev_b32 v16, 5, v16
  v_lshl_add_u32 v16, v17, 4, v16
  v_lshlrev_b32 v4, 3, v3
  v_and_b32 v4, 0x70, v4
  v_xor_b32 v4, v4, v16
  v_lshl_add_u32 v4, v3, 7, v4
  s_lshl_b32 s3, s70, 12
  v_add_u32 v4, s3, v4
  v_xor_b32 v5, 64, v4
  v_add_u32 v16, s10, v16
  s_cmp_eq_u32 s96, 0
  s_cselect_b32 s7, 128, 0
  s_add_u32 s7, s7, 2048
  v_mad_u32_u24 v12, v13, s7, v16
  v_lshl_add_u32 v18, v17, 4, v13
  v_lshlrev_b32 v18, 3, v18
  v_and_b32 v16, 1, v2
  v_lshl_add_u32 v18, v16, 2, v18
  s_lshl_b32 s10, s69, 14
  v_add_u32 v18, s10, v18
  v_lshrrev_b32 v6, 2, v1
  v_lshlrev_b32 v6, 7, v6
  v_and_b32 v17, 3, v1
  v_lshl_add_u32 v6, v17, 3, v6
  v_bfe_u32 v17, v1, 3, 2
  v_lshl_add_u32 v6, v17, 5, v6
  v_xor_b32 v7, 32, v6
  v_xor_b32 v8, 64, v6
  v_xor_b32 v9, 96, v6
  s_mov_b32 s11, 0xffff0000
  s_add_u32 s36, s34, 8388608
  s_addc_u32 s37, s35, 0
  s_and_b32 s37, s37, 0xffff
  s_mov_b32 s38, 14680064
  s_mov_b32 s39, 0x00020000
  s_mov_b32 s44, s32
  s_and_b32 s45, s33, 0xffff
  s_mov_b32 s46, 4194304
  s_mov_b32 s47, 0x00020000
  s_add_u32 s48, s22, 33554432
  s_addc_u32 s49, s23, 0
  s_and_b32 s49, s49, 0xffff
  s_mov_b32 s50, 4194304
  s_mov_b32 s51, 0x00020000
  s_cmp_eq_u32 s96, 0
  s_cselect_b64 s[44:45], s[48:49], s[44:45]
  s_lshl_b32 s46, s7, 11
  s_add_u32 s56, s34, 24379392
  s_addc_u32 s57, s35, 0
  s_and_b32 s57, s57, 0xffff
  s_mov_b32 s58, 262144
  s_mov_b32 s59, 0x00020000
  s_mul_i32 s9, s8, 7168
  s_add_u32 s36, s36, s9
  s_addc_u32 s37, s37, 0x100000
  s_add_u32 s64, s36, 114688
  s_addc_u32 s65, s37, 0
  s_mov_b32 s38, 114688
  s_mov_b32 s39, 0x00800000
  s_mov_b32 s66, 114688
  s_mov_b32 s67, 0x00800000
  s_add_u32 s60, s34, 25165824
  s_addc_u32 s61, s35, 0
  s_and_b32 s61, s61, 0xffff
  s_mov_b32 s62, 4194304
  s_mov_b32 s63, 0x00020000
  s_or_b32 s61, s61, 0x100000
  s_mov_b32 s63, 0x00800000
  s_lshl4_add_u32 s4, s68, s69
  s_lshl2_add_u32 s4, s4, s70
  s_add_u32 s52, s22, 41943040
  s_addc_u32 s53, s23, 0
  s_and_b32 s53, s53, 0xffff
  s_mov_b32 s54, 524288
  s_mov_b32 s55, 0x00020000
  s_add_u32 s6, s96, 4
  s_lshl_b32 s6, s6, 10
  s_add_u32 s6, s6, s4
  s_lshl_b32 s6, s6, 6
  v_mov_b32 v19, 1
  s_lshl_b32 s4, s4, 12
  s_xor_b32 s5, s4, 16384
  v_add_u32 v26, 131072, v6
  v_add_u32 v27, 131072, v7
  v_add_u32 v28, 131072, v8
  v_add_u32 v29, 131072, v9
  v_add_u32 v20, 65536, v6
  v_add_u32 v21, 65536, v7
  v_add_u32 v22, 65536, v8
  v_add_u32 v23, 65536, v9
  v_readlane_b32 s51, v15, 3
  v_readlane_b32 s48, v15, 4
  v_readlane_b32 s49, v15, 5
  s_waitcnt lgkmcnt(0)
  ds_read_b64_tr_b16 v[160:161], v6 offset:0
  ds_read_b64_tr_b16 v[162:163], v6 offset:2048
  ds_read_b64_tr_b16 v[164:165], v7 offset:0
  ds_read_b64_tr_b16 v[166:167], v7 offset:2048
  ds_read_b64_tr_b16 v[168:169], v8 offset:0
  ds_read_b64_tr_b16 v[170:171], v8 offset:2048
  ds_read_b64_tr_b16 v[172:173], v9 offset:0
  ds_read_b64_tr_b16 v[174:175], v9 offset:2048
  ds_read_b64_tr_b16 v[176:177], v6 offset:4096
  ds_read_b64_tr_b16 v[178:179], v6 offset:6144
  ds_read_b64_tr_b16 v[180:181], v7 offset:4096
  ds_read_b64_tr_b16 v[182:183], v7 offset:6144
  ds_read_b64_tr_b16 v[184:185], v8 offset:4096
  ds_read_b64_tr_b16 v[186:187], v8 offset:6144
  ds_read_b64_tr_b16 v[188:189], v9 offset:4096
  ds_read_b64_tr_b16 v[190:191], v9 offset:6144
  v_lshlrev_b32 v216, 16, v10
  v_and_b32 v217, s11, v10
  v_lshlrev_b32 v218, 16, v11
  v_and_b32 v219, s11, v11
  v_lshlrev_b32 v96, 16, v240
  v_and_b32 v97, s11, v240
  v_pk_add_f32 v[96:97], v[96:97], v[216:217]
  v_lshlrev_b32 v98, 16, v241
  v_and_b32 v99, s11, v241
  v_pk_add_f32 v[98:99], v[98:99], v[218:219]
  v_lshlrev_b32 v100, 16, v248
  v_and_b32 v101, s11, v248
  v_pk_add_f32 v[100:101], v[100:101], v[216:217]
  v_lshlrev_b32 v102, 16, v249
  v_and_b32 v103, s11, v249
  v_pk_add_f32 v[102:103], v[102:103], v[218:219]
  v_lshlrev_b32 v216, 16, v24
  v_and_b32 v217, s11, v24
  v_lshlrev_b32 v218, 16, v25
  v_and_b32 v219, s11, v25
  v_lshlrev_b32 v104, 16, v242
  v_and_b32 v105, s11, v242
  v_pk_add_f32 v[104:105], v[104:105], v[216:217]
  v_lshlrev_b32 v106, 16, v243
  v_and_b32 v107, s11, v243
  v_pk_add_f32 v[106:107], v[106:107], v[218:219]
  v_lshlrev_b32 v108, 16, v250
  v_and_b32 v109, s11, v250
  v_pk_add_f32 v[108:109], v[108:109], v[216:217]
  v_lshlrev_b32 v110, 16, v251
  v_and_b32 v111, s11, v251
  v_pk_add_f32 v[110:111], v[110:111], v[218:219]
  v_lshlrev_b32 v216, 16, v124
  v_and_b32 v217, s11, v124
  v_lshlrev_b32 v218, 16, v125
  v_and_b32 v219, s11, v125
  v_lshlrev_b32 v112, 16, v244
  v_and_b32 v113, s11, v244
  v_pk_add_f32 v[112:113], v[112:113], v[216:217]
  v_lshlrev_b32 v114, 16, v245
  v_and_b32 v115, s11, v245
  v_pk_add_f32 v[114:115], v[114:115], v[218:219]
  v_lshlrev_b32 v116, 16, v252
  v_and_b32 v117, s11, v252
  v_pk_add_f32 v[116:117], v[116:117], v[216:217]
  v_lshlrev_b32 v118, 16, v253
  v_and_b32 v119, s11, v253
  v_pk_add_f32 v[118:119], v[118:119], v[218:219]
  v_lshlrev_b32 v216, 16, v126
  v_and_b32 v217, s11, v126
  v_lshlrev_b32 v218, 16, v127
  v_and_b32 v219, s11, v127
  v_lshlrev_b32 v120, 16, v246
  v_and_b32 v121, s11, v246
  v_pk_add_f32 v[120:121], v[120:121], v[216:217]
  v_lshlrev_b32 v122, 16, v247
  v_and_b32 v123, s11, v247
  v_pk_add_f32 v[122:123], v[122:123], v[218:219]
  v_lshlrev_b32 v124, 16, v254
  v_and_b32 v125, s11, v254
  v_pk_add_f32 v[124:125], v[124:125], v[216:217]
  v_lshlrev_b32 v126, 16, v255
  v_and_b32 v127, s11, v255
  v_pk_add_f32 v[126:127], v[126:127], v[218:219]
  s_waitcnt lgkmcnt(8)
  v_mfma_f32_16x16x32_bf16 v[128:131], v[160:163], v[32:35], 0
  ds_read_b64_tr_b16 v[192:193], v6 offset:8192
  v_mfma_f32_16x16x32_bf16 v[132:135], v[160:163], v[36:39], 0
  ds_read_b64_tr_b16 v[194:195], v6 offset:10240
  v_mfma_f32_16x16x32_bf16 v[140:143], v[164:167], v[36:39], 0
  ds_read_b64_tr_b16 v[196:197], v7 offset:8192
  v_mfma_f32_16x16x32_bf16 v[136:139], v[164:167], v[32:35], 0
  ds_read_b64_tr_b16 v[198:199], v7 offset:10240
  v_mfma_f32_16x16x32_bf16 v[144:147], v[168:171], v[32:35], 0
  ds_read_b64_tr_b16 v[200:201], v8 offset:8192
  v_mfma_f32_16x16x32_bf16 v[148:151], v[168:171], v[36:39], 0
  ds_read_b64_tr_b16 v[202:203], v8 offset:10240
  v_mfma_f32_16x16x32_bf16 v[156:159], v[172:175], v[36:39], 0
  ds_read_b64_tr_b16 v[204:205], v9 offset:8192
  v_mfma_f32_16x16x32_bf16 v[152:155], v[172:175], v[32:35], 0
  ds_read_b64_tr_b16 v[206:207], v9 offset:10240
  s_waitcnt lgkmcnt(8)
  v_mfma_f32_16x16x32_bf16 v[128:131], v[176:179], v[40:43], v[128:131]
  ds_read_b64_tr_b16 v[208:209], v6 offset:12288
  v_mfma_f32_16x16x32_bf16 v[132:135], v[176:179], v[44:47], v[132:135]
  ds_read_b64_tr_b16 v[210:211], v6 offset:14336
  v_mfma_f32_16x16x32_bf16 v[140:143], v[180:183], v[44:47], v[140:143]
  ds_read_b64_tr_b16 v[212:213], v7 offset:12288
  v_mfma_f32_16x16x32_bf16 v[136:139], v[180:183], v[40:43], v[136:139]
  ds_read_b64_tr_b16 v[214:215], v7 offset:14336
  v_mfma_f32_16x16x32_bf16 v[144:147], v[184:187], v[40:43], v[144:147]
  ds_read_b64_tr_b16 v[216:217], v8 offset:12288
  v_mfma_f32_16x16x32_bf16 v[148:151], v[184:187], v[44:47], v[148:151]
  ds_read_b64_tr_b16 v[218:219], v8 offset:14336
  v_mfma_f32_16x16x32_bf16 v[156:159], v[188:191], v[44:47], v[156:159]
  ds_read_b64_tr_b16 v[220:221], v9 offset:12288
  v_mfma_f32_16x16x32_bf16 v[152:155], v[188:191], v[40:43], v[152:155]
  ds_read_b64_tr_b16 v[222:223], v9 offset:14336
  s_waitcnt lgkmcnt(8)
  v_mfma_f32_16x16x32_bf16 v[96:99], v[192:195], v[32:35], v[96:99]
  ds_read_b64_tr_b16 v[160:161], v6 offset:16384
  v_mfma_f32_16x16x32_bf16 v[100:103], v[192:195], v[36:39], v[100:103]
  ds_read_b64_tr_b16 v[162:163], v6 offset:18432
  v_mfma_f32_16x16x32_bf16 v[108:111], v[196:199], v[36:39], v[108:111]
  ds_read_b64_tr_b16 v[164:165], v7 offset:16384
  v_mfma_f32_16x16x32_bf16 v[104:107], v[196:199], v[32:35], v[104:107]
  ds_read_b64_tr_b16 v[166:167], v7 offset:18432
  v_mfma_f32_16x16x32_bf16 v[112:115], v[200:203], v[32:35], v[112:115]
  ds_read_b64_tr_b16 v[168:169], v8 offset:16384
  v_mfma_f32_16x16x32_bf16 v[116:119], v[200:203], v[36:39], v[116:119]
  ds_read_b64_tr_b16 v[170:171], v8 offset:18432
  v_mfma_f32_16x16x32_bf16 v[124:127], v[204:207], v[36:39], v[124:127]
  ds_read_b64_tr_b16 v[172:173], v9 offset:16384
  v_mfma_f32_16x16x32_bf16 v[120:123], v[204:207], v[32:35], v[120:123]
  ds_read_b64_tr_b16 v[174:175], v9 offset:18432
  s_waitcnt lgkmcnt(8)
  v_mfma_f32_16x16x32_bf16 v[96:99], v[208:211], v[40:43], v[96:99]
  ds_read_b64_tr_b16 v[176:177], v6 offset:20480
  v_mfma_f32_16x16x32_bf16 v[100:103], v[208:211], v[44:47], v[100:103]
  ds_read_b64_tr_b16 v[178:179], v6 offset:22528
  v_mfma_f32_16x16x32_bf16 v[108:111], v[212:215], v[44:47], v[108:111]
  ds_read_b64_tr_b16 v[180:181], v7 offset:20480
  v_mfma_f32_16x16x32_bf16 v[104:107], v[212:215], v[40:43], v[104:107]
  ds_read_b64_tr_b16 v[182:183], v7 offset:22528
  v_mfma_f32_16x16x32_bf16 v[112:115], v[216:219], v[40:43], v[112:115]
  ds_read_b64_tr_b16 v[184:185], v8 offset:20480
  v_mfma_f32_16x16x32_bf16 v[116:119], v[216:219], v[44:47], v[116:119]
  ds_read_b64_tr_b16 v[186:187], v8 offset:22528
  v_mfma_f32_16x16x32_bf16 v[124:127], v[220:223], v[44:47], v[124:127]
  ds_read_b64_tr_b16 v[188:189], v9 offset:20480
  v_mfma_f32_16x16x32_bf16 v[120:123], v[220:223], v[40:43], v[120:123]
  ds_read_b64_tr_b16 v[190:191], v9 offset:22528
  s_waitcnt lgkmcnt(8)
  v_mfma_f32_16x16x32_bf16 v[128:131], v[160:163], v[48:51], v[128:131]
  ds_read_b64_tr_b16 v[192:193], v6 offset:24576
  v_mfma_f32_16x16x32_bf16 v[132:135], v[160:163], v[52:55], v[132:135]
  ds_read_b64_tr_b16 v[194:195], v6 offset:26624
  v_mfma_f32_16x16x32_bf16 v[140:143], v[164:167], v[52:55], v[140:143]
  ds_read_b64_tr_b16 v[196:197], v7 offset:24576
  v_mfma_f32_16x16x32_bf16 v[136:139], v[164:167], v[48:51], v[136:139]
  ds_read_b64_tr_b16 v[198:199], v7 offset:26624
  v_mfma_f32_16x16x32_bf16 v[144:147], v[168:171], v[48:51], v[144:147]
  ds_read_b64_tr_b16 v[200:201], v8 offset:24576
  v_mfma_f32_16x16x32_bf16 v[148:151], v[168:171], v[52:55], v[148:151]
  ds_read_b64_tr_b16 v[202:203], v8 offset:26624
  v_mfma_f32_16x16x32_bf16 v[156:159], v[172:175], v[52:55], v[156:159]
  ds_read_b64_tr_b16 v[204:205], v9 offset:24576
  v_mfma_f32_16x16x32_bf16 v[152:155], v[172:175], v[48:51], v[152:155]
  ds_read_b64_tr_b16 v[206:207], v9 offset:26624
  s_waitcnt lgkmcnt(8)
  s_barrier
  buffer_load_dwordx4 v[80:83], off, s[36:39], s51 offset:0
  buffer_load_dwordx4 v[84:87], off, s[64:67], s51 offset:0
  buffer_load_dwordx4 v[88:91], off, s[36:39], s51 offset:1024
  buffer_load_dwordx4 v[92:95], off, s[64:67], s51 offset:1024
  buffer_load_dwordx4 v[224:227], off, s[36:39], s48 offset:0
  buffer_load_dwordx4 v[228:231], off, s[64:67], s48 offset:0
  buffer_load_dwordx4 v[232:235], off, s[36:39], s48 offset:1024
  buffer_load_dwordx4 v[236:239], off, s[64:67], s48 offset:1024
  buffer_load_dwordx4 v[240:243], off, s[36:39], s49 offset:0
  buffer_load_dwordx4 v[244:247], off, s[64:67], s49 offset:0
  buffer_load_dwordx4 v[248:251], off, s[36:39], s49 offset:1024
  buffer_load_dwordx4 v[252:255], off, s[64:67], s49 offset:1024
  v_mfma_f32_16x16x32_bf16 v[128:131], v[176:179], v[56:59], v[128:131]
  ds_read_b64_tr_b16 v[208:209], v6 offset:28672
  v_readlane_b32 s50, v15, 6
  v_mfma_f32_16x16x32_bf16 v[132:135], v[176:179], v[60:63], v[132:135]
  ds_read_b64_tr_b16 v[210:211], v6 offset:30720
  v_mfma_f32_16x16x32_bf16 v[140:143], v[180:183], v[60:63], v[140:143]
  ds_read_b64_tr_b16 v[212:213], v7 offset:28672
  v_mfma_f32_16x16x32_bf16 v[136:139], v[180:183], v[56:59], v[136:139]
  buffer_load_dwordx4 v[32:35], off, s[36:39], s50 offset:0
  v_mfma_f32_16x16x32_bf16 v[144:147], v[184:187], v[56:59], v[144:147]
  ds_read_b64_tr_b16 v[214:215], v7 offset:30720
  ds_read_b64_tr_b16 v[216:217], v8 offset:28672
  v_mfma_f32_16x16x32_bf16 v[148:151], v[184:187], v[60:63], v[148:151]
  ds_read_b64_tr_b16 v[218:219], v8 offset:30720
  ds_read_b64_tr_b16 v[220:221], v9 offset:28672
  v_mfma_f32_16x16x32_bf16 v[156:159], v[188:191], v[60:63], v[156:159]
  buffer_load_dwordx4 v[36:39], off, s[64:67], s50 offset:0
  v_mfma_f32_16x16x32_bf16 v[152:155], v[188:191], v[56:59], v[152:155]
  ds_read_b64_tr_b16 v[222:223], v9 offset:30720
  s_waitcnt lgkmcnt(8)
  v_mfma_f32_16x16x32_bf16 v[96:99], v[192:195], v[48:51], v[96:99]
  ds_read_b64_tr_b16 v[160:161], v6 offset:32768
  v_mfma_f32_16x16x32_bf16 v[100:103], v[192:195], v[52:55], v[100:103]
  buffer_load_dwordx4 v[40:43], off, s[36:39], s50 offset:1024
  v_mfma_f32_16x16x32_bf16 v[108:111], v[196:199], v[52:55], v[108:111]
  ds_read_b64_tr_b16 v[162:163], v6 offset:34816
  ds_read_b64_tr_b16 v[164:165], v7 offset:32768
  v_mfma_f32_16x16x32_bf16 v[104:107], v[196:199], v[48:51], v[104:107]
  ds_read_b64_tr_b16 v[166:167], v7 offset:34816
  v_mfma_f32_16x16x32_bf16 v[112:115], v[200:203], v[48:51], v[112:115]
  buffer_load_dwordx4 v[44:47], off, s[64:67], s50 offset:1024
  v_mfma_f32_16x16x32_bf16 v[116:119], v[200:203], v[52:55], v[116:119]
  ds_read_b64_tr_b16 v[168:169], v8 offset:32768
  ds_read_b64_tr_b16 v[170:171], v8 offset:34816
  v_mfma_f32_16x16x32_bf16 v[124:127], v[204:207], v[52:55], v[124:127]
  ds_read_b64_tr_b16 v[172:173], v9 offset:32768
  v_mfma_f32_16x16x32_bf16 v[120:123], v[204:207], v[48:51], v[120:123]
  ds_read_b64_tr_b16 v[174:175], v9 offset:34816
  s_waitcnt lgkmcnt(8)
  v_mfma_f32_16x16x32_bf16 v[96:99], v[208:211], v[56:59], v[96:99]
  ds_read_b64_tr_b16 v[176:177], v6 offset:36864
  v_mfma_f32_16x16x32_bf16 v[100:103], v[208:211], v[60:63], v[100:103]
  ds_read_b64_tr_b16 v[178:179], v6 offset:38912
  v_mfma_f32_16x16x32_bf16 v[108:111], v[212:215], v[60:63], v[108:111]
  ds_read_b64_tr_b16 v[180:181], v7 offset:36864
  v_mfma_f32_16x16x32_bf16 v[104:107], v[212:215], v[56:59], v[104:107]
  ds_read_b64_tr_b16 v[182:183], v7 offset:38912
  v_mfma_f32_16x16x32_bf16 v[112:115], v[216:219], v[56:59], v[112:115]
  ds_read_b64_tr_b16 v[184:185], v8 offset:36864
  v_mfma_f32_16x16x32_bf16 v[116:119], v[216:219], v[60:63], v[116:119]
  ds_read_b64_tr_b16 v[186:187], v8 offset:38912
  v_readlane_b32 s51, v15, 7
  v_mfma_f32_16x16x32_bf16 v[124:127], v[220:223], v[60:63], v[124:127]
  ds_read_b64_tr_b16 v[188:189], v9 offset:36864
  v_mfma_f32_16x16x32_bf16 v[120:123], v[220:223], v[56:59], v[120:123]
  ds_read_b64_tr_b16 v[190:191], v9 offset:38912
  s_waitcnt lgkmcnt(8)
  v_mfma_f32_16x16x32_bf16 v[128:131], v[160:163], v[64:67], v[128:131]
  buffer_load_dwordx4 v[48:51], off, s[36:39], s51 offset:0
  v_mfma_f32_16x16x32_bf16 v[132:135], v[160:163], v[68:71], v[132:135]
  ds_read_b64_tr_b16 v[192:193], v6 offset:40960
  ds_read_b64_tr_b16 v[194:195], v6 offset:43008
  v_mfma_f32_16x16x32_bf16 v[140:143], v[164:167], v[68:71], v[140:143]
  ds_read_b64_tr_b16 v[196:197], v7 offset:40960
  v_mfma_f32_16x16x32_bf16 v[136:139], v[164:167], v[64:67], v[136:139]
  buffer_load_dwordx4 v[52:55], off, s[64:67], s51 offset:0
  v_mfma_f32_16x16x32_bf16 v[144:147], v[168:171], v[64:67], v[144:147]
  ds_read_b64_tr_b16 v[198:199], v7 offset:43008
  ds_read_b64_tr_b16 v[200:201], v8 offset:40960
  v_mfma_f32_16x16x32_bf16 v[148:151], v[168:171], v[68:71], v[148:151]
  ds_read_b64_tr_b16 v[202:203], v8 offset:43008
  ds_read_b64_tr_b16 v[204:205], v9 offset:40960
  v_mfma_f32_16x16x32_bf16 v[156:159], v[172:175], v[68:71], v[156:159]
  buffer_load_dwordx4 v[56:59], off, s[36:39], s51 offset:1024
  v_mfma_f32_16x16x32_bf16 v[152:155], v[172:175], v[64:67], v[152:155]
  ds_read_b64_tr_b16 v[206:207], v9 offset:43008
  s_waitcnt lgkmcnt(8)
  v_mfma_f32_16x16x32_bf16 v[128:131], v[176:179], v[72:75], v[128:131]
  ds_read_b64_tr_b16 v[208:209], v6 offset:45056
  v_mfma_f32_16x16x32_bf16 v[132:135], v[176:179], v[76:79], v[132:135]
  buffer_load_dwordx4 v[60:63], off, s[64:67], s51 offset:1024
  v_mfma_f32_16x16x32_bf16 v[140:143], v[180:183], v[76:79], v[140:143]
  ds_read_b64_tr_b16 v[210:211], v6 offset:47104
  ds_read_b64_tr_b16 v[212:213], v7 offset:45056
  v_mfma_f32_16x16x32_bf16 v[136:139], v[180:183], v[72:75], v[136:139]
  ds_read_b64_tr_b16 v[214:215], v7 offset:47104
  v_mfma_f32_16x16x32_bf16 v[144:147], v[184:187], v[72:75], v[144:147]
  ds_read_b64_tr_b16 v[216:217], v8 offset:45056
  v_mfma_f32_16x16x32_bf16 v[148:151], v[184:187], v[76:79], v[148:151]
  ds_read_b64_tr_b16 v[218:219], v8 offset:47104
  v_mfma_f32_16x16x32_bf16 v[156:159], v[188:191], v[76:79], v[156:159]
  ds_read_b64_tr_b16 v[220:221], v9 offset:45056
  v_mfma_f32_16x16x32_bf16 v[152:155], v[188:191], v[72:75], v[152:155]
  ds_read_b64_tr_b16 v[222:223], v9 offset:47104
  s_waitcnt lgkmcnt(8)
  v_mfma_f32_16x16x32_bf16 v[96:99], v[192:195], v[64:67], v[96:99]
  ds_read_b64_tr_b16 v[160:161], v6 offset:49152
  v_mfma_f32_16x16x32_bf16 v[100:103], v[192:195], v[68:71], v[100:103]
  ds_read_b64_tr_b16 v[162:163], v6 offset:51200
  v_mfma_f32_16x16x32_bf16 v[108:111], v[196:199], v[68:71], v[108:111]
  ds_read_b64_tr_b16 v[164:165], v7 offset:49152
  v_mfma_f32_16x16x32_bf16 v[104:107], v[196:199], v[64:67], v[104:107]
  ds_read_b64_tr_b16 v[166:167], v7 offset:51200
  v_mfma_f32_16x16x32_bf16 v[112:115], v[200:203], v[64:67], v[112:115]
  ds_read_b64_tr_b16 v[168:169], v8 offset:49152
  v_mfma_f32_16x16x32_bf16 v[116:119], v[200:203], v[68:71], v[116:119]
  ds_read_b64_tr_b16 v[170:171], v8 offset:51200
  v_mfma_f32_16x16x32_bf16 v[124:127], v[204:207], v[68:71], v[124:127]
  ds_read_b64_tr_b16 v[172:173], v9 offset:49152
  v_mfma_f32_16x16x32_bf16 v[120:123], v[204:207], v[64:67], v[120:123]
  ds_read_b64_tr_b16 v[174:175], v9 offset:51200
  s_waitcnt lgkmcnt(8)
  v_mfma_f32_16x16x32_bf16 v[96:99], v[208:211], v[72:75], v[96:99]
  ds_read_b64_tr_b16 v[176:177], v6 offset:53248
  v_mfma_f32_16x16x32_bf16 v[100:103], v[208:211], v[76:79], v[100:103]
  ds_read_b64_tr_b16 v[178:179], v6 offset:55296
  v_mfma_f32_16x16x32_bf16 v[108:111], v[212:215], v[76:79], v[108:111]
  ds_read_b64_tr_b16 v[180:181], v7 offset:53248
  v_mfma_f32_16x16x32_bf16 v[104:107], v[212:215], v[72:75], v[104:107]
  ds_read_b64_tr_b16 v[182:183], v7 offset:55296
  v_mfma_f32_16x16x32_bf16 v[112:115], v[216:219], v[72:75], v[112:115]
  ds_read_b64_tr_b16 v[184:185], v8 offset:53248
  v_mfma_f32_16x16x32_bf16 v[116:119], v[216:219], v[76:79], v[116:119]
  ds_read_b64_tr_b16 v[186:187], v8 offset:55296
  v_readlane_b32 s48, v15, 8
  v_mfma_f32_16x16x32_bf16 v[124:127], v[220:223], v[76:79], v[124:127]
  ds_read_b64_tr_b16 v[188:189], v9 offset:53248
  v_mfma_f32_16x16x32_bf16 v[120:123], v[220:223], v[72:75], v[120:123]
  ds_read_b64_tr_b16 v[190:191], v9 offset:55296
  s_waitcnt vmcnt(18) lgkmcnt(8)
  v_mfma_f32_16x16x32_bf16 v[128:131], v[160:163], v[80:83], v[128:131]
  buffer_load_dwordx4 v[64:67], off, s[36:39], s48 offset:0
  v_mfma_f32_16x16x32_bf16 v[132:135], v[160:163], v[84:87], v[132:135]
  ds_read_b64_tr_b16 v[192:193], v6 offset:57344
  ds_read_b64_tr_b16 v[194:195], v6 offset:59392
  v_mfma_f32_16x16x32_bf16 v[140:143], v[164:167], v[84:87], v[140:143]
  ds_read_b64_tr_b16 v[196:197], v7 offset:57344
  v_mfma_f32_16x16x32_bf16 v[136:139], v[164:167], v[80:83], v[136:139]
  ds_read_b64_tr_b16 v[198:199], v7 offset:59392
  v_mfma_f32_16x16x32_bf16 v[144:147], v[168:171], v[80:83], v[144:147]
  ds_read_b64_tr_b16 v[200:201], v8 offset:57344
  v_mfma_f32_16x16x32_bf16 v[148:151], v[168:171], v[84:87], v[148:151]
  ds_read_b64_tr_b16 v[202:203], v8 offset:59392
  ds_read_b64_tr_b16 v[204:205], v9 offset:57344
  v_mfma_f32_16x16x32_bf16 v[156:159], v[172:175], v[84:87], v[156:159]
  buffer_load_dwordx4 v[68:71], off, s[64:67], s48 offset:0
  v_mfma_f32_16x16x32_bf16 v[152:155], v[172:175], v[80:83], v[152:155]
  ds_read_b64_tr_b16 v[206:207], v9 offset:59392
  s_waitcnt vmcnt(18) lgkmcnt(8)
  v_mfma_f32_16x16x32_bf16 v[128:131], v[176:179], v[88:91], v[128:131]
  ds_read_b64_tr_b16 v[208:209], v6 offset:61440
  v_mfma_f32_16x16x32_bf16 v[132:135], v[176:179], v[92:95], v[132:135]
  ds_read_b64_tr_b16 v[210:211], v6 offset:63488
  v_mfma_f32_16x16x32_bf16 v[140:143], v[180:183], v[92:95], v[140:143]
  ds_read_b64_tr_b16 v[212:213], v7 offset:61440
  v_mfma_f32_16x16x32_bf16 v[136:139], v[180:183], v[88:91], v[136:139]
  ds_read_b64_tr_b16 v[214:215], v7 offset:63488
  v_mfma_f32_16x16x32_bf16 v[144:147], v[184:187], v[88:91], v[144:147]
  buffer_load_dwordx4 v[72:75], off, s[36:39], s48 offset:1024
  v_mfma_f32_16x16x32_bf16 v[148:151], v[184:187], v[92:95], v[148:151]
  ds_read_b64_tr_b16 v[216:217], v8 offset:61440
  ds_read_b64_tr_b16 v[218:219], v8 offset:63488
  v_mfma_f32_16x16x32_bf16 v[156:159], v[188:191], v[92:95], v[156:159]
  ds_read_b64_tr_b16 v[220:221], v9 offset:61440
  v_mfma_f32_16x16x32_bf16 v[152:155], v[188:191], v[88:91], v[152:155]
  ds_read_b64_tr_b16 v[222:223], v9 offset:63488
  s_waitcnt lgkmcnt(8)
  v_mfma_f32_16x16x32_bf16 v[96:99], v[192:195], v[80:83], v[96:99]
  ds_read_b64_tr_b16 v[160:161], v20 offset:0
  v_mfma_f32_16x16x32_bf16 v[100:103], v[192:195], v[84:87], v[100:103]
  ds_read_b64_tr_b16 v[162:163], v20 offset:2048
  v_mfma_f32_16x16x32_bf16 v[108:111], v[196:199], v[84:87], v[108:111]
  buffer_load_dwordx4 v[76:79], off, s[64:67], s48 offset:1024
  v_mfma_f32_16x16x32_bf16 v[104:107], v[196:199], v[80:83], v[104:107]
  ds_read_b64_tr_b16 v[164:165], v21 offset:0
  ds_read_b64_tr_b16 v[166:167], v21 offset:2048
  v_mfma_f32_16x16x32_bf16 v[112:115], v[200:203], v[80:83], v[112:115]
  ds_read_b64_tr_b16 v[168:169], v22 offset:0
  v_mfma_f32_16x16x32_bf16 v[116:119], v[200:203], v[84:87], v[116:119]
  ds_read_b64_tr_b16 v[170:171], v22 offset:2048
  v_mfma_f32_16x16x32_bf16 v[124:127], v[204:207], v[84:87], v[124:127]
  ds_read_b64_tr_b16 v[172:173], v23 offset:0
  v_mfma_f32_16x16x32_bf16 v[120:123], v[204:207], v[80:83], v[120:123]
  ds_read_b64_tr_b16 v[174:175], v23 offset:2048
  s_waitcnt lgkmcnt(8)
  s_barrier
  v_mfma_f32_16x16x32_bf16 v[96:99], v[208:211], v[88:91], v[96:99]
  ds_read_b64_tr_b16 v[176:177], v20 offset:4096
  v_mfma_f32_16x16x32_bf16 v[100:103], v[208:211], v[92:95], v[100:103]
  ds_read_b64_tr_b16 v[178:179], v20 offset:6144
  v_mfma_f32_16x16x32_bf16 v[108:111], v[212:215], v[92:95], v[108:111]
  ds_read_b64_tr_b16 v[180:181], v21 offset:4096
  v_mfma_f32_16x16x32_bf16 v[104:107], v[212:215], v[88:91], v[104:107]
  ds_read_b64_tr_b16 v[182:183], v21 offset:6144
  v_mfma_f32_16x16x32_bf16 v[112:115], v[216:219], v[88:91], v[112:115]
  ds_read_b64_tr_b16 v[184:185], v22 offset:4096
  v_mfma_f32_16x16x32_bf16 v[116:119], v[216:219], v[92:95], v[116:119]
  ds_read_b64_tr_b16 v[186:187], v22 offset:6144
  v_readlane_b32 s49, v15, 9
  v_mfma_f32_16x16x32_bf16 v[124:127], v[220:223], v[92:95], v[124:127]
  ds_read_b64_tr_b16 v[188:189], v23 offset:4096
  v_mfma_f32_16x16x32_bf16 v[120:123], v[220:223], v[88:91], v[120:123]
  ds_read_b64_tr_b16 v[190:191], v23 offset:6144
  s_waitcnt vmcnt(18) lgkmcnt(8)
  v_mfma_f32_16x16x32_bf16 v[128:131], v[160:163], v[224:227], v[128:131]
  buffer_load_dwordx4 v[80:83], off, s[36:39], s49 offset:0
  v_mfma_f32_16x16x32_bf16 v[132:135], v[160:163], v[228:231], v[132:135]
  ds_read_b64_tr_b16 v[192:193], v20 offset:8192
  ds_read_b64_tr_b16 v[194:195], v20 offset:10240
  v_mfma_f32_16x16x32_bf16 v[140:143], v[164:167], v[228:231], v[140:143]
  ds_read_b64_tr_b16 v[196:197], v21 offset:8192
  v_mfma_f32_16x16x32_bf16 v[136:139], v[164:167], v[224:227], v[136:139]
  ds_read_b64_tr_b16 v[198:199], v21 offset:10240
  v_mfma_f32_16x16x32_bf16 v[144:147], v[168:171], v[224:227], v[144:147]
  ds_read_b64_tr_b16 v[200:201], v22 offset:8192
  v_mfma_f32_16x16x32_bf16 v[148:151], v[168:171], v[228:231], v[148:151]
  ds_read_b64_tr_b16 v[202:203], v22 offset:10240
  ds_read_b64_tr_b16 v[204:205], v23 offset:8192
  v_mfma_f32_16x16x32_bf16 v[156:159], v[172:175], v[228:231], v[156:159]
  buffer_load_dwordx4 v[84:87], off, s[64:67], s49 offset:0
  v_mfma_f32_16x16x32_bf16 v[152:155], v[172:175], v[224:227], v[152:155]
  ds_read_b64_tr_b16 v[206:207], v23 offset:10240
  s_waitcnt vmcnt(18) lgkmcnt(8)
  v_mfma_f32_16x16x32_bf16 v[128:131], v[176:179], v[232:235], v[128:131]
  ds_read_b64_tr_b16 v[208:209], v20 offset:12288
  v_mfma_f32_16x16x32_bf16 v[132:135], v[176:179], v[236:239], v[132:135]
  ds_read_b64_tr_b16 v[210:211], v20 offset:14336
  v_mfma_f32_16x16x32_bf16 v[140:143], v[180:183], v[236:239], v[140:143]
  ds_read_b64_tr_b16 v[212:213], v21 offset:12288
  v_mfma_f32_16x16x32_bf16 v[136:139], v[180:183], v[232:235], v[136:139]
  ds_read_b64_tr_b16 v[214:215], v21 offset:14336
  v_mfma_f32_16x16x32_bf16 v[144:147], v[184:187], v[232:235], v[144:147]
  buffer_load_dwordx4 v[88:91], off, s[36:39], s49 offset:1024
  v_mfma_f32_16x16x32_bf16 v[148:151], v[184:187], v[236:239], v[148:151]
  ds_read_b64_tr_b16 v[216:217], v22 offset:12288
  ds_read_b64_tr_b16 v[218:219], v22 offset:14336
  v_mfma_f32_16x16x32_bf16 v[156:159], v[188:191], v[236:239], v[156:159]
  ds_read_b64_tr_b16 v[220:221], v23 offset:12288
  v_mfma_f32_16x16x32_bf16 v[152:155], v[188:191], v[232:235], v[152:155]
  ds_read_b64_tr_b16 v[222:223], v23 offset:14336
  s_waitcnt lgkmcnt(8)
  v_mfma_f32_16x16x32_bf16 v[96:99], v[192:195], v[224:227], v[96:99]
  ds_read_b64_tr_b16 v[160:161], v20 offset:16384
  v_mfma_f32_16x16x32_bf16 v[100:103], v[192:195], v[228:231], v[100:103]
  ds_read_b64_tr_b16 v[162:163], v20 offset:18432
  v_mfma_f32_16x16x32_bf16 v[108:111], v[196:199], v[228:231], v[108:111]
  buffer_load_dwordx4 v[92:95], off, s[64:67], s49 offset:1024
  v_mfma_f32_16x16x32_bf16 v[104:107], v[196:199], v[224:227], v[104:107]
  ds_read_b64_tr_b16 v[164:165], v21 offset:16384
  ds_read_b64_tr_b16 v[166:167], v21 offset:18432
  v_mfma_f32_16x16x32_bf16 v[112:115], v[200:203], v[224:227], v[112:115]
  ds_read_b64_tr_b16 v[168:169], v22 offset:16384
  v_mfma_f32_16x16x32_bf16 v[116:119], v[200:203], v[228:231], v[116:119]
  ds_read_b64_tr_b16 v[170:171], v22 offset:18432
  v_mfma_f32_16x16x32_bf16 v[124:127], v[204:207], v[228:231], v[124:127]
  ds_read_b64_tr_b16 v[172:173], v23 offset:16384
  v_mfma_f32_16x16x32_bf16 v[120:123], v[204:207], v[224:227], v[120:123]
  ds_read_b64_tr_b16 v[174:175], v23 offset:18432
  s_waitcnt lgkmcnt(8)
  v_mfma_f32_16x16x32_bf16 v[96:99], v[208:211], v[232:235], v[96:99]
  ds_read_b64_tr_b16 v[176:177], v20 offset:20480
  v_mfma_f32_16x16x32_bf16 v[100:103], v[208:211], v[236:239], v[100:103]
  ds_read_b64_tr_b16 v[178:179], v20 offset:22528
  v_mfma_f32_16x16x32_bf16 v[108:111], v[212:215], v[236:239], v[108:111]
  ds_read_b64_tr_b16 v[180:181], v21 offset:20480
  v_mfma_f32_16x16x32_bf16 v[104:107], v[212:215], v[232:235], v[104:107]
  ds_read_b64_tr_b16 v[182:183], v21 offset:22528
  v_mfma_f32_16x16x32_bf16 v[112:115], v[216:219], v[232:235], v[112:115]
  ds_read_b64_tr_b16 v[184:185], v22 offset:20480
  v_mfma_f32_16x16x32_bf16 v[116:119], v[216:219], v[236:239], v[116:119]
  ds_read_b64_tr_b16 v[186:187], v22 offset:22528
  v_readlane_b32 s50, v15, 10
  v_mfma_f32_16x16x32_bf16 v[124:127], v[220:223], v[236:239], v[124:127]
  ds_read_b64_tr_b16 v[188:189], v23 offset:20480
  v_mfma_f32_16x16x32_bf16 v[120:123], v[220:223], v[232:235], v[120:123]
  ds_read_b64_tr_b16 v[190:191], v23 offset:22528
  s_waitcnt vmcnt(18) lgkmcnt(8)
  v_mfma_f32_16x16x32_bf16 v[128:131], v[160:163], v[240:243], v[128:131]
  buffer_load_dwordx4 v[224:227], off, s[36:39], s50 offset:0
  v_mfma_f32_16x16x32_bf16 v[132:135], v[160:163], v[244:247], v[132:135]
  ds_read_b64_tr_b16 v[192:193], v20 offset:24576
  ds_read_b64_tr_b16 v[194:195], v20 offset:26624
  v_mfma_f32_16x16x32_bf16 v[140:143], v[164:167], v[244:247], v[140:143]
  ds_read_b64_tr_b16 v[196:197], v21 offset:24576
  v_mfma_f32_16x16x32_bf16 v[136:139], v[164:167], v[240:243], v[136:139]
  ds_read_b64_tr_b16 v[198:199], v21 offset:26624
  v_mfma_f32_16x16x32_bf16 v[144:147], v[168:171], v[240:243], v[144:147]
  ds_read_b64_tr_b16 v[200:201], v22 offset:24576
  v_mfma_f32_16x16x32_bf16 v[148:151], v[168:171], v[244:247], v[148:151]
  ds_read_b64_tr_b16 v[202:203], v22 offset:26624
  ds_read_b64_tr_b16 v[204:205], v23 offset:24576
  v_mfma_f32_16x16x32_bf16 v[156:159], v[172:175], v[244:247], v[156:159]
  buffer_load_dwordx4 v[228:231], off, s[64:67], s50 offset:0
  v_mfma_f32_16x16x32_bf16 v[152:155], v[172:175], v[240:243], v[152:155]
  ds_read_b64_tr_b16 v[206:207], v23 offset:26624
  s_waitcnt vmcnt(18) lgkmcnt(8)
  v_mfma_f32_16x16x32_bf16 v[128:131], v[176:179], v[248:251], v[128:131]
  ds_read_b64_tr_b16 v[208:209], v20 offset:28672
  v_mfma_f32_16x16x32_bf16 v[132:135], v[176:179], v[252:255], v[132:135]
  ds_read_b64_tr_b16 v[210:211], v20 offset:30720
  v_mfma_f32_16x16x32_bf16 v[140:143], v[180:183], v[252:255], v[140:143]
  ds_read_b64_tr_b16 v[212:213], v21 offset:28672
  v_mfma_f32_16x16x32_bf16 v[136:139], v[180:183], v[248:251], v[136:139]
  ds_read_b64_tr_b16 v[214:215], v21 offset:30720
  v_mfma_f32_16x16x32_bf16 v[144:147], v[184:187], v[248:251], v[144:147]
  buffer_load_dwordx4 v[232:235], off, s[36:39], s50 offset:1024
  v_mfma_f32_16x16x32_bf16 v[148:151], v[184:187], v[252:255], v[148:151]
  ds_read_b64_tr_b16 v[216:217], v22 offset:28672
  ds_read_b64_tr_b16 v[218:219], v22 offset:30720
  v_mfma_f32_16x16x32_bf16 v[156:159], v[188:191], v[252:255], v[156:159]
  ds_read_b64_tr_b16 v[220:221], v23 offset:28672
  v_mfma_f32_16x16x32_bf16 v[152:155], v[188:191], v[248:251], v[152:155]
  ds_read_b64_tr_b16 v[222:223], v23 offset:30720
  s_waitcnt lgkmcnt(8)
  v_mfma_f32_16x16x32_bf16 v[96:99], v[192:195], v[240:243], v[96:99]
  ds_read_b64_tr_b16 v[160:161], v20 offset:32768
  v_mfma_f32_16x16x32_bf16 v[100:103], v[192:195], v[244:247], v[100:103]
  ds_read_b64_tr_b16 v[162:163], v20 offset:34816
  v_mfma_f32_16x16x32_bf16 v[108:111], v[196:199], v[244:247], v[108:111]
  buffer_load_dwordx4 v[236:239], off, s[64:67], s50 offset:1024
  v_mfma_f32_16x16x32_bf16 v[104:107], v[196:199], v[240:243], v[104:107]
  ds_read_b64_tr_b16 v[164:165], v21 offset:32768
  ds_read_b64_tr_b16 v[166:167], v21 offset:34816
  v_mfma_f32_16x16x32_bf16 v[112:115], v[200:203], v[240:243], v[112:115]
  ds_read_b64_tr_b16 v[168:169], v22 offset:32768
  v_mfma_f32_16x16x32_bf16 v[116:119], v[200:203], v[244:247], v[116:119]
  ds_read_b64_tr_b16 v[170:171], v22 offset:34816
  v_mfma_f32_16x16x32_bf16 v[124:127], v[204:207], v[244:247], v[124:127]
  ds_read_b64_tr_b16 v[172:173], v23 offset:32768
  v_mfma_f32_16x16x32_bf16 v[120:123], v[204:207], v[240:243], v[120:123]
  ds_read_b64_tr_b16 v[174:175], v23 offset:34816
  s_waitcnt lgkmcnt(8)
  s_barrier
  v_mfma_f32_16x16x32_bf16 v[96:99], v[208:211], v[248:251], v[96:99]
  ds_read_b64_tr_b16 v[176:177], v20 offset:36864
  v_mfma_f32_16x16x32_bf16 v[100:103], v[208:211], v[252:255], v[100:103]
  ds_read_b64_tr_b16 v[178:179], v20 offset:38912
  v_mfma_f32_16x16x32_bf16 v[108:111], v[212:215], v[252:255], v[108:111]
  ds_read_b64_tr_b16 v[180:181], v21 offset:36864
  v_mfma_f32_16x16x32_bf16 v[104:107], v[212:215], v[248:251], v[104:107]
  ds_read_b64_tr_b16 v[182:183], v21 offset:38912
  v_mfma_f32_16x16x32_bf16 v[112:115], v[216:219], v[248:251], v[112:115]
  ds_read_b64_tr_b16 v[184:185], v22 offset:36864
  v_mfma_f32_16x16x32_bf16 v[116:119], v[216:219], v[252:255], v[116:119]
  ds_read_b64_tr_b16 v[186:187], v22 offset:38912
  v_readlane_b32 s51, v15, 11
  v_mfma_f32_16x16x32_bf16 v[124:127], v[220:223], v[252:255], v[124:127]
  ds_read_b64_tr_b16 v[188:189], v23 offset:36864
  v_mfma_f32_16x16x32_bf16 v[120:123], v[220:223], v[248:251], v[120:123]
  ds_read_b64_tr_b16 v[190:191], v23 offset:38912
  s_waitcnt vmcnt(18) lgkmcnt(8)
  v_mfma_f32_16x16x32_bf16 v[128:131], v[160:163], v[32:35], v[128:131]
  buffer_load_dwordx4 v[240:243], off, s[36:39], s51 offset:0
  v_mfma_f32_16x16x32_bf16 v[132:135], v[160:163], v[36:39], v[132:135]
  ds_read_b64_tr_b16 v[192:193], v20 offset:40960
  ds_read_b64_tr_b16 v[194:195], v20 offset:43008
  v_mfma_f32_16x16x32_bf16 v[140:143], v[164:167], v[36:39], v[140:143]
  ds_read_b64_tr_b16 v[196:197], v21 offset:40960
  v_mfma_f32_16x16x32_bf16 v[136:139], v[164:167], v[32:35], v[136:139]
  ds_read_b64_tr_b16 v[198:199], v21 offset:43008
  v_mfma_f32_16x16x32_bf16 v[144:147], v[168:171], v[32:35], v[144:147]
  ds_read_b64_tr_b16 v[200:201], v22 offset:40960
  v_mfma_f32_16x16x32_bf16 v[148:151], v[168:171], v[36:39], v[148:151]
  ds_read_b64_tr_b16 v[202:203], v22 offset:43008
  ds_read_b64_tr_b16 v[204:205], v23 offset:40960
  v_mfma_f32_16x16x32_bf16 v[156:159], v[172:175], v[36:39], v[156:159]
  buffer_load_dwordx4 v[244:247], off, s[64:67], s51 offset:0
  v_mfma_f32_16x16x32_bf16 v[152:155], v[172:175], v[32:35], v[152:155]
  ds_read_b64_tr_b16 v[206:207], v23 offset:43008
  s_waitcnt vmcnt(18) lgkmcnt(8)
  v_mfma_f32_16x16x32_bf16 v[128:131], v[176:179], v[40:43], v[128:131]
  ds_read_b64_tr_b16 v[208:209], v20 offset:45056
  v_mfma_f32_16x16x32_bf16 v[132:135], v[176:179], v[44:47], v[132:135]
  ds_read_b64_tr_b16 v[210:211], v20 offset:47104
  v_mfma_f32_16x16x32_bf16 v[140:143], v[180:183], v[44:47], v[140:143]
  ds_read_b64_tr_b16 v[212:213], v21 offset:45056
  v_mfma_f32_16x16x32_bf16 v[136:139], v[180:183], v[40:43], v[136:139]
  ds_read_b64_tr_b16 v[214:215], v21 offset:47104
  v_mfma_f32_16x16x32_bf16 v[144:147], v[184:187], v[40:43], v[144:147]
  buffer_load_dwordx4 v[248:251], off, s[36:39], s51 offset:1024
  v_mfma_f32_16x16x32_bf16 v[148:151], v[184:187], v[44:47], v[148:151]
  ds_read_b64_tr_b16 v[216:217], v22 offset:45056
  ds_read_b64_tr_b16 v[218:219], v22 offset:47104
  v_mfma_f32_16x16x32_bf16 v[156:159], v[188:191], v[44:47], v[156:159]
  ds_read_b64_tr_b16 v[220:221], v23 offset:45056
  v_mfma_f32_16x16x32_bf16 v[152:155], v[188:191], v[40:43], v[152:155]
  ds_read_b64_tr_b16 v[222:223], v23 offset:47104
  s_waitcnt lgkmcnt(8)
  v_mfma_f32_16x16x32_bf16 v[96:99], v[192:195], v[32:35], v[96:99]
  ds_read_b64_tr_b16 v[160:161], v20 offset:49152
  v_mfma_f32_16x16x32_bf16 v[100:103], v[192:195], v[36:39], v[100:103]
  ds_read_b64_tr_b16 v[162:163], v20 offset:51200
  v_mfma_f32_16x16x32_bf16 v[108:111], v[196:199], v[36:39], v[108:111]
  buffer_load_dwordx4 v[252:255], off, s[64:67], s51 offset:1024
  v_mfma_f32_16x16x32_bf16 v[104:107], v[196:199], v[32:35], v[104:107]
  ds_read_b64_tr_b16 v[164:165], v21 offset:49152
  ds_read_b64_tr_b16 v[166:167], v21 offset:51200
  v_mfma_f32_16x16x32_bf16 v[112:115], v[200:203], v[32:35], v[112:115]
  ds_read_b64_tr_b16 v[168:169], v22 offset:49152
  v_mfma_f32_16x16x32_bf16 v[116:119], v[200:203], v[36:39], v[116:119]
  ds_read_b64_tr_b16 v[170:171], v22 offset:51200
  v_mfma_f32_16x16x32_bf16 v[124:127], v[204:207], v[36:39], v[124:127]
  ds_read_b64_tr_b16 v[172:173], v23 offset:49152
  v_mfma_f32_16x16x32_bf16 v[120:123], v[204:207], v[32:35], v[120:123]
  ds_read_b64_tr_b16 v[174:175], v23 offset:51200
  s_waitcnt lgkmcnt(8)
  v_mfma_f32_16x16x32_bf16 v[96:99], v[208:211], v[40:43], v[96:99]
  ds_read_b64_tr_b16 v[176:177], v20 offset:53248
  v_mfma_f32_16x16x32_bf16 v[100:103], v[208:211], v[44:47], v[100:103]
  ds_read_b64_tr_b16 v[178:179], v20 offset:55296
  v_mfma_f32_16x16x32_bf16 v[108:111], v[212:215], v[44:47], v[108:111]
  ds_read_b64_tr_b16 v[180:181], v21 offset:53248
  v_mfma_f32_16x16x32_bf16 v[104:107], v[212:215], v[40:43], v[104:107]
  ds_read_b64_tr_b16 v[182:183], v21 offset:55296
  v_mfma_f32_16x16x32_bf16 v[112:115], v[216:219], v[40:43], v[112:115]
  ds_read_b64_tr_b16 v[184:185], v22 offset:53248
  v_mfma_f32_16x16x32_bf16 v[116:119], v[216:219], v[44:47], v[116:119]
  ds_read_b64_tr_b16 v[186:187], v22 offset:55296
  v_readlane_b32 s48, v15, 12
  v_mfma_f32_16x16x32_bf16 v[124:127], v[220:223], v[44:47], v[124:127]
  ds_read_b64_tr_b16 v[188:189], v23 offset:53248
  v_mfma_f32_16x16x32_bf16 v[120:123], v[220:223], v[40:43], v[120:123]
  ds_read_b64_tr_b16 v[190:191], v23 offset:55296
  s_waitcnt vmcnt(18) lgkmcnt(8)
  v_mfma_f32_16x16x32_bf16 v[128:131], v[160:163], v[48:51], v[128:131]
  buffer_load_dwordx4 v[32:35], off, s[36:39], s48 offset:0
  v_mfma_f32_16x16x32_bf16 v[132:135], v[160:163], v[52:55], v[132:135]
  ds_read_b64_tr_b16 v[192:193], v20 offset:57344
  ds_read_b64_tr_b16 v[194:195], v20 offset:59392
  v_mfma_f32_16x16x32_bf16 v[140:143], v[164:167], v[52:55], v[140:143]
  ds_read_b64_tr_b16 v[196:197], v21 offset:57344
  v_mfma_f32_16x16x32_bf16 v[136:139], v[164:167], v[48:51], v[136:139]
  ds_read_b64_tr_b16 v[198:199], v21 offset:59392
  v_mfma_f32_16x16x32_bf16 v[144:147], v[168:171], v[48:51], v[144:147]
  ds_read_b64_tr_b16 v[200:201], v22 offset:57344
  v_mfma_f32_16x16x32_bf16 v[148:151], v[168:171], v[52:55], v[148:151]
  ds_read_b64_tr_b16 v[202:203], v22 offset:59392
  ds_read_b64_tr_b16 v[204:205], v23 offset:57344
  v_mfma_f32_16x16x32_bf16 v[156:159], v[172:175], v[52:55], v[156:159]
  buffer_load_dwordx4 v[36:39], off, s[64:67], s48 offset:0
  v_mfma_f32_16x16x32_bf16 v[152:155], v[172:175], v[48:51], v[152:155]
  ds_read_b64_tr_b16 v[206:207], v23 offset:59392
  s_waitcnt vmcnt(18) lgkmcnt(8)
  v_mfma_f32_16x16x32_bf16 v[128:131], v[176:179], v[56:59], v[128:131]
  ds_read_b64_tr_b16 v[208:209], v20 offset:61440
  v_mfma_f32_16x16x32_bf16 v[132:135], v[176:179], v[60:63], v[132:135]
  ds_read_b64_tr_b16 v[210:211], v20 offset:63488
  v_mfma_f32_16x16x32_bf16 v[140:143], v[180:183], v[60:63], v[140:143]
  ds_read_b64_tr_b16 v[212:213], v21 offset:61440
  v_mfma_f32_16x16x32_bf16 v[136:139], v[180:183], v[56:59], v[136:139]
  ds_read_b64_tr_b16 v[214:215], v21 offset:63488
  v_mfma_f32_16x16x32_bf16 v[144:147], v[184:187], v[56:59], v[144:147]
  buffer_load_dwordx4 v[40:43], off, s[36:39], s48 offset:1024
  v_mfma_f32_16x16x32_bf16 v[148:151], v[184:187], v[60:63], v[148:151]
  ds_read_b64_tr_b16 v[216:217], v22 offset:61440
  ds_read_b64_tr_b16 v[218:219], v22 offset:63488
  v_mfma_f32_16x16x32_bf16 v[156:159], v[188:191], v[60:63], v[156:159]
  ds_read_b64_tr_b16 v[220:221], v23 offset:61440
  v_mfma_f32_16x16x32_bf16 v[152:155], v[188:191], v[56:59], v[152:155]
  ds_read_b64_tr_b16 v[222:223], v23 offset:63488
  s_waitcnt lgkmcnt(8)
  v_mfma_f32_16x16x32_bf16 v[96:99], v[192:195], v[48:51], v[96:99]
  ds_read_b64_tr_b16 v[160:161], v26 offset:0
  v_mfma_f32_16x16x32_bf16 v[100:103], v[192:195], v[52:55], v[100:103]
  ds_read_b64_tr_b16 v[162:163], v26 offset:2048
  v_mfma_f32_16x16x32_bf16 v[108:111], v[196:199], v[52:55], v[108:111]
  buffer_load_dwordx4 v[44:47], off, s[64:67], s48 offset:1024
  v_mfma_f32_16x16x32_bf16 v[104:107], v[196:199], v[48:51], v[104:107]
  ds_read_b64_tr_b16 v[164:165], v27 offset:0
  ds_read_b64_tr_b16 v[166:167], v27 offset:2048
  v_mfma_f32_16x16x32_bf16 v[112:115], v[200:203], v[48:51], v[112:115]
  ds_read_b64_tr_b16 v[168:169], v28 offset:0
  v_mfma_f32_16x16x32_bf16 v[116:119], v[200:203], v[52:55], v[116:119]
  ds_read_b64_tr_b16 v[170:171], v28 offset:2048
  v_mfma_f32_16x16x32_bf16 v[124:127], v[204:207], v[52:55], v[124:127]
  ds_read_b64_tr_b16 v[172:173], v29 offset:0
  v_mfma_f32_16x16x32_bf16 v[120:123], v[204:207], v[48:51], v[120:123]
  ds_read_b64_tr_b16 v[174:175], v29 offset:2048
  s_waitcnt lgkmcnt(8)
  s_barrier
  v_mfma_f32_16x16x32_bf16 v[96:99], v[208:211], v[56:59], v[96:99]
  ds_read_b64_tr_b16 v[176:177], v26 offset:4096
  v_mfma_f32_16x16x32_bf16 v[100:103], v[208:211], v[60:63], v[100:103]
  ds_read_b64_tr_b16 v[178:179], v26 offset:6144
  v_mfma_f32_16x16x32_bf16 v[108:111], v[212:215], v[60:63], v[108:111]
  ds_read_b64_tr_b16 v[180:181], v27 offset:4096
  v_mfma_f32_16x16x32_bf16 v[104:107], v[212:215], v[56:59], v[104:107]
  ds_read_b64_tr_b16 v[182:183], v27 offset:6144
  v_mfma_f32_16x16x32_bf16 v[112:115], v[216:219], v[56:59], v[112:115]
  ds_read_b64_tr_b16 v[184:185], v28 offset:4096
  v_mfma_f32_16x16x32_bf16 v[116:119], v[216:219], v[60:63], v[116:119]
  ds_read_b64_tr_b16 v[186:187], v28 offset:6144
  v_readlane_b32 s49, v15, 13
  v_mfma_f32_16x16x32_bf16 v[124:127], v[220:223], v[60:63], v[124:127]
  ds_read_b64_tr_b16 v[188:189], v29 offset:4096
  v_mfma_f32_16x16x32_bf16 v[120:123], v[220:223], v[56:59], v[120:123]
  ds_read_b64_tr_b16 v[190:191], v29 offset:6144
  s_waitcnt vmcnt(18) lgkmcnt(8)
  v_mfma_f32_16x16x32_bf16 v[128:131], v[160:163], v[64:67], v[128:131]
  buffer_load_dwordx4 v[48:51], off, s[36:39], s49 offset:0
  v_mfma_f32_16x16x32_bf16 v[132:135], v[160:163], v[68:71], v[132:135]
  ds_read_b64_tr_b16 v[192:193], v26 offset:8192
  ds_read_b64_tr_b16 v[194:195], v26 offset:10240
  v_mfma_f32_16x16x32_bf16 v[140:143], v[164:167], v[68:71], v[140:143]
  ds_read_b64_tr_b16 v[196:197], v27 offset:8192
  v_mfma_f32_16x16x32_bf16 v[136:139], v[164:167], v[64:67], v[136:139]
  ds_read_b64_tr_b16 v[198:199], v27 offset:10240
  v_mfma_f32_16x16x32_bf16 v[144:147], v[168:171], v[64:67], v[144:147]
  ds_read_b64_tr_b16 v[200:201], v28 offset:8192
  v_mfma_f32_16x16x32_bf16 v[148:151], v[168:171], v[68:71], v[148:151]
  ds_read_b64_tr_b16 v[202:203], v28 offset:10240
  ds_read_b64_tr_b16 v[204:205], v29 offset:8192
  v_mfma_f32_16x16x32_bf16 v[156:159], v[172:175], v[68:71], v[156:159]
  buffer_load_dwordx4 v[52:55], off, s[64:67], s49 offset:0
  v_mfma_f32_16x16x32_bf16 v[152:155], v[172:175], v[64:67], v[152:155]
  ds_read_b64_tr_b16 v[206:207], v29 offset:10240
  s_waitcnt vmcnt(18) lgkmcnt(8)
  v_mfma_f32_16x16x32_bf16 v[128:131], v[176:179], v[72:75], v[128:131]
  ds_read_b64_tr_b16 v[208:209], v26 offset:12288
  v_mfma_f32_16x16x32_bf16 v[132:135], v[176:179], v[76:79], v[132:135]
  ds_read_b64_tr_b16 v[210:211], v26 offset:14336
  v_mfma_f32_16x16x32_bf16 v[140:143], v[180:183], v[76:79], v[140:143]
  ds_read_b64_tr_b16 v[212:213], v27 offset:12288
  v_mfma_f32_16x16x32_bf16 v[136:139], v[180:183], v[72:75], v[136:139]
  ds_read_b64_tr_b16 v[214:215], v27 offset:14336
  v_mfma_f32_16x16x32_bf16 v[144:147], v[184:187], v[72:75], v[144:147]
  buffer_load_dwordx4 v[56:59], off, s[36:39], s49 offset:1024
  v_mfma_f32_16x16x32_bf16 v[148:151], v[184:187], v[76:79], v[148:151]
  ds_read_b64_tr_b16 v[216:217], v28 offset:12288
  ds_read_b64_tr_b16 v[218:219], v28 offset:14336
  v_mfma_f32_16x16x32_bf16 v[156:159], v[188:191], v[76:79], v[156:159]
  ds_read_b64_tr_b16 v[220:221], v29 offset:12288
  v_mfma_f32_16x16x32_bf16 v[152:155], v[188:191], v[72:75], v[152:155]
  ds_read_b64_tr_b16 v[222:223], v29 offset:14336
  s_waitcnt lgkmcnt(8)
  v_mfma_f32_16x16x32_bf16 v[96:99], v[192:195], v[64:67], v[96:99]
  ds_read_b64_tr_b16 v[160:161], v26 offset:16384
  v_mfma_f32_16x16x32_bf16 v[100:103], v[192:195], v[68:71], v[100:103]
  ds_read_b64_tr_b16 v[162:163], v26 offset:18432
  v_mfma_f32_16x16x32_bf16 v[108:111], v[196:199], v[68:71], v[108:111]
  buffer_load_dwordx4 v[60:63], off, s[64:67], s49 offset:1024
  v_mfma_f32_16x16x32_bf16 v[104:107], v[196:199], v[64:67], v[104:107]
  ds_read_b64_tr_b16 v[164:165], v27 offset:16384
  ds_read_b64_tr_b16 v[166:167], v27 offset:18432
  v_mfma_f32_16x16x32_bf16 v[112:115], v[200:203], v[64:67], v[112:115]
  ds_read_b64_tr_b16 v[168:169], v28 offset:16384
  v_mfma_f32_16x16x32_bf16 v[116:119], v[200:203], v[68:71], v[116:119]
  ds_read_b64_tr_b16 v[170:171], v28 offset:18432
  v_mfma_f32_16x16x32_bf16 v[124:127], v[204:207], v[68:71], v[124:127]
  ds_read_b64_tr_b16 v[172:173], v29 offset:16384
  v_mfma_f32_16x16x32_bf16 v[120:123], v[204:207], v[64:67], v[120:123]
  ds_read_b64_tr_b16 v[174:175], v29 offset:18432
  s_waitcnt lgkmcnt(8)
  v_mfma_f32_16x16x32_bf16 v[96:99], v[208:211], v[72:75], v[96:99]
  ds_read_b64_tr_b16 v[176:177], v26 offset:20480
  v_mfma_f32_16x16x32_bf16 v[100:103], v[208:211], v[76:79], v[100:103]
  ds_read_b64_tr_b16 v[178:179], v26 offset:22528
  v_mfma_f32_16x16x32_bf16 v[108:111], v[212:215], v[76:79], v[108:111]
  ds_read_b64_tr_b16 v[180:181], v27 offset:20480
  v_mfma_f32_16x16x32_bf16 v[104:107], v[212:215], v[72:75], v[104:107]
  ds_read_b64_tr_b16 v[182:183], v27 offset:22528
  v_mfma_f32_16x16x32_bf16 v[112:115], v[216:219], v[72:75], v[112:115]
  ds_read_b64_tr_b16 v[184:185], v28 offset:20480
  v_mfma_f32_16x16x32_bf16 v[116:119], v[216:219], v[76:79], v[116:119]
  ds_read_b64_tr_b16 v[186:187], v28 offset:22528
  v_readlane_b32 s50, v15, 14
  v_mfma_f32_16x16x32_bf16 v[124:127], v[220:223], v[76:79], v[124:127]
  ds_read_b64_tr_b16 v[188:189], v29 offset:20480
  v_mfma_f32_16x16x32_bf16 v[120:123], v[220:223], v[72:75], v[120:123]
  ds_read_b64_tr_b16 v[190:191], v29 offset:22528
  s_waitcnt vmcnt(18) lgkmcnt(8)
  v_mfma_f32_16x16x32_bf16 v[128:131], v[160:163], v[80:83], v[128:131]
  buffer_load_dwordx4 v[64:67], off, s[36:39], s50 offset:0
  v_mfma_f32_16x16x32_bf16 v[132:135], v[160:163], v[84:87], v[132:135]
  ds_read_b64_tr_b16 v[192:193], v26 offset:24576
  ds_read_b64_tr_b16 v[194:195], v26 offset:26624
  v_mfma_f32_16x16x32_bf16 v[140:143], v[164:167], v[84:87], v[140:143]
  ds_read_b64_tr_b16 v[196:197], v27 offset:24576
  v_mfma_f32_16x16x32_bf16 v[136:139], v[164:167], v[80:83], v[136:139]
  ds_read_b64_tr_b16 v[198:199], v27 offset:26624
  v_mfma_f32_16x16x32_bf16 v[144:147], v[168:171], v[80:83], v[144:147]
  ds_read_b64_tr_b16 v[200:201], v28 offset:24576
  v_mfma_f32_16x16x32_bf16 v[148:151], v[168:171], v[84:87], v[148:151]
  ds_read_b64_tr_b16 v[202:203], v28 offset:26624
  ds_read_b64_tr_b16 v[204:205], v29 offset:24576
  v_mfma_f32_16x16x32_bf16 v[156:159], v[172:175], v[84:87], v[156:159]
  buffer_load_dwordx4 v[68:71], off, s[64:67], s50 offset:0
  v_mfma_f32_16x16x32_bf16 v[152:155], v[172:175], v[80:83], v[152:155]
  ds_read_b64_tr_b16 v[206:207], v29 offset:26624
  s_waitcnt vmcnt(18) lgkmcnt(8)
  v_mfma_f32_16x16x32_bf16 v[128:131], v[176:179], v[88:91], v[128:131]
  ds_read_b64_tr_b16 v[208:209], v26 offset:28672
  v_mfma_f32_16x16x32_bf16 v[132:135], v[176:179], v[92:95], v[132:135]
  ds_read_b64_tr_b16 v[210:211], v26 offset:30720
  v_mfma_f32_16x16x32_bf16 v[140:143], v[180:183], v[92:95], v[140:143]
  ds_read_b64_tr_b16 v[212:213], v27 offset:28672
  v_mfma_f32_16x16x32_bf16 v[136:139], v[180:183], v[88:91], v[136:139]
  ds_read_b64_tr_b16 v[214:215], v27 offset:30720
  v_mfma_f32_16x16x32_bf16 v[144:147], v[184:187], v[88:91], v[144:147]
  buffer_load_dwordx4 v[72:75], off, s[36:39], s50 offset:1024
  v_mfma_f32_16x16x32_bf16 v[148:151], v[184:187], v[92:95], v[148:151]
  ds_read_b64_tr_b16 v[216:217], v28 offset:28672
  ds_read_b64_tr_b16 v[218:219], v28 offset:30720
  v_mfma_f32_16x16x32_bf16 v[156:159], v[188:191], v[92:95], v[156:159]
  ds_read_b64_tr_b16 v[220:221], v29 offset:28672
  v_mfma_f32_16x16x32_bf16 v[152:155], v[188:191], v[88:91], v[152:155]
  ds_read_b64_tr_b16 v[222:223], v29 offset:30720
  s_waitcnt lgkmcnt(8)
  v_mfma_f32_16x16x32_bf16 v[96:99], v[192:195], v[80:83], v[96:99]
  ds_read_b64_tr_b16 v[160:161], v6 offset:0
  v_mfma_f32_16x16x32_bf16 v[100:103], v[192:195], v[84:87], v[100:103]
  ds_read_b64_tr_b16 v[162:163], v6 offset:2048
  v_mfma_f32_16x16x32_bf16 v[108:111], v[196:199], v[84:87], v[108:111]
  buffer_load_dwordx4 v[76:79], off, s[64:67], s50 offset:1024
  v_mfma_f32_16x16x32_bf16 v[104:107], v[196:199], v[80:83], v[104:107]
  ds_read_b64_tr_b16 v[164:165], v7 offset:0
  ds_read_b64_tr_b16 v[166:167], v7 offset:2048
  v_mfma_f32_16x16x32_bf16 v[112:115], v[200:203], v[80:83], v[112:115]
  ds_read_b64_tr_b16 v[168:169], v8 offset:0
  v_mfma_f32_16x16x32_bf16 v[116:119], v[200:203], v[84:87], v[116:119]
  ds_read_b64_tr_b16 v[170:171], v8 offset:2048
  v_mfma_f32_16x16x32_bf16 v[124:127], v[204:207], v[84:87], v[124:127]
  ds_read_b64_tr_b16 v[172:173], v9 offset:0
  v_mfma_f32_16x16x32_bf16 v[120:123], v[204:207], v[80:83], v[120:123]
  ds_read_b64_tr_b16 v[174:175], v9 offset:2048
  s_waitcnt lgkmcnt(8)
  s_barrier
  v_mfma_f32_16x16x32_bf16 v[96:99], v[208:211], v[88:91], v[96:99]
  ds_read_b64_tr_b16 v[176:177], v6 offset:4096
  v_mfma_f32_16x16x32_bf16 v[100:103], v[208:211], v[92:95], v[100:103]
  ds_read_b64_tr_b16 v[178:179], v6 offset:6144
  v_mfma_f32_16x16x32_bf16 v[108:111], v[212:215], v[92:95], v[108:111]
  ds_read_b64_tr_b16 v[180:181], v7 offset:4096
  v_mfma_f32_16x16x32_bf16 v[104:107], v[212:215], v[88:91], v[104:107]
  ds_read_b64_tr_b16 v[182:183], v7 offset:6144
  v_mfma_f32_16x16x32_bf16 v[112:115], v[216:219], v[88:91], v[112:115]
  ds_read_b64_tr_b16 v[184:185], v8 offset:4096
  v_mfma_f32_16x16x32_bf16 v[116:119], v[216:219], v[92:95], v[116:119]
  ds_read_b64_tr_b16 v[186:187], v8 offset:6144
  v_readlane_b32 s51, v15, 15
  v_mfma_f32_16x16x32_bf16 v[124:127], v[220:223], v[92:95], v[124:127]
  ds_read_b64_tr_b16 v[188:189], v9 offset:4096
  v_mfma_f32_16x16x32_bf16 v[120:123], v[220:223], v[88:91], v[120:123]
  ds_read_b64_tr_b16 v[190:191], v9 offset:6144
  s_waitcnt vmcnt(18) lgkmcnt(8)
  v_mfma_f32_16x16x32_bf16 v[128:131], v[160:163], v[224:227], v[128:131]
  buffer_load_dwordx4 v[80:83], off, s[36:39], s51 offset:0
  v_mfma_f32_16x16x32_bf16 v[132:135], v[160:163], v[228:231], v[132:135]
  ds_read_b64_tr_b16 v[192:193], v6 offset:8192
  ds_read_b64_tr_b16 v[194:195], v6 offset:10240
  v_mfma_f32_16x16x32_bf16 v[140:143], v[164:167], v[228:231], v[140:143]
  ds_read_b64_tr_b16 v[196:197], v7 offset:8192
  v_mfma_f32_16x16x32_bf16 v[136:139], v[164:167], v[224:227], v[136:139]
  ds_read_b64_tr_b16 v[198:199], v7 offset:10240
  v_mfma_f32_16x16x32_bf16 v[144:147], v[168:171], v[224:227], v[144:147]
  ds_read_b64_tr_b16 v[200:201], v8 offset:8192
  v_mfma_f32_16x16x32_bf16 v[148:151], v[168:171], v[228:231], v[148:151]
  ds_read_b64_tr_b16 v[202:203], v8 offset:10240
  ds_read_b64_tr_b16 v[204:205], v9 offset:8192
  v_mfma_f32_16x16x32_bf16 v[156:159], v[172:175], v[228:231], v[156:159]
  buffer_load_dwordx4 v[84:87], off, s[64:67], s51 offset:0
  v_mfma_f32_16x16x32_bf16 v[152:155], v[172:175], v[224:227], v[152:155]
  ds_read_b64_tr_b16 v[206:207], v9 offset:10240
  s_waitcnt vmcnt(18) lgkmcnt(8)
  v_mfma_f32_16x16x32_bf16 v[128:131], v[176:179], v[232:235], v[128:131]
  ds_read_b64_tr_b16 v[208:209], v6 offset:12288
  v_mfma_f32_16x16x32_bf16 v[132:135], v[176:179], v[236:239], v[132:135]
  ds_read_b64_tr_b16 v[210:211], v6 offset:14336
  v_mfma_f32_16x16x32_bf16 v[140:143], v[180:183], v[236:239], v[140:143]
  ds_read_b64_tr_b16 v[212:213], v7 offset:12288
  v_mfma_f32_16x16x32_bf16 v[136:139], v[180:183], v[232:235], v[136:139]
  ds_read_b64_tr_b16 v[214:215], v7 offset:14336
  v_mfma_f32_16x16x32_bf16 v[144:147], v[184:187], v[232:235], v[144:147]
  buffer_load_dwordx4 v[88:91], off, s[36:39], s51 offset:1024
  v_mfma_f32_16x16x32_bf16 v[148:151], v[184:187], v[236:239], v[148:151]
  ds_read_b64_tr_b16 v[216:217], v8 offset:12288
  ds_read_b64_tr_b16 v[218:219], v8 offset:14336
  v_mfma_f32_16x16x32_bf16 v[156:159], v[188:191], v[236:239], v[156:159]
  ds_read_b64_tr_b16 v[220:221], v9 offset:12288
  v_mfma_f32_16x16x32_bf16 v[152:155], v[188:191], v[232:235], v[152:155]
  ds_read_b64_tr_b16 v[222:223], v9 offset:14336
  s_waitcnt lgkmcnt(8)
  v_mfma_f32_16x16x32_bf16 v[96:99], v[192:195], v[224:227], v[96:99]
  ds_read_b64_tr_b16 v[160:161], v6 offset:16384
  v_mfma_f32_16x16x32_bf16 v[100:103], v[192:195], v[228:231], v[100:103]
  ds_read_b64_tr_b16 v[162:163], v6 offset:18432
  v_mfma_f32_16x16x32_bf16 v[108:111], v[196:199], v[228:231], v[108:111]
  buffer_load_dwordx4 v[92:95], off, s[64:67], s51 offset:1024
  v_mfma_f32_16x16x32_bf16 v[104:107], v[196:199], v[224:227], v[104:107]
  ds_read_b64_tr_b16 v[164:165], v7 offset:16384
  ds_read_b64_tr_b16 v[166:167], v7 offset:18432
  v_mfma_f32_16x16x32_bf16 v[112:115], v[200:203], v[224:227], v[112:115]
  ds_read_b64_tr_b16 v[168:169], v8 offset:16384
  v_mfma_f32_16x16x32_bf16 v[116:119], v[200:203], v[228:231], v[116:119]
  ds_read_b64_tr_b16 v[170:171], v8 offset:18432
  v_mfma_f32_16x16x32_bf16 v[124:127], v[204:207], v[228:231], v[124:127]
  ds_read_b64_tr_b16 v[172:173], v9 offset:16384
  v_mfma_f32_16x16x32_bf16 v[120:123], v[204:207], v[224:227], v[120:123]
  ds_read_b64_tr_b16 v[174:175], v9 offset:18432
  s_waitcnt lgkmcnt(8)
  v_mfma_f32_16x16x32_bf16 v[96:99], v[208:211], v[232:235], v[96:99]
  ds_read_b64_tr_b16 v[176:177], v6 offset:20480
  v_mfma_f32_16x16x32_bf16 v[100:103], v[208:211], v[236:239], v[100:103]
  ds_read_b64_tr_b16 v[178:179], v6 offset:22528
  v_mfma_f32_16x16x32_bf16 v[108:111], v[212:215], v[236:239], v[108:111]
  ds_read_b64_tr_b16 v[180:181], v7 offset:20480
  v_mfma_f32_16x16x32_bf16 v[104:107], v[212:215], v[232:235], v[104:107]
  ds_read_b64_tr_b16 v[182:183], v7 offset:22528
  v_mfma_f32_16x16x32_bf16 v[112:115], v[216:219], v[232:235], v[112:115]
  ds_read_b64_tr_b16 v[184:185], v8 offset:20480
  v_mfma_f32_16x16x32_bf16 v[116:119], v[216:219], v[236:239], v[116:119]
  ds_read_b64_tr_b16 v[186:187], v8 offset:22528
  v_readlane_b32 s48, v15, 16
  v_mfma_f32_16x16x32_bf16 v[124:127], v[220:223], v[236:239], v[124:127]
  ds_read_b64_tr_b16 v[188:189], v9 offset:20480
  v_mfma_f32_16x16x32_bf16 v[120:123], v[220:223], v[232:235], v[120:123]
  ds_read_b64_tr_b16 v[190:191], v9 offset:22528
  s_waitcnt vmcnt(18) lgkmcnt(8)
  v_mfma_f32_16x16x32_bf16 v[128:131], v[160:163], v[240:243], v[128:131]
  buffer_load_dwordx4 v[224:227], off, s[36:39], s48 offset:0
  v_mfma_f32_16x16x32_bf16 v[132:135], v[160:163], v[244:247], v[132:135]
  ds_read_b64_tr_b16 v[192:193], v6 offset:24576
  ds_read_b64_tr_b16 v[194:195], v6 offset:26624
  v_mfma_f32_16x16x32_bf16 v[140:143], v[164:167], v[244:247], v[140:143]
  ds_read_b64_tr_b16 v[196:197], v7 offset:24576
  v_mfma_f32_16x16x32_bf16 v[136:139], v[164:167], v[240:243], v[136:139]
  ds_read_b64_tr_b16 v[198:199], v7 offset:26624
  v_mfma_f32_16x16x32_bf16 v[144:147], v[168:171], v[240:243], v[144:147]
  ds_read_b64_tr_b16 v[200:201], v8 offset:24576
  v_mfma_f32_16x16x32_bf16 v[148:151], v[168:171], v[244:247], v[148:151]
  ds_read_b64_tr_b16 v[202:203], v8 offset:26624
  ds_read_b64_tr_b16 v[204:205], v9 offset:24576
  v_mfma_f32_16x16x32_bf16 v[156:159], v[172:175], v[244:247], v[156:159]
  buffer_load_dwordx4 v[228:231], off, s[64:67], s48 offset:0
  v_mfma_f32_16x16x32_bf16 v[152:155], v[172:175], v[240:243], v[152:155]
  ds_read_b64_tr_b16 v[206:207], v9 offset:26624
  s_waitcnt vmcnt(18) lgkmcnt(8)
  v_mfma_f32_16x16x32_bf16 v[128:131], v[176:179], v[248:251], v[128:131]
  ds_read_b64_tr_b16 v[208:209], v6 offset:28672
  v_mfma_f32_16x16x32_bf16 v[132:135], v[176:179], v[252:255], v[132:135]
  ds_read_b64_tr_b16 v[210:211], v6 offset:30720
  v_mfma_f32_16x16x32_bf16 v[140:143], v[180:183], v[252:255], v[140:143]
  ds_read_b64_tr_b16 v[212:213], v7 offset:28672
  v_mfma_f32_16x16x32_bf16 v[136:139], v[180:183], v[248:251], v[136:139]
  ds_read_b64_tr_b16 v[214:215], v7 offset:30720
  v_mfma_f32_16x16x32_bf16 v[144:147], v[184:187], v[248:251], v[144:147]
  buffer_load_dwordx4 v[232:235], off, s[36:39], s48 offset:1024
  v_mfma_f32_16x16x32_bf16 v[148:151], v[184:187], v[252:255], v[148:151]
  ds_read_b64_tr_b16 v[216:217], v8 offset:28672
  ds_read_b64_tr_b16 v[218:219], v8 offset:30720
  v_mfma_f32_16x16x32_bf16 v[156:159], v[188:191], v[252:255], v[156:159]
  ds_read_b64_tr_b16 v[220:221], v9 offset:28672
  v_mfma_f32_16x16x32_bf16 v[152:155], v[188:191], v[248:251], v[152:155]
  ds_read_b64_tr_b16 v[222:223], v9 offset:30720
  s_waitcnt lgkmcnt(8)
  v_mfma_f32_16x16x32_bf16 v[96:99], v[192:195], v[240:243], v[96:99]
  ds_read_b64_tr_b16 v[160:161], v6 offset:32768
  v_mfma_f32_16x16x32_bf16 v[100:103], v[192:195], v[244:247], v[100:103]
  ds_read_b64_tr_b16 v[162:163], v6 offset:34816
  v_mfma_f32_16x16x32_bf16 v[108:111], v[196:199], v[244:247], v[108:111]
  buffer_load_dwordx4 v[236:239], off, s[64:67], s48 offset:1024
  v_mfma_f32_16x16x32_bf16 v[104:107], v[196:199], v[240:243], v[104:107]
  ds_read_b64_tr_b16 v[164:165], v7 offset:32768
  ds_read_b64_tr_b16 v[166:167], v7 offset:34816
  v_mfma_f32_16x16x32_bf16 v[112:115], v[200:203], v[240:243], v[112:115]
  ds_read_b64_tr_b16 v[168:169], v8 offset:32768
  v_mfma_f32_16x16x32_bf16 v[116:119], v[200:203], v[244:247], v[116:119]
  ds_read_b64_tr_b16 v[170:171], v8 offset:34816
  v_mfma_f32_16x16x32_bf16 v[124:127], v[204:207], v[244:247], v[124:127]
  ds_read_b64_tr_b16 v[172:173], v9 offset:32768
  v_mfma_f32_16x16x32_bf16 v[120:123], v[204:207], v[240:243], v[120:123]
  ds_read_b64_tr_b16 v[174:175], v9 offset:34816
  s_waitcnt lgkmcnt(8)
  s_barrier
  v_mfma_f32_16x16x32_bf16 v[96:99], v[208:211], v[248:251], v[96:99]
  ds_read_b64_tr_b16 v[176:177], v6 offset:36864
  v_mfma_f32_16x16x32_bf16 v[100:103], v[208:211], v[252:255], v[100:103]
  ds_read_b64_tr_b16 v[178:179], v6 offset:38912
  v_mfma_f32_16x16x32_bf16 v[108:111], v[212:215], v[252:255], v[108:111]
  ds_read_b64_tr_b16 v[180:181], v7 offset:36864
  v_mfma_f32_16x16x32_bf16 v[104:107], v[212:215], v[248:251], v[104:107]
  ds_read_b64_tr_b16 v[182:183], v7 offset:38912
  v_mfma_f32_16x16x32_bf16 v[112:115], v[216:219], v[248:251], v[112:115]
  ds_read_b64_tr_b16 v[184:185], v8 offset:36864
  v_mfma_f32_16x16x32_bf16 v[116:119], v[216:219], v[252:255], v[116:119]
  ds_read_b64_tr_b16 v[186:187], v8 offset:38912
  v_readlane_b32 s49, v15, 17
  v_mfma_f32_16x16x32_bf16 v[124:127], v[220:223], v[252:255], v[124:127]
  ds_read_b64_tr_b16 v[188:189], v9 offset:36864
  v_mfma_f32_16x16x32_bf16 v[120:123], v[220:223], v[248:251], v[120:123]
  ds_read_b64_tr_b16 v[190:191], v9 offset:38912
  s_waitcnt vmcnt(18) lgkmcnt(8)
  v_mfma_f32_16x16x32_bf16 v[128:131], v[160:163], v[32:35], v[128:131]
  buffer_load_dwordx4 v[240:243], off, s[36:39], s49 offset:0
  v_mfma_f32_16x16x32_bf16 v[132:135], v[160:163], v[36:39], v[132:135]
  ds_read_b64_tr_b16 v[192:193], v6 offset:40960
  ds_read_b64_tr_b16 v[194:195], v6 offset:43008
  v_mfma_f32_16x16x32_bf16 v[140:143], v[164:167], v[36:39], v[140:143]
  ds_read_b64_tr_b16 v[196:197], v7 offset:40960
  v_mfma_f32_16x16x32_bf16 v[136:139], v[164:167], v[32:35], v[136:139]
  ds_read_b64_tr_b16 v[198:199], v7 offset:43008
  v_mfma_f32_16x16x32_bf16 v[144:147], v[168:171], v[32:35], v[144:147]
  ds_read_b64_tr_b16 v[200:201], v8 offset:40960
  v_mfma_f32_16x16x32_bf16 v[148:151], v[168:171], v[36:39], v[148:151]
  ds_read_b64_tr_b16 v[202:203], v8 offset:43008
  ds_read_b64_tr_b16 v[204:205], v9 offset:40960
  v_mfma_f32_16x16x32_bf16 v[156:159], v[172:175], v[36:39], v[156:159]
  buffer_load_dwordx4 v[244:247], off, s[64:67], s49 offset:0
  v_mfma_f32_16x16x32_bf16 v[152:155], v[172:175], v[32:35], v[152:155]
  ds_read_b64_tr_b16 v[206:207], v9 offset:43008
  s_waitcnt vmcnt(18) lgkmcnt(8)
  v_mfma_f32_16x16x32_bf16 v[128:131], v[176:179], v[40:43], v[128:131]
  ds_read_b64_tr_b16 v[208:209], v6 offset:45056
  v_mfma_f32_16x16x32_bf16 v[132:135], v[176:179], v[44:47], v[132:135]
  ds_read_b64_tr_b16 v[210:211], v6 offset:47104
  v_mfma_f32_16x16x32_bf16 v[140:143], v[180:183], v[44:47], v[140:143]
  ds_read_b64_tr_b16 v[212:213], v7 offset:45056
  v_mfma_f32_16x16x32_bf16 v[136:139], v[180:183], v[40:43], v[136:139]
  ds_read_b64_tr_b16 v[214:215], v7 offset:47104
  v_mfma_f32_16x16x32_bf16 v[144:147], v[184:187], v[40:43], v[144:147]
  buffer_load_dwordx4 v[248:251], off, s[36:39], s49 offset:1024
  v_mfma_f32_16x16x32_bf16 v[148:151], v[184:187], v[44:47], v[148:151]
  ds_read_b64_tr_b16 v[216:217], v8 offset:45056
  ds_read_b64_tr_b16 v[218:219], v8 offset:47104
  v_mfma_f32_16x16x32_bf16 v[156:159], v[188:191], v[44:47], v[156:159]
  ds_read_b64_tr_b16 v[220:221], v9 offset:45056
  v_mfma_f32_16x16x32_bf16 v[152:155], v[188:191], v[40:43], v[152:155]
  ds_read_b64_tr_b16 v[222:223], v9 offset:47104
  s_waitcnt lgkmcnt(8)
  v_mfma_f32_16x16x32_bf16 v[96:99], v[192:195], v[32:35], v[96:99]
  ds_read_b64_tr_b16 v[160:161], v6 offset:49152
  v_mfma_f32_16x16x32_bf16 v[100:103], v[192:195], v[36:39], v[100:103]
  ds_read_b64_tr_b16 v[162:163], v6 offset:51200
  v_mfma_f32_16x16x32_bf16 v[108:111], v[196:199], v[36:39], v[108:111]
  buffer_load_dwordx4 v[252:255], off, s[64:67], s49 offset:1024
  v_mfma_f32_16x16x32_bf16 v[104:107], v[196:199], v[32:35], v[104:107]
  ds_read_b64_tr_b16 v[164:165], v7 offset:49152
  ds_read_b64_tr_b16 v[166:167], v7 offset:51200
  v_mfma_f32_16x16x32_bf16 v[112:115], v[200:203], v[32:35], v[112:115]
  ds_read_b64_tr_b16 v[168:169], v8 offset:49152
  v_mfma_f32_16x16x32_bf16 v[116:119], v[200:203], v[36:39], v[116:119]
  ds_read_b64_tr_b16 v[170:171], v8 offset:51200
  v_mfma_f32_16x16x32_bf16 v[124:127], v[204:207], v[36:39], v[124:127]
  ds_read_b64_tr_b16 v[172:173], v9 offset:49152
  v_mfma_f32_16x16x32_bf16 v[120:123], v[204:207], v[32:35], v[120:123]
  ds_read_b64_tr_b16 v[174:175], v9 offset:51200
  s_waitcnt lgkmcnt(8)
  v_mfma_f32_16x16x32_bf16 v[96:99], v[208:211], v[40:43], v[96:99]
  ds_read_b64_tr_b16 v[176:177], v6 offset:53248
  v_mfma_f32_16x16x32_bf16 v[100:103], v[208:211], v[44:47], v[100:103]
  ds_read_b64_tr_b16 v[178:179], v6 offset:55296
  v_mfma_f32_16x16x32_bf16 v[108:111], v[212:215], v[44:47], v[108:111]
  ds_read_b64_tr_b16 v[180:181], v7 offset:53248
  v_mfma_f32_16x16x32_bf16 v[104:107], v[212:215], v[40:43], v[104:107]
  ds_read_b64_tr_b16 v[182:183], v7 offset:55296
  v_mfma_f32_16x16x32_bf16 v[112:115], v[216:219], v[40:43], v[112:115]
  ds_read_b64_tr_b16 v[184:185], v8 offset:53248
  v_mfma_f32_16x16x32_bf16 v[116:119], v[216:219], v[44:47], v[116:119]
  ds_read_b64_tr_b16 v[186:187], v8 offset:55296
  v_readlane_b32 s50, v15, 18
  v_mfma_f32_16x16x32_bf16 v[124:127], v[220:223], v[44:47], v[124:127]
  ds_read_b64_tr_b16 v[188:189], v9 offset:53248
  v_mfma_f32_16x16x32_bf16 v[120:123], v[220:223], v[40:43], v[120:123]
  ds_read_b64_tr_b16 v[190:191], v9 offset:55296
  s_waitcnt vmcnt(18) lgkmcnt(8)
  v_mfma_f32_16x16x32_bf16 v[128:131], v[160:163], v[48:51], v[128:131]
  buffer_load_dwordx4 v[32:35], off, s[36:39], s50 offset:0
  v_mfma_f32_16x16x32_bf16 v[132:135], v[160:163], v[52:55], v[132:135]
  ds_read_b64_tr_b16 v[192:193], v6 offset:57344
  ds_read_b64_tr_b16 v[194:195], v6 offset:59392
  v_mfma_f32_16x16x32_bf16 v[140:143], v[164:167], v[52:55], v[140:143]
  ds_read_b64_tr_b16 v[196:197], v7 offset:57344
  v_mfma_f32_16x16x32_bf16 v[136:139], v[164:167], v[48:51], v[136:139]
  ds_read_b64_tr_b16 v[198:199], v7 offset:59392
  v_mfma_f32_16x16x32_bf16 v[144:147], v[168:171], v[48:51], v[144:147]
  ds_read_b64_tr_b16 v[200:201], v8 offset:57344
  v_mfma_f32_16x16x32_bf16 v[148:151], v[168:171], v[52:55], v[148:151]
  ds_read_b64_tr_b16 v[202:203], v8 offset:59392
  ds_read_b64_tr_b16 v[204:205], v9 offset:57344
  v_mfma_f32_16x16x32_bf16 v[156:159], v[172:175], v[52:55], v[156:159]
  buffer_load_dwordx4 v[36:39], off, s[64:67], s50 offset:0
  v_mfma_f32_16x16x32_bf16 v[152:155], v[172:175], v[48:51], v[152:155]
  ds_read_b64_tr_b16 v[206:207], v9 offset:59392
  s_waitcnt vmcnt(18) lgkmcnt(8)
  v_mfma_f32_16x16x32_bf16 v[128:131], v[176:179], v[56:59], v[128:131]
  ds_read_b64_tr_b16 v[208:209], v6 offset:61440
  v_mfma_f32_16x16x32_bf16 v[132:135], v[176:179], v[60:63], v[132:135]
  ds_read_b64_tr_b16 v[210:211], v6 offset:63488
  v_mfma_f32_16x16x32_bf16 v[140:143], v[180:183], v[60:63], v[140:143]
  ds_read_b64_tr_b16 v[212:213], v7 offset:61440
  v_mfma_f32_16x16x32_bf16 v[136:139], v[180:183], v[56:59], v[136:139]
  ds_read_b64_tr_b16 v[214:215], v7 offset:63488
  v_mfma_f32_16x16x32_bf16 v[144:147], v[184:187], v[56:59], v[144:147]
  buffer_load_dwordx4 v[40:43], off, s[36:39], s50 offset:1024
  v_mfma_f32_16x16x32_bf16 v[148:151], v[184:187], v[60:63], v[148:151]
  ds_read_b64_tr_b16 v[216:217], v8 offset:61440
  ds_read_b64_tr_b16 v[218:219], v8 offset:63488
  v_mfma_f32_16x16x32_bf16 v[156:159], v[188:191], v[60:63], v[156:159]
  ds_read_b64_tr_b16 v[220:221], v9 offset:61440
  v_mfma_f32_16x16x32_bf16 v[152:155], v[188:191], v[56:59], v[152:155]
  ds_read_b64_tr_b16 v[222:223], v9 offset:63488
  s_waitcnt lgkmcnt(8)
  v_mfma_f32_16x16x32_bf16 v[96:99], v[192:195], v[48:51], v[96:99]
  ds_read_b64_tr_b16 v[160:161], v20 offset:0
  v_mfma_f32_16x16x32_bf16 v[100:103], v[192:195], v[52:55], v[100:103]
  ds_read_b64_tr_b16 v[162:163], v20 offset:2048
  v_mfma_f32_16x16x32_bf16 v[108:111], v[196:199], v[52:55], v[108:111]
  buffer_load_dwordx4 v[44:47], off, s[64:67], s50 offset:1024
  v_mfma_f32_16x16x32_bf16 v[104:107], v[196:199], v[48:51], v[104:107]
  ds_read_b64_tr_b16 v[164:165], v21 offset:0
  ds_read_b64_tr_b16 v[166:167], v21 offset:2048
  v_mfma_f32_16x16x32_bf16 v[112:115], v[200:203], v[48:51], v[112:115]
  ds_read_b64_tr_b16 v[168:169], v22 offset:0
  v_mfma_f32_16x16x32_bf16 v[116:119], v[200:203], v[52:55], v[116:119]
  ds_read_b64_tr_b16 v[170:171], v22 offset:2048
  v_mfma_f32_16x16x32_bf16 v[124:127], v[204:207], v[52:55], v[124:127]
  ds_read_b64_tr_b16 v[172:173], v23 offset:0
  v_mfma_f32_16x16x32_bf16 v[120:123], v[204:207], v[48:51], v[120:123]
  ds_read_b64_tr_b16 v[174:175], v23 offset:2048
  s_waitcnt lgkmcnt(8)
  s_barrier
  v_mfma_f32_16x16x32_bf16 v[96:99], v[208:211], v[56:59], v[96:99]
  ds_read_b64_tr_b16 v[176:177], v20 offset:4096
  v_mfma_f32_16x16x32_bf16 v[100:103], v[208:211], v[60:63], v[100:103]
  ds_read_b64_tr_b16 v[178:179], v20 offset:6144
  v_mfma_f32_16x16x32_bf16 v[108:111], v[212:215], v[60:63], v[108:111]
  ds_read_b64_tr_b16 v[180:181], v21 offset:4096
  v_mfma_f32_16x16x32_bf16 v[104:107], v[212:215], v[56:59], v[104:107]
  ds_read_b64_tr_b16 v[182:183], v21 offset:6144
  v_mfma_f32_16x16x32_bf16 v[112:115], v[216:219], v[56:59], v[112:115]
  ds_read_b64_tr_b16 v[184:185], v22 offset:4096
  v_mfma_f32_16x16x32_bf16 v[116:119], v[216:219], v[60:63], v[116:119]
  ds_read_b64_tr_b16 v[186:187], v22 offset:6144
  v_readlane_b32 s51, v15, 19
  v_mfma_f32_16x16x32_bf16 v[124:127], v[220:223], v[60:63], v[124:127]
  ds_read_b64_tr_b16 v[188:189], v23 offset:4096
  v_mfma_f32_16x16x32_bf16 v[120:123], v[220:223], v[56:59], v[120:123]
  ds_read_b64_tr_b16 v[190:191], v23 offset:6144
  s_waitcnt vmcnt(18) lgkmcnt(8)
  v_mfma_f32_16x16x32_bf16 v[128:131], v[160:163], v[64:67], v[128:131]
  buffer_load_dwordx4 v[48:51], off, s[36:39], s51 offset:0
  v_mfma_f32_16x16x32_bf16 v[132:135], v[160:163], v[68:71], v[132:135]
  ds_read_b64_tr_b16 v[192:193], v20 offset:8192
  ds_read_b64_tr_b16 v[194:195], v20 offset:10240
  v_mfma_f32_16x16x32_bf16 v[140:143], v[164:167], v[68:71], v[140:143]
  ds_read_b64_tr_b16 v[196:197], v21 offset:8192
  v_mfma_f32_16x16x32_bf16 v[136:139], v[164:167], v[64:67], v[136:139]
  ds_read_b64_tr_b16 v[198:199], v21 offset:10240
  v_mfma_f32_16x16x32_bf16 v[144:147], v[168:171], v[64:67], v[144:147]
  ds_read_b64_tr_b16 v[200:201], v22 offset:8192
  v_mfma_f32_16x16x32_bf16 v[148:151], v[168:171], v[68:71], v[148:151]
  ds_read_b64_tr_b16 v[202:203], v22 offset:10240
  ds_read_b64_tr_b16 v[204:205], v23 offset:8192
  v_mfma_f32_16x16x32_bf16 v[156:159], v[172:175], v[68:71], v[156:159]
  buffer_load_dwordx4 v[52:55], off, s[64:67], s51 offset:0
  v_mfma_f32_16x16x32_bf16 v[152:155], v[172:175], v[64:67], v[152:155]
  ds_read_b64_tr_b16 v[206:207], v23 offset:10240
  s_waitcnt vmcnt(18) lgkmcnt(8)
  v_mfma_f32_16x16x32_bf16 v[128:131], v[176:179], v[72:75], v[128:131]
  ds_read_b64_tr_b16 v[208:209], v20 offset:12288
  v_mfma_f32_16x16x32_bf16 v[132:135], v[176:179], v[76:79], v[132:135]
  ds_read_b64_tr_b16 v[210:211], v20 offset:14336
  v_mfma_f32_16x16x32_bf16 v[140:143], v[180:183], v[76:79], v[140:143]
  ds_read_b64_tr_b16 v[212:213], v21 offset:12288
  v_mfma_f32_16x16x32_bf16 v[136:139], v[180:183], v[72:75], v[136:139]
  ds_read_b64_tr_b16 v[214:215], v21 offset:14336
  v_mfma_f32_16x16x32_bf16 v[144:147], v[184:187], v[72:75], v[144:147]
  buffer_load_dwordx4 v[56:59], off, s[36:39], s51 offset:1024
  v_mfma_f32_16x16x32_bf16 v[148:151], v[184:187], v[76:79], v[148:151]
  ds_read_b64_tr_b16 v[216:217], v22 offset:12288
  ds_read_b64_tr_b16 v[218:219], v22 offset:14336
  v_mfma_f32_16x16x32_bf16 v[156:159], v[188:191], v[76:79], v[156:159]
  ds_read_b64_tr_b16 v[220:221], v23 offset:12288
  v_mfma_f32_16x16x32_bf16 v[152:155], v[188:191], v[72:75], v[152:155]
  ds_read_b64_tr_b16 v[222:223], v23 offset:14336
  s_waitcnt lgkmcnt(8)
  v_mfma_f32_16x16x32_bf16 v[96:99], v[192:195], v[64:67], v[96:99]
  ds_read_b64_tr_b16 v[160:161], v20 offset:16384
  v_mfma_f32_16x16x32_bf16 v[100:103], v[192:195], v[68:71], v[100:103]
  ds_read_b64_tr_b16 v[162:163], v20 offset:18432
  v_mfma_f32_16x16x32_bf16 v[108:111], v[196:199], v[68:71], v[108:111]
  buffer_load_dwordx4 v[60:63], off, s[64:67], s51 offset:1024
  v_mfma_f32_16x16x32_bf16 v[104:107], v[196:199], v[64:67], v[104:107]
  ds_read_b64_tr_b16 v[164:165], v21 offset:16384
  ds_read_b64_tr_b16 v[166:167], v21 offset:18432
  v_mfma_f32_16x16x32_bf16 v[112:115], v[200:203], v[64:67], v[112:115]
  ds_read_b64_tr_b16 v[168:169], v22 offset:16384
  v_mfma_f32_16x16x32_bf16 v[116:119], v[200:203], v[68:71], v[116:119]
  ds_read_b64_tr_b16 v[170:171], v22 offset:18432
  v_mfma_f32_16x16x32_bf16 v[124:127], v[204:207], v[68:71], v[124:127]
  ds_read_b64_tr_b16 v[172:173], v23 offset:16384
  v_mfma_f32_16x16x32_bf16 v[120:123], v[204:207], v[64:67], v[120:123]
  ds_read_b64_tr_b16 v[174:175], v23 offset:18432
  s_waitcnt lgkmcnt(8)
  v_mfma_f32_16x16x32_bf16 v[96:99], v[208:211], v[72:75], v[96:99]
  ds_read_b64_tr_b16 v[176:177], v20 offset:20480
  v_mfma_f32_16x16x32_bf16 v[100:103], v[208:211], v[76:79], v[100:103]
  ds_read_b64_tr_b16 v[178:179], v20 offset:22528
  v_mfma_f32_16x16x32_bf16 v[108:111], v[212:215], v[76:79], v[108:111]
  ds_read_b64_tr_b16 v[180:181], v21 offset:20480
  v_mfma_f32_16x16x32_bf16 v[104:107], v[212:215], v[72:75], v[104:107]
  ds_read_b64_tr_b16 v[182:183], v21 offset:22528
  v_mfma_f32_16x16x32_bf16 v[112:115], v[216:219], v[72:75], v[112:115]
  ds_read_b64_tr_b16 v[184:185], v22 offset:20480
  v_mfma_f32_16x16x32_bf16 v[116:119], v[216:219], v[76:79], v[116:119]
  ds_read_b64_tr_b16 v[186:187], v22 offset:22528
  v_readlane_b32 s48, v15, 20
  v_mfma_f32_16x16x32_bf16 v[124:127], v[220:223], v[76:79], v[124:127]
  ds_read_b64_tr_b16 v[188:189], v23 offset:20480
  v_mfma_f32_16x16x32_bf16 v[120:123], v[220:223], v[72:75], v[120:123]
  ds_read_b64_tr_b16 v[190:191], v23 offset:22528
  s_waitcnt vmcnt(18) lgkmcnt(8)
  v_mfma_f32_16x16x32_bf16 v[128:131], v[160:163], v[80:83], v[128:131]
  buffer_load_dwordx4 v[64:67], off, s[36:39], s48 offset:0
  v_mfma_f32_16x16x32_bf16 v[132:135], v[160:163], v[84:87], v[132:135]
  ds_read_b64_tr_b16 v[192:193], v20 offset:24576
  ds_read_b64_tr_b16 v[194:195], v20 offset:26624
  v_mfma_f32_16x16x32_bf16 v[140:143], v[164:167], v[84:87], v[140:143]
  ds_read_b64_tr_b16 v[196:197], v21 offset:24576
  v_mfma_f32_16x16x32_bf16 v[136:139], v[164:167], v[80:83], v[136:139]
  ds_read_b64_tr_b16 v[198:199], v21 offset:26624
  v_mfma_f32_16x16x32_bf16 v[144:147], v[168:171], v[80:83], v[144:147]
  ds_read_b64_tr_b16 v[200:201], v22 offset:24576
  v_mfma_f32_16x16x32_bf16 v[148:151], v[168:171], v[84:87], v[148:151]
  ds_read_b64_tr_b16 v[202:203], v22 offset:26624
  ds_read_b64_tr_b16 v[204:205], v23 offset:24576
  v_mfma_f32_16x16x32_bf16 v[156:159], v[172:175], v[84:87], v[156:159]
  buffer_load_dwordx4 v[68:71], off, s[64:67], s48 offset:0
  v_mfma_f32_16x16x32_bf16 v[152:155], v[172:175], v[80:83], v[152:155]
  ds_read_b64_tr_b16 v[206:207], v23 offset:26624
  s_waitcnt vmcnt(18) lgkmcnt(8)
  v_mfma_f32_16x16x32_bf16 v[128:131], v[176:179], v[88:91], v[128:131]
  ds_read_b64_tr_b16 v[208:209], v20 offset:28672
  v_mfma_f32_16x16x32_bf16 v[132:135], v[176:179], v[92:95], v[132:135]
  ds_read_b64_tr_b16 v[210:211], v20 offset:30720
  v_mfma_f32_16x16x32_bf16 v[140:143], v[180:183], v[92:95], v[140:143]
  ds_read_b64_tr_b16 v[212:213], v21 offset:28672
  v_mfma_f32_16x16x32_bf16 v[136:139], v[180:183], v[88:91], v[136:139]
  ds_read_b64_tr_b16 v[214:215], v21 offset:30720
  v_mfma_f32_16x16x32_bf16 v[144:147], v[184:187], v[88:91], v[144:147]
  buffer_load_dwordx4 v[72:75], off, s[36:39], s48 offset:1024
  v_mfma_f32_16x16x32_bf16 v[148:151], v[184:187], v[92:95], v[148:151]
  ds_read_b64_tr_b16 v[216:217], v22 offset:28672
  ds_read_b64_tr_b16 v[218:219], v22 offset:30720
  v_mfma_f32_16x16x32_bf16 v[156:159], v[188:191], v[92:95], v[156:159]
  ds_read_b64_tr_b16 v[220:221], v23 offset:28672
  v_mfma_f32_16x16x32_bf16 v[152:155], v[188:191], v[88:91], v[152:155]
  ds_read_b64_tr_b16 v[222:223], v23 offset:30720
  s_waitcnt lgkmcnt(8)
  v_mfma_f32_16x16x32_bf16 v[96:99], v[192:195], v[80:83], v[96:99]
  ds_read_b64_tr_b16 v[160:161], v20 offset:32768
  v_mfma_f32_16x16x32_bf16 v[100:103], v[192:195], v[84:87], v[100:103]
  ds_read_b64_tr_b16 v[162:163], v20 offset:34816
  v_mfma_f32_16x16x32_bf16 v[108:111], v[196:199], v[84:87], v[108:111]
  buffer_load_dwordx4 v[76:79], off, s[64:67], s48 offset:1024
  v_mfma_f32_16x16x32_bf16 v[104:107], v[196:199], v[80:83], v[104:107]
  ds_read_b64_tr_b16 v[164:165], v21 offset:32768
  ds_read_b64_tr_b16 v[166:167], v21 offset:34816
  v_mfma_f32_16x16x32_bf16 v[112:115], v[200:203], v[80:83], v[112:115]
  ds_read_b64_tr_b16 v[168:169], v22 offset:32768
  v_mfma_f32_16x16x32_bf16 v[116:119], v[200:203], v[84:87], v[116:119]
  ds_read_b64_tr_b16 v[170:171], v22 offset:34816
  v_mfma_f32_16x16x32_bf16 v[124:127], v[204:207], v[84:87], v[124:127]
  ds_read_b64_tr_b16 v[172:173], v23 offset:32768
  v_mfma_f32_16x16x32_bf16 v[120:123], v[204:207], v[80:83], v[120:123]
  ds_read_b64_tr_b16 v[174:175], v23 offset:34816
  s_waitcnt lgkmcnt(8)
  s_barrier
  v_mfma_f32_16x16x32_bf16 v[96:99], v[208:211], v[88:91], v[96:99]
  ds_read_b64_tr_b16 v[176:177], v20 offset:36864
  v_mfma_f32_16x16x32_bf16 v[100:103], v[208:211], v[92:95], v[100:103]
  ds_read_b64_tr_b16 v[178:179], v20 offset:38912
  v_mfma_f32_16x16x32_bf16 v[108:111], v[212:215], v[92:95], v[108:111]
  ds_read_b64_tr_b16 v[180:181], v21 offset:36864
  v_mfma_f32_16x16x32_bf16 v[104:107], v[212:215], v[88:91], v[104:107]
  ds_read_b64_tr_b16 v[182:183], v21 offset:38912
  v_mfma_f32_16x16x32_bf16 v[112:115], v[216:219], v[88:91], v[112:115]
  ds_read_b64_tr_b16 v[184:185], v22 offset:36864
  v_mfma_f32_16x16x32_bf16 v[116:119], v[216:219], v[92:95], v[116:119]
  ds_read_b64_tr_b16 v[186:187], v22 offset:38912
  v_readlane_b32 s49, v15, 21
  v_mfma_f32_16x16x32_bf16 v[124:127], v[220:223], v[92:95], v[124:127]
  ds_read_b64_tr_b16 v[188:189], v23 offset:36864
  v_mfma_f32_16x16x32_bf16 v[120:123], v[220:223], v[88:91], v[120:123]
  ds_read_b64_tr_b16 v[190:191], v23 offset:38912
  s_waitcnt vmcnt(18) lgkmcnt(8)
  v_mfma_f32_16x16x32_bf16 v[128:131], v[160:163], v[224:227], v[128:131]
  buffer_load_dwordx4 v[80:83], off, s[36:39], s49 offset:0
  v_mfma_f32_16x16x32_bf16 v[132:135], v[160:163], v[228:231], v[132:135]
  ds_read_b64_tr_b16 v[192:193], v20 offset:40960
  ds_read_b64_tr_b16 v[194:195], v20 offset:43008
  v_mfma_f32_16x16x32_bf16 v[140:143], v[164:167], v[228:231], v[140:143]
  ds_read_b64_tr_b16 v[196:197], v21 offset:40960
  v_mfma_f32_16x16x32_bf16 v[136:139], v[164:167], v[224:227], v[136:139]
  ds_read_b64_tr_b16 v[198:199], v21 offset:43008
  v_mfma_f32_16x16x32_bf16 v[144:147], v[168:171], v[224:227], v[144:147]
  ds_read_b64_tr_b16 v[200:201], v22 offset:40960
  v_mfma_f32_16x16x32_bf16 v[148:151], v[168:171], v[228:231], v[148:151]
  ds_read_b64_tr_b16 v[202:203], v22 offset:43008
  ds_read_b64_tr_b16 v[204:205], v23 offset:40960
  v_mfma_f32_16x16x32_bf16 v[156:159], v[172:175], v[228:231], v[156:159]
  buffer_load_dwordx4 v[84:87], off, s[64:67], s49 offset:0
  v_mfma_f32_16x16x32_bf16 v[152:155], v[172:175], v[224:227], v[152:155]
  ds_read_b64_tr_b16 v[206:207], v23 offset:43008
  s_waitcnt vmcnt(18) lgkmcnt(8)
  v_mfma_f32_16x16x32_bf16 v[128:131], v[176:179], v[232:235], v[128:131]
  ds_read_b64_tr_b16 v[208:209], v20 offset:45056
  v_mfma_f32_16x16x32_bf16 v[132:135], v[176:179], v[236:239], v[132:135]
  ds_read_b64_tr_b16 v[210:211], v20 offset:47104
  v_mfma_f32_16x16x32_bf16 v[140:143], v[180:183], v[236:239], v[140:143]
  ds_read_b64_tr_b16 v[212:213], v21 offset:45056
  v_mfma_f32_16x16x32_bf16 v[136:139], v[180:183], v[232:235], v[136:139]
  ds_read_b64_tr_b16 v[214:215], v21 offset:47104
  v_mfma_f32_16x16x32_bf16 v[144:147], v[184:187], v[232:235], v[144:147]
  buffer_load_dwordx4 v[88:91], off, s[36:39], s49 offset:1024
  v_mfma_f32_16x16x32_bf16 v[148:151], v[184:187], v[236:239], v[148:151]
  ds_read_b64_tr_b16 v[216:217], v22 offset:45056
  ds_read_b64_tr_b16 v[218:219], v22 offset:47104
  v_mfma_f32_16x16x32_bf16 v[156:159], v[188:191], v[236:239], v[156:159]
  ds_read_b64_tr_b16 v[220:221], v23 offset:45056
  v_mfma_f32_16x16x32_bf16 v[152:155], v[188:191], v[232:235], v[152:155]
  ds_read_b64_tr_b16 v[222:223], v23 offset:47104
  s_waitcnt lgkmcnt(8)
  v_mfma_f32_16x16x32_bf16 v[96:99], v[192:195], v[224:227], v[96:99]
  ds_read_b64_tr_b16 v[160:161], v20 offset:49152
  v_mfma_f32_16x16x32_bf16 v[100:103], v[192:195], v[228:231], v[100:103]
  ds_read_b64_tr_b16 v[162:163], v20 offset:51200
  v_mfma_f32_16x16x32_bf16 v[108:111], v[196:199], v[228:231], v[108:111]
  buffer_load_dwordx4 v[92:95], off, s[64:67], s49 offset:1024
  v_mfma_f32_16x16x32_bf16 v[104:107], v[196:199], v[224:227], v[104:107]
  ds_read_b64_tr_b16 v[164:165], v21 offset:49152
  ds_read_b64_tr_b16 v[166:167], v21 offset:51200
  v_mfma_f32_16x16x32_bf16 v[112:115], v[200:203], v[224:227], v[112:115]
  ds_read_b64_tr_b16 v[168:169], v22 offset:49152
  v_mfma_f32_16x16x32_bf16 v[116:119], v[200:203], v[228:231], v[116:119]
  ds_read_b64_tr_b16 v[170:171], v22 offset:51200
  v_mfma_f32_16x16x32_bf16 v[124:127], v[204:207], v[228:231], v[124:127]
  ds_read_b64_tr_b16 v[172:173], v23 offset:49152
  v_mfma_f32_16x16x32_bf16 v[120:123], v[204:207], v[224:227], v[120:123]
  ds_read_b64_tr_b16 v[174:175], v23 offset:51200
  s_waitcnt lgkmcnt(8)
  v_mfma_f32_16x16x32_bf16 v[96:99], v[208:211], v[232:235], v[96:99]
  ds_read_b64_tr_b16 v[176:177], v20 offset:53248
  v_mfma_f32_16x16x32_bf16 v[100:103], v[208:211], v[236:239], v[100:103]
  ds_read_b64_tr_b16 v[178:179], v20 offset:55296
  v_mfma_f32_16x16x32_bf16 v[108:111], v[212:215], v[236:239], v[108:111]
  ds_read_b64_tr_b16 v[180:181], v21 offset:53248
  v_mfma_f32_16x16x32_bf16 v[104:107], v[212:215], v[232:235], v[104:107]
  ds_read_b64_tr_b16 v[182:183], v21 offset:55296
  v_mfma_f32_16x16x32_bf16 v[112:115], v[216:219], v[232:235], v[112:115]
  ds_read_b64_tr_b16 v[184:185], v22 offset:53248
  v_mfma_f32_16x16x32_bf16 v[116:119], v[216:219], v[236:239], v[116:119]
  ds_read_b64_tr_b16 v[186:187], v22 offset:55296
  v_readlane_b32 s50, v15, 22
  v_mfma_f32_16x16x32_bf16 v[124:127], v[220:223], v[236:239], v[124:127]
  ds_read_b64_tr_b16 v[188:189], v23 offset:53248
  v_mfma_f32_16x16x32_bf16 v[120:123], v[220:223], v[232:235], v[120:123]
  ds_read_b64_tr_b16 v[190:191], v23 offset:55296
  s_waitcnt vmcnt(18) lgkmcnt(8)
  v_mfma_f32_16x16x32_bf16 v[128:131], v[160:163], v[240:243], v[128:131]
  buffer_load_dwordx4 v[224:227], off, s[36:39], s50 offset:0
  v_mfma_f32_16x16x32_bf16 v[132:135], v[160:163], v[244:247], v[132:135]
  ds_read_b64_tr_b16 v[192:193], v20 offset:57344
  ds_read_b64_tr_b16 v[194:195], v20 offset:59392
  v_mfma_f32_16x16x32_bf16 v[140:143], v[164:167], v[244:247], v[140:143]
  ds_read_b64_tr_b16 v[196:197], v21 offset:57344
  v_mfma_f32_16x16x32_bf16 v[136:139], v[164:167], v[240:243], v[136:139]
  ds_read_b64_tr_b16 v[198:199], v21 offset:59392
  v_mfma_f32_16x16x32_bf16 v[144:147], v[168:171], v[240:243], v[144:147]
  ds_read_b64_tr_b16 v[200:201], v22 offset:57344
  v_mfma_f32_16x16x32_bf16 v[148:151], v[168:171], v[244:247], v[148:151]
  ds_read_b64_tr_b16 v[202:203], v22 offset:59392
  ds_read_b64_tr_b16 v[204:205], v23 offset:57344
  v_mfma_f32_16x16x32_bf16 v[156:159], v[172:175], v[244:247], v[156:159]
  buffer_load_dwordx4 v[228:231], off, s[64:67], s50 offset:0
  v_mfma_f32_16x16x32_bf16 v[152:155], v[172:175], v[240:243], v[152:155]
  ds_read_b64_tr_b16 v[206:207], v23 offset:59392
  s_waitcnt vmcnt(18) lgkmcnt(8)
  v_mfma_f32_16x16x32_bf16 v[128:131], v[176:179], v[248:251], v[128:131]
  ds_read_b64_tr_b16 v[208:209], v20 offset:61440
  v_mfma_f32_16x16x32_bf16 v[132:135], v[176:179], v[252:255], v[132:135]
  ds_read_b64_tr_b16 v[210:211], v20 offset:63488
  v_mfma_f32_16x16x32_bf16 v[140:143], v[180:183], v[252:255], v[140:143]
  ds_read_b64_tr_b16 v[212:213], v21 offset:61440
  v_mfma_f32_16x16x32_bf16 v[136:139], v[180:183], v[248:251], v[136:139]
  ds_read_b64_tr_b16 v[214:215], v21 offset:63488
  v_mfma_f32_16x16x32_bf16 v[144:147], v[184:187], v[248:251], v[144:147]
  buffer_load_dwordx4 v[232:235], off, s[36:39], s50 offset:1024
  v_mfma_f32_16x16x32_bf16 v[148:151], v[184:187], v[252:255], v[148:151]
  ds_read_b64_tr_b16 v[216:217], v22 offset:61440
  ds_read_b64_tr_b16 v[218:219], v22 offset:63488
  v_mfma_f32_16x16x32_bf16 v[156:159], v[188:191], v[252:255], v[156:159]
  ds_read_b64_tr_b16 v[220:221], v23 offset:61440
  v_mfma_f32_16x16x32_bf16 v[152:155], v[188:191], v[248:251], v[152:155]
  ds_read_b64_tr_b16 v[222:223], v23 offset:63488
  s_waitcnt vmcnt(17) lgkmcnt(8)
  v_mfma_f32_16x16x32_bf16 v[128:131], v[192:195], v[32:35], v[128:131]
  ds_read_b64_tr_b16 v[160:161], v26 offset:0
  v_mfma_f32_16x16x32_bf16 v[132:135], v[192:195], v[36:39], v[132:135]
  ds_read_b64_tr_b16 v[162:163], v26 offset:2048
  v_mfma_f32_16x16x32_bf16 v[140:143], v[196:199], v[36:39], v[140:143]
  buffer_load_dwordx4 v[236:239], off, s[64:67], s50 offset:1024
  v_mfma_f32_16x16x32_bf16 v[136:139], v[196:199], v[32:35], v[136:139]
  ds_read_b64_tr_b16 v[164:165], v27 offset:0
  ds_read_b64_tr_b16 v[166:167], v27 offset:2048
  v_mfma_f32_16x16x32_bf16 v[144:147], v[200:203], v[32:35], v[144:147]
  ds_read_b64_tr_b16 v[168:169], v28 offset:0
  v_mfma_f32_16x16x32_bf16 v[148:151], v[200:203], v[36:39], v[148:151]
  ds_read_b64_tr_b16 v[170:171], v28 offset:2048
  v_mfma_f32_16x16x32_bf16 v[156:159], v[204:207], v[36:39], v[156:159]
  ds_read_b64_tr_b16 v[172:173], v29 offset:0
  v_mfma_f32_16x16x32_bf16 v[152:155], v[204:207], v[32:35], v[152:155]
  ds_read_b64_tr_b16 v[174:175], v29 offset:2048
  s_waitcnt vmcnt(16) lgkmcnt(8)
  s_barrier
  v_mfma_f32_16x16x32_bf16 v[128:131], v[208:211], v[40:43], v[128:131]
  ds_read_b64_tr_b16 v[176:177], v26 offset:4096
  v_mfma_f32_16x16x32_bf16 v[132:135], v[208:211], v[44:47], v[132:135]
  ds_read_b64_tr_b16 v[178:179], v26 offset:6144
  v_mfma_f32_16x16x32_bf16 v[140:143], v[212:215], v[44:47], v[140:143]
  ds_read_b64_tr_b16 v[180:181], v27 offset:4096
  v_mfma_f32_16x16x32_bf16 v[136:139], v[212:215], v[40:43], v[136:139]
  ds_read_b64_tr_b16 v[182:183], v27 offset:6144
  v_mfma_f32_16x16x32_bf16 v[144:147], v[216:219], v[40:43], v[144:147]
  ds_read_b64_tr_b16 v[184:185], v28 offset:4096
  v_mfma_f32_16x16x32_bf16 v[148:151], v[216:219], v[44:47], v[148:151]
  ds_read_b64_tr_b16 v[186:187], v28 offset:6144
  v_mfma_f32_16x16x32_bf16 v[156:159], v[220:223], v[44:47], v[156:159]
  ds_read_b64_tr_b16 v[188:189], v29 offset:4096
  v_mfma_f32_16x16x32_bf16 v[152:155], v[220:223], v[40:43], v[152:155]
  ds_read_b64_tr_b16 v[190:191], v29 offset:6144
  s_waitcnt vmcnt(14) lgkmcnt(8)
  v_mfma_f32_16x16x32_bf16 v[128:131], v[160:163], v[48:51], v[128:131]
  ds_read_b64_tr_b16 v[192:193], v26 offset:8192
  v_mfma_f32_16x16x32_bf16 v[132:135], v[160:163], v[52:55], v[132:135]
  ds_read_b64_tr_b16 v[194:195], v26 offset:10240
  v_mfma_f32_16x16x32_bf16 v[140:143], v[164:167], v[52:55], v[140:143]
  ds_read_b64_tr_b16 v[196:197], v27 offset:8192
  v_mfma_f32_16x16x32_bf16 v[136:139], v[164:167], v[48:51], v[136:139]
  ds_read_b64_tr_b16 v[198:199], v27 offset:10240
  v_mfma_f32_16x16x32_bf16 v[144:147], v[168:171], v[48:51], v[144:147]
  ds_read_b64_tr_b16 v[200:201], v28 offset:8192
  v_mfma_f32_16x16x32_bf16 v[148:151], v[168:171], v[52:55], v[148:151]
  ds_read_b64_tr_b16 v[202:203], v28 offset:10240
  v_mfma_f32_16x16x32_bf16 v[156:159], v[172:175], v[52:55], v[156:159]
  ds_read_b64_tr_b16 v[204:205], v29 offset:8192
  v_mfma_f32_16x16x32_bf16 v[152:155], v[172:175], v[48:51], v[152:155]
  ds_read_b64_tr_b16 v[206:207], v29 offset:10240
  s_waitcnt vmcnt(12) lgkmcnt(8)
  v_mfma_f32_16x16x32_bf16 v[128:131], v[176:179], v[56:59], v[128:131]
  ds_read_b64_tr_b16 v[208:209], v26 offset:12288
  v_mfma_f32_16x16x32_bf16 v[132:135], v[176:179], v[60:63], v[132:135]
  ds_read_b64_tr_b16 v[210:211], v26 offset:14336
  v_mfma_f32_16x16x32_bf16 v[140:143], v[180:183], v[60:63], v[140:143]
  ds_read_b64_tr_b16 v[212:213], v27 offset:12288
  v_mfma_f32_16x16x32_bf16 v[136:139], v[180:183], v[56:59], v[136:139]
  ds_read_b64_tr_b16 v[214:215], v27 offset:14336
  v_mfma_f32_16x16x32_bf16 v[144:147], v[184:187], v[56:59], v[144:147]
  ds_read_b64_tr_b16 v[216:217], v28 offset:12288
  v_mfma_f32_16x16x32_bf16 v[148:151], v[184:187], v[60:63], v[148:151]
  ds_read_b64_tr_b16 v[218:219], v28 offset:14336
  v_mfma_f32_16x16x32_bf16 v[156:159], v[188:191], v[60:63], v[156:159]
  ds_read_b64_tr_b16 v[220:221], v29 offset:12288
  v_mfma_f32_16x16x32_bf16 v[152:155], v[188:191], v[56:59], v[152:155]
  ds_read_b64_tr_b16 v[222:223], v29 offset:14336
  s_waitcnt vmcnt(10) lgkmcnt(8)
  v_mfma_f32_16x16x32_bf16 v[128:131], v[192:195], v[64:67], v[128:131]
  ds_read_b64_tr_b16 v[160:161], v26 offset:16384
  v_mfma_f32_16x16x32_bf16 v[132:135], v[192:195], v[68:71], v[132:135]
  ds_read_b64_tr_b16 v[162:163], v26 offset:18432
  v_mfma_f32_16x16x32_bf16 v[140:143], v[196:199], v[68:71], v[140:143]
  ds_read_b64_tr_b16 v[164:165], v27 offset:16384
  v_mfma_f32_16x16x32_bf16 v[136:139], v[196:199], v[64:67], v[136:139]
  ds_read_b64_tr_b16 v[166:167], v27 offset:18432
  v_mfma_f32_16x16x32_bf16 v[144:147], v[200:203], v[64:67], v[144:147]
  ds_read_b64_tr_b16 v[168:169], v28 offset:16384
  v_mfma_f32_16x16x32_bf16 v[148:151], v[200:203], v[68:71], v[148:151]
  ds_read_b64_tr_b16 v[170:171], v28 offset:18432
  v_mfma_f32_16x16x32_bf16 v[156:159], v[204:207], v[68:71], v[156:159]
  ds_read_b64_tr_b16 v[172:173], v29 offset:16384
  v_mfma_f32_16x16x32_bf16 v[152:155], v[204:207], v[64:67], v[152:155]
  ds_read_b64_tr_b16 v[174:175], v29 offset:18432
  s_waitcnt vmcnt(8) lgkmcnt(8)
  v_mfma_f32_16x16x32_bf16 v[128:131], v[208:211], v[72:75], v[128:131]
  ds_read_b64_tr_b16 v[176:177], v26 offset:20480
  v_mfma_f32_16x16x32_bf16 v[132:135], v[208:211], v[76:79], v[132:135]
  ds_read_b64_tr_b16 v[178:179], v26 offset:22528
  v_mfma_f32_16x16x32_bf16 v[140:143], v[212:215], v[76:79], v[140:143]
  ds_read_b64_tr_b16 v[180:181], v27 offset:20480
  v_mfma_f32_16x16x32_bf16 v[136:139], v[212:215], v[72:75], v[136:139]
  ds_read_b64_tr_b16 v[182:183], v27 offset:22528
  v_mfma_f32_16x16x32_bf16 v[144:147], v[216:219], v[72:75], v[144:147]
  ds_read_b64_tr_b16 v[184:185], v28 offset:20480
  v_mfma_f32_16x16x32_bf16 v[148:151], v[216:219], v[76:79], v[148:151]
  ds_read_b64_tr_b16 v[186:187], v28 offset:22528
  v_mfma_f32_16x16x32_bf16 v[156:159], v[220:223], v[76:79], v[156:159]
  ds_read_b64_tr_b16 v[188:189], v29 offset:20480
  v_mfma_f32_16x16x32_bf16 v[152:155], v[220:223], v[72:75], v[152:155]
  ds_read_b64_tr_b16 v[190:191], v29 offset:22528
  s_waitcnt vmcnt(6) lgkmcnt(8)
  v_mfma_f32_16x16x32_bf16 v[128:131], v[160:163], v[80:83], v[128:131]
  ds_read_b64_tr_b16 v[192:193], v26 offset:24576
  v_mfma_f32_16x16x32_bf16 v[132:135], v[160:163], v[84:87], v[132:135]
  ds_read_b64_tr_b16 v[194:195], v26 offset:26624
  v_mfma_f32_16x16x32_bf16 v[140:143], v[164:167], v[84:87], v[140:143]
  ds_read_b64_tr_b16 v[196:197], v27 offset:24576
  v_mfma_f32_16x16x32_bf16 v[136:139], v[164:167], v[80:83], v[136:139]
  ds_read_b64_tr_b16 v[198:199], v27 offset:26624
  v_mfma_f32_16x16x32_bf16 v[144:147], v[168:171], v[80:83], v[144:147]
  ds_read_b64_tr_b16 v[200:201], v28 offset:24576
  v_mfma_f32_16x16x32_bf16 v[148:151], v[168:171], v[84:87], v[148:151]
  ds_read_b64_tr_b16 v[202:203], v28 offset:26624
  v_mfma_f32_16x16x32_bf16 v[156:159], v[172:175], v[84:87], v[156:159]
  ds_read_b64_tr_b16 v[204:205], v29 offset:24576
  v_mfma_f32_16x16x32_bf16 v[152:155], v[172:175], v[80:83], v[152:155]
  ds_read_b64_tr_b16 v[206:207], v29 offset:26624
  s_waitcnt vmcnt(4) lgkmcnt(8)
  v_mfma_f32_16x16x32_bf16 v[128:131], v[176:179], v[88:91], v[128:131]
  ds_read_b64_tr_b16 v[208:209], v26 offset:28672
  v_mfma_f32_16x16x32_bf16 v[132:135], v[176:179], v[92:95], v[132:135]
  ds_read_b64_tr_b16 v[210:211], v26 offset:30720
  v_mfma_f32_16x16x32_bf16 v[140:143], v[180:183], v[92:95], v[140:143]
  ds_read_b64_tr_b16 v[212:213], v27 offset:28672
  v_mfma_f32_16x16x32_bf16 v[136:139], v[180:183], v[88:91], v[136:139]
  ds_read_b64_tr_b16 v[214:215], v27 offset:30720
  v_mfma_f32_16x16x32_bf16 v[144:147], v[184:187], v[88:91], v[144:147]
  ds_read_b64_tr_b16 v[216:217], v28 offset:28672
  v_mfma_f32_16x16x32_bf16 v[148:151], v[184:187], v[92:95], v[148:151]
  ds_read_b64_tr_b16 v[218:219], v28 offset:30720
  v_mfma_f32_16x16x32_bf16 v[156:159], v[188:191], v[92:95], v[156:159]
  ds_read_b64_tr_b16 v[220:221], v29 offset:28672
  v_mfma_f32_16x16x32_bf16 v[152:155], v[188:191], v[88:91], v[152:155]
  ds_read_b64_tr_b16 v[222:223], v29 offset:30720
  s_waitcnt vmcnt(2) lgkmcnt(8)
  v_mfma_f32_16x16x32_bf16 v[128:131], v[192:195], v[224:227], v[128:131]
  ds_read_b64_tr_b16 v[160:161], v6 offset:0
  v_mfma_f32_16x16x32_bf16 v[132:135], v[192:195], v[228:231], v[132:135]
  ds_read_b64_tr_b16 v[162:163], v6 offset:2048
  v_mfma_f32_16x16x32_bf16 v[140:143], v[196:199], v[228:231], v[140:143]
  ds_read_b64_tr_b16 v[164:165], v7 offset:0
  v_mfma_f32_16x16x32_bf16 v[136:139], v[196:199], v[224:227], v[136:139]
  ds_read_b64_tr_b16 v[166:167], v7 offset:2048
  v_mfma_f32_16x16x32_bf16 v[144:147], v[200:203], v[224:227], v[144:147]
  ds_read_b64_tr_b16 v[168:169], v8 offset:0
  v_mfma_f32_16x16x32_bf16 v[148:151], v[200:203], v[228:231], v[148:151]
  ds_read_b64_tr_b16 v[170:171], v8 offset:2048
  v_mfma_f32_16x16x32_bf16 v[156:159], v[204:207], v[228:231], v[156:159]
  ds_read_b64_tr_b16 v[172:173], v9 offset:0
  v_mfma_f32_16x16x32_bf16 v[152:155], v[204:207], v[224:227], v[152:155]
  ds_read_b64_tr_b16 v[174:175], v9 offset:2048
  s_waitcnt vmcnt(0) lgkmcnt(8)
  s_barrier
  v_mfma_f32_16x16x32_bf16 v[128:131], v[208:211], v[232:235], v[128:131]
  ds_read_b64_tr_b16 v[176:177], v6 offset:4096
  v_mfma_f32_16x16x32_bf16 v[132:135], v[208:211], v[236:239], v[132:135]
  ds_read_b64_tr_b16 v[178:179], v6 offset:6144
  v_mfma_f32_16x16x32_bf16 v[140:143], v[212:215], v[236:239], v[140:143]
  ds_read_b64_tr_b16 v[180:181], v7 offset:4096
  v_mfma_f32_16x16x32_bf16 v[136:139], v[212:215], v[232:235], v[136:139]
  ds_read_b64_tr_b16 v[182:183], v7 offset:6144
  v_mfma_f32_16x16x32_bf16 v[144:147], v[216:219], v[232:235], v[144:147]
  ds_read_b64_tr_b16 v[184:185], v8 offset:4096
  v_mfma_f32_16x16x32_bf16 v[148:151], v[216:219], v[236:239], v[148:151]
  ds_read_b64_tr_b16 v[186:187], v8 offset:6144
  v_mfma_f32_16x16x32_bf16 v[156:159], v[220:223], v[236:239], v[156:159]
  ds_read_b64_tr_b16 v[188:189], v9 offset:4096
  v_mfma_f32_16x16x32_bf16 v[152:155], v[220:223], v[232:235], v[152:155]
  ds_read_b64_tr_b16 v[190:191], v9 offset:6144
  s_waitcnt lgkmcnt(8)
  v_mfma_f32_16x16x32_bf16 v[96:99], v[160:163], v[240:243], v[96:99]
  ds_read_b64_tr_b16 v[192:193], v6 offset:8192
  v_mfma_f32_16x16x32_bf16 v[100:103], v[160:163], v[244:247], v[100:103]
  ds_read_b64_tr_b16 v[194:195], v6 offset:10240
  v_mfma_f32_16x16x32_bf16 v[108:111], v[164:167], v[244:247], v[108:111]
  ds_read_b64_tr_b16 v[196:197], v7 offset:8192
  v_cvt_pk_bf16_f32 v128, v128, v129
  v_mfma_f32_16x16x32_bf16 v[104:107], v[164:167], v[240:243], v[104:107]
  ds_read_b64_tr_b16 v[198:199], v7 offset:10240
  v_cvt_pk_bf16_f32 v129, v130, v131
  v_mfma_f32_16x16x32_bf16 v[112:115], v[168:171], v[240:243], v[112:115]
  ds_read_b64_tr_b16 v[200:201], v8 offset:8192
  v_cvt_pk_bf16_f32 v130, v132, v133
  v_mfma_f32_16x16x32_bf16 v[116:119], v[168:171], v[244:247], v[116:119]
  ds_read_b64_tr_b16 v[202:203], v8 offset:10240
  v_cvt_pk_bf16_f32 v131, v134, v135
  v_mfma_f32_16x16x32_bf16 v[124:127], v[172:175], v[244:247], v[124:127]
  ds_read_b64_tr_b16 v[204:205], v9 offset:8192
  buffer_store_dwordx4 v[128:131], off, s[60:63], s4 offset:0 sc1
  v_mfma_f32_16x16x32_bf16 v[120:123], v[172:175], v[240:243], v[120:123]
  ds_read_b64_tr_b16 v[206:207], v9 offset:10240
  s_waitcnt lgkmcnt(8)
  v_mfma_f32_16x16x32_bf16 v[96:99], v[176:179], v[248:251], v[96:99]
  ds_read_b64_tr_b16 v[208:209], v6 offset:12288
  v_cvt_pk_bf16_f32 v132, v136, v137
  v_mfma_f32_16x16x32_bf16 v[100:103], v[176:179], v[252:255], v[100:103]
  ds_read_b64_tr_b16 v[210:211], v6 offset:14336
  v_cvt_pk_bf16_f32 v133, v138, v139
  v_mfma_f32_16x16x32_bf16 v[108:111], v[180:183], v[252:255], v[108:111]
  ds_read_b64_tr_b16 v[212:213], v7 offset:12288
  v_cvt_pk_bf16_f32 v134, v140, v141
  v_mfma_f32_16x16x32_bf16 v[104:107], v[180:183], v[248:251], v[104:107]
  ds_read_b64_tr_b16 v[214:215], v7 offset:14336
  v_cvt_pk_bf16_f32 v135, v142, v143
  v_mfma_f32_16x16x32_bf16 v[112:115], v[184:187], v[248:251], v[112:115]
  ds_read_b64_tr_b16 v[216:217], v8 offset:12288
  buffer_store_dwordx4 v[132:135], off, s[60:63], s4 offset:1024 sc1
  v_mfma_f32_16x16x32_bf16 v[116:119], v[184:187], v[252:255], v[116:119]
  ds_read_b64_tr_b16 v[218:219], v8 offset:14336
  v_readlane_b32 s51, v15, 23
  v_mfma_f32_16x16x32_bf16 v[124:127], v[188:191], v[252:255], v[124:127]
  ds_read_b64_tr_b16 v[220:221], v9 offset:12288
  v_cvt_pk_bf16_f32 v136, v144, v145
  v_mfma_f32_16x16x32_bf16 v[120:123], v[188:191], v[248:251], v[120:123]
  ds_read_b64_tr_b16 v[222:223], v9 offset:14336
  s_waitcnt lgkmcnt(8)
  v_mfma_f32_16x16x32_bf16 v[96:99], v[192:195], v[32:35], v[96:99]
  ds_read_b64_tr_b16 v[160:161], v6 offset:16384
  buffer_load_dwordx4 v[240:243], off, s[36:39], s51 offset:0
  v_mfma_f32_16x16x32_bf16 v[100:103], v[192:195], v[36:39], v[100:103]
  ds_read_b64_tr_b16 v[162:163], v6 offset:18432
  v_cvt_pk_bf16_f32 v137, v146, v147
  v_mfma_f32_16x16x32_bf16 v[108:111], v[196:199], v[36:39], v[108:111]
  ds_read_b64_tr_b16 v[164:165], v7 offset:16384
  v_cvt_pk_bf16_f32 v138, v148, v149
  v_mfma_f32_16x16x32_bf16 v[104:107], v[196:199], v[32:35], v[104:107]
  ds_read_b64_tr_b16 v[166:167], v7 offset:18432
  v_cvt_pk_bf16_f32 v139, v150, v151
  v_mfma_f32_16x16x32_bf16 v[112:115], v[200:203], v[32:35], v[112:115]
  ds_read_b64_tr_b16 v[168:169], v8 offset:16384
  buffer_load_dwordx4 v[244:247], off, s[64:67], s51 offset:0
  v_mfma_f32_16x16x32_bf16 v[116:119], v[200:203], v[36:39], v[116:119]
  ds_read_b64_tr_b16 v[170:171], v8 offset:18432
  buffer_store_dwordx4 v[136:139], off, s[60:63], s4 offset:2048 sc1
  v_mfma_f32_16x16x32_bf16 v[124:127], v[204:207], v[36:39], v[124:127]
  ds_read_b64_tr_b16 v[172:173], v9 offset:16384
  v_cvt_pk_bf16_f32 v140, v152, v153
  v_mfma_f32_16x16x32_bf16 v[120:123], v[204:207], v[32:35], v[120:123]
  ds_read_b64_tr_b16 v[174:175], v9 offset:18432
  s_waitcnt lgkmcnt(8)
  v_mfma_f32_16x16x32_bf16 v[96:99], v[208:211], v[40:43], v[96:99]
  ds_read_b64_tr_b16 v[176:177], v6 offset:20480
  buffer_load_dwordx4 v[248:251], off, s[36:39], s51 offset:1024
  v_mfma_f32_16x16x32_bf16 v[100:103], v[208:211], v[44:47], v[100:103]
  ds_read_b64_tr_b16 v[178:179], v6 offset:22528
  v_cvt_pk_bf16_f32 v141, v154, v155
  v_mfma_f32_16x16x32_bf16 v[108:111], v[212:215], v[44:47], v[108:111]
  ds_read_b64_tr_b16 v[180:181], v7 offset:20480
  v_cvt_pk_bf16_f32 v142, v156, v157
  v_mfma_f32_16x16x32_bf16 v[104:107], v[212:215], v[40:43], v[104:107]
  ds_read_b64_tr_b16 v[182:183], v7 offset:22528
  v_cvt_pk_bf16_f32 v143, v158, v159
  v_mfma_f32_16x16x32_bf16 v[112:115], v[216:219], v[40:43], v[112:115]
  ds_read_b64_tr_b16 v[184:185], v8 offset:20480
  buffer_load_dwordx4 v[252:255], off, s[64:67], s51 offset:1024
  v_mfma_f32_16x16x32_bf16 v[116:119], v[216:219], v[44:47], v[116:119]
  ds_read_b64_tr_b16 v[186:187], v8 offset:22528
  buffer_store_dwordx4 v[140:143], off, s[60:63], s4 offset:3072 sc1
  v_mfma_f32_16x16x32_bf16 v[124:127], v[220:223], v[44:47], v[124:127]
  ds_read_b64_tr_b16 v[188:189], v9 offset:20480
  v_readlane_b32 s48, v15, 24
  v_mfma_f32_16x16x32_bf16 v[120:123], v[220:223], v[40:43], v[120:123]
  ds_read_b64_tr_b16 v[190:191], v9 offset:22528
  s_waitcnt lgkmcnt(8)
  v_mfma_f32_16x16x32_bf16 v[96:99], v[160:163], v[48:51], v[96:99]
  ds_read_b64_tr_b16 v[192:193], v6 offset:24576
  v_mfma_f32_16x16x32_bf16 v[100:103], v[160:163], v[52:55], v[100:103]
  buffer_load_dwordx4 v[32:35], off, s[36:39], s48 offset:0
  v_mfma_f32_16x16x32_bf16 v[108:111], v[164:167], v[52:55], v[108:111]
  ds_read_b64_tr_b16 v[194:195], v6 offset:26624
  ds_read_b64_tr_b16 v[196:197], v7 offset:24576
  v_mfma_f32_16x16x32_bf16 v[104:107], v[164:167], v[48:51], v[104:107]
  ds_read_b64_tr_b16 v[198:199], v7 offset:26624
  v_mfma_f32_16x16x32_bf16 v[112:115], v[168:171], v[48:51], v[112:115]
  ds_read_b64_tr_b16 v[200:201], v8 offset:24576
  v_mfma_f32_16x16x32_bf16 v[116:119], v[168:171], v[52:55], v[116:119]
  buffer_load_dwordx4 v[36:39], off, s[64:67], s48 offset:0
  v_mfma_f32_16x16x32_bf16 v[124:127], v[172:175], v[52:55], v[124:127]
  ds_read_b64_tr_b16 v[202:203], v8 offset:26624
  ds_read_b64_tr_b16 v[204:205], v9 offset:24576
  v_mfma_f32_16x16x32_bf16 v[120:123], v[172:175], v[48:51], v[120:123]
  ds_read_b64_tr_b16 v[206:207], v9 offset:26624
  s_waitcnt lgkmcnt(8)
  v_mfma_f32_16x16x32_bf16 v[96:99], v[176:179], v[56:59], v[96:99]
  ds_read_b64_tr_b16 v[208:209], v6 offset:28672
  v_mfma_f32_16x16x32_bf16 v[100:103], v[176:179], v[60:63], v[100:103]
  buffer_load_dwordx4 v[40:43], off, s[36:39], s48 offset:1024
  v_mfma_f32_16x16x32_bf16 v[108:111], v[180:183], v[60:63], v[108:111]
  ds_read_b64_tr_b16 v[210:211], v6 offset:30720
  ds_read_b64_tr_b16 v[212:213], v7 offset:28672
  v_mfma_f32_16x16x32_bf16 v[104:107], v[180:183], v[56:59], v[104:107]
  ds_read_b64_tr_b16 v[214:215], v7 offset:30720
  v_mfma_f32_16x16x32_bf16 v[112:115], v[184:187], v[56:59], v[112:115]
  ds_read_b64_tr_b16 v[216:217], v8 offset:28672
  v_mfma_f32_16x16x32_bf16 v[116:119], v[184:187], v[60:63], v[116:119]
  buffer_load_dwordx4 v[44:47], off, s[64:67], s48 offset:1024
  v_mfma_f32_16x16x32_bf16 v[124:127], v[188:191], v[60:63], v[124:127]
  ds_read_b64_tr_b16 v[218:219], v8 offset:30720
  ds_read_b64_tr_b16 v[220:221], v9 offset:28672
  v_mfma_f32_16x16x32_bf16 v[120:123], v[188:191], v[56:59], v[120:123]
  ds_read_b64_tr_b16 v[222:223], v9 offset:30720
  s_waitcnt lgkmcnt(8)
  v_mfma_f32_16x16x32_bf16 v[96:99], v[192:195], v[64:67], v[96:99]
  ds_read_b64_tr_b16 v[160:161], v6 offset:32768
  v_readlane_b32 s49, v15, 25
  v_mfma_f32_16x16x32_bf16 v[100:103], v[192:195], v[68:71], v[100:103]
  ds_read_b64_tr_b16 v[162:163], v6 offset:34816
  v_mfma_f32_16x16x32_bf16 v[108:111], v[196:199], v[68:71], v[108:111]
  ds_read_b64_tr_b16 v[164:165], v7 offset:32768
  v_mfma_f32_16x16x32_bf16 v[104:107], v[196:199], v[64:67], v[104:107]
  buffer_load_dwordx4 v[48:51], off, s[36:39], s49 offset:0
  v_mfma_f32_16x16x32_bf16 v[112:115], v[200:203], v[64:67], v[112:115]
  ds_read_b64_tr_b16 v[166:167], v7 offset:34816
  ds_read_b64_tr_b16 v[168:169], v8 offset:32768
  v_mfma_f32_16x16x32_bf16 v[116:119], v[200:203], v[68:71], v[116:119]
  ds_read_b64_tr_b16 v[170:171], v8 offset:34816
  v_mfma_f32_16x16x32_bf16 v[124:127], v[204:207], v[68:71], v[124:127]
  ds_read_b64_tr_b16 v[172:173], v9 offset:32768
  v_mfma_f32_16x16x32_bf16 v[120:123], v[204:207], v[64:67], v[120:123]
  ds_read_b64_tr_b16 v[174:175], v9 offset:34816
  s_waitcnt lgkmcnt(8)
  s_barrier
  v_mfma_f32_16x16x32_bf16 v[96:99], v[208:211], v[72:75], v[96:99]
  buffer_load_dwordx4 v[52:55], off, s[64:67], s49 offset:0
  v_mfma_f32_16x16x32_bf16 v[100:103], v[208:211], v[76:79], v[100:103]
  ds_read_b64_tr_b16 v[176:177], v6 offset:36864
  ds_read_b64_tr_b16 v[178:179], v6 offset:38912
  v_mfma_f32_16x16x32_bf16 v[108:111], v[212:215], v[76:79], v[108:111]
  ds_read_b64_tr_b16 v[180:181], v7 offset:36864
  v_mfma_f32_16x16x32_bf16 v[104:107], v[212:215], v[72:75], v[104:107]
  ds_read_b64_tr_b16 v[182:183], v7 offset:38912
  v_mfma_f32_16x16x32_bf16 v[112:115], v[216:219], v[72:75], v[112:115]
  buffer_load_dwordx4 v[56:59], off, s[36:39], s49 offset:1024
  v_mfma_f32_16x16x32_bf16 v[116:119], v[216:219], v[76:79], v[116:119]
  ds_read_b64_tr_b16 v[184:185], v8 offset:36864
  ds_read_b64_tr_b16 v[186:187], v8 offset:38912
  v_mfma_f32_16x16x32_bf16 v[124:127], v[220:223], v[76:79], v[124:127]
  ds_read_b64_tr_b16 v[188:189], v9 offset:36864
  v_mfma_f32_16x16x32_bf16 v[120:123], v[220:223], v[72:75], v[120:123]
  ds_read_b64_tr_b16 v[190:191], v9 offset:38912
  s_waitcnt lgkmcnt(8)
  v_mfma_f32_16x16x32_bf16 v[96:99], v[160:163], v[80:83], v[96:99]
  ds_read_b64_tr_b16 v[192:193], v6 offset:40960
  buffer_load_dwordx4 v[60:63], off, s[64:67], s49 offset:1024
  v_mfma_f32_16x16x32_bf16 v[100:103], v[160:163], v[84:87], v[100:103]
  ds_read_b64_tr_b16 v[194:195], v6 offset:43008
  s_waitcnt vmcnt(8)
  v_mfma_f32_16x16x32_bf16 v[108:111], v[164:167], v[84:87], v[108:111]
  ds_read_b64_tr_b16 v[196:197], v7 offset:40960
  v_readlane_b32 s50, v15, 26
  v_mfma_f32_16x16x32_bf16 v[104:107], v[164:167], v[80:83], v[104:107]
  buffer_store_dword v19, off, s[52:55], s6 sc1
  v_mfma_f32_16x16x32_bf16 v[112:115], v[168:171], v[80:83], v[112:115]
  ds_read_b64_tr_b16 v[198:199], v7 offset:43008
  ds_read_b64_tr_b16 v[200:201], v8 offset:40960
  v_mfma_f32_16x16x32_bf16 v[116:119], v[168:171], v[84:87], v[116:119]
  buffer_load_dwordx4 v[64:67], off, s[36:39], s50 offset:0
  v_mfma_f32_16x16x32_bf16 v[124:127], v[172:175], v[84:87], v[124:127]
  ds_read_b64_tr_b16 v[202:203], v8 offset:43008
  ds_read_b64_tr_b16 v[204:205], v9 offset:40960
  v_mfma_f32_16x16x32_bf16 v[120:123], v[172:175], v[80:83], v[120:123]
  ds_read_b64_tr_b16 v[206:207], v9 offset:43008
  s_waitcnt lgkmcnt(8)
  v_mfma_f32_16x16x32_bf16 v[96:99], v[176:179], v[88:91], v[96:99]
  ds_read_b64_tr_b16 v[208:209], v6 offset:45056
  v_mfma_f32_16x16x32_bf16 v[100:103], v[176:179], v[92:95], v[100:103]
  buffer_load_dwordx4 v[68:71], off, s[64:67], s50 offset:0
  v_mfma_f32_16x16x32_bf16 v[108:111], v[180:183], v[92:95], v[108:111]
  ds_read_b64_tr_b16 v[210:211], v6 offset:47104
  ds_read_b64_tr_b16 v[212:213], v7 offset:45056
  v_mfma_f32_16x16x32_bf16 v[104:107], v[180:183], v[88:91], v[104:107]
  ds_read_b64_tr_b16 v[214:215], v7 offset:47104
  v_mfma_f32_16x16x32_bf16 v[112:115], v[184:187], v[88:91], v[112:115]
  ds_read_b64_tr_b16 v[216:217], v8 offset:45056
  v_mfma_f32_16x16x32_bf16 v[116:119], v[184:187], v[92:95], v[116:119]
  buffer_load_dwordx4 v[72:75], off, s[36:39], s50 offset:1024
  v_mfma_f32_16x16x32_bf16 v[124:127], v[188:191], v[92:95], v[124:127]
  ds_read_b64_tr_b16 v[218:219], v8 offset:47104
  ds_read_b64_tr_b16 v[220:221], v9 offset:45056
  v_mfma_f32_16x16x32_bf16 v[120:123], v[188:191], v[88:91], v[120:123]
  ds_read_b64_tr_b16 v[222:223], v9 offset:47104
  s_waitcnt lgkmcnt(8)
  v_mfma_f32_16x16x32_bf16 v[96:99], v[192:195], v[224:227], v[96:99]
  ds_read_b64_tr_b16 v[160:161], v6 offset:49152
  v_mfma_f32_16x16x32_bf16 v[100:103], v[192:195], v[228:231], v[100:103]
  buffer_load_dwordx4 v[76:79], off, s[64:67], s50 offset:1024
  v_mfma_f32_16x16x32_bf16 v[108:111], v[196:199], v[228:231], v[108:111]
  ds_read_b64_tr_b16 v[162:163], v6 offset:51200
  ds_read_b64_tr_b16 v[164:165], v7 offset:49152
  v_mfma_f32_16x16x32_bf16 v[104:107], v[196:199], v[224:227], v[104:107]
  ds_read_b64_tr_b16 v[166:167], v7 offset:51200
  v_readlane_b32 s51, v15, 27
  v_mfma_f32_16x16x32_bf16 v[112:115], v[200:203], v[224:227], v[112:115]
  ds_read_b64_tr_b16 v[168:169], v8 offset:49152
  v_mfma_f32_16x16x32_bf16 v[116:119], v[200:203], v[228:231], v[116:119]
  ds_read_b64_tr_b16 v[170:171], v8 offset:51200
  ds_read_b64_tr_b16 v[172:173], v9 offset:49152
  v_mfma_f32_16x16x32_bf16 v[124:127], v[204:207], v[228:231], v[124:127]
  buffer_load_dwordx4 v[80:83], off, s[36:39], s51 offset:0
  v_mfma_f32_16x16x32_bf16 v[120:123], v[204:207], v[224:227], v[120:123]
  ds_read_b64_tr_b16 v[174:175], v9 offset:51200
  s_waitcnt lgkmcnt(8)
  v_mfma_f32_16x16x32_bf16 v[96:99], v[208:211], v[232:235], v[96:99]
  ds_read_b64_tr_b16 v[176:177], v6 offset:53248
  v_mfma_f32_16x16x32_bf16 v[100:103], v[208:211], v[236:239], v[100:103]
  ds_read_b64_tr_b16 v[178:179], v6 offset:55296
  v_mfma_f32_16x16x32_bf16 v[108:111], v[212:215], v[236:239], v[108:111]
  buffer_load_dwordx4 v[84:87], off, s[64:67], s51 offset:0
  v_mfma_f32_16x16x32_bf16 v[104:107], v[212:215], v[232:235], v[104:107]
  ds_read_b64_tr_b16 v[180:181], v7 offset:53248
  ds_read_b64_tr_b16 v[182:183], v7 offset:55296
  v_mfma_f32_16x16x32_bf16 v[112:115], v[216:219], v[232:235], v[112:115]
  ds_read_b64_tr_b16 v[184:185], v8 offset:53248
  v_mfma_f32_16x16x32_bf16 v[116:119], v[216:219], v[236:239], v[116:119]
  ds_read_b64_tr_b16 v[186:187], v8 offset:55296
  ds_read_b64_tr_b16 v[188:189], v9 offset:53248
  v_mfma_f32_16x16x32_bf16 v[124:127], v[220:223], v[236:239], v[124:127]
  buffer_load_dwordx4 v[88:91], off, s[36:39], s51 offset:1024
  v_mfma_f32_16x16x32_bf16 v[120:123], v[220:223], v[232:235], v[120:123]
  ds_read_b64_tr_b16 v[190:191], v9 offset:55296
  s_waitcnt lgkmcnt(8)
  v_mfma_f32_16x16x32_bf16 v[96:99], v[160:163], v[240:243], v[96:99]
  ds_read_b64_tr_b16 v[192:193], v6 offset:57344
  v_mfma_f32_16x16x32_bf16 v[100:103], v[160:163], v[244:247], v[100:103]
  ds_read_b64_tr_b16 v[194:195], v6 offset:59392
  v_mfma_f32_16x16x32_bf16 v[108:111], v[164:167], v[244:247], v[108:111]
  buffer_load_dwordx4 v[92:95], off, s[64:67], s51 offset:1024
  v_mfma_f32_16x16x32_bf16 v[104:107], v[164:167], v[240:243], v[104:107]
  ds_read_b64_tr_b16 v[196:197], v7 offset:57344
  ds_read_b64_tr_b16 v[198:199], v7 offset:59392
  v_mfma_f32_16x16x32_bf16 v[112:115], v[168:171], v[240:243], v[112:115]
  ds_read_b64_tr_b16 v[200:201], v8 offset:57344
  v_readlane_b32 s48, v15, 28
  v_mfma_f32_16x16x32_bf16 v[116:119], v[168:171], v[244:247], v[116:119]
  ds_read_b64_tr_b16 v[202:203], v8 offset:59392
  v_mfma_f32_16x16x32_bf16 v[124:127], v[172:175], v[244:247], v[124:127]
  ds_read_b64_tr_b16 v[204:205], v9 offset:57344
  v_mfma_f32_16x16x32_bf16 v[120:123], v[172:175], v[240:243], v[120:123]
  ds_read_b64_tr_b16 v[206:207], v9 offset:59392
  s_waitcnt lgkmcnt(8)
  v_mfma_f32_16x16x32_bf16 v[96:99], v[176:179], v[248:251], v[96:99]
  buffer_load_dwordx4 v[224:227], off, s[36:39], s48 offset:0
  v_mfma_f32_16x16x32_bf16 v[100:103], v[176:179], v[252:255], v[100:103]
  ds_read_b64_tr_b16 v[208:209], v6 offset:61440
  ds_read_b64_tr_b16 v[210:211], v6 offset:63488
  v_mfma_f32_16x16x32_bf16 v[108:111], v[180:183], v[252:255], v[108:111]
  ds_read_b64_tr_b16 v[212:213], v7 offset:61440
  v_mfma_f32_16x16x32_bf16 v[104:107], v[180:183], v[248:251], v[104:107]
  ds_read_b64_tr_b16 v[214:215], v7 offset:63488
  v_mfma_f32_16x16x32_bf16 v[112:115], v[184:187], v[248:251], v[112:115]
  buffer_load_dwordx4 v[228:231], off, s[64:67], s48 offset:0
  v_mfma_f32_16x16x32_bf16 v[116:119], v[184:187], v[252:255], v[116:119]
  ds_read_b64_tr_b16 v[216:217], v8 offset:61440
  ds_read_b64_tr_b16 v[218:219], v8 offset:63488
  v_mfma_f32_16x16x32_bf16 v[124:127], v[188:191], v[252:255], v[124:127]
  ds_read_b64_tr_b16 v[220:221], v9 offset:61440
  v_mfma_f32_16x16x32_bf16 v[120:123], v[188:191], v[248:251], v[120:123]
  ds_read_b64_tr_b16 v[222:223], v9 offset:63488
  s_waitcnt vmcnt(17) lgkmcnt(8)
  v_mfma_f32_16x16x32_bf16 v[96:99], v[192:195], v[32:35], v[96:99]
  buffer_load_dwordx4 v[232:235], off, s[36:39], s48 offset:1024
  v_mfma_f32_16x16x32_bf16 v[100:103], v[192:195], v[36:39], v[100:103]
  ds_read_b64_tr_b16 v[160:161], v20 offset:0
  ds_read_b64_tr_b16 v[162:163], v20 offset:2048
  v_mfma_f32_16x16x32_bf16 v[108:111], v[196:199], v[36:39], v[108:111]
  ds_read_b64_tr_b16 v[164:165], v21 offset:0
  v_mfma_f32_16x16x32_bf16 v[104:107], v[196:199], v[32:35], v[104:107]
  ds_read_b64_tr_b16 v[166:167], v21 offset:2048
  v_mfma_f32_16x16x32_bf16 v[112:115], v[200:203], v[32:35], v[112:115]
  buffer_load_dwordx4 v[236:239], off, s[64:67], s48 offset:1024
  v_mfma_f32_16x16x32_bf16 v[116:119], v[200:203], v[36:39], v[116:119]
  ds_read_b64_tr_b16 v[168:169], v22 offset:0
  ds_read_b64_tr_b16 v[170:171], v22 offset:2048
  v_mfma_f32_16x16x32_bf16 v[124:127], v[204:207], v[36:39], v[124:127]
  ds_read_b64_tr_b16 v[172:173], v23 offset:0
  v_readlane_b32 s49, v15, 29
  v_mfma_f32_16x16x32_bf16 v[120:123], v[204:207], v[32:35], v[120:123]
  ds_read_b64_tr_b16 v[174:175], v23 offset:2048
  s_waitcnt vmcnt(17) lgkmcnt(8)
  v_mfma_f32_16x16x32_bf16 v[96:99], v[208:211], v[40:43], v[96:99]
  ds_read_b64_tr_b16 v[176:177], v20 offset:4096
  v_mfma_f32_16x16x32_bf16 v[100:103], v[208:211], v[44:47], v[100:103]
  buffer_load_dwordx4 v[240:243], off, s[36:39], s49 offset:0
  v_mfma_f32_16x16x32_bf16 v[108:111], v[212:215], v[44:47], v[108:111]
  ds_read_b64_tr_b16 v[178:179], v20 offset:6144
  ds_read_b64_tr_b16 v[180:181], v21 offset:4096
  v_mfma_f32_16x16x32_bf16 v[104:107], v[212:215], v[40:43], v[104:107]
  ds_read_b64_tr_b16 v[182:183], v21 offset:6144
  v_mfma_f32_16x16x32_bf16 v[112:115], v[216:219], v[40:43], v[112:115]
  ds_read_b64_tr_b16 v[184:185], v22 offset:4096
  v_mfma_f32_16x16x32_bf16 v[116:119], v[216:219], v[44:47], v[116:119]
  buffer_load_dwordx4 v[244:247], off, s[64:67], s49 offset:0
  v_mfma_f32_16x16x32_bf16 v[124:127], v[220:223], v[44:47], v[124:127]
  ds_read_b64_tr_b16 v[186:187], v22 offset:6144
  ds_read_b64_tr_b16 v[188:189], v23 offset:4096
  v_mfma_f32_16x16x32_bf16 v[120:123], v[220:223], v[40:43], v[120:123]
  ds_read_b64_tr_b16 v[190:191], v23 offset:6144
  s_waitcnt vmcnt(17) lgkmcnt(8)
  v_mfma_f32_16x16x32_bf16 v[96:99], v[160:163], v[48:51], v[96:99]
  ds_read_b64_tr_b16 v[192:193], v20 offset:8192
  v_mfma_f32_16x16x32_bf16 v[100:103], v[160:163], v[52:55], v[100:103]
  buffer_load_dwordx4 v[248:251], off, s[36:39], s49 offset:1024
  v_mfma_f32_16x16x32_bf16 v[108:111], v[164:167], v[52:55], v[108:111]
  ds_read_b64_tr_b16 v[194:195], v20 offset:10240
  ds_read_b64_tr_b16 v[196:197], v21 offset:8192
  v_mfma_f32_16x16x32_bf16 v[104:107], v[164:167], v[48:51], v[104:107]
  ds_read_b64_tr_b16 v[198:199], v21 offset:10240
  v_mfma_f32_16x16x32_bf16 v[112:115], v[168:171], v[48:51], v[112:115]
  ds_read_b64_tr_b16 v[200:201], v22 offset:8192
  v_mfma_f32_16x16x32_bf16 v[116:119], v[168:171], v[52:55], v[116:119]
  buffer_load_dwordx4 v[252:255], off, s[64:67], s49 offset:1024
  v_mfma_f32_16x16x32_bf16 v[124:127], v[172:175], v[52:55], v[124:127]
  ds_read_b64_tr_b16 v[202:203], v22 offset:10240
  ds_read_b64_tr_b16 v[204:205], v23 offset:8192
  v_mfma_f32_16x16x32_bf16 v[120:123], v[172:175], v[48:51], v[120:123]
  ds_read_b64_tr_b16 v[206:207], v23 offset:10240
  s_waitcnt vmcnt(17) lgkmcnt(8)
  v_mfma_f32_16x16x32_bf16 v[96:99], v[176:179], v[56:59], v[96:99]
  ds_read_b64_tr_b16 v[208:209], v20 offset:12288
  v_readlane_b32 s50, v15, 30
  v_mfma_f32_16x16x32_bf16 v[100:103], v[176:179], v[60:63], v[100:103]
  ds_read_b64_tr_b16 v[210:211], v20 offset:14336
  v_mfma_f32_16x16x32_bf16 v[108:111], v[180:183], v[60:63], v[108:111]
  ds_read_b64_tr_b16 v[212:213], v21 offset:12288
  v_mfma_f32_16x16x32_bf16 v[104:107], v[180:183], v[56:59], v[104:107]
  buffer_load_dwordx4 v[32:35], off, s[36:39], s50 offset:0
  v_mfma_f32_16x16x32_bf16 v[112:115], v[184:187], v[56:59], v[112:115]
  ds_read_b64_tr_b16 v[214:215], v21 offset:14336
  ds_read_b64_tr_b16 v[216:217], v22 offset:12288
  v_mfma_f32_16x16x32_bf16 v[116:119], v[184:187], v[60:63], v[116:119]
  ds_read_b64_tr_b16 v[218:219], v22 offset:14336
  v_mfma_f32_16x16x32_bf16 v[124:127], v[188:191], v[60:63], v[124:127]
  ds_read_b64_tr_b16 v[220:221], v23 offset:12288
  v_mfma_f32_16x16x32_bf16 v[120:123], v[188:191], v[56:59], v[120:123]
  ds_read_b64_tr_b16 v[222:223], v23 offset:14336
  s_waitcnt vmcnt(15) lgkmcnt(8)
  v_mfma_f32_16x16x32_bf16 v[96:99], v[192:195], v[64:67], v[96:99]
  buffer_load_dwordx4 v[36:39], off, s[64:67], s50 offset:0
  v_mfma_f32_16x16x32_bf16 v[100:103], v[192:195], v[68:71], v[100:103]
  ds_read_b64_tr_b16 v[160:161], v20 offset:16384
  ds_read_b64_tr_b16 v[162:163], v20 offset:18432
  v_mfma_f32_16x16x32_bf16 v[108:111], v[196:199], v[68:71], v[108:111]
  ds_read_b64_tr_b16 v[164:165], v21 offset:16384
  v_mfma_f32_16x16x32_bf16 v[104:107], v[196:199], v[64:67], v[104:107]
  ds_read_b64_tr_b16 v[166:167], v21 offset:18432
  v_mfma_f32_16x16x32_bf16 v[112:115], v[200:203], v[64:67], v[112:115]
  buffer_load_dwordx4 v[40:43], off, s[36:39], s50 offset:1024
  v_mfma_f32_16x16x32_bf16 v[116:119], v[200:203], v[68:71], v[116:119]
  ds_read_b64_tr_b16 v[168:169], v22 offset:16384
  ds_read_b64_tr_b16 v[170:171], v22 offset:18432
  v_mfma_f32_16x16x32_bf16 v[124:127], v[204:207], v[68:71], v[124:127]
  ds_read_b64_tr_b16 v[172:173], v23 offset:16384
  v_mfma_f32_16x16x32_bf16 v[120:123], v[204:207], v[64:67], v[120:123]
  ds_read_b64_tr_b16 v[174:175], v23 offset:18432
  s_waitcnt vmcnt(15) lgkmcnt(8)
  v_mfma_f32_16x16x32_bf16 v[96:99], v[208:211], v[72:75], v[96:99]
  buffer_load_dwordx4 v[44:47], off, s[64:67], s50 offset:1024
  v_mfma_f32_16x16x32_bf16 v[100:103], v[208:211], v[76:79], v[100:103]
  ds_read_b64_tr_b16 v[176:177], v20 offset:20480
  ds_read_b64_tr_b16 v[178:179], v20 offset:22528
  v_mfma_f32_16x16x32_bf16 v[108:111], v[212:215], v[76:79], v[108:111]
  ds_read_b64_tr_b16 v[180:181], v21 offset:20480
  v_readlane_b32 s51, v15, 31
  v_mfma_f32_16x16x32_bf16 v[104:107], v[212:215], v[72:75], v[104:107]
  ds_read_b64_tr_b16 v[182:183], v21 offset:22528
  v_mfma_f32_16x16x32_bf16 v[112:115], v[216:219], v[72:75], v[112:115]
  ds_read_b64_tr_b16 v[184:185], v22 offset:20480
  v_mfma_f32_16x16x32_bf16 v[116:119], v[216:219], v[76:79], v[116:119]
  buffer_load_dwordx4 v[48:51], off, s[36:39], s51 offset:0
  v_mfma_f32_16x16x32_bf16 v[124:127], v[220:223], v[76:79], v[124:127]
  ds_read_b64_tr_b16 v[186:187], v22 offset:22528
  ds_read_b64_tr_b16 v[188:189], v23 offset:20480
  v_mfma_f32_16x16x32_bf16 v[120:123], v[220:223], v[72:75], v[120:123]
  ds_read_b64_tr_b16 v[190:191], v23 offset:22528
  s_waitcnt vmcnt(15) lgkmcnt(8)
  v_mfma_f32_16x16x32_bf16 v[96:99], v[160:163], v[80:83], v[96:99]
  ds_read_b64_tr_b16 v[192:193], v20 offset:24576
  v_mfma_f32_16x16x32_bf16 v[100:103], v[160:163], v[84:87], v[100:103]
  buffer_load_dwordx4 v[52:55], off, s[64:67], s51 offset:0
  v_mfma_f32_16x16x32_bf16 v[108:111], v[164:167], v[84:87], v[108:111]
  ds_read_b64_tr_b16 v[194:195], v20 offset:26624
  ds_read_b64_tr_b16 v[196:197], v21 offset:24576
  v_mfma_f32_16x16x32_bf16 v[104:107], v[164:167], v[80:83], v[104:107]
  ds_read_b64_tr_b16 v[198:199], v21 offset:26624
  v_mfma_f32_16x16x32_bf16 v[112:115], v[168:171], v[80:83], v[112:115]
  ds_read_b64_tr_b16 v[200:201], v22 offset:24576
  v_mfma_f32_16x16x32_bf16 v[116:119], v[168:171], v[84:87], v[116:119]
  buffer_load_dwordx4 v[56:59], off, s[36:39], s51 offset:1024
  v_mfma_f32_16x16x32_bf16 v[124:127], v[172:175], v[84:87], v[124:127]
  ds_read_b64_tr_b16 v[202:203], v22 offset:26624
  ds_read_b64_tr_b16 v[204:205], v23 offset:24576
  v_mfma_f32_16x16x32_bf16 v[120:123], v[172:175], v[80:83], v[120:123]
  ds_read_b64_tr_b16 v[206:207], v23 offset:26624
  s_waitcnt vmcnt(15) lgkmcnt(8)
  s_barrier
  v_mfma_f32_16x16x32_bf16 v[96:99], v[176:179], v[88:91], v[96:99]
  ds_read_b64_tr_b16 v[208:209], v20 offset:28672
  buffer_load_dwordx4 v[144:147], off, s[60:63], s5 offset:0 sc1
  v_mfma_f32_16x16x32_bf16 v[100:103], v[176:179], v[92:95], v[100:103]
  ds_read_b64_tr_b16 v[210:211], v20 offset:30720
  buffer_load_dwordx4 v[60:63], off, s[64:67], s51 offset:1024
  v_mfma_f32_16x16x32_bf16 v[108:111], v[180:183], v[92:95], v[108:111]
  ds_read_b64_tr_b16 v[212:213], v21 offset:28672
  buffer_load_dwordx4 v[148:151], off, s[60:63], s5 offset:1024 sc1
  v_mfma_f32_16x16x32_bf16 v[104:107], v[180:183], v[88:91], v[104:107]
  ds_read_b64_tr_b16 v[214:215], v21 offset:30720
  v_readlane_b32 s48, v15, 32
  v_mfma_f32_16x16x32_bf16 v[112:115], v[184:187], v[88:91], v[112:115]
  buffer_load_dwordx4 v[152:155], off, s[60:63], s5 offset:2048 sc1
  v_mfma_f32_16x16x32_bf16 v[116:119], v[184:187], v[92:95], v[116:119]
  ds_read_b64_tr_b16 v[216:217], v22 offset:28672
  ds_read_b64_tr_b16 v[218:219], v22 offset:30720
  v_mfma_f32_16x16x32_bf16 v[124:127], v[188:191], v[92:95], v[124:127]
  ds_read_b64_tr_b16 v[220:221], v23 offset:28672
  buffer_load_dwordx4 v[64:67], off, s[36:39], s48 offset:0
  v_mfma_f32_16x16x32_bf16 v[120:123], v[188:191], v[88:91], v[120:123]
  ds_read_b64_tr_b16 v[222:223], v23 offset:30720
  s_waitcnt vmcnt(18) lgkmcnt(8)
  v_mfma_f32_16x16x32_bf16 v[96:99], v[192:195], v[224:227], v[96:99]
  buffer_load_dwordx4 v[156:159], off, s[60:63], s5 offset:3072 sc1
  v_mfma_f32_16x16x32_bf16 v[100:103], v[192:195], v[228:231], v[100:103]
  ds_read_b64_tr_b16 v[160:161], v20 offset:32768
  ds_read_b64_tr_b16 v[162:163], v20 offset:34816
  v_mfma_f32_16x16x32_bf16 v[108:111], v[196:199], v[228:231], v[108:111]
  buffer_load_dwordx4 v[68:71], off, s[64:67], s48 offset:0
  v_mfma_f32_16x16x32_bf16 v[104:107], v[196:199], v[224:227], v[104:107]
  ds_read_b64_tr_b16 v[164:165], v21 offset:32768
  ds_read_b64_tr_b16 v[166:167], v21 offset:34816
  v_mfma_f32_16x16x32_bf16 v[112:115], v[200:203], v[224:227], v[112:115]
  ds_read_b64_tr_b16 v[168:169], v22 offset:32768
  v_mfma_f32_16x16x32_bf16 v[116:119], v[200:203], v[228:231], v[116:119]
  ds_read_b64_tr_b16 v[170:171], v22 offset:34816
  ds_read_b64_tr_b16 v[172:173], v23 offset:32768
  v_mfma_f32_16x16x32_bf16 v[124:127], v[204:207], v[228:231], v[124:127]
  buffer_load_dwordx4 v[72:75], off, s[36:39], s48 offset:1024
  v_mfma_f32_16x16x32_bf16 v[120:123], v[204:207], v[224:227], v[120:123]
  ds_read_b64_tr_b16 v[174:175], v23 offset:34816
  s_waitcnt vmcnt(19) lgkmcnt(8)
  v_mfma_f32_16x16x32_bf16 v[96:99], v[208:211], v[232:235], v[96:99]
  ds_read_b64_tr_b16 v[176:177], v20 offset:36864
  v_mfma_f32_16x16x32_bf16 v[100:103], v[208:211], v[236:239], v[100:103]
  ds_read_b64_tr_b16 v[178:179], v20 offset:38912
  v_mfma_f32_16x16x32_bf16 v[108:111], v[212:215], v[236:239], v[108:111]
  buffer_load_dwordx4 v[76:79], off, s[64:67], s48 offset:1024
  v_mfma_f32_16x16x32_bf16 v[104:107], v[212:215], v[232:235], v[104:107]
  ds_read_b64_tr_b16 v[180:181], v21 offset:36864
  ds_read_b64_tr_b16 v[182:183], v21 offset:38912
  v_mfma_f32_16x16x32_bf16 v[112:115], v[216:219], v[232:235], v[112:115]
  ds_read_b64_tr_b16 v[184:185], v22 offset:36864
  v_mfma_f32_16x16x32_bf16 v[116:119], v[216:219], v[236:239], v[116:119]
  ds_read_b64_tr_b16 v[186:187], v22 offset:38912
  v_mfma_f32_16x16x32_bf16 v[124:127], v[220:223], v[236:239], v[124:127]
  ds_read_b64_tr_b16 v[188:189], v23 offset:36864
  v_mfma_f32_16x16x32_bf16 v[120:123], v[220:223], v[232:235], v[120:123]
  ds_read_b64_tr_b16 v[190:191], v23 offset:38912
  s_waitcnt vmcnt(18) lgkmcnt(8)
  v_mfma_f32_16x16x32_bf16 v[96:99], v[160:163], v[240:243], v[96:99]
  ds_read_b64_tr_b16 v[192:193], v20 offset:40960
  v_mfma_f32_16x16x32_bf16 v[100:103], v[160:163], v[244:247], v[100:103]
  ds_read_b64_tr_b16 v[194:195], v20 offset:43008
  v_mfma_f32_16x16x32_bf16 v[108:111], v[164:167], v[244:247], v[108:111]
  ds_read_b64_tr_b16 v[196:197], v21 offset:40960
  v_mfma_f32_16x16x32_bf16 v[104:107], v[164:167], v[240:243], v[104:107]
  ds_read_b64_tr_b16 v[198:199], v21 offset:43008
  v_mfma_f32_16x16x32_bf16 v[112:115], v[168:171], v[240:243], v[112:115]
  ds_read_b64_tr_b16 v[200:201], v22 offset:40960
  v_mfma_f32_16x16x32_bf16 v[116:119], v[168:171], v[244:247], v[116:119]
  ds_read_b64_tr_b16 v[202:203], v22 offset:43008
  v_mfma_f32_16x16x32_bf16 v[124:127], v[172:175], v[244:247], v[124:127]
  ds_read_b64_tr_b16 v[204:205], v23 offset:40960
  v_mfma_f32_16x16x32_bf16 v[120:123], v[172:175], v[240:243], v[120:123]
  ds_read_b64_tr_b16 v[206:207], v23 offset:43008
  s_waitcnt vmcnt(16) lgkmcnt(8)
  v_mfma_f32_16x16x32_bf16 v[96:99], v[176:179], v[248:251], v[96:99]
  ds_read_b64_tr_b16 v[208:209], v20 offset:45056
  v_mfma_f32_16x16x32_bf16 v[100:103], v[176:179], v[252:255], v[100:103]
  ds_read_b64_tr_b16 v[210:211], v20 offset:47104
  v_mfma_f32_16x16x32_bf16 v[108:111], v[180:183], v[252:255], v[108:111]
  ds_read_b64_tr_b16 v[212:213], v21 offset:45056
  v_mfma_f32_16x16x32_bf16 v[104:107], v[180:183], v[248:251], v[104:107]
  ds_read_b64_tr_b16 v[214:215], v21 offset:47104
  v_mfma_f32_16x16x32_bf16 v[112:115], v[184:187], v[248:251], v[112:115]
  ds_read_b64_tr_b16 v[216:217], v22 offset:45056
  v_mfma_f32_16x16x32_bf16 v[116:119], v[184:187], v[252:255], v[116:119]
  ds_read_b64_tr_b16 v[218:219], v22 offset:47104
  v_mfma_f32_16x16x32_bf16 v[124:127], v[188:191], v[252:255], v[124:127]
  ds_read_b64_tr_b16 v[220:221], v23 offset:45056
  v_mfma_f32_16x16x32_bf16 v[120:123], v[188:191], v[248:251], v[120:123]
  ds_read_b64_tr_b16 v[222:223], v23 offset:47104
  s_waitcnt vmcnt(14) lgkmcnt(8)
  v_mfma_f32_16x16x32_bf16 v[96:99], v[192:195], v[32:35], v[96:99]
  ds_read_b64_tr_b16 v[160:161], v20 offset:49152
  v_mfma_f32_16x16x32_bf16 v[100:103], v[192:195], v[36:39], v[100:103]
  ds_read_b64_tr_b16 v[162:163], v20 offset:51200
  v_mfma_f32_16x16x32_bf16 v[108:111], v[196:199], v[36:39], v[108:111]
  ds_read_b64_tr_b16 v[164:165], v21 offset:49152
  v_mfma_f32_16x16x32_bf16 v[104:107], v[196:199], v[32:35], v[104:107]
  ds_read_b64_tr_b16 v[166:167], v21 offset:51200
  v_mfma_f32_16x16x32_bf16 v[112:115], v[200:203], v[32:35], v[112:115]
  ds_read_b64_tr_b16 v[168:169], v22 offset:49152
  v_mfma_f32_16x16x32_bf16 v[116:119], v[200:203], v[36:39], v[116:119]
  ds_read_b64_tr_b16 v[170:171], v22 offset:51200
  v_mfma_f32_16x16x32_bf16 v[124:127], v[204:207], v[36:39], v[124:127]
  ds_read_b64_tr_b16 v[172:173], v23 offset:49152
  v_mfma_f32_16x16x32_bf16 v[120:123], v[204:207], v[32:35], v[120:123]
  ds_read_b64_tr_b16 v[174:175], v23 offset:51200
  s_waitcnt vmcnt(12) lgkmcnt(8)
  v_mfma_f32_16x16x32_bf16 v[96:99], v[208:211], v[40:43], v[96:99]
  ds_read_b64_tr_b16 v[176:177], v20 offset:53248
  v_mfma_f32_16x16x32_bf16 v[100:103], v[208:211], v[44:47], v[100:103]
  ds_read_b64_tr_b16 v[178:179], v20 offset:55296
  v_mfma_f32_16x16x32_bf16 v[108:111], v[212:215], v[44:47], v[108:111]
  ds_read_b64_tr_b16 v[180:181], v21 offset:53248
  v_mfma_f32_16x16x32_bf16 v[104:107], v[212:215], v[40:43], v[104:107]
  ds_read_b64_tr_b16 v[182:183], v21 offset:55296
  v_mfma_f32_16x16x32_bf16 v[112:115], v[216:219], v[40:43], v[112:115]
  ds_read_b64_tr_b16 v[184:185], v22 offset:53248
  v_mfma_f32_16x16x32_bf16 v[116:119], v[216:219], v[44:47], v[116:119]
  ds_read_b64_tr_b16 v[186:187], v22 offset:55296
  v_mfma_f32_16x16x32_bf16 v[124:127], v[220:223], v[44:47], v[124:127]
  ds_read_b64_tr_b16 v[188:189], v23 offset:53248
  v_mfma_f32_16x16x32_bf16 v[120:123], v[220:223], v[40:43], v[120:123]
  ds_read_b64_tr_b16 v[190:191], v23 offset:55296
  s_waitcnt vmcnt(10) lgkmcnt(8)
  v_mfma_f32_16x16x32_bf16 v[96:99], v[160:163], v[48:51], v[96:99]
  ds_read_b64_tr_b16 v[192:193], v20 offset:57344
  s_waitcnt vmcnt(3)
  v_mfma_f32_16x16x32_bf16 v[100:103], v[160:163], v[52:55], v[100:103]
  ds_read_b64_tr_b16 v[194:195], v20 offset:59392
  v_lshlrev_b32 v128, 16, v144
  v_mfma_f32_16x16x32_bf16 v[108:111], v[164:167], v[52:55], v[108:111]
  ds_read_b64_tr_b16 v[196:197], v21 offset:57344
  v_and_b32 v129, s11, v144
  v_mfma_f32_16x16x32_bf16 v[104:107], v[164:167], v[48:51], v[104:107]
  ds_read_b64_tr_b16 v[198:199], v21 offset:59392
  v_lshlrev_b32 v130, 16, v145
  v_mfma_f32_16x16x32_bf16 v[112:115], v[168:171], v[48:51], v[112:115]
  ds_read_b64_tr_b16 v[200:201], v22 offset:57344
  v_and_b32 v131, s11, v145
  v_mfma_f32_16x16x32_bf16 v[116:119], v[168:171], v[52:55], v[116:119]
  ds_read_b64_tr_b16 v[202:203], v22 offset:59392
  v_lshlrev_b32 v132, 16, v146
  v_mfma_f32_16x16x32_bf16 v[124:127], v[172:175], v[52:55], v[124:127]
  ds_read_b64_tr_b16 v[204:205], v23 offset:57344
  v_and_b32 v133, s11, v146
  v_mfma_f32_16x16x32_bf16 v[120:123], v[172:175], v[48:51], v[120:123]
  ds_read_b64_tr_b16 v[206:207], v23 offset:59392
  s_waitcnt lgkmcnt(8)
  v_mfma_f32_16x16x32_bf16 v[96:99], v[176:179], v[56:59], v[96:99]
  ds_read_b64_tr_b16 v[208:209], v20 offset:61440
  v_lshlrev_b32 v134, 16, v147
  v_mfma_f32_16x16x32_bf16 v[100:103], v[176:179], v[60:63], v[100:103]
  ds_read_b64_tr_b16 v[210:211], v20 offset:63488
  v_and_b32 v135, s11, v147
  v_mfma_f32_16x16x32_bf16 v[108:111], v[180:183], v[60:63], v[108:111]
  ds_read_b64_tr_b16 v[212:213], v21 offset:61440
  v_lshlrev_b32 v136, 16, v148
  v_mfma_f32_16x16x32_bf16 v[104:107], v[180:183], v[56:59], v[104:107]
  ds_read_b64_tr_b16 v[214:215], v21 offset:63488
  v_and_b32 v137, s11, v148
  v_mfma_f32_16x16x32_bf16 v[112:115], v[184:187], v[56:59], v[112:115]
  ds_read_b64_tr_b16 v[216:217], v22 offset:61440
  v_lshlrev_b32 v138, 16, v149
  v_mfma_f32_16x16x32_bf16 v[116:119], v[184:187], v[60:63], v[116:119]
  ds_read_b64_tr_b16 v[218:219], v22 offset:63488
  v_and_b32 v139, s11, v149
  v_mfma_f32_16x16x32_bf16 v[124:127], v[188:191], v[60:63], v[124:127]
  ds_read_b64_tr_b16 v[220:221], v23 offset:61440
  v_lshlrev_b32 v140, 16, v150
  v_mfma_f32_16x16x32_bf16 v[120:123], v[188:191], v[56:59], v[120:123]
  ds_read_b64_tr_b16 v[222:223], v23 offset:63488
  s_waitcnt vmcnt(2) lgkmcnt(8)
  v_mfma_f32_16x16x32_bf16 v[96:99], v[192:195], v[64:67], v[96:99]
  v_mov_b32 v20, 0
  v_mov_b32 v21, 0
  v_mfma_f32_16x16x32_bf16 v[100:103], v[192:195], v[68:71], v[100:103]
  v_mov_b32 v22, 0
  v_mov_b32 v23, 0
  v_mfma_f32_16x16x32_bf16 v[108:111], v[196:199], v[68:71], v[108:111]
  v_and_b32 v141, s11, v150
  v_lshlrev_b32 v142, 16, v151
  v_and_b32 v143, s11, v151
  v_mfma_f32_16x16x32_bf16 v[104:107], v[196:199], v[64:67], v[104:107]
  v_lshlrev_b32 v144, 16, v152
  v_and_b32 v145, s11, v152
  v_lshlrev_b32 v146, 16, v153
  v_mfma_f32_16x16x32_bf16 v[112:115], v[200:203], v[64:67], v[112:115]
  v_and_b32 v147, s11, v153
  v_lshlrev_b32 v148, 16, v154
  v_and_b32 v149, s11, v154
  v_mfma_f32_16x16x32_bf16 v[116:119], v[200:203], v[68:71], v[116:119]
  v_lshlrev_b32 v150, 16, v155
  v_and_b32 v151, s11, v155
  v_lshlrev_b32 v152, 16, v156
  v_mfma_f32_16x16x32_bf16 v[124:127], v[204:207], v[68:71], v[124:127]
  v_and_b32 v153, s11, v156
  v_lshlrev_b32 v154, 16, v157
  v_and_b32 v155, s11, v157
  v_mfma_f32_16x16x32_bf16 v[120:123], v[204:207], v[64:67], v[120:123]
  s_waitcnt vmcnt(0) lgkmcnt(0)
  v_lshlrev_b32 v156, 16, v158
  v_and_b32 v157, s11, v158
  v_mfma_f32_16x16x32_bf16 v[96:99], v[208:211], v[72:75], v[96:99]
  v_lshlrev_b32 v158, 16, v159
  v_and_b32 v159, s11, v159
  v_mfma_f32_16x16x32_bf16 v[100:103], v[208:211], v[76:79], v[100:103]
  v_mfma_f32_16x16x32_bf16 v[108:111], v[212:215], v[76:79], v[108:111]
  v_mfma_f32_16x16x32_bf16 v[104:107], v[212:215], v[72:75], v[104:107]
  v_mfma_f32_16x16x32_bf16 v[112:115], v[216:219], v[72:75], v[112:115]
  v_mfma_f32_16x16x32_bf16 v[116:119], v[216:219], v[76:79], v[116:119]
  v_mfma_f32_16x16x32_bf16 v[124:127], v[220:223], v[76:79], v[124:127]
  v_mfma_f32_16x16x32_bf16 v[120:123], v[220:223], v[72:75], v[120:123]
  s_lshl_b32 s3, s7, 4
  s_mov_b32 s10, 0x3f803f80
  s_nop 4
  v_pk_add_f32 v[96:97], v[96:97], v[128:129]
  v_pk_add_f32 v[98:99], v[98:99], v[130:131]
  v_cvt_pk_bf16_f32 v240, v96, v97
  v_cvt_pk_bf16_f32 v241, v98, v99
  v_pk_add_f32 v[104:105], v[104:105], v[136:137]
  v_pk_add_f32 v[106:107], v[106:107], v[138:139]
  v_cvt_pk_bf16_f32 v242, v104, v105
  v_cvt_pk_bf16_f32 v243, v106, v107
  s_nop 1
  v_permlane16_swap_b32 v240, v242
  v_permlane16_swap_b32 v241, v243
  buffer_store_dwordx4 v[240:243], v12, s[44:47], 0 offen offset:0 sc1
  ds_write_b128 v4, v[240:243] offset:0
  v_pk_add_f32 v[112:113], v[112:113], v[144:145]
  v_pk_add_f32 v[114:115], v[114:115], v[146:147]
  v_cvt_pk_bf16_f32 v244, v112, v113
  v_cvt_pk_bf16_f32 v245, v114, v115
  v_pk_add_f32 v[120:121], v[120:121], v[152:153]
  v_pk_add_f32 v[122:123], v[122:123], v[154:155]
  v_cvt_pk_bf16_f32 v246, v120, v121
  v_cvt_pk_bf16_f32 v247, v122, v123
  s_nop 1
  v_permlane16_swap_b32 v244, v246
  v_permlane16_swap_b32 v245, v247
  buffer_store_dwordx4 v[244:247], v12, s[44:47], 0 offen offset:64 sc1
  ds_write_b128 v5, v[244:247] offset:0
  v_pk_add_f32 v[100:101], v[100:101], v[132:133]
  v_pk_add_f32 v[102:103], v[102:103], v[134:135]
  v_cvt_pk_bf16_f32 v248, v100, v101
  v_cvt_pk_bf16_f32 v249, v102, v103
  v_pk_add_f32 v[108:109], v[108:109], v[140:141]
  v_pk_add_f32 v[110:111], v[110:111], v[142:143]
  v_cvt_pk_bf16_f32 v250, v108, v109
  v_cvt_pk_bf16_f32 v251, v110, v111
  s_nop 1
  v_permlane16_swap_b32 v248, v250
  v_permlane16_swap_b32 v249, v251
  buffer_store_dwordx4 v[248:251], v12, s[44:47], s3 offen offset:0 sc1
  ds_write_b128 v4, v[248:251] offset:2048
  v_pk_add_f32 v[116:117], v[116:117], v[148:149]
  v_pk_add_f32 v[118:119], v[118:119], v[150:151]
  v_cvt_pk_bf16_f32 v252, v116, v117
  v_cvt_pk_bf16_f32 v253, v118, v119
  v_pk_add_f32 v[124:125], v[124:125], v[156:157]
  v_pk_add_f32 v[126:127], v[126:127], v[158:159]
  v_cvt_pk_bf16_f32 v254, v124, v125
  v_cvt_pk_bf16_f32 v255, v126, v127
  s_nop 1
  v_permlane16_swap_b32 v252, v254
  v_permlane16_swap_b32 v253, v255
  buffer_store_dwordx4 v[252:255], v12, s[44:47], s3 offen offset:64 sc1
  ds_write_b128 v5, v[252:255] offset:2048
  v_dot2_f32_bf16 v20, v240, s10, v20
  v_dot2_f32_bf16 v22, v240, v240, v22
  v_dot2_f32_bf16 v20, v241, s10, v20
  v_dot2_f32_bf16 v22, v241, v241, v22
  v_dot2_f32_bf16 v20, v242, s10, v20
  v_dot2_f32_bf16 v22, v242, v242, v22
  v_dot2_f32_bf16 v20, v243, s10, v20
  v_dot2_f32_bf16 v22, v243, v243, v22
  v_dot2_f32_bf16 v20, v244, s10, v20
  v_dot2_f32_bf16 v22, v244, v244, v22
  v_dot2_f32_bf16 v20, v245, s10, v20
  v_dot2_f32_bf16 v22, v245, v245, v22
  v_dot2_f32_bf16 v20, v246, s10, v20
  v_dot2_f32_bf16 v22, v246, v246, v22
  v_dot2_f32_bf16 v20, v247, s10, v20
  v_dot2_f32_bf16 v22, v247, v247, v22
  v_dot2_f32_bf16 v21, v248, s10, v21
  v_dot2_f32_bf16 v23, v248, v248, v23
  v_dot2_f32_bf16 v21, v249, s10, v21
  v_dot2_f32_bf16 v23, v249, v249, v23
  v_dot2_f32_bf16 v21, v250, s10, v21
  v_dot2_f32_bf16 v23, v250, v250, v23
  v_dot2_f32_bf16 v21, v251, s10, v21
  v_dot2_f32_bf16 v23, v251, v251, v23
  v_dot2_f32_bf16 v21, v252, s10, v21
  v_dot2_f32_bf16 v23, v252, v252, v23
  v_dot2_f32_bf16 v21, v253, s10, v21
  v_dot2_f32_bf16 v23, v253, v253, v23
  v_dot2_f32_bf16 v21, v254, s10, v21
  v_dot2_f32_bf16 v23, v254, v254, v23
  v_dot2_f32_bf16 v21, v255, s10, v21
  v_dot2_f32_bf16 v23, v255, v255, v23
  s_nop 2
  v_permlane32_swap_b32 v20, v21
  v_permlane32_swap_b32 v22, v23
  v_add_f32 v20, v20, v21
  v_add_f32 v22, v22, v23
  s_nop 1
  v_permlane16_swap_b32 v20, v22
  v_add_f32 v20, v20, v22
  buffer_store_dword v20, v18, s[56:59], 0 offen sc1
  s_cmp_eq_u32 s96, 1
  s_cbranch_scc1 L_w2_end
  s_waitcnt vmcnt(0) lgkmcnt(0)
  s_barrier
  s_mov_b32 s96, 1
  s_add_u32 s12, s22, 33554432
  s_addc_u32 s13, s23, 0
  s_add_u32 s34, s22, 67108864
  s_addc_u32 s35, s23, 0
  s_add_u32 s97, s97, 1
  s_branch L_attn_body
L_w2_c1:
```

```asm
; @launch grid=(256,1,1) block=(512,1,1) lds=163840
.amdgcn_target "amdgcn-amd-amdhsa--gfx950"
.text
.globl interleave_layers__sliding_local_dilated__dense_activation_gelu__prompt_kernel
.p2align 12
.fill 832, 4, 0xbf800000
.type interleave_layers__sliding_local_dilated__dense_activation_gelu__prompt_kernel,@function
interleave_layers__sliding_local_dilated__dense_activation_gelu__prompt_kernel:
L_attn_c0:
  s_load_dwordx4 s[16:19], s[0:1], 0
  s_load_dwordx2 s[20:21], s[0:1], 16
  s_load_dwordx2 s[22:23], s[0:1], 80
  s_load_dwordx8 s[24:31], s[0:1], 32
  s_load_dwordx2 s[32:33], s[0:1], 64
  s_load_dwordx2 s[34:35], s[0:1], 80
  s_load_dwordx2 s[12:13], s[0:1], 0
  s_load_dwordx2 s[64:65], s[0:1], 72
  s_mov_b32 s96, 0
  s_mov_b32 s97, 0
L_attn_body:
  s_cmp_ge_u32 s2, 256
  s_cbranch_scc1 L_attn_end
  v_lshrrev_b32 v2, 6, v0
  v_and_b32 v1, 63, v0
  v_readfirstlane_b32 s70, v2
  s_and_b32 s3, s2, 7
  s_lshr_b32 s99, s2, 3
  s_and_b32 s5, s3, 1
  s_lshl_b32 s5, s5, 3
  s_and_b32 s6, s99, 7
  s_add_u32 s68, s5, s6
  s_lshr_b32 s5, s3, 1
  s_lshl_b32 s5, s5, 2
  s_lshr_b32 s6, s99, 3
  s_add_u32 s69, s5, s6
  s_cmp_eq_u32 s96, 0
  s_cbranch_scc1 L_attn_map
  s_and_b32 s3, s2, 7
  s_and_b32 s5, s3, 3
  s_lshl_b32 s5, s5, 2
  s_and_b32 s6, s99, 3
  s_add_u32 s68, s5, s6
  s_lshr_b32 s5, s3, 2
  s_lshl_b32 s5, s5, 3
  s_lshr_b32 s6, s99, 2
  s_add_u32 s69, s5, s6
L_attn_map:
  s_cmp_lt_u32 s70, 4
  s_cbranch_scc1 L_attn_compute
L_attn_loader:
  s_add_u32 s8, s70, s69
  s_and_b32 s8, s8, 3
  s_add_u32 s9, s70, s68
  s_and_b32 s9, s9, 3
  s_lshl_b32 s76, s8, 12
  s_lshl_b32 s77, s9, 11
  s_add_u32 s77, s77, 16384
  s_lshl_b32 s11, s68, 7
  v_and_b32 v10, 7, v1
  v_lshrrev_b32 v3, 3, v1
  s_lshr_b32 s10, s76, 7
  s_lshl_b32 s3, s68, 7
  s_add_u32 s10, s10, s3
  v_add_u32 v3, s10, v3
  s_cmp_eq_u32 s96, 1
  s_cselect_b32 s5, 128, 0
  s_add_u32 s5, s5, 2048
  s_lshl_b32 s6, s5, 3
  v_mul_u32_u24 v3, s5, v3
  v_lshrrev_b32 v2, 4, v1
  v_xor_b32 v4, v2, v10
  v_lshl_add_u32 v4, v4, 4, v3
  v_add_u32 v3, s6, v3
  v_add_u32 v5, 4, v2
  v_xor_b32 v5, v5, v10
  v_lshl_add_u32 v5, v5, 4, v3
  v_add_u32 v3, s6, v3
  v_xor_b32 v6, v2, v10
  v_lshl_add_u32 v6, v6, 4, v3
  v_add_u32 v3, s6, v3
  v_add_u32 v7, 4, v2
  v_xor_b32 v7, v7, v10
  v_lshl_add_u32 v7, v7, 4, v3
  v_lshrrev_b32 v3, 3, v1
  s_lshl_b32 s10, s9, 4
  v_add_u32 v3, s10, v3
  v_mul_u32_u24 v3, 6144, v3
  v_lshrrev_b32 v2, 3, v1
  v_and_b32 v2, 2, v2
  v_xor_b32 v2, v2, v10
  s_mul_i32 s10, s69, 128
  v_add_u32 v3, s10, v3
  v_lshl_add_u32 v8, v2, 4, v3
  v_xor_b32 v2, 4, v2
  v_add_u32 v3, 49152, v3
  v_lshl_add_u32 v9, v2, 4, v3
  s_and_b32 s10, s70, 3
  s_lshl_b32 s78, s10, 9
  s_add_u32 s78, s78, 40960
  s_lshl_b32 s14, s10, 2
  s_add_u32 s14, s14, s11
  s_sub_u32 s14, s14, 16
  v_lshrrev_b32 v3, 3, v1
  v_add_u32 v3, s14, v3
  v_max_i32 v3, 0, v3
  v_mul_u32_u24 v3, s5, v3
  s_lshl_b32 s14, s10, 1
  v_lshrrev_b32 v2, 4, v1
  v_add_u32 v2, s14, v2
  v_and_b32 v2, 7, v2
  v_xor_b32 v2, v2, v10
  v_lshl_add_u32 v28, v2, 4, v3
  s_cmp_eq_u32 s10, 0
  s_cselect_b32 s14, 0xffffff00, -1
  s_mov_b32 s15, 0
  s_mov_b32 s75, 0
  s_add_u32 s100, s68, s69
  s_mov_b32 s101, -1
  s_add_u32 s3, s68, s69
  s_and_b32 s3, s3, 3
  s_mov_b32 s100, 0x75463102
  s_mov_b32 s101, 0xfdceb98a
  s_cmp_eq_u32 s3, 1
  s_cselect_b32 s100, 0x65742130, s100
  s_cselect_b32 s101, 0xedfca9b8, s101
  s_cmp_eq_u32 s3, 2
  s_cselect_b32 s100, 0x68532410, s100
  s_cselect_b32 s101, 0xfedbac97, s101
  s_cmp_eq_u32 s3, 3
  s_cselect_b32 s100, 0x96435210, s100
  s_cselect_b32 s101, 0xfecbda87, s101
  s_mov_b32 s91, s69
  s_and_b32 s92, s69, 3
  s_add_u32 s92, s92, 1
  s_and_b32 s73, s100, 15
  s_cmp_eq_u32 s73, s91
  s_cselect_b32 s74, 4, 0
  s_lshr_b64 s[100:101], s[100:101], s74
  s_and_b32 s73, s100, 15
  s_sub_u32 s92, s92, 1
  s_cselect_b32 s73, s91, s73
  s_cselect_b32 s74, 0, 4
  s_lshr_b64 s[100:101], s[100:101], s74
  s_mul_i32 s74, s73, 393216
  s_lshl_b32 s73, s73, 7
  s_waitcnt lgkmcnt(0)
  s_mov_b32 s36, s12
  s_and_b32 s37, s13, 0xffff
  s_mov_b32 s38, 4194304
  s_mov_b32 s39, 0x00020000
  s_cmp_eq_u32 s96, 1
  s_cselect_b32 s38, 128, 0
  s_add_u32 s38, s38, 2048
  s_lshl_b32 s38, s38, 11
  s_mov_b32 s40, s18
  s_and_b32 s41, s19, 0xffff
  s_mov_b32 s42, 6291456
  s_mov_b32 s43, 0x00020000
  s_cmp_lg_u32 s96, 0
  s_cbranch_scc1 L_attn_ld1
  s_mov_b32 s48, s28
  s_and_b32 s49, s29, 0xffff
  s_mov_b32 s50, 7340032
  s_mov_b32 s51, 0x00020000
  s_cmp_eq_u32 s96, 0
  s_cselect_b32 s50, s50, 0
  s_and_b32 s3, s70, 3
  s_lshl_b32 s4, s2, 2
  s_add_u32 s3, s3, s4
  s_mul_i32 s98, s3, 3584
  s_add_u32 s98, s98, 0
  s_add_u32 s3, s75, s76
  s_add_u32 m0, s3, 0
  s_nop 0
  buffer_load_dwordx4 v4, s[36:39], s73 offen lds
  s_add_u32 m0, s3, 1024
  s_nop 0
  buffer_load_dwordx4 v5, s[36:39], s73 offen lds
  s_add_u32 m0, s3, 2048
  s_nop 0
  buffer_load_dwordx4 v6, s[36:39], s73 offen lds
  s_add_u32 m0, s3, 3072
  s_nop 0
  buffer_load_dwordx4 v7, s[36:39], s73 offen lds
  s_add_u32 m0, s78, s75
  s_mov_b64 exec, s[14:15]
  buffer_load_dwordx4 v28, s[36:39], s73 offen lds
  s_mov_b64 exec, -1
  s_add_u32 s3, s75, s77
  s_add_u32 m0, s3, 0
  s_add_u32 s4, s74, 0
  buffer_load_dwordx4 v8, s[40:43], s4 offen lds
  s_add_u32 m0, s3, 1024
  s_nop 0
  buffer_load_dwordx4 v9, s[40:43], s4 offen lds
  s_add_u32 m0, s3, 8192
  s_add_u32 s4, s74, 2048
  buffer_load_dwordx4 v8, s[40:43], s4 offen lds
  s_add_u32 m0, s3, 9216
  s_nop 0
  buffer_load_dwordx4 v9, s[40:43], s4 offen lds
  s_add_u32 m0, s3, 16384
  s_add_u32 s4, s74, 4096
  buffer_load_dwordx4 v8, s[40:43], s4 offen lds
  s_add_u32 m0, s3, 17408
  s_nop 0
  buffer_load_dwordx4 v9, s[40:43], s4 offen lds
  s_and_b32 s73, s100, 15
  s_cmp_eq_u32 s73, s91
  s_cselect_b32 s74, 4, 0
  s_lshr_b64 s[100:101], s[100:101], s74
  s_and_b32 s73, s100, 15
  s_sub_u32 s92, s92, 1
  s_cselect_b32 s73, s91, s73
  s_cselect_b32 s74, 0, 4
  s_lshr_b64 s[100:101], s[100:101], s74
  s_mul_i32 s74, s73, 393216
  s_lshl_b32 s73, s73, 7
  s_add_u32 s75, s75, 43008
  s_cmp_eq_u32 s75, 129024
  s_cselect_b32 s75, 0, s75
  s_add_u32 s3, s75, s76
  s_add_u32 m0, s3, 0
  s_nop 0
  buffer_load_dwordx4 v4, s[36:39], s73 offen lds
  s_add_u32 m0, s3, 1024
  s_nop 0
  buffer_load_dwordx4 v5, s[36:39], s73 offen lds
  s_add_u32 m0, s3, 2048
  s_nop 0
  buffer_load_dwordx4 v6, s[36:39], s73 offen lds
  s_add_u32 m0, s3, 3072
  s_nop 0
  buffer_load_dwordx4 v7, s[36:39], s73 offen lds
  s_add_u32 m0, s78, s75
  s_mov_b64 exec, s[14:15]
  buffer_load_dwordx4 v28, s[36:39], s73 offen lds
  s_mov_b64 exec, -1
  s_add_u32 s3, s75, s77
  s_add_u32 m0, s3, 0
  s_add_u32 s4, s74, 0
  buffer_load_dwordx4 v8, s[40:43], s4 offen lds
  s_add_u32 m0, s3, 1024
  s_nop 0
  buffer_load_dwordx4 v9, s[40:43], s4 offen lds
  s_add_u32 m0, s3, 8192
  s_add_u32 s4, s74, 2048
  buffer_load_dwordx4 v8, s[40:43], s4 offen lds
  s_add_u32 m0, s3, 9216
  s_nop 0
  buffer_load_dwordx4 v9, s[40:43], s4 offen lds
  s_add_u32 m0, s3, 16384
  s_add_u32 s4, s74, 4096
  buffer_load_dwordx4 v8, s[40:43], s4 offen lds
  s_add_u32 m0, s3, 17408
  s_nop 0
  buffer_load_dwordx4 v9, s[40:43], s4 offen lds
  s_and_b32 s73, s100, 15
  s_cmp_eq_u32 s73, s91
  s_cselect_b32 s74, 4, 0
  s_lshr_b64 s[100:101], s[100:101], s74
  s_and_b32 s73, s100, 15
  s_sub_u32 s92, s92, 1
  s_cselect_b32 s73, s91, s73
  s_cselect_b32 s74, 0, 4
  s_lshr_b64 s[100:101], s[100:101], s74
  s_mul_i32 s74, s73, 393216
  s_lshl_b32 s73, s73, 7
  s_add_u32 s75, s75, 43008
  s_cmp_eq_u32 s75, 129024
  s_cselect_b32 s75, 0, s75
  s_mov_b32 s52, s24
  s_and_b32 s53, s25, 0xffff
  s_mov_b32 s54, 7340032
  s_mov_b32 s55, 0x00020000
  s_min_u32 s3, s2, 223
  s_mul_i32 s4, s3, 4682
  s_lshr_b32 s4, s4, 16
  s_mul_i32 s5, s4, 14
  s_sub_u32 s3, s3, s5
  s_lshl_b32 s3, s3, 2
  s_and_b32 s5, s70, 3
  s_add_u32 s3, s3, s5
  s_mul_i32 s5, s4, 458752
  s_lshl_b32 s8, s3, 7
  s_add_u32 s95, s5, s8
  s_lshl_b32 s9, s4, 14
  s_lshl_b32 s8, s3, 8
  s_add_u32 s94, s9, s8
  v_lshrrev_b32 v2, 3, v1
  v_mul_u32_u24 v2, 7168, v2
  v_and_b32 v3, 7, v1
  v_lshl_add_u32 v26, v3, 4, v2
  s_and_b32 s3, s70, 3
  s_lshl_b32 s4, s2, 2
  s_add_u32 s3, s3, s4
  s_sub_u32 s4, 384, s40
  s_and_b32 s4, s4, 0x380
  s_mul_i32 s5, s3, 6144
  s_add_u32 s5, s5, s4
  s_buffer_load_dword s84, s[40:43], s5 offset:0
  s_buffer_load_dword s84, s[40:43], s5 offset:64
  s_buffer_load_dword s84, s[40:43], s5 offset:1024
  s_buffer_load_dword s84, s[40:43], s5 offset:1088
  s_buffer_load_dword s84, s[40:43], s5 offset:2048
  s_buffer_load_dword s84, s[40:43], s5 offset:2112
  s_buffer_load_dword s84, s[40:43], s5 offset:3072
  s_buffer_load_dword s84, s[40:43], s5 offset:3136
  s_buffer_load_dword s84, s[40:43], s5 offset:4096
  s_buffer_load_dword s84, s[40:43], s5 offset:4160
  s_buffer_load_dword s84, s[40:43], s5 offset:5120
  s_buffer_load_dword s84, s[40:43], s5 offset:5184
  s_add_u32 s56, s22, 24903680
  s_addc_u32 s57, s23, 0
  s_and_b32 s57, s57, 0xffff
  s_mov_b32 s58, 262144
  s_mov_b32 s59, 0x00020000
  s_and_b32 s3, s70, 3
  s_lshl2_add_u32 s4, s68, s3
  s_lshl_b32 s4, s4, 8
  v_lshrrev_b32 v2, 4, v1
  v_and_b32 v3, 15, v1
  v_lshl_add_u32 v3, v3, 4, s4
  v_lshl_add_u32 v18, v2, 14, v3
  s_lshl_b32 s4, s68, 5
  s_add_u32 s4, s4, s3
  s_sub_u32 s4, s4, 4
  s_max_i32 s4, s4, 0
  s_lshl_b32 s4, s4, 5
  v_lshrrev_b32 v2, 2, v1
  v_and_b32 v3, 3, v1
  v_lshl_add_u32 v3, v3, 3, s4
  v_lshl_add_u32 v19, v2, 14, v3
  s_lshl_b32 s3, s68, 2
  s_sub_u32 s3, s3, 4
  v_and_b32 v20, 7, v1
  v_add_u32 v20, s3, v20
  v_max_i32 v20, 0, v20
  v_lshlrev_b32 v20, 2, v20
  s_and_b32 s65, s65, 0xffff
  s_mov_b32 s66, 256
  s_mov_b32 s67, 0x00020000
  s_waitcnt vmcnt(11)
  s_barrier
  s_add_u32 s3, s75, s76
  s_add_u32 m0, s3, 0
  s_nop 0
  buffer_load_dwordx4 v4, s[36:39], s73 offen lds
  s_add_u32 m0, s3, 1024
  s_nop 0
  buffer_load_dwordx4 v5, s[36:39], s73 offen lds
  s_add_u32 m0, s3, 2048
  s_nop 0
  buffer_load_dwordx4 v6, s[36:39], s73 offen lds
  s_add_u32 m0, s3, 3072
  s_nop 0
  buffer_load_dwordx4 v7, s[36:39], s73 offen lds
  s_add_u32 m0, s78, s75
  s_mov_b64 exec, s[14:15]
  buffer_load_dwordx4 v28, s[36:39], s73 offen lds
  s_mov_b64 exec, -1
  s_add_u32 s3, s75, s77
  s_add_u32 m0, s3, 0
  s_add_u32 s4, s74, 0
  buffer_load_dwordx4 v8, s[40:43], s4 offen lds
  s_add_u32 m0, s3, 1024
  s_nop 0
  buffer_load_dwordx4 v9, s[40:43], s4 offen lds
  s_add_u32 m0, s3, 8192
  s_add_u32 s4, s74, 2048
  buffer_load_dwordx4 v8, s[40:43], s4 offen lds
  s_add_u32 m0, s3, 9216
  s_nop 0
  buffer_load_dwordx4 v9, s[40:43], s4 offen lds
  s_add_u32 m0, s3, 16384
  s_add_u32 s4, s74, 4096
  buffer_load_dwordx4 v8, s[40:43], s4 offen lds
  s_add_u32 m0, s3, 17408
  s_nop 0
  buffer_load_dwordx4 v9, s[40:43], s4 offen lds
  s_and_b32 s73, s100, 15
  s_cmp_eq_u32 s73, s91
  s_cselect_b32 s74, 4, 0
  s_lshr_b64 s[100:101], s[100:101], s74
  s_and_b32 s73, s100, 15
  s_sub_u32 s92, s92, 1
  s_cselect_b32 s73, s91, s73
  s_cselect_b32 s74, 0, 4
  s_lshr_b64 s[100:101], s[100:101], s74
  s_mul_i32 s74, s73, 393216
  s_lshl_b32 s73, s73, 7
  s_add_u32 s75, s75, 43008
  s_cmp_eq_u32 s75, 129024
  s_cselect_b32 s75, 0, s75
  s_buffer_load_dword s84, s[48:51], s98 offset:0
  s_buffer_load_dword s84, s[48:51], s98 offset:64
  s_buffer_load_dword s84, s[48:51], s98 offset:128
  s_buffer_load_dword s84, s[48:51], s98 offset:192
  s_add_u32 s98, s98, 256
  buffer_load_dwordx4 v[64:67], v26, s[52:55], s95 offen
  s_add_u32 s95, s95, 57344
  buffer_load_dwordx4 v[68:71], v26, s[52:55], s95 offen
  s_add_u32 s95, s95, 57344
  s_waitcnt vmcnt(13)
  s_barrier
  s_add_u32 s3, s75, s76
  s_add_u32 m0, s3, 0
  s_nop 0
  buffer_load_dwordx4 v4, s[36:39], s73 offen lds
  s_add_u32 m0, s3, 1024
  s_nop 0
  buffer_load_dwordx4 v5, s[36:39], s73 offen lds
  s_add_u32 m0, s3, 2048
  s_nop 0
  buffer_load_dwordx4 v6, s[36:39], s73 offen lds
  s_add_u32 m0, s3, 3072
  s_nop 0
  buffer_load_dwordx4 v7, s[36:39], s73 offen lds
  s_add_u32 m0, s78, s75
  s_mov_b64 exec, s[14:15]
  buffer_load_dwordx4 v28, s[36:39], s73 offen lds
  s_mov_b64 exec, -1
  s_add_u32 s3, s75, s77
  s_add_u32 m0, s3, 0
  s_add_u32 s4, s74, 0
  buffer_load_dwordx4 v8, s[40:43], s4 offen lds
  s_add_u32 m0, s3, 1024
  s_nop 0
  buffer_load_dwordx4 v9, s[40:43], s4 offen lds
  s_add_u32 m0, s3, 8192
  s_add_u32 s4, s74, 2048
  buffer_load_dwordx4 v8, s[40:43], s4 offen lds
  s_add_u32 m0, s3, 9216
  s_nop 0
  buffer_load_dwordx4 v9, s[40:43], s4 offen lds
  s_add_u32 m0, s3, 16384
  s_add_u32 s4, s74, 4096
  buffer_load_dwordx4 v8, s[40:43], s4 offen lds
  s_add_u32 m0, s3, 17408
  s_nop 0
  buffer_load_dwordx4 v9, s[40:43], s4 offen lds
  s_and_b32 s73, s100, 15
  s_cmp_eq_u32 s73, s91
  s_cselect_b32 s74, 4, 0
  s_lshr_b64 s[100:101], s[100:101], s74
  s_and_b32 s73, s100, 15
  s_sub_u32 s92, s92, 1
  s_cselect_b32 s73, s91, s73
  s_cselect_b32 s74, 0, 4
  s_lshr_b64 s[100:101], s[100:101], s74
  s_mul_i32 s74, s73, 393216
  s_lshl_b32 s73, s73, 7
  s_add_u32 s75, s75, 43008
  s_cmp_eq_u32 s75, 129024
  s_cselect_b32 s75, 0, s75
  s_buffer_load_dword s84, s[48:51], s98 offset:0
  s_buffer_load_dword s84, s[48:51], s98 offset:64
  s_buffer_load_dword s84, s[48:51], s98 offset:128
  s_buffer_load_dword s84, s[48:51], s98 offset:192
  s_add_u32 s98, s98, 256
  buffer_load_dwordx4 v[72:75], v26, s[52:55], s95 offen
  s_add_u32 s95, s95, 57344
  buffer_load_dwordx4 v[76:79], v26, s[52:55], s95 offen
  s_add_u32 s95, s95, 57344
  s_waitcnt vmcnt(15)
  s_barrier
  s_add_u32 s3, s75, s76
  s_add_u32 m0, s3, 0
  s_nop 0
  buffer_load_dwordx4 v4, s[36:39], s73 offen lds
  s_add_u32 m0, s3, 1024
  s_nop 0
  buffer_load_dwordx4 v5, s[36:39], s73 offen lds
  s_add_u32 m0, s3, 2048
  s_nop 0
  buffer_load_dwordx4 v6, s[36:39], s73 offen lds
  s_add_u32 m0, s3, 3072
  s_nop 0
  buffer_load_dwordx4 v7, s[36:39], s73 offen lds
  s_add_u32 m0, s78, s75
  s_mov_b64 exec, s[14:15]
  buffer_load_dwordx4 v28, s[36:39], s73 offen lds
  s_mov_b64 exec, -1
  s_add_u32 s3, s75, s77
  s_add_u32 m0, s3, 0
  s_add_u32 s4, s74, 0
  buffer_load_dwordx4 v8, s[40:43], s4 offen lds
  s_add_u32 m0, s3, 1024
  s_nop 0
  buffer_load_dwordx4 v9, s[40:43], s4 offen lds
  s_add_u32 m0, s3, 8192
  s_add_u32 s4, s74, 2048
  buffer_load_dwordx4 v8, s[40:43], s4 offen lds
  s_add_u32 m0, s3, 9216
  s_nop 0
  buffer_load_dwordx4 v9, s[40:43], s4 offen lds
  s_add_u32 m0, s3, 16384
  s_add_u32 s4, s74, 4096
  buffer_load_dwordx4 v8, s[40:43], s4 offen lds
  s_add_u32 m0, s3, 17408
  s_nop 0
  buffer_load_dwordx4 v9, s[40:43], s4 offen lds
  s_and_b32 s73, s100, 15
  s_cmp_eq_u32 s73, s91
  s_cselect_b32 s74, 4, 0
  s_lshr_b64 s[100:101], s[100:101], s74
  s_and_b32 s73, s100, 15
  s_sub_u32 s92, s92, 1
  s_cselect_b32 s73, s91, s73
  s_cselect_b32 s74, 0, 4
  s_lshr_b64 s[100:101], s[100:101], s74
  s_mul_i32 s74, s73, 393216
  s_lshl_b32 s73, s73, 7
  s_add_u32 s75, s75, 43008
  s_cmp_eq_u32 s75, 129024
  s_cselect_b32 s75, 0, s75
  s_buffer_load_dword s84, s[48:51], s98 offset:0
  s_buffer_load_dword s84, s[48:51], s98 offset:64
  s_buffer_load_dword s84, s[48:51], s98 offset:128
  s_buffer_load_dword s84, s[48:51], s98 offset:192
  s_add_u32 s98, s98, 256
  buffer_load_dwordx4 v[80:83], v26, s[52:55], s95 offen
  s_add_u32 s95, s95, 57344
  buffer_load_dwordx4 v[84:87], v26, s[52:55], s95 offen
  s_add_u32 s95, s95, 57344
  s_waitcnt vmcnt(15)
  s_barrier
  s_add_u32 s3, s75, s76
  s_add_u32 m0, s3, 0
  s_nop 0
  buffer_load_dwordx4 v4, s[36:39], s73 offen lds
  s_add_u32 m0, s3, 1024
  s_nop 0
  buffer_load_dwordx4 v5, s[36:39], s73 offen lds
  s_add_u32 m0, s3, 2048
  s_nop 0
  buffer_load_dwordx4 v6, s[36:39], s73 offen lds
  s_add_u32 m0, s3, 3072
  s_nop 0
  buffer_load_dwordx4 v7, s[36:39], s73 offen lds
  s_add_u32 m0, s78, s75
  s_mov_b64 exec, s[14:15]
  buffer_load_dwordx4 v28, s[36:39], s73 offen lds
  s_mov_b64 exec, -1
  s_add_u32 s3, s75, s77
  s_add_u32 m0, s3, 0
  s_add_u32 s4, s74, 0
  buffer_load_dwordx4 v8, s[40:43], s4 offen lds
  s_add_u32 m0, s3, 1024
  s_nop 0
  buffer_load_dwordx4 v9, s[40:43], s4 offen lds
  s_add_u32 m0, s3, 8192
  s_add_u32 s4, s74, 2048
  buffer_load_dwordx4 v8, s[40:43], s4 offen lds
  s_add_u32 m0, s3, 9216
  s_nop 0
  buffer_load_dwordx4 v9, s[40:43], s4 offen lds
  s_add_u32 m0, s3, 16384
  s_add_u32 s4, s74, 4096
  buffer_load_dwordx4 v8, s[40:43], s4 offen lds
  s_add_u32 m0, s3, 17408
  s_nop 0
  buffer_load_dwordx4 v9, s[40:43], s4 offen lds
  s_and_b32 s73, s100, 15
  s_cmp_eq_u32 s73, s91
  s_cselect_b32 s74, 4, 0
  s_lshr_b64 s[100:101], s[100:101], s74
  s_and_b32 s73, s100, 15
  s_sub_u32 s92, s92, 1
  s_cselect_b32 s73, s91, s73
  s_cselect_b32 s74, 0, 4
  s_lshr_b64 s[100:101], s[100:101], s74
  s_mul_i32 s74, s73, 393216
  s_lshl_b32 s73, s73, 7
  s_add_u32 s75, s75, 43008
  s_cmp_eq_u32 s75, 129024
  s_cselect_b32 s75, 0, s75
  s_buffer_load_dword s84, s[48:51], s98 offset:0
  s_buffer_load_dword s84, s[48:51], s98 offset:64
  s_buffer_load_dword s84, s[48:51], s98 offset:128
  s_buffer_load_dword s84, s[48:51], s98 offset:192
  s_add_u32 s98, s98, 256
  buffer_load_dwordx4 v[88:91], v26, s[52:55], s95 offen
  s_add_u32 s95, s95, 57344
  buffer_load_dwordx4 v[92:95], v26, s[52:55], s95 offen
  s_waitcnt vmcnt(15)
  s_barrier
  s_add_u32 s3, s75, s76
  s_add_u32 m0, s3, 0
  s_nop 0
  buffer_load_dwordx4 v4, s[36:39], s73 offen lds
  s_add_u32 m0, s3, 1024
  s_nop 0
  buffer_load_dwordx4 v5, s[36:39], s73 offen lds
  s_add_u32 m0, s3, 2048
  s_nop 0
  buffer_load_dwordx4 v6, s[36:39], s73 offen lds
  s_add_u32 m0, s3, 3072
  s_nop 0
  buffer_load_dwordx4 v7, s[36:39], s73 offen lds
  s_add_u32 m0, s78, s75
  s_mov_b64 exec, s[14:15]
  buffer_load_dwordx4 v28, s[36:39], s73 offen lds
  s_mov_b64 exec, -1
  s_add_u32 s3, s75, s77
  s_add_u32 m0, s3, 0
  s_add_u32 s4, s74, 0
  buffer_load_dwordx4 v8, s[40:43], s4 offen lds
  s_add_u32 m0, s3, 1024
  s_nop 0
  buffer_load_dwordx4 v9, s[40:43], s4 offen lds
  s_add_u32 m0, s3, 8192
  s_add_u32 s4, s74, 2048
  buffer_load_dwordx4 v8, s[40:43], s4 offen lds
  s_add_u32 m0, s3, 9216
  s_nop 0
  buffer_load_dwordx4 v9, s[40:43], s4 offen lds
  s_add_u32 m0, s3, 16384
  s_add_u32 s4, s74, 4096
  buffer_load_dwordx4 v8, s[40:43], s4 offen lds
  s_add_u32 m0, s3, 17408
  s_nop 0
  buffer_load_dwordx4 v9, s[40:43], s4 offen lds
  s_and_b32 s73, s100, 15
  s_cmp_eq_u32 s73, s91
  s_cselect_b32 s74, 4, 0
  s_lshr_b64 s[100:101], s[100:101], s74
  s_and_b32 s73, s100, 15
  s_sub_u32 s92, s92, 1
  s_cselect_b32 s73, s91, s73
  s_cselect_b32 s74, 0, 4
  s_lshr_b64 s[100:101], s[100:101], s74
  s_mul_i32 s74, s73, 393216
  s_lshl_b32 s73, s73, 7
  s_add_u32 s75, s75, 43008
  s_cmp_eq_u32 s75, 129024
  s_cselect_b32 s75, 0, s75
  s_buffer_load_dword s84, s[48:51], s98 offset:0
  s_buffer_load_dword s84, s[48:51], s98 offset:64
  s_buffer_load_dword s84, s[48:51], s98 offset:128
  s_buffer_load_dword s84, s[48:51], s98 offset:192
  s_add_u32 s98, s98, 256
  s_waitcnt vmcnt(13)
  s_barrier
  s_mov_b32 s79, 6
L_attn0_ld1:
  s_add_u32 s3, s75, s76
  s_add_u32 m0, s3, 0
  s_nop 0
  buffer_load_dwordx4 v4, s[36:39], s73 offen lds
  s_add_u32 m0, s3, 1024
  s_nop 0
  buffer_load_dwordx4 v5, s[36:39], s73 offen lds
  s_add_u32 m0, s3, 2048
  s_nop 0
  buffer_load_dwordx4 v6, s[36:39], s73 offen lds
  s_add_u32 m0, s3, 3072
  s_nop 0
  buffer_load_dwordx4 v7, s[36:39], s73 offen lds
  s_add_u32 m0, s78, s75
  s_mov_b64 exec, s[14:15]
  buffer_load_dwordx4 v28, s[36:39], s73 offen lds
  s_mov_b64 exec, -1
  s_add_u32 s3, s75, s77
  s_add_u32 m0, s3, 0
  s_add_u32 s4, s74, 0
  buffer_load_dwordx4 v8, s[40:43], s4 offen lds
  s_add_u32 m0, s3, 1024
  s_nop 0
  buffer_load_dwordx4 v9, s[40:43], s4 offen lds
  s_add_u32 m0, s3, 8192
  s_add_u32 s4, s74, 2048
  buffer_load_dwordx4 v8, s[40:43], s4 offen lds
  s_add_u32 m0, s3, 9216
  s_nop 0
  buffer_load_dwordx4 v9, s[40:43], s4 offen lds
  s_add_u32 m0, s3, 16384
  s_add_u32 s4, s74, 4096
  buffer_load_dwordx4 v8, s[40:43], s4 offen lds
  s_add_u32 m0, s3, 17408
  s_nop 0
  buffer_load_dwordx4 v9, s[40:43], s4 offen lds
  s_and_b32 s73, s100, 15
  s_cmp_eq_u32 s73, s91
  s_cselect_b32 s74, 4, 0
  s_lshr_b64 s[100:101], s[100:101], s74
  s_and_b32 s73, s100, 15
  s_sub_u32 s92, s92, 1
  s_cselect_b32 s73, s91, s73
  s_cselect_b32 s74, 0, 4
  s_lshr_b64 s[100:101], s[100:101], s74
  s_mul_i32 s74, s73, 393216
  s_lshl_b32 s73, s73, 7
  s_add_u32 s75, s75, 43008
  s_cmp_eq_u32 s75, 129024
  s_cselect_b32 s75, 0, s75
  s_buffer_load_dword s84, s[48:51], s98 offset:0
  s_buffer_load_dword s84, s[48:51], s98 offset:64
  s_buffer_load_dword s84, s[48:51], s98 offset:128
  s_buffer_load_dword s84, s[48:51], s98 offset:192
  s_add_u32 s98, s98, 256
  s_waitcnt vmcnt(11)
  s_barrier
  s_sub_u32 s79, s79, 1
  s_cmp_lg_u32 s79, 0
  s_cbranch_scc1 L_attn0_ld1
  s_add_u32 s3, s75, s76
  s_add_u32 m0, s3, 0
  s_nop 0
  buffer_load_dwordx4 v4, s[36:39], s73 offen lds
  s_add_u32 m0, s3, 1024
  s_nop 0
  buffer_load_dwordx4 v5, s[36:39], s73 offen lds
  s_add_u32 m0, s3, 2048
  s_nop 0
  buffer_load_dwordx4 v6, s[36:39], s73 offen lds
  s_add_u32 m0, s3, 3072
  s_nop 0
  buffer_load_dwordx4 v7, s[36:39], s73 offen lds
  s_add_u32 m0, s78, s75
  s_mov_b64 exec, s[14:15]
  buffer_load_dwordx4 v28, s[36:39], s73 offen lds
  s_mov_b64 exec, -1
  s_add_u32 s3, s75, s77
  s_add_u32 m0, s3, 0
  s_add_u32 s4, s74, 0
  buffer_load_dwordx4 v8, s[40:43], s4 offen lds
  s_add_u32 m0, s3, 1024
  s_nop 0
  buffer_load_dwordx4 v9, s[40:43], s4 offen lds
  s_add_u32 m0, s3, 8192
  s_add_u32 s4, s74, 2048
  buffer_load_dwordx4 v8, s[40:43], s4 offen lds
  s_add_u32 m0, s3, 9216
  s_nop 0
  buffer_load_dwordx4 v9, s[40:43], s4 offen lds
  s_add_u32 m0, s3, 16384
  s_add_u32 s4, s74, 4096
  buffer_load_dwordx4 v8, s[40:43], s4 offen lds
  s_add_u32 m0, s3, 17408
  s_nop 0
  buffer_load_dwordx4 v9, s[40:43], s4 offen lds
  s_and_b32 s73, s100, 15
  s_cmp_eq_u32 s73, s91
  s_cselect_b32 s74, 4, 0
  s_lshr_b64 s[100:101], s[100:101], s74
  s_and_b32 s73, s100, 15
  s_sub_u32 s92, s92, 1
  s_cselect_b32 s73, s91, s73
  s_cselect_b32 s74, 0, 4
  s_lshr_b64 s[100:101], s[100:101], s74
  s_mul_i32 s74, s73, 393216
  s_lshl_b32 s73, s73, 7
  s_add_u32 s75, s75, 43008
  s_cmp_eq_u32 s75, 129024
  s_cselect_b32 s75, 0, s75
  s_buffer_load_dword s84, s[48:51], s98 offset:0
  s_buffer_load_dword s84, s[48:51], s98 offset:64
  s_buffer_load_dword s84, s[48:51], s98 offset:128
  s_buffer_load_dword s84, s[48:51], s98 offset:192
  s_add_u32 s98, s98, 256
  buffer_load_dword v21, v20, s[64:67], 0 offen sc1
  s_waitcnt vmcnt(12)
  s_barrier
  s_add_u32 s3, s75, s76
  s_add_u32 m0, s3, 0
  s_nop 0
  buffer_load_dwordx4 v4, s[36:39], s73 offen lds
  s_add_u32 m0, s3, 1024
  s_nop 0
  buffer_load_dwordx4 v5, s[36:39], s73 offen lds
  s_add_u32 m0, s3, 2048
  s_nop 0
  buffer_load_dwordx4 v6, s[36:39], s73 offen lds
  s_add_u32 m0, s3, 3072
  s_nop 0
  buffer_load_dwordx4 v7, s[36:39], s73 offen lds
  s_add_u32 m0, s78, s75
  s_mov_b64 exec, s[14:15]
  buffer_load_dwordx4 v28, s[36:39], s73 offen lds
  s_mov_b64 exec, -1
  s_add_u32 s3, s75, s77
  s_add_u32 m0, s3, 0
  s_add_u32 s4, s74, 0
  buffer_load_dwordx4 v8, s[40:43], s4 offen lds
  s_add_u32 m0, s3, 1024
  s_nop 0
  buffer_load_dwordx4 v9, s[40:43], s4 offen lds
  s_add_u32 m0, s3, 8192
  s_add_u32 s4, s74, 2048
  buffer_load_dwordx4 v8, s[40:43], s4 offen lds
  s_add_u32 m0, s3, 9216
  s_nop 0
  buffer_load_dwordx4 v9, s[40:43], s4 offen lds
  s_add_u32 m0, s3, 16384
  s_add_u32 s4, s74, 4096
  buffer_load_dwordx4 v8, s[40:43], s4 offen lds
  s_add_u32 m0, s3, 17408
  s_nop 0
  buffer_load_dwordx4 v9, s[40:43], s4 offen lds
  s_and_b32 s73, s100, 15
  s_cmp_eq_u32 s73, s91
  s_cselect_b32 s74, 4, 0
  s_lshr_b64 s[100:101], s[100:101], s74
  s_and_b32 s73, s100, 15
  s_sub_u32 s92, s92, 1
  s_cselect_b32 s73, s91, s73
  s_cselect_b32 s74, 0, 4
  s_lshr_b64 s[100:101], s[100:101], s74
  s_mul_i32 s74, s73, 393216
  s_lshl_b32 s73, s73, 7
  s_add_u32 s75, s75, 43008
  s_cmp_eq_u32 s75, 129024
  s_cselect_b32 s75, 0, s75
  s_buffer_load_dword s84, s[48:51], s98 offset:0
  s_buffer_load_dword s84, s[48:51], s98 offset:64
  s_buffer_load_dword s84, s[48:51], s98 offset:128
  s_buffer_load_dword s84, s[48:51], s98 offset:192
  s_add_u32 s98, s98, 256
  s_waitcnt vmcnt(12)
  s_barrier
  s_add_u32 s3, s75, s76
  s_add_u32 m0, s3, 0
  s_nop 0
  buffer_load_dwordx4 v4, s[36:39], s73 offen lds
  s_add_u32 m0, s3, 1024
  s_nop 0
  buffer_load_dwordx4 v5, s[36:39], s73 offen lds
  s_add_u32 m0, s3, 2048
  s_nop 0
  buffer_load_dwordx4 v6, s[36:39], s73 offen lds
  s_add_u32 m0, s3, 3072
  s_nop 0
  buffer_load_dwordx4 v7, s[36:39], s73 offen lds
  s_add_u32 m0, s78, s75
  s_mov_b64 exec, s[14:15]
  buffer_load_dwordx4 v28, s[36:39], s73 offen lds
  s_mov_b64 exec, -1
  s_add_u32 s3, s75, s77
  s_add_u32 m0, s3, 0
  s_add_u32 s4, s74, 0
  buffer_load_dwordx4 v8, s[40:43], s4 offen lds
  s_add_u32 m0, s3, 1024
  s_nop 0
  buffer_load_dwordx4 v9, s[40:43], s4 offen lds
  s_add_u32 m0, s3, 8192
  s_add_u32 s4, s74, 2048
  buffer_load_dwordx4 v8, s[40:43], s4 offen lds
  s_add_u32 m0, s3, 9216
  s_nop 0
  buffer_load_dwordx4 v9, s[40:43], s4 offen lds
  s_add_u32 m0, s3, 16384
  s_add_u32 s4, s74, 4096
  buffer_load_dwordx4 v8, s[40:43], s4 offen lds
  s_add_u32 m0, s3, 17408
  s_nop 0
  buffer_load_dwordx4 v9, s[40:43], s4 offen lds
  s_and_b32 s73, s100, 15
  s_cmp_eq_u32 s73, s91
  s_cselect_b32 s74, 4, 0
  s_lshr_b64 s[100:101], s[100:101], s74
  s_and_b32 s73, s100, 15
  s_sub_u32 s92, s92, 1
  s_cselect_b32 s73, s91, s73
  s_cselect_b32 s74, 0, 4
  s_lshr_b64 s[100:101], s[100:101], s74
  s_mul_i32 s74, s73, 393216
  s_lshl_b32 s73, s73, 7
  s_add_u32 s75, s75, 43008
  s_cmp_eq_u32 s75, 129024
  s_cselect_b32 s75, 0, s75
  s_buffer_load_dword s84, s[48:51], s98 offset:0
  s_buffer_load_dword s84, s[48:51], s98 offset:64
  s_buffer_load_dword s84, s[48:51], s98 offset:128
  s_buffer_load_dword s84, s[48:51], s98 offset:192
  s_add_u32 s98, s98, 256
  s_waitcnt vmcnt(11)
  s_barrier
  s_mov_b32 s5, 0x100000
  L_attn_dchk:
  v_cmp_ne_u32 vcc, 0x01010101, v21
  s_cbranch_vccz L_attn_dok
  s_sub_u32 s5, s5, 1
  buffer_load_dword v21, v20, s[64:67], 0 offen sc1
  s_waitcnt vmcnt(0)
  s_cbranch_scc0 L_attn_dchk
  L_attn_dok:
  buffer_load_dwordx4 v[32:35], v18, s[56:59], 0 offen
  s_mov_b32 s3, 65536
  buffer_load_dwordx4 v[36:39], v18, s[56:59], s3 offen
  s_mov_b32 s3, 131072
  buffer_load_dwordx4 v[40:43], v18, s[56:59], s3 offen
  s_mov_b32 s3, 196608
  buffer_load_dwordx4 v[44:47], v18, s[56:59], s3 offen
  buffer_load_dwordx2 v[48:49], v19, s[56:59], 0 offen
  s_mov_b32 s60, s20
  s_and_b32 s61, s21, 0xffff
  s_mov_b32 s62, 2097152
  s_mov_b32 s63, 0x00020000
  s_and_b32 s3, s70, 3
  s_mul_i32 s3, s3, 8
  s_mul_i32 s4, s99, 32
  s_add_u32 s3, s3, s4
  v_lshrrev_b32 v2, 3, v1
  v_add_u32 v2, s3, v2
  v_mul_u32_u24 v2, 2048, v2
  v_and_b32 v3, 7, v1
  v_lshl_add_u32 v2, v3, 8, v2
  s_and_b32 s3, s2, 7
  s_lshr_b32 s3, s3, 2
  s_mul_i32 s3, s3, 128
  buffer_load_dword v96, v2, s[60:63], s3 offen
  s_waitcnt vmcnt(6)
  s_barrier
  s_mov_b32 s79, 0x4000
  s_waitcnt vmcnt(1)
L_attn_schk:
  v_pk_add_f32 v[32:33], v[32:33], v[36:37]
  v_pk_add_f32 v[34:35], v[34:35], v[38:39]
  v_pk_add_f32 v[40:41], v[40:41], v[44:45]
  v_pk_add_f32 v[42:43], v[42:43], v[46:47]
  v_pk_add_f32 v[32:33], v[32:33], v[40:41]
  v_pk_add_f32 v[34:35], v[34:35], v[42:43]
  s_nop 1
  v_permlane32_swap_b32 v32, v34
  v_permlane32_swap_b32 v33, v35
  v_pk_add_f32 v[32:33], v[32:33], v[34:35]
  v_cmp_u_f32 vcc, v32, v33
  v_cmp_u_f32 s[4:5], v48, v49
  s_or_b64 s[4:5], vcc, s[4:5]
  s_cbranch_scc0 L_attn_sok
  s_sub_u32 s79, s79, 1
  s_cbranch_scc1 L_attn_sok
  buffer_load_dwordx4 v[32:35], v18, s[56:59], 0 offen sc1
  s_mov_b32 s3, 65536
  buffer_load_dwordx4 v[36:39], v18, s[56:59], s3 offen sc1
  s_mov_b32 s3, 131072
  buffer_load_dwordx4 v[40:43], v18, s[56:59], s3 offen sc1
  s_mov_b32 s3, 196608
  buffer_load_dwordx4 v[44:47], v18, s[56:59], s3 offen sc1
  buffer_load_dwordx2 v[48:49], v19, s[56:59], 0 offen sc1
  s_waitcnt vmcnt(0)
  s_branch L_attn_schk
L_attn_sok:
  v_mov_b32 v34, v32
  v_mov_b32 v35, v33
  s_nop 0
  v_permlane16_swap_b32 v32, v34
  v_permlane16_swap_b32 v33, v35
  v_pk_add_f32 v[32:33], v[32:33], v[34:35]
  v_mul_f32 v32, 0x3a800000, v32
  v_mul_f32 v33, 0x3a800000, v33
  v_fma_f32 v33, -v32, v32, v33
  v_max_f32 v33, 0, v33
  v_add_f32 v33, 0x3727c5ac, v33
  v_rsq_f32 v33, v33
  s_nop 0
  s_and_b32 s3, s70, 3
  s_lshl_b32 s5, s3, 7
  s_add_u32 s5, s5, 129088
  v_and_b32 v3, 15, v1
  v_lshrrev_b32 v2, 5, v1
  v_lshl_add_u32 v2, v3, 1, v2
  v_lshl_add_u32 v2, v2, 2, s5
  ds_write2_b32 v2, v32, v33 offset0:0 offset1:160
  v_mov_b32 v50, v48
  v_mov_b32 v51, v49
  s_nop 0
  v_permlane32_swap_b32 v48, v50
  v_permlane32_swap_b32 v49, v51
  v_pk_add_f32 v[48:49], v[48:49], v[50:51]
  v_mov_b32 v50, v48
  v_mov_b32 v51, v49
  s_nop 0
  v_permlane16_swap_b32 v48, v50
  v_permlane16_swap_b32 v49, v51
  v_pk_add_f32 v[48:49], v[48:49], v[50:51]
  s_nop 1
  v_add_f32_dpp v48, v48, v48 row_ror:8 row_mask:0xf bank_mask:0xf
  v_add_f32_dpp v49, v49, v49 row_ror:8 row_mask:0xf bank_mask:0xf
  s_nop 1
  v_add_f32_dpp v48, v48, v48 row_ror:4 row_mask:0xf bank_mask:0xf
  v_add_f32_dpp v49, v49, v49 row_ror:4 row_mask:0xf bank_mask:0xf
  v_mul_f32 v48, 0x3a800000, v48
  v_mul_f32 v49, 0x3a800000, v49
  v_fma_f32 v49, -v48, v48, v49
  v_max_f32 v49, 0, v49
  v_add_f32 v49, 0x3727c5ac, v49
  v_rsq_f32 v49, v49
  s_nop 0
  s_lshl_b32 s5, s3, 4
  s_add_u32 s5, s5, 129024
  v_and_b32 v3, 3, v1
  v_lshl_add_u32 v2, v3, 2, s5
  ds_write2_b32 v2, v48, v49 offset0:0 offset1:160
  s_waitcnt lgkmcnt(0)
  s_barrier
  s_barrier
  s_branch L_attn_ldend
L_attn_ld1:
  s_add_u32 s3, s68, s69
  s_and_b32 s3, s3, 3
  s_mov_b32 s100, 0x68532410
  s_mov_b32 s101, 0xfedbac97
  s_cmp_eq_u32 s3, 1
  s_cselect_b32 s100, 0x96435210, s100
  s_cselect_b32 s101, 0xfecbda87, s101
  s_cmp_eq_u32 s3, 2
  s_cselect_b32 s100, 0x75463210, s100
  s_cselect_b32 s101, 0xfdceb98a, s101
  s_cmp_eq_u32 s3, 3
  s_cselect_b32 s100, 0x65743210, s100
  s_cselect_b32 s101, 0xedfca9b8, s101
  s_add_u32 s56, s22, 24379392
  s_addc_u32 s57, s23, 0
  s_and_b32 s57, s57, 0xffff
  s_mov_b32 s58, 262144
  s_mov_b32 s59, 0x00020000
  s_and_b32 s3, s70, 3
  s_lshl2_add_u32 s4, s68, s3
  s_lshl_b32 s4, s4, 8
  v_lshrrev_b32 v2, 4, v1
  v_and_b32 v3, 15, v1
  v_lshl_add_u32 v3, v3, 4, s4
  v_lshl_add_u32 v18, v2, 14, v3
  s_lshl_b32 s4, s68, 5
  s_add_u32 s4, s4, s3
  s_sub_u32 s4, s4, 4
  s_max_i32 s4, s4, 0
  s_lshl_b32 s4, s4, 5
  v_lshrrev_b32 v2, 2, v1
  v_and_b32 v3, 3, v1
  v_lshl_add_u32 v3, v3, 3, s4
  v_lshl_add_u32 v19, v2, 14, v3
  s_add_u32 s64, s22, 41943040
  s_addc_u32 s65, s23, 0
  s_and_b32 s65, s65, 0xffff
  s_mov_b32 s66, 524288
  s_mov_b32 s67, 0x00020000
  v_and_b32 v30, 3, v1
  v_lshlrev_b32 v30, 6, v30
  s_mov_b32 s79, 0x100000
  s_cmp_lg_u32 s70, 4
  s_cbranch_scc1 L_attn_xgo
  s_setprio 3
L_attn_xpoll:
  buffer_load_dword v12, v30, s[64:67], s86 offen sc1
  s_sub_u32 s79, s79, 1
  s_cbranch_scc1 L_attn_xgo
  s_waitcnt vmcnt(0)
  v_cmp_ne_u32 vcc, 1, v12
  s_cbranch_vccnz L_attn_xpoll
L_attn_xgo:
  s_setprio 0
  s_barrier
  s_lshr_b32 s3, s69, 3
  s_and_b32 s73, s69, 7
  s_lshl1_add_u32 s91, s73, s3
  s_mul_i32 s74, s91, 393216
  s_lshl_b32 s73, s91, 7
  s_mov_b32 s88, s73
  s_add_u32 m0, s77, 0
  s_add_u32 s4, s74, 0
  buffer_load_dwordx4 v8, s[40:43], s4 offen lds
  s_add_u32 m0, s77, 1024
  s_nop 0
  buffer_load_dwordx4 v9, s[40:43], s4 offen lds
  s_add_u32 m0, s77, 8192
  s_add_u32 s4, s74, 2048
  buffer_load_dwordx4 v8, s[40:43], s4 offen lds
  s_add_u32 m0, s77, 9216
  s_nop 0
  buffer_load_dwordx4 v9, s[40:43], s4 offen lds
  s_add_u32 m0, s77, 16384
  s_add_u32 s4, s74, 4096
  buffer_load_dwordx4 v8, s[40:43], s4 offen lds
  s_add_u32 m0, s77, 17408
  s_nop 0
  buffer_load_dwordx4 v9, s[40:43], s4 offen lds
  s_and_b32 s73, s100, 15
  s_cmp_eq_u32 s73, s91
  s_cselect_b32 s74, 4, 0
  s_lshr_b64 s[100:101], s[100:101], s74
  s_and_b32 s73, s100, 15
  s_lshr_b64 s[100:101], s[100:101], 4
  s_mul_i32 s74, s73, 393216
  s_lshl_b32 s73, s73, 7
  s_mov_b32 s75, 0
  s_add_u32 s44, s22, 41943040
  s_addc_u32 s45, s23, 0
  s_and_b32 s45, s45, 0xffff
  s_mov_b32 s46, 524288
  s_mov_b32 s47, 0x00020000
  s_lshl4_add_u32 s3, s97, s68
  s_and_b32 s4, s69, 15
  s_lshl4_add_u32 s3, s3, s4
  s_lshl_b32 s3, s3, 7
  s_sub_u32 s3, s3, 32768
  v_lshlrev_b32 v11, 7, v1
  s_cmp_eq_u32 s68, 0
  s_cselect_b32 s4, 15, 31
  v_and_b32 v2, 16, v1
  v_lshl_add_u32 v11, v2, 2, v11
  v_and_b32 v2, s4, v1
  v_lshlrev_b32 v2, 2, v2
  v_mov_b32 v3, 1
  s_mov_b32 s79, 0x100000
  s_waitcnt vmcnt(0)
  s_cmp_lg_u32 s70, 4
  s_barrier
  s_cbranch_scc1 L_attn_nofl
  s_mov_b32 exec_lo, 0xffffffff
  s_mov_b32 exec_hi, 0
  buffer_store_dword v3, v11, s[44:47], s87 offen sc1
  s_mov_b64 exec, -1
L_attn_nofl:
  s_mov_b32 s5, s3
  s_mov_b32 s89, s73
  s_add_u32 m0, s77, 43008
  s_add_u32 s4, s74, 0
  buffer_load_dwordx4 v8, s[40:43], s4 offen lds
  s_add_u32 m0, s77, 44032
  s_nop 0
  buffer_load_dwordx4 v9, s[40:43], s4 offen lds
  s_add_u32 m0, s77, 51200
  s_add_u32 s4, s74, 2048
  buffer_load_dwordx4 v8, s[40:43], s4 offen lds
  s_add_u32 m0, s77, 52224
  s_nop 0
  buffer_load_dwordx4 v9, s[40:43], s4 offen lds
  s_add_u32 m0, s77, 59392
  s_add_u32 s4, s74, 4096
  buffer_load_dwordx4 v8, s[40:43], s4 offen lds
  s_add_u32 m0, s77, 60416
  s_nop 0
  buffer_load_dwordx4 v9, s[40:43], s4 offen lds
  s_and_b32 s73, s100, 15
  s_cmp_eq_u32 s73, s91
  s_cselect_b32 s74, 4, 0
  s_lshr_b64 s[100:101], s[100:101], s74
  s_and_b32 s73, s100, 15
  s_lshr_b64 s[100:101], s[100:101], 4
  s_mul_i32 s74, s73, 393216
  s_lshl_b32 s73, s73, 7
  s_mov_b32 s90, s73
  s_add_u32 m0, s77, 86016
  s_add_u32 s4, s74, 0
  buffer_load_dwordx4 v8, s[40:43], s4 offen lds
  s_add_u32 m0, s77, 87040
  s_nop 0
  buffer_load_dwordx4 v9, s[40:43], s4 offen lds
  s_add_u32 m0, s77, 94208
  s_add_u32 s4, s74, 2048
  buffer_load_dwordx4 v8, s[40:43], s4 offen lds
  s_add_u32 m0, s77, 95232
  s_nop 0
  buffer_load_dwordx4 v9, s[40:43], s4 offen lds
  s_add_u32 m0, s77, 102400
  s_add_u32 s4, s74, 4096
  buffer_load_dwordx4 v8, s[40:43], s4 offen lds
  s_add_u32 m0, s77, 103424
  s_nop 0
  buffer_load_dwordx4 v9, s[40:43], s4 offen lds
  s_and_b32 s73, s100, 15
  s_cmp_eq_u32 s73, s91
  s_cselect_b32 s74, 4, 0
  s_lshr_b64 s[100:101], s[100:101], s74
  s_and_b32 s73, s100, 15
  s_lshr_b64 s[100:101], s[100:101], 4
  s_mul_i32 s74, s73, 393216
  s_lshl_b32 s73, s73, 7
  s_mov_b32 s3, s5
  s_cmp_lg_u32 s70, 4
  s_cbranch_scc1 L_attn_dep
L_attn_poll:
  buffer_load_dword v3, v2, s[44:47], s3 offen sc1
  s_sub_u32 s79, s79, 1
  s_cbranch_scc1 L_attn_dep
  s_waitcnt vmcnt(0)
  v_cmp_ne_u32 vcc, 1, v3
  s_cbranch_vccnz L_attn_poll
L_attn_dep:
  s_barrier
  s_add_u32 m0, s78, 89344
  s_mov_b64 exec, s[14:15]
  buffer_load_dwordx4 v28, s[36:39], s88 offen lds
  s_mov_b64 exec, -1
  s_add_u32 m0, s76, 43008
  s_nop 0
  buffer_load_dwordx4 v4, s[36:39], s89 offen lds
  s_add_u32 m0, s76, 44032
  s_nop 0
  buffer_load_dwordx4 v5, s[36:39], s89 offen lds
  s_add_u32 m0, s76, 45056
  s_nop 0
  buffer_load_dwordx4 v6, s[36:39], s89 offen lds
  s_add_u32 m0, s76, 46080
  s_nop 0
  buffer_load_dwordx4 v7, s[36:39], s89 offen lds
  s_add_u32 m0, s78, 43008
  s_mov_b64 exec, s[14:15]
  buffer_load_dwordx4 v28, s[36:39], s89 offen lds
  s_mov_b64 exec, -1
  s_add_u32 m0, s76, 86016
  s_nop 0
  buffer_load_dwordx4 v4, s[36:39], s90 offen lds
  s_add_u32 m0, s76, 87040
  s_nop 0
  buffer_load_dwordx4 v5, s[36:39], s90 offen lds
  s_add_u32 m0, s76, 88064
  s_nop 0
  buffer_load_dwordx4 v6, s[36:39], s90 offen lds
  s_add_u32 m0, s76, 89088
  s_nop 0
  buffer_load_dwordx4 v7, s[36:39], s90 offen lds
  s_add_u32 m0, s78, 86016
  s_mov_b64 exec, s[14:15]
  buffer_load_dwordx4 v28, s[36:39], s90 offen lds
  s_mov_b64 exec, -1
  s_waitcnt vmcnt(5)
  s_barrier
  s_mov_b32 s79, 12
L_attn1_ld1:
  s_add_u32 s3, s75, s76
  s_add_u32 m0, s3, 0
  s_nop 0
  buffer_load_dwordx4 v4, s[36:39], s73 offen lds
  s_add_u32 m0, s3, 1024
  s_nop 0
  buffer_load_dwordx4 v5, s[36:39], s73 offen lds
  s_add_u32 m0, s3, 2048
  s_nop 0
  buffer_load_dwordx4 v6, s[36:39], s73 offen lds
  s_add_u32 m0, s3, 3072
  s_nop 0
  buffer_load_dwordx4 v7, s[36:39], s73 offen lds
  s_add_u32 m0, s78, s75
  s_mov_b64 exec, s[14:15]
  buffer_load_dwordx4 v28, s[36:39], s73 offen lds
  s_mov_b64 exec, -1
  s_add_u32 s3, s75, s77
  s_add_u32 m0, s3, 0
  s_add_u32 s4, s74, 0
  buffer_load_dwordx4 v8, s[40:43], s4 offen lds
  s_add_u32 m0, s3, 1024
  s_nop 0
  buffer_load_dwordx4 v9, s[40:43], s4 offen lds
  s_add_u32 m0, s3, 8192
  s_add_u32 s4, s74, 2048
  buffer_load_dwordx4 v8, s[40:43], s4 offen lds
  s_add_u32 m0, s3, 9216
  s_nop 0
  buffer_load_dwordx4 v9, s[40:43], s4 offen lds
  s_add_u32 m0, s3, 16384
  s_add_u32 s4, s74, 4096
  buffer_load_dwordx4 v8, s[40:43], s4 offen lds
  s_add_u32 m0, s3, 17408
  s_nop 0
  buffer_load_dwordx4 v9, s[40:43], s4 offen lds
  s_and_b32 s73, s100, 15
  s_cmp_eq_u32 s73, s91
  s_cselect_b32 s74, 4, 0
  s_lshr_b64 s[100:101], s[100:101], s74
  s_and_b32 s73, s100, 15
  s_lshr_b64 s[100:101], s[100:101], 4
  s_mul_i32 s74, s73, 393216
  s_lshl_b32 s73, s73, 7
  s_add_u32 s75, s75, 43008
  s_cmp_eq_u32 s75, 129024
  s_cselect_b32 s75, 0, s75
  s_waitcnt vmcnt(11)
  s_barrier
  s_sub_u32 s79, s79, 1
  s_cmp_lg_u32 s79, 0
  s_cbranch_scc1 L_attn1_ld1
  s_add_u32 s3, s75, s76
  s_add_u32 m0, s3, 0
  s_nop 0
  buffer_load_dwordx4 v4, s[36:39], s73 offen lds
  s_add_u32 m0, s3, 1024
  s_nop 0
  buffer_load_dwordx4 v5, s[36:39], s73 offen lds
  s_add_u32 m0, s3, 2048
  s_nop 0
  buffer_load_dwordx4 v6, s[36:39], s73 offen lds
  s_add_u32 m0, s3, 3072
  s_nop 0
  buffer_load_dwordx4 v7, s[36:39], s73 offen lds
  s_add_u32 m0, s78, s75
  s_mov_b64 exec, s[14:15]
  buffer_load_dwordx4 v28, s[36:39], s73 offen lds
  s_mov_b64 exec, -1
  s_add_u32 s3, s75, s77
  s_add_u32 m0, s3, 0
  s_add_u32 s4, s74, 0
  buffer_load_dwordx4 v8, s[40:43], s4 offen lds
  s_add_u32 m0, s3, 1024
  s_nop 0
  buffer_load_dwordx4 v9, s[40:43], s4 offen lds
  s_add_u32 m0, s3, 8192
  s_add_u32 s4, s74, 2048
  buffer_load_dwordx4 v8, s[40:43], s4 offen lds
  s_add_u32 m0, s3, 9216
  s_nop 0
  buffer_load_dwordx4 v9, s[40:43], s4 offen lds
  s_add_u32 m0, s3, 16384
  s_add_u32 s4, s74, 4096
  buffer_load_dwordx4 v8, s[40:43], s4 offen lds
  s_add_u32 m0, s3, 17408
  s_nop 0
  buffer_load_dwordx4 v9, s[40:43], s4 offen lds
  s_and_b32 s73, s100, 15
  s_cmp_eq_u32 s73, s91
  s_cselect_b32 s74, 4, 0
  s_lshr_b64 s[100:101], s[100:101], s74
  s_and_b32 s73, s100, 15
  s_lshr_b64 s[100:101], s[100:101], 4
  s_mul_i32 s74, s73, 393216
  s_lshl_b32 s73, s73, 7
  s_add_u32 s75, s75, 43008
  s_cmp_eq_u32 s75, 129024
  s_cselect_b32 s75, 0, s75
  s_mov_b32 s60, s20
  s_and_b32 s61, s21, 0xffff
  s_mov_b32 s62, 2097152
  s_mov_b32 s63, 0x00020000
  s_and_b32 s3, s70, 3
  s_mul_i32 s3, s3, 8
  s_mul_i32 s4, s99, 32
  s_add_u32 s3, s3, s4
  v_lshrrev_b32 v2, 3, v1
  v_add_u32 v2, s3, v2
  v_mul_u32_u24 v2, 2048, v2
  v_and_b32 v3, 7, v1
  v_lshl_add_u32 v2, v3, 8, v2
  s_and_b32 s3, s2, 7
  s_lshr_b32 s3, s3, 2
  s_mul_i32 s3, s3, 128
  buffer_load_dword v96, v2, s[60:63], s3 offen
  s_waitcnt vmcnt(12)
  s_barrier
  buffer_load_dwordx4 v[32:35], v18, s[56:59], 0 offen
  s_mov_b32 s3, 65536
  buffer_load_dwordx4 v[36:39], v18, s[56:59], s3 offen
  s_mov_b32 s3, 131072
  buffer_load_dwordx4 v[40:43], v18, s[56:59], s3 offen
  s_mov_b32 s3, 196608
  buffer_load_dwordx4 v[44:47], v18, s[56:59], s3 offen
  buffer_load_dwordx2 v[48:49], v19, s[56:59], 0 offen
  s_waitcnt vmcnt(6)
  s_barrier
  s_waitcnt vmcnt(0)
  v_pk_add_f32 v[32:33], v[32:33], v[36:37]
  v_pk_add_f32 v[34:35], v[34:35], v[38:39]
  v_pk_add_f32 v[40:41], v[40:41], v[44:45]
  v_pk_add_f32 v[42:43], v[42:43], v[46:47]
  v_pk_add_f32 v[32:33], v[32:33], v[40:41]
  v_pk_add_f32 v[34:35], v[34:35], v[42:43]
  s_nop 1
  v_permlane32_swap_b32 v32, v34
  v_permlane32_swap_b32 v33, v35
  v_pk_add_f32 v[32:33], v[32:33], v[34:35]
  v_mov_b32 v34, v32
  v_mov_b32 v35, v33
  s_nop 0
  v_permlane16_swap_b32 v32, v34
  v_permlane16_swap_b32 v33, v35
  v_pk_add_f32 v[32:33], v[32:33], v[34:35]
  v_mul_f32 v32, 0x3a800000, v32
  v_mul_f32 v33, 0x3a800000, v33
  v_fma_f32 v33, -v32, v32, v33
  v_max_f32 v33, 0, v33
  v_add_f32 v33, 0x3727c5ac, v33
  v_rsq_f32 v33, v33
  s_nop 0
  s_and_b32 s3, s70, 3
  s_lshl_b32 s5, s3, 7
  s_add_u32 s5, s5, 129088
  v_and_b32 v3, 15, v1
  v_lshrrev_b32 v2, 5, v1
  v_lshl_add_u32 v2, v3, 1, v2
  v_lshl_add_u32 v2, v2, 2, s5
  ds_write2_b32 v2, v32, v33 offset0:0 offset1:160
  v_mov_b32 v50, v48
  v_mov_b32 v51, v49
  s_nop 0
  v_permlane32_swap_b32 v48, v50
  v_permlane32_swap_b32 v49, v51
  v_pk_add_f32 v[48:49], v[48:49], v[50:51]
  v_mov_b32 v50, v48
  v_mov_b32 v51, v49
  s_nop 0
  v_permlane16_swap_b32 v48, v50
  v_permlane16_swap_b32 v49, v51
  v_pk_add_f32 v[48:49], v[48:49], v[50:51]
  s_nop 1
  v_add_f32_dpp v48, v48, v48 row_ror:8 row_mask:0xf bank_mask:0xf
  v_add_f32_dpp v49, v49, v49 row_ror:8 row_mask:0xf bank_mask:0xf
  s_nop 1
  v_add_f32_dpp v48, v48, v48 row_ror:4 row_mask:0xf bank_mask:0xf
  v_add_f32_dpp v49, v49, v49 row_ror:4 row_mask:0xf bank_mask:0xf
  v_mul_f32 v48, 0x3a800000, v48
  v_mul_f32 v49, 0x3a800000, v49
  v_fma_f32 v49, -v48, v48, v49
  v_max_f32 v49, 0, v49
  v_add_f32 v49, 0x3727c5ac, v49
  v_rsq_f32 v49, v49
  s_nop 0
  s_lshl_b32 s5, s3, 4
  s_add_u32 s5, s5, 129024
  v_and_b32 v3, 3, v1
  v_lshl_add_u32 v2, v3, 2, s5
  ds_write2_b32 v2, v48, v49 offset0:0 offset1:160
  s_waitcnt lgkmcnt(0)
  s_barrier
  s_barrier
L_attn_ldend:
  s_lshl_b32 s87, s97, 15
  s_lshl_b32 s4, s68, 11
  s_add_u32 s87, s87, s4
  s_lshl_b32 s4, s69, 2
  s_add_u32 s87, s87, s4
  s_add_u32 s97, s97, 1
  s_branch L_wo_body
L_attn_end:
  s_endpgm
.fill 1021, 4, 0xbf800000
L_attn_compute:
  s_cmp_lg_u32 s96, 0
  s_cbranch_scc1 L_pfc1_skip
  s_getpc_b64 s[4:5]
L_pfc1:
  s_lshl_b32 s3, s99, 2
  s_add_u32 s3, s3, s70
  s_mul_i32 s3, s3, 320
  s_min_u32 s3, s3, L_w2_c1-L_attn_c0-320
  s_add_i32 s3, s3, L_attn_c0-L_pfc1
  s_ashr_i32 s6, s3, 31
  s_add_u32 s4, s4, s3
  s_addc_u32 s5, s5, s6
  s_load_dword s40, s[4:5], 0
  s_load_dword s40, s[4:5], 64
  s_load_dword s40, s[4:5], 128
  s_load_dword s40, s[4:5], 192
  s_load_dword s40, s[4:5], 256
L_pfc1_skip:
  s_and_b32 s71, s70, 1
  s_lshr_b32 s72, s70, 1
  v_and_b32 v3, 31, v1
  v_lshlrev_b32 v3, 2, v3
  v_add_u32 v3, 40960, v3
  v_mov_b32 v236, 0x3f803f80
  v_mov_b32 v237, 0x3f803f80
  v_mov_b32 v238, 0x3f803f80
  v_mov_b32 v239, 0x3f803f80
  ds_write_b32 v3, v236
  ds_write_b32 v3, v236 offset:43008
  v_add_u32 v3, 86016, v3
  ds_write_b32 v3, v236
  ds_write_b32 v3, v236 offset:3328
  v_and_b32 v3, 15, v1
  v_lshrrev_b32 v2, 4, v1
  v_lshrrev_b32 v33, 1, v3
  s_lshl_b32 s8, s71, 13
  v_xor_b32 v4, v2, v33
  v_lshlrev_b32 v4, 4, v4
  v_lshl_add_u32 v4, v3, 7, v4
  v_add_u32 v8, 40960, v4
  v_add_u32 v4, s8, v4
  v_add_u32 v5, 4, v2
  v_xor_b32 v5, v5, v33
  v_lshlrev_b32 v5, 4, v5
  v_lshl_add_u32 v5, v3, 7, v5
  v_add_u32 v9, 40960, v5
  v_add_u32 v5, s8, v5
  v_bfe_u32 v34, v1, 2, 2
  v_lshl_add_u32 v34, v2, 3, v34
  v_lshlrev_b32 v34, 7, v34
  v_and_b32 v33, 3, v1
  v_lshl_add_u32 v34, v33, 3, v34
  v_bfe_u32 v33, v1, 3, 2
  v_lshl_add_u32 v34, v33, 5, v34
  s_lshl_b32 s8, s70, 5
  v_xor_b32 v34, s8, v34
  v_add_u32 v6, 16384, v34
  v_xor_b32 v7, 32, v6
  s_mov_b32 s75, 0
  v_add_u32_e64 v10, s75, v4
  v_add_u32_e64 v11, s75, v5
  v_add_u32_e64 v12, s75, v6
  v_add_u32_e64 v13, s75, v7
  v_add_u32_e64 v14, s75, v8
  v_add_u32_e64 v15, s75, v9
  s_add_u32 s75, s75, 43008
  s_cmp_eq_u32 s75, 129024
  s_cselect_b32 s75, 0, s75
  s_and_b32 s79, s69, 3
  s_add_u32 s79, s79, 1
  s_mul_i32 s98, s96, 3
  s_cmp_eq_u32 s96, 0
  s_cbranch_scc1 L_attn_nog
  s_mov_b32 s79, 15
  ds_read_b128 v[32:35], v10 offset:0
  ds_read_b128 v[36:39], v10 offset:2048
  ds_read_b128 v[40:43], v10 offset:4096
  ds_read_b128 v[44:47], v10 offset:6144
  ds_read_b64_tr_b16 v[52:53], v12 offset:0
  ds_read_b64_tr_b16 v[54:55], v12 offset:512
  ds_read_b64_tr_b16 v[56:57], v13 offset:0
  ds_read_b64_tr_b16 v[58:59], v13 offset:512
  ds_read_b64_tr_b16 v[60:61], v12 offset:8192
  ds_read_b64_tr_b16 v[62:63], v12 offset:8704
  ds_read_b64_tr_b16 v[64:65], v13 offset:8192
  ds_read_b64_tr_b16 v[66:67], v13 offset:8704
  ds_read_b64_tr_b16 v[68:69], v12 offset:16384
  ds_read_b64_tr_b16 v[70:71], v12 offset:16896
  ds_read_b64_tr_b16 v[72:73], v13 offset:16384
  ds_read_b64_tr_b16 v[74:75], v13 offset:16896
  s_waitcnt lgkmcnt(0)
  v_mfma_f32_16x16x32_bf16 v[128:131], v[52:55], v[32:35], 0
  ds_read_b128 v[76:79], v11 offset:0
  v_mfma_f32_16x16x32_bf16 v[132:135], v[52:55], v[36:39], 0
  ds_read_b128 v[80:83], v11 offset:2048
  v_mfma_f32_16x16x32_bf16 v[136:139], v[52:55], v[40:43], 0
  ds_read_b128 v[84:87], v11 offset:4096
  v_mfma_f32_16x16x32_bf16 v[140:143], v[52:55], v[44:47], 0
  ds_read_b128 v[88:91], v11 offset:6144
  v_mfma_f32_16x16x32_bf16 v[156:159], v[56:59], v[44:47], 0
  ds_read_b64_tr_b16 v[96:97], v12 offset:4096
  v_mfma_f32_16x16x32_bf16 v[152:155], v[56:59], v[40:43], 0
  ds_read_b64_tr_b16 v[98:99], v12 offset:4608
  v_mfma_f32_16x16x32_bf16 v[148:151], v[56:59], v[36:39], 0
  ds_read_b64_tr_b16 v[100:101], v13 offset:4096
  v_mfma_f32_16x16x32_bf16 v[144:147], v[56:59], v[32:35], 0
  ds_read_b64_tr_b16 v[102:103], v13 offset:4608
  v_mfma_f32_16x16x32_bf16 v[160:163], v[60:63], v[32:35], 0
  ds_read_b64_tr_b16 v[104:105], v12 offset:12288
  v_mfma_f32_16x16x32_bf16 v[164:167], v[60:63], v[36:39], 0
  ds_read_b64_tr_b16 v[106:107], v12 offset:12800
  v_mfma_f32_16x16x32_bf16 v[168:171], v[60:63], v[40:43], 0
  ds_read_b64_tr_b16 v[108:109], v13 offset:12288
  v_mfma_f32_16x16x32_bf16 v[172:175], v[60:63], v[44:47], 0
  ds_read_b64_tr_b16 v[110:111], v13 offset:12800
  v_mfma_f32_16x16x32_bf16 v[188:191], v[64:67], v[44:47], 0
  ds_read_b64_tr_b16 v[112:113], v12 offset:20480
  v_mfma_f32_16x16x32_bf16 v[184:187], v[64:67], v[40:43], 0
  ds_read_b64_tr_b16 v[114:115], v12 offset:20992
  v_mfma_f32_16x16x32_bf16 v[180:183], v[64:67], v[36:39], 0
  ds_read_b64_tr_b16 v[116:117], v13 offset:20480
  v_mfma_f32_16x16x32_bf16 v[176:179], v[64:67], v[32:35], 0
  ds_read_b64_tr_b16 v[118:119], v13 offset:20992
  v_mfma_f32_16x16x32_bf16 v[192:195], v[32:35], v[68:71], 0
  v_add_u32_e64 v10, s75, v4
  v_mfma_f32_16x16x32_bf16 v[196:199], v[36:39], v[68:71], 0
  v_add_u32_e64 v11, s75, v5
  v_mfma_f32_16x16x32_bf16 v[200:203], v[40:43], v[68:71], 0
  v_add_u32_e64 v12, s75, v6
  v_mfma_f32_16x16x32_bf16 v[204:207], v[44:47], v[68:71], 0
  v_add_u32_e64 v13, s75, v7
  v_mfma_f32_16x16x32_bf16 v[220:223], v[44:47], v[72:75], 0
  v_add_u32_e64 v14, s75, v8
  v_mfma_f32_16x16x32_bf16 v[216:219], v[40:43], v[72:75], 0
  v_add_u32_e64 v15, s75, v9
  v_mfma_f32_16x16x32_bf16 v[212:215], v[36:39], v[72:75], 0
  s_add_u32 s75, s75, 43008
  v_mfma_f32_16x16x32_bf16 v[208:211], v[32:35], v[72:75], 0
  s_cmp_eq_u32 s75, 129024
  s_cselect_b32 s75, 0, s75
  s_waitcnt lgkmcnt(0)
  v_mfma_f32_16x16x32_bf16 v[128:131], v[96:99], v[76:79], v[128:131]
  v_mfma_f32_16x16x32_bf16 v[132:135], v[96:99], v[80:83], v[132:135]
  v_mfma_f32_16x16x32_bf16 v[136:139], v[96:99], v[84:87], v[136:139]
  v_mfma_f32_16x16x32_bf16 v[140:143], v[96:99], v[88:91], v[140:143]
  v_mfma_f32_16x16x32_bf16 v[156:159], v[100:103], v[88:91], v[156:159]
  v_mfma_f32_16x16x32_bf16 v[152:155], v[100:103], v[84:87], v[152:155]
  v_mfma_f32_16x16x32_bf16 v[148:151], v[100:103], v[80:83], v[148:151]
  v_mfma_f32_16x16x32_bf16 v[144:147], v[100:103], v[76:79], v[144:147]
  v_mfma_f32_16x16x32_bf16 v[160:163], v[104:107], v[76:79], v[160:163]
  v_mfma_f32_16x16x32_bf16 v[164:167], v[104:107], v[80:83], v[164:167]
  v_mfma_f32_16x16x32_bf16 v[168:171], v[104:107], v[84:87], v[168:171]
  v_mfma_f32_16x16x32_bf16 v[172:175], v[104:107], v[88:91], v[172:175]
  v_mfma_f32_16x16x32_bf16 v[188:191], v[108:111], v[88:91], v[188:191]
  v_mfma_f32_16x16x32_bf16 v[184:187], v[108:111], v[84:87], v[184:187]
  v_mfma_f32_16x16x32_bf16 v[180:183], v[108:111], v[80:83], v[180:183]
  v_mfma_f32_16x16x32_bf16 v[176:179], v[108:111], v[76:79], v[176:179]
  v_mfma_f32_16x16x32_bf16 v[192:195], v[76:79], v[112:115], v[192:195]
  v_mfma_f32_16x16x32_bf16 v[196:199], v[80:83], v[112:115], v[196:199]
  v_mfma_f32_16x16x32_bf16 v[200:203], v[84:87], v[112:115], v[200:203]
  v_mfma_f32_16x16x32_bf16 v[204:207], v[88:91], v[112:115], v[204:207]
  v_mfma_f32_16x16x32_bf16 v[220:223], v[88:91], v[116:119], v[220:223]
  v_mfma_f32_16x16x32_bf16 v[216:219], v[84:87], v[116:119], v[216:219]
  v_mfma_f32_16x16x32_bf16 v[212:215], v[80:83], v[116:119], v[212:215]
  v_mfma_f32_16x16x32_bf16 v[208:211], v[76:79], v[116:119], v[208:211]
  s_barrier
  v_mov_b32 v76, v52
  v_mov_b32 v77, v53
  v_mov_b32 v78, v54
  v_mov_b32 v79, v55
  v_mov_b32 v80, v60
  v_mov_b32 v81, v61
  v_mov_b32 v82, v62
  v_mov_b32 v83, v63
  v_mov_b32 v84, v68
  v_mov_b32 v85, v69
  v_mov_b32 v86, v70
  v_mov_b32 v87, v71
L_attn_nog:
  v_and_b32 v35, 1, v2
  v_xor_b32 v35, s71, v35
  s_lshl_b32 s8, s68, 7
  s_lshl_b32 s9, s71, 6
  s_add_u32 s8, s8, s9
  s_add_u32 s10, s8, s69
  s_lshl_b32 s10, s10, 11
  s_lshl_b32 s11, s72, 10
  s_add_u32 s10, s10, s11
  v_lshl_add_u32 v31, v1, 4, s10
  s_mul_i32 s10, s72, 14336
  s_add_u32 s10, s10, 1024
  s_lshl_b32 s11, s71, 10
  s_add_u32 s4, s10, s11
  s_sub_u32 s5, s10, s11
  s_mul_i32 s6, s71, 6144
  v_lshl_add_u32 v16, v1, 4, s4
  v_add_u32 v17, s6, v16
  v_lshl_add_u32 v18, v1, 4, s5
  v_add_u32 v18, s6, v18
  v_lshl_add_u32 v19, v2, 8, s4
  v_lshl_add_u32 v20, v2, 8, s5
  v_lshl_add_u32 v21, v3, 4, s4
  v_lshl_add_u32 v22, v3, 4, s5
  s_lshl_b32 s10, s71, 8
  s_add_u32 s10, s10, 129024
  v_lshl_add_u32 v23, v3, 2, s10
  v_lshl_add_u32 v24, v2, 4, s10
  v_and_b32 v33, 1, v3
  v_cmp_eq_u32 s[48:49], 1, v33
  v_lshl_add_u32 v34, v2, 2, v33
  v_add_u32 v35, 2, v34
  v_cmp_gt_u32 s[50:51], v34, v3
  v_cmp_gt_u32 s[52:53], v35, v3
  v_mov_b32 v36, 0xffff
  v_mov_b32 v37, 0xffff0000
  v_cndmask_b32 v36, v36, v37, s[48:49]
  s_add_u32 s10, s10, 704
  v_lshl_add_u32 v34, v34, 2, s10
  v_lshl_add_u32 v35, v35, 2, s10
  v_subrev_u32 v38, 64, v34
  v_subrev_u32 v39, 64, v35
  v_cndmask_b32 v25, v34, v38, s[50:51]
  v_cndmask_b32 v26, v35, v39, s[52:53]
  v_cndmask_b32 v27, 0, v36, s[50:51]
  v_cndmask_b32 v29, 0, v36, s[52:53]
  v_xor_b32 v28, v27, v36
  v_xor_b32 v30, v29, v36
  s_cmp_eq_u32 s8, 0
  s_cselect_b64 s[54:55], s[50:51], 0
  s_cselect_b64 s[14:15], s[52:53], 0
  s_cmp_lg_u32 s96, 0
  s_cbranch_scc1 L_attn_nozero
  v_mov_b32 v122, 0
  v_mov_b32 v123, 0
  v_mov_b32 v124, 0
  v_mov_b32 v125, 0
  v_mov_b32 v126, 0
  v_mov_b32 v127, 0
  v_mov_b32 v128, 0
  v_mov_b32 v129, 0
  v_mov_b32 v130, 0
  v_mov_b32 v131, 0
  v_mov_b32 v132, 0
  v_mov_b32 v133, 0
  v_mov_b32 v134, 0
  v_mov_b32 v135, 0
  v_mov_b32 v136, 0
  v_mov_b32 v137, 0
  v_mov_b32 v138, 0
  v_mov_b32 v139, 0
  v_mov_b32 v140, 0
  v_mov_b32 v141, 0
  v_mov_b32 v142, 0
  v_mov_b32 v143, 0
  v_mov_b32 v144, 0
  v_mov_b32 v145, 0
  v_mov_b32 v146, 0
  v_mov_b32 v147, 0
  v_mov_b32 v148, 0
  v_mov_b32 v149, 0
  v_mov_b32 v150, 0
  v_mov_b32 v151, 0
  v_mov_b32 v152, 0
  v_mov_b32 v153, 0
  v_mov_b32 v154, 0
  v_mov_b32 v155, 0
  v_mov_b32 v156, 0
  v_mov_b32 v157, 0
  v_mov_b32 v158, 0
  v_mov_b32 v159, 0
  v_mov_b32 v160, 0
  v_mov_b32 v161, 0
  v_mov_b32 v162, 0
  v_mov_b32 v163, 0
  v_mov_b32 v164, 0
  v_mov_b32 v165, 0
  v_mov_b32 v166, 0
  v_mov_b32 v167, 0
  v_mov_b32 v168, 0
  v_mov_b32 v169, 0
  v_mov_b32 v170, 0
  v_mov_b32 v171, 0
  v_mov_b32 v172, 0
  v_mov_b32 v173, 0
  v_mov_b32 v174, 0
  v_mov_b32 v175, 0
  v_mov_b32 v176, 0
  v_mov_b32 v177, 0
  v_mov_b32 v178, 0
  v_mov_b32 v179, 0
  v_mov_b32 v180, 0
  v_mov_b32 v181, 0
  v_mov_b32 v182, 0
  v_mov_b32 v183, 0
  v_mov_b32 v184, 0
  v_mov_b32 v185, 0
  v_mov_b32 v186, 0
  v_mov_b32 v187, 0
  v_mov_b32 v188, 0
  v_mov_b32 v189, 0
  v_mov_b32 v190, 0
  v_mov_b32 v191, 0
  v_mov_b32 v192, 0
  v_mov_b32 v193, 0
  v_mov_b32 v194, 0
  v_mov_b32 v195, 0
  v_mov_b32 v196, 0
  v_mov_b32 v197, 0
  v_mov_b32 v198, 0
  v_mov_b32 v199, 0
  v_mov_b32 v200, 0
  v_mov_b32 v201, 0
  v_mov_b32 v202, 0
  v_mov_b32 v203, 0
  v_mov_b32 v204, 0
  v_mov_b32 v205, 0
  v_mov_b32 v206, 0
  v_mov_b32 v207, 0
  v_mov_b32 v208, 0
  v_mov_b32 v209, 0
  v_mov_b32 v210, 0
  v_mov_b32 v211, 0
  v_mov_b32 v212, 0
  v_mov_b32 v213, 0
  v_mov_b32 v214, 0
  v_mov_b32 v215, 0
  v_mov_b32 v216, 0
  v_mov_b32 v217, 0
  v_mov_b32 v218, 0
  v_mov_b32 v219, 0
  v_mov_b32 v220, 0
  v_mov_b32 v221, 0
  v_mov_b32 v222, 0
  v_mov_b32 v223, 0
  v_mov_b32 v224, 0
  v_mov_b32 v225, 0
  v_mov_b32 v226, 0
  v_mov_b32 v227, 0
  v_mov_b32 v228, 0
  v_mov_b32 v229, 0
  v_mov_b32 v230, 0
  v_mov_b32 v231, 0
  v_mov_b32 v232, 0
  v_mov_b32 v233, 0
  v_mov_b32 v234, 0
  v_mov_b32 v235, 0
  s_waitcnt lgkmcnt(0)
  s_lshl_b32 s3, s72, 5
  s_add_u32 s3, s3, s8
  s_lshl_b32 s4, s69, 14
  s_lshl3_add_u32 s3, s3, s4
  v_lshrrev_b32 v121, 1, v2
  v_lshl_add_u32 v121, v121, 4, v3
  v_and_b32 v120, 1, v2
  v_lshl_add_u32 v121, v121, 1, v120
  v_lshl_add_u32 v120, v121, 2, s3
  s_add_u32 s56, s22, 24903680
  s_addc_u32 s57, s23, 0
  s_and_b32 s57, s57, 0xffff
  s_mov_b32 s58, 262144
  s_mov_b32 s59, 0x00020000
  s_add_u32 s60, s22, 41943040
  s_addc_u32 s61, s23, 0
  s_and_b32 s61, s61, 0xffff
  s_mov_b32 s62, 524288
  s_mov_b32 s63, 0x00020000
  s_lshl_b32 s3, s2, 11
  s_cmp_lg_u32 s70, 0
  s_cbranch_scc1 L_attn_noclr
  s_lshl_b32 s5, s68, 10
  s_add_u32 s4, s4, s5
  v_lshlrev_b32 v121, 4, v1
  v_mov_b32 v40, -1
  v_mov_b32 v41, -1
  v_mov_b32 v42, -1
  v_mov_b32 v43, -1
  buffer_store_dwordx4 v[40:43], v121, s[56:59], s4 offen sc1
  buffer_store_dwordx4 v[128:131], v121, s[60:63], s3 offen offset:0 sc1
  buffer_store_dwordx4 v[128:131], v121, s[60:63], s3 offen offset:1024 sc1
  v_mov_b32 v126, 1
L_attn_noclr:
  s_and_b32 s65, s65, 0xffff
  s_mov_b32 s66, 256
  s_mov_b32 s67, 0x00020000
  s_mov_b32 s7, 0x3f803f80
L_attn_nozero:
  s_waitcnt lgkmcnt(0)
  s_mov_b32 s44, s34
  s_and_b32 s45, s35, 0xffff
  s_mov_b32 s46, 4194304
  s_mov_b32 s47, 0x00020000
  s_cmp_eq_u32 s96, 0
  s_barrier
  s_cbranch_scc1 L_attn_first
  ds_read_b128 v[88:91], v14 offset:46336
  ds_read_b128 v[92:95], v15 offset:46336
  ds_read_b128 v[32:35], v10 offset:0
  ds_read_b128 v[36:39], v10 offset:2048
  ds_read_b128 v[40:43], v10 offset:4096
  ds_read_b128 v[44:47], v10 offset:6144
  ds_read_b128 v[48:51], v14
  ds_read_b64_tr_b16 v[52:53], v12 offset:0
  ds_read_b64_tr_b16 v[54:55], v12 offset:512
  ds_read_b64_tr_b16 v[56:57], v13 offset:0
  ds_read_b64_tr_b16 v[58:59], v13 offset:512
  ds_read_b64_tr_b16 v[60:61], v12 offset:8192
  ds_read_b64_tr_b16 v[62:63], v12 offset:8704
  ds_read_b64_tr_b16 v[64:65], v13 offset:8192
  ds_read_b64_tr_b16 v[66:67], v13 offset:8704
  ds_read_b64_tr_b16 v[68:69], v12 offset:16384
  ds_read_b64_tr_b16 v[70:71], v12 offset:16896
  ds_read_b64_tr_b16 v[72:73], v13 offset:16384
  ds_read_b64_tr_b16 v[74:75], v13 offset:16896
  s_waitcnt lgkmcnt(15)
  v_mfma_f32_16x16x32_bf16 v[224:227], v[76:79], v[88:91], 0
  v_mfma_f32_16x16x32_bf16 v[228:231], v[80:83], v[88:91], 0
  v_mfma_f32_16x16x32_bf16 v[232:235], v[88:91], v[84:87], 0
  v_mfma_f32_16x16x32_bf16 v[224:227], v[96:99], v[92:95], v[224:227]
  v_mfma_f32_16x16x32_bf16 v[228:231], v[104:107], v[92:95], v[228:231]
  v_mfma_f32_16x16x32_bf16 v[232:235], v[92:95], v[112:115], v[232:235]
  s_waitcnt lgkmcnt(0)
  s_branch L_attn_loop
L_attn_first:
  ds_read_b128 v[32:35], v10 offset:0
  ds_read_b128 v[36:39], v10 offset:2048
  ds_read_b128 v[40:43], v10 offset:4096
  ds_read_b128 v[44:47], v10 offset:6144
  ds_read_b128 v[48:51], v14
  ds_read_b64_tr_b16 v[52:53], v12 offset:0
  ds_read_b64_tr_b16 v[54:55], v12 offset:512
  ds_read_b64_tr_b16 v[56:57], v13 offset:0
  ds_read_b64_tr_b16 v[58:59], v13 offset:512
  ds_read_b64_tr_b16 v[60:61], v12 offset:8192
  ds_read_b64_tr_b16 v[62:63], v12 offset:8704
  ds_read_b64_tr_b16 v[64:65], v13 offset:8192
  ds_read_b64_tr_b16 v[66:67], v13 offset:8704
  ds_read_b64_tr_b16 v[68:69], v12 offset:16384
  ds_read_b64_tr_b16 v[70:71], v12 offset:16896
  ds_read_b64_tr_b16 v[72:73], v13 offset:16384
  ds_read_b64_tr_b16 v[74:75], v13 offset:16896
.p2align 5
  s_nop 0
  s_nop 0
  s_nop 0
  s_waitcnt lgkmcnt(0)
L_attn_loop:
  v_mfma_f32_16x16x32_bf16 v[128:131], v[52:55], v[32:35], v[128:131]
  ds_read_b128 v[76:79], v11 offset:0
  v_mfma_f32_16x16x32_bf16 v[132:135], v[52:55], v[36:39], v[132:135]
  ds_read_b128 v[80:83], v11 offset:2048
  v_mfma_f32_16x16x32_bf16 v[136:139], v[52:55], v[40:43], v[136:139]
  ds_read_b128 v[84:87], v11 offset:4096
  v_mfma_f32_16x16x32_bf16 v[140:143], v[52:55], v[44:47], v[140:143]
  ds_read_b128 v[88:91], v11 offset:6144
  v_mfma_f32_16x16x32_bf16 v[224:227], v[52:55], v[48:51], v[224:227]
  ds_read_b128 v[92:95], v15
  v_mfma_f32_16x16x32_bf16 v[156:159], v[56:59], v[44:47], v[156:159]
  ds_read_b64_tr_b16 v[96:97], v12 offset:4096
  v_mfma_f32_16x16x32_bf16 v[152:155], v[56:59], v[40:43], v[152:155]
  ds_read_b64_tr_b16 v[98:99], v12 offset:4608
  v_mfma_f32_16x16x32_bf16 v[148:151], v[56:59], v[36:39], v[148:151]
  ds_read_b64_tr_b16 v[100:101], v13 offset:4096
  v_mfma_f32_16x16x32_bf16 v[144:147], v[56:59], v[32:35], v[144:147]
  ds_read_b64_tr_b16 v[102:103], v13 offset:4608
  v_mfma_f32_16x16x32_bf16 v[160:163], v[60:63], v[32:35], v[160:163]
  ds_read_b64_tr_b16 v[104:105], v12 offset:12288
  v_mfma_f32_16x16x32_bf16 v[164:167], v[60:63], v[36:39], v[164:167]
  ds_read_b64_tr_b16 v[106:107], v12 offset:12800
  v_mfma_f32_16x16x32_bf16 v[168:171], v[60:63], v[40:43], v[168:171]
  ds_read_b64_tr_b16 v[108:109], v13 offset:12288
  v_mfma_f32_16x16x32_bf16 v[172:175], v[60:63], v[44:47], v[172:175]
  ds_read_b64_tr_b16 v[110:111], v13 offset:12800
  v_mfma_f32_16x16x32_bf16 v[228:231], v[60:63], v[48:51], v[228:231]
  ds_read_b64_tr_b16 v[112:113], v12 offset:20480
  v_mfma_f32_16x16x32_bf16 v[188:191], v[64:67], v[44:47], v[188:191]
  ds_read_b64_tr_b16 v[114:115], v12 offset:20992
  v_mfma_f32_16x16x32_bf16 v[184:187], v[64:67], v[40:43], v[184:187]
  ds_read_b64_tr_b16 v[116:117], v13 offset:20480
  v_mfma_f32_16x16x32_bf16 v[180:183], v[64:67], v[36:39], v[180:183]
  ds_read_b64_tr_b16 v[118:119], v13 offset:20992
  v_mfma_f32_16x16x32_bf16 v[176:179], v[64:67], v[32:35], v[176:179]
  v_add_u32_e64 v10, s75, v4
  v_mfma_f32_16x16x32_bf16 v[192:195], v[32:35], v[68:71], v[192:195]
  v_add_u32_e64 v11, s75, v5
  v_mfma_f32_16x16x32_bf16 v[196:199], v[36:39], v[68:71], v[196:199]
  v_add_u32_e64 v12, s75, v6
  v_mfma_f32_16x16x32_bf16 v[200:203], v[40:43], v[68:71], v[200:203]
  v_add_u32_e64 v13, s75, v7
  v_mfma_f32_16x16x32_bf16 v[204:207], v[44:47], v[68:71], v[204:207]
  v_add_u32_e64 v14, s75, v8
  v_mfma_f32_16x16x32_bf16 v[232:235], v[48:51], v[68:71], v[232:235]
  v_add_u32_e64 v15, s75, v9
  v_mfma_f32_16x16x32_bf16 v[220:223], v[44:47], v[72:75], v[220:223]
  s_add_u32 s75, s75, 43008
  v_mfma_f32_16x16x32_bf16 v[216:219], v[40:43], v[72:75], v[216:219]
  s_cmp_eq_u32 s75, 129024
  v_mfma_f32_16x16x32_bf16 v[212:215], v[36:39], v[72:75], v[212:215]
  s_cselect_b32 s75, 0, s75
  s_sub_u32 s79, s79, 1
  v_mfma_f32_16x16x32_bf16 v[208:211], v[32:35], v[72:75], v[208:211]
  s_waitcnt lgkmcnt(0)
  s_barrier
  v_mfma_f32_16x16x32_bf16 v[128:131], v[96:99], v[76:79], v[128:131]
  ds_read_b128 v[32:35], v10 offset:0
  v_mfma_f32_16x16x32_bf16 v[132:135], v[96:99], v[80:83], v[132:135]
  ds_read_b128 v[36:39], v10 offset:2048
  v_mfma_f32_16x16x32_bf16 v[136:139], v[96:99], v[84:87], v[136:139]
  ds_read_b128 v[40:43], v10 offset:4096
  v_mfma_f32_16x16x32_bf16 v[140:143], v[96:99], v[88:91], v[140:143]
  ds_read_b128 v[44:47], v10 offset:6144
  v_mfma_f32_16x16x32_bf16 v[224:227], v[96:99], v[92:95], v[224:227]
  ds_read_b128 v[48:51], v14
  v_mfma_f32_16x16x32_bf16 v[156:159], v[100:103], v[88:91], v[156:159]
  ds_read_b64_tr_b16 v[52:53], v12 offset:0
  v_mfma_f32_16x16x32_bf16 v[152:155], v[100:103], v[84:87], v[152:155]
  ds_read_b64_tr_b16 v[54:55], v12 offset:512
  v_mfma_f32_16x16x32_bf16 v[148:151], v[100:103], v[80:83], v[148:151]
  ds_read_b64_tr_b16 v[56:57], v13 offset:0
  v_mfma_f32_16x16x32_bf16 v[144:147], v[100:103], v[76:79], v[144:147]
  ds_read_b64_tr_b16 v[58:59], v13 offset:512
  v_mfma_f32_16x16x32_bf16 v[160:163], v[104:107], v[76:79], v[160:163]
  ds_read_b64_tr_b16 v[60:61], v12 offset:8192
  v_mfma_f32_16x16x32_bf16 v[164:167], v[104:107], v[80:83], v[164:167]
  ds_read_b64_tr_b16 v[62:63], v12 offset:8704
  v_mfma_f32_16x16x32_bf16 v[168:171], v[104:107], v[84:87], v[168:171]
  ds_read_b64_tr_b16 v[64:65], v13 offset:8192
  v_mfma_f32_16x16x32_bf16 v[172:175], v[104:107], v[88:91], v[172:175]
  ds_read_b64_tr_b16 v[66:67], v13 offset:8704
  v_mfma_f32_16x16x32_bf16 v[228:231], v[104:107], v[92:95], v[228:231]
  ds_read_b64_tr_b16 v[68:69], v12 offset:16384
  v_mfma_f32_16x16x32_bf16 v[188:191], v[108:111], v[88:91], v[188:191]
  ds_read_b64_tr_b16 v[70:71], v12 offset:16896
  v_mfma_f32_16x16x32_bf16 v[184:187], v[108:111], v[84:87], v[184:187]
  ds_read_b64_tr_b16 v[72:73], v13 offset:16384
  v_mfma_f32_16x16x32_bf16 v[180:183], v[108:111], v[80:83], v[180:183]
  ds_read_b64_tr_b16 v[74:75], v13 offset:16896
  v_mfma_f32_16x16x32_bf16 v[176:179], v[108:111], v[76:79], v[176:179]
  s_cmp_lg_u32 s79, 0
  s_nop 0
  v_mfma_f32_16x16x32_bf16 v[192:195], v[76:79], v[112:115], v[192:195]
  v_mfma_f32_16x16x32_bf16 v[196:199], v[80:83], v[112:115], v[196:199]
  v_mfma_f32_16x16x32_bf16 v[200:203], v[84:87], v[112:115], v[200:203]
  v_mfma_f32_16x16x32_bf16 v[204:207], v[88:91], v[112:115], v[204:207]
  v_mfma_f32_16x16x32_bf16 v[232:235], v[92:95], v[112:115], v[232:235]
  v_mfma_f32_16x16x32_bf16 v[220:223], v[88:91], v[116:119], v[220:223]
  v_mfma_f32_16x16x32_bf16 v[216:219], v[84:87], v[116:119], v[216:219]
  v_mfma_f32_16x16x32_bf16 v[212:215], v[80:83], v[116:119], v[212:215]
  v_mfma_f32_16x16x32_bf16 v[208:211], v[76:79], v[116:119], v[208:211]
  s_waitcnt lgkmcnt(0)
  s_cbranch_scc1 L_attn_loop
L_attn_lend:
  s_add_u32 s98, s98, 1
  s_cmp_gt_u32 s98, 3
  s_cbranch_scc1 L_attn_exit
  s_cmp_lg_u32 s98, 1
  s_cbranch_scc1 L_attn_hook0
  s_mov_b32 s79, 1
  s_cmp_lg_u32 s72, 0
  s_cbranch_scc1 L_attn_dot0
  v_dot2_f32_bf16 v122, v32, s7, v122
  v_dot2_f32_bf16 v124, v32, v32, v124
  v_dot2_f32_bf16 v123, v36, s7, v123
  v_dot2_f32_bf16 v125, v36, v36, v125
  v_dot2_f32_bf16 v122, v33, s7, v122
  v_dot2_f32_bf16 v124, v33, v33, v124
  v_dot2_f32_bf16 v123, v37, s7, v123
  v_dot2_f32_bf16 v125, v37, v37, v125
  v_dot2_f32_bf16 v122, v34, s7, v122
  v_dot2_f32_bf16 v124, v34, v34, v124
  v_dot2_f32_bf16 v123, v38, s7, v123
  v_dot2_f32_bf16 v125, v38, v38, v125
  v_dot2_f32_bf16 v122, v35, s7, v122
  v_dot2_f32_bf16 v124, v35, v35, v124
  v_dot2_f32_bf16 v123, v39, s7, v123
  v_dot2_f32_bf16 v125, v39, v39, v125
  s_branch L_attn_dote0
  L_attn_dot0:
  v_dot2_f32_bf16 v122, v40, s7, v122
  v_dot2_f32_bf16 v124, v40, v40, v124
  v_dot2_f32_bf16 v123, v44, s7, v123
  v_dot2_f32_bf16 v125, v44, v44, v125
  v_dot2_f32_bf16 v122, v41, s7, v122
  v_dot2_f32_bf16 v124, v41, v41, v124
  v_dot2_f32_bf16 v123, v45, s7, v123
  v_dot2_f32_bf16 v125, v45, v45, v125
  v_dot2_f32_bf16 v122, v42, s7, v122
  v_dot2_f32_bf16 v124, v42, v42, v124
  v_dot2_f32_bf16 v123, v46, s7, v123
  v_dot2_f32_bf16 v125, v46, v46, v125
  v_dot2_f32_bf16 v122, v43, s7, v122
  v_dot2_f32_bf16 v124, v43, v43, v124
  v_dot2_f32_bf16 v123, v47, s7, v123
  v_dot2_f32_bf16 v125, v47, v47, v125
  L_attn_dote0:
  s_cmp_lg_u32 s70, 0
  s_cbranch_scc1 L_attn_loop
  s_waitcnt vmcnt(0)
  s_lshl4_add_u32 s3, s68, s69
  s_mov_b64 exec, 1
  buffer_store_byte v126, off, s[64:67], s3 sc1
  s_mov_b64 exec, -1
  s_branch L_attn_loop
L_attn_hook0:
  s_cmp_lg_u32 s98, 2
  s_cbranch_scc1 L_attn_hook1
  s_and_b32 s79, s69, 3
  s_add_u32 s79, s79, 1
  s_sub_u32 s79, 13, s79
  s_cmp_lg_u32 s72, 0
  s_cbranch_scc1 L_attn_dot1
  v_dot2_f32_bf16 v122, v76, s7, v122
  v_dot2_f32_bf16 v124, v76, v76, v124
  v_dot2_f32_bf16 v123, v80, s7, v123
  v_dot2_f32_bf16 v125, v80, v80, v125
  v_dot2_f32_bf16 v122, v77, s7, v122
  v_dot2_f32_bf16 v124, v77, v77, v124
  v_dot2_f32_bf16 v123, v81, s7, v123
  v_dot2_f32_bf16 v125, v81, v81, v125
  v_dot2_f32_bf16 v122, v78, s7, v122
  v_dot2_f32_bf16 v124, v78, v78, v124
  v_dot2_f32_bf16 v123, v82, s7, v123
  v_dot2_f32_bf16 v125, v82, v82, v125
  v_dot2_f32_bf16 v122, v79, s7, v122
  v_dot2_f32_bf16 v124, v79, v79, v124
  v_dot2_f32_bf16 v123, v83, s7, v123
  v_dot2_f32_bf16 v125, v83, v83, v125
  s_branch L_attn_dote1
  L_attn_dot1:
  v_dot2_f32_bf16 v122, v84, s7, v122
  v_dot2_f32_bf16 v124, v84, v84, v124
  v_dot2_f32_bf16 v123, v88, s7, v123
  v_dot2_f32_bf16 v125, v88, v88, v125
  v_dot2_f32_bf16 v122, v85, s7, v122
  v_dot2_f32_bf16 v124, v85, v85, v124
  v_dot2_f32_bf16 v123, v89, s7, v123
  v_dot2_f32_bf16 v125, v89, v89, v125
  v_dot2_f32_bf16 v122, v86, s7, v122
  v_dot2_f32_bf16 v124, v86, v86, v124
  v_dot2_f32_bf16 v123, v90, s7, v123
  v_dot2_f32_bf16 v125, v90, v90, v125
  v_dot2_f32_bf16 v122, v87, s7, v122
  v_dot2_f32_bf16 v124, v87, v87, v124
  v_dot2_f32_bf16 v123, v91, s7, v123
  v_dot2_f32_bf16 v125, v91, v91, v125
  L_attn_dote1:
  s_nop 2
  v_permlane32_swap_b32 v122, v123
  v_permlane32_swap_b32 v124, v125
  v_add_f32 v122, v122, v123
  v_add_f32 v124, v124, v125
  s_nop 0
  s_nop 0
  v_permlane16_swap_b32 v122, v124
  v_add_f32 v122, v122, v124
  buffer_store_dword v122, v120, s[56:59], 0 offen sc1
  s_branch L_attn_loop
L_attn_hook1:
  s_mov_b32 s79, 2
  s_mov_b32 s36, s16
  s_and_b32 s37, s17, 0xffff
  s_mov_b32 s38, 4194304
  s_mov_b32 s39, 0x00020000
  s_and_b32 s3, s2, 3
  s_and_b32 s4, s99, 3
  s_lshl2_add_u32 s3, s3, s4
  s_lshl2_add_u32 s3, s3, s70
  s_lshl_b32 s3, s3, 16
  s_bfe_u32 s4, s2, 0x10002
  s_lshr_b32 s5, s99, 2
  s_lshl1_add_u32 s4, s5, s4
  s_lshl_b32 s4, s4, 7
  s_add_u32 s3, s3, s4
  s_add_u32 s4, s3, 32768
  v_and_b32 v122, 15, v1
  v_lshlrev_b32 v123, 1, v1
  v_and_b32 v123, 32, v123
  v_lshl_add_u32 v122, v122, 11, v123
  v_lshrrev_b32 v123, 1, v1
  v_and_b32 v123, 16, v123
  v_add_u32 v122, v122, v123
  buffer_load_dwordx4 v[240:243], v122, s[36:39], s3 offen offset:0
  buffer_load_dwordx4 v[244:247], v122, s[36:39], s3 offen offset:64
  buffer_load_dwordx4 v[248:251], v122, s[36:39], s4 offen offset:0
  buffer_load_dwordx4 v[252:255], v122, s[36:39], s4 offen offset:64
  s_branch L_attn_loop
L_attn_exit:
  ds_read2_b32 v[66:67], v23 offset0:0 offset1:160
  ds_read2_b32 v[68:69], v23 offset0:16 offset1:176
  ds_read2_b32 v[70:71], v23 offset0:32 offset1:192
  ds_read2_b32 v[72:73], v23 offset0:48 offset1:208
  ds_read2_b32 v[74:75], v23 offset0:64 offset1:224
  ds_read2_b32 v[76:77], v25 offset0:0 offset1:16
  ds_read2_b32 v[80:81], v26 offset0:0 offset1:16
  ds_read2_b32 v[78:79], v25 offset0:32 offset1:48
  ds_read2_b32 v[82:83], v26 offset0:32 offset1:48
  ds_write_b128 v16, v[224:227] offset:0
  ds_write_b128 v16, v[228:231] offset:2048
  ds_write_b128 v16, v[232:235] offset:4096
  s_cmp_eq_u32 s71, 1
  s_cbranch_scc1 L_attn_nop3
  ds_write_b128 v16, v[172:175] offset:8192
  ds_write_b128 v16, v[188:191] offset:9216
  ds_write_b128 v16, v[204:207] offset:10240
  ds_write_b128 v16, v[220:223] offset:11264
L_attn_nop3:
  ds_read_b128 v[84:87], v24 offset:0
  ds_read_b128 v[104:107], v24 offset:640
  ds_read_b128 v[88:91], v24 offset:64
  ds_read_b128 v[108:111], v24 offset:704
  ds_read_b128 v[92:95], v24 offset:128
  ds_read_b128 v[112:115], v24 offset:768
  ds_read_b128 v[96:99], v24 offset:192
  ds_read_b128 v[116:119], v24 offset:832
  ds_read_b128 v[100:103], v24 offset:256
  ds_read_b128 v[120:123], v24 offset:896
  s_waitcnt lgkmcnt(10)
  s_barrier
  ds_read_b128 v[48:51], v19 offset:0
  ds_read_b128 v[52:55], v20 offset:1024
  ds_read_b128 v[56:59], v19 offset:2048
  ds_read_b128 v[60:63], v20 offset:3072
  ds_read_b32 v64, v21 offset:4096
  ds_read_b32 v65, v22 offset:5120
  ds_read_b128 v[32:35], v17 offset:2048
  ds_read_b128 v[36:39], v18 offset:3072
  ds_read_b128 v[40:43], v17 offset:4096
  ds_read_b128 v[44:47], v18 offset:5120
  v_mul_f32 v69, 0x3e8293ee, v69
  v_mul_f32 v71, 0x3e8293ee, v71
  v_mul_f32 v73, 0x3e8293ee, v73
  v_mul_f32 v75, 0x3e8293ee, v75
  v_mul_f32 v76, v76, v69
  v_mul_f32 v80, v80, v69
  v_mul_f32 v77, v77, v71
  v_mul_f32 v81, v81, v71
  v_mul_f32 v78, v78, v73
  v_mul_f32 v82, v82, v73
  v_mul_f32 v79, v79, v75
  v_mul_f32 v83, v83, v75
  s_waitcnt lgkmcnt(6)
  v_pk_fma_f32 v[128:129], v[48:49], v[68:69], v[128:129] op_sel:[0,0,0] op_sel_hi:[1,0,1] neg_lo:[0,1,0] neg_hi:[0,1,0]
  v_pk_fma_f32 v[130:131], v[50:51], v[68:69], v[130:131] op_sel:[0,0,0] op_sel_hi:[1,0,1] neg_lo:[0,1,0] neg_hi:[0,1,0]
  v_pk_fma_f32 v[144:145], v[52:53], v[68:69], v[144:145] op_sel:[0,0,0] op_sel_hi:[1,0,1] neg_lo:[0,1,0] neg_hi:[0,1,0]
  v_pk_fma_f32 v[146:147], v[54:55], v[68:69], v[146:147] op_sel:[0,0,0] op_sel_hi:[1,0,1] neg_lo:[0,1,0] neg_hi:[0,1,0]
  v_cvt_pk_bf16_f32 v128, v128, v129
  v_cvt_pk_bf16_f32 v129, v130, v131
  v_cvt_pk_bf16_f32 v130, v144, v145
  v_cvt_pk_bf16_f32 v131, v146, v147
  v_pk_fma_f32 v[160:161], v[56:57], v[68:69], v[160:161] op_sel:[0,0,0] op_sel_hi:[1,0,1] neg_lo:[0,1,0] neg_hi:[0,1,0]
  v_pk_fma_f32 v[162:163], v[58:59], v[68:69], v[162:163] op_sel:[0,0,0] op_sel_hi:[1,0,1] neg_lo:[0,1,0] neg_hi:[0,1,0]
  v_pk_fma_f32 v[176:177], v[60:61], v[68:69], v[176:177] op_sel:[0,0,0] op_sel_hi:[1,0,1] neg_lo:[0,1,0] neg_hi:[0,1,0]
  v_pk_fma_f32 v[178:179], v[62:63], v[68:69], v[178:179] op_sel:[0,0,0] op_sel_hi:[1,0,1] neg_lo:[0,1,0] neg_hi:[0,1,0]
  v_cvt_pk_bf16_f32 v160, v160, v161
  v_cvt_pk_bf16_f32 v161, v162, v163
  v_cvt_pk_bf16_f32 v162, v176, v177
  v_cvt_pk_bf16_f32 v163, v178, v179
  v_pk_fma_f32 v[132:133], v[48:49], v[70:71], v[132:133] op_sel:[0,0,0] op_sel_hi:[1,0,1] neg_lo:[0,1,0] neg_hi:[0,1,0]
  v_pk_fma_f32 v[134:135], v[50:51], v[70:71], v[134:135] op_sel:[0,0,0] op_sel_hi:[1,0,1] neg_lo:[0,1,0] neg_hi:[0,1,0]
  v_pk_fma_f32 v[148:149], v[52:53], v[70:71], v[148:149] op_sel:[0,0,0] op_sel_hi:[1,0,1] neg_lo:[0,1,0] neg_hi:[0,1,0]
  v_pk_fma_f32 v[150:151], v[54:55], v[70:71], v[150:151] op_sel:[0,0,0] op_sel_hi:[1,0,1] neg_lo:[0,1,0] neg_hi:[0,1,0]
  v_cvt_pk_bf16_f32 v132, v132, v133
  v_cvt_pk_bf16_f32 v133, v134, v135
  v_cvt_pk_bf16_f32 v134, v148, v149
  v_cvt_pk_bf16_f32 v135, v150, v151
  v_pk_fma_f32 v[164:165], v[56:57], v[70:71], v[164:165] op_sel:[0,0,0] op_sel_hi:[1,0,1] neg_lo:[0,1,0] neg_hi:[0,1,0]
  v_pk_fma_f32 v[166:167], v[58:59], v[70:71], v[166:167] op_sel:[0,0,0] op_sel_hi:[1,0,1] neg_lo:[0,1,0] neg_hi:[0,1,0]
  v_pk_fma_f32 v[180:181], v[60:61], v[70:71], v[180:181] op_sel:[0,0,0] op_sel_hi:[1,0,1] neg_lo:[0,1,0] neg_hi:[0,1,0]
  v_pk_fma_f32 v[182:183], v[62:63], v[70:71], v[182:183] op_sel:[0,0,0] op_sel_hi:[1,0,1] neg_lo:[0,1,0] neg_hi:[0,1,0]
  v_cvt_pk_bf16_f32 v164, v164, v165
  v_cvt_pk_bf16_f32 v165, v166, v167
  v_cvt_pk_bf16_f32 v166, v180, v181
  v_cvt_pk_bf16_f32 v167, v182, v183
  v_mfma_f32_16x16x32_bf16 v[144:147], v[160:163], v[128:131], 0
  v_pk_fma_f32 v[136:137], v[48:49], v[72:73], v[136:137] op_sel:[0,0,0] op_sel_hi:[1,0,1] neg_lo:[0,1,0] neg_hi:[0,1,0]
  v_pk_fma_f32 v[138:139], v[50:51], v[72:73], v[138:139] op_sel:[0,0,0] op_sel_hi:[1,0,1] neg_lo:[0,1,0] neg_hi:[0,1,0]
  v_pk_fma_f32 v[152:153], v[52:53], v[72:73], v[152:153] op_sel:[0,0,0] op_sel_hi:[1,0,1] neg_lo:[0,1,0] neg_hi:[0,1,0]
  v_pk_fma_f32 v[154:155], v[54:55], v[72:73], v[154:155] op_sel:[0,0,0] op_sel_hi:[1,0,1] neg_lo:[0,1,0] neg_hi:[0,1,0]
  v_cvt_pk_bf16_f32 v136, v136, v137
  v_cvt_pk_bf16_f32 v137, v138, v139
  v_cvt_pk_bf16_f32 v138, v152, v153
  v_cvt_pk_bf16_f32 v139, v154, v155
  v_pk_fma_f32 v[168:169], v[56:57], v[72:73], v[168:169] op_sel:[0,0,0] op_sel_hi:[1,0,1] neg_lo:[0,1,0] neg_hi:[0,1,0]
  v_pk_fma_f32 v[170:171], v[58:59], v[72:73], v[170:171] op_sel:[0,0,0] op_sel_hi:[1,0,1] neg_lo:[0,1,0] neg_hi:[0,1,0]
  v_pk_fma_f32 v[184:185], v[60:61], v[72:73], v[184:185] op_sel:[0,0,0] op_sel_hi:[1,0,1] neg_lo:[0,1,0] neg_hi:[0,1,0]
  v_pk_fma_f32 v[186:187], v[62:63], v[72:73], v[186:187] op_sel:[0,0,0] op_sel_hi:[1,0,1] neg_lo:[0,1,0] neg_hi:[0,1,0]
  v_cvt_pk_bf16_f32 v168, v168, v169
  v_cvt_pk_bf16_f32 v169, v170, v171
  v_cvt_pk_bf16_f32 v170, v184, v185
  v_cvt_pk_bf16_f32 v171, v186, v187
  v_mfma_f32_16x16x32_bf16 v[148:151], v[164:167], v[132:135], 0
  v_mfma_f32_16x16x32_bf16 v[180:183], v[160:163], v[132:135], 0
  v_pk_fma_f32 v[140:141], v[48:49], v[74:75], v[140:141] op_sel:[0,0,0] op_sel_hi:[1,0,1] neg_lo:[0,1,0] neg_hi:[0,1,0]
  v_pk_fma_f32 v[142:143], v[50:51], v[74:75], v[142:143] op_sel:[0,0,0] op_sel_hi:[1,0,1] neg_lo:[0,1,0] neg_hi:[0,1,0]
  v_pk_fma_f32 v[156:157], v[52:53], v[74:75], v[156:157] op_sel:[0,0,0] op_sel_hi:[1,0,1] neg_lo:[0,1,0] neg_hi:[0,1,0]
  v_pk_fma_f32 v[158:159], v[54:55], v[74:75], v[158:159] op_sel:[0,0,0] op_sel_hi:[1,0,1] neg_lo:[0,1,0] neg_hi:[0,1,0]
  v_cvt_pk_bf16_f32 v140, v140, v141
  v_cvt_pk_bf16_f32 v141, v142, v143
  v_cvt_pk_bf16_f32 v142, v156, v157
  v_cvt_pk_bf16_f32 v143, v158, v159
  v_pk_fma_f32 v[172:173], v[56:57], v[74:75], v[172:173] op_sel:[0,0,0] op_sel_hi:[1,0,1] neg_lo:[0,1,0] neg_hi:[0,1,0]
  v_pk_fma_f32 v[174:175], v[58:59], v[74:75], v[174:175] op_sel:[0,0,0] op_sel_hi:[1,0,1] neg_lo:[0,1,0] neg_hi:[0,1,0]
  v_pk_fma_f32 v[188:189], v[60:61], v[74:75], v[188:189] op_sel:[0,0,0] op_sel_hi:[1,0,1] neg_lo:[0,1,0] neg_hi:[0,1,0]
  v_pk_fma_f32 v[190:191], v[62:63], v[74:75], v[190:191] op_sel:[0,0,0] op_sel_hi:[1,0,1] neg_lo:[0,1,0] neg_hi:[0,1,0]
  v_cvt_pk_bf16_f32 v172, v172, v173
  v_cvt_pk_bf16_f32 v173, v174, v175
  v_cvt_pk_bf16_f32 v174, v188, v189
  v_cvt_pk_bf16_f32 v175, v190, v191
  s_waitcnt lgkmcnt(0)
  v_pk_fma_f32 v[32:33], v[56:57], v[66:67], v[32:33] op_sel:[0,0,0] op_sel_hi:[1,0,1] neg_lo:[0,1,0] neg_hi:[0,1,0]
  v_pk_fma_f32 v[34:35], v[58:59], v[66:67], v[34:35] op_sel:[0,0,0] op_sel_hi:[1,0,1] neg_lo:[0,1,0] neg_hi:[0,1,0]
  v_pk_fma_f32 v[36:37], v[60:61], v[66:67], v[36:37] op_sel:[0,0,0] op_sel_hi:[1,0,1] neg_lo:[0,1,0] neg_hi:[0,1,0]
  v_pk_fma_f32 v[38:39], v[62:63], v[66:67], v[38:39] op_sel:[0,0,0] op_sel_hi:[1,0,1] neg_lo:[0,1,0] neg_hi:[0,1,0]
  v_cvt_pk_bf16_f32 v32, v32, v33
  v_cvt_pk_bf16_f32 v33, v34, v35
  v_cvt_pk_bf16_f32 v34, v36, v37
  v_cvt_pk_bf16_f32 v35, v38, v39
  v_mfma_f32_16x16x32_bf16 v[152:155], v[168:171], v[136:139], 0
  v_mfma_f32_16x16x32_bf16 v[184:187], v[164:167], v[136:139], 0
  v_mfma_f32_16x16x32_bf16 v[156:159], v[172:175], v[140:143], 0
  v_mfma_f32_16x16x32_bf16 v[188:191], v[168:171], v[140:143], 0
  v_mfma_f32_16x16x32_bf16 v[176:179], v[32:35], v[128:131], 0
  v_pk_fma_f32 v[40:41], v[84:85], v[64:65], v[40:41] op_sel:[0,0,0] op_sel_hi:[1,0,1] neg_lo:[1,0,0] neg_hi:[1,0,0]
  v_pk_fma_f32 v[42:43], v[86:87], v[64:65], v[42:43] op_sel:[0,0,0] op_sel_hi:[1,0,1] neg_lo:[1,0,0] neg_hi:[1,0,0]
  v_pk_mul_f32 v[40:41], v[40:41], v[104:105]
  v_pk_mul_f32 v[42:43], v[42:43], v[106:107]
  v_cvt_pk_bf16_f32 v4, v40, v41
  v_cvt_pk_bf16_f32 v5, v42, v43
  v_pk_fma_f32 v[192:193], v[88:89], v[64:65], v[192:193] op_sel:[0,0,0] op_sel_hi:[1,0,1] neg_lo:[1,0,0] neg_hi:[1,0,0]
  v_pk_fma_f32 v[194:195], v[90:91], v[64:65], v[194:195] op_sel:[0,0,0] op_sel_hi:[1,0,1] neg_lo:[1,0,0] neg_hi:[1,0,0]
  v_pk_mul_f32 v[192:193], v[192:193], v[108:109]
  v_pk_mul_f32 v[194:195], v[194:195], v[110:111]
  v_cvt_pk_bf16_f32 v6, v192, v193
  v_cvt_pk_bf16_f32 v7, v194, v195
  v_pk_fma_f32 v[196:197], v[92:93], v[64:65], v[196:197] op_sel:[0,0,0] op_sel_hi:[1,0,1] neg_lo:[1,0,0] neg_hi:[1,0,0]
  v_pk_fma_f32 v[198:199], v[94:95], v[64:65], v[198:199] op_sel:[0,0,0] op_sel_hi:[1,0,1] neg_lo:[1,0,0] neg_hi:[1,0,0]
  v_pk_mul_f32 v[196:197], v[196:197], v[112:113]
  v_pk_mul_f32 v[198:199], v[198:199], v[114:115]
  v_cvt_pk_bf16_f32 v8, v196, v197
  v_cvt_pk_bf16_f32 v9, v198, v199
  v_pk_fma_f32 v[200:201], v[96:97], v[64:65], v[200:201] op_sel:[0,0,0] op_sel_hi:[1,0,1] neg_lo:[1,0,0] neg_hi:[1,0,0]
  v_pk_fma_f32 v[202:203], v[98:99], v[64:65], v[202:203] op_sel:[0,0,0] op_sel_hi:[1,0,1] neg_lo:[1,0,0] neg_hi:[1,0,0]
  v_pk_mul_f32 v[200:201], v[200:201], v[116:117]
  v_pk_mul_f32 v[202:203], v[202:203], v[118:119]
  v_cvt_pk_bf16_f32 v10, v200, v201
  v_cvt_pk_bf16_f32 v11, v202, v203
  v_pk_fma_f32 v[204:205], v[100:101], v[64:65], v[204:205] op_sel:[0,0,0] op_sel_hi:[1,0,1] neg_lo:[1,0,0] neg_hi:[1,0,0]
  v_pk_fma_f32 v[206:207], v[102:103], v[64:65], v[206:207] op_sel:[0,0,0] op_sel_hi:[1,0,1] neg_lo:[1,0,0] neg_hi:[1,0,0]
  v_pk_mul_f32 v[204:205], v[204:205], v[120:121]
  v_pk_mul_f32 v[206:207], v[206:207], v[122:123]
  v_cvt_pk_bf16_f32 v12, v204, v205
  v_cvt_pk_bf16_f32 v13, v206, v207
  v_pk_fma_f32 v[44:45], v[84:85], v[64:65], v[44:45] op_sel:[0,1,0] op_sel_hi:[1,1,1] neg_lo:[1,0,0] neg_hi:[1,0,0]
  v_pk_fma_f32 v[46:47], v[86:87], v[64:65], v[46:47] op_sel:[0,1,0] op_sel_hi:[1,1,1] neg_lo:[1,0,0] neg_hi:[1,0,0]
  v_pk_mul_f32 v[44:45], v[44:45], v[104:105]
  v_pk_mul_f32 v[46:47], v[46:47], v[106:107]
  v_cvt_pk_bf16_f32 v224, v44, v45
  v_cvt_pk_bf16_f32 v225, v46, v47
  v_pk_fma_f32 v[208:209], v[88:89], v[64:65], v[208:209] op_sel:[0,1,0] op_sel_hi:[1,1,1] neg_lo:[1,0,0] neg_hi:[1,0,0]
  v_pk_fma_f32 v[210:211], v[90:91], v[64:65], v[210:211] op_sel:[0,1,0] op_sel_hi:[1,1,1] neg_lo:[1,0,0] neg_hi:[1,0,0]
  v_pk_mul_f32 v[208:209], v[208:209], v[108:109]
  v_pk_mul_f32 v[210:211], v[210:211], v[110:111]
  v_cvt_pk_bf16_f32 v226, v208, v209
  v_cvt_pk_bf16_f32 v227, v210, v211
  v_pk_fma_f32 v[212:213], v[92:93], v[64:65], v[212:213] op_sel:[0,1,0] op_sel_hi:[1,1,1] neg_lo:[1,0,0] neg_hi:[1,0,0]
  v_pk_fma_f32 v[214:215], v[94:95], v[64:65], v[214:215] op_sel:[0,1,0] op_sel_hi:[1,1,1] neg_lo:[1,0,0] neg_hi:[1,0,0]
  v_pk_mul_f32 v[212:213], v[212:213], v[112:113]
  v_pk_mul_f32 v[214:215], v[214:215], v[114:115]
  v_cvt_pk_bf16_f32 v228, v212, v213
  v_cvt_pk_bf16_f32 v229, v214, v215
  v_pk_fma_f32 v[216:217], v[96:97], v[64:65], v[216:217] op_sel:[0,1,0] op_sel_hi:[1,1,1] neg_lo:[1,0,0] neg_hi:[1,0,0]
  v_pk_fma_f32 v[218:219], v[98:99], v[64:65], v[218:219] op_sel:[0,1,0] op_sel_hi:[1,1,1] neg_lo:[1,0,0] neg_hi:[1,0,0]
  v_pk_mul_f32 v[216:217], v[216:217], v[116:117]
  v_pk_mul_f32 v[218:219], v[218:219], v[118:119]
  v_cvt_pk_bf16_f32 v230, v216, v217
  v_cvt_pk_bf16_f32 v231, v218, v219
  v_pk_fma_f32 v[220:221], v[100:101], v[64:65], v[220:221] op_sel:[0,1,0] op_sel_hi:[1,1,1] neg_lo:[1,0,0] neg_hi:[1,0,0]
  v_pk_fma_f32 v[222:223], v[102:103], v[64:65], v[222:223] op_sel:[0,1,0] op_sel_hi:[1,1,1] neg_lo:[1,0,0] neg_hi:[1,0,0]
  v_pk_mul_f32 v[220:221], v[220:221], v[120:121]
  v_pk_mul_f32 v[222:223], v[222:223], v[122:123]
  v_cvt_pk_bf16_f32 v232, v220, v221
  v_cvt_pk_bf16_f32 v233, v222, v223
  v_cndmask_b32 v148, v148, v149, s[48:49]
  v_cndmask_b32 v180, v180, v181, s[48:49]
  v_cndmask_b32 v150, v150, v151, s[48:49]
  v_cndmask_b32 v182, v182, v183, s[48:49]
  v_cndmask_b32 v36, v148, v180, s[50:51]
  v_cndmask_b32 v37, v150, v182, s[52:53]
  v_mul_f32 v36, v36, v77
  v_mul_f32 v37, v37, v81
  v_cndmask_b32 v152, v152, v153, s[48:49]
  v_cndmask_b32 v184, v184, v185, s[48:49]
  v_cndmask_b32 v154, v154, v155, s[48:49]
  v_cndmask_b32 v186, v186, v187, s[48:49]
  v_cndmask_b32 v40, v152, v184, s[50:51]
  v_cndmask_b32 v41, v154, v186, s[52:53]
  v_mul_f32 v40, v40, v78
  v_mul_f32 v41, v41, v82
  v_cndmask_b32 v156, v156, v157, s[48:49]
  v_cndmask_b32 v188, v188, v189, s[48:49]
  v_cndmask_b32 v158, v158, v159, s[48:49]
  v_cndmask_b32 v190, v190, v191, s[48:49]
  v_cndmask_b32 v44, v156, v188, s[50:51]
  v_cndmask_b32 v45, v158, v190, s[52:53]
  v_mul_f32 v44, v44, v79
  v_mul_f32 v45, v45, v83
  v_cndmask_b32 v144, v144, v145, s[48:49]
  v_cndmask_b32 v176, v176, v177, s[48:49]
  v_cndmask_b32 v146, v146, v147, s[48:49]
  v_cndmask_b32 v178, v178, v179, s[48:49]
  v_cndmask_b32 v32, v144, v176, s[50:51]
  v_cndmask_b32 v33, v146, v178, s[52:53]
  v_mul_f32 v32, v32, v76
  v_mul_f32 v33, v33, v80
  v_mov_b32 v48, 0xceabfb8f
  v_cndmask_b32 v32, v32, v48, s[54:55]
  v_cndmask_b32 v33, v33, v48, s[14:15]
  v_max_f32 v34, v32, v33
  v_max_f32 v38, v36, v37
  v_max_f32 v42, v40, v41
  v_max_f32 v46, v44, v45
  v_mov_b32 v35, v34
  v_mov_b32 v39, v38
  v_mov_b32 v43, v42
  v_mov_b32 v47, v46
  v_permlane32_swap_b32 v34, v35
  v_permlane32_swap_b32 v38, v39
  v_permlane32_swap_b32 v42, v43
  v_permlane32_swap_b32 v46, v47
  v_max_f32 v34, v34, v35
  v_max_f32 v38, v38, v39
  v_max_f32 v42, v42, v43
  v_max_f32 v46, v46, v47
  v_mov_b32 v35, v34
  v_mov_b32 v39, v38
  v_mov_b32 v43, v42
  v_mov_b32 v47, v46
  v_permlane16_swap_b32 v34, v35
  v_permlane16_swap_b32 v38, v39
  v_permlane16_swap_b32 v42, v43
  v_permlane16_swap_b32 v46, v47
  v_max_f32 v34, v34, v35
  v_max_f32 v38, v38, v39
  v_max_f32 v42, v42, v43
  v_max_f32 v46, v46, v47
  v_sub_f32 v32, v32, v34
  v_sub_f32 v33, v33, v34
  v_sub_f32 v36, v36, v38
  v_sub_f32 v37, v37, v38
  v_sub_f32 v40, v40, v42
  v_sub_f32 v41, v41, v42
  v_sub_f32 v44, v44, v46
  v_sub_f32 v45, v45, v46
  v_exp_f32 v32, v32
  v_exp_f32 v33, v33
  v_exp_f32 v36, v36
  v_exp_f32 v37, v37
  v_exp_f32 v40, v40
  v_exp_f32 v41, v41
  v_exp_f32 v44, v44
  v_exp_f32 v45, v45
  v_cvt_pk_bf16_f32 v32, v32, v32
  v_cvt_pk_bf16_f32 v33, v33, v33
  v_and_b32 v128, v32, v27
  v_and_b32 v129, v33, v29
  v_and_b32 v130, v32, v28
  v_and_b32 v131, v33, v30
  v_cvt_pk_bf16_f32 v36, v36, v36
  v_cvt_pk_bf16_f32 v37, v37, v37
  v_and_b32 v132, v36, v27
  v_and_b32 v133, v37, v29
  v_and_b32 v134, v36, v28
  v_and_b32 v135, v37, v30
  v_mfma_f32_16x16x32_bf16 v[144:147], v[236:239], v[128:131], 0
  v_mfma_f32_16x16x32_bf16 v[192:195], v[4:7], v[128:131], 0
  v_mfma_f32_16x16x32_bf16 v[208:211], v[224:227], v[128:131], 0
  v_cvt_pk_bf16_f32 v40, v40, v40
  v_cvt_pk_bf16_f32 v41, v41, v41
  v_and_b32 v136, v40, v27
  v_and_b32 v137, v41, v29
  v_and_b32 v138, v40, v28
  v_and_b32 v139, v41, v30
  v_mfma_f32_16x16x32_bf16 v[148:151], v[236:239], v[132:135], 0
  v_mfma_f32_16x16x32_bf16 v[196:199], v[6:9], v[132:135], 0
  v_mfma_f32_16x16x32_bf16 v[212:215], v[226:229], v[132:135], 0
  v_cvt_pk_bf16_f32 v44, v44, v44
  v_cvt_pk_bf16_f32 v45, v45, v45
  v_and_b32 v140, v44, v27
  v_and_b32 v141, v45, v29
  v_and_b32 v142, v44, v28
  v_and_b32 v143, v45, v30
  v_mfma_f32_16x16x32_bf16 v[152:155], v[236:239], v[136:139], 0
  v_mfma_f32_16x16x32_bf16 v[200:203], v[8:11], v[136:139], 0
  v_mfma_f32_16x16x32_bf16 v[216:219], v[228:231], v[136:139], 0
  v_mfma_f32_16x16x32_bf16 v[156:159], v[236:239], v[140:143], 0
  v_mfma_f32_16x16x32_bf16 v[204:207], v[10:13], v[140:143], 0
  v_mfma_f32_16x16x32_bf16 v[220:223], v[230:233], v[140:143], 0
  s_cmp_eq_u32 s71, 1
  s_cbranch_scc1 L_attn_out1
  v_rcp_f32 v144, v144
  s_mov_b32 s3, 0
  v_pk_mul_f32 v[192:193], v[192:193], v[144:145] op_sel_hi:[1,0]
  v_pk_mul_f32 v[194:195], v[194:195], v[144:145] op_sel_hi:[1,0]
  v_pk_mul_f32 v[208:209], v[208:209], v[144:145] op_sel_hi:[1,0]
  v_pk_mul_f32 v[210:211], v[210:211], v[144:145] op_sel_hi:[1,0]
  v_cvt_pk_bf16_f32 v48, v192, v193
  v_cvt_pk_bf16_f32 v49, v194, v195
  v_cvt_pk_bf16_f32 v50, v208, v209
  v_cvt_pk_bf16_f32 v51, v210, v211
  buffer_store_dwordx4 v[48:51], v31, s[44:47], s3 offen sc1
  v_rcp_f32 v148, v148
  s_mov_b32 s3, 32768
  v_pk_mul_f32 v[196:197], v[196:197], v[148:149] op_sel_hi:[1,0]
  v_pk_mul_f32 v[198:199], v[198:199], v[148:149] op_sel_hi:[1,0]
  v_pk_mul_f32 v[212:213], v[212:213], v[148:149] op_sel_hi:[1,0]
  v_pk_mul_f32 v[214:215], v[214:215], v[148:149] op_sel_hi:[1,0]
  v_cvt_pk_bf16_f32 v52, v196, v197
  v_cvt_pk_bf16_f32 v53, v198, v199
  v_cvt_pk_bf16_f32 v54, v212, v213
  v_cvt_pk_bf16_f32 v55, v214, v215
  buffer_store_dwordx4 v[52:55], v31, s[44:47], s3 offen sc1
  v_rcp_f32 v152, v152
  s_mov_b32 s3, 65536
  v_pk_mul_f32 v[200:201], v[200:201], v[152:153] op_sel_hi:[1,0]
  v_pk_mul_f32 v[202:203], v[202:203], v[152:153] op_sel_hi:[1,0]
  v_pk_mul_f32 v[216:217], v[216:217], v[152:153] op_sel_hi:[1,0]
  v_pk_mul_f32 v[218:219], v[218:219], v[152:153] op_sel_hi:[1,0]
  v_cvt_pk_bf16_f32 v56, v200, v201
  v_cvt_pk_bf16_f32 v57, v202, v203
  v_cvt_pk_bf16_f32 v58, v216, v217
  v_cvt_pk_bf16_f32 v59, v218, v219
  buffer_store_dwordx4 v[56:59], v31, s[44:47], s3 offen sc1
  v_rcp_f32 v156, v156
  s_mov_b32 s3, 98304
  v_pk_mul_f32 v[204:205], v[204:205], v[156:157] op_sel_hi:[1,0]
  v_pk_mul_f32 v[206:207], v[206:207], v[156:157] op_sel_hi:[1,0]
  v_pk_mul_f32 v[220:221], v[220:221], v[156:157] op_sel_hi:[1,0]
  v_pk_mul_f32 v[222:223], v[222:223], v[156:157] op_sel_hi:[1,0]
  v_cvt_pk_bf16_f32 v60, v204, v205
  v_cvt_pk_bf16_f32 v61, v206, v207
  v_cvt_pk_bf16_f32 v62, v220, v221
  v_cvt_pk_bf16_f32 v63, v222, v223
  buffer_store_dwordx4 v[60:63], v31, s[44:47], s3 offen sc1
  s_branch L_attn_out2
L_attn_out1:
  v_rcp_f32 v144, v144
  s_mov_b32 s3, 0
  v_pk_mul_f32 v[192:193], v[192:193], v[144:145] op_sel_hi:[1,0]
  v_pk_mul_f32 v[194:195], v[194:195], v[144:145] op_sel_hi:[1,0]
  v_pk_mul_f32 v[208:209], v[208:209], v[144:145] op_sel_hi:[1,0]
  v_pk_mul_f32 v[210:211], v[210:211], v[144:145] op_sel_hi:[1,0]
  v_cvt_pk_bf16_f32 v50, v192, v193
  v_cvt_pk_bf16_f32 v51, v194, v195
  v_cvt_pk_bf16_f32 v48, v208, v209
  v_cvt_pk_bf16_f32 v49, v210, v211
  buffer_store_dwordx4 v[48:51], v31, s[44:47], s3 offen sc1
  v_rcp_f32 v148, v148
  s_mov_b32 s3, 32768
  v_pk_mul_f32 v[196:197], v[196:197], v[148:149] op_sel_hi:[1,0]
  v_pk_mul_f32 v[198:199], v[198:199], v[148:149] op_sel_hi:[1,0]
  v_pk_mul_f32 v[212:213], v[212:213], v[148:149] op_sel_hi:[1,0]
  v_pk_mul_f32 v[214:215], v[214:215], v[148:149] op_sel_hi:[1,0]
  v_cvt_pk_bf16_f32 v54, v196, v197
  v_cvt_pk_bf16_f32 v55, v198, v199
  v_cvt_pk_bf16_f32 v52, v212, v213
  v_cvt_pk_bf16_f32 v53, v214, v215
  buffer_store_dwordx4 v[52:55], v31, s[44:47], s3 offen sc1
  v_rcp_f32 v152, v152
  s_mov_b32 s3, 65536
  v_pk_mul_f32 v[200:201], v[200:201], v[152:153] op_sel_hi:[1,0]
  v_pk_mul_f32 v[202:203], v[202:203], v[152:153] op_sel_hi:[1,0]
  v_pk_mul_f32 v[216:217], v[216:217], v[152:153] op_sel_hi:[1,0]
  v_pk_mul_f32 v[218:219], v[218:219], v[152:153] op_sel_hi:[1,0]
  v_cvt_pk_bf16_f32 v58, v200, v201
  v_cvt_pk_bf16_f32 v59, v202, v203
  v_cvt_pk_bf16_f32 v56, v216, v217
  v_cvt_pk_bf16_f32 v57, v218, v219
  buffer_store_dwordx4 v[56:59], v31, s[44:47], s3 offen sc1
  v_rcp_f32 v156, v156
  s_mov_b32 s3, 98304
  v_pk_mul_f32 v[204:205], v[204:205], v[156:157] op_sel_hi:[1,0]
  v_pk_mul_f32 v[206:207], v[206:207], v[156:157] op_sel_hi:[1,0]
  v_pk_mul_f32 v[220:221], v[220:221], v[156:157] op_sel_hi:[1,0]
  v_pk_mul_f32 v[222:223], v[222:223], v[156:157] op_sel_hi:[1,0]
  v_cvt_pk_bf16_f32 v62, v204, v205
  v_cvt_pk_bf16_f32 v63, v206, v207
  v_cvt_pk_bf16_f32 v60, v220, v221
  v_cvt_pk_bf16_f32 v61, v222, v223
  buffer_store_dwordx4 v[60:63], v31, s[44:47], s3 offen sc1
L_attn_out2:
  s_waitcnt vmcnt(0) lgkmcnt(0)
  s_barrier
  s_add_u32 s97, s97, 1
  s_branch L_wo_body
.section .rodata,"a"
.p2align 6
.amdhsa_kernel interleave_layers__sliding_local_dilated__dense_activation_gelu__prompt_kernel
  .amdhsa_next_free_vgpr 256
  .amdhsa_next_free_sgpr 102
  .amdhsa_accum_offset 256
  .amdhsa_group_segment_fixed_size 0
  .amdhsa_kernarg_size 88
  .amdhsa_user_sgpr_count 2
  .amdhsa_user_sgpr_kernarg_segment_ptr 1
  .amdhsa_system_sgpr_workgroup_id_x 1
  .amdhsa_float_denorm_mode_32 3
  .amdhsa_float_denorm_mode_16_64 3
.end_amdhsa_kernel
.text
L_attn_c1:
L_wo_c0:
L_wo_body:
  s_cmp_ge_u32 s2, 256
  s_cbranch_scc1 L_wo_end
  v_lshrrev_b32 v2, 6, v0
  v_and_b32 v1, 63, v0
  v_readfirstlane_b32 s70, v2
  s_and_b32 s3, s2, 7
  s_lshr_b32 s99, s2, 3
  s_and_b32 s5, s3, 3
  s_lshl_b32 s5, s5, 2
  s_and_b32 s6, s99, 3
  s_add_u32 s68, s5, s6
  s_lshr_b32 s5, s3, 2
  s_lshr_b32 s78, s99, 2
  s_lshl1_add_u32 s69, s78, s5
  s_add_u32 s3, s68, s78
  s_lshl_b32 s3, s3, 3
  s_lshl_b32 s85, 0xffff02, s3
  s_sub_u32 s3, 0, s3
  s_lshr_b32 s3, 0xffff02, s3
  s_or_b32 s85, s85, s3
  s_cmp_lt_u32 s70, 4
  s_cbranch_scc1 L_wo_compute
L_wo_loader:
  s_add_u32 s3, s96, s70
  s_cmp_lg_u32 s3, 4
  s_cbranch_scc1 L_wo_chk0
  s_load_dwordx2 s[64:65], s[0:1], 72
  s_waitcnt lgkmcnt(0)
  s_and_b32 s65, s65, 0xffff
  s_mov_b32 s66, 256
  s_mov_b32 s67, 0x00020000
  v_lshlrev_b32 v17, 2, v1
  buffer_load_dword v12, v17, s[64:67], 0 offen sc1
L_wo_chk0:
  s_cmp_lg_u32 s96, 0
  s_cbranch_scc1 L_wo_nofirst
  s_waitcnt vmcnt(1)
  s_mov_b32 s7, 0xffff0000
  v_lshlrev_b32 v32, 16, v64
  v_and_b32 v33, s7, v64
  v_lshlrev_b32 v34, 16, v65
  v_and_b32 v35, s7, v65
  v_lshlrev_b32 v36, 16, v66
  v_and_b32 v37, s7, v66
  v_lshlrev_b32 v38, 16, v67
  v_and_b32 v39, s7, v67
  v_lshlrev_b32 v40, 16, v68
  v_and_b32 v41, s7, v68
  v_pk_add_f32 v[32:33], v[32:33], v[40:41]
  v_lshlrev_b32 v40, 16, v69
  v_and_b32 v41, s7, v69
  v_pk_add_f32 v[34:35], v[34:35], v[40:41]
  v_lshlrev_b32 v40, 16, v70
  v_and_b32 v41, s7, v70
  v_pk_add_f32 v[36:37], v[36:37], v[40:41]
  v_lshlrev_b32 v40, 16, v71
  v_and_b32 v41, s7, v71
  v_pk_add_f32 v[38:39], v[38:39], v[40:41]
  v_lshlrev_b32 v40, 16, v72
  v_and_b32 v41, s7, v72
  v_pk_add_f32 v[32:33], v[32:33], v[40:41]
  v_lshlrev_b32 v40, 16, v73
  v_and_b32 v41, s7, v73
  v_pk_add_f32 v[34:35], v[34:35], v[40:41]
  v_lshlrev_b32 v40, 16, v74
  v_and_b32 v41, s7, v74
  v_pk_add_f32 v[36:37], v[36:37], v[40:41]
  v_lshlrev_b32 v40, 16, v75
  v_and_b32 v41, s7, v75
  v_pk_add_f32 v[38:39], v[38:39], v[40:41]
  v_lshlrev_b32 v40, 16, v76
  v_and_b32 v41, s7, v76
  v_pk_add_f32 v[32:33], v[32:33], v[40:41]
  v_lshlrev_b32 v40, 16, v77
  v_and_b32 v41, s7, v77
  v_pk_add_f32 v[34:35], v[34:35], v[40:41]
  v_lshlrev_b32 v40, 16, v78
  v_and_b32 v41, s7, v78
  v_pk_add_f32 v[36:37], v[36:37], v[40:41]
  v_lshlrev_b32 v40, 16, v79
  v_and_b32 v41, s7, v79
  v_pk_add_f32 v[38:39], v[38:39], v[40:41]
  v_lshlrev_b32 v40, 16, v80
  v_and_b32 v41, s7, v80
  v_pk_add_f32 v[32:33], v[32:33], v[40:41]
  v_lshlrev_b32 v40, 16, v81
  v_and_b32 v41, s7, v81
  v_pk_add_f32 v[34:35], v[34:35], v[40:41]
  v_lshlrev_b32 v40, 16, v82
  v_and_b32 v41, s7, v82
  v_pk_add_f32 v[36:37], v[36:37], v[40:41]
  v_lshlrev_b32 v40, 16, v83
  v_and_b32 v41, s7, v83
  v_pk_add_f32 v[38:39], v[38:39], v[40:41]
  v_lshlrev_b32 v40, 16, v84
  v_and_b32 v41, s7, v84
  v_pk_add_f32 v[32:33], v[32:33], v[40:41]
  v_lshlrev_b32 v40, 16, v85
  v_and_b32 v41, s7, v85
  v_pk_add_f32 v[34:35], v[34:35], v[40:41]
  v_lshlrev_b32 v40, 16, v86
  v_and_b32 v41, s7, v86
  v_pk_add_f32 v[36:37], v[36:37], v[40:41]
  v_lshlrev_b32 v40, 16, v87
  v_and_b32 v41, s7, v87
  v_pk_add_f32 v[38:39], v[38:39], v[40:41]
  v_lshlrev_b32 v40, 16, v88
  v_and_b32 v41, s7, v88
  v_pk_add_f32 v[32:33], v[32:33], v[40:41]
  v_lshlrev_b32 v40, 16, v89
  v_and_b32 v41, s7, v89
  v_pk_add_f32 v[34:35], v[34:35], v[40:41]
  v_lshlrev_b32 v40, 16, v90
  v_and_b32 v41, s7, v90
  v_pk_add_f32 v[36:37], v[36:37], v[40:41]
  v_lshlrev_b32 v40, 16, v91
  v_and_b32 v41, s7, v91
  v_pk_add_f32 v[38:39], v[38:39], v[40:41]
  v_lshlrev_b32 v40, 16, v92
  v_and_b32 v41, s7, v92
  v_pk_add_f32 v[32:33], v[32:33], v[40:41]
  v_lshlrev_b32 v40, 16, v93
  v_and_b32 v41, s7, v93
  v_pk_add_f32 v[34:35], v[34:35], v[40:41]
  v_lshlrev_b32 v40, 16, v94
  v_and_b32 v41, s7, v94
  v_pk_add_f32 v[36:37], v[36:37], v[40:41]
  v_lshlrev_b32 v40, 16, v95
  v_and_b32 v41, s7, v95
  v_pk_add_f32 v[38:39], v[38:39], v[40:41]
  s_add_u32 s52, s22, 24641536
  s_addc_u32 s53, s23, 0
  s_and_b32 s53, s53, 0xffff
  s_mov_b32 s54, 262144
  s_mov_b32 s55, 0x00020000
  v_permlane32_swap_b32 v32, v36
  v_permlane32_swap_b32 v33, v37
  v_permlane32_swap_b32 v34, v38
  v_permlane32_swap_b32 v35, v39
  v_add_f32 v32, v32, v36
  v_add_f32 v33, v33, v37
  v_add_f32 v34, v34, v38
  v_add_f32 v35, v35, v39
  v_and_b32 v2, 7, v1
  v_lshlrev_b32 v2, 5, v2
  v_permlane16_swap_b32 v32, v34
  v_permlane16_swap_b32 v33, v35
  v_add_f32 v32, v32, v34
  v_add_f32 v33, v33, v35
  v_lshrrev_b32 v3, 4, v1
  v_lshl_add_u32 v2, v3, 3, v2
  v_add_f32_dpp v32, v32, v32 row_ror:8 row_mask:0xf bank_mask:0xf
  v_add_f32_dpp v33, v33, v33 row_ror:8 row_mask:0xf bank_mask:0xf
  buffer_store_dwordx2 v[32:33], v2, s[52:55], s94 offen sc1
L_wo_nofirst:
  v_and_b32 v2, 3, v1
  v_lshlrev_b32 v2, 3, v2
  v_bfe_i32 v16, s85, v2, 8
  s_and_b32 s3, s68, 3
  s_mul_i32 s4, s3, 4
  v_add3_u32 v3, v16, v1, s4
  v_and_b32 v3, 15, v3
  v_lshlrev_b32 v16, 17, v3
  s_add_u32 s9, s70, s68
  s_and_b32 s9, s9, 3
  s_lshl_b32 s77, s9, 11
  v_and_b32 v10, 7, v1
  v_lshrrev_b32 v3, 3, v1
  s_lshl_b32 s10, s9, 4
  v_add_u32 v3, s10, v3
  v_mul_u32_u24 v3, 2048, v3
  v_lshrrev_b32 v2, 3, v1
  v_and_b32 v2, 6, v2
  v_xor_b32 v2, v2, v10
  s_lshl_b32 s10, s69, 7
  v_add_u32 v3, s10, v3
  v_lshl_add_u32 v8, v2, 4, v3
  v_add_u32 v3, 16384, v3
  v_lshl_add_u32 v9, v2, 4, v3
  s_mov_b32 s40, s20
  s_and_b32 s41, s21, 0xffff
  s_mov_b32 s42, 2097152
  s_mov_b32 s43, 0x00020000
  v_readlane_b32 s74, v16, 0
  s_add_u32 m0, s77, 28672
  s_add_u32 s4, s74, 0
  buffer_load_dwordx4 v8, s[40:43], s4 offen lds
  s_add_u32 m0, s77, 29696
  s_nop 0
  buffer_load_dwordx4 v9, s[40:43], s4 offen lds
  v_readlane_b32 s74, v16, 1
  s_add_u32 m0, s77, 36864
  s_add_u32 s4, s74, 0
  buffer_load_dwordx4 v8, s[40:43], s4 offen lds
  s_add_u32 m0, s77, 37888
  s_nop 0
  buffer_load_dwordx4 v9, s[40:43], s4 offen lds
  v_readlane_b32 s74, v16, 2
  s_add_u32 m0, s77, 45056
  s_add_u32 s4, s74, 0
  buffer_load_dwordx4 v8, s[40:43], s4 offen lds
  s_add_u32 m0, s77, 46080
  s_nop 0
  buffer_load_dwordx4 v9, s[40:43], s4 offen lds
  v_readlane_b32 s74, v16, 3
  s_add_u32 m0, s77, 53248
  s_add_u32 s4, s74, 0
  buffer_load_dwordx4 v8, s[40:43], s4 offen lds
  s_add_u32 m0, s77, 54272
  s_nop 0
  buffer_load_dwordx4 v9, s[40:43], s4 offen lds
  v_readlane_b32 s74, v16, 4
  s_add_u32 m0, s77, 61440
  s_add_u32 s4, s74, 0
  buffer_load_dwordx4 v8, s[40:43], s4 offen lds
  s_add_u32 m0, s77, 62464
  s_nop 0
  buffer_load_dwordx4 v9, s[40:43], s4 offen lds
  v_readlane_b32 s74, v16, 5
  s_add_u32 m0, s77, 69632
  s_add_u32 s4, s74, 0
  buffer_load_dwordx4 v8, s[40:43], s4 offen lds
  s_add_u32 m0, s77, 70656
  s_nop 0
  buffer_load_dwordx4 v9, s[40:43], s4 offen lds
  s_waitcnt vmcnt(12)
  s_add_u32 s3, s96, s70
  s_cmp_lg_u32 s3, 4
  s_cbranch_scc1 L_wo_chk1
  v_cmp_ne_u32 vcc, 0x01010101, v12
  s_cbranch_vccz L_wo_chk1
  s_load_dwordx2 s[64:65], s[0:1], 72
  s_waitcnt lgkmcnt(0)
  s_and_b32 s65, s65, 0xffff
  s_mov_b32 s66, 256
  s_mov_b32 s67, 0x00020000
  v_lshlrev_b32 v17, 2, v1
  s_mov_b32 s79, 0x100000
L_wo_chkl:
  buffer_load_dword v12, v17, s[64:67], 0 offen sc1
  s_sub_u32 s79, s79, 1
  s_cbranch_scc1 L_wo_chk1
  s_waitcnt vmcnt(0)
  v_cmp_ne_u32 vcc, 0x01010101, v12
  s_cbranch_vccnz L_wo_chkl
L_wo_chk1:
  s_add_u32 s44, s22, 41943040
  s_addc_u32 s45, s23, 0
  s_and_b32 s45, s45, 0xffff
  s_mov_b32 s46, 524288
  s_mov_b32 s47, 0x00020000
  s_lshl4_add_u32 s3, s97, s68
  s_and_b32 s4, s69, 15
  s_lshl4_add_u32 s3, s3, s4
  s_lshl_b32 s3, s3, 7
  s_sub_u32 s3, s3, 32768
  v_lshlrev_b32 v11, 7, v1
  v_and_b32 v2, 15, v1
  v_lshlrev_b32 v2, 2, v2
  v_mov_b32 v3, 1
  s_mov_b32 s79, 0x100000
  s_cmp_lg_u32 s70, 4
  s_barrier
  s_cbranch_scc1 L_wo_nofl
  s_mov_b32 exec_lo, 0xffff
  s_mov_b32 exec_hi, 0
  buffer_store_dword v3, v11, s[44:47], s87 offen sc1
  s_mov_b64 exec, -1
L_wo_nofl:
  s_mov_b32 s5, s3
  v_readlane_b32 s74, v16, 6
  s_add_u32 m0, s77, 77824
  s_add_u32 s4, s74, 0
  buffer_load_dwordx4 v8, s[40:43], s4 offen lds
  s_add_u32 m0, s77, 78848
  s_nop 0
  buffer_load_dwordx4 v9, s[40:43], s4 offen lds
  v_readlane_b32 s74, v16, 7
  s_add_u32 m0, s77, 86016
  s_add_u32 s4, s74, 0
  buffer_load_dwordx4 v8, s[40:43], s4 offen lds
  s_add_u32 m0, s77, 87040
  s_nop 0
  buffer_load_dwordx4 v9, s[40:43], s4 offen lds
  v_readlane_b32 s74, v16, 8
  s_add_u32 m0, s77, 94208
  s_add_u32 s4, s74, 0
  buffer_load_dwordx4 v8, s[40:43], s4 offen lds
  s_add_u32 m0, s77, 95232
  s_nop 0
  buffer_load_dwordx4 v9, s[40:43], s4 offen lds
  v_readlane_b32 s74, v16, 9
  s_add_u32 m0, s77, 102400
  s_add_u32 s4, s74, 0
  buffer_load_dwordx4 v8, s[40:43], s4 offen lds
  s_add_u32 m0, s77, 103424
  s_nop 0
  buffer_load_dwordx4 v9, s[40:43], s4 offen lds
  v_readlane_b32 s74, v16, 10
  s_add_u32 m0, s77, 110592
  s_add_u32 s4, s74, 0
  buffer_load_dwordx4 v8, s[40:43], s4 offen lds
  s_add_u32 m0, s77, 111616
  s_nop 0
  buffer_load_dwordx4 v9, s[40:43], s4 offen lds
  v_readlane_b32 s74, v16, 11
  s_add_u32 m0, s77, 118784
  s_add_u32 s4, s74, 0
  buffer_load_dwordx4 v8, s[40:43], s4 offen lds
  s_add_u32 m0, s77, 119808
  s_nop 0
  buffer_load_dwordx4 v9, s[40:43], s4 offen lds
  v_readlane_b32 s74, v16, 12
  s_add_u32 m0, s77, 131072
  s_add_u32 s4, s74, 0
  buffer_load_dwordx4 v8, s[40:43], s4 offen lds
  s_add_u32 m0, s77, 132096
  s_nop 0
  buffer_load_dwordx4 v9, s[40:43], s4 offen lds
  v_readlane_b32 s74, v16, 13
  s_add_u32 m0, s77, 139264
  s_add_u32 s4, s74, 0
  buffer_load_dwordx4 v8, s[40:43], s4 offen lds
  s_add_u32 m0, s77, 140288
  s_nop 0
  buffer_load_dwordx4 v9, s[40:43], s4 offen lds
  v_readlane_b32 s74, v16, 14
  s_add_u32 m0, s77, 147456
  s_add_u32 s4, s74, 0
  buffer_load_dwordx4 v8, s[40:43], s4 offen lds
  s_add_u32 m0, s77, 148480
  s_nop 0
  buffer_load_dwordx4 v9, s[40:43], s4 offen lds
  v_readlane_b32 s74, v16, 15
  s_add_u32 m0, s77, 155648
  s_add_u32 s4, s74, 0
  buffer_load_dwordx4 v8, s[40:43], s4 offen lds
  s_add_u32 m0, s77, 156672
  s_nop 0
  buffer_load_dwordx4 v9, s[40:43], s4 offen lds
  s_mov_b32 s3, s5
  s_cmp_lg_u32 s70, 4
  s_cbranch_scc1 L_wo_dep
L_wo_poll:
  buffer_load_dword v3, v2, s[44:47], s3 offen sc1
  s_sub_u32 s79, s79, 1
  s_cbranch_scc1 L_wo_dep
  s_waitcnt vmcnt(0)
  v_cmp_ne_u32 vcc, 1, v3
  s_cbranch_vccnz L_wo_poll
L_wo_dep:
  s_waitcnt vmcnt(20) lgkmcnt(0)
  s_barrier
  s_waitcnt vmcnt(2)
  s_barrier
  s_lshl_b32 s87, s97, 15
  s_lshl_b32 s4, s68, 11
  s_add_u32 s87, s87, s4
  s_lshl_b32 s4, s69, 2
  s_add_u32 s87, s87, s4
  s_add_u32 s97, s97, 1
  s_branch L_w1_body
L_wo_end:
  s_endpgm
L_wo_compute:
  v_and_b32 v2, 3, v1
  v_lshlrev_b32 v2, 3, v2
  v_bfe_i32 v15, s85, v2, 8
  s_and_b32 s3, s68, 3
  s_mul_i32 s4, s3, 4
  v_add3_u32 v3, v15, v1, s4
  v_and_b32 v3, 15, v3
  v_lshlrev_b32 v15, 11, v3
  v_and_b32 v3, 15, v1
  v_lshrrev_b32 v2, 4, v1
  s_lshl_b32 s8, s68, 7
  s_lshl_b32 s9, s70, 5
  s_add_u32 s8, s8, s9
  s_mul_i32 s9, s8, 2048
  v_add_u32 v13, s8, v3
  s_lshl_b32 s10, s69, 7
  v_lshl_add_u32 v14, v2, 3, s10
  v_and_b32 v16, 1, v2
  v_lshrrev_b32 v17, 1, v2
  v_lshlrev_b32 v16, 4, v1
  s_add_u32 s9, s8, s69
  s_lshl_b32 s9, s9, 11
  v_add_u32 v12, s9, v16
  s_lshl_b32 s9, s70, 12
  v_add_u32 v19, s9, v16
  v_lshl_add_u32 v18, v17, 4, v13
  v_lshlrev_b32 v18, 3, v18
  v_and_b32 v16, 1, v2
  v_lshl_add_u32 v18, v16, 2, v18
  s_lshl_b32 s10, s69, 14
  v_add_u32 v18, s10, v18
  v_lshrrev_b32 v6, 2, v1
  v_lshlrev_b32 v6, 7, v6
  v_and_b32 v17, 3, v1
  v_lshl_add_u32 v6, v17, 3, v6
  v_bfe_u32 v17, v1, 3, 2
  v_lshl_add_u32 v6, v17, 5, v6
  v_xor_b32 v7, 32, v6
  v_xor_b32 v8, 64, v6
  v_xor_b32 v9, 96, v6
  s_mov_b32 s11, 0xffff0000
  s_mov_b32 s36, s34
  s_and_b32 s37, s35, 0xffff
  s_mov_b32 s38, 4194304
  s_mov_b32 s39, 0x00020000
  s_add_u32 s44, s34, 4194304
  s_addc_u32 s45, s35, 0
  s_and_b32 s45, s45, 0xffff
  s_mov_b32 s46, 4194304
  s_mov_b32 s47, 0x00020000
  s_add_u32 s56, s34, 24117248
  s_addc_u32 s57, s35, 0
  s_and_b32 s57, s57, 0xffff
  s_mov_b32 s58, 262144
  s_mov_b32 s59, 0x00020000
  s_mul_i32 s9, s8, 2048
  s_add_u32 s36, s36, s9
  s_addc_u32 s37, s37, 0x100000
  s_add_u32 s64, s36, 32768
  s_addc_u32 s65, s37, 0
  s_mov_b32 s38, 32768
  s_mov_b32 s39, 0x00800000
  s_mov_b32 s66, 32768
  s_mov_b32 s67, 0x00800000
  s_cmp_lg_u32 s96, 0
  s_cbranch_scc1 L_pfc2_skip
  s_getpc_b64 s[4:5]
L_pfc2:
  s_lshl_b32 s3, s99, 2
  s_add_u32 s3, s3, s70
  s_mul_i32 s3, s3, 128
  s_min_u32 s3, s3, L_w1_c1-L_w1_c0-128
  s_add_i32 s3, s3, L_w1_c0-L_pfc2
  s_ashr_i32 s6, s3, 31
  s_add_u32 s4, s4, s3
  s_addc_u32 s5, s5, s6
  s_load_dword s40, s[4:5], 0
  s_load_dword s40, s[4:5], 64
L_pfc2_skip:
  v_add_u32 v26, 155648, v6
  v_add_u32 v27, 155648, v7
  v_add_u32 v28, 155648, v8
  v_add_u32 v29, 155648, v9
  v_add_u32 v20, 94208, v6
  v_add_u32 v21, 94208, v7
  v_add_u32 v22, 94208, v8
  v_add_u32 v23, 94208, v9
  v_add_u32 v6, 28672, v6
  v_add_u32 v7, 28672, v7
  v_add_u32 v8, 28672, v8
  v_add_u32 v9, 28672, v9
  v_readlane_b32 s48, v15, 0
  v_readlane_b32 s49, v15, 1
  v_readlane_b32 s50, v15, 2
  s_cmp_lg_u32 s96, 0
  s_cbranch_scc1 L_wo_nosw
  v_permlane16_swap_b32 v240, v242
  v_permlane16_swap_b32 v241, v243
  v_permlane16_swap_b32 v244, v246
  v_permlane16_swap_b32 v245, v247
  v_permlane16_swap_b32 v248, v250
  v_permlane16_swap_b32 v249, v251
  v_permlane16_swap_b32 v252, v254
  v_permlane16_swap_b32 v253, v255
L_wo_nosw:
  s_waitcnt lgkmcnt(0)
  s_barrier
  buffer_load_dwordx4 v[32:35], off, s[36:39], s48 offset:0
  buffer_load_dwordx4 v[36:39], off, s[64:67], s48 offset:0
  buffer_load_dwordx4 v[40:43], off, s[36:39], s48 offset:1024
  buffer_load_dwordx4 v[44:47], off, s[64:67], s48 offset:1024
  buffer_load_dwordx4 v[48:51], off, s[36:39], s49 offset:0
  buffer_load_dwordx4 v[52:55], off, s[64:67], s49 offset:0
  buffer_load_dwordx4 v[56:59], off, s[36:39], s49 offset:1024
  buffer_load_dwordx4 v[60:63], off, s[64:67], s49 offset:1024
  buffer_load_dwordx4 v[64:67], off, s[36:39], s50 offset:0
  buffer_load_dwordx4 v[68:71], off, s[64:67], s50 offset:0
  buffer_load_dwordx4 v[72:75], off, s[36:39], s50 offset:1024
  buffer_load_dwordx4 v[76:79], off, s[64:67], s50 offset:1024
  ds_read_b64_tr_b16 v[160:161], v6 offset:0
  ds_read_b64_tr_b16 v[162:163], v6 offset:2048
  ds_read_b64_tr_b16 v[164:165], v7 offset:0
  ds_read_b64_tr_b16 v[166:167], v7 offset:2048
  ds_read_b64_tr_b16 v[168:169], v8 offset:0
  ds_read_b64_tr_b16 v[170:171], v8 offset:2048
  ds_read_b64_tr_b16 v[172:173], v9 offset:0
  ds_read_b64_tr_b16 v[174:175], v9 offset:2048
  ds_read_b64_tr_b16 v[176:177], v6 offset:4096
  ds_read_b64_tr_b16 v[178:179], v6 offset:6144
  ds_read_b64_tr_b16 v[180:181], v7 offset:4096
  ds_read_b64_tr_b16 v[182:183], v7 offset:6144
  ds_read_b64_tr_b16 v[184:185], v8 offset:4096
  ds_read_b64_tr_b16 v[186:187], v8 offset:6144
  ds_read_b64_tr_b16 v[188:189], v9 offset:4096
  ds_read_b64_tr_b16 v[190:191], v9 offset:6144
  v_lshlrev_b32 v96, 16, v240
  v_and_b32 v97, s11, v240
  v_lshlrev_b32 v98, 16, v241
  v_and_b32 v99, s11, v241
  v_lshlrev_b32 v100, 16, v248
  v_and_b32 v101, s11, v248
  v_lshlrev_b32 v102, 16, v249
  v_and_b32 v103, s11, v249
  v_lshlrev_b32 v104, 16, v242
  v_and_b32 v105, s11, v242
  v_lshlrev_b32 v106, 16, v243
  v_and_b32 v107, s11, v243
  v_lshlrev_b32 v108, 16, v250
  v_and_b32 v109, s11, v250
  v_lshlrev_b32 v110, 16, v251
  v_and_b32 v111, s11, v251
  v_lshlrev_b32 v112, 16, v244
  v_and_b32 v113, s11, v244
  v_lshlrev_b32 v114, 16, v245
  v_and_b32 v115, s11, v245
  v_lshlrev_b32 v116, 16, v252
  v_and_b32 v117, s11, v252
  v_lshlrev_b32 v118, 16, v253
  v_and_b32 v119, s11, v253
  v_lshlrev_b32 v120, 16, v246
  v_and_b32 v121, s11, v246
  v_lshlrev_b32 v122, 16, v247
  v_and_b32 v123, s11, v247
  v_lshlrev_b32 v124, 16, v254
  v_and_b32 v125, s11, v254
  v_lshlrev_b32 v126, 16, v255
  v_and_b32 v127, s11, v255
  s_waitcnt vmcnt(10) lgkmcnt(8)
  v_mfma_f32_16x16x32_bf16 v[96:99], v[160:163], v[32:35], v[96:99]
  ds_read_b64_tr_b16 v[192:193], v6 offset:8192
  v_readlane_b32 s51, v15, 3
  v_mfma_f32_16x16x32_bf16 v[100:103], v[160:163], v[36:39], v[100:103]
  ds_read_b64_tr_b16 v[194:195], v6 offset:10240
  v_mfma_f32_16x16x32_bf16 v[108:111], v[164:167], v[36:39], v[108:111]
  ds_read_b64_tr_b16 v[196:197], v7 offset:8192
  v_mfma_f32_16x16x32_bf16 v[104:107], v[164:167], v[32:35], v[104:107]
  buffer_load_dwordx4 v[80:83], off, s[36:39], s51 offset:0
  v_mfma_f32_16x16x32_bf16 v[112:115], v[168:171], v[32:35], v[112:115]
  ds_read_b64_tr_b16 v[198:199], v7 offset:10240
  ds_read_b64_tr_b16 v[200:201], v8 offset:8192
  v_mfma_f32_16x16x32_bf16 v[116:119], v[168:171], v[36:39], v[116:119]
  ds_read_b64_tr_b16 v[202:203], v8 offset:10240
  ds_read_b64_tr_b16 v[204:205], v9 offset:8192
  v_mfma_f32_16x16x32_bf16 v[124:127], v[172:175], v[36:39], v[124:127]
  buffer_load_dwordx4 v[84:87], off, s[64:67], s51 offset:0
  v_mfma_f32_16x16x32_bf16 v[120:123], v[172:175], v[32:35], v[120:123]
  ds_read_b64_tr_b16 v[206:207], v9 offset:10240
  s_waitcnt vmcnt(10) lgkmcnt(8)
  v_mfma_f32_16x16x32_bf16 v[96:99], v[176:179], v[40:43], v[96:99]
  ds_read_b64_tr_b16 v[208:209], v6 offset:12288
  v_mfma_f32_16x16x32_bf16 v[100:103], v[176:179], v[44:47], v[100:103]
  buffer_load_dwordx4 v[88:91], off, s[36:39], s51 offset:1024
  v_mfma_f32_16x16x32_bf16 v[108:111], v[180:183], v[44:47], v[108:111]
  ds_read_b64_tr_b16 v[210:211], v6 offset:14336
  ds_read_b64_tr_b16 v[212:213], v7 offset:12288
  v_mfma_f32_16x16x32_bf16 v[104:107], v[180:183], v[40:43], v[104:107]
  ds_read_b64_tr_b16 v[214:215], v7 offset:14336
  ds_read_b64_tr_b16 v[216:217], v8 offset:12288
  v_mfma_f32_16x16x32_bf16 v[112:115], v[184:187], v[40:43], v[112:115]
  buffer_load_dwordx4 v[92:95], off, s[64:67], s51 offset:1024
  v_mfma_f32_16x16x32_bf16 v[116:119], v[184:187], v[44:47], v[116:119]
  ds_read_b64_tr_b16 v[218:219], v8 offset:14336
  v_readlane_b32 s48, v15, 4
  v_mfma_f32_16x16x32_bf16 v[124:127], v[188:191], v[44:47], v[124:127]
  ds_read_b64_tr_b16 v[220:221], v9 offset:12288
  v_mfma_f32_16x16x32_bf16 v[120:123], v[188:191], v[40:43], v[120:123]
  ds_read_b64_tr_b16 v[222:223], v9 offset:14336
  s_waitcnt vmcnt(10) lgkmcnt(8)
  v_mfma_f32_16x16x32_bf16 v[96:99], v[192:195], v[48:51], v[96:99]
  buffer_load_dwordx4 v[32:35], off, s[36:39], s48 offset:0
  v_mfma_f32_16x16x32_bf16 v[100:103], v[192:195], v[52:55], v[100:103]
  ds_read_b64_tr_b16 v[160:161], v6 offset:16384
  ds_read_b64_tr_b16 v[162:163], v6 offset:18432
  v_mfma_f32_16x16x32_bf16 v[108:111], v[196:199], v[52:55], v[108:111]
  ds_read_b64_tr_b16 v[164:165], v7 offset:16384
  v_mfma_f32_16x16x32_bf16 v[104:107], v[196:199], v[48:51], v[104:107]
  buffer_load_dwordx4 v[36:39], off, s[64:67], s48 offset:0
  v_mfma_f32_16x16x32_bf16 v[112:115], v[200:203], v[48:51], v[112:115]
  ds_read_b64_tr_b16 v[166:167], v7 offset:18432
  ds_read_b64_tr_b16 v[168:169], v8 offset:16384
  v_mfma_f32_16x16x32_bf16 v[116:119], v[200:203], v[52:55], v[116:119]
  ds_read_b64_tr_b16 v[170:171], v8 offset:18432
  ds_read_b64_tr_b16 v[172:173], v9 offset:16384
  v_mfma_f32_16x16x32_bf16 v[124:127], v[204:207], v[52:55], v[124:127]
  buffer_load_dwordx4 v[40:43], off, s[36:39], s48 offset:1024
  v_mfma_f32_16x16x32_bf16 v[120:123], v[204:207], v[48:51], v[120:123]
  ds_read_b64_tr_b16 v[174:175], v9 offset:18432
  s_waitcnt vmcnt(11) lgkmcnt(8)
  v_mfma_f32_16x16x32_bf16 v[96:99], v[208:211], v[56:59], v[96:99]
  ds_read_b64_tr_b16 v[176:177], v6 offset:20480
  v_mfma_f32_16x16x32_bf16 v[100:103], v[208:211], v[60:63], v[100:103]
  buffer_load_dwordx4 v[44:47], off, s[64:67], s48 offset:1024
  v_mfma_f32_16x16x32_bf16 v[108:111], v[212:215], v[60:63], v[108:111]
  ds_read_b64_tr_b16 v[178:179], v6 offset:22528
  ds_read_b64_tr_b16 v[180:181], v7 offset:20480
  v_mfma_f32_16x16x32_bf16 v[104:107], v[212:215], v[56:59], v[104:107]
  ds_read_b64_tr_b16 v[182:183], v7 offset:22528
  v_mfma_f32_16x16x32_bf16 v[112:115], v[216:219], v[56:59], v[112:115]
  ds_read_b64_tr_b16 v[184:185], v8 offset:20480
  v_mfma_f32_16x16x32_bf16 v[116:119], v[216:219], v[60:63], v[116:119]
  ds_read_b64_tr_b16 v[186:187], v8 offset:22528
  v_readlane_b32 s49, v15, 5
  v_mfma_f32_16x16x32_bf16 v[124:127], v[220:223], v[60:63], v[124:127]
  ds_read_b64_tr_b16 v[188:189], v9 offset:20480
  v_mfma_f32_16x16x32_bf16 v[120:123], v[220:223], v[56:59], v[120:123]
  ds_read_b64_tr_b16 v[190:191], v9 offset:22528
  s_waitcnt vmcnt(10) lgkmcnt(8)
  v_mfma_f32_16x16x32_bf16 v[96:99], v[160:163], v[64:67], v[96:99]
  buffer_load_dwordx4 v[48:51], off, s[36:39], s49 offset:0
  v_mfma_f32_16x16x32_bf16 v[100:103], v[160:163], v[68:71], v[100:103]
  ds_read_b64_tr_b16 v[192:193], v6 offset:24576
  ds_read_b64_tr_b16 v[194:195], v6 offset:26624
  v_mfma_f32_16x16x32_bf16 v[108:111], v[164:167], v[68:71], v[108:111]
  ds_read_b64_tr_b16 v[196:197], v7 offset:24576
  v_mfma_f32_16x16x32_bf16 v[104:107], v[164:167], v[64:67], v[104:107]
  buffer_load_dwordx4 v[52:55], off, s[64:67], s49 offset:0
  v_mfma_f32_16x16x32_bf16 v[112:115], v[168:171], v[64:67], v[112:115]
  ds_read_b64_tr_b16 v[198:199], v7 offset:26624
  ds_read_b64_tr_b16 v[200:201], v8 offset:24576
  v_mfma_f32_16x16x32_bf16 v[116:119], v[168:171], v[68:71], v[116:119]
  ds_read_b64_tr_b16 v[202:203], v8 offset:26624
  ds_read_b64_tr_b16 v[204:205], v9 offset:24576
  v_mfma_f32_16x16x32_bf16 v[124:127], v[172:175], v[68:71], v[124:127]
  buffer_load_dwordx4 v[56:59], off, s[36:39], s49 offset:1024
  v_mfma_f32_16x16x32_bf16 v[120:123], v[172:175], v[64:67], v[120:123]
  ds_read_b64_tr_b16 v[206:207], v9 offset:26624
  s_waitcnt vmcnt(11) lgkmcnt(8)
  v_mfma_f32_16x16x32_bf16 v[96:99], v[176:179], v[72:75], v[96:99]
  ds_read_b64_tr_b16 v[208:209], v6 offset:28672
  v_mfma_f32_16x16x32_bf16 v[100:103], v[176:179], v[76:79], v[100:103]
  buffer_load_dwordx4 v[60:63], off, s[64:67], s49 offset:1024
  v_mfma_f32_16x16x32_bf16 v[108:111], v[180:183], v[76:79], v[108:111]
  ds_read_b64_tr_b16 v[210:211], v6 offset:30720
  ds_read_b64_tr_b16 v[212:213], v7 offset:28672
  v_mfma_f32_16x16x32_bf16 v[104:107], v[180:183], v[72:75], v[104:107]
  ds_read_b64_tr_b16 v[214:215], v7 offset:30720
  v_mfma_f32_16x16x32_bf16 v[112:115], v[184:187], v[72:75], v[112:115]
  ds_read_b64_tr_b16 v[216:217], v8 offset:28672
  v_mfma_f32_16x16x32_bf16 v[116:119], v[184:187], v[76:79], v[116:119]
  ds_read_b64_tr_b16 v[218:219], v8 offset:30720
  v_readlane_b32 s50, v15, 6
  v_mfma_f32_16x16x32_bf16 v[124:127], v[188:191], v[76:79], v[124:127]
  ds_read_b64_tr_b16 v[220:221], v9 offset:28672
  v_mfma_f32_16x16x32_bf16 v[120:123], v[188:191], v[72:75], v[120:123]
  ds_read_b64_tr_b16 v[222:223], v9 offset:30720
  s_waitcnt vmcnt(10) lgkmcnt(8)
  v_mfma_f32_16x16x32_bf16 v[96:99], v[192:195], v[80:83], v[96:99]
  buffer_load_dwordx4 v[64:67], off, s[36:39], s50 offset:0
  v_mfma_f32_16x16x32_bf16 v[100:103], v[192:195], v[84:87], v[100:103]
  ds_read_b64_tr_b16 v[160:161], v6 offset:32768
  ds_read_b64_tr_b16 v[162:163], v6 offset:34816
  v_mfma_f32_16x16x32_bf16 v[108:111], v[196:199], v[84:87], v[108:111]
  ds_read_b64_tr_b16 v[164:165], v7 offset:32768
  v_mfma_f32_16x16x32_bf16 v[104:107], v[196:199], v[80:83], v[104:107]
  buffer_load_dwordx4 v[68:71], off, s[64:67], s50 offset:0
  v_mfma_f32_16x16x32_bf16 v[112:115], v[200:203], v[80:83], v[112:115]
  ds_read_b64_tr_b16 v[166:167], v7 offset:34816
  ds_read_b64_tr_b16 v[168:169], v8 offset:32768
  v_mfma_f32_16x16x32_bf16 v[116:119], v[200:203], v[84:87], v[116:119]
  ds_read_b64_tr_b16 v[170:171], v8 offset:34816
  ds_read_b64_tr_b16 v[172:173], v9 offset:32768
  v_mfma_f32_16x16x32_bf16 v[124:127], v[204:207], v[84:87], v[124:127]
  buffer_load_dwordx4 v[72:75], off, s[36:39], s50 offset:1024
  v_mfma_f32_16x16x32_bf16 v[120:123], v[204:207], v[80:83], v[120:123]
  ds_read_b64_tr_b16 v[174:175], v9 offset:34816
  s_waitcnt vmcnt(11) lgkmcnt(8)
  v_mfma_f32_16x16x32_bf16 v[96:99], v[208:211], v[88:91], v[96:99]
  ds_read_b64_tr_b16 v[176:177], v6 offset:36864
  v_mfma_f32_16x16x32_bf16 v[100:103], v[208:211], v[92:95], v[100:103]
  buffer_load_dwordx4 v[76:79], off, s[64:67], s50 offset:1024
  v_mfma_f32_16x16x32_bf16 v[108:111], v[212:215], v[92:95], v[108:111]
  ds_read_b64_tr_b16 v[178:179], v6 offset:38912
  ds_read_b64_tr_b16 v[180:181], v7 offset:36864
  v_mfma_f32_16x16x32_bf16 v[104:107], v[212:215], v[88:91], v[104:107]
  ds_read_b64_tr_b16 v[182:183], v7 offset:38912
  v_mfma_f32_16x16x32_bf16 v[112:115], v[216:219], v[88:91], v[112:115]
  ds_read_b64_tr_b16 v[184:185], v8 offset:36864
  v_mfma_f32_16x16x32_bf16 v[116:119], v[216:219], v[92:95], v[116:119]
  ds_read_b64_tr_b16 v[186:187], v8 offset:38912
  v_readlane_b32 s51, v15, 7
  v_mfma_f32_16x16x32_bf16 v[124:127], v[220:223], v[92:95], v[124:127]
  ds_read_b64_tr_b16 v[188:189], v9 offset:36864
  v_mfma_f32_16x16x32_bf16 v[120:123], v[220:223], v[88:91], v[120:123]
  ds_read_b64_tr_b16 v[190:191], v9 offset:38912
  s_waitcnt vmcnt(10) lgkmcnt(8)
  v_mfma_f32_16x16x32_bf16 v[96:99], v[160:163], v[32:35], v[96:99]
  buffer_load_dwordx4 v[80:83], off, s[36:39], s51 offset:0
  v_mfma_f32_16x16x32_bf16 v[100:103], v[160:163], v[36:39], v[100:103]
  ds_read_b64_tr_b16 v[192:193], v6 offset:40960
  ds_read_b64_tr_b16 v[194:195], v6 offset:43008
  v_mfma_f32_16x16x32_bf16 v[108:111], v[164:167], v[36:39], v[108:111]
  ds_read_b64_tr_b16 v[196:197], v7 offset:40960
  v_mfma_f32_16x16x32_bf16 v[104:107], v[164:167], v[32:35], v[104:107]
  buffer_load_dwordx4 v[84:87], off, s[64:67], s51 offset:0
  v_mfma_f32_16x16x32_bf16 v[112:115], v[168:171], v[32:35], v[112:115]
  ds_read_b64_tr_b16 v[198:199], v7 offset:43008
  ds_read_b64_tr_b16 v[200:201], v8 offset:40960
  v_mfma_f32_16x16x32_bf16 v[116:119], v[168:171], v[36:39], v[116:119]
  ds_read_b64_tr_b16 v[202:203], v8 offset:43008
  ds_read_b64_tr_b16 v[204:205], v9 offset:40960
  v_mfma_f32_16x16x32_bf16 v[124:127], v[172:175], v[36:39], v[124:127]
  buffer_load_dwordx4 v[88:91], off, s[36:39], s51 offset:1024
  v_mfma_f32_16x16x32_bf16 v[120:123], v[172:175], v[32:35], v[120:123]
  ds_read_b64_tr_b16 v[206:207], v9 offset:43008
  s_waitcnt vmcnt(11) lgkmcnt(8)
  s_barrier
  v_mfma_f32_16x16x32_bf16 v[96:99], v[176:179], v[40:43], v[96:99]
  ds_read_b64_tr_b16 v[208:209], v6 offset:45056
  v_mfma_f32_16x16x32_bf16 v[100:103], v[176:179], v[44:47], v[100:103]
  buffer_load_dwordx4 v[92:95], off, s[64:67], s51 offset:1024
  v_mfma_f32_16x16x32_bf16 v[108:111], v[180:183], v[44:47], v[108:111]
  ds_read_b64_tr_b16 v[210:211], v6 offset:47104
  ds_read_b64_tr_b16 v[212:213], v7 offset:45056
  v_mfma_f32_16x16x32_bf16 v[104:107], v[180:183], v[40:43], v[104:107]
  ds_read_b64_tr_b16 v[214:215], v7 offset:47104
  v_mfma_f32_16x16x32_bf16 v[112:115], v[184:187], v[40:43], v[112:115]
  ds_read_b64_tr_b16 v[216:217], v8 offset:45056
  v_mfma_f32_16x16x32_bf16 v[116:119], v[184:187], v[44:47], v[116:119]
  ds_read_b64_tr_b16 v[218:219], v8 offset:47104
  v_readlane_b32 s48, v15, 8
  v_mfma_f32_16x16x32_bf16 v[124:127], v[188:191], v[44:47], v[124:127]
  ds_read_b64_tr_b16 v[220:221], v9 offset:45056
  v_mfma_f32_16x16x32_bf16 v[120:123], v[188:191], v[40:43], v[120:123]
  ds_read_b64_tr_b16 v[222:223], v9 offset:47104
  s_waitcnt vmcnt(10) lgkmcnt(8)
  v_mfma_f32_16x16x32_bf16 v[96:99], v[192:195], v[48:51], v[96:99]
  buffer_load_dwordx4 v[32:35], off, s[36:39], s48 offset:0
  v_mfma_f32_16x16x32_bf16 v[100:103], v[192:195], v[52:55], v[100:103]
  ds_read_b64_tr_b16 v[160:161], v6 offset:49152
  ds_read_b64_tr_b16 v[162:163], v6 offset:51200
  v_mfma_f32_16x16x32_bf16 v[108:111], v[196:199], v[52:55], v[108:111]
  ds_read_b64_tr_b16 v[164:165], v7 offset:49152
  v_mfma_f32_16x16x32_bf16 v[104:107], v[196:199], v[48:51], v[104:107]
  buffer_load_dwordx4 v[36:39], off, s[64:67], s48 offset:0
  v_mfma_f32_16x16x32_bf16 v[112:115], v[200:203], v[48:51], v[112:115]
  ds_read_b64_tr_b16 v[166:167], v7 offset:51200
  ds_read_b64_tr_b16 v[168:169], v8 offset:49152
  v_mfma_f32_16x16x32_bf16 v[116:119], v[200:203], v[52:55], v[116:119]
  ds_read_b64_tr_b16 v[170:171], v8 offset:51200
  ds_read_b64_tr_b16 v[172:173], v9 offset:49152
  v_mfma_f32_16x16x32_bf16 v[124:127], v[204:207], v[52:55], v[124:127]
  buffer_load_dwordx4 v[40:43], off, s[36:39], s48 offset:1024
  v_mfma_f32_16x16x32_bf16 v[120:123], v[204:207], v[48:51], v[120:123]
  ds_read_b64_tr_b16 v[174:175], v9 offset:51200
  s_waitcnt vmcnt(11) lgkmcnt(8)
  v_mfma_f32_16x16x32_bf16 v[96:99], v[208:211], v[56:59], v[96:99]
  ds_read_b64_tr_b16 v[176:177], v6 offset:53248
  v_mfma_f32_16x16x32_bf16 v[100:103], v[208:211], v[60:63], v[100:103]
  buffer_load_dwordx4 v[44:47], off, s[64:67], s48 offset:1024
  v_mfma_f32_16x16x32_bf16 v[108:111], v[212:215], v[60:63], v[108:111]
  ds_read_b64_tr_b16 v[178:179], v6 offset:55296
  ds_read_b64_tr_b16 v[180:181], v7 offset:53248
  v_mfma_f32_16x16x32_bf16 v[104:107], v[212:215], v[56:59], v[104:107]
  ds_read_b64_tr_b16 v[182:183], v7 offset:55296
  v_mfma_f32_16x16x32_bf16 v[112:115], v[216:219], v[56:59], v[112:115]
  ds_read_b64_tr_b16 v[184:185], v8 offset:53248
  v_mfma_f32_16x16x32_bf16 v[116:119], v[216:219], v[60:63], v[116:119]
  ds_read_b64_tr_b16 v[186:187], v8 offset:55296
  v_readlane_b32 s49, v15, 9
  v_mfma_f32_16x16x32_bf16 v[124:127], v[220:223], v[60:63], v[124:127]
  ds_read_b64_tr_b16 v[188:189], v9 offset:53248
  v_mfma_f32_16x16x32_bf16 v[120:123], v[220:223], v[56:59], v[120:123]
  ds_read_b64_tr_b16 v[190:191], v9 offset:55296
  s_waitcnt vmcnt(10) lgkmcnt(8)
  v_mfma_f32_16x16x32_bf16 v[96:99], v[160:163], v[64:67], v[96:99]
  buffer_load_dwordx4 v[48:51], off, s[36:39], s49 offset:0
  v_mfma_f32_16x16x32_bf16 v[100:103], v[160:163], v[68:71], v[100:103]
  ds_read_b64_tr_b16 v[192:193], v6 offset:57344
  ds_read_b64_tr_b16 v[194:195], v6 offset:59392
  v_mfma_f32_16x16x32_bf16 v[108:111], v[164:167], v[68:71], v[108:111]
  ds_read_b64_tr_b16 v[196:197], v7 offset:57344
  v_mfma_f32_16x16x32_bf16 v[104:107], v[164:167], v[64:67], v[104:107]
  buffer_load_dwordx4 v[52:55], off, s[64:67], s49 offset:0
  v_mfma_f32_16x16x32_bf16 v[112:115], v[168:171], v[64:67], v[112:115]
  ds_read_b64_tr_b16 v[198:199], v7 offset:59392
  ds_read_b64_tr_b16 v[200:201], v8 offset:57344
  v_mfma_f32_16x16x32_bf16 v[116:119], v[168:171], v[68:71], v[116:119]
  ds_read_b64_tr_b16 v[202:203], v8 offset:59392
  ds_read_b64_tr_b16 v[204:205], v9 offset:57344
  v_mfma_f32_16x16x32_bf16 v[124:127], v[172:175], v[68:71], v[124:127]
  buffer_load_dwordx4 v[56:59], off, s[36:39], s49 offset:1024
  v_mfma_f32_16x16x32_bf16 v[120:123], v[172:175], v[64:67], v[120:123]
  ds_read_b64_tr_b16 v[206:207], v9 offset:59392
  s_waitcnt vmcnt(11) lgkmcnt(8)
  v_mfma_f32_16x16x32_bf16 v[96:99], v[176:179], v[72:75], v[96:99]
  ds_read_b64_tr_b16 v[208:209], v6 offset:61440
  v_mfma_f32_16x16x32_bf16 v[100:103], v[176:179], v[76:79], v[100:103]
  buffer_load_dwordx4 v[60:63], off, s[64:67], s49 offset:1024
  v_mfma_f32_16x16x32_bf16 v[108:111], v[180:183], v[76:79], v[108:111]
  ds_read_b64_tr_b16 v[210:211], v6 offset:63488
  ds_read_b64_tr_b16 v[212:213], v7 offset:61440
  v_mfma_f32_16x16x32_bf16 v[104:107], v[180:183], v[72:75], v[104:107]
  ds_read_b64_tr_b16 v[214:215], v7 offset:63488
  v_mfma_f32_16x16x32_bf16 v[112:115], v[184:187], v[72:75], v[112:115]
  ds_read_b64_tr_b16 v[216:217], v8 offset:61440
  v_mfma_f32_16x16x32_bf16 v[116:119], v[184:187], v[76:79], v[116:119]
  ds_read_b64_tr_b16 v[218:219], v8 offset:63488
  v_readlane_b32 s50, v15, 10
  v_mfma_f32_16x16x32_bf16 v[124:127], v[188:191], v[76:79], v[124:127]
  ds_read_b64_tr_b16 v[220:221], v9 offset:61440
  v_mfma_f32_16x16x32_bf16 v[120:123], v[188:191], v[72:75], v[120:123]
  ds_read_b64_tr_b16 v[222:223], v9 offset:63488
  s_waitcnt vmcnt(10) lgkmcnt(8)
  v_mfma_f32_16x16x32_bf16 v[96:99], v[192:195], v[80:83], v[96:99]
  buffer_load_dwordx4 v[64:67], off, s[36:39], s50 offset:0
  v_mfma_f32_16x16x32_bf16 v[100:103], v[192:195], v[84:87], v[100:103]
  ds_read_b64_tr_b16 v[160:161], v20 offset:0
  ds_read_b64_tr_b16 v[162:163], v20 offset:2048
  v_mfma_f32_16x16x32_bf16 v[108:111], v[196:199], v[84:87], v[108:111]
  ds_read_b64_tr_b16 v[164:165], v21 offset:0
  v_mfma_f32_16x16x32_bf16 v[104:107], v[196:199], v[80:83], v[104:107]
  buffer_load_dwordx4 v[68:71], off, s[64:67], s50 offset:0
  v_mfma_f32_16x16x32_bf16 v[112:115], v[200:203], v[80:83], v[112:115]
  ds_read_b64_tr_b16 v[166:167], v21 offset:2048
  ds_read_b64_tr_b16 v[168:169], v22 offset:0
  v_mfma_f32_16x16x32_bf16 v[116:119], v[200:203], v[84:87], v[116:119]
  ds_read_b64_tr_b16 v[170:171], v22 offset:2048
  ds_read_b64_tr_b16 v[172:173], v23 offset:0
  v_mfma_f32_16x16x32_bf16 v[124:127], v[204:207], v[84:87], v[124:127]
  buffer_load_dwordx4 v[72:75], off, s[36:39], s50 offset:1024
  v_mfma_f32_16x16x32_bf16 v[120:123], v[204:207], v[80:83], v[120:123]
  ds_read_b64_tr_b16 v[174:175], v23 offset:2048
  s_waitcnt vmcnt(11) lgkmcnt(8)
  v_mfma_f32_16x16x32_bf16 v[96:99], v[208:211], v[88:91], v[96:99]
  ds_read_b64_tr_b16 v[176:177], v20 offset:4096
  v_mfma_f32_16x16x32_bf16 v[100:103], v[208:211], v[92:95], v[100:103]
  buffer_load_dwordx4 v[76:79], off, s[64:67], s50 offset:1024
  v_mfma_f32_16x16x32_bf16 v[108:111], v[212:215], v[92:95], v[108:111]
  ds_read_b64_tr_b16 v[178:179], v20 offset:6144
  ds_read_b64_tr_b16 v[180:181], v21 offset:4096
  v_mfma_f32_16x16x32_bf16 v[104:107], v[212:215], v[88:91], v[104:107]
  ds_read_b64_tr_b16 v[182:183], v21 offset:6144
  v_mfma_f32_16x16x32_bf16 v[112:115], v[216:219], v[88:91], v[112:115]
  ds_read_b64_tr_b16 v[184:185], v22 offset:4096
  v_mfma_f32_16x16x32_bf16 v[116:119], v[216:219], v[92:95], v[116:119]
  ds_read_b64_tr_b16 v[186:187], v22 offset:6144
  v_readlane_b32 s51, v15, 11
  v_mfma_f32_16x16x32_bf16 v[124:127], v[220:223], v[92:95], v[124:127]
  ds_read_b64_tr_b16 v[188:189], v23 offset:4096
  v_mfma_f32_16x16x32_bf16 v[120:123], v[220:223], v[88:91], v[120:123]
  ds_read_b64_tr_b16 v[190:191], v23 offset:6144
  s_waitcnt vmcnt(10) lgkmcnt(8)
  v_mfma_f32_16x16x32_bf16 v[96:99], v[160:163], v[32:35], v[96:99]
  buffer_load_dwordx4 v[80:83], off, s[36:39], s51 offset:0
  v_mfma_f32_16x16x32_bf16 v[100:103], v[160:163], v[36:39], v[100:103]
  ds_read_b64_tr_b16 v[192:193], v20 offset:8192
  ds_read_b64_tr_b16 v[194:195], v20 offset:10240
  v_mfma_f32_16x16x32_bf16 v[108:111], v[164:167], v[36:39], v[108:111]
  ds_read_b64_tr_b16 v[196:197], v21 offset:8192
  v_mfma_f32_16x16x32_bf16 v[104:107], v[164:167], v[32:35], v[104:107]
  buffer_load_dwordx4 v[84:87], off, s[64:67], s51 offset:0
  v_mfma_f32_16x16x32_bf16 v[112:115], v[168:171], v[32:35], v[112:115]
  ds_read_b64_tr_b16 v[198:199], v21 offset:10240
  ds_read_b64_tr_b16 v[200:201], v22 offset:8192
  v_mfma_f32_16x16x32_bf16 v[116:119], v[168:171], v[36:39], v[116:119]
  ds_read_b64_tr_b16 v[202:203], v22 offset:10240
  ds_read_b64_tr_b16 v[204:205], v23 offset:8192
  v_mfma_f32_16x16x32_bf16 v[124:127], v[172:175], v[36:39], v[124:127]
  buffer_load_dwordx4 v[88:91], off, s[36:39], s51 offset:1024
  v_mfma_f32_16x16x32_bf16 v[120:123], v[172:175], v[32:35], v[120:123]
  ds_read_b64_tr_b16 v[206:207], v23 offset:10240
  s_waitcnt vmcnt(11) lgkmcnt(8)
  v_mfma_f32_16x16x32_bf16 v[96:99], v[176:179], v[40:43], v[96:99]
  ds_read_b64_tr_b16 v[208:209], v20 offset:12288
  v_mfma_f32_16x16x32_bf16 v[100:103], v[176:179], v[44:47], v[100:103]
  buffer_load_dwordx4 v[92:95], off, s[64:67], s51 offset:1024
  v_mfma_f32_16x16x32_bf16 v[108:111], v[180:183], v[44:47], v[108:111]
  ds_read_b64_tr_b16 v[210:211], v20 offset:14336
  ds_read_b64_tr_b16 v[212:213], v21 offset:12288
  v_mfma_f32_16x16x32_bf16 v[104:107], v[180:183], v[40:43], v[104:107]
  ds_read_b64_tr_b16 v[214:215], v21 offset:14336
  v_mfma_f32_16x16x32_bf16 v[112:115], v[184:187], v[40:43], v[112:115]
  ds_read_b64_tr_b16 v[216:217], v22 offset:12288
  v_mfma_f32_16x16x32_bf16 v[116:119], v[184:187], v[44:47], v[116:119]
  ds_read_b64_tr_b16 v[218:219], v22 offset:14336
  v_readlane_b32 s48, v15, 12
  v_mfma_f32_16x16x32_bf16 v[124:127], v[188:191], v[44:47], v[124:127]
  ds_read_b64_tr_b16 v[220:221], v23 offset:12288
  v_mfma_f32_16x16x32_bf16 v[120:123], v[188:191], v[40:43], v[120:123]
  ds_read_b64_tr_b16 v[222:223], v23 offset:14336
  s_waitcnt vmcnt(10) lgkmcnt(8)
  v_mfma_f32_16x16x32_bf16 v[96:99], v[192:195], v[48:51], v[96:99]
  buffer_load_dwordx4 v[32:35], off, s[36:39], s48 offset:0
  v_mfma_f32_16x16x32_bf16 v[100:103], v[192:195], v[52:55], v[100:103]
  ds_read_b64_tr_b16 v[160:161], v20 offset:16384
  ds_read_b64_tr_b16 v[162:163], v20 offset:18432
  v_mfma_f32_16x16x32_bf16 v[108:111], v[196:199], v[52:55], v[108:111]
  ds_read_b64_tr_b16 v[164:165], v21 offset:16384
  v_mfma_f32_16x16x32_bf16 v[104:107], v[196:199], v[48:51], v[104:107]
  buffer_load_dwordx4 v[36:39], off, s[64:67], s48 offset:0
  v_mfma_f32_16x16x32_bf16 v[112:115], v[200:203], v[48:51], v[112:115]
  ds_read_b64_tr_b16 v[166:167], v21 offset:18432
  ds_read_b64_tr_b16 v[168:169], v22 offset:16384
  v_mfma_f32_16x16x32_bf16 v[116:119], v[200:203], v[52:55], v[116:119]
  ds_read_b64_tr_b16 v[170:171], v22 offset:18432
  ds_read_b64_tr_b16 v[172:173], v23 offset:16384
  v_mfma_f32_16x16x32_bf16 v[124:127], v[204:207], v[52:55], v[124:127]
  buffer_load_dwordx4 v[40:43], off, s[36:39], s48 offset:1024
  v_mfma_f32_16x16x32_bf16 v[120:123], v[204:207], v[48:51], v[120:123]
  ds_read_b64_tr_b16 v[174:175], v23 offset:18432
  s_waitcnt vmcnt(11) lgkmcnt(8)
  v_mfma_f32_16x16x32_bf16 v[96:99], v[208:211], v[56:59], v[96:99]
  ds_read_b64_tr_b16 v[176:177], v20 offset:20480
  v_mfma_f32_16x16x32_bf16 v[100:103], v[208:211], v[60:63], v[100:103]
  buffer_load_dwordx4 v[44:47], off, s[64:67], s48 offset:1024
  v_mfma_f32_16x16x32_bf16 v[108:111], v[212:215], v[60:63], v[108:111]
  ds_read_b64_tr_b16 v[178:179], v20 offset:22528
  ds_read_b64_tr_b16 v[180:181], v21 offset:20480
  v_mfma_f32_16x16x32_bf16 v[104:107], v[212:215], v[56:59], v[104:107]
  ds_read_b64_tr_b16 v[182:183], v21 offset:22528
  v_mfma_f32_16x16x32_bf16 v[112:115], v[216:219], v[56:59], v[112:115]
  ds_read_b64_tr_b16 v[184:185], v22 offset:20480
  v_mfma_f32_16x16x32_bf16 v[116:119], v[216:219], v[60:63], v[116:119]
  ds_read_b64_tr_b16 v[186:187], v22 offset:22528
  v_readlane_b32 s49, v15, 13
  v_mfma_f32_16x16x32_bf16 v[124:127], v[220:223], v[60:63], v[124:127]
  ds_read_b64_tr_b16 v[188:189], v23 offset:20480
  v_mfma_f32_16x16x32_bf16 v[120:123], v[220:223], v[56:59], v[120:123]
  ds_read_b64_tr_b16 v[190:191], v23 offset:22528
  s_waitcnt vmcnt(10) lgkmcnt(8)
  v_mfma_f32_16x16x32_bf16 v[96:99], v[160:163], v[64:67], v[96:99]
  buffer_load_dwordx4 v[48:51], off, s[36:39], s49 offset:0
  v_mfma_f32_16x16x32_bf16 v[100:103], v[160:163], v[68:71], v[100:103]
  ds_read_b64_tr_b16 v[192:193], v20 offset:24576
  ds_read_b64_tr_b16 v[194:195], v20 offset:26624
  v_mfma_f32_16x16x32_bf16 v[108:111], v[164:167], v[68:71], v[108:111]
  ds_read_b64_tr_b16 v[196:197], v21 offset:24576
  v_mfma_f32_16x16x32_bf16 v[104:107], v[164:167], v[64:67], v[104:107]
  buffer_load_dwordx4 v[52:55], off, s[64:67], s49 offset:0
  v_mfma_f32_16x16x32_bf16 v[112:115], v[168:171], v[64:67], v[112:115]
  ds_read_b64_tr_b16 v[198:199], v21 offset:26624
  ds_read_b64_tr_b16 v[200:201], v22 offset:24576
  v_mfma_f32_16x16x32_bf16 v[116:119], v[168:171], v[68:71], v[116:119]
  ds_read_b64_tr_b16 v[202:203], v22 offset:26624
  ds_read_b64_tr_b16 v[204:205], v23 offset:24576
  v_mfma_f32_16x16x32_bf16 v[124:127], v[172:175], v[68:71], v[124:127]
  buffer_load_dwordx4 v[56:59], off, s[36:39], s49 offset:1024
  v_mfma_f32_16x16x32_bf16 v[120:123], v[172:175], v[64:67], v[120:123]
  ds_read_b64_tr_b16 v[206:207], v23 offset:26624
  s_waitcnt vmcnt(11) lgkmcnt(8)
  v_mfma_f32_16x16x32_bf16 v[96:99], v[176:179], v[72:75], v[96:99]
  ds_read_b64_tr_b16 v[208:209], v20 offset:28672
  v_mfma_f32_16x16x32_bf16 v[100:103], v[176:179], v[76:79], v[100:103]
  buffer_load_dwordx4 v[60:63], off, s[64:67], s49 offset:1024
  v_mfma_f32_16x16x32_bf16 v[108:111], v[180:183], v[76:79], v[108:111]
  ds_read_b64_tr_b16 v[210:211], v20 offset:30720
  ds_read_b64_tr_b16 v[212:213], v21 offset:28672
  v_mfma_f32_16x16x32_bf16 v[104:107], v[180:183], v[72:75], v[104:107]
  ds_read_b64_tr_b16 v[214:215], v21 offset:30720
  v_mfma_f32_16x16x32_bf16 v[112:115], v[184:187], v[72:75], v[112:115]
  ds_read_b64_tr_b16 v[216:217], v22 offset:28672
  v_mfma_f32_16x16x32_bf16 v[116:119], v[184:187], v[76:79], v[116:119]
  ds_read_b64_tr_b16 v[218:219], v22 offset:30720
  v_readlane_b32 s50, v15, 14
  v_mfma_f32_16x16x32_bf16 v[124:127], v[188:191], v[76:79], v[124:127]
  ds_read_b64_tr_b16 v[220:221], v23 offset:28672
  v_mfma_f32_16x16x32_bf16 v[120:123], v[188:191], v[72:75], v[120:123]
  ds_read_b64_tr_b16 v[222:223], v23 offset:30720
  s_waitcnt vmcnt(10) lgkmcnt(8)
  v_mfma_f32_16x16x32_bf16 v[96:99], v[192:195], v[80:83], v[96:99]
  buffer_load_dwordx4 v[64:67], off, s[36:39], s50 offset:0
  v_mfma_f32_16x16x32_bf16 v[100:103], v[192:195], v[84:87], v[100:103]
  ds_read_b64_tr_b16 v[160:161], v20 offset:36864
  ds_read_b64_tr_b16 v[162:163], v20 offset:38912
  v_mfma_f32_16x16x32_bf16 v[108:111], v[196:199], v[84:87], v[108:111]
  ds_read_b64_tr_b16 v[164:165], v21 offset:36864
  v_mfma_f32_16x16x32_bf16 v[104:107], v[196:199], v[80:83], v[104:107]
  buffer_load_dwordx4 v[68:71], off, s[64:67], s50 offset:0
  v_mfma_f32_16x16x32_bf16 v[112:115], v[200:203], v[80:83], v[112:115]
  ds_read_b64_tr_b16 v[166:167], v21 offset:38912
  ds_read_b64_tr_b16 v[168:169], v22 offset:36864
  v_mfma_f32_16x16x32_bf16 v[116:119], v[200:203], v[84:87], v[116:119]
  ds_read_b64_tr_b16 v[170:171], v22 offset:38912
  ds_read_b64_tr_b16 v[172:173], v23 offset:36864
  v_mfma_f32_16x16x32_bf16 v[124:127], v[204:207], v[84:87], v[124:127]
  buffer_load_dwordx4 v[72:75], off, s[36:39], s50 offset:1024
  v_mfma_f32_16x16x32_bf16 v[120:123], v[204:207], v[80:83], v[120:123]
  ds_read_b64_tr_b16 v[174:175], v23 offset:38912
  s_waitcnt vmcnt(11) lgkmcnt(8)
  v_mfma_f32_16x16x32_bf16 v[96:99], v[208:211], v[88:91], v[96:99]
  ds_read_b64_tr_b16 v[176:177], v20 offset:40960
  v_mfma_f32_16x16x32_bf16 v[100:103], v[208:211], v[92:95], v[100:103]
  buffer_load_dwordx4 v[76:79], off, s[64:67], s50 offset:1024
  v_mfma_f32_16x16x32_bf16 v[108:111], v[212:215], v[92:95], v[108:111]
  ds_read_b64_tr_b16 v[178:179], v20 offset:43008
  ds_read_b64_tr_b16 v[180:181], v21 offset:40960
  v_mfma_f32_16x16x32_bf16 v[104:107], v[212:215], v[88:91], v[104:107]
  ds_read_b64_tr_b16 v[182:183], v21 offset:43008
  v_mfma_f32_16x16x32_bf16 v[112:115], v[216:219], v[88:91], v[112:115]
  ds_read_b64_tr_b16 v[184:185], v22 offset:40960
  v_mfma_f32_16x16x32_bf16 v[116:119], v[216:219], v[92:95], v[116:119]
  ds_read_b64_tr_b16 v[186:187], v22 offset:43008
  v_readlane_b32 s51, v15, 15
  v_mfma_f32_16x16x32_bf16 v[124:127], v[220:223], v[92:95], v[124:127]
  ds_read_b64_tr_b16 v[188:189], v23 offset:40960
  v_mfma_f32_16x16x32_bf16 v[120:123], v[220:223], v[88:91], v[120:123]
  ds_read_b64_tr_b16 v[190:191], v23 offset:43008
  s_waitcnt vmcnt(10) lgkmcnt(8)
  v_mfma_f32_16x16x32_bf16 v[96:99], v[160:163], v[32:35], v[96:99]
  buffer_load_dwordx4 v[80:83], off, s[36:39], s51 offset:0
  v_mfma_f32_16x16x32_bf16 v[100:103], v[160:163], v[36:39], v[100:103]
  ds_read_b64_tr_b16 v[192:193], v20 offset:45056
  ds_read_b64_tr_b16 v[194:195], v20 offset:47104
  v_mfma_f32_16x16x32_bf16 v[108:111], v[164:167], v[36:39], v[108:111]
  ds_read_b64_tr_b16 v[196:197], v21 offset:45056
  v_mfma_f32_16x16x32_bf16 v[104:107], v[164:167], v[32:35], v[104:107]
  buffer_load_dwordx4 v[84:87], off, s[64:67], s51 offset:0
  v_mfma_f32_16x16x32_bf16 v[112:115], v[168:171], v[32:35], v[112:115]
  ds_read_b64_tr_b16 v[198:199], v21 offset:47104
  ds_read_b64_tr_b16 v[200:201], v22 offset:45056
  v_mfma_f32_16x16x32_bf16 v[116:119], v[168:171], v[36:39], v[116:119]
  ds_read_b64_tr_b16 v[202:203], v22 offset:47104
  ds_read_b64_tr_b16 v[204:205], v23 offset:45056
  v_mfma_f32_16x16x32_bf16 v[124:127], v[172:175], v[36:39], v[124:127]
  buffer_load_dwordx4 v[88:91], off, s[36:39], s51 offset:1024
  v_mfma_f32_16x16x32_bf16 v[120:123], v[172:175], v[32:35], v[120:123]
  ds_read_b64_tr_b16 v[206:207], v23 offset:47104
  s_waitcnt vmcnt(11) lgkmcnt(8)
  v_mfma_f32_16x16x32_bf16 v[96:99], v[176:179], v[40:43], v[96:99]
  ds_read_b64_tr_b16 v[208:209], v20 offset:49152
  v_mfma_f32_16x16x32_bf16 v[100:103], v[176:179], v[44:47], v[100:103]
  buffer_load_dwordx4 v[92:95], off, s[64:67], s51 offset:1024
  v_mfma_f32_16x16x32_bf16 v[108:111], v[180:183], v[44:47], v[108:111]
  ds_read_b64_tr_b16 v[210:211], v20 offset:51200
  ds_read_b64_tr_b16 v[212:213], v21 offset:49152
  v_mfma_f32_16x16x32_bf16 v[104:107], v[180:183], v[40:43], v[104:107]
  ds_read_b64_tr_b16 v[214:215], v21 offset:51200
  v_mfma_f32_16x16x32_bf16 v[112:115], v[184:187], v[40:43], v[112:115]
  ds_read_b64_tr_b16 v[216:217], v22 offset:49152
  v_mfma_f32_16x16x32_bf16 v[116:119], v[184:187], v[44:47], v[116:119]
  ds_read_b64_tr_b16 v[218:219], v22 offset:51200
  v_mfma_f32_16x16x32_bf16 v[124:127], v[188:191], v[44:47], v[124:127]
  ds_read_b64_tr_b16 v[220:221], v23 offset:49152
  v_mfma_f32_16x16x32_bf16 v[120:123], v[188:191], v[40:43], v[120:123]
  ds_read_b64_tr_b16 v[222:223], v23 offset:51200
  s_waitcnt vmcnt(10) lgkmcnt(8)
  v_mfma_f32_16x16x32_bf16 v[96:99], v[192:195], v[48:51], v[96:99]
  ds_read_b64_tr_b16 v[160:161], v20 offset:53248
  v_mfma_f32_16x16x32_bf16 v[100:103], v[192:195], v[52:55], v[100:103]
  ds_read_b64_tr_b16 v[162:163], v20 offset:55296
  v_mfma_f32_16x16x32_bf16 v[108:111], v[196:199], v[52:55], v[108:111]
  ds_read_b64_tr_b16 v[164:165], v21 offset:53248
  v_mfma_f32_16x16x32_bf16 v[104:107], v[196:199], v[48:51], v[104:107]
  ds_read_b64_tr_b16 v[166:167], v21 offset:55296
  v_mfma_f32_16x16x32_bf16 v[112:115], v[200:203], v[48:51], v[112:115]
  ds_read_b64_tr_b16 v[168:169], v22 offset:53248
  v_mfma_f32_16x16x32_bf16 v[116:119], v[200:203], v[52:55], v[116:119]
  ds_read_b64_tr_b16 v[170:171], v22 offset:55296
  v_mfma_f32_16x16x32_bf16 v[124:127], v[204:207], v[52:55], v[124:127]
  ds_read_b64_tr_b16 v[172:173], v23 offset:53248
  v_mfma_f32_16x16x32_bf16 v[120:123], v[204:207], v[48:51], v[120:123]
  ds_read_b64_tr_b16 v[174:175], v23 offset:55296
  s_waitcnt vmcnt(8) lgkmcnt(8)
  s_barrier
  v_mfma_f32_16x16x32_bf16 v[96:99], v[208:211], v[56:59], v[96:99]
  ds_read_b64_tr_b16 v[176:177], v20 offset:57344
  v_mfma_f32_16x16x32_bf16 v[100:103], v[208:211], v[60:63], v[100:103]
  ds_read_b64_tr_b16 v[178:179], v20 offset:59392
  v_mfma_f32_16x16x32_bf16 v[108:111], v[212:215], v[60:63], v[108:111]
  ds_read_b64_tr_b16 v[180:181], v21 offset:57344
  v_mfma_f32_16x16x32_bf16 v[104:107], v[212:215], v[56:59], v[104:107]
  ds_read_b64_tr_b16 v[182:183], v21 offset:59392
  v_mfma_f32_16x16x32_bf16 v[112:115], v[216:219], v[56:59], v[112:115]
  ds_read_b64_tr_b16 v[184:185], v22 offset:57344
  v_mfma_f32_16x16x32_bf16 v[116:119], v[216:219], v[60:63], v[116:119]
  ds_read_b64_tr_b16 v[186:187], v22 offset:59392
  v_mfma_f32_16x16x32_bf16 v[124:127], v[220:223], v[60:63], v[124:127]
  ds_read_b64_tr_b16 v[188:189], v23 offset:57344
  v_mfma_f32_16x16x32_bf16 v[120:123], v[220:223], v[56:59], v[120:123]
  ds_read_b64_tr_b16 v[190:191], v23 offset:59392
  s_waitcnt vmcnt(6) lgkmcnt(8)
  v_mfma_f32_16x16x32_bf16 v[96:99], v[160:163], v[64:67], v[96:99]
  ds_read_b64_tr_b16 v[192:193], v26 offset:0
  v_mfma_f32_16x16x32_bf16 v[100:103], v[160:163], v[68:71], v[100:103]
  ds_read_b64_tr_b16 v[194:195], v26 offset:2048
  v_mfma_f32_16x16x32_bf16 v[108:111], v[164:167], v[68:71], v[108:111]
  ds_read_b64_tr_b16 v[196:197], v27 offset:0
  v_mfma_f32_16x16x32_bf16 v[104:107], v[164:167], v[64:67], v[104:107]
  ds_read_b64_tr_b16 v[198:199], v27 offset:2048
  v_mfma_f32_16x16x32_bf16 v[112:115], v[168:171], v[64:67], v[112:115]
  ds_read_b64_tr_b16 v[200:201], v28 offset:0
  v_mfma_f32_16x16x32_bf16 v[116:119], v[168:171], v[68:71], v[116:119]
  ds_read_b64_tr_b16 v[202:203], v28 offset:2048
  v_mfma_f32_16x16x32_bf16 v[124:127], v[172:175], v[68:71], v[124:127]
  ds_read_b64_tr_b16 v[204:205], v29 offset:0
  v_mfma_f32_16x16x32_bf16 v[120:123], v[172:175], v[64:67], v[120:123]
  ds_read_b64_tr_b16 v[206:207], v29 offset:2048
  s_waitcnt vmcnt(4) lgkmcnt(8)
  v_mfma_f32_16x16x32_bf16 v[96:99], v[176:179], v[72:75], v[96:99]
  ds_read_b64_tr_b16 v[208:209], v26 offset:4096
  v_mfma_f32_16x16x32_bf16 v[100:103], v[176:179], v[76:79], v[100:103]
  ds_read_b64_tr_b16 v[210:211], v26 offset:6144
  v_mfma_f32_16x16x32_bf16 v[108:111], v[180:183], v[76:79], v[108:111]
  ds_read_b64_tr_b16 v[212:213], v27 offset:4096
  v_mfma_f32_16x16x32_bf16 v[104:107], v[180:183], v[72:75], v[104:107]
  ds_read_b64_tr_b16 v[214:215], v27 offset:6144
  v_mfma_f32_16x16x32_bf16 v[112:115], v[184:187], v[72:75], v[112:115]
  ds_read_b64_tr_b16 v[216:217], v28 offset:4096
  v_mfma_f32_16x16x32_bf16 v[116:119], v[184:187], v[76:79], v[116:119]
  ds_read_b64_tr_b16 v[218:219], v28 offset:6144
  v_mfma_f32_16x16x32_bf16 v[124:127], v[188:191], v[76:79], v[124:127]
  ds_read_b64_tr_b16 v[220:221], v29 offset:4096
  v_mfma_f32_16x16x32_bf16 v[120:123], v[188:191], v[72:75], v[120:123]
  ds_read_b64_tr_b16 v[222:223], v29 offset:6144
  s_waitcnt vmcnt(2) lgkmcnt(8)
  v_mfma_f32_16x16x32_bf16 v[96:99], v[192:195], v[80:83], v[96:99]
  v_mov_b32 v20, 0
  v_mov_b32 v21, 0
  v_mfma_f32_16x16x32_bf16 v[100:103], v[192:195], v[84:87], v[100:103]
  v_mov_b32 v22, 0
  v_mov_b32 v23, 0
  v_mfma_f32_16x16x32_bf16 v[108:111], v[196:199], v[84:87], v[108:111]
  v_mfma_f32_16x16x32_bf16 v[104:107], v[196:199], v[80:83], v[104:107]
  v_mfma_f32_16x16x32_bf16 v[112:115], v[200:203], v[80:83], v[112:115]
  v_mfma_f32_16x16x32_bf16 v[116:119], v[200:203], v[84:87], v[116:119]
  v_mfma_f32_16x16x32_bf16 v[124:127], v[204:207], v[84:87], v[124:127]
  v_mfma_f32_16x16x32_bf16 v[120:123], v[204:207], v[80:83], v[120:123]
  s_waitcnt vmcnt(0) lgkmcnt(0)
  v_mfma_f32_16x16x32_bf16 v[96:99], v[208:211], v[88:91], v[96:99]
  v_mfma_f32_16x16x32_bf16 v[100:103], v[208:211], v[92:95], v[100:103]
  v_mfma_f32_16x16x32_bf16 v[108:111], v[212:215], v[92:95], v[108:111]
  v_mfma_f32_16x16x32_bf16 v[104:107], v[212:215], v[88:91], v[104:107]
  v_mfma_f32_16x16x32_bf16 v[112:115], v[216:219], v[88:91], v[112:115]
  v_mfma_f32_16x16x32_bf16 v[116:119], v[216:219], v[92:95], v[116:119]
  v_mfma_f32_16x16x32_bf16 v[124:127], v[220:223], v[92:95], v[124:127]
  v_mfma_f32_16x16x32_bf16 v[120:123], v[220:223], v[88:91], v[120:123]
  s_mov_b32 s3, 32768
  s_mov_b32 s10, 0x3f803f80
  s_nop 4
  v_cvt_pk_bf16_f32 v240, v96, v97
  v_cvt_pk_bf16_f32 v241, v98, v99
  v_cvt_pk_bf16_f32 v242, v104, v105
  v_cvt_pk_bf16_f32 v243, v106, v107
  buffer_store_dwordx4 v[240:243], v12, s[44:47], 0 offen offset:0 sc1
  ds_write_b128 v19, v[240:243] offset:0
  v_cvt_pk_bf16_f32 v244, v112, v113
  v_cvt_pk_bf16_f32 v245, v114, v115
  v_cvt_pk_bf16_f32 v246, v120, v121
  v_cvt_pk_bf16_f32 v247, v122, v123
  buffer_store_dwordx4 v[244:247], v12, s[44:47], 0 offen offset:1024 sc1
  ds_write_b128 v19, v[244:247] offset:1024
  v_cvt_pk_bf16_f32 v248, v100, v101
  v_cvt_pk_bf16_f32 v249, v102, v103
  v_cvt_pk_bf16_f32 v250, v108, v109
  v_cvt_pk_bf16_f32 v251, v110, v111
  buffer_store_dwordx4 v[248:251], v12, s[44:47], s3 offen offset:0 sc1
  ds_write_b128 v19, v[248:251] offset:2048
  v_cvt_pk_bf16_f32 v252, v116, v117
  v_cvt_pk_bf16_f32 v253, v118, v119
  v_cvt_pk_bf16_f32 v254, v124, v125
  v_cvt_pk_bf16_f32 v255, v126, v127
  buffer_store_dwordx4 v[252:255], v12, s[44:47], s3 offen offset:1024 sc1
  ds_write_b128 v19, v[252:255] offset:3072
  v_dot2_f32_bf16 v20, v240, s10, v20
  v_dot2_f32_bf16 v22, v240, v240, v22
  v_dot2_f32_bf16 v20, v241, s10, v20
  v_dot2_f32_bf16 v22, v241, v241, v22
  v_dot2_f32_bf16 v20, v242, s10, v20
  v_dot2_f32_bf16 v22, v242, v242, v22
  v_dot2_f32_bf16 v20, v243, s10, v20
  v_dot2_f32_bf16 v22, v243, v243, v22
  v_dot2_f32_bf16 v20, v244, s10, v20
  v_dot2_f32_bf16 v22, v244, v244, v22
  v_dot2_f32_bf16 v20, v245, s10, v20
  v_dot2_f32_bf16 v22, v245, v245, v22
  v_dot2_f32_bf16 v20, v246, s10, v20
  v_dot2_f32_bf16 v22, v246, v246, v22
  v_dot2_f32_bf16 v20, v247, s10, v20
  v_dot2_f32_bf16 v22, v247, v247, v22
  v_dot2_f32_bf16 v21, v248, s10, v21
  v_dot2_f32_bf16 v23, v248, v248, v23
  v_dot2_f32_bf16 v21, v249, s10, v21
  v_dot2_f32_bf16 v23, v249, v249, v23
  v_dot2_f32_bf16 v21, v250, s10, v21
  v_dot2_f32_bf16 v23, v250, v250, v23
  v_dot2_f32_bf16 v21, v251, s10, v21
  v_dot2_f32_bf16 v23, v251, v251, v23
  v_dot2_f32_bf16 v21, v252, s10, v21
  v_dot2_f32_bf16 v23, v252, v252, v23
  v_dot2_f32_bf16 v21, v253, s10, v21
  v_dot2_f32_bf16 v23, v253, v253, v23
  v_dot2_f32_bf16 v21, v254, s10, v21
  v_dot2_f32_bf16 v23, v254, v254, v23
  v_dot2_f32_bf16 v21, v255, s10, v21
  v_dot2_f32_bf16 v23, v255, v255, v23
  s_nop 2
  v_permlane32_swap_b32 v20, v21
  v_permlane32_swap_b32 v22, v23
  v_add_f32 v20, v20, v21
  v_add_f32 v22, v22, v23
  s_nop 1
  v_permlane16_swap_b32 v20, v22
  v_add_f32 v20, v20, v22
  buffer_store_dword v20, v18, s[56:59], 0 offen sc1
  s_waitcnt vmcnt(0) lgkmcnt(0)
  s_barrier
  s_add_u32 s97, s97, 1
  s_branch L_w1_body
L_wo_c1:
L_w1_c0:
L_w1_body:
  s_cmp_ge_u32 s2, 256
  s_cbranch_scc1 L_w1_end
  v_lshrrev_b32 v2, 6, v0
  v_and_b32 v1, 63, v0
  v_readfirstlane_b32 s70, v2
  s_and_b32 s3, s2, 7
  s_lshr_b32 s99, s2, 3
  s_and_b32 s5, s3, 3
  s_lshl_b32 s5, s5, 2
  s_and_b32 s6, s99, 3
  s_add_u32 s68, s5, s6
  s_lshr_b32 s5, s3, 2
  s_lshl_b32 s5, s5, 3
  s_lshr_b32 s6, s99, 2
  s_add_u32 s69, s5, s6
  s_cmp_lt_u32 s70, 4
  s_cbranch_scc1 L_w1_compute
L_w1_loader:
  s_add_u32 s8, s70, s69
  s_and_b32 s8, s8, 3
  s_add_u32 s9, s70, s68
  s_and_b32 s9, s9, 3
  s_lshl_b32 s76, s8, 12
  s_lshl_b32 s77, s9, 11
  s_add_u32 s77, s77, 16384
  s_lshl_b32 s11, s68, 7
  v_and_b32 v10, 7, v1
  s_lshr_b32 s10, s76, 11
  s_lshl_b32 s3, s68, 3
  s_add_u32 s10, s10, s3
  s_mul_i32 s10, s10, 32768
  v_lshl_add_u32 v4, v1, 4, s10
  v_add_u32 v5, 32768, v4
  v_lshrrev_b32 v3, 3, v1
  s_lshl_b32 s10, s9, 4
  v_add_u32 v3, s10, v3
  v_mul_u32_u24 v3, 7168, v3
  v_lshrrev_b32 v2, 3, v1
  v_and_b32 v2, 6, v2
  v_xor_b32 v2, v2, v10
  s_mul_i32 s10, s69, 128
  v_add_u32 v3, s10, v3
  v_lshl_add_u32 v8, v2, 4, v3
  v_add_u32 v3, 57344, v3
  v_lshl_add_u32 v9, v2, 4, v3
  v_lshrrev_b32 v3, 2, v1
  s_lshl_b32 s10, s9, 4
  v_add_u32 v3, s10, v3
  v_mul_u32_u24 v3, 7168, v3
  v_bfe_u32 v2, v1, 4, 1
  v_xor_b32 v2, v2, v1
  v_and_b32 v2, 3, v2
  s_lshl_b32 s10, s69, 6
  s_add_u32 s10, s10, 2048
  v_add_u32 v3, s10, v3
  v_lshl_add_u32 v28, v2, 4, v3
  s_lshl_b32 s78, s69, 7
  s_add_u32 s78, s78, 3072
  s_mov_b32 s75, 0
  s_add_u32 s100, s68, s69
  s_mov_b32 s101, -1
  s_add_u32 s3, s68, s69
  s_and_b32 s3, s3, 3
  s_mov_b32 s100, 0x68532410
  s_mov_b32 s101, 0xfedbac97
  s_cmp_eq_u32 s3, 1
  s_cselect_b32 s100, 0x96435210, s100
  s_cselect_b32 s101, 0xfecbda87, s101
  s_cmp_eq_u32 s3, 2
  s_cselect_b32 s100, 0x75463210, s100
  s_cselect_b32 s101, 0xfdceb98a, s101
  s_cmp_eq_u32 s3, 3
  s_cselect_b32 s100, 0x65743210, s100
  s_cselect_b32 s101, 0xedfca9b8, s101
  s_waitcnt lgkmcnt(0)
  s_mov_b32 s40, s24
  s_and_b32 s41, s25, 0xffff
  s_mov_b32 s42, 7340032
  s_mov_b32 s43, 0x00020000
  s_cmp_lg_u32 s96, 0
  s_cbranch_scc1 L_pfc3_skip
  s_getpc_b64 s[4:5]
L_pfc3:
  s_lshl_b32 s3, s99, 2
  s_add_u32 s3, s3, s70
  s_sub_u32 s3, s3, 4
  s_mul_i32 s3, s3, 192
  s_min_u32 s3, s3, L_w2_c1-L_w2_c0-192
  s_add_i32 s3, s3, L_w2_c0-L_pfc3
  s_ashr_i32 s6, s3, 31
  s_add_u32 s4, s4, s3
  s_addc_u32 s5, s5, s6
  s_load_dword s84, s[4:5], 0
  s_load_dword s84, s[4:5], 64
  s_load_dword s84, s[4:5], 128
L_pfc3_skip:
  s_add_u32 s36, s34, 4194304
  s_addc_u32 s37, s35, 0
  s_and_b32 s37, s37, 0xffff
  s_mov_b32 s38, 4194304
  s_mov_b32 s39, 0x00020000
  s_add_u32 s56, s34, 24117248
  s_addc_u32 s57, s35, 0
  s_and_b32 s57, s57, 0xffff
  s_mov_b32 s58, 262144
  s_mov_b32 s59, 0x00020000
  s_add_u32 s64, s22, 24641536
  s_addc_u32 s65, s23, 0
  s_and_b32 s65, s65, 0xffff
  s_mov_b32 s66, 262144
  s_mov_b32 s67, 0x00020000
  s_mov_b32 s52, s26
  s_and_b32 s53, s27, 0xffff
  s_mov_b32 s54, 7168
  s_mov_b32 s55, 0x00020000
  s_and_b32 s3, s70, 3
  s_lshl2_add_u32 s4, s68, s3
  s_lshl_b32 s4, s4, 8
  v_lshrrev_b32 v2, 4, v1
  v_and_b32 v3, 15, v1
  v_lshl_add_u32 v3, v3, 4, s4
  v_lshl_add_u32 v18, v2, 14, v3
  s_lshl_b32 s4, s69, 7
  s_lshl_b32 s5, s70, 6
  s_add_u32 s4, s4, s5
  s_add_u32 s4, s4, 1216
  s_lshl_b32 s5, s69, 6
  s_cmp_eq_u32 s70, 4
  s_cselect_b32 s4, s5, s4
  s_lshr_b32 s5, s5, 1
  s_add_u32 s5, s5, 1024
  s_cmp_eq_u32 s70, 7
  s_cselect_b32 s4, s5, s4
  v_and_b32 v3, 15, v1
  v_lshl_add_u32 v3, v3, 2, s4
  v_lshrrev_b32 v2, 4, v1
  v_add_lshl_u32 v23, v3, v2, 1
  v_lshlrev_b32 v3, 2, v3
  v_lshl_add_u32 v22, v2, 14, v3
  s_mov_b32 s60, s28
  s_and_b32 s61, s29, 0xffff
  s_mov_b32 s62, 7340032
  s_mov_b32 s63, 0x00020000
  s_cmp_eq_u32 s96, 0
  s_cselect_b32 s62, s62, 0
  s_and_b32 s3, s70, 3
  s_lshl_b32 s4, s2, 2
  s_add_u32 s3, s3, s4
  s_mul_i32 s98, s3, 3584
  s_add_u32 s98, s98, 3670016
  s_buffer_load_dword s84, s[60:63], s98 offset:0
  s_buffer_load_dword s84, s[60:63], s98 offset:64
  s_buffer_load_dword s84, s[60:63], s98 offset:128
  s_buffer_load_dword s84, s[60:63], s98 offset:192
  s_waitcnt vmcnt(0)
  s_barrier
  s_lshr_b32 s3, s69, 3
  s_and_b32 s73, s69, 7
  s_lshl1_add_u32 s91, s73, s3
  s_mul_i32 s74, s91, 458752
  s_lshl_b32 s73, s91, 11
  s_mov_b32 s88, s73
  s_add_u32 m0, s77, 0
  s_add_u32 s4, s74, 0
  buffer_load_dwordx4 v8, s[40:43], s4 offen lds
  s_add_u32 m0, s77, 1024
  s_nop 0
  buffer_load_dwordx4 v9, s[40:43], s4 offen lds
  s_add_u32 m0, s77, 8192
  s_add_u32 s4, s74, s78
  buffer_load_dwordx4 v8, s[40:43], s4 offen lds
  s_add_u32 m0, s77, 9216
  s_nop 0
  buffer_load_dwordx4 v9, s[40:43], s4 offen lds
  s_add_u32 m0, s77, 16384
  s_add_u32 s4, s4, 128
  buffer_load_dwordx4 v8, s[40:43], s4 offen lds
  s_add_u32 m0, s77, 17408
  s_nop 0
  buffer_load_dwordx4 v9, s[40:43], s4 offen lds
  s_add_u32 m0, s77, 24576
  s_nop 0
  buffer_load_dwordx4 v28, s[40:43], s74 offen lds
  s_and_b32 s73, s100, 15
  s_cmp_eq_u32 s73, s91
  s_cselect_b32 s74, 4, 0
  s_lshr_b64 s[100:101], s[100:101], s74
  s_and_b32 s73, s100, 15
  s_lshr_b64 s[100:101], s[100:101], 4
  s_mul_i32 s74, s73, 458752
  s_lshl_b32 s73, s73, 11
  s_add_u32 s3, s96, s70
  s_cmp_lg_u32 s3, 4
  s_cbranch_scc1 L_w1_chkNone
  s_add_u32 s44, s22, 41943040
  s_addc_u32 s45, s23, 0
  s_and_b32 s45, s45, 0xffff
  s_mov_b32 s46, 524288
  s_mov_b32 s47, 0x00020000
  v_lshrrev_b32 v2, 2, v1
  v_and_b32 v3, 3, v1
  v_lshlrev_b32 v2, 11, v2
  v_lshl_add_u32 v17, v3, 4, v2
  s_and_b32 s3, s69, 15
  s_lshl_b32 s3, s3, 7
  s_mov_b32 s79, 0x100000
L_w1_chkl:
  buffer_load_dwordx4 v[12:15], v17, s[44:47], s3 offen sc1
  s_sub_u32 s79, s79, 1
  s_cbranch_scc1 L_w1_chkNone
  s_waitcnt vmcnt(0)
  v_and_b32 v12, v12, v13
  v_and_b32 v14, v14, v15
  v_and_b32 v12, v12, v14
  v_cmp_ne_u32 vcc, 1, v12
  s_cbranch_vccnz L_w1_chkl
L_w1_chkNone:
  s_mov_b32 s75, 0
  s_add_u32 s44, s22, 41943040
  s_addc_u32 s45, s23, 0
  s_and_b32 s45, s45, 0xffff
  s_mov_b32 s46, 524288
  s_mov_b32 s47, 0x00020000
  s_lshl4_add_u32 s3, s97, s68
  s_and_b32 s4, s69, 15
  s_lshl4_add_u32 s3, s3, s4
  s_lshl_b32 s3, s3, 7
  s_sub_u32 s3, s3, 32768
  v_lshlrev_b32 v11, 7, v1
  v_and_b32 v2, 15, v1
  v_lshlrev_b32 v2, 2, v2
  v_mov_b32 v3, 1
  s_mov_b32 s79, 0x100000
  s_waitcnt vmcnt(0)
  s_cmp_lg_u32 s70, 4
  s_barrier
  s_cbranch_scc1 L_w1_nofl
  s_mov_b32 exec_lo, 0xffff
  s_mov_b32 exec_hi, 0
  buffer_store_dword v3, v11, s[44:47], s87 offen sc1
  s_mov_b64 exec, -1
L_w1_nofl:
  s_mov_b32 s5, s3
  s_mov_b32 s89, s73
  s_add_u32 m0, s77, 49152
  s_add_u32 s4, s74, 0
  buffer_load_dwordx4 v8, s[40:43], s4 offen lds
  s_add_u32 m0, s77, 50176
  s_nop 0
  buffer_load_dwordx4 v9, s[40:43], s4 offen lds
  s_add_u32 m0, s77, 57344
  s_add_u32 s4, s74, s78
  buffer_load_dwordx4 v8, s[40:43], s4 offen lds
  s_add_u32 m0, s77, 58368
  s_nop 0
  buffer_load_dwordx4 v9, s[40:43], s4 offen lds
  s_add_u32 m0, s77, 65536
  s_add_u32 s4, s4, 128
  buffer_load_dwordx4 v8, s[40:43], s4 offen lds
  s_add_u32 m0, s77, 66560
  s_nop 0
  buffer_load_dwordx4 v9, s[40:43], s4 offen lds
  s_add_u32 m0, s77, 73728
  s_nop 0
  buffer_load_dwordx4 v28, s[40:43], s74 offen lds
  s_and_b32 s73, s100, 15
  s_cmp_eq_u32 s73, s91
  s_cselect_b32 s74, 4, 0
  s_lshr_b64 s[100:101], s[100:101], s74
  s_and_b32 s73, s100, 15
  s_lshr_b64 s[100:101], s[100:101], 4
  s_mul_i32 s74, s73, 458752
  s_lshl_b32 s73, s73, 11
  s_mov_b32 s90, s73
  s_add_u32 m0, s77, 98304
  s_add_u32 s4, s74, 0
  buffer_load_dwordx4 v8, s[40:43], s4 offen lds
  s_add_u32 m0, s77, 99328
  s_nop 0
  buffer_load_dwordx4 v9, s[40:43], s4 offen lds
  s_add_u32 m0, s77, 106496
  s_add_u32 s4, s74, s78
  buffer_load_dwordx4 v8, s[40:43], s4 offen lds
  s_add_u32 m0, s77, 107520
  s_nop 0
  buffer_load_dwordx4 v9, s[40:43], s4 offen lds
  s_add_u32 m0, s77, 114688
  s_add_u32 s4, s4, 128
  buffer_load_dwordx4 v8, s[40:43], s4 offen lds
  s_add_u32 m0, s77, 115712
  s_nop 0
  buffer_load_dwordx4 v9, s[40:43], s4 offen lds
  s_add_u32 m0, s77, 122880
  s_nop 0
  buffer_load_dwordx4 v28, s[40:43], s74 offen lds
  s_and_b32 s73, s100, 15
  s_cmp_eq_u32 s73, s91
  s_cselect_b32 s74, 4, 0
  s_lshr_b64 s[100:101], s[100:101], s74
  s_and_b32 s73, s100, 15
  s_lshr_b64 s[100:101], s[100:101], 4
  s_mul_i32 s74, s73, 458752
  s_lshl_b32 s73, s73, 11
  s_mov_b32 s3, s5
  s_cmp_lg_u32 s70, 4
  s_cbranch_scc1 L_w1_dep
L_w1_poll:
  buffer_load_dword v3, v2, s[44:47], s3 offen sc1
  s_sub_u32 s79, s79, 1
  s_cbranch_scc1 L_w1_dep
  s_waitcnt vmcnt(0)
  v_cmp_ne_u32 vcc, 1, v3
  s_cbranch_vccnz L_w1_poll
L_w1_dep:
  s_barrier
  s_add_u32 m0, s76, 49152
  s_nop 0
  buffer_load_dwordx4 v4, s[36:39], s89 offen offset:0 lds
  buffer_load_dwordx4 v4, s[36:39], s89 offen offset:1024 lds
  s_add_u32 m0, s76, 51200
  s_nop 0
  buffer_load_dwordx4 v5, s[36:39], s89 offen offset:0 lds
  buffer_load_dwordx4 v5, s[36:39], s89 offen offset:1024 lds
  s_add_u32 m0, s76, 98304
  s_nop 0
  buffer_load_dwordx4 v4, s[36:39], s90 offen offset:0 lds
  buffer_load_dwordx4 v4, s[36:39], s90 offen offset:1024 lds
  s_add_u32 m0, s76, 100352
  s_nop 0
  buffer_load_dwordx4 v5, s[36:39], s90 offen offset:0 lds
  buffer_load_dwordx4 v5, s[36:39], s90 offen offset:1024 lds
  s_waitcnt vmcnt(4)
  s_barrier
  s_mov_b32 s79, 13
L_w1_ld1:
  s_add_u32 s3, s75, s76
  s_add_u32 m0, s3, 0
  s_nop 0
  buffer_load_dwordx4 v4, s[36:39], s73 offen offset:0 lds
  buffer_load_dwordx4 v4, s[36:39], s73 offen offset:1024 lds
  s_add_u32 m0, s3, 2048
  s_nop 0
  buffer_load_dwordx4 v5, s[36:39], s73 offen offset:0 lds
  buffer_load_dwordx4 v5, s[36:39], s73 offen offset:1024 lds
  s_add_u32 s3, s75, s77
  s_add_u32 m0, s3, 0
  s_add_u32 s4, s74, 0
  buffer_load_dwordx4 v8, s[40:43], s4 offen lds
  s_add_u32 m0, s3, 1024
  s_nop 0
  buffer_load_dwordx4 v9, s[40:43], s4 offen lds
  s_add_u32 m0, s3, 8192
  s_add_u32 s4, s74, s78
  buffer_load_dwordx4 v8, s[40:43], s4 offen lds
  s_add_u32 m0, s3, 9216
  s_nop 0
  buffer_load_dwordx4 v9, s[40:43], s4 offen lds
  s_add_u32 m0, s3, 16384
  s_add_u32 s4, s4, 128
  buffer_load_dwordx4 v8, s[40:43], s4 offen lds
  s_add_u32 m0, s3, 17408
  s_nop 0
  buffer_load_dwordx4 v9, s[40:43], s4 offen lds
  s_add_u32 m0, s3, 24576
  s_nop 0
  buffer_load_dwordx4 v28, s[40:43], s74 offen lds
  s_and_b32 s73, s100, 15
  s_cmp_eq_u32 s73, s91
  s_cselect_b32 s74, 4, 0
  s_lshr_b64 s[100:101], s[100:101], s74
  s_and_b32 s73, s100, 15
  s_lshr_b64 s[100:101], s[100:101], 4
  s_mul_i32 s74, s73, 458752
  s_lshl_b32 s73, s73, 11
  s_add_u32 s75, s75, 49152
  s_cmp_eq_u32 s75, 147456
  s_cselect_b32 s75, 0, s75
  s_buffer_load_dword s84, s[60:63], s98 offset:256
  s_buffer_load_dword s84, s[60:63], s98 offset:320
  s_buffer_load_dword s84, s[60:63], s98 offset:384
  s_buffer_load_dword s84, s[60:63], s98 offset:448
  s_add_u32 s98, s98, 256
  s_waitcnt vmcnt(11)
  s_barrier
  s_sub_u32 s79, s79, 1
  s_cmp_lg_u32 s79, 0
  s_cbranch_scc1 L_w1_ld1
  buffer_load_dwordx4 v[64:67], v22, s[64:67], 0 offen
  s_mov_b32 s3, 65536
  buffer_load_dwordx4 v[68:71], v22, s[64:67], s3 offen
  s_mov_b32 s3, 131072
  buffer_load_dwordx4 v[72:75], v22, s[64:67], s3 offen
  s_mov_b32 s3, 196608
  buffer_load_dwordx4 v[76:79], v22, s[64:67], s3 offen
  buffer_load_ushort v80, v23, s[52:55], 0 offen
  buffer_load_dwordx4 v[32:35], v18, s[56:59], 0 offen
  s_mov_b32 s3, 65536
  buffer_load_dwordx4 v[36:39], v18, s[56:59], s3 offen
  s_mov_b32 s3, 131072
  buffer_load_dwordx4 v[40:43], v18, s[56:59], s3 offen
  s_mov_b32 s3, 196608
  buffer_load_dwordx4 v[44:47], v18, s[56:59], s3 offen
  s_waitcnt vmcnt(9)
  s_barrier
  s_waitcnt vmcnt(0)
  v_pk_add_f32 v[32:33], v[32:33], v[36:37]
  v_pk_add_f32 v[34:35], v[34:35], v[38:39]
  v_pk_add_f32 v[40:41], v[40:41], v[44:45]
  v_pk_add_f32 v[42:43], v[42:43], v[46:47]
  v_pk_add_f32 v[32:33], v[32:33], v[40:41]
  v_pk_add_f32 v[34:35], v[34:35], v[42:43]
  s_nop 1
  v_permlane32_swap_b32 v32, v34
  v_permlane32_swap_b32 v33, v35
  v_pk_add_f32 v[32:33], v[32:33], v[34:35]
  v_mov_b32 v34, v32
  v_mov_b32 v35, v33
  s_nop 0
  v_permlane16_swap_b32 v32, v34
  v_permlane16_swap_b32 v33, v35
  v_pk_add_f32 v[32:33], v[32:33], v[34:35]
  v_mul_f32 v32, 0x3a800000, v32
  v_mul_f32 v33, 0x3a800000, v33
  v_fma_f32 v33, -v32, v32, v33
  v_max_f32 v33, 0, v33
  v_add_f32 v33, 0x3727c5ac, v33
  v_rsq_f32 v33, v33
  s_nop 0
  s_and_b32 s3, s70, 3
  s_lshl_b32 s5, s3, 7
  s_add_u32 s5, s5, 110656
  v_and_b32 v3, 15, v1
  v_lshrrev_b32 v2, 5, v1
  v_lshl_add_u32 v2, v3, 1, v2
  v_lshl_add_u32 v2, v2, 2, s5
  ds_write2_b32 v2, v32, v33 offset0:0 offset1:160
  v_pk_add_f32 v[64:65], v[64:65], v[68:69]
  v_pk_add_f32 v[66:67], v[66:67], v[70:71]
  v_pk_add_f32 v[72:73], v[72:73], v[76:77]
  v_pk_add_f32 v[74:75], v[74:75], v[78:79]
  v_pk_add_f32 v[64:65], v[64:65], v[72:73]
  v_pk_add_f32 v[66:67], v[66:67], v[74:75]
  s_nop 1
  v_permlane32_swap_b32 v64, v66
  v_permlane32_swap_b32 v65, v67
  v_pk_add_f32 v[64:65], v[64:65], v[66:67]
  v_lshlrev_b32 v80, 16, v80
  s_lshl_b32 s5, s3, 8
  s_add_u32 s5, s5, 111872
  v_permlane16_swap_b32 v64, v65
  v_lshrrev_b32 v2, 4, v1
  v_lshl_add_u32 v2, v3, 2, v2
  v_lshl_add_u32 v2, v2, 2, s5
  v_add_f32 v64, v64, v65
  ds_write2st64_b32 v2, v64, v80 offset0:0 offset1:4
  s_waitcnt lgkmcnt(0)
  s_barrier
  s_lshl_b32 s87, s97, 15
  s_lshl_b32 s4, s68, 11
  s_add_u32 s87, s87, s4
  s_lshl_b32 s4, s69, 2
  s_add_u32 s87, s87, s4
  s_add_u32 s97, s97, 1
  s_branch L_w2_body
L_w1_end:
  s_endpgm
L_w1_compute:
  s_and_b32 s71, s70, 1
  s_lshr_b32 s72, s70, 1
  v_and_b32 v3, 15, v1
  v_lshrrev_b32 v2, 4, v1
  s_lshl_b32 s8, s71, 13
  v_lshl_add_u32 v4, v1, 4, s8
  v_lshrrev_b32 v13, 2, v1
  v_lshlrev_b32 v13, 7, v13
  v_and_b32 v17, 3, v1
  v_lshl_add_u32 v13, v17, 3, v13
  v_bfe_u32 v17, v1, 3, 2
  v_lshl_add_u32 v13, v17, 5, v13
  s_lshl_b32 s9, s72, 6
  v_xor_b32 v13, s9, v13
  v_add_u32 v5, 16384, v13
  v_xor_b32 v6, 32, v5
  v_and_b32 v16, 1, v2
  v_lshrrev_b32 v17, 1, v2
  v_lshrrev_b32 v13, 2, v1
  v_and_b32 v14, 1, v1
  v_lshl_add_u32 v13, v13, 1, v14
  v_xor_b32 v14, s72, v16
  v_lshl_add_u32 v13, v13, 1, v14
  v_bfe_u32 v14, v1, 1, 1
  v_lshl_add_u32 v13, v13, 1, v14
  v_lshlrev_b32 v13, 3, v13
  v_add_u32 v7, 40960, v13
  s_mov_b32 s75, 0
  v_add_u32_e64 v20, s75, v4
  v_add_u32_e64 v21, s75, v5
  v_add_u32_e64 v22, s75, v6
  v_add_u32_e64 v23, s75, v7
  s_add_u32 s75, s75, 49152
  s_cmp_eq_u32 s75, 147456
  s_cselect_b32 s75, 0, s75
  s_mov_b32 s79, 15
  ds_read_b128 v[32:35], v20 offset:0
  ds_read_b128 v[36:39], v20 offset:2048
  ds_read_b128 v[40:43], v20 offset:4096
  ds_read_b128 v[44:47], v20 offset:6144
  ds_read_b64_tr_b16 v[48:49], v21 offset:0
  ds_read_b64_tr_b16 v[50:51], v21 offset:2048
  ds_read_b64_tr_b16 v[52:53], v22 offset:0
  ds_read_b64_tr_b16 v[54:55], v22 offset:2048
  ds_read_b64_tr_b16 v[56:57], v21 offset:8192
  ds_read_b64_tr_b16 v[58:59], v21 offset:10240
  ds_read_b64_tr_b16 v[60:61], v22 offset:8192
  ds_read_b64_tr_b16 v[62:63], v22 offset:10240
  ds_read_b64_tr_b16 v[64:65], v21 offset:16384
  ds_read_b64_tr_b16 v[66:67], v21 offset:18432
  ds_read_b64_tr_b16 v[68:69], v22 offset:16384
  ds_read_b64_tr_b16 v[70:71], v22 offset:18432
  ds_read_b64_tr_b16 v[72:73], v23 offset:0
  ds_read_b64_tr_b16 v[74:75], v23 offset:2048
  s_waitcnt lgkmcnt(0)
  v_mfma_f32_16x16x32_bf16 v[128:131], v[48:51], v[32:35], 0
  ds_read_b128 v[80:83], v20 offset:1024
  v_mfma_f32_16x16x32_bf16 v[132:135], v[48:51], v[36:39], 0
  ds_read_b128 v[84:87], v20 offset:3072
  v_mfma_f32_16x16x32_bf16 v[136:139], v[48:51], v[40:43], 0
  ds_read_b128 v[88:91], v20 offset:5120
  v_mfma_f32_16x16x32_bf16 v[140:143], v[48:51], v[44:47], 0
  ds_read_b128 v[92:95], v20 offset:7168
  v_mfma_f32_16x16x32_bf16 v[156:159], v[52:55], v[44:47], 0
  ds_read_b64_tr_b16 v[96:97], v21 offset:4096
  v_mfma_f32_16x16x32_bf16 v[152:155], v[52:55], v[40:43], 0
  ds_read_b64_tr_b16 v[98:99], v21 offset:6144
  v_mfma_f32_16x16x32_bf16 v[148:151], v[52:55], v[36:39], 0
  ds_read_b64_tr_b16 v[100:101], v22 offset:4096
  v_mfma_f32_16x16x32_bf16 v[144:147], v[52:55], v[32:35], 0
  ds_read_b64_tr_b16 v[102:103], v22 offset:6144
  v_mfma_f32_16x16x32_bf16 v[160:163], v[56:59], v[32:35], 0
  ds_read_b64_tr_b16 v[104:105], v21 offset:12288
  v_mfma_f32_16x16x32_bf16 v[164:167], v[56:59], v[36:39], 0
  ds_read_b64_tr_b16 v[106:107], v21 offset:14336
  v_mfma_f32_16x16x32_bf16 v[168:171], v[56:59], v[40:43], 0
  ds_read_b64_tr_b16 v[108:109], v22 offset:12288
  v_mfma_f32_16x16x32_bf16 v[172:175], v[56:59], v[44:47], 0
  ds_read_b64_tr_b16 v[110:111], v22 offset:14336
  v_mfma_f32_16x16x32_bf16 v[188:191], v[60:63], v[44:47], 0
  ds_read_b64_tr_b16 v[112:113], v21 offset:20480
  v_mfma_f32_16x16x32_bf16 v[184:187], v[60:63], v[40:43], 0
  ds_read_b64_tr_b16 v[114:115], v21 offset:22528
  v_mfma_f32_16x16x32_bf16 v[180:183], v[60:63], v[36:39], 0
  ds_read_b64_tr_b16 v[116:117], v22 offset:20480
  v_mfma_f32_16x16x32_bf16 v[176:179], v[60:63], v[32:35], 0
  ds_read_b64_tr_b16 v[118:119], v22 offset:22528
  v_mfma_f32_16x16x32_bf16 v[192:195], v[64:67], v[32:35], 0
  ds_read_b64_tr_b16 v[120:121], v23 offset:4096
  v_mfma_f32_16x16x32_bf16 v[196:199], v[64:67], v[36:39], 0
  ds_read_b64_tr_b16 v[122:123], v23 offset:6144
  v_mfma_f32_16x16x32_bf16 v[200:203], v[64:67], v[40:43], 0
  v_add_u32_e64 v20, s75, v4
  v_mfma_f32_16x16x32_bf16 v[204:207], v[64:67], v[44:47], 0
  v_add_u32_e64 v21, s75, v5
  v_mfma_f32_16x16x32_bf16 v[220:223], v[68:71], v[44:47], 0
  v_add_u32_e64 v22, s75, v6
  v_mfma_f32_16x16x32_bf16 v[216:219], v[68:71], v[40:43], 0
  v_add_u32_e64 v23, s75, v7
  v_mfma_f32_16x16x32_bf16 v[212:215], v[68:71], v[36:39], 0
  s_add_u32 s75, s75, 49152
  v_mfma_f32_16x16x32_bf16 v[208:211], v[68:71], v[32:35], 0
  s_cmp_eq_u32 s75, 147456
  v_mfma_f32_16x16x32_bf16 v[224:227], v[72:75], v[32:35], 0
  s_cselect_b32 s75, 0, s75
  v_mfma_f32_16x16x32_bf16 v[228:231], v[72:75], v[36:39], 0
  v_mfma_f32_16x16x32_bf16 v[232:235], v[72:75], v[40:43], 0
  v_mfma_f32_16x16x32_bf16 v[236:239], v[72:75], v[44:47], 0
  s_waitcnt lgkmcnt(0)
  v_mfma_f32_16x16x32_bf16 v[128:131], v[96:99], v[80:83], v[128:131]
  v_mfma_f32_16x16x32_bf16 v[132:135], v[96:99], v[84:87], v[132:135]
  v_mfma_f32_16x16x32_bf16 v[136:139], v[96:99], v[88:91], v[136:139]
  v_mfma_f32_16x16x32_bf16 v[140:143], v[96:99], v[92:95], v[140:143]
  v_mfma_f32_16x16x32_bf16 v[156:159], v[100:103], v[92:95], v[156:159]
  v_mfma_f32_16x16x32_bf16 v[152:155], v[100:103], v[88:91], v[152:155]
  v_mfma_f32_16x16x32_bf16 v[148:151], v[100:103], v[84:87], v[148:151]
  v_mfma_f32_16x16x32_bf16 v[144:147], v[100:103], v[80:83], v[144:147]
  v_mfma_f32_16x16x32_bf16 v[160:163], v[104:107], v[80:83], v[160:163]
  v_mfma_f32_16x16x32_bf16 v[164:167], v[104:107], v[84:87], v[164:167]
  v_mfma_f32_16x16x32_bf16 v[168:171], v[104:107], v[88:91], v[168:171]
  v_mfma_f32_16x16x32_bf16 v[172:175], v[104:107], v[92:95], v[172:175]
  v_mfma_f32_16x16x32_bf16 v[188:191], v[108:111], v[92:95], v[188:191]
  v_mfma_f32_16x16x32_bf16 v[184:187], v[108:111], v[88:91], v[184:187]
  v_mfma_f32_16x16x32_bf16 v[180:183], v[108:111], v[84:87], v[180:183]
  v_mfma_f32_16x16x32_bf16 v[176:179], v[108:111], v[80:83], v[176:179]
  v_mfma_f32_16x16x32_bf16 v[192:195], v[112:115], v[80:83], v[192:195]
  v_mfma_f32_16x16x32_bf16 v[196:199], v[112:115], v[84:87], v[196:199]
  v_mfma_f32_16x16x32_bf16 v[200:203], v[112:115], v[88:91], v[200:203]
  v_mfma_f32_16x16x32_bf16 v[204:207], v[112:115], v[92:95], v[204:207]
  v_mfma_f32_16x16x32_bf16 v[220:223], v[116:119], v[92:95], v[220:223]
  v_mfma_f32_16x16x32_bf16 v[216:219], v[116:119], v[88:91], v[216:219]
  v_mfma_f32_16x16x32_bf16 v[212:215], v[116:119], v[84:87], v[212:215]
  v_mfma_f32_16x16x32_bf16 v[208:211], v[116:119], v[80:83], v[208:211]
  v_mfma_f32_16x16x32_bf16 v[224:227], v[120:123], v[80:83], v[224:227]
  v_mfma_f32_16x16x32_bf16 v[228:231], v[120:123], v[84:87], v[228:231]
  v_mfma_f32_16x16x32_bf16 v[232:235], v[120:123], v[88:91], v[232:235]
  v_mfma_f32_16x16x32_bf16 v[236:239], v[120:123], v[92:95], v[236:239]
  s_barrier
  s_lshl_b32 s8, s68, 7
  s_lshl_b32 s9, s71, 6
  s_add_u32 s8, s8, s9
  s_mul_i32 s8, s8, 7168
  v_lshlrev_b32 v14, 8, v17
  v_lshl_add_u32 v14, v3, 4, v14
  s_lshl3_add_u32 s9, s71, s72
  s_lshl_b32 s9, s9, 10
  s_add_u32 s9, s9, 114688
  v_lshl_add_u32 v18, v1, 4, s9
  s_mov_b32 s52, s30
  s_and_b32 s53, s31, 0xffff
  s_mov_b32 s54, 2048
  s_mov_b32 s55, 0x00020000
  s_lshr_b32 s9, s69, 3
  s_and_b32 s10, s69, 7
  s_lshl1_add_u32 s9, s10, s9
  s_lshl_b32 s9, s9, 7
  v_lshl_add_u32 v19, v2, 3, s9
  v_add_u32 v14, s8, v14
  s_lshl_b32 s10, s69, 11
  s_lshl_b32 s9, s72, 10
  s_add_u32 s9, s9, s10
  v_lshl_add_u32 v12, v1, 4, s8
  v_add_u32 v12, s9, v12
  v_lshl_add_u32 v17, v16, 2, v17
  v_mul_u32_u24 v16, 114688, v16
  s_lshr_b32 s9, s9, 1
  v_add3_u32 v13, v16, v14, s9
  s_lshl_b32 s9, s71, 8
  s_add_u32 s9, s9, 110656
  v_lshl_add_u32 v14, v3, 2, s9
  s_lshl_b32 s9, s72, 7
  s_add_u32 s9, s9, 111872
  v_lshl_add_u32 v15, v2, 4, s9
  s_lshl_b32 s9, s72, 5
  s_add_u32 s9, s9, 111872
  v_lshl_add_u32 v16, v17, 4, s9
  s_add_u32 s44, s34, 8388608
  s_addc_u32 s45, s35, 0
  s_and_b32 s45, s45, 0xffff
  s_mov_b32 s46, 14680064
  s_mov_b32 s47, 0x00020000
  s_barrier
  ds_read_b128 v[32:35], v20 offset:0
  ds_read_b128 v[36:39], v20 offset:2048
  ds_read_b128 v[40:43], v20 offset:4096
  ds_read_b128 v[44:47], v20 offset:6144
  ds_read_b64_tr_b16 v[48:49], v21 offset:0
  ds_read_b64_tr_b16 v[50:51], v21 offset:2048
  ds_read_b64_tr_b16 v[52:53], v22 offset:0
  ds_read_b64_tr_b16 v[54:55], v22 offset:2048
  ds_read_b64_tr_b16 v[56:57], v21 offset:8192
  ds_read_b64_tr_b16 v[58:59], v21 offset:10240
  ds_read_b64_tr_b16 v[60:61], v22 offset:8192
  ds_read_b64_tr_b16 v[62:63], v22 offset:10240
  ds_read_b64_tr_b16 v[64:65], v21 offset:16384
  ds_read_b64_tr_b16 v[66:67], v21 offset:18432
  ds_read_b64_tr_b16 v[68:69], v22 offset:16384
  ds_read_b64_tr_b16 v[70:71], v22 offset:18432
  ds_read_b64_tr_b16 v[72:73], v23 offset:0
  ds_read_b64_tr_b16 v[74:75], v23 offset:2048
.p2align 5
  s_nop 0
  s_nop 0
  s_nop 0
  s_waitcnt lgkmcnt(0)
L_w1_loop:
  v_mfma_f32_16x16x32_bf16 v[128:131], v[48:51], v[32:35], v[128:131]
  ds_read_b128 v[80:83], v20 offset:1024
  v_mfma_f32_16x16x32_bf16 v[132:135], v[48:51], v[36:39], v[132:135]
  ds_read_b128 v[84:87], v20 offset:3072
  v_mfma_f32_16x16x32_bf16 v[136:139], v[48:51], v[40:43], v[136:139]
  ds_read_b128 v[88:91], v20 offset:5120
  v_mfma_f32_16x16x32_bf16 v[140:143], v[48:51], v[44:47], v[140:143]
  ds_read_b128 v[92:95], v20 offset:7168
  v_mfma_f32_16x16x32_bf16 v[156:159], v[52:55], v[44:47], v[156:159]
  ds_read_b64_tr_b16 v[96:97], v21 offset:4096
  v_mfma_f32_16x16x32_bf16 v[152:155], v[52:55], v[40:43], v[152:155]
  ds_read_b64_tr_b16 v[98:99], v21 offset:6144
  v_mfma_f32_16x16x32_bf16 v[148:151], v[52:55], v[36:39], v[148:151]
  ds_read_b64_tr_b16 v[100:101], v22 offset:4096
  v_mfma_f32_16x16x32_bf16 v[144:147], v[52:55], v[32:35], v[144:147]
  ds_read_b64_tr_b16 v[102:103], v22 offset:6144
  v_mfma_f32_16x16x32_bf16 v[160:163], v[56:59], v[32:35], v[160:163]
  ds_read_b64_tr_b16 v[104:105], v21 offset:12288
  v_mfma_f32_16x16x32_bf16 v[164:167], v[56:59], v[36:39], v[164:167]
  ds_read_b64_tr_b16 v[106:107], v21 offset:14336
  v_mfma_f32_16x16x32_bf16 v[168:171], v[56:59], v[40:43], v[168:171]
  ds_read_b64_tr_b16 v[108:109], v22 offset:12288
  v_mfma_f32_16x16x32_bf16 v[172:175], v[56:59], v[44:47], v[172:175]
  ds_read_b64_tr_b16 v[110:111], v22 offset:14336
  v_mfma_f32_16x16x32_bf16 v[188:191], v[60:63], v[44:47], v[188:191]
  ds_read_b64_tr_b16 v[112:113], v21 offset:20480
  v_mfma_f32_16x16x32_bf16 v[184:187], v[60:63], v[40:43], v[184:187]
  ds_read_b64_tr_b16 v[114:115], v21 offset:22528
  v_mfma_f32_16x16x32_bf16 v[180:183], v[60:63], v[36:39], v[180:183]
  ds_read_b64_tr_b16 v[116:117], v22 offset:20480
  v_mfma_f32_16x16x32_bf16 v[176:179], v[60:63], v[32:35], v[176:179]
  ds_read_b64_tr_b16 v[118:119], v22 offset:22528
  v_mfma_f32_16x16x32_bf16 v[192:195], v[64:67], v[32:35], v[192:195]
  ds_read_b64_tr_b16 v[120:121], v23 offset:4096
  v_mfma_f32_16x16x32_bf16 v[196:199], v[64:67], v[36:39], v[196:199]
  ds_read_b64_tr_b16 v[122:123], v23 offset:6144
  v_mfma_f32_16x16x32_bf16 v[200:203], v[64:67], v[40:43], v[200:203]
  v_add_u32_e64 v20, s75, v4
  v_mfma_f32_16x16x32_bf16 v[204:207], v[64:67], v[44:47], v[204:207]
  v_add_u32_e64 v21, s75, v5
  v_mfma_f32_16x16x32_bf16 v[220:223], v[68:71], v[44:47], v[220:223]
  v_add_u32_e64 v22, s75, v6
  v_mfma_f32_16x16x32_bf16 v[216:219], v[68:71], v[40:43], v[216:219]
  v_add_u32_e64 v23, s75, v7
  v_mfma_f32_16x16x32_bf16 v[212:215], v[68:71], v[36:39], v[212:215]
  s_add_u32 s75, s75, 49152
  v_mfma_f32_16x16x32_bf16 v[208:211], v[68:71], v[32:35], v[208:211]
  s_cmp_eq_u32 s75, 147456
  v_mfma_f32_16x16x32_bf16 v[224:227], v[72:75], v[32:35], v[224:227]
  s_cselect_b32 s75, 0, s75
  s_sub_u32 s79, s79, 1
  v_mfma_f32_16x16x32_bf16 v[228:231], v[72:75], v[36:39], v[228:231]
  v_mfma_f32_16x16x32_bf16 v[232:235], v[72:75], v[40:43], v[232:235]
  v_mfma_f32_16x16x32_bf16 v[236:239], v[72:75], v[44:47], v[236:239]
  s_waitcnt lgkmcnt(0)
  s_barrier
  v_mfma_f32_16x16x32_bf16 v[128:131], v[96:99], v[80:83], v[128:131]
  ds_read_b128 v[32:35], v20 offset:0
  v_mfma_f32_16x16x32_bf16 v[132:135], v[96:99], v[84:87], v[132:135]
  ds_read_b128 v[36:39], v20 offset:2048
  v_mfma_f32_16x16x32_bf16 v[136:139], v[96:99], v[88:91], v[136:139]
  ds_read_b128 v[40:43], v20 offset:4096
  v_mfma_f32_16x16x32_bf16 v[140:143], v[96:99], v[92:95], v[140:143]
  ds_read_b128 v[44:47], v20 offset:6144
  v_mfma_f32_16x16x32_bf16 v[156:159], v[100:103], v[92:95], v[156:159]
  ds_read_b64_tr_b16 v[48:49], v21 offset:0
  v_mfma_f32_16x16x32_bf16 v[152:155], v[100:103], v[88:91], v[152:155]
  ds_read_b64_tr_b16 v[50:51], v21 offset:2048
  v_mfma_f32_16x16x32_bf16 v[148:151], v[100:103], v[84:87], v[148:151]
  ds_read_b64_tr_b16 v[52:53], v22 offset:0
  v_mfma_f32_16x16x32_bf16 v[144:147], v[100:103], v[80:83], v[144:147]
  ds_read_b64_tr_b16 v[54:55], v22 offset:2048
  v_mfma_f32_16x16x32_bf16 v[160:163], v[104:107], v[80:83], v[160:163]
  ds_read_b64_tr_b16 v[56:57], v21 offset:8192
  v_mfma_f32_16x16x32_bf16 v[164:167], v[104:107], v[84:87], v[164:167]
  ds_read_b64_tr_b16 v[58:59], v21 offset:10240
  v_mfma_f32_16x16x32_bf16 v[168:171], v[104:107], v[88:91], v[168:171]
  ds_read_b64_tr_b16 v[60:61], v22 offset:8192
  v_mfma_f32_16x16x32_bf16 v[172:175], v[104:107], v[92:95], v[172:175]
  ds_read_b64_tr_b16 v[62:63], v22 offset:10240
  v_mfma_f32_16x16x32_bf16 v[188:191], v[108:111], v[92:95], v[188:191]
  ds_read_b64_tr_b16 v[64:65], v21 offset:16384
  v_mfma_f32_16x16x32_bf16 v[184:187], v[108:111], v[88:91], v[184:187]
  ds_read_b64_tr_b16 v[66:67], v21 offset:18432
  v_mfma_f32_16x16x32_bf16 v[180:183], v[108:111], v[84:87], v[180:183]
  ds_read_b64_tr_b16 v[68:69], v22 offset:16384
  v_mfma_f32_16x16x32_bf16 v[176:179], v[108:111], v[80:83], v[176:179]
  ds_read_b64_tr_b16 v[70:71], v22 offset:18432
  v_mfma_f32_16x16x32_bf16 v[192:195], v[112:115], v[80:83], v[192:195]
  ds_read_b64_tr_b16 v[72:73], v23 offset:0
  v_mfma_f32_16x16x32_bf16 v[196:199], v[112:115], v[84:87], v[196:199]
  ds_read_b64_tr_b16 v[74:75], v23 offset:2048
  v_mfma_f32_16x16x32_bf16 v[200:203], v[112:115], v[88:91], v[200:203]
  s_cmp_lg_u32 s79, 0
  s_nop 0
  v_mfma_f32_16x16x32_bf16 v[204:207], v[112:115], v[92:95], v[204:207]
  v_mfma_f32_16x16x32_bf16 v[220:223], v[116:119], v[92:95], v[220:223]
  v_mfma_f32_16x16x32_bf16 v[216:219], v[116:119], v[88:91], v[216:219]
  v_mfma_f32_16x16x32_bf16 v[212:215], v[116:119], v[84:87], v[212:215]
  v_mfma_f32_16x16x32_bf16 v[208:211], v[116:119], v[80:83], v[208:211]
  v_mfma_f32_16x16x32_bf16 v[224:227], v[120:123], v[80:83], v[224:227]
  v_mfma_f32_16x16x32_bf16 v[228:231], v[120:123], v[84:87], v[228:231]
  v_mfma_f32_16x16x32_bf16 v[232:235], v[120:123], v[88:91], v[232:235]
  v_mfma_f32_16x16x32_bf16 v[236:239], v[120:123], v[92:95], v[236:239]
  s_waitcnt lgkmcnt(0)
  s_cbranch_scc1 L_w1_loop
L_w1_lend:
L_w1_exit:
  ds_read2_b32 v[88:89], v14 offset0:0 offset1:160
  ds_read2_b32 v[90:91], v14 offset0:16 offset1:176
  ds_read2_b32 v[92:93], v14 offset0:32 offset1:192
  ds_read2_b32 v[94:95], v14 offset0:48 offset1:208
  ds_read_b128 v[32:35], v15 offset:0
  ds_read_b128 v[60:63], v15 offset:1024
  ds_read_b128 v[36:39], v15 offset:64
  ds_read_b128 v[64:67], v15 offset:1088
  ds_read_b128 v[40:43], v15 offset:256
  ds_read_b128 v[68:71], v15 offset:1280
  ds_read_b128 v[44:47], v15 offset:320
  ds_read_b128 v[72:75], v15 offset:1344
  ds_read_b128 v[48:51], v15 offset:512
  ds_read_b128 v[76:79], v15 offset:1536
  ds_read_b128 v[52:55], v15 offset:576
  ds_read_b128 v[80:83], v15 offset:1600
  ds_read_b128 v[56:59], v16 offset:768
  ds_read_b128 v[84:87], v16 offset:1792
  buffer_load_dwordx2 v[10:11], v19, s[52:55], 0 offen offset:0
  buffer_load_dwordx2 v[24:25], v19, s[52:55], 0 offen offset:32
  buffer_load_dwordx2 v[124:125], v19, s[52:55], 0 offen offset:64
  buffer_load_dwordx2 v[126:127], v19, s[52:55], 0 offen offset:96
  v_mov_b32 v96, 0xc0135761
  v_mov_b32 v97, 0xbdd2d3e8
  v_mov_b32 v98, 1.0
  s_waitcnt lgkmcnt(0)
  v_mul_f32 v88, v88, v89
  v_mul_f32 v90, v90, v91
  v_mul_f32 v92, v92, v93
  v_mul_f32 v94, v94, v95
  v_pk_fma_f32 v[100:101], v[32:33], v[88:89], v[60:61] op_sel:[0,0,0] op_sel_hi:[1,0,1] neg_lo:[0,1,0] neg_hi:[0,1,0]
  v_pk_fma_f32 v[102:103], v[34:35], v[88:89], v[62:63] op_sel:[0,0,0] op_sel_hi:[1,0,1] neg_lo:[0,1,0] neg_hi:[0,1,0]
  v_pk_fma_f32 v[128:129], v[128:129], v[88:89], v[100:101] op_sel:[0,1,0] op_sel_hi:[1,1,1]
  v_pk_fma_f32 v[130:131], v[130:131], v[88:89], v[102:103] op_sel:[0,1,0] op_sel_hi:[1,1,1]
  v_pk_mul_f32 v[100:101], v[128:129], v[128:129]
  v_pk_mul_f32 v[102:103], v[130:131], v[130:131]
  v_pk_fma_f32 v[100:101], v[100:101], v[96:97], v[96:97] op_sel:[0,1,0] op_sel_hi:[1,1,0]
  v_pk_fma_f32 v[102:103], v[102:103], v[96:97], v[96:97] op_sel:[0,1,0] op_sel_hi:[1,1,0]
  v_pk_mul_f32 v[100:101], v[100:101], v[128:129]
  v_pk_mul_f32 v[102:103], v[102:103], v[130:131]
  v_exp_f32 v100, v100
  v_exp_f32 v101, v101
  v_exp_f32 v102, v102
  v_exp_f32 v103, v103
  v_pk_add_f32 v[100:101], v[100:101], v[98:99] op_sel_hi:[1,0]
  v_pk_add_f32 v[102:103], v[102:103], v[98:99] op_sel_hi:[1,0]
  v_rcp_f32 v100, v100
  v_rcp_f32 v101, v101
  v_rcp_f32 v102, v102
  v_rcp_f32 v103, v103
  v_pk_mul_f32 v[128:129], v[128:129], v[100:101]
  v_pk_mul_f32 v[130:131], v[130:131], v[102:103]
  v_cvt_pk_bf16_f32 v108, v128, v129
  v_cvt_pk_bf16_f32 v109, v130, v131
  v_pk_fma_f32 v[104:105], v[36:37], v[88:89], v[64:65] op_sel:[0,0,0] op_sel_hi:[1,0,1] neg_lo:[0,1,0] neg_hi:[0,1,0]
  v_pk_fma_f32 v[106:107], v[38:39], v[88:89], v[66:67] op_sel:[0,0,0] op_sel_hi:[1,0,1] neg_lo:[0,1,0] neg_hi:[0,1,0]
  v_pk_fma_f32 v[144:145], v[144:145], v[88:89], v[104:105] op_sel:[0,1,0] op_sel_hi:[1,1,1]
  v_pk_fma_f32 v[146:147], v[146:147], v[88:89], v[106:107] op_sel:[0,1,0] op_sel_hi:[1,1,1]
  v_pk_mul_f32 v[104:105], v[144:145], v[144:145]
  v_pk_mul_f32 v[106:107], v[146:147], v[146:147]
  v_pk_fma_f32 v[104:105], v[104:105], v[96:97], v[96:97] op_sel:[0,1,0] op_sel_hi:[1,1,0]
  v_pk_fma_f32 v[106:107], v[106:107], v[96:97], v[96:97] op_sel:[0,1,0] op_sel_hi:[1,1,0]
  v_pk_mul_f32 v[104:105], v[104:105], v[144:145]
  v_pk_mul_f32 v[106:107], v[106:107], v[146:147]
  v_exp_f32 v104, v104
  v_exp_f32 v105, v105
  v_exp_f32 v106, v106
  v_exp_f32 v107, v107
  v_pk_add_f32 v[104:105], v[104:105], v[98:99] op_sel_hi:[1,0]
  v_pk_add_f32 v[106:107], v[106:107], v[98:99] op_sel_hi:[1,0]
  v_rcp_f32 v104, v104
  v_rcp_f32 v105, v105
  v_rcp_f32 v106, v106
  v_rcp_f32 v107, v107
  v_pk_mul_f32 v[144:145], v[144:145], v[104:105]
  v_pk_mul_f32 v[146:147], v[146:147], v[106:107]
  v_cvt_pk_bf16_f32 v110, v144, v145
  v_cvt_pk_bf16_f32 v111, v146, v147
  s_mov_b32 s3, 0
  buffer_store_dwordx4 v[108:111], v12, s[44:47], s3 offen sc1
  ds_write_b128 v18, v[108:111] offset:32768
  v_pk_fma_f32 v[100:101], v[32:33], v[90:91], v[60:61] op_sel:[0,0,0] op_sel_hi:[1,0,1] neg_lo:[0,1,0] neg_hi:[0,1,0]
  v_pk_fma_f32 v[102:103], v[34:35], v[90:91], v[62:63] op_sel:[0,0,0] op_sel_hi:[1,0,1] neg_lo:[0,1,0] neg_hi:[0,1,0]
  v_pk_fma_f32 v[132:133], v[132:133], v[90:91], v[100:101] op_sel:[0,1,0] op_sel_hi:[1,1,1]
  v_pk_fma_f32 v[134:135], v[134:135], v[90:91], v[102:103] op_sel:[0,1,0] op_sel_hi:[1,1,1]
  v_pk_mul_f32 v[100:101], v[132:133], v[132:133]
  v_pk_mul_f32 v[102:103], v[134:135], v[134:135]
  v_pk_fma_f32 v[100:101], v[100:101], v[96:97], v[96:97] op_sel:[0,1,0] op_sel_hi:[1,1,0]
  v_pk_fma_f32 v[102:103], v[102:103], v[96:97], v[96:97] op_sel:[0,1,0] op_sel_hi:[1,1,0]
  v_pk_mul_f32 v[100:101], v[100:101], v[132:133]
  v_pk_mul_f32 v[102:103], v[102:103], v[134:135]
  v_exp_f32 v100, v100
  v_exp_f32 v101, v101
  v_exp_f32 v102, v102
  v_exp_f32 v103, v103
  v_pk_add_f32 v[100:101], v[100:101], v[98:99] op_sel_hi:[1,0]
  v_pk_add_f32 v[102:103], v[102:103], v[98:99] op_sel_hi:[1,0]
  v_rcp_f32 v100, v100
  v_rcp_f32 v101, v101
  v_rcp_f32 v102, v102
  v_rcp_f32 v103, v103
  v_pk_mul_f32 v[132:133], v[132:133], v[100:101]
  v_pk_mul_f32 v[134:135], v[134:135], v[102:103]
  v_cvt_pk_bf16_f32 v112, v132, v133
  v_cvt_pk_bf16_f32 v113, v134, v135
  v_pk_fma_f32 v[104:105], v[36:37], v[90:91], v[64:65] op_sel:[0,0,0] op_sel_hi:[1,0,1] neg_lo:[0,1,0] neg_hi:[0,1,0]
  v_pk_fma_f32 v[106:107], v[38:39], v[90:91], v[66:67] op_sel:[0,0,0] op_sel_hi:[1,0,1] neg_lo:[0,1,0] neg_hi:[0,1,0]
  v_pk_fma_f32 v[148:149], v[148:149], v[90:91], v[104:105] op_sel:[0,1,0] op_sel_hi:[1,1,1]
  v_pk_fma_f32 v[150:151], v[150:151], v[90:91], v[106:107] op_sel:[0,1,0] op_sel_hi:[1,1,1]
  v_pk_mul_f32 v[104:105], v[148:149], v[148:149]
  v_pk_mul_f32 v[106:107], v[150:151], v[150:151]
  v_pk_fma_f32 v[104:105], v[104:105], v[96:97], v[96:97] op_sel:[0,1,0] op_sel_hi:[1,1,0]
  v_pk_fma_f32 v[106:107], v[106:107], v[96:97], v[96:97] op_sel:[0,1,0] op_sel_hi:[1,1,0]
  v_pk_mul_f32 v[104:105], v[104:105], v[148:149]
  v_pk_mul_f32 v[106:107], v[106:107], v[150:151]
  v_exp_f32 v104, v104
  v_exp_f32 v105, v105
  v_exp_f32 v106, v106
  v_exp_f32 v107, v107
  v_pk_add_f32 v[104:105], v[104:105], v[98:99] op_sel_hi:[1,0]
  v_pk_add_f32 v[106:107], v[106:107], v[98:99] op_sel_hi:[1,0]
  v_rcp_f32 v104, v104
  v_rcp_f32 v105, v105
  v_rcp_f32 v106, v106
  v_rcp_f32 v107, v107
  v_pk_mul_f32 v[148:149], v[148:149], v[104:105]
  v_pk_mul_f32 v[150:151], v[150:151], v[106:107]
  v_cvt_pk_bf16_f32 v114, v148, v149
  v_cvt_pk_bf16_f32 v115, v150, v151
  s_mov_b32 s3, 114688
  buffer_store_dwordx4 v[112:115], v12, s[44:47], s3 offen sc1
  ds_write_b128 v18, v[112:115] offset:34816
  v_pk_fma_f32 v[100:101], v[32:33], v[92:93], v[60:61] op_sel:[0,0,0] op_sel_hi:[1,0,1] neg_lo:[0,1,0] neg_hi:[0,1,0]
  v_pk_fma_f32 v[102:103], v[34:35], v[92:93], v[62:63] op_sel:[0,0,0] op_sel_hi:[1,0,1] neg_lo:[0,1,0] neg_hi:[0,1,0]
  v_pk_fma_f32 v[136:137], v[136:137], v[92:93], v[100:101] op_sel:[0,1,0] op_sel_hi:[1,1,1]
  v_pk_fma_f32 v[138:139], v[138:139], v[92:93], v[102:103] op_sel:[0,1,0] op_sel_hi:[1,1,1]
  v_pk_mul_f32 v[100:101], v[136:137], v[136:137]
  v_pk_mul_f32 v[102:103], v[138:139], v[138:139]
  v_pk_fma_f32 v[100:101], v[100:101], v[96:97], v[96:97] op_sel:[0,1,0] op_sel_hi:[1,1,0]
  v_pk_fma_f32 v[102:103], v[102:103], v[96:97], v[96:97] op_sel:[0,1,0] op_sel_hi:[1,1,0]
  v_pk_mul_f32 v[100:101], v[100:101], v[136:137]
  v_pk_mul_f32 v[102:103], v[102:103], v[138:139]
  v_exp_f32 v100, v100
  v_exp_f32 v101, v101
  v_exp_f32 v102, v102
  v_exp_f32 v103, v103
  v_pk_add_f32 v[100:101], v[100:101], v[98:99] op_sel_hi:[1,0]
  v_pk_add_f32 v[102:103], v[102:103], v[98:99] op_sel_hi:[1,0]
  v_rcp_f32 v100, v100
  v_rcp_f32 v101, v101
  v_rcp_f32 v102, v102
  v_rcp_f32 v103, v103
  v_pk_mul_f32 v[136:137], v[136:137], v[100:101]
  v_pk_mul_f32 v[138:139], v[138:139], v[102:103]
  v_cvt_pk_bf16_f32 v116, v136, v137
  v_cvt_pk_bf16_f32 v117, v138, v139
  v_pk_fma_f32 v[104:105], v[36:37], v[92:93], v[64:65] op_sel:[0,0,0] op_sel_hi:[1,0,1] neg_lo:[0,1,0] neg_hi:[0,1,0]
  v_pk_fma_f32 v[106:107], v[38:39], v[92:93], v[66:67] op_sel:[0,0,0] op_sel_hi:[1,0,1] neg_lo:[0,1,0] neg_hi:[0,1,0]
  v_pk_fma_f32 v[152:153], v[152:153], v[92:93], v[104:105] op_sel:[0,1,0] op_sel_hi:[1,1,1]
  v_pk_fma_f32 v[154:155], v[154:155], v[92:93], v[106:107] op_sel:[0,1,0] op_sel_hi:[1,1,1]
  v_pk_mul_f32 v[104:105], v[152:153], v[152:153]
  v_pk_mul_f32 v[106:107], v[154:155], v[154:155]
  v_pk_fma_f32 v[104:105], v[104:105], v[96:97], v[96:97] op_sel:[0,1,0] op_sel_hi:[1,1,0]
  v_pk_fma_f32 v[106:107], v[106:107], v[96:97], v[96:97] op_sel:[0,1,0] op_sel_hi:[1,1,0]
  v_pk_mul_f32 v[104:105], v[104:105], v[152:153]
  v_pk_mul_f32 v[106:107], v[106:107], v[154:155]
  v_exp_f32 v104, v104
  v_exp_f32 v105, v105
  v_exp_f32 v106, v106
  v_exp_f32 v107, v107
  v_pk_add_f32 v[104:105], v[104:105], v[98:99] op_sel_hi:[1,0]
  v_pk_add_f32 v[106:107], v[106:107], v[98:99] op_sel_hi:[1,0]
  v_rcp_f32 v104, v104
  v_rcp_f32 v105, v105
  v_rcp_f32 v106, v106
  v_rcp_f32 v107, v107
  v_pk_mul_f32 v[152:153], v[152:153], v[104:105]
  v_pk_mul_f32 v[154:155], v[154:155], v[106:107]
  v_cvt_pk_bf16_f32 v118, v152, v153
  v_cvt_pk_bf16_f32 v119, v154, v155
  s_mov_b32 s3, 229376
  buffer_store_dwordx4 v[116:119], v12, s[44:47], s3 offen sc1
  ds_write_b128 v18, v[116:119] offset:36864
  v_pk_fma_f32 v[100:101], v[32:33], v[94:95], v[60:61] op_sel:[0,0,0] op_sel_hi:[1,0,1] neg_lo:[0,1,0] neg_hi:[0,1,0]
  v_pk_fma_f32 v[102:103], v[34:35], v[94:95], v[62:63] op_sel:[0,0,0] op_sel_hi:[1,0,1] neg_lo:[0,1,0] neg_hi:[0,1,0]
  v_pk_fma_f32 v[140:141], v[140:141], v[94:95], v[100:101] op_sel:[0,1,0] op_sel_hi:[1,1,1]
  v_pk_fma_f32 v[142:143], v[142:143], v[94:95], v[102:103] op_sel:[0,1,0] op_sel_hi:[1,1,1]
  v_pk_mul_f32 v[100:101], v[140:141], v[140:141]
  v_pk_mul_f32 v[102:103], v[142:143], v[142:143]
  v_pk_fma_f32 v[100:101], v[100:101], v[96:97], v[96:97] op_sel:[0,1,0] op_sel_hi:[1,1,0]
  v_pk_fma_f32 v[102:103], v[102:103], v[96:97], v[96:97] op_sel:[0,1,0] op_sel_hi:[1,1,0]
  v_pk_mul_f32 v[100:101], v[100:101], v[140:141]
  v_pk_mul_f32 v[102:103], v[102:103], v[142:143]
  v_exp_f32 v100, v100
  v_exp_f32 v101, v101
  v_exp_f32 v102, v102
  v_exp_f32 v103, v103
  v_pk_add_f32 v[100:101], v[100:101], v[98:99] op_sel_hi:[1,0]
  v_pk_add_f32 v[102:103], v[102:103], v[98:99] op_sel_hi:[1,0]
  v_rcp_f32 v100, v100
  v_rcp_f32 v101, v101
  v_rcp_f32 v102, v102
  v_rcp_f32 v103, v103
  v_pk_mul_f32 v[140:141], v[140:141], v[100:101]
  v_pk_mul_f32 v[142:143], v[142:143], v[102:103]
  v_cvt_pk_bf16_f32 v120, v140, v141
  v_cvt_pk_bf16_f32 v121, v142, v143
  v_pk_fma_f32 v[104:105], v[36:37], v[94:95], v[64:65] op_sel:[0,0,0] op_sel_hi:[1,0,1] neg_lo:[0,1,0] neg_hi:[0,1,0]
  v_pk_fma_f32 v[106:107], v[38:39], v[94:95], v[66:67] op_sel:[0,0,0] op_sel_hi:[1,0,1] neg_lo:[0,1,0] neg_hi:[0,1,0]
  v_pk_fma_f32 v[156:157], v[156:157], v[94:95], v[104:105] op_sel:[0,1,0] op_sel_hi:[1,1,1]
  v_pk_fma_f32 v[158:159], v[158:159], v[94:95], v[106:107] op_sel:[0,1,0] op_sel_hi:[1,1,1]
  v_pk_mul_f32 v[104:105], v[156:157], v[156:157]
  v_pk_mul_f32 v[106:107], v[158:159], v[158:159]
  v_pk_fma_f32 v[104:105], v[104:105], v[96:97], v[96:97] op_sel:[0,1,0] op_sel_hi:[1,1,0]
  v_pk_fma_f32 v[106:107], v[106:107], v[96:97], v[96:97] op_sel:[0,1,0] op_sel_hi:[1,1,0]
  v_pk_mul_f32 v[104:105], v[104:105], v[156:157]
  v_pk_mul_f32 v[106:107], v[106:107], v[158:159]
  v_exp_f32 v104, v104
  v_exp_f32 v105, v105
  v_exp_f32 v106, v106
  v_exp_f32 v107, v107
  v_pk_add_f32 v[104:105], v[104:105], v[98:99] op_sel_hi:[1,0]
  v_pk_add_f32 v[106:107], v[106:107], v[98:99] op_sel_hi:[1,0]
  v_rcp_f32 v104, v104
  v_rcp_f32 v105, v105
  v_rcp_f32 v106, v106
  v_rcp_f32 v107, v107
  v_pk_mul_f32 v[156:157], v[156:157], v[104:105]
  v_pk_mul_f32 v[158:159], v[158:159], v[106:107]
  v_cvt_pk_bf16_f32 v122, v156, v157
  v_cvt_pk_bf16_f32 v123, v158, v159
  s_mov_b32 s3, 344064
  buffer_store_dwordx4 v[120:123], v12, s[44:47], s3 offen sc1
  ds_write_b128 v18, v[120:123] offset:38912
  v_pk_fma_f32 v[100:101], v[56:57], v[88:89], v[84:85] op_sel:[0,0,0] op_sel_hi:[1,0,1] neg_lo:[0,1,0] neg_hi:[0,1,0]
  v_pk_fma_f32 v[102:103], v[58:59], v[88:89], v[86:87] op_sel:[0,0,0] op_sel_hi:[1,0,1] neg_lo:[0,1,0] neg_hi:[0,1,0]
  v_pk_fma_f32 v[224:225], v[224:225], v[88:89], v[100:101] op_sel:[0,1,0] op_sel_hi:[1,1,1]
  v_pk_fma_f32 v[226:227], v[226:227], v[88:89], v[102:103] op_sel:[0,1,0] op_sel_hi:[1,1,1]
  v_pk_mul_f32 v[100:101], v[224:225], v[224:225]
  v_pk_mul_f32 v[102:103], v[226:227], v[226:227]
  v_pk_fma_f32 v[100:101], v[100:101], v[96:97], v[96:97] op_sel:[0,1,0] op_sel_hi:[1,1,0]
  v_pk_fma_f32 v[102:103], v[102:103], v[96:97], v[96:97] op_sel:[0,1,0] op_sel_hi:[1,1,0]
  v_pk_mul_f32 v[100:101], v[100:101], v[224:225]
  v_pk_mul_f32 v[102:103], v[102:103], v[226:227]
  v_exp_f32 v100, v100
  v_exp_f32 v101, v101
  v_exp_f32 v102, v102
  v_exp_f32 v103, v103
  v_pk_add_f32 v[100:101], v[100:101], v[98:99] op_sel_hi:[1,0]
  v_pk_add_f32 v[102:103], v[102:103], v[98:99] op_sel_hi:[1,0]
  v_rcp_f32 v100, v100
  v_rcp_f32 v101, v101
  v_rcp_f32 v102, v102
  v_rcp_f32 v103, v103
  v_pk_mul_f32 v[224:225], v[224:225], v[100:101]
  v_pk_mul_f32 v[226:227], v[226:227], v[102:103]
  v_cvt_pk_bf16_f32 v108, v224, v225
  v_cvt_pk_bf16_f32 v109, v226, v227
  v_pk_fma_f32 v[100:101], v[56:57], v[90:91], v[84:85] op_sel:[0,0,0] op_sel_hi:[1,0,1] neg_lo:[0,1,0] neg_hi:[0,1,0]
  v_pk_fma_f32 v[102:103], v[58:59], v[90:91], v[86:87] op_sel:[0,0,0] op_sel_hi:[1,0,1] neg_lo:[0,1,0] neg_hi:[0,1,0]
  v_pk_fma_f32 v[228:229], v[228:229], v[90:91], v[100:101] op_sel:[0,1,0] op_sel_hi:[1,1,1]
  v_pk_fma_f32 v[230:231], v[230:231], v[90:91], v[102:103] op_sel:[0,1,0] op_sel_hi:[1,1,1]
  v_pk_mul_f32 v[100:101], v[228:229], v[228:229]
  v_pk_mul_f32 v[102:103], v[230:231], v[230:231]
  v_pk_fma_f32 v[100:101], v[100:101], v[96:97], v[96:97] op_sel:[0,1,0] op_sel_hi:[1,1,0]
  v_pk_fma_f32 v[102:103], v[102:103], v[96:97], v[96:97] op_sel:[0,1,0] op_sel_hi:[1,1,0]
  v_pk_mul_f32 v[100:101], v[100:101], v[228:229]
  v_pk_mul_f32 v[102:103], v[102:103], v[230:231]
  v_exp_f32 v100, v100
  v_exp_f32 v101, v101
  v_exp_f32 v102, v102
  v_exp_f32 v103, v103
  v_pk_add_f32 v[100:101], v[100:101], v[98:99] op_sel_hi:[1,0]
  v_pk_add_f32 v[102:103], v[102:103], v[98:99] op_sel_hi:[1,0]
  v_rcp_f32 v100, v100
  v_rcp_f32 v101, v101
  v_rcp_f32 v102, v102
  v_rcp_f32 v103, v103
  v_pk_mul_f32 v[228:229], v[228:229], v[100:101]
  v_pk_mul_f32 v[230:231], v[230:231], v[102:103]
  v_cvt_pk_bf16_f32 v110, v228, v229
  v_cvt_pk_bf16_f32 v111, v230, v231
  s_mov_b32 s3, 32768
  s_nop 0
  v_permlane16_swap_b32 v108, v110
  v_permlane16_swap_b32 v109, v111
  buffer_store_dwordx4 v[108:111], v13, s[44:47], s3 offen sc1
  v_pk_fma_f32 v[100:101], v[56:57], v[92:93], v[84:85] op_sel:[0,0,0] op_sel_hi:[1,0,1] neg_lo:[0,1,0] neg_hi:[0,1,0]
  v_pk_fma_f32 v[102:103], v[58:59], v[92:93], v[86:87] op_sel:[0,0,0] op_sel_hi:[1,0,1] neg_lo:[0,1,0] neg_hi:[0,1,0]
  v_pk_fma_f32 v[232:233], v[232:233], v[92:93], v[100:101] op_sel:[0,1,0] op_sel_hi:[1,1,1]
  v_pk_fma_f32 v[234:235], v[234:235], v[92:93], v[102:103] op_sel:[0,1,0] op_sel_hi:[1,1,1]
  v_pk_mul_f32 v[100:101], v[232:233], v[232:233]
  v_pk_mul_f32 v[102:103], v[234:235], v[234:235]
  v_pk_fma_f32 v[100:101], v[100:101], v[96:97], v[96:97] op_sel:[0,1,0] op_sel_hi:[1,1,0]
  v_pk_fma_f32 v[102:103], v[102:103], v[96:97], v[96:97] op_sel:[0,1,0] op_sel_hi:[1,1,0]
  v_pk_mul_f32 v[100:101], v[100:101], v[232:233]
  v_pk_mul_f32 v[102:103], v[102:103], v[234:235]
  v_exp_f32 v100, v100
  v_exp_f32 v101, v101
  v_exp_f32 v102, v102
  v_exp_f32 v103, v103
  v_pk_add_f32 v[100:101], v[100:101], v[98:99] op_sel_hi:[1,0]
  v_pk_add_f32 v[102:103], v[102:103], v[98:99] op_sel_hi:[1,0]
  v_rcp_f32 v100, v100
  v_rcp_f32 v101, v101
  v_rcp_f32 v102, v102
  v_rcp_f32 v103, v103
  v_pk_mul_f32 v[232:233], v[232:233], v[100:101]
  v_pk_mul_f32 v[234:235], v[234:235], v[102:103]
  v_cvt_pk_bf16_f32 v112, v232, v233
  v_cvt_pk_bf16_f32 v113, v234, v235
  v_pk_fma_f32 v[100:101], v[56:57], v[94:95], v[84:85] op_sel:[0,0,0] op_sel_hi:[1,0,1] neg_lo:[0,1,0] neg_hi:[0,1,0]
  v_pk_fma_f32 v[102:103], v[58:59], v[94:95], v[86:87] op_sel:[0,0,0] op_sel_hi:[1,0,1] neg_lo:[0,1,0] neg_hi:[0,1,0]
  v_pk_fma_f32 v[236:237], v[236:237], v[94:95], v[100:101] op_sel:[0,1,0] op_sel_hi:[1,1,1]
  v_pk_fma_f32 v[238:239], v[238:239], v[94:95], v[102:103] op_sel:[0,1,0] op_sel_hi:[1,1,1]
  v_pk_mul_f32 v[100:101], v[236:237], v[236:237]
  v_pk_mul_f32 v[102:103], v[238:239], v[238:239]
  v_pk_fma_f32 v[100:101], v[100:101], v[96:97], v[96:97] op_sel:[0,1,0] op_sel_hi:[1,1,0]
  v_pk_fma_f32 v[102:103], v[102:103], v[96:97], v[96:97] op_sel:[0,1,0] op_sel_hi:[1,1,0]
  v_pk_mul_f32 v[100:101], v[100:101], v[236:237]
  v_pk_mul_f32 v[102:103], v[102:103], v[238:239]
  v_exp_f32 v100, v100
  v_exp_f32 v101, v101
  v_exp_f32 v102, v102
  v_exp_f32 v103, v103
  v_pk_add_f32 v[100:101], v[100:101], v[98:99] op_sel_hi:[1,0]
  v_pk_add_f32 v[102:103], v[102:103], v[98:99] op_sel_hi:[1,0]
  v_rcp_f32 v100, v100
  v_rcp_f32 v101, v101
  v_rcp_f32 v102, v102
  v_rcp_f32 v103, v103
  v_pk_mul_f32 v[236:237], v[236:237], v[100:101]
  v_pk_mul_f32 v[238:239], v[238:239], v[102:103]
  v_cvt_pk_bf16_f32 v114, v236, v237
  v_cvt_pk_bf16_f32 v115, v238, v239
  s_mov_b32 s3, 262144
  s_nop 0
  v_permlane16_swap_b32 v112, v114
  v_permlane16_swap_b32 v113, v115
  buffer_store_dwordx4 v[112:115], v13, s[44:47], s3 offen sc1
  v_pk_fma_f32 v[100:101], v[40:41], v[88:89], v[68:69] op_sel:[0,0,0] op_sel_hi:[1,0,1] neg_lo:[0,1,0] neg_hi:[0,1,0]
  v_pk_fma_f32 v[102:103], v[42:43], v[88:89], v[70:71] op_sel:[0,0,0] op_sel_hi:[1,0,1] neg_lo:[0,1,0] neg_hi:[0,1,0]
  v_pk_fma_f32 v[160:161], v[160:161], v[88:89], v[100:101] op_sel:[0,1,0] op_sel_hi:[1,1,1]
  v_pk_fma_f32 v[162:163], v[162:163], v[88:89], v[102:103] op_sel:[0,1,0] op_sel_hi:[1,1,1]
  v_pk_mul_f32 v[100:101], v[160:161], v[160:161]
  v_pk_mul_f32 v[102:103], v[162:163], v[162:163]
  v_pk_fma_f32 v[100:101], v[100:101], v[96:97], v[96:97] op_sel:[0,1,0] op_sel_hi:[1,1,0]
  v_pk_fma_f32 v[102:103], v[102:103], v[96:97], v[96:97] op_sel:[0,1,0] op_sel_hi:[1,1,0]
  v_pk_mul_f32 v[100:101], v[100:101], v[160:161]
  v_pk_mul_f32 v[102:103], v[102:103], v[162:163]
  v_exp_f32 v100, v100
  v_exp_f32 v101, v101
  v_exp_f32 v102, v102
  v_exp_f32 v103, v103
  v_pk_add_f32 v[100:101], v[100:101], v[98:99] op_sel_hi:[1,0]
  v_pk_add_f32 v[102:103], v[102:103], v[98:99] op_sel_hi:[1,0]
  v_rcp_f32 v100, v100
  v_rcp_f32 v101, v101
  v_rcp_f32 v102, v102
  v_rcp_f32 v103, v103
  v_pk_mul_f32 v[160:161], v[160:161], v[100:101]
  v_pk_mul_f32 v[162:163], v[162:163], v[102:103]
  v_cvt_pk_bf16_f32 v116, v160, v161
  v_cvt_pk_bf16_f32 v117, v162, v163
  v_pk_fma_f32 v[104:105], v[44:45], v[88:89], v[72:73] op_sel:[0,0,0] op_sel_hi:[1,0,1] neg_lo:[0,1,0] neg_hi:[0,1,0]
  v_pk_fma_f32 v[106:107], v[46:47], v[88:89], v[74:75] op_sel:[0,0,0] op_sel_hi:[1,0,1] neg_lo:[0,1,0] neg_hi:[0,1,0]
  v_pk_fma_f32 v[176:177], v[176:177], v[88:89], v[104:105] op_sel:[0,1,0] op_sel_hi:[1,1,1]
  v_pk_fma_f32 v[178:179], v[178:179], v[88:89], v[106:107] op_sel:[0,1,0] op_sel_hi:[1,1,1]
  v_pk_mul_f32 v[104:105], v[176:177], v[176:177]
  v_pk_mul_f32 v[106:107], v[178:179], v[178:179]
  v_pk_fma_f32 v[104:105], v[104:105], v[96:97], v[96:97] op_sel:[0,1,0] op_sel_hi:[1,1,0]
  v_pk_fma_f32 v[106:107], v[106:107], v[96:97], v[96:97] op_sel:[0,1,0] op_sel_hi:[1,1,0]
  v_pk_mul_f32 v[104:105], v[104:105], v[176:177]
  v_pk_mul_f32 v[106:107], v[106:107], v[178:179]
  v_exp_f32 v104, v104
  v_exp_f32 v105, v105
  v_exp_f32 v106, v106
  v_exp_f32 v107, v107
  v_pk_add_f32 v[104:105], v[104:105], v[98:99] op_sel_hi:[1,0]
  v_pk_add_f32 v[106:107], v[106:107], v[98:99] op_sel_hi:[1,0]
  v_rcp_f32 v104, v104
  v_rcp_f32 v105, v105
  v_rcp_f32 v106, v106
  v_rcp_f32 v107, v107
  v_pk_mul_f32 v[176:177], v[176:177], v[104:105]
  v_pk_mul_f32 v[178:179], v[178:179], v[106:107]
  v_cvt_pk_bf16_f32 v118, v176, v177
  v_cvt_pk_bf16_f32 v119, v178, v179
  s_add_u32 s3, s10, 49152
  buffer_store_dwordx4 v[116:119], v12, s[44:47], s3 offen sc1
  ds_write_b128 v18, v[116:119] offset:0
  v_pk_fma_f32 v[100:101], v[48:49], v[88:89], v[76:77] op_sel:[0,0,0] op_sel_hi:[1,0,1] neg_lo:[0,1,0] neg_hi:[0,1,0]
  v_pk_fma_f32 v[102:103], v[50:51], v[88:89], v[78:79] op_sel:[0,0,0] op_sel_hi:[1,0,1] neg_lo:[0,1,0] neg_hi:[0,1,0]
  v_pk_fma_f32 v[192:193], v[192:193], v[88:89], v[100:101] op_sel:[0,1,0] op_sel_hi:[1,1,1]
  v_pk_fma_f32 v[194:195], v[194:195], v[88:89], v[102:103] op_sel:[0,1,0] op_sel_hi:[1,1,1]
  v_pk_mul_f32 v[100:101], v[192:193], v[192:193]
  v_pk_mul_f32 v[102:103], v[194:195], v[194:195]
  v_pk_fma_f32 v[100:101], v[100:101], v[96:97], v[96:97] op_sel:[0,1,0] op_sel_hi:[1,1,0]
  v_pk_fma_f32 v[102:103], v[102:103], v[96:97], v[96:97] op_sel:[0,1,0] op_sel_hi:[1,1,0]
  v_pk_mul_f32 v[100:101], v[100:101], v[192:193]
  v_pk_mul_f32 v[102:103], v[102:103], v[194:195]
  v_exp_f32 v100, v100
  v_exp_f32 v101, v101
  v_exp_f32 v102, v102
  v_exp_f32 v103, v103
  v_pk_add_f32 v[100:101], v[100:101], v[98:99] op_sel_hi:[1,0]
  v_pk_add_f32 v[102:103], v[102:103], v[98:99] op_sel_hi:[1,0]
  v_rcp_f32 v100, v100
  v_rcp_f32 v101, v101
  v_rcp_f32 v102, v102
  v_rcp_f32 v103, v103
  v_pk_mul_f32 v[192:193], v[192:193], v[100:101]
  v_pk_mul_f32 v[194:195], v[194:195], v[102:103]
  v_cvt_pk_bf16_f32 v120, v192, v193
  v_cvt_pk_bf16_f32 v121, v194, v195
  v_pk_fma_f32 v[104:105], v[52:53], v[88:89], v[80:81] op_sel:[0,0,0] op_sel_hi:[1,0,1] neg_lo:[0,1,0] neg_hi:[0,1,0]
  v_pk_fma_f32 v[106:107], v[54:55], v[88:89], v[82:83] op_sel:[0,0,0] op_sel_hi:[1,0,1] neg_lo:[0,1,0] neg_hi:[0,1,0]
  v_pk_fma_f32 v[208:209], v[208:209], v[88:89], v[104:105] op_sel:[0,1,0] op_sel_hi:[1,1,1]
  v_pk_fma_f32 v[210:211], v[210:211], v[88:89], v[106:107] op_sel:[0,1,0] op_sel_hi:[1,1,1]
  v_pk_mul_f32 v[104:105], v[208:209], v[208:209]
  v_pk_mul_f32 v[106:107], v[210:211], v[210:211]
  v_pk_fma_f32 v[104:105], v[104:105], v[96:97], v[96:97] op_sel:[0,1,0] op_sel_hi:[1,1,0]
  v_pk_fma_f32 v[106:107], v[106:107], v[96:97], v[96:97] op_sel:[0,1,0] op_sel_hi:[1,1,0]
  v_pk_mul_f32 v[104:105], v[104:105], v[208:209]
  v_pk_mul_f32 v[106:107], v[106:107], v[210:211]
  v_exp_f32 v104, v104
  v_exp_f32 v105, v105
  v_exp_f32 v106, v106
  v_exp_f32 v107, v107
  v_pk_add_f32 v[104:105], v[104:105], v[98:99] op_sel_hi:[1,0]
  v_pk_add_f32 v[106:107], v[106:107], v[98:99] op_sel_hi:[1,0]
  v_rcp_f32 v104, v104
  v_rcp_f32 v105, v105
  v_rcp_f32 v106, v106
  v_rcp_f32 v107, v107
  v_pk_mul_f32 v[208:209], v[208:209], v[104:105]
  v_pk_mul_f32 v[210:211], v[210:211], v[106:107]
  v_cvt_pk_bf16_f32 v122, v208, v209
  v_cvt_pk_bf16_f32 v123, v210, v211
  s_add_u32 s3, s10, 51200
  buffer_store_dwordx4 v[120:123], v12, s[44:47], s3 offen sc1
  ds_write_b128 v18, v[120:123] offset:16384
  v_pk_fma_f32 v[100:101], v[40:41], v[90:91], v[68:69] op_sel:[0,0,0] op_sel_hi:[1,0,1] neg_lo:[0,1,0] neg_hi:[0,1,0]
  v_pk_fma_f32 v[102:103], v[42:43], v[90:91], v[70:71] op_sel:[0,0,0] op_sel_hi:[1,0,1] neg_lo:[0,1,0] neg_hi:[0,1,0]
  v_pk_fma_f32 v[164:165], v[164:165], v[90:91], v[100:101] op_sel:[0,1,0] op_sel_hi:[1,1,1]
  v_pk_fma_f32 v[166:167], v[166:167], v[90:91], v[102:103] op_sel:[0,1,0] op_sel_hi:[1,1,1]
  v_pk_mul_f32 v[100:101], v[164:165], v[164:165]
  v_pk_mul_f32 v[102:103], v[166:167], v[166:167]
  v_pk_fma_f32 v[100:101], v[100:101], v[96:97], v[96:97] op_sel:[0,1,0] op_sel_hi:[1,1,0]
  v_pk_fma_f32 v[102:103], v[102:103], v[96:97], v[96:97] op_sel:[0,1,0] op_sel_hi:[1,1,0]
  v_pk_mul_f32 v[100:101], v[100:101], v[164:165]
  v_pk_mul_f32 v[102:103], v[102:103], v[166:167]
  v_exp_f32 v100, v100
  v_exp_f32 v101, v101
  v_exp_f32 v102, v102
  v_exp_f32 v103, v103
  v_pk_add_f32 v[100:101], v[100:101], v[98:99] op_sel_hi:[1,0]
  v_pk_add_f32 v[102:103], v[102:103], v[98:99] op_sel_hi:[1,0]
  v_rcp_f32 v100, v100
  v_rcp_f32 v101, v101
  v_rcp_f32 v102, v102
  v_rcp_f32 v103, v103
  v_pk_mul_f32 v[164:165], v[164:165], v[100:101]
  v_pk_mul_f32 v[166:167], v[166:167], v[102:103]
  v_cvt_pk_bf16_f32 v108, v164, v165
  v_cvt_pk_bf16_f32 v109, v166, v167
  v_pk_fma_f32 v[104:105], v[44:45], v[90:91], v[72:73] op_sel:[0,0,0] op_sel_hi:[1,0,1] neg_lo:[0,1,0] neg_hi:[0,1,0]
  v_pk_fma_f32 v[106:107], v[46:47], v[90:91], v[74:75] op_sel:[0,0,0] op_sel_hi:[1,0,1] neg_lo:[0,1,0] neg_hi:[0,1,0]
  v_pk_fma_f32 v[180:181], v[180:181], v[90:91], v[104:105] op_sel:[0,1,0] op_sel_hi:[1,1,1]
  v_pk_fma_f32 v[182:183], v[182:183], v[90:91], v[106:107] op_sel:[0,1,0] op_sel_hi:[1,1,1]
  v_pk_mul_f32 v[104:105], v[180:181], v[180:181]
  v_pk_mul_f32 v[106:107], v[182:183], v[182:183]
  v_pk_fma_f32 v[104:105], v[104:105], v[96:97], v[96:97] op_sel:[0,1,0] op_sel_hi:[1,1,0]
  v_pk_fma_f32 v[106:107], v[106:107], v[96:97], v[96:97] op_sel:[0,1,0] op_sel_hi:[1,1,0]
  v_pk_mul_f32 v[104:105], v[104:105], v[180:181]
  v_pk_mul_f32 v[106:107], v[106:107], v[182:183]
  v_exp_f32 v104, v104
  v_exp_f32 v105, v105
  v_exp_f32 v106, v106
  v_exp_f32 v107, v107
  v_pk_add_f32 v[104:105], v[104:105], v[98:99] op_sel_hi:[1,0]
  v_pk_add_f32 v[106:107], v[106:107], v[98:99] op_sel_hi:[1,0]
  v_rcp_f32 v104, v104
  v_rcp_f32 v105, v105
  v_rcp_f32 v106, v106
  v_rcp_f32 v107, v107
  v_pk_mul_f32 v[180:181], v[180:181], v[104:105]
  v_pk_mul_f32 v[182:183], v[182:183], v[106:107]
  v_cvt_pk_bf16_f32 v110, v180, v181
  v_cvt_pk_bf16_f32 v111, v182, v183
  s_add_u32 s3, s10, 163840
  buffer_store_dwordx4 v[108:111], v12, s[44:47], s3 offen sc1
  ds_write_b128 v18, v[108:111] offset:2048
  v_pk_fma_f32 v[100:101], v[48:49], v[90:91], v[76:77] op_sel:[0,0,0] op_sel_hi:[1,0,1] neg_lo:[0,1,0] neg_hi:[0,1,0]
  v_pk_fma_f32 v[102:103], v[50:51], v[90:91], v[78:79] op_sel:[0,0,0] op_sel_hi:[1,0,1] neg_lo:[0,1,0] neg_hi:[0,1,0]
  v_pk_fma_f32 v[196:197], v[196:197], v[90:91], v[100:101] op_sel:[0,1,0] op_sel_hi:[1,1,1]
  v_pk_fma_f32 v[198:199], v[198:199], v[90:91], v[102:103] op_sel:[0,1,0] op_sel_hi:[1,1,1]
  v_pk_mul_f32 v[100:101], v[196:197], v[196:197]
  v_pk_mul_f32 v[102:103], v[198:199], v[198:199]
  v_pk_fma_f32 v[100:101], v[100:101], v[96:97], v[96:97] op_sel:[0,1,0] op_sel_hi:[1,1,0]
  v_pk_fma_f32 v[102:103], v[102:103], v[96:97], v[96:97] op_sel:[0,1,0] op_sel_hi:[1,1,0]
  v_pk_mul_f32 v[100:101], v[100:101], v[196:197]
  v_pk_mul_f32 v[102:103], v[102:103], v[198:199]
  v_exp_f32 v100, v100
  v_exp_f32 v101, v101
  v_exp_f32 v102, v102
  v_exp_f32 v103, v103
  v_pk_add_f32 v[100:101], v[100:101], v[98:99] op_sel_hi:[1,0]
  v_pk_add_f32 v[102:103], v[102:103], v[98:99] op_sel_hi:[1,0]
  v_rcp_f32 v100, v100
  v_rcp_f32 v101, v101
  v_rcp_f32 v102, v102
  v_rcp_f32 v103, v103
  v_pk_mul_f32 v[196:197], v[196:197], v[100:101]
  v_pk_mul_f32 v[198:199], v[198:199], v[102:103]
  v_cvt_pk_bf16_f32 v112, v196, v197
  v_cvt_pk_bf16_f32 v113, v198, v199
  v_pk_fma_f32 v[104:105], v[52:53], v[90:91], v[80:81] op_sel:[0,0,0] op_sel_hi:[1,0,1] neg_lo:[0,1,0] neg_hi:[0,1,0]
  v_pk_fma_f32 v[106:107], v[54:55], v[90:91], v[82:83] op_sel:[0,0,0] op_sel_hi:[1,0,1] neg_lo:[0,1,0] neg_hi:[0,1,0]
  v_pk_fma_f32 v[212:213], v[212:213], v[90:91], v[104:105] op_sel:[0,1,0] op_sel_hi:[1,1,1]
  v_pk_fma_f32 v[214:215], v[214:215], v[90:91], v[106:107] op_sel:[0,1,0] op_sel_hi:[1,1,1]
  v_pk_mul_f32 v[104:105], v[212:213], v[212:213]
  v_pk_mul_f32 v[106:107], v[214:215], v[214:215]
  v_pk_fma_f32 v[104:105], v[104:105], v[96:97], v[96:97] op_sel:[0,1,0] op_sel_hi:[1,1,0]
  v_pk_fma_f32 v[106:107], v[106:107], v[96:97], v[96:97] op_sel:[0,1,0] op_sel_hi:[1,1,0]
  v_pk_mul_f32 v[104:105], v[104:105], v[212:213]
  v_pk_mul_f32 v[106:107], v[106:107], v[214:215]
  v_exp_f32 v104, v104
  v_exp_f32 v105, v105
  v_exp_f32 v106, v106
  v_exp_f32 v107, v107
  v_pk_add_f32 v[104:105], v[104:105], v[98:99] op_sel_hi:[1,0]
  v_pk_add_f32 v[106:107], v[106:107], v[98:99] op_sel_hi:[1,0]
  v_rcp_f32 v104, v104
  v_rcp_f32 v105, v105
  v_rcp_f32 v106, v106
  v_rcp_f32 v107, v107
  v_pk_mul_f32 v[212:213], v[212:213], v[104:105]
  v_pk_mul_f32 v[214:215], v[214:215], v[106:107]
  v_cvt_pk_bf16_f32 v114, v212, v213
  v_cvt_pk_bf16_f32 v115, v214, v215
  s_add_u32 s3, s10, 165888
  buffer_store_dwordx4 v[112:115], v12, s[44:47], s3 offen sc1
  ds_write_b128 v18, v[112:115] offset:18432
  v_pk_fma_f32 v[100:101], v[40:41], v[92:93], v[68:69] op_sel:[0,0,0] op_sel_hi:[1,0,1] neg_lo:[0,1,0] neg_hi:[0,1,0]
  v_pk_fma_f32 v[102:103], v[42:43], v[92:93], v[70:71] op_sel:[0,0,0] op_sel_hi:[1,0,1] neg_lo:[0,1,0] neg_hi:[0,1,0]
  v_pk_fma_f32 v[168:169], v[168:169], v[92:93], v[100:101] op_sel:[0,1,0] op_sel_hi:[1,1,1]
  v_pk_fma_f32 v[170:171], v[170:171], v[92:93], v[102:103] op_sel:[0,1,0] op_sel_hi:[1,1,1]
  v_pk_mul_f32 v[100:101], v[168:169], v[168:169]
  v_pk_mul_f32 v[102:103], v[170:171], v[170:171]
  v_pk_fma_f32 v[100:101], v[100:101], v[96:97], v[96:97] op_sel:[0,1,0] op_sel_hi:[1,1,0]
  v_pk_fma_f32 v[102:103], v[102:103], v[96:97], v[96:97] op_sel:[0,1,0] op_sel_hi:[1,1,0]
  v_pk_mul_f32 v[100:101], v[100:101], v[168:169]
  v_pk_mul_f32 v[102:103], v[102:103], v[170:171]
  v_exp_f32 v100, v100
  v_exp_f32 v101, v101
  v_exp_f32 v102, v102
  v_exp_f32 v103, v103
  v_pk_add_f32 v[100:101], v[100:101], v[98:99] op_sel_hi:[1,0]
  v_pk_add_f32 v[102:103], v[102:103], v[98:99] op_sel_hi:[1,0]
  v_rcp_f32 v100, v100
  v_rcp_f32 v101, v101
  v_rcp_f32 v102, v102
  v_rcp_f32 v103, v103
  v_pk_mul_f32 v[168:169], v[168:169], v[100:101]
  v_pk_mul_f32 v[170:171], v[170:171], v[102:103]
  v_cvt_pk_bf16_f32 v116, v168, v169
  v_cvt_pk_bf16_f32 v117, v170, v171
  v_pk_fma_f32 v[104:105], v[44:45], v[92:93], v[72:73] op_sel:[0,0,0] op_sel_hi:[1,0,1] neg_lo:[0,1,0] neg_hi:[0,1,0]
  v_pk_fma_f32 v[106:107], v[46:47], v[92:93], v[74:75] op_sel:[0,0,0] op_sel_hi:[1,0,1] neg_lo:[0,1,0] neg_hi:[0,1,0]
  v_pk_fma_f32 v[184:185], v[184:185], v[92:93], v[104:105] op_sel:[0,1,0] op_sel_hi:[1,1,1]
  v_pk_fma_f32 v[186:187], v[186:187], v[92:93], v[106:107] op_sel:[0,1,0] op_sel_hi:[1,1,1]
  v_pk_mul_f32 v[104:105], v[184:185], v[184:185]
  v_pk_mul_f32 v[106:107], v[186:187], v[186:187]
  v_pk_fma_f32 v[104:105], v[104:105], v[96:97], v[96:97] op_sel:[0,1,0] op_sel_hi:[1,1,0]
  v_pk_fma_f32 v[106:107], v[106:107], v[96:97], v[96:97] op_sel:[0,1,0] op_sel_hi:[1,1,0]
  v_pk_mul_f32 v[104:105], v[104:105], v[184:185]
  v_pk_mul_f32 v[106:107], v[106:107], v[186:187]
  v_exp_f32 v104, v104
  v_exp_f32 v105, v105
  v_exp_f32 v106, v106
  v_exp_f32 v107, v107
  v_pk_add_f32 v[104:105], v[104:105], v[98:99] op_sel_hi:[1,0]
  v_pk_add_f32 v[106:107], v[106:107], v[98:99] op_sel_hi:[1,0]
  v_rcp_f32 v104, v104
  v_rcp_f32 v105, v105
  v_rcp_f32 v106, v106
  v_rcp_f32 v107, v107
  v_pk_mul_f32 v[184:185], v[184:185], v[104:105]
  v_pk_mul_f32 v[186:187], v[186:187], v[106:107]
  v_cvt_pk_bf16_f32 v118, v184, v185
  v_cvt_pk_bf16_f32 v119, v186, v187
  s_add_u32 s3, s10, 278528
  buffer_store_dwordx4 v[116:119], v12, s[44:47], s3 offen sc1
  ds_write_b128 v18, v[116:119] offset:4096
  v_pk_fma_f32 v[100:101], v[48:49], v[92:93], v[76:77] op_sel:[0,0,0] op_sel_hi:[1,0,1] neg_lo:[0,1,0] neg_hi:[0,1,0]
  v_pk_fma_f32 v[102:103], v[50:51], v[92:93], v[78:79] op_sel:[0,0,0] op_sel_hi:[1,0,1] neg_lo:[0,1,0] neg_hi:[0,1,0]
  v_pk_fma_f32 v[200:201], v[200:201], v[92:93], v[100:101] op_sel:[0,1,0] op_sel_hi:[1,1,1]
  v_pk_fma_f32 v[202:203], v[202:203], v[92:93], v[102:103] op_sel:[0,1,0] op_sel_hi:[1,1,1]
  v_pk_mul_f32 v[100:101], v[200:201], v[200:201]
  v_pk_mul_f32 v[102:103], v[202:203], v[202:203]
  v_pk_fma_f32 v[100:101], v[100:101], v[96:97], v[96:97] op_sel:[0,1,0] op_sel_hi:[1,1,0]
  v_pk_fma_f32 v[102:103], v[102:103], v[96:97], v[96:97] op_sel:[0,1,0] op_sel_hi:[1,1,0]
  v_pk_mul_f32 v[100:101], v[100:101], v[200:201]
  v_pk_mul_f32 v[102:103], v[102:103], v[202:203]
  v_exp_f32 v100, v100
  v_exp_f32 v101, v101
  v_exp_f32 v102, v102
  v_exp_f32 v103, v103
  v_pk_add_f32 v[100:101], v[100:101], v[98:99] op_sel_hi:[1,0]
  v_pk_add_f32 v[102:103], v[102:103], v[98:99] op_sel_hi:[1,0]
  v_rcp_f32 v100, v100
  v_rcp_f32 v101, v101
  v_rcp_f32 v102, v102
  v_rcp_f32 v103, v103
  v_pk_mul_f32 v[200:201], v[200:201], v[100:101]
  v_pk_mul_f32 v[202:203], v[202:203], v[102:103]
  v_cvt_pk_bf16_f32 v120, v200, v201
  v_cvt_pk_bf16_f32 v121, v202, v203
  v_pk_fma_f32 v[104:105], v[52:53], v[92:93], v[80:81] op_sel:[0,0,0] op_sel_hi:[1,0,1] neg_lo:[0,1,0] neg_hi:[0,1,0]
  v_pk_fma_f32 v[106:107], v[54:55], v[92:93], v[82:83] op_sel:[0,0,0] op_sel_hi:[1,0,1] neg_lo:[0,1,0] neg_hi:[0,1,0]
  v_pk_fma_f32 v[216:217], v[216:217], v[92:93], v[104:105] op_sel:[0,1,0] op_sel_hi:[1,1,1]
  v_pk_fma_f32 v[218:219], v[218:219], v[92:93], v[106:107] op_sel:[0,1,0] op_sel_hi:[1,1,1]
  v_pk_mul_f32 v[104:105], v[216:217], v[216:217]
  v_pk_mul_f32 v[106:107], v[218:219], v[218:219]
  v_pk_fma_f32 v[104:105], v[104:105], v[96:97], v[96:97] op_sel:[0,1,0] op_sel_hi:[1,1,0]
  v_pk_fma_f32 v[106:107], v[106:107], v[96:97], v[96:97] op_sel:[0,1,0] op_sel_hi:[1,1,0]
  v_pk_mul_f32 v[104:105], v[104:105], v[216:217]
  v_pk_mul_f32 v[106:107], v[106:107], v[218:219]
  v_exp_f32 v104, v104
  v_exp_f32 v105, v105
  v_exp_f32 v106, v106
  v_exp_f32 v107, v107
  v_pk_add_f32 v[104:105], v[104:105], v[98:99] op_sel_hi:[1,0]
  v_pk_add_f32 v[106:107], v[106:107], v[98:99] op_sel_hi:[1,0]
  v_rcp_f32 v104, v104
  v_rcp_f32 v105, v105
  v_rcp_f32 v106, v106
  v_rcp_f32 v107, v107
  v_pk_mul_f32 v[216:217], v[216:217], v[104:105]
  v_pk_mul_f32 v[218:219], v[218:219], v[106:107]
  v_cvt_pk_bf16_f32 v122, v216, v217
  v_cvt_pk_bf16_f32 v123, v218, v219
  s_add_u32 s3, s10, 280576
  buffer_store_dwordx4 v[120:123], v12, s[44:47], s3 offen sc1
  ds_write_b128 v18, v[120:123] offset:20480
  v_pk_fma_f32 v[100:101], v[40:41], v[94:95], v[68:69] op_sel:[0,0,0] op_sel_hi:[1,0,1] neg_lo:[0,1,0] neg_hi:[0,1,0]
  v_pk_fma_f32 v[102:103], v[42:43], v[94:95], v[70:71] op_sel:[0,0,0] op_sel_hi:[1,0,1] neg_lo:[0,1,0] neg_hi:[0,1,0]
  v_pk_fma_f32 v[172:173], v[172:173], v[94:95], v[100:101] op_sel:[0,1,0] op_sel_hi:[1,1,1]
  v_pk_fma_f32 v[174:175], v[174:175], v[94:95], v[102:103] op_sel:[0,1,0] op_sel_hi:[1,1,1]
  v_pk_mul_f32 v[100:101], v[172:173], v[172:173]
  v_pk_mul_f32 v[102:103], v[174:175], v[174:175]
  v_pk_fma_f32 v[100:101], v[100:101], v[96:97], v[96:97] op_sel:[0,1,0] op_sel_hi:[1,1,0]
  v_pk_fma_f32 v[102:103], v[102:103], v[96:97], v[96:97] op_sel:[0,1,0] op_sel_hi:[1,1,0]
  v_pk_mul_f32 v[100:101], v[100:101], v[172:173]
  v_pk_mul_f32 v[102:103], v[102:103], v[174:175]
  v_exp_f32 v100, v100
  v_exp_f32 v101, v101
  v_exp_f32 v102, v102
  v_exp_f32 v103, v103
  v_pk_add_f32 v[100:101], v[100:101], v[98:99] op_sel_hi:[1,0]
  v_pk_add_f32 v[102:103], v[102:103], v[98:99] op_sel_hi:[1,0]
  v_rcp_f32 v100, v100
  v_rcp_f32 v101, v101
  v_rcp_f32 v102, v102
  v_rcp_f32 v103, v103
  v_pk_mul_f32 v[172:173], v[172:173], v[100:101]
  v_pk_mul_f32 v[174:175], v[174:175], v[102:103]
  v_cvt_pk_bf16_f32 v108, v172, v173
  v_cvt_pk_bf16_f32 v109, v174, v175
  v_pk_fma_f32 v[104:105], v[44:45], v[94:95], v[72:73] op_sel:[0,0,0] op_sel_hi:[1,0,1] neg_lo:[0,1,0] neg_hi:[0,1,0]
  v_pk_fma_f32 v[106:107], v[46:47], v[94:95], v[74:75] op_sel:[0,0,0] op_sel_hi:[1,0,1] neg_lo:[0,1,0] neg_hi:[0,1,0]
  v_pk_fma_f32 v[188:189], v[188:189], v[94:95], v[104:105] op_sel:[0,1,0] op_sel_hi:[1,1,1]
  v_pk_fma_f32 v[190:191], v[190:191], v[94:95], v[106:107] op_sel:[0,1,0] op_sel_hi:[1,1,1]
  v_pk_mul_f32 v[104:105], v[188:189], v[188:189]
  v_pk_mul_f32 v[106:107], v[190:191], v[190:191]
  v_pk_fma_f32 v[104:105], v[104:105], v[96:97], v[96:97] op_sel:[0,1,0] op_sel_hi:[1,1,0]
  v_pk_fma_f32 v[106:107], v[106:107], v[96:97], v[96:97] op_sel:[0,1,0] op_sel_hi:[1,1,0]
  v_pk_mul_f32 v[104:105], v[104:105], v[188:189]
  v_pk_mul_f32 v[106:107], v[106:107], v[190:191]
  v_exp_f32 v104, v104
  v_exp_f32 v105, v105
  v_exp_f32 v106, v106
  v_exp_f32 v107, v107
  v_pk_add_f32 v[104:105], v[104:105], v[98:99] op_sel_hi:[1,0]
  v_pk_add_f32 v[106:107], v[106:107], v[98:99] op_sel_hi:[1,0]
  v_rcp_f32 v104, v104
  v_rcp_f32 v105, v105
  v_rcp_f32 v106, v106
  v_rcp_f32 v107, v107
  v_pk_mul_f32 v[188:189], v[188:189], v[104:105]
  v_pk_mul_f32 v[190:191], v[190:191], v[106:107]
  v_cvt_pk_bf16_f32 v110, v188, v189
  v_cvt_pk_bf16_f32 v111, v190, v191
  s_add_u32 s3, s10, 393216
  buffer_store_dwordx4 v[108:111], v12, s[44:47], s3 offen sc1
  ds_write_b128 v18, v[108:111] offset:6144
  v_pk_fma_f32 v[100:101], v[48:49], v[94:95], v[76:77] op_sel:[0,0,0] op_sel_hi:[1,0,1] neg_lo:[0,1,0] neg_hi:[0,1,0]
  v_pk_fma_f32 v[102:103], v[50:51], v[94:95], v[78:79] op_sel:[0,0,0] op_sel_hi:[1,0,1] neg_lo:[0,1,0] neg_hi:[0,1,0]
  v_pk_fma_f32 v[204:205], v[204:205], v[94:95], v[100:101] op_sel:[0,1,0] op_sel_hi:[1,1,1]
  v_pk_fma_f32 v[206:207], v[206:207], v[94:95], v[102:103] op_sel:[0,1,0] op_sel_hi:[1,1,1]
  v_pk_mul_f32 v[100:101], v[204:205], v[204:205]
  v_pk_mul_f32 v[102:103], v[206:207], v[206:207]
  v_pk_fma_f32 v[100:101], v[100:101], v[96:97], v[96:97] op_sel:[0,1,0] op_sel_hi:[1,1,0]
  v_pk_fma_f32 v[102:103], v[102:103], v[96:97], v[96:97] op_sel:[0,1,0] op_sel_hi:[1,1,0]
  v_pk_mul_f32 v[100:101], v[100:101], v[204:205]
  v_pk_mul_f32 v[102:103], v[102:103], v[206:207]
  v_exp_f32 v100, v100
  v_exp_f32 v101, v101
  v_exp_f32 v102, v102
  v_exp_f32 v103, v103
  v_pk_add_f32 v[100:101], v[100:101], v[98:99] op_sel_hi:[1,0]
  v_pk_add_f32 v[102:103], v[102:103], v[98:99] op_sel_hi:[1,0]
  v_rcp_f32 v100, v100
  v_rcp_f32 v101, v101
  v_rcp_f32 v102, v102
  v_rcp_f32 v103, v103
  v_pk_mul_f32 v[204:205], v[204:205], v[100:101]
  v_pk_mul_f32 v[206:207], v[206:207], v[102:103]
  v_cvt_pk_bf16_f32 v112, v204, v205
  v_cvt_pk_bf16_f32 v113, v206, v207
  v_pk_fma_f32 v[104:105], v[52:53], v[94:95], v[80:81] op_sel:[0,0,0] op_sel_hi:[1,0,1] neg_lo:[0,1,0] neg_hi:[0,1,0]
  v_pk_fma_f32 v[106:107], v[54:55], v[94:95], v[82:83] op_sel:[0,0,0] op_sel_hi:[1,0,1] neg_lo:[0,1,0] neg_hi:[0,1,0]
  v_pk_fma_f32 v[220:221], v[220:221], v[94:95], v[104:105] op_sel:[0,1,0] op_sel_hi:[1,1,1]
  v_pk_fma_f32 v[222:223], v[222:223], v[94:95], v[106:107] op_sel:[0,1,0] op_sel_hi:[1,1,1]
  v_pk_mul_f32 v[104:105], v[220:221], v[220:221]
  v_pk_mul_f32 v[106:107], v[222:223], v[222:223]
  v_pk_fma_f32 v[104:105], v[104:105], v[96:97], v[96:97] op_sel:[0,1,0] op_sel_hi:[1,1,0]
  v_pk_fma_f32 v[106:107], v[106:107], v[96:97], v[96:97] op_sel:[0,1,0] op_sel_hi:[1,1,0]
  v_pk_mul_f32 v[104:105], v[104:105], v[220:221]
  v_pk_mul_f32 v[106:107], v[106:107], v[222:223]
  v_exp_f32 v104, v104
  v_exp_f32 v105, v105
  v_exp_f32 v106, v106
  v_exp_f32 v107, v107
  v_pk_add_f32 v[104:105], v[104:105], v[98:99] op_sel_hi:[1,0]
  v_pk_add_f32 v[106:107], v[106:107], v[98:99] op_sel_hi:[1,0]
  v_rcp_f32 v104, v104
  v_rcp_f32 v105, v105
  v_rcp_f32 v106, v106
  v_rcp_f32 v107, v107
  v_pk_mul_f32 v[220:221], v[220:221], v[104:105]
  v_pk_mul_f32 v[222:223], v[222:223], v[106:107]
  v_cvt_pk_bf16_f32 v114, v220, v221
  v_cvt_pk_bf16_f32 v115, v222, v223
  s_add_u32 s3, s10, 395264
  buffer_store_dwordx4 v[112:115], v12, s[44:47], s3 offen sc1
  ds_write_b128 v18, v[112:115] offset:22528
  s_waitcnt vmcnt(0) lgkmcnt(0)
  s_barrier
  s_add_u32 s97, s97, 1
  s_branch L_w2_body
L_w1_c1:
L_w2_c0:
L_w2_body:
  s_cmp_ge_u32 s2, 256
  s_cbranch_scc1 L_w2_end
  v_lshrrev_b32 v2, 6, v0
  v_and_b32 v1, 63, v0
  v_readfirstlane_b32 s70, v2
  s_and_b32 s3, s2, 7
  s_lshr_b32 s99, s2, 3
  s_and_b32 s5, s3, 3
  s_lshl_b32 s5, s5, 2
  s_and_b32 s6, s99, 3
  s_add_u32 s68, s5, s6
  s_lshr_b32 s5, s3, 2
  s_lshr_b32 s78, s99, 2
  s_lshl1_add_u32 s69, s78, s5
  s_add_u32 s3, s68, s78
  s_lshl_b32 s3, s3, 3
  s_lshl_b32 s85, 0xffff02, s3
  s_sub_u32 s3, 0, s3
  s_lshr_b32 s3, 0xffff02, s3
  s_or_b32 s85, s85, s3
  s_cmp_lt_u32 s70, 4
  s_cbranch_scc1 L_w2_compute
L_w2_loader:
  s_add_u32 s3, s68, s78
  s_and_b32 s3, s3, 3
  s_mov_b32 s4, 0x1616160
  s_cmp_eq_u32 s3, 1
  s_cselect_b32 s4, 0x5858580, s4
  s_cmp_eq_u32 s3, 2
  s_cselect_b32 s4, 0x16161600, s4
  s_cmp_eq_u32 s3, 3
  s_cselect_b32 s4, 0x58585800, s4
  v_subrev_u32 v2, 3, v1
  v_min_u32 v2, 16, v2
  v_lshlrev_b32 v3, 1, v2
  v_bfe_i32 v16, s4, v3, 2
  v_sub_u32 v16, v1, v16
  v_subrev_u32 v16, 7, v16
  v_ashrrev_i32 v3, 1, v16
  v_cmp_eq_u32 vcc, s78, v3
  s_and_b32 s3, s69, 1
  v_or_b32 v2, 14, v16
  v_cndmask_b32 v2, v16, v2, vcc
  v_cmp_gt_i32 vcc, 0, v16
  s_lshl2_add_u32 s4, s3, 20
  v_add_u32 v16, s4, v16
  s_lshl4_add_u32 s4, s3, 24
  v_add_u32 v2, s4, v2
  v_cndmask_b32 v16, v2, v16, vcc
  s_and_b32 s5, s68, 3
  s_mul_i32 s5, s5, 3
  s_sub_u32 s5, s5, 23
  v_add_u32 v3, s5, v1
  v_subrev_u32 v2, 10, v3
  v_min_u32 v3, v3, v2
  v_subrev_u32 v2, 10, v3
  v_min_u32 v3, v3, v2
  v_cmp_gt_u32 vcc, 23, v1
  s_sub_u32 s5, s3, 46
  v_lshl_add_u32 v2, v1, 1, s5
  v_cndmask_b32 v3, v3, v2, vcc
  s_add_u32 s5, s78, 3
  v_ashrrev_i32 v2, 1, v3
  v_add_u32 v2, s5, v2
  v_and_b32 v2, 7, v2
  v_and_b32 v3, 1, v3
  v_cmp_gt_u32 vcc, 21, v1
  v_lshl_add_u32 v3, v3, 3, v2
  s_lshl1_add_u32 s4, s78, s4
  s_lshl3_add_u32 s3, s3, s78
  v_cndmask_b32 v3, v3, v16, vcc
  v_writelane_b32 v3, s4, 0
  s_add_u32 s4, s4, 1
  v_writelane_b32 v3, s3, 2
  v_writelane_b32 v3, s4, 1
  v_lshlrev_b32 v16, 17, v3
  s_add_u32 s9, s70, s68
  s_and_b32 s9, s9, 3
  s_lshl_b32 s77, s9, 11
  v_and_b32 v10, 7, v1
  v_lshrrev_b32 v3, 3, v1
  s_lshl_b32 s10, s9, 4
  v_add_u32 v3, s10, v3
  v_mul_u32_u24 v3, 2048, v3
  v_lshrrev_b32 v2, 3, v1
  v_and_b32 v2, 6, v2
  v_xor_b32 v2, v2, v10
  s_lshl_b32 s10, s69, 7
  v_add_u32 v3, s10, v3
  v_lshl_add_u32 v8, v2, 4, v3
  v_add_u32 v3, 16384, v3
  v_lshl_add_u32 v9, v2, 4, v3
  s_mov_b32 s40, s28
  s_and_b32 s41, s29, 0xffff
  s_mov_b32 s42, 7340032
  s_mov_b32 s43, 0x00020000
  s_bitcmp1_b32 s69, 0
  s_mov_b32 s76, 128
  s_cselect_b32 s76, -128, s76
  v_readlane_b32 s74, v16, 0
  s_add_u32 m0, s77, 0
  s_add_u32 s4, s74, s76
  buffer_load_dwordx4 v8, s[40:43], s4 offen lds
  s_add_u32 m0, s77, 1024
  s_nop 0
  buffer_load_dwordx4 v9, s[40:43], s4 offen lds
  s_add_u32 m0, s77, 8192
  s_add_u32 s4, s74, 0
  buffer_load_dwordx4 v8, s[40:43], s4 offen lds
  s_add_u32 m0, s77, 9216
  s_nop 0
  buffer_load_dwordx4 v9, s[40:43], s4 offen lds
  v_readlane_b32 s74, v16, 1
  s_add_u32 m0, s77, 16384
  s_add_u32 s4, s74, s76
  buffer_load_dwordx4 v8, s[40:43], s4 offen lds
  s_add_u32 m0, s77, 17408
  s_nop 0
  buffer_load_dwordx4 v9, s[40:43], s4 offen lds
  s_add_u32 m0, s77, 24576
  s_add_u32 s4, s74, 0
  buffer_load_dwordx4 v8, s[40:43], s4 offen lds
  s_add_u32 m0, s77, 25600
  s_nop 0
  buffer_load_dwordx4 v9, s[40:43], s4 offen lds
  v_readlane_b32 s74, v16, 2
  s_add_u32 m0, s77, 32768
  s_add_u32 s4, s74, s76
  buffer_load_dwordx4 v8, s[40:43], s4 offen lds
  s_add_u32 m0, s77, 33792
  s_nop 0
  buffer_load_dwordx4 v9, s[40:43], s4 offen lds
  s_add_u32 m0, s77, 40960
  s_add_u32 s4, s74, 0
  buffer_load_dwordx4 v8, s[40:43], s4 offen lds
  s_add_u32 m0, s77, 41984
  s_nop 0
  buffer_load_dwordx4 v9, s[40:43], s4 offen lds
  v_readlane_b32 s74, v16, 3
  s_add_u32 m0, s77, 49152
  s_add_u32 s4, s74, s76
  buffer_load_dwordx4 v8, s[40:43], s4 offen lds
  s_add_u32 m0, s77, 50176
  s_nop 0
  buffer_load_dwordx4 v9, s[40:43], s4 offen lds
  s_add_u32 m0, s77, 57344
  s_add_u32 s4, s74, 0
  buffer_load_dwordx4 v8, s[40:43], s4 offen lds
  s_add_u32 m0, s77, 58368
  s_nop 0
  buffer_load_dwordx4 v9, s[40:43], s4 offen lds
  v_readlane_b32 s74, v16, 4
  s_add_u32 m0, s77, 65536
  s_add_u32 s4, s74, s76
  buffer_load_dwordx4 v8, s[40:43], s4 offen lds
  s_add_u32 m0, s77, 66560
  s_nop 0
  buffer_load_dwordx4 v9, s[40:43], s4 offen lds
  s_add_u32 m0, s77, 73728
  s_add_u32 s4, s74, 0
  buffer_load_dwordx4 v8, s[40:43], s4 offen lds
  s_add_u32 m0, s77, 74752
  s_nop 0
  buffer_load_dwordx4 v9, s[40:43], s4 offen lds
  s_add_u32 s44, s22, 41943040
  s_addc_u32 s45, s23, 0
  s_and_b32 s45, s45, 0xffff
  s_mov_b32 s46, 524288
  s_mov_b32 s47, 0x00020000
  s_lshl4_add_u32 s3, s97, s68
  s_and_b32 s4, s69, 15
  s_lshl4_add_u32 s3, s3, s4
  s_lshl_b32 s3, s3, 7
  s_sub_u32 s3, s3, 32768
  v_lshlrev_b32 v11, 7, v1
  v_and_b32 v2, 15, v1
  v_lshlrev_b32 v2, 2, v2
  v_mov_b32 v3, 1
  s_mov_b32 s79, 0x100000
  s_cmp_lg_u32 s70, 4
  s_barrier
  s_cbranch_scc1 L_w2_nofl
  s_mov_b32 exec_lo, 0xffff
  s_mov_b32 exec_hi, 0
  buffer_store_dword v3, v11, s[44:47], s87 offen sc1
  s_mov_b64 exec, -1
L_w2_nofl:
  s_mov_b32 s5, s3
  v_readlane_b32 s74, v16, 5
  s_add_u32 m0, s77, 81920
  s_add_u32 s4, s74, s76
  buffer_load_dwordx4 v8, s[40:43], s4 offen lds
  s_add_u32 m0, s77, 82944
  s_nop 0
  buffer_load_dwordx4 v9, s[40:43], s4 offen lds
  s_add_u32 m0, s77, 90112
  s_add_u32 s4, s74, 0
  buffer_load_dwordx4 v8, s[40:43], s4 offen lds
  s_add_u32 m0, s77, 91136
  s_nop 0
  buffer_load_dwordx4 v9, s[40:43], s4 offen lds
  v_readlane_b32 s74, v16, 6
  s_add_u32 m0, s77, 98304
  s_add_u32 s4, s74, s76
  buffer_load_dwordx4 v8, s[40:43], s4 offen lds
  s_add_u32 m0, s77, 99328
  s_nop 0
  buffer_load_dwordx4 v9, s[40:43], s4 offen lds
  s_add_u32 m0, s77, 106496
  s_add_u32 s4, s74, 0
  buffer_load_dwordx4 v8, s[40:43], s4 offen lds
  s_add_u32 m0, s77, 107520
  s_nop 0
  buffer_load_dwordx4 v9, s[40:43], s4 offen lds
  s_waitcnt vmcnt(20)
  s_barrier
  v_readlane_b32 s74, v16, 7
  s_add_u32 m0, s77, 114688
  s_add_u32 s4, s74, s76
  buffer_load_dwordx4 v8, s[40:43], s4 offen lds
  s_add_u32 m0, s77, 115712
  s_nop 0
  buffer_load_dwordx4 v9, s[40:43], s4 offen lds
  s_add_u32 m0, s77, 122880
  s_add_u32 s4, s74, 0
  buffer_load_dwordx4 v8, s[40:43], s4 offen lds
  s_add_u32 m0, s77, 123904
  s_nop 0
  buffer_load_dwordx4 v9, s[40:43], s4 offen lds
  v_readlane_b32 s74, v16, 8
  s_add_u32 m0, s77, 131072
  s_add_u32 s4, s74, s76
  buffer_load_dwordx4 v8, s[40:43], s4 offen lds
  s_add_u32 m0, s77, 132096
  s_nop 0
  buffer_load_dwordx4 v9, s[40:43], s4 offen lds
  s_add_u32 m0, s77, 139264
  s_add_u32 s4, s74, 0
  buffer_load_dwordx4 v8, s[40:43], s4 offen lds
  s_add_u32 m0, s77, 140288
  s_nop 0
  buffer_load_dwordx4 v9, s[40:43], s4 offen lds
  v_readlane_b32 s74, v16, 9
  s_add_u32 m0, s77, 147456
  s_add_u32 s4, s74, s76
  buffer_load_dwordx4 v8, s[40:43], s4 offen lds
  s_add_u32 m0, s77, 148480
  s_nop 0
  buffer_load_dwordx4 v9, s[40:43], s4 offen lds
  s_add_u32 m0, s77, 155648
  s_add_u32 s4, s74, 0
  buffer_load_dwordx4 v8, s[40:43], s4 offen lds
  s_add_u32 m0, s77, 156672
  s_nop 0
  buffer_load_dwordx4 v9, s[40:43], s4 offen lds
  s_mov_b32 s3, s5
  s_cmp_lg_u32 s70, 4
  s_cbranch_scc1 L_w2_dep
L_w2_poll:
  buffer_load_dword v3, v2, s[44:47], s3 offen sc1
  s_sub_u32 s79, s79, 1
  s_cbranch_scc1 L_w2_dep
  s_waitcnt vmcnt(0)
  v_cmp_ne_u32 vcc, 1, v3
  s_cbranch_vccnz L_w2_poll
L_w2_dep:
  s_waitcnt vmcnt(22) lgkmcnt(0)
  s_barrier
  v_readlane_b32 s74, v16, 10
  s_add_u32 m0, s77, 0
  s_add_u32 s4, s74, s76
  buffer_load_dwordx4 v8, s[40:43], s4 offen lds
  s_add_u32 m0, s77, 1024
  s_nop 0
  buffer_load_dwordx4 v9, s[40:43], s4 offen lds
  s_waitcnt vmcnt(4)
  s_add_u32 m0, s77, 8192
  s_add_u32 s4, s74, 0
  buffer_load_dwordx4 v8, s[40:43], s4 offen lds
  s_add_u32 m0, s77, 9216
  s_nop 0
  buffer_load_dwordx4 v9, s[40:43], s4 offen lds
  s_waitcnt vmcnt(4)
  v_readlane_b32 s74, v16, 11
  s_add_u32 m0, s77, 16384
  s_add_u32 s4, s74, s76
  buffer_load_dwordx4 v8, s[40:43], s4 offen lds
  s_add_u32 m0, s77, 17408
  s_nop 0
  buffer_load_dwordx4 v9, s[40:43], s4 offen lds
  s_waitcnt vmcnt(20)
  s_barrier
  s_add_u32 m0, s77, 24576
  s_add_u32 s4, s74, 0
  buffer_load_dwordx4 v8, s[40:43], s4 offen lds
  s_add_u32 m0, s77, 25600
  s_nop 0
  buffer_load_dwordx4 v9, s[40:43], s4 offen lds
  s_waitcnt vmcnt(4)
  v_readlane_b32 s74, v16, 12
  s_add_u32 m0, s77, 32768
  s_add_u32 s4, s74, s76
  buffer_load_dwordx4 v8, s[40:43], s4 offen lds
  s_add_u32 m0, s77, 33792
  s_nop 0
  buffer_load_dwordx4 v9, s[40:43], s4 offen lds
  s_waitcnt vmcnt(4)
  s_add_u32 m0, s77, 40960
  s_add_u32 s4, s74, 0
  buffer_load_dwordx4 v8, s[40:43], s4 offen lds
  s_add_u32 m0, s77, 41984
  s_nop 0
  buffer_load_dwordx4 v9, s[40:43], s4 offen lds
  s_waitcnt vmcnt(4)
  v_readlane_b32 s74, v16, 13
  s_add_u32 m0, s77, 49152
  s_add_u32 s4, s74, s76
  buffer_load_dwordx4 v8, s[40:43], s4 offen lds
  s_add_u32 m0, s77, 50176
  s_nop 0
  buffer_load_dwordx4 v9, s[40:43], s4 offen lds
  s_waitcnt vmcnt(4)
  s_add_u32 m0, s77, 57344
  s_add_u32 s4, s74, 0
  buffer_load_dwordx4 v8, s[40:43], s4 offen lds
  s_add_u32 m0, s77, 58368
  s_nop 0
  buffer_load_dwordx4 v9, s[40:43], s4 offen lds
  s_waitcnt vmcnt(22)
  s_barrier
  v_readlane_b32 s74, v16, 14
  s_add_u32 m0, s77, 65536
  s_add_u32 s4, s74, s76
  buffer_load_dwordx4 v8, s[40:43], s4 offen lds
  s_add_u32 m0, s77, 66560
  s_nop 0
  buffer_load_dwordx4 v9, s[40:43], s4 offen lds
  s_waitcnt vmcnt(4)
  s_add_u32 m0, s77, 73728
  s_add_u32 s4, s74, 0
  buffer_load_dwordx4 v8, s[40:43], s4 offen lds
  s_add_u32 m0, s77, 74752
  s_nop 0
  buffer_load_dwordx4 v9, s[40:43], s4 offen lds
  s_waitcnt vmcnt(4)
  v_readlane_b32 s74, v16, 15
  s_add_u32 m0, s77, 81920
  s_add_u32 s4, s74, s76
  buffer_load_dwordx4 v8, s[40:43], s4 offen lds
  s_add_u32 m0, s77, 82944
  s_nop 0
  buffer_load_dwordx4 v9, s[40:43], s4 offen lds
  s_waitcnt vmcnt(4)
  s_add_u32 m0, s77, 90112
  s_add_u32 s4, s74, 0
  buffer_load_dwordx4 v8, s[40:43], s4 offen lds
  s_add_u32 m0, s77, 91136
  s_nop 0
  buffer_load_dwordx4 v9, s[40:43], s4 offen lds
  s_waitcnt vmcnt(22)
  s_barrier
  v_readlane_b32 s74, v16, 16
  s_add_u32 m0, s77, 98304
  s_add_u32 s4, s74, s76
  buffer_load_dwordx4 v8, s[40:43], s4 offen lds
  s_add_u32 m0, s77, 99328
  s_nop 0
  buffer_load_dwordx4 v9, s[40:43], s4 offen lds
  s_waitcnt vmcnt(4)
  s_add_u32 m0, s77, 106496
  s_add_u32 s4, s74, 0
  buffer_load_dwordx4 v8, s[40:43], s4 offen lds
  s_add_u32 m0, s77, 107520
  s_nop 0
  buffer_load_dwordx4 v9, s[40:43], s4 offen lds
  s_waitcnt vmcnt(4)
  v_readlane_b32 s74, v16, 17
  s_add_u32 m0, s77, 114688
  s_add_u32 s4, s74, s76
  buffer_load_dwordx4 v8, s[40:43], s4 offen lds
  s_add_u32 m0, s77, 115712
  s_nop 0
  buffer_load_dwordx4 v9, s[40:43], s4 offen lds
  s_waitcnt vmcnt(4)
  v_readlane_b32 s74, v16, 18
  s_add_u32 m0, s77, 122880
  s_add_u32 s4, s74, s76
  buffer_load_dwordx4 v8, s[40:43], s4 offen lds
  s_add_u32 m0, s77, 123904
  s_nop 0
  buffer_load_dwordx4 v9, s[40:43], s4 offen lds
  s_waitcnt vmcnt(22)
  s_barrier
  v_readlane_b32 s74, v16, 19
  s_add_u32 m0, s77, 131072
  s_add_u32 s4, s74, s76
  buffer_load_dwordx4 v8, s[40:43], s4 offen lds
  s_add_u32 m0, s77, 132096
  s_nop 0
  buffer_load_dwordx4 v9, s[40:43], s4 offen lds
  s_waitcnt vmcnt(4)
  v_readlane_b32 s74, v16, 20
  s_add_u32 m0, s77, 139264
  s_add_u32 s4, s74, s76
  buffer_load_dwordx4 v8, s[40:43], s4 offen lds
  s_add_u32 m0, s77, 140288
  s_nop 0
  buffer_load_dwordx4 v9, s[40:43], s4 offen lds
  s_waitcnt vmcnt(4)
  v_readlane_b32 s74, v16, 21
  s_add_u32 m0, s77, 147456
  s_add_u32 s4, s74, s76
  buffer_load_dwordx4 v8, s[40:43], s4 offen lds
  s_add_u32 m0, s77, 148480
  s_nop 0
  buffer_load_dwordx4 v9, s[40:43], s4 offen lds
  s_waitcnt vmcnt(4)
  v_readlane_b32 s74, v16, 22
  s_add_u32 m0, s77, 155648
  s_add_u32 s4, s74, s76
  buffer_load_dwordx4 v8, s[40:43], s4 offen lds
  s_add_u32 m0, s77, 156672
  s_nop 0
  buffer_load_dwordx4 v9, s[40:43], s4 offen lds
  s_waitcnt vmcnt(22)
  s_barrier
  v_readlane_b32 s74, v16, 17
  s_add_u32 m0, s77, 0
  s_add_u32 s4, s74, 0
  buffer_load_dwordx4 v8, s[40:43], s4 offen lds
  s_add_u32 m0, s77, 1024
  s_nop 0
  buffer_load_dwordx4 v9, s[40:43], s4 offen lds
  s_waitcnt vmcnt(4)
  v_readlane_b32 s74, v16, 18
  s_add_u32 m0, s77, 8192
  s_add_u32 s4, s74, 0
  buffer_load_dwordx4 v8, s[40:43], s4 offen lds
  s_add_u32 m0, s77, 9216
  s_nop 0
  buffer_load_dwordx4 v9, s[40:43], s4 offen lds
  s_waitcnt vmcnt(4)
  v_readlane_b32 s74, v16, 19
  s_add_u32 m0, s77, 16384
  s_add_u32 s4, s74, 0
  buffer_load_dwordx4 v8, s[40:43], s4 offen lds
  s_add_u32 m0, s77, 17408
  s_nop 0
  buffer_load_dwordx4 v9, s[40:43], s4 offen lds
  s_waitcnt vmcnt(4)
  v_readlane_b32 s74, v16, 20
  s_add_u32 m0, s77, 24576
  s_add_u32 s4, s74, 0
  buffer_load_dwordx4 v8, s[40:43], s4 offen lds
  s_add_u32 m0, s77, 25600
  s_nop 0
  buffer_load_dwordx4 v9, s[40:43], s4 offen lds
  s_waitcnt vmcnt(22)
  s_barrier
  v_readlane_b32 s74, v16, 21
  s_add_u32 m0, s77, 32768
  s_add_u32 s4, s74, 0
  buffer_load_dwordx4 v8, s[40:43], s4 offen lds
  s_add_u32 m0, s77, 33792
  s_nop 0
  buffer_load_dwordx4 v9, s[40:43], s4 offen lds
  s_waitcnt vmcnt(4)
  v_readlane_b32 s74, v16, 22
  s_add_u32 m0, s77, 40960
  s_add_u32 s4, s74, 0
  buffer_load_dwordx4 v8, s[40:43], s4 offen lds
  s_add_u32 m0, s77, 41984
  s_nop 0
  buffer_load_dwordx4 v9, s[40:43], s4 offen lds
  s_waitcnt vmcnt(4)
  v_readlane_b32 s74, v16, 23
  s_add_u32 m0, s77, 49152
  s_add_u32 s4, s74, 0
  buffer_load_dwordx4 v8, s[40:43], s4 offen lds
  s_add_u32 m0, s77, 50176
  s_nop 0
  buffer_load_dwordx4 v9, s[40:43], s4 offen lds
  s_waitcnt vmcnt(4)
  v_readlane_b32 s74, v16, 24
  s_add_u32 m0, s77, 57344
  s_add_u32 s4, s74, 0
  buffer_load_dwordx4 v8, s[40:43], s4 offen lds
  s_add_u32 m0, s77, 58368
  s_nop 0
  buffer_load_dwordx4 v9, s[40:43], s4 offen lds
  s_waitcnt vmcnt(22)
  s_barrier
  v_readlane_b32 s74, v16, 25
  s_add_u32 m0, s77, 65536
  s_add_u32 s4, s74, 0
  buffer_load_dwordx4 v8, s[40:43], s4 offen lds
  s_add_u32 m0, s77, 66560
  s_nop 0
  buffer_load_dwordx4 v9, s[40:43], s4 offen lds
  s_waitcnt vmcnt(4)
  v_readlane_b32 s74, v16, 26
  s_add_u32 m0, s77, 73728
  s_add_u32 s4, s74, 0
  buffer_load_dwordx4 v8, s[40:43], s4 offen lds
  s_add_u32 m0, s77, 74752
  s_nop 0
  buffer_load_dwordx4 v9, s[40:43], s4 offen lds
  s_waitcnt vmcnt(4)
  v_readlane_b32 s74, v16, 27
  s_add_u32 m0, s77, 81920
  s_add_u32 s4, s74, 0
  buffer_load_dwordx4 v8, s[40:43], s4 offen lds
  s_add_u32 m0, s77, 82944
  s_nop 0
  buffer_load_dwordx4 v9, s[40:43], s4 offen lds
  s_waitcnt vmcnt(4)
  v_readlane_b32 s74, v16, 28
  s_add_u32 m0, s77, 90112
  s_add_u32 s4, s74, 0
  buffer_load_dwordx4 v8, s[40:43], s4 offen lds
  s_add_u32 m0, s77, 91136
  s_nop 0
  buffer_load_dwordx4 v9, s[40:43], s4 offen lds
  s_waitcnt vmcnt(22)
  s_barrier
  v_readlane_b32 s74, v16, 29
  s_add_u32 m0, s77, 98304
  s_add_u32 s4, s74, 0
  buffer_load_dwordx4 v8, s[40:43], s4 offen lds
  s_add_u32 m0, s77, 99328
  s_nop 0
  buffer_load_dwordx4 v9, s[40:43], s4 offen lds
  s_waitcnt vmcnt(4)
  v_readlane_b32 s74, v16, 30
  s_add_u32 m0, s77, 106496
  s_add_u32 s4, s74, 0
  buffer_load_dwordx4 v8, s[40:43], s4 offen lds
  s_add_u32 m0, s77, 107520
  s_nop 0
  buffer_load_dwordx4 v9, s[40:43], s4 offen lds
  s_waitcnt vmcnt(4)
  v_readlane_b32 s74, v16, 31
  s_add_u32 m0, s77, 114688
  s_add_u32 s4, s74, 0
  buffer_load_dwordx4 v8, s[40:43], s4 offen lds
  s_add_u32 m0, s77, 115712
  s_nop 0
  buffer_load_dwordx4 v9, s[40:43], s4 offen lds
  s_waitcnt vmcnt(4)
  v_readlane_b32 s74, v16, 32
  s_add_u32 m0, s77, 122880
  s_add_u32 s4, s74, 0
  buffer_load_dwordx4 v8, s[40:43], s4 offen lds
  s_add_u32 m0, s77, 123904
  s_nop 0
  buffer_load_dwordx4 v9, s[40:43], s4 offen lds
  s_waitcnt vmcnt(22)
  s_barrier
  s_add_u32 s64, s22, 41943040
  s_addc_u32 s65, s23, 0
  s_and_b32 s65, s65, 0xffff
  s_mov_b32 s66, 524288
  s_mov_b32 s67, 0x00020000
  s_lshl4_add_u32 s6, s68, s69
  s_xor_b32 s6, s6, 1
  s_add_u32 s7, s96, 4
  s_lshl_b32 s7, s7, 8
  s_add_u32 s6, s6, s7
  s_lshl_b32 s86, s6, 8
  v_and_b32 v2, 3, v1
  v_lshlrev_b32 v30, 6, v2
  s_mov_b32 s79, 0x100000
  s_waitcnt vmcnt(0)
  s_barrier
  s_cmp_eq_u32 s96, 0
  s_cbranch_scc1 L_w2_zskip
  s_cmp_lg_u32 s70, 4
  s_cbranch_scc1 L_w2_xgo
  s_setprio 3
L_w2_xpoll:
  buffer_load_dword v5, v30, s[64:67], s86 offen sc1
  s_sub_u32 s79, s79, 1
  s_cbranch_scc1 L_w2_xgo
  s_waitcnt vmcnt(0)
  v_cmp_ne_u32 vcc, 1, v5
  s_cbranch_vccnz L_w2_xpoll
L_w2_xgo:
  s_setprio 0
  s_waitcnt vmcnt(0)
  s_barrier
L_w2_zskip:
  s_cmp_eq_u32 s96, 1
  s_cbranch_scc1 L_w2_end
  s_lshl_b32 s87, s97, 15
  s_lshl_b32 s4, s68, 11
  s_add_u32 s87, s87, s4
  s_lshl_b32 s4, s69, 2
  s_add_u32 s87, s87, s4
  s_mov_b32 s96, 1
  s_add_u32 s12, s22, 33554432
  s_addc_u32 s13, s23, 0
  s_add_u32 s34, s22, 67108864
  s_addc_u32 s35, s23, 0
  s_add_u32 s97, s97, 1
  s_branch L_attn_body
L_w2_end:
  s_endpgm
L_w2_compute:
  s_lshl_b32 s3, s70, 12
  s_add_u32 s3, s3, 114688
  v_lshl_add_u32 v2, v1, 4, s3
  ds_read_b128 v[32:35], v2 offset:0
  ds_read_b128 v[36:39], v2 offset:2048
  ds_read_b128 v[40:43], v2 offset:1024
  ds_read_b128 v[44:47], v2 offset:3072
  ds_read_b128 v[48:51], v2 offset:16384
  ds_read_b128 v[52:55], v2 offset:18432
  ds_read_b128 v[56:59], v2 offset:17408
  ds_read_b128 v[60:63], v2 offset:19456
  ds_read_b128 v[64:67], v2 offset:32768
  ds_read_b128 v[68:71], v2 offset:34816
  ds_read_b128 v[72:75], v2 offset:33792
  ds_read_b128 v[76:79], v2 offset:35840
  s_add_u32 s3, s68, s78
  s_and_b32 s3, s3, 3
  s_mov_b32 s4, 0x1616160
  s_cmp_eq_u32 s3, 1
  s_cselect_b32 s4, 0x5858580, s4
  s_cmp_eq_u32 s3, 2
  s_cselect_b32 s4, 0x16161600, s4
  s_cmp_eq_u32 s3, 3
  s_cselect_b32 s4, 0x58585800, s4
  v_subrev_u32 v2, 3, v1
  v_min_u32 v2, 16, v2
  v_lshlrev_b32 v3, 1, v2
  v_bfe_i32 v15, s4, v3, 2
  v_sub_u32 v15, v1, v15
  v_subrev_u32 v15, 7, v15
  v_ashrrev_i32 v3, 1, v15
  v_cmp_eq_u32 vcc, s78, v3
  s_and_b32 s3, s69, 1
  v_or_b32 v2, 14, v15
  v_cndmask_b32 v2, v15, v2, vcc
  v_cmp_gt_i32 vcc, 0, v15
  s_lshl2_add_u32 s4, s3, 20
  v_add_u32 v15, s4, v15
  s_lshl4_add_u32 s4, s3, 24
  v_add_u32 v2, s4, v2
  v_cndmask_b32 v15, v2, v15, vcc
  s_and_b32 s5, s68, 3
  s_mul_i32 s5, s5, 3
  s_sub_u32 s5, s5, 23
  v_add_u32 v3, s5, v1
  v_subrev_u32 v2, 10, v3
  v_min_u32 v3, v3, v2
  v_subrev_u32 v2, 10, v3
  v_min_u32 v3, v3, v2
  v_cmp_gt_u32 vcc, 23, v1
  s_sub_u32 s5, s3, 46
  v_lshl_add_u32 v2, v1, 1, s5
  v_cndmask_b32 v3, v3, v2, vcc
  s_add_u32 s5, s78, 3
  v_ashrrev_i32 v2, 1, v3
  v_add_u32 v2, s5, v2
  v_and_b32 v2, 7, v2
  v_and_b32 v3, 1, v3
  v_cmp_gt_u32 vcc, 21, v1
  v_lshl_add_u32 v3, v3, 3, v2
  s_lshl1_add_u32 s4, s78, s4
  s_lshl3_add_u32 s3, s3, s78
  v_cndmask_b32 v3, v3, v15, vcc
  v_writelane_b32 v3, s4, 0
  s_add_u32 s4, s4, 1
  v_writelane_b32 v3, s3, 2
  v_writelane_b32 v3, s4, 1
  v_lshlrev_b32 v15, 11, v3
  s_waitcnt lgkmcnt(0)
  s_barrier
  v_and_b32 v3, 15, v1
  v_lshrrev_b32 v2, 4, v1
  s_lshl_b32 s8, s68, 7
  s_lshl_b32 s9, s70, 5
  s_add_u32 s8, s8, s9
  s_mul_i32 s9, s8, 7168
  v_add_u32 v13, s8, v3
  s_lshl_b32 s10, s69, 7
  v_lshl_add_u32 v14, v2, 3, s10
  v_and_b32 v16, 1, v2
  v_lshrrev_b32 v17, 1, v2
  v_lshlrev_b32 v4, 3, v3
  v_and_b32 v4, 0x70, v4
  v_lshlrev_b32 v16, 3, v2
  v_xor_b32 v4, v4, v16
  v_lshl_add_u32 v4, v3, 7, v4
  s_lshl_b32 s3, s70, 12
  v_add_u32 v4, s3, v4
  v_lshl_add_u32 v5, v1, 4, s3
  s_cmp_eq_u32 s96, 0
  s_cselect_b32 s7, 128, 0
  s_add_u32 s7, s7, 2048
  v_xor_b32 v16, v1, v2
  v_and_b32 v16, 7, v16
  v_lshl_add_u32 v16, v16, 4, s10
  v_lshrrev_b32 v14, 3, v1
  v_add_u32 v14, s8, v14
  v_mad_u32_u24 v12, v14, s7, v16
  v_lshl_add_u32 v18, v17, 4, v13
  v_lshlrev_b32 v18, 3, v18
  v_and_b32 v16, 1, v2
  v_lshl_add_u32 v18, v16, 2, v18
  s_lshl_b32 s10, s69, 14
  v_add_u32 v18, s10, v18
  v_lshrrev_b32 v6, 2, v1
  v_lshlrev_b32 v6, 7, v6
  v_and_b32 v17, 3, v1
  v_lshl_add_u32 v6, v17, 3, v6
  v_bfe_u32 v17, v1, 3, 2
  v_lshl_add_u32 v6, v17, 5, v6
  v_xor_b32 v7, 32, v6
  v_xor_b32 v8, 64, v6
  v_xor_b32 v9, 96, v6
  s_mov_b32 s11, 0xffff0000
  s_add_u32 s36, s34, 8388608
  s_addc_u32 s37, s35, 0
  s_and_b32 s37, s37, 0xffff
  s_mov_b32 s38, 14680064
  s_mov_b32 s39, 0x00020000
  s_mov_b32 s44, s32
  s_and_b32 s45, s33, 0xffff
  s_mov_b32 s46, 4194304
  s_mov_b32 s47, 0x00020000
  s_add_u32 s48, s22, 33554432
  s_addc_u32 s49, s23, 0
  s_and_b32 s49, s49, 0xffff
  s_mov_b32 s50, 4194304
  s_mov_b32 s51, 0x00020000
  s_cmp_eq_u32 s96, 0
  s_cselect_b64 s[44:45], s[48:49], s[44:45]
  s_lshl_b32 s46, s7, 11
  s_add_u32 s56, s34, 24379392
  s_addc_u32 s57, s35, 0
  s_and_b32 s57, s57, 0xffff
  s_mov_b32 s58, 262144
  s_mov_b32 s59, 0x00020000
  s_mul_i32 s9, s8, 7168
  s_add_u32 s36, s36, s9
  s_addc_u32 s37, s37, 0x100000
  s_add_u32 s64, s36, 114688
  s_addc_u32 s65, s37, 0
  s_mov_b32 s38, 114688
  s_mov_b32 s39, 0x00800000
  s_mov_b32 s66, 114688
  s_mov_b32 s67, 0x00800000
  s_add_u32 s60, s34, 25165824
  s_addc_u32 s61, s35, 0
  s_and_b32 s61, s61, 0xffff
  s_mov_b32 s62, 4194304
  s_mov_b32 s63, 0x00020000
  s_or_b32 s61, s61, 0x100000
  s_mov_b32 s63, 0x00800000
  s_lshl4_add_u32 s4, s68, s69
  s_lshl2_add_u32 s4, s4, s70
  s_add_u32 s52, s22, 41943040
  s_addc_u32 s53, s23, 0
  s_and_b32 s53, s53, 0xffff
  s_mov_b32 s54, 524288
  s_mov_b32 s55, 0x00020000
  s_add_u32 s6, s96, 4
  s_lshl_b32 s6, s6, 10
  s_add_u32 s6, s6, s4
  s_lshl_b32 s6, s6, 6
  v_mov_b32 v19, 1
  s_lshl_b32 s4, s4, 12
  s_xor_b32 s5, s4, 16384
  v_add_u32 v26, 131072, v6
  v_add_u32 v27, 131072, v7
  v_add_u32 v28, 131072, v8
  v_add_u32 v29, 131072, v9
  v_add_u32 v20, 65536, v6
  v_add_u32 v21, 65536, v7
  v_add_u32 v22, 65536, v8
  v_add_u32 v23, 65536, v9
  v_readlane_b32 s51, v15, 3
  v_readlane_b32 s48, v15, 4
  v_readlane_b32 s49, v15, 5
  s_waitcnt lgkmcnt(0)
  ds_read_b64_tr_b16 v[160:161], v6 offset:0
  ds_read_b64_tr_b16 v[162:163], v6 offset:2048
  ds_read_b64_tr_b16 v[164:165], v7 offset:0
  ds_read_b64_tr_b16 v[166:167], v7 offset:2048
  ds_read_b64_tr_b16 v[168:169], v8 offset:0
  ds_read_b64_tr_b16 v[170:171], v8 offset:2048
  ds_read_b64_tr_b16 v[172:173], v9 offset:0
  ds_read_b64_tr_b16 v[174:175], v9 offset:2048
  ds_read_b64_tr_b16 v[176:177], v6 offset:4096
  ds_read_b64_tr_b16 v[178:179], v6 offset:6144
  ds_read_b64_tr_b16 v[180:181], v7 offset:4096
  ds_read_b64_tr_b16 v[182:183], v7 offset:6144
  ds_read_b64_tr_b16 v[184:185], v8 offset:4096
  ds_read_b64_tr_b16 v[186:187], v8 offset:6144
  ds_read_b64_tr_b16 v[188:189], v9 offset:4096
  ds_read_b64_tr_b16 v[190:191], v9 offset:6144
  v_lshlrev_b32 v216, 16, v10
  v_and_b32 v217, s11, v10
  v_lshlrev_b32 v218, 16, v11
  v_and_b32 v219, s11, v11
  v_lshlrev_b32 v96, 16, v240
  v_and_b32 v97, s11, v240
  v_pk_add_f32 v[96:97], v[96:97], v[216:217]
  v_lshlrev_b32 v98, 16, v241
  v_and_b32 v99, s11, v241
  v_pk_add_f32 v[98:99], v[98:99], v[218:219]
  v_lshlrev_b32 v100, 16, v248
  v_and_b32 v101, s11, v248
  v_pk_add_f32 v[100:101], v[100:101], v[216:217]
  v_lshlrev_b32 v102, 16, v249
  v_and_b32 v103, s11, v249
  v_pk_add_f32 v[102:103], v[102:103], v[218:219]
  v_lshlrev_b32 v216, 16, v24
  v_and_b32 v217, s11, v24
  v_lshlrev_b32 v218, 16, v25
  v_and_b32 v219, s11, v25
  v_lshlrev_b32 v104, 16, v242
  v_and_b32 v105, s11, v242
  v_pk_add_f32 v[104:105], v[104:105], v[216:217]
  v_lshlrev_b32 v106, 16, v243
  v_and_b32 v107, s11, v243
  v_pk_add_f32 v[106:107], v[106:107], v[218:219]
  v_lshlrev_b32 v108, 16, v250
  v_and_b32 v109, s11, v250
  v_pk_add_f32 v[108:109], v[108:109], v[216:217]
  v_lshlrev_b32 v110, 16, v251
  v_and_b32 v111, s11, v251
  v_pk_add_f32 v[110:111], v[110:111], v[218:219]
  v_lshlrev_b32 v216, 16, v124
  v_and_b32 v217, s11, v124
  v_lshlrev_b32 v218, 16, v125
  v_and_b32 v219, s11, v125
  v_lshlrev_b32 v112, 16, v244
  v_and_b32 v113, s11, v244
  v_pk_add_f32 v[112:113], v[112:113], v[216:217]
  v_lshlrev_b32 v114, 16, v245
  v_and_b32 v115, s11, v245
  v_pk_add_f32 v[114:115], v[114:115], v[218:219]
  v_lshlrev_b32 v116, 16, v252
  v_and_b32 v117, s11, v252
  v_pk_add_f32 v[116:117], v[116:117], v[216:217]
  v_lshlrev_b32 v118, 16, v253
  v_and_b32 v119, s11, v253
  v_pk_add_f32 v[118:119], v[118:119], v[218:219]
  v_lshlrev_b32 v216, 16, v126
  v_and_b32 v217, s11, v126
  v_lshlrev_b32 v218, 16, v127
  v_and_b32 v219, s11, v127
  v_lshlrev_b32 v120, 16, v246
  v_and_b32 v121, s11, v246
  v_pk_add_f32 v[120:121], v[120:121], v[216:217]
  v_lshlrev_b32 v122, 16, v247
  v_and_b32 v123, s11, v247
  v_pk_add_f32 v[122:123], v[122:123], v[218:219]
  v_lshlrev_b32 v124, 16, v254
  v_and_b32 v125, s11, v254
  v_pk_add_f32 v[124:125], v[124:125], v[216:217]
  v_lshlrev_b32 v126, 16, v255
  v_and_b32 v127, s11, v255
  v_pk_add_f32 v[126:127], v[126:127], v[218:219]
  s_waitcnt lgkmcnt(8)
  v_mfma_f32_16x16x32_bf16 v[128:131], v[160:163], v[32:35], 0
  ds_read_b64_tr_b16 v[192:193], v6 offset:8192
  v_mfma_f32_16x16x32_bf16 v[132:135], v[160:163], v[36:39], 0
  ds_read_b64_tr_b16 v[194:195], v6 offset:10240
  v_mfma_f32_16x16x32_bf16 v[140:143], v[164:167], v[36:39], 0
  ds_read_b64_tr_b16 v[196:197], v7 offset:8192
  v_mfma_f32_16x16x32_bf16 v[136:139], v[164:167], v[32:35], 0
  ds_read_b64_tr_b16 v[198:199], v7 offset:10240
  v_mfma_f32_16x16x32_bf16 v[144:147], v[168:171], v[32:35], 0
  ds_read_b64_tr_b16 v[200:201], v8 offset:8192
  v_mfma_f32_16x16x32_bf16 v[148:151], v[168:171], v[36:39], 0
  ds_read_b64_tr_b16 v[202:203], v8 offset:10240
  v_mfma_f32_16x16x32_bf16 v[156:159], v[172:175], v[36:39], 0
  ds_read_b64_tr_b16 v[204:205], v9 offset:8192
  v_mfma_f32_16x16x32_bf16 v[152:155], v[172:175], v[32:35], 0
  ds_read_b64_tr_b16 v[206:207], v9 offset:10240
  s_waitcnt lgkmcnt(8)
  v_mfma_f32_16x16x32_bf16 v[128:131], v[176:179], v[40:43], v[128:131]
  ds_read_b64_tr_b16 v[208:209], v6 offset:12288
  v_mfma_f32_16x16x32_bf16 v[132:135], v[176:179], v[44:47], v[132:135]
  ds_read_b64_tr_b16 v[210:211], v6 offset:14336
  v_mfma_f32_16x16x32_bf16 v[140:143], v[180:183], v[44:47], v[140:143]
  ds_read_b64_tr_b16 v[212:213], v7 offset:12288
  v_mfma_f32_16x16x32_bf16 v[136:139], v[180:183], v[40:43], v[136:139]
  ds_read_b64_tr_b16 v[214:215], v7 offset:14336
  v_mfma_f32_16x16x32_bf16 v[144:147], v[184:187], v[40:43], v[144:147]
  ds_read_b64_tr_b16 v[216:217], v8 offset:12288
  v_mfma_f32_16x16x32_bf16 v[148:151], v[184:187], v[44:47], v[148:151]
  ds_read_b64_tr_b16 v[218:219], v8 offset:14336
  v_mfma_f32_16x16x32_bf16 v[156:159], v[188:191], v[44:47], v[156:159]
  ds_read_b64_tr_b16 v[220:221], v9 offset:12288
  v_mfma_f32_16x16x32_bf16 v[152:155], v[188:191], v[40:43], v[152:155]
  ds_read_b64_tr_b16 v[222:223], v9 offset:14336
  s_waitcnt lgkmcnt(8)
  v_mfma_f32_16x16x32_bf16 v[96:99], v[192:195], v[32:35], v[96:99]
  ds_read_b64_tr_b16 v[160:161], v6 offset:16384
  v_mfma_f32_16x16x32_bf16 v[100:103], v[192:195], v[36:39], v[100:103]
  ds_read_b64_tr_b16 v[162:163], v6 offset:18432
  v_mfma_f32_16x16x32_bf16 v[108:111], v[196:199], v[36:39], v[108:111]
  ds_read_b64_tr_b16 v[164:165], v7 offset:16384
  v_mfma_f32_16x16x32_bf16 v[104:107], v[196:199], v[32:35], v[104:107]
  ds_read_b64_tr_b16 v[166:167], v7 offset:18432
  v_mfma_f32_16x16x32_bf16 v[112:115], v[200:203], v[32:35], v[112:115]
  ds_read_b64_tr_b16 v[168:169], v8 offset:16384
  v_mfma_f32_16x16x32_bf16 v[116:119], v[200:203], v[36:39], v[116:119]
  ds_read_b64_tr_b16 v[170:171], v8 offset:18432
  v_mfma_f32_16x16x32_bf16 v[124:127], v[204:207], v[36:39], v[124:127]
  ds_read_b64_tr_b16 v[172:173], v9 offset:16384
  v_mfma_f32_16x16x32_bf16 v[120:123], v[204:207], v[32:35], v[120:123]
  ds_read_b64_tr_b16 v[174:175], v9 offset:18432
  s_waitcnt lgkmcnt(8)
  v_mfma_f32_16x16x32_bf16 v[96:99], v[208:211], v[40:43], v[96:99]
  ds_read_b64_tr_b16 v[176:177], v6 offset:20480
  v_mfma_f32_16x16x32_bf16 v[100:103], v[208:211], v[44:47], v[100:103]
  ds_read_b64_tr_b16 v[178:179], v6 offset:22528
  v_mfma_f32_16x16x32_bf16 v[108:111], v[212:215], v[44:47], v[108:111]
  ds_read_b64_tr_b16 v[180:181], v7 offset:20480
  v_mfma_f32_16x16x32_bf16 v[104:107], v[212:215], v[40:43], v[104:107]
  ds_read_b64_tr_b16 v[182:183], v7 offset:22528
  v_mfma_f32_16x16x32_bf16 v[112:115], v[216:219], v[40:43], v[112:115]
  ds_read_b64_tr_b16 v[184:185], v8 offset:20480
  v_mfma_f32_16x16x32_bf16 v[116:119], v[216:219], v[44:47], v[116:119]
  ds_read_b64_tr_b16 v[186:187], v8 offset:22528
  v_mfma_f32_16x16x32_bf16 v[124:127], v[220:223], v[44:47], v[124:127]
  ds_read_b64_tr_b16 v[188:189], v9 offset:20480
  v_mfma_f32_16x16x32_bf16 v[120:123], v[220:223], v[40:43], v[120:123]
  ds_read_b64_tr_b16 v[190:191], v9 offset:22528
  s_waitcnt lgkmcnt(8)
  v_mfma_f32_16x16x32_bf16 v[128:131], v[160:163], v[48:51], v[128:131]
  ds_read_b64_tr_b16 v[192:193], v6 offset:24576
  v_mfma_f32_16x16x32_bf16 v[132:135], v[160:163], v[52:55], v[132:135]
  ds_read_b64_tr_b16 v[194:195], v6 offset:26624
  v_mfma_f32_16x16x32_bf16 v[140:143], v[164:167], v[52:55], v[140:143]
  ds_read_b64_tr_b16 v[196:197], v7 offset:24576
  v_mfma_f32_16x16x32_bf16 v[136:139], v[164:167], v[48:51], v[136:139]
  ds_read_b64_tr_b16 v[198:199], v7 offset:26624
  v_mfma_f32_16x16x32_bf16 v[144:147], v[168:171], v[48:51], v[144:147]
  ds_read_b64_tr_b16 v[200:201], v8 offset:24576
  v_mfma_f32_16x16x32_bf16 v[148:151], v[168:171], v[52:55], v[148:151]
  ds_read_b64_tr_b16 v[202:203], v8 offset:26624
  v_mfma_f32_16x16x32_bf16 v[156:159], v[172:175], v[52:55], v[156:159]
  ds_read_b64_tr_b16 v[204:205], v9 offset:24576
  v_mfma_f32_16x16x32_bf16 v[152:155], v[172:175], v[48:51], v[152:155]
  ds_read_b64_tr_b16 v[206:207], v9 offset:26624
  s_waitcnt lgkmcnt(8)
  s_barrier
  buffer_load_dwordx4 v[80:83], off, s[36:39], s51 offset:0
  buffer_load_dwordx4 v[84:87], off, s[64:67], s51 offset:0
  buffer_load_dwordx4 v[88:91], off, s[36:39], s51 offset:1024
  buffer_load_dwordx4 v[92:95], off, s[64:67], s51 offset:1024
  buffer_load_dwordx4 v[224:227], off, s[36:39], s48 offset:0
  buffer_load_dwordx4 v[228:231], off, s[64:67], s48 offset:0
  buffer_load_dwordx4 v[232:235], off, s[36:39], s48 offset:1024
  buffer_load_dwordx4 v[236:239], off, s[64:67], s48 offset:1024
  buffer_load_dwordx4 v[240:243], off, s[36:39], s49 offset:0
  buffer_load_dwordx4 v[244:247], off, s[64:67], s49 offset:0
  buffer_load_dwordx4 v[248:251], off, s[36:39], s49 offset:1024
  buffer_load_dwordx4 v[252:255], off, s[64:67], s49 offset:1024
  v_mfma_f32_16x16x32_bf16 v[128:131], v[176:179], v[56:59], v[128:131]
  ds_read_b64_tr_b16 v[208:209], v6 offset:28672
  v_readlane_b32 s50, v15, 6
  v_mfma_f32_16x16x32_bf16 v[132:135], v[176:179], v[60:63], v[132:135]
  ds_read_b64_tr_b16 v[210:211], v6 offset:30720
  v_mfma_f32_16x16x32_bf16 v[140:143], v[180:183], v[60:63], v[140:143]
  ds_read_b64_tr_b16 v[212:213], v7 offset:28672
  v_mfma_f32_16x16x32_bf16 v[136:139], v[180:183], v[56:59], v[136:139]
  buffer_load_dwordx4 v[32:35], off, s[36:39], s50 offset:0
  v_mfma_f32_16x16x32_bf16 v[144:147], v[184:187], v[56:59], v[144:147]
  ds_read_b64_tr_b16 v[214:215], v7 offset:30720
  ds_read_b64_tr_b16 v[216:217], v8 offset:28672
  v_mfma_f32_16x16x32_bf16 v[148:151], v[184:187], v[60:63], v[148:151]
  ds_read_b64_tr_b16 v[218:219], v8 offset:30720
  ds_read_b64_tr_b16 v[220:221], v9 offset:28672
  v_mfma_f32_16x16x32_bf16 v[156:159], v[188:191], v[60:63], v[156:159]
  buffer_load_dwordx4 v[36:39], off, s[64:67], s50 offset:0
  v_mfma_f32_16x16x32_bf16 v[152:155], v[188:191], v[56:59], v[152:155]
  ds_read_b64_tr_b16 v[222:223], v9 offset:30720
  s_waitcnt lgkmcnt(8)
  v_mfma_f32_16x16x32_bf16 v[96:99], v[192:195], v[48:51], v[96:99]
  ds_read_b64_tr_b16 v[160:161], v6 offset:32768
  v_mfma_f32_16x16x32_bf16 v[100:103], v[192:195], v[52:55], v[100:103]
  buffer_load_dwordx4 v[40:43], off, s[36:39], s50 offset:1024
  v_mfma_f32_16x16x32_bf16 v[108:111], v[196:199], v[52:55], v[108:111]
  ds_read_b64_tr_b16 v[162:163], v6 offset:34816
  ds_read_b64_tr_b16 v[164:165], v7 offset:32768
  v_mfma_f32_16x16x32_bf16 v[104:107], v[196:199], v[48:51], v[104:107]
  ds_read_b64_tr_b16 v[166:167], v7 offset:34816
  v_mfma_f32_16x16x32_bf16 v[112:115], v[200:203], v[48:51], v[112:115]
  buffer_load_dwordx4 v[44:47], off, s[64:67], s50 offset:1024
  v_mfma_f32_16x16x32_bf16 v[116:119], v[200:203], v[52:55], v[116:119]
  ds_read_b64_tr_b16 v[168:169], v8 offset:32768
  ds_read_b64_tr_b16 v[170:171], v8 offset:34816
  v_mfma_f32_16x16x32_bf16 v[124:127], v[204:207], v[52:55], v[124:127]
  ds_read_b64_tr_b16 v[172:173], v9 offset:32768
  v_mfma_f32_16x16x32_bf16 v[120:123], v[204:207], v[48:51], v[120:123]
  ds_read_b64_tr_b16 v[174:175], v9 offset:34816
  s_waitcnt lgkmcnt(8)
  v_mfma_f32_16x16x32_bf16 v[96:99], v[208:211], v[56:59], v[96:99]
  ds_read_b64_tr_b16 v[176:177], v6 offset:36864
  v_mfma_f32_16x16x32_bf16 v[100:103], v[208:211], v[60:63], v[100:103]
  ds_read_b64_tr_b16 v[178:179], v6 offset:38912
  v_mfma_f32_16x16x32_bf16 v[108:111], v[212:215], v[60:63], v[108:111]
  ds_read_b64_tr_b16 v[180:181], v7 offset:36864
  v_mfma_f32_16x16x32_bf16 v[104:107], v[212:215], v[56:59], v[104:107]
  ds_read_b64_tr_b16 v[182:183], v7 offset:38912
  v_mfma_f32_16x16x32_bf16 v[112:115], v[216:219], v[56:59], v[112:115]
  ds_read_b64_tr_b16 v[184:185], v8 offset:36864
  v_mfma_f32_16x16x32_bf16 v[116:119], v[216:219], v[60:63], v[116:119]
  ds_read_b64_tr_b16 v[186:187], v8 offset:38912
  v_readlane_b32 s51, v15, 7
  v_mfma_f32_16x16x32_bf16 v[124:127], v[220:223], v[60:63], v[124:127]
  ds_read_b64_tr_b16 v[188:189], v9 offset:36864
  v_mfma_f32_16x16x32_bf16 v[120:123], v[220:223], v[56:59], v[120:123]
  ds_read_b64_tr_b16 v[190:191], v9 offset:38912
  s_waitcnt lgkmcnt(8)
  v_mfma_f32_16x16x32_bf16 v[128:131], v[160:163], v[64:67], v[128:131]
  buffer_load_dwordx4 v[48:51], off, s[36:39], s51 offset:0
  v_mfma_f32_16x16x32_bf16 v[132:135], v[160:163], v[68:71], v[132:135]
  ds_read_b64_tr_b16 v[192:193], v6 offset:40960
  ds_read_b64_tr_b16 v[194:195], v6 offset:43008
  v_mfma_f32_16x16x32_bf16 v[140:143], v[164:167], v[68:71], v[140:143]
  ds_read_b64_tr_b16 v[196:197], v7 offset:40960
  v_mfma_f32_16x16x32_bf16 v[136:139], v[164:167], v[64:67], v[136:139]
  buffer_load_dwordx4 v[52:55], off, s[64:67], s51 offset:0
  v_mfma_f32_16x16x32_bf16 v[144:147], v[168:171], v[64:67], v[144:147]
  ds_read_b64_tr_b16 v[198:199], v7 offset:43008
  ds_read_b64_tr_b16 v[200:201], v8 offset:40960
  v_mfma_f32_16x16x32_bf16 v[148:151], v[168:171], v[68:71], v[148:151]
  ds_read_b64_tr_b16 v[202:203], v8 offset:43008
  ds_read_b64_tr_b16 v[204:205], v9 offset:40960
  v_mfma_f32_16x16x32_bf16 v[156:159], v[172:175], v[68:71], v[156:159]
  buffer_load_dwordx4 v[56:59], off, s[36:39], s51 offset:1024
  v_mfma_f32_16x16x32_bf16 v[152:155], v[172:175], v[64:67], v[152:155]
  ds_read_b64_tr_b16 v[206:207], v9 offset:43008
  s_waitcnt lgkmcnt(8)
  v_mfma_f32_16x16x32_bf16 v[128:131], v[176:179], v[72:75], v[128:131]
  ds_read_b64_tr_b16 v[208:209], v6 offset:45056
  v_mfma_f32_16x16x32_bf16 v[132:135], v[176:179], v[76:79], v[132:135]
  buffer_load_dwordx4 v[60:63], off, s[64:67], s51 offset:1024
  v_mfma_f32_16x16x32_bf16 v[140:143], v[180:183], v[76:79], v[140:143]
  ds_read_b64_tr_b16 v[210:211], v6 offset:47104
  ds_read_b64_tr_b16 v[212:213], v7 offset:45056
  v_mfma_f32_16x16x32_bf16 v[136:139], v[180:183], v[72:75], v[136:139]
  ds_read_b64_tr_b16 v[214:215], v7 offset:47104
  v_mfma_f32_16x16x32_bf16 v[144:147], v[184:187], v[72:75], v[144:147]
  ds_read_b64_tr_b16 v[216:217], v8 offset:45056
  v_mfma_f32_16x16x32_bf16 v[148:151], v[184:187], v[76:79], v[148:151]
  ds_read_b64_tr_b16 v[218:219], v8 offset:47104
  v_mfma_f32_16x16x32_bf16 v[156:159], v[188:191], v[76:79], v[156:159]
  ds_read_b64_tr_b16 v[220:221], v9 offset:45056
  v_mfma_f32_16x16x32_bf16 v[152:155], v[188:191], v[72:75], v[152:155]
  ds_read_b64_tr_b16 v[222:223], v9 offset:47104
  s_waitcnt lgkmcnt(8)
  v_mfma_f32_16x16x32_bf16 v[96:99], v[192:195], v[64:67], v[96:99]
  ds_read_b64_tr_b16 v[160:161], v6 offset:49152
  v_mfma_f32_16x16x32_bf16 v[100:103], v[192:195], v[68:71], v[100:103]
  ds_read_b64_tr_b16 v[162:163], v6 offset:51200
  v_mfma_f32_16x16x32_bf16 v[108:111], v[196:199], v[68:71], v[108:111]
  ds_read_b64_tr_b16 v[164:165], v7 offset:49152
  v_mfma_f32_16x16x32_bf16 v[104:107], v[196:199], v[64:67], v[104:107]
  ds_read_b64_tr_b16 v[166:167], v7 offset:51200
  v_mfma_f32_16x16x32_bf16 v[112:115], v[200:203], v[64:67], v[112:115]
  ds_read_b64_tr_b16 v[168:169], v8 offset:49152
  v_mfma_f32_16x16x32_bf16 v[116:119], v[200:203], v[68:71], v[116:119]
  ds_read_b64_tr_b16 v[170:171], v8 offset:51200
  v_mfma_f32_16x16x32_bf16 v[124:127], v[204:207], v[68:71], v[124:127]
  ds_read_b64_tr_b16 v[172:173], v9 offset:49152
  v_mfma_f32_16x16x32_bf16 v[120:123], v[204:207], v[64:67], v[120:123]
  ds_read_b64_tr_b16 v[174:175], v9 offset:51200
  s_waitcnt lgkmcnt(8)
  v_mfma_f32_16x16x32_bf16 v[96:99], v[208:211], v[72:75], v[96:99]
  ds_read_b64_tr_b16 v[176:177], v6 offset:53248
  v_mfma_f32_16x16x32_bf16 v[100:103], v[208:211], v[76:79], v[100:103]
  ds_read_b64_tr_b16 v[178:179], v6 offset:55296
  v_mfma_f32_16x16x32_bf16 v[108:111], v[212:215], v[76:79], v[108:111]
  ds_read_b64_tr_b16 v[180:181], v7 offset:53248
  v_mfma_f32_16x16x32_bf16 v[104:107], v[212:215], v[72:75], v[104:107]
  ds_read_b64_tr_b16 v[182:183], v7 offset:55296
  v_mfma_f32_16x16x32_bf16 v[112:115], v[216:219], v[72:75], v[112:115]
  ds_read_b64_tr_b16 v[184:185], v8 offset:53248
  v_mfma_f32_16x16x32_bf16 v[116:119], v[216:219], v[76:79], v[116:119]
  ds_read_b64_tr_b16 v[186:187], v8 offset:55296
  v_readlane_b32 s48, v15, 8
  v_mfma_f32_16x16x32_bf16 v[124:127], v[220:223], v[76:79], v[124:127]
  ds_read_b64_tr_b16 v[188:189], v9 offset:53248
  v_mfma_f32_16x16x32_bf16 v[120:123], v[220:223], v[72:75], v[120:123]
  ds_read_b64_tr_b16 v[190:191], v9 offset:55296
  s_waitcnt vmcnt(18) lgkmcnt(8)
  v_mfma_f32_16x16x32_bf16 v[128:131], v[160:163], v[80:83], v[128:131]
  buffer_load_dwordx4 v[64:67], off, s[36:39], s48 offset:0
  v_mfma_f32_16x16x32_bf16 v[132:135], v[160:163], v[84:87], v[132:135]
  ds_read_b64_tr_b16 v[192:193], v6 offset:57344
  ds_read_b64_tr_b16 v[194:195], v6 offset:59392
  v_mfma_f32_16x16x32_bf16 v[140:143], v[164:167], v[84:87], v[140:143]
  ds_read_b64_tr_b16 v[196:197], v7 offset:57344
  v_mfma_f32_16x16x32_bf16 v[136:139], v[164:167], v[80:83], v[136:139]
  ds_read_b64_tr_b16 v[198:199], v7 offset:59392
  v_mfma_f32_16x16x32_bf16 v[144:147], v[168:171], v[80:83], v[144:147]
  ds_read_b64_tr_b16 v[200:201], v8 offset:57344
  v_mfma_f32_16x16x32_bf16 v[148:151], v[168:171], v[84:87], v[148:151]
  ds_read_b64_tr_b16 v[202:203], v8 offset:59392
  ds_read_b64_tr_b16 v[204:205], v9 offset:57344
  v_mfma_f32_16x16x32_bf16 v[156:159], v[172:175], v[84:87], v[156:159]
  buffer_load_dwordx4 v[68:71], off, s[64:67], s48 offset:0
  v_mfma_f32_16x16x32_bf16 v[152:155], v[172:175], v[80:83], v[152:155]
  ds_read_b64_tr_b16 v[206:207], v9 offset:59392
  s_waitcnt vmcnt(18) lgkmcnt(8)
  v_mfma_f32_16x16x32_bf16 v[128:131], v[176:179], v[88:91], v[128:131]
  ds_read_b64_tr_b16 v[208:209], v6 offset:61440
  v_mfma_f32_16x16x32_bf16 v[132:135], v[176:179], v[92:95], v[132:135]
  ds_read_b64_tr_b16 v[210:211], v6 offset:63488
  v_mfma_f32_16x16x32_bf16 v[140:143], v[180:183], v[92:95], v[140:143]
  ds_read_b64_tr_b16 v[212:213], v7 offset:61440
  v_mfma_f32_16x16x32_bf16 v[136:139], v[180:183], v[88:91], v[136:139]
  ds_read_b64_tr_b16 v[214:215], v7 offset:63488
  v_mfma_f32_16x16x32_bf16 v[144:147], v[184:187], v[88:91], v[144:147]
  buffer_load_dwordx4 v[72:75], off, s[36:39], s48 offset:1024
  v_mfma_f32_16x16x32_bf16 v[148:151], v[184:187], v[92:95], v[148:151]
  ds_read_b64_tr_b16 v[216:217], v8 offset:61440
  ds_read_b64_tr_b16 v[218:219], v8 offset:63488
  v_mfma_f32_16x16x32_bf16 v[156:159], v[188:191], v[92:95], v[156:159]
  ds_read_b64_tr_b16 v[220:221], v9 offset:61440
  v_mfma_f32_16x16x32_bf16 v[152:155], v[188:191], v[88:91], v[152:155]
  ds_read_b64_tr_b16 v[222:223], v9 offset:63488
  s_waitcnt lgkmcnt(8)
  v_mfma_f32_16x16x32_bf16 v[96:99], v[192:195], v[80:83], v[96:99]
  ds_read_b64_tr_b16 v[160:161], v20 offset:0
  v_mfma_f32_16x16x32_bf16 v[100:103], v[192:195], v[84:87], v[100:103]
  ds_read_b64_tr_b16 v[162:163], v20 offset:2048
  v_mfma_f32_16x16x32_bf16 v[108:111], v[196:199], v[84:87], v[108:111]
  buffer_load_dwordx4 v[76:79], off, s[64:67], s48 offset:1024
  v_mfma_f32_16x16x32_bf16 v[104:107], v[196:199], v[80:83], v[104:107]
  ds_read_b64_tr_b16 v[164:165], v21 offset:0
  ds_read_b64_tr_b16 v[166:167], v21 offset:2048
  v_mfma_f32_16x16x32_bf16 v[112:115], v[200:203], v[80:83], v[112:115]
  ds_read_b64_tr_b16 v[168:169], v22 offset:0
  v_mfma_f32_16x16x32_bf16 v[116:119], v[200:203], v[84:87], v[116:119]
  ds_read_b64_tr_b16 v[170:171], v22 offset:2048
  v_mfma_f32_16x16x32_bf16 v[124:127], v[204:207], v[84:87], v[124:127]
  ds_read_b64_tr_b16 v[172:173], v23 offset:0
  v_mfma_f32_16x16x32_bf16 v[120:123], v[204:207], v[80:83], v[120:123]
  ds_read_b64_tr_b16 v[174:175], v23 offset:2048
  s_waitcnt lgkmcnt(8)
  s_barrier
  v_mfma_f32_16x16x32_bf16 v[96:99], v[208:211], v[88:91], v[96:99]
  ds_read_b64_tr_b16 v[176:177], v20 offset:4096
  v_mfma_f32_16x16x32_bf16 v[100:103], v[208:211], v[92:95], v[100:103]
  ds_read_b64_tr_b16 v[178:179], v20 offset:6144
  v_mfma_f32_16x16x32_bf16 v[108:111], v[212:215], v[92:95], v[108:111]
  ds_read_b64_tr_b16 v[180:181], v21 offset:4096
  v_mfma_f32_16x16x32_bf16 v[104:107], v[212:215], v[88:91], v[104:107]
  ds_read_b64_tr_b16 v[182:183], v21 offset:6144
  v_mfma_f32_16x16x32_bf16 v[112:115], v[216:219], v[88:91], v[112:115]
  ds_read_b64_tr_b16 v[184:185], v22 offset:4096
  v_mfma_f32_16x16x32_bf16 v[116:119], v[216:219], v[92:95], v[116:119]
  ds_read_b64_tr_b16 v[186:187], v22 offset:6144
  v_readlane_b32 s49, v15, 9
  v_mfma_f32_16x16x32_bf16 v[124:127], v[220:223], v[92:95], v[124:127]
  ds_read_b64_tr_b16 v[188:189], v23 offset:4096
  v_mfma_f32_16x16x32_bf16 v[120:123], v[220:223], v[88:91], v[120:123]
  ds_read_b64_tr_b16 v[190:191], v23 offset:6144
  s_waitcnt vmcnt(18) lgkmcnt(8)
  v_mfma_f32_16x16x32_bf16 v[128:131], v[160:163], v[224:227], v[128:131]
  buffer_load_dwordx4 v[80:83], off, s[36:39], s49 offset:0
  v_mfma_f32_16x16x32_bf16 v[132:135], v[160:163], v[228:231], v[132:135]
  ds_read_b64_tr_b16 v[192:193], v20 offset:8192
  ds_read_b64_tr_b16 v[194:195], v20 offset:10240
  v_mfma_f32_16x16x32_bf16 v[140:143], v[164:167], v[228:231], v[140:143]
  ds_read_b64_tr_b16 v[196:197], v21 offset:8192
  v_mfma_f32_16x16x32_bf16 v[136:139], v[164:167], v[224:227], v[136:139]
  ds_read_b64_tr_b16 v[198:199], v21 offset:10240
  v_mfma_f32_16x16x32_bf16 v[144:147], v[168:171], v[224:227], v[144:147]
  ds_read_b64_tr_b16 v[200:201], v22 offset:8192
  v_mfma_f32_16x16x32_bf16 v[148:151], v[168:171], v[228:231], v[148:151]
  ds_read_b64_tr_b16 v[202:203], v22 offset:10240
  ds_read_b64_tr_b16 v[204:205], v23 offset:8192
  v_mfma_f32_16x16x32_bf16 v[156:159], v[172:175], v[228:231], v[156:159]
  buffer_load_dwordx4 v[84:87], off, s[64:67], s49 offset:0
  v_mfma_f32_16x16x32_bf16 v[152:155], v[172:175], v[224:227], v[152:155]
  ds_read_b64_tr_b16 v[206:207], v23 offset:10240
  s_waitcnt vmcnt(18) lgkmcnt(8)
  v_mfma_f32_16x16x32_bf16 v[128:131], v[176:179], v[232:235], v[128:131]
  ds_read_b64_tr_b16 v[208:209], v20 offset:12288
  v_mfma_f32_16x16x32_bf16 v[132:135], v[176:179], v[236:239], v[132:135]
  ds_read_b64_tr_b16 v[210:211], v20 offset:14336
  v_mfma_f32_16x16x32_bf16 v[140:143], v[180:183], v[236:239], v[140:143]
  ds_read_b64_tr_b16 v[212:213], v21 offset:12288
  v_mfma_f32_16x16x32_bf16 v[136:139], v[180:183], v[232:235], v[136:139]
  ds_read_b64_tr_b16 v[214:215], v21 offset:14336
  v_mfma_f32_16x16x32_bf16 v[144:147], v[184:187], v[232:235], v[144:147]
  buffer_load_dwordx4 v[88:91], off, s[36:39], s49 offset:1024
  v_mfma_f32_16x16x32_bf16 v[148:151], v[184:187], v[236:239], v[148:151]
  ds_read_b64_tr_b16 v[216:217], v22 offset:12288
  ds_read_b64_tr_b16 v[218:219], v22 offset:14336
  v_mfma_f32_16x16x32_bf16 v[156:159], v[188:191], v[236:239], v[156:159]
  ds_read_b64_tr_b16 v[220:221], v23 offset:12288
  v_mfma_f32_16x16x32_bf16 v[152:155], v[188:191], v[232:235], v[152:155]
  ds_read_b64_tr_b16 v[222:223], v23 offset:14336
  s_waitcnt lgkmcnt(8)
  v_mfma_f32_16x16x32_bf16 v[96:99], v[192:195], v[224:227], v[96:99]
  ds_read_b64_tr_b16 v[160:161], v20 offset:16384
  v_mfma_f32_16x16x32_bf16 v[100:103], v[192:195], v[228:231], v[100:103]
  ds_read_b64_tr_b16 v[162:163], v20 offset:18432
  v_mfma_f32_16x16x32_bf16 v[108:111], v[196:199], v[228:231], v[108:111]
  buffer_load_dwordx4 v[92:95], off, s[64:67], s49 offset:1024
  v_mfma_f32_16x16x32_bf16 v[104:107], v[196:199], v[224:227], v[104:107]
  ds_read_b64_tr_b16 v[164:165], v21 offset:16384
  ds_read_b64_tr_b16 v[166:167], v21 offset:18432
  v_mfma_f32_16x16x32_bf16 v[112:115], v[200:203], v[224:227], v[112:115]
  ds_read_b64_tr_b16 v[168:169], v22 offset:16384
  v_mfma_f32_16x16x32_bf16 v[116:119], v[200:203], v[228:231], v[116:119]
  ds_read_b64_tr_b16 v[170:171], v22 offset:18432
  v_mfma_f32_16x16x32_bf16 v[124:127], v[204:207], v[228:231], v[124:127]
  ds_read_b64_tr_b16 v[172:173], v23 offset:16384
  v_mfma_f32_16x16x32_bf16 v[120:123], v[204:207], v[224:227], v[120:123]
  ds_read_b64_tr_b16 v[174:175], v23 offset:18432
  s_waitcnt lgkmcnt(8)
  v_mfma_f32_16x16x32_bf16 v[96:99], v[208:211], v[232:235], v[96:99]
  ds_read_b64_tr_b16 v[176:177], v20 offset:20480
  v_mfma_f32_16x16x32_bf16 v[100:103], v[208:211], v[236:239], v[100:103]
  ds_read_b64_tr_b16 v[178:179], v20 offset:22528
  v_mfma_f32_16x16x32_bf16 v[108:111], v[212:215], v[236:239], v[108:111]
  ds_read_b64_tr_b16 v[180:181], v21 offset:20480
  v_mfma_f32_16x16x32_bf16 v[104:107], v[212:215], v[232:235], v[104:107]
  ds_read_b64_tr_b16 v[182:183], v21 offset:22528
  v_mfma_f32_16x16x32_bf16 v[112:115], v[216:219], v[232:235], v[112:115]
  ds_read_b64_tr_b16 v[184:185], v22 offset:20480
  v_mfma_f32_16x16x32_bf16 v[116:119], v[216:219], v[236:239], v[116:119]
  ds_read_b64_tr_b16 v[186:187], v22 offset:22528
  v_readlane_b32 s50, v15, 10
  v_mfma_f32_16x16x32_bf16 v[124:127], v[220:223], v[236:239], v[124:127]
  ds_read_b64_tr_b16 v[188:189], v23 offset:20480
  v_mfma_f32_16x16x32_bf16 v[120:123], v[220:223], v[232:235], v[120:123]
  ds_read_b64_tr_b16 v[190:191], v23 offset:22528
  s_waitcnt vmcnt(18) lgkmcnt(8)
  v_mfma_f32_16x16x32_bf16 v[128:131], v[160:163], v[240:243], v[128:131]
  buffer_load_dwordx4 v[224:227], off, s[36:39], s50 offset:0
  v_mfma_f32_16x16x32_bf16 v[132:135], v[160:163], v[244:247], v[132:135]
  ds_read_b64_tr_b16 v[192:193], v20 offset:24576
  ds_read_b64_tr_b16 v[194:195], v20 offset:26624
  v_mfma_f32_16x16x32_bf16 v[140:143], v[164:167], v[244:247], v[140:143]
  ds_read_b64_tr_b16 v[196:197], v21 offset:24576
  v_mfma_f32_16x16x32_bf16 v[136:139], v[164:167], v[240:243], v[136:139]
  ds_read_b64_tr_b16 v[198:199], v21 offset:26624
  v_mfma_f32_16x16x32_bf16 v[144:147], v[168:171], v[240:243], v[144:147]
  ds_read_b64_tr_b16 v[200:201], v22 offset:24576
  v_mfma_f32_16x16x32_bf16 v[148:151], v[168:171], v[244:247], v[148:151]
  ds_read_b64_tr_b16 v[202:203], v22 offset:26624
  ds_read_b64_tr_b16 v[204:205], v23 offset:24576
  v_mfma_f32_16x16x32_bf16 v[156:159], v[172:175], v[244:247], v[156:159]
  buffer_load_dwordx4 v[228:231], off, s[64:67], s50 offset:0
  v_mfma_f32_16x16x32_bf16 v[152:155], v[172:175], v[240:243], v[152:155]
  ds_read_b64_tr_b16 v[206:207], v23 offset:26624
  s_waitcnt vmcnt(18) lgkmcnt(8)
  v_mfma_f32_16x16x32_bf16 v[128:131], v[176:179], v[248:251], v[128:131]
  ds_read_b64_tr_b16 v[208:209], v20 offset:28672
  v_mfma_f32_16x16x32_bf16 v[132:135], v[176:179], v[252:255], v[132:135]
  ds_read_b64_tr_b16 v[210:211], v20 offset:30720
  v_mfma_f32_16x16x32_bf16 v[140:143], v[180:183], v[252:255], v[140:143]
  ds_read_b64_tr_b16 v[212:213], v21 offset:28672
  v_mfma_f32_16x16x32_bf16 v[136:139], v[180:183], v[248:251], v[136:139]
  ds_read_b64_tr_b16 v[214:215], v21 offset:30720
  v_mfma_f32_16x16x32_bf16 v[144:147], v[184:187], v[248:251], v[144:147]
  buffer_load_dwordx4 v[232:235], off, s[36:39], s50 offset:1024
  v_mfma_f32_16x16x32_bf16 v[148:151], v[184:187], v[252:255], v[148:151]
  ds_read_b64_tr_b16 v[216:217], v22 offset:28672
  ds_read_b64_tr_b16 v[218:219], v22 offset:30720
  v_mfma_f32_16x16x32_bf16 v[156:159], v[188:191], v[252:255], v[156:159]
  ds_read_b64_tr_b16 v[220:221], v23 offset:28672
  v_mfma_f32_16x16x32_bf16 v[152:155], v[188:191], v[248:251], v[152:155]
  ds_read_b64_tr_b16 v[222:223], v23 offset:30720
  s_waitcnt lgkmcnt(8)
  v_mfma_f32_16x16x32_bf16 v[96:99], v[192:195], v[240:243], v[96:99]
  ds_read_b64_tr_b16 v[160:161], v20 offset:32768
  v_mfma_f32_16x16x32_bf16 v[100:103], v[192:195], v[244:247], v[100:103]
  ds_read_b64_tr_b16 v[162:163], v20 offset:34816
  v_mfma_f32_16x16x32_bf16 v[108:111], v[196:199], v[244:247], v[108:111]
  buffer_load_dwordx4 v[236:239], off, s[64:67], s50 offset:1024
  v_mfma_f32_16x16x32_bf16 v[104:107], v[196:199], v[240:243], v[104:107]
  ds_read_b64_tr_b16 v[164:165], v21 offset:32768
  ds_read_b64_tr_b16 v[166:167], v21 offset:34816
  v_mfma_f32_16x16x32_bf16 v[112:115], v[200:203], v[240:243], v[112:115]
  ds_read_b64_tr_b16 v[168:169], v22 offset:32768
  v_mfma_f32_16x16x32_bf16 v[116:119], v[200:203], v[244:247], v[116:119]
  ds_read_b64_tr_b16 v[170:171], v22 offset:34816
  v_mfma_f32_16x16x32_bf16 v[124:127], v[204:207], v[244:247], v[124:127]
  ds_read_b64_tr_b16 v[172:173], v23 offset:32768
  v_mfma_f32_16x16x32_bf16 v[120:123], v[204:207], v[240:243], v[120:123]
  ds_read_b64_tr_b16 v[174:175], v23 offset:34816
  s_waitcnt lgkmcnt(8)
  s_barrier
  v_mfma_f32_16x16x32_bf16 v[96:99], v[208:211], v[248:251], v[96:99]
  ds_read_b64_tr_b16 v[176:177], v20 offset:36864
  v_mfma_f32_16x16x32_bf16 v[100:103], v[208:211], v[252:255], v[100:103]
  ds_read_b64_tr_b16 v[178:179], v20 offset:38912
  v_mfma_f32_16x16x32_bf16 v[108:111], v[212:215], v[252:255], v[108:111]
  ds_read_b64_tr_b16 v[180:181], v21 offset:36864
  v_mfma_f32_16x16x32_bf16 v[104:107], v[212:215], v[248:251], v[104:107]
  ds_read_b64_tr_b16 v[182:183], v21 offset:38912
  v_mfma_f32_16x16x32_bf16 v[112:115], v[216:219], v[248:251], v[112:115]
  ds_read_b64_tr_b16 v[184:185], v22 offset:36864
  v_mfma_f32_16x16x32_bf16 v[116:119], v[216:219], v[252:255], v[116:119]
  ds_read_b64_tr_b16 v[186:187], v22 offset:38912
  v_readlane_b32 s51, v15, 11
  v_mfma_f32_16x16x32_bf16 v[124:127], v[220:223], v[252:255], v[124:127]
  ds_read_b64_tr_b16 v[188:189], v23 offset:36864
  v_mfma_f32_16x16x32_bf16 v[120:123], v[220:223], v[248:251], v[120:123]
  ds_read_b64_tr_b16 v[190:191], v23 offset:38912
  s_waitcnt vmcnt(18) lgkmcnt(8)
  v_mfma_f32_16x16x32_bf16 v[128:131], v[160:163], v[32:35], v[128:131]
  buffer_load_dwordx4 v[240:243], off, s[36:39], s51 offset:0
  v_mfma_f32_16x16x32_bf16 v[132:135], v[160:163], v[36:39], v[132:135]
  ds_read_b64_tr_b16 v[192:193], v20 offset:40960
  ds_read_b64_tr_b16 v[194:195], v20 offset:43008
  v_mfma_f32_16x16x32_bf16 v[140:143], v[164:167], v[36:39], v[140:143]
  ds_read_b64_tr_b16 v[196:197], v21 offset:40960
  v_mfma_f32_16x16x32_bf16 v[136:139], v[164:167], v[32:35], v[136:139]
  ds_read_b64_tr_b16 v[198:199], v21 offset:43008
  v_mfma_f32_16x16x32_bf16 v[144:147], v[168:171], v[32:35], v[144:147]
  ds_read_b64_tr_b16 v[200:201], v22 offset:40960
  v_mfma_f32_16x16x32_bf16 v[148:151], v[168:171], v[36:39], v[148:151]
  ds_read_b64_tr_b16 v[202:203], v22 offset:43008
  ds_read_b64_tr_b16 v[204:205], v23 offset:40960
  v_mfma_f32_16x16x32_bf16 v[156:159], v[172:175], v[36:39], v[156:159]
  buffer_load_dwordx4 v[244:247], off, s[64:67], s51 offset:0
  v_mfma_f32_16x16x32_bf16 v[152:155], v[172:175], v[32:35], v[152:155]
  ds_read_b64_tr_b16 v[206:207], v23 offset:43008
  s_waitcnt vmcnt(18) lgkmcnt(8)
  v_mfma_f32_16x16x32_bf16 v[128:131], v[176:179], v[40:43], v[128:131]
  ds_read_b64_tr_b16 v[208:209], v20 offset:45056
  v_mfma_f32_16x16x32_bf16 v[132:135], v[176:179], v[44:47], v[132:135]
  ds_read_b64_tr_b16 v[210:211], v20 offset:47104
  v_mfma_f32_16x16x32_bf16 v[140:143], v[180:183], v[44:47], v[140:143]
  ds_read_b64_tr_b16 v[212:213], v21 offset:45056
  v_mfma_f32_16x16x32_bf16 v[136:139], v[180:183], v[40:43], v[136:139]
  ds_read_b64_tr_b16 v[214:215], v21 offset:47104
  v_mfma_f32_16x16x32_bf16 v[144:147], v[184:187], v[40:43], v[144:147]
  buffer_load_dwordx4 v[248:251], off, s[36:39], s51 offset:1024
  v_mfma_f32_16x16x32_bf16 v[148:151], v[184:187], v[44:47], v[148:151]
  ds_read_b64_tr_b16 v[216:217], v22 offset:45056
  ds_read_b64_tr_b16 v[218:219], v22 offset:47104
  v_mfma_f32_16x16x32_bf16 v[156:159], v[188:191], v[44:47], v[156:159]
  ds_read_b64_tr_b16 v[220:221], v23 offset:45056
  v_mfma_f32_16x16x32_bf16 v[152:155], v[188:191], v[40:43], v[152:155]
  ds_read_b64_tr_b16 v[222:223], v23 offset:47104
  s_waitcnt lgkmcnt(8)
  v_mfma_f32_16x16x32_bf16 v[96:99], v[192:195], v[32:35], v[96:99]
  ds_read_b64_tr_b16 v[160:161], v20 offset:49152
  v_mfma_f32_16x16x32_bf16 v[100:103], v[192:195], v[36:39], v[100:103]
  ds_read_b64_tr_b16 v[162:163], v20 offset:51200
  v_mfma_f32_16x16x32_bf16 v[108:111], v[196:199], v[36:39], v[108:111]
  buffer_load_dwordx4 v[252:255], off, s[64:67], s51 offset:1024
  v_mfma_f32_16x16x32_bf16 v[104:107], v[196:199], v[32:35], v[104:107]
  ds_read_b64_tr_b16 v[164:165], v21 offset:49152
  ds_read_b64_tr_b16 v[166:167], v21 offset:51200
  v_mfma_f32_16x16x32_bf16 v[112:115], v[200:203], v[32:35], v[112:115]
  ds_read_b64_tr_b16 v[168:169], v22 offset:49152
  v_mfma_f32_16x16x32_bf16 v[116:119], v[200:203], v[36:39], v[116:119]
  ds_read_b64_tr_b16 v[170:171], v22 offset:51200
  v_mfma_f32_16x16x32_bf16 v[124:127], v[204:207], v[36:39], v[124:127]
  ds_read_b64_tr_b16 v[172:173], v23 offset:49152
  v_mfma_f32_16x16x32_bf16 v[120:123], v[204:207], v[32:35], v[120:123]
  ds_read_b64_tr_b16 v[174:175], v23 offset:51200
  s_waitcnt lgkmcnt(8)
  v_mfma_f32_16x16x32_bf16 v[96:99], v[208:211], v[40:43], v[96:99]
  ds_read_b64_tr_b16 v[176:177], v20 offset:53248
  v_mfma_f32_16x16x32_bf16 v[100:103], v[208:211], v[44:47], v[100:103]
  ds_read_b64_tr_b16 v[178:179], v20 offset:55296
  v_mfma_f32_16x16x32_bf16 v[108:111], v[212:215], v[44:47], v[108:111]
  ds_read_b64_tr_b16 v[180:181], v21 offset:53248
  v_mfma_f32_16x16x32_bf16 v[104:107], v[212:215], v[40:43], v[104:107]
  ds_read_b64_tr_b16 v[182:183], v21 offset:55296
  v_mfma_f32_16x16x32_bf16 v[112:115], v[216:219], v[40:43], v[112:115]
  ds_read_b64_tr_b16 v[184:185], v22 offset:53248
  v_mfma_f32_16x16x32_bf16 v[116:119], v[216:219], v[44:47], v[116:119]
  ds_read_b64_tr_b16 v[186:187], v22 offset:55296
  v_readlane_b32 s48, v15, 12
  v_mfma_f32_16x16x32_bf16 v[124:127], v[220:223], v[44:47], v[124:127]
  ds_read_b64_tr_b16 v[188:189], v23 offset:53248
  v_mfma_f32_16x16x32_bf16 v[120:123], v[220:223], v[40:43], v[120:123]
  ds_read_b64_tr_b16 v[190:191], v23 offset:55296
  s_waitcnt vmcnt(18) lgkmcnt(8)
  v_mfma_f32_16x16x32_bf16 v[128:131], v[160:163], v[48:51], v[128:131]
  buffer_load_dwordx4 v[32:35], off, s[36:39], s48 offset:0
  v_mfma_f32_16x16x32_bf16 v[132:135], v[160:163], v[52:55], v[132:135]
  ds_read_b64_tr_b16 v[192:193], v20 offset:57344
  ds_read_b64_tr_b16 v[194:195], v20 offset:59392
  v_mfma_f32_16x16x32_bf16 v[140:143], v[164:167], v[52:55], v[140:143]
  ds_read_b64_tr_b16 v[196:197], v21 offset:57344
  v_mfma_f32_16x16x32_bf16 v[136:139], v[164:167], v[48:51], v[136:139]
  ds_read_b64_tr_b16 v[198:199], v21 offset:59392
  v_mfma_f32_16x16x32_bf16 v[144:147], v[168:171], v[48:51], v[144:147]
  ds_read_b64_tr_b16 v[200:201], v22 offset:57344
  v_mfma_f32_16x16x32_bf16 v[148:151], v[168:171], v[52:55], v[148:151]
  ds_read_b64_tr_b16 v[202:203], v22 offset:59392
  ds_read_b64_tr_b16 v[204:205], v23 offset:57344
  v_mfma_f32_16x16x32_bf16 v[156:159], v[172:175], v[52:55], v[156:159]
  buffer_load_dwordx4 v[36:39], off, s[64:67], s48 offset:0
  v_mfma_f32_16x16x32_bf16 v[152:155], v[172:175], v[48:51], v[152:155]
  ds_read_b64_tr_b16 v[206:207], v23 offset:59392
  s_waitcnt vmcnt(18) lgkmcnt(8)
  v_mfma_f32_16x16x32_bf16 v[128:131], v[176:179], v[56:59], v[128:131]
  ds_read_b64_tr_b16 v[208:209], v20 offset:61440
  v_mfma_f32_16x16x32_bf16 v[132:135], v[176:179], v[60:63], v[132:135]
  ds_read_b64_tr_b16 v[210:211], v20 offset:63488
  v_mfma_f32_16x16x32_bf16 v[140:143], v[180:183], v[60:63], v[140:143]
  ds_read_b64_tr_b16 v[212:213], v21 offset:61440
  v_mfma_f32_16x16x32_bf16 v[136:139], v[180:183], v[56:59], v[136:139]
  ds_read_b64_tr_b16 v[214:215], v21 offset:63488
  v_mfma_f32_16x16x32_bf16 v[144:147], v[184:187], v[56:59], v[144:147]
  buffer_load_dwordx4 v[40:43], off, s[36:39], s48 offset:1024
  v_mfma_f32_16x16x32_bf16 v[148:151], v[184:187], v[60:63], v[148:151]
  ds_read_b64_tr_b16 v[216:217], v22 offset:61440
  ds_read_b64_tr_b16 v[218:219], v22 offset:63488
  v_mfma_f32_16x16x32_bf16 v[156:159], v[188:191], v[60:63], v[156:159]
  ds_read_b64_tr_b16 v[220:221], v23 offset:61440
  v_mfma_f32_16x16x32_bf16 v[152:155], v[188:191], v[56:59], v[152:155]
  ds_read_b64_tr_b16 v[222:223], v23 offset:63488
  s_waitcnt lgkmcnt(8)
  v_mfma_f32_16x16x32_bf16 v[96:99], v[192:195], v[48:51], v[96:99]
  ds_read_b64_tr_b16 v[160:161], v26 offset:0
  v_mfma_f32_16x16x32_bf16 v[100:103], v[192:195], v[52:55], v[100:103]
  ds_read_b64_tr_b16 v[162:163], v26 offset:2048
  v_mfma_f32_16x16x32_bf16 v[108:111], v[196:199], v[52:55], v[108:111]
  buffer_load_dwordx4 v[44:47], off, s[64:67], s48 offset:1024
  v_mfma_f32_16x16x32_bf16 v[104:107], v[196:199], v[48:51], v[104:107]
  ds_read_b64_tr_b16 v[164:165], v27 offset:0
  ds_read_b64_tr_b16 v[166:167], v27 offset:2048
  v_mfma_f32_16x16x32_bf16 v[112:115], v[200:203], v[48:51], v[112:115]
  ds_read_b64_tr_b16 v[168:169], v28 offset:0
  v_mfma_f32_16x16x32_bf16 v[116:119], v[200:203], v[52:55], v[116:119]
  ds_read_b64_tr_b16 v[170:171], v28 offset:2048
  v_mfma_f32_16x16x32_bf16 v[124:127], v[204:207], v[52:55], v[124:127]
  ds_read_b64_tr_b16 v[172:173], v29 offset:0
  v_mfma_f32_16x16x32_bf16 v[120:123], v[204:207], v[48:51], v[120:123]
  ds_read_b64_tr_b16 v[174:175], v29 offset:2048
  s_waitcnt lgkmcnt(8)
  s_barrier
  v_mfma_f32_16x16x32_bf16 v[96:99], v[208:211], v[56:59], v[96:99]
  ds_read_b64_tr_b16 v[176:177], v26 offset:4096
  v_mfma_f32_16x16x32_bf16 v[100:103], v[208:211], v[60:63], v[100:103]
  ds_read_b64_tr_b16 v[178:179], v26 offset:6144
  v_mfma_f32_16x16x32_bf16 v[108:111], v[212:215], v[60:63], v[108:111]
  ds_read_b64_tr_b16 v[180:181], v27 offset:4096
  v_mfma_f32_16x16x32_bf16 v[104:107], v[212:215], v[56:59], v[104:107]
  ds_read_b64_tr_b16 v[182:183], v27 offset:6144
  v_mfma_f32_16x16x32_bf16 v[112:115], v[216:219], v[56:59], v[112:115]
  ds_read_b64_tr_b16 v[184:185], v28 offset:4096
  v_mfma_f32_16x16x32_bf16 v[116:119], v[216:219], v[60:63], v[116:119]
  ds_read_b64_tr_b16 v[186:187], v28 offset:6144
  v_readlane_b32 s49, v15, 13
  v_mfma_f32_16x16x32_bf16 v[124:127], v[220:223], v[60:63], v[124:127]
  ds_read_b64_tr_b16 v[188:189], v29 offset:4096
  v_mfma_f32_16x16x32_bf16 v[120:123], v[220:223], v[56:59], v[120:123]
  ds_read_b64_tr_b16 v[190:191], v29 offset:6144
  s_waitcnt vmcnt(18) lgkmcnt(8)
  v_mfma_f32_16x16x32_bf16 v[128:131], v[160:163], v[64:67], v[128:131]
  buffer_load_dwordx4 v[48:51], off, s[36:39], s49 offset:0
  v_mfma_f32_16x16x32_bf16 v[132:135], v[160:163], v[68:71], v[132:135]
  ds_read_b64_tr_b16 v[192:193], v26 offset:8192
  ds_read_b64_tr_b16 v[194:195], v26 offset:10240
  v_mfma_f32_16x16x32_bf16 v[140:143], v[164:167], v[68:71], v[140:143]
  ds_read_b64_tr_b16 v[196:197], v27 offset:8192
  v_mfma_f32_16x16x32_bf16 v[136:139], v[164:167], v[64:67], v[136:139]
  ds_read_b64_tr_b16 v[198:199], v27 offset:10240
  v_mfma_f32_16x16x32_bf16 v[144:147], v[168:171], v[64:67], v[144:147]
  ds_read_b64_tr_b16 v[200:201], v28 offset:8192
  v_mfma_f32_16x16x32_bf16 v[148:151], v[168:171], v[68:71], v[148:151]
  ds_read_b64_tr_b16 v[202:203], v28 offset:10240
  ds_read_b64_tr_b16 v[204:205], v29 offset:8192
  v_mfma_f32_16x16x32_bf16 v[156:159], v[172:175], v[68:71], v[156:159]
  buffer_load_dwordx4 v[52:55], off, s[64:67], s49 offset:0
  v_mfma_f32_16x16x32_bf16 v[152:155], v[172:175], v[64:67], v[152:155]
  ds_read_b64_tr_b16 v[206:207], v29 offset:10240
  s_waitcnt vmcnt(18) lgkmcnt(8)
  v_mfma_f32_16x16x32_bf16 v[128:131], v[176:179], v[72:75], v[128:131]
  ds_read_b64_tr_b16 v[208:209], v26 offset:12288
  v_mfma_f32_16x16x32_bf16 v[132:135], v[176:179], v[76:79], v[132:135]
  ds_read_b64_tr_b16 v[210:211], v26 offset:14336
  v_mfma_f32_16x16x32_bf16 v[140:143], v[180:183], v[76:79], v[140:143]
  ds_read_b64_tr_b16 v[212:213], v27 offset:12288
  v_mfma_f32_16x16x32_bf16 v[136:139], v[180:183], v[72:75], v[136:139]
  ds_read_b64_tr_b16 v[214:215], v27 offset:14336
  v_mfma_f32_16x16x32_bf16 v[144:147], v[184:187], v[72:75], v[144:147]
  buffer_load_dwordx4 v[56:59], off, s[36:39], s49 offset:1024
  v_mfma_f32_16x16x32_bf16 v[148:151], v[184:187], v[76:79], v[148:151]
  ds_read_b64_tr_b16 v[216:217], v28 offset:12288
  ds_read_b64_tr_b16 v[218:219], v28 offset:14336
  v_mfma_f32_16x16x32_bf16 v[156:159], v[188:191], v[76:79], v[156:159]
  ds_read_b64_tr_b16 v[220:221], v29 offset:12288
  v_mfma_f32_16x16x32_bf16 v[152:155], v[188:191], v[72:75], v[152:155]
  ds_read_b64_tr_b16 v[222:223], v29 offset:14336
  s_waitcnt lgkmcnt(8)
  v_mfma_f32_16x16x32_bf16 v[96:99], v[192:195], v[64:67], v[96:99]
  ds_read_b64_tr_b16 v[160:161], v26 offset:16384
  v_mfma_f32_16x16x32_bf16 v[100:103], v[192:195], v[68:71], v[100:103]
  ds_read_b64_tr_b16 v[162:163], v26 offset:18432
  v_mfma_f32_16x16x32_bf16 v[108:111], v[196:199], v[68:71], v[108:111]
  buffer_load_dwordx4 v[60:63], off, s[64:67], s49 offset:1024
  v_mfma_f32_16x16x32_bf16 v[104:107], v[196:199], v[64:67], v[104:107]
  ds_read_b64_tr_b16 v[164:165], v27 offset:16384
  ds_read_b64_tr_b16 v[166:167], v27 offset:18432
  v_mfma_f32_16x16x32_bf16 v[112:115], v[200:203], v[64:67], v[112:115]
  ds_read_b64_tr_b16 v[168:169], v28 offset:16384
  v_mfma_f32_16x16x32_bf16 v[116:119], v[200:203], v[68:71], v[116:119]
  ds_read_b64_tr_b16 v[170:171], v28 offset:18432
  v_mfma_f32_16x16x32_bf16 v[124:127], v[204:207], v[68:71], v[124:127]
  ds_read_b64_tr_b16 v[172:173], v29 offset:16384
  v_mfma_f32_16x16x32_bf16 v[120:123], v[204:207], v[64:67], v[120:123]
  ds_read_b64_tr_b16 v[174:175], v29 offset:18432
  s_waitcnt lgkmcnt(8)
  v_mfma_f32_16x16x32_bf16 v[96:99], v[208:211], v[72:75], v[96:99]
  ds_read_b64_tr_b16 v[176:177], v26 offset:20480
  v_mfma_f32_16x16x32_bf16 v[100:103], v[208:211], v[76:79], v[100:103]
  ds_read_b64_tr_b16 v[178:179], v26 offset:22528
  v_mfma_f32_16x16x32_bf16 v[108:111], v[212:215], v[76:79], v[108:111]
  ds_read_b64_tr_b16 v[180:181], v27 offset:20480
  v_mfma_f32_16x16x32_bf16 v[104:107], v[212:215], v[72:75], v[104:107]
  ds_read_b64_tr_b16 v[182:183], v27 offset:22528
  v_mfma_f32_16x16x32_bf16 v[112:115], v[216:219], v[72:75], v[112:115]
  ds_read_b64_tr_b16 v[184:185], v28 offset:20480
  v_mfma_f32_16x16x32_bf16 v[116:119], v[216:219], v[76:79], v[116:119]
  ds_read_b64_tr_b16 v[186:187], v28 offset:22528
  v_readlane_b32 s50, v15, 14
  v_mfma_f32_16x16x32_bf16 v[124:127], v[220:223], v[76:79], v[124:127]
  ds_read_b64_tr_b16 v[188:189], v29 offset:20480
  v_mfma_f32_16x16x32_bf16 v[120:123], v[220:223], v[72:75], v[120:123]
  ds_read_b64_tr_b16 v[190:191], v29 offset:22528
  s_waitcnt vmcnt(18) lgkmcnt(8)
  v_mfma_f32_16x16x32_bf16 v[128:131], v[160:163], v[80:83], v[128:131]
  buffer_load_dwordx4 v[64:67], off, s[36:39], s50 offset:0
  v_mfma_f32_16x16x32_bf16 v[132:135], v[160:163], v[84:87], v[132:135]
  ds_read_b64_tr_b16 v[192:193], v26 offset:24576
  ds_read_b64_tr_b16 v[194:195], v26 offset:26624
  v_mfma_f32_16x16x32_bf16 v[140:143], v[164:167], v[84:87], v[140:143]
  ds_read_b64_tr_b16 v[196:197], v27 offset:24576
  v_mfma_f32_16x16x32_bf16 v[136:139], v[164:167], v[80:83], v[136:139]
  ds_read_b64_tr_b16 v[198:199], v27 offset:26624
  v_mfma_f32_16x16x32_bf16 v[144:147], v[168:171], v[80:83], v[144:147]
  ds_read_b64_tr_b16 v[200:201], v28 offset:24576
  v_mfma_f32_16x16x32_bf16 v[148:151], v[168:171], v[84:87], v[148:151]
  ds_read_b64_tr_b16 v[202:203], v28 offset:26624
  ds_read_b64_tr_b16 v[204:205], v29 offset:24576
  v_mfma_f32_16x16x32_bf16 v[156:159], v[172:175], v[84:87], v[156:159]
  buffer_load_dwordx4 v[68:71], off, s[64:67], s50 offset:0
  v_mfma_f32_16x16x32_bf16 v[152:155], v[172:175], v[80:83], v[152:155]
  ds_read_b64_tr_b16 v[206:207], v29 offset:26624
  s_waitcnt vmcnt(18) lgkmcnt(8)
  v_mfma_f32_16x16x32_bf16 v[128:131], v[176:179], v[88:91], v[128:131]
  ds_read_b64_tr_b16 v[208:209], v26 offset:28672
  v_mfma_f32_16x16x32_bf16 v[132:135], v[176:179], v[92:95], v[132:135]
  ds_read_b64_tr_b16 v[210:211], v26 offset:30720
  v_mfma_f32_16x16x32_bf16 v[140:143], v[180:183], v[92:95], v[140:143]
  ds_read_b64_tr_b16 v[212:213], v27 offset:28672
  v_mfma_f32_16x16x32_bf16 v[136:139], v[180:183], v[88:91], v[136:139]
  ds_read_b64_tr_b16 v[214:215], v27 offset:30720
  v_mfma_f32_16x16x32_bf16 v[144:147], v[184:187], v[88:91], v[144:147]
  buffer_load_dwordx4 v[72:75], off, s[36:39], s50 offset:1024
  v_mfma_f32_16x16x32_bf16 v[148:151], v[184:187], v[92:95], v[148:151]
  ds_read_b64_tr_b16 v[216:217], v28 offset:28672
  ds_read_b64_tr_b16 v[218:219], v28 offset:30720
  v_mfma_f32_16x16x32_bf16 v[156:159], v[188:191], v[92:95], v[156:159]
  ds_read_b64_tr_b16 v[220:221], v29 offset:28672
  v_mfma_f32_16x16x32_bf16 v[152:155], v[188:191], v[88:91], v[152:155]
  ds_read_b64_tr_b16 v[222:223], v29 offset:30720
  s_waitcnt lgkmcnt(8)
  v_mfma_f32_16x16x32_bf16 v[96:99], v[192:195], v[80:83], v[96:99]
  ds_read_b64_tr_b16 v[160:161], v6 offset:0
  v_mfma_f32_16x16x32_bf16 v[100:103], v[192:195], v[84:87], v[100:103]
  ds_read_b64_tr_b16 v[162:163], v6 offset:2048
  v_mfma_f32_16x16x32_bf16 v[108:111], v[196:199], v[84:87], v[108:111]
  buffer_load_dwordx4 v[76:79], off, s[64:67], s50 offset:1024
  v_mfma_f32_16x16x32_bf16 v[104:107], v[196:199], v[80:83], v[104:107]
  ds_read_b64_tr_b16 v[164:165], v7 offset:0
  ds_read_b64_tr_b16 v[166:167], v7 offset:2048
  v_mfma_f32_16x16x32_bf16 v[112:115], v[200:203], v[80:83], v[112:115]
  ds_read_b64_tr_b16 v[168:169], v8 offset:0
  v_mfma_f32_16x16x32_bf16 v[116:119], v[200:203], v[84:87], v[116:119]
  ds_read_b64_tr_b16 v[170:171], v8 offset:2048
  v_mfma_f32_16x16x32_bf16 v[124:127], v[204:207], v[84:87], v[124:127]
  ds_read_b64_tr_b16 v[172:173], v9 offset:0
  v_mfma_f32_16x16x32_bf16 v[120:123], v[204:207], v[80:83], v[120:123]
  ds_read_b64_tr_b16 v[174:175], v9 offset:2048
  s_waitcnt lgkmcnt(8)
  s_barrier
  v_mfma_f32_16x16x32_bf16 v[96:99], v[208:211], v[88:91], v[96:99]
  ds_read_b64_tr_b16 v[176:177], v6 offset:4096
  v_mfma_f32_16x16x32_bf16 v[100:103], v[208:211], v[92:95], v[100:103]
  ds_read_b64_tr_b16 v[178:179], v6 offset:6144
  v_mfma_f32_16x16x32_bf16 v[108:111], v[212:215], v[92:95], v[108:111]
  ds_read_b64_tr_b16 v[180:181], v7 offset:4096
  v_mfma_f32_16x16x32_bf16 v[104:107], v[212:215], v[88:91], v[104:107]
  ds_read_b64_tr_b16 v[182:183], v7 offset:6144
  v_mfma_f32_16x16x32_bf16 v[112:115], v[216:219], v[88:91], v[112:115]
  ds_read_b64_tr_b16 v[184:185], v8 offset:4096
  v_mfma_f32_16x16x32_bf16 v[116:119], v[216:219], v[92:95], v[116:119]
  ds_read_b64_tr_b16 v[186:187], v8 offset:6144
  v_readlane_b32 s51, v15, 15
  v_mfma_f32_16x16x32_bf16 v[124:127], v[220:223], v[92:95], v[124:127]
  ds_read_b64_tr_b16 v[188:189], v9 offset:4096
  v_mfma_f32_16x16x32_bf16 v[120:123], v[220:223], v[88:91], v[120:123]
  ds_read_b64_tr_b16 v[190:191], v9 offset:6144
  s_waitcnt vmcnt(18) lgkmcnt(8)
  v_mfma_f32_16x16x32_bf16 v[128:131], v[160:163], v[224:227], v[128:131]
  buffer_load_dwordx4 v[80:83], off, s[36:39], s51 offset:0
  v_mfma_f32_16x16x32_bf16 v[132:135], v[160:163], v[228:231], v[132:135]
  ds_read_b64_tr_b16 v[192:193], v6 offset:8192
  ds_read_b64_tr_b16 v[194:195], v6 offset:10240
  v_mfma_f32_16x16x32_bf16 v[140:143], v[164:167], v[228:231], v[140:143]
  ds_read_b64_tr_b16 v[196:197], v7 offset:8192
  v_mfma_f32_16x16x32_bf16 v[136:139], v[164:167], v[224:227], v[136:139]
  ds_read_b64_tr_b16 v[198:199], v7 offset:10240
  v_mfma_f32_16x16x32_bf16 v[144:147], v[168:171], v[224:227], v[144:147]
  ds_read_b64_tr_b16 v[200:201], v8 offset:8192
  v_mfma_f32_16x16x32_bf16 v[148:151], v[168:171], v[228:231], v[148:151]
  ds_read_b64_tr_b16 v[202:203], v8 offset:10240
  ds_read_b64_tr_b16 v[204:205], v9 offset:8192
  v_mfma_f32_16x16x32_bf16 v[156:159], v[172:175], v[228:231], v[156:159]
  buffer_load_dwordx4 v[84:87], off, s[64:67], s51 offset:0
  v_mfma_f32_16x16x32_bf16 v[152:155], v[172:175], v[224:227], v[152:155]
  ds_read_b64_tr_b16 v[206:207], v9 offset:10240
  s_waitcnt vmcnt(18) lgkmcnt(8)
  v_mfma_f32_16x16x32_bf16 v[128:131], v[176:179], v[232:235], v[128:131]
  ds_read_b64_tr_b16 v[208:209], v6 offset:12288
  v_mfma_f32_16x16x32_bf16 v[132:135], v[176:179], v[236:239], v[132:135]
  ds_read_b64_tr_b16 v[210:211], v6 offset:14336
  v_mfma_f32_16x16x32_bf16 v[140:143], v[180:183], v[236:239], v[140:143]
  ds_read_b64_tr_b16 v[212:213], v7 offset:12288
  v_mfma_f32_16x16x32_bf16 v[136:139], v[180:183], v[232:235], v[136:139]
  ds_read_b64_tr_b16 v[214:215], v7 offset:14336
  v_mfma_f32_16x16x32_bf16 v[144:147], v[184:187], v[232:235], v[144:147]
  buffer_load_dwordx4 v[88:91], off, s[36:39], s51 offset:1024
  v_mfma_f32_16x16x32_bf16 v[148:151], v[184:187], v[236:239], v[148:151]
  ds_read_b64_tr_b16 v[216:217], v8 offset:12288
  ds_read_b64_tr_b16 v[218:219], v8 offset:14336
  v_mfma_f32_16x16x32_bf16 v[156:159], v[188:191], v[236:239], v[156:159]
  ds_read_b64_tr_b16 v[220:221], v9 offset:12288
  v_mfma_f32_16x16x32_bf16 v[152:155], v[188:191], v[232:235], v[152:155]
  ds_read_b64_tr_b16 v[222:223], v9 offset:14336
  s_waitcnt lgkmcnt(8)
  v_mfma_f32_16x16x32_bf16 v[96:99], v[192:195], v[224:227], v[96:99]
  ds_read_b64_tr_b16 v[160:161], v6 offset:16384
  v_mfma_f32_16x16x32_bf16 v[100:103], v[192:195], v[228:231], v[100:103]
  ds_read_b64_tr_b16 v[162:163], v6 offset:18432
  v_mfma_f32_16x16x32_bf16 v[108:111], v[196:199], v[228:231], v[108:111]
  buffer_load_dwordx4 v[92:95], off, s[64:67], s51 offset:1024
  v_mfma_f32_16x16x32_bf16 v[104:107], v[196:199], v[224:227], v[104:107]
  ds_read_b64_tr_b16 v[164:165], v7 offset:16384
  ds_read_b64_tr_b16 v[166:167], v7 offset:18432
  v_mfma_f32_16x16x32_bf16 v[112:115], v[200:203], v[224:227], v[112:115]
  ds_read_b64_tr_b16 v[168:169], v8 offset:16384
  v_mfma_f32_16x16x32_bf16 v[116:119], v[200:203], v[228:231], v[116:119]
  ds_read_b64_tr_b16 v[170:171], v8 offset:18432
  v_mfma_f32_16x16x32_bf16 v[124:127], v[204:207], v[228:231], v[124:127]
  ds_read_b64_tr_b16 v[172:173], v9 offset:16384
  v_mfma_f32_16x16x32_bf16 v[120:123], v[204:207], v[224:227], v[120:123]
  ds_read_b64_tr_b16 v[174:175], v9 offset:18432
  s_waitcnt lgkmcnt(8)
  v_mfma_f32_16x16x32_bf16 v[96:99], v[208:211], v[232:235], v[96:99]
  ds_read_b64_tr_b16 v[176:177], v6 offset:20480
  v_mfma_f32_16x16x32_bf16 v[100:103], v[208:211], v[236:239], v[100:103]
  ds_read_b64_tr_b16 v[178:179], v6 offset:22528
  v_mfma_f32_16x16x32_bf16 v[108:111], v[212:215], v[236:239], v[108:111]
  ds_read_b64_tr_b16 v[180:181], v7 offset:20480
  v_mfma_f32_16x16x32_bf16 v[104:107], v[212:215], v[232:235], v[104:107]
  ds_read_b64_tr_b16 v[182:183], v7 offset:22528
  v_mfma_f32_16x16x32_bf16 v[112:115], v[216:219], v[232:235], v[112:115]
  ds_read_b64_tr_b16 v[184:185], v8 offset:20480
  v_mfma_f32_16x16x32_bf16 v[116:119], v[216:219], v[236:239], v[116:119]
  ds_read_b64_tr_b16 v[186:187], v8 offset:22528
  v_readlane_b32 s48, v15, 16
  v_mfma_f32_16x16x32_bf16 v[124:127], v[220:223], v[236:239], v[124:127]
  ds_read_b64_tr_b16 v[188:189], v9 offset:20480
  v_mfma_f32_16x16x32_bf16 v[120:123], v[220:223], v[232:235], v[120:123]
  ds_read_b64_tr_b16 v[190:191], v9 offset:22528
  s_waitcnt vmcnt(18) lgkmcnt(8)
  v_mfma_f32_16x16x32_bf16 v[128:131], v[160:163], v[240:243], v[128:131]
  buffer_load_dwordx4 v[224:227], off, s[36:39], s48 offset:0
  v_mfma_f32_16x16x32_bf16 v[132:135], v[160:163], v[244:247], v[132:135]
  ds_read_b64_tr_b16 v[192:193], v6 offset:24576
  ds_read_b64_tr_b16 v[194:195], v6 offset:26624
  v_mfma_f32_16x16x32_bf16 v[140:143], v[164:167], v[244:247], v[140:143]
  ds_read_b64_tr_b16 v[196:197], v7 offset:24576
  v_mfma_f32_16x16x32_bf16 v[136:139], v[164:167], v[240:243], v[136:139]
  ds_read_b64_tr_b16 v[198:199], v7 offset:26624
  v_mfma_f32_16x16x32_bf16 v[144:147], v[168:171], v[240:243], v[144:147]
  ds_read_b64_tr_b16 v[200:201], v8 offset:24576
  v_mfma_f32_16x16x32_bf16 v[148:151], v[168:171], v[244:247], v[148:151]
  ds_read_b64_tr_b16 v[202:203], v8 offset:26624
  ds_read_b64_tr_b16 v[204:205], v9 offset:24576
  v_mfma_f32_16x16x32_bf16 v[156:159], v[172:175], v[244:247], v[156:159]
  buffer_load_dwordx4 v[228:231], off, s[64:67], s48 offset:0
  v_mfma_f32_16x16x32_bf16 v[152:155], v[172:175], v[240:243], v[152:155]
  ds_read_b64_tr_b16 v[206:207], v9 offset:26624
  s_waitcnt vmcnt(18) lgkmcnt(8)
  v_mfma_f32_16x16x32_bf16 v[128:131], v[176:179], v[248:251], v[128:131]
  ds_read_b64_tr_b16 v[208:209], v6 offset:28672
  v_mfma_f32_16x16x32_bf16 v[132:135], v[176:179], v[252:255], v[132:135]
  ds_read_b64_tr_b16 v[210:211], v6 offset:30720
  v_mfma_f32_16x16x32_bf16 v[140:143], v[180:183], v[252:255], v[140:143]
  ds_read_b64_tr_b16 v[212:213], v7 offset:28672
  v_mfma_f32_16x16x32_bf16 v[136:139], v[180:183], v[248:251], v[136:139]
  ds_read_b64_tr_b16 v[214:215], v7 offset:30720
  v_mfma_f32_16x16x32_bf16 v[144:147], v[184:187], v[248:251], v[144:147]
  buffer_load_dwordx4 v[232:235], off, s[36:39], s48 offset:1024
  v_mfma_f32_16x16x32_bf16 v[148:151], v[184:187], v[252:255], v[148:151]
  ds_read_b64_tr_b16 v[216:217], v8 offset:28672
  ds_read_b64_tr_b16 v[218:219], v8 offset:30720
  v_mfma_f32_16x16x32_bf16 v[156:159], v[188:191], v[252:255], v[156:159]
  ds_read_b64_tr_b16 v[220:221], v9 offset:28672
  v_mfma_f32_16x16x32_bf16 v[152:155], v[188:191], v[248:251], v[152:155]
  ds_read_b64_tr_b16 v[222:223], v9 offset:30720
  s_waitcnt lgkmcnt(8)
  v_mfma_f32_16x16x32_bf16 v[96:99], v[192:195], v[240:243], v[96:99]
  ds_read_b64_tr_b16 v[160:161], v6 offset:32768
  v_mfma_f32_16x16x32_bf16 v[100:103], v[192:195], v[244:247], v[100:103]
  ds_read_b64_tr_b16 v[162:163], v6 offset:34816
  v_mfma_f32_16x16x32_bf16 v[108:111], v[196:199], v[244:247], v[108:111]
  buffer_load_dwordx4 v[236:239], off, s[64:67], s48 offset:1024
  v_mfma_f32_16x16x32_bf16 v[104:107], v[196:199], v[240:243], v[104:107]
  ds_read_b64_tr_b16 v[164:165], v7 offset:32768
  ds_read_b64_tr_b16 v[166:167], v7 offset:34816
  v_mfma_f32_16x16x32_bf16 v[112:115], v[200:203], v[240:243], v[112:115]
  ds_read_b64_tr_b16 v[168:169], v8 offset:32768
  v_mfma_f32_16x16x32_bf16 v[116:119], v[200:203], v[244:247], v[116:119]
  ds_read_b64_tr_b16 v[170:171], v8 offset:34816
  v_mfma_f32_16x16x32_bf16 v[124:127], v[204:207], v[244:247], v[124:127]
  ds_read_b64_tr_b16 v[172:173], v9 offset:32768
  v_mfma_f32_16x16x32_bf16 v[120:123], v[204:207], v[240:243], v[120:123]
  ds_read_b64_tr_b16 v[174:175], v9 offset:34816
  s_waitcnt lgkmcnt(8)
  s_barrier
  v_mfma_f32_16x16x32_bf16 v[96:99], v[208:211], v[248:251], v[96:99]
  ds_read_b64_tr_b16 v[176:177], v6 offset:36864
  v_mfma_f32_16x16x32_bf16 v[100:103], v[208:211], v[252:255], v[100:103]
  ds_read_b64_tr_b16 v[178:179], v6 offset:38912
  v_mfma_f32_16x16x32_bf16 v[108:111], v[212:215], v[252:255], v[108:111]
  ds_read_b64_tr_b16 v[180:181], v7 offset:36864
  v_mfma_f32_16x16x32_bf16 v[104:107], v[212:215], v[248:251], v[104:107]
  ds_read_b64_tr_b16 v[182:183], v7 offset:38912
  v_mfma_f32_16x16x32_bf16 v[112:115], v[216:219], v[248:251], v[112:115]
  ds_read_b64_tr_b16 v[184:185], v8 offset:36864
  v_mfma_f32_16x16x32_bf16 v[116:119], v[216:219], v[252:255], v[116:119]
  ds_read_b64_tr_b16 v[186:187], v8 offset:38912
  v_readlane_b32 s49, v15, 17
  v_mfma_f32_16x16x32_bf16 v[124:127], v[220:223], v[252:255], v[124:127]
  ds_read_b64_tr_b16 v[188:189], v9 offset:36864
  v_mfma_f32_16x16x32_bf16 v[120:123], v[220:223], v[248:251], v[120:123]
  ds_read_b64_tr_b16 v[190:191], v9 offset:38912
  s_waitcnt vmcnt(18) lgkmcnt(8)
  v_mfma_f32_16x16x32_bf16 v[128:131], v[160:163], v[32:35], v[128:131]
  buffer_load_dwordx4 v[240:243], off, s[36:39], s49 offset:0
  v_mfma_f32_16x16x32_bf16 v[132:135], v[160:163], v[36:39], v[132:135]
  ds_read_b64_tr_b16 v[192:193], v6 offset:40960
  ds_read_b64_tr_b16 v[194:195], v6 offset:43008
  v_mfma_f32_16x16x32_bf16 v[140:143], v[164:167], v[36:39], v[140:143]
  ds_read_b64_tr_b16 v[196:197], v7 offset:40960
  v_mfma_f32_16x16x32_bf16 v[136:139], v[164:167], v[32:35], v[136:139]
  ds_read_b64_tr_b16 v[198:199], v7 offset:43008
  v_mfma_f32_16x16x32_bf16 v[144:147], v[168:171], v[32:35], v[144:147]
  ds_read_b64_tr_b16 v[200:201], v8 offset:40960
  v_mfma_f32_16x16x32_bf16 v[148:151], v[168:171], v[36:39], v[148:151]
  ds_read_b64_tr_b16 v[202:203], v8 offset:43008
  ds_read_b64_tr_b16 v[204:205], v9 offset:40960
  v_mfma_f32_16x16x32_bf16 v[156:159], v[172:175], v[36:39], v[156:159]
  buffer_load_dwordx4 v[244:247], off, s[64:67], s49 offset:0
  v_mfma_f32_16x16x32_bf16 v[152:155], v[172:175], v[32:35], v[152:155]
  ds_read_b64_tr_b16 v[206:207], v9 offset:43008
  s_waitcnt vmcnt(18) lgkmcnt(8)
  v_mfma_f32_16x16x32_bf16 v[128:131], v[176:179], v[40:43], v[128:131]
  ds_read_b64_tr_b16 v[208:209], v6 offset:45056
  v_mfma_f32_16x16x32_bf16 v[132:135], v[176:179], v[44:47], v[132:135]
  ds_read_b64_tr_b16 v[210:211], v6 offset:47104
  v_mfma_f32_16x16x32_bf16 v[140:143], v[180:183], v[44:47], v[140:143]
  ds_read_b64_tr_b16 v[212:213], v7 offset:45056
  v_mfma_f32_16x16x32_bf16 v[136:139], v[180:183], v[40:43], v[136:139]
  ds_read_b64_tr_b16 v[214:215], v7 offset:47104
  v_mfma_f32_16x16x32_bf16 v[144:147], v[184:187], v[40:43], v[144:147]
  buffer_load_dwordx4 v[248:251], off, s[36:39], s49 offset:1024
  v_mfma_f32_16x16x32_bf16 v[148:151], v[184:187], v[44:47], v[148:151]
  ds_read_b64_tr_b16 v[216:217], v8 offset:45056
  ds_read_b64_tr_b16 v[218:219], v8 offset:47104
  v_mfma_f32_16x16x32_bf16 v[156:159], v[188:191], v[44:47], v[156:159]
  ds_read_b64_tr_b16 v[220:221], v9 offset:45056
  v_mfma_f32_16x16x32_bf16 v[152:155], v[188:191], v[40:43], v[152:155]
  ds_read_b64_tr_b16 v[222:223], v9 offset:47104
  s_waitcnt lgkmcnt(8)
  v_mfma_f32_16x16x32_bf16 v[96:99], v[192:195], v[32:35], v[96:99]
  ds_read_b64_tr_b16 v[160:161], v6 offset:49152
  v_mfma_f32_16x16x32_bf16 v[100:103], v[192:195], v[36:39], v[100:103]
  ds_read_b64_tr_b16 v[162:163], v6 offset:51200
  v_mfma_f32_16x16x32_bf16 v[108:111], v[196:199], v[36:39], v[108:111]
  buffer_load_dwordx4 v[252:255], off, s[64:67], s49 offset:1024
  v_mfma_f32_16x16x32_bf16 v[104:107], v[196:199], v[32:35], v[104:107]
  ds_read_b64_tr_b16 v[164:165], v7 offset:49152
  ds_read_b64_tr_b16 v[166:167], v7 offset:51200
  v_mfma_f32_16x16x32_bf16 v[112:115], v[200:203], v[32:35], v[112:115]
  ds_read_b64_tr_b16 v[168:169], v8 offset:49152
  v_mfma_f32_16x16x32_bf16 v[116:119], v[200:203], v[36:39], v[116:119]
  ds_read_b64_tr_b16 v[170:171], v8 offset:51200
  v_mfma_f32_16x16x32_bf16 v[124:127], v[204:207], v[36:39], v[124:127]
  ds_read_b64_tr_b16 v[172:173], v9 offset:49152
  v_mfma_f32_16x16x32_bf16 v[120:123], v[204:207], v[32:35], v[120:123]
  ds_read_b64_tr_b16 v[174:175], v9 offset:51200
  s_waitcnt lgkmcnt(8)
  v_mfma_f32_16x16x32_bf16 v[96:99], v[208:211], v[40:43], v[96:99]
  ds_read_b64_tr_b16 v[176:177], v6 offset:53248
  v_mfma_f32_16x16x32_bf16 v[100:103], v[208:211], v[44:47], v[100:103]
  ds_read_b64_tr_b16 v[178:179], v6 offset:55296
  v_mfma_f32_16x16x32_bf16 v[108:111], v[212:215], v[44:47], v[108:111]
  ds_read_b64_tr_b16 v[180:181], v7 offset:53248
  v_mfma_f32_16x16x32_bf16 v[104:107], v[212:215], v[40:43], v[104:107]
  ds_read_b64_tr_b16 v[182:183], v7 offset:55296
  v_mfma_f32_16x16x32_bf16 v[112:115], v[216:219], v[40:43], v[112:115]
  ds_read_b64_tr_b16 v[184:185], v8 offset:53248
  v_mfma_f32_16x16x32_bf16 v[116:119], v[216:219], v[44:47], v[116:119]
  ds_read_b64_tr_b16 v[186:187], v8 offset:55296
  v_readlane_b32 s50, v15, 18
  v_mfma_f32_16x16x32_bf16 v[124:127], v[220:223], v[44:47], v[124:127]
  ds_read_b64_tr_b16 v[188:189], v9 offset:53248
  v_mfma_f32_16x16x32_bf16 v[120:123], v[220:223], v[40:43], v[120:123]
  ds_read_b64_tr_b16 v[190:191], v9 offset:55296
  s_waitcnt vmcnt(18) lgkmcnt(8)
  v_mfma_f32_16x16x32_bf16 v[128:131], v[160:163], v[48:51], v[128:131]
  buffer_load_dwordx4 v[32:35], off, s[36:39], s50 offset:0
  v_mfma_f32_16x16x32_bf16 v[132:135], v[160:163], v[52:55], v[132:135]
  ds_read_b64_tr_b16 v[192:193], v6 offset:57344
  ds_read_b64_tr_b16 v[194:195], v6 offset:59392
  v_mfma_f32_16x16x32_bf16 v[140:143], v[164:167], v[52:55], v[140:143]
  ds_read_b64_tr_b16 v[196:197], v7 offset:57344
  v_mfma_f32_16x16x32_bf16 v[136:139], v[164:167], v[48:51], v[136:139]
  ds_read_b64_tr_b16 v[198:199], v7 offset:59392
  v_mfma_f32_16x16x32_bf16 v[144:147], v[168:171], v[48:51], v[144:147]
  ds_read_b64_tr_b16 v[200:201], v8 offset:57344
  v_mfma_f32_16x16x32_bf16 v[148:151], v[168:171], v[52:55], v[148:151]
  ds_read_b64_tr_b16 v[202:203], v8 offset:59392
  ds_read_b64_tr_b16 v[204:205], v9 offset:57344
  v_mfma_f32_16x16x32_bf16 v[156:159], v[172:175], v[52:55], v[156:159]
  buffer_load_dwordx4 v[36:39], off, s[64:67], s50 offset:0
  v_mfma_f32_16x16x32_bf16 v[152:155], v[172:175], v[48:51], v[152:155]
  ds_read_b64_tr_b16 v[206:207], v9 offset:59392
  s_waitcnt vmcnt(18) lgkmcnt(8)
  v_mfma_f32_16x16x32_bf16 v[128:131], v[176:179], v[56:59], v[128:131]
  ds_read_b64_tr_b16 v[208:209], v6 offset:61440
  v_mfma_f32_16x16x32_bf16 v[132:135], v[176:179], v[60:63], v[132:135]
  ds_read_b64_tr_b16 v[210:211], v6 offset:63488
  v_mfma_f32_16x16x32_bf16 v[140:143], v[180:183], v[60:63], v[140:143]
  ds_read_b64_tr_b16 v[212:213], v7 offset:61440
  v_mfma_f32_16x16x32_bf16 v[136:139], v[180:183], v[56:59], v[136:139]
  ds_read_b64_tr_b16 v[214:215], v7 offset:63488
  v_mfma_f32_16x16x32_bf16 v[144:147], v[184:187], v[56:59], v[144:147]
  buffer_load_dwordx4 v[40:43], off, s[36:39], s50 offset:1024
  v_mfma_f32_16x16x32_bf16 v[148:151], v[184:187], v[60:63], v[148:151]
  ds_read_b64_tr_b16 v[216:217], v8 offset:61440
  ds_read_b64_tr_b16 v[218:219], v8 offset:63488
  v_mfma_f32_16x16x32_bf16 v[156:159], v[188:191], v[60:63], v[156:159]
  ds_read_b64_tr_b16 v[220:221], v9 offset:61440
  v_mfma_f32_16x16x32_bf16 v[152:155], v[188:191], v[56:59], v[152:155]
  ds_read_b64_tr_b16 v[222:223], v9 offset:63488
  s_waitcnt lgkmcnt(8)
  v_mfma_f32_16x16x32_bf16 v[96:99], v[192:195], v[48:51], v[96:99]
  ds_read_b64_tr_b16 v[160:161], v20 offset:0
  v_mfma_f32_16x16x32_bf16 v[100:103], v[192:195], v[52:55], v[100:103]
  ds_read_b64_tr_b16 v[162:163], v20 offset:2048
  v_mfma_f32_16x16x32_bf16 v[108:111], v[196:199], v[52:55], v[108:111]
  buffer_load_dwordx4 v[44:47], off, s[64:67], s50 offset:1024
  v_mfma_f32_16x16x32_bf16 v[104:107], v[196:199], v[48:51], v[104:107]
  ds_read_b64_tr_b16 v[164:165], v21 offset:0
  ds_read_b64_tr_b16 v[166:167], v21 offset:2048
  v_mfma_f32_16x16x32_bf16 v[112:115], v[200:203], v[48:51], v[112:115]
  ds_read_b64_tr_b16 v[168:169], v22 offset:0
  v_mfma_f32_16x16x32_bf16 v[116:119], v[200:203], v[52:55], v[116:119]
  ds_read_b64_tr_b16 v[170:171], v22 offset:2048
  v_mfma_f32_16x16x32_bf16 v[124:127], v[204:207], v[52:55], v[124:127]
  ds_read_b64_tr_b16 v[172:173], v23 offset:0
  v_mfma_f32_16x16x32_bf16 v[120:123], v[204:207], v[48:51], v[120:123]
  ds_read_b64_tr_b16 v[174:175], v23 offset:2048
  s_waitcnt lgkmcnt(8)
  s_barrier
  v_mfma_f32_16x16x32_bf16 v[96:99], v[208:211], v[56:59], v[96:99]
  ds_read_b64_tr_b16 v[176:177], v20 offset:4096
  v_mfma_f32_16x16x32_bf16 v[100:103], v[208:211], v[60:63], v[100:103]
  ds_read_b64_tr_b16 v[178:179], v20 offset:6144
  v_mfma_f32_16x16x32_bf16 v[108:111], v[212:215], v[60:63], v[108:111]
  ds_read_b64_tr_b16 v[180:181], v21 offset:4096
  v_mfma_f32_16x16x32_bf16 v[104:107], v[212:215], v[56:59], v[104:107]
  ds_read_b64_tr_b16 v[182:183], v21 offset:6144
  v_mfma_f32_16x16x32_bf16 v[112:115], v[216:219], v[56:59], v[112:115]
  ds_read_b64_tr_b16 v[184:185], v22 offset:4096
  v_mfma_f32_16x16x32_bf16 v[116:119], v[216:219], v[60:63], v[116:119]
  ds_read_b64_tr_b16 v[186:187], v22 offset:6144
  v_readlane_b32 s51, v15, 19
  v_mfma_f32_16x16x32_bf16 v[124:127], v[220:223], v[60:63], v[124:127]
  ds_read_b64_tr_b16 v[188:189], v23 offset:4096
  v_mfma_f32_16x16x32_bf16 v[120:123], v[220:223], v[56:59], v[120:123]
  ds_read_b64_tr_b16 v[190:191], v23 offset:6144
  s_waitcnt vmcnt(18) lgkmcnt(8)
  v_mfma_f32_16x16x32_bf16 v[128:131], v[160:163], v[64:67], v[128:131]
  buffer_load_dwordx4 v[48:51], off, s[36:39], s51 offset:0
  v_mfma_f32_16x16x32_bf16 v[132:135], v[160:163], v[68:71], v[132:135]
  ds_read_b64_tr_b16 v[192:193], v20 offset:8192
  ds_read_b64_tr_b16 v[194:195], v20 offset:10240
  v_mfma_f32_16x16x32_bf16 v[140:143], v[164:167], v[68:71], v[140:143]
  ds_read_b64_tr_b16 v[196:197], v21 offset:8192
  v_mfma_f32_16x16x32_bf16 v[136:139], v[164:167], v[64:67], v[136:139]
  ds_read_b64_tr_b16 v[198:199], v21 offset:10240
  v_mfma_f32_16x16x32_bf16 v[144:147], v[168:171], v[64:67], v[144:147]
  ds_read_b64_tr_b16 v[200:201], v22 offset:8192
  v_mfma_f32_16x16x32_bf16 v[148:151], v[168:171], v[68:71], v[148:151]
  ds_read_b64_tr_b16 v[202:203], v22 offset:10240
  ds_read_b64_tr_b16 v[204:205], v23 offset:8192
  v_mfma_f32_16x16x32_bf16 v[156:159], v[172:175], v[68:71], v[156:159]
  buffer_load_dwordx4 v[52:55], off, s[64:67], s51 offset:0
  v_mfma_f32_16x16x32_bf16 v[152:155], v[172:175], v[64:67], v[152:155]
  ds_read_b64_tr_b16 v[206:207], v23 offset:10240
  s_waitcnt vmcnt(18) lgkmcnt(8)
  v_mfma_f32_16x16x32_bf16 v[128:131], v[176:179], v[72:75], v[128:131]
  ds_read_b64_tr_b16 v[208:209], v20 offset:12288
  v_mfma_f32_16x16x32_bf16 v[132:135], v[176:179], v[76:79], v[132:135]
  ds_read_b64_tr_b16 v[210:211], v20 offset:14336
  v_mfma_f32_16x16x32_bf16 v[140:143], v[180:183], v[76:79], v[140:143]
  ds_read_b64_tr_b16 v[212:213], v21 offset:12288
  v_mfma_f32_16x16x32_bf16 v[136:139], v[180:183], v[72:75], v[136:139]
  ds_read_b64_tr_b16 v[214:215], v21 offset:14336
  v_mfma_f32_16x16x32_bf16 v[144:147], v[184:187], v[72:75], v[144:147]
  buffer_load_dwordx4 v[56:59], off, s[36:39], s51 offset:1024
  v_mfma_f32_16x16x32_bf16 v[148:151], v[184:187], v[76:79], v[148:151]
  ds_read_b64_tr_b16 v[216:217], v22 offset:12288
  ds_read_b64_tr_b16 v[218:219], v22 offset:14336
  v_mfma_f32_16x16x32_bf16 v[156:159], v[188:191], v[76:79], v[156:159]
  ds_read_b64_tr_b16 v[220:221], v23 offset:12288
  v_mfma_f32_16x16x32_bf16 v[152:155], v[188:191], v[72:75], v[152:155]
  ds_read_b64_tr_b16 v[222:223], v23 offset:14336
  s_waitcnt lgkmcnt(8)
  v_mfma_f32_16x16x32_bf16 v[96:99], v[192:195], v[64:67], v[96:99]
  ds_read_b64_tr_b16 v[160:161], v20 offset:16384
  v_mfma_f32_16x16x32_bf16 v[100:103], v[192:195], v[68:71], v[100:103]
  ds_read_b64_tr_b16 v[162:163], v20 offset:18432
  v_mfma_f32_16x16x32_bf16 v[108:111], v[196:199], v[68:71], v[108:111]
  buffer_load_dwordx4 v[60:63], off, s[64:67], s51 offset:1024
  v_mfma_f32_16x16x32_bf16 v[104:107], v[196:199], v[64:67], v[104:107]
  ds_read_b64_tr_b16 v[164:165], v21 offset:16384
  ds_read_b64_tr_b16 v[166:167], v21 offset:18432
  v_mfma_f32_16x16x32_bf16 v[112:115], v[200:203], v[64:67], v[112:115]
  ds_read_b64_tr_b16 v[168:169], v22 offset:16384
  v_mfma_f32_16x16x32_bf16 v[116:119], v[200:203], v[68:71], v[116:119]
  ds_read_b64_tr_b16 v[170:171], v22 offset:18432
  v_mfma_f32_16x16x32_bf16 v[124:127], v[204:207], v[68:71], v[124:127]
  ds_read_b64_tr_b16 v[172:173], v23 offset:16384
  v_mfma_f32_16x16x32_bf16 v[120:123], v[204:207], v[64:67], v[120:123]
  ds_read_b64_tr_b16 v[174:175], v23 offset:18432
  s_waitcnt lgkmcnt(8)
  v_mfma_f32_16x16x32_bf16 v[96:99], v[208:211], v[72:75], v[96:99]
  ds_read_b64_tr_b16 v[176:177], v20 offset:20480
  v_mfma_f32_16x16x32_bf16 v[100:103], v[208:211], v[76:79], v[100:103]
  ds_read_b64_tr_b16 v[178:179], v20 offset:22528
  v_mfma_f32_16x16x32_bf16 v[108:111], v[212:215], v[76:79], v[108:111]
  ds_read_b64_tr_b16 v[180:181], v21 offset:20480
  v_mfma_f32_16x16x32_bf16 v[104:107], v[212:215], v[72:75], v[104:107]
  ds_read_b64_tr_b16 v[182:183], v21 offset:22528
  v_mfma_f32_16x16x32_bf16 v[112:115], v[216:219], v[72:75], v[112:115]
  ds_read_b64_tr_b16 v[184:185], v22 offset:20480
  v_mfma_f32_16x16x32_bf16 v[116:119], v[216:219], v[76:79], v[116:119]
  ds_read_b64_tr_b16 v[186:187], v22 offset:22528
  v_readlane_b32 s48, v15, 20
  v_mfma_f32_16x16x32_bf16 v[124:127], v[220:223], v[76:79], v[124:127]
  ds_read_b64_tr_b16 v[188:189], v23 offset:20480
  v_mfma_f32_16x16x32_bf16 v[120:123], v[220:223], v[72:75], v[120:123]
  ds_read_b64_tr_b16 v[190:191], v23 offset:22528
  s_waitcnt vmcnt(18) lgkmcnt(8)
  v_mfma_f32_16x16x32_bf16 v[128:131], v[160:163], v[80:83], v[128:131]
  buffer_load_dwordx4 v[64:67], off, s[36:39], s48 offset:0
  v_mfma_f32_16x16x32_bf16 v[132:135], v[160:163], v[84:87], v[132:135]
  ds_read_b64_tr_b16 v[192:193], v20 offset:24576
  ds_read_b64_tr_b16 v[194:195], v20 offset:26624
  v_mfma_f32_16x16x32_bf16 v[140:143], v[164:167], v[84:87], v[140:143]
  ds_read_b64_tr_b16 v[196:197], v21 offset:24576
  v_mfma_f32_16x16x32_bf16 v[136:139], v[164:167], v[80:83], v[136:139]
  ds_read_b64_tr_b16 v[198:199], v21 offset:26624
  v_mfma_f32_16x16x32_bf16 v[144:147], v[168:171], v[80:83], v[144:147]
  ds_read_b64_tr_b16 v[200:201], v22 offset:24576
  v_mfma_f32_16x16x32_bf16 v[148:151], v[168:171], v[84:87], v[148:151]
  ds_read_b64_tr_b16 v[202:203], v22 offset:26624
  ds_read_b64_tr_b16 v[204:205], v23 offset:24576
  v_mfma_f32_16x16x32_bf16 v[156:159], v[172:175], v[84:87], v[156:159]
  buffer_load_dwordx4 v[68:71], off, s[64:67], s48 offset:0
  v_mfma_f32_16x16x32_bf16 v[152:155], v[172:175], v[80:83], v[152:155]
  ds_read_b64_tr_b16 v[206:207], v23 offset:26624
  s_waitcnt vmcnt(18) lgkmcnt(8)
  v_mfma_f32_16x16x32_bf16 v[128:131], v[176:179], v[88:91], v[128:131]
  ds_read_b64_tr_b16 v[208:209], v20 offset:28672
  v_mfma_f32_16x16x32_bf16 v[132:135], v[176:179], v[92:95], v[132:135]
  ds_read_b64_tr_b16 v[210:211], v20 offset:30720
  v_mfma_f32_16x16x32_bf16 v[140:143], v[180:183], v[92:95], v[140:143]
  ds_read_b64_tr_b16 v[212:213], v21 offset:28672
  v_mfma_f32_16x16x32_bf16 v[136:139], v[180:183], v[88:91], v[136:139]
  ds_read_b64_tr_b16 v[214:215], v21 offset:30720
  v_mfma_f32_16x16x32_bf16 v[144:147], v[184:187], v[88:91], v[144:147]
  buffer_load_dwordx4 v[72:75], off, s[36:39], s48 offset:1024
  v_mfma_f32_16x16x32_bf16 v[148:151], v[184:187], v[92:95], v[148:151]
  ds_read_b64_tr_b16 v[216:217], v22 offset:28672
  ds_read_b64_tr_b16 v[218:219], v22 offset:30720
  v_mfma_f32_16x16x32_bf16 v[156:159], v[188:191], v[92:95], v[156:159]
  ds_read_b64_tr_b16 v[220:221], v23 offset:28672
  v_mfma_f32_16x16x32_bf16 v[152:155], v[188:191], v[88:91], v[152:155]
  ds_read_b64_tr_b16 v[222:223], v23 offset:30720
  s_waitcnt lgkmcnt(8)
  v_mfma_f32_16x16x32_bf16 v[96:99], v[192:195], v[80:83], v[96:99]
  ds_read_b64_tr_b16 v[160:161], v20 offset:32768
  v_mfma_f32_16x16x32_bf16 v[100:103], v[192:195], v[84:87], v[100:103]
  ds_read_b64_tr_b16 v[162:163], v20 offset:34816
  v_mfma_f32_16x16x32_bf16 v[108:111], v[196:199], v[84:87], v[108:111]
  buffer_load_dwordx4 v[76:79], off, s[64:67], s48 offset:1024
  v_mfma_f32_16x16x32_bf16 v[104:107], v[196:199], v[80:83], v[104:107]
  ds_read_b64_tr_b16 v[164:165], v21 offset:32768
  ds_read_b64_tr_b16 v[166:167], v21 offset:34816
  v_mfma_f32_16x16x32_bf16 v[112:115], v[200:203], v[80:83], v[112:115]
  ds_read_b64_tr_b16 v[168:169], v22 offset:32768
  v_mfma_f32_16x16x32_bf16 v[116:119], v[200:203], v[84:87], v[116:119]
  ds_read_b64_tr_b16 v[170:171], v22 offset:34816
  v_mfma_f32_16x16x32_bf16 v[124:127], v[204:207], v[84:87], v[124:127]
  ds_read_b64_tr_b16 v[172:173], v23 offset:32768
  v_mfma_f32_16x16x32_bf16 v[120:123], v[204:207], v[80:83], v[120:123]
  ds_read_b64_tr_b16 v[174:175], v23 offset:34816
  s_waitcnt lgkmcnt(8)
  s_barrier
  v_mfma_f32_16x16x32_bf16 v[96:99], v[208:211], v[88:91], v[96:99]
  ds_read_b64_tr_b16 v[176:177], v20 offset:36864
  v_mfma_f32_16x16x32_bf16 v[100:103], v[208:211], v[92:95], v[100:103]
  ds_read_b64_tr_b16 v[178:179], v20 offset:38912
  v_mfma_f32_16x16x32_bf16 v[108:111], v[212:215], v[92:95], v[108:111]
  ds_read_b64_tr_b16 v[180:181], v21 offset:36864
  v_mfma_f32_16x16x32_bf16 v[104:107], v[212:215], v[88:91], v[104:107]
  ds_read_b64_tr_b16 v[182:183], v21 offset:38912
  v_mfma_f32_16x16x32_bf16 v[112:115], v[216:219], v[88:91], v[112:115]
  ds_read_b64_tr_b16 v[184:185], v22 offset:36864
  v_mfma_f32_16x16x32_bf16 v[116:119], v[216:219], v[92:95], v[116:119]
  ds_read_b64_tr_b16 v[186:187], v22 offset:38912
  v_readlane_b32 s49, v15, 21
  v_mfma_f32_16x16x32_bf16 v[124:127], v[220:223], v[92:95], v[124:127]
  ds_read_b64_tr_b16 v[188:189], v23 offset:36864
  v_mfma_f32_16x16x32_bf16 v[120:123], v[220:223], v[88:91], v[120:123]
  ds_read_b64_tr_b16 v[190:191], v23 offset:38912
  s_waitcnt vmcnt(18) lgkmcnt(8)
  v_mfma_f32_16x16x32_bf16 v[128:131], v[160:163], v[224:227], v[128:131]
  buffer_load_dwordx4 v[80:83], off, s[36:39], s49 offset:0
  v_mfma_f32_16x16x32_bf16 v[132:135], v[160:163], v[228:231], v[132:135]
  ds_read_b64_tr_b16 v[192:193], v20 offset:40960
  ds_read_b64_tr_b16 v[194:195], v20 offset:43008
  v_mfma_f32_16x16x32_bf16 v[140:143], v[164:167], v[228:231], v[140:143]
  ds_read_b64_tr_b16 v[196:197], v21 offset:40960
  v_mfma_f32_16x16x32_bf16 v[136:139], v[164:167], v[224:227], v[136:139]
  ds_read_b64_tr_b16 v[198:199], v21 offset:43008
  v_mfma_f32_16x16x32_bf16 v[144:147], v[168:171], v[224:227], v[144:147]
  ds_read_b64_tr_b16 v[200:201], v22 offset:40960
  v_mfma_f32_16x16x32_bf16 v[148:151], v[168:171], v[228:231], v[148:151]
  ds_read_b64_tr_b16 v[202:203], v22 offset:43008
  ds_read_b64_tr_b16 v[204:205], v23 offset:40960
  v_mfma_f32_16x16x32_bf16 v[156:159], v[172:175], v[228:231], v[156:159]
  buffer_load_dwordx4 v[84:87], off, s[64:67], s49 offset:0
  v_mfma_f32_16x16x32_bf16 v[152:155], v[172:175], v[224:227], v[152:155]
  ds_read_b64_tr_b16 v[206:207], v23 offset:43008
  s_waitcnt vmcnt(18) lgkmcnt(8)
  v_mfma_f32_16x16x32_bf16 v[128:131], v[176:179], v[232:235], v[128:131]
  ds_read_b64_tr_b16 v[208:209], v20 offset:45056
  v_mfma_f32_16x16x32_bf16 v[132:135], v[176:179], v[236:239], v[132:135]
  ds_read_b64_tr_b16 v[210:211], v20 offset:47104
  v_mfma_f32_16x16x32_bf16 v[140:143], v[180:183], v[236:239], v[140:143]
  ds_read_b64_tr_b16 v[212:213], v21 offset:45056
  v_mfma_f32_16x16x32_bf16 v[136:139], v[180:183], v[232:235], v[136:139]
  ds_read_b64_tr_b16 v[214:215], v21 offset:47104
  v_mfma_f32_16x16x32_bf16 v[144:147], v[184:187], v[232:235], v[144:147]
  buffer_load_dwordx4 v[88:91], off, s[36:39], s49 offset:1024
  v_mfma_f32_16x16x32_bf16 v[148:151], v[184:187], v[236:239], v[148:151]
  ds_read_b64_tr_b16 v[216:217], v22 offset:45056
  ds_read_b64_tr_b16 v[218:219], v22 offset:47104
  v_mfma_f32_16x16x32_bf16 v[156:159], v[188:191], v[236:239], v[156:159]
  ds_read_b64_tr_b16 v[220:221], v23 offset:45056
  v_mfma_f32_16x16x32_bf16 v[152:155], v[188:191], v[232:235], v[152:155]
  ds_read_b64_tr_b16 v[222:223], v23 offset:47104
  s_waitcnt lgkmcnt(8)
  v_mfma_f32_16x16x32_bf16 v[96:99], v[192:195], v[224:227], v[96:99]
  ds_read_b64_tr_b16 v[160:161], v20 offset:49152
  v_mfma_f32_16x16x32_bf16 v[100:103], v[192:195], v[228:231], v[100:103]
  ds_read_b64_tr_b16 v[162:163], v20 offset:51200
  v_mfma_f32_16x16x32_bf16 v[108:111], v[196:199], v[228:231], v[108:111]
  buffer_load_dwordx4 v[92:95], off, s[64:67], s49 offset:1024
  v_mfma_f32_16x16x32_bf16 v[104:107], v[196:199], v[224:227], v[104:107]
  ds_read_b64_tr_b16 v[164:165], v21 offset:49152
  ds_read_b64_tr_b16 v[166:167], v21 offset:51200
  v_mfma_f32_16x16x32_bf16 v[112:115], v[200:203], v[224:227], v[112:115]
  ds_read_b64_tr_b16 v[168:169], v22 offset:49152
  v_mfma_f32_16x16x32_bf16 v[116:119], v[200:203], v[228:231], v[116:119]
  ds_read_b64_tr_b16 v[170:171], v22 offset:51200
  v_mfma_f32_16x16x32_bf16 v[124:127], v[204:207], v[228:231], v[124:127]
  ds_read_b64_tr_b16 v[172:173], v23 offset:49152
  v_mfma_f32_16x16x32_bf16 v[120:123], v[204:207], v[224:227], v[120:123]
  ds_read_b64_tr_b16 v[174:175], v23 offset:51200
  s_waitcnt lgkmcnt(8)
  v_mfma_f32_16x16x32_bf16 v[96:99], v[208:211], v[232:235], v[96:99]
  ds_read_b64_tr_b16 v[176:177], v20 offset:53248
  v_mfma_f32_16x16x32_bf16 v[100:103], v[208:211], v[236:239], v[100:103]
  ds_read_b64_tr_b16 v[178:179], v20 offset:55296
  v_mfma_f32_16x16x32_bf16 v[108:111], v[212:215], v[236:239], v[108:111]
  ds_read_b64_tr_b16 v[180:181], v21 offset:53248
  v_mfma_f32_16x16x32_bf16 v[104:107], v[212:215], v[232:235], v[104:107]
  ds_read_b64_tr_b16 v[182:183], v21 offset:55296
  v_mfma_f32_16x16x32_bf16 v[112:115], v[216:219], v[232:235], v[112:115]
  ds_read_b64_tr_b16 v[184:185], v22 offset:53248
  v_mfma_f32_16x16x32_bf16 v[116:119], v[216:219], v[236:239], v[116:119]
  ds_read_b64_tr_b16 v[186:187], v22 offset:55296
  v_readlane_b32 s50, v15, 22
  v_mfma_f32_16x16x32_bf16 v[124:127], v[220:223], v[236:239], v[124:127]
  ds_read_b64_tr_b16 v[188:189], v23 offset:53248
  v_mfma_f32_16x16x32_bf16 v[120:123], v[220:223], v[232:235], v[120:123]
  ds_read_b64_tr_b16 v[190:191], v23 offset:55296
  s_waitcnt vmcnt(18) lgkmcnt(8)
  v_mfma_f32_16x16x32_bf16 v[128:131], v[160:163], v[240:243], v[128:131]
  buffer_load_dwordx4 v[224:227], off, s[36:39], s50 offset:0
  v_mfma_f32_16x16x32_bf16 v[132:135], v[160:163], v[244:247], v[132:135]
  ds_read_b64_tr_b16 v[192:193], v20 offset:57344
  ds_read_b64_tr_b16 v[194:195], v20 offset:59392
  v_mfma_f32_16x16x32_bf16 v[140:143], v[164:167], v[244:247], v[140:143]
  ds_read_b64_tr_b16 v[196:197], v21 offset:57344
  v_mfma_f32_16x16x32_bf16 v[136:139], v[164:167], v[240:243], v[136:139]
  ds_read_b64_tr_b16 v[198:199], v21 offset:59392
  v_mfma_f32_16x16x32_bf16 v[144:147], v[168:171], v[240:243], v[144:147]
  ds_read_b64_tr_b16 v[200:201], v22 offset:57344
  v_mfma_f32_16x16x32_bf16 v[148:151], v[168:171], v[244:247], v[148:151]
  ds_read_b64_tr_b16 v[202:203], v22 offset:59392
  ds_read_b64_tr_b16 v[204:205], v23 offset:57344
  v_mfma_f32_16x16x32_bf16 v[156:159], v[172:175], v[244:247], v[156:159]
  buffer_load_dwordx4 v[228:231], off, s[64:67], s50 offset:0
  v_mfma_f32_16x16x32_bf16 v[152:155], v[172:175], v[240:243], v[152:155]
  ds_read_b64_tr_b16 v[206:207], v23 offset:59392
  s_waitcnt vmcnt(18) lgkmcnt(8)
  v_mfma_f32_16x16x32_bf16 v[128:131], v[176:179], v[248:251], v[128:131]
  ds_read_b64_tr_b16 v[208:209], v20 offset:61440
  v_mfma_f32_16x16x32_bf16 v[132:135], v[176:179], v[252:255], v[132:135]
  ds_read_b64_tr_b16 v[210:211], v20 offset:63488
  v_mfma_f32_16x16x32_bf16 v[140:143], v[180:183], v[252:255], v[140:143]
  ds_read_b64_tr_b16 v[212:213], v21 offset:61440
  v_mfma_f32_16x16x32_bf16 v[136:139], v[180:183], v[248:251], v[136:139]
  ds_read_b64_tr_b16 v[214:215], v21 offset:63488
  v_mfma_f32_16x16x32_bf16 v[144:147], v[184:187], v[248:251], v[144:147]
  buffer_load_dwordx4 v[232:235], off, s[36:39], s50 offset:1024
  v_mfma_f32_16x16x32_bf16 v[148:151], v[184:187], v[252:255], v[148:151]
  ds_read_b64_tr_b16 v[216:217], v22 offset:61440
  ds_read_b64_tr_b16 v[218:219], v22 offset:63488
  v_mfma_f32_16x16x32_bf16 v[156:159], v[188:191], v[252:255], v[156:159]
  ds_read_b64_tr_b16 v[220:221], v23 offset:61440
  v_mfma_f32_16x16x32_bf16 v[152:155], v[188:191], v[248:251], v[152:155]
  ds_read_b64_tr_b16 v[222:223], v23 offset:63488
  s_waitcnt vmcnt(17) lgkmcnt(8)
  v_mfma_f32_16x16x32_bf16 v[128:131], v[192:195], v[32:35], v[128:131]
  ds_read_b64_tr_b16 v[160:161], v26 offset:0
  v_mfma_f32_16x16x32_bf16 v[132:135], v[192:195], v[36:39], v[132:135]
  ds_read_b64_tr_b16 v[162:163], v26 offset:2048
  v_mfma_f32_16x16x32_bf16 v[140:143], v[196:199], v[36:39], v[140:143]
  buffer_load_dwordx4 v[236:239], off, s[64:67], s50 offset:1024
  v_mfma_f32_16x16x32_bf16 v[136:139], v[196:199], v[32:35], v[136:139]
  ds_read_b64_tr_b16 v[164:165], v27 offset:0
  ds_read_b64_tr_b16 v[166:167], v27 offset:2048
  v_mfma_f32_16x16x32_bf16 v[144:147], v[200:203], v[32:35], v[144:147]
  ds_read_b64_tr_b16 v[168:169], v28 offset:0
  v_mfma_f32_16x16x32_bf16 v[148:151], v[200:203], v[36:39], v[148:151]
  ds_read_b64_tr_b16 v[170:171], v28 offset:2048
  v_mfma_f32_16x16x32_bf16 v[156:159], v[204:207], v[36:39], v[156:159]
  ds_read_b64_tr_b16 v[172:173], v29 offset:0
  v_mfma_f32_16x16x32_bf16 v[152:155], v[204:207], v[32:35], v[152:155]
  ds_read_b64_tr_b16 v[174:175], v29 offset:2048
  s_waitcnt vmcnt(16) lgkmcnt(8)
  s_barrier
  v_mfma_f32_16x16x32_bf16 v[128:131], v[208:211], v[40:43], v[128:131]
  ds_read_b64_tr_b16 v[176:177], v26 offset:4096
  v_mfma_f32_16x16x32_bf16 v[132:135], v[208:211], v[44:47], v[132:135]
  ds_read_b64_tr_b16 v[178:179], v26 offset:6144
  v_mfma_f32_16x16x32_bf16 v[140:143], v[212:215], v[44:47], v[140:143]
  ds_read_b64_tr_b16 v[180:181], v27 offset:4096
  v_mfma_f32_16x16x32_bf16 v[136:139], v[212:215], v[40:43], v[136:139]
  ds_read_b64_tr_b16 v[182:183], v27 offset:6144
  v_mfma_f32_16x16x32_bf16 v[144:147], v[216:219], v[40:43], v[144:147]
  ds_read_b64_tr_b16 v[184:185], v28 offset:4096
  v_mfma_f32_16x16x32_bf16 v[148:151], v[216:219], v[44:47], v[148:151]
  ds_read_b64_tr_b16 v[186:187], v28 offset:6144
  v_mfma_f32_16x16x32_bf16 v[156:159], v[220:223], v[44:47], v[156:159]
  ds_read_b64_tr_b16 v[188:189], v29 offset:4096
  v_mfma_f32_16x16x32_bf16 v[152:155], v[220:223], v[40:43], v[152:155]
  ds_read_b64_tr_b16 v[190:191], v29 offset:6144
  s_waitcnt vmcnt(14) lgkmcnt(8)
  v_mfma_f32_16x16x32_bf16 v[128:131], v[160:163], v[48:51], v[128:131]
  ds_read_b64_tr_b16 v[192:193], v26 offset:8192
  v_mfma_f32_16x16x32_bf16 v[132:135], v[160:163], v[52:55], v[132:135]
  ds_read_b64_tr_b16 v[194:195], v26 offset:10240
  v_mfma_f32_16x16x32_bf16 v[140:143], v[164:167], v[52:55], v[140:143]
  ds_read_b64_tr_b16 v[196:197], v27 offset:8192
  v_mfma_f32_16x16x32_bf16 v[136:139], v[164:167], v[48:51], v[136:139]
  ds_read_b64_tr_b16 v[198:199], v27 offset:10240
  v_mfma_f32_16x16x32_bf16 v[144:147], v[168:171], v[48:51], v[144:147]
  ds_read_b64_tr_b16 v[200:201], v28 offset:8192
  v_mfma_f32_16x16x32_bf16 v[148:151], v[168:171], v[52:55], v[148:151]
  ds_read_b64_tr_b16 v[202:203], v28 offset:10240
  v_mfma_f32_16x16x32_bf16 v[156:159], v[172:175], v[52:55], v[156:159]
  ds_read_b64_tr_b16 v[204:205], v29 offset:8192
  v_mfma_f32_16x16x32_bf16 v[152:155], v[172:175], v[48:51], v[152:155]
  ds_read_b64_tr_b16 v[206:207], v29 offset:10240
  s_waitcnt vmcnt(12) lgkmcnt(8)
  v_mfma_f32_16x16x32_bf16 v[128:131], v[176:179], v[56:59], v[128:131]
  ds_read_b64_tr_b16 v[208:209], v26 offset:12288
  v_mfma_f32_16x16x32_bf16 v[132:135], v[176:179], v[60:63], v[132:135]
  ds_read_b64_tr_b16 v[210:211], v26 offset:14336
  v_mfma_f32_16x16x32_bf16 v[140:143], v[180:183], v[60:63], v[140:143]
  ds_read_b64_tr_b16 v[212:213], v27 offset:12288
  v_mfma_f32_16x16x32_bf16 v[136:139], v[180:183], v[56:59], v[136:139]
  ds_read_b64_tr_b16 v[214:215], v27 offset:14336
  v_mfma_f32_16x16x32_bf16 v[144:147], v[184:187], v[56:59], v[144:147]
  ds_read_b64_tr_b16 v[216:217], v28 offset:12288
  v_mfma_f32_16x16x32_bf16 v[148:151], v[184:187], v[60:63], v[148:151]
  ds_read_b64_tr_b16 v[218:219], v28 offset:14336
  v_mfma_f32_16x16x32_bf16 v[156:159], v[188:191], v[60:63], v[156:159]
  ds_read_b64_tr_b16 v[220:221], v29 offset:12288
  v_mfma_f32_16x16x32_bf16 v[152:155], v[188:191], v[56:59], v[152:155]
  ds_read_b64_tr_b16 v[222:223], v29 offset:14336
  s_waitcnt vmcnt(10) lgkmcnt(8)
  v_mfma_f32_16x16x32_bf16 v[128:131], v[192:195], v[64:67], v[128:131]
  ds_read_b64_tr_b16 v[160:161], v26 offset:16384
  v_mfma_f32_16x16x32_bf16 v[132:135], v[192:195], v[68:71], v[132:135]
  ds_read_b64_tr_b16 v[162:163], v26 offset:18432
  v_mfma_f32_16x16x32_bf16 v[140:143], v[196:199], v[68:71], v[140:143]
  ds_read_b64_tr_b16 v[164:165], v27 offset:16384
  v_mfma_f32_16x16x32_bf16 v[136:139], v[196:199], v[64:67], v[136:139]
  ds_read_b64_tr_b16 v[166:167], v27 offset:18432
  v_mfma_f32_16x16x32_bf16 v[144:147], v[200:203], v[64:67], v[144:147]
  ds_read_b64_tr_b16 v[168:169], v28 offset:16384
  v_mfma_f32_16x16x32_bf16 v[148:151], v[200:203], v[68:71], v[148:151]
  ds_read_b64_tr_b16 v[170:171], v28 offset:18432
  v_mfma_f32_16x16x32_bf16 v[156:159], v[204:207], v[68:71], v[156:159]
  ds_read_b64_tr_b16 v[172:173], v29 offset:16384
  v_mfma_f32_16x16x32_bf16 v[152:155], v[204:207], v[64:67], v[152:155]
  ds_read_b64_tr_b16 v[174:175], v29 offset:18432
  s_waitcnt vmcnt(8) lgkmcnt(8)
  v_mfma_f32_16x16x32_bf16 v[128:131], v[208:211], v[72:75], v[128:131]
  ds_read_b64_tr_b16 v[176:177], v26 offset:20480
  v_mfma_f32_16x16x32_bf16 v[132:135], v[208:211], v[76:79], v[132:135]
  ds_read_b64_tr_b16 v[178:179], v26 offset:22528
  v_mfma_f32_16x16x32_bf16 v[140:143], v[212:215], v[76:79], v[140:143]
  ds_read_b64_tr_b16 v[180:181], v27 offset:20480
  v_mfma_f32_16x16x32_bf16 v[136:139], v[212:215], v[72:75], v[136:139]
  ds_read_b64_tr_b16 v[182:183], v27 offset:22528
  v_mfma_f32_16x16x32_bf16 v[144:147], v[216:219], v[72:75], v[144:147]
  ds_read_b64_tr_b16 v[184:185], v28 offset:20480
  v_mfma_f32_16x16x32_bf16 v[148:151], v[216:219], v[76:79], v[148:151]
  ds_read_b64_tr_b16 v[186:187], v28 offset:22528
  v_mfma_f32_16x16x32_bf16 v[156:159], v[220:223], v[76:79], v[156:159]
  ds_read_b64_tr_b16 v[188:189], v29 offset:20480
  v_mfma_f32_16x16x32_bf16 v[152:155], v[220:223], v[72:75], v[152:155]
  ds_read_b64_tr_b16 v[190:191], v29 offset:22528
  s_waitcnt vmcnt(6) lgkmcnt(8)
  v_mfma_f32_16x16x32_bf16 v[128:131], v[160:163], v[80:83], v[128:131]
  ds_read_b64_tr_b16 v[192:193], v26 offset:24576
  v_mfma_f32_16x16x32_bf16 v[132:135], v[160:163], v[84:87], v[132:135]
  ds_read_b64_tr_b16 v[194:195], v26 offset:26624
  v_mfma_f32_16x16x32_bf16 v[140:143], v[164:167], v[84:87], v[140:143]
  ds_read_b64_tr_b16 v[196:197], v27 offset:24576
  v_mfma_f32_16x16x32_bf16 v[136:139], v[164:167], v[80:83], v[136:139]
  ds_read_b64_tr_b16 v[198:199], v27 offset:26624
  v_mfma_f32_16x16x32_bf16 v[144:147], v[168:171], v[80:83], v[144:147]
  ds_read_b64_tr_b16 v[200:201], v28 offset:24576
  v_mfma_f32_16x16x32_bf16 v[148:151], v[168:171], v[84:87], v[148:151]
  ds_read_b64_tr_b16 v[202:203], v28 offset:26624
  v_mfma_f32_16x16x32_bf16 v[156:159], v[172:175], v[84:87], v[156:159]
  ds_read_b64_tr_b16 v[204:205], v29 offset:24576
  v_mfma_f32_16x16x32_bf16 v[152:155], v[172:175], v[80:83], v[152:155]
  ds_read_b64_tr_b16 v[206:207], v29 offset:26624
  s_waitcnt vmcnt(4) lgkmcnt(8)
  v_mfma_f32_16x16x32_bf16 v[128:131], v[176:179], v[88:91], v[128:131]
  ds_read_b64_tr_b16 v[208:209], v26 offset:28672
  v_mfma_f32_16x16x32_bf16 v[132:135], v[176:179], v[92:95], v[132:135]
  ds_read_b64_tr_b16 v[210:211], v26 offset:30720
  v_mfma_f32_16x16x32_bf16 v[140:143], v[180:183], v[92:95], v[140:143]
  ds_read_b64_tr_b16 v[212:213], v27 offset:28672
  v_mfma_f32_16x16x32_bf16 v[136:139], v[180:183], v[88:91], v[136:139]
  ds_read_b64_tr_b16 v[214:215], v27 offset:30720
  v_mfma_f32_16x16x32_bf16 v[144:147], v[184:187], v[88:91], v[144:147]
  ds_read_b64_tr_b16 v[216:217], v28 offset:28672
  v_mfma_f32_16x16x32_bf16 v[148:151], v[184:187], v[92:95], v[148:151]
  ds_read_b64_tr_b16 v[218:219], v28 offset:30720
  v_mfma_f32_16x16x32_bf16 v[156:159], v[188:191], v[92:95], v[156:159]
  ds_read_b64_tr_b16 v[220:221], v29 offset:28672
  v_mfma_f32_16x16x32_bf16 v[152:155], v[188:191], v[88:91], v[152:155]
  ds_read_b64_tr_b16 v[222:223], v29 offset:30720
  s_waitcnt vmcnt(2) lgkmcnt(8)
  v_mfma_f32_16x16x32_bf16 v[128:131], v[192:195], v[224:227], v[128:131]
  ds_read_b64_tr_b16 v[160:161], v6 offset:0
  v_mfma_f32_16x16x32_bf16 v[132:135], v[192:195], v[228:231], v[132:135]
  ds_read_b64_tr_b16 v[162:163], v6 offset:2048
  v_mfma_f32_16x16x32_bf16 v[140:143], v[196:199], v[228:231], v[140:143]
  ds_read_b64_tr_b16 v[164:165], v7 offset:0
  v_mfma_f32_16x16x32_bf16 v[136:139], v[196:199], v[224:227], v[136:139]
  ds_read_b64_tr_b16 v[166:167], v7 offset:2048
  v_mfma_f32_16x16x32_bf16 v[144:147], v[200:203], v[224:227], v[144:147]
  ds_read_b64_tr_b16 v[168:169], v8 offset:0
  v_mfma_f32_16x16x32_bf16 v[148:151], v[200:203], v[228:231], v[148:151]
  ds_read_b64_tr_b16 v[170:171], v8 offset:2048
  v_mfma_f32_16x16x32_bf16 v[156:159], v[204:207], v[228:231], v[156:159]
  ds_read_b64_tr_b16 v[172:173], v9 offset:0
  v_mfma_f32_16x16x32_bf16 v[152:155], v[204:207], v[224:227], v[152:155]
  ds_read_b64_tr_b16 v[174:175], v9 offset:2048
  s_waitcnt vmcnt(0) lgkmcnt(8)
  s_barrier
  v_mfma_f32_16x16x32_bf16 v[128:131], v[208:211], v[232:235], v[128:131]
  ds_read_b64_tr_b16 v[176:177], v6 offset:4096
  v_mfma_f32_16x16x32_bf16 v[132:135], v[208:211], v[236:239], v[132:135]
  ds_read_b64_tr_b16 v[178:179], v6 offset:6144
  v_mfma_f32_16x16x32_bf16 v[140:143], v[212:215], v[236:239], v[140:143]
  ds_read_b64_tr_b16 v[180:181], v7 offset:4096
  v_mfma_f32_16x16x32_bf16 v[136:139], v[212:215], v[232:235], v[136:139]
  ds_read_b64_tr_b16 v[182:183], v7 offset:6144
  v_mfma_f32_16x16x32_bf16 v[144:147], v[216:219], v[232:235], v[144:147]
  ds_read_b64_tr_b16 v[184:185], v8 offset:4096
  v_mfma_f32_16x16x32_bf16 v[148:151], v[216:219], v[236:239], v[148:151]
  ds_read_b64_tr_b16 v[186:187], v8 offset:6144
  v_mfma_f32_16x16x32_bf16 v[156:159], v[220:223], v[236:239], v[156:159]
  ds_read_b64_tr_b16 v[188:189], v9 offset:4096
  v_mfma_f32_16x16x32_bf16 v[152:155], v[220:223], v[232:235], v[152:155]
  ds_read_b64_tr_b16 v[190:191], v9 offset:6144
  s_waitcnt lgkmcnt(8)
  v_mfma_f32_16x16x32_bf16 v[96:99], v[160:163], v[240:243], v[96:99]
  ds_read_b64_tr_b16 v[192:193], v6 offset:8192
  v_mfma_f32_16x16x32_bf16 v[100:103], v[160:163], v[244:247], v[100:103]
  ds_read_b64_tr_b16 v[194:195], v6 offset:10240
  v_mfma_f32_16x16x32_bf16 v[108:111], v[164:167], v[244:247], v[108:111]
  ds_read_b64_tr_b16 v[196:197], v7 offset:8192
  v_cvt_pk_bf16_f32 v128, v128, v129
  v_mfma_f32_16x16x32_bf16 v[104:107], v[164:167], v[240:243], v[104:107]
  ds_read_b64_tr_b16 v[198:199], v7 offset:10240
  v_cvt_pk_bf16_f32 v129, v130, v131
  v_mfma_f32_16x16x32_bf16 v[112:115], v[168:171], v[240:243], v[112:115]
  ds_read_b64_tr_b16 v[200:201], v8 offset:8192
  v_cvt_pk_bf16_f32 v130, v132, v133
  v_mfma_f32_16x16x32_bf16 v[116:119], v[168:171], v[244:247], v[116:119]
  ds_read_b64_tr_b16 v[202:203], v8 offset:10240
  v_cvt_pk_bf16_f32 v131, v134, v135
  v_mfma_f32_16x16x32_bf16 v[124:127], v[172:175], v[244:247], v[124:127]
  ds_read_b64_tr_b16 v[204:205], v9 offset:8192
  buffer_store_dwordx4 v[128:131], off, s[60:63], s4 offset:0 sc1
  v_mfma_f32_16x16x32_bf16 v[120:123], v[172:175], v[240:243], v[120:123]
  ds_read_b64_tr_b16 v[206:207], v9 offset:10240
  s_waitcnt lgkmcnt(8)
  v_mfma_f32_16x16x32_bf16 v[96:99], v[176:179], v[248:251], v[96:99]
  ds_read_b64_tr_b16 v[208:209], v6 offset:12288
  v_cvt_pk_bf16_f32 v132, v136, v137
  v_mfma_f32_16x16x32_bf16 v[100:103], v[176:179], v[252:255], v[100:103]
  ds_read_b64_tr_b16 v[210:211], v6 offset:14336
  v_cvt_pk_bf16_f32 v133, v138, v139
  v_mfma_f32_16x16x32_bf16 v[108:111], v[180:183], v[252:255], v[108:111]
  ds_read_b64_tr_b16 v[212:213], v7 offset:12288
  v_cvt_pk_bf16_f32 v134, v140, v141
  v_mfma_f32_16x16x32_bf16 v[104:107], v[180:183], v[248:251], v[104:107]
  ds_read_b64_tr_b16 v[214:215], v7 offset:14336
  v_cvt_pk_bf16_f32 v135, v142, v143
  v_mfma_f32_16x16x32_bf16 v[112:115], v[184:187], v[248:251], v[112:115]
  ds_read_b64_tr_b16 v[216:217], v8 offset:12288
  buffer_store_dwordx4 v[132:135], off, s[60:63], s4 offset:1024 sc1
  v_mfma_f32_16x16x32_bf16 v[116:119], v[184:187], v[252:255], v[116:119]
  ds_read_b64_tr_b16 v[218:219], v8 offset:14336
  v_readlane_b32 s51, v15, 23
  v_mfma_f32_16x16x32_bf16 v[124:127], v[188:191], v[252:255], v[124:127]
  ds_read_b64_tr_b16 v[220:221], v9 offset:12288
  v_cvt_pk_bf16_f32 v136, v144, v145
  v_mfma_f32_16x16x32_bf16 v[120:123], v[188:191], v[248:251], v[120:123]
  ds_read_b64_tr_b16 v[222:223], v9 offset:14336
  s_waitcnt lgkmcnt(8)
  v_mfma_f32_16x16x32_bf16 v[96:99], v[192:195], v[32:35], v[96:99]
  ds_read_b64_tr_b16 v[160:161], v6 offset:16384
  buffer_load_dwordx4 v[240:243], off, s[36:39], s51 offset:0
  v_mfma_f32_16x16x32_bf16 v[100:103], v[192:195], v[36:39], v[100:103]
  ds_read_b64_tr_b16 v[162:163], v6 offset:18432
  v_cvt_pk_bf16_f32 v137, v146, v147
  v_mfma_f32_16x16x32_bf16 v[108:111], v[196:199], v[36:39], v[108:111]
  ds_read_b64_tr_b16 v[164:165], v7 offset:16384
  v_cvt_pk_bf16_f32 v138, v148, v149
  v_mfma_f32_16x16x32_bf16 v[104:107], v[196:199], v[32:35], v[104:107]
  ds_read_b64_tr_b16 v[166:167], v7 offset:18432
  v_cvt_pk_bf16_f32 v139, v150, v151
  v_mfma_f32_16x16x32_bf16 v[112:115], v[200:203], v[32:35], v[112:115]
  ds_read_b64_tr_b16 v[168:169], v8 offset:16384
  buffer_load_dwordx4 v[244:247], off, s[64:67], s51 offset:0
  v_mfma_f32_16x16x32_bf16 v[116:119], v[200:203], v[36:39], v[116:119]
  ds_read_b64_tr_b16 v[170:171], v8 offset:18432
  buffer_store_dwordx4 v[136:139], off, s[60:63], s4 offset:2048 sc1
  v_mfma_f32_16x16x32_bf16 v[124:127], v[204:207], v[36:39], v[124:127]
  ds_read_b64_tr_b16 v[172:173], v9 offset:16384
  v_cvt_pk_bf16_f32 v140, v152, v153
  v_mfma_f32_16x16x32_bf16 v[120:123], v[204:207], v[32:35], v[120:123]
  ds_read_b64_tr_b16 v[174:175], v9 offset:18432
  s_waitcnt lgkmcnt(8)
  v_mfma_f32_16x16x32_bf16 v[96:99], v[208:211], v[40:43], v[96:99]
  ds_read_b64_tr_b16 v[176:177], v6 offset:20480
  buffer_load_dwordx4 v[248:251], off, s[36:39], s51 offset:1024
  v_mfma_f32_16x16x32_bf16 v[100:103], v[208:211], v[44:47], v[100:103]
  ds_read_b64_tr_b16 v[178:179], v6 offset:22528
  v_cvt_pk_bf16_f32 v141, v154, v155
  v_mfma_f32_16x16x32_bf16 v[108:111], v[212:215], v[44:47], v[108:111]
  ds_read_b64_tr_b16 v[180:181], v7 offset:20480
  v_cvt_pk_bf16_f32 v142, v156, v157
  v_mfma_f32_16x16x32_bf16 v[104:107], v[212:215], v[40:43], v[104:107]
  ds_read_b64_tr_b16 v[182:183], v7 offset:22528
  v_cvt_pk_bf16_f32 v143, v158, v159
  v_mfma_f32_16x16x32_bf16 v[112:115], v[216:219], v[40:43], v[112:115]
  ds_read_b64_tr_b16 v[184:185], v8 offset:20480
  buffer_load_dwordx4 v[252:255], off, s[64:67], s51 offset:1024
  v_mfma_f32_16x16x32_bf16 v[116:119], v[216:219], v[44:47], v[116:119]
  ds_read_b64_tr_b16 v[186:187], v8 offset:22528
  buffer_store_dwordx4 v[140:143], off, s[60:63], s4 offset:3072 sc1
  v_mfma_f32_16x16x32_bf16 v[124:127], v[220:223], v[44:47], v[124:127]
  ds_read_b64_tr_b16 v[188:189], v9 offset:20480
  v_readlane_b32 s48, v15, 24
  v_mfma_f32_16x16x32_bf16 v[120:123], v[220:223], v[40:43], v[120:123]
  ds_read_b64_tr_b16 v[190:191], v9 offset:22528
  s_waitcnt lgkmcnt(8)
  v_mfma_f32_16x16x32_bf16 v[96:99], v[160:163], v[48:51], v[96:99]
  ds_read_b64_tr_b16 v[192:193], v6 offset:24576
  v_mfma_f32_16x16x32_bf16 v[100:103], v[160:163], v[52:55], v[100:103]
  buffer_load_dwordx4 v[32:35], off, s[36:39], s48 offset:0
  v_mfma_f32_16x16x32_bf16 v[108:111], v[164:167], v[52:55], v[108:111]
  ds_read_b64_tr_b16 v[194:195], v6 offset:26624
  ds_read_b64_tr_b16 v[196:197], v7 offset:24576
  v_mfma_f32_16x16x32_bf16 v[104:107], v[164:167], v[48:51], v[104:107]
  ds_read_b64_tr_b16 v[198:199], v7 offset:26624
  v_mfma_f32_16x16x32_bf16 v[112:115], v[168:171], v[48:51], v[112:115]
  ds_read_b64_tr_b16 v[200:201], v8 offset:24576
  v_mfma_f32_16x16x32_bf16 v[116:119], v[168:171], v[52:55], v[116:119]
  buffer_load_dwordx4 v[36:39], off, s[64:67], s48 offset:0
  v_mfma_f32_16x16x32_bf16 v[124:127], v[172:175], v[52:55], v[124:127]
  ds_read_b64_tr_b16 v[202:203], v8 offset:26624
  ds_read_b64_tr_b16 v[204:205], v9 offset:24576
  v_mfma_f32_16x16x32_bf16 v[120:123], v[172:175], v[48:51], v[120:123]
  ds_read_b64_tr_b16 v[206:207], v9 offset:26624
  s_waitcnt lgkmcnt(8)
  v_mfma_f32_16x16x32_bf16 v[96:99], v[176:179], v[56:59], v[96:99]
  ds_read_b64_tr_b16 v[208:209], v6 offset:28672
  v_mfma_f32_16x16x32_bf16 v[100:103], v[176:179], v[60:63], v[100:103]
  buffer_load_dwordx4 v[40:43], off, s[36:39], s48 offset:1024
  v_mfma_f32_16x16x32_bf16 v[108:111], v[180:183], v[60:63], v[108:111]
  ds_read_b64_tr_b16 v[210:211], v6 offset:30720
  ds_read_b64_tr_b16 v[212:213], v7 offset:28672
  v_mfma_f32_16x16x32_bf16 v[104:107], v[180:183], v[56:59], v[104:107]
  ds_read_b64_tr_b16 v[214:215], v7 offset:30720
  v_mfma_f32_16x16x32_bf16 v[112:115], v[184:187], v[56:59], v[112:115]
  ds_read_b64_tr_b16 v[216:217], v8 offset:28672
  v_mfma_f32_16x16x32_bf16 v[116:119], v[184:187], v[60:63], v[116:119]
  buffer_load_dwordx4 v[44:47], off, s[64:67], s48 offset:1024
  v_mfma_f32_16x16x32_bf16 v[124:127], v[188:191], v[60:63], v[124:127]
  ds_read_b64_tr_b16 v[218:219], v8 offset:30720
  ds_read_b64_tr_b16 v[220:221], v9 offset:28672
  v_mfma_f32_16x16x32_bf16 v[120:123], v[188:191], v[56:59], v[120:123]
  ds_read_b64_tr_b16 v[222:223], v9 offset:30720
  s_waitcnt lgkmcnt(8)
  v_mfma_f32_16x16x32_bf16 v[96:99], v[192:195], v[64:67], v[96:99]
  ds_read_b64_tr_b16 v[160:161], v6 offset:32768
  v_readlane_b32 s49, v15, 25
  v_mfma_f32_16x16x32_bf16 v[100:103], v[192:195], v[68:71], v[100:103]
  ds_read_b64_tr_b16 v[162:163], v6 offset:34816
  v_mfma_f32_16x16x32_bf16 v[108:111], v[196:199], v[68:71], v[108:111]
  ds_read_b64_tr_b16 v[164:165], v7 offset:32768
  v_mfma_f32_16x16x32_bf16 v[104:107], v[196:199], v[64:67], v[104:107]
  buffer_load_dwordx4 v[48:51], off, s[36:39], s49 offset:0
  v_mfma_f32_16x16x32_bf16 v[112:115], v[200:203], v[64:67], v[112:115]
  ds_read_b64_tr_b16 v[166:167], v7 offset:34816
  ds_read_b64_tr_b16 v[168:169], v8 offset:32768
  v_mfma_f32_16x16x32_bf16 v[116:119], v[200:203], v[68:71], v[116:119]
  ds_read_b64_tr_b16 v[170:171], v8 offset:34816
  v_mfma_f32_16x16x32_bf16 v[124:127], v[204:207], v[68:71], v[124:127]
  ds_read_b64_tr_b16 v[172:173], v9 offset:32768
  v_mfma_f32_16x16x32_bf16 v[120:123], v[204:207], v[64:67], v[120:123]
  ds_read_b64_tr_b16 v[174:175], v9 offset:34816
  s_waitcnt lgkmcnt(8)
  s_barrier
  v_mfma_f32_16x16x32_bf16 v[96:99], v[208:211], v[72:75], v[96:99]
  buffer_load_dwordx4 v[52:55], off, s[64:67], s49 offset:0
  v_mfma_f32_16x16x32_bf16 v[100:103], v[208:211], v[76:79], v[100:103]
  ds_read_b64_tr_b16 v[176:177], v6 offset:36864
  ds_read_b64_tr_b16 v[178:179], v6 offset:38912
  v_mfma_f32_16x16x32_bf16 v[108:111], v[212:215], v[76:79], v[108:111]
  ds_read_b64_tr_b16 v[180:181], v7 offset:36864
  v_mfma_f32_16x16x32_bf16 v[104:107], v[212:215], v[72:75], v[104:107]
  ds_read_b64_tr_b16 v[182:183], v7 offset:38912
  v_mfma_f32_16x16x32_bf16 v[112:115], v[216:219], v[72:75], v[112:115]
  buffer_load_dwordx4 v[56:59], off, s[36:39], s49 offset:1024
  v_mfma_f32_16x16x32_bf16 v[116:119], v[216:219], v[76:79], v[116:119]
  ds_read_b64_tr_b16 v[184:185], v8 offset:36864
  ds_read_b64_tr_b16 v[186:187], v8 offset:38912
  v_mfma_f32_16x16x32_bf16 v[124:127], v[220:223], v[76:79], v[124:127]
  ds_read_b64_tr_b16 v[188:189], v9 offset:36864
  v_mfma_f32_16x16x32_bf16 v[120:123], v[220:223], v[72:75], v[120:123]
  ds_read_b64_tr_b16 v[190:191], v9 offset:38912
  s_waitcnt lgkmcnt(8)
  v_mfma_f32_16x16x32_bf16 v[96:99], v[160:163], v[80:83], v[96:99]
  ds_read_b64_tr_b16 v[192:193], v6 offset:40960
  buffer_load_dwordx4 v[60:63], off, s[64:67], s49 offset:1024
  v_mfma_f32_16x16x32_bf16 v[100:103], v[160:163], v[84:87], v[100:103]
  ds_read_b64_tr_b16 v[194:195], v6 offset:43008
  s_waitcnt vmcnt(8)
  v_mfma_f32_16x16x32_bf16 v[108:111], v[164:167], v[84:87], v[108:111]
  ds_read_b64_tr_b16 v[196:197], v7 offset:40960
  v_readlane_b32 s50, v15, 26
  v_mfma_f32_16x16x32_bf16 v[104:107], v[164:167], v[80:83], v[104:107]
  buffer_store_dword v19, off, s[52:55], s6 sc1
  v_mfma_f32_16x16x32_bf16 v[112:115], v[168:171], v[80:83], v[112:115]
  ds_read_b64_tr_b16 v[198:199], v7 offset:43008
  ds_read_b64_tr_b16 v[200:201], v8 offset:40960
  v_mfma_f32_16x16x32_bf16 v[116:119], v[168:171], v[84:87], v[116:119]
  buffer_load_dwordx4 v[64:67], off, s[36:39], s50 offset:0
  v_mfma_f32_16x16x32_bf16 v[124:127], v[172:175], v[84:87], v[124:127]
  ds_read_b64_tr_b16 v[202:203], v8 offset:43008
  ds_read_b64_tr_b16 v[204:205], v9 offset:40960
  v_mfma_f32_16x16x32_bf16 v[120:123], v[172:175], v[80:83], v[120:123]
  ds_read_b64_tr_b16 v[206:207], v9 offset:43008
  s_waitcnt lgkmcnt(8)
  v_mfma_f32_16x16x32_bf16 v[96:99], v[176:179], v[88:91], v[96:99]
  ds_read_b64_tr_b16 v[208:209], v6 offset:45056
  v_mfma_f32_16x16x32_bf16 v[100:103], v[176:179], v[92:95], v[100:103]
  buffer_load_dwordx4 v[68:71], off, s[64:67], s50 offset:0
  v_mfma_f32_16x16x32_bf16 v[108:111], v[180:183], v[92:95], v[108:111]
  ds_read_b64_tr_b16 v[210:211], v6 offset:47104
  ds_read_b64_tr_b16 v[212:213], v7 offset:45056
  v_mfma_f32_16x16x32_bf16 v[104:107], v[180:183], v[88:91], v[104:107]
  ds_read_b64_tr_b16 v[214:215], v7 offset:47104
  v_mfma_f32_16x16x32_bf16 v[112:115], v[184:187], v[88:91], v[112:115]
  ds_read_b64_tr_b16 v[216:217], v8 offset:45056
  v_mfma_f32_16x16x32_bf16 v[116:119], v[184:187], v[92:95], v[116:119]
  buffer_load_dwordx4 v[72:75], off, s[36:39], s50 offset:1024
  v_mfma_f32_16x16x32_bf16 v[124:127], v[188:191], v[92:95], v[124:127]
  ds_read_b64_tr_b16 v[218:219], v8 offset:47104
  ds_read_b64_tr_b16 v[220:221], v9 offset:45056
  v_mfma_f32_16x16x32_bf16 v[120:123], v[188:191], v[88:91], v[120:123]
  ds_read_b64_tr_b16 v[222:223], v9 offset:47104
  s_waitcnt lgkmcnt(8)
  v_mfma_f32_16x16x32_bf16 v[96:99], v[192:195], v[224:227], v[96:99]
  ds_read_b64_tr_b16 v[160:161], v6 offset:49152
  v_mfma_f32_16x16x32_bf16 v[100:103], v[192:195], v[228:231], v[100:103]
  buffer_load_dwordx4 v[76:79], off, s[64:67], s50 offset:1024
  v_mfma_f32_16x16x32_bf16 v[108:111], v[196:199], v[228:231], v[108:111]
  ds_read_b64_tr_b16 v[162:163], v6 offset:51200
  ds_read_b64_tr_b16 v[164:165], v7 offset:49152
  v_mfma_f32_16x16x32_bf16 v[104:107], v[196:199], v[224:227], v[104:107]
  ds_read_b64_tr_b16 v[166:167], v7 offset:51200
  v_readlane_b32 s51, v15, 27
  v_mfma_f32_16x16x32_bf16 v[112:115], v[200:203], v[224:227], v[112:115]
  ds_read_b64_tr_b16 v[168:169], v8 offset:49152
  v_mfma_f32_16x16x32_bf16 v[116:119], v[200:203], v[228:231], v[116:119]
  ds_read_b64_tr_b16 v[170:171], v8 offset:51200
  ds_read_b64_tr_b16 v[172:173], v9 offset:49152
  v_mfma_f32_16x16x32_bf16 v[124:127], v[204:207], v[228:231], v[124:127]
  buffer_load_dwordx4 v[80:83], off, s[36:39], s51 offset:0
  v_mfma_f32_16x16x32_bf16 v[120:123], v[204:207], v[224:227], v[120:123]
  ds_read_b64_tr_b16 v[174:175], v9 offset:51200
  s_waitcnt lgkmcnt(8)
  v_mfma_f32_16x16x32_bf16 v[96:99], v[208:211], v[232:235], v[96:99]
  ds_read_b64_tr_b16 v[176:177], v6 offset:53248
  v_mfma_f32_16x16x32_bf16 v[100:103], v[208:211], v[236:239], v[100:103]
  ds_read_b64_tr_b16 v[178:179], v6 offset:55296
  v_mfma_f32_16x16x32_bf16 v[108:111], v[212:215], v[236:239], v[108:111]
  buffer_load_dwordx4 v[84:87], off, s[64:67], s51 offset:0
  v_mfma_f32_16x16x32_bf16 v[104:107], v[212:215], v[232:235], v[104:107]
  ds_read_b64_tr_b16 v[180:181], v7 offset:53248
  ds_read_b64_tr_b16 v[182:183], v7 offset:55296
  v_mfma_f32_16x16x32_bf16 v[112:115], v[216:219], v[232:235], v[112:115]
  ds_read_b64_tr_b16 v[184:185], v8 offset:53248
  v_mfma_f32_16x16x32_bf16 v[116:119], v[216:219], v[236:239], v[116:119]
  ds_read_b64_tr_b16 v[186:187], v8 offset:55296
  ds_read_b64_tr_b16 v[188:189], v9 offset:53248
  v_mfma_f32_16x16x32_bf16 v[124:127], v[220:223], v[236:239], v[124:127]
  buffer_load_dwordx4 v[88:91], off, s[36:39], s51 offset:1024
  v_mfma_f32_16x16x32_bf16 v[120:123], v[220:223], v[232:235], v[120:123]
  ds_read_b64_tr_b16 v[190:191], v9 offset:55296
  s_waitcnt lgkmcnt(8)
  v_mfma_f32_16x16x32_bf16 v[96:99], v[160:163], v[240:243], v[96:99]
  ds_read_b64_tr_b16 v[192:193], v6 offset:57344
  v_mfma_f32_16x16x32_bf16 v[100:103], v[160:163], v[244:247], v[100:103]
  ds_read_b64_tr_b16 v[194:195], v6 offset:59392
  v_mfma_f32_16x16x32_bf16 v[108:111], v[164:167], v[244:247], v[108:111]
  buffer_load_dwordx4 v[92:95], off, s[64:67], s51 offset:1024
  v_mfma_f32_16x16x32_bf16 v[104:107], v[164:167], v[240:243], v[104:107]
  ds_read_b64_tr_b16 v[196:197], v7 offset:57344
  ds_read_b64_tr_b16 v[198:199], v7 offset:59392
  v_mfma_f32_16x16x32_bf16 v[112:115], v[168:171], v[240:243], v[112:115]
  ds_read_b64_tr_b16 v[200:201], v8 offset:57344
  v_readlane_b32 s48, v15, 28
  v_mfma_f32_16x16x32_bf16 v[116:119], v[168:171], v[244:247], v[116:119]
  ds_read_b64_tr_b16 v[202:203], v8 offset:59392
  v_mfma_f32_16x16x32_bf16 v[124:127], v[172:175], v[244:247], v[124:127]
  ds_read_b64_tr_b16 v[204:205], v9 offset:57344
  v_mfma_f32_16x16x32_bf16 v[120:123], v[172:175], v[240:243], v[120:123]
  ds_read_b64_tr_b16 v[206:207], v9 offset:59392
  s_waitcnt lgkmcnt(8)
  v_mfma_f32_16x16x32_bf16 v[96:99], v[176:179], v[248:251], v[96:99]
  buffer_load_dwordx4 v[224:227], off, s[36:39], s48 offset:0
  v_mfma_f32_16x16x32_bf16 v[100:103], v[176:179], v[252:255], v[100:103]
  ds_read_b64_tr_b16 v[208:209], v6 offset:61440
  ds_read_b64_tr_b16 v[210:211], v6 offset:63488
  v_mfma_f32_16x16x32_bf16 v[108:111], v[180:183], v[252:255], v[108:111]
  ds_read_b64_tr_b16 v[212:213], v7 offset:61440
  v_mfma_f32_16x16x32_bf16 v[104:107], v[180:183], v[248:251], v[104:107]
  ds_read_b64_tr_b16 v[214:215], v7 offset:63488
  v_mfma_f32_16x16x32_bf16 v[112:115], v[184:187], v[248:251], v[112:115]
  buffer_load_dwordx4 v[228:231], off, s[64:67], s48 offset:0
  v_mfma_f32_16x16x32_bf16 v[116:119], v[184:187], v[252:255], v[116:119]
  ds_read_b64_tr_b16 v[216:217], v8 offset:61440
  ds_read_b64_tr_b16 v[218:219], v8 offset:63488
  v_mfma_f32_16x16x32_bf16 v[124:127], v[188:191], v[252:255], v[124:127]
  ds_read_b64_tr_b16 v[220:221], v9 offset:61440
  v_mfma_f32_16x16x32_bf16 v[120:123], v[188:191], v[248:251], v[120:123]
  ds_read_b64_tr_b16 v[222:223], v9 offset:63488
  s_waitcnt vmcnt(17) lgkmcnt(8)
  v_mfma_f32_16x16x32_bf16 v[96:99], v[192:195], v[32:35], v[96:99]
  buffer_load_dwordx4 v[232:235], off, s[36:39], s48 offset:1024
  v_mfma_f32_16x16x32_bf16 v[100:103], v[192:195], v[36:39], v[100:103]
  ds_read_b64_tr_b16 v[160:161], v20 offset:0
  ds_read_b64_tr_b16 v[162:163], v20 offset:2048
  v_mfma_f32_16x16x32_bf16 v[108:111], v[196:199], v[36:39], v[108:111]
  ds_read_b64_tr_b16 v[164:165], v21 offset:0
  v_mfma_f32_16x16x32_bf16 v[104:107], v[196:199], v[32:35], v[104:107]
  ds_read_b64_tr_b16 v[166:167], v21 offset:2048
  v_mfma_f32_16x16x32_bf16 v[112:115], v[200:203], v[32:35], v[112:115]
  buffer_load_dwordx4 v[236:239], off, s[64:67], s48 offset:1024
  v_mfma_f32_16x16x32_bf16 v[116:119], v[200:203], v[36:39], v[116:119]
  ds_read_b64_tr_b16 v[168:169], v22 offset:0
  ds_read_b64_tr_b16 v[170:171], v22 offset:2048
  v_mfma_f32_16x16x32_bf16 v[124:127], v[204:207], v[36:39], v[124:127]
  ds_read_b64_tr_b16 v[172:173], v23 offset:0
  v_readlane_b32 s49, v15, 29
  v_mfma_f32_16x16x32_bf16 v[120:123], v[204:207], v[32:35], v[120:123]
  ds_read_b64_tr_b16 v[174:175], v23 offset:2048
  s_waitcnt vmcnt(17) lgkmcnt(8)
  v_mfma_f32_16x16x32_bf16 v[96:99], v[208:211], v[40:43], v[96:99]
  ds_read_b64_tr_b16 v[176:177], v20 offset:4096
  v_mfma_f32_16x16x32_bf16 v[100:103], v[208:211], v[44:47], v[100:103]
  buffer_load_dwordx4 v[240:243], off, s[36:39], s49 offset:0
  v_mfma_f32_16x16x32_bf16 v[108:111], v[212:215], v[44:47], v[108:111]
  ds_read_b64_tr_b16 v[178:179], v20 offset:6144
  ds_read_b64_tr_b16 v[180:181], v21 offset:4096
  v_mfma_f32_16x16x32_bf16 v[104:107], v[212:215], v[40:43], v[104:107]
  ds_read_b64_tr_b16 v[182:183], v21 offset:6144
  v_mfma_f32_16x16x32_bf16 v[112:115], v[216:219], v[40:43], v[112:115]
  ds_read_b64_tr_b16 v[184:185], v22 offset:4096
  v_mfma_f32_16x16x32_bf16 v[116:119], v[216:219], v[44:47], v[116:119]
  buffer_load_dwordx4 v[244:247], off, s[64:67], s49 offset:0
  v_mfma_f32_16x16x32_bf16 v[124:127], v[220:223], v[44:47], v[124:127]
  ds_read_b64_tr_b16 v[186:187], v22 offset:6144
  ds_read_b64_tr_b16 v[188:189], v23 offset:4096
  v_mfma_f32_16x16x32_bf16 v[120:123], v[220:223], v[40:43], v[120:123]
  ds_read_b64_tr_b16 v[190:191], v23 offset:6144
  s_waitcnt vmcnt(17) lgkmcnt(8)
  v_mfma_f32_16x16x32_bf16 v[96:99], v[160:163], v[48:51], v[96:99]
  ds_read_b64_tr_b16 v[192:193], v20 offset:8192
  v_mfma_f32_16x16x32_bf16 v[100:103], v[160:163], v[52:55], v[100:103]
  buffer_load_dwordx4 v[248:251], off, s[36:39], s49 offset:1024
  v_mfma_f32_16x16x32_bf16 v[108:111], v[164:167], v[52:55], v[108:111]
  ds_read_b64_tr_b16 v[194:195], v20 offset:10240
  ds_read_b64_tr_b16 v[196:197], v21 offset:8192
  v_mfma_f32_16x16x32_bf16 v[104:107], v[164:167], v[48:51], v[104:107]
  ds_read_b64_tr_b16 v[198:199], v21 offset:10240
  v_mfma_f32_16x16x32_bf16 v[112:115], v[168:171], v[48:51], v[112:115]
  ds_read_b64_tr_b16 v[200:201], v22 offset:8192
  v_mfma_f32_16x16x32_bf16 v[116:119], v[168:171], v[52:55], v[116:119]
  buffer_load_dwordx4 v[252:255], off, s[64:67], s49 offset:1024
  v_mfma_f32_16x16x32_bf16 v[124:127], v[172:175], v[52:55], v[124:127]
  ds_read_b64_tr_b16 v[202:203], v22 offset:10240
  ds_read_b64_tr_b16 v[204:205], v23 offset:8192
  v_mfma_f32_16x16x32_bf16 v[120:123], v[172:175], v[48:51], v[120:123]
  ds_read_b64_tr_b16 v[206:207], v23 offset:10240
  s_waitcnt vmcnt(17) lgkmcnt(8)
  v_mfma_f32_16x16x32_bf16 v[96:99], v[176:179], v[56:59], v[96:99]
  ds_read_b64_tr_b16 v[208:209], v20 offset:12288
  v_readlane_b32 s50, v15, 30
  v_mfma_f32_16x16x32_bf16 v[100:103], v[176:179], v[60:63], v[100:103]
  ds_read_b64_tr_b16 v[210:211], v20 offset:14336
  v_mfma_f32_16x16x32_bf16 v[108:111], v[180:183], v[60:63], v[108:111]
  ds_read_b64_tr_b16 v[212:213], v21 offset:12288
  v_mfma_f32_16x16x32_bf16 v[104:107], v[180:183], v[56:59], v[104:107]
  buffer_load_dwordx4 v[32:35], off, s[36:39], s50 offset:0
  v_mfma_f32_16x16x32_bf16 v[112:115], v[184:187], v[56:59], v[112:115]
  ds_read_b64_tr_b16 v[214:215], v21 offset:14336
  ds_read_b64_tr_b16 v[216:217], v22 offset:12288
  v_mfma_f32_16x16x32_bf16 v[116:119], v[184:187], v[60:63], v[116:119]
  ds_read_b64_tr_b16 v[218:219], v22 offset:14336
  v_mfma_f32_16x16x32_bf16 v[124:127], v[188:191], v[60:63], v[124:127]
  ds_read_b64_tr_b16 v[220:221], v23 offset:12288
  v_mfma_f32_16x16x32_bf16 v[120:123], v[188:191], v[56:59], v[120:123]
  ds_read_b64_tr_b16 v[222:223], v23 offset:14336
  s_waitcnt vmcnt(15) lgkmcnt(8)
  v_mfma_f32_16x16x32_bf16 v[96:99], v[192:195], v[64:67], v[96:99]
  buffer_load_dwordx4 v[36:39], off, s[64:67], s50 offset:0
  v_mfma_f32_16x16x32_bf16 v[100:103], v[192:195], v[68:71], v[100:103]
  ds_read_b64_tr_b16 v[160:161], v20 offset:16384
  ds_read_b64_tr_b16 v[162:163], v20 offset:18432
  v_mfma_f32_16x16x32_bf16 v[108:111], v[196:199], v[68:71], v[108:111]
  ds_read_b64_tr_b16 v[164:165], v21 offset:16384
  v_mfma_f32_16x16x32_bf16 v[104:107], v[196:199], v[64:67], v[104:107]
  ds_read_b64_tr_b16 v[166:167], v21 offset:18432
  v_mfma_f32_16x16x32_bf16 v[112:115], v[200:203], v[64:67], v[112:115]
  buffer_load_dwordx4 v[40:43], off, s[36:39], s50 offset:1024
  v_mfma_f32_16x16x32_bf16 v[116:119], v[200:203], v[68:71], v[116:119]
  ds_read_b64_tr_b16 v[168:169], v22 offset:16384
  ds_read_b64_tr_b16 v[170:171], v22 offset:18432
  v_mfma_f32_16x16x32_bf16 v[124:127], v[204:207], v[68:71], v[124:127]
  ds_read_b64_tr_b16 v[172:173], v23 offset:16384
  v_mfma_f32_16x16x32_bf16 v[120:123], v[204:207], v[64:67], v[120:123]
  ds_read_b64_tr_b16 v[174:175], v23 offset:18432
  s_waitcnt vmcnt(15) lgkmcnt(8)
  v_mfma_f32_16x16x32_bf16 v[96:99], v[208:211], v[72:75], v[96:99]
  buffer_load_dwordx4 v[44:47], off, s[64:67], s50 offset:1024
  v_mfma_f32_16x16x32_bf16 v[100:103], v[208:211], v[76:79], v[100:103]
  ds_read_b64_tr_b16 v[176:177], v20 offset:20480
  ds_read_b64_tr_b16 v[178:179], v20 offset:22528
  v_mfma_f32_16x16x32_bf16 v[108:111], v[212:215], v[76:79], v[108:111]
  ds_read_b64_tr_b16 v[180:181], v21 offset:20480
  v_readlane_b32 s51, v15, 31
  v_mfma_f32_16x16x32_bf16 v[104:107], v[212:215], v[72:75], v[104:107]
  ds_read_b64_tr_b16 v[182:183], v21 offset:22528
  v_mfma_f32_16x16x32_bf16 v[112:115], v[216:219], v[72:75], v[112:115]
  ds_read_b64_tr_b16 v[184:185], v22 offset:20480
  v_mfma_f32_16x16x32_bf16 v[116:119], v[216:219], v[76:79], v[116:119]
  buffer_load_dwordx4 v[48:51], off, s[36:39], s51 offset:0
  v_mfma_f32_16x16x32_bf16 v[124:127], v[220:223], v[76:79], v[124:127]
  ds_read_b64_tr_b16 v[186:187], v22 offset:22528
  ds_read_b64_tr_b16 v[188:189], v23 offset:20480
  v_mfma_f32_16x16x32_bf16 v[120:123], v[220:223], v[72:75], v[120:123]
  ds_read_b64_tr_b16 v[190:191], v23 offset:22528
  s_waitcnt vmcnt(15) lgkmcnt(8)
  v_mfma_f32_16x16x32_bf16 v[96:99], v[160:163], v[80:83], v[96:99]
  ds_read_b64_tr_b16 v[192:193], v20 offset:24576
  v_mfma_f32_16x16x32_bf16 v[100:103], v[160:163], v[84:87], v[100:103]
  buffer_load_dwordx4 v[52:55], off, s[64:67], s51 offset:0
  v_mfma_f32_16x16x32_bf16 v[108:111], v[164:167], v[84:87], v[108:111]
  ds_read_b64_tr_b16 v[194:195], v20 offset:26624
  ds_read_b64_tr_b16 v[196:197], v21 offset:24576
  v_mfma_f32_16x16x32_bf16 v[104:107], v[164:167], v[80:83], v[104:107]
  ds_read_b64_tr_b16 v[198:199], v21 offset:26624
  v_mfma_f32_16x16x32_bf16 v[112:115], v[168:171], v[80:83], v[112:115]
  ds_read_b64_tr_b16 v[200:201], v22 offset:24576
  v_mfma_f32_16x16x32_bf16 v[116:119], v[168:171], v[84:87], v[116:119]
  buffer_load_dwordx4 v[56:59], off, s[36:39], s51 offset:1024
  v_mfma_f32_16x16x32_bf16 v[124:127], v[172:175], v[84:87], v[124:127]
  ds_read_b64_tr_b16 v[202:203], v22 offset:26624
  ds_read_b64_tr_b16 v[204:205], v23 offset:24576
  v_mfma_f32_16x16x32_bf16 v[120:123], v[172:175], v[80:83], v[120:123]
  ds_read_b64_tr_b16 v[206:207], v23 offset:26624
  s_waitcnt vmcnt(15) lgkmcnt(8)
  s_barrier
  v_mfma_f32_16x16x32_bf16 v[96:99], v[176:179], v[88:91], v[96:99]
  ds_read_b64_tr_b16 v[208:209], v20 offset:28672
  buffer_load_dwordx4 v[144:147], off, s[60:63], s5 offset:0 sc1
  v_mfma_f32_16x16x32_bf16 v[100:103], v[176:179], v[92:95], v[100:103]
  ds_read_b64_tr_b16 v[210:211], v20 offset:30720
  buffer_load_dwordx4 v[60:63], off, s[64:67], s51 offset:1024
  v_mfma_f32_16x16x32_bf16 v[108:111], v[180:183], v[92:95], v[108:111]
  ds_read_b64_tr_b16 v[212:213], v21 offset:28672
  buffer_load_dwordx4 v[148:151], off, s[60:63], s5 offset:1024 sc1
  v_mfma_f32_16x16x32_bf16 v[104:107], v[180:183], v[88:91], v[104:107]
  ds_read_b64_tr_b16 v[214:215], v21 offset:30720
  v_readlane_b32 s48, v15, 32
  v_mfma_f32_16x16x32_bf16 v[112:115], v[184:187], v[88:91], v[112:115]
  buffer_load_dwordx4 v[152:155], off, s[60:63], s5 offset:2048 sc1
  v_mfma_f32_16x16x32_bf16 v[116:119], v[184:187], v[92:95], v[116:119]
  ds_read_b64_tr_b16 v[216:217], v22 offset:28672
  ds_read_b64_tr_b16 v[218:219], v22 offset:30720
  v_mfma_f32_16x16x32_bf16 v[124:127], v[188:191], v[92:95], v[124:127]
  ds_read_b64_tr_b16 v[220:221], v23 offset:28672
  buffer_load_dwordx4 v[64:67], off, s[36:39], s48 offset:0
  v_mfma_f32_16x16x32_bf16 v[120:123], v[188:191], v[88:91], v[120:123]
  ds_read_b64_tr_b16 v[222:223], v23 offset:30720
  s_waitcnt vmcnt(18) lgkmcnt(8)
  v_mfma_f32_16x16x32_bf16 v[96:99], v[192:195], v[224:227], v[96:99]
  buffer_load_dwordx4 v[156:159], off, s[60:63], s5 offset:3072 sc1
  v_mfma_f32_16x16x32_bf16 v[100:103], v[192:195], v[228:231], v[100:103]
  ds_read_b64_tr_b16 v[160:161], v20 offset:32768
  ds_read_b64_tr_b16 v[162:163], v20 offset:34816
  v_mfma_f32_16x16x32_bf16 v[108:111], v[196:199], v[228:231], v[108:111]
  buffer_load_dwordx4 v[68:71], off, s[64:67], s48 offset:0
  v_mfma_f32_16x16x32_bf16 v[104:107], v[196:199], v[224:227], v[104:107]
  ds_read_b64_tr_b16 v[164:165], v21 offset:32768
  ds_read_b64_tr_b16 v[166:167], v21 offset:34816
  v_mfma_f32_16x16x32_bf16 v[112:115], v[200:203], v[224:227], v[112:115]
  ds_read_b64_tr_b16 v[168:169], v22 offset:32768
  v_mfma_f32_16x16x32_bf16 v[116:119], v[200:203], v[228:231], v[116:119]
  ds_read_b64_tr_b16 v[170:171], v22 offset:34816
  ds_read_b64_tr_b16 v[172:173], v23 offset:32768
  v_mfma_f32_16x16x32_bf16 v[124:127], v[204:207], v[228:231], v[124:127]
  buffer_load_dwordx4 v[72:75], off, s[36:39], s48 offset:1024
  v_mfma_f32_16x16x32_bf16 v[120:123], v[204:207], v[224:227], v[120:123]
  ds_read_b64_tr_b16 v[174:175], v23 offset:34816
  s_waitcnt vmcnt(19) lgkmcnt(8)
  v_mfma_f32_16x16x32_bf16 v[96:99], v[208:211], v[232:235], v[96:99]
  ds_read_b64_tr_b16 v[176:177], v20 offset:36864
  v_mfma_f32_16x16x32_bf16 v[100:103], v[208:211], v[236:239], v[100:103]
  ds_read_b64_tr_b16 v[178:179], v20 offset:38912
  v_mfma_f32_16x16x32_bf16 v[108:111], v[212:215], v[236:239], v[108:111]
  buffer_load_dwordx4 v[76:79], off, s[64:67], s48 offset:1024
  v_mfma_f32_16x16x32_bf16 v[104:107], v[212:215], v[232:235], v[104:107]
  ds_read_b64_tr_b16 v[180:181], v21 offset:36864
  ds_read_b64_tr_b16 v[182:183], v21 offset:38912
  v_mfma_f32_16x16x32_bf16 v[112:115], v[216:219], v[232:235], v[112:115]
  ds_read_b64_tr_b16 v[184:185], v22 offset:36864
  v_mfma_f32_16x16x32_bf16 v[116:119], v[216:219], v[236:239], v[116:119]
  ds_read_b64_tr_b16 v[186:187], v22 offset:38912
  v_mfma_f32_16x16x32_bf16 v[124:127], v[220:223], v[236:239], v[124:127]
  ds_read_b64_tr_b16 v[188:189], v23 offset:36864
  v_mfma_f32_16x16x32_bf16 v[120:123], v[220:223], v[232:235], v[120:123]
  ds_read_b64_tr_b16 v[190:191], v23 offset:38912
  s_waitcnt vmcnt(18) lgkmcnt(8)
  v_mfma_f32_16x16x32_bf16 v[96:99], v[160:163], v[240:243], v[96:99]
  ds_read_b64_tr_b16 v[192:193], v20 offset:40960
  v_mfma_f32_16x16x32_bf16 v[100:103], v[160:163], v[244:247], v[100:103]
  ds_read_b64_tr_b16 v[194:195], v20 offset:43008
  v_mfma_f32_16x16x32_bf16 v[108:111], v[164:167], v[244:247], v[108:111]
  ds_read_b64_tr_b16 v[196:197], v21 offset:40960
  v_mfma_f32_16x16x32_bf16 v[104:107], v[164:167], v[240:243], v[104:107]
  ds_read_b64_tr_b16 v[198:199], v21 offset:43008
  v_mfma_f32_16x16x32_bf16 v[112:115], v[168:171], v[240:243], v[112:115]
  ds_read_b64_tr_b16 v[200:201], v22 offset:40960
  v_mfma_f32_16x16x32_bf16 v[116:119], v[168:171], v[244:247], v[116:119]
  ds_read_b64_tr_b16 v[202:203], v22 offset:43008
  v_mfma_f32_16x16x32_bf16 v[124:127], v[172:175], v[244:247], v[124:127]
  ds_read_b64_tr_b16 v[204:205], v23 offset:40960
  v_mfma_f32_16x16x32_bf16 v[120:123], v[172:175], v[240:243], v[120:123]
  ds_read_b64_tr_b16 v[206:207], v23 offset:43008
  s_waitcnt vmcnt(16) lgkmcnt(8)
  v_mfma_f32_16x16x32_bf16 v[96:99], v[176:179], v[248:251], v[96:99]
  ds_read_b64_tr_b16 v[208:209], v20 offset:45056
  v_mfma_f32_16x16x32_bf16 v[100:103], v[176:179], v[252:255], v[100:103]
  ds_read_b64_tr_b16 v[210:211], v20 offset:47104
  v_mfma_f32_16x16x32_bf16 v[108:111], v[180:183], v[252:255], v[108:111]
  ds_read_b64_tr_b16 v[212:213], v21 offset:45056
  v_mfma_f32_16x16x32_bf16 v[104:107], v[180:183], v[248:251], v[104:107]
  ds_read_b64_tr_b16 v[214:215], v21 offset:47104
  v_mfma_f32_16x16x32_bf16 v[112:115], v[184:187], v[248:251], v[112:115]
  ds_read_b64_tr_b16 v[216:217], v22 offset:45056
  v_mfma_f32_16x16x32_bf16 v[116:119], v[184:187], v[252:255], v[116:119]
  ds_read_b64_tr_b16 v[218:219], v22 offset:47104
  v_mfma_f32_16x16x32_bf16 v[124:127], v[188:191], v[252:255], v[124:127]
  ds_read_b64_tr_b16 v[220:221], v23 offset:45056
  v_mfma_f32_16x16x32_bf16 v[120:123], v[188:191], v[248:251], v[120:123]
  ds_read_b64_tr_b16 v[222:223], v23 offset:47104
  s_waitcnt vmcnt(14) lgkmcnt(8)
  v_mfma_f32_16x16x32_bf16 v[96:99], v[192:195], v[32:35], v[96:99]
  ds_read_b64_tr_b16 v[160:161], v20 offset:49152
  v_mfma_f32_16x16x32_bf16 v[100:103], v[192:195], v[36:39], v[100:103]
  ds_read_b64_tr_b16 v[162:163], v20 offset:51200
  v_mfma_f32_16x16x32_bf16 v[108:111], v[196:199], v[36:39], v[108:111]
  ds_read_b64_tr_b16 v[164:165], v21 offset:49152
  v_mfma_f32_16x16x32_bf16 v[104:107], v[196:199], v[32:35], v[104:107]
  ds_read_b64_tr_b16 v[166:167], v21 offset:51200
  v_mfma_f32_16x16x32_bf16 v[112:115], v[200:203], v[32:35], v[112:115]
  ds_read_b64_tr_b16 v[168:169], v22 offset:49152
  v_mfma_f32_16x16x32_bf16 v[116:119], v[200:203], v[36:39], v[116:119]
  ds_read_b64_tr_b16 v[170:171], v22 offset:51200
  v_mfma_f32_16x16x32_bf16 v[124:127], v[204:207], v[36:39], v[124:127]
  ds_read_b64_tr_b16 v[172:173], v23 offset:49152
  v_mfma_f32_16x16x32_bf16 v[120:123], v[204:207], v[32:35], v[120:123]
  ds_read_b64_tr_b16 v[174:175], v23 offset:51200
  s_waitcnt vmcnt(12) lgkmcnt(8)
  v_mfma_f32_16x16x32_bf16 v[96:99], v[208:211], v[40:43], v[96:99]
  ds_read_b64_tr_b16 v[176:177], v20 offset:53248
  v_mfma_f32_16x16x32_bf16 v[100:103], v[208:211], v[44:47], v[100:103]
  ds_read_b64_tr_b16 v[178:179], v20 offset:55296
  v_mfma_f32_16x16x32_bf16 v[108:111], v[212:215], v[44:47], v[108:111]
  ds_read_b64_tr_b16 v[180:181], v21 offset:53248
  v_mfma_f32_16x16x32_bf16 v[104:107], v[212:215], v[40:43], v[104:107]
  ds_read_b64_tr_b16 v[182:183], v21 offset:55296
  v_mfma_f32_16x16x32_bf16 v[112:115], v[216:219], v[40:43], v[112:115]
  ds_read_b64_tr_b16 v[184:185], v22 offset:53248
  v_mfma_f32_16x16x32_bf16 v[116:119], v[216:219], v[44:47], v[116:119]
  ds_read_b64_tr_b16 v[186:187], v22 offset:55296
  v_mfma_f32_16x16x32_bf16 v[124:127], v[220:223], v[44:47], v[124:127]
  ds_read_b64_tr_b16 v[188:189], v23 offset:53248
  v_mfma_f32_16x16x32_bf16 v[120:123], v[220:223], v[40:43], v[120:123]
  ds_read_b64_tr_b16 v[190:191], v23 offset:55296
  s_waitcnt vmcnt(10) lgkmcnt(8)
  v_mfma_f32_16x16x32_bf16 v[96:99], v[160:163], v[48:51], v[96:99]
  ds_read_b64_tr_b16 v[192:193], v20 offset:57344
  s_waitcnt vmcnt(3)
  v_mfma_f32_16x16x32_bf16 v[100:103], v[160:163], v[52:55], v[100:103]
  ds_read_b64_tr_b16 v[194:195], v20 offset:59392
  v_lshlrev_b32 v128, 16, v144
  v_mfma_f32_16x16x32_bf16 v[108:111], v[164:167], v[52:55], v[108:111]
  ds_read_b64_tr_b16 v[196:197], v21 offset:57344
  v_and_b32 v129, s11, v144
  v_mfma_f32_16x16x32_bf16 v[104:107], v[164:167], v[48:51], v[104:107]
  ds_read_b64_tr_b16 v[198:199], v21 offset:59392
  v_lshlrev_b32 v130, 16, v145
  v_mfma_f32_16x16x32_bf16 v[112:115], v[168:171], v[48:51], v[112:115]
  ds_read_b64_tr_b16 v[200:201], v22 offset:57344
  v_and_b32 v131, s11, v145
  v_mfma_f32_16x16x32_bf16 v[116:119], v[168:171], v[52:55], v[116:119]
  ds_read_b64_tr_b16 v[202:203], v22 offset:59392
  v_lshlrev_b32 v132, 16, v146
  v_mfma_f32_16x16x32_bf16 v[124:127], v[172:175], v[52:55], v[124:127]
  ds_read_b64_tr_b16 v[204:205], v23 offset:57344
  v_and_b32 v133, s11, v146
  v_mfma_f32_16x16x32_bf16 v[120:123], v[172:175], v[48:51], v[120:123]
  ds_read_b64_tr_b16 v[206:207], v23 offset:59392
  s_waitcnt lgkmcnt(8)
  v_mfma_f32_16x16x32_bf16 v[96:99], v[176:179], v[56:59], v[96:99]
  ds_read_b64_tr_b16 v[208:209], v20 offset:61440
  v_lshlrev_b32 v134, 16, v147
  v_mfma_f32_16x16x32_bf16 v[100:103], v[176:179], v[60:63], v[100:103]
  ds_read_b64_tr_b16 v[210:211], v20 offset:63488
  v_and_b32 v135, s11, v147
  v_mfma_f32_16x16x32_bf16 v[108:111], v[180:183], v[60:63], v[108:111]
  ds_read_b64_tr_b16 v[212:213], v21 offset:61440
  v_lshlrev_b32 v136, 16, v148
  v_mfma_f32_16x16x32_bf16 v[104:107], v[180:183], v[56:59], v[104:107]
  ds_read_b64_tr_b16 v[214:215], v21 offset:63488
  v_and_b32 v137, s11, v148
  v_mfma_f32_16x16x32_bf16 v[112:115], v[184:187], v[56:59], v[112:115]
  ds_read_b64_tr_b16 v[216:217], v22 offset:61440
  v_lshlrev_b32 v138, 16, v149
  v_mfma_f32_16x16x32_bf16 v[116:119], v[184:187], v[60:63], v[116:119]
  ds_read_b64_tr_b16 v[218:219], v22 offset:63488
  v_and_b32 v139, s11, v149
  v_mfma_f32_16x16x32_bf16 v[124:127], v[188:191], v[60:63], v[124:127]
  ds_read_b64_tr_b16 v[220:221], v23 offset:61440
  v_lshlrev_b32 v140, 16, v150
  v_mfma_f32_16x16x32_bf16 v[120:123], v[188:191], v[56:59], v[120:123]
  ds_read_b64_tr_b16 v[222:223], v23 offset:63488
  s_waitcnt vmcnt(2) lgkmcnt(8)
  v_mfma_f32_16x16x32_bf16 v[96:99], v[192:195], v[64:67], v[96:99]
  v_mov_b32 v20, 0
  v_mov_b32 v21, 0
  v_mfma_f32_16x16x32_bf16 v[100:103], v[192:195], v[68:71], v[100:103]
  v_mov_b32 v22, 0
  v_mov_b32 v23, 0
  v_mfma_f32_16x16x32_bf16 v[108:111], v[196:199], v[68:71], v[108:111]
  v_and_b32 v141, s11, v150
  v_lshlrev_b32 v142, 16, v151
  v_and_b32 v143, s11, v151
  v_mfma_f32_16x16x32_bf16 v[104:107], v[196:199], v[64:67], v[104:107]
  v_lshlrev_b32 v144, 16, v152
  v_and_b32 v145, s11, v152
  v_lshlrev_b32 v146, 16, v153
  v_mfma_f32_16x16x32_bf16 v[112:115], v[200:203], v[64:67], v[112:115]
  v_and_b32 v147, s11, v153
  v_lshlrev_b32 v148, 16, v154
  v_and_b32 v149, s11, v154
  v_mfma_f32_16x16x32_bf16 v[116:119], v[200:203], v[68:71], v[116:119]
  v_lshlrev_b32 v150, 16, v155
  v_and_b32 v151, s11, v155
  v_lshlrev_b32 v152, 16, v156
  v_mfma_f32_16x16x32_bf16 v[124:127], v[204:207], v[68:71], v[124:127]
  v_and_b32 v153, s11, v156
  v_lshlrev_b32 v154, 16, v157
  v_and_b32 v155, s11, v157
  v_mfma_f32_16x16x32_bf16 v[120:123], v[204:207], v[64:67], v[120:123]
  s_waitcnt vmcnt(0) lgkmcnt(0)
  v_lshlrev_b32 v156, 16, v158
  v_and_b32 v157, s11, v158
  v_mfma_f32_16x16x32_bf16 v[96:99], v[208:211], v[72:75], v[96:99]
  v_lshlrev_b32 v158, 16, v159
  v_and_b32 v159, s11, v159
  v_mfma_f32_16x16x32_bf16 v[100:103], v[208:211], v[76:79], v[100:103]
  v_mfma_f32_16x16x32_bf16 v[108:111], v[212:215], v[76:79], v[108:111]
  v_mfma_f32_16x16x32_bf16 v[104:107], v[212:215], v[72:75], v[104:107]
  v_mfma_f32_16x16x32_bf16 v[112:115], v[216:219], v[72:75], v[112:115]
  v_mfma_f32_16x16x32_bf16 v[116:119], v[216:219], v[76:79], v[116:119]
  v_mfma_f32_16x16x32_bf16 v[124:127], v[220:223], v[76:79], v[124:127]
  v_mfma_f32_16x16x32_bf16 v[120:123], v[220:223], v[72:75], v[120:123]
  s_lshl_b32 s3, s7, 4
  s_mov_b32 s10, 0x3f803f80
  s_lshl_b32 s4, s7, 3
  s_add_u32 s5, s3, s4
  v_xor_b32 v6, 32, v4
  v_xor_b32 v7, 64, v4
  v_xor_b32 v8, 96, v4
  v_xor_b32 v9, 64, v12
  v_pk_add_f32 v[96:97], v[96:97], v[128:129]
  v_pk_add_f32 v[98:99], v[98:99], v[130:131]
  v_cvt_pk_bf16_f32 v240, v96, v97
  v_cvt_pk_bf16_f32 v241, v98, v99
  v_pk_add_f32 v[104:105], v[104:105], v[136:137]
  v_pk_add_f32 v[106:107], v[106:107], v[138:139]
  v_cvt_pk_bf16_f32 v242, v104, v105
  v_cvt_pk_bf16_f32 v243, v106, v107
  ds_write_b64 v4, v[240:241] offset:0
  ds_write_b64 v6, v[242:243] offset:0
  v_pk_add_f32 v[112:113], v[112:113], v[144:145]
  v_pk_add_f32 v[114:115], v[114:115], v[146:147]
  v_cvt_pk_bf16_f32 v244, v112, v113
  v_cvt_pk_bf16_f32 v245, v114, v115
  v_pk_add_f32 v[120:121], v[120:121], v[152:153]
  v_pk_add_f32 v[122:123], v[122:123], v[154:155]
  v_cvt_pk_bf16_f32 v246, v120, v121
  v_cvt_pk_bf16_f32 v247, v122, v123
  ds_write_b64 v7, v[244:245] offset:0
  ds_write_b64 v8, v[246:247] offset:0
  ds_read_b128 v[32:35], v5 offset:0
  ds_read_b128 v[36:39], v5 offset:1024
  v_pk_add_f32 v[100:101], v[100:101], v[132:133]
  v_pk_add_f32 v[102:103], v[102:103], v[134:135]
  v_cvt_pk_bf16_f32 v248, v100, v101
  v_cvt_pk_bf16_f32 v249, v102, v103
  v_pk_add_f32 v[108:109], v[108:109], v[140:141]
  v_pk_add_f32 v[110:111], v[110:111], v[142:143]
  v_cvt_pk_bf16_f32 v250, v108, v109
  v_cvt_pk_bf16_f32 v251, v110, v111
  ds_write_b64 v4, v[248:249] offset:2048
  ds_write_b64 v6, v[250:251] offset:2048
  v_pk_add_f32 v[116:117], v[116:117], v[148:149]
  v_pk_add_f32 v[118:119], v[118:119], v[150:151]
  v_cvt_pk_bf16_f32 v252, v116, v117
  v_cvt_pk_bf16_f32 v253, v118, v119
  v_pk_add_f32 v[124:125], v[124:125], v[156:157]
  v_pk_add_f32 v[126:127], v[126:127], v[158:159]
  v_cvt_pk_bf16_f32 v254, v124, v125
  v_cvt_pk_bf16_f32 v255, v126, v127
  ds_write_b64 v7, v[252:253] offset:2048
  ds_write_b64 v8, v[254:255] offset:2048
  ds_read_b128 v[40:43], v5 offset:2048
  ds_read_b128 v[44:47], v5 offset:3072
  s_waitcnt lgkmcnt(7)
  buffer_store_dwordx4 v[32:35], v12, s[44:47], 0 offen sc1
  s_waitcnt lgkmcnt(6)
  buffer_store_dwordx4 v[36:39], v9, s[44:47], s4 offen sc1
  s_waitcnt lgkmcnt(1)
  buffer_store_dwordx4 v[40:43], v12, s[44:47], s3 offen sc1
  s_waitcnt lgkmcnt(0)
  buffer_store_dwordx4 v[44:47], v9, s[44:47], s5 offen sc1
  s_cmp_eq_u32 s96, 1
  s_cbranch_scc1 L_w2_end
  v_dot2_f32_bf16 v20, v240, s10, v20
  v_dot2_f32_bf16 v22, v240, v240, v22
  v_dot2_f32_bf16 v20, v241, s10, v20
  v_dot2_f32_bf16 v22, v241, v241, v22
  v_dot2_f32_bf16 v20, v242, s10, v20
  v_dot2_f32_bf16 v22, v242, v242, v22
  v_dot2_f32_bf16 v20, v243, s10, v20
  v_dot2_f32_bf16 v22, v243, v243, v22
  v_dot2_f32_bf16 v20, v244, s10, v20
  v_dot2_f32_bf16 v22, v244, v244, v22
  v_dot2_f32_bf16 v20, v245, s10, v20
  v_dot2_f32_bf16 v22, v245, v245, v22
  v_dot2_f32_bf16 v20, v246, s10, v20
  v_dot2_f32_bf16 v22, v246, v246, v22
  v_dot2_f32_bf16 v20, v247, s10, v20
  v_dot2_f32_bf16 v22, v247, v247, v22
  v_dot2_f32_bf16 v21, v248, s10, v21
  v_dot2_f32_bf16 v23, v248, v248, v23
  v_dot2_f32_bf16 v21, v249, s10, v21
  v_dot2_f32_bf16 v23, v249, v249, v23
  v_dot2_f32_bf16 v21, v250, s10, v21
  v_dot2_f32_bf16 v23, v250, v250, v23
  v_dot2_f32_bf16 v21, v251, s10, v21
  v_dot2_f32_bf16 v23, v251, v251, v23
  v_dot2_f32_bf16 v21, v252, s10, v21
  v_dot2_f32_bf16 v23, v252, v252, v23
  v_dot2_f32_bf16 v21, v253, s10, v21
  v_dot2_f32_bf16 v23, v253, v253, v23
  v_dot2_f32_bf16 v21, v254, s10, v21
  v_dot2_f32_bf16 v23, v254, v254, v23
  v_dot2_f32_bf16 v21, v255, s10, v21
  v_dot2_f32_bf16 v23, v255, v255, v23
  s_nop 2
  v_permlane32_swap_b32 v20, v21
  v_permlane32_swap_b32 v22, v23
  v_add_f32 v20, v20, v21
  v_add_f32 v22, v22, v23
  s_nop 1
  v_permlane16_swap_b32 v20, v22
  v_add_f32 v20, v20, v22
  buffer_store_dword v20, v18, s[56:59], 0 offen sc1
  s_waitcnt vmcnt(0) lgkmcnt(0)
  s_barrier
  s_mov_b32 s96, 1
  s_add_u32 s12, s22, 33554432
  s_addc_u32 s13, s23, 0
  s_add_u32 s34, s22, 67108864
  s_addc_u32 s35, s23, 0
  s_add_u32 s97, s97, 1
  s_branch L_attn_body
L_w2_c1:
```

```asm
; @launch grid=(256,1,1) block=(512,1,1) lds=163840
.amdgcn_target "amdgcn-amd-amdhsa--gfx950"
.text
.globl interleave_layers__sliding_local_dilated__dense_activation_gelu__prompt_kernel
.p2align 12
.fill 832, 4, 0xbf800000
.type interleave_layers__sliding_local_dilated__dense_activation_gelu__prompt_kernel,@function
interleave_layers__sliding_local_dilated__dense_activation_gelu__prompt_kernel:
L_attn_c0:
  s_load_dwordx4 s[16:19], s[0:1], 0
  s_load_dwordx2 s[20:21], s[0:1], 16
  s_load_dwordx2 s[22:23], s[0:1], 80
  s_load_dwordx8 s[24:31], s[0:1], 32
  s_load_dwordx2 s[32:33], s[0:1], 64
  s_load_dwordx2 s[34:35], s[0:1], 80
  s_load_dwordx2 s[12:13], s[0:1], 0
  s_load_dwordx2 s[64:65], s[0:1], 72
  s_mov_b32 s96, 0
  s_mov_b32 s97, 0
L_attn_body:
  s_cmp_ge_u32 s2, 256
  s_cbranch_scc1 L_attn_end
  v_lshrrev_b32 v2, 6, v0
  v_and_b32 v1, 63, v0
  v_readfirstlane_b32 s70, v2
  s_and_b32 s3, s2, 7
  s_lshr_b32 s99, s2, 3
  s_and_b32 s5, s3, 1
  s_lshl_b32 s5, s5, 3
  s_and_b32 s6, s99, 7
  s_add_u32 s68, s5, s6
  s_lshr_b32 s5, s3, 1
  s_lshl_b32 s5, s5, 2
  s_lshr_b32 s6, s99, 3
  s_add_u32 s69, s5, s6
  s_cmp_eq_u32 s96, 0
  s_cbranch_scc1 L_attn_map
  s_and_b32 s3, s2, 7
  s_and_b32 s5, s3, 3
  s_lshl_b32 s5, s5, 2
  s_and_b32 s6, s99, 3
  s_add_u32 s68, s5, s6
  s_lshr_b32 s5, s3, 2
  s_lshl_b32 s5, s5, 3
  s_lshr_b32 s6, s99, 2
  s_add_u32 s69, s5, s6
L_attn_map:
  s_cmp_lt_u32 s70, 4
  s_cbranch_scc1 L_attn_compute
L_attn_loader:
  s_add_u32 s8, s70, s69
  s_and_b32 s8, s8, 3
  s_add_u32 s9, s70, s68
  s_and_b32 s9, s9, 3
  s_lshl_b32 s76, s8, 12
  s_lshl_b32 s77, s9, 11
  s_add_u32 s77, s77, 16384
  s_lshl_b32 s11, s68, 7
  v_and_b32 v10, 7, v1
  v_lshrrev_b32 v3, 3, v1
  s_lshr_b32 s10, s76, 7
  s_lshl_b32 s3, s68, 7
  s_add_u32 s10, s10, s3
  v_add_u32 v3, s10, v3
  s_cmp_eq_u32 s96, 1
  s_cselect_b32 s5, 128, 0
  s_add_u32 s5, s5, 2048
  s_lshl_b32 s6, s5, 3
  v_mul_u32_u24 v3, s5, v3
  v_lshrrev_b32 v2, 4, v1
  v_xor_b32 v4, v2, v10
  v_lshl_add_u32 v4, v4, 4, v3
  v_add_u32 v3, s6, v3
  v_add_u32 v5, 4, v2
  v_xor_b32 v5, v5, v10
  v_lshl_add_u32 v5, v5, 4, v3
  v_add_u32 v3, s6, v3
  v_xor_b32 v6, v2, v10
  v_lshl_add_u32 v6, v6, 4, v3
  v_add_u32 v3, s6, v3
  v_add_u32 v7, 4, v2
  v_xor_b32 v7, v7, v10
  v_lshl_add_u32 v7, v7, 4, v3
  v_lshrrev_b32 v3, 3, v1
  s_lshl_b32 s10, s9, 4
  v_add_u32 v3, s10, v3
  v_mul_u32_u24 v3, 6144, v3
  v_lshrrev_b32 v2, 3, v1
  v_and_b32 v2, 2, v2
  v_xor_b32 v2, v2, v10
  s_mul_i32 s10, s69, 128
  v_add_u32 v3, s10, v3
  v_lshl_add_u32 v8, v2, 4, v3
  v_xor_b32 v2, 4, v2
  v_add_u32 v3, 49152, v3
  v_lshl_add_u32 v9, v2, 4, v3
  s_and_b32 s10, s70, 3
  s_lshl_b32 s78, s10, 9
  s_add_u32 s78, s78, 40960
  s_lshl_b32 s14, s10, 2
  s_add_u32 s14, s14, s11
  s_sub_u32 s14, s14, 16
  v_lshrrev_b32 v3, 3, v1
  v_add_u32 v3, s14, v3
  v_max_i32 v3, 0, v3
  v_mul_u32_u24 v3, s5, v3
  s_lshl_b32 s14, s10, 1
  v_lshrrev_b32 v2, 4, v1
  v_add_u32 v2, s14, v2
  v_and_b32 v2, 7, v2
  v_xor_b32 v2, v2, v10
  v_lshl_add_u32 v28, v2, 4, v3
  s_cmp_eq_u32 s10, 0
  s_cselect_b32 s14, 0xffffff00, -1
  s_mov_b32 s15, 0
  s_mov_b32 s75, 0
  s_add_u32 s100, s68, s69
  s_mov_b32 s101, -1
  s_add_u32 s3, s68, s69
  s_and_b32 s3, s3, 3
  s_mov_b32 s100, 0x75463102
  s_mov_b32 s101, 0xfdceb98a
  s_cmp_eq_u32 s3, 1
  s_cselect_b32 s100, 0x65742130, s100
  s_cselect_b32 s101, 0xedfca9b8, s101
  s_cmp_eq_u32 s3, 2
  s_cselect_b32 s100, 0x68532410, s100
  s_cselect_b32 s101, 0xfedbac97, s101
  s_cmp_eq_u32 s3, 3
  s_cselect_b32 s100, 0x96435210, s100
  s_cselect_b32 s101, 0xfecbda87, s101
  s_mov_b32 s91, s69
  s_and_b32 s92, s69, 3
  s_add_u32 s92, s92, 1
  s_and_b32 s73, s100, 15
  s_cmp_eq_u32 s73, s91
  s_cselect_b32 s74, 4, 0
  s_lshr_b64 s[100:101], s[100:101], s74
  s_and_b32 s73, s100, 15
  s_sub_u32 s92, s92, 1
  s_cselect_b32 s73, s91, s73
  s_cselect_b32 s74, 0, 4
  s_lshr_b64 s[100:101], s[100:101], s74
  s_mul_i32 s74, s73, 393216
  s_lshl_b32 s73, s73, 7
  s_waitcnt lgkmcnt(0)
  s_mov_b32 s36, s12
  s_and_b32 s37, s13, 0xffff
  s_mov_b32 s38, 4194304
  s_mov_b32 s39, 0x00020000
  s_cmp_eq_u32 s96, 1
  s_cselect_b32 s38, 128, 0
  s_add_u32 s38, s38, 2048
  s_lshl_b32 s38, s38, 11
  s_mov_b32 s40, s18
  s_and_b32 s41, s19, 0xffff
  s_mov_b32 s42, 6291456
  s_mov_b32 s43, 0x00020000
  s_cmp_lg_u32 s96, 0
  s_cbranch_scc1 L_attn_ld1
  s_mov_b32 s48, s28
  s_and_b32 s49, s29, 0xffff
  s_mov_b32 s50, 7340032
  s_mov_b32 s51, 0x00020000
  s_cmp_eq_u32 s96, 0
  s_cselect_b32 s50, s50, 0
  s_and_b32 s3, s70, 3
  s_lshl_b32 s4, s2, 2
  s_add_u32 s3, s3, s4
  s_mul_i32 s98, s3, 3584
  s_add_u32 s98, s98, 0
  s_add_u32 s3, s75, s76
  s_add_u32 m0, s3, 0
  s_nop 0
  buffer_load_dwordx4 v4, s[36:39], s73 offen lds
  s_add_u32 m0, s3, 1024
  s_nop 0
  buffer_load_dwordx4 v5, s[36:39], s73 offen lds
  s_add_u32 m0, s3, 2048
  s_nop 0
  buffer_load_dwordx4 v6, s[36:39], s73 offen lds
  s_add_u32 m0, s3, 3072
  s_nop 0
  buffer_load_dwordx4 v7, s[36:39], s73 offen lds
  s_add_u32 m0, s78, s75
  s_mov_b64 exec, s[14:15]
  buffer_load_dwordx4 v28, s[36:39], s73 offen lds
  s_mov_b64 exec, -1
  s_add_u32 s3, s75, s77
  s_add_u32 m0, s3, 0
  s_add_u32 s4, s74, 0
  buffer_load_dwordx4 v8, s[40:43], s4 offen lds
  s_add_u32 m0, s3, 1024
  s_nop 0
  buffer_load_dwordx4 v9, s[40:43], s4 offen lds
  s_add_u32 m0, s3, 8192
  s_add_u32 s4, s74, 2048
  buffer_load_dwordx4 v8, s[40:43], s4 offen lds
  s_add_u32 m0, s3, 9216
  s_nop 0
  buffer_load_dwordx4 v9, s[40:43], s4 offen lds
  s_add_u32 m0, s3, 16384
  s_add_u32 s4, s74, 4096
  buffer_load_dwordx4 v8, s[40:43], s4 offen lds
  s_add_u32 m0, s3, 17408
  s_nop 0
  buffer_load_dwordx4 v9, s[40:43], s4 offen lds
  s_and_b32 s73, s100, 15
  s_cmp_eq_u32 s73, s91
  s_cselect_b32 s74, 4, 0
  s_lshr_b64 s[100:101], s[100:101], s74
  s_and_b32 s73, s100, 15
  s_sub_u32 s92, s92, 1
  s_cselect_b32 s73, s91, s73
  s_cselect_b32 s74, 0, 4
  s_lshr_b64 s[100:101], s[100:101], s74
  s_mul_i32 s74, s73, 393216
  s_lshl_b32 s73, s73, 7
  s_add_u32 s75, s75, 43008
  s_cmp_eq_u32 s75, 129024
  s_cselect_b32 s75, 0, s75
  s_add_u32 s3, s75, s76
  s_add_u32 m0, s3, 0
  s_nop 0
  buffer_load_dwordx4 v4, s[36:39], s73 offen lds
  s_add_u32 m0, s3, 1024
  s_nop 0
  buffer_load_dwordx4 v5, s[36:39], s73 offen lds
  s_add_u32 m0, s3, 2048
  s_nop 0
  buffer_load_dwordx4 v6, s[36:39], s73 offen lds
  s_add_u32 m0, s3, 3072
  s_nop 0
  buffer_load_dwordx4 v7, s[36:39], s73 offen lds
  s_add_u32 m0, s78, s75
  s_mov_b64 exec, s[14:15]
  buffer_load_dwordx4 v28, s[36:39], s73 offen lds
  s_mov_b64 exec, -1
  s_add_u32 s3, s75, s77
  s_add_u32 m0, s3, 0
  s_add_u32 s4, s74, 0
  buffer_load_dwordx4 v8, s[40:43], s4 offen lds
  s_add_u32 m0, s3, 1024
  s_nop 0
  buffer_load_dwordx4 v9, s[40:43], s4 offen lds
  s_add_u32 m0, s3, 8192
  s_add_u32 s4, s74, 2048
  buffer_load_dwordx4 v8, s[40:43], s4 offen lds
  s_add_u32 m0, s3, 9216
  s_nop 0
  buffer_load_dwordx4 v9, s[40:43], s4 offen lds
  s_add_u32 m0, s3, 16384
  s_add_u32 s4, s74, 4096
  buffer_load_dwordx4 v8, s[40:43], s4 offen lds
  s_add_u32 m0, s3, 17408
  s_nop 0
  buffer_load_dwordx4 v9, s[40:43], s4 offen lds
  s_and_b32 s73, s100, 15
  s_cmp_eq_u32 s73, s91
  s_cselect_b32 s74, 4, 0
  s_lshr_b64 s[100:101], s[100:101], s74
  s_and_b32 s73, s100, 15
  s_sub_u32 s92, s92, 1
  s_cselect_b32 s73, s91, s73
  s_cselect_b32 s74, 0, 4
  s_lshr_b64 s[100:101], s[100:101], s74
  s_mul_i32 s74, s73, 393216
  s_lshl_b32 s73, s73, 7
  s_add_u32 s75, s75, 43008
  s_cmp_eq_u32 s75, 129024
  s_cselect_b32 s75, 0, s75
  s_mov_b32 s52, s24
  s_and_b32 s53, s25, 0xffff
  s_mov_b32 s54, 7340032
  s_mov_b32 s55, 0x00020000
  s_min_u32 s3, s2, 223
  s_mul_i32 s4, s3, 4682
  s_lshr_b32 s4, s4, 16
  s_mul_i32 s5, s4, 14
  s_sub_u32 s3, s3, s5
  s_lshl_b32 s3, s3, 2
  s_and_b32 s5, s70, 3
  s_add_u32 s3, s3, s5
  s_mul_i32 s5, s4, 458752
  s_lshl_b32 s8, s3, 7
  s_add_u32 s95, s5, s8
  s_lshl_b32 s9, s4, 14
  s_lshl_b32 s8, s3, 8
  s_add_u32 s94, s9, s8
  v_lshrrev_b32 v2, 3, v1
  v_mul_u32_u24 v2, 7168, v2
  v_and_b32 v3, 7, v1
  v_lshl_add_u32 v26, v3, 4, v2
  s_and_b32 s3, s70, 3
  s_lshl_b32 s4, s2, 2
  s_add_u32 s3, s3, s4
  s_sub_u32 s4, 384, s40
  s_and_b32 s4, s4, 0x380
  s_mul_i32 s5, s3, 6144
  s_add_u32 s5, s5, s4
  s_buffer_load_dword s84, s[40:43], s5 offset:0
  s_buffer_load_dword s84, s[40:43], s5 offset:64
  s_buffer_load_dword s84, s[40:43], s5 offset:1024
  s_buffer_load_dword s84, s[40:43], s5 offset:1088
  s_buffer_load_dword s84, s[40:43], s5 offset:2048
  s_buffer_load_dword s84, s[40:43], s5 offset:2112
  s_buffer_load_dword s84, s[40:43], s5 offset:3072
  s_buffer_load_dword s84, s[40:43], s5 offset:3136
  s_buffer_load_dword s84, s[40:43], s5 offset:4096
  s_buffer_load_dword s84, s[40:43], s5 offset:4160
  s_buffer_load_dword s84, s[40:43], s5 offset:5120
  s_buffer_load_dword s84, s[40:43], s5 offset:5184
  s_add_u32 s56, s22, 24903680
  s_addc_u32 s57, s23, 0
  s_and_b32 s57, s57, 0xffff
  s_mov_b32 s58, 262144
  s_mov_b32 s59, 0x00020000
  s_and_b32 s3, s70, 3
  s_lshl2_add_u32 s4, s68, s3
  s_lshl_b32 s4, s4, 8
  v_lshrrev_b32 v2, 4, v1
  v_and_b32 v3, 15, v1
  v_lshl_add_u32 v3, v3, 4, s4
  v_lshl_add_u32 v18, v2, 14, v3
  s_lshl_b32 s4, s68, 5
  s_add_u32 s4, s4, s3
  s_sub_u32 s4, s4, 4
  s_max_i32 s4, s4, 0
  s_lshl_b32 s4, s4, 5
  v_lshrrev_b32 v2, 2, v1
  v_and_b32 v3, 3, v1
  v_lshl_add_u32 v3, v3, 3, s4
  v_lshl_add_u32 v19, v2, 14, v3
  s_lshl_b32 s3, s68, 2
  s_sub_u32 s3, s3, 4
  v_and_b32 v20, 7, v1
  v_add_u32 v20, s3, v20
  v_max_i32 v20, 0, v20
  v_lshlrev_b32 v20, 2, v20
  s_and_b32 s65, s65, 0xffff
  s_mov_b32 s66, 256
  s_mov_b32 s67, 0x00020000
  s_waitcnt vmcnt(11)
  s_barrier
  s_add_u32 s3, s75, s76
  s_add_u32 m0, s3, 0
  s_nop 0
  buffer_load_dwordx4 v4, s[36:39], s73 offen lds
  s_add_u32 m0, s3, 1024
  s_nop 0
  buffer_load_dwordx4 v5, s[36:39], s73 offen lds
  s_add_u32 m0, s3, 2048
  s_nop 0
  buffer_load_dwordx4 v6, s[36:39], s73 offen lds
  s_add_u32 m0, s3, 3072
  s_nop 0
  buffer_load_dwordx4 v7, s[36:39], s73 offen lds
  s_add_u32 m0, s78, s75
  s_mov_b64 exec, s[14:15]
  buffer_load_dwordx4 v28, s[36:39], s73 offen lds
  s_mov_b64 exec, -1
  s_add_u32 s3, s75, s77
  s_add_u32 m0, s3, 0
  s_add_u32 s4, s74, 0
  buffer_load_dwordx4 v8, s[40:43], s4 offen lds
  s_add_u32 m0, s3, 1024
  s_nop 0
  buffer_load_dwordx4 v9, s[40:43], s4 offen lds
  s_add_u32 m0, s3, 8192
  s_add_u32 s4, s74, 2048
  buffer_load_dwordx4 v8, s[40:43], s4 offen lds
  s_add_u32 m0, s3, 9216
  s_nop 0
  buffer_load_dwordx4 v9, s[40:43], s4 offen lds
  s_add_u32 m0, s3, 16384
  s_add_u32 s4, s74, 4096
  buffer_load_dwordx4 v8, s[40:43], s4 offen lds
  s_add_u32 m0, s3, 17408
  s_nop 0
  buffer_load_dwordx4 v9, s[40:43], s4 offen lds
  s_and_b32 s73, s100, 15
  s_cmp_eq_u32 s73, s91
  s_cselect_b32 s74, 4, 0
  s_lshr_b64 s[100:101], s[100:101], s74
  s_and_b32 s73, s100, 15
  s_sub_u32 s92, s92, 1
  s_cselect_b32 s73, s91, s73
  s_cselect_b32 s74, 0, 4
  s_lshr_b64 s[100:101], s[100:101], s74
  s_mul_i32 s74, s73, 393216
  s_lshl_b32 s73, s73, 7
  s_add_u32 s75, s75, 43008
  s_cmp_eq_u32 s75, 129024
  s_cselect_b32 s75, 0, s75
  s_buffer_load_dword s84, s[48:51], s98 offset:0
  s_buffer_load_dword s84, s[48:51], s98 offset:64
  s_buffer_load_dword s84, s[48:51], s98 offset:128
  s_buffer_load_dword s84, s[48:51], s98 offset:192
  s_add_u32 s98, s98, 256
  buffer_load_dwordx4 v[64:67], v26, s[52:55], s95 offen
  s_add_u32 s95, s95, 57344
  buffer_load_dwordx4 v[68:71], v26, s[52:55], s95 offen
  s_add_u32 s95, s95, 57344
  s_waitcnt vmcnt(13)
  s_barrier
  s_add_u32 s3, s75, s76
  s_add_u32 m0, s3, 0
  s_nop 0
  buffer_load_dwordx4 v4, s[36:39], s73 offen lds
  s_add_u32 m0, s3, 1024
  s_nop 0
  buffer_load_dwordx4 v5, s[36:39], s73 offen lds
  s_add_u32 m0, s3, 2048
  s_nop 0
  buffer_load_dwordx4 v6, s[36:39], s73 offen lds
  s_add_u32 m0, s3, 3072
  s_nop 0
  buffer_load_dwordx4 v7, s[36:39], s73 offen lds
  s_add_u32 m0, s78, s75
  s_mov_b64 exec, s[14:15]
  buffer_load_dwordx4 v28, s[36:39], s73 offen lds
  s_mov_b64 exec, -1
  s_add_u32 s3, s75, s77
  s_add_u32 m0, s3, 0
  s_add_u32 s4, s74, 0
  buffer_load_dwordx4 v8, s[40:43], s4 offen lds
  s_add_u32 m0, s3, 1024
  s_nop 0
  buffer_load_dwordx4 v9, s[40:43], s4 offen lds
  s_add_u32 m0, s3, 8192
  s_add_u32 s4, s74, 2048
  buffer_load_dwordx4 v8, s[40:43], s4 offen lds
  s_add_u32 m0, s3, 9216
  s_nop 0
  buffer_load_dwordx4 v9, s[40:43], s4 offen lds
  s_add_u32 m0, s3, 16384
  s_add_u32 s4, s74, 4096
  buffer_load_dwordx4 v8, s[40:43], s4 offen lds
  s_add_u32 m0, s3, 17408
  s_nop 0
  buffer_load_dwordx4 v9, s[40:43], s4 offen lds
  s_and_b32 s73, s100, 15
  s_cmp_eq_u32 s73, s91
  s_cselect_b32 s74, 4, 0
  s_lshr_b64 s[100:101], s[100:101], s74
  s_and_b32 s73, s100, 15
  s_sub_u32 s92, s92, 1
  s_cselect_b32 s73, s91, s73
  s_cselect_b32 s74, 0, 4
  s_lshr_b64 s[100:101], s[100:101], s74
  s_mul_i32 s74, s73, 393216
  s_lshl_b32 s73, s73, 7
  s_add_u32 s75, s75, 43008
  s_cmp_eq_u32 s75, 129024
  s_cselect_b32 s75, 0, s75
  s_buffer_load_dword s84, s[48:51], s98 offset:0
  s_buffer_load_dword s84, s[48:51], s98 offset:64
  s_buffer_load_dword s84, s[48:51], s98 offset:128
  s_buffer_load_dword s84, s[48:51], s98 offset:192
  s_add_u32 s98, s98, 256
  buffer_load_dwordx4 v[72:75], v26, s[52:55], s95 offen
  s_add_u32 s95, s95, 57344
  buffer_load_dwordx4 v[76:79], v26, s[52:55], s95 offen
  s_add_u32 s95, s95, 57344
  s_waitcnt vmcnt(15)
  s_barrier
  s_add_u32 s3, s75, s76
  s_add_u32 m0, s3, 0
  s_nop 0
  buffer_load_dwordx4 v4, s[36:39], s73 offen lds
  s_add_u32 m0, s3, 1024
  s_nop 0
  buffer_load_dwordx4 v5, s[36:39], s73 offen lds
  s_add_u32 m0, s3, 2048
  s_nop 0
  buffer_load_dwordx4 v6, s[36:39], s73 offen lds
  s_add_u32 m0, s3, 3072
  s_nop 0
  buffer_load_dwordx4 v7, s[36:39], s73 offen lds
  s_add_u32 m0, s78, s75
  s_mov_b64 exec, s[14:15]
  buffer_load_dwordx4 v28, s[36:39], s73 offen lds
  s_mov_b64 exec, -1
  s_add_u32 s3, s75, s77
  s_add_u32 m0, s3, 0
  s_add_u32 s4, s74, 0
  buffer_load_dwordx4 v8, s[40:43], s4 offen lds
  s_add_u32 m0, s3, 1024
  s_nop 0
  buffer_load_dwordx4 v9, s[40:43], s4 offen lds
  s_add_u32 m0, s3, 8192
  s_add_u32 s4, s74, 2048
  buffer_load_dwordx4 v8, s[40:43], s4 offen lds
  s_add_u32 m0, s3, 9216
  s_nop 0
  buffer_load_dwordx4 v9, s[40:43], s4 offen lds
  s_add_u32 m0, s3, 16384
  s_add_u32 s4, s74, 4096
  buffer_load_dwordx4 v8, s[40:43], s4 offen lds
  s_add_u32 m0, s3, 17408
  s_nop 0
  buffer_load_dwordx4 v9, s[40:43], s4 offen lds
  s_and_b32 s73, s100, 15
  s_cmp_eq_u32 s73, s91
  s_cselect_b32 s74, 4, 0
  s_lshr_b64 s[100:101], s[100:101], s74
  s_and_b32 s73, s100, 15
  s_sub_u32 s92, s92, 1
  s_cselect_b32 s73, s91, s73
  s_cselect_b32 s74, 0, 4
  s_lshr_b64 s[100:101], s[100:101], s74
  s_mul_i32 s74, s73, 393216
  s_lshl_b32 s73, s73, 7
  s_add_u32 s75, s75, 43008
  s_cmp_eq_u32 s75, 129024
  s_cselect_b32 s75, 0, s75
  s_buffer_load_dword s84, s[48:51], s98 offset:0
  s_buffer_load_dword s84, s[48:51], s98 offset:64
  s_buffer_load_dword s84, s[48:51], s98 offset:128
  s_buffer_load_dword s84, s[48:51], s98 offset:192
  s_add_u32 s98, s98, 256
  buffer_load_dwordx4 v[80:83], v26, s[52:55], s95 offen
  s_add_u32 s95, s95, 57344
  buffer_load_dwordx4 v[84:87], v26, s[52:55], s95 offen
  s_add_u32 s95, s95, 57344
  s_waitcnt vmcnt(15)
  s_barrier
  s_add_u32 s3, s75, s76
  s_add_u32 m0, s3, 0
  s_nop 0
  buffer_load_dwordx4 v4, s[36:39], s73 offen lds
  s_add_u32 m0, s3, 1024
  s_nop 0
  buffer_load_dwordx4 v5, s[36:39], s73 offen lds
  s_add_u32 m0, s3, 2048
  s_nop 0
  buffer_load_dwordx4 v6, s[36:39], s73 offen lds
  s_add_u32 m0, s3, 3072
  s_nop 0
  buffer_load_dwordx4 v7, s[36:39], s73 offen lds
  s_add_u32 m0, s78, s75
  s_mov_b64 exec, s[14:15]
  buffer_load_dwordx4 v28, s[36:39], s73 offen lds
  s_mov_b64 exec, -1
  s_add_u32 s3, s75, s77
  s_add_u32 m0, s3, 0
  s_add_u32 s4, s74, 0
  buffer_load_dwordx4 v8, s[40:43], s4 offen lds
  s_add_u32 m0, s3, 1024
  s_nop 0
  buffer_load_dwordx4 v9, s[40:43], s4 offen lds
  s_add_u32 m0, s3, 8192
  s_add_u32 s4, s74, 2048
  buffer_load_dwordx4 v8, s[40:43], s4 offen lds
  s_add_u32 m0, s3, 9216
  s_nop 0
  buffer_load_dwordx4 v9, s[40:43], s4 offen lds
  s_add_u32 m0, s3, 16384
  s_add_u32 s4, s74, 4096
  buffer_load_dwordx4 v8, s[40:43], s4 offen lds
  s_add_u32 m0, s3, 17408
  s_nop 0
  buffer_load_dwordx4 v9, s[40:43], s4 offen lds
  s_and_b32 s73, s100, 15
  s_cmp_eq_u32 s73, s91
  s_cselect_b32 s74, 4, 0
  s_lshr_b64 s[100:101], s[100:101], s74
  s_and_b32 s73, s100, 15
  s_sub_u32 s92, s92, 1
  s_cselect_b32 s73, s91, s73
  s_cselect_b32 s74, 0, 4
  s_lshr_b64 s[100:101], s[100:101], s74
  s_mul_i32 s74, s73, 393216
  s_lshl_b32 s73, s73, 7
  s_add_u32 s75, s75, 43008
  s_cmp_eq_u32 s75, 129024
  s_cselect_b32 s75, 0, s75
  s_buffer_load_dword s84, s[48:51], s98 offset:0
  s_buffer_load_dword s84, s[48:51], s98 offset:64
  s_buffer_load_dword s84, s[48:51], s98 offset:128
  s_buffer_load_dword s84, s[48:51], s98 offset:192
  s_add_u32 s98, s98, 256
  buffer_load_dwordx4 v[88:91], v26, s[52:55], s95 offen
  s_add_u32 s95, s95, 57344
  buffer_load_dwordx4 v[92:95], v26, s[52:55], s95 offen
  s_waitcnt vmcnt(15)
  s_barrier
  s_add_u32 s3, s75, s76
  s_add_u32 m0, s3, 0
  s_nop 0
  buffer_load_dwordx4 v4, s[36:39], s73 offen lds
  s_add_u32 m0, s3, 1024
  s_nop 0
  buffer_load_dwordx4 v5, s[36:39], s73 offen lds
  s_add_u32 m0, s3, 2048
  s_nop 0
  buffer_load_dwordx4 v6, s[36:39], s73 offen lds
  s_add_u32 m0, s3, 3072
  s_nop 0
  buffer_load_dwordx4 v7, s[36:39], s73 offen lds
  s_add_u32 m0, s78, s75
  s_mov_b64 exec, s[14:15]
  buffer_load_dwordx4 v28, s[36:39], s73 offen lds
  s_mov_b64 exec, -1
  s_add_u32 s3, s75, s77
  s_add_u32 m0, s3, 0
  s_add_u32 s4, s74, 0
  buffer_load_dwordx4 v8, s[40:43], s4 offen lds
  s_add_u32 m0, s3, 1024
  s_nop 0
  buffer_load_dwordx4 v9, s[40:43], s4 offen lds
  s_add_u32 m0, s3, 8192
  s_add_u32 s4, s74, 2048
  buffer_load_dwordx4 v8, s[40:43], s4 offen lds
  s_add_u32 m0, s3, 9216
  s_nop 0
  buffer_load_dwordx4 v9, s[40:43], s4 offen lds
  s_add_u32 m0, s3, 16384
  s_add_u32 s4, s74, 4096
  buffer_load_dwordx4 v8, s[40:43], s4 offen lds
  s_add_u32 m0, s3, 17408
  s_nop 0
  buffer_load_dwordx4 v9, s[40:43], s4 offen lds
  s_and_b32 s73, s100, 15
  s_cmp_eq_u32 s73, s91
  s_cselect_b32 s74, 4, 0
  s_lshr_b64 s[100:101], s[100:101], s74
  s_and_b32 s73, s100, 15
  s_sub_u32 s92, s92, 1
  s_cselect_b32 s73, s91, s73
  s_cselect_b32 s74, 0, 4
  s_lshr_b64 s[100:101], s[100:101], s74
  s_mul_i32 s74, s73, 393216
  s_lshl_b32 s73, s73, 7
  s_add_u32 s75, s75, 43008
  s_cmp_eq_u32 s75, 129024
  s_cselect_b32 s75, 0, s75
  s_buffer_load_dword s84, s[48:51], s98 offset:0
  s_buffer_load_dword s84, s[48:51], s98 offset:64
  s_buffer_load_dword s84, s[48:51], s98 offset:128
  s_buffer_load_dword s84, s[48:51], s98 offset:192
  s_add_u32 s98, s98, 256
  s_waitcnt vmcnt(13)
  s_barrier
  s_mov_b32 s79, 6
L_attn0_ld1:
  s_add_u32 s3, s75, s76
  s_add_u32 m0, s3, 0
  s_nop 0
  buffer_load_dwordx4 v4, s[36:39], s73 offen lds
  s_add_u32 m0, s3, 1024
  s_nop 0
  buffer_load_dwordx4 v5, s[36:39], s73 offen lds
  s_add_u32 m0, s3, 2048
  s_nop 0
  buffer_load_dwordx4 v6, s[36:39], s73 offen lds
  s_add_u32 m0, s3, 3072
  s_nop 0
  buffer_load_dwordx4 v7, s[36:39], s73 offen lds
  s_add_u32 m0, s78, s75
  s_mov_b64 exec, s[14:15]
  buffer_load_dwordx4 v28, s[36:39], s73 offen lds
  s_mov_b64 exec, -1
  s_add_u32 s3, s75, s77
  s_add_u32 m0, s3, 0
  s_add_u32 s4, s74, 0
  buffer_load_dwordx4 v8, s[40:43], s4 offen lds
  s_add_u32 m0, s3, 1024
  s_nop 0
  buffer_load_dwordx4 v9, s[40:43], s4 offen lds
  s_add_u32 m0, s3, 8192
  s_add_u32 s4, s74, 2048
  buffer_load_dwordx4 v8, s[40:43], s4 offen lds
  s_add_u32 m0, s3, 9216
  s_nop 0
  buffer_load_dwordx4 v9, s[40:43], s4 offen lds
  s_add_u32 m0, s3, 16384
  s_add_u32 s4, s74, 4096
  buffer_load_dwordx4 v8, s[40:43], s4 offen lds
  s_add_u32 m0, s3, 17408
  s_nop 0
  buffer_load_dwordx4 v9, s[40:43], s4 offen lds
  s_and_b32 s73, s100, 15
  s_cmp_eq_u32 s73, s91
  s_cselect_b32 s74, 4, 0
  s_lshr_b64 s[100:101], s[100:101], s74
  s_and_b32 s73, s100, 15
  s_sub_u32 s92, s92, 1
  s_cselect_b32 s73, s91, s73
  s_cselect_b32 s74, 0, 4
  s_lshr_b64 s[100:101], s[100:101], s74
  s_mul_i32 s74, s73, 393216
  s_lshl_b32 s73, s73, 7
  s_add_u32 s75, s75, 43008
  s_cmp_eq_u32 s75, 129024
  s_cselect_b32 s75, 0, s75
  s_buffer_load_dword s84, s[48:51], s98 offset:0
  s_buffer_load_dword s84, s[48:51], s98 offset:64
  s_buffer_load_dword s84, s[48:51], s98 offset:128
  s_buffer_load_dword s84, s[48:51], s98 offset:192
  s_add_u32 s98, s98, 256
  s_waitcnt vmcnt(11)
  s_barrier
  s_sub_u32 s79, s79, 1
  s_cmp_lg_u32 s79, 0
  s_cbranch_scc1 L_attn0_ld1
  s_add_u32 s3, s75, s76
  s_add_u32 m0, s3, 0
  s_nop 0
  buffer_load_dwordx4 v4, s[36:39], s73 offen lds
  s_add_u32 m0, s3, 1024
  s_nop 0
  buffer_load_dwordx4 v5, s[36:39], s73 offen lds
  s_add_u32 m0, s3, 2048
  s_nop 0
  buffer_load_dwordx4 v6, s[36:39], s73 offen lds
  s_add_u32 m0, s3, 3072
  s_nop 0
  buffer_load_dwordx4 v7, s[36:39], s73 offen lds
  s_add_u32 m0, s78, s75
  s_mov_b64 exec, s[14:15]
  buffer_load_dwordx4 v28, s[36:39], s73 offen lds
  s_mov_b64 exec, -1
  s_add_u32 s3, s75, s77
  s_add_u32 m0, s3, 0
  s_add_u32 s4, s74, 0
  buffer_load_dwordx4 v8, s[40:43], s4 offen lds
  s_add_u32 m0, s3, 1024
  s_nop 0
  buffer_load_dwordx4 v9, s[40:43], s4 offen lds
  s_add_u32 m0, s3, 8192
  s_add_u32 s4, s74, 2048
  buffer_load_dwordx4 v8, s[40:43], s4 offen lds
  s_add_u32 m0, s3, 9216
  s_nop 0
  buffer_load_dwordx4 v9, s[40:43], s4 offen lds
  s_add_u32 m0, s3, 16384
  s_add_u32 s4, s74, 4096
  buffer_load_dwordx4 v8, s[40:43], s4 offen lds
  s_add_u32 m0, s3, 17408
  s_nop 0
  buffer_load_dwordx4 v9, s[40:43], s4 offen lds
  s_and_b32 s73, s100, 15
  s_cmp_eq_u32 s73, s91
  s_cselect_b32 s74, 4, 0
  s_lshr_b64 s[100:101], s[100:101], s74
  s_and_b32 s73, s100, 15
  s_sub_u32 s92, s92, 1
  s_cselect_b32 s73, s91, s73
  s_cselect_b32 s74, 0, 4
  s_lshr_b64 s[100:101], s[100:101], s74
  s_mul_i32 s74, s73, 393216
  s_lshl_b32 s73, s73, 7
  s_add_u32 s75, s75, 43008
  s_cmp_eq_u32 s75, 129024
  s_cselect_b32 s75, 0, s75
  s_buffer_load_dword s84, s[48:51], s98 offset:0
  s_buffer_load_dword s84, s[48:51], s98 offset:64
  s_buffer_load_dword s84, s[48:51], s98 offset:128
  s_buffer_load_dword s84, s[48:51], s98 offset:192
  s_add_u32 s98, s98, 256
  buffer_load_dword v21, v20, s[64:67], 0 offen sc1
  s_waitcnt vmcnt(12)
  s_barrier
  s_add_u32 s3, s75, s76
  s_add_u32 m0, s3, 0
  s_nop 0
  buffer_load_dwordx4 v4, s[36:39], s73 offen lds
  s_add_u32 m0, s3, 1024
  s_nop 0
  buffer_load_dwordx4 v5, s[36:39], s73 offen lds
  s_add_u32 m0, s3, 2048
  s_nop 0
  buffer_load_dwordx4 v6, s[36:39], s73 offen lds
  s_add_u32 m0, s3, 3072
  s_nop 0
  buffer_load_dwordx4 v7, s[36:39], s73 offen lds
  s_add_u32 m0, s78, s75
  s_mov_b64 exec, s[14:15]
  buffer_load_dwordx4 v28, s[36:39], s73 offen lds
  s_mov_b64 exec, -1
  s_add_u32 s3, s75, s77
  s_add_u32 m0, s3, 0
  s_add_u32 s4, s74, 0
  buffer_load_dwordx4 v8, s[40:43], s4 offen lds
  s_add_u32 m0, s3, 1024
  s_nop 0
  buffer_load_dwordx4 v9, s[40:43], s4 offen lds
  s_add_u32 m0, s3, 8192
  s_add_u32 s4, s74, 2048
  buffer_load_dwordx4 v8, s[40:43], s4 offen lds
  s_add_u32 m0, s3, 9216
  s_nop 0
  buffer_load_dwordx4 v9, s[40:43], s4 offen lds
  s_add_u32 m0, s3, 16384
  s_add_u32 s4, s74, 4096
  buffer_load_dwordx4 v8, s[40:43], s4 offen lds
  s_add_u32 m0, s3, 17408
  s_nop 0
  buffer_load_dwordx4 v9, s[40:43], s4 offen lds
  s_and_b32 s73, s100, 15
  s_cmp_eq_u32 s73, s91
  s_cselect_b32 s74, 4, 0
  s_lshr_b64 s[100:101], s[100:101], s74
  s_and_b32 s73, s100, 15
  s_sub_u32 s92, s92, 1
  s_cselect_b32 s73, s91, s73
  s_cselect_b32 s74, 0, 4
  s_lshr_b64 s[100:101], s[100:101], s74
  s_mul_i32 s74, s73, 393216
  s_lshl_b32 s73, s73, 7
  s_add_u32 s75, s75, 43008
  s_cmp_eq_u32 s75, 129024
  s_cselect_b32 s75, 0, s75
  s_buffer_load_dword s84, s[48:51], s98 offset:0
  s_buffer_load_dword s84, s[48:51], s98 offset:64
  s_buffer_load_dword s84, s[48:51], s98 offset:128
  s_buffer_load_dword s84, s[48:51], s98 offset:192
  s_add_u32 s98, s98, 256
  s_waitcnt vmcnt(12)
  s_barrier
  s_add_u32 s3, s75, s76
  s_add_u32 m0, s3, 0
  s_nop 0
  buffer_load_dwordx4 v4, s[36:39], s73 offen lds
  s_add_u32 m0, s3, 1024
  s_nop 0
  buffer_load_dwordx4 v5, s[36:39], s73 offen lds
  s_add_u32 m0, s3, 2048
  s_nop 0
  buffer_load_dwordx4 v6, s[36:39], s73 offen lds
  s_add_u32 m0, s3, 3072
  s_nop 0
  buffer_load_dwordx4 v7, s[36:39], s73 offen lds
  s_add_u32 m0, s78, s75
  s_mov_b64 exec, s[14:15]
  buffer_load_dwordx4 v28, s[36:39], s73 offen lds
  s_mov_b64 exec, -1
  s_add_u32 s3, s75, s77
  s_add_u32 m0, s3, 0
  s_add_u32 s4, s74, 0
  buffer_load_dwordx4 v8, s[40:43], s4 offen lds
  s_add_u32 m0, s3, 1024
  s_nop 0
  buffer_load_dwordx4 v9, s[40:43], s4 offen lds
  s_add_u32 m0, s3, 8192
  s_add_u32 s4, s74, 2048
  buffer_load_dwordx4 v8, s[40:43], s4 offen lds
  s_add_u32 m0, s3, 9216
  s_nop 0
  buffer_load_dwordx4 v9, s[40:43], s4 offen lds
  s_add_u32 m0, s3, 16384
  s_add_u32 s4, s74, 4096
  buffer_load_dwordx4 v8, s[40:43], s4 offen lds
  s_add_u32 m0, s3, 17408
  s_nop 0
  buffer_load_dwordx4 v9, s[40:43], s4 offen lds
  s_and_b32 s73, s100, 15
  s_cmp_eq_u32 s73, s91
  s_cselect_b32 s74, 4, 0
  s_lshr_b64 s[100:101], s[100:101], s74
  s_and_b32 s73, s100, 15
  s_sub_u32 s92, s92, 1
  s_cselect_b32 s73, s91, s73
  s_cselect_b32 s74, 0, 4
  s_lshr_b64 s[100:101], s[100:101], s74
  s_mul_i32 s74, s73, 393216
  s_lshl_b32 s73, s73, 7
  s_add_u32 s75, s75, 43008
  s_cmp_eq_u32 s75, 129024
  s_cselect_b32 s75, 0, s75
  s_buffer_load_dword s84, s[48:51], s98 offset:0
  s_buffer_load_dword s84, s[48:51], s98 offset:64
  s_buffer_load_dword s84, s[48:51], s98 offset:128
  s_buffer_load_dword s84, s[48:51], s98 offset:192
  s_add_u32 s98, s98, 256
  s_waitcnt vmcnt(11)
  s_barrier
  s_mov_b32 s5, 0x100000
  L_attn_dchk:
  v_cmp_ne_u32 vcc, 0x01010101, v21
  s_cbranch_vccz L_attn_dok
  s_sub_u32 s5, s5, 1
  buffer_load_dword v21, v20, s[64:67], 0 offen sc1
  s_waitcnt vmcnt(0)
  s_cbranch_scc0 L_attn_dchk
  L_attn_dok:
  buffer_load_dwordx4 v[32:35], v18, s[56:59], 0 offen
  s_mov_b32 s3, 65536
  buffer_load_dwordx4 v[36:39], v18, s[56:59], s3 offen
  s_mov_b32 s3, 131072
  buffer_load_dwordx4 v[40:43], v18, s[56:59], s3 offen
  s_mov_b32 s3, 196608
  buffer_load_dwordx4 v[44:47], v18, s[56:59], s3 offen
  buffer_load_dwordx2 v[48:49], v19, s[56:59], 0 offen
  s_mov_b32 s60, s20
  s_and_b32 s61, s21, 0xffff
  s_mov_b32 s62, 2097152
  s_mov_b32 s63, 0x00020000
  s_and_b32 s3, s70, 3
  s_mul_i32 s3, s3, 8
  s_mul_i32 s4, s99, 32
  s_add_u32 s3, s3, s4
  v_lshrrev_b32 v2, 3, v1
  v_add_u32 v2, s3, v2
  v_mul_u32_u24 v2, 2048, v2
  v_and_b32 v3, 7, v1
  v_lshl_add_u32 v2, v3, 8, v2
  s_and_b32 s3, s2, 7
  s_lshr_b32 s3, s3, 2
  s_mul_i32 s3, s3, 128
  buffer_load_dword v96, v2, s[60:63], s3 offen
  s_waitcnt vmcnt(6)
  s_barrier
  s_mov_b32 s79, 0x4000
  s_waitcnt vmcnt(1)
L_attn_schk:
  v_pk_add_f32 v[32:33], v[32:33], v[36:37]
  v_pk_add_f32 v[34:35], v[34:35], v[38:39]
  v_pk_add_f32 v[40:41], v[40:41], v[44:45]
  v_pk_add_f32 v[42:43], v[42:43], v[46:47]
  v_pk_add_f32 v[32:33], v[32:33], v[40:41]
  v_pk_add_f32 v[34:35], v[34:35], v[42:43]
  s_nop 1
  v_permlane32_swap_b32 v32, v34
  v_permlane32_swap_b32 v33, v35
  v_pk_add_f32 v[32:33], v[32:33], v[34:35]
  v_cmp_u_f32 vcc, v32, v33
  v_cmp_u_f32 s[4:5], v48, v49
  s_or_b64 s[4:5], vcc, s[4:5]
  s_cbranch_scc0 L_attn_sok
  s_sub_u32 s79, s79, 1
  s_cbranch_scc1 L_attn_sok
  buffer_load_dwordx4 v[32:35], v18, s[56:59], 0 offen sc1
  s_mov_b32 s3, 65536
  buffer_load_dwordx4 v[36:39], v18, s[56:59], s3 offen sc1
  s_mov_b32 s3, 131072
  buffer_load_dwordx4 v[40:43], v18, s[56:59], s3 offen sc1
  s_mov_b32 s3, 196608
  buffer_load_dwordx4 v[44:47], v18, s[56:59], s3 offen sc1
  buffer_load_dwordx2 v[48:49], v19, s[56:59], 0 offen sc1
  s_waitcnt vmcnt(0)
  s_branch L_attn_schk
L_attn_sok:
  v_mov_b32 v34, v32
  v_mov_b32 v35, v33
  s_nop 0
  v_permlane16_swap_b32 v32, v34
  v_permlane16_swap_b32 v33, v35
  v_pk_add_f32 v[32:33], v[32:33], v[34:35]
  v_mul_f32 v32, 0x3a800000, v32
  v_mul_f32 v33, 0x3a800000, v33
  v_fma_f32 v33, -v32, v32, v33
  v_max_f32 v33, 0, v33
  v_add_f32 v33, 0x3727c5ac, v33
  v_rsq_f32 v33, v33
  s_nop 0
  s_and_b32 s3, s70, 3
  s_lshl_b32 s5, s3, 7
  s_add_u32 s5, s5, 129088
  v_and_b32 v3, 15, v1
  v_lshrrev_b32 v2, 5, v1
  v_lshl_add_u32 v2, v3, 1, v2
  v_lshl_add_u32 v2, v2, 2, s5
  ds_write2_b32 v2, v32, v33 offset0:0 offset1:160
  v_mov_b32 v50, v48
  v_mov_b32 v51, v49
  s_nop 0
  v_permlane32_swap_b32 v48, v50
  v_permlane32_swap_b32 v49, v51
  v_pk_add_f32 v[48:49], v[48:49], v[50:51]
  v_mov_b32 v50, v48
  v_mov_b32 v51, v49
  s_nop 0
  v_permlane16_swap_b32 v48, v50
  v_permlane16_swap_b32 v49, v51
  v_pk_add_f32 v[48:49], v[48:49], v[50:51]
  s_nop 1
  v_add_f32_dpp v48, v48, v48 row_ror:8 row_mask:0xf bank_mask:0xf
  v_add_f32_dpp v49, v49, v49 row_ror:8 row_mask:0xf bank_mask:0xf
  s_nop 1
  v_add_f32_dpp v48, v48, v48 row_ror:4 row_mask:0xf bank_mask:0xf
  v_add_f32_dpp v49, v49, v49 row_ror:4 row_mask:0xf bank_mask:0xf
  v_mul_f32 v48, 0x3a800000, v48
  v_mul_f32 v49, 0x3a800000, v49
  v_fma_f32 v49, -v48, v48, v49
  v_max_f32 v49, 0, v49
  v_add_f32 v49, 0x3727c5ac, v49
  v_rsq_f32 v49, v49
  s_nop 0
  s_lshl_b32 s5, s3, 4
  s_add_u32 s5, s5, 129024
  v_and_b32 v3, 3, v1
  v_lshl_add_u32 v2, v3, 2, s5
  ds_write2_b32 v2, v48, v49 offset0:0 offset1:160
  s_waitcnt lgkmcnt(0)
  s_barrier
  s_barrier
  s_branch L_attn_ldend
L_attn_ld1:
  s_add_u32 s3, s68, s69
  s_and_b32 s3, s3, 3
  s_mov_b32 s100, 0x68532410
  s_mov_b32 s101, 0xfedbac97
  s_cmp_eq_u32 s3, 1
  s_cselect_b32 s100, 0x96435210, s100
  s_cselect_b32 s101, 0xfecbda87, s101
  s_cmp_eq_u32 s3, 2
  s_cselect_b32 s100, 0x75463210, s100
  s_cselect_b32 s101, 0xfdceb98a, s101
  s_cmp_eq_u32 s3, 3
  s_cselect_b32 s100, 0x65743210, s100
  s_cselect_b32 s101, 0xedfca9b8, s101
  s_add_u32 s56, s22, 24379392
  s_addc_u32 s57, s23, 0
  s_and_b32 s57, s57, 0xffff
  s_mov_b32 s58, 262144
  s_mov_b32 s59, 0x00020000
  s_and_b32 s3, s70, 3
  s_lshl2_add_u32 s4, s68, s3
  s_lshl_b32 s4, s4, 8
  v_lshrrev_b32 v2, 4, v1
  v_and_b32 v3, 15, v1
  v_lshl_add_u32 v3, v3, 4, s4
  v_lshl_add_u32 v18, v2, 14, v3
  s_lshl_b32 s4, s68, 5
  s_add_u32 s4, s4, s3
  s_sub_u32 s4, s4, 4
  s_max_i32 s4, s4, 0
  s_lshl_b32 s4, s4, 5
  v_lshrrev_b32 v2, 2, v1
  v_and_b32 v3, 3, v1
  v_lshl_add_u32 v3, v3, 3, s4
  v_lshl_add_u32 v19, v2, 14, v3
  s_add_u32 s64, s22, 41943040
  s_addc_u32 s65, s23, 0
  s_and_b32 s65, s65, 0xffff
  s_mov_b32 s66, 524288
  s_mov_b32 s67, 0x00020000
  v_and_b32 v30, 3, v1
  v_lshlrev_b32 v30, 6, v30
  s_mov_b32 s79, 0x100000
  s_cmp_lg_u32 s70, 4
  s_cbranch_scc1 L_attn_xgo
  s_setprio 3
L_attn_xpoll:
  buffer_load_dword v12, v30, s[64:67], s86 offen sc1
  s_sub_u32 s79, s79, 1
  s_cbranch_scc1 L_attn_xgo
  s_waitcnt vmcnt(0)
  v_cmp_ne_u32 vcc, 1, v12
  s_cbranch_vccnz L_attn_xpoll
L_attn_xgo:
  s_setprio 0
  s_barrier
  s_lshr_b32 s3, s69, 3
  s_and_b32 s73, s69, 7
  s_lshl1_add_u32 s91, s73, s3
  s_mul_i32 s74, s91, 393216
  s_lshl_b32 s73, s91, 7
  s_mov_b32 s88, s73
  s_add_u32 m0, s77, 0
  s_add_u32 s4, s74, 0
  buffer_load_dwordx4 v8, s[40:43], s4 offen lds
  s_add_u32 m0, s77, 1024
  s_nop 0
  buffer_load_dwordx4 v9, s[40:43], s4 offen lds
  s_add_u32 m0, s77, 8192
  s_add_u32 s4, s74, 2048
  buffer_load_dwordx4 v8, s[40:43], s4 offen lds
  s_add_u32 m0, s77, 9216
  s_nop 0
  buffer_load_dwordx4 v9, s[40:43], s4 offen lds
  s_add_u32 m0, s77, 16384
  s_add_u32 s4, s74, 4096
  buffer_load_dwordx4 v8, s[40:43], s4 offen lds
  s_add_u32 m0, s77, 17408
  s_nop 0
  buffer_load_dwordx4 v9, s[40:43], s4 offen lds
  s_and_b32 s73, s100, 15
  s_cmp_eq_u32 s73, s91
  s_cselect_b32 s74, 4, 0
  s_lshr_b64 s[100:101], s[100:101], s74
  s_and_b32 s73, s100, 15
  s_lshr_b64 s[100:101], s[100:101], 4
  s_mul_i32 s74, s73, 393216
  s_lshl_b32 s73, s73, 7
  s_mov_b32 s75, 0
  s_add_u32 s44, s22, 41943040
  s_addc_u32 s45, s23, 0
  s_and_b32 s45, s45, 0xffff
  s_mov_b32 s46, 524288
  s_mov_b32 s47, 0x00020000
  s_lshl4_add_u32 s3, s97, s68
  s_and_b32 s4, s69, 15
  s_lshl4_add_u32 s3, s3, s4
  s_lshl_b32 s3, s3, 7
  s_sub_u32 s3, s3, 32768
  v_lshlrev_b32 v11, 7, v1
  s_cmp_eq_u32 s68, 0
  s_cselect_b32 s4, 15, 31
  v_and_b32 v2, 16, v1
  v_lshl_add_u32 v11, v2, 2, v11
  v_and_b32 v2, s4, v1
  v_lshlrev_b32 v2, 2, v2
  v_mov_b32 v3, 1
  s_mov_b32 s79, 0x100000
  s_waitcnt vmcnt(0)
  s_cmp_lg_u32 s70, 4
  s_barrier
  s_cbranch_scc1 L_attn_nofl
  s_mov_b32 exec_lo, 0xffffffff
  s_mov_b32 exec_hi, 0
  buffer_store_dword v3, v11, s[44:47], s87 offen sc1
  s_mov_b64 exec, -1
L_attn_nofl:
  s_mov_b32 s5, s3
  s_mov_b32 s89, s73
  s_add_u32 m0, s77, 43008
  s_add_u32 s4, s74, 0
  buffer_load_dwordx4 v8, s[40:43], s4 offen lds
  s_add_u32 m0, s77, 44032
  s_nop 0
  buffer_load_dwordx4 v9, s[40:43], s4 offen lds
  s_add_u32 m0, s77, 51200
  s_add_u32 s4, s74, 2048
  buffer_load_dwordx4 v8, s[40:43], s4 offen lds
  s_add_u32 m0, s77, 52224
  s_nop 0
  buffer_load_dwordx4 v9, s[40:43], s4 offen lds
  s_add_u32 m0, s77, 59392
  s_add_u32 s4, s74, 4096
  buffer_load_dwordx4 v8, s[40:43], s4 offen lds
  s_add_u32 m0, s77, 60416
  s_nop 0
  buffer_load_dwordx4 v9, s[40:43], s4 offen lds
  s_and_b32 s73, s100, 15
  s_cmp_eq_u32 s73, s91
  s_cselect_b32 s74, 4, 0
  s_lshr_b64 s[100:101], s[100:101], s74
  s_and_b32 s73, s100, 15
  s_lshr_b64 s[100:101], s[100:101], 4
  s_mul_i32 s74, s73, 393216
  s_lshl_b32 s73, s73, 7
  s_mov_b32 s90, s73
  s_add_u32 m0, s77, 86016
  s_add_u32 s4, s74, 0
  buffer_load_dwordx4 v8, s[40:43], s4 offen lds
  s_add_u32 m0, s77, 87040
  s_nop 0
  buffer_load_dwordx4 v9, s[40:43], s4 offen lds
  s_add_u32 m0, s77, 94208
  s_add_u32 s4, s74, 2048
  buffer_load_dwordx4 v8, s[40:43], s4 offen lds
  s_add_u32 m0, s77, 95232
  s_nop 0
  buffer_load_dwordx4 v9, s[40:43], s4 offen lds
  s_add_u32 m0, s77, 102400
  s_add_u32 s4, s74, 4096
  buffer_load_dwordx4 v8, s[40:43], s4 offen lds
  s_add_u32 m0, s77, 103424
  s_nop 0
  buffer_load_dwordx4 v9, s[40:43], s4 offen lds
  s_and_b32 s73, s100, 15
  s_cmp_eq_u32 s73, s91
  s_cselect_b32 s74, 4, 0
  s_lshr_b64 s[100:101], s[100:101], s74
  s_and_b32 s73, s100, 15
  s_lshr_b64 s[100:101], s[100:101], 4
  s_mul_i32 s74, s73, 393216
  s_lshl_b32 s73, s73, 7
  s_mov_b32 s3, s5
  s_cmp_lg_u32 s70, 4
  s_cbranch_scc1 L_attn_dep
L_attn_poll:
  buffer_load_dword v3, v2, s[44:47], s3 offen sc1
  s_sub_u32 s79, s79, 1
  s_cbranch_scc1 L_attn_dep
  s_waitcnt vmcnt(0)
  v_cmp_ne_u32 vcc, 1, v3
  s_cbranch_vccnz L_attn_poll
L_attn_dep:
  s_barrier
  s_add_u32 m0, s78, 89344
  s_mov_b64 exec, s[14:15]
  buffer_load_dwordx4 v28, s[36:39], s88 offen lds
  s_mov_b64 exec, -1
  s_add_u32 m0, s76, 43008
  s_nop 0
  buffer_load_dwordx4 v4, s[36:39], s89 offen lds
  s_add_u32 m0, s76, 44032
  s_nop 0
  buffer_load_dwordx4 v5, s[36:39], s89 offen lds
  s_add_u32 m0, s76, 45056
  s_nop 0
  buffer_load_dwordx4 v6, s[36:39], s89 offen lds
  s_add_u32 m0, s76, 46080
  s_nop 0
  buffer_load_dwordx4 v7, s[36:39], s89 offen lds
  s_add_u32 m0, s78, 43008
  s_mov_b64 exec, s[14:15]
  buffer_load_dwordx4 v28, s[36:39], s89 offen lds
  s_mov_b64 exec, -1
  s_add_u32 m0, s76, 86016
  s_nop 0
  buffer_load_dwordx4 v4, s[36:39], s90 offen lds
  s_add_u32 m0, s76, 87040
  s_nop 0
  buffer_load_dwordx4 v5, s[36:39], s90 offen lds
  s_add_u32 m0, s76, 88064
  s_nop 0
  buffer_load_dwordx4 v6, s[36:39], s90 offen lds
  s_add_u32 m0, s76, 89088
  s_nop 0
  buffer_load_dwordx4 v7, s[36:39], s90 offen lds
  s_add_u32 m0, s78, 86016
  s_mov_b64 exec, s[14:15]
  buffer_load_dwordx4 v28, s[36:39], s90 offen lds
  s_mov_b64 exec, -1
  s_waitcnt vmcnt(5)
  s_barrier
  s_mov_b32 s79, 12
L_attn1_ld1:
  s_add_u32 s3, s75, s76
  s_add_u32 m0, s3, 0
  s_nop 0
  buffer_load_dwordx4 v4, s[36:39], s73 offen lds
  s_add_u32 m0, s3, 1024
  s_nop 0
  buffer_load_dwordx4 v5, s[36:39], s73 offen lds
  s_add_u32 m0, s3, 2048
  s_nop 0
  buffer_load_dwordx4 v6, s[36:39], s73 offen lds
  s_add_u32 m0, s3, 3072
  s_nop 0
  buffer_load_dwordx4 v7, s[36:39], s73 offen lds
  s_add_u32 m0, s78, s75
  s_mov_b64 exec, s[14:15]
  buffer_load_dwordx4 v28, s[36:39], s73 offen lds
  s_mov_b64 exec, -1
  s_add_u32 s3, s75, s77
  s_add_u32 m0, s3, 0
  s_add_u32 s4, s74, 0
  buffer_load_dwordx4 v8, s[40:43], s4 offen lds
  s_add_u32 m0, s3, 1024
  s_nop 0
  buffer_load_dwordx4 v9, s[40:43], s4 offen lds
  s_add_u32 m0, s3, 8192
  s_add_u32 s4, s74, 2048
  buffer_load_dwordx4 v8, s[40:43], s4 offen lds
  s_add_u32 m0, s3, 9216
  s_nop 0
  buffer_load_dwordx4 v9, s[40:43], s4 offen lds
  s_add_u32 m0, s3, 16384
  s_add_u32 s4, s74, 4096
  buffer_load_dwordx4 v8, s[40:43], s4 offen lds
  s_add_u32 m0, s3, 17408
  s_nop 0
  buffer_load_dwordx4 v9, s[40:43], s4 offen lds
  s_and_b32 s73, s100, 15
  s_cmp_eq_u32 s73, s91
  s_cselect_b32 s74, 4, 0
  s_lshr_b64 s[100:101], s[100:101], s74
  s_and_b32 s73, s100, 15
  s_lshr_b64 s[100:101], s[100:101], 4
  s_mul_i32 s74, s73, 393216
  s_lshl_b32 s73, s73, 7
  s_add_u32 s75, s75, 43008
  s_cmp_eq_u32 s75, 129024
  s_cselect_b32 s75, 0, s75
  s_waitcnt vmcnt(11)
  s_barrier
  s_sub_u32 s79, s79, 1
  s_cmp_lg_u32 s79, 0
  s_cbranch_scc1 L_attn1_ld1
  s_add_u32 s3, s75, s76
  s_add_u32 m0, s3, 0
  s_nop 0
  buffer_load_dwordx4 v4, s[36:39], s73 offen lds
  s_add_u32 m0, s3, 1024
  s_nop 0
  buffer_load_dwordx4 v5, s[36:39], s73 offen lds
  s_add_u32 m0, s3, 2048
  s_nop 0
  buffer_load_dwordx4 v6, s[36:39], s73 offen lds
  s_add_u32 m0, s3, 3072
  s_nop 0
  buffer_load_dwordx4 v7, s[36:39], s73 offen lds
  s_add_u32 m0, s78, s75
  s_mov_b64 exec, s[14:15]
  buffer_load_dwordx4 v28, s[36:39], s73 offen lds
  s_mov_b64 exec, -1
  s_add_u32 s3, s75, s77
  s_add_u32 m0, s3, 0
  s_add_u32 s4, s74, 0
  buffer_load_dwordx4 v8, s[40:43], s4 offen lds
  s_add_u32 m0, s3, 1024
  s_nop 0
  buffer_load_dwordx4 v9, s[40:43], s4 offen lds
  s_add_u32 m0, s3, 8192
  s_add_u32 s4, s74, 2048
  buffer_load_dwordx4 v8, s[40:43], s4 offen lds
  s_add_u32 m0, s3, 9216
  s_nop 0
  buffer_load_dwordx4 v9, s[40:43], s4 offen lds
  s_add_u32 m0, s3, 16384
  s_add_u32 s4, s74, 4096
  buffer_load_dwordx4 v8, s[40:43], s4 offen lds
  s_add_u32 m0, s3, 17408
  s_nop 0
  buffer_load_dwordx4 v9, s[40:43], s4 offen lds
  s_and_b32 s73, s100, 15
  s_cmp_eq_u32 s73, s91
  s_cselect_b32 s74, 4, 0
  s_lshr_b64 s[100:101], s[100:101], s74
  s_and_b32 s73, s100, 15
  s_lshr_b64 s[100:101], s[100:101], 4
  s_mul_i32 s74, s73, 393216
  s_lshl_b32 s73, s73, 7
  s_add_u32 s75, s75, 43008
  s_cmp_eq_u32 s75, 129024
  s_cselect_b32 s75, 0, s75
  s_mov_b32 s60, s20
  s_and_b32 s61, s21, 0xffff
  s_mov_b32 s62, 2097152
  s_mov_b32 s63, 0x00020000
  s_and_b32 s3, s70, 3
  s_mul_i32 s3, s3, 8
  s_mul_i32 s4, s99, 32
  s_add_u32 s3, s3, s4
  v_lshrrev_b32 v2, 3, v1
  v_add_u32 v2, s3, v2
  v_mul_u32_u24 v2, 2048, v2
  v_and_b32 v3, 7, v1
  v_lshl_add_u32 v2, v3, 8, v2
  s_and_b32 s3, s2, 7
  s_lshr_b32 s3, s3, 2
  s_mul_i32 s3, s3, 128
  buffer_load_dword v96, v2, s[60:63], s3 offen
  s_waitcnt vmcnt(12)
  s_barrier
  buffer_load_dwordx4 v[32:35], v18, s[56:59], 0 offen
  s_mov_b32 s3, 65536
  buffer_load_dwordx4 v[36:39], v18, s[56:59], s3 offen
  s_mov_b32 s3, 131072
  buffer_load_dwordx4 v[40:43], v18, s[56:59], s3 offen
  s_mov_b32 s3, 196608
  buffer_load_dwordx4 v[44:47], v18, s[56:59], s3 offen
  buffer_load_dwordx2 v[48:49], v19, s[56:59], 0 offen
  s_waitcnt vmcnt(6)
  s_barrier
  s_waitcnt vmcnt(0)
  v_pk_add_f32 v[32:33], v[32:33], v[36:37]
  v_pk_add_f32 v[34:35], v[34:35], v[38:39]
  v_pk_add_f32 v[40:41], v[40:41], v[44:45]
  v_pk_add_f32 v[42:43], v[42:43], v[46:47]
  v_pk_add_f32 v[32:33], v[32:33], v[40:41]
  v_pk_add_f32 v[34:35], v[34:35], v[42:43]
  s_nop 1
  v_permlane32_swap_b32 v32, v34
  v_permlane32_swap_b32 v33, v35
  v_pk_add_f32 v[32:33], v[32:33], v[34:35]
  v_mov_b32 v34, v32
  v_mov_b32 v35, v33
  s_nop 0
  v_permlane16_swap_b32 v32, v34
  v_permlane16_swap_b32 v33, v35
  v_pk_add_f32 v[32:33], v[32:33], v[34:35]
  v_mul_f32 v32, 0x3a800000, v32
  v_mul_f32 v33, 0x3a800000, v33
  v_fma_f32 v33, -v32, v32, v33
  v_max_f32 v33, 0, v33
  v_add_f32 v33, 0x3727c5ac, v33
  v_rsq_f32 v33, v33
  s_nop 0
  s_and_b32 s3, s70, 3
  s_lshl_b32 s5, s3, 7
  s_add_u32 s5, s5, 129088
  v_and_b32 v3, 15, v1
  v_lshrrev_b32 v2, 5, v1
  v_lshl_add_u32 v2, v3, 1, v2
  v_lshl_add_u32 v2, v2, 2, s5
  ds_write2_b32 v2, v32, v33 offset0:0 offset1:160
  v_mov_b32 v50, v48
  v_mov_b32 v51, v49
  s_nop 0
  v_permlane32_swap_b32 v48, v50
  v_permlane32_swap_b32 v49, v51
  v_pk_add_f32 v[48:49], v[48:49], v[50:51]
  v_mov_b32 v50, v48
  v_mov_b32 v51, v49
  s_nop 0
  v_permlane16_swap_b32 v48, v50
  v_permlane16_swap_b32 v49, v51
  v_pk_add_f32 v[48:49], v[48:49], v[50:51]
  s_nop 1
  v_add_f32_dpp v48, v48, v48 row_ror:8 row_mask:0xf bank_mask:0xf
  v_add_f32_dpp v49, v49, v49 row_ror:8 row_mask:0xf bank_mask:0xf
  s_nop 1
  v_add_f32_dpp v48, v48, v48 row_ror:4 row_mask:0xf bank_mask:0xf
  v_add_f32_dpp v49, v49, v49 row_ror:4 row_mask:0xf bank_mask:0xf
  v_mul_f32 v48, 0x3a800000, v48
  v_mul_f32 v49, 0x3a800000, v49
  v_fma_f32 v49, -v48, v48, v49
  v_max_f32 v49, 0, v49
  v_add_f32 v49, 0x3727c5ac, v49
  v_rsq_f32 v49, v49
  s_nop 0
  s_lshl_b32 s5, s3, 4
  s_add_u32 s5, s5, 129024
  v_and_b32 v3, 3, v1
  v_lshl_add_u32 v2, v3, 2, s5
  ds_write2_b32 v2, v48, v49 offset0:0 offset1:160
  s_waitcnt lgkmcnt(0)
  s_barrier
  s_barrier
L_attn_ldend:
  s_lshl_b32 s87, s97, 15
  s_lshl_b32 s4, s68, 11
  s_add_u32 s87, s87, s4
  s_lshl_b32 s4, s69, 2
  s_add_u32 s87, s87, s4
  s_add_u32 s97, s97, 1
  s_branch L_wo_body
L_attn_end:
  s_endpgm
.fill 1021, 4, 0xbf800000
L_attn_compute:
  s_cmp_lg_u32 s96, 0
  s_cbranch_scc1 L_pfc1_skip
  s_getpc_b64 s[4:5]
L_pfc1:
  s_lshl_b32 s3, s99, 2
  s_add_u32 s3, s3, s70
  s_mul_i32 s3, s3, 320
  s_min_u32 s3, s3, L_w2_c1-L_attn_c0-320
  s_add_i32 s3, s3, L_attn_c0-L_pfc1
  s_ashr_i32 s6, s3, 31
  s_add_u32 s4, s4, s3
  s_addc_u32 s5, s5, s6
  s_load_dword s40, s[4:5], 0
  s_load_dword s40, s[4:5], 64
  s_load_dword s40, s[4:5], 128
  s_load_dword s40, s[4:5], 192
  s_load_dword s40, s[4:5], 256
L_pfc1_skip:
  s_and_b32 s71, s70, 1
  s_lshr_b32 s72, s70, 1
  v_and_b32 v3, 31, v1
  v_lshlrev_b32 v3, 2, v3
  v_add_u32 v3, 40960, v3
  v_mov_b32 v236, 0x3f803f80
  v_mov_b32 v237, 0x3f803f80
  v_mov_b32 v238, 0x3f803f80
  v_mov_b32 v239, 0x3f803f80
  ds_write_b32 v3, v236
  ds_write_b32 v3, v236 offset:43008
  v_add_u32 v3, 86016, v3
  ds_write_b32 v3, v236
  ds_write_b32 v3, v236 offset:3328
  v_and_b32 v3, 15, v1
  v_lshrrev_b32 v2, 4, v1
  v_lshrrev_b32 v33, 1, v3
  s_lshl_b32 s8, s71, 13
  v_xor_b32 v4, v2, v33
  v_lshlrev_b32 v4, 4, v4
  v_lshl_add_u32 v4, v3, 7, v4
  v_add_u32 v8, 40960, v4
  v_add_u32 v4, s8, v4
  v_add_u32 v5, 4, v2
  v_xor_b32 v5, v5, v33
  v_lshlrev_b32 v5, 4, v5
  v_lshl_add_u32 v5, v3, 7, v5
  v_add_u32 v9, 40960, v5
  v_add_u32 v5, s8, v5
  v_bfe_u32 v34, v1, 2, 2
  v_lshl_add_u32 v34, v2, 3, v34
  v_lshlrev_b32 v34, 7, v34
  v_and_b32 v33, 3, v1
  v_lshl_add_u32 v34, v33, 3, v34
  v_bfe_u32 v33, v1, 3, 2
  v_lshl_add_u32 v34, v33, 5, v34
  s_lshl_b32 s8, s70, 5
  v_xor_b32 v34, s8, v34
  v_add_u32 v6, 16384, v34
  v_xor_b32 v7, 32, v6
  s_mov_b32 s75, 0
  v_add_u32_e64 v10, s75, v4
  v_add_u32_e64 v11, s75, v5
  v_add_u32_e64 v12, s75, v6
  v_add_u32_e64 v13, s75, v7
  v_add_u32_e64 v14, s75, v8
  v_add_u32_e64 v15, s75, v9
  s_add_u32 s75, s75, 43008
  s_cmp_eq_u32 s75, 129024
  s_cselect_b32 s75, 0, s75
  s_and_b32 s79, s69, 3
  s_add_u32 s79, s79, 1
  s_mul_i32 s98, s96, 3
  s_cmp_eq_u32 s96, 0
  s_cbranch_scc1 L_attn_nog
  s_mov_b32 s79, 15
  ds_read_b128 v[32:35], v10 offset:0
  ds_read_b128 v[36:39], v10 offset:2048
  ds_read_b128 v[40:43], v10 offset:4096
  ds_read_b128 v[44:47], v10 offset:6144
  ds_read_b64_tr_b16 v[52:53], v12 offset:0
  ds_read_b64_tr_b16 v[54:55], v12 offset:512
  ds_read_b64_tr_b16 v[56:57], v13 offset:0
  ds_read_b64_tr_b16 v[58:59], v13 offset:512
  ds_read_b64_tr_b16 v[60:61], v12 offset:8192
  ds_read_b64_tr_b16 v[62:63], v12 offset:8704
  ds_read_b64_tr_b16 v[64:65], v13 offset:8192
  ds_read_b64_tr_b16 v[66:67], v13 offset:8704
  ds_read_b64_tr_b16 v[68:69], v12 offset:16384
  ds_read_b64_tr_b16 v[70:71], v12 offset:16896
  ds_read_b64_tr_b16 v[72:73], v13 offset:16384
  ds_read_b64_tr_b16 v[74:75], v13 offset:16896
  s_waitcnt lgkmcnt(0)
  v_mfma_f32_16x16x32_bf16 v[128:131], v[52:55], v[32:35], 0
  ds_read_b128 v[76:79], v11 offset:0
  v_mfma_f32_16x16x32_bf16 v[132:135], v[52:55], v[36:39], 0
  ds_read_b128 v[80:83], v11 offset:2048
  v_mfma_f32_16x16x32_bf16 v[136:139], v[52:55], v[40:43], 0
  ds_read_b128 v[84:87], v11 offset:4096
  v_mfma_f32_16x16x32_bf16 v[140:143], v[52:55], v[44:47], 0
  ds_read_b128 v[88:91], v11 offset:6144
  v_mfma_f32_16x16x32_bf16 v[156:159], v[56:59], v[44:47], 0
  ds_read_b64_tr_b16 v[96:97], v12 offset:4096
  v_mfma_f32_16x16x32_bf16 v[152:155], v[56:59], v[40:43], 0
  ds_read_b64_tr_b16 v[98:99], v12 offset:4608
  v_mfma_f32_16x16x32_bf16 v[148:151], v[56:59], v[36:39], 0
  ds_read_b64_tr_b16 v[100:101], v13 offset:4096
  v_mfma_f32_16x16x32_bf16 v[144:147], v[56:59], v[32:35], 0
  ds_read_b64_tr_b16 v[102:103], v13 offset:4608
  v_mfma_f32_16x16x32_bf16 v[160:163], v[60:63], v[32:35], 0
  ds_read_b64_tr_b16 v[104:105], v12 offset:12288
  v_mfma_f32_16x16x32_bf16 v[164:167], v[60:63], v[36:39], 0
  ds_read_b64_tr_b16 v[106:107], v12 offset:12800
  v_mfma_f32_16x16x32_bf16 v[168:171], v[60:63], v[40:43], 0
  ds_read_b64_tr_b16 v[108:109], v13 offset:12288
  v_mfma_f32_16x16x32_bf16 v[172:175], v[60:63], v[44:47], 0
  ds_read_b64_tr_b16 v[110:111], v13 offset:12800
  v_mfma_f32_16x16x32_bf16 v[188:191], v[64:67], v[44:47], 0
  ds_read_b64_tr_b16 v[112:113], v12 offset:20480
  v_mfma_f32_16x16x32_bf16 v[184:187], v[64:67], v[40:43], 0
  ds_read_b64_tr_b16 v[114:115], v12 offset:20992
  v_mfma_f32_16x16x32_bf16 v[180:183], v[64:67], v[36:39], 0
  ds_read_b64_tr_b16 v[116:117], v13 offset:20480
  v_mfma_f32_16x16x32_bf16 v[176:179], v[64:67], v[32:35], 0
  ds_read_b64_tr_b16 v[118:119], v13 offset:20992
  v_mfma_f32_16x16x32_bf16 v[192:195], v[32:35], v[68:71], 0
  v_add_u32_e64 v10, s75, v4
  v_mfma_f32_16x16x32_bf16 v[196:199], v[36:39], v[68:71], 0
  v_add_u32_e64 v11, s75, v5
  v_mfma_f32_16x16x32_bf16 v[200:203], v[40:43], v[68:71], 0
  v_add_u32_e64 v12, s75, v6
  v_mfma_f32_16x16x32_bf16 v[204:207], v[44:47], v[68:71], 0
  v_add_u32_e64 v13, s75, v7
  v_mfma_f32_16x16x32_bf16 v[220:223], v[44:47], v[72:75], 0
  v_add_u32_e64 v14, s75, v8
  v_mfma_f32_16x16x32_bf16 v[216:219], v[40:43], v[72:75], 0
  v_add_u32_e64 v15, s75, v9
  v_mfma_f32_16x16x32_bf16 v[212:215], v[36:39], v[72:75], 0
  s_add_u32 s75, s75, 43008
  v_mfma_f32_16x16x32_bf16 v[208:211], v[32:35], v[72:75], 0
  s_cmp_eq_u32 s75, 129024
  s_cselect_b32 s75, 0, s75
  s_waitcnt lgkmcnt(0)
  v_mfma_f32_16x16x32_bf16 v[128:131], v[96:99], v[76:79], v[128:131]
  v_mfma_f32_16x16x32_bf16 v[132:135], v[96:99], v[80:83], v[132:135]
  v_mfma_f32_16x16x32_bf16 v[136:139], v[96:99], v[84:87], v[136:139]
  v_mfma_f32_16x16x32_bf16 v[140:143], v[96:99], v[88:91], v[140:143]
  v_mfma_f32_16x16x32_bf16 v[156:159], v[100:103], v[88:91], v[156:159]
  v_mfma_f32_16x16x32_bf16 v[152:155], v[100:103], v[84:87], v[152:155]
  v_mfma_f32_16x16x32_bf16 v[148:151], v[100:103], v[80:83], v[148:151]
  v_mfma_f32_16x16x32_bf16 v[144:147], v[100:103], v[76:79], v[144:147]
  v_mfma_f32_16x16x32_bf16 v[160:163], v[104:107], v[76:79], v[160:163]
  v_mfma_f32_16x16x32_bf16 v[164:167], v[104:107], v[80:83], v[164:167]
  v_mfma_f32_16x16x32_bf16 v[168:171], v[104:107], v[84:87], v[168:171]
  v_mfma_f32_16x16x32_bf16 v[172:175], v[104:107], v[88:91], v[172:175]
  v_mfma_f32_16x16x32_bf16 v[188:191], v[108:111], v[88:91], v[188:191]
  v_mfma_f32_16x16x32_bf16 v[184:187], v[108:111], v[84:87], v[184:187]
  v_mfma_f32_16x16x32_bf16 v[180:183], v[108:111], v[80:83], v[180:183]
  v_mfma_f32_16x16x32_bf16 v[176:179], v[108:111], v[76:79], v[176:179]
  v_mfma_f32_16x16x32_bf16 v[192:195], v[76:79], v[112:115], v[192:195]
  v_mfma_f32_16x16x32_bf16 v[196:199], v[80:83], v[112:115], v[196:199]
  v_mfma_f32_16x16x32_bf16 v[200:203], v[84:87], v[112:115], v[200:203]
  v_mfma_f32_16x16x32_bf16 v[204:207], v[88:91], v[112:115], v[204:207]
  v_mfma_f32_16x16x32_bf16 v[220:223], v[88:91], v[116:119], v[220:223]
  v_mfma_f32_16x16x32_bf16 v[216:219], v[84:87], v[116:119], v[216:219]
  v_mfma_f32_16x16x32_bf16 v[212:215], v[80:83], v[116:119], v[212:215]
  v_mfma_f32_16x16x32_bf16 v[208:211], v[76:79], v[116:119], v[208:211]
  s_barrier
  v_mov_b32 v76, v52
  v_mov_b32 v77, v53
  v_mov_b32 v78, v54
  v_mov_b32 v79, v55
  v_mov_b32 v80, v60
  v_mov_b32 v81, v61
  v_mov_b32 v82, v62
  v_mov_b32 v83, v63
  v_mov_b32 v84, v68
  v_mov_b32 v85, v69
  v_mov_b32 v86, v70
  v_mov_b32 v87, v71
L_attn_nog:
  v_and_b32 v35, 1, v2
  v_xor_b32 v35, s71, v35
  s_lshl_b32 s8, s68, 7
  s_lshl_b32 s9, s71, 6
  s_add_u32 s8, s8, s9
  s_mul_i32 s10, s8, 7
  s_lshl2_add_u32 s11, s69, s72
  s_add_u32 s10, s10, s11
  s_lshl_b32 s10, s10, 10
  v_lshl_add_u32 v31, v1, 4, s10
  s_mul_i32 s10, s72, 14336
  s_add_u32 s10, s10, 1024
  s_lshl_b32 s11, s71, 10
  s_add_u32 s4, s10, s11
  s_sub_u32 s5, s10, s11
  s_mul_i32 s6, s71, 6144
  v_lshl_add_u32 v16, v1, 4, s4
  v_add_u32 v17, s6, v16
  v_lshl_add_u32 v18, v1, 4, s5
  v_add_u32 v18, s6, v18
  v_lshl_add_u32 v19, v2, 8, s4
  v_lshl_add_u32 v20, v2, 8, s5
  v_lshl_add_u32 v21, v3, 4, s4
  v_lshl_add_u32 v22, v3, 4, s5
  s_lshl_b32 s10, s71, 8
  s_add_u32 s10, s10, 129024
  v_lshl_add_u32 v23, v3, 2, s10
  v_lshl_add_u32 v24, v2, 4, s10
  v_and_b32 v33, 1, v3
  v_cmp_eq_u32 s[48:49], 1, v33
  v_lshl_add_u32 v34, v2, 2, v33
  v_add_u32 v35, 2, v34
  v_cmp_gt_u32 s[50:51], v34, v3
  v_cmp_gt_u32 s[52:53], v35, v3
  v_mov_b32 v36, 0xffff
  v_mov_b32 v37, 0xffff0000
  v_cndmask_b32 v36, v36, v37, s[48:49]
  s_add_u32 s10, s10, 704
  v_lshl_add_u32 v34, v34, 2, s10
  v_lshl_add_u32 v35, v35, 2, s10
  v_subrev_u32 v38, 64, v34
  v_subrev_u32 v39, 64, v35
  v_cndmask_b32 v25, v34, v38, s[50:51]
  v_cndmask_b32 v26, v35, v39, s[52:53]
  v_cndmask_b32 v27, 0, v36, s[50:51]
  v_cndmask_b32 v29, 0, v36, s[52:53]
  v_xor_b32 v28, v27, v36
  v_xor_b32 v30, v29, v36
  s_cmp_eq_u32 s8, 0
  s_cselect_b64 s[54:55], s[50:51], 0
  s_cselect_b64 s[14:15], s[52:53], 0
  s_cmp_lg_u32 s96, 0
  s_cbranch_scc1 L_attn_nozero
  v_mov_b32 v122, 0
  v_mov_b32 v123, 0
  v_mov_b32 v124, 0
  v_mov_b32 v125, 0
  v_mov_b32 v126, 0
  v_mov_b32 v127, 0
  v_mov_b32 v128, 0
  v_mov_b32 v129, 0
  v_mov_b32 v130, 0
  v_mov_b32 v131, 0
  v_mov_b32 v132, 0
  v_mov_b32 v133, 0
  v_mov_b32 v134, 0
  v_mov_b32 v135, 0
  v_mov_b32 v136, 0
  v_mov_b32 v137, 0
  v_mov_b32 v138, 0
  v_mov_b32 v139, 0
  v_mov_b32 v140, 0
  v_mov_b32 v141, 0
  v_mov_b32 v142, 0
  v_mov_b32 v143, 0
  v_mov_b32 v144, 0
  v_mov_b32 v145, 0
  v_mov_b32 v146, 0
  v_mov_b32 v147, 0
  v_mov_b32 v148, 0
  v_mov_b32 v149, 0
  v_mov_b32 v150, 0
  v_mov_b32 v151, 0
  v_mov_b32 v152, 0
  v_mov_b32 v153, 0
  v_mov_b32 v154, 0
  v_mov_b32 v155, 0
  v_mov_b32 v156, 0
  v_mov_b32 v157, 0
  v_mov_b32 v158, 0
  v_mov_b32 v159, 0
  v_mov_b32 v160, 0
  v_mov_b32 v161, 0
  v_mov_b32 v162, 0
  v_mov_b32 v163, 0
  v_mov_b32 v164, 0
  v_mov_b32 v165, 0
  v_mov_b32 v166, 0
  v_mov_b32 v167, 0
  v_mov_b32 v168, 0
  v_mov_b32 v169, 0
  v_mov_b32 v170, 0
  v_mov_b32 v171, 0
  v_mov_b32 v172, 0
  v_mov_b32 v173, 0
  v_mov_b32 v174, 0
  v_mov_b32 v175, 0
  v_mov_b32 v176, 0
  v_mov_b32 v177, 0
  v_mov_b32 v178, 0
  v_mov_b32 v179, 0
  v_mov_b32 v180, 0
  v_mov_b32 v181, 0
  v_mov_b32 v182, 0
  v_mov_b32 v183, 0
  v_mov_b32 v184, 0
  v_mov_b32 v185, 0
  v_mov_b32 v186, 0
  v_mov_b32 v187, 0
  v_mov_b32 v188, 0
  v_mov_b32 v189, 0
  v_mov_b32 v190, 0
  v_mov_b32 v191, 0
  v_mov_b32 v192, 0
  v_mov_b32 v193, 0
  v_mov_b32 v194, 0
  v_mov_b32 v195, 0
  v_mov_b32 v196, 0
  v_mov_b32 v197, 0
  v_mov_b32 v198, 0
  v_mov_b32 v199, 0
  v_mov_b32 v200, 0
  v_mov_b32 v201, 0
  v_mov_b32 v202, 0
  v_mov_b32 v203, 0
  v_mov_b32 v204, 0
  v_mov_b32 v205, 0
  v_mov_b32 v206, 0
  v_mov_b32 v207, 0
  v_mov_b32 v208, 0
  v_mov_b32 v209, 0
  v_mov_b32 v210, 0
  v_mov_b32 v211, 0
  v_mov_b32 v212, 0
  v_mov_b32 v213, 0
  v_mov_b32 v214, 0
  v_mov_b32 v215, 0
  v_mov_b32 v216, 0
  v_mov_b32 v217, 0
  v_mov_b32 v218, 0
  v_mov_b32 v219, 0
  v_mov_b32 v220, 0
  v_mov_b32 v221, 0
  v_mov_b32 v222, 0
  v_mov_b32 v223, 0
  v_mov_b32 v224, 0
  v_mov_b32 v225, 0
  v_mov_b32 v226, 0
  v_mov_b32 v227, 0
  v_mov_b32 v228, 0
  v_mov_b32 v229, 0
  v_mov_b32 v230, 0
  v_mov_b32 v231, 0
  v_mov_b32 v232, 0
  v_mov_b32 v233, 0
  v_mov_b32 v234, 0
  v_mov_b32 v235, 0
  s_waitcnt lgkmcnt(0)
  s_lshl_b32 s3, s72, 5
  s_add_u32 s3, s3, s8
  s_lshl_b32 s4, s69, 14
  s_lshl3_add_u32 s3, s3, s4
  v_lshrrev_b32 v121, 1, v2
  v_lshl_add_u32 v121, v121, 4, v3
  v_and_b32 v120, 1, v2
  v_lshl_add_u32 v121, v121, 1, v120
  v_lshl_add_u32 v120, v121, 2, s3
  s_add_u32 s56, s22, 24903680
  s_addc_u32 s57, s23, 0
  s_and_b32 s57, s57, 0xffff
  s_mov_b32 s58, 262144
  s_mov_b32 s59, 0x00020000
  s_add_u32 s60, s22, 41943040
  s_addc_u32 s61, s23, 0
  s_and_b32 s61, s61, 0xffff
  s_mov_b32 s62, 524288
  s_mov_b32 s63, 0x00020000
  s_lshl_b32 s3, s2, 11
  s_cmp_lg_u32 s70, 0
  s_cbranch_scc1 L_attn_noclr
  s_lshl_b32 s5, s68, 10
  s_add_u32 s4, s4, s5
  v_lshlrev_b32 v121, 4, v1
  v_mov_b32 v40, -1
  v_mov_b32 v41, -1
  v_mov_b32 v42, -1
  v_mov_b32 v43, -1
  buffer_store_dwordx4 v[40:43], v121, s[56:59], s4 offen sc1
  buffer_store_dwordx4 v[128:131], v121, s[60:63], s3 offen offset:0 sc1
  buffer_store_dwordx4 v[128:131], v121, s[60:63], s3 offen offset:1024 sc1
  v_mov_b32 v126, 1
L_attn_noclr:
  s_and_b32 s65, s65, 0xffff
  s_mov_b32 s66, 256
  s_mov_b32 s67, 0x00020000
  s_mov_b32 s7, 0x3f803f80
L_attn_nozero:
  s_waitcnt lgkmcnt(0)
  s_add_u32 s44, s34, 8439808
  s_addc_u32 s45, s35, 0
  s_and_b32 s45, s45, 0xffff
  s_mov_b32 s46, 14628864
  s_mov_b32 s47, 0x00020000
  s_cmp_eq_u32 s96, 0
  s_barrier
  s_cbranch_scc1 L_attn_first
  ds_read_b128 v[88:91], v14 offset:46336
  ds_read_b128 v[92:95], v15 offset:46336
  ds_read_b128 v[32:35], v10 offset:0
  ds_read_b128 v[36:39], v10 offset:2048
  ds_read_b128 v[40:43], v10 offset:4096
  ds_read_b128 v[44:47], v10 offset:6144
  ds_read_b128 v[48:51], v14
  ds_read_b64_tr_b16 v[52:53], v12 offset:0
  ds_read_b64_tr_b16 v[54:55], v12 offset:512
  ds_read_b64_tr_b16 v[56:57], v13 offset:0
  ds_read_b64_tr_b16 v[58:59], v13 offset:512
  ds_read_b64_tr_b16 v[60:61], v12 offset:8192
  ds_read_b64_tr_b16 v[62:63], v12 offset:8704
  ds_read_b64_tr_b16 v[64:65], v13 offset:8192
  ds_read_b64_tr_b16 v[66:67], v13 offset:8704
  ds_read_b64_tr_b16 v[68:69], v12 offset:16384
  ds_read_b64_tr_b16 v[70:71], v12 offset:16896
  ds_read_b64_tr_b16 v[72:73], v13 offset:16384
  ds_read_b64_tr_b16 v[74:75], v13 offset:16896
  s_waitcnt lgkmcnt(15)
  v_mfma_f32_16x16x32_bf16 v[224:227], v[76:79], v[88:91], 0
  v_mfma_f32_16x16x32_bf16 v[228:231], v[80:83], v[88:91], 0
  v_mfma_f32_16x16x32_bf16 v[232:235], v[88:91], v[84:87], 0
  v_mfma_f32_16x16x32_bf16 v[224:227], v[96:99], v[92:95], v[224:227]
  v_mfma_f32_16x16x32_bf16 v[228:231], v[104:107], v[92:95], v[228:231]
  v_mfma_f32_16x16x32_bf16 v[232:235], v[92:95], v[112:115], v[232:235]
  s_waitcnt lgkmcnt(0)
  s_branch L_attn_loop
L_attn_first:
  ds_read_b128 v[32:35], v10 offset:0
  ds_read_b128 v[36:39], v10 offset:2048
  ds_read_b128 v[40:43], v10 offset:4096
  ds_read_b128 v[44:47], v10 offset:6144
  ds_read_b128 v[48:51], v14
  ds_read_b64_tr_b16 v[52:53], v12 offset:0
  ds_read_b64_tr_b16 v[54:55], v12 offset:512
  ds_read_b64_tr_b16 v[56:57], v13 offset:0
  ds_read_b64_tr_b16 v[58:59], v13 offset:512
  ds_read_b64_tr_b16 v[60:61], v12 offset:8192
  ds_read_b64_tr_b16 v[62:63], v12 offset:8704
  ds_read_b64_tr_b16 v[64:65], v13 offset:8192
  ds_read_b64_tr_b16 v[66:67], v13 offset:8704
  ds_read_b64_tr_b16 v[68:69], v12 offset:16384
  ds_read_b64_tr_b16 v[70:71], v12 offset:16896
  ds_read_b64_tr_b16 v[72:73], v13 offset:16384
  ds_read_b64_tr_b16 v[74:75], v13 offset:16896
.p2align 5
  s_nop 0
  s_nop 0
  s_nop 0
  s_waitcnt lgkmcnt(0)
L_attn_loop:
  v_mfma_f32_16x16x32_bf16 v[128:131], v[52:55], v[32:35], v[128:131]
  ds_read_b128 v[76:79], v11 offset:0
  v_mfma_f32_16x16x32_bf16 v[132:135], v[52:55], v[36:39], v[132:135]
  ds_read_b128 v[80:83], v11 offset:2048
  v_mfma_f32_16x16x32_bf16 v[136:139], v[52:55], v[40:43], v[136:139]
  ds_read_b128 v[84:87], v11 offset:4096
  v_mfma_f32_16x16x32_bf16 v[140:143], v[52:55], v[44:47], v[140:143]
  ds_read_b128 v[88:91], v11 offset:6144
  v_mfma_f32_16x16x32_bf16 v[224:227], v[52:55], v[48:51], v[224:227]
  ds_read_b128 v[92:95], v15
  v_mfma_f32_16x16x32_bf16 v[156:159], v[56:59], v[44:47], v[156:159]
  ds_read_b64_tr_b16 v[96:97], v12 offset:4096
  v_mfma_f32_16x16x32_bf16 v[152:155], v[56:59], v[40:43], v[152:155]
  ds_read_b64_tr_b16 v[98:99], v12 offset:4608
  v_mfma_f32_16x16x32_bf16 v[148:151], v[56:59], v[36:39], v[148:151]
  ds_read_b64_tr_b16 v[100:101], v13 offset:4096
  v_mfma_f32_16x16x32_bf16 v[144:147], v[56:59], v[32:35], v[144:147]
  ds_read_b64_tr_b16 v[102:103], v13 offset:4608
  v_mfma_f32_16x16x32_bf16 v[160:163], v[60:63], v[32:35], v[160:163]
  ds_read_b64_tr_b16 v[104:105], v12 offset:12288
  v_mfma_f32_16x16x32_bf16 v[164:167], v[60:63], v[36:39], v[164:167]
  ds_read_b64_tr_b16 v[106:107], v12 offset:12800
  v_mfma_f32_16x16x32_bf16 v[168:171], v[60:63], v[40:43], v[168:171]
  ds_read_b64_tr_b16 v[108:109], v13 offset:12288
  v_mfma_f32_16x16x32_bf16 v[172:175], v[60:63], v[44:47], v[172:175]
  ds_read_b64_tr_b16 v[110:111], v13 offset:12800
  v_mfma_f32_16x16x32_bf16 v[228:231], v[60:63], v[48:51], v[228:231]
  ds_read_b64_tr_b16 v[112:113], v12 offset:20480
  v_mfma_f32_16x16x32_bf16 v[188:191], v[64:67], v[44:47], v[188:191]
  ds_read_b64_tr_b16 v[114:115], v12 offset:20992
  v_mfma_f32_16x16x32_bf16 v[184:187], v[64:67], v[40:43], v[184:187]
  ds_read_b64_tr_b16 v[116:117], v13 offset:20480
  v_mfma_f32_16x16x32_bf16 v[180:183], v[64:67], v[36:39], v[180:183]
  ds_read_b64_tr_b16 v[118:119], v13 offset:20992
  v_mfma_f32_16x16x32_bf16 v[176:179], v[64:67], v[32:35], v[176:179]
  v_add_u32_e64 v10, s75, v4
  v_mfma_f32_16x16x32_bf16 v[192:195], v[32:35], v[68:71], v[192:195]
  v_add_u32_e64 v11, s75, v5
  v_mfma_f32_16x16x32_bf16 v[196:199], v[36:39], v[68:71], v[196:199]
  v_add_u32_e64 v12, s75, v6
  v_mfma_f32_16x16x32_bf16 v[200:203], v[40:43], v[68:71], v[200:203]
  v_add_u32_e64 v13, s75, v7
  v_mfma_f32_16x16x32_bf16 v[204:207], v[44:47], v[68:71], v[204:207]
  v_add_u32_e64 v14, s75, v8
  v_mfma_f32_16x16x32_bf16 v[232:235], v[48:51], v[68:71], v[232:235]
  v_add_u32_e64 v15, s75, v9
  v_mfma_f32_16x16x32_bf16 v[220:223], v[44:47], v[72:75], v[220:223]
  s_add_u32 s75, s75, 43008
  v_mfma_f32_16x16x32_bf16 v[216:219], v[40:43], v[72:75], v[216:219]
  s_cmp_eq_u32 s75, 129024
  v_mfma_f32_16x16x32_bf16 v[212:215], v[36:39], v[72:75], v[212:215]
  s_cselect_b32 s75, 0, s75
  s_sub_u32 s79, s79, 1
  v_mfma_f32_16x16x32_bf16 v[208:211], v[32:35], v[72:75], v[208:211]
  s_waitcnt lgkmcnt(0)
  s_barrier
  v_mfma_f32_16x16x32_bf16 v[128:131], v[96:99], v[76:79], v[128:131]
  ds_read_b128 v[32:35], v10 offset:0
  v_mfma_f32_16x16x32_bf16 v[132:135], v[96:99], v[80:83], v[132:135]
  ds_read_b128 v[36:39], v10 offset:2048
  v_mfma_f32_16x16x32_bf16 v[136:139], v[96:99], v[84:87], v[136:139]
  ds_read_b128 v[40:43], v10 offset:4096
  v_mfma_f32_16x16x32_bf16 v[140:143], v[96:99], v[88:91], v[140:143]
  ds_read_b128 v[44:47], v10 offset:6144
  v_mfma_f32_16x16x32_bf16 v[224:227], v[96:99], v[92:95], v[224:227]
  ds_read_b128 v[48:51], v14
  v_mfma_f32_16x16x32_bf16 v[156:159], v[100:103], v[88:91], v[156:159]
  ds_read_b64_tr_b16 v[52:53], v12 offset:0
  v_mfma_f32_16x16x32_bf16 v[152:155], v[100:103], v[84:87], v[152:155]
  ds_read_b64_tr_b16 v[54:55], v12 offset:512
  v_mfma_f32_16x16x32_bf16 v[148:151], v[100:103], v[80:83], v[148:151]
  ds_read_b64_tr_b16 v[56:57], v13 offset:0
  v_mfma_f32_16x16x32_bf16 v[144:147], v[100:103], v[76:79], v[144:147]
  ds_read_b64_tr_b16 v[58:59], v13 offset:512
  v_mfma_f32_16x16x32_bf16 v[160:163], v[104:107], v[76:79], v[160:163]
  ds_read_b64_tr_b16 v[60:61], v12 offset:8192
  v_mfma_f32_16x16x32_bf16 v[164:167], v[104:107], v[80:83], v[164:167]
  ds_read_b64_tr_b16 v[62:63], v12 offset:8704
  v_mfma_f32_16x16x32_bf16 v[168:171], v[104:107], v[84:87], v[168:171]
  ds_read_b64_tr_b16 v[64:65], v13 offset:8192
  v_mfma_f32_16x16x32_bf16 v[172:175], v[104:107], v[88:91], v[172:175]
  ds_read_b64_tr_b16 v[66:67], v13 offset:8704
  v_mfma_f32_16x16x32_bf16 v[228:231], v[104:107], v[92:95], v[228:231]
  ds_read_b64_tr_b16 v[68:69], v12 offset:16384
  v_mfma_f32_16x16x32_bf16 v[188:191], v[108:111], v[88:91], v[188:191]
  ds_read_b64_tr_b16 v[70:71], v12 offset:16896
  v_mfma_f32_16x16x32_bf16 v[184:187], v[108:111], v[84:87], v[184:187]
  ds_read_b64_tr_b16 v[72:73], v13 offset:16384
  v_mfma_f32_16x16x32_bf16 v[180:183], v[108:111], v[80:83], v[180:183]
  ds_read_b64_tr_b16 v[74:75], v13 offset:16896
  v_mfma_f32_16x16x32_bf16 v[176:179], v[108:111], v[76:79], v[176:179]
  s_cmp_lg_u32 s79, 0
  s_nop 0
  v_mfma_f32_16x16x32_bf16 v[192:195], v[76:79], v[112:115], v[192:195]
  v_mfma_f32_16x16x32_bf16 v[196:199], v[80:83], v[112:115], v[196:199]
  v_mfma_f32_16x16x32_bf16 v[200:203], v[84:87], v[112:115], v[200:203]
  v_mfma_f32_16x16x32_bf16 v[204:207], v[88:91], v[112:115], v[204:207]
  v_mfma_f32_16x16x32_bf16 v[232:235], v[92:95], v[112:115], v[232:235]
  v_mfma_f32_16x16x32_bf16 v[220:223], v[88:91], v[116:119], v[220:223]
  v_mfma_f32_16x16x32_bf16 v[216:219], v[84:87], v[116:119], v[216:219]
  v_mfma_f32_16x16x32_bf16 v[212:215], v[80:83], v[116:119], v[212:215]
  v_mfma_f32_16x16x32_bf16 v[208:211], v[76:79], v[116:119], v[208:211]
  s_waitcnt lgkmcnt(0)
  s_cbranch_scc1 L_attn_loop
L_attn_lend:
  s_add_u32 s98, s98, 1
  s_cmp_gt_u32 s98, 3
  s_cbranch_scc1 L_attn_exit
  s_cmp_lg_u32 s98, 1
  s_cbranch_scc1 L_attn_hook0
  s_mov_b32 s79, 1
  s_cmp_lg_u32 s72, 0
  s_cbranch_scc1 L_attn_dot0
  v_dot2_f32_bf16 v122, v32, s7, v122
  v_dot2_f32_bf16 v124, v32, v32, v124
  v_dot2_f32_bf16 v123, v36, s7, v123
  v_dot2_f32_bf16 v125, v36, v36, v125
  v_dot2_f32_bf16 v122, v33, s7, v122
  v_dot2_f32_bf16 v124, v33, v33, v124
  v_dot2_f32_bf16 v123, v37, s7, v123
  v_dot2_f32_bf16 v125, v37, v37, v125
  v_dot2_f32_bf16 v122, v34, s7, v122
  v_dot2_f32_bf16 v124, v34, v34, v124
  v_dot2_f32_bf16 v123, v38, s7, v123
  v_dot2_f32_bf16 v125, v38, v38, v125
  v_dot2_f32_bf16 v122, v35, s7, v122
  v_dot2_f32_bf16 v124, v35, v35, v124
  v_dot2_f32_bf16 v123, v39, s7, v123
  v_dot2_f32_bf16 v125, v39, v39, v125
  s_branch L_attn_dote0
  L_attn_dot0:
  v_dot2_f32_bf16 v122, v40, s7, v122
  v_dot2_f32_bf16 v124, v40, v40, v124
  v_dot2_f32_bf16 v123, v44, s7, v123
  v_dot2_f32_bf16 v125, v44, v44, v125
  v_dot2_f32_bf16 v122, v41, s7, v122
  v_dot2_f32_bf16 v124, v41, v41, v124
  v_dot2_f32_bf16 v123, v45, s7, v123
  v_dot2_f32_bf16 v125, v45, v45, v125
  v_dot2_f32_bf16 v122, v42, s7, v122
  v_dot2_f32_bf16 v124, v42, v42, v124
  v_dot2_f32_bf16 v123, v46, s7, v123
  v_dot2_f32_bf16 v125, v46, v46, v125
  v_dot2_f32_bf16 v122, v43, s7, v122
  v_dot2_f32_bf16 v124, v43, v43, v124
  v_dot2_f32_bf16 v123, v47, s7, v123
  v_dot2_f32_bf16 v125, v47, v47, v125
  L_attn_dote0:
  s_cmp_lg_u32 s70, 0
  s_cbranch_scc1 L_attn_loop
  s_waitcnt vmcnt(0)
  s_lshl4_add_u32 s3, s68, s69
  s_mov_b64 exec, 1
  buffer_store_byte v126, off, s[64:67], s3 sc1
  s_mov_b64 exec, -1
  s_branch L_attn_loop
L_attn_hook0:
  s_cmp_lg_u32 s98, 2
  s_cbranch_scc1 L_attn_hook1
  s_and_b32 s79, s69, 3
  s_add_u32 s79, s79, 1
  s_sub_u32 s79, 13, s79
  s_cmp_lg_u32 s72, 0
  s_cbranch_scc1 L_attn_dot1
  v_dot2_f32_bf16 v122, v76, s7, v122
  v_dot2_f32_bf16 v124, v76, v76, v124
  v_dot2_f32_bf16 v123, v80, s7, v123
  v_dot2_f32_bf16 v125, v80, v80, v125
  v_dot2_f32_bf16 v122, v77, s7, v122
  v_dot2_f32_bf16 v124, v77, v77, v124
  v_dot2_f32_bf16 v123, v81, s7, v123
  v_dot2_f32_bf16 v125, v81, v81, v125
  v_dot2_f32_bf16 v122, v78, s7, v122
  v_dot2_f32_bf16 v124, v78, v78, v124
  v_dot2_f32_bf16 v123, v82, s7, v123
  v_dot2_f32_bf16 v125, v82, v82, v125
  v_dot2_f32_bf16 v122, v79, s7, v122
  v_dot2_f32_bf16 v124, v79, v79, v124
  v_dot2_f32_bf16 v123, v83, s7, v123
  v_dot2_f32_bf16 v125, v83, v83, v125
  s_branch L_attn_dote1
  L_attn_dot1:
  v_dot2_f32_bf16 v122, v84, s7, v122
  v_dot2_f32_bf16 v124, v84, v84, v124
  v_dot2_f32_bf16 v123, v88, s7, v123
  v_dot2_f32_bf16 v125, v88, v88, v125
  v_dot2_f32_bf16 v122, v85, s7, v122
  v_dot2_f32_bf16 v124, v85, v85, v124
  v_dot2_f32_bf16 v123, v89, s7, v123
  v_dot2_f32_bf16 v125, v89, v89, v125
  v_dot2_f32_bf16 v122, v86, s7, v122
  v_dot2_f32_bf16 v124, v86, v86, v124
  v_dot2_f32_bf16 v123, v90, s7, v123
  v_dot2_f32_bf16 v125, v90, v90, v125
  v_dot2_f32_bf16 v122, v87, s7, v122
  v_dot2_f32_bf16 v124, v87, v87, v124
  v_dot2_f32_bf16 v123, v91, s7, v123
  v_dot2_f32_bf16 v125, v91, v91, v125
  L_attn_dote1:
  s_nop 2
  v_permlane32_swap_b32 v122, v123
  v_permlane32_swap_b32 v124, v125
  v_add_f32 v122, v122, v123
  v_add_f32 v124, v124, v125
  s_nop 0
  s_nop 0
  v_permlane16_swap_b32 v122, v124
  v_add_f32 v122, v122, v124
  buffer_store_dword v122, v120, s[56:59], 0 offen sc1
  s_branch L_attn_loop
L_attn_hook1:
  s_mov_b32 s79, 2
  s_mov_b32 s36, s16
  s_and_b32 s37, s17, 0xffff
  s_mov_b32 s38, 4194304
  s_mov_b32 s39, 0x00020000
  s_and_b32 s3, s2, 3
  s_and_b32 s4, s99, 3
  s_lshl2_add_u32 s3, s3, s4
  s_lshl2_add_u32 s3, s3, s70
  s_lshl_b32 s3, s3, 16
  s_bfe_u32 s4, s2, 0x10002
  s_lshr_b32 s5, s99, 2
  s_lshl1_add_u32 s4, s5, s4
  s_lshl_b32 s4, s4, 7
  s_add_u32 s3, s3, s4
  s_add_u32 s4, s3, 32768
  v_and_b32 v122, 15, v1
  v_lshlrev_b32 v123, 1, v1
  v_and_b32 v123, 32, v123
  v_lshl_add_u32 v122, v122, 11, v123
  v_lshrrev_b32 v123, 1, v1
  v_and_b32 v123, 16, v123
  v_add_u32 v122, v122, v123
  buffer_load_dwordx4 v[240:243], v122, s[36:39], s3 offen offset:0
  buffer_load_dwordx4 v[244:247], v122, s[36:39], s3 offen offset:64
  buffer_load_dwordx4 v[248:251], v122, s[36:39], s4 offen offset:0
  buffer_load_dwordx4 v[252:255], v122, s[36:39], s4 offen offset:64
  s_branch L_attn_loop
L_attn_exit:
  ds_read2_b32 v[66:67], v23 offset0:0 offset1:160
  ds_read2_b32 v[68:69], v23 offset0:16 offset1:176
  ds_read2_b32 v[70:71], v23 offset0:32 offset1:192
  ds_read2_b32 v[72:73], v23 offset0:48 offset1:208
  ds_read2_b32 v[74:75], v23 offset0:64 offset1:224
  ds_read2_b32 v[76:77], v25 offset0:0 offset1:16
  ds_read2_b32 v[80:81], v26 offset0:0 offset1:16
  ds_read2_b32 v[78:79], v25 offset0:32 offset1:48
  ds_read2_b32 v[82:83], v26 offset0:32 offset1:48
  ds_write_b128 v16, v[224:227] offset:0
  ds_write_b128 v16, v[228:231] offset:2048
  ds_write_b128 v16, v[232:235] offset:4096
  s_cmp_eq_u32 s71, 1
  s_cbranch_scc1 L_attn_nop3
  ds_write_b128 v16, v[172:175] offset:8192
  ds_write_b128 v16, v[188:191] offset:9216
  ds_write_b128 v16, v[204:207] offset:10240
  ds_write_b128 v16, v[220:223] offset:11264
L_attn_nop3:
  ds_read_b128 v[84:87], v24 offset:0
  ds_read_b128 v[104:107], v24 offset:640
  ds_read_b128 v[88:91], v24 offset:64
  ds_read_b128 v[108:111], v24 offset:704
  ds_read_b128 v[92:95], v24 offset:128
  ds_read_b128 v[112:115], v24 offset:768
  ds_read_b128 v[96:99], v24 offset:192
  ds_read_b128 v[116:119], v24 offset:832
  ds_read_b128 v[100:103], v24 offset:256
  ds_read_b128 v[120:123], v24 offset:896
  s_waitcnt lgkmcnt(10)
  s_barrier
  ds_read_b128 v[48:51], v19 offset:0
  ds_read_b128 v[52:55], v20 offset:1024
  ds_read_b128 v[56:59], v19 offset:2048
  ds_read_b128 v[60:63], v20 offset:3072
  ds_read_b32 v64, v21 offset:4096
  ds_read_b32 v65, v22 offset:5120
  ds_read_b128 v[32:35], v17 offset:2048
  ds_read_b128 v[36:39], v18 offset:3072
  ds_read_b128 v[40:43], v17 offset:4096
  ds_read_b128 v[44:47], v18 offset:5120
  v_mul_f32 v69, 0x3e8293ee, v69
  v_mul_f32 v71, 0x3e8293ee, v71
  v_mul_f32 v73, 0x3e8293ee, v73
  v_mul_f32 v75, 0x3e8293ee, v75
  v_mul_f32 v76, v76, v69
  v_mul_f32 v80, v80, v69
  v_mul_f32 v77, v77, v71
  v_mul_f32 v81, v81, v71
  v_mul_f32 v78, v78, v73
  v_mul_f32 v82, v82, v73
  v_mul_f32 v79, v79, v75
  v_mul_f32 v83, v83, v75
  s_waitcnt lgkmcnt(6)
  v_pk_fma_f32 v[128:129], v[48:49], v[68:69], v[128:129] op_sel:[0,0,0] op_sel_hi:[1,0,1] neg_lo:[0,1,0] neg_hi:[0,1,0]
  v_pk_fma_f32 v[130:131], v[50:51], v[68:69], v[130:131] op_sel:[0,0,0] op_sel_hi:[1,0,1] neg_lo:[0,1,0] neg_hi:[0,1,0]
  v_pk_fma_f32 v[144:145], v[52:53], v[68:69], v[144:145] op_sel:[0,0,0] op_sel_hi:[1,0,1] neg_lo:[0,1,0] neg_hi:[0,1,0]
  v_pk_fma_f32 v[146:147], v[54:55], v[68:69], v[146:147] op_sel:[0,0,0] op_sel_hi:[1,0,1] neg_lo:[0,1,0] neg_hi:[0,1,0]
  v_cvt_pk_bf16_f32 v128, v128, v129
  v_cvt_pk_bf16_f32 v129, v130, v131
  v_cvt_pk_bf16_f32 v130, v144, v145
  v_cvt_pk_bf16_f32 v131, v146, v147
  v_pk_fma_f32 v[160:161], v[56:57], v[68:69], v[160:161] op_sel:[0,0,0] op_sel_hi:[1,0,1] neg_lo:[0,1,0] neg_hi:[0,1,0]
  v_pk_fma_f32 v[162:163], v[58:59], v[68:69], v[162:163] op_sel:[0,0,0] op_sel_hi:[1,0,1] neg_lo:[0,1,0] neg_hi:[0,1,0]
  v_pk_fma_f32 v[176:177], v[60:61], v[68:69], v[176:177] op_sel:[0,0,0] op_sel_hi:[1,0,1] neg_lo:[0,1,0] neg_hi:[0,1,0]
  v_pk_fma_f32 v[178:179], v[62:63], v[68:69], v[178:179] op_sel:[0,0,0] op_sel_hi:[1,0,1] neg_lo:[0,1,0] neg_hi:[0,1,0]
  v_cvt_pk_bf16_f32 v160, v160, v161
  v_cvt_pk_bf16_f32 v161, v162, v163
  v_cvt_pk_bf16_f32 v162, v176, v177
  v_cvt_pk_bf16_f32 v163, v178, v179
  v_pk_fma_f32 v[132:133], v[48:49], v[70:71], v[132:133] op_sel:[0,0,0] op_sel_hi:[1,0,1] neg_lo:[0,1,0] neg_hi:[0,1,0]
  v_pk_fma_f32 v[134:135], v[50:51], v[70:71], v[134:135] op_sel:[0,0,0] op_sel_hi:[1,0,1] neg_lo:[0,1,0] neg_hi:[0,1,0]
  v_pk_fma_f32 v[148:149], v[52:53], v[70:71], v[148:149] op_sel:[0,0,0] op_sel_hi:[1,0,1] neg_lo:[0,1,0] neg_hi:[0,1,0]
  v_pk_fma_f32 v[150:151], v[54:55], v[70:71], v[150:151] op_sel:[0,0,0] op_sel_hi:[1,0,1] neg_lo:[0,1,0] neg_hi:[0,1,0]
  v_cvt_pk_bf16_f32 v132, v132, v133
  v_cvt_pk_bf16_f32 v133, v134, v135
  v_cvt_pk_bf16_f32 v134, v148, v149
  v_cvt_pk_bf16_f32 v135, v150, v151
  v_pk_fma_f32 v[164:165], v[56:57], v[70:71], v[164:165] op_sel:[0,0,0] op_sel_hi:[1,0,1] neg_lo:[0,1,0] neg_hi:[0,1,0]
  v_pk_fma_f32 v[166:167], v[58:59], v[70:71], v[166:167] op_sel:[0,0,0] op_sel_hi:[1,0,1] neg_lo:[0,1,0] neg_hi:[0,1,0]
  v_pk_fma_f32 v[180:181], v[60:61], v[70:71], v[180:181] op_sel:[0,0,0] op_sel_hi:[1,0,1] neg_lo:[0,1,0] neg_hi:[0,1,0]
  v_pk_fma_f32 v[182:183], v[62:63], v[70:71], v[182:183] op_sel:[0,0,0] op_sel_hi:[1,0,1] neg_lo:[0,1,0] neg_hi:[0,1,0]
  v_cvt_pk_bf16_f32 v164, v164, v165
  v_cvt_pk_bf16_f32 v165, v166, v167
  v_cvt_pk_bf16_f32 v166, v180, v181
  v_cvt_pk_bf16_f32 v167, v182, v183
  v_mfma_f32_16x16x32_bf16 v[144:147], v[160:163], v[128:131], 0
  v_pk_fma_f32 v[136:137], v[48:49], v[72:73], v[136:137] op_sel:[0,0,0] op_sel_hi:[1,0,1] neg_lo:[0,1,0] neg_hi:[0,1,0]
  v_pk_fma_f32 v[138:139], v[50:51], v[72:73], v[138:139] op_sel:[0,0,0] op_sel_hi:[1,0,1] neg_lo:[0,1,0] neg_hi:[0,1,0]
  v_pk_fma_f32 v[152:153], v[52:53], v[72:73], v[152:153] op_sel:[0,0,0] op_sel_hi:[1,0,1] neg_lo:[0,1,0] neg_hi:[0,1,0]
  v_pk_fma_f32 v[154:155], v[54:55], v[72:73], v[154:155] op_sel:[0,0,0] op_sel_hi:[1,0,1] neg_lo:[0,1,0] neg_hi:[0,1,0]
  v_cvt_pk_bf16_f32 v136, v136, v137
  v_cvt_pk_bf16_f32 v137, v138, v139
  v_cvt_pk_bf16_f32 v138, v152, v153
  v_cvt_pk_bf16_f32 v139, v154, v155
  v_pk_fma_f32 v[168:169], v[56:57], v[72:73], v[168:169] op_sel:[0,0,0] op_sel_hi:[1,0,1] neg_lo:[0,1,0] neg_hi:[0,1,0]
  v_pk_fma_f32 v[170:171], v[58:59], v[72:73], v[170:171] op_sel:[0,0,0] op_sel_hi:[1,0,1] neg_lo:[0,1,0] neg_hi:[0,1,0]
  v_pk_fma_f32 v[184:185], v[60:61], v[72:73], v[184:185] op_sel:[0,0,0] op_sel_hi:[1,0,1] neg_lo:[0,1,0] neg_hi:[0,1,0]
  v_pk_fma_f32 v[186:187], v[62:63], v[72:73], v[186:187] op_sel:[0,0,0] op_sel_hi:[1,0,1] neg_lo:[0,1,0] neg_hi:[0,1,0]
  v_cvt_pk_bf16_f32 v168, v168, v169
  v_cvt_pk_bf16_f32 v169, v170, v171
  v_cvt_pk_bf16_f32 v170, v184, v185
  v_cvt_pk_bf16_f32 v171, v186, v187
  v_mfma_f32_16x16x32_bf16 v[148:151], v[164:167], v[132:135], 0
  v_mfma_f32_16x16x32_bf16 v[180:183], v[160:163], v[132:135], 0
  v_pk_fma_f32 v[140:141], v[48:49], v[74:75], v[140:141] op_sel:[0,0,0] op_sel_hi:[1,0,1] neg_lo:[0,1,0] neg_hi:[0,1,0]
  v_pk_fma_f32 v[142:143], v[50:51], v[74:75], v[142:143] op_sel:[0,0,0] op_sel_hi:[1,0,1] neg_lo:[0,1,0] neg_hi:[0,1,0]
  v_pk_fma_f32 v[156:157], v[52:53], v[74:75], v[156:157] op_sel:[0,0,0] op_sel_hi:[1,0,1] neg_lo:[0,1,0] neg_hi:[0,1,0]
  v_pk_fma_f32 v[158:159], v[54:55], v[74:75], v[158:159] op_sel:[0,0,0] op_sel_hi:[1,0,1] neg_lo:[0,1,0] neg_hi:[0,1,0]
  v_cvt_pk_bf16_f32 v140, v140, v141
  v_cvt_pk_bf16_f32 v141, v142, v143
  v_cvt_pk_bf16_f32 v142, v156, v157
  v_cvt_pk_bf16_f32 v143, v158, v159
  v_pk_fma_f32 v[172:173], v[56:57], v[74:75], v[172:173] op_sel:[0,0,0] op_sel_hi:[1,0,1] neg_lo:[0,1,0] neg_hi:[0,1,0]
  v_pk_fma_f32 v[174:175], v[58:59], v[74:75], v[174:175] op_sel:[0,0,0] op_sel_hi:[1,0,1] neg_lo:[0,1,0] neg_hi:[0,1,0]
  v_pk_fma_f32 v[188:189], v[60:61], v[74:75], v[188:189] op_sel:[0,0,0] op_sel_hi:[1,0,1] neg_lo:[0,1,0] neg_hi:[0,1,0]
  v_pk_fma_f32 v[190:191], v[62:63], v[74:75], v[190:191] op_sel:[0,0,0] op_sel_hi:[1,0,1] neg_lo:[0,1,0] neg_hi:[0,1,0]
  v_cvt_pk_bf16_f32 v172, v172, v173
  v_cvt_pk_bf16_f32 v173, v174, v175
  v_cvt_pk_bf16_f32 v174, v188, v189
  v_cvt_pk_bf16_f32 v175, v190, v191
  s_waitcnt lgkmcnt(0)
  v_pk_fma_f32 v[32:33], v[56:57], v[66:67], v[32:33] op_sel:[0,0,0] op_sel_hi:[1,0,1] neg_lo:[0,1,0] neg_hi:[0,1,0]
  v_pk_fma_f32 v[34:35], v[58:59], v[66:67], v[34:35] op_sel:[0,0,0] op_sel_hi:[1,0,1] neg_lo:[0,1,0] neg_hi:[0,1,0]
  v_pk_fma_f32 v[36:37], v[60:61], v[66:67], v[36:37] op_sel:[0,0,0] op_sel_hi:[1,0,1] neg_lo:[0,1,0] neg_hi:[0,1,0]
  v_pk_fma_f32 v[38:39], v[62:63], v[66:67], v[38:39] op_sel:[0,0,0] op_sel_hi:[1,0,1] neg_lo:[0,1,0] neg_hi:[0,1,0]
  v_cvt_pk_bf16_f32 v32, v32, v33
  v_cvt_pk_bf16_f32 v33, v34, v35
  v_cvt_pk_bf16_f32 v34, v36, v37
  v_cvt_pk_bf16_f32 v35, v38, v39
  v_mfma_f32_16x16x32_bf16 v[152:155], v[168:171], v[136:139], 0
  v_mfma_f32_16x16x32_bf16 v[184:187], v[164:167], v[136:139], 0
  v_mfma_f32_16x16x32_bf16 v[156:159], v[172:175], v[140:143], 0
  v_mfma_f32_16x16x32_bf16 v[188:191], v[168:171], v[140:143], 0
  v_mfma_f32_16x16x32_bf16 v[176:179], v[32:35], v[128:131], 0
  v_pk_fma_f32 v[40:41], v[84:85], v[64:65], v[40:41] op_sel:[0,0,0] op_sel_hi:[1,0,1] neg_lo:[1,0,0] neg_hi:[1,0,0]
  v_pk_fma_f32 v[42:43], v[86:87], v[64:65], v[42:43] op_sel:[0,0,0] op_sel_hi:[1,0,1] neg_lo:[1,0,0] neg_hi:[1,0,0]
  v_pk_mul_f32 v[40:41], v[40:41], v[104:105]
  v_pk_mul_f32 v[42:43], v[42:43], v[106:107]
  v_cvt_pk_bf16_f32 v4, v40, v41
  v_cvt_pk_bf16_f32 v5, v42, v43
  v_pk_fma_f32 v[192:193], v[88:89], v[64:65], v[192:193] op_sel:[0,0,0] op_sel_hi:[1,0,1] neg_lo:[1,0,0] neg_hi:[1,0,0]
  v_pk_fma_f32 v[194:195], v[90:91], v[64:65], v[194:195] op_sel:[0,0,0] op_sel_hi:[1,0,1] neg_lo:[1,0,0] neg_hi:[1,0,0]
  v_pk_mul_f32 v[192:193], v[192:193], v[108:109]
  v_pk_mul_f32 v[194:195], v[194:195], v[110:111]
  v_cvt_pk_bf16_f32 v6, v192, v193
  v_cvt_pk_bf16_f32 v7, v194, v195
  v_pk_fma_f32 v[196:197], v[92:93], v[64:65], v[196:197] op_sel:[0,0,0] op_sel_hi:[1,0,1] neg_lo:[1,0,0] neg_hi:[1,0,0]
  v_pk_fma_f32 v[198:199], v[94:95], v[64:65], v[198:199] op_sel:[0,0,0] op_sel_hi:[1,0,1] neg_lo:[1,0,0] neg_hi:[1,0,0]
  v_pk_mul_f32 v[196:197], v[196:197], v[112:113]
  v_pk_mul_f32 v[198:199], v[198:199], v[114:115]
  v_cvt_pk_bf16_f32 v8, v196, v197
  v_cvt_pk_bf16_f32 v9, v198, v199
  v_pk_fma_f32 v[200:201], v[96:97], v[64:65], v[200:201] op_sel:[0,0,0] op_sel_hi:[1,0,1] neg_lo:[1,0,0] neg_hi:[1,0,0]
  v_pk_fma_f32 v[202:203], v[98:99], v[64:65], v[202:203] op_sel:[0,0,0] op_sel_hi:[1,0,1] neg_lo:[1,0,0] neg_hi:[1,0,0]
  v_pk_mul_f32 v[200:201], v[200:201], v[116:117]
  v_pk_mul_f32 v[202:203], v[202:203], v[118:119]
  v_cvt_pk_bf16_f32 v10, v200, v201
  v_cvt_pk_bf16_f32 v11, v202, v203
  v_pk_fma_f32 v[204:205], v[100:101], v[64:65], v[204:205] op_sel:[0,0,0] op_sel_hi:[1,0,1] neg_lo:[1,0,0] neg_hi:[1,0,0]
  v_pk_fma_f32 v[206:207], v[102:103], v[64:65], v[206:207] op_sel:[0,0,0] op_sel_hi:[1,0,1] neg_lo:[1,0,0] neg_hi:[1,0,0]
  v_pk_mul_f32 v[204:205], v[204:205], v[120:121]
  v_pk_mul_f32 v[206:207], v[206:207], v[122:123]
  v_cvt_pk_bf16_f32 v12, v204, v205
  v_cvt_pk_bf16_f32 v13, v206, v207
  v_pk_fma_f32 v[44:45], v[84:85], v[64:65], v[44:45] op_sel:[0,1,0] op_sel_hi:[1,1,1] neg_lo:[1,0,0] neg_hi:[1,0,0]
  v_pk_fma_f32 v[46:47], v[86:87], v[64:65], v[46:47] op_sel:[0,1,0] op_sel_hi:[1,1,1] neg_lo:[1,0,0] neg_hi:[1,0,0]
  v_pk_mul_f32 v[44:45], v[44:45], v[104:105]
  v_pk_mul_f32 v[46:47], v[46:47], v[106:107]
  v_cvt_pk_bf16_f32 v224, v44, v45
  v_cvt_pk_bf16_f32 v225, v46, v47
  v_pk_fma_f32 v[208:209], v[88:89], v[64:65], v[208:209] op_sel:[0,1,0] op_sel_hi:[1,1,1] neg_lo:[1,0,0] neg_hi:[1,0,0]
  v_pk_fma_f32 v[210:211], v[90:91], v[64:65], v[210:211] op_sel:[0,1,0] op_sel_hi:[1,1,1] neg_lo:[1,0,0] neg_hi:[1,0,0]
  v_pk_mul_f32 v[208:209], v[208:209], v[108:109]
  v_pk_mul_f32 v[210:211], v[210:211], v[110:111]
  v_cvt_pk_bf16_f32 v226, v208, v209
  v_cvt_pk_bf16_f32 v227, v210, v211
  v_pk_fma_f32 v[212:213], v[92:93], v[64:65], v[212:213] op_sel:[0,1,0] op_sel_hi:[1,1,1] neg_lo:[1,0,0] neg_hi:[1,0,0]
  v_pk_fma_f32 v[214:215], v[94:95], v[64:65], v[214:215] op_sel:[0,1,0] op_sel_hi:[1,1,1] neg_lo:[1,0,0] neg_hi:[1,0,0]
  v_pk_mul_f32 v[212:213], v[212:213], v[112:113]
  v_pk_mul_f32 v[214:215], v[214:215], v[114:115]
  v_cvt_pk_bf16_f32 v228, v212, v213
  v_cvt_pk_bf16_f32 v229, v214, v215
  v_pk_fma_f32 v[216:217], v[96:97], v[64:65], v[216:217] op_sel:[0,1,0] op_sel_hi:[1,1,1] neg_lo:[1,0,0] neg_hi:[1,0,0]
  v_pk_fma_f32 v[218:219], v[98:99], v[64:65], v[218:219] op_sel:[0,1,0] op_sel_hi:[1,1,1] neg_lo:[1,0,0] neg_hi:[1,0,0]
  v_pk_mul_f32 v[216:217], v[216:217], v[116:117]
  v_pk_mul_f32 v[218:219], v[218:219], v[118:119]
  v_cvt_pk_bf16_f32 v230, v216, v217
  v_cvt_pk_bf16_f32 v231, v218, v219
  v_pk_fma_f32 v[220:221], v[100:101], v[64:65], v[220:221] op_sel:[0,1,0] op_sel_hi:[1,1,1] neg_lo:[1,0,0] neg_hi:[1,0,0]
  v_pk_fma_f32 v[222:223], v[102:103], v[64:65], v[222:223] op_sel:[0,1,0] op_sel_hi:[1,1,1] neg_lo:[1,0,0] neg_hi:[1,0,0]
  v_pk_mul_f32 v[220:221], v[220:221], v[120:121]
  v_pk_mul_f32 v[222:223], v[222:223], v[122:123]
  v_cvt_pk_bf16_f32 v232, v220, v221
  v_cvt_pk_bf16_f32 v233, v222, v223
  v_cndmask_b32 v148, v148, v149, s[48:49]
  v_cndmask_b32 v180, v180, v181, s[48:49]
  v_cndmask_b32 v150, v150, v151, s[48:49]
  v_cndmask_b32 v182, v182, v183, s[48:49]
  v_cndmask_b32 v36, v148, v180, s[50:51]
  v_cndmask_b32 v37, v150, v182, s[52:53]
  v_mul_f32 v36, v36, v77
  v_mul_f32 v37, v37, v81
  v_cndmask_b32 v152, v152, v153, s[48:49]
  v_cndmask_b32 v184, v184, v185, s[48:49]
  v_cndmask_b32 v154, v154, v155, s[48:49]
  v_cndmask_b32 v186, v186, v187, s[48:49]
  v_cndmask_b32 v40, v152, v184, s[50:51]
  v_cndmask_b32 v41, v154, v186, s[52:53]
  v_mul_f32 v40, v40, v78
  v_mul_f32 v41, v41, v82
  v_cndmask_b32 v156, v156, v157, s[48:49]
  v_cndmask_b32 v188, v188, v189, s[48:49]
  v_cndmask_b32 v158, v158, v159, s[48:49]
  v_cndmask_b32 v190, v190, v191, s[48:49]
  v_cndmask_b32 v44, v156, v188, s[50:51]
  v_cndmask_b32 v45, v158, v190, s[52:53]
  v_mul_f32 v44, v44, v79
  v_mul_f32 v45, v45, v83
  v_cndmask_b32 v144, v144, v145, s[48:49]
  v_cndmask_b32 v176, v176, v177, s[48:49]
  v_cndmask_b32 v146, v146, v147, s[48:49]
  v_cndmask_b32 v178, v178, v179, s[48:49]
  v_cndmask_b32 v32, v144, v176, s[50:51]
  v_cndmask_b32 v33, v146, v178, s[52:53]
  v_mul_f32 v32, v32, v76
  v_mul_f32 v33, v33, v80
  v_mov_b32 v48, 0xceabfb8f
  v_cndmask_b32 v32, v32, v48, s[54:55]
  v_cndmask_b32 v33, v33, v48, s[14:15]
  v_max_f32 v34, v32, v33
  v_max_f32 v38, v36, v37
  v_max_f32 v42, v40, v41
  v_max_f32 v46, v44, v45
  v_mov_b32 v35, v34
  v_mov_b32 v39, v38
  v_mov_b32 v43, v42
  v_mov_b32 v47, v46
  v_permlane32_swap_b32 v34, v35
  v_permlane32_swap_b32 v38, v39
  v_permlane32_swap_b32 v42, v43
  v_permlane32_swap_b32 v46, v47
  v_max_f32 v34, v34, v35
  v_max_f32 v38, v38, v39
  v_max_f32 v42, v42, v43
  v_max_f32 v46, v46, v47
  v_mov_b32 v35, v34
  v_mov_b32 v39, v38
  v_mov_b32 v43, v42
  v_mov_b32 v47, v46
  v_permlane16_swap_b32 v34, v35
  v_permlane16_swap_b32 v38, v39
  v_permlane16_swap_b32 v42, v43
  v_permlane16_swap_b32 v46, v47
  v_max_f32 v34, v34, v35
  v_max_f32 v38, v38, v39
  v_max_f32 v42, v42, v43
  v_max_f32 v46, v46, v47
  v_sub_f32 v32, v32, v34
  v_sub_f32 v33, v33, v34
  v_sub_f32 v36, v36, v38
  v_sub_f32 v37, v37, v38
  v_sub_f32 v40, v40, v42
  v_sub_f32 v41, v41, v42
  v_sub_f32 v44, v44, v46
  v_sub_f32 v45, v45, v46
  v_exp_f32 v32, v32
  v_exp_f32 v33, v33
  v_exp_f32 v36, v36
  v_exp_f32 v37, v37
  v_exp_f32 v40, v40
  v_exp_f32 v41, v41
  v_exp_f32 v44, v44
  v_exp_f32 v45, v45
  v_cvt_pk_bf16_f32 v32, v32, v32
  v_cvt_pk_bf16_f32 v33, v33, v33
  v_and_b32 v128, v32, v27
  v_and_b32 v129, v33, v29
  v_and_b32 v130, v32, v28
  v_and_b32 v131, v33, v30
  v_cvt_pk_bf16_f32 v36, v36, v36
  v_cvt_pk_bf16_f32 v37, v37, v37
  v_and_b32 v132, v36, v27
  v_and_b32 v133, v37, v29
  v_and_b32 v134, v36, v28
  v_and_b32 v135, v37, v30
  v_mfma_f32_16x16x32_bf16 v[144:147], v[236:239], v[128:131], 0
  v_mfma_f32_16x16x32_bf16 v[192:195], v[4:7], v[128:131], 0
  v_mfma_f32_16x16x32_bf16 v[208:211], v[224:227], v[128:131], 0
  v_cvt_pk_bf16_f32 v40, v40, v40
  v_cvt_pk_bf16_f32 v41, v41, v41
  v_and_b32 v136, v40, v27
  v_and_b32 v137, v41, v29
  v_and_b32 v138, v40, v28
  v_and_b32 v139, v41, v30
  v_mfma_f32_16x16x32_bf16 v[148:151], v[236:239], v[132:135], 0
  v_mfma_f32_16x16x32_bf16 v[196:199], v[6:9], v[132:135], 0
  v_mfma_f32_16x16x32_bf16 v[212:215], v[226:229], v[132:135], 0
  v_cvt_pk_bf16_f32 v44, v44, v44
  v_cvt_pk_bf16_f32 v45, v45, v45
  v_and_b32 v140, v44, v27
  v_and_b32 v141, v45, v29
  v_and_b32 v142, v44, v28
  v_and_b32 v143, v45, v30
  v_mfma_f32_16x16x32_bf16 v[152:155], v[236:239], v[136:139], 0
  v_mfma_f32_16x16x32_bf16 v[200:203], v[8:11], v[136:139], 0
  v_mfma_f32_16x16x32_bf16 v[216:219], v[228:231], v[136:139], 0
  v_mfma_f32_16x16x32_bf16 v[156:159], v[236:239], v[140:143], 0
  v_mfma_f32_16x16x32_bf16 v[204:207], v[10:13], v[140:143], 0
  v_mfma_f32_16x16x32_bf16 v[220:223], v[230:233], v[140:143], 0
  s_cmp_eq_u32 s71, 1
  s_cbranch_scc1 L_attn_out1
  v_rcp_f32 v144, v144
  s_mov_b32 s3, 0
  v_pk_mul_f32 v[192:193], v[192:193], v[144:145] op_sel_hi:[1,0]
  v_pk_mul_f32 v[194:195], v[194:195], v[144:145] op_sel_hi:[1,0]
  v_pk_mul_f32 v[208:209], v[208:209], v[144:145] op_sel_hi:[1,0]
  v_pk_mul_f32 v[210:211], v[210:211], v[144:145] op_sel_hi:[1,0]
  v_cvt_pk_bf16_f32 v48, v192, v193
  v_cvt_pk_bf16_f32 v49, v194, v195
  v_cvt_pk_bf16_f32 v50, v208, v209
  v_cvt_pk_bf16_f32 v51, v210, v211
  buffer_store_dwordx4 v[48:51], v31, s[44:47], s3 offen sc1
  v_rcp_f32 v148, v148
  s_mov_b32 s3, 114688
  v_pk_mul_f32 v[196:197], v[196:197], v[148:149] op_sel_hi:[1,0]
  v_pk_mul_f32 v[198:199], v[198:199], v[148:149] op_sel_hi:[1,0]
  v_pk_mul_f32 v[212:213], v[212:213], v[148:149] op_sel_hi:[1,0]
  v_pk_mul_f32 v[214:215], v[214:215], v[148:149] op_sel_hi:[1,0]
  v_cvt_pk_bf16_f32 v52, v196, v197
  v_cvt_pk_bf16_f32 v53, v198, v199
  v_cvt_pk_bf16_f32 v54, v212, v213
  v_cvt_pk_bf16_f32 v55, v214, v215
  buffer_store_dwordx4 v[52:55], v31, s[44:47], s3 offen sc1
  v_rcp_f32 v152, v152
  s_mov_b32 s3, 229376
  v_pk_mul_f32 v[200:201], v[200:201], v[152:153] op_sel_hi:[1,0]
  v_pk_mul_f32 v[202:203], v[202:203], v[152:153] op_sel_hi:[1,0]
  v_pk_mul_f32 v[216:217], v[216:217], v[152:153] op_sel_hi:[1,0]
  v_pk_mul_f32 v[218:219], v[218:219], v[152:153] op_sel_hi:[1,0]
  v_cvt_pk_bf16_f32 v56, v200, v201
  v_cvt_pk_bf16_f32 v57, v202, v203
  v_cvt_pk_bf16_f32 v58, v216, v217
  v_cvt_pk_bf16_f32 v59, v218, v219
  buffer_store_dwordx4 v[56:59], v31, s[44:47], s3 offen sc1
  v_rcp_f32 v156, v156
  s_mov_b32 s3, 344064
  v_pk_mul_f32 v[204:205], v[204:205], v[156:157] op_sel_hi:[1,0]
  v_pk_mul_f32 v[206:207], v[206:207], v[156:157] op_sel_hi:[1,0]
  v_pk_mul_f32 v[220:221], v[220:221], v[156:157] op_sel_hi:[1,0]
  v_pk_mul_f32 v[222:223], v[222:223], v[156:157] op_sel_hi:[1,0]
  v_cvt_pk_bf16_f32 v60, v204, v205
  v_cvt_pk_bf16_f32 v61, v206, v207
  v_cvt_pk_bf16_f32 v62, v220, v221
  v_cvt_pk_bf16_f32 v63, v222, v223
  buffer_store_dwordx4 v[60:63], v31, s[44:47], s3 offen sc1
  s_branch L_attn_out2
L_attn_out1:
  v_rcp_f32 v144, v144
  s_mov_b32 s3, 0
  v_pk_mul_f32 v[192:193], v[192:193], v[144:145] op_sel_hi:[1,0]
  v_pk_mul_f32 v[194:195], v[194:195], v[144:145] op_sel_hi:[1,0]
  v_pk_mul_f32 v[208:209], v[208:209], v[144:145] op_sel_hi:[1,0]
  v_pk_mul_f32 v[210:211], v[210:211], v[144:145] op_sel_hi:[1,0]
  v_cvt_pk_bf16_f32 v50, v192, v193
  v_cvt_pk_bf16_f32 v51, v194, v195
  v_cvt_pk_bf16_f32 v48, v208, v209
  v_cvt_pk_bf16_f32 v49, v210, v211
  buffer_store_dwordx4 v[48:51], v31, s[44:47], s3 offen sc1
  v_rcp_f32 v148, v148
  s_mov_b32 s3, 114688
  v_pk_mul_f32 v[196:197], v[196:197], v[148:149] op_sel_hi:[1,0]
  v_pk_mul_f32 v[198:199], v[198:199], v[148:149] op_sel_hi:[1,0]
  v_pk_mul_f32 v[212:213], v[212:213], v[148:149] op_sel_hi:[1,0]
  v_pk_mul_f32 v[214:215], v[214:215], v[148:149] op_sel_hi:[1,0]
  v_cvt_pk_bf16_f32 v54, v196, v197
  v_cvt_pk_bf16_f32 v55, v198, v199
  v_cvt_pk_bf16_f32 v52, v212, v213
  v_cvt_pk_bf16_f32 v53, v214, v215
  buffer_store_dwordx4 v[52:55], v31, s[44:47], s3 offen sc1
  v_rcp_f32 v152, v152
  s_mov_b32 s3, 229376
  v_pk_mul_f32 v[200:201], v[200:201], v[152:153] op_sel_hi:[1,0]
  v_pk_mul_f32 v[202:203], v[202:203], v[152:153] op_sel_hi:[1,0]
  v_pk_mul_f32 v[216:217], v[216:217], v[152:153] op_sel_hi:[1,0]
  v_pk_mul_f32 v[218:219], v[218:219], v[152:153] op_sel_hi:[1,0]
  v_cvt_pk_bf16_f32 v58, v200, v201
  v_cvt_pk_bf16_f32 v59, v202, v203
  v_cvt_pk_bf16_f32 v56, v216, v217
  v_cvt_pk_bf16_f32 v57, v218, v219
  buffer_store_dwordx4 v[56:59], v31, s[44:47], s3 offen sc1
  v_rcp_f32 v156, v156
  s_mov_b32 s3, 344064
  v_pk_mul_f32 v[204:205], v[204:205], v[156:157] op_sel_hi:[1,0]
  v_pk_mul_f32 v[206:207], v[206:207], v[156:157] op_sel_hi:[1,0]
  v_pk_mul_f32 v[220:221], v[220:221], v[156:157] op_sel_hi:[1,0]
  v_pk_mul_f32 v[222:223], v[222:223], v[156:157] op_sel_hi:[1,0]
  v_cvt_pk_bf16_f32 v62, v204, v205
  v_cvt_pk_bf16_f32 v63, v206, v207
  v_cvt_pk_bf16_f32 v60, v220, v221
  v_cvt_pk_bf16_f32 v61, v222, v223
  buffer_store_dwordx4 v[60:63], v31, s[44:47], s3 offen sc1
L_attn_out2:
  s_waitcnt vmcnt(0) lgkmcnt(0)
  s_barrier
  s_add_u32 s97, s97, 1
  s_branch L_wo_body
.section .rodata,"a"
.p2align 6
.amdhsa_kernel interleave_layers__sliding_local_dilated__dense_activation_gelu__prompt_kernel
  .amdhsa_next_free_vgpr 256
  .amdhsa_next_free_sgpr 102
  .amdhsa_accum_offset 256
  .amdhsa_group_segment_fixed_size 0
  .amdhsa_kernarg_size 88
  .amdhsa_user_sgpr_count 2
  .amdhsa_user_sgpr_kernarg_segment_ptr 1
  .amdhsa_system_sgpr_workgroup_id_x 1
  .amdhsa_float_denorm_mode_32 3
  .amdhsa_float_denorm_mode_16_64 3
.end_amdhsa_kernel
.text
L_attn_c1:
L_wo_c0:
L_wo_body:
  s_cmp_ge_u32 s2, 256
  s_cbranch_scc1 L_wo_end
  v_lshrrev_b32 v2, 6, v0
  v_and_b32 v1, 63, v0
  v_readfirstlane_b32 s70, v2
  s_and_b32 s3, s2, 7
  s_lshr_b32 s99, s2, 3
  s_and_b32 s5, s3, 3
  s_lshl_b32 s5, s5, 2
  s_and_b32 s6, s99, 3
  s_add_u32 s68, s5, s6
  s_lshr_b32 s5, s3, 2
  s_lshr_b32 s78, s99, 2
  s_lshl1_add_u32 s69, s78, s5
  s_add_u32 s3, s68, s78
  s_lshl_b32 s3, s3, 3
  s_lshl_b32 s85, 0xffff02, s3
  s_sub_u32 s3, 0, s3
  s_lshr_b32 s3, 0xffff02, s3
  s_or_b32 s85, s85, s3
  s_cmp_lt_u32 s70, 4
  s_cbranch_scc1 L_wo_compute
L_wo_loader:
  s_add_u32 s3, s96, s70
  s_cmp_lg_u32 s3, 4
  s_cbranch_scc1 L_wo_chk0
  s_load_dwordx2 s[64:65], s[0:1], 72
  s_waitcnt lgkmcnt(0)
  s_and_b32 s65, s65, 0xffff
  s_mov_b32 s66, 256
  s_mov_b32 s67, 0x00020000
  v_lshlrev_b32 v17, 2, v1
  buffer_load_dword v12, v17, s[64:67], 0 offen sc1
L_wo_chk0:
  s_cmp_lg_u32 s96, 0
  s_cbranch_scc1 L_wo_nofirst
  s_waitcnt vmcnt(1)
  s_mov_b32 s7, 0xffff0000
  v_lshlrev_b32 v32, 16, v64
  v_and_b32 v33, s7, v64
  v_lshlrev_b32 v34, 16, v65
  v_and_b32 v35, s7, v65
  v_lshlrev_b32 v36, 16, v66
  v_and_b32 v37, s7, v66
  v_lshlrev_b32 v38, 16, v67
  v_and_b32 v39, s7, v67
  v_lshlrev_b32 v40, 16, v68
  v_and_b32 v41, s7, v68
  v_pk_add_f32 v[32:33], v[32:33], v[40:41]
  v_lshlrev_b32 v40, 16, v69
  v_and_b32 v41, s7, v69
  v_pk_add_f32 v[34:35], v[34:35], v[40:41]
  v_lshlrev_b32 v40, 16, v70
  v_and_b32 v41, s7, v70
  v_pk_add_f32 v[36:37], v[36:37], v[40:41]
  v_lshlrev_b32 v40, 16, v71
  v_and_b32 v41, s7, v71
  v_pk_add_f32 v[38:39], v[38:39], v[40:41]
  v_lshlrev_b32 v40, 16, v72
  v_and_b32 v41, s7, v72
  v_pk_add_f32 v[32:33], v[32:33], v[40:41]
  v_lshlrev_b32 v40, 16, v73
  v_and_b32 v41, s7, v73
  v_pk_add_f32 v[34:35], v[34:35], v[40:41]
  v_lshlrev_b32 v40, 16, v74
  v_and_b32 v41, s7, v74
  v_pk_add_f32 v[36:37], v[36:37], v[40:41]
  v_lshlrev_b32 v40, 16, v75
  v_and_b32 v41, s7, v75
  v_pk_add_f32 v[38:39], v[38:39], v[40:41]
  v_lshlrev_b32 v40, 16, v76
  v_and_b32 v41, s7, v76
  v_pk_add_f32 v[32:33], v[32:33], v[40:41]
  v_lshlrev_b32 v40, 16, v77
  v_and_b32 v41, s7, v77
  v_pk_add_f32 v[34:35], v[34:35], v[40:41]
  v_lshlrev_b32 v40, 16, v78
  v_and_b32 v41, s7, v78
  v_pk_add_f32 v[36:37], v[36:37], v[40:41]
  v_lshlrev_b32 v40, 16, v79
  v_and_b32 v41, s7, v79
  v_pk_add_f32 v[38:39], v[38:39], v[40:41]
  v_lshlrev_b32 v40, 16, v80
  v_and_b32 v41, s7, v80
  v_pk_add_f32 v[32:33], v[32:33], v[40:41]
  v_lshlrev_b32 v40, 16, v81
  v_and_b32 v41, s7, v81
  v_pk_add_f32 v[34:35], v[34:35], v[40:41]
  v_lshlrev_b32 v40, 16, v82
  v_and_b32 v41, s7, v82
  v_pk_add_f32 v[36:37], v[36:37], v[40:41]
  v_lshlrev_b32 v40, 16, v83
  v_and_b32 v41, s7, v83
  v_pk_add_f32 v[38:39], v[38:39], v[40:41]
  v_lshlrev_b32 v40, 16, v84
  v_and_b32 v41, s7, v84
  v_pk_add_f32 v[32:33], v[32:33], v[40:41]
  v_lshlrev_b32 v40, 16, v85
  v_and_b32 v41, s7, v85
  v_pk_add_f32 v[34:35], v[34:35], v[40:41]
  v_lshlrev_b32 v40, 16, v86
  v_and_b32 v41, s7, v86
  v_pk_add_f32 v[36:37], v[36:37], v[40:41]
  v_lshlrev_b32 v40, 16, v87
  v_and_b32 v41, s7, v87
  v_pk_add_f32 v[38:39], v[38:39], v[40:41]
  v_lshlrev_b32 v40, 16, v88
  v_and_b32 v41, s7, v88
  v_pk_add_f32 v[32:33], v[32:33], v[40:41]
  v_lshlrev_b32 v40, 16, v89
  v_and_b32 v41, s7, v89
  v_pk_add_f32 v[34:35], v[34:35], v[40:41]
  v_lshlrev_b32 v40, 16, v90
  v_and_b32 v41, s7, v90
  v_pk_add_f32 v[36:37], v[36:37], v[40:41]
  v_lshlrev_b32 v40, 16, v91
  v_and_b32 v41, s7, v91
  v_pk_add_f32 v[38:39], v[38:39], v[40:41]
  v_lshlrev_b32 v40, 16, v92
  v_and_b32 v41, s7, v92
  v_pk_add_f32 v[32:33], v[32:33], v[40:41]
  v_lshlrev_b32 v40, 16, v93
  v_and_b32 v41, s7, v93
  v_pk_add_f32 v[34:35], v[34:35], v[40:41]
  v_lshlrev_b32 v40, 16, v94
  v_and_b32 v41, s7, v94
  v_pk_add_f32 v[36:37], v[36:37], v[40:41]
  v_lshlrev_b32 v40, 16, v95
  v_and_b32 v41, s7, v95
  v_pk_add_f32 v[38:39], v[38:39], v[40:41]
  s_add_u32 s52, s22, 24641536
  s_addc_u32 s53, s23, 0
  s_and_b32 s53, s53, 0xffff
  s_mov_b32 s54, 262144
  s_mov_b32 s55, 0x00020000
  v_permlane32_swap_b32 v32, v36
  v_permlane32_swap_b32 v33, v37
  v_permlane32_swap_b32 v34, v38
  v_permlane32_swap_b32 v35, v39
  v_add_f32 v32, v32, v36
  v_add_f32 v33, v33, v37
  v_add_f32 v34, v34, v38
  v_add_f32 v35, v35, v39
  v_and_b32 v2, 7, v1
  v_lshlrev_b32 v2, 5, v2
  v_permlane16_swap_b32 v32, v34
  v_permlane16_swap_b32 v33, v35
  v_add_f32 v32, v32, v34
  v_add_f32 v33, v33, v35
  v_lshrrev_b32 v3, 4, v1
  v_lshl_add_u32 v2, v3, 3, v2
  v_add_f32_dpp v32, v32, v32 row_ror:8 row_mask:0xf bank_mask:0xf
  v_add_f32_dpp v33, v33, v33 row_ror:8 row_mask:0xf bank_mask:0xf
  buffer_store_dwordx2 v[32:33], v2, s[52:55], s94 offen sc1
L_wo_nofirst:
  v_and_b32 v2, 3, v1
  v_lshlrev_b32 v2, 3, v2
  v_bfe_i32 v16, s85, v2, 8
  s_and_b32 s3, s68, 3
  s_mul_i32 s4, s3, 4
  v_add3_u32 v3, v16, v1, s4
  v_and_b32 v3, 15, v3
  v_lshlrev_b32 v16, 17, v3
  s_add_u32 s9, s70, s68
  s_and_b32 s9, s9, 3
  s_lshl_b32 s77, s9, 11
  v_and_b32 v10, 7, v1
  v_lshrrev_b32 v3, 3, v1
  s_lshl_b32 s10, s9, 4
  v_add_u32 v3, s10, v3
  v_mul_u32_u24 v3, 2048, v3
  v_lshrrev_b32 v2, 3, v1
  v_and_b32 v2, 6, v2
  v_xor_b32 v2, v2, v10
  s_lshl_b32 s10, s69, 7
  v_add_u32 v3, s10, v3
  v_lshl_add_u32 v8, v2, 4, v3
  v_add_u32 v3, 16384, v3
  v_lshl_add_u32 v9, v2, 4, v3
  s_mov_b32 s40, s20
  s_and_b32 s41, s21, 0xffff
  s_mov_b32 s42, 2097152
  s_mov_b32 s43, 0x00020000
  v_readlane_b32 s74, v16, 0
  s_add_u32 m0, s77, 28672
  s_add_u32 s4, s74, 0
  buffer_load_dwordx4 v8, s[40:43], s4 offen lds
  s_add_u32 m0, s77, 29696
  s_nop 0
  buffer_load_dwordx4 v9, s[40:43], s4 offen lds
  v_readlane_b32 s74, v16, 1
  s_add_u32 m0, s77, 36864
  s_add_u32 s4, s74, 0
  buffer_load_dwordx4 v8, s[40:43], s4 offen lds
  s_add_u32 m0, s77, 37888
  s_nop 0
  buffer_load_dwordx4 v9, s[40:43], s4 offen lds
  v_readlane_b32 s74, v16, 2
  s_add_u32 m0, s77, 45056
  s_add_u32 s4, s74, 0
  buffer_load_dwordx4 v8, s[40:43], s4 offen lds
  s_add_u32 m0, s77, 46080
  s_nop 0
  buffer_load_dwordx4 v9, s[40:43], s4 offen lds
  v_readlane_b32 s74, v16, 3
  s_add_u32 m0, s77, 53248
  s_add_u32 s4, s74, 0
  buffer_load_dwordx4 v8, s[40:43], s4 offen lds
  s_add_u32 m0, s77, 54272
  s_nop 0
  buffer_load_dwordx4 v9, s[40:43], s4 offen lds
  v_readlane_b32 s74, v16, 4
  s_add_u32 m0, s77, 61440
  s_add_u32 s4, s74, 0
  buffer_load_dwordx4 v8, s[40:43], s4 offen lds
  s_add_u32 m0, s77, 62464
  s_nop 0
  buffer_load_dwordx4 v9, s[40:43], s4 offen lds
  v_readlane_b32 s74, v16, 5
  s_add_u32 m0, s77, 69632
  s_add_u32 s4, s74, 0
  buffer_load_dwordx4 v8, s[40:43], s4 offen lds
  s_add_u32 m0, s77, 70656
  s_nop 0
  buffer_load_dwordx4 v9, s[40:43], s4 offen lds
  s_waitcnt vmcnt(12)
  s_add_u32 s3, s96, s70
  s_cmp_lg_u32 s3, 4
  s_cbranch_scc1 L_wo_chk1
  v_cmp_ne_u32 vcc, 0x01010101, v12
  s_cbranch_vccz L_wo_chk1
  s_load_dwordx2 s[64:65], s[0:1], 72
  s_waitcnt lgkmcnt(0)
  s_and_b32 s65, s65, 0xffff
  s_mov_b32 s66, 256
  s_mov_b32 s67, 0x00020000
  v_lshlrev_b32 v17, 2, v1
  s_mov_b32 s79, 0x100000
L_wo_chkl:
  buffer_load_dword v12, v17, s[64:67], 0 offen sc1
  s_sub_u32 s79, s79, 1
  s_cbranch_scc1 L_wo_chk1
  s_waitcnt vmcnt(0)
  v_cmp_ne_u32 vcc, 0x01010101, v12
  s_cbranch_vccnz L_wo_chkl
L_wo_chk1:
  s_add_u32 s44, s22, 41943040
  s_addc_u32 s45, s23, 0
  s_and_b32 s45, s45, 0xffff
  s_mov_b32 s46, 524288
  s_mov_b32 s47, 0x00020000
  s_lshl4_add_u32 s3, s97, s68
  s_and_b32 s4, s69, 15
  s_lshl4_add_u32 s3, s3, s4
  s_lshl_b32 s3, s3, 7
  s_sub_u32 s3, s3, 32768
  v_lshlrev_b32 v11, 7, v1
  v_and_b32 v2, 15, v1
  v_lshlrev_b32 v2, 2, v2
  v_mov_b32 v3, 1
  s_mov_b32 s79, 0x100000
  s_cmp_lg_u32 s70, 4
  s_barrier
  s_cbranch_scc1 L_wo_nofl
  s_mov_b32 exec_lo, 0xffff
  s_mov_b32 exec_hi, 0
  buffer_store_dword v3, v11, s[44:47], s87 offen sc1
  s_mov_b64 exec, -1
L_wo_nofl:
  s_mov_b32 s5, s3
  v_readlane_b32 s74, v16, 6
  s_add_u32 m0, s77, 77824
  s_add_u32 s4, s74, 0
  buffer_load_dwordx4 v8, s[40:43], s4 offen lds
  s_add_u32 m0, s77, 78848
  s_nop 0
  buffer_load_dwordx4 v9, s[40:43], s4 offen lds
  v_readlane_b32 s74, v16, 7
  s_add_u32 m0, s77, 86016
  s_add_u32 s4, s74, 0
  buffer_load_dwordx4 v8, s[40:43], s4 offen lds
  s_add_u32 m0, s77, 87040
  s_nop 0
  buffer_load_dwordx4 v9, s[40:43], s4 offen lds
  v_readlane_b32 s74, v16, 8
  s_add_u32 m0, s77, 94208
  s_add_u32 s4, s74, 0
  buffer_load_dwordx4 v8, s[40:43], s4 offen lds
  s_add_u32 m0, s77, 95232
  s_nop 0
  buffer_load_dwordx4 v9, s[40:43], s4 offen lds
  v_readlane_b32 s74, v16, 9
  s_add_u32 m0, s77, 102400
  s_add_u32 s4, s74, 0
  buffer_load_dwordx4 v8, s[40:43], s4 offen lds
  s_add_u32 m0, s77, 103424
  s_nop 0
  buffer_load_dwordx4 v9, s[40:43], s4 offen lds
  v_readlane_b32 s74, v16, 10
  s_add_u32 m0, s77, 110592
  s_add_u32 s4, s74, 0
  buffer_load_dwordx4 v8, s[40:43], s4 offen lds
  s_add_u32 m0, s77, 111616
  s_nop 0
  buffer_load_dwordx4 v9, s[40:43], s4 offen lds
  v_readlane_b32 s74, v16, 11
  s_add_u32 m0, s77, 118784
  s_add_u32 s4, s74, 0
  buffer_load_dwordx4 v8, s[40:43], s4 offen lds
  s_add_u32 m0, s77, 119808
  s_nop 0
  buffer_load_dwordx4 v9, s[40:43], s4 offen lds
  v_readlane_b32 s74, v16, 12
  s_add_u32 m0, s77, 131072
  s_add_u32 s4, s74, 0
  buffer_load_dwordx4 v8, s[40:43], s4 offen lds
  s_add_u32 m0, s77, 132096
  s_nop 0
  buffer_load_dwordx4 v9, s[40:43], s4 offen lds
  v_readlane_b32 s74, v16, 13
  s_add_u32 m0, s77, 139264
  s_add_u32 s4, s74, 0
  buffer_load_dwordx4 v8, s[40:43], s4 offen lds
  s_add_u32 m0, s77, 140288
  s_nop 0
  buffer_load_dwordx4 v9, s[40:43], s4 offen lds
  v_readlane_b32 s74, v16, 14
  s_add_u32 m0, s77, 147456
  s_add_u32 s4, s74, 0
  buffer_load_dwordx4 v8, s[40:43], s4 offen lds
  s_add_u32 m0, s77, 148480
  s_nop 0
  buffer_load_dwordx4 v9, s[40:43], s4 offen lds
  v_readlane_b32 s74, v16, 15
  s_add_u32 m0, s77, 155648
  s_add_u32 s4, s74, 0
  buffer_load_dwordx4 v8, s[40:43], s4 offen lds
  s_add_u32 m0, s77, 156672
  s_nop 0
  buffer_load_dwordx4 v9, s[40:43], s4 offen lds
  s_mov_b32 s3, s5
  s_cmp_lg_u32 s70, 4
  s_cbranch_scc1 L_wo_dep
L_wo_poll:
  buffer_load_dword v3, v2, s[44:47], s3 offen sc1
  s_sub_u32 s79, s79, 1
  s_cbranch_scc1 L_wo_dep
  s_waitcnt vmcnt(0)
  v_cmp_ne_u32 vcc, 1, v3
  s_cbranch_vccnz L_wo_poll
L_wo_dep:
  s_waitcnt vmcnt(20) lgkmcnt(0)
  s_barrier
  s_waitcnt vmcnt(2)
  s_barrier
  s_lshl_b32 s87, s97, 15
  s_lshl_b32 s4, s68, 11
  s_add_u32 s87, s87, s4
  s_lshl_b32 s4, s69, 2
  s_add_u32 s87, s87, s4
  s_add_u32 s97, s97, 1
  s_branch L_w1_body
L_wo_end:
  s_endpgm
L_wo_compute:
  v_and_b32 v2, 3, v1
  v_lshlrev_b32 v2, 3, v2
  v_bfe_i32 v15, s85, v2, 8
  s_and_b32 s3, s68, 3
  s_mul_i32 s4, s3, 4
  v_add3_u32 v3, v15, v1, s4
  v_and_b32 v3, 15, v3
  v_lshlrev_b32 v15, 12, v3
  v_and_b32 v3, 15, v1
  v_lshrrev_b32 v2, 4, v1
  s_lshl_b32 s8, s68, 7
  s_lshl_b32 s9, s70, 5
  s_add_u32 s8, s8, s9
  s_mul_i32 s9, s8, 7168
  v_add_u32 v13, s8, v3
  s_lshl_b32 s10, s69, 7
  v_lshl_add_u32 v14, v2, 3, s10
  v_and_b32 v16, 1, v2
  v_lshrrev_b32 v17, 1, v2
  v_lshlrev_b32 v16, 4, v1
  s_add_u32 s9, s8, s69
  s_lshl_b32 s9, s9, 11
  v_add_u32 v12, s9, v16
  s_lshl_b32 s9, s70, 12
  v_add_u32 v19, s9, v16
  v_lshl_add_u32 v18, v17, 4, v13
  v_lshlrev_b32 v18, 3, v18
  v_and_b32 v16, 1, v2
  v_lshl_add_u32 v18, v16, 2, v18
  s_lshl_b32 s10, s69, 14
  v_add_u32 v18, s10, v18
  v_lshrrev_b32 v6, 2, v1
  v_lshlrev_b32 v6, 7, v6
  v_and_b32 v17, 3, v1
  v_lshl_add_u32 v6, v17, 3, v6
  v_bfe_u32 v17, v1, 3, 2
  v_lshl_add_u32 v6, v17, 5, v6
  v_xor_b32 v7, 32, v6
  v_xor_b32 v8, 64, v6
  v_xor_b32 v9, 96, v6
  s_mov_b32 s11, 0xffff0000
  s_add_u32 s36, s34, 8439808
  s_addc_u32 s37, s35, 0
  s_and_b32 s37, s37, 0xffff
  s_mov_b32 s38, 4194304
  s_mov_b32 s39, 0x00020000
  s_add_u32 s44, s34, 4194304
  s_addc_u32 s45, s35, 0
  s_and_b32 s45, s45, 0xffff
  s_mov_b32 s46, 4194304
  s_mov_b32 s47, 0x00020000
  s_add_u32 s56, s34, 24117248
  s_addc_u32 s57, s35, 0
  s_and_b32 s57, s57, 0xffff
  s_mov_b32 s58, 262144
  s_mov_b32 s59, 0x00020000
  s_mul_i32 s9, s8, 7168
  s_add_u32 s36, s36, s9
  s_addc_u32 s37, s37, 0x100000
  s_add_u32 s64, s36, 114688
  s_addc_u32 s65, s37, 0
  s_mov_b32 s38, 63488
  s_mov_b32 s39, 0x00800000
  s_mov_b32 s66, 63488
  s_mov_b32 s67, 0x00800000
  s_cmp_lg_u32 s96, 0
  s_cbranch_scc1 L_pfc2_skip
  s_getpc_b64 s[4:5]
L_pfc2:
  s_lshl_b32 s3, s99, 2
  s_add_u32 s3, s3, s70
  s_mul_i32 s3, s3, 128
  s_min_u32 s3, s3, L_w1_c1-L_w1_c0-128
  s_add_i32 s3, s3, L_w1_c0-L_pfc2
  s_ashr_i32 s6, s3, 31
  s_add_u32 s4, s4, s3
  s_addc_u32 s5, s5, s6
  s_load_dword s40, s[4:5], 0
  s_load_dword s40, s[4:5], 64
L_pfc2_skip:
  v_add_u32 v26, 155648, v6
  v_add_u32 v27, 155648, v7
  v_add_u32 v28, 155648, v8
  v_add_u32 v29, 155648, v9
  v_add_u32 v20, 94208, v6
  v_add_u32 v21, 94208, v7
  v_add_u32 v22, 94208, v8
  v_add_u32 v23, 94208, v9
  v_add_u32 v6, 28672, v6
  v_add_u32 v7, 28672, v7
  v_add_u32 v8, 28672, v8
  v_add_u32 v9, 28672, v9
  v_readlane_b32 s48, v15, 0
  v_readlane_b32 s49, v15, 1
  v_readlane_b32 s50, v15, 2
  s_cmp_lg_u32 s96, 0
  s_cbranch_scc1 L_wo_nosw
  v_permlane16_swap_b32 v240, v242
  v_permlane16_swap_b32 v241, v243
  v_permlane16_swap_b32 v244, v246
  v_permlane16_swap_b32 v245, v247
  v_permlane16_swap_b32 v248, v250
  v_permlane16_swap_b32 v249, v251
  v_permlane16_swap_b32 v252, v254
  v_permlane16_swap_b32 v253, v255
L_wo_nosw:
  s_waitcnt lgkmcnt(0)
  s_barrier
  buffer_load_dwordx4 v[32:35], off, s[36:39], s48 offset:0
  buffer_load_dwordx4 v[36:39], off, s[64:67], s48 offset:0
  buffer_load_dwordx4 v[40:43], off, s[36:39], s48 offset:1024
  buffer_load_dwordx4 v[44:47], off, s[64:67], s48 offset:1024
  buffer_load_dwordx4 v[48:51], off, s[36:39], s49 offset:0
  buffer_load_dwordx4 v[52:55], off, s[64:67], s49 offset:0
  buffer_load_dwordx4 v[56:59], off, s[36:39], s49 offset:1024
  buffer_load_dwordx4 v[60:63], off, s[64:67], s49 offset:1024
  buffer_load_dwordx4 v[64:67], off, s[36:39], s50 offset:0
  buffer_load_dwordx4 v[68:71], off, s[64:67], s50 offset:0
  buffer_load_dwordx4 v[72:75], off, s[36:39], s50 offset:1024
  buffer_load_dwordx4 v[76:79], off, s[64:67], s50 offset:1024
  ds_read_b64_tr_b16 v[160:161], v6 offset:0
  ds_read_b64_tr_b16 v[162:163], v6 offset:2048
  ds_read_b64_tr_b16 v[164:165], v7 offset:0
  ds_read_b64_tr_b16 v[166:167], v7 offset:2048
  ds_read_b64_tr_b16 v[168:169], v8 offset:0
  ds_read_b64_tr_b16 v[170:171], v8 offset:2048
  ds_read_b64_tr_b16 v[172:173], v9 offset:0
  ds_read_b64_tr_b16 v[174:175], v9 offset:2048
  ds_read_b64_tr_b16 v[176:177], v6 offset:4096
  ds_read_b64_tr_b16 v[178:179], v6 offset:6144
  ds_read_b64_tr_b16 v[180:181], v7 offset:4096
  ds_read_b64_tr_b16 v[182:183], v7 offset:6144
  ds_read_b64_tr_b16 v[184:185], v8 offset:4096
  ds_read_b64_tr_b16 v[186:187], v8 offset:6144
  ds_read_b64_tr_b16 v[188:189], v9 offset:4096
  ds_read_b64_tr_b16 v[190:191], v9 offset:6144
  v_lshlrev_b32 v96, 16, v240
  v_and_b32 v97, s11, v240
  v_lshlrev_b32 v98, 16, v241
  v_and_b32 v99, s11, v241
  v_lshlrev_b32 v100, 16, v248
  v_and_b32 v101, s11, v248
  v_lshlrev_b32 v102, 16, v249
  v_and_b32 v103, s11, v249
  v_lshlrev_b32 v104, 16, v242
  v_and_b32 v105, s11, v242
  v_lshlrev_b32 v106, 16, v243
  v_and_b32 v107, s11, v243
  v_lshlrev_b32 v108, 16, v250
  v_and_b32 v109, s11, v250
  v_lshlrev_b32 v110, 16, v251
  v_and_b32 v111, s11, v251
  v_lshlrev_b32 v112, 16, v244
  v_and_b32 v113, s11, v244
  v_lshlrev_b32 v114, 16, v245
  v_and_b32 v115, s11, v245
  v_lshlrev_b32 v116, 16, v252
  v_and_b32 v117, s11, v252
  v_lshlrev_b32 v118, 16, v253
  v_and_b32 v119, s11, v253
  v_lshlrev_b32 v120, 16, v246
  v_and_b32 v121, s11, v246
  v_lshlrev_b32 v122, 16, v247
  v_and_b32 v123, s11, v247
  v_lshlrev_b32 v124, 16, v254
  v_and_b32 v125, s11, v254
  v_lshlrev_b32 v126, 16, v255
  v_and_b32 v127, s11, v255
  s_waitcnt vmcnt(10) lgkmcnt(8)
  v_mfma_f32_16x16x32_bf16 v[96:99], v[160:163], v[32:35], v[96:99]
  ds_read_b64_tr_b16 v[192:193], v6 offset:8192
  v_readlane_b32 s51, v15, 3
  v_mfma_f32_16x16x32_bf16 v[100:103], v[160:163], v[36:39], v[100:103]
  ds_read_b64_tr_b16 v[194:195], v6 offset:10240
  v_mfma_f32_16x16x32_bf16 v[108:111], v[164:167], v[36:39], v[108:111]
  ds_read_b64_tr_b16 v[196:197], v7 offset:8192
  v_mfma_f32_16x16x32_bf16 v[104:107], v[164:167], v[32:35], v[104:107]
  buffer_load_dwordx4 v[80:83], off, s[36:39], s51 offset:0
  v_mfma_f32_16x16x32_bf16 v[112:115], v[168:171], v[32:35], v[112:115]
  ds_read_b64_tr_b16 v[198:199], v7 offset:10240
  ds_read_b64_tr_b16 v[200:201], v8 offset:8192
  v_mfma_f32_16x16x32_bf16 v[116:119], v[168:171], v[36:39], v[116:119]
  ds_read_b64_tr_b16 v[202:203], v8 offset:10240
  ds_read_b64_tr_b16 v[204:205], v9 offset:8192
  v_mfma_f32_16x16x32_bf16 v[124:127], v[172:175], v[36:39], v[124:127]
  buffer_load_dwordx4 v[84:87], off, s[64:67], s51 offset:0
  v_mfma_f32_16x16x32_bf16 v[120:123], v[172:175], v[32:35], v[120:123]
  ds_read_b64_tr_b16 v[206:207], v9 offset:10240
  s_waitcnt vmcnt(10) lgkmcnt(8)
  v_mfma_f32_16x16x32_bf16 v[96:99], v[176:179], v[40:43], v[96:99]
  ds_read_b64_tr_b16 v[208:209], v6 offset:12288
  v_mfma_f32_16x16x32_bf16 v[100:103], v[176:179], v[44:47], v[100:103]
  buffer_load_dwordx4 v[88:91], off, s[36:39], s51 offset:1024
  v_mfma_f32_16x16x32_bf16 v[108:111], v[180:183], v[44:47], v[108:111]
  ds_read_b64_tr_b16 v[210:211], v6 offset:14336
  ds_read_b64_tr_b16 v[212:213], v7 offset:12288
  v_mfma_f32_16x16x32_bf16 v[104:107], v[180:183], v[40:43], v[104:107]
  ds_read_b64_tr_b16 v[214:215], v7 offset:14336
  ds_read_b64_tr_b16 v[216:217], v8 offset:12288
  v_mfma_f32_16x16x32_bf16 v[112:115], v[184:187], v[40:43], v[112:115]
  buffer_load_dwordx4 v[92:95], off, s[64:67], s51 offset:1024
  v_mfma_f32_16x16x32_bf16 v[116:119], v[184:187], v[44:47], v[116:119]
  ds_read_b64_tr_b16 v[218:219], v8 offset:14336
  v_readlane_b32 s48, v15, 4
  v_mfma_f32_16x16x32_bf16 v[124:127], v[188:191], v[44:47], v[124:127]
  ds_read_b64_tr_b16 v[220:221], v9 offset:12288
  v_mfma_f32_16x16x32_bf16 v[120:123], v[188:191], v[40:43], v[120:123]
  ds_read_b64_tr_b16 v[222:223], v9 offset:14336
  s_waitcnt vmcnt(10) lgkmcnt(8)
  v_mfma_f32_16x16x32_bf16 v[96:99], v[192:195], v[48:51], v[96:99]
  buffer_load_dwordx4 v[32:35], off, s[36:39], s48 offset:0
  v_mfma_f32_16x16x32_bf16 v[100:103], v[192:195], v[52:55], v[100:103]
  ds_read_b64_tr_b16 v[160:161], v6 offset:16384
  ds_read_b64_tr_b16 v[162:163], v6 offset:18432
  v_mfma_f32_16x16x32_bf16 v[108:111], v[196:199], v[52:55], v[108:111]
  ds_read_b64_tr_b16 v[164:165], v7 offset:16384
  v_mfma_f32_16x16x32_bf16 v[104:107], v[196:199], v[48:51], v[104:107]
  buffer_load_dwordx4 v[36:39], off, s[64:67], s48 offset:0
  v_mfma_f32_16x16x32_bf16 v[112:115], v[200:203], v[48:51], v[112:115]
  ds_read_b64_tr_b16 v[166:167], v7 offset:18432
  ds_read_b64_tr_b16 v[168:169], v8 offset:16384
  v_mfma_f32_16x16x32_bf16 v[116:119], v[200:203], v[52:55], v[116:119]
  ds_read_b64_tr_b16 v[170:171], v8 offset:18432
  ds_read_b64_tr_b16 v[172:173], v9 offset:16384
  v_mfma_f32_16x16x32_bf16 v[124:127], v[204:207], v[52:55], v[124:127]
  buffer_load_dwordx4 v[40:43], off, s[36:39], s48 offset:1024
  v_mfma_f32_16x16x32_bf16 v[120:123], v[204:207], v[48:51], v[120:123]
  ds_read_b64_tr_b16 v[174:175], v9 offset:18432
  s_waitcnt vmcnt(11) lgkmcnt(8)
  v_mfma_f32_16x16x32_bf16 v[96:99], v[208:211], v[56:59], v[96:99]
  ds_read_b64_tr_b16 v[176:177], v6 offset:20480
  v_mfma_f32_16x16x32_bf16 v[100:103], v[208:211], v[60:63], v[100:103]
  buffer_load_dwordx4 v[44:47], off, s[64:67], s48 offset:1024
  v_mfma_f32_16x16x32_bf16 v[108:111], v[212:215], v[60:63], v[108:111]
  ds_read_b64_tr_b16 v[178:179], v6 offset:22528
  ds_read_b64_tr_b16 v[180:181], v7 offset:20480
  v_mfma_f32_16x16x32_bf16 v[104:107], v[212:215], v[56:59], v[104:107]
  ds_read_b64_tr_b16 v[182:183], v7 offset:22528
  v_mfma_f32_16x16x32_bf16 v[112:115], v[216:219], v[56:59], v[112:115]
  ds_read_b64_tr_b16 v[184:185], v8 offset:20480
  v_mfma_f32_16x16x32_bf16 v[116:119], v[216:219], v[60:63], v[116:119]
  ds_read_b64_tr_b16 v[186:187], v8 offset:22528
  v_readlane_b32 s49, v15, 5
  v_mfma_f32_16x16x32_bf16 v[124:127], v[220:223], v[60:63], v[124:127]
  ds_read_b64_tr_b16 v[188:189], v9 offset:20480
  v_mfma_f32_16x16x32_bf16 v[120:123], v[220:223], v[56:59], v[120:123]
  ds_read_b64_tr_b16 v[190:191], v9 offset:22528
  s_waitcnt vmcnt(10) lgkmcnt(8)
  v_mfma_f32_16x16x32_bf16 v[96:99], v[160:163], v[64:67], v[96:99]
  buffer_load_dwordx4 v[48:51], off, s[36:39], s49 offset:0
  v_mfma_f32_16x16x32_bf16 v[100:103], v[160:163], v[68:71], v[100:103]
  ds_read_b64_tr_b16 v[192:193], v6 offset:24576
  ds_read_b64_tr_b16 v[194:195], v6 offset:26624
  v_mfma_f32_16x16x32_bf16 v[108:111], v[164:167], v[68:71], v[108:111]
  ds_read_b64_tr_b16 v[196:197], v7 offset:24576
  v_mfma_f32_16x16x32_bf16 v[104:107], v[164:167], v[64:67], v[104:107]
  buffer_load_dwordx4 v[52:55], off, s[64:67], s49 offset:0
  v_mfma_f32_16x16x32_bf16 v[112:115], v[168:171], v[64:67], v[112:115]
  ds_read_b64_tr_b16 v[198:199], v7 offset:26624
  ds_read_b64_tr_b16 v[200:201], v8 offset:24576
  v_mfma_f32_16x16x32_bf16 v[116:119], v[168:171], v[68:71], v[116:119]
  ds_read_b64_tr_b16 v[202:203], v8 offset:26624
  ds_read_b64_tr_b16 v[204:205], v9 offset:24576
  v_mfma_f32_16x16x32_bf16 v[124:127], v[172:175], v[68:71], v[124:127]
  buffer_load_dwordx4 v[56:59], off, s[36:39], s49 offset:1024
  v_mfma_f32_16x16x32_bf16 v[120:123], v[172:175], v[64:67], v[120:123]
  ds_read_b64_tr_b16 v[206:207], v9 offset:26624
  s_waitcnt vmcnt(11) lgkmcnt(8)
  v_mfma_f32_16x16x32_bf16 v[96:99], v[176:179], v[72:75], v[96:99]
  ds_read_b64_tr_b16 v[208:209], v6 offset:28672
  v_mfma_f32_16x16x32_bf16 v[100:103], v[176:179], v[76:79], v[100:103]
  buffer_load_dwordx4 v[60:63], off, s[64:67], s49 offset:1024
  v_mfma_f32_16x16x32_bf16 v[108:111], v[180:183], v[76:79], v[108:111]
  ds_read_b64_tr_b16 v[210:211], v6 offset:30720
  ds_read_b64_tr_b16 v[212:213], v7 offset:28672
  v_mfma_f32_16x16x32_bf16 v[104:107], v[180:183], v[72:75], v[104:107]
  ds_read_b64_tr_b16 v[214:215], v7 offset:30720
  v_mfma_f32_16x16x32_bf16 v[112:115], v[184:187], v[72:75], v[112:115]
  ds_read_b64_tr_b16 v[216:217], v8 offset:28672
  v_mfma_f32_16x16x32_bf16 v[116:119], v[184:187], v[76:79], v[116:119]
  ds_read_b64_tr_b16 v[218:219], v8 offset:30720
  v_readlane_b32 s50, v15, 6
  v_mfma_f32_16x16x32_bf16 v[124:127], v[188:191], v[76:79], v[124:127]
  ds_read_b64_tr_b16 v[220:221], v9 offset:28672
  v_mfma_f32_16x16x32_bf16 v[120:123], v[188:191], v[72:75], v[120:123]
  ds_read_b64_tr_b16 v[222:223], v9 offset:30720
  s_waitcnt vmcnt(10) lgkmcnt(8)
  v_mfma_f32_16x16x32_bf16 v[96:99], v[192:195], v[80:83], v[96:99]
  buffer_load_dwordx4 v[64:67], off, s[36:39], s50 offset:0
  v_mfma_f32_16x16x32_bf16 v[100:103], v[192:195], v[84:87], v[100:103]
  ds_read_b64_tr_b16 v[160:161], v6 offset:32768
  ds_read_b64_tr_b16 v[162:163], v6 offset:34816
  v_mfma_f32_16x16x32_bf16 v[108:111], v[196:199], v[84:87], v[108:111]
  ds_read_b64_tr_b16 v[164:165], v7 offset:32768
  v_mfma_f32_16x16x32_bf16 v[104:107], v[196:199], v[80:83], v[104:107]
  buffer_load_dwordx4 v[68:71], off, s[64:67], s50 offset:0
  v_mfma_f32_16x16x32_bf16 v[112:115], v[200:203], v[80:83], v[112:115]
  ds_read_b64_tr_b16 v[166:167], v7 offset:34816
  ds_read_b64_tr_b16 v[168:169], v8 offset:32768
  v_mfma_f32_16x16x32_bf16 v[116:119], v[200:203], v[84:87], v[116:119]
  ds_read_b64_tr_b16 v[170:171], v8 offset:34816
  ds_read_b64_tr_b16 v[172:173], v9 offset:32768
  v_mfma_f32_16x16x32_bf16 v[124:127], v[204:207], v[84:87], v[124:127]
  buffer_load_dwordx4 v[72:75], off, s[36:39], s50 offset:1024
  v_mfma_f32_16x16x32_bf16 v[120:123], v[204:207], v[80:83], v[120:123]
  ds_read_b64_tr_b16 v[174:175], v9 offset:34816
  s_waitcnt vmcnt(11) lgkmcnt(8)
  v_mfma_f32_16x16x32_bf16 v[96:99], v[208:211], v[88:91], v[96:99]
  ds_read_b64_tr_b16 v[176:177], v6 offset:36864
  v_mfma_f32_16x16x32_bf16 v[100:103], v[208:211], v[92:95], v[100:103]
  buffer_load_dwordx4 v[76:79], off, s[64:67], s50 offset:1024
  v_mfma_f32_16x16x32_bf16 v[108:111], v[212:215], v[92:95], v[108:111]
  ds_read_b64_tr_b16 v[178:179], v6 offset:38912
  ds_read_b64_tr_b16 v[180:181], v7 offset:36864
  v_mfma_f32_16x16x32_bf16 v[104:107], v[212:215], v[88:91], v[104:107]
  ds_read_b64_tr_b16 v[182:183], v7 offset:38912
  v_mfma_f32_16x16x32_bf16 v[112:115], v[216:219], v[88:91], v[112:115]
  ds_read_b64_tr_b16 v[184:185], v8 offset:36864
  v_mfma_f32_16x16x32_bf16 v[116:119], v[216:219], v[92:95], v[116:119]
  ds_read_b64_tr_b16 v[186:187], v8 offset:38912
  v_readlane_b32 s51, v15, 7
  v_mfma_f32_16x16x32_bf16 v[124:127], v[220:223], v[92:95], v[124:127]
  ds_read_b64_tr_b16 v[188:189], v9 offset:36864
  v_mfma_f32_16x16x32_bf16 v[120:123], v[220:223], v[88:91], v[120:123]
  ds_read_b64_tr_b16 v[190:191], v9 offset:38912
  s_waitcnt vmcnt(10) lgkmcnt(8)
  v_mfma_f32_16x16x32_bf16 v[96:99], v[160:163], v[32:35], v[96:99]
  buffer_load_dwordx4 v[80:83], off, s[36:39], s51 offset:0
  v_mfma_f32_16x16x32_bf16 v[100:103], v[160:163], v[36:39], v[100:103]
  ds_read_b64_tr_b16 v[192:193], v6 offset:40960
  ds_read_b64_tr_b16 v[194:195], v6 offset:43008
  v_mfma_f32_16x16x32_bf16 v[108:111], v[164:167], v[36:39], v[108:111]
  ds_read_b64_tr_b16 v[196:197], v7 offset:40960
  v_mfma_f32_16x16x32_bf16 v[104:107], v[164:167], v[32:35], v[104:107]
  buffer_load_dwordx4 v[84:87], off, s[64:67], s51 offset:0
  v_mfma_f32_16x16x32_bf16 v[112:115], v[168:171], v[32:35], v[112:115]
  ds_read_b64_tr_b16 v[198:199], v7 offset:43008
  ds_read_b64_tr_b16 v[200:201], v8 offset:40960
  v_mfma_f32_16x16x32_bf16 v[116:119], v[168:171], v[36:39], v[116:119]
  ds_read_b64_tr_b16 v[202:203], v8 offset:43008
  ds_read_b64_tr_b16 v[204:205], v9 offset:40960
  v_mfma_f32_16x16x32_bf16 v[124:127], v[172:175], v[36:39], v[124:127]
  buffer_load_dwordx4 v[88:91], off, s[36:39], s51 offset:1024
  v_mfma_f32_16x16x32_bf16 v[120:123], v[172:175], v[32:35], v[120:123]
  ds_read_b64_tr_b16 v[206:207], v9 offset:43008
  s_waitcnt vmcnt(11) lgkmcnt(8)
  s_barrier
  v_mfma_f32_16x16x32_bf16 v[96:99], v[176:179], v[40:43], v[96:99]
  ds_read_b64_tr_b16 v[208:209], v6 offset:45056
  v_mfma_f32_16x16x32_bf16 v[100:103], v[176:179], v[44:47], v[100:103]
  buffer_load_dwordx4 v[92:95], off, s[64:67], s51 offset:1024
  v_mfma_f32_16x16x32_bf16 v[108:111], v[180:183], v[44:47], v[108:111]
  ds_read_b64_tr_b16 v[210:211], v6 offset:47104
  ds_read_b64_tr_b16 v[212:213], v7 offset:45056
  v_mfma_f32_16x16x32_bf16 v[104:107], v[180:183], v[40:43], v[104:107]
  ds_read_b64_tr_b16 v[214:215], v7 offset:47104
  v_mfma_f32_16x16x32_bf16 v[112:115], v[184:187], v[40:43], v[112:115]
  ds_read_b64_tr_b16 v[216:217], v8 offset:45056
  v_mfma_f32_16x16x32_bf16 v[116:119], v[184:187], v[44:47], v[116:119]
  ds_read_b64_tr_b16 v[218:219], v8 offset:47104
  v_readlane_b32 s48, v15, 8
  v_mfma_f32_16x16x32_bf16 v[124:127], v[188:191], v[44:47], v[124:127]
  ds_read_b64_tr_b16 v[220:221], v9 offset:45056
  v_mfma_f32_16x16x32_bf16 v[120:123], v[188:191], v[40:43], v[120:123]
  ds_read_b64_tr_b16 v[222:223], v9 offset:47104
  s_waitcnt vmcnt(10) lgkmcnt(8)
  v_mfma_f32_16x16x32_bf16 v[96:99], v[192:195], v[48:51], v[96:99]
  buffer_load_dwordx4 v[32:35], off, s[36:39], s48 offset:0
  v_mfma_f32_16x16x32_bf16 v[100:103], v[192:195], v[52:55], v[100:103]
  ds_read_b64_tr_b16 v[160:161], v6 offset:49152
  ds_read_b64_tr_b16 v[162:163], v6 offset:51200
  v_mfma_f32_16x16x32_bf16 v[108:111], v[196:199], v[52:55], v[108:111]
  ds_read_b64_tr_b16 v[164:165], v7 offset:49152
  v_mfma_f32_16x16x32_bf16 v[104:107], v[196:199], v[48:51], v[104:107]
  buffer_load_dwordx4 v[36:39], off, s[64:67], s48 offset:0
  v_mfma_f32_16x16x32_bf16 v[112:115], v[200:203], v[48:51], v[112:115]
  ds_read_b64_tr_b16 v[166:167], v7 offset:51200
  ds_read_b64_tr_b16 v[168:169], v8 offset:49152
  v_mfma_f32_16x16x32_bf16 v[116:119], v[200:203], v[52:55], v[116:119]
  ds_read_b64_tr_b16 v[170:171], v8 offset:51200
  ds_read_b64_tr_b16 v[172:173], v9 offset:49152
  v_mfma_f32_16x16x32_bf16 v[124:127], v[204:207], v[52:55], v[124:127]
  buffer_load_dwordx4 v[40:43], off, s[36:39], s48 offset:1024
  v_mfma_f32_16x16x32_bf16 v[120:123], v[204:207], v[48:51], v[120:123]
  ds_read_b64_tr_b16 v[174:175], v9 offset:51200
  s_waitcnt vmcnt(11) lgkmcnt(8)
  v_mfma_f32_16x16x32_bf16 v[96:99], v[208:211], v[56:59], v[96:99]
  ds_read_b64_tr_b16 v[176:177], v6 offset:53248
  v_mfma_f32_16x16x32_bf16 v[100:103], v[208:211], v[60:63], v[100:103]
  buffer_load_dwordx4 v[44:47], off, s[64:67], s48 offset:1024
  v_mfma_f32_16x16x32_bf16 v[108:111], v[212:215], v[60:63], v[108:111]
  ds_read_b64_tr_b16 v[178:179], v6 offset:55296
  ds_read_b64_tr_b16 v[180:181], v7 offset:53248
  v_mfma_f32_16x16x32_bf16 v[104:107], v[212:215], v[56:59], v[104:107]
  ds_read_b64_tr_b16 v[182:183], v7 offset:55296
  v_mfma_f32_16x16x32_bf16 v[112:115], v[216:219], v[56:59], v[112:115]
  ds_read_b64_tr_b16 v[184:185], v8 offset:53248
  v_mfma_f32_16x16x32_bf16 v[116:119], v[216:219], v[60:63], v[116:119]
  ds_read_b64_tr_b16 v[186:187], v8 offset:55296
  v_readlane_b32 s49, v15, 9
  v_mfma_f32_16x16x32_bf16 v[124:127], v[220:223], v[60:63], v[124:127]
  ds_read_b64_tr_b16 v[188:189], v9 offset:53248
  v_mfma_f32_16x16x32_bf16 v[120:123], v[220:223], v[56:59], v[120:123]
  ds_read_b64_tr_b16 v[190:191], v9 offset:55296
  s_waitcnt vmcnt(10) lgkmcnt(8)
  v_mfma_f32_16x16x32_bf16 v[96:99], v[160:163], v[64:67], v[96:99]
  buffer_load_dwordx4 v[48:51], off, s[36:39], s49 offset:0
  v_mfma_f32_16x16x32_bf16 v[100:103], v[160:163], v[68:71], v[100:103]
  ds_read_b64_tr_b16 v[192:193], v6 offset:57344
  ds_read_b64_tr_b16 v[194:195], v6 offset:59392
  v_mfma_f32_16x16x32_bf16 v[108:111], v[164:167], v[68:71], v[108:111]
  ds_read_b64_tr_b16 v[196:197], v7 offset:57344
  v_mfma_f32_16x16x32_bf16 v[104:107], v[164:167], v[64:67], v[104:107]
  buffer_load_dwordx4 v[52:55], off, s[64:67], s49 offset:0
  v_mfma_f32_16x16x32_bf16 v[112:115], v[168:171], v[64:67], v[112:115]
  ds_read_b64_tr_b16 v[198:199], v7 offset:59392
  ds_read_b64_tr_b16 v[200:201], v8 offset:57344
  v_mfma_f32_16x16x32_bf16 v[116:119], v[168:171], v[68:71], v[116:119]
  ds_read_b64_tr_b16 v[202:203], v8 offset:59392
  ds_read_b64_tr_b16 v[204:205], v9 offset:57344
  v_mfma_f32_16x16x32_bf16 v[124:127], v[172:175], v[68:71], v[124:127]
  buffer_load_dwordx4 v[56:59], off, s[36:39], s49 offset:1024
  v_mfma_f32_16x16x32_bf16 v[120:123], v[172:175], v[64:67], v[120:123]
  ds_read_b64_tr_b16 v[206:207], v9 offset:59392
  s_waitcnt vmcnt(11) lgkmcnt(8)
  v_mfma_f32_16x16x32_bf16 v[96:99], v[176:179], v[72:75], v[96:99]
  ds_read_b64_tr_b16 v[208:209], v6 offset:61440
  v_mfma_f32_16x16x32_bf16 v[100:103], v[176:179], v[76:79], v[100:103]
  buffer_load_dwordx4 v[60:63], off, s[64:67], s49 offset:1024
  v_mfma_f32_16x16x32_bf16 v[108:111], v[180:183], v[76:79], v[108:111]
  ds_read_b64_tr_b16 v[210:211], v6 offset:63488
  ds_read_b64_tr_b16 v[212:213], v7 offset:61440
  v_mfma_f32_16x16x32_bf16 v[104:107], v[180:183], v[72:75], v[104:107]
  ds_read_b64_tr_b16 v[214:215], v7 offset:63488
  v_mfma_f32_16x16x32_bf16 v[112:115], v[184:187], v[72:75], v[112:115]
  ds_read_b64_tr_b16 v[216:217], v8 offset:61440
  v_mfma_f32_16x16x32_bf16 v[116:119], v[184:187], v[76:79], v[116:119]
  ds_read_b64_tr_b16 v[218:219], v8 offset:63488
  v_readlane_b32 s50, v15, 10
  v_mfma_f32_16x16x32_bf16 v[124:127], v[188:191], v[76:79], v[124:127]
  ds_read_b64_tr_b16 v[220:221], v9 offset:61440
  v_mfma_f32_16x16x32_bf16 v[120:123], v[188:191], v[72:75], v[120:123]
  ds_read_b64_tr_b16 v[222:223], v9 offset:63488
  s_waitcnt vmcnt(10) lgkmcnt(8)
  v_mfma_f32_16x16x32_bf16 v[96:99], v[192:195], v[80:83], v[96:99]
  buffer_load_dwordx4 v[64:67], off, s[36:39], s50 offset:0
  v_mfma_f32_16x16x32_bf16 v[100:103], v[192:195], v[84:87], v[100:103]
  ds_read_b64_tr_b16 v[160:161], v20 offset:0
  ds_read_b64_tr_b16 v[162:163], v20 offset:2048
  v_mfma_f32_16x16x32_bf16 v[108:111], v[196:199], v[84:87], v[108:111]
  ds_read_b64_tr_b16 v[164:165], v21 offset:0
  v_mfma_f32_16x16x32_bf16 v[104:107], v[196:199], v[80:83], v[104:107]
  buffer_load_dwordx4 v[68:71], off, s[64:67], s50 offset:0
  v_mfma_f32_16x16x32_bf16 v[112:115], v[200:203], v[80:83], v[112:115]
  ds_read_b64_tr_b16 v[166:167], v21 offset:2048
  ds_read_b64_tr_b16 v[168:169], v22 offset:0
  v_mfma_f32_16x16x32_bf16 v[116:119], v[200:203], v[84:87], v[116:119]
  ds_read_b64_tr_b16 v[170:171], v22 offset:2048
  ds_read_b64_tr_b16 v[172:173], v23 offset:0
  v_mfma_f32_16x16x32_bf16 v[124:127], v[204:207], v[84:87], v[124:127]
  buffer_load_dwordx4 v[72:75], off, s[36:39], s50 offset:1024
  v_mfma_f32_16x16x32_bf16 v[120:123], v[204:207], v[80:83], v[120:123]
  ds_read_b64_tr_b16 v[174:175], v23 offset:2048
  s_waitcnt vmcnt(11) lgkmcnt(8)
  v_mfma_f32_16x16x32_bf16 v[96:99], v[208:211], v[88:91], v[96:99]
  ds_read_b64_tr_b16 v[176:177], v20 offset:4096
  v_mfma_f32_16x16x32_bf16 v[100:103], v[208:211], v[92:95], v[100:103]
  buffer_load_dwordx4 v[76:79], off, s[64:67], s50 offset:1024
  v_mfma_f32_16x16x32_bf16 v[108:111], v[212:215], v[92:95], v[108:111]
  ds_read_b64_tr_b16 v[178:179], v20 offset:6144
  ds_read_b64_tr_b16 v[180:181], v21 offset:4096
  v_mfma_f32_16x16x32_bf16 v[104:107], v[212:215], v[88:91], v[104:107]
  ds_read_b64_tr_b16 v[182:183], v21 offset:6144
  v_mfma_f32_16x16x32_bf16 v[112:115], v[216:219], v[88:91], v[112:115]
  ds_read_b64_tr_b16 v[184:185], v22 offset:4096
  v_mfma_f32_16x16x32_bf16 v[116:119], v[216:219], v[92:95], v[116:119]
  ds_read_b64_tr_b16 v[186:187], v22 offset:6144
  v_readlane_b32 s51, v15, 11
  v_mfma_f32_16x16x32_bf16 v[124:127], v[220:223], v[92:95], v[124:127]
  ds_read_b64_tr_b16 v[188:189], v23 offset:4096
  v_mfma_f32_16x16x32_bf16 v[120:123], v[220:223], v[88:91], v[120:123]
  ds_read_b64_tr_b16 v[190:191], v23 offset:6144
  s_waitcnt vmcnt(10) lgkmcnt(8)
  v_mfma_f32_16x16x32_bf16 v[96:99], v[160:163], v[32:35], v[96:99]
  buffer_load_dwordx4 v[80:83], off, s[36:39], s51 offset:0
  v_mfma_f32_16x16x32_bf16 v[100:103], v[160:163], v[36:39], v[100:103]
  ds_read_b64_tr_b16 v[192:193], v20 offset:8192
  ds_read_b64_tr_b16 v[194:195], v20 offset:10240
  v_mfma_f32_16x16x32_bf16 v[108:111], v[164:167], v[36:39], v[108:111]
  ds_read_b64_tr_b16 v[196:197], v21 offset:8192
  v_mfma_f32_16x16x32_bf16 v[104:107], v[164:167], v[32:35], v[104:107]
  buffer_load_dwordx4 v[84:87], off, s[64:67], s51 offset:0
  v_mfma_f32_16x16x32_bf16 v[112:115], v[168:171], v[32:35], v[112:115]
  ds_read_b64_tr_b16 v[198:199], v21 offset:10240
  ds_read_b64_tr_b16 v[200:201], v22 offset:8192
  v_mfma_f32_16x16x32_bf16 v[116:119], v[168:171], v[36:39], v[116:119]
  ds_read_b64_tr_b16 v[202:203], v22 offset:10240
  ds_read_b64_tr_b16 v[204:205], v23 offset:8192
  v_mfma_f32_16x16x32_bf16 v[124:127], v[172:175], v[36:39], v[124:127]
  buffer_load_dwordx4 v[88:91], off, s[36:39], s51 offset:1024
  v_mfma_f32_16x16x32_bf16 v[120:123], v[172:175], v[32:35], v[120:123]
  ds_read_b64_tr_b16 v[206:207], v23 offset:10240
  s_waitcnt vmcnt(11) lgkmcnt(8)
  v_mfma_f32_16x16x32_bf16 v[96:99], v[176:179], v[40:43], v[96:99]
  ds_read_b64_tr_b16 v[208:209], v20 offset:12288
  v_mfma_f32_16x16x32_bf16 v[100:103], v[176:179], v[44:47], v[100:103]
  buffer_load_dwordx4 v[92:95], off, s[64:67], s51 offset:1024
  v_mfma_f32_16x16x32_bf16 v[108:111], v[180:183], v[44:47], v[108:111]
  ds_read_b64_tr_b16 v[210:211], v20 offset:14336
  ds_read_b64_tr_b16 v[212:213], v21 offset:12288
  v_mfma_f32_16x16x32_bf16 v[104:107], v[180:183], v[40:43], v[104:107]
  ds_read_b64_tr_b16 v[214:215], v21 offset:14336
  v_mfma_f32_16x16x32_bf16 v[112:115], v[184:187], v[40:43], v[112:115]
  ds_read_b64_tr_b16 v[216:217], v22 offset:12288
  v_mfma_f32_16x16x32_bf16 v[116:119], v[184:187], v[44:47], v[116:119]
  ds_read_b64_tr_b16 v[218:219], v22 offset:14336
  v_readlane_b32 s48, v15, 12
  v_mfma_f32_16x16x32_bf16 v[124:127], v[188:191], v[44:47], v[124:127]
  ds_read_b64_tr_b16 v[220:221], v23 offset:12288
  v_mfma_f32_16x16x32_bf16 v[120:123], v[188:191], v[40:43], v[120:123]
  ds_read_b64_tr_b16 v[222:223], v23 offset:14336
  s_waitcnt vmcnt(10) lgkmcnt(8)
  v_mfma_f32_16x16x32_bf16 v[96:99], v[192:195], v[48:51], v[96:99]
  buffer_load_dwordx4 v[32:35], off, s[36:39], s48 offset:0
  v_mfma_f32_16x16x32_bf16 v[100:103], v[192:195], v[52:55], v[100:103]
  ds_read_b64_tr_b16 v[160:161], v20 offset:16384
  ds_read_b64_tr_b16 v[162:163], v20 offset:18432
  v_mfma_f32_16x16x32_bf16 v[108:111], v[196:199], v[52:55], v[108:111]
  ds_read_b64_tr_b16 v[164:165], v21 offset:16384
  v_mfma_f32_16x16x32_bf16 v[104:107], v[196:199], v[48:51], v[104:107]
  buffer_load_dwordx4 v[36:39], off, s[64:67], s48 offset:0
  v_mfma_f32_16x16x32_bf16 v[112:115], v[200:203], v[48:51], v[112:115]
  ds_read_b64_tr_b16 v[166:167], v21 offset:18432
  ds_read_b64_tr_b16 v[168:169], v22 offset:16384
  v_mfma_f32_16x16x32_bf16 v[116:119], v[200:203], v[52:55], v[116:119]
  ds_read_b64_tr_b16 v[170:171], v22 offset:18432
  ds_read_b64_tr_b16 v[172:173], v23 offset:16384
  v_mfma_f32_16x16x32_bf16 v[124:127], v[204:207], v[52:55], v[124:127]
  buffer_load_dwordx4 v[40:43], off, s[36:39], s48 offset:1024
  v_mfma_f32_16x16x32_bf16 v[120:123], v[204:207], v[48:51], v[120:123]
  ds_read_b64_tr_b16 v[174:175], v23 offset:18432
  s_waitcnt vmcnt(11) lgkmcnt(8)
  v_mfma_f32_16x16x32_bf16 v[96:99], v[208:211], v[56:59], v[96:99]
  ds_read_b64_tr_b16 v[176:177], v20 offset:20480
  v_mfma_f32_16x16x32_bf16 v[100:103], v[208:211], v[60:63], v[100:103]
  buffer_load_dwordx4 v[44:47], off, s[64:67], s48 offset:1024
  v_mfma_f32_16x16x32_bf16 v[108:111], v[212:215], v[60:63], v[108:111]
  ds_read_b64_tr_b16 v[178:179], v20 offset:22528
  ds_read_b64_tr_b16 v[180:181], v21 offset:20480
  v_mfma_f32_16x16x32_bf16 v[104:107], v[212:215], v[56:59], v[104:107]
  ds_read_b64_tr_b16 v[182:183], v21 offset:22528
  v_mfma_f32_16x16x32_bf16 v[112:115], v[216:219], v[56:59], v[112:115]
  ds_read_b64_tr_b16 v[184:185], v22 offset:20480
  v_mfma_f32_16x16x32_bf16 v[116:119], v[216:219], v[60:63], v[116:119]
  ds_read_b64_tr_b16 v[186:187], v22 offset:22528
  v_readlane_b32 s49, v15, 13
  v_mfma_f32_16x16x32_bf16 v[124:127], v[220:223], v[60:63], v[124:127]
  ds_read_b64_tr_b16 v[188:189], v23 offset:20480
  v_mfma_f32_16x16x32_bf16 v[120:123], v[220:223], v[56:59], v[120:123]
  ds_read_b64_tr_b16 v[190:191], v23 offset:22528
  s_waitcnt vmcnt(10) lgkmcnt(8)
  v_mfma_f32_16x16x32_bf16 v[96:99], v[160:163], v[64:67], v[96:99]
  buffer_load_dwordx4 v[48:51], off, s[36:39], s49 offset:0
  v_mfma_f32_16x16x32_bf16 v[100:103], v[160:163], v[68:71], v[100:103]
  ds_read_b64_tr_b16 v[192:193], v20 offset:24576
  ds_read_b64_tr_b16 v[194:195], v20 offset:26624
  v_mfma_f32_16x16x32_bf16 v[108:111], v[164:167], v[68:71], v[108:111]
  ds_read_b64_tr_b16 v[196:197], v21 offset:24576
  v_mfma_f32_16x16x32_bf16 v[104:107], v[164:167], v[64:67], v[104:107]
  buffer_load_dwordx4 v[52:55], off, s[64:67], s49 offset:0
  v_mfma_f32_16x16x32_bf16 v[112:115], v[168:171], v[64:67], v[112:115]
  ds_read_b64_tr_b16 v[198:199], v21 offset:26624
  ds_read_b64_tr_b16 v[200:201], v22 offset:24576
  v_mfma_f32_16x16x32_bf16 v[116:119], v[168:171], v[68:71], v[116:119]
  ds_read_b64_tr_b16 v[202:203], v22 offset:26624
  ds_read_b64_tr_b16 v[204:205], v23 offset:24576
  v_mfma_f32_16x16x32_bf16 v[124:127], v[172:175], v[68:71], v[124:127]
  buffer_load_dwordx4 v[56:59], off, s[36:39], s49 offset:1024
  v_mfma_f32_16x16x32_bf16 v[120:123], v[172:175], v[64:67], v[120:123]
  ds_read_b64_tr_b16 v[206:207], v23 offset:26624
  s_waitcnt vmcnt(11) lgkmcnt(8)
  v_mfma_f32_16x16x32_bf16 v[96:99], v[176:179], v[72:75], v[96:99]
  ds_read_b64_tr_b16 v[208:209], v20 offset:28672
  v_mfma_f32_16x16x32_bf16 v[100:103], v[176:179], v[76:79], v[100:103]
  buffer_load_dwordx4 v[60:63], off, s[64:67], s49 offset:1024
  v_mfma_f32_16x16x32_bf16 v[108:111], v[180:183], v[76:79], v[108:111]
  ds_read_b64_tr_b16 v[210:211], v20 offset:30720
  ds_read_b64_tr_b16 v[212:213], v21 offset:28672
  v_mfma_f32_16x16x32_bf16 v[104:107], v[180:183], v[72:75], v[104:107]
  ds_read_b64_tr_b16 v[214:215], v21 offset:30720
  v_mfma_f32_16x16x32_bf16 v[112:115], v[184:187], v[72:75], v[112:115]
  ds_read_b64_tr_b16 v[216:217], v22 offset:28672
  v_mfma_f32_16x16x32_bf16 v[116:119], v[184:187], v[76:79], v[116:119]
  ds_read_b64_tr_b16 v[218:219], v22 offset:30720
  v_readlane_b32 s50, v15, 14
  v_mfma_f32_16x16x32_bf16 v[124:127], v[188:191], v[76:79], v[124:127]
  ds_read_b64_tr_b16 v[220:221], v23 offset:28672
  v_mfma_f32_16x16x32_bf16 v[120:123], v[188:191], v[72:75], v[120:123]
  ds_read_b64_tr_b16 v[222:223], v23 offset:30720
  s_waitcnt vmcnt(10) lgkmcnt(8)
  v_mfma_f32_16x16x32_bf16 v[96:99], v[192:195], v[80:83], v[96:99]
  buffer_load_dwordx4 v[64:67], off, s[36:39], s50 offset:0
  v_mfma_f32_16x16x32_bf16 v[100:103], v[192:195], v[84:87], v[100:103]
  ds_read_b64_tr_b16 v[160:161], v20 offset:36864
  ds_read_b64_tr_b16 v[162:163], v20 offset:38912
  v_mfma_f32_16x16x32_bf16 v[108:111], v[196:199], v[84:87], v[108:111]
  ds_read_b64_tr_b16 v[164:165], v21 offset:36864
  v_mfma_f32_16x16x32_bf16 v[104:107], v[196:199], v[80:83], v[104:107]
  buffer_load_dwordx4 v[68:71], off, s[64:67], s50 offset:0
  v_mfma_f32_16x16x32_bf16 v[112:115], v[200:203], v[80:83], v[112:115]
  ds_read_b64_tr_b16 v[166:167], v21 offset:38912
  ds_read_b64_tr_b16 v[168:169], v22 offset:36864
  v_mfma_f32_16x16x32_bf16 v[116:119], v[200:203], v[84:87], v[116:119]
  ds_read_b64_tr_b16 v[170:171], v22 offset:38912
  ds_read_b64_tr_b16 v[172:173], v23 offset:36864
  v_mfma_f32_16x16x32_bf16 v[124:127], v[204:207], v[84:87], v[124:127]
  buffer_load_dwordx4 v[72:75], off, s[36:39], s50 offset:1024
  v_mfma_f32_16x16x32_bf16 v[120:123], v[204:207], v[80:83], v[120:123]
  ds_read_b64_tr_b16 v[174:175], v23 offset:38912
  s_waitcnt vmcnt(11) lgkmcnt(8)
  v_mfma_f32_16x16x32_bf16 v[96:99], v[208:211], v[88:91], v[96:99]
  ds_read_b64_tr_b16 v[176:177], v20 offset:40960
  v_mfma_f32_16x16x32_bf16 v[100:103], v[208:211], v[92:95], v[100:103]
  buffer_load_dwordx4 v[76:79], off, s[64:67], s50 offset:1024
  v_mfma_f32_16x16x32_bf16 v[108:111], v[212:215], v[92:95], v[108:111]
  ds_read_b64_tr_b16 v[178:179], v20 offset:43008
  ds_read_b64_tr_b16 v[180:181], v21 offset:40960
  v_mfma_f32_16x16x32_bf16 v[104:107], v[212:215], v[88:91], v[104:107]
  ds_read_b64_tr_b16 v[182:183], v21 offset:43008
  v_mfma_f32_16x16x32_bf16 v[112:115], v[216:219], v[88:91], v[112:115]
  ds_read_b64_tr_b16 v[184:185], v22 offset:40960
  v_mfma_f32_16x16x32_bf16 v[116:119], v[216:219], v[92:95], v[116:119]
  ds_read_b64_tr_b16 v[186:187], v22 offset:43008
  v_readlane_b32 s51, v15, 15
  v_mfma_f32_16x16x32_bf16 v[124:127], v[220:223], v[92:95], v[124:127]
  ds_read_b64_tr_b16 v[188:189], v23 offset:40960
  v_mfma_f32_16x16x32_bf16 v[120:123], v[220:223], v[88:91], v[120:123]
  ds_read_b64_tr_b16 v[190:191], v23 offset:43008
  s_waitcnt vmcnt(10) lgkmcnt(8)
  v_mfma_f32_16x16x32_bf16 v[96:99], v[160:163], v[32:35], v[96:99]
  buffer_load_dwordx4 v[80:83], off, s[36:39], s51 offset:0
  v_mfma_f32_16x16x32_bf16 v[100:103], v[160:163], v[36:39], v[100:103]
  ds_read_b64_tr_b16 v[192:193], v20 offset:45056
  ds_read_b64_tr_b16 v[194:195], v20 offset:47104
  v_mfma_f32_16x16x32_bf16 v[108:111], v[164:167], v[36:39], v[108:111]
  ds_read_b64_tr_b16 v[196:197], v21 offset:45056
  v_mfma_f32_16x16x32_bf16 v[104:107], v[164:167], v[32:35], v[104:107]
  buffer_load_dwordx4 v[84:87], off, s[64:67], s51 offset:0
  v_mfma_f32_16x16x32_bf16 v[112:115], v[168:171], v[32:35], v[112:115]
  ds_read_b64_tr_b16 v[198:199], v21 offset:47104
  ds_read_b64_tr_b16 v[200:201], v22 offset:45056
  v_mfma_f32_16x16x32_bf16 v[116:119], v[168:171], v[36:39], v[116:119]
  ds_read_b64_tr_b16 v[202:203], v22 offset:47104
  ds_read_b64_tr_b16 v[204:205], v23 offset:45056
  v_mfma_f32_16x16x32_bf16 v[124:127], v[172:175], v[36:39], v[124:127]
  buffer_load_dwordx4 v[88:91], off, s[36:39], s51 offset:1024
  v_mfma_f32_16x16x32_bf16 v[120:123], v[172:175], v[32:35], v[120:123]
  ds_read_b64_tr_b16 v[206:207], v23 offset:47104
  s_waitcnt vmcnt(11) lgkmcnt(8)
  v_mfma_f32_16x16x32_bf16 v[96:99], v[176:179], v[40:43], v[96:99]
  ds_read_b64_tr_b16 v[208:209], v20 offset:49152
  v_mfma_f32_16x16x32_bf16 v[100:103], v[176:179], v[44:47], v[100:103]
  buffer_load_dwordx4 v[92:95], off, s[64:67], s51 offset:1024
  v_mfma_f32_16x16x32_bf16 v[108:111], v[180:183], v[44:47], v[108:111]
  ds_read_b64_tr_b16 v[210:211], v20 offset:51200
  ds_read_b64_tr_b16 v[212:213], v21 offset:49152
  v_mfma_f32_16x16x32_bf16 v[104:107], v[180:183], v[40:43], v[104:107]
  ds_read_b64_tr_b16 v[214:215], v21 offset:51200
  v_mfma_f32_16x16x32_bf16 v[112:115], v[184:187], v[40:43], v[112:115]
  ds_read_b64_tr_b16 v[216:217], v22 offset:49152
  v_mfma_f32_16x16x32_bf16 v[116:119], v[184:187], v[44:47], v[116:119]
  ds_read_b64_tr_b16 v[218:219], v22 offset:51200
  v_mfma_f32_16x16x32_bf16 v[124:127], v[188:191], v[44:47], v[124:127]
  ds_read_b64_tr_b16 v[220:221], v23 offset:49152
  v_mfma_f32_16x16x32_bf16 v[120:123], v[188:191], v[40:43], v[120:123]
  ds_read_b64_tr_b16 v[222:223], v23 offset:51200
  s_waitcnt vmcnt(10) lgkmcnt(8)
  v_mfma_f32_16x16x32_bf16 v[96:99], v[192:195], v[48:51], v[96:99]
  ds_read_b64_tr_b16 v[160:161], v20 offset:53248
  v_mfma_f32_16x16x32_bf16 v[100:103], v[192:195], v[52:55], v[100:103]
  ds_read_b64_tr_b16 v[162:163], v20 offset:55296
  v_mfma_f32_16x16x32_bf16 v[108:111], v[196:199], v[52:55], v[108:111]
  ds_read_b64_tr_b16 v[164:165], v21 offset:53248
  v_mfma_f32_16x16x32_bf16 v[104:107], v[196:199], v[48:51], v[104:107]
  ds_read_b64_tr_b16 v[166:167], v21 offset:55296
  v_mfma_f32_16x16x32_bf16 v[112:115], v[200:203], v[48:51], v[112:115]
  ds_read_b64_tr_b16 v[168:169], v22 offset:53248
  v_mfma_f32_16x16x32_bf16 v[116:119], v[200:203], v[52:55], v[116:119]
  ds_read_b64_tr_b16 v[170:171], v22 offset:55296
  v_mfma_f32_16x16x32_bf16 v[124:127], v[204:207], v[52:55], v[124:127]
  ds_read_b64_tr_b16 v[172:173], v23 offset:53248
  v_mfma_f32_16x16x32_bf16 v[120:123], v[204:207], v[48:51], v[120:123]
  ds_read_b64_tr_b16 v[174:175], v23 offset:55296
  s_waitcnt vmcnt(8) lgkmcnt(8)
  s_barrier
  v_mfma_f32_16x16x32_bf16 v[96:99], v[208:211], v[56:59], v[96:99]
  ds_read_b64_tr_b16 v[176:177], v20 offset:57344
  v_mfma_f32_16x16x32_bf16 v[100:103], v[208:211], v[60:63], v[100:103]
  ds_read_b64_tr_b16 v[178:179], v20 offset:59392
  v_mfma_f32_16x16x32_bf16 v[108:111], v[212:215], v[60:63], v[108:111]
  ds_read_b64_tr_b16 v[180:181], v21 offset:57344
  v_mfma_f32_16x16x32_bf16 v[104:107], v[212:215], v[56:59], v[104:107]
  ds_read_b64_tr_b16 v[182:183], v21 offset:59392
  v_mfma_f32_16x16x32_bf16 v[112:115], v[216:219], v[56:59], v[112:115]
  ds_read_b64_tr_b16 v[184:185], v22 offset:57344
  v_mfma_f32_16x16x32_bf16 v[116:119], v[216:219], v[60:63], v[116:119]
  ds_read_b64_tr_b16 v[186:187], v22 offset:59392
  v_mfma_f32_16x16x32_bf16 v[124:127], v[220:223], v[60:63], v[124:127]
  ds_read_b64_tr_b16 v[188:189], v23 offset:57344
  v_mfma_f32_16x16x32_bf16 v[120:123], v[220:223], v[56:59], v[120:123]
  ds_read_b64_tr_b16 v[190:191], v23 offset:59392
  s_waitcnt vmcnt(6) lgkmcnt(8)
  v_mfma_f32_16x16x32_bf16 v[96:99], v[160:163], v[64:67], v[96:99]
  ds_read_b64_tr_b16 v[192:193], v26 offset:0
  v_mfma_f32_16x16x32_bf16 v[100:103], v[160:163], v[68:71], v[100:103]
  ds_read_b64_tr_b16 v[194:195], v26 offset:2048
  v_mfma_f32_16x16x32_bf16 v[108:111], v[164:167], v[68:71], v[108:111]
  ds_read_b64_tr_b16 v[196:197], v27 offset:0
  v_mfma_f32_16x16x32_bf16 v[104:107], v[164:167], v[64:67], v[104:107]
  ds_read_b64_tr_b16 v[198:199], v27 offset:2048
  v_mfma_f32_16x16x32_bf16 v[112:115], v[168:171], v[64:67], v[112:115]
  ds_read_b64_tr_b16 v[200:201], v28 offset:0
  v_mfma_f32_16x16x32_bf16 v[116:119], v[168:171], v[68:71], v[116:119]
  ds_read_b64_tr_b16 v[202:203], v28 offset:2048
  v_mfma_f32_16x16x32_bf16 v[124:127], v[172:175], v[68:71], v[124:127]
  ds_read_b64_tr_b16 v[204:205], v29 offset:0
  v_mfma_f32_16x16x32_bf16 v[120:123], v[172:175], v[64:67], v[120:123]
  ds_read_b64_tr_b16 v[206:207], v29 offset:2048
  s_waitcnt vmcnt(4) lgkmcnt(8)
  v_mfma_f32_16x16x32_bf16 v[96:99], v[176:179], v[72:75], v[96:99]
  ds_read_b64_tr_b16 v[208:209], v26 offset:4096
  v_mfma_f32_16x16x32_bf16 v[100:103], v[176:179], v[76:79], v[100:103]
  ds_read_b64_tr_b16 v[210:211], v26 offset:6144
  v_mfma_f32_16x16x32_bf16 v[108:111], v[180:183], v[76:79], v[108:111]
  ds_read_b64_tr_b16 v[212:213], v27 offset:4096
  v_mfma_f32_16x16x32_bf16 v[104:107], v[180:183], v[72:75], v[104:107]
  ds_read_b64_tr_b16 v[214:215], v27 offset:6144
  v_mfma_f32_16x16x32_bf16 v[112:115], v[184:187], v[72:75], v[112:115]
  ds_read_b64_tr_b16 v[216:217], v28 offset:4096
  v_mfma_f32_16x16x32_bf16 v[116:119], v[184:187], v[76:79], v[116:119]
  ds_read_b64_tr_b16 v[218:219], v28 offset:6144
  v_mfma_f32_16x16x32_bf16 v[124:127], v[188:191], v[76:79], v[124:127]
  ds_read_b64_tr_b16 v[220:221], v29 offset:4096
  v_mfma_f32_16x16x32_bf16 v[120:123], v[188:191], v[72:75], v[120:123]
  ds_read_b64_tr_b16 v[222:223], v29 offset:6144
  s_waitcnt vmcnt(2) lgkmcnt(8)
  v_mfma_f32_16x16x32_bf16 v[96:99], v[192:195], v[80:83], v[96:99]
  v_mov_b32 v20, 0
  v_mov_b32 v21, 0
  v_mfma_f32_16x16x32_bf16 v[100:103], v[192:195], v[84:87], v[100:103]
  v_mov_b32 v22, 0
  v_mov_b32 v23, 0
  v_mfma_f32_16x16x32_bf16 v[108:111], v[196:199], v[84:87], v[108:111]
  v_mfma_f32_16x16x32_bf16 v[104:107], v[196:199], v[80:83], v[104:107]
  v_mfma_f32_16x16x32_bf16 v[112:115], v[200:203], v[80:83], v[112:115]
  v_mfma_f32_16x16x32_bf16 v[116:119], v[200:203], v[84:87], v[116:119]
  v_mfma_f32_16x16x32_bf16 v[124:127], v[204:207], v[84:87], v[124:127]
  v_mfma_f32_16x16x32_bf16 v[120:123], v[204:207], v[80:83], v[120:123]
  s_waitcnt vmcnt(0) lgkmcnt(0)
  v_mfma_f32_16x16x32_bf16 v[96:99], v[208:211], v[88:91], v[96:99]
  v_mfma_f32_16x16x32_bf16 v[100:103], v[208:211], v[92:95], v[100:103]
  v_mfma_f32_16x16x32_bf16 v[108:111], v[212:215], v[92:95], v[108:111]
  v_mfma_f32_16x16x32_bf16 v[104:107], v[212:215], v[88:91], v[104:107]
  v_mfma_f32_16x16x32_bf16 v[112:115], v[216:219], v[88:91], v[112:115]
  v_mfma_f32_16x16x32_bf16 v[116:119], v[216:219], v[92:95], v[116:119]
  v_mfma_f32_16x16x32_bf16 v[124:127], v[220:223], v[92:95], v[124:127]
  v_mfma_f32_16x16x32_bf16 v[120:123], v[220:223], v[88:91], v[120:123]
  s_mov_b32 s3, 32768
  s_mov_b32 s10, 0x3f803f80
  s_nop 4
  v_cvt_pk_bf16_f32 v240, v96, v97
  v_cvt_pk_bf16_f32 v241, v98, v99
  v_cvt_pk_bf16_f32 v242, v104, v105
  v_cvt_pk_bf16_f32 v243, v106, v107
  buffer_store_dwordx4 v[240:243], v12, s[44:47], 0 offen offset:0 sc1
  ds_write_b128 v19, v[240:243] offset:0
  v_cvt_pk_bf16_f32 v244, v112, v113
  v_cvt_pk_bf16_f32 v245, v114, v115
  v_cvt_pk_bf16_f32 v246, v120, v121
  v_cvt_pk_bf16_f32 v247, v122, v123
  buffer_store_dwordx4 v[244:247], v12, s[44:47], 0 offen offset:1024 sc1
  ds_write_b128 v19, v[244:247] offset:1024
  v_cvt_pk_bf16_f32 v248, v100, v101
  v_cvt_pk_bf16_f32 v249, v102, v103
  v_cvt_pk_bf16_f32 v250, v108, v109
  v_cvt_pk_bf16_f32 v251, v110, v111
  buffer_store_dwordx4 v[248:251], v12, s[44:47], s3 offen offset:0 sc1
  ds_write_b128 v19, v[248:251] offset:2048
  v_cvt_pk_bf16_f32 v252, v116, v117
  v_cvt_pk_bf16_f32 v253, v118, v119
  v_cvt_pk_bf16_f32 v254, v124, v125
  v_cvt_pk_bf16_f32 v255, v126, v127
  buffer_store_dwordx4 v[252:255], v12, s[44:47], s3 offen offset:1024 sc1
  ds_write_b128 v19, v[252:255] offset:3072
  v_dot2_f32_bf16 v20, v240, s10, v20
  v_dot2_f32_bf16 v22, v240, v240, v22
  v_dot2_f32_bf16 v20, v241, s10, v20
  v_dot2_f32_bf16 v22, v241, v241, v22
  v_dot2_f32_bf16 v20, v242, s10, v20
  v_dot2_f32_bf16 v22, v242, v242, v22
  v_dot2_f32_bf16 v20, v243, s10, v20
  v_dot2_f32_bf16 v22, v243, v243, v22
  v_dot2_f32_bf16 v20, v244, s10, v20
  v_dot2_f32_bf16 v22, v244, v244, v22
  v_dot2_f32_bf16 v20, v245, s10, v20
  v_dot2_f32_bf16 v22, v245, v245, v22
  v_dot2_f32_bf16 v20, v246, s10, v20
  v_dot2_f32_bf16 v22, v246, v246, v22
  v_dot2_f32_bf16 v20, v247, s10, v20
  v_dot2_f32_bf16 v22, v247, v247, v22
  v_dot2_f32_bf16 v21, v248, s10, v21
  v_dot2_f32_bf16 v23, v248, v248, v23
  v_dot2_f32_bf16 v21, v249, s10, v21
  v_dot2_f32_bf16 v23, v249, v249, v23
  v_dot2_f32_bf16 v21, v250, s10, v21
  v_dot2_f32_bf16 v23, v250, v250, v23
  v_dot2_f32_bf16 v21, v251, s10, v21
  v_dot2_f32_bf16 v23, v251, v251, v23
  v_dot2_f32_bf16 v21, v252, s10, v21
  v_dot2_f32_bf16 v23, v252, v252, v23
  v_dot2_f32_bf16 v21, v253, s10, v21
  v_dot2_f32_bf16 v23, v253, v253, v23
  v_dot2_f32_bf16 v21, v254, s10, v21
  v_dot2_f32_bf16 v23, v254, v254, v23
  v_dot2_f32_bf16 v21, v255, s10, v21
  v_dot2_f32_bf16 v23, v255, v255, v23
  s_nop 2
  v_permlane32_swap_b32 v20, v21
  v_permlane32_swap_b32 v22, v23
  v_add_f32 v20, v20, v21
  v_add_f32 v22, v22, v23
  s_nop 1
  v_permlane16_swap_b32 v20, v22
  v_add_f32 v20, v20, v22
  buffer_store_dword v20, v18, s[56:59], 0 offen sc1
  s_waitcnt vmcnt(0) lgkmcnt(0)
  s_barrier
  s_add_u32 s97, s97, 1
  s_branch L_w1_body
L_wo_c1:
L_w1_c0:
L_w1_body:
  s_cmp_ge_u32 s2, 256
  s_cbranch_scc1 L_w1_end
  v_lshrrev_b32 v2, 6, v0
  v_and_b32 v1, 63, v0
  v_readfirstlane_b32 s70, v2
  s_and_b32 s3, s2, 7
  s_lshr_b32 s99, s2, 3
  s_and_b32 s5, s3, 3
  s_lshl_b32 s5, s5, 2
  s_and_b32 s6, s99, 3
  s_add_u32 s68, s5, s6
  s_lshr_b32 s5, s3, 2
  s_lshl_b32 s5, s5, 3
  s_lshr_b32 s6, s99, 2
  s_add_u32 s69, s5, s6
  s_cmp_lt_u32 s70, 4
  s_cbranch_scc1 L_w1_compute
L_w1_loader:
  s_add_u32 s8, s70, s69
  s_and_b32 s8, s8, 3
  s_add_u32 s9, s70, s68
  s_and_b32 s9, s9, 3
  s_lshl_b32 s76, s8, 12
  s_lshl_b32 s77, s9, 11
  s_add_u32 s77, s77, 16384
  s_lshl_b32 s11, s68, 7
  v_and_b32 v10, 7, v1
  s_lshr_b32 s10, s76, 11
  s_lshl_b32 s3, s68, 3
  s_add_u32 s10, s10, s3
  s_mul_i32 s10, s10, 32768
  v_lshl_add_u32 v4, v1, 4, s10
  v_add_u32 v5, 32768, v4
  v_lshrrev_b32 v3, 3, v1
  s_lshl_b32 s10, s9, 4
  v_add_u32 v3, s10, v3
  v_mul_u32_u24 v3, 7168, v3
  v_lshrrev_b32 v2, 3, v1
  v_and_b32 v2, 6, v2
  v_xor_b32 v2, v2, v10
  s_mul_i32 s10, s69, 128
  v_add_u32 v3, s10, v3
  v_lshl_add_u32 v8, v2, 4, v3
  v_add_u32 v3, 57344, v3
  v_lshl_add_u32 v9, v2, 4, v3
  v_lshrrev_b32 v3, 2, v1
  s_lshl_b32 s10, s9, 4
  v_add_u32 v3, s10, v3
  v_mul_u32_u24 v3, 7168, v3
  v_bfe_u32 v2, v1, 4, 1
  v_xor_b32 v2, v2, v1
  v_and_b32 v2, 3, v2
  s_lshl_b32 s10, s69, 6
  s_add_u32 s10, s10, 2048
  v_add_u32 v3, s10, v3
  v_lshl_add_u32 v28, v2, 4, v3
  s_lshl_b32 s78, s69, 7
  s_add_u32 s78, s78, 3072
  s_mov_b32 s75, 0
  s_add_u32 s100, s68, s69
  s_mov_b32 s101, -1
  s_add_u32 s3, s68, s69
  s_and_b32 s3, s3, 3
  s_mov_b32 s100, 0x68532410
  s_mov_b32 s101, 0xfedbac97
  s_cmp_eq_u32 s3, 1
  s_cselect_b32 s100, 0x96435210, s100
  s_cselect_b32 s101, 0xfecbda87, s101
  s_cmp_eq_u32 s3, 2
  s_cselect_b32 s100, 0x75463210, s100
  s_cselect_b32 s101, 0xfdceb98a, s101
  s_cmp_eq_u32 s3, 3
  s_cselect_b32 s100, 0x65743210, s100
  s_cselect_b32 s101, 0xedfca9b8, s101
  s_waitcnt lgkmcnt(0)
  s_mov_b32 s40, s24
  s_and_b32 s41, s25, 0xffff
  s_mov_b32 s42, 7340032
  s_mov_b32 s43, 0x00020000
  s_cmp_lg_u32 s96, 0
  s_cbranch_scc1 L_pfc3_skip
  s_getpc_b64 s[4:5]
L_pfc3:
  s_lshl_b32 s3, s99, 2
  s_add_u32 s3, s3, s70
  s_sub_u32 s3, s3, 4
  s_mul_i32 s3, s3, 192
  s_min_u32 s3, s3, L_w2_c1-L_w2_c0-192
  s_add_i32 s3, s3, L_w2_c0-L_pfc3
  s_ashr_i32 s6, s3, 31
  s_add_u32 s4, s4, s3
  s_addc_u32 s5, s5, s6
  s_load_dword s84, s[4:5], 0
  s_load_dword s84, s[4:5], 64
  s_load_dword s84, s[4:5], 128
L_pfc3_skip:
  s_add_u32 s36, s34, 4194304
  s_addc_u32 s37, s35, 0
  s_and_b32 s37, s37, 0xffff
  s_mov_b32 s38, 4194304
  s_mov_b32 s39, 0x00020000
  s_add_u32 s56, s34, 24117248
  s_addc_u32 s57, s35, 0
  s_and_b32 s57, s57, 0xffff
  s_mov_b32 s58, 262144
  s_mov_b32 s59, 0x00020000
  s_add_u32 s64, s22, 24641536
  s_addc_u32 s65, s23, 0
  s_and_b32 s65, s65, 0xffff
  s_mov_b32 s66, 262144
  s_mov_b32 s67, 0x00020000
  s_mov_b32 s52, s26
  s_and_b32 s53, s27, 0xffff
  s_mov_b32 s54, 7168
  s_mov_b32 s55, 0x00020000
  s_and_b32 s3, s70, 3
  s_lshl2_add_u32 s4, s68, s3
  s_lshl_b32 s4, s4, 8
  v_lshrrev_b32 v2, 4, v1
  v_and_b32 v3, 15, v1
  v_lshl_add_u32 v3, v3, 4, s4
  v_lshl_add_u32 v18, v2, 14, v3
  s_lshl_b32 s4, s69, 7
  s_lshl_b32 s5, s70, 6
  s_add_u32 s4, s4, s5
  s_add_u32 s4, s4, 1216
  s_lshl_b32 s5, s69, 6
  s_cmp_eq_u32 s70, 4
  s_cselect_b32 s4, s5, s4
  s_lshr_b32 s5, s5, 1
  s_add_u32 s5, s5, 1024
  s_cmp_eq_u32 s70, 7
  s_cselect_b32 s4, s5, s4
  v_and_b32 v3, 15, v1
  v_lshl_add_u32 v3, v3, 2, s4
  v_lshrrev_b32 v2, 4, v1
  v_add_lshl_u32 v23, v3, v2, 1
  v_lshlrev_b32 v3, 2, v3
  v_lshl_add_u32 v22, v2, 14, v3
  s_mov_b32 s60, s28
  s_and_b32 s61, s29, 0xffff
  s_mov_b32 s62, 7340032
  s_mov_b32 s63, 0x00020000
  s_cmp_eq_u32 s96, 0
  s_cselect_b32 s62, s62, 0
  s_and_b32 s3, s70, 3
  s_lshl_b32 s4, s2, 2
  s_add_u32 s3, s3, s4
  s_mul_i32 s98, s3, 3584
  s_add_u32 s98, s98, 3670016
  s_buffer_load_dword s84, s[60:63], s98 offset:0
  s_buffer_load_dword s84, s[60:63], s98 offset:64
  s_buffer_load_dword s84, s[60:63], s98 offset:128
  s_buffer_load_dword s84, s[60:63], s98 offset:192
  s_waitcnt vmcnt(0)
  s_barrier
  s_lshr_b32 s3, s69, 3
  s_and_b32 s73, s69, 7
  s_lshl1_add_u32 s91, s73, s3
  s_mul_i32 s74, s91, 458752
  s_lshl_b32 s73, s91, 11
  s_mov_b32 s88, s73
  s_add_u32 m0, s77, 0
  s_add_u32 s4, s74, 0
  buffer_load_dwordx4 v8, s[40:43], s4 offen lds
  s_add_u32 m0, s77, 1024
  s_nop 0
  buffer_load_dwordx4 v9, s[40:43], s4 offen lds
  s_add_u32 m0, s77, 8192
  s_add_u32 s4, s74, s78
  buffer_load_dwordx4 v8, s[40:43], s4 offen lds
  s_add_u32 m0, s77, 9216
  s_nop 0
  buffer_load_dwordx4 v9, s[40:43], s4 offen lds
  s_add_u32 m0, s77, 16384
  s_add_u32 s4, s4, 128
  buffer_load_dwordx4 v8, s[40:43], s4 offen lds
  s_add_u32 m0, s77, 17408
  s_nop 0
  buffer_load_dwordx4 v9, s[40:43], s4 offen lds
  s_add_u32 m0, s77, 24576
  s_nop 0
  buffer_load_dwordx4 v28, s[40:43], s74 offen lds
  s_and_b32 s73, s100, 15
  s_cmp_eq_u32 s73, s91
  s_cselect_b32 s74, 4, 0
  s_lshr_b64 s[100:101], s[100:101], s74
  s_and_b32 s73, s100, 15
  s_lshr_b64 s[100:101], s[100:101], 4
  s_mul_i32 s74, s73, 458752
  s_lshl_b32 s73, s73, 11
  s_add_u32 s3, s96, s70
  s_cmp_lg_u32 s3, 4
  s_cbranch_scc1 L_w1_chkNone
  s_add_u32 s44, s22, 41943040
  s_addc_u32 s45, s23, 0
  s_and_b32 s45, s45, 0xffff
  s_mov_b32 s46, 524288
  s_mov_b32 s47, 0x00020000
  v_lshrrev_b32 v2, 2, v1
  v_and_b32 v3, 3, v1
  v_lshlrev_b32 v2, 11, v2
  v_lshl_add_u32 v17, v3, 4, v2
  s_and_b32 s3, s69, 15
  s_lshl_b32 s3, s3, 7
  s_mov_b32 s79, 0x100000
L_w1_chkl:
  buffer_load_dwordx4 v[12:15], v17, s[44:47], s3 offen sc1
  s_sub_u32 s79, s79, 1
  s_cbranch_scc1 L_w1_chkNone
  s_waitcnt vmcnt(0)
  v_and_b32 v12, v12, v13
  v_and_b32 v14, v14, v15
  v_and_b32 v12, v12, v14
  v_cmp_ne_u32 vcc, 1, v12
  s_cbranch_vccnz L_w1_chkl
L_w1_chkNone:
  s_mov_b32 s75, 0
  s_add_u32 s44, s22, 41943040
  s_addc_u32 s45, s23, 0
  s_and_b32 s45, s45, 0xffff
  s_mov_b32 s46, 524288
  s_mov_b32 s47, 0x00020000
  s_lshl4_add_u32 s3, s97, s68
  s_and_b32 s4, s69, 15
  s_lshl4_add_u32 s3, s3, s4
  s_lshl_b32 s3, s3, 7
  s_sub_u32 s3, s3, 32768
  v_lshlrev_b32 v11, 7, v1
  v_and_b32 v2, 15, v1
  v_lshlrev_b32 v2, 2, v2
  s_getreg_b32 s4, hwreg(HW_REG_XCC_ID, 0, 4)
  v_add_u32 v3, 1, s4
  s_mov_b32 s79, 0x100000
  s_waitcnt vmcnt(0)
  s_cmp_lg_u32 s70, 4
  s_barrier
  s_cbranch_scc1 L_w1_nofl
  s_mov_b32 exec_lo, 0xffff
  s_mov_b32 exec_hi, 0
  buffer_store_dword v3, v11, s[44:47], s87 offen sc1
  s_mov_b64 exec, -1
L_w1_nofl:
  s_mov_b32 s5, s3
  s_mov_b32 s89, s73
  s_add_u32 m0, s77, 49152
  s_add_u32 s4, s74, 0
  buffer_load_dwordx4 v8, s[40:43], s4 offen lds
  s_add_u32 m0, s77, 50176
  s_nop 0
  buffer_load_dwordx4 v9, s[40:43], s4 offen lds
  s_add_u32 m0, s77, 57344
  s_add_u32 s4, s74, s78
  buffer_load_dwordx4 v8, s[40:43], s4 offen lds
  s_add_u32 m0, s77, 58368
  s_nop 0
  buffer_load_dwordx4 v9, s[40:43], s4 offen lds
  s_add_u32 m0, s77, 65536
  s_add_u32 s4, s4, 128
  buffer_load_dwordx4 v8, s[40:43], s4 offen lds
  s_add_u32 m0, s77, 66560
  s_nop 0
  buffer_load_dwordx4 v9, s[40:43], s4 offen lds
  s_add_u32 m0, s77, 73728
  s_nop 0
  buffer_load_dwordx4 v28, s[40:43], s74 offen lds
  s_and_b32 s73, s100, 15
  s_cmp_eq_u32 s73, s91
  s_cselect_b32 s74, 4, 0
  s_lshr_b64 s[100:101], s[100:101], s74
  s_and_b32 s73, s100, 15
  s_lshr_b64 s[100:101], s[100:101], 4
  s_mul_i32 s74, s73, 458752
  s_lshl_b32 s73, s73, 11
  s_mov_b32 s90, s73
  s_add_u32 m0, s77, 98304
  s_add_u32 s4, s74, 0
  buffer_load_dwordx4 v8, s[40:43], s4 offen lds
  s_add_u32 m0, s77, 99328
  s_nop 0
  buffer_load_dwordx4 v9, s[40:43], s4 offen lds
  s_add_u32 m0, s77, 106496
  s_add_u32 s4, s74, s78
  buffer_load_dwordx4 v8, s[40:43], s4 offen lds
  s_add_u32 m0, s77, 107520
  s_nop 0
  buffer_load_dwordx4 v9, s[40:43], s4 offen lds
  s_add_u32 m0, s77, 114688
  s_add_u32 s4, s4, 128
  buffer_load_dwordx4 v8, s[40:43], s4 offen lds
  s_add_u32 m0, s77, 115712
  s_nop 0
  buffer_load_dwordx4 v9, s[40:43], s4 offen lds
  s_add_u32 m0, s77, 122880
  s_nop 0
  buffer_load_dwordx4 v28, s[40:43], s74 offen lds
  s_and_b32 s73, s100, 15
  s_cmp_eq_u32 s73, s91
  s_cselect_b32 s74, 4, 0
  s_lshr_b64 s[100:101], s[100:101], s74
  s_and_b32 s73, s100, 15
  s_lshr_b64 s[100:101], s[100:101], 4
  s_mul_i32 s74, s73, 458752
  s_lshl_b32 s73, s73, 11
  s_mov_b32 s3, s5
  s_cmp_lg_u32 s70, 4
  s_cbranch_scc1 L_w1_dep
L_w1_poll:
  buffer_load_dword v27, v2, s[44:47], s3 offen sc1
  s_sub_u32 s79, s79, 1
  s_cbranch_scc1 L_w1_dep
  s_waitcnt vmcnt(0)
  v_cmp_eq_u32 vcc, 0, v27
  s_cbranch_vccnz L_w1_poll
L_w1_dep:
  s_barrier
  s_add_u32 m0, s76, 49152
  s_nop 0
  buffer_load_dwordx4 v4, s[36:39], s89 offen offset:0 lds
  buffer_load_dwordx4 v4, s[36:39], s89 offen offset:1024 lds
  s_add_u32 m0, s76, 51200
  s_nop 0
  buffer_load_dwordx4 v5, s[36:39], s89 offen offset:0 lds
  buffer_load_dwordx4 v5, s[36:39], s89 offen offset:1024 lds
  s_add_u32 m0, s76, 98304
  s_nop 0
  buffer_load_dwordx4 v4, s[36:39], s90 offen offset:0 lds
  buffer_load_dwordx4 v4, s[36:39], s90 offen offset:1024 lds
  s_add_u32 m0, s76, 100352
  s_nop 0
  buffer_load_dwordx4 v5, s[36:39], s90 offen offset:0 lds
  buffer_load_dwordx4 v5, s[36:39], s90 offen offset:1024 lds
  s_waitcnt vmcnt(4)
  s_barrier
  s_mov_b32 s79, 13
L_w1_ld1:
  s_add_u32 s3, s75, s76
  s_add_u32 m0, s3, 0
  s_nop 0
  buffer_load_dwordx4 v4, s[36:39], s73 offen offset:0 lds
  buffer_load_dwordx4 v4, s[36:39], s73 offen offset:1024 lds
  s_add_u32 m0, s3, 2048
  s_nop 0
  buffer_load_dwordx4 v5, s[36:39], s73 offen offset:0 lds
  buffer_load_dwordx4 v5, s[36:39], s73 offen offset:1024 lds
  s_add_u32 s3, s75, s77
  s_add_u32 m0, s3, 0
  s_add_u32 s4, s74, 0
  buffer_load_dwordx4 v8, s[40:43], s4 offen lds
  s_add_u32 m0, s3, 1024
  s_nop 0
  buffer_load_dwordx4 v9, s[40:43], s4 offen lds
  s_add_u32 m0, s3, 8192
  s_add_u32 s4, s74, s78
  buffer_load_dwordx4 v8, s[40:43], s4 offen lds
  s_add_u32 m0, s3, 9216
  s_nop 0
  buffer_load_dwordx4 v9, s[40:43], s4 offen lds
  s_add_u32 m0, s3, 16384
  s_add_u32 s4, s4, 128
  buffer_load_dwordx4 v8, s[40:43], s4 offen lds
  s_add_u32 m0, s3, 17408
  s_nop 0
  buffer_load_dwordx4 v9, s[40:43], s4 offen lds
  s_add_u32 m0, s3, 24576
  s_nop 0
  buffer_load_dwordx4 v28, s[40:43], s74 offen lds
  s_and_b32 s73, s100, 15
  s_cmp_eq_u32 s73, s91
  s_cselect_b32 s74, 4, 0
  s_lshr_b64 s[100:101], s[100:101], s74
  s_and_b32 s73, s100, 15
  s_lshr_b64 s[100:101], s[100:101], 4
  s_mul_i32 s74, s73, 458752
  s_lshl_b32 s73, s73, 11
  s_add_u32 s75, s75, 49152
  s_cmp_eq_u32 s75, 147456
  s_cselect_b32 s75, 0, s75
  s_buffer_load_dword s84, s[60:63], s98 offset:256
  s_buffer_load_dword s84, s[60:63], s98 offset:320
  s_buffer_load_dword s84, s[60:63], s98 offset:384
  s_buffer_load_dword s84, s[60:63], s98 offset:448
  s_add_u32 s98, s98, 256
  s_waitcnt vmcnt(11)
  s_barrier
  s_sub_u32 s79, s79, 1
  s_cmp_lg_u32 s79, 0
  s_cbranch_scc1 L_w1_ld1
  buffer_load_dwordx4 v[64:67], v22, s[64:67], 0 offen
  s_mov_b32 s3, 65536
  buffer_load_dwordx4 v[68:71], v22, s[64:67], s3 offen
  s_mov_b32 s3, 131072
  buffer_load_dwordx4 v[72:75], v22, s[64:67], s3 offen
  s_mov_b32 s3, 196608
  buffer_load_dwordx4 v[76:79], v22, s[64:67], s3 offen
  buffer_load_ushort v80, v23, s[52:55], 0 offen
  buffer_load_dwordx4 v[32:35], v18, s[56:59], 0 offen
  s_mov_b32 s3, 65536
  buffer_load_dwordx4 v[36:39], v18, s[56:59], s3 offen
  s_mov_b32 s3, 131072
  buffer_load_dwordx4 v[40:43], v18, s[56:59], s3 offen
  s_mov_b32 s3, 196608
  buffer_load_dwordx4 v[44:47], v18, s[56:59], s3 offen
  s_waitcnt vmcnt(9)
  s_barrier
  s_waitcnt vmcnt(0)
  v_pk_add_f32 v[32:33], v[32:33], v[36:37]
  v_pk_add_f32 v[34:35], v[34:35], v[38:39]
  v_pk_add_f32 v[40:41], v[40:41], v[44:45]
  v_pk_add_f32 v[42:43], v[42:43], v[46:47]
  v_pk_add_f32 v[32:33], v[32:33], v[40:41]
  v_pk_add_f32 v[34:35], v[34:35], v[42:43]
  s_nop 1
  v_permlane32_swap_b32 v32, v34
  v_permlane32_swap_b32 v33, v35
  v_pk_add_f32 v[32:33], v[32:33], v[34:35]
  v_mov_b32 v34, v32
  v_mov_b32 v35, v33
  s_nop 0
  v_permlane16_swap_b32 v32, v34
  v_permlane16_swap_b32 v33, v35
  v_pk_add_f32 v[32:33], v[32:33], v[34:35]
  v_mul_f32 v32, 0x3a800000, v32
  v_mul_f32 v33, 0x3a800000, v33
  v_fma_f32 v33, -v32, v32, v33
  v_max_f32 v33, 0, v33
  v_add_f32 v33, 0x3727c5ac, v33
  v_rsq_f32 v33, v33
  s_nop 0
  s_and_b32 s3, s70, 3
  s_lshl_b32 s5, s3, 7
  s_add_u32 s5, s5, 110656
  v_and_b32 v3, 15, v1
  v_lshrrev_b32 v2, 5, v1
  v_lshl_add_u32 v2, v3, 1, v2
  v_lshl_add_u32 v2, v2, 2, s5
  ds_write2_b32 v2, v32, v33 offset0:0 offset1:160
  v_pk_add_f32 v[64:65], v[64:65], v[68:69]
  v_pk_add_f32 v[66:67], v[66:67], v[70:71]
  v_pk_add_f32 v[72:73], v[72:73], v[76:77]
  v_pk_add_f32 v[74:75], v[74:75], v[78:79]
  v_pk_add_f32 v[64:65], v[64:65], v[72:73]
  v_pk_add_f32 v[66:67], v[66:67], v[74:75]
  s_nop 1
  v_permlane32_swap_b32 v64, v66
  v_permlane32_swap_b32 v65, v67
  v_pk_add_f32 v[64:65], v[64:65], v[66:67]
  v_lshlrev_b32 v80, 16, v80
  s_lshl_b32 s5, s3, 8
  s_add_u32 s5, s5, 111872
  v_permlane16_swap_b32 v64, v65
  v_lshrrev_b32 v2, 4, v1
  v_lshl_add_u32 v2, v3, 2, v2
  v_lshl_add_u32 v2, v2, 2, s5
  v_add_f32 v64, v64, v65
  ds_write2st64_b32 v2, v64, v80 offset0:0 offset1:4
  v_xor_b32_dpp v64, v27, v27 row_ror:2 row_mask:0xf bank_mask:0xf
  s_lshl2_add_u32 s5, s3, 110592
  v_cmp_ne_u32 vcc, 0, v64
  v_mov_b32 v2, s5
  s_or_b32 s92, vcc_lo, vcc_hi
  v_mov_b32 v64, s92
  ds_write_b32 v2, v64
  s_waitcnt lgkmcnt(0)
  s_barrier
  s_lshl_b32 s87, s97, 15
  s_lshl_b32 s4, s68, 11
  s_add_u32 s87, s87, s4
  s_lshl_b32 s4, s69, 2
  s_add_u32 s87, s87, s4
  s_add_u32 s97, s97, 1
  s_branch L_w2_body
L_w1_end:
  s_endpgm
L_w1_compute:
  s_and_b32 s71, s70, 1
  s_lshr_b32 s72, s70, 1
  v_and_b32 v3, 15, v1
  v_lshrrev_b32 v2, 4, v1
  s_lshl_b32 s8, s71, 13
  v_lshl_add_u32 v4, v1, 4, s8
  v_lshrrev_b32 v13, 2, v1
  v_lshlrev_b32 v13, 7, v13
  v_and_b32 v17, 3, v1
  v_lshl_add_u32 v13, v17, 3, v13
  v_bfe_u32 v17, v1, 3, 2
  v_lshl_add_u32 v13, v17, 5, v13
  s_lshl_b32 s9, s72, 6
  v_xor_b32 v13, s9, v13
  v_add_u32 v5, 16384, v13
  v_xor_b32 v6, 32, v5
  v_and_b32 v16, 1, v2
  v_lshrrev_b32 v17, 1, v2
  v_lshrrev_b32 v13, 2, v1
  v_and_b32 v14, 1, v1
  v_lshl_add_u32 v13, v13, 1, v14
  v_xor_b32 v14, s72, v16
  v_lshl_add_u32 v13, v13, 1, v14
  v_bfe_u32 v14, v1, 1, 1
  v_lshl_add_u32 v13, v13, 1, v14
  v_lshlrev_b32 v13, 3, v13
  v_add_u32 v7, 40960, v13
  s_mov_b32 s75, 0
  v_add_u32_e64 v20, s75, v4
  v_add_u32_e64 v21, s75, v5
  v_add_u32_e64 v22, s75, v6
  v_add_u32_e64 v23, s75, v7
  s_add_u32 s75, s75, 49152
  s_cmp_eq_u32 s75, 147456
  s_cselect_b32 s75, 0, s75
  s_mov_b32 s79, 15
  ds_read_b128 v[32:35], v20 offset:0
  ds_read_b128 v[36:39], v20 offset:2048
  ds_read_b128 v[40:43], v20 offset:4096
  ds_read_b128 v[44:47], v20 offset:6144
  ds_read_b64_tr_b16 v[48:49], v21 offset:0
  ds_read_b64_tr_b16 v[50:51], v21 offset:2048
  ds_read_b64_tr_b16 v[52:53], v22 offset:0
  ds_read_b64_tr_b16 v[54:55], v22 offset:2048
  ds_read_b64_tr_b16 v[56:57], v21 offset:8192
  ds_read_b64_tr_b16 v[58:59], v21 offset:10240
  ds_read_b64_tr_b16 v[60:61], v22 offset:8192
  ds_read_b64_tr_b16 v[62:63], v22 offset:10240
  ds_read_b64_tr_b16 v[64:65], v21 offset:16384
  ds_read_b64_tr_b16 v[66:67], v21 offset:18432
  ds_read_b64_tr_b16 v[68:69], v22 offset:16384
  ds_read_b64_tr_b16 v[70:71], v22 offset:18432
  ds_read_b64_tr_b16 v[72:73], v23 offset:0
  ds_read_b64_tr_b16 v[74:75], v23 offset:2048
  s_waitcnt lgkmcnt(0)
  v_mfma_f32_16x16x32_bf16 v[128:131], v[48:51], v[32:35], 0
  ds_read_b128 v[80:83], v20 offset:1024
  v_mfma_f32_16x16x32_bf16 v[132:135], v[48:51], v[36:39], 0
  ds_read_b128 v[84:87], v20 offset:3072
  v_mfma_f32_16x16x32_bf16 v[136:139], v[48:51], v[40:43], 0
  ds_read_b128 v[88:91], v20 offset:5120
  v_mfma_f32_16x16x32_bf16 v[140:143], v[48:51], v[44:47], 0
  ds_read_b128 v[92:95], v20 offset:7168
  v_mfma_f32_16x16x32_bf16 v[156:159], v[52:55], v[44:47], 0
  ds_read_b64_tr_b16 v[96:97], v21 offset:4096
  v_mfma_f32_16x16x32_bf16 v[152:155], v[52:55], v[40:43], 0
  ds_read_b64_tr_b16 v[98:99], v21 offset:6144
  v_mfma_f32_16x16x32_bf16 v[148:151], v[52:55], v[36:39], 0
  ds_read_b64_tr_b16 v[100:101], v22 offset:4096
  v_mfma_f32_16x16x32_bf16 v[144:147], v[52:55], v[32:35], 0
  ds_read_b64_tr_b16 v[102:103], v22 offset:6144
  v_mfma_f32_16x16x32_bf16 v[160:163], v[56:59], v[32:35], 0
  ds_read_b64_tr_b16 v[104:105], v21 offset:12288
  v_mfma_f32_16x16x32_bf16 v[164:167], v[56:59], v[36:39], 0
  ds_read_b64_tr_b16 v[106:107], v21 offset:14336
  v_mfma_f32_16x16x32_bf16 v[168:171], v[56:59], v[40:43], 0
  ds_read_b64_tr_b16 v[108:109], v22 offset:12288
  v_mfma_f32_16x16x32_bf16 v[172:175], v[56:59], v[44:47], 0
  ds_read_b64_tr_b16 v[110:111], v22 offset:14336
  v_mfma_f32_16x16x32_bf16 v[188:191], v[60:63], v[44:47], 0
  ds_read_b64_tr_b16 v[112:113], v21 offset:20480
  v_mfma_f32_16x16x32_bf16 v[184:187], v[60:63], v[40:43], 0
  ds_read_b64_tr_b16 v[114:115], v21 offset:22528
  v_mfma_f32_16x16x32_bf16 v[180:183], v[60:63], v[36:39], 0
  ds_read_b64_tr_b16 v[116:117], v22 offset:20480
  v_mfma_f32_16x16x32_bf16 v[176:179], v[60:63], v[32:35], 0
  ds_read_b64_tr_b16 v[118:119], v22 offset:22528
  v_mfma_f32_16x16x32_bf16 v[192:195], v[64:67], v[32:35], 0
  ds_read_b64_tr_b16 v[120:121], v23 offset:4096
  v_mfma_f32_16x16x32_bf16 v[196:199], v[64:67], v[36:39], 0
  ds_read_b64_tr_b16 v[122:123], v23 offset:6144
  v_mfma_f32_16x16x32_bf16 v[200:203], v[64:67], v[40:43], 0
  v_add_u32_e64 v20, s75, v4
  v_mfma_f32_16x16x32_bf16 v[204:207], v[64:67], v[44:47], 0
  v_add_u32_e64 v21, s75, v5
  v_mfma_f32_16x16x32_bf16 v[220:223], v[68:71], v[44:47], 0
  v_add_u32_e64 v22, s75, v6
  v_mfma_f32_16x16x32_bf16 v[216:219], v[68:71], v[40:43], 0
  v_add_u32_e64 v23, s75, v7
  v_mfma_f32_16x16x32_bf16 v[212:215], v[68:71], v[36:39], 0
  s_add_u32 s75, s75, 49152
  v_mfma_f32_16x16x32_bf16 v[208:211], v[68:71], v[32:35], 0
  s_cmp_eq_u32 s75, 147456
  v_mfma_f32_16x16x32_bf16 v[224:227], v[72:75], v[32:35], 0
  s_cselect_b32 s75, 0, s75
  v_mfma_f32_16x16x32_bf16 v[228:231], v[72:75], v[36:39], 0
  v_mfma_f32_16x16x32_bf16 v[232:235], v[72:75], v[40:43], 0
  v_mfma_f32_16x16x32_bf16 v[236:239], v[72:75], v[44:47], 0
  s_waitcnt lgkmcnt(0)
  v_mfma_f32_16x16x32_bf16 v[128:131], v[96:99], v[80:83], v[128:131]
  v_mfma_f32_16x16x32_bf16 v[132:135], v[96:99], v[84:87], v[132:135]
  v_mfma_f32_16x16x32_bf16 v[136:139], v[96:99], v[88:91], v[136:139]
  v_mfma_f32_16x16x32_bf16 v[140:143], v[96:99], v[92:95], v[140:143]
  v_mfma_f32_16x16x32_bf16 v[156:159], v[100:103], v[92:95], v[156:159]
  v_mfma_f32_16x16x32_bf16 v[152:155], v[100:103], v[88:91], v[152:155]
  v_mfma_f32_16x16x32_bf16 v[148:151], v[100:103], v[84:87], v[148:151]
  v_mfma_f32_16x16x32_bf16 v[144:147], v[100:103], v[80:83], v[144:147]
  v_mfma_f32_16x16x32_bf16 v[160:163], v[104:107], v[80:83], v[160:163]
  v_mfma_f32_16x16x32_bf16 v[164:167], v[104:107], v[84:87], v[164:167]
  v_mfma_f32_16x16x32_bf16 v[168:171], v[104:107], v[88:91], v[168:171]
  v_mfma_f32_16x16x32_bf16 v[172:175], v[104:107], v[92:95], v[172:175]
  v_mfma_f32_16x16x32_bf16 v[188:191], v[108:111], v[92:95], v[188:191]
  v_mfma_f32_16x16x32_bf16 v[184:187], v[108:111], v[88:91], v[184:187]
  v_mfma_f32_16x16x32_bf16 v[180:183], v[108:111], v[84:87], v[180:183]
  v_mfma_f32_16x16x32_bf16 v[176:179], v[108:111], v[80:83], v[176:179]
  v_mfma_f32_16x16x32_bf16 v[192:195], v[112:115], v[80:83], v[192:195]
  v_mfma_f32_16x16x32_bf16 v[196:199], v[112:115], v[84:87], v[196:199]
  v_mfma_f32_16x16x32_bf16 v[200:203], v[112:115], v[88:91], v[200:203]
  v_mfma_f32_16x16x32_bf16 v[204:207], v[112:115], v[92:95], v[204:207]
  v_mfma_f32_16x16x32_bf16 v[220:223], v[116:119], v[92:95], v[220:223]
  v_mfma_f32_16x16x32_bf16 v[216:219], v[116:119], v[88:91], v[216:219]
  v_mfma_f32_16x16x32_bf16 v[212:215], v[116:119], v[84:87], v[212:215]
  v_mfma_f32_16x16x32_bf16 v[208:211], v[116:119], v[80:83], v[208:211]
  v_mfma_f32_16x16x32_bf16 v[224:227], v[120:123], v[80:83], v[224:227]
  v_mfma_f32_16x16x32_bf16 v[228:231], v[120:123], v[84:87], v[228:231]
  v_mfma_f32_16x16x32_bf16 v[232:235], v[120:123], v[88:91], v[232:235]
  v_mfma_f32_16x16x32_bf16 v[236:239], v[120:123], v[92:95], v[236:239]
  s_barrier
  s_lshl_b32 s8, s68, 7
  s_lshl_b32 s9, s71, 6
  s_add_u32 s8, s8, s9
  s_mul_i32 s8, s8, 7168
  v_lshlrev_b32 v14, 8, v17
  v_lshl_add_u32 v14, v3, 4, v14
  s_lshl3_add_u32 s9, s71, s72
  s_lshl_b32 s9, s9, 10
  s_add_u32 s9, s9, 114688
  v_lshl_add_u32 v18, v1, 4, s9
  s_mov_b32 s52, s30
  s_and_b32 s53, s31, 0xffff
  s_mov_b32 s54, 2048
  s_mov_b32 s55, 0x00020000
  s_lshr_b32 s9, s69, 3
  s_and_b32 s10, s69, 7
  s_lshl1_add_u32 s9, s10, s9
  s_lshl_b32 s9, s9, 7
  v_lshl_add_u32 v19, v2, 3, s9
  v_add_u32 v14, s8, v14
  s_lshl_b32 s10, s69, 11
  s_lshl_b32 s9, s72, 10
  s_add_u32 s9, s9, s10
  v_lshl_add_u32 v12, v1, 4, s8
  v_add_u32 v12, s9, v12
  v_lshl_add_u32 v17, v16, 2, v17
  v_mul_u32_u24 v16, 114688, v16
  s_lshr_b32 s9, s9, 1
  v_add3_u32 v13, v16, v14, s9
  s_lshl_b32 s9, s71, 8
  s_add_u32 s9, s9, 110656
  v_lshl_add_u32 v14, v3, 2, s9
  s_lshl_b32 s9, s72, 7
  s_add_u32 s9, s9, 111872
  v_lshl_add_u32 v15, v2, 4, s9
  s_lshl_b32 s9, s72, 5
  s_add_u32 s9, s9, 111872
  v_lshl_add_u32 v16, v17, 4, s9
  v_mov_b32 v17, 110592
  s_add_u32 s44, s34, 8388608
  s_addc_u32 s45, s35, 0
  s_and_b32 s45, s45, 0xffff
  s_mov_b32 s46, 14680064
  s_mov_b32 s47, 0x00020000
  s_barrier
  ds_read_b128 v[32:35], v20 offset:0
  ds_read_b128 v[36:39], v20 offset:2048
  ds_read_b128 v[40:43], v20 offset:4096
  ds_read_b128 v[44:47], v20 offset:6144
  ds_read_b64_tr_b16 v[48:49], v21 offset:0
  ds_read_b64_tr_b16 v[50:51], v21 offset:2048
  ds_read_b64_tr_b16 v[52:53], v22 offset:0
  ds_read_b64_tr_b16 v[54:55], v22 offset:2048
  ds_read_b64_tr_b16 v[56:57], v21 offset:8192
  ds_read_b64_tr_b16 v[58:59], v21 offset:10240
  ds_read_b64_tr_b16 v[60:61], v22 offset:8192
  ds_read_b64_tr_b16 v[62:63], v22 offset:10240
  ds_read_b64_tr_b16 v[64:65], v21 offset:16384
  ds_read_b64_tr_b16 v[66:67], v21 offset:18432
  ds_read_b64_tr_b16 v[68:69], v22 offset:16384
  ds_read_b64_tr_b16 v[70:71], v22 offset:18432
  ds_read_b64_tr_b16 v[72:73], v23 offset:0
  ds_read_b64_tr_b16 v[74:75], v23 offset:2048
.p2align 5
  s_nop 0
  s_nop 0
  s_nop 0
  s_waitcnt lgkmcnt(0)
L_w1_loop:
  v_mfma_f32_16x16x32_bf16 v[128:131], v[48:51], v[32:35], v[128:131]
  ds_read_b128 v[80:83], v20 offset:1024
  v_mfma_f32_16x16x32_bf16 v[132:135], v[48:51], v[36:39], v[132:135]
  ds_read_b128 v[84:87], v20 offset:3072
  v_mfma_f32_16x16x32_bf16 v[136:139], v[48:51], v[40:43], v[136:139]
  ds_read_b128 v[88:91], v20 offset:5120
  v_mfma_f32_16x16x32_bf16 v[140:143], v[48:51], v[44:47], v[140:143]
  ds_read_b128 v[92:95], v20 offset:7168
  v_mfma_f32_16x16x32_bf16 v[156:159], v[52:55], v[44:47], v[156:159]
  ds_read_b64_tr_b16 v[96:97], v21 offset:4096
  v_mfma_f32_16x16x32_bf16 v[152:155], v[52:55], v[40:43], v[152:155]
  ds_read_b64_tr_b16 v[98:99], v21 offset:6144
  v_mfma_f32_16x16x32_bf16 v[148:151], v[52:55], v[36:39], v[148:151]
  ds_read_b64_tr_b16 v[100:101], v22 offset:4096
  v_mfma_f32_16x16x32_bf16 v[144:147], v[52:55], v[32:35], v[144:147]
  ds_read_b64_tr_b16 v[102:103], v22 offset:6144
  v_mfma_f32_16x16x32_bf16 v[160:163], v[56:59], v[32:35], v[160:163]
  ds_read_b64_tr_b16 v[104:105], v21 offset:12288
  v_mfma_f32_16x16x32_bf16 v[164:167], v[56:59], v[36:39], v[164:167]
  ds_read_b64_tr_b16 v[106:107], v21 offset:14336
  v_mfma_f32_16x16x32_bf16 v[168:171], v[56:59], v[40:43], v[168:171]
  ds_read_b64_tr_b16 v[108:109], v22 offset:12288
  v_mfma_f32_16x16x32_bf16 v[172:175], v[56:59], v[44:47], v[172:175]
  ds_read_b64_tr_b16 v[110:111], v22 offset:14336
  v_mfma_f32_16x16x32_bf16 v[188:191], v[60:63], v[44:47], v[188:191]
  ds_read_b64_tr_b16 v[112:113], v21 offset:20480
  v_mfma_f32_16x16x32_bf16 v[184:187], v[60:63], v[40:43], v[184:187]
  ds_read_b64_tr_b16 v[114:115], v21 offset:22528
  v_mfma_f32_16x16x32_bf16 v[180:183], v[60:63], v[36:39], v[180:183]
  ds_read_b64_tr_b16 v[116:117], v22 offset:20480
  v_mfma_f32_16x16x32_bf16 v[176:179], v[60:63], v[32:35], v[176:179]
  ds_read_b64_tr_b16 v[118:119], v22 offset:22528
  v_mfma_f32_16x16x32_bf16 v[192:195], v[64:67], v[32:35], v[192:195]
  ds_read_b64_tr_b16 v[120:121], v23 offset:4096
  v_mfma_f32_16x16x32_bf16 v[196:199], v[64:67], v[36:39], v[196:199]
  ds_read_b64_tr_b16 v[122:123], v23 offset:6144
  v_mfma_f32_16x16x32_bf16 v[200:203], v[64:67], v[40:43], v[200:203]
  v_add_u32_e64 v20, s75, v4
  v_mfma_f32_16x16x32_bf16 v[204:207], v[64:67], v[44:47], v[204:207]
  v_add_u32_e64 v21, s75, v5
  v_mfma_f32_16x16x32_bf16 v[220:223], v[68:71], v[44:47], v[220:223]
  v_add_u32_e64 v22, s75, v6
  v_mfma_f32_16x16x32_bf16 v[216:219], v[68:71], v[40:43], v[216:219]
  v_add_u32_e64 v23, s75, v7
  v_mfma_f32_16x16x32_bf16 v[212:215], v[68:71], v[36:39], v[212:215]
  s_add_u32 s75, s75, 49152
  v_mfma_f32_16x16x32_bf16 v[208:211], v[68:71], v[32:35], v[208:211]
  s_cmp_eq_u32 s75, 147456
  v_mfma_f32_16x16x32_bf16 v[224:227], v[72:75], v[32:35], v[224:227]
  s_cselect_b32 s75, 0, s75
  s_sub_u32 s79, s79, 1
  v_mfma_f32_16x16x32_bf16 v[228:231], v[72:75], v[36:39], v[228:231]
  v_mfma_f32_16x16x32_bf16 v[232:235], v[72:75], v[40:43], v[232:235]
  v_mfma_f32_16x16x32_bf16 v[236:239], v[72:75], v[44:47], v[236:239]
  s_waitcnt lgkmcnt(0)
  s_barrier
  v_mfma_f32_16x16x32_bf16 v[128:131], v[96:99], v[80:83], v[128:131]
  ds_read_b128 v[32:35], v20 offset:0
  v_mfma_f32_16x16x32_bf16 v[132:135], v[96:99], v[84:87], v[132:135]
  ds_read_b128 v[36:39], v20 offset:2048
  v_mfma_f32_16x16x32_bf16 v[136:139], v[96:99], v[88:91], v[136:139]
  ds_read_b128 v[40:43], v20 offset:4096
  v_mfma_f32_16x16x32_bf16 v[140:143], v[96:99], v[92:95], v[140:143]
  ds_read_b128 v[44:47], v20 offset:6144
  v_mfma_f32_16x16x32_bf16 v[156:159], v[100:103], v[92:95], v[156:159]
  ds_read_b64_tr_b16 v[48:49], v21 offset:0
  v_mfma_f32_16x16x32_bf16 v[152:155], v[100:103], v[88:91], v[152:155]
  ds_read_b64_tr_b16 v[50:51], v21 offset:2048
  v_mfma_f32_16x16x32_bf16 v[148:151], v[100:103], v[84:87], v[148:151]
  ds_read_b64_tr_b16 v[52:53], v22 offset:0
  v_mfma_f32_16x16x32_bf16 v[144:147], v[100:103], v[80:83], v[144:147]
  ds_read_b64_tr_b16 v[54:55], v22 offset:2048
  v_mfma_f32_16x16x32_bf16 v[160:163], v[104:107], v[80:83], v[160:163]
  ds_read_b64_tr_b16 v[56:57], v21 offset:8192
  v_mfma_f32_16x16x32_bf16 v[164:167], v[104:107], v[84:87], v[164:167]
  ds_read_b64_tr_b16 v[58:59], v21 offset:10240
  v_mfma_f32_16x16x32_bf16 v[168:171], v[104:107], v[88:91], v[168:171]
  ds_read_b64_tr_b16 v[60:61], v22 offset:8192
  v_mfma_f32_16x16x32_bf16 v[172:175], v[104:107], v[92:95], v[172:175]
  ds_read_b64_tr_b16 v[62:63], v22 offset:10240
  v_mfma_f32_16x16x32_bf16 v[188:191], v[108:111], v[92:95], v[188:191]
  ds_read_b64_tr_b16 v[64:65], v21 offset:16384
  v_mfma_f32_16x16x32_bf16 v[184:187], v[108:111], v[88:91], v[184:187]
  ds_read_b64_tr_b16 v[66:67], v21 offset:18432
  v_mfma_f32_16x16x32_bf16 v[180:183], v[108:111], v[84:87], v[180:183]
  ds_read_b64_tr_b16 v[68:69], v22 offset:16384
  v_mfma_f32_16x16x32_bf16 v[176:179], v[108:111], v[80:83], v[176:179]
  ds_read_b64_tr_b16 v[70:71], v22 offset:18432
  v_mfma_f32_16x16x32_bf16 v[192:195], v[112:115], v[80:83], v[192:195]
  ds_read_b64_tr_b16 v[72:73], v23 offset:0
  v_mfma_f32_16x16x32_bf16 v[196:199], v[112:115], v[84:87], v[196:199]
  ds_read_b64_tr_b16 v[74:75], v23 offset:2048
  v_mfma_f32_16x16x32_bf16 v[200:203], v[112:115], v[88:91], v[200:203]
  s_cmp_lg_u32 s79, 0
  s_nop 0
  v_mfma_f32_16x16x32_bf16 v[204:207], v[112:115], v[92:95], v[204:207]
  v_mfma_f32_16x16x32_bf16 v[220:223], v[116:119], v[92:95], v[220:223]
  v_mfma_f32_16x16x32_bf16 v[216:219], v[116:119], v[88:91], v[216:219]
  v_mfma_f32_16x16x32_bf16 v[212:215], v[116:119], v[84:87], v[212:215]
  v_mfma_f32_16x16x32_bf16 v[208:211], v[116:119], v[80:83], v[208:211]
  v_mfma_f32_16x16x32_bf16 v[224:227], v[120:123], v[80:83], v[224:227]
  v_mfma_f32_16x16x32_bf16 v[228:231], v[120:123], v[84:87], v[228:231]
  v_mfma_f32_16x16x32_bf16 v[232:235], v[120:123], v[88:91], v[232:235]
  v_mfma_f32_16x16x32_bf16 v[236:239], v[120:123], v[92:95], v[236:239]
  s_waitcnt lgkmcnt(0)
  s_cbranch_scc1 L_w1_loop
L_w1_lend:
L_w1_exit:
  ds_read2_b32 v[88:89], v14 offset0:0 offset1:160
  ds_read2_b32 v[90:91], v14 offset0:16 offset1:176
  ds_read2_b32 v[92:93], v14 offset0:32 offset1:192
  ds_read2_b32 v[94:95], v14 offset0:48 offset1:208
  ds_read_b128 v[32:35], v15 offset:0
  ds_read_b128 v[60:63], v15 offset:1024
  ds_read_b128 v[36:39], v15 offset:64
  ds_read_b128 v[64:67], v15 offset:1088
  ds_read_b128 v[40:43], v15 offset:256
  ds_read_b128 v[68:71], v15 offset:1280
  ds_read_b128 v[44:47], v15 offset:320
  ds_read_b128 v[72:75], v15 offset:1344
  ds_read_b128 v[48:51], v15 offset:512
  ds_read_b128 v[76:79], v15 offset:1536
  ds_read_b128 v[52:55], v15 offset:576
  ds_read_b128 v[80:83], v15 offset:1600
  ds_read_b128 v[56:59], v16 offset:768
  ds_read_b128 v[84:87], v16 offset:1792
  ds_read_b32 v17, v17
  buffer_load_dwordx2 v[10:11], v19, s[52:55], 0 offen offset:0
  buffer_load_dwordx2 v[24:25], v19, s[52:55], 0 offen offset:32
  buffer_load_dwordx2 v[124:125], v19, s[52:55], 0 offen offset:64
  buffer_load_dwordx2 v[126:127], v19, s[52:55], 0 offen offset:96
  v_mov_b32 v96, 0xc0135761
  v_mov_b32 v97, 0xbdd2d3e8
  v_mov_b32 v98, 1.0
  s_waitcnt lgkmcnt(0)
  v_readfirstlane_b32 s98, v17
  v_mul_f32 v88, v88, v89
  v_mul_f32 v90, v90, v91
  v_mul_f32 v92, v92, v93
  v_mul_f32 v94, v94, v95
  s_cmp_lg_u32 s98, 0
  s_cselect_b32 s98, 34603008, 0
  s_add_u32 s44, s44, s98
  s_addc_u32 s45, s45, 0
  v_pk_fma_f32 v[100:101], v[32:33], v[88:89], v[60:61] op_sel:[0,0,0] op_sel_hi:[1,0,1] neg_lo:[0,1,0] neg_hi:[0,1,0]
  v_pk_fma_f32 v[102:103], v[34:35], v[88:89], v[62:63] op_sel:[0,0,0] op_sel_hi:[1,0,1] neg_lo:[0,1,0] neg_hi:[0,1,0]
  v_pk_fma_f32 v[128:129], v[128:129], v[88:89], v[100:101] op_sel:[0,1,0] op_sel_hi:[1,1,1]
  v_pk_fma_f32 v[130:131], v[130:131], v[88:89], v[102:103] op_sel:[0,1,0] op_sel_hi:[1,1,1]
  v_pk_mul_f32 v[100:101], v[128:129], v[128:129]
  v_pk_mul_f32 v[102:103], v[130:131], v[130:131]
  v_pk_fma_f32 v[100:101], v[100:101], v[96:97], v[96:97] op_sel:[0,1,0] op_sel_hi:[1,1,0]
  v_pk_fma_f32 v[102:103], v[102:103], v[96:97], v[96:97] op_sel:[0,1,0] op_sel_hi:[1,1,0]
  v_pk_mul_f32 v[100:101], v[100:101], v[128:129]
  v_pk_mul_f32 v[102:103], v[102:103], v[130:131]
  v_exp_f32 v100, v100
  v_exp_f32 v101, v101
  v_exp_f32 v102, v102
  v_exp_f32 v103, v103
  v_pk_add_f32 v[100:101], v[100:101], v[98:99] op_sel_hi:[1,0]
  v_pk_add_f32 v[102:103], v[102:103], v[98:99] op_sel_hi:[1,0]
  v_rcp_f32 v100, v100
  v_rcp_f32 v101, v101
  v_rcp_f32 v102, v102
  v_rcp_f32 v103, v103
  v_pk_mul_f32 v[128:129], v[128:129], v[100:101]
  v_pk_mul_f32 v[130:131], v[130:131], v[102:103]
  v_cvt_pk_bf16_f32 v108, v128, v129
  v_cvt_pk_bf16_f32 v109, v130, v131
  v_pk_fma_f32 v[104:105], v[36:37], v[88:89], v[64:65] op_sel:[0,0,0] op_sel_hi:[1,0,1] neg_lo:[0,1,0] neg_hi:[0,1,0]
  v_pk_fma_f32 v[106:107], v[38:39], v[88:89], v[66:67] op_sel:[0,0,0] op_sel_hi:[1,0,1] neg_lo:[0,1,0] neg_hi:[0,1,0]
  v_pk_fma_f32 v[144:145], v[144:145], v[88:89], v[104:105] op_sel:[0,1,0] op_sel_hi:[1,1,1]
  v_pk_fma_f32 v[146:147], v[146:147], v[88:89], v[106:107] op_sel:[0,1,0] op_sel_hi:[1,1,1]
  v_pk_mul_f32 v[104:105], v[144:145], v[144:145]
  v_pk_mul_f32 v[106:107], v[146:147], v[146:147]
  v_pk_fma_f32 v[104:105], v[104:105], v[96:97], v[96:97] op_sel:[0,1,0] op_sel_hi:[1,1,0]
  v_pk_fma_f32 v[106:107], v[106:107], v[96:97], v[96:97] op_sel:[0,1,0] op_sel_hi:[1,1,0]
  v_pk_mul_f32 v[104:105], v[104:105], v[144:145]
  v_pk_mul_f32 v[106:107], v[106:107], v[146:147]
  v_exp_f32 v104, v104
  v_exp_f32 v105, v105
  v_exp_f32 v106, v106
  v_exp_f32 v107, v107
  v_pk_add_f32 v[104:105], v[104:105], v[98:99] op_sel_hi:[1,0]
  v_pk_add_f32 v[106:107], v[106:107], v[98:99] op_sel_hi:[1,0]
  v_rcp_f32 v104, v104
  v_rcp_f32 v105, v105
  v_rcp_f32 v106, v106
  v_rcp_f32 v107, v107
  v_pk_mul_f32 v[144:145], v[144:145], v[104:105]
  v_pk_mul_f32 v[146:147], v[146:147], v[106:107]
  v_cvt_pk_bf16_f32 v110, v144, v145
  v_cvt_pk_bf16_f32 v111, v146, v147
  s_mov_b32 s3, 0
  buffer_store_dwordx4 v[108:111], v12, s[44:47], s3 offen sc1
  ds_write_b128 v18, v[108:111] offset:32768
  v_pk_fma_f32 v[100:101], v[32:33], v[90:91], v[60:61] op_sel:[0,0,0] op_sel_hi:[1,0,1] neg_lo:[0,1,0] neg_hi:[0,1,0]
  v_pk_fma_f32 v[102:103], v[34:35], v[90:91], v[62:63] op_sel:[0,0,0] op_sel_hi:[1,0,1] neg_lo:[0,1,0] neg_hi:[0,1,0]
  v_pk_fma_f32 v[132:133], v[132:133], v[90:91], v[100:101] op_sel:[0,1,0] op_sel_hi:[1,1,1]
  v_pk_fma_f32 v[134:135], v[134:135], v[90:91], v[102:103] op_sel:[0,1,0] op_sel_hi:[1,1,1]
  v_pk_mul_f32 v[100:101], v[132:133], v[132:133]
  v_pk_mul_f32 v[102:103], v[134:135], v[134:135]
  v_pk_fma_f32 v[100:101], v[100:101], v[96:97], v[96:97] op_sel:[0,1,0] op_sel_hi:[1,1,0]
  v_pk_fma_f32 v[102:103], v[102:103], v[96:97], v[96:97] op_sel:[0,1,0] op_sel_hi:[1,1,0]
  v_pk_mul_f32 v[100:101], v[100:101], v[132:133]
  v_pk_mul_f32 v[102:103], v[102:103], v[134:135]
  v_exp_f32 v100, v100
  v_exp_f32 v101, v101
  v_exp_f32 v102, v102
  v_exp_f32 v103, v103
  v_pk_add_f32 v[100:101], v[100:101], v[98:99] op_sel_hi:[1,0]
  v_pk_add_f32 v[102:103], v[102:103], v[98:99] op_sel_hi:[1,0]
  v_rcp_f32 v100, v100
  v_rcp_f32 v101, v101
  v_rcp_f32 v102, v102
  v_rcp_f32 v103, v103
  v_pk_mul_f32 v[132:133], v[132:133], v[100:101]
  v_pk_mul_f32 v[134:135], v[134:135], v[102:103]
  v_cvt_pk_bf16_f32 v112, v132, v133
  v_cvt_pk_bf16_f32 v113, v134, v135
  v_pk_fma_f32 v[104:105], v[36:37], v[90:91], v[64:65] op_sel:[0,0,0] op_sel_hi:[1,0,1] neg_lo:[0,1,0] neg_hi:[0,1,0]
  v_pk_fma_f32 v[106:107], v[38:39], v[90:91], v[66:67] op_sel:[0,0,0] op_sel_hi:[1,0,1] neg_lo:[0,1,0] neg_hi:[0,1,0]
  v_pk_fma_f32 v[148:149], v[148:149], v[90:91], v[104:105] op_sel:[0,1,0] op_sel_hi:[1,1,1]
  v_pk_fma_f32 v[150:151], v[150:151], v[90:91], v[106:107] op_sel:[0,1,0] op_sel_hi:[1,1,1]
  v_pk_mul_f32 v[104:105], v[148:149], v[148:149]
  v_pk_mul_f32 v[106:107], v[150:151], v[150:151]
  v_pk_fma_f32 v[104:105], v[104:105], v[96:97], v[96:97] op_sel:[0,1,0] op_sel_hi:[1,1,0]
  v_pk_fma_f32 v[106:107], v[106:107], v[96:97], v[96:97] op_sel:[0,1,0] op_sel_hi:[1,1,0]
  v_pk_mul_f32 v[104:105], v[104:105], v[148:149]
  v_pk_mul_f32 v[106:107], v[106:107], v[150:151]
  v_exp_f32 v104, v104
  v_exp_f32 v105, v105
  v_exp_f32 v106, v106
  v_exp_f32 v107, v107
  v_pk_add_f32 v[104:105], v[104:105], v[98:99] op_sel_hi:[1,0]
  v_pk_add_f32 v[106:107], v[106:107], v[98:99] op_sel_hi:[1,0]
  v_rcp_f32 v104, v104
  v_rcp_f32 v105, v105
  v_rcp_f32 v106, v106
  v_rcp_f32 v107, v107
  v_pk_mul_f32 v[148:149], v[148:149], v[104:105]
  v_pk_mul_f32 v[150:151], v[150:151], v[106:107]
  v_cvt_pk_bf16_f32 v114, v148, v149
  v_cvt_pk_bf16_f32 v115, v150, v151
  s_mov_b32 s3, 114688
  buffer_store_dwordx4 v[112:115], v12, s[44:47], s3 offen sc1
  ds_write_b128 v18, v[112:115] offset:34816
  v_pk_fma_f32 v[100:101], v[32:33], v[92:93], v[60:61] op_sel:[0,0,0] op_sel_hi:[1,0,1] neg_lo:[0,1,0] neg_hi:[0,1,0]
  v_pk_fma_f32 v[102:103], v[34:35], v[92:93], v[62:63] op_sel:[0,0,0] op_sel_hi:[1,0,1] neg_lo:[0,1,0] neg_hi:[0,1,0]
  v_pk_fma_f32 v[136:137], v[136:137], v[92:93], v[100:101] op_sel:[0,1,0] op_sel_hi:[1,1,1]
  v_pk_fma_f32 v[138:139], v[138:139], v[92:93], v[102:103] op_sel:[0,1,0] op_sel_hi:[1,1,1]
  v_pk_mul_f32 v[100:101], v[136:137], v[136:137]
  v_pk_mul_f32 v[102:103], v[138:139], v[138:139]
  v_pk_fma_f32 v[100:101], v[100:101], v[96:97], v[96:97] op_sel:[0,1,0] op_sel_hi:[1,1,0]
  v_pk_fma_f32 v[102:103], v[102:103], v[96:97], v[96:97] op_sel:[0,1,0] op_sel_hi:[1,1,0]
  v_pk_mul_f32 v[100:101], v[100:101], v[136:137]
  v_pk_mul_f32 v[102:103], v[102:103], v[138:139]
  v_exp_f32 v100, v100
  v_exp_f32 v101, v101
  v_exp_f32 v102, v102
  v_exp_f32 v103, v103
  v_pk_add_f32 v[100:101], v[100:101], v[98:99] op_sel_hi:[1,0]
  v_pk_add_f32 v[102:103], v[102:103], v[98:99] op_sel_hi:[1,0]
  v_rcp_f32 v100, v100
  v_rcp_f32 v101, v101
  v_rcp_f32 v102, v102
  v_rcp_f32 v103, v103
  v_pk_mul_f32 v[136:137], v[136:137], v[100:101]
  v_pk_mul_f32 v[138:139], v[138:139], v[102:103]
  v_cvt_pk_bf16_f32 v116, v136, v137
  v_cvt_pk_bf16_f32 v117, v138, v139
  v_pk_fma_f32 v[104:105], v[36:37], v[92:93], v[64:65] op_sel:[0,0,0] op_sel_hi:[1,0,1] neg_lo:[0,1,0] neg_hi:[0,1,0]
  v_pk_fma_f32 v[106:107], v[38:39], v[92:93], v[66:67] op_sel:[0,0,0] op_sel_hi:[1,0,1] neg_lo:[0,1,0] neg_hi:[0,1,0]
  v_pk_fma_f32 v[152:153], v[152:153], v[92:93], v[104:105] op_sel:[0,1,0] op_sel_hi:[1,1,1]
  v_pk_fma_f32 v[154:155], v[154:155], v[92:93], v[106:107] op_sel:[0,1,0] op_sel_hi:[1,1,1]
  v_pk_mul_f32 v[104:105], v[152:153], v[152:153]
  v_pk_mul_f32 v[106:107], v[154:155], v[154:155]
  v_pk_fma_f32 v[104:105], v[104:105], v[96:97], v[96:97] op_sel:[0,1,0] op_sel_hi:[1,1,0]
  v_pk_fma_f32 v[106:107], v[106:107], v[96:97], v[96:97] op_sel:[0,1,0] op_sel_hi:[1,1,0]
  v_pk_mul_f32 v[104:105], v[104:105], v[152:153]
  v_pk_mul_f32 v[106:107], v[106:107], v[154:155]
  v_exp_f32 v104, v104
  v_exp_f32 v105, v105
  v_exp_f32 v106, v106
  v_exp_f32 v107, v107
  v_pk_add_f32 v[104:105], v[104:105], v[98:99] op_sel_hi:[1,0]
  v_pk_add_f32 v[106:107], v[106:107], v[98:99] op_sel_hi:[1,0]
  v_rcp_f32 v104, v104
  v_rcp_f32 v105, v105
  v_rcp_f32 v106, v106
  v_rcp_f32 v107, v107
  v_pk_mul_f32 v[152:153], v[152:153], v[104:105]
  v_pk_mul_f32 v[154:155], v[154:155], v[106:107]
  v_cvt_pk_bf16_f32 v118, v152, v153
  v_cvt_pk_bf16_f32 v119, v154, v155
  s_mov_b32 s3, 229376
  buffer_store_dwordx4 v[116:119], v12, s[44:47], s3 offen sc1
  ds_write_b128 v18, v[116:119] offset:36864
  v_pk_fma_f32 v[100:101], v[32:33], v[94:95], v[60:61] op_sel:[0,0,0] op_sel_hi:[1,0,1] neg_lo:[0,1,0] neg_hi:[0,1,0]
  v_pk_fma_f32 v[102:103], v[34:35], v[94:95], v[62:63] op_sel:[0,0,0] op_sel_hi:[1,0,1] neg_lo:[0,1,0] neg_hi:[0,1,0]
  v_pk_fma_f32 v[140:141], v[140:141], v[94:95], v[100:101] op_sel:[0,1,0] op_sel_hi:[1,1,1]
  v_pk_fma_f32 v[142:143], v[142:143], v[94:95], v[102:103] op_sel:[0,1,0] op_sel_hi:[1,1,1]
  v_pk_mul_f32 v[100:101], v[140:141], v[140:141]
  v_pk_mul_f32 v[102:103], v[142:143], v[142:143]
  v_pk_fma_f32 v[100:101], v[100:101], v[96:97], v[96:97] op_sel:[0,1,0] op_sel_hi:[1,1,0]
  v_pk_fma_f32 v[102:103], v[102:103], v[96:97], v[96:97] op_sel:[0,1,0] op_sel_hi:[1,1,0]
  v_pk_mul_f32 v[100:101], v[100:101], v[140:141]
  v_pk_mul_f32 v[102:103], v[102:103], v[142:143]
  v_exp_f32 v100, v100
  v_exp_f32 v101, v101
  v_exp_f32 v102, v102
  v_exp_f32 v103, v103
  v_pk_add_f32 v[100:101], v[100:101], v[98:99] op_sel_hi:[1,0]
  v_pk_add_f32 v[102:103], v[102:103], v[98:99] op_sel_hi:[1,0]
  v_rcp_f32 v100, v100
  v_rcp_f32 v101, v101
  v_rcp_f32 v102, v102
  v_rcp_f32 v103, v103
  v_pk_mul_f32 v[140:141], v[140:141], v[100:101]
  v_pk_mul_f32 v[142:143], v[142:143], v[102:103]
  v_cvt_pk_bf16_f32 v120, v140, v141
  v_cvt_pk_bf16_f32 v121, v142, v143
  v_pk_fma_f32 v[104:105], v[36:37], v[94:95], v[64:65] op_sel:[0,0,0] op_sel_hi:[1,0,1] neg_lo:[0,1,0] neg_hi:[0,1,0]
  v_pk_fma_f32 v[106:107], v[38:39], v[94:95], v[66:67] op_sel:[0,0,0] op_sel_hi:[1,0,1] neg_lo:[0,1,0] neg_hi:[0,1,0]
  v_pk_fma_f32 v[156:157], v[156:157], v[94:95], v[104:105] op_sel:[0,1,0] op_sel_hi:[1,1,1]
  v_pk_fma_f32 v[158:159], v[158:159], v[94:95], v[106:107] op_sel:[0,1,0] op_sel_hi:[1,1,1]
  v_pk_mul_f32 v[104:105], v[156:157], v[156:157]
  v_pk_mul_f32 v[106:107], v[158:159], v[158:159]
  v_pk_fma_f32 v[104:105], v[104:105], v[96:97], v[96:97] op_sel:[0,1,0] op_sel_hi:[1,1,0]
  v_pk_fma_f32 v[106:107], v[106:107], v[96:97], v[96:97] op_sel:[0,1,0] op_sel_hi:[1,1,0]
  v_pk_mul_f32 v[104:105], v[104:105], v[156:157]
  v_pk_mul_f32 v[106:107], v[106:107], v[158:159]
  v_exp_f32 v104, v104
  v_exp_f32 v105, v105
  v_exp_f32 v106, v106
  v_exp_f32 v107, v107
  v_pk_add_f32 v[104:105], v[104:105], v[98:99] op_sel_hi:[1,0]
  v_pk_add_f32 v[106:107], v[106:107], v[98:99] op_sel_hi:[1,0]
  v_rcp_f32 v104, v104
  v_rcp_f32 v105, v105
  v_rcp_f32 v106, v106
  v_rcp_f32 v107, v107
  v_pk_mul_f32 v[156:157], v[156:157], v[104:105]
  v_pk_mul_f32 v[158:159], v[158:159], v[106:107]
  v_cvt_pk_bf16_f32 v122, v156, v157
  v_cvt_pk_bf16_f32 v123, v158, v159
  s_mov_b32 s3, 344064
  buffer_store_dwordx4 v[120:123], v12, s[44:47], s3 offen sc1
  ds_write_b128 v18, v[120:123] offset:38912
  v_pk_fma_f32 v[100:101], v[56:57], v[88:89], v[84:85] op_sel:[0,0,0] op_sel_hi:[1,0,1] neg_lo:[0,1,0] neg_hi:[0,1,0]
  v_pk_fma_f32 v[102:103], v[58:59], v[88:89], v[86:87] op_sel:[0,0,0] op_sel_hi:[1,0,1] neg_lo:[0,1,0] neg_hi:[0,1,0]
  v_pk_fma_f32 v[224:225], v[224:225], v[88:89], v[100:101] op_sel:[0,1,0] op_sel_hi:[1,1,1]
  v_pk_fma_f32 v[226:227], v[226:227], v[88:89], v[102:103] op_sel:[0,1,0] op_sel_hi:[1,1,1]
  v_pk_mul_f32 v[100:101], v[224:225], v[224:225]
  v_pk_mul_f32 v[102:103], v[226:227], v[226:227]
  v_pk_fma_f32 v[100:101], v[100:101], v[96:97], v[96:97] op_sel:[0,1,0] op_sel_hi:[1,1,0]
  v_pk_fma_f32 v[102:103], v[102:103], v[96:97], v[96:97] op_sel:[0,1,0] op_sel_hi:[1,1,0]
  v_pk_mul_f32 v[100:101], v[100:101], v[224:225]
  v_pk_mul_f32 v[102:103], v[102:103], v[226:227]
  v_exp_f32 v100, v100
  v_exp_f32 v101, v101
  v_exp_f32 v102, v102
  v_exp_f32 v103, v103
  v_pk_add_f32 v[100:101], v[100:101], v[98:99] op_sel_hi:[1,0]
  v_pk_add_f32 v[102:103], v[102:103], v[98:99] op_sel_hi:[1,0]
  v_rcp_f32 v100, v100
  v_rcp_f32 v101, v101
  v_rcp_f32 v102, v102
  v_rcp_f32 v103, v103
  v_pk_mul_f32 v[224:225], v[224:225], v[100:101]
  v_pk_mul_f32 v[226:227], v[226:227], v[102:103]
  v_cvt_pk_bf16_f32 v108, v224, v225
  v_cvt_pk_bf16_f32 v109, v226, v227
  v_pk_fma_f32 v[100:101], v[56:57], v[90:91], v[84:85] op_sel:[0,0,0] op_sel_hi:[1,0,1] neg_lo:[0,1,0] neg_hi:[0,1,0]
  v_pk_fma_f32 v[102:103], v[58:59], v[90:91], v[86:87] op_sel:[0,0,0] op_sel_hi:[1,0,1] neg_lo:[0,1,0] neg_hi:[0,1,0]
  v_pk_fma_f32 v[228:229], v[228:229], v[90:91], v[100:101] op_sel:[0,1,0] op_sel_hi:[1,1,1]
  v_pk_fma_f32 v[230:231], v[230:231], v[90:91], v[102:103] op_sel:[0,1,0] op_sel_hi:[1,1,1]
  v_pk_mul_f32 v[100:101], v[228:229], v[228:229]
  v_pk_mul_f32 v[102:103], v[230:231], v[230:231]
  v_pk_fma_f32 v[100:101], v[100:101], v[96:97], v[96:97] op_sel:[0,1,0] op_sel_hi:[1,1,0]
  v_pk_fma_f32 v[102:103], v[102:103], v[96:97], v[96:97] op_sel:[0,1,0] op_sel_hi:[1,1,0]
  v_pk_mul_f32 v[100:101], v[100:101], v[228:229]
  v_pk_mul_f32 v[102:103], v[102:103], v[230:231]
  v_exp_f32 v100, v100
  v_exp_f32 v101, v101
  v_exp_f32 v102, v102
  v_exp_f32 v103, v103
  v_pk_add_f32 v[100:101], v[100:101], v[98:99] op_sel_hi:[1,0]
  v_pk_add_f32 v[102:103], v[102:103], v[98:99] op_sel_hi:[1,0]
  v_rcp_f32 v100, v100
  v_rcp_f32 v101, v101
  v_rcp_f32 v102, v102
  v_rcp_f32 v103, v103
  v_pk_mul_f32 v[228:229], v[228:229], v[100:101]
  v_pk_mul_f32 v[230:231], v[230:231], v[102:103]
  v_cvt_pk_bf16_f32 v110, v228, v229
  v_cvt_pk_bf16_f32 v111, v230, v231
  s_mov_b32 s3, 32768
  s_nop 0
  v_permlane16_swap_b32 v108, v110
  v_permlane16_swap_b32 v109, v111
  buffer_store_dwordx4 v[108:111], v13, s[44:47], s3 offen sc1
  v_pk_fma_f32 v[100:101], v[56:57], v[92:93], v[84:85] op_sel:[0,0,0] op_sel_hi:[1,0,1] neg_lo:[0,1,0] neg_hi:[0,1,0]
  v_pk_fma_f32 v[102:103], v[58:59], v[92:93], v[86:87] op_sel:[0,0,0] op_sel_hi:[1,0,1] neg_lo:[0,1,0] neg_hi:[0,1,0]
  v_pk_fma_f32 v[232:233], v[232:233], v[92:93], v[100:101] op_sel:[0,1,0] op_sel_hi:[1,1,1]
  v_pk_fma_f32 v[234:235], v[234:235], v[92:93], v[102:103] op_sel:[0,1,0] op_sel_hi:[1,1,1]
  v_pk_mul_f32 v[100:101], v[232:233], v[232:233]
  v_pk_mul_f32 v[102:103], v[234:235], v[234:235]
  v_pk_fma_f32 v[100:101], v[100:101], v[96:97], v[96:97] op_sel:[0,1,0] op_sel_hi:[1,1,0]
  v_pk_fma_f32 v[102:103], v[102:103], v[96:97], v[96:97] op_sel:[0,1,0] op_sel_hi:[1,1,0]
  v_pk_mul_f32 v[100:101], v[100:101], v[232:233]
  v_pk_mul_f32 v[102:103], v[102:103], v[234:235]
  v_exp_f32 v100, v100
  v_exp_f32 v101, v101
  v_exp_f32 v102, v102
  v_exp_f32 v103, v103
  v_pk_add_f32 v[100:101], v[100:101], v[98:99] op_sel_hi:[1,0]
  v_pk_add_f32 v[102:103], v[102:103], v[98:99] op_sel_hi:[1,0]
  v_rcp_f32 v100, v100
  v_rcp_f32 v101, v101
  v_rcp_f32 v102, v102
  v_rcp_f32 v103, v103
  v_pk_mul_f32 v[232:233], v[232:233], v[100:101]
  v_pk_mul_f32 v[234:235], v[234:235], v[102:103]
  v_cvt_pk_bf16_f32 v112, v232, v233
  v_cvt_pk_bf16_f32 v113, v234, v235
  v_pk_fma_f32 v[100:101], v[56:57], v[94:95], v[84:85] op_sel:[0,0,0] op_sel_hi:[1,0,1] neg_lo:[0,1,0] neg_hi:[0,1,0]
  v_pk_fma_f32 v[102:103], v[58:59], v[94:95], v[86:87] op_sel:[0,0,0] op_sel_hi:[1,0,1] neg_lo:[0,1,0] neg_hi:[0,1,0]
  v_pk_fma_f32 v[236:237], v[236:237], v[94:95], v[100:101] op_sel:[0,1,0] op_sel_hi:[1,1,1]
  v_pk_fma_f32 v[238:239], v[238:239], v[94:95], v[102:103] op_sel:[0,1,0] op_sel_hi:[1,1,1]
  v_pk_mul_f32 v[100:101], v[236:237], v[236:237]
  v_pk_mul_f32 v[102:103], v[238:239], v[238:239]
  v_pk_fma_f32 v[100:101], v[100:101], v[96:97], v[96:97] op_sel:[0,1,0] op_sel_hi:[1,1,0]
  v_pk_fma_f32 v[102:103], v[102:103], v[96:97], v[96:97] op_sel:[0,1,0] op_sel_hi:[1,1,0]
  v_pk_mul_f32 v[100:101], v[100:101], v[236:237]
  v_pk_mul_f32 v[102:103], v[102:103], v[238:239]
  v_exp_f32 v100, v100
  v_exp_f32 v101, v101
  v_exp_f32 v102, v102
  v_exp_f32 v103, v103
  v_pk_add_f32 v[100:101], v[100:101], v[98:99] op_sel_hi:[1,0]
  v_pk_add_f32 v[102:103], v[102:103], v[98:99] op_sel_hi:[1,0]
  v_rcp_f32 v100, v100
  v_rcp_f32 v101, v101
  v_rcp_f32 v102, v102
  v_rcp_f32 v103, v103
  v_pk_mul_f32 v[236:237], v[236:237], v[100:101]
  v_pk_mul_f32 v[238:239], v[238:239], v[102:103]
  v_cvt_pk_bf16_f32 v114, v236, v237
  v_cvt_pk_bf16_f32 v115, v238, v239
  s_mov_b32 s3, 262144
  s_nop 0
  v_permlane16_swap_b32 v112, v114
  v_permlane16_swap_b32 v113, v115
  buffer_store_dwordx4 v[112:115], v13, s[44:47], s3 offen sc1
  v_pk_fma_f32 v[100:101], v[40:41], v[88:89], v[68:69] op_sel:[0,0,0] op_sel_hi:[1,0,1] neg_lo:[0,1,0] neg_hi:[0,1,0]
  v_pk_fma_f32 v[102:103], v[42:43], v[88:89], v[70:71] op_sel:[0,0,0] op_sel_hi:[1,0,1] neg_lo:[0,1,0] neg_hi:[0,1,0]
  v_pk_fma_f32 v[160:161], v[160:161], v[88:89], v[100:101] op_sel:[0,1,0] op_sel_hi:[1,1,1]
  v_pk_fma_f32 v[162:163], v[162:163], v[88:89], v[102:103] op_sel:[0,1,0] op_sel_hi:[1,1,1]
  v_pk_mul_f32 v[100:101], v[160:161], v[160:161]
  v_pk_mul_f32 v[102:103], v[162:163], v[162:163]
  v_pk_fma_f32 v[100:101], v[100:101], v[96:97], v[96:97] op_sel:[0,1,0] op_sel_hi:[1,1,0]
  v_pk_fma_f32 v[102:103], v[102:103], v[96:97], v[96:97] op_sel:[0,1,0] op_sel_hi:[1,1,0]
  v_pk_mul_f32 v[100:101], v[100:101], v[160:161]
  v_pk_mul_f32 v[102:103], v[102:103], v[162:163]
  v_exp_f32 v100, v100
  v_exp_f32 v101, v101
  v_exp_f32 v102, v102
  v_exp_f32 v103, v103
  v_pk_add_f32 v[100:101], v[100:101], v[98:99] op_sel_hi:[1,0]
  v_pk_add_f32 v[102:103], v[102:103], v[98:99] op_sel_hi:[1,0]
  v_rcp_f32 v100, v100
  v_rcp_f32 v101, v101
  v_rcp_f32 v102, v102
  v_rcp_f32 v103, v103
  v_pk_mul_f32 v[160:161], v[160:161], v[100:101]
  v_pk_mul_f32 v[162:163], v[162:163], v[102:103]
  v_cvt_pk_bf16_f32 v116, v160, v161
  v_cvt_pk_bf16_f32 v117, v162, v163
  v_pk_fma_f32 v[104:105], v[44:45], v[88:89], v[72:73] op_sel:[0,0,0] op_sel_hi:[1,0,1] neg_lo:[0,1,0] neg_hi:[0,1,0]
  v_pk_fma_f32 v[106:107], v[46:47], v[88:89], v[74:75] op_sel:[0,0,0] op_sel_hi:[1,0,1] neg_lo:[0,1,0] neg_hi:[0,1,0]
  v_pk_fma_f32 v[176:177], v[176:177], v[88:89], v[104:105] op_sel:[0,1,0] op_sel_hi:[1,1,1]
  v_pk_fma_f32 v[178:179], v[178:179], v[88:89], v[106:107] op_sel:[0,1,0] op_sel_hi:[1,1,1]
  v_pk_mul_f32 v[104:105], v[176:177], v[176:177]
  v_pk_mul_f32 v[106:107], v[178:179], v[178:179]
  v_pk_fma_f32 v[104:105], v[104:105], v[96:97], v[96:97] op_sel:[0,1,0] op_sel_hi:[1,1,0]
  v_pk_fma_f32 v[106:107], v[106:107], v[96:97], v[96:97] op_sel:[0,1,0] op_sel_hi:[1,1,0]
  v_pk_mul_f32 v[104:105], v[104:105], v[176:177]
  v_pk_mul_f32 v[106:107], v[106:107], v[178:179]
  v_exp_f32 v104, v104
  v_exp_f32 v105, v105
  v_exp_f32 v106, v106
  v_exp_f32 v107, v107
  v_pk_add_f32 v[104:105], v[104:105], v[98:99] op_sel_hi:[1,0]
  v_pk_add_f32 v[106:107], v[106:107], v[98:99] op_sel_hi:[1,0]
  v_rcp_f32 v104, v104
  v_rcp_f32 v105, v105
  v_rcp_f32 v106, v106
  v_rcp_f32 v107, v107
  v_pk_mul_f32 v[176:177], v[176:177], v[104:105]
  v_pk_mul_f32 v[178:179], v[178:179], v[106:107]
  v_cvt_pk_bf16_f32 v118, v176, v177
  v_cvt_pk_bf16_f32 v119, v178, v179
  s_add_u32 s3, s10, 49152
  buffer_store_dwordx4 v[116:119], v12, s[44:47], s3 offen sc1
  ds_write_b128 v18, v[116:119] offset:0
  v_pk_fma_f32 v[100:101], v[40:41], v[90:91], v[68:69] op_sel:[0,0,0] op_sel_hi:[1,0,1] neg_lo:[0,1,0] neg_hi:[0,1,0]
  v_pk_fma_f32 v[102:103], v[42:43], v[90:91], v[70:71] op_sel:[0,0,0] op_sel_hi:[1,0,1] neg_lo:[0,1,0] neg_hi:[0,1,0]
  v_pk_fma_f32 v[164:165], v[164:165], v[90:91], v[100:101] op_sel:[0,1,0] op_sel_hi:[1,1,1]
  v_pk_fma_f32 v[166:167], v[166:167], v[90:91], v[102:103] op_sel:[0,1,0] op_sel_hi:[1,1,1]
  v_pk_mul_f32 v[100:101], v[164:165], v[164:165]
  v_pk_mul_f32 v[102:103], v[166:167], v[166:167]
  v_pk_fma_f32 v[100:101], v[100:101], v[96:97], v[96:97] op_sel:[0,1,0] op_sel_hi:[1,1,0]
  v_pk_fma_f32 v[102:103], v[102:103], v[96:97], v[96:97] op_sel:[0,1,0] op_sel_hi:[1,1,0]
  v_pk_mul_f32 v[100:101], v[100:101], v[164:165]
  v_pk_mul_f32 v[102:103], v[102:103], v[166:167]
  v_exp_f32 v100, v100
  v_exp_f32 v101, v101
  v_exp_f32 v102, v102
  v_exp_f32 v103, v103
  v_pk_add_f32 v[100:101], v[100:101], v[98:99] op_sel_hi:[1,0]
  v_pk_add_f32 v[102:103], v[102:103], v[98:99] op_sel_hi:[1,0]
  v_rcp_f32 v100, v100
  v_rcp_f32 v101, v101
  v_rcp_f32 v102, v102
  v_rcp_f32 v103, v103
  v_pk_mul_f32 v[164:165], v[164:165], v[100:101]
  v_pk_mul_f32 v[166:167], v[166:167], v[102:103]
  v_cvt_pk_bf16_f32 v120, v164, v165
  v_cvt_pk_bf16_f32 v121, v166, v167
  v_pk_fma_f32 v[104:105], v[44:45], v[90:91], v[72:73] op_sel:[0,0,0] op_sel_hi:[1,0,1] neg_lo:[0,1,0] neg_hi:[0,1,0]
  v_pk_fma_f32 v[106:107], v[46:47], v[90:91], v[74:75] op_sel:[0,0,0] op_sel_hi:[1,0,1] neg_lo:[0,1,0] neg_hi:[0,1,0]
  v_pk_fma_f32 v[180:181], v[180:181], v[90:91], v[104:105] op_sel:[0,1,0] op_sel_hi:[1,1,1]
  v_pk_fma_f32 v[182:183], v[182:183], v[90:91], v[106:107] op_sel:[0,1,0] op_sel_hi:[1,1,1]
  v_pk_mul_f32 v[104:105], v[180:181], v[180:181]
  v_pk_mul_f32 v[106:107], v[182:183], v[182:183]
  v_pk_fma_f32 v[104:105], v[104:105], v[96:97], v[96:97] op_sel:[0,1,0] op_sel_hi:[1,1,0]
  v_pk_fma_f32 v[106:107], v[106:107], v[96:97], v[96:97] op_sel:[0,1,0] op_sel_hi:[1,1,0]
  v_pk_mul_f32 v[104:105], v[104:105], v[180:181]
  v_pk_mul_f32 v[106:107], v[106:107], v[182:183]
  v_exp_f32 v104, v104
  v_exp_f32 v105, v105
  v_exp_f32 v106, v106
  v_exp_f32 v107, v107
  v_pk_add_f32 v[104:105], v[104:105], v[98:99] op_sel_hi:[1,0]
  v_pk_add_f32 v[106:107], v[106:107], v[98:99] op_sel_hi:[1,0]
  v_rcp_f32 v104, v104
  v_rcp_f32 v105, v105
  v_rcp_f32 v106, v106
  v_rcp_f32 v107, v107
  v_pk_mul_f32 v[180:181], v[180:181], v[104:105]
  v_pk_mul_f32 v[182:183], v[182:183], v[106:107]
  v_cvt_pk_bf16_f32 v122, v180, v181
  v_cvt_pk_bf16_f32 v123, v182, v183
  s_add_u32 s3, s10, 163840
  buffer_store_dwordx4 v[120:123], v12, s[44:47], s3 offen sc1
  ds_write_b128 v18, v[120:123] offset:2048
  v_pk_fma_f32 v[100:101], v[40:41], v[92:93], v[68:69] op_sel:[0,0,0] op_sel_hi:[1,0,1] neg_lo:[0,1,0] neg_hi:[0,1,0]
  v_pk_fma_f32 v[102:103], v[42:43], v[92:93], v[70:71] op_sel:[0,0,0] op_sel_hi:[1,0,1] neg_lo:[0,1,0] neg_hi:[0,1,0]
  v_pk_fma_f32 v[168:169], v[168:169], v[92:93], v[100:101] op_sel:[0,1,0] op_sel_hi:[1,1,1]
  v_pk_fma_f32 v[170:171], v[170:171], v[92:93], v[102:103] op_sel:[0,1,0] op_sel_hi:[1,1,1]
  v_pk_mul_f32 v[100:101], v[168:169], v[168:169]
  v_pk_mul_f32 v[102:103], v[170:171], v[170:171]
  v_pk_fma_f32 v[100:101], v[100:101], v[96:97], v[96:97] op_sel:[0,1,0] op_sel_hi:[1,1,0]
  v_pk_fma_f32 v[102:103], v[102:103], v[96:97], v[96:97] op_sel:[0,1,0] op_sel_hi:[1,1,0]
  v_pk_mul_f32 v[100:101], v[100:101], v[168:169]
  v_pk_mul_f32 v[102:103], v[102:103], v[170:171]
  v_exp_f32 v100, v100
  v_exp_f32 v101, v101
  v_exp_f32 v102, v102
  v_exp_f32 v103, v103
  v_pk_add_f32 v[100:101], v[100:101], v[98:99] op_sel_hi:[1,0]
  v_pk_add_f32 v[102:103], v[102:103], v[98:99] op_sel_hi:[1,0]
  v_rcp_f32 v100, v100
  v_rcp_f32 v101, v101
  v_rcp_f32 v102, v102
  v_rcp_f32 v103, v103
  v_pk_mul_f32 v[168:169], v[168:169], v[100:101]
  v_pk_mul_f32 v[170:171], v[170:171], v[102:103]
  v_cvt_pk_bf16_f32 v108, v168, v169
  v_cvt_pk_bf16_f32 v109, v170, v171
  v_pk_fma_f32 v[104:105], v[44:45], v[92:93], v[72:73] op_sel:[0,0,0] op_sel_hi:[1,0,1] neg_lo:[0,1,0] neg_hi:[0,1,0]
  v_pk_fma_f32 v[106:107], v[46:47], v[92:93], v[74:75] op_sel:[0,0,0] op_sel_hi:[1,0,1] neg_lo:[0,1,0] neg_hi:[0,1,0]
  v_pk_fma_f32 v[184:185], v[184:185], v[92:93], v[104:105] op_sel:[0,1,0] op_sel_hi:[1,1,1]
  v_pk_fma_f32 v[186:187], v[186:187], v[92:93], v[106:107] op_sel:[0,1,0] op_sel_hi:[1,1,1]
  v_pk_mul_f32 v[104:105], v[184:185], v[184:185]
  v_pk_mul_f32 v[106:107], v[186:187], v[186:187]
  v_pk_fma_f32 v[104:105], v[104:105], v[96:97], v[96:97] op_sel:[0,1,0] op_sel_hi:[1,1,0]
  v_pk_fma_f32 v[106:107], v[106:107], v[96:97], v[96:97] op_sel:[0,1,0] op_sel_hi:[1,1,0]
  v_pk_mul_f32 v[104:105], v[104:105], v[184:185]
  v_pk_mul_f32 v[106:107], v[106:107], v[186:187]
  v_exp_f32 v104, v104
  v_exp_f32 v105, v105
  v_exp_f32 v106, v106
  v_exp_f32 v107, v107
  v_pk_add_f32 v[104:105], v[104:105], v[98:99] op_sel_hi:[1,0]
  v_pk_add_f32 v[106:107], v[106:107], v[98:99] op_sel_hi:[1,0]
  v_rcp_f32 v104, v104
  v_rcp_f32 v105, v105
  v_rcp_f32 v106, v106
  v_rcp_f32 v107, v107
  v_pk_mul_f32 v[184:185], v[184:185], v[104:105]
  v_pk_mul_f32 v[186:187], v[186:187], v[106:107]
  v_cvt_pk_bf16_f32 v110, v184, v185
  v_cvt_pk_bf16_f32 v111, v186, v187
  s_add_u32 s3, s10, 278528
  buffer_store_dwordx4 v[108:111], v12, s[44:47], s3 offen sc1
  ds_write_b128 v18, v[108:111] offset:4096
  v_pk_fma_f32 v[100:101], v[40:41], v[94:95], v[68:69] op_sel:[0,0,0] op_sel_hi:[1,0,1] neg_lo:[0,1,0] neg_hi:[0,1,0]
  v_pk_fma_f32 v[102:103], v[42:43], v[94:95], v[70:71] op_sel:[0,0,0] op_sel_hi:[1,0,1] neg_lo:[0,1,0] neg_hi:[0,1,0]
  v_pk_fma_f32 v[172:173], v[172:173], v[94:95], v[100:101] op_sel:[0,1,0] op_sel_hi:[1,1,1]
  v_pk_fma_f32 v[174:175], v[174:175], v[94:95], v[102:103] op_sel:[0,1,0] op_sel_hi:[1,1,1]
  v_pk_mul_f32 v[100:101], v[172:173], v[172:173]
  v_pk_mul_f32 v[102:103], v[174:175], v[174:175]
  v_pk_fma_f32 v[100:101], v[100:101], v[96:97], v[96:97] op_sel:[0,1,0] op_sel_hi:[1,1,0]
  v_pk_fma_f32 v[102:103], v[102:103], v[96:97], v[96:97] op_sel:[0,1,0] op_sel_hi:[1,1,0]
  v_pk_mul_f32 v[100:101], v[100:101], v[172:173]
  v_pk_mul_f32 v[102:103], v[102:103], v[174:175]
  v_exp_f32 v100, v100
  v_exp_f32 v101, v101
  v_exp_f32 v102, v102
  v_exp_f32 v103, v103
  v_pk_add_f32 v[100:101], v[100:101], v[98:99] op_sel_hi:[1,0]
  v_pk_add_f32 v[102:103], v[102:103], v[98:99] op_sel_hi:[1,0]
  v_rcp_f32 v100, v100
  v_rcp_f32 v101, v101
  v_rcp_f32 v102, v102
  v_rcp_f32 v103, v103
  v_pk_mul_f32 v[172:173], v[172:173], v[100:101]
  v_pk_mul_f32 v[174:175], v[174:175], v[102:103]
  v_cvt_pk_bf16_f32 v112, v172, v173
  v_cvt_pk_bf16_f32 v113, v174, v175
  v_pk_fma_f32 v[104:105], v[44:45], v[94:95], v[72:73] op_sel:[0,0,0] op_sel_hi:[1,0,1] neg_lo:[0,1,0] neg_hi:[0,1,0]
  v_pk_fma_f32 v[106:107], v[46:47], v[94:95], v[74:75] op_sel:[0,0,0] op_sel_hi:[1,0,1] neg_lo:[0,1,0] neg_hi:[0,1,0]
  v_pk_fma_f32 v[188:189], v[188:189], v[94:95], v[104:105] op_sel:[0,1,0] op_sel_hi:[1,1,1]
  v_pk_fma_f32 v[190:191], v[190:191], v[94:95], v[106:107] op_sel:[0,1,0] op_sel_hi:[1,1,1]
  v_pk_mul_f32 v[104:105], v[188:189], v[188:189]
  v_pk_mul_f32 v[106:107], v[190:191], v[190:191]
  v_pk_fma_f32 v[104:105], v[104:105], v[96:97], v[96:97] op_sel:[0,1,0] op_sel_hi:[1,1,0]
  v_pk_fma_f32 v[106:107], v[106:107], v[96:97], v[96:97] op_sel:[0,1,0] op_sel_hi:[1,1,0]
  v_pk_mul_f32 v[104:105], v[104:105], v[188:189]
  v_pk_mul_f32 v[106:107], v[106:107], v[190:191]
  v_exp_f32 v104, v104
  v_exp_f32 v105, v105
  v_exp_f32 v106, v106
  v_exp_f32 v107, v107
  v_pk_add_f32 v[104:105], v[104:105], v[98:99] op_sel_hi:[1,0]
  v_pk_add_f32 v[106:107], v[106:107], v[98:99] op_sel_hi:[1,0]
  v_rcp_f32 v104, v104
  v_rcp_f32 v105, v105
  v_rcp_f32 v106, v106
  v_rcp_f32 v107, v107
  v_pk_mul_f32 v[188:189], v[188:189], v[104:105]
  v_pk_mul_f32 v[190:191], v[190:191], v[106:107]
  v_cvt_pk_bf16_f32 v114, v188, v189
  v_cvt_pk_bf16_f32 v115, v190, v191
  s_add_u32 s3, s10, 393216
  buffer_store_dwordx4 v[112:115], v12, s[44:47], s3 offen sc1
  ds_write_b128 v18, v[112:115] offset:6144
  v_pk_fma_f32 v[100:101], v[48:49], v[88:89], v[76:77] op_sel:[0,0,0] op_sel_hi:[1,0,1] neg_lo:[0,1,0] neg_hi:[0,1,0]
  v_pk_fma_f32 v[102:103], v[50:51], v[88:89], v[78:79] op_sel:[0,0,0] op_sel_hi:[1,0,1] neg_lo:[0,1,0] neg_hi:[0,1,0]
  v_pk_fma_f32 v[192:193], v[192:193], v[88:89], v[100:101] op_sel:[0,1,0] op_sel_hi:[1,1,1]
  v_pk_fma_f32 v[194:195], v[194:195], v[88:89], v[102:103] op_sel:[0,1,0] op_sel_hi:[1,1,1]
  v_pk_mul_f32 v[100:101], v[192:193], v[192:193]
  v_pk_mul_f32 v[102:103], v[194:195], v[194:195]
  v_pk_fma_f32 v[100:101], v[100:101], v[96:97], v[96:97] op_sel:[0,1,0] op_sel_hi:[1,1,0]
  v_pk_fma_f32 v[102:103], v[102:103], v[96:97], v[96:97] op_sel:[0,1,0] op_sel_hi:[1,1,0]
  v_pk_mul_f32 v[100:101], v[100:101], v[192:193]
  v_pk_mul_f32 v[102:103], v[102:103], v[194:195]
  v_exp_f32 v100, v100
  v_exp_f32 v101, v101
  v_exp_f32 v102, v102
  v_exp_f32 v103, v103
  v_pk_add_f32 v[100:101], v[100:101], v[98:99] op_sel_hi:[1,0]
  v_pk_add_f32 v[102:103], v[102:103], v[98:99] op_sel_hi:[1,0]
  v_rcp_f32 v100, v100
  v_rcp_f32 v101, v101
  v_rcp_f32 v102, v102
  v_rcp_f32 v103, v103
  v_pk_mul_f32 v[192:193], v[192:193], v[100:101]
  v_pk_mul_f32 v[194:195], v[194:195], v[102:103]
  v_cvt_pk_bf16_f32 v116, v192, v193
  v_cvt_pk_bf16_f32 v117, v194, v195
  v_pk_fma_f32 v[104:105], v[52:53], v[88:89], v[80:81] op_sel:[0,0,0] op_sel_hi:[1,0,1] neg_lo:[0,1,0] neg_hi:[0,1,0]
  v_pk_fma_f32 v[106:107], v[54:55], v[88:89], v[82:83] op_sel:[0,0,0] op_sel_hi:[1,0,1] neg_lo:[0,1,0] neg_hi:[0,1,0]
  v_pk_fma_f32 v[208:209], v[208:209], v[88:89], v[104:105] op_sel:[0,1,0] op_sel_hi:[1,1,1]
  v_pk_fma_f32 v[210:211], v[210:211], v[88:89], v[106:107] op_sel:[0,1,0] op_sel_hi:[1,1,1]
  v_pk_mul_f32 v[104:105], v[208:209], v[208:209]
  v_pk_mul_f32 v[106:107], v[210:211], v[210:211]
  v_pk_fma_f32 v[104:105], v[104:105], v[96:97], v[96:97] op_sel:[0,1,0] op_sel_hi:[1,1,0]
  v_pk_fma_f32 v[106:107], v[106:107], v[96:97], v[96:97] op_sel:[0,1,0] op_sel_hi:[1,1,0]
  v_pk_mul_f32 v[104:105], v[104:105], v[208:209]
  v_pk_mul_f32 v[106:107], v[106:107], v[210:211]
  v_exp_f32 v104, v104
  v_exp_f32 v105, v105
  v_exp_f32 v106, v106
  v_exp_f32 v107, v107
  v_pk_add_f32 v[104:105], v[104:105], v[98:99] op_sel_hi:[1,0]
  v_pk_add_f32 v[106:107], v[106:107], v[98:99] op_sel_hi:[1,0]
  v_rcp_f32 v104, v104
  v_rcp_f32 v105, v105
  v_rcp_f32 v106, v106
  v_rcp_f32 v107, v107
  v_pk_mul_f32 v[208:209], v[208:209], v[104:105]
  v_pk_mul_f32 v[210:211], v[210:211], v[106:107]
  v_cvt_pk_bf16_f32 v118, v208, v209
  v_cvt_pk_bf16_f32 v119, v210, v211
  s_add_u32 s3, s10, 51200
  buffer_store_dwordx4 v[116:119], v12, s[44:47], s3 offen
  ds_write_b128 v18, v[116:119] offset:16384
  v_pk_fma_f32 v[100:101], v[48:49], v[90:91], v[76:77] op_sel:[0,0,0] op_sel_hi:[1,0,1] neg_lo:[0,1,0] neg_hi:[0,1,0]
  v_pk_fma_f32 v[102:103], v[50:51], v[90:91], v[78:79] op_sel:[0,0,0] op_sel_hi:[1,0,1] neg_lo:[0,1,0] neg_hi:[0,1,0]
  v_pk_fma_f32 v[196:197], v[196:197], v[90:91], v[100:101] op_sel:[0,1,0] op_sel_hi:[1,1,1]
  v_pk_fma_f32 v[198:199], v[198:199], v[90:91], v[102:103] op_sel:[0,1,0] op_sel_hi:[1,1,1]
  v_pk_mul_f32 v[100:101], v[196:197], v[196:197]
  v_pk_mul_f32 v[102:103], v[198:199], v[198:199]
  v_pk_fma_f32 v[100:101], v[100:101], v[96:97], v[96:97] op_sel:[0,1,0] op_sel_hi:[1,1,0]
  v_pk_fma_f32 v[102:103], v[102:103], v[96:97], v[96:97] op_sel:[0,1,0] op_sel_hi:[1,1,0]
  v_pk_mul_f32 v[100:101], v[100:101], v[196:197]
  v_pk_mul_f32 v[102:103], v[102:103], v[198:199]
  v_exp_f32 v100, v100
  v_exp_f32 v101, v101
  v_exp_f32 v102, v102
  v_exp_f32 v103, v103
  v_pk_add_f32 v[100:101], v[100:101], v[98:99] op_sel_hi:[1,0]
  v_pk_add_f32 v[102:103], v[102:103], v[98:99] op_sel_hi:[1,0]
  v_rcp_f32 v100, v100
  v_rcp_f32 v101, v101
  v_rcp_f32 v102, v102
  v_rcp_f32 v103, v103
  v_pk_mul_f32 v[196:197], v[196:197], v[100:101]
  v_pk_mul_f32 v[198:199], v[198:199], v[102:103]
  v_cvt_pk_bf16_f32 v120, v196, v197
  v_cvt_pk_bf16_f32 v121, v198, v199
  v_pk_fma_f32 v[104:105], v[52:53], v[90:91], v[80:81] op_sel:[0,0,0] op_sel_hi:[1,0,1] neg_lo:[0,1,0] neg_hi:[0,1,0]
  v_pk_fma_f32 v[106:107], v[54:55], v[90:91], v[82:83] op_sel:[0,0,0] op_sel_hi:[1,0,1] neg_lo:[0,1,0] neg_hi:[0,1,0]
  v_pk_fma_f32 v[212:213], v[212:213], v[90:91], v[104:105] op_sel:[0,1,0] op_sel_hi:[1,1,1]
  v_pk_fma_f32 v[214:215], v[214:215], v[90:91], v[106:107] op_sel:[0,1,0] op_sel_hi:[1,1,1]
  v_pk_mul_f32 v[104:105], v[212:213], v[212:213]
  v_pk_mul_f32 v[106:107], v[214:215], v[214:215]
  v_pk_fma_f32 v[104:105], v[104:105], v[96:97], v[96:97] op_sel:[0,1,0] op_sel_hi:[1,1,0]
  v_pk_fma_f32 v[106:107], v[106:107], v[96:97], v[96:97] op_sel:[0,1,0] op_sel_hi:[1,1,0]
  v_pk_mul_f32 v[104:105], v[104:105], v[212:213]
  v_pk_mul_f32 v[106:107], v[106:107], v[214:215]
  v_exp_f32 v104, v104
  v_exp_f32 v105, v105
  v_exp_f32 v106, v106
  v_exp_f32 v107, v107
  v_pk_add_f32 v[104:105], v[104:105], v[98:99] op_sel_hi:[1,0]
  v_pk_add_f32 v[106:107], v[106:107], v[98:99] op_sel_hi:[1,0]
  v_rcp_f32 v104, v104
  v_rcp_f32 v105, v105
  v_rcp_f32 v106, v106
  v_rcp_f32 v107, v107
  v_pk_mul_f32 v[212:213], v[212:213], v[104:105]
  v_pk_mul_f32 v[214:215], v[214:215], v[106:107]
  v_cvt_pk_bf16_f32 v122, v212, v213
  v_cvt_pk_bf16_f32 v123, v214, v215
  s_add_u32 s3, s10, 165888
  buffer_store_dwordx4 v[120:123], v12, s[44:47], s3 offen
  ds_write_b128 v18, v[120:123] offset:18432
  v_pk_fma_f32 v[100:101], v[48:49], v[92:93], v[76:77] op_sel:[0,0,0] op_sel_hi:[1,0,1] neg_lo:[0,1,0] neg_hi:[0,1,0]
  v_pk_fma_f32 v[102:103], v[50:51], v[92:93], v[78:79] op_sel:[0,0,0] op_sel_hi:[1,0,1] neg_lo:[0,1,0] neg_hi:[0,1,0]
  v_pk_fma_f32 v[200:201], v[200:201], v[92:93], v[100:101] op_sel:[0,1,0] op_sel_hi:[1,1,1]
  v_pk_fma_f32 v[202:203], v[202:203], v[92:93], v[102:103] op_sel:[0,1,0] op_sel_hi:[1,1,1]
  v_pk_mul_f32 v[100:101], v[200:201], v[200:201]
  v_pk_mul_f32 v[102:103], v[202:203], v[202:203]
  v_pk_fma_f32 v[100:101], v[100:101], v[96:97], v[96:97] op_sel:[0,1,0] op_sel_hi:[1,1,0]
  v_pk_fma_f32 v[102:103], v[102:103], v[96:97], v[96:97] op_sel:[0,1,0] op_sel_hi:[1,1,0]
  v_pk_mul_f32 v[100:101], v[100:101], v[200:201]
  v_pk_mul_f32 v[102:103], v[102:103], v[202:203]
  v_exp_f32 v100, v100
  v_exp_f32 v101, v101
  v_exp_f32 v102, v102
  v_exp_f32 v103, v103
  v_pk_add_f32 v[100:101], v[100:101], v[98:99] op_sel_hi:[1,0]
  v_pk_add_f32 v[102:103], v[102:103], v[98:99] op_sel_hi:[1,0]
  v_rcp_f32 v100, v100
  v_rcp_f32 v101, v101
  v_rcp_f32 v102, v102
  v_rcp_f32 v103, v103
  v_pk_mul_f32 v[200:201], v[200:201], v[100:101]
  v_pk_mul_f32 v[202:203], v[202:203], v[102:103]
  v_cvt_pk_bf16_f32 v108, v200, v201
  v_cvt_pk_bf16_f32 v109, v202, v203
  v_pk_fma_f32 v[104:105], v[52:53], v[92:93], v[80:81] op_sel:[0,0,0] op_sel_hi:[1,0,1] neg_lo:[0,1,0] neg_hi:[0,1,0]
  v_pk_fma_f32 v[106:107], v[54:55], v[92:93], v[82:83] op_sel:[0,0,0] op_sel_hi:[1,0,1] neg_lo:[0,1,0] neg_hi:[0,1,0]
  v_pk_fma_f32 v[216:217], v[216:217], v[92:93], v[104:105] op_sel:[0,1,0] op_sel_hi:[1,1,1]
  v_pk_fma_f32 v[218:219], v[218:219], v[92:93], v[106:107] op_sel:[0,1,0] op_sel_hi:[1,1,1]
  v_pk_mul_f32 v[104:105], v[216:217], v[216:217]
  v_pk_mul_f32 v[106:107], v[218:219], v[218:219]
  v_pk_fma_f32 v[104:105], v[104:105], v[96:97], v[96:97] op_sel:[0,1,0] op_sel_hi:[1,1,0]
  v_pk_fma_f32 v[106:107], v[106:107], v[96:97], v[96:97] op_sel:[0,1,0] op_sel_hi:[1,1,0]
  v_pk_mul_f32 v[104:105], v[104:105], v[216:217]
  v_pk_mul_f32 v[106:107], v[106:107], v[218:219]
  v_exp_f32 v104, v104
  v_exp_f32 v105, v105
  v_exp_f32 v106, v106
  v_exp_f32 v107, v107
  v_pk_add_f32 v[104:105], v[104:105], v[98:99] op_sel_hi:[1,0]
  v_pk_add_f32 v[106:107], v[106:107], v[98:99] op_sel_hi:[1,0]
  v_rcp_f32 v104, v104
  v_rcp_f32 v105, v105
  v_rcp_f32 v106, v106
  v_rcp_f32 v107, v107
  v_pk_mul_f32 v[216:217], v[216:217], v[104:105]
  v_pk_mul_f32 v[218:219], v[218:219], v[106:107]
  v_cvt_pk_bf16_f32 v110, v216, v217
  v_cvt_pk_bf16_f32 v111, v218, v219
  s_add_u32 s3, s10, 280576
  buffer_store_dwordx4 v[108:111], v12, s[44:47], s3 offen
  ds_write_b128 v18, v[108:111] offset:20480
  v_pk_fma_f32 v[100:101], v[48:49], v[94:95], v[76:77] op_sel:[0,0,0] op_sel_hi:[1,0,1] neg_lo:[0,1,0] neg_hi:[0,1,0]
  v_pk_fma_f32 v[102:103], v[50:51], v[94:95], v[78:79] op_sel:[0,0,0] op_sel_hi:[1,0,1] neg_lo:[0,1,0] neg_hi:[0,1,0]
  v_pk_fma_f32 v[204:205], v[204:205], v[94:95], v[100:101] op_sel:[0,1,0] op_sel_hi:[1,1,1]
  v_pk_fma_f32 v[206:207], v[206:207], v[94:95], v[102:103] op_sel:[0,1,0] op_sel_hi:[1,1,1]
  v_pk_mul_f32 v[100:101], v[204:205], v[204:205]
  v_pk_mul_f32 v[102:103], v[206:207], v[206:207]
  v_pk_fma_f32 v[100:101], v[100:101], v[96:97], v[96:97] op_sel:[0,1,0] op_sel_hi:[1,1,0]
  v_pk_fma_f32 v[102:103], v[102:103], v[96:97], v[96:97] op_sel:[0,1,0] op_sel_hi:[1,1,0]
  v_pk_mul_f32 v[100:101], v[100:101], v[204:205]
  v_pk_mul_f32 v[102:103], v[102:103], v[206:207]
  v_exp_f32 v100, v100
  v_exp_f32 v101, v101
  v_exp_f32 v102, v102
  v_exp_f32 v103, v103
  v_pk_add_f32 v[100:101], v[100:101], v[98:99] op_sel_hi:[1,0]
  v_pk_add_f32 v[102:103], v[102:103], v[98:99] op_sel_hi:[1,0]
  v_rcp_f32 v100, v100
  v_rcp_f32 v101, v101
  v_rcp_f32 v102, v102
  v_rcp_f32 v103, v103
  v_pk_mul_f32 v[204:205], v[204:205], v[100:101]
  v_pk_mul_f32 v[206:207], v[206:207], v[102:103]
  v_cvt_pk_bf16_f32 v112, v204, v205
  v_cvt_pk_bf16_f32 v113, v206, v207
  v_pk_fma_f32 v[104:105], v[52:53], v[94:95], v[80:81] op_sel:[0,0,0] op_sel_hi:[1,0,1] neg_lo:[0,1,0] neg_hi:[0,1,0]
  v_pk_fma_f32 v[106:107], v[54:55], v[94:95], v[82:83] op_sel:[0,0,0] op_sel_hi:[1,0,1] neg_lo:[0,1,0] neg_hi:[0,1,0]
  v_pk_fma_f32 v[220:221], v[220:221], v[94:95], v[104:105] op_sel:[0,1,0] op_sel_hi:[1,1,1]
  v_pk_fma_f32 v[222:223], v[222:223], v[94:95], v[106:107] op_sel:[0,1,0] op_sel_hi:[1,1,1]
  v_pk_mul_f32 v[104:105], v[220:221], v[220:221]
  v_pk_mul_f32 v[106:107], v[222:223], v[222:223]
  v_pk_fma_f32 v[104:105], v[104:105], v[96:97], v[96:97] op_sel:[0,1,0] op_sel_hi:[1,1,0]
  v_pk_fma_f32 v[106:107], v[106:107], v[96:97], v[96:97] op_sel:[0,1,0] op_sel_hi:[1,1,0]
  v_pk_mul_f32 v[104:105], v[104:105], v[220:221]
  v_pk_mul_f32 v[106:107], v[106:107], v[222:223]
  v_exp_f32 v104, v104
  v_exp_f32 v105, v105
  v_exp_f32 v106, v106
  v_exp_f32 v107, v107
  v_pk_add_f32 v[104:105], v[104:105], v[98:99] op_sel_hi:[1,0]
  v_pk_add_f32 v[106:107], v[106:107], v[98:99] op_sel_hi:[1,0]
  v_rcp_f32 v104, v104
  v_rcp_f32 v105, v105
  v_rcp_f32 v106, v106
  v_rcp_f32 v107, v107
  v_pk_mul_f32 v[220:221], v[220:221], v[104:105]
  v_pk_mul_f32 v[222:223], v[222:223], v[106:107]
  v_cvt_pk_bf16_f32 v114, v220, v221
  v_cvt_pk_bf16_f32 v115, v222, v223
  s_add_u32 s3, s10, 395264
  buffer_store_dwordx4 v[112:115], v12, s[44:47], s3 offen
  ds_write_b128 v18, v[112:115] offset:22528
  s_waitcnt vmcnt(0) lgkmcnt(0)
  s_barrier
  s_add_u32 s97, s97, 1
  s_branch L_w2_body
L_w1_c1:
L_w2_c0:
L_w2_body:
  s_cmp_ge_u32 s2, 256
  s_cbranch_scc1 L_w2_end
  v_lshrrev_b32 v2, 6, v0
  v_and_b32 v1, 63, v0
  v_readfirstlane_b32 s70, v2
  s_and_b32 s3, s2, 7
  s_lshr_b32 s99, s2, 3
  s_and_b32 s5, s3, 3
  s_lshl_b32 s5, s5, 2
  s_and_b32 s6, s99, 3
  s_add_u32 s68, s5, s6
  s_lshr_b32 s5, s3, 2
  s_lshr_b32 s78, s99, 2
  s_lshl1_add_u32 s69, s78, s5
  s_add_u32 s3, s68, s78
  s_lshl_b32 s3, s3, 3
  s_lshl_b32 s85, 0xffff02, s3
  s_sub_u32 s3, 0, s3
  s_lshr_b32 s3, 0xffff02, s3
  s_or_b32 s85, s85, s3
  s_cmp_lt_u32 s70, 4
  s_cbranch_scc1 L_w2_compute
L_w2_loader:
  s_add_u32 s3, s68, s78
  s_and_b32 s3, s3, 3
  s_mov_b32 s4, 0x1616160
  s_cmp_eq_u32 s3, 1
  s_cselect_b32 s4, 0x5858580, s4
  s_cmp_eq_u32 s3, 2
  s_cselect_b32 s4, 0x16161600, s4
  s_cmp_eq_u32 s3, 3
  s_cselect_b32 s4, 0x58585800, s4
  v_subrev_u32 v2, 3, v1
  v_min_u32 v2, 16, v2
  v_lshlrev_b32 v3, 1, v2
  v_bfe_i32 v16, s4, v3, 2
  v_sub_u32 v16, v1, v16
  v_subrev_u32 v16, 7, v16
  v_ashrrev_i32 v3, 1, v16
  v_cmp_eq_u32 vcc, s78, v3
  s_and_b32 s3, s69, 1
  v_or_b32 v2, 14, v16
  v_cndmask_b32 v2, v16, v2, vcc
  v_cmp_gt_i32 vcc, 0, v16
  s_lshl2_add_u32 s4, s3, 20
  v_add_u32 v16, s4, v16
  s_lshl4_add_u32 s4, s3, 24
  v_add_u32 v2, s4, v2
  v_cndmask_b32 v16, v2, v16, vcc
  s_and_b32 s5, s68, 3
  s_mul_i32 s5, s5, 3
  s_sub_u32 s5, s5, 23
  v_add_u32 v3, s5, v1
  v_subrev_u32 v2, 10, v3
  v_min_u32 v3, v3, v2
  v_subrev_u32 v2, 10, v3
  v_min_u32 v3, v3, v2
  v_cmp_gt_u32 vcc, 23, v1
  s_sub_u32 s5, s3, 46
  v_lshl_add_u32 v2, v1, 1, s5
  v_cndmask_b32 v3, v3, v2, vcc
  s_add_u32 s5, s78, 3
  v_ashrrev_i32 v2, 1, v3
  v_add_u32 v2, s5, v2
  v_and_b32 v2, 7, v2
  v_and_b32 v3, 1, v3
  v_cmp_gt_u32 vcc, 21, v1
  v_lshl_add_u32 v3, v3, 3, v2
  s_lshl1_add_u32 s4, s78, s4
  s_lshl3_add_u32 s3, s3, s78
  v_cndmask_b32 v3, v3, v16, vcc
  v_writelane_b32 v3, s4, 0
  s_add_u32 s4, s4, 1
  v_writelane_b32 v3, s3, 2
  v_writelane_b32 v3, s4, 1
  v_lshlrev_b32 v16, 17, v3
  s_add_u32 s9, s70, s68
  s_and_b32 s9, s9, 3
  s_lshl_b32 s77, s9, 11
  v_and_b32 v10, 7, v1
  v_lshrrev_b32 v3, 3, v1
  s_lshl_b32 s10, s9, 4
  v_add_u32 v3, s10, v3
  v_mul_u32_u24 v3, 2048, v3
  v_lshrrev_b32 v2, 3, v1
  v_and_b32 v2, 6, v2
  v_xor_b32 v2, v2, v10
  s_lshl_b32 s10, s69, 7
  v_add_u32 v3, s10, v3
  v_lshl_add_u32 v8, v2, 4, v3
  v_add_u32 v3, 16384, v3
  v_lshl_add_u32 v9, v2, 4, v3
  s_mov_b32 s40, s28
  s_and_b32 s41, s29, 0xffff
  s_mov_b32 s42, 7340032
  s_mov_b32 s43, 0x00020000
  s_bitcmp1_b32 s69, 0
  s_mov_b32 s76, 128
  s_cselect_b32 s76, -128, s76
  v_readlane_b32 s74, v16, 0
  s_add_u32 m0, s77, 0
  s_add_u32 s4, s74, s76
  buffer_load_dwordx4 v8, s[40:43], s4 offen lds
  s_add_u32 m0, s77, 1024
  s_nop 0
  buffer_load_dwordx4 v9, s[40:43], s4 offen lds
  s_add_u32 m0, s77, 8192
  s_add_u32 s4, s74, 0
  buffer_load_dwordx4 v8, s[40:43], s4 offen lds
  s_add_u32 m0, s77, 9216
  s_nop 0
  buffer_load_dwordx4 v9, s[40:43], s4 offen lds
  v_readlane_b32 s74, v16, 1
  s_add_u32 m0, s77, 16384
  s_add_u32 s4, s74, s76
  buffer_load_dwordx4 v8, s[40:43], s4 offen lds
  s_add_u32 m0, s77, 17408
  s_nop 0
  buffer_load_dwordx4 v9, s[40:43], s4 offen lds
  s_add_u32 m0, s77, 24576
  s_add_u32 s4, s74, 0
  buffer_load_dwordx4 v8, s[40:43], s4 offen lds
  s_add_u32 m0, s77, 25600
  s_nop 0
  buffer_load_dwordx4 v9, s[40:43], s4 offen lds
  v_readlane_b32 s74, v16, 2
  s_add_u32 m0, s77, 32768
  s_add_u32 s4, s74, s76
  buffer_load_dwordx4 v8, s[40:43], s4 offen lds
  s_add_u32 m0, s77, 33792
  s_nop 0
  buffer_load_dwordx4 v9, s[40:43], s4 offen lds
  s_add_u32 m0, s77, 40960
  s_add_u32 s4, s74, 0
  buffer_load_dwordx4 v8, s[40:43], s4 offen lds
  s_add_u32 m0, s77, 41984
  s_nop 0
  buffer_load_dwordx4 v9, s[40:43], s4 offen lds
  v_readlane_b32 s74, v16, 3
  s_add_u32 m0, s77, 49152
  s_add_u32 s4, s74, s76
  buffer_load_dwordx4 v8, s[40:43], s4 offen lds
  s_add_u32 m0, s77, 50176
  s_nop 0
  buffer_load_dwordx4 v9, s[40:43], s4 offen lds
  s_add_u32 m0, s77, 57344
  s_add_u32 s4, s74, 0
  buffer_load_dwordx4 v8, s[40:43], s4 offen lds
  s_add_u32 m0, s77, 58368
  s_nop 0
  buffer_load_dwordx4 v9, s[40:43], s4 offen lds
  v_readlane_b32 s74, v16, 4
  s_add_u32 m0, s77, 65536
  s_add_u32 s4, s74, s76
  buffer_load_dwordx4 v8, s[40:43], s4 offen lds
  s_add_u32 m0, s77, 66560
  s_nop 0
  buffer_load_dwordx4 v9, s[40:43], s4 offen lds
  s_add_u32 m0, s77, 73728
  s_add_u32 s4, s74, 0
  buffer_load_dwordx4 v8, s[40:43], s4 offen lds
  s_add_u32 m0, s77, 74752
  s_nop 0
  buffer_load_dwordx4 v9, s[40:43], s4 offen lds
  s_add_u32 s44, s22, 41943040
  s_addc_u32 s45, s23, 0
  s_and_b32 s45, s45, 0xffff
  s_mov_b32 s46, 524288
  s_mov_b32 s47, 0x00020000
  s_lshl4_add_u32 s3, s97, s68
  s_and_b32 s4, s69, 15
  s_lshl4_add_u32 s3, s3, s4
  s_lshl_b32 s3, s3, 7
  s_sub_u32 s3, s3, 32768
  v_lshlrev_b32 v11, 7, v1
  v_and_b32 v2, 15, v1
  v_lshlrev_b32 v2, 2, v2
  v_mov_b32 v3, 1
  s_mov_b32 s79, 0x100000
  v_cmp_ne_u32 vcc, s92, 0
  s_cmp_lg_u32 s70, 4
  s_barrier
  s_cbranch_scc1 L_w2_nofl
  s_cbranch_vccnz L_w2_wb
L_w2_wbd:
  s_mov_b32 exec_lo, 0xffff
  s_mov_b32 exec_hi, 0
  buffer_store_dword v3, v11, s[44:47], s87 offen sc1
  s_mov_b64 exec, -1
L_w2_nofl:
  s_mov_b32 s5, s3
  v_readlane_b32 s74, v16, 5
  s_add_u32 m0, s77, 81920
  s_add_u32 s4, s74, s76
  buffer_load_dwordx4 v8, s[40:43], s4 offen lds
  s_add_u32 m0, s77, 82944
  s_nop 0
  buffer_load_dwordx4 v9, s[40:43], s4 offen lds
  s_add_u32 m0, s77, 90112
  s_add_u32 s4, s74, 0
  buffer_load_dwordx4 v8, s[40:43], s4 offen lds
  s_add_u32 m0, s77, 91136
  s_nop 0
  buffer_load_dwordx4 v9, s[40:43], s4 offen lds
  v_readlane_b32 s74, v16, 6
  s_add_u32 m0, s77, 98304
  s_add_u32 s4, s74, s76
  buffer_load_dwordx4 v8, s[40:43], s4 offen lds
  s_add_u32 m0, s77, 99328
  s_nop 0
  buffer_load_dwordx4 v9, s[40:43], s4 offen lds
  s_add_u32 m0, s77, 106496
  s_add_u32 s4, s74, 0
  buffer_load_dwordx4 v8, s[40:43], s4 offen lds
  s_add_u32 m0, s77, 107520
  s_nop 0
  buffer_load_dwordx4 v9, s[40:43], s4 offen lds
  s_waitcnt vmcnt(20)
  s_barrier
  v_readlane_b32 s74, v16, 7
  s_add_u32 m0, s77, 114688
  s_add_u32 s4, s74, s76
  buffer_load_dwordx4 v8, s[40:43], s4 offen lds
  s_add_u32 m0, s77, 115712
  s_nop 0
  buffer_load_dwordx4 v9, s[40:43], s4 offen lds
  s_add_u32 m0, s77, 122880
  s_add_u32 s4, s74, 0
  buffer_load_dwordx4 v8, s[40:43], s4 offen lds
  s_add_u32 m0, s77, 123904
  s_nop 0
  buffer_load_dwordx4 v9, s[40:43], s4 offen lds
  v_readlane_b32 s74, v16, 8
  s_add_u32 m0, s77, 131072
  s_add_u32 s4, s74, s76
  buffer_load_dwordx4 v8, s[40:43], s4 offen lds
  s_add_u32 m0, s77, 132096
  s_nop 0
  buffer_load_dwordx4 v9, s[40:43], s4 offen lds
  s_add_u32 m0, s77, 139264
  s_add_u32 s4, s74, 0
  buffer_load_dwordx4 v8, s[40:43], s4 offen lds
  s_add_u32 m0, s77, 140288
  s_nop 0
  buffer_load_dwordx4 v9, s[40:43], s4 offen lds
  v_readlane_b32 s74, v16, 9
  s_add_u32 m0, s77, 147456
  s_add_u32 s4, s74, s76
  buffer_load_dwordx4 v8, s[40:43], s4 offen lds
  s_add_u32 m0, s77, 148480
  s_nop 0
  buffer_load_dwordx4 v9, s[40:43], s4 offen lds
  s_add_u32 m0, s77, 155648
  s_add_u32 s4, s74, 0
  buffer_load_dwordx4 v8, s[40:43], s4 offen lds
  s_add_u32 m0, s77, 156672
  s_nop 0
  buffer_load_dwordx4 v9, s[40:43], s4 offen lds
  s_mov_b32 s3, s5
  s_cmp_lg_u32 s70, 4
  s_cbranch_scc1 L_w2_dep
L_w2_poll:
  buffer_load_dword v3, v2, s[44:47], s3 offen sc1
  s_sub_u32 s79, s79, 1
  s_cbranch_scc1 L_w2_dep
  s_waitcnt vmcnt(0)
  v_cmp_ne_u32 vcc, 1, v3
  s_cbranch_vccnz L_w2_poll
L_w2_dep:
  s_waitcnt vmcnt(22) lgkmcnt(0)
  s_barrier
  v_readlane_b32 s74, v16, 10
  s_add_u32 m0, s77, 0
  s_add_u32 s4, s74, s76
  buffer_load_dwordx4 v8, s[40:43], s4 offen lds
  s_add_u32 m0, s77, 1024
  s_nop 0
  buffer_load_dwordx4 v9, s[40:43], s4 offen lds
  s_waitcnt vmcnt(4)
  s_add_u32 m0, s77, 8192
  s_add_u32 s4, s74, 0
  buffer_load_dwordx4 v8, s[40:43], s4 offen lds
  s_add_u32 m0, s77, 9216
  s_nop 0
  buffer_load_dwordx4 v9, s[40:43], s4 offen lds
  s_waitcnt vmcnt(4)
  v_readlane_b32 s74, v16, 11
  s_add_u32 m0, s77, 16384
  s_add_u32 s4, s74, s76
  buffer_load_dwordx4 v8, s[40:43], s4 offen lds
  s_add_u32 m0, s77, 17408
  s_nop 0
  buffer_load_dwordx4 v9, s[40:43], s4 offen lds
  s_waitcnt vmcnt(20)
  s_barrier
  s_add_u32 m0, s77, 24576
  s_add_u32 s4, s74, 0
  buffer_load_dwordx4 v8, s[40:43], s4 offen lds
  s_add_u32 m0, s77, 25600
  s_nop 0
  buffer_load_dwordx4 v9, s[40:43], s4 offen lds
  s_waitcnt vmcnt(4)
  v_readlane_b32 s74, v16, 12
  s_add_u32 m0, s77, 32768
  s_add_u32 s4, s74, s76
  buffer_load_dwordx4 v8, s[40:43], s4 offen lds
  s_add_u32 m0, s77, 33792
  s_nop 0
  buffer_load_dwordx4 v9, s[40:43], s4 offen lds
  s_waitcnt vmcnt(4)
  s_add_u32 m0, s77, 40960
  s_add_u32 s4, s74, 0
  buffer_load_dwordx4 v8, s[40:43], s4 offen lds
  s_add_u32 m0, s77, 41984
  s_nop 0
  buffer_load_dwordx4 v9, s[40:43], s4 offen lds
  s_waitcnt vmcnt(4)
  v_readlane_b32 s74, v16, 13
  s_add_u32 m0, s77, 49152
  s_add_u32 s4, s74, s76
  buffer_load_dwordx4 v8, s[40:43], s4 offen lds
  s_add_u32 m0, s77, 50176
  s_nop 0
  buffer_load_dwordx4 v9, s[40:43], s4 offen lds
  s_waitcnt vmcnt(4)
  s_add_u32 m0, s77, 57344
  s_add_u32 s4, s74, 0
  buffer_load_dwordx4 v8, s[40:43], s4 offen lds
  s_add_u32 m0, s77, 58368
  s_nop 0
  buffer_load_dwordx4 v9, s[40:43], s4 offen lds
  s_waitcnt vmcnt(22)
  s_barrier
  v_readlane_b32 s74, v16, 14
  s_add_u32 m0, s77, 65536
  s_add_u32 s4, s74, s76
  buffer_load_dwordx4 v8, s[40:43], s4 offen lds
  s_add_u32 m0, s77, 66560
  s_nop 0
  buffer_load_dwordx4 v9, s[40:43], s4 offen lds
  s_waitcnt vmcnt(4)
  s_add_u32 m0, s77, 73728
  s_add_u32 s4, s74, 0
  buffer_load_dwordx4 v8, s[40:43], s4 offen lds
  s_add_u32 m0, s77, 74752
  s_nop 0
  buffer_load_dwordx4 v9, s[40:43], s4 offen lds
  s_waitcnt vmcnt(4)
  v_readlane_b32 s74, v16, 15
  s_add_u32 m0, s77, 81920
  s_add_u32 s4, s74, s76
  buffer_load_dwordx4 v8, s[40:43], s4 offen lds
  s_add_u32 m0, s77, 82944
  s_nop 0
  buffer_load_dwordx4 v9, s[40:43], s4 offen lds
  s_waitcnt vmcnt(4)
  s_add_u32 m0, s77, 90112
  s_add_u32 s4, s74, 0
  buffer_load_dwordx4 v8, s[40:43], s4 offen lds
  s_add_u32 m0, s77, 91136
  s_nop 0
  buffer_load_dwordx4 v9, s[40:43], s4 offen lds
  s_waitcnt vmcnt(22)
  s_barrier
  v_readlane_b32 s74, v16, 16
  s_add_u32 m0, s77, 98304
  s_add_u32 s4, s74, s76
  buffer_load_dwordx4 v8, s[40:43], s4 offen lds
  s_add_u32 m0, s77, 99328
  s_nop 0
  buffer_load_dwordx4 v9, s[40:43], s4 offen lds
  s_waitcnt vmcnt(4)
  s_add_u32 m0, s77, 106496
  s_add_u32 s4, s74, 0
  buffer_load_dwordx4 v8, s[40:43], s4 offen lds
  s_add_u32 m0, s77, 107520
  s_nop 0
  buffer_load_dwordx4 v9, s[40:43], s4 offen lds
  s_waitcnt vmcnt(4)
  v_readlane_b32 s74, v16, 17
  s_add_u32 m0, s77, 114688
  s_add_u32 s4, s74, s76
  buffer_load_dwordx4 v8, s[40:43], s4 offen lds
  s_add_u32 m0, s77, 115712
  s_nop 0
  buffer_load_dwordx4 v9, s[40:43], s4 offen lds
  s_waitcnt vmcnt(4)
  v_readlane_b32 s74, v16, 18
  s_add_u32 m0, s77, 122880
  s_add_u32 s4, s74, s76
  buffer_load_dwordx4 v8, s[40:43], s4 offen lds
  s_add_u32 m0, s77, 123904
  s_nop 0
  buffer_load_dwordx4 v9, s[40:43], s4 offen lds
  s_waitcnt vmcnt(22)
  s_barrier
  v_readlane_b32 s74, v16, 19
  s_add_u32 m0, s77, 131072
  s_add_u32 s4, s74, s76
  buffer_load_dwordx4 v8, s[40:43], s4 offen lds
  s_add_u32 m0, s77, 132096
  s_nop 0
  buffer_load_dwordx4 v9, s[40:43], s4 offen lds
  s_waitcnt vmcnt(4)
  v_readlane_b32 s74, v16, 20
  s_add_u32 m0, s77, 139264
  s_add_u32 s4, s74, s76
  buffer_load_dwordx4 v8, s[40:43], s4 offen lds
  s_add_u32 m0, s77, 140288
  s_nop 0
  buffer_load_dwordx4 v9, s[40:43], s4 offen lds
  s_waitcnt vmcnt(4)
  v_readlane_b32 s74, v16, 21
  s_add_u32 m0, s77, 147456
  s_add_u32 s4, s74, s76
  buffer_load_dwordx4 v8, s[40:43], s4 offen lds
  s_add_u32 m0, s77, 148480
  s_nop 0
  buffer_load_dwordx4 v9, s[40:43], s4 offen lds
  s_waitcnt vmcnt(4)
  v_readlane_b32 s74, v16, 22
  s_add_u32 m0, s77, 155648
  s_add_u32 s4, s74, s76
  buffer_load_dwordx4 v8, s[40:43], s4 offen lds
  s_add_u32 m0, s77, 156672
  s_nop 0
  buffer_load_dwordx4 v9, s[40:43], s4 offen lds
  s_waitcnt vmcnt(22)
  s_barrier
  v_readlane_b32 s74, v16, 17
  s_add_u32 m0, s77, 0
  s_add_u32 s4, s74, 0
  buffer_load_dwordx4 v8, s[40:43], s4 offen lds
  s_add_u32 m0, s77, 1024
  s_nop 0
  buffer_load_dwordx4 v9, s[40:43], s4 offen lds
  s_waitcnt vmcnt(4)
  v_readlane_b32 s74, v16, 18
  s_add_u32 m0, s77, 8192
  s_add_u32 s4, s74, 0
  buffer_load_dwordx4 v8, s[40:43], s4 offen lds
  s_add_u32 m0, s77, 9216
  s_nop 0
  buffer_load_dwordx4 v9, s[40:43], s4 offen lds
  s_waitcnt vmcnt(4)
  v_readlane_b32 s74, v16, 19
  s_add_u32 m0, s77, 16384
  s_add_u32 s4, s74, 0
  buffer_load_dwordx4 v8, s[40:43], s4 offen lds
  s_add_u32 m0, s77, 17408
  s_nop 0
  buffer_load_dwordx4 v9, s[40:43], s4 offen lds
  s_waitcnt vmcnt(4)
  v_readlane_b32 s74, v16, 20
  s_add_u32 m0, s77, 24576
  s_add_u32 s4, s74, 0
  buffer_load_dwordx4 v8, s[40:43], s4 offen lds
  s_add_u32 m0, s77, 25600
  s_nop 0
  buffer_load_dwordx4 v9, s[40:43], s4 offen lds
  s_waitcnt vmcnt(22)
  s_barrier
  v_readlane_b32 s74, v16, 21
  s_add_u32 m0, s77, 32768
  s_add_u32 s4, s74, 0
  buffer_load_dwordx4 v8, s[40:43], s4 offen lds
  s_add_u32 m0, s77, 33792
  s_nop 0
  buffer_load_dwordx4 v9, s[40:43], s4 offen lds
  s_waitcnt vmcnt(4)
  v_readlane_b32 s74, v16, 22
  s_add_u32 m0, s77, 40960
  s_add_u32 s4, s74, 0
  buffer_load_dwordx4 v8, s[40:43], s4 offen lds
  s_add_u32 m0, s77, 41984
  s_nop 0
  buffer_load_dwordx4 v9, s[40:43], s4 offen lds
  s_waitcnt vmcnt(4)
  v_readlane_b32 s74, v16, 23
  s_add_u32 m0, s77, 49152
  s_add_u32 s4, s74, 0
  buffer_load_dwordx4 v8, s[40:43], s4 offen lds
  s_add_u32 m0, s77, 50176
  s_nop 0
  buffer_load_dwordx4 v9, s[40:43], s4 offen lds
  s_waitcnt vmcnt(4)
  v_readlane_b32 s74, v16, 24
  s_add_u32 m0, s77, 57344
  s_add_u32 s4, s74, 0
  buffer_load_dwordx4 v8, s[40:43], s4 offen lds
  s_add_u32 m0, s77, 58368
  s_nop 0
  buffer_load_dwordx4 v9, s[40:43], s4 offen lds
  s_waitcnt vmcnt(22)
  s_barrier
  v_readlane_b32 s74, v16, 25
  s_add_u32 m0, s77, 65536
  s_add_u32 s4, s74, 0
  buffer_load_dwordx4 v8, s[40:43], s4 offen lds
  s_add_u32 m0, s77, 66560
  s_nop 0
  buffer_load_dwordx4 v9, s[40:43], s4 offen lds
  s_waitcnt vmcnt(4)
  v_readlane_b32 s74, v16, 26
  s_add_u32 m0, s77, 73728
  s_add_u32 s4, s74, 0
  buffer_load_dwordx4 v8, s[40:43], s4 offen lds
  s_add_u32 m0, s77, 74752
  s_nop 0
  buffer_load_dwordx4 v9, s[40:43], s4 offen lds
  s_waitcnt vmcnt(4)
  v_readlane_b32 s74, v16, 27
  s_add_u32 m0, s77, 81920
  s_add_u32 s4, s74, 0
  buffer_load_dwordx4 v8, s[40:43], s4 offen lds
  s_add_u32 m0, s77, 82944
  s_nop 0
  buffer_load_dwordx4 v9, s[40:43], s4 offen lds
  s_waitcnt vmcnt(4)
  v_readlane_b32 s74, v16, 28
  s_add_u32 m0, s77, 90112
  s_add_u32 s4, s74, 0
  buffer_load_dwordx4 v8, s[40:43], s4 offen lds
  s_add_u32 m0, s77, 91136
  s_nop 0
  buffer_load_dwordx4 v9, s[40:43], s4 offen lds
  s_waitcnt vmcnt(22)
  s_barrier
  v_readlane_b32 s74, v16, 29
  s_add_u32 m0, s77, 98304
  s_add_u32 s4, s74, 0
  buffer_load_dwordx4 v8, s[40:43], s4 offen lds
  s_add_u32 m0, s77, 99328
  s_nop 0
  buffer_load_dwordx4 v9, s[40:43], s4 offen lds
  s_waitcnt vmcnt(4)
  v_readlane_b32 s74, v16, 30
  s_add_u32 m0, s77, 106496
  s_add_u32 s4, s74, 0
  buffer_load_dwordx4 v8, s[40:43], s4 offen lds
  s_add_u32 m0, s77, 107520
  s_nop 0
  buffer_load_dwordx4 v9, s[40:43], s4 offen lds
  s_waitcnt vmcnt(4)
  v_readlane_b32 s74, v16, 31
  s_add_u32 m0, s77, 114688
  s_add_u32 s4, s74, 0
  buffer_load_dwordx4 v8, s[40:43], s4 offen lds
  s_add_u32 m0, s77, 115712
  s_nop 0
  buffer_load_dwordx4 v9, s[40:43], s4 offen lds
  s_waitcnt vmcnt(4)
  v_readlane_b32 s74, v16, 32
  s_add_u32 m0, s77, 122880
  s_add_u32 s4, s74, 0
  buffer_load_dwordx4 v8, s[40:43], s4 offen lds
  s_add_u32 m0, s77, 123904
  s_nop 0
  buffer_load_dwordx4 v9, s[40:43], s4 offen lds
  s_waitcnt vmcnt(22)
  s_barrier
  s_add_u32 s64, s22, 41943040
  s_addc_u32 s65, s23, 0
  s_and_b32 s65, s65, 0xffff
  s_mov_b32 s66, 524288
  s_mov_b32 s67, 0x00020000
  s_lshl4_add_u32 s6, s68, s69
  s_xor_b32 s6, s6, 1
  s_add_u32 s7, s96, 4
  s_lshl_b32 s7, s7, 8
  s_add_u32 s6, s6, s7
  s_lshl_b32 s86, s6, 8
  v_and_b32 v2, 3, v1
  v_lshlrev_b32 v30, 6, v2
  s_mov_b32 s79, 0x100000
  s_waitcnt vmcnt(0)
  s_barrier
  s_cmp_eq_u32 s96, 0
  s_cbranch_scc1 L_w2_zskip
  s_cmp_lg_u32 s70, 4
  s_cbranch_scc1 L_w2_xgo
  s_setprio 3
L_w2_xpoll:
  buffer_load_dword v5, v30, s[64:67], s86 offen sc1
  s_sub_u32 s79, s79, 1
  s_cbranch_scc1 L_w2_xgo
  s_waitcnt vmcnt(0)
  v_cmp_ne_u32 vcc, 1, v5
  s_cbranch_vccnz L_w2_xpoll
L_w2_xgo:
  s_setprio 0
  s_waitcnt vmcnt(0)
  s_barrier
L_w2_zskip:
  s_cmp_eq_u32 s96, 1
  s_cbranch_scc1 L_w2_end
  s_lshl_b32 s87, s97, 15
  s_lshl_b32 s4, s68, 11
  s_add_u32 s87, s87, s4
  s_lshl_b32 s4, s69, 2
  s_add_u32 s87, s87, s4
  s_mov_b32 s96, 1
  s_add_u32 s12, s22, 33554432
  s_addc_u32 s13, s23, 0
  s_add_u32 s34, s22, 67108864
  s_addc_u32 s35, s23, 0
  s_add_u32 s97, s97, 1
  s_branch L_attn_body
L_w2_wb:
  buffer_wbl2 sc1
  s_waitcnt vmcnt(0)
  s_branch L_w2_wbd
L_w2_end:
  s_endpgm
L_w2_compute:
  s_lshl_b32 s3, s70, 12
  s_add_u32 s3, s3, 114688
  v_lshl_add_u32 v2, v1, 4, s3
  ds_read_b128 v[32:35], v2 offset:0
  ds_read_b128 v[36:39], v2 offset:2048
  ds_read_b128 v[40:43], v2 offset:1024
  ds_read_b128 v[44:47], v2 offset:3072
  ds_read_b128 v[48:51], v2 offset:16384
  ds_read_b128 v[52:55], v2 offset:18432
  ds_read_b128 v[56:59], v2 offset:17408
  ds_read_b128 v[60:63], v2 offset:19456
  ds_read_b128 v[64:67], v2 offset:32768
  ds_read_b128 v[68:71], v2 offset:34816
  ds_read_b128 v[72:75], v2 offset:33792
  ds_read_b128 v[76:79], v2 offset:35840
  s_add_u32 s3, s68, s78
  s_and_b32 s3, s3, 3
  s_mov_b32 s4, 0x1616160
  s_cmp_eq_u32 s3, 1
  s_cselect_b32 s4, 0x5858580, s4
  s_cmp_eq_u32 s3, 2
  s_cselect_b32 s4, 0x16161600, s4
  s_cmp_eq_u32 s3, 3
  s_cselect_b32 s4, 0x58585800, s4
  v_subrev_u32 v2, 3, v1
  v_min_u32 v2, 16, v2
  v_lshlrev_b32 v3, 1, v2
  v_bfe_i32 v15, s4, v3, 2
  v_sub_u32 v15, v1, v15
  v_subrev_u32 v15, 7, v15
  v_ashrrev_i32 v3, 1, v15
  v_cmp_eq_u32 vcc, s78, v3
  s_and_b32 s3, s69, 1
  v_or_b32 v2, 14, v15
  v_cndmask_b32 v2, v15, v2, vcc
  v_cmp_gt_i32 vcc, 0, v15
  s_lshl2_add_u32 s4, s3, 20
  v_add_u32 v15, s4, v15
  s_lshl4_add_u32 s4, s3, 24
  v_add_u32 v2, s4, v2
  v_cndmask_b32 v15, v2, v15, vcc
  s_and_b32 s5, s68, 3
  s_mul_i32 s5, s5, 3
  s_sub_u32 s5, s5, 23
  v_add_u32 v3, s5, v1
  v_subrev_u32 v2, 10, v3
  v_min_u32 v3, v3, v2
  v_subrev_u32 v2, 10, v3
  v_min_u32 v3, v3, v2
  v_cmp_gt_u32 vcc, 23, v1
  s_sub_u32 s5, s3, 46
  v_lshl_add_u32 v2, v1, 1, s5
  v_cndmask_b32 v3, v3, v2, vcc
  s_add_u32 s5, s78, 3
  v_ashrrev_i32 v2, 1, v3
  v_add_u32 v2, s5, v2
  v_and_b32 v2, 7, v2
  v_and_b32 v3, 1, v3
  v_cmp_gt_u32 vcc, 21, v1
  v_lshl_add_u32 v3, v3, 3, v2
  s_lshl1_add_u32 s4, s78, s4
  s_lshl3_add_u32 s3, s3, s78
  v_cndmask_b32 v3, v3, v15, vcc
  v_writelane_b32 v3, s4, 0
  s_add_u32 s4, s4, 1
  v_writelane_b32 v3, s3, 2
  v_writelane_b32 v3, s4, 1
  v_lshlrev_b32 v15, 11, v3
  s_waitcnt lgkmcnt(0)
  s_barrier
  v_and_b32 v3, 15, v1
  v_lshrrev_b32 v2, 4, v1
  s_lshl_b32 s8, s68, 7
  s_lshl_b32 s9, s70, 5
  s_add_u32 s8, s8, s9
  s_mul_i32 s9, s8, 7168
  v_add_u32 v13, s8, v3
  s_lshl_b32 s10, s69, 7
  v_lshl_add_u32 v14, v2, 3, s10
  v_and_b32 v16, 1, v2
  v_lshrrev_b32 v17, 1, v2
  v_lshlrev_b32 v4, 3, v3
  v_and_b32 v4, 0x70, v4
  v_lshlrev_b32 v16, 3, v2
  v_xor_b32 v4, v4, v16
  v_lshl_add_u32 v4, v3, 7, v4
  s_lshl_b32 s3, s70, 12
  v_add_u32 v4, s3, v4
  v_lshl_add_u32 v5, v1, 4, s3
  s_cmp_eq_u32 s96, 0
  s_cselect_b32 s7, 128, 0
  s_add_u32 s7, s7, 2048
  v_xor_b32 v16, v1, v2
  v_and_b32 v16, 7, v16
  v_lshl_add_u32 v16, v16, 4, s10
  v_lshrrev_b32 v14, 3, v1
  v_add_u32 v14, s8, v14
  v_mad_u32_u24 v12, v14, s7, v16
  v_lshl_add_u32 v18, v17, 4, v13
  v_lshlrev_b32 v18, 3, v18
  v_and_b32 v16, 1, v2
  v_lshl_add_u32 v18, v16, 2, v18
  s_lshl_b32 s10, s69, 14
  v_add_u32 v18, s10, v18
  v_lshrrev_b32 v6, 2, v1
  v_lshlrev_b32 v6, 7, v6
  v_and_b32 v17, 3, v1
  v_lshl_add_u32 v6, v17, 3, v6
  v_bfe_u32 v17, v1, 3, 2
  v_lshl_add_u32 v6, v17, 5, v6
  v_xor_b32 v7, 32, v6
  v_xor_b32 v8, 64, v6
  v_xor_b32 v9, 96, v6
  s_mov_b32 s11, 0xffff0000
  s_add_u32 s36, s34, 8388608
  s_addc_u32 s37, s35, 0
  s_and_b32 s37, s37, 0xffff
  s_mov_b32 s38, 14680064
  s_mov_b32 s39, 0x00020000
  s_mov_b32 s44, s32
  s_and_b32 s45, s33, 0xffff
  s_mov_b32 s46, 4194304
  s_mov_b32 s47, 0x00020000
  s_add_u32 s48, s22, 33554432
  s_addc_u32 s49, s23, 0
  s_and_b32 s49, s49, 0xffff
  s_mov_b32 s50, 4194304
  s_mov_b32 s51, 0x00020000
  s_cmp_eq_u32 s96, 0
  s_cselect_b64 s[44:45], s[48:49], s[44:45]
  s_lshl_b32 s46, s7, 11
  s_add_u32 s56, s34, 24379392
  s_addc_u32 s57, s35, 0
  s_and_b32 s57, s57, 0xffff
  s_mov_b32 s58, 262144
  s_mov_b32 s59, 0x00020000
  s_mul_i32 s9, s8, 7168
  s_add_u32 s9, s9, s98
  s_add_u32 s36, s36, s9
  s_addc_u32 s37, s37, 0x100000
  s_add_u32 s64, s36, 114688
  s_addc_u32 s65, s37, 0
  s_mov_b32 s38, 114688
  s_mov_b32 s39, 0x00800000
  s_mov_b32 s66, 114688
  s_mov_b32 s67, 0x00800000
  s_add_u32 s60, s34, 25165824
  s_addc_u32 s61, s35, 0
  s_and_b32 s61, s61, 0xffff
  s_mov_b32 s62, 4194304
  s_mov_b32 s63, 0x00020000
  s_or_b32 s61, s61, 0x100000
  s_mov_b32 s63, 0x00800000
  s_lshl4_add_u32 s4, s68, s69
  s_lshl2_add_u32 s4, s4, s70
  s_add_u32 s52, s22, 41943040
  s_addc_u32 s53, s23, 0
  s_and_b32 s53, s53, 0xffff
  s_mov_b32 s54, 524288
  s_mov_b32 s55, 0x00020000
  s_add_u32 s6, s96, 4
  s_lshl_b32 s6, s6, 10
  s_add_u32 s6, s6, s4
  s_lshl_b32 s6, s6, 6
  v_mov_b32 v19, 1
  s_lshl_b32 s4, s4, 12
  s_xor_b32 s5, s4, 16384
  v_add_u32 v26, 131072, v6
  v_add_u32 v27, 131072, v7
  v_add_u32 v28, 131072, v8
  v_add_u32 v29, 131072, v9
  v_add_u32 v20, 65536, v6
  v_add_u32 v21, 65536, v7
  v_add_u32 v22, 65536, v8
  v_add_u32 v23, 65536, v9
  v_readlane_b32 s51, v15, 3
  v_readlane_b32 s48, v15, 4
  v_readlane_b32 s49, v15, 5
  s_waitcnt lgkmcnt(0)
  ds_read_b64_tr_b16 v[160:161], v6 offset:0
  ds_read_b64_tr_b16 v[162:163], v6 offset:2048
  ds_read_b64_tr_b16 v[164:165], v7 offset:0
  ds_read_b64_tr_b16 v[166:167], v7 offset:2048
  ds_read_b64_tr_b16 v[168:169], v8 offset:0
  ds_read_b64_tr_b16 v[170:171], v8 offset:2048
  ds_read_b64_tr_b16 v[172:173], v9 offset:0
  ds_read_b64_tr_b16 v[174:175], v9 offset:2048
  ds_read_b64_tr_b16 v[176:177], v6 offset:4096
  ds_read_b64_tr_b16 v[178:179], v6 offset:6144
  ds_read_b64_tr_b16 v[180:181], v7 offset:4096
  ds_read_b64_tr_b16 v[182:183], v7 offset:6144
  ds_read_b64_tr_b16 v[184:185], v8 offset:4096
  ds_read_b64_tr_b16 v[186:187], v8 offset:6144
  ds_read_b64_tr_b16 v[188:189], v9 offset:4096
  ds_read_b64_tr_b16 v[190:191], v9 offset:6144
  v_lshlrev_b32 v216, 16, v10
  v_and_b32 v217, s11, v10
  v_lshlrev_b32 v218, 16, v11
  v_and_b32 v219, s11, v11
  v_lshlrev_b32 v96, 16, v240
  v_and_b32 v97, s11, v240
  v_pk_add_f32 v[96:97], v[96:97], v[216:217]
  v_lshlrev_b32 v98, 16, v241
  v_and_b32 v99, s11, v241
  v_pk_add_f32 v[98:99], v[98:99], v[218:219]
  v_lshlrev_b32 v100, 16, v248
  v_and_b32 v101, s11, v248
  v_pk_add_f32 v[100:101], v[100:101], v[216:217]
  v_lshlrev_b32 v102, 16, v249
  v_and_b32 v103, s11, v249
  v_pk_add_f32 v[102:103], v[102:103], v[218:219]
  v_lshlrev_b32 v216, 16, v24
  v_and_b32 v217, s11, v24
  v_lshlrev_b32 v218, 16, v25
  v_and_b32 v219, s11, v25
  v_lshlrev_b32 v104, 16, v242
  v_and_b32 v105, s11, v242
  v_pk_add_f32 v[104:105], v[104:105], v[216:217]
  v_lshlrev_b32 v106, 16, v243
  v_and_b32 v107, s11, v243
  v_pk_add_f32 v[106:107], v[106:107], v[218:219]
  v_lshlrev_b32 v108, 16, v250
  v_and_b32 v109, s11, v250
  v_pk_add_f32 v[108:109], v[108:109], v[216:217]
  v_lshlrev_b32 v110, 16, v251
  v_and_b32 v111, s11, v251
  v_pk_add_f32 v[110:111], v[110:111], v[218:219]
  v_lshlrev_b32 v216, 16, v124
  v_and_b32 v217, s11, v124
  v_lshlrev_b32 v218, 16, v125
  v_and_b32 v219, s11, v125
  v_lshlrev_b32 v112, 16, v244
  v_and_b32 v113, s11, v244
  v_pk_add_f32 v[112:113], v[112:113], v[216:217]
  v_lshlrev_b32 v114, 16, v245
  v_and_b32 v115, s11, v245
  v_pk_add_f32 v[114:115], v[114:115], v[218:219]
  v_lshlrev_b32 v116, 16, v252
  v_and_b32 v117, s11, v252
  v_pk_add_f32 v[116:117], v[116:117], v[216:217]
  v_lshlrev_b32 v118, 16, v253
  v_and_b32 v119, s11, v253
  v_pk_add_f32 v[118:119], v[118:119], v[218:219]
  v_lshlrev_b32 v216, 16, v126
  v_and_b32 v217, s11, v126
  v_lshlrev_b32 v218, 16, v127
  v_and_b32 v219, s11, v127
  v_lshlrev_b32 v120, 16, v246
  v_and_b32 v121, s11, v246
  v_pk_add_f32 v[120:121], v[120:121], v[216:217]
  v_lshlrev_b32 v122, 16, v247
  v_and_b32 v123, s11, v247
  v_pk_add_f32 v[122:123], v[122:123], v[218:219]
  v_lshlrev_b32 v124, 16, v254
  v_and_b32 v125, s11, v254
  v_pk_add_f32 v[124:125], v[124:125], v[216:217]
  v_lshlrev_b32 v126, 16, v255
  v_and_b32 v127, s11, v255
  v_pk_add_f32 v[126:127], v[126:127], v[218:219]
  s_waitcnt lgkmcnt(8)
  v_mfma_f32_16x16x32_bf16 v[128:131], v[160:163], v[32:35], 0
  ds_read_b64_tr_b16 v[192:193], v6 offset:8192
  v_mfma_f32_16x16x32_bf16 v[132:135], v[160:163], v[36:39], 0
  ds_read_b64_tr_b16 v[194:195], v6 offset:10240
  v_mfma_f32_16x16x32_bf16 v[140:143], v[164:167], v[36:39], 0
  ds_read_b64_tr_b16 v[196:197], v7 offset:8192
  v_mfma_f32_16x16x32_bf16 v[136:139], v[164:167], v[32:35], 0
  ds_read_b64_tr_b16 v[198:199], v7 offset:10240
  v_mfma_f32_16x16x32_bf16 v[144:147], v[168:171], v[32:35], 0
  ds_read_b64_tr_b16 v[200:201], v8 offset:8192
  v_mfma_f32_16x16x32_bf16 v[148:151], v[168:171], v[36:39], 0
  ds_read_b64_tr_b16 v[202:203], v8 offset:10240
  v_mfma_f32_16x16x32_bf16 v[156:159], v[172:175], v[36:39], 0
  ds_read_b64_tr_b16 v[204:205], v9 offset:8192
  v_mfma_f32_16x16x32_bf16 v[152:155], v[172:175], v[32:35], 0
  ds_read_b64_tr_b16 v[206:207], v9 offset:10240
  s_waitcnt lgkmcnt(8)
  v_mfma_f32_16x16x32_bf16 v[128:131], v[176:179], v[40:43], v[128:131]
  ds_read_b64_tr_b16 v[208:209], v6 offset:12288
  v_mfma_f32_16x16x32_bf16 v[132:135], v[176:179], v[44:47], v[132:135]
  ds_read_b64_tr_b16 v[210:211], v6 offset:14336
  v_mfma_f32_16x16x32_bf16 v[140:143], v[180:183], v[44:47], v[140:143]
  ds_read_b64_tr_b16 v[212:213], v7 offset:12288
  v_mfma_f32_16x16x32_bf16 v[136:139], v[180:183], v[40:43], v[136:139]
  ds_read_b64_tr_b16 v[214:215], v7 offset:14336
  v_mfma_f32_16x16x32_bf16 v[144:147], v[184:187], v[40:43], v[144:147]
  ds_read_b64_tr_b16 v[216:217], v8 offset:12288
  v_mfma_f32_16x16x32_bf16 v[148:151], v[184:187], v[44:47], v[148:151]
  ds_read_b64_tr_b16 v[218:219], v8 offset:14336
  v_mfma_f32_16x16x32_bf16 v[156:159], v[188:191], v[44:47], v[156:159]
  ds_read_b64_tr_b16 v[220:221], v9 offset:12288
  v_mfma_f32_16x16x32_bf16 v[152:155], v[188:191], v[40:43], v[152:155]
  ds_read_b64_tr_b16 v[222:223], v9 offset:14336
  s_waitcnt lgkmcnt(8)
  v_mfma_f32_16x16x32_bf16 v[96:99], v[192:195], v[32:35], v[96:99]
  ds_read_b64_tr_b16 v[160:161], v6 offset:16384
  v_mfma_f32_16x16x32_bf16 v[100:103], v[192:195], v[36:39], v[100:103]
  ds_read_b64_tr_b16 v[162:163], v6 offset:18432
  v_mfma_f32_16x16x32_bf16 v[108:111], v[196:199], v[36:39], v[108:111]
  ds_read_b64_tr_b16 v[164:165], v7 offset:16384
  v_mfma_f32_16x16x32_bf16 v[104:107], v[196:199], v[32:35], v[104:107]
  ds_read_b64_tr_b16 v[166:167], v7 offset:18432
  v_mfma_f32_16x16x32_bf16 v[112:115], v[200:203], v[32:35], v[112:115]
  ds_read_b64_tr_b16 v[168:169], v8 offset:16384
  v_mfma_f32_16x16x32_bf16 v[116:119], v[200:203], v[36:39], v[116:119]
  ds_read_b64_tr_b16 v[170:171], v8 offset:18432
  v_mfma_f32_16x16x32_bf16 v[124:127], v[204:207], v[36:39], v[124:127]
  ds_read_b64_tr_b16 v[172:173], v9 offset:16384
  v_mfma_f32_16x16x32_bf16 v[120:123], v[204:207], v[32:35], v[120:123]
  ds_read_b64_tr_b16 v[174:175], v9 offset:18432
  s_waitcnt lgkmcnt(8)
  v_mfma_f32_16x16x32_bf16 v[96:99], v[208:211], v[40:43], v[96:99]
  ds_read_b64_tr_b16 v[176:177], v6 offset:20480
  v_mfma_f32_16x16x32_bf16 v[100:103], v[208:211], v[44:47], v[100:103]
  ds_read_b64_tr_b16 v[178:179], v6 offset:22528
  v_mfma_f32_16x16x32_bf16 v[108:111], v[212:215], v[44:47], v[108:111]
  ds_read_b64_tr_b16 v[180:181], v7 offset:20480
  v_mfma_f32_16x16x32_bf16 v[104:107], v[212:215], v[40:43], v[104:107]
  ds_read_b64_tr_b16 v[182:183], v7 offset:22528
  v_mfma_f32_16x16x32_bf16 v[112:115], v[216:219], v[40:43], v[112:115]
  ds_read_b64_tr_b16 v[184:185], v8 offset:20480
  v_mfma_f32_16x16x32_bf16 v[116:119], v[216:219], v[44:47], v[116:119]
  ds_read_b64_tr_b16 v[186:187], v8 offset:22528
  v_mfma_f32_16x16x32_bf16 v[124:127], v[220:223], v[44:47], v[124:127]
  ds_read_b64_tr_b16 v[188:189], v9 offset:20480
  v_mfma_f32_16x16x32_bf16 v[120:123], v[220:223], v[40:43], v[120:123]
  ds_read_b64_tr_b16 v[190:191], v9 offset:22528
  s_waitcnt lgkmcnt(8)
  v_mfma_f32_16x16x32_bf16 v[128:131], v[160:163], v[48:51], v[128:131]
  ds_read_b64_tr_b16 v[192:193], v6 offset:24576
  v_mfma_f32_16x16x32_bf16 v[132:135], v[160:163], v[52:55], v[132:135]
  ds_read_b64_tr_b16 v[194:195], v6 offset:26624
  v_mfma_f32_16x16x32_bf16 v[140:143], v[164:167], v[52:55], v[140:143]
  ds_read_b64_tr_b16 v[196:197], v7 offset:24576
  v_mfma_f32_16x16x32_bf16 v[136:139], v[164:167], v[48:51], v[136:139]
  ds_read_b64_tr_b16 v[198:199], v7 offset:26624
  v_mfma_f32_16x16x32_bf16 v[144:147], v[168:171], v[48:51], v[144:147]
  ds_read_b64_tr_b16 v[200:201], v8 offset:24576
  v_mfma_f32_16x16x32_bf16 v[148:151], v[168:171], v[52:55], v[148:151]
  ds_read_b64_tr_b16 v[202:203], v8 offset:26624
  v_mfma_f32_16x16x32_bf16 v[156:159], v[172:175], v[52:55], v[156:159]
  ds_read_b64_tr_b16 v[204:205], v9 offset:24576
  v_mfma_f32_16x16x32_bf16 v[152:155], v[172:175], v[48:51], v[152:155]
  ds_read_b64_tr_b16 v[206:207], v9 offset:26624
  s_waitcnt lgkmcnt(8)
  s_barrier
  buffer_load_dwordx4 v[80:83], off, s[36:39], s51 offset:0 sc1
  buffer_load_dwordx4 v[84:87], off, s[64:67], s51 offset:0 sc1
  buffer_load_dwordx4 v[88:91], off, s[36:39], s51 offset:1024 sc1
  buffer_load_dwordx4 v[92:95], off, s[64:67], s51 offset:1024 sc1
  buffer_load_dwordx4 v[224:227], off, s[36:39], s48 offset:0 sc1
  buffer_load_dwordx4 v[228:231], off, s[64:67], s48 offset:0 sc1
  buffer_load_dwordx4 v[232:235], off, s[36:39], s48 offset:1024 sc1
  buffer_load_dwordx4 v[236:239], off, s[64:67], s48 offset:1024 sc1
  buffer_load_dwordx4 v[240:243], off, s[36:39], s49 offset:0 sc1
  buffer_load_dwordx4 v[244:247], off, s[64:67], s49 offset:0 sc1
  buffer_load_dwordx4 v[248:251], off, s[36:39], s49 offset:1024 sc1
  buffer_load_dwordx4 v[252:255], off, s[64:67], s49 offset:1024 sc1
  v_mfma_f32_16x16x32_bf16 v[128:131], v[176:179], v[56:59], v[128:131]
  ds_read_b64_tr_b16 v[208:209], v6 offset:28672
  v_readlane_b32 s50, v15, 6
  v_mfma_f32_16x16x32_bf16 v[132:135], v[176:179], v[60:63], v[132:135]
  ds_read_b64_tr_b16 v[210:211], v6 offset:30720
  v_mfma_f32_16x16x32_bf16 v[140:143], v[180:183], v[60:63], v[140:143]
  ds_read_b64_tr_b16 v[212:213], v7 offset:28672
  v_mfma_f32_16x16x32_bf16 v[136:139], v[180:183], v[56:59], v[136:139]
  buffer_load_dwordx4 v[32:35], off, s[36:39], s50 offset:0 sc1
  v_mfma_f32_16x16x32_bf16 v[144:147], v[184:187], v[56:59], v[144:147]
  ds_read_b64_tr_b16 v[214:215], v7 offset:30720
  ds_read_b64_tr_b16 v[216:217], v8 offset:28672
  v_mfma_f32_16x16x32_bf16 v[148:151], v[184:187], v[60:63], v[148:151]
  ds_read_b64_tr_b16 v[218:219], v8 offset:30720
  ds_read_b64_tr_b16 v[220:221], v9 offset:28672
  v_mfma_f32_16x16x32_bf16 v[156:159], v[188:191], v[60:63], v[156:159]
  buffer_load_dwordx4 v[36:39], off, s[64:67], s50 offset:0 sc1
  v_mfma_f32_16x16x32_bf16 v[152:155], v[188:191], v[56:59], v[152:155]
  ds_read_b64_tr_b16 v[222:223], v9 offset:30720
  s_waitcnt lgkmcnt(8)
  v_mfma_f32_16x16x32_bf16 v[96:99], v[192:195], v[48:51], v[96:99]
  ds_read_b64_tr_b16 v[160:161], v6 offset:32768
  v_mfma_f32_16x16x32_bf16 v[100:103], v[192:195], v[52:55], v[100:103]
  buffer_load_dwordx4 v[40:43], off, s[36:39], s50 offset:1024 sc1
  v_mfma_f32_16x16x32_bf16 v[108:111], v[196:199], v[52:55], v[108:111]
  ds_read_b64_tr_b16 v[162:163], v6 offset:34816
  ds_read_b64_tr_b16 v[164:165], v7 offset:32768
  v_mfma_f32_16x16x32_bf16 v[104:107], v[196:199], v[48:51], v[104:107]
  ds_read_b64_tr_b16 v[166:167], v7 offset:34816
  v_mfma_f32_16x16x32_bf16 v[112:115], v[200:203], v[48:51], v[112:115]
  buffer_load_dwordx4 v[44:47], off, s[64:67], s50 offset:1024 sc1
  v_mfma_f32_16x16x32_bf16 v[116:119], v[200:203], v[52:55], v[116:119]
  ds_read_b64_tr_b16 v[168:169], v8 offset:32768
  ds_read_b64_tr_b16 v[170:171], v8 offset:34816
  v_mfma_f32_16x16x32_bf16 v[124:127], v[204:207], v[52:55], v[124:127]
  ds_read_b64_tr_b16 v[172:173], v9 offset:32768
  v_mfma_f32_16x16x32_bf16 v[120:123], v[204:207], v[48:51], v[120:123]
  ds_read_b64_tr_b16 v[174:175], v9 offset:34816
  s_waitcnt lgkmcnt(8)
  v_mfma_f32_16x16x32_bf16 v[96:99], v[208:211], v[56:59], v[96:99]
  ds_read_b64_tr_b16 v[176:177], v6 offset:36864
  v_mfma_f32_16x16x32_bf16 v[100:103], v[208:211], v[60:63], v[100:103]
  ds_read_b64_tr_b16 v[178:179], v6 offset:38912
  v_mfma_f32_16x16x32_bf16 v[108:111], v[212:215], v[60:63], v[108:111]
  ds_read_b64_tr_b16 v[180:181], v7 offset:36864
  v_mfma_f32_16x16x32_bf16 v[104:107], v[212:215], v[56:59], v[104:107]
  ds_read_b64_tr_b16 v[182:183], v7 offset:38912
  v_mfma_f32_16x16x32_bf16 v[112:115], v[216:219], v[56:59], v[112:115]
  ds_read_b64_tr_b16 v[184:185], v8 offset:36864
  v_mfma_f32_16x16x32_bf16 v[116:119], v[216:219], v[60:63], v[116:119]
  ds_read_b64_tr_b16 v[186:187], v8 offset:38912
  v_readlane_b32 s51, v15, 7
  v_mfma_f32_16x16x32_bf16 v[124:127], v[220:223], v[60:63], v[124:127]
  ds_read_b64_tr_b16 v[188:189], v9 offset:36864
  v_mfma_f32_16x16x32_bf16 v[120:123], v[220:223], v[56:59], v[120:123]
  ds_read_b64_tr_b16 v[190:191], v9 offset:38912
  s_waitcnt lgkmcnt(8)
  v_mfma_f32_16x16x32_bf16 v[128:131], v[160:163], v[64:67], v[128:131]
  buffer_load_dwordx4 v[48:51], off, s[36:39], s51 offset:0 sc1
  v_mfma_f32_16x16x32_bf16 v[132:135], v[160:163], v[68:71], v[132:135]
  ds_read_b64_tr_b16 v[192:193], v6 offset:40960
  ds_read_b64_tr_b16 v[194:195], v6 offset:43008
  v_mfma_f32_16x16x32_bf16 v[140:143], v[164:167], v[68:71], v[140:143]
  ds_read_b64_tr_b16 v[196:197], v7 offset:40960
  v_mfma_f32_16x16x32_bf16 v[136:139], v[164:167], v[64:67], v[136:139]
  buffer_load_dwordx4 v[52:55], off, s[64:67], s51 offset:0 sc1
  v_mfma_f32_16x16x32_bf16 v[144:147], v[168:171], v[64:67], v[144:147]
  ds_read_b64_tr_b16 v[198:199], v7 offset:43008
  ds_read_b64_tr_b16 v[200:201], v8 offset:40960
  v_mfma_f32_16x16x32_bf16 v[148:151], v[168:171], v[68:71], v[148:151]
  ds_read_b64_tr_b16 v[202:203], v8 offset:43008
  ds_read_b64_tr_b16 v[204:205], v9 offset:40960
  v_mfma_f32_16x16x32_bf16 v[156:159], v[172:175], v[68:71], v[156:159]
  buffer_load_dwordx4 v[56:59], off, s[36:39], s51 offset:1024 sc1
  v_mfma_f32_16x16x32_bf16 v[152:155], v[172:175], v[64:67], v[152:155]
  ds_read_b64_tr_b16 v[206:207], v9 offset:43008
  s_waitcnt lgkmcnt(8)
  v_mfma_f32_16x16x32_bf16 v[128:131], v[176:179], v[72:75], v[128:131]
  ds_read_b64_tr_b16 v[208:209], v6 offset:45056
  v_mfma_f32_16x16x32_bf16 v[132:135], v[176:179], v[76:79], v[132:135]
  buffer_load_dwordx4 v[60:63], off, s[64:67], s51 offset:1024 sc1
  v_mfma_f32_16x16x32_bf16 v[140:143], v[180:183], v[76:79], v[140:143]
  ds_read_b64_tr_b16 v[210:211], v6 offset:47104
  ds_read_b64_tr_b16 v[212:213], v7 offset:45056
  v_mfma_f32_16x16x32_bf16 v[136:139], v[180:183], v[72:75], v[136:139]
  ds_read_b64_tr_b16 v[214:215], v7 offset:47104
  v_mfma_f32_16x16x32_bf16 v[144:147], v[184:187], v[72:75], v[144:147]
  ds_read_b64_tr_b16 v[216:217], v8 offset:45056
  v_mfma_f32_16x16x32_bf16 v[148:151], v[184:187], v[76:79], v[148:151]
  ds_read_b64_tr_b16 v[218:219], v8 offset:47104
  v_mfma_f32_16x16x32_bf16 v[156:159], v[188:191], v[76:79], v[156:159]
  ds_read_b64_tr_b16 v[220:221], v9 offset:45056
  v_mfma_f32_16x16x32_bf16 v[152:155], v[188:191], v[72:75], v[152:155]
  ds_read_b64_tr_b16 v[222:223], v9 offset:47104
  s_waitcnt lgkmcnt(8)
  v_mfma_f32_16x16x32_bf16 v[96:99], v[192:195], v[64:67], v[96:99]
  ds_read_b64_tr_b16 v[160:161], v6 offset:49152
  v_mfma_f32_16x16x32_bf16 v[100:103], v[192:195], v[68:71], v[100:103]
  ds_read_b64_tr_b16 v[162:163], v6 offset:51200
  v_mfma_f32_16x16x32_bf16 v[108:111], v[196:199], v[68:71], v[108:111]
  ds_read_b64_tr_b16 v[164:165], v7 offset:49152
  v_mfma_f32_16x16x32_bf16 v[104:107], v[196:199], v[64:67], v[104:107]
  ds_read_b64_tr_b16 v[166:167], v7 offset:51200
  v_mfma_f32_16x16x32_bf16 v[112:115], v[200:203], v[64:67], v[112:115]
  ds_read_b64_tr_b16 v[168:169], v8 offset:49152
  v_mfma_f32_16x16x32_bf16 v[116:119], v[200:203], v[68:71], v[116:119]
  ds_read_b64_tr_b16 v[170:171], v8 offset:51200
  v_mfma_f32_16x16x32_bf16 v[124:127], v[204:207], v[68:71], v[124:127]
  ds_read_b64_tr_b16 v[172:173], v9 offset:49152
  v_mfma_f32_16x16x32_bf16 v[120:123], v[204:207], v[64:67], v[120:123]
  ds_read_b64_tr_b16 v[174:175], v9 offset:51200
  s_waitcnt lgkmcnt(8)
  v_mfma_f32_16x16x32_bf16 v[96:99], v[208:211], v[72:75], v[96:99]
  ds_read_b64_tr_b16 v[176:177], v6 offset:53248
  v_mfma_f32_16x16x32_bf16 v[100:103], v[208:211], v[76:79], v[100:103]
  ds_read_b64_tr_b16 v[178:179], v6 offset:55296
  v_mfma_f32_16x16x32_bf16 v[108:111], v[212:215], v[76:79], v[108:111]
  ds_read_b64_tr_b16 v[180:181], v7 offset:53248
  v_mfma_f32_16x16x32_bf16 v[104:107], v[212:215], v[72:75], v[104:107]
  ds_read_b64_tr_b16 v[182:183], v7 offset:55296
  v_mfma_f32_16x16x32_bf16 v[112:115], v[216:219], v[72:75], v[112:115]
  ds_read_b64_tr_b16 v[184:185], v8 offset:53248
  v_mfma_f32_16x16x32_bf16 v[116:119], v[216:219], v[76:79], v[116:119]
  ds_read_b64_tr_b16 v[186:187], v8 offset:55296
  v_readlane_b32 s48, v15, 8
  v_mfma_f32_16x16x32_bf16 v[124:127], v[220:223], v[76:79], v[124:127]
  ds_read_b64_tr_b16 v[188:189], v9 offset:53248
  v_mfma_f32_16x16x32_bf16 v[120:123], v[220:223], v[72:75], v[120:123]
  ds_read_b64_tr_b16 v[190:191], v9 offset:55296
  s_waitcnt vmcnt(18) lgkmcnt(8)
  v_mfma_f32_16x16x32_bf16 v[128:131], v[160:163], v[80:83], v[128:131]
  buffer_load_dwordx4 v[64:67], off, s[36:39], s48 offset:0 sc1
  v_mfma_f32_16x16x32_bf16 v[132:135], v[160:163], v[84:87], v[132:135]
  ds_read_b64_tr_b16 v[192:193], v6 offset:57344
  ds_read_b64_tr_b16 v[194:195], v6 offset:59392
  v_mfma_f32_16x16x32_bf16 v[140:143], v[164:167], v[84:87], v[140:143]
  ds_read_b64_tr_b16 v[196:197], v7 offset:57344
  v_mfma_f32_16x16x32_bf16 v[136:139], v[164:167], v[80:83], v[136:139]
  ds_read_b64_tr_b16 v[198:199], v7 offset:59392
  v_mfma_f32_16x16x32_bf16 v[144:147], v[168:171], v[80:83], v[144:147]
  ds_read_b64_tr_b16 v[200:201], v8 offset:57344
  v_mfma_f32_16x16x32_bf16 v[148:151], v[168:171], v[84:87], v[148:151]
  ds_read_b64_tr_b16 v[202:203], v8 offset:59392
  ds_read_b64_tr_b16 v[204:205], v9 offset:57344
  v_mfma_f32_16x16x32_bf16 v[156:159], v[172:175], v[84:87], v[156:159]
  buffer_load_dwordx4 v[68:71], off, s[64:67], s48 offset:0 sc1
  v_mfma_f32_16x16x32_bf16 v[152:155], v[172:175], v[80:83], v[152:155]
  ds_read_b64_tr_b16 v[206:207], v9 offset:59392
  s_waitcnt vmcnt(18) lgkmcnt(8)
  v_mfma_f32_16x16x32_bf16 v[128:131], v[176:179], v[88:91], v[128:131]
  ds_read_b64_tr_b16 v[208:209], v6 offset:61440
  v_mfma_f32_16x16x32_bf16 v[132:135], v[176:179], v[92:95], v[132:135]
  ds_read_b64_tr_b16 v[210:211], v6 offset:63488
  v_mfma_f32_16x16x32_bf16 v[140:143], v[180:183], v[92:95], v[140:143]
  ds_read_b64_tr_b16 v[212:213], v7 offset:61440
  v_mfma_f32_16x16x32_bf16 v[136:139], v[180:183], v[88:91], v[136:139]
  ds_read_b64_tr_b16 v[214:215], v7 offset:63488
  v_mfma_f32_16x16x32_bf16 v[144:147], v[184:187], v[88:91], v[144:147]
  buffer_load_dwordx4 v[72:75], off, s[36:39], s48 offset:1024 sc1
  v_mfma_f32_16x16x32_bf16 v[148:151], v[184:187], v[92:95], v[148:151]
  ds_read_b64_tr_b16 v[216:217], v8 offset:61440
  ds_read_b64_tr_b16 v[218:219], v8 offset:63488
  v_mfma_f32_16x16x32_bf16 v[156:159], v[188:191], v[92:95], v[156:159]
  ds_read_b64_tr_b16 v[220:221], v9 offset:61440
  v_mfma_f32_16x16x32_bf16 v[152:155], v[188:191], v[88:91], v[152:155]
  ds_read_b64_tr_b16 v[222:223], v9 offset:63488
  s_waitcnt lgkmcnt(8)
  v_mfma_f32_16x16x32_bf16 v[96:99], v[192:195], v[80:83], v[96:99]
  ds_read_b64_tr_b16 v[160:161], v20 offset:0
  v_mfma_f32_16x16x32_bf16 v[100:103], v[192:195], v[84:87], v[100:103]
  ds_read_b64_tr_b16 v[162:163], v20 offset:2048
  v_mfma_f32_16x16x32_bf16 v[108:111], v[196:199], v[84:87], v[108:111]
  buffer_load_dwordx4 v[76:79], off, s[64:67], s48 offset:1024 sc1
  v_mfma_f32_16x16x32_bf16 v[104:107], v[196:199], v[80:83], v[104:107]
  ds_read_b64_tr_b16 v[164:165], v21 offset:0
  ds_read_b64_tr_b16 v[166:167], v21 offset:2048
  v_mfma_f32_16x16x32_bf16 v[112:115], v[200:203], v[80:83], v[112:115]
  ds_read_b64_tr_b16 v[168:169], v22 offset:0
  v_mfma_f32_16x16x32_bf16 v[116:119], v[200:203], v[84:87], v[116:119]
  ds_read_b64_tr_b16 v[170:171], v22 offset:2048
  v_mfma_f32_16x16x32_bf16 v[124:127], v[204:207], v[84:87], v[124:127]
  ds_read_b64_tr_b16 v[172:173], v23 offset:0
  v_mfma_f32_16x16x32_bf16 v[120:123], v[204:207], v[80:83], v[120:123]
  ds_read_b64_tr_b16 v[174:175], v23 offset:2048
  s_waitcnt lgkmcnt(8)
  s_barrier
  v_mfma_f32_16x16x32_bf16 v[96:99], v[208:211], v[88:91], v[96:99]
  ds_read_b64_tr_b16 v[176:177], v20 offset:4096
  v_mfma_f32_16x16x32_bf16 v[100:103], v[208:211], v[92:95], v[100:103]
  ds_read_b64_tr_b16 v[178:179], v20 offset:6144
  v_mfma_f32_16x16x32_bf16 v[108:111], v[212:215], v[92:95], v[108:111]
  ds_read_b64_tr_b16 v[180:181], v21 offset:4096
  v_mfma_f32_16x16x32_bf16 v[104:107], v[212:215], v[88:91], v[104:107]
  ds_read_b64_tr_b16 v[182:183], v21 offset:6144
  v_mfma_f32_16x16x32_bf16 v[112:115], v[216:219], v[88:91], v[112:115]
  ds_read_b64_tr_b16 v[184:185], v22 offset:4096
  v_mfma_f32_16x16x32_bf16 v[116:119], v[216:219], v[92:95], v[116:119]
  ds_read_b64_tr_b16 v[186:187], v22 offset:6144
  v_readlane_b32 s49, v15, 9
  v_mfma_f32_16x16x32_bf16 v[124:127], v[220:223], v[92:95], v[124:127]
  ds_read_b64_tr_b16 v[188:189], v23 offset:4096
  v_mfma_f32_16x16x32_bf16 v[120:123], v[220:223], v[88:91], v[120:123]
  ds_read_b64_tr_b16 v[190:191], v23 offset:6144
  s_waitcnt vmcnt(18) lgkmcnt(8)
  v_mfma_f32_16x16x32_bf16 v[128:131], v[160:163], v[224:227], v[128:131]
  buffer_load_dwordx4 v[80:83], off, s[36:39], s49 offset:0 sc1
  v_mfma_f32_16x16x32_bf16 v[132:135], v[160:163], v[228:231], v[132:135]
  ds_read_b64_tr_b16 v[192:193], v20 offset:8192
  ds_read_b64_tr_b16 v[194:195], v20 offset:10240
  v_mfma_f32_16x16x32_bf16 v[140:143], v[164:167], v[228:231], v[140:143]
  ds_read_b64_tr_b16 v[196:197], v21 offset:8192
  v_mfma_f32_16x16x32_bf16 v[136:139], v[164:167], v[224:227], v[136:139]
  ds_read_b64_tr_b16 v[198:199], v21 offset:10240
  v_mfma_f32_16x16x32_bf16 v[144:147], v[168:171], v[224:227], v[144:147]
  ds_read_b64_tr_b16 v[200:201], v22 offset:8192
  v_mfma_f32_16x16x32_bf16 v[148:151], v[168:171], v[228:231], v[148:151]
  ds_read_b64_tr_b16 v[202:203], v22 offset:10240
  ds_read_b64_tr_b16 v[204:205], v23 offset:8192
  v_mfma_f32_16x16x32_bf16 v[156:159], v[172:175], v[228:231], v[156:159]
  buffer_load_dwordx4 v[84:87], off, s[64:67], s49 offset:0 sc1
  v_mfma_f32_16x16x32_bf16 v[152:155], v[172:175], v[224:227], v[152:155]
  ds_read_b64_tr_b16 v[206:207], v23 offset:10240
  s_waitcnt vmcnt(18) lgkmcnt(8)
  v_mfma_f32_16x16x32_bf16 v[128:131], v[176:179], v[232:235], v[128:131]
  ds_read_b64_tr_b16 v[208:209], v20 offset:12288
  v_mfma_f32_16x16x32_bf16 v[132:135], v[176:179], v[236:239], v[132:135]
  ds_read_b64_tr_b16 v[210:211], v20 offset:14336
  v_mfma_f32_16x16x32_bf16 v[140:143], v[180:183], v[236:239], v[140:143]
  ds_read_b64_tr_b16 v[212:213], v21 offset:12288
  v_mfma_f32_16x16x32_bf16 v[136:139], v[180:183], v[232:235], v[136:139]
  ds_read_b64_tr_b16 v[214:215], v21 offset:14336
  v_mfma_f32_16x16x32_bf16 v[144:147], v[184:187], v[232:235], v[144:147]
  buffer_load_dwordx4 v[88:91], off, s[36:39], s49 offset:1024 sc1
  v_mfma_f32_16x16x32_bf16 v[148:151], v[184:187], v[236:239], v[148:151]
  ds_read_b64_tr_b16 v[216:217], v22 offset:12288
  ds_read_b64_tr_b16 v[218:219], v22 offset:14336
  v_mfma_f32_16x16x32_bf16 v[156:159], v[188:191], v[236:239], v[156:159]
  ds_read_b64_tr_b16 v[220:221], v23 offset:12288
  v_mfma_f32_16x16x32_bf16 v[152:155], v[188:191], v[232:235], v[152:155]
  ds_read_b64_tr_b16 v[222:223], v23 offset:14336
  s_waitcnt lgkmcnt(8)
  v_mfma_f32_16x16x32_bf16 v[96:99], v[192:195], v[224:227], v[96:99]
  ds_read_b64_tr_b16 v[160:161], v20 offset:16384
  v_mfma_f32_16x16x32_bf16 v[100:103], v[192:195], v[228:231], v[100:103]
  ds_read_b64_tr_b16 v[162:163], v20 offset:18432
  v_mfma_f32_16x16x32_bf16 v[108:111], v[196:199], v[228:231], v[108:111]
  buffer_load_dwordx4 v[92:95], off, s[64:67], s49 offset:1024 sc1
  v_mfma_f32_16x16x32_bf16 v[104:107], v[196:199], v[224:227], v[104:107]
  ds_read_b64_tr_b16 v[164:165], v21 offset:16384
  ds_read_b64_tr_b16 v[166:167], v21 offset:18432
  v_mfma_f32_16x16x32_bf16 v[112:115], v[200:203], v[224:227], v[112:115]
  ds_read_b64_tr_b16 v[168:169], v22 offset:16384
  v_mfma_f32_16x16x32_bf16 v[116:119], v[200:203], v[228:231], v[116:119]
  ds_read_b64_tr_b16 v[170:171], v22 offset:18432
  v_mfma_f32_16x16x32_bf16 v[124:127], v[204:207], v[228:231], v[124:127]
  ds_read_b64_tr_b16 v[172:173], v23 offset:16384
  v_mfma_f32_16x16x32_bf16 v[120:123], v[204:207], v[224:227], v[120:123]
  ds_read_b64_tr_b16 v[174:175], v23 offset:18432
  s_waitcnt lgkmcnt(8)
  v_mfma_f32_16x16x32_bf16 v[96:99], v[208:211], v[232:235], v[96:99]
  ds_read_b64_tr_b16 v[176:177], v20 offset:20480
  v_mfma_f32_16x16x32_bf16 v[100:103], v[208:211], v[236:239], v[100:103]
  ds_read_b64_tr_b16 v[178:179], v20 offset:22528
  v_mfma_f32_16x16x32_bf16 v[108:111], v[212:215], v[236:239], v[108:111]
  ds_read_b64_tr_b16 v[180:181], v21 offset:20480
  v_mfma_f32_16x16x32_bf16 v[104:107], v[212:215], v[232:235], v[104:107]
  ds_read_b64_tr_b16 v[182:183], v21 offset:22528
  v_mfma_f32_16x16x32_bf16 v[112:115], v[216:219], v[232:235], v[112:115]
  ds_read_b64_tr_b16 v[184:185], v22 offset:20480
  v_mfma_f32_16x16x32_bf16 v[116:119], v[216:219], v[236:239], v[116:119]
  ds_read_b64_tr_b16 v[186:187], v22 offset:22528
  v_readlane_b32 s50, v15, 10
  v_mfma_f32_16x16x32_bf16 v[124:127], v[220:223], v[236:239], v[124:127]
  ds_read_b64_tr_b16 v[188:189], v23 offset:20480
  v_mfma_f32_16x16x32_bf16 v[120:123], v[220:223], v[232:235], v[120:123]
  ds_read_b64_tr_b16 v[190:191], v23 offset:22528
  s_waitcnt vmcnt(18) lgkmcnt(8)
  v_mfma_f32_16x16x32_bf16 v[128:131], v[160:163], v[240:243], v[128:131]
  buffer_load_dwordx4 v[224:227], off, s[36:39], s50 offset:0 sc1
  v_mfma_f32_16x16x32_bf16 v[132:135], v[160:163], v[244:247], v[132:135]
  ds_read_b64_tr_b16 v[192:193], v20 offset:24576
  ds_read_b64_tr_b16 v[194:195], v20 offset:26624
  v_mfma_f32_16x16x32_bf16 v[140:143], v[164:167], v[244:247], v[140:143]
  ds_read_b64_tr_b16 v[196:197], v21 offset:24576
  v_mfma_f32_16x16x32_bf16 v[136:139], v[164:167], v[240:243], v[136:139]
  ds_read_b64_tr_b16 v[198:199], v21 offset:26624
  v_mfma_f32_16x16x32_bf16 v[144:147], v[168:171], v[240:243], v[144:147]
  ds_read_b64_tr_b16 v[200:201], v22 offset:24576
  v_mfma_f32_16x16x32_bf16 v[148:151], v[168:171], v[244:247], v[148:151]
  ds_read_b64_tr_b16 v[202:203], v22 offset:26624
  ds_read_b64_tr_b16 v[204:205], v23 offset:24576
  v_mfma_f32_16x16x32_bf16 v[156:159], v[172:175], v[244:247], v[156:159]
  buffer_load_dwordx4 v[228:231], off, s[64:67], s50 offset:0 sc1
  v_mfma_f32_16x16x32_bf16 v[152:155], v[172:175], v[240:243], v[152:155]
  ds_read_b64_tr_b16 v[206:207], v23 offset:26624
  s_waitcnt vmcnt(18) lgkmcnt(8)
  v_mfma_f32_16x16x32_bf16 v[128:131], v[176:179], v[248:251], v[128:131]
  ds_read_b64_tr_b16 v[208:209], v20 offset:28672
  v_mfma_f32_16x16x32_bf16 v[132:135], v[176:179], v[252:255], v[132:135]
  ds_read_b64_tr_b16 v[210:211], v20 offset:30720
  v_mfma_f32_16x16x32_bf16 v[140:143], v[180:183], v[252:255], v[140:143]
  ds_read_b64_tr_b16 v[212:213], v21 offset:28672
  v_mfma_f32_16x16x32_bf16 v[136:139], v[180:183], v[248:251], v[136:139]
  ds_read_b64_tr_b16 v[214:215], v21 offset:30720
  v_mfma_f32_16x16x32_bf16 v[144:147], v[184:187], v[248:251], v[144:147]
  buffer_load_dwordx4 v[232:235], off, s[36:39], s50 offset:1024 sc1
  v_mfma_f32_16x16x32_bf16 v[148:151], v[184:187], v[252:255], v[148:151]
  ds_read_b64_tr_b16 v[216:217], v22 offset:28672
  ds_read_b64_tr_b16 v[218:219], v22 offset:30720
  v_mfma_f32_16x16x32_bf16 v[156:159], v[188:191], v[252:255], v[156:159]
  ds_read_b64_tr_b16 v[220:221], v23 offset:28672
  v_mfma_f32_16x16x32_bf16 v[152:155], v[188:191], v[248:251], v[152:155]
  ds_read_b64_tr_b16 v[222:223], v23 offset:30720
  s_waitcnt lgkmcnt(8)
  v_mfma_f32_16x16x32_bf16 v[96:99], v[192:195], v[240:243], v[96:99]
  ds_read_b64_tr_b16 v[160:161], v20 offset:32768
  v_mfma_f32_16x16x32_bf16 v[100:103], v[192:195], v[244:247], v[100:103]
  ds_read_b64_tr_b16 v[162:163], v20 offset:34816
  v_mfma_f32_16x16x32_bf16 v[108:111], v[196:199], v[244:247], v[108:111]
  buffer_load_dwordx4 v[236:239], off, s[64:67], s50 offset:1024 sc1
  v_mfma_f32_16x16x32_bf16 v[104:107], v[196:199], v[240:243], v[104:107]
  ds_read_b64_tr_b16 v[164:165], v21 offset:32768
  ds_read_b64_tr_b16 v[166:167], v21 offset:34816
  v_mfma_f32_16x16x32_bf16 v[112:115], v[200:203], v[240:243], v[112:115]
  ds_read_b64_tr_b16 v[168:169], v22 offset:32768
  v_mfma_f32_16x16x32_bf16 v[116:119], v[200:203], v[244:247], v[116:119]
  ds_read_b64_tr_b16 v[170:171], v22 offset:34816
  v_mfma_f32_16x16x32_bf16 v[124:127], v[204:207], v[244:247], v[124:127]
  ds_read_b64_tr_b16 v[172:173], v23 offset:32768
  v_mfma_f32_16x16x32_bf16 v[120:123], v[204:207], v[240:243], v[120:123]
  ds_read_b64_tr_b16 v[174:175], v23 offset:34816
  s_waitcnt lgkmcnt(8)
  s_barrier
  v_mfma_f32_16x16x32_bf16 v[96:99], v[208:211], v[248:251], v[96:99]
  ds_read_b64_tr_b16 v[176:177], v20 offset:36864
  v_mfma_f32_16x16x32_bf16 v[100:103], v[208:211], v[252:255], v[100:103]
  ds_read_b64_tr_b16 v[178:179], v20 offset:38912
  v_mfma_f32_16x16x32_bf16 v[108:111], v[212:215], v[252:255], v[108:111]
  ds_read_b64_tr_b16 v[180:181], v21 offset:36864
  v_mfma_f32_16x16x32_bf16 v[104:107], v[212:215], v[248:251], v[104:107]
  ds_read_b64_tr_b16 v[182:183], v21 offset:38912
  v_mfma_f32_16x16x32_bf16 v[112:115], v[216:219], v[248:251], v[112:115]
  ds_read_b64_tr_b16 v[184:185], v22 offset:36864
  v_mfma_f32_16x16x32_bf16 v[116:119], v[216:219], v[252:255], v[116:119]
  ds_read_b64_tr_b16 v[186:187], v22 offset:38912
  v_readlane_b32 s51, v15, 11
  v_mfma_f32_16x16x32_bf16 v[124:127], v[220:223], v[252:255], v[124:127]
  ds_read_b64_tr_b16 v[188:189], v23 offset:36864
  v_mfma_f32_16x16x32_bf16 v[120:123], v[220:223], v[248:251], v[120:123]
  ds_read_b64_tr_b16 v[190:191], v23 offset:38912
  s_waitcnt vmcnt(18) lgkmcnt(8)
  v_mfma_f32_16x16x32_bf16 v[128:131], v[160:163], v[32:35], v[128:131]
  buffer_load_dwordx4 v[240:243], off, s[36:39], s51 offset:0 sc1
  v_mfma_f32_16x16x32_bf16 v[132:135], v[160:163], v[36:39], v[132:135]
  ds_read_b64_tr_b16 v[192:193], v20 offset:40960
  ds_read_b64_tr_b16 v[194:195], v20 offset:43008
  v_mfma_f32_16x16x32_bf16 v[140:143], v[164:167], v[36:39], v[140:143]
  ds_read_b64_tr_b16 v[196:197], v21 offset:40960
  v_mfma_f32_16x16x32_bf16 v[136:139], v[164:167], v[32:35], v[136:139]
  ds_read_b64_tr_b16 v[198:199], v21 offset:43008
  v_mfma_f32_16x16x32_bf16 v[144:147], v[168:171], v[32:35], v[144:147]
  ds_read_b64_tr_b16 v[200:201], v22 offset:40960
  v_mfma_f32_16x16x32_bf16 v[148:151], v[168:171], v[36:39], v[148:151]
  ds_read_b64_tr_b16 v[202:203], v22 offset:43008
  ds_read_b64_tr_b16 v[204:205], v23 offset:40960
  v_mfma_f32_16x16x32_bf16 v[156:159], v[172:175], v[36:39], v[156:159]
  buffer_load_dwordx4 v[244:247], off, s[64:67], s51 offset:0 sc1
  v_mfma_f32_16x16x32_bf16 v[152:155], v[172:175], v[32:35], v[152:155]
  ds_read_b64_tr_b16 v[206:207], v23 offset:43008
  s_waitcnt vmcnt(18) lgkmcnt(8)
  v_mfma_f32_16x16x32_bf16 v[128:131], v[176:179], v[40:43], v[128:131]
  ds_read_b64_tr_b16 v[208:209], v20 offset:45056
  v_mfma_f32_16x16x32_bf16 v[132:135], v[176:179], v[44:47], v[132:135]
  ds_read_b64_tr_b16 v[210:211], v20 offset:47104
  v_mfma_f32_16x16x32_bf16 v[140:143], v[180:183], v[44:47], v[140:143]
  ds_read_b64_tr_b16 v[212:213], v21 offset:45056
  v_mfma_f32_16x16x32_bf16 v[136:139], v[180:183], v[40:43], v[136:139]
  ds_read_b64_tr_b16 v[214:215], v21 offset:47104
  v_mfma_f32_16x16x32_bf16 v[144:147], v[184:187], v[40:43], v[144:147]
  buffer_load_dwordx4 v[248:251], off, s[36:39], s51 offset:1024 sc1
  v_mfma_f32_16x16x32_bf16 v[148:151], v[184:187], v[44:47], v[148:151]
  ds_read_b64_tr_b16 v[216:217], v22 offset:45056
  ds_read_b64_tr_b16 v[218:219], v22 offset:47104
  v_mfma_f32_16x16x32_bf16 v[156:159], v[188:191], v[44:47], v[156:159]
  ds_read_b64_tr_b16 v[220:221], v23 offset:45056
  v_mfma_f32_16x16x32_bf16 v[152:155], v[188:191], v[40:43], v[152:155]
  ds_read_b64_tr_b16 v[222:223], v23 offset:47104
  s_waitcnt lgkmcnt(8)
  v_mfma_f32_16x16x32_bf16 v[96:99], v[192:195], v[32:35], v[96:99]
  ds_read_b64_tr_b16 v[160:161], v20 offset:49152
  v_mfma_f32_16x16x32_bf16 v[100:103], v[192:195], v[36:39], v[100:103]
  ds_read_b64_tr_b16 v[162:163], v20 offset:51200
  v_mfma_f32_16x16x32_bf16 v[108:111], v[196:199], v[36:39], v[108:111]
  buffer_load_dwordx4 v[252:255], off, s[64:67], s51 offset:1024 sc1
  v_mfma_f32_16x16x32_bf16 v[104:107], v[196:199], v[32:35], v[104:107]
  ds_read_b64_tr_b16 v[164:165], v21 offset:49152
  ds_read_b64_tr_b16 v[166:167], v21 offset:51200
  v_mfma_f32_16x16x32_bf16 v[112:115], v[200:203], v[32:35], v[112:115]
  ds_read_b64_tr_b16 v[168:169], v22 offset:49152
  v_mfma_f32_16x16x32_bf16 v[116:119], v[200:203], v[36:39], v[116:119]
  ds_read_b64_tr_b16 v[170:171], v22 offset:51200
  v_mfma_f32_16x16x32_bf16 v[124:127], v[204:207], v[36:39], v[124:127]
  ds_read_b64_tr_b16 v[172:173], v23 offset:49152
  v_mfma_f32_16x16x32_bf16 v[120:123], v[204:207], v[32:35], v[120:123]
  ds_read_b64_tr_b16 v[174:175], v23 offset:51200
  s_waitcnt lgkmcnt(8)
  v_mfma_f32_16x16x32_bf16 v[96:99], v[208:211], v[40:43], v[96:99]
  ds_read_b64_tr_b16 v[176:177], v20 offset:53248
  v_mfma_f32_16x16x32_bf16 v[100:103], v[208:211], v[44:47], v[100:103]
  ds_read_b64_tr_b16 v[178:179], v20 offset:55296
  v_mfma_f32_16x16x32_bf16 v[108:111], v[212:215], v[44:47], v[108:111]
  ds_read_b64_tr_b16 v[180:181], v21 offset:53248
  v_mfma_f32_16x16x32_bf16 v[104:107], v[212:215], v[40:43], v[104:107]
  ds_read_b64_tr_b16 v[182:183], v21 offset:55296
  v_mfma_f32_16x16x32_bf16 v[112:115], v[216:219], v[40:43], v[112:115]
  ds_read_b64_tr_b16 v[184:185], v22 offset:53248
  v_mfma_f32_16x16x32_bf16 v[116:119], v[216:219], v[44:47], v[116:119]
  ds_read_b64_tr_b16 v[186:187], v22 offset:55296
  v_readlane_b32 s48, v15, 12
  v_mfma_f32_16x16x32_bf16 v[124:127], v[220:223], v[44:47], v[124:127]
  ds_read_b64_tr_b16 v[188:189], v23 offset:53248
  v_mfma_f32_16x16x32_bf16 v[120:123], v[220:223], v[40:43], v[120:123]
  ds_read_b64_tr_b16 v[190:191], v23 offset:55296
  s_waitcnt vmcnt(18) lgkmcnt(8)
  v_mfma_f32_16x16x32_bf16 v[128:131], v[160:163], v[48:51], v[128:131]
  buffer_load_dwordx4 v[32:35], off, s[36:39], s48 offset:0 sc1
  v_mfma_f32_16x16x32_bf16 v[132:135], v[160:163], v[52:55], v[132:135]
  ds_read_b64_tr_b16 v[192:193], v20 offset:57344
  ds_read_b64_tr_b16 v[194:195], v20 offset:59392
  v_mfma_f32_16x16x32_bf16 v[140:143], v[164:167], v[52:55], v[140:143]
  ds_read_b64_tr_b16 v[196:197], v21 offset:57344
  v_mfma_f32_16x16x32_bf16 v[136:139], v[164:167], v[48:51], v[136:139]
  ds_read_b64_tr_b16 v[198:199], v21 offset:59392
  v_mfma_f32_16x16x32_bf16 v[144:147], v[168:171], v[48:51], v[144:147]
  ds_read_b64_tr_b16 v[200:201], v22 offset:57344
  v_mfma_f32_16x16x32_bf16 v[148:151], v[168:171], v[52:55], v[148:151]
  ds_read_b64_tr_b16 v[202:203], v22 offset:59392
  ds_read_b64_tr_b16 v[204:205], v23 offset:57344
  v_mfma_f32_16x16x32_bf16 v[156:159], v[172:175], v[52:55], v[156:159]
  buffer_load_dwordx4 v[36:39], off, s[64:67], s48 offset:0 sc1
  v_mfma_f32_16x16x32_bf16 v[152:155], v[172:175], v[48:51], v[152:155]
  ds_read_b64_tr_b16 v[206:207], v23 offset:59392
  s_waitcnt vmcnt(18) lgkmcnt(8)
  v_mfma_f32_16x16x32_bf16 v[128:131], v[176:179], v[56:59], v[128:131]
  ds_read_b64_tr_b16 v[208:209], v20 offset:61440
  v_mfma_f32_16x16x32_bf16 v[132:135], v[176:179], v[60:63], v[132:135]
  ds_read_b64_tr_b16 v[210:211], v20 offset:63488
  v_mfma_f32_16x16x32_bf16 v[140:143], v[180:183], v[60:63], v[140:143]
  ds_read_b64_tr_b16 v[212:213], v21 offset:61440
  v_mfma_f32_16x16x32_bf16 v[136:139], v[180:183], v[56:59], v[136:139]
  ds_read_b64_tr_b16 v[214:215], v21 offset:63488
  v_mfma_f32_16x16x32_bf16 v[144:147], v[184:187], v[56:59], v[144:147]
  buffer_load_dwordx4 v[40:43], off, s[36:39], s48 offset:1024 sc1
  v_mfma_f32_16x16x32_bf16 v[148:151], v[184:187], v[60:63], v[148:151]
  ds_read_b64_tr_b16 v[216:217], v22 offset:61440
  ds_read_b64_tr_b16 v[218:219], v22 offset:63488
  v_mfma_f32_16x16x32_bf16 v[156:159], v[188:191], v[60:63], v[156:159]
  ds_read_b64_tr_b16 v[220:221], v23 offset:61440
  v_mfma_f32_16x16x32_bf16 v[152:155], v[188:191], v[56:59], v[152:155]
  ds_read_b64_tr_b16 v[222:223], v23 offset:63488
  s_waitcnt lgkmcnt(8)
  v_mfma_f32_16x16x32_bf16 v[96:99], v[192:195], v[48:51], v[96:99]
  ds_read_b64_tr_b16 v[160:161], v26 offset:0
  v_mfma_f32_16x16x32_bf16 v[100:103], v[192:195], v[52:55], v[100:103]
  ds_read_b64_tr_b16 v[162:163], v26 offset:2048
  v_mfma_f32_16x16x32_bf16 v[108:111], v[196:199], v[52:55], v[108:111]
  buffer_load_dwordx4 v[44:47], off, s[64:67], s48 offset:1024 sc1
  v_mfma_f32_16x16x32_bf16 v[104:107], v[196:199], v[48:51], v[104:107]
  ds_read_b64_tr_b16 v[164:165], v27 offset:0
  ds_read_b64_tr_b16 v[166:167], v27 offset:2048
  v_mfma_f32_16x16x32_bf16 v[112:115], v[200:203], v[48:51], v[112:115]
  ds_read_b64_tr_b16 v[168:169], v28 offset:0
  v_mfma_f32_16x16x32_bf16 v[116:119], v[200:203], v[52:55], v[116:119]
  ds_read_b64_tr_b16 v[170:171], v28 offset:2048
  v_mfma_f32_16x16x32_bf16 v[124:127], v[204:207], v[52:55], v[124:127]
  ds_read_b64_tr_b16 v[172:173], v29 offset:0
  v_mfma_f32_16x16x32_bf16 v[120:123], v[204:207], v[48:51], v[120:123]
  ds_read_b64_tr_b16 v[174:175], v29 offset:2048
  s_waitcnt lgkmcnt(8)
  s_barrier
  v_mfma_f32_16x16x32_bf16 v[96:99], v[208:211], v[56:59], v[96:99]
  ds_read_b64_tr_b16 v[176:177], v26 offset:4096
  v_mfma_f32_16x16x32_bf16 v[100:103], v[208:211], v[60:63], v[100:103]
  ds_read_b64_tr_b16 v[178:179], v26 offset:6144
  v_mfma_f32_16x16x32_bf16 v[108:111], v[212:215], v[60:63], v[108:111]
  ds_read_b64_tr_b16 v[180:181], v27 offset:4096
  v_mfma_f32_16x16x32_bf16 v[104:107], v[212:215], v[56:59], v[104:107]
  ds_read_b64_tr_b16 v[182:183], v27 offset:6144
  v_mfma_f32_16x16x32_bf16 v[112:115], v[216:219], v[56:59], v[112:115]
  ds_read_b64_tr_b16 v[184:185], v28 offset:4096
  v_mfma_f32_16x16x32_bf16 v[116:119], v[216:219], v[60:63], v[116:119]
  ds_read_b64_tr_b16 v[186:187], v28 offset:6144
  v_readlane_b32 s49, v15, 13
  v_mfma_f32_16x16x32_bf16 v[124:127], v[220:223], v[60:63], v[124:127]
  ds_read_b64_tr_b16 v[188:189], v29 offset:4096
  v_mfma_f32_16x16x32_bf16 v[120:123], v[220:223], v[56:59], v[120:123]
  ds_read_b64_tr_b16 v[190:191], v29 offset:6144
  s_waitcnt vmcnt(18) lgkmcnt(8)
  v_mfma_f32_16x16x32_bf16 v[128:131], v[160:163], v[64:67], v[128:131]
  buffer_load_dwordx4 v[48:51], off, s[36:39], s49 offset:0 sc1
  v_mfma_f32_16x16x32_bf16 v[132:135], v[160:163], v[68:71], v[132:135]
  ds_read_b64_tr_b16 v[192:193], v26 offset:8192
  ds_read_b64_tr_b16 v[194:195], v26 offset:10240
  v_mfma_f32_16x16x32_bf16 v[140:143], v[164:167], v[68:71], v[140:143]
  ds_read_b64_tr_b16 v[196:197], v27 offset:8192
  v_mfma_f32_16x16x32_bf16 v[136:139], v[164:167], v[64:67], v[136:139]
  ds_read_b64_tr_b16 v[198:199], v27 offset:10240
  v_mfma_f32_16x16x32_bf16 v[144:147], v[168:171], v[64:67], v[144:147]
  ds_read_b64_tr_b16 v[200:201], v28 offset:8192
  v_mfma_f32_16x16x32_bf16 v[148:151], v[168:171], v[68:71], v[148:151]
  ds_read_b64_tr_b16 v[202:203], v28 offset:10240
  ds_read_b64_tr_b16 v[204:205], v29 offset:8192
  v_mfma_f32_16x16x32_bf16 v[156:159], v[172:175], v[68:71], v[156:159]
  buffer_load_dwordx4 v[52:55], off, s[64:67], s49 offset:0 sc1
  v_mfma_f32_16x16x32_bf16 v[152:155], v[172:175], v[64:67], v[152:155]
  ds_read_b64_tr_b16 v[206:207], v29 offset:10240
  s_waitcnt vmcnt(18) lgkmcnt(8)
  v_mfma_f32_16x16x32_bf16 v[128:131], v[176:179], v[72:75], v[128:131]
  ds_read_b64_tr_b16 v[208:209], v26 offset:12288
  v_mfma_f32_16x16x32_bf16 v[132:135], v[176:179], v[76:79], v[132:135]
  ds_read_b64_tr_b16 v[210:211], v26 offset:14336
  v_mfma_f32_16x16x32_bf16 v[140:143], v[180:183], v[76:79], v[140:143]
  ds_read_b64_tr_b16 v[212:213], v27 offset:12288
  v_mfma_f32_16x16x32_bf16 v[136:139], v[180:183], v[72:75], v[136:139]
  ds_read_b64_tr_b16 v[214:215], v27 offset:14336
  v_mfma_f32_16x16x32_bf16 v[144:147], v[184:187], v[72:75], v[144:147]
  buffer_load_dwordx4 v[56:59], off, s[36:39], s49 offset:1024 sc1
  v_mfma_f32_16x16x32_bf16 v[148:151], v[184:187], v[76:79], v[148:151]
  ds_read_b64_tr_b16 v[216:217], v28 offset:12288
  ds_read_b64_tr_b16 v[218:219], v28 offset:14336
  v_mfma_f32_16x16x32_bf16 v[156:159], v[188:191], v[76:79], v[156:159]
  ds_read_b64_tr_b16 v[220:221], v29 offset:12288
  v_mfma_f32_16x16x32_bf16 v[152:155], v[188:191], v[72:75], v[152:155]
  ds_read_b64_tr_b16 v[222:223], v29 offset:14336
  s_waitcnt lgkmcnt(8)
  v_mfma_f32_16x16x32_bf16 v[96:99], v[192:195], v[64:67], v[96:99]
  ds_read_b64_tr_b16 v[160:161], v26 offset:16384
  v_mfma_f32_16x16x32_bf16 v[100:103], v[192:195], v[68:71], v[100:103]
  ds_read_b64_tr_b16 v[162:163], v26 offset:18432
  v_mfma_f32_16x16x32_bf16 v[108:111], v[196:199], v[68:71], v[108:111]
  buffer_load_dwordx4 v[60:63], off, s[64:67], s49 offset:1024 sc1
  v_mfma_f32_16x16x32_bf16 v[104:107], v[196:199], v[64:67], v[104:107]
  ds_read_b64_tr_b16 v[164:165], v27 offset:16384
  ds_read_b64_tr_b16 v[166:167], v27 offset:18432
  v_mfma_f32_16x16x32_bf16 v[112:115], v[200:203], v[64:67], v[112:115]
  ds_read_b64_tr_b16 v[168:169], v28 offset:16384
  v_mfma_f32_16x16x32_bf16 v[116:119], v[200:203], v[68:71], v[116:119]
  ds_read_b64_tr_b16 v[170:171], v28 offset:18432
  v_mfma_f32_16x16x32_bf16 v[124:127], v[204:207], v[68:71], v[124:127]
  ds_read_b64_tr_b16 v[172:173], v29 offset:16384
  v_mfma_f32_16x16x32_bf16 v[120:123], v[204:207], v[64:67], v[120:123]
  ds_read_b64_tr_b16 v[174:175], v29 offset:18432
  s_waitcnt lgkmcnt(8)
  v_mfma_f32_16x16x32_bf16 v[96:99], v[208:211], v[72:75], v[96:99]
  ds_read_b64_tr_b16 v[176:177], v26 offset:20480
  v_mfma_f32_16x16x32_bf16 v[100:103], v[208:211], v[76:79], v[100:103]
  ds_read_b64_tr_b16 v[178:179], v26 offset:22528
  v_mfma_f32_16x16x32_bf16 v[108:111], v[212:215], v[76:79], v[108:111]
  ds_read_b64_tr_b16 v[180:181], v27 offset:20480
  v_mfma_f32_16x16x32_bf16 v[104:107], v[212:215], v[72:75], v[104:107]
  ds_read_b64_tr_b16 v[182:183], v27 offset:22528
  v_mfma_f32_16x16x32_bf16 v[112:115], v[216:219], v[72:75], v[112:115]
  ds_read_b64_tr_b16 v[184:185], v28 offset:20480
  v_mfma_f32_16x16x32_bf16 v[116:119], v[216:219], v[76:79], v[116:119]
  ds_read_b64_tr_b16 v[186:187], v28 offset:22528
  v_readlane_b32 s50, v15, 14
  v_mfma_f32_16x16x32_bf16 v[124:127], v[220:223], v[76:79], v[124:127]
  ds_read_b64_tr_b16 v[188:189], v29 offset:20480
  v_mfma_f32_16x16x32_bf16 v[120:123], v[220:223], v[72:75], v[120:123]
  ds_read_b64_tr_b16 v[190:191], v29 offset:22528
  s_waitcnt vmcnt(18) lgkmcnt(8)
  v_mfma_f32_16x16x32_bf16 v[128:131], v[160:163], v[80:83], v[128:131]
  buffer_load_dwordx4 v[64:67], off, s[36:39], s50 offset:0 sc1
  v_mfma_f32_16x16x32_bf16 v[132:135], v[160:163], v[84:87], v[132:135]
  ds_read_b64_tr_b16 v[192:193], v26 offset:24576
  ds_read_b64_tr_b16 v[194:195], v26 offset:26624
  v_mfma_f32_16x16x32_bf16 v[140:143], v[164:167], v[84:87], v[140:143]
  ds_read_b64_tr_b16 v[196:197], v27 offset:24576
  v_mfma_f32_16x16x32_bf16 v[136:139], v[164:167], v[80:83], v[136:139]
  ds_read_b64_tr_b16 v[198:199], v27 offset:26624
  v_mfma_f32_16x16x32_bf16 v[144:147], v[168:171], v[80:83], v[144:147]
  ds_read_b64_tr_b16 v[200:201], v28 offset:24576
  v_mfma_f32_16x16x32_bf16 v[148:151], v[168:171], v[84:87], v[148:151]
  ds_read_b64_tr_b16 v[202:203], v28 offset:26624
  ds_read_b64_tr_b16 v[204:205], v29 offset:24576
  v_mfma_f32_16x16x32_bf16 v[156:159], v[172:175], v[84:87], v[156:159]
  buffer_load_dwordx4 v[68:71], off, s[64:67], s50 offset:0 sc1
  v_mfma_f32_16x16x32_bf16 v[152:155], v[172:175], v[80:83], v[152:155]
  ds_read_b64_tr_b16 v[206:207], v29 offset:26624
  s_waitcnt vmcnt(18) lgkmcnt(8)
  v_mfma_f32_16x16x32_bf16 v[128:131], v[176:179], v[88:91], v[128:131]
  ds_read_b64_tr_b16 v[208:209], v26 offset:28672
  v_mfma_f32_16x16x32_bf16 v[132:135], v[176:179], v[92:95], v[132:135]
  ds_read_b64_tr_b16 v[210:211], v26 offset:30720
  v_mfma_f32_16x16x32_bf16 v[140:143], v[180:183], v[92:95], v[140:143]
  ds_read_b64_tr_b16 v[212:213], v27 offset:28672
  v_mfma_f32_16x16x32_bf16 v[136:139], v[180:183], v[88:91], v[136:139]
  ds_read_b64_tr_b16 v[214:215], v27 offset:30720
  v_mfma_f32_16x16x32_bf16 v[144:147], v[184:187], v[88:91], v[144:147]
  buffer_load_dwordx4 v[72:75], off, s[36:39], s50 offset:1024 sc1
  v_mfma_f32_16x16x32_bf16 v[148:151], v[184:187], v[92:95], v[148:151]
  ds_read_b64_tr_b16 v[216:217], v28 offset:28672
  ds_read_b64_tr_b16 v[218:219], v28 offset:30720
  v_mfma_f32_16x16x32_bf16 v[156:159], v[188:191], v[92:95], v[156:159]
  ds_read_b64_tr_b16 v[220:221], v29 offset:28672
  v_mfma_f32_16x16x32_bf16 v[152:155], v[188:191], v[88:91], v[152:155]
  ds_read_b64_tr_b16 v[222:223], v29 offset:30720
  s_waitcnt lgkmcnt(8)
  v_mfma_f32_16x16x32_bf16 v[96:99], v[192:195], v[80:83], v[96:99]
  ds_read_b64_tr_b16 v[160:161], v6 offset:0
  v_mfma_f32_16x16x32_bf16 v[100:103], v[192:195], v[84:87], v[100:103]
  ds_read_b64_tr_b16 v[162:163], v6 offset:2048
  v_mfma_f32_16x16x32_bf16 v[108:111], v[196:199], v[84:87], v[108:111]
  buffer_load_dwordx4 v[76:79], off, s[64:67], s50 offset:1024 sc1
  v_mfma_f32_16x16x32_bf16 v[104:107], v[196:199], v[80:83], v[104:107]
  ds_read_b64_tr_b16 v[164:165], v7 offset:0
  ds_read_b64_tr_b16 v[166:167], v7 offset:2048
  v_mfma_f32_16x16x32_bf16 v[112:115], v[200:203], v[80:83], v[112:115]
  ds_read_b64_tr_b16 v[168:169], v8 offset:0
  v_mfma_f32_16x16x32_bf16 v[116:119], v[200:203], v[84:87], v[116:119]
  ds_read_b64_tr_b16 v[170:171], v8 offset:2048
  v_mfma_f32_16x16x32_bf16 v[124:127], v[204:207], v[84:87], v[124:127]
  ds_read_b64_tr_b16 v[172:173], v9 offset:0
  v_mfma_f32_16x16x32_bf16 v[120:123], v[204:207], v[80:83], v[120:123]
  ds_read_b64_tr_b16 v[174:175], v9 offset:2048
  s_waitcnt lgkmcnt(8)
  s_barrier
  v_mfma_f32_16x16x32_bf16 v[96:99], v[208:211], v[88:91], v[96:99]
  ds_read_b64_tr_b16 v[176:177], v6 offset:4096
  v_mfma_f32_16x16x32_bf16 v[100:103], v[208:211], v[92:95], v[100:103]
  ds_read_b64_tr_b16 v[178:179], v6 offset:6144
  v_mfma_f32_16x16x32_bf16 v[108:111], v[212:215], v[92:95], v[108:111]
  ds_read_b64_tr_b16 v[180:181], v7 offset:4096
  v_mfma_f32_16x16x32_bf16 v[104:107], v[212:215], v[88:91], v[104:107]
  ds_read_b64_tr_b16 v[182:183], v7 offset:6144
  v_mfma_f32_16x16x32_bf16 v[112:115], v[216:219], v[88:91], v[112:115]
  ds_read_b64_tr_b16 v[184:185], v8 offset:4096
  v_mfma_f32_16x16x32_bf16 v[116:119], v[216:219], v[92:95], v[116:119]
  ds_read_b64_tr_b16 v[186:187], v8 offset:6144
  v_readlane_b32 s51, v15, 15
  v_mfma_f32_16x16x32_bf16 v[124:127], v[220:223], v[92:95], v[124:127]
  ds_read_b64_tr_b16 v[188:189], v9 offset:4096
  v_mfma_f32_16x16x32_bf16 v[120:123], v[220:223], v[88:91], v[120:123]
  ds_read_b64_tr_b16 v[190:191], v9 offset:6144
  s_waitcnt vmcnt(18) lgkmcnt(8)
  v_mfma_f32_16x16x32_bf16 v[128:131], v[160:163], v[224:227], v[128:131]
  buffer_load_dwordx4 v[80:83], off, s[36:39], s51 offset:0 sc1
  v_mfma_f32_16x16x32_bf16 v[132:135], v[160:163], v[228:231], v[132:135]
  ds_read_b64_tr_b16 v[192:193], v6 offset:8192
  ds_read_b64_tr_b16 v[194:195], v6 offset:10240
  v_mfma_f32_16x16x32_bf16 v[140:143], v[164:167], v[228:231], v[140:143]
  ds_read_b64_tr_b16 v[196:197], v7 offset:8192
  v_mfma_f32_16x16x32_bf16 v[136:139], v[164:167], v[224:227], v[136:139]
  ds_read_b64_tr_b16 v[198:199], v7 offset:10240
  v_mfma_f32_16x16x32_bf16 v[144:147], v[168:171], v[224:227], v[144:147]
  ds_read_b64_tr_b16 v[200:201], v8 offset:8192
  v_mfma_f32_16x16x32_bf16 v[148:151], v[168:171], v[228:231], v[148:151]
  ds_read_b64_tr_b16 v[202:203], v8 offset:10240
  ds_read_b64_tr_b16 v[204:205], v9 offset:8192
  v_mfma_f32_16x16x32_bf16 v[156:159], v[172:175], v[228:231], v[156:159]
  buffer_load_dwordx4 v[84:87], off, s[64:67], s51 offset:0 sc1
  v_mfma_f32_16x16x32_bf16 v[152:155], v[172:175], v[224:227], v[152:155]
  ds_read_b64_tr_b16 v[206:207], v9 offset:10240
  s_waitcnt vmcnt(18) lgkmcnt(8)
  v_mfma_f32_16x16x32_bf16 v[128:131], v[176:179], v[232:235], v[128:131]
  ds_read_b64_tr_b16 v[208:209], v6 offset:12288
  v_mfma_f32_16x16x32_bf16 v[132:135], v[176:179], v[236:239], v[132:135]
  ds_read_b64_tr_b16 v[210:211], v6 offset:14336
  v_mfma_f32_16x16x32_bf16 v[140:143], v[180:183], v[236:239], v[140:143]
  ds_read_b64_tr_b16 v[212:213], v7 offset:12288
  v_mfma_f32_16x16x32_bf16 v[136:139], v[180:183], v[232:235], v[136:139]
  ds_read_b64_tr_b16 v[214:215], v7 offset:14336
  v_mfma_f32_16x16x32_bf16 v[144:147], v[184:187], v[232:235], v[144:147]
  buffer_load_dwordx4 v[88:91], off, s[36:39], s51 offset:1024 sc1
  v_mfma_f32_16x16x32_bf16 v[148:151], v[184:187], v[236:239], v[148:151]
  ds_read_b64_tr_b16 v[216:217], v8 offset:12288
  ds_read_b64_tr_b16 v[218:219], v8 offset:14336
  v_mfma_f32_16x16x32_bf16 v[156:159], v[188:191], v[236:239], v[156:159]
  ds_read_b64_tr_b16 v[220:221], v9 offset:12288
  v_mfma_f32_16x16x32_bf16 v[152:155], v[188:191], v[232:235], v[152:155]
  ds_read_b64_tr_b16 v[222:223], v9 offset:14336
  s_waitcnt lgkmcnt(8)
  v_mfma_f32_16x16x32_bf16 v[96:99], v[192:195], v[224:227], v[96:99]
  ds_read_b64_tr_b16 v[160:161], v6 offset:16384
  v_mfma_f32_16x16x32_bf16 v[100:103], v[192:195], v[228:231], v[100:103]
  ds_read_b64_tr_b16 v[162:163], v6 offset:18432
  v_mfma_f32_16x16x32_bf16 v[108:111], v[196:199], v[228:231], v[108:111]
  buffer_load_dwordx4 v[92:95], off, s[64:67], s51 offset:1024 sc1
  v_mfma_f32_16x16x32_bf16 v[104:107], v[196:199], v[224:227], v[104:107]
  ds_read_b64_tr_b16 v[164:165], v7 offset:16384
  ds_read_b64_tr_b16 v[166:167], v7 offset:18432
  v_mfma_f32_16x16x32_bf16 v[112:115], v[200:203], v[224:227], v[112:115]
  ds_read_b64_tr_b16 v[168:169], v8 offset:16384
  v_mfma_f32_16x16x32_bf16 v[116:119], v[200:203], v[228:231], v[116:119]
  ds_read_b64_tr_b16 v[170:171], v8 offset:18432
  v_mfma_f32_16x16x32_bf16 v[124:127], v[204:207], v[228:231], v[124:127]
  ds_read_b64_tr_b16 v[172:173], v9 offset:16384
  v_mfma_f32_16x16x32_bf16 v[120:123], v[204:207], v[224:227], v[120:123]
  ds_read_b64_tr_b16 v[174:175], v9 offset:18432
  s_waitcnt lgkmcnt(8)
  v_mfma_f32_16x16x32_bf16 v[96:99], v[208:211], v[232:235], v[96:99]
  ds_read_b64_tr_b16 v[176:177], v6 offset:20480
  v_mfma_f32_16x16x32_bf16 v[100:103], v[208:211], v[236:239], v[100:103]
  ds_read_b64_tr_b16 v[178:179], v6 offset:22528
  v_mfma_f32_16x16x32_bf16 v[108:111], v[212:215], v[236:239], v[108:111]
  ds_read_b64_tr_b16 v[180:181], v7 offset:20480
  v_mfma_f32_16x16x32_bf16 v[104:107], v[212:215], v[232:235], v[104:107]
  ds_read_b64_tr_b16 v[182:183], v7 offset:22528
  v_mfma_f32_16x16x32_bf16 v[112:115], v[216:219], v[232:235], v[112:115]
  ds_read_b64_tr_b16 v[184:185], v8 offset:20480
  v_mfma_f32_16x16x32_bf16 v[116:119], v[216:219], v[236:239], v[116:119]
  ds_read_b64_tr_b16 v[186:187], v8 offset:22528
  v_readlane_b32 s48, v15, 16
  v_mfma_f32_16x16x32_bf16 v[124:127], v[220:223], v[236:239], v[124:127]
  ds_read_b64_tr_b16 v[188:189], v9 offset:20480
  v_mfma_f32_16x16x32_bf16 v[120:123], v[220:223], v[232:235], v[120:123]
  ds_read_b64_tr_b16 v[190:191], v9 offset:22528
  s_waitcnt vmcnt(18) lgkmcnt(8)
  v_mfma_f32_16x16x32_bf16 v[128:131], v[160:163], v[240:243], v[128:131]
  buffer_load_dwordx4 v[224:227], off, s[36:39], s48 offset:0 sc1
  v_mfma_f32_16x16x32_bf16 v[132:135], v[160:163], v[244:247], v[132:135]
  ds_read_b64_tr_b16 v[192:193], v6 offset:24576
  ds_read_b64_tr_b16 v[194:195], v6 offset:26624
  v_mfma_f32_16x16x32_bf16 v[140:143], v[164:167], v[244:247], v[140:143]
  ds_read_b64_tr_b16 v[196:197], v7 offset:24576
  v_mfma_f32_16x16x32_bf16 v[136:139], v[164:167], v[240:243], v[136:139]
  ds_read_b64_tr_b16 v[198:199], v7 offset:26624
  v_mfma_f32_16x16x32_bf16 v[144:147], v[168:171], v[240:243], v[144:147]
  ds_read_b64_tr_b16 v[200:201], v8 offset:24576
  v_mfma_f32_16x16x32_bf16 v[148:151], v[168:171], v[244:247], v[148:151]
  ds_read_b64_tr_b16 v[202:203], v8 offset:26624
  ds_read_b64_tr_b16 v[204:205], v9 offset:24576
  v_mfma_f32_16x16x32_bf16 v[156:159], v[172:175], v[244:247], v[156:159]
  buffer_load_dwordx4 v[228:231], off, s[64:67], s48 offset:0 sc1
  v_mfma_f32_16x16x32_bf16 v[152:155], v[172:175], v[240:243], v[152:155]
  ds_read_b64_tr_b16 v[206:207], v9 offset:26624
  s_waitcnt vmcnt(18) lgkmcnt(8)
  v_mfma_f32_16x16x32_bf16 v[128:131], v[176:179], v[248:251], v[128:131]
  ds_read_b64_tr_b16 v[208:209], v6 offset:28672
  v_mfma_f32_16x16x32_bf16 v[132:135], v[176:179], v[252:255], v[132:135]
  ds_read_b64_tr_b16 v[210:211], v6 offset:30720
  v_mfma_f32_16x16x32_bf16 v[140:143], v[180:183], v[252:255], v[140:143]
  ds_read_b64_tr_b16 v[212:213], v7 offset:28672
  v_mfma_f32_16x16x32_bf16 v[136:139], v[180:183], v[248:251], v[136:139]
  ds_read_b64_tr_b16 v[214:215], v7 offset:30720
  v_mfma_f32_16x16x32_bf16 v[144:147], v[184:187], v[248:251], v[144:147]
  buffer_load_dwordx4 v[232:235], off, s[36:39], s48 offset:1024 sc1
  v_mfma_f32_16x16x32_bf16 v[148:151], v[184:187], v[252:255], v[148:151]
  ds_read_b64_tr_b16 v[216:217], v8 offset:28672
  ds_read_b64_tr_b16 v[218:219], v8 offset:30720
  v_mfma_f32_16x16x32_bf16 v[156:159], v[188:191], v[252:255], v[156:159]
  ds_read_b64_tr_b16 v[220:221], v9 offset:28672
  v_mfma_f32_16x16x32_bf16 v[152:155], v[188:191], v[248:251], v[152:155]
  ds_read_b64_tr_b16 v[222:223], v9 offset:30720
  s_waitcnt lgkmcnt(8)
  v_mfma_f32_16x16x32_bf16 v[96:99], v[192:195], v[240:243], v[96:99]
  ds_read_b64_tr_b16 v[160:161], v6 offset:32768
  v_mfma_f32_16x16x32_bf16 v[100:103], v[192:195], v[244:247], v[100:103]
  ds_read_b64_tr_b16 v[162:163], v6 offset:34816
  v_mfma_f32_16x16x32_bf16 v[108:111], v[196:199], v[244:247], v[108:111]
  buffer_load_dwordx4 v[236:239], off, s[64:67], s48 offset:1024 sc1
  v_mfma_f32_16x16x32_bf16 v[104:107], v[196:199], v[240:243], v[104:107]
  ds_read_b64_tr_b16 v[164:165], v7 offset:32768
  ds_read_b64_tr_b16 v[166:167], v7 offset:34816
  v_mfma_f32_16x16x32_bf16 v[112:115], v[200:203], v[240:243], v[112:115]
  ds_read_b64_tr_b16 v[168:169], v8 offset:32768
  v_mfma_f32_16x16x32_bf16 v[116:119], v[200:203], v[244:247], v[116:119]
  ds_read_b64_tr_b16 v[170:171], v8 offset:34816
  v_mfma_f32_16x16x32_bf16 v[124:127], v[204:207], v[244:247], v[124:127]
  ds_read_b64_tr_b16 v[172:173], v9 offset:32768
  v_mfma_f32_16x16x32_bf16 v[120:123], v[204:207], v[240:243], v[120:123]
  ds_read_b64_tr_b16 v[174:175], v9 offset:34816
  s_waitcnt lgkmcnt(8)
  s_barrier
  v_mfma_f32_16x16x32_bf16 v[96:99], v[208:211], v[248:251], v[96:99]
  ds_read_b64_tr_b16 v[176:177], v6 offset:36864
  v_mfma_f32_16x16x32_bf16 v[100:103], v[208:211], v[252:255], v[100:103]
  ds_read_b64_tr_b16 v[178:179], v6 offset:38912
  v_mfma_f32_16x16x32_bf16 v[108:111], v[212:215], v[252:255], v[108:111]
  ds_read_b64_tr_b16 v[180:181], v7 offset:36864
  v_mfma_f32_16x16x32_bf16 v[104:107], v[212:215], v[248:251], v[104:107]
  ds_read_b64_tr_b16 v[182:183], v7 offset:38912
  v_mfma_f32_16x16x32_bf16 v[112:115], v[216:219], v[248:251], v[112:115]
  ds_read_b64_tr_b16 v[184:185], v8 offset:36864
  v_mfma_f32_16x16x32_bf16 v[116:119], v[216:219], v[252:255], v[116:119]
  ds_read_b64_tr_b16 v[186:187], v8 offset:38912
  v_readlane_b32 s49, v15, 17
  v_mfma_f32_16x16x32_bf16 v[124:127], v[220:223], v[252:255], v[124:127]
  ds_read_b64_tr_b16 v[188:189], v9 offset:36864
  v_mfma_f32_16x16x32_bf16 v[120:123], v[220:223], v[248:251], v[120:123]
  ds_read_b64_tr_b16 v[190:191], v9 offset:38912
  s_waitcnt vmcnt(18) lgkmcnt(8)
  v_mfma_f32_16x16x32_bf16 v[128:131], v[160:163], v[32:35], v[128:131]
  buffer_load_dwordx4 v[240:243], off, s[36:39], s49 offset:0 sc1
  v_mfma_f32_16x16x32_bf16 v[132:135], v[160:163], v[36:39], v[132:135]
  ds_read_b64_tr_b16 v[192:193], v6 offset:40960
  ds_read_b64_tr_b16 v[194:195], v6 offset:43008
  v_mfma_f32_16x16x32_bf16 v[140:143], v[164:167], v[36:39], v[140:143]
  ds_read_b64_tr_b16 v[196:197], v7 offset:40960
  v_mfma_f32_16x16x32_bf16 v[136:139], v[164:167], v[32:35], v[136:139]
  ds_read_b64_tr_b16 v[198:199], v7 offset:43008
  v_mfma_f32_16x16x32_bf16 v[144:147], v[168:171], v[32:35], v[144:147]
  ds_read_b64_tr_b16 v[200:201], v8 offset:40960
  v_mfma_f32_16x16x32_bf16 v[148:151], v[168:171], v[36:39], v[148:151]
  ds_read_b64_tr_b16 v[202:203], v8 offset:43008
  ds_read_b64_tr_b16 v[204:205], v9 offset:40960
  v_mfma_f32_16x16x32_bf16 v[156:159], v[172:175], v[36:39], v[156:159]
  buffer_load_dwordx4 v[244:247], off, s[64:67], s49 offset:0 sc1
  v_mfma_f32_16x16x32_bf16 v[152:155], v[172:175], v[32:35], v[152:155]
  ds_read_b64_tr_b16 v[206:207], v9 offset:43008
  s_waitcnt vmcnt(18) lgkmcnt(8)
  v_mfma_f32_16x16x32_bf16 v[128:131], v[176:179], v[40:43], v[128:131]
  ds_read_b64_tr_b16 v[208:209], v6 offset:45056
  v_mfma_f32_16x16x32_bf16 v[132:135], v[176:179], v[44:47], v[132:135]
  ds_read_b64_tr_b16 v[210:211], v6 offset:47104
  v_mfma_f32_16x16x32_bf16 v[140:143], v[180:183], v[44:47], v[140:143]
  ds_read_b64_tr_b16 v[212:213], v7 offset:45056
  v_mfma_f32_16x16x32_bf16 v[136:139], v[180:183], v[40:43], v[136:139]
  ds_read_b64_tr_b16 v[214:215], v7 offset:47104
  v_mfma_f32_16x16x32_bf16 v[144:147], v[184:187], v[40:43], v[144:147]
  buffer_load_dwordx4 v[248:251], off, s[36:39], s49 offset:1024 sc1
  v_mfma_f32_16x16x32_bf16 v[148:151], v[184:187], v[44:47], v[148:151]
  ds_read_b64_tr_b16 v[216:217], v8 offset:45056
  ds_read_b64_tr_b16 v[218:219], v8 offset:47104
  v_mfma_f32_16x16x32_bf16 v[156:159], v[188:191], v[44:47], v[156:159]
  ds_read_b64_tr_b16 v[220:221], v9 offset:45056
  v_mfma_f32_16x16x32_bf16 v[152:155], v[188:191], v[40:43], v[152:155]
  ds_read_b64_tr_b16 v[222:223], v9 offset:47104
  s_waitcnt lgkmcnt(8)
  v_mfma_f32_16x16x32_bf16 v[96:99], v[192:195], v[32:35], v[96:99]
  ds_read_b64_tr_b16 v[160:161], v6 offset:49152
  v_mfma_f32_16x16x32_bf16 v[100:103], v[192:195], v[36:39], v[100:103]
  ds_read_b64_tr_b16 v[162:163], v6 offset:51200
  v_mfma_f32_16x16x32_bf16 v[108:111], v[196:199], v[36:39], v[108:111]
  buffer_load_dwordx4 v[252:255], off, s[64:67], s49 offset:1024 sc1
  v_mfma_f32_16x16x32_bf16 v[104:107], v[196:199], v[32:35], v[104:107]
  ds_read_b64_tr_b16 v[164:165], v7 offset:49152
  ds_read_b64_tr_b16 v[166:167], v7 offset:51200
  v_mfma_f32_16x16x32_bf16 v[112:115], v[200:203], v[32:35], v[112:115]
  ds_read_b64_tr_b16 v[168:169], v8 offset:49152
  v_mfma_f32_16x16x32_bf16 v[116:119], v[200:203], v[36:39], v[116:119]
  ds_read_b64_tr_b16 v[170:171], v8 offset:51200
  v_mfma_f32_16x16x32_bf16 v[124:127], v[204:207], v[36:39], v[124:127]
  ds_read_b64_tr_b16 v[172:173], v9 offset:49152
  v_mfma_f32_16x16x32_bf16 v[120:123], v[204:207], v[32:35], v[120:123]
  ds_read_b64_tr_b16 v[174:175], v9 offset:51200
  s_waitcnt lgkmcnt(8)
  v_mfma_f32_16x16x32_bf16 v[96:99], v[208:211], v[40:43], v[96:99]
  ds_read_b64_tr_b16 v[176:177], v6 offset:53248
  v_mfma_f32_16x16x32_bf16 v[100:103], v[208:211], v[44:47], v[100:103]
  ds_read_b64_tr_b16 v[178:179], v6 offset:55296
  v_mfma_f32_16x16x32_bf16 v[108:111], v[212:215], v[44:47], v[108:111]
  ds_read_b64_tr_b16 v[180:181], v7 offset:53248
  v_mfma_f32_16x16x32_bf16 v[104:107], v[212:215], v[40:43], v[104:107]
  ds_read_b64_tr_b16 v[182:183], v7 offset:55296
  v_mfma_f32_16x16x32_bf16 v[112:115], v[216:219], v[40:43], v[112:115]
  ds_read_b64_tr_b16 v[184:185], v8 offset:53248
  v_mfma_f32_16x16x32_bf16 v[116:119], v[216:219], v[44:47], v[116:119]
  ds_read_b64_tr_b16 v[186:187], v8 offset:55296
  v_readlane_b32 s50, v15, 18
  v_mfma_f32_16x16x32_bf16 v[124:127], v[220:223], v[44:47], v[124:127]
  ds_read_b64_tr_b16 v[188:189], v9 offset:53248
  v_mfma_f32_16x16x32_bf16 v[120:123], v[220:223], v[40:43], v[120:123]
  ds_read_b64_tr_b16 v[190:191], v9 offset:55296
  s_waitcnt vmcnt(18) lgkmcnt(8)
  v_mfma_f32_16x16x32_bf16 v[128:131], v[160:163], v[48:51], v[128:131]
  buffer_load_dwordx4 v[32:35], off, s[36:39], s50 offset:0 sc1
  v_mfma_f32_16x16x32_bf16 v[132:135], v[160:163], v[52:55], v[132:135]
  ds_read_b64_tr_b16 v[192:193], v6 offset:57344
  ds_read_b64_tr_b16 v[194:195], v6 offset:59392
  v_mfma_f32_16x16x32_bf16 v[140:143], v[164:167], v[52:55], v[140:143]
  ds_read_b64_tr_b16 v[196:197], v7 offset:57344
  v_mfma_f32_16x16x32_bf16 v[136:139], v[164:167], v[48:51], v[136:139]
  ds_read_b64_tr_b16 v[198:199], v7 offset:59392
  v_mfma_f32_16x16x32_bf16 v[144:147], v[168:171], v[48:51], v[144:147]
  ds_read_b64_tr_b16 v[200:201], v8 offset:57344
  v_mfma_f32_16x16x32_bf16 v[148:151], v[168:171], v[52:55], v[148:151]
  ds_read_b64_tr_b16 v[202:203], v8 offset:59392
  ds_read_b64_tr_b16 v[204:205], v9 offset:57344
  v_mfma_f32_16x16x32_bf16 v[156:159], v[172:175], v[52:55], v[156:159]
  buffer_load_dwordx4 v[36:39], off, s[64:67], s50 offset:0 sc1
  v_mfma_f32_16x16x32_bf16 v[152:155], v[172:175], v[48:51], v[152:155]
  ds_read_b64_tr_b16 v[206:207], v9 offset:59392
  s_waitcnt vmcnt(18) lgkmcnt(8)
  v_mfma_f32_16x16x32_bf16 v[128:131], v[176:179], v[56:59], v[128:131]
  ds_read_b64_tr_b16 v[208:209], v6 offset:61440
  v_mfma_f32_16x16x32_bf16 v[132:135], v[176:179], v[60:63], v[132:135]
  ds_read_b64_tr_b16 v[210:211], v6 offset:63488
  v_mfma_f32_16x16x32_bf16 v[140:143], v[180:183], v[60:63], v[140:143]
  ds_read_b64_tr_b16 v[212:213], v7 offset:61440
  v_mfma_f32_16x16x32_bf16 v[136:139], v[180:183], v[56:59], v[136:139]
  ds_read_b64_tr_b16 v[214:215], v7 offset:63488
  v_mfma_f32_16x16x32_bf16 v[144:147], v[184:187], v[56:59], v[144:147]
  buffer_load_dwordx4 v[40:43], off, s[36:39], s50 offset:1024 sc1
  v_mfma_f32_16x16x32_bf16 v[148:151], v[184:187], v[60:63], v[148:151]
  ds_read_b64_tr_b16 v[216:217], v8 offset:61440
  ds_read_b64_tr_b16 v[218:219], v8 offset:63488
  v_mfma_f32_16x16x32_bf16 v[156:159], v[188:191], v[60:63], v[156:159]
  ds_read_b64_tr_b16 v[220:221], v9 offset:61440
  v_mfma_f32_16x16x32_bf16 v[152:155], v[188:191], v[56:59], v[152:155]
  ds_read_b64_tr_b16 v[222:223], v9 offset:63488
  s_waitcnt lgkmcnt(8)
  v_mfma_f32_16x16x32_bf16 v[96:99], v[192:195], v[48:51], v[96:99]
  ds_read_b64_tr_b16 v[160:161], v20 offset:0
  v_mfma_f32_16x16x32_bf16 v[100:103], v[192:195], v[52:55], v[100:103]
  ds_read_b64_tr_b16 v[162:163], v20 offset:2048
  v_mfma_f32_16x16x32_bf16 v[108:111], v[196:199], v[52:55], v[108:111]
  buffer_load_dwordx4 v[44:47], off, s[64:67], s50 offset:1024 sc1
  v_mfma_f32_16x16x32_bf16 v[104:107], v[196:199], v[48:51], v[104:107]
  ds_read_b64_tr_b16 v[164:165], v21 offset:0
  ds_read_b64_tr_b16 v[166:167], v21 offset:2048
  v_mfma_f32_16x16x32_bf16 v[112:115], v[200:203], v[48:51], v[112:115]
  ds_read_b64_tr_b16 v[168:169], v22 offset:0
  v_mfma_f32_16x16x32_bf16 v[116:119], v[200:203], v[52:55], v[116:119]
  ds_read_b64_tr_b16 v[170:171], v22 offset:2048
  v_mfma_f32_16x16x32_bf16 v[124:127], v[204:207], v[52:55], v[124:127]
  ds_read_b64_tr_b16 v[172:173], v23 offset:0
  v_mfma_f32_16x16x32_bf16 v[120:123], v[204:207], v[48:51], v[120:123]
  ds_read_b64_tr_b16 v[174:175], v23 offset:2048
  s_waitcnt lgkmcnt(8)
  s_barrier
  v_mfma_f32_16x16x32_bf16 v[96:99], v[208:211], v[56:59], v[96:99]
  ds_read_b64_tr_b16 v[176:177], v20 offset:4096
  v_mfma_f32_16x16x32_bf16 v[100:103], v[208:211], v[60:63], v[100:103]
  ds_read_b64_tr_b16 v[178:179], v20 offset:6144
  v_mfma_f32_16x16x32_bf16 v[108:111], v[212:215], v[60:63], v[108:111]
  ds_read_b64_tr_b16 v[180:181], v21 offset:4096
  v_mfma_f32_16x16x32_bf16 v[104:107], v[212:215], v[56:59], v[104:107]
  ds_read_b64_tr_b16 v[182:183], v21 offset:6144
  v_mfma_f32_16x16x32_bf16 v[112:115], v[216:219], v[56:59], v[112:115]
  ds_read_b64_tr_b16 v[184:185], v22 offset:4096
  v_mfma_f32_16x16x32_bf16 v[116:119], v[216:219], v[60:63], v[116:119]
  ds_read_b64_tr_b16 v[186:187], v22 offset:6144
  v_readlane_b32 s51, v15, 19
  v_mfma_f32_16x16x32_bf16 v[124:127], v[220:223], v[60:63], v[124:127]
  ds_read_b64_tr_b16 v[188:189], v23 offset:4096
  v_mfma_f32_16x16x32_bf16 v[120:123], v[220:223], v[56:59], v[120:123]
  ds_read_b64_tr_b16 v[190:191], v23 offset:6144
  s_waitcnt vmcnt(18) lgkmcnt(8)
  v_mfma_f32_16x16x32_bf16 v[128:131], v[160:163], v[64:67], v[128:131]
  buffer_load_dwordx4 v[48:51], off, s[36:39], s51 offset:0 sc1
  v_mfma_f32_16x16x32_bf16 v[132:135], v[160:163], v[68:71], v[132:135]
  ds_read_b64_tr_b16 v[192:193], v20 offset:8192
  ds_read_b64_tr_b16 v[194:195], v20 offset:10240
  v_mfma_f32_16x16x32_bf16 v[140:143], v[164:167], v[68:71], v[140:143]
  ds_read_b64_tr_b16 v[196:197], v21 offset:8192
  v_mfma_f32_16x16x32_bf16 v[136:139], v[164:167], v[64:67], v[136:139]
  ds_read_b64_tr_b16 v[198:199], v21 offset:10240
  v_mfma_f32_16x16x32_bf16 v[144:147], v[168:171], v[64:67], v[144:147]
  ds_read_b64_tr_b16 v[200:201], v22 offset:8192
  v_mfma_f32_16x16x32_bf16 v[148:151], v[168:171], v[68:71], v[148:151]
  ds_read_b64_tr_b16 v[202:203], v22 offset:10240
  ds_read_b64_tr_b16 v[204:205], v23 offset:8192
  v_mfma_f32_16x16x32_bf16 v[156:159], v[172:175], v[68:71], v[156:159]
  buffer_load_dwordx4 v[52:55], off, s[64:67], s51 offset:0 sc1
  v_mfma_f32_16x16x32_bf16 v[152:155], v[172:175], v[64:67], v[152:155]
  ds_read_b64_tr_b16 v[206:207], v23 offset:10240
  s_waitcnt vmcnt(18) lgkmcnt(8)
  v_mfma_f32_16x16x32_bf16 v[128:131], v[176:179], v[72:75], v[128:131]
  ds_read_b64_tr_b16 v[208:209], v20 offset:12288
  v_mfma_f32_16x16x32_bf16 v[132:135], v[176:179], v[76:79], v[132:135]
  ds_read_b64_tr_b16 v[210:211], v20 offset:14336
  v_mfma_f32_16x16x32_bf16 v[140:143], v[180:183], v[76:79], v[140:143]
  ds_read_b64_tr_b16 v[212:213], v21 offset:12288
  v_mfma_f32_16x16x32_bf16 v[136:139], v[180:183], v[72:75], v[136:139]
  ds_read_b64_tr_b16 v[214:215], v21 offset:14336
  v_mfma_f32_16x16x32_bf16 v[144:147], v[184:187], v[72:75], v[144:147]
  buffer_load_dwordx4 v[56:59], off, s[36:39], s51 offset:1024 sc1
  v_mfma_f32_16x16x32_bf16 v[148:151], v[184:187], v[76:79], v[148:151]
  ds_read_b64_tr_b16 v[216:217], v22 offset:12288
  ds_read_b64_tr_b16 v[218:219], v22 offset:14336
  v_mfma_f32_16x16x32_bf16 v[156:159], v[188:191], v[76:79], v[156:159]
  ds_read_b64_tr_b16 v[220:221], v23 offset:12288
  v_mfma_f32_16x16x32_bf16 v[152:155], v[188:191], v[72:75], v[152:155]
  ds_read_b64_tr_b16 v[222:223], v23 offset:14336
  s_waitcnt lgkmcnt(8)
  v_mfma_f32_16x16x32_bf16 v[96:99], v[192:195], v[64:67], v[96:99]
  ds_read_b64_tr_b16 v[160:161], v20 offset:16384
  v_mfma_f32_16x16x32_bf16 v[100:103], v[192:195], v[68:71], v[100:103]
  ds_read_b64_tr_b16 v[162:163], v20 offset:18432
  v_mfma_f32_16x16x32_bf16 v[108:111], v[196:199], v[68:71], v[108:111]
  buffer_load_dwordx4 v[60:63], off, s[64:67], s51 offset:1024 sc1
  v_mfma_f32_16x16x32_bf16 v[104:107], v[196:199], v[64:67], v[104:107]
  ds_read_b64_tr_b16 v[164:165], v21 offset:16384
  ds_read_b64_tr_b16 v[166:167], v21 offset:18432
  v_mfma_f32_16x16x32_bf16 v[112:115], v[200:203], v[64:67], v[112:115]
  ds_read_b64_tr_b16 v[168:169], v22 offset:16384
  v_mfma_f32_16x16x32_bf16 v[116:119], v[200:203], v[68:71], v[116:119]
  ds_read_b64_tr_b16 v[170:171], v22 offset:18432
  v_mfma_f32_16x16x32_bf16 v[124:127], v[204:207], v[68:71], v[124:127]
  ds_read_b64_tr_b16 v[172:173], v23 offset:16384
  v_mfma_f32_16x16x32_bf16 v[120:123], v[204:207], v[64:67], v[120:123]
  ds_read_b64_tr_b16 v[174:175], v23 offset:18432
  s_waitcnt lgkmcnt(8)
  v_mfma_f32_16x16x32_bf16 v[96:99], v[208:211], v[72:75], v[96:99]
  ds_read_b64_tr_b16 v[176:177], v20 offset:20480
  v_mfma_f32_16x16x32_bf16 v[100:103], v[208:211], v[76:79], v[100:103]
  ds_read_b64_tr_b16 v[178:179], v20 offset:22528
  v_mfma_f32_16x16x32_bf16 v[108:111], v[212:215], v[76:79], v[108:111]
  ds_read_b64_tr_b16 v[180:181], v21 offset:20480
  v_mfma_f32_16x16x32_bf16 v[104:107], v[212:215], v[72:75], v[104:107]
  ds_read_b64_tr_b16 v[182:183], v21 offset:22528
  v_mfma_f32_16x16x32_bf16 v[112:115], v[216:219], v[72:75], v[112:115]
  ds_read_b64_tr_b16 v[184:185], v22 offset:20480
  v_mfma_f32_16x16x32_bf16 v[116:119], v[216:219], v[76:79], v[116:119]
  ds_read_b64_tr_b16 v[186:187], v22 offset:22528
  v_readlane_b32 s48, v15, 20
  v_mfma_f32_16x16x32_bf16 v[124:127], v[220:223], v[76:79], v[124:127]
  ds_read_b64_tr_b16 v[188:189], v23 offset:20480
  v_mfma_f32_16x16x32_bf16 v[120:123], v[220:223], v[72:75], v[120:123]
  ds_read_b64_tr_b16 v[190:191], v23 offset:22528
  s_waitcnt vmcnt(18) lgkmcnt(8)
  v_mfma_f32_16x16x32_bf16 v[128:131], v[160:163], v[80:83], v[128:131]
  buffer_load_dwordx4 v[64:67], off, s[36:39], s48 offset:0 sc1
  v_mfma_f32_16x16x32_bf16 v[132:135], v[160:163], v[84:87], v[132:135]
  ds_read_b64_tr_b16 v[192:193], v20 offset:24576
  ds_read_b64_tr_b16 v[194:195], v20 offset:26624
  v_mfma_f32_16x16x32_bf16 v[140:143], v[164:167], v[84:87], v[140:143]
  ds_read_b64_tr_b16 v[196:197], v21 offset:24576
  v_mfma_f32_16x16x32_bf16 v[136:139], v[164:167], v[80:83], v[136:139]
  ds_read_b64_tr_b16 v[198:199], v21 offset:26624
  v_mfma_f32_16x16x32_bf16 v[144:147], v[168:171], v[80:83], v[144:147]
  ds_read_b64_tr_b16 v[200:201], v22 offset:24576
  v_mfma_f32_16x16x32_bf16 v[148:151], v[168:171], v[84:87], v[148:151]
  ds_read_b64_tr_b16 v[202:203], v22 offset:26624
  ds_read_b64_tr_b16 v[204:205], v23 offset:24576
  v_mfma_f32_16x16x32_bf16 v[156:159], v[172:175], v[84:87], v[156:159]
  buffer_load_dwordx4 v[68:71], off, s[64:67], s48 offset:0 sc1
  v_mfma_f32_16x16x32_bf16 v[152:155], v[172:175], v[80:83], v[152:155]
  ds_read_b64_tr_b16 v[206:207], v23 offset:26624
  s_waitcnt vmcnt(18) lgkmcnt(8)
  v_mfma_f32_16x16x32_bf16 v[128:131], v[176:179], v[88:91], v[128:131]
  ds_read_b64_tr_b16 v[208:209], v20 offset:28672
  v_mfma_f32_16x16x32_bf16 v[132:135], v[176:179], v[92:95], v[132:135]
  ds_read_b64_tr_b16 v[210:211], v20 offset:30720
  v_mfma_f32_16x16x32_bf16 v[140:143], v[180:183], v[92:95], v[140:143]
  ds_read_b64_tr_b16 v[212:213], v21 offset:28672
  v_mfma_f32_16x16x32_bf16 v[136:139], v[180:183], v[88:91], v[136:139]
  ds_read_b64_tr_b16 v[214:215], v21 offset:30720
  v_mfma_f32_16x16x32_bf16 v[144:147], v[184:187], v[88:91], v[144:147]
  buffer_load_dwordx4 v[72:75], off, s[36:39], s48 offset:1024 sc1
  v_mfma_f32_16x16x32_bf16 v[148:151], v[184:187], v[92:95], v[148:151]
  ds_read_b64_tr_b16 v[216:217], v22 offset:28672
  ds_read_b64_tr_b16 v[218:219], v22 offset:30720
  v_mfma_f32_16x16x32_bf16 v[156:159], v[188:191], v[92:95], v[156:159]
  ds_read_b64_tr_b16 v[220:221], v23 offset:28672
  v_mfma_f32_16x16x32_bf16 v[152:155], v[188:191], v[88:91], v[152:155]
  ds_read_b64_tr_b16 v[222:223], v23 offset:30720
  s_waitcnt lgkmcnt(8)
  v_mfma_f32_16x16x32_bf16 v[96:99], v[192:195], v[80:83], v[96:99]
  ds_read_b64_tr_b16 v[160:161], v20 offset:32768
  v_mfma_f32_16x16x32_bf16 v[100:103], v[192:195], v[84:87], v[100:103]
  ds_read_b64_tr_b16 v[162:163], v20 offset:34816
  v_mfma_f32_16x16x32_bf16 v[108:111], v[196:199], v[84:87], v[108:111]
  buffer_load_dwordx4 v[76:79], off, s[64:67], s48 offset:1024 sc1
  v_mfma_f32_16x16x32_bf16 v[104:107], v[196:199], v[80:83], v[104:107]
  ds_read_b64_tr_b16 v[164:165], v21 offset:32768
  ds_read_b64_tr_b16 v[166:167], v21 offset:34816
  v_mfma_f32_16x16x32_bf16 v[112:115], v[200:203], v[80:83], v[112:115]
  ds_read_b64_tr_b16 v[168:169], v22 offset:32768
  v_mfma_f32_16x16x32_bf16 v[116:119], v[200:203], v[84:87], v[116:119]
  ds_read_b64_tr_b16 v[170:171], v22 offset:34816
  v_mfma_f32_16x16x32_bf16 v[124:127], v[204:207], v[84:87], v[124:127]
  ds_read_b64_tr_b16 v[172:173], v23 offset:32768
  v_mfma_f32_16x16x32_bf16 v[120:123], v[204:207], v[80:83], v[120:123]
  ds_read_b64_tr_b16 v[174:175], v23 offset:34816
  s_waitcnt lgkmcnt(8)
  s_barrier
  v_mfma_f32_16x16x32_bf16 v[96:99], v[208:211], v[88:91], v[96:99]
  ds_read_b64_tr_b16 v[176:177], v20 offset:36864
  v_mfma_f32_16x16x32_bf16 v[100:103], v[208:211], v[92:95], v[100:103]
  ds_read_b64_tr_b16 v[178:179], v20 offset:38912
  v_mfma_f32_16x16x32_bf16 v[108:111], v[212:215], v[92:95], v[108:111]
  ds_read_b64_tr_b16 v[180:181], v21 offset:36864
  v_mfma_f32_16x16x32_bf16 v[104:107], v[212:215], v[88:91], v[104:107]
  ds_read_b64_tr_b16 v[182:183], v21 offset:38912
  v_mfma_f32_16x16x32_bf16 v[112:115], v[216:219], v[88:91], v[112:115]
  ds_read_b64_tr_b16 v[184:185], v22 offset:36864
  v_mfma_f32_16x16x32_bf16 v[116:119], v[216:219], v[92:95], v[116:119]
  ds_read_b64_tr_b16 v[186:187], v22 offset:38912
  v_readlane_b32 s49, v15, 21
  v_mfma_f32_16x16x32_bf16 v[124:127], v[220:223], v[92:95], v[124:127]
  ds_read_b64_tr_b16 v[188:189], v23 offset:36864
  v_mfma_f32_16x16x32_bf16 v[120:123], v[220:223], v[88:91], v[120:123]
  ds_read_b64_tr_b16 v[190:191], v23 offset:38912
  s_waitcnt vmcnt(18) lgkmcnt(8)
  v_mfma_f32_16x16x32_bf16 v[128:131], v[160:163], v[224:227], v[128:131]
  buffer_load_dwordx4 v[80:83], off, s[36:39], s49 offset:0 sc1
  v_mfma_f32_16x16x32_bf16 v[132:135], v[160:163], v[228:231], v[132:135]
  ds_read_b64_tr_b16 v[192:193], v20 offset:40960
  ds_read_b64_tr_b16 v[194:195], v20 offset:43008
  v_mfma_f32_16x16x32_bf16 v[140:143], v[164:167], v[228:231], v[140:143]
  ds_read_b64_tr_b16 v[196:197], v21 offset:40960
  v_mfma_f32_16x16x32_bf16 v[136:139], v[164:167], v[224:227], v[136:139]
  ds_read_b64_tr_b16 v[198:199], v21 offset:43008
  v_mfma_f32_16x16x32_bf16 v[144:147], v[168:171], v[224:227], v[144:147]
  ds_read_b64_tr_b16 v[200:201], v22 offset:40960
  v_mfma_f32_16x16x32_bf16 v[148:151], v[168:171], v[228:231], v[148:151]
  ds_read_b64_tr_b16 v[202:203], v22 offset:43008
  ds_read_b64_tr_b16 v[204:205], v23 offset:40960
  v_mfma_f32_16x16x32_bf16 v[156:159], v[172:175], v[228:231], v[156:159]
  buffer_load_dwordx4 v[84:87], off, s[64:67], s49 offset:0 sc1
  v_mfma_f32_16x16x32_bf16 v[152:155], v[172:175], v[224:227], v[152:155]
  ds_read_b64_tr_b16 v[206:207], v23 offset:43008
  s_waitcnt vmcnt(18) lgkmcnt(8)
  v_mfma_f32_16x16x32_bf16 v[128:131], v[176:179], v[232:235], v[128:131]
  ds_read_b64_tr_b16 v[208:209], v20 offset:45056
  v_mfma_f32_16x16x32_bf16 v[132:135], v[176:179], v[236:239], v[132:135]
  ds_read_b64_tr_b16 v[210:211], v20 offset:47104
  v_mfma_f32_16x16x32_bf16 v[140:143], v[180:183], v[236:239], v[140:143]
  ds_read_b64_tr_b16 v[212:213], v21 offset:45056
  v_mfma_f32_16x16x32_bf16 v[136:139], v[180:183], v[232:235], v[136:139]
  ds_read_b64_tr_b16 v[214:215], v21 offset:47104
  v_mfma_f32_16x16x32_bf16 v[144:147], v[184:187], v[232:235], v[144:147]
  buffer_load_dwordx4 v[88:91], off, s[36:39], s49 offset:1024 sc1
  v_mfma_f32_16x16x32_bf16 v[148:151], v[184:187], v[236:239], v[148:151]
  ds_read_b64_tr_b16 v[216:217], v22 offset:45056
  ds_read_b64_tr_b16 v[218:219], v22 offset:47104
  v_mfma_f32_16x16x32_bf16 v[156:159], v[188:191], v[236:239], v[156:159]
  ds_read_b64_tr_b16 v[220:221], v23 offset:45056
  v_mfma_f32_16x16x32_bf16 v[152:155], v[188:191], v[232:235], v[152:155]
  ds_read_b64_tr_b16 v[222:223], v23 offset:47104
  s_waitcnt lgkmcnt(8)
  v_mfma_f32_16x16x32_bf16 v[96:99], v[192:195], v[224:227], v[96:99]
  ds_read_b64_tr_b16 v[160:161], v20 offset:49152
  v_mfma_f32_16x16x32_bf16 v[100:103], v[192:195], v[228:231], v[100:103]
  ds_read_b64_tr_b16 v[162:163], v20 offset:51200
  v_mfma_f32_16x16x32_bf16 v[108:111], v[196:199], v[228:231], v[108:111]
  buffer_load_dwordx4 v[92:95], off, s[64:67], s49 offset:1024 sc1
  v_mfma_f32_16x16x32_bf16 v[104:107], v[196:199], v[224:227], v[104:107]
  ds_read_b64_tr_b16 v[164:165], v21 offset:49152
  ds_read_b64_tr_b16 v[166:167], v21 offset:51200
  v_mfma_f32_16x16x32_bf16 v[112:115], v[200:203], v[224:227], v[112:115]
  ds_read_b64_tr_b16 v[168:169], v22 offset:49152
  v_mfma_f32_16x16x32_bf16 v[116:119], v[200:203], v[228:231], v[116:119]
  ds_read_b64_tr_b16 v[170:171], v22 offset:51200
  v_mfma_f32_16x16x32_bf16 v[124:127], v[204:207], v[228:231], v[124:127]
  ds_read_b64_tr_b16 v[172:173], v23 offset:49152
  v_mfma_f32_16x16x32_bf16 v[120:123], v[204:207], v[224:227], v[120:123]
  ds_read_b64_tr_b16 v[174:175], v23 offset:51200
  s_waitcnt lgkmcnt(8)
  v_mfma_f32_16x16x32_bf16 v[96:99], v[208:211], v[232:235], v[96:99]
  ds_read_b64_tr_b16 v[176:177], v20 offset:53248
  v_mfma_f32_16x16x32_bf16 v[100:103], v[208:211], v[236:239], v[100:103]
  ds_read_b64_tr_b16 v[178:179], v20 offset:55296
  v_mfma_f32_16x16x32_bf16 v[108:111], v[212:215], v[236:239], v[108:111]
  ds_read_b64_tr_b16 v[180:181], v21 offset:53248
  v_mfma_f32_16x16x32_bf16 v[104:107], v[212:215], v[232:235], v[104:107]
  ds_read_b64_tr_b16 v[182:183], v21 offset:55296
  v_mfma_f32_16x16x32_bf16 v[112:115], v[216:219], v[232:235], v[112:115]
  ds_read_b64_tr_b16 v[184:185], v22 offset:53248
  v_mfma_f32_16x16x32_bf16 v[116:119], v[216:219], v[236:239], v[116:119]
  ds_read_b64_tr_b16 v[186:187], v22 offset:55296
  v_readlane_b32 s50, v15, 22
  v_mfma_f32_16x16x32_bf16 v[124:127], v[220:223], v[236:239], v[124:127]
  ds_read_b64_tr_b16 v[188:189], v23 offset:53248
  v_mfma_f32_16x16x32_bf16 v[120:123], v[220:223], v[232:235], v[120:123]
  ds_read_b64_tr_b16 v[190:191], v23 offset:55296
  s_waitcnt vmcnt(18) lgkmcnt(8)
  v_mfma_f32_16x16x32_bf16 v[128:131], v[160:163], v[240:243], v[128:131]
  buffer_load_dwordx4 v[224:227], off, s[36:39], s50 offset:0 sc1
  v_mfma_f32_16x16x32_bf16 v[132:135], v[160:163], v[244:247], v[132:135]
  ds_read_b64_tr_b16 v[192:193], v20 offset:57344
  ds_read_b64_tr_b16 v[194:195], v20 offset:59392
  v_mfma_f32_16x16x32_bf16 v[140:143], v[164:167], v[244:247], v[140:143]
  ds_read_b64_tr_b16 v[196:197], v21 offset:57344
  v_mfma_f32_16x16x32_bf16 v[136:139], v[164:167], v[240:243], v[136:139]
  ds_read_b64_tr_b16 v[198:199], v21 offset:59392
  v_mfma_f32_16x16x32_bf16 v[144:147], v[168:171], v[240:243], v[144:147]
  ds_read_b64_tr_b16 v[200:201], v22 offset:57344
  v_mfma_f32_16x16x32_bf16 v[148:151], v[168:171], v[244:247], v[148:151]
  ds_read_b64_tr_b16 v[202:203], v22 offset:59392
  ds_read_b64_tr_b16 v[204:205], v23 offset:57344
  v_mfma_f32_16x16x32_bf16 v[156:159], v[172:175], v[244:247], v[156:159]
  buffer_load_dwordx4 v[228:231], off, s[64:67], s50 offset:0 sc1
  v_mfma_f32_16x16x32_bf16 v[152:155], v[172:175], v[240:243], v[152:155]
  ds_read_b64_tr_b16 v[206:207], v23 offset:59392
  s_waitcnt vmcnt(18) lgkmcnt(8)
  v_mfma_f32_16x16x32_bf16 v[128:131], v[176:179], v[248:251], v[128:131]
  ds_read_b64_tr_b16 v[208:209], v20 offset:61440
  v_mfma_f32_16x16x32_bf16 v[132:135], v[176:179], v[252:255], v[132:135]
  ds_read_b64_tr_b16 v[210:211], v20 offset:63488
  v_mfma_f32_16x16x32_bf16 v[140:143], v[180:183], v[252:255], v[140:143]
  ds_read_b64_tr_b16 v[212:213], v21 offset:61440
  v_mfma_f32_16x16x32_bf16 v[136:139], v[180:183], v[248:251], v[136:139]
  ds_read_b64_tr_b16 v[214:215], v21 offset:63488
  v_mfma_f32_16x16x32_bf16 v[144:147], v[184:187], v[248:251], v[144:147]
  buffer_load_dwordx4 v[232:235], off, s[36:39], s50 offset:1024 sc1
  v_mfma_f32_16x16x32_bf16 v[148:151], v[184:187], v[252:255], v[148:151]
  ds_read_b64_tr_b16 v[216:217], v22 offset:61440
  ds_read_b64_tr_b16 v[218:219], v22 offset:63488
  v_mfma_f32_16x16x32_bf16 v[156:159], v[188:191], v[252:255], v[156:159]
  ds_read_b64_tr_b16 v[220:221], v23 offset:61440
  v_mfma_f32_16x16x32_bf16 v[152:155], v[188:191], v[248:251], v[152:155]
  ds_read_b64_tr_b16 v[222:223], v23 offset:63488
  s_waitcnt vmcnt(17) lgkmcnt(8)
  v_mfma_f32_16x16x32_bf16 v[128:131], v[192:195], v[32:35], v[128:131]
  ds_read_b64_tr_b16 v[160:161], v26 offset:0
  v_mfma_f32_16x16x32_bf16 v[132:135], v[192:195], v[36:39], v[132:135]
  ds_read_b64_tr_b16 v[162:163], v26 offset:2048
  v_mfma_f32_16x16x32_bf16 v[140:143], v[196:199], v[36:39], v[140:143]
  buffer_load_dwordx4 v[236:239], off, s[64:67], s50 offset:1024 sc1
  v_mfma_f32_16x16x32_bf16 v[136:139], v[196:199], v[32:35], v[136:139]
  ds_read_b64_tr_b16 v[164:165], v27 offset:0
  ds_read_b64_tr_b16 v[166:167], v27 offset:2048
  v_mfma_f32_16x16x32_bf16 v[144:147], v[200:203], v[32:35], v[144:147]
  ds_read_b64_tr_b16 v[168:169], v28 offset:0
  v_mfma_f32_16x16x32_bf16 v[148:151], v[200:203], v[36:39], v[148:151]
  ds_read_b64_tr_b16 v[170:171], v28 offset:2048
  v_mfma_f32_16x16x32_bf16 v[156:159], v[204:207], v[36:39], v[156:159]
  ds_read_b64_tr_b16 v[172:173], v29 offset:0
  v_mfma_f32_16x16x32_bf16 v[152:155], v[204:207], v[32:35], v[152:155]
  ds_read_b64_tr_b16 v[174:175], v29 offset:2048
  s_waitcnt vmcnt(16) lgkmcnt(8)
  s_barrier
  v_mfma_f32_16x16x32_bf16 v[128:131], v[208:211], v[40:43], v[128:131]
  ds_read_b64_tr_b16 v[176:177], v26 offset:4096
  v_mfma_f32_16x16x32_bf16 v[132:135], v[208:211], v[44:47], v[132:135]
  ds_read_b64_tr_b16 v[178:179], v26 offset:6144
  v_mfma_f32_16x16x32_bf16 v[140:143], v[212:215], v[44:47], v[140:143]
  ds_read_b64_tr_b16 v[180:181], v27 offset:4096
  v_mfma_f32_16x16x32_bf16 v[136:139], v[212:215], v[40:43], v[136:139]
  ds_read_b64_tr_b16 v[182:183], v27 offset:6144
  v_mfma_f32_16x16x32_bf16 v[144:147], v[216:219], v[40:43], v[144:147]
  ds_read_b64_tr_b16 v[184:185], v28 offset:4096
  v_mfma_f32_16x16x32_bf16 v[148:151], v[216:219], v[44:47], v[148:151]
  ds_read_b64_tr_b16 v[186:187], v28 offset:6144
  v_mfma_f32_16x16x32_bf16 v[156:159], v[220:223], v[44:47], v[156:159]
  ds_read_b64_tr_b16 v[188:189], v29 offset:4096
  v_mfma_f32_16x16x32_bf16 v[152:155], v[220:223], v[40:43], v[152:155]
  ds_read_b64_tr_b16 v[190:191], v29 offset:6144
  s_waitcnt vmcnt(14) lgkmcnt(8)
  v_mfma_f32_16x16x32_bf16 v[128:131], v[160:163], v[48:51], v[128:131]
  ds_read_b64_tr_b16 v[192:193], v26 offset:8192
  v_mfma_f32_16x16x32_bf16 v[132:135], v[160:163], v[52:55], v[132:135]
  ds_read_b64_tr_b16 v[194:195], v26 offset:10240
  v_mfma_f32_16x16x32_bf16 v[140:143], v[164:167], v[52:55], v[140:143]
  ds_read_b64_tr_b16 v[196:197], v27 offset:8192
  v_mfma_f32_16x16x32_bf16 v[136:139], v[164:167], v[48:51], v[136:139]
  ds_read_b64_tr_b16 v[198:199], v27 offset:10240
  v_mfma_f32_16x16x32_bf16 v[144:147], v[168:171], v[48:51], v[144:147]
  ds_read_b64_tr_b16 v[200:201], v28 offset:8192
  v_mfma_f32_16x16x32_bf16 v[148:151], v[168:171], v[52:55], v[148:151]
  ds_read_b64_tr_b16 v[202:203], v28 offset:10240
  v_mfma_f32_16x16x32_bf16 v[156:159], v[172:175], v[52:55], v[156:159]
  ds_read_b64_tr_b16 v[204:205], v29 offset:8192
  v_mfma_f32_16x16x32_bf16 v[152:155], v[172:175], v[48:51], v[152:155]
  ds_read_b64_tr_b16 v[206:207], v29 offset:10240
  s_waitcnt vmcnt(12) lgkmcnt(8)
  v_mfma_f32_16x16x32_bf16 v[128:131], v[176:179], v[56:59], v[128:131]
  ds_read_b64_tr_b16 v[208:209], v26 offset:12288
  v_mfma_f32_16x16x32_bf16 v[132:135], v[176:179], v[60:63], v[132:135]
  ds_read_b64_tr_b16 v[210:211], v26 offset:14336
  v_mfma_f32_16x16x32_bf16 v[140:143], v[180:183], v[60:63], v[140:143]
  ds_read_b64_tr_b16 v[212:213], v27 offset:12288
  v_mfma_f32_16x16x32_bf16 v[136:139], v[180:183], v[56:59], v[136:139]
  ds_read_b64_tr_b16 v[214:215], v27 offset:14336
  v_mfma_f32_16x16x32_bf16 v[144:147], v[184:187], v[56:59], v[144:147]
  ds_read_b64_tr_b16 v[216:217], v28 offset:12288
  v_mfma_f32_16x16x32_bf16 v[148:151], v[184:187], v[60:63], v[148:151]
  ds_read_b64_tr_b16 v[218:219], v28 offset:14336
  v_mfma_f32_16x16x32_bf16 v[156:159], v[188:191], v[60:63], v[156:159]
  ds_read_b64_tr_b16 v[220:221], v29 offset:12288
  v_mfma_f32_16x16x32_bf16 v[152:155], v[188:191], v[56:59], v[152:155]
  ds_read_b64_tr_b16 v[222:223], v29 offset:14336
  s_waitcnt vmcnt(10) lgkmcnt(8)
  v_mfma_f32_16x16x32_bf16 v[128:131], v[192:195], v[64:67], v[128:131]
  ds_read_b64_tr_b16 v[160:161], v26 offset:16384
  v_mfma_f32_16x16x32_bf16 v[132:135], v[192:195], v[68:71], v[132:135]
  ds_read_b64_tr_b16 v[162:163], v26 offset:18432
  v_mfma_f32_16x16x32_bf16 v[140:143], v[196:199], v[68:71], v[140:143]
  ds_read_b64_tr_b16 v[164:165], v27 offset:16384
  v_mfma_f32_16x16x32_bf16 v[136:139], v[196:199], v[64:67], v[136:139]
  ds_read_b64_tr_b16 v[166:167], v27 offset:18432
  v_mfma_f32_16x16x32_bf16 v[144:147], v[200:203], v[64:67], v[144:147]
  ds_read_b64_tr_b16 v[168:169], v28 offset:16384
  v_mfma_f32_16x16x32_bf16 v[148:151], v[200:203], v[68:71], v[148:151]
  ds_read_b64_tr_b16 v[170:171], v28 offset:18432
  v_mfma_f32_16x16x32_bf16 v[156:159], v[204:207], v[68:71], v[156:159]
  ds_read_b64_tr_b16 v[172:173], v29 offset:16384
  v_mfma_f32_16x16x32_bf16 v[152:155], v[204:207], v[64:67], v[152:155]
  ds_read_b64_tr_b16 v[174:175], v29 offset:18432
  s_waitcnt vmcnt(8) lgkmcnt(8)
  v_mfma_f32_16x16x32_bf16 v[128:131], v[208:211], v[72:75], v[128:131]
  ds_read_b64_tr_b16 v[176:177], v26 offset:20480
  v_mfma_f32_16x16x32_bf16 v[132:135], v[208:211], v[76:79], v[132:135]
  ds_read_b64_tr_b16 v[178:179], v26 offset:22528
  v_mfma_f32_16x16x32_bf16 v[140:143], v[212:215], v[76:79], v[140:143]
  ds_read_b64_tr_b16 v[180:181], v27 offset:20480
  v_mfma_f32_16x16x32_bf16 v[136:139], v[212:215], v[72:75], v[136:139]
  ds_read_b64_tr_b16 v[182:183], v27 offset:22528
  v_mfma_f32_16x16x32_bf16 v[144:147], v[216:219], v[72:75], v[144:147]
  ds_read_b64_tr_b16 v[184:185], v28 offset:20480
  v_mfma_f32_16x16x32_bf16 v[148:151], v[216:219], v[76:79], v[148:151]
  ds_read_b64_tr_b16 v[186:187], v28 offset:22528
  v_mfma_f32_16x16x32_bf16 v[156:159], v[220:223], v[76:79], v[156:159]
  ds_read_b64_tr_b16 v[188:189], v29 offset:20480
  v_mfma_f32_16x16x32_bf16 v[152:155], v[220:223], v[72:75], v[152:155]
  ds_read_b64_tr_b16 v[190:191], v29 offset:22528
  s_waitcnt vmcnt(6) lgkmcnt(8)
  v_mfma_f32_16x16x32_bf16 v[128:131], v[160:163], v[80:83], v[128:131]
  ds_read_b64_tr_b16 v[192:193], v26 offset:24576
  v_mfma_f32_16x16x32_bf16 v[132:135], v[160:163], v[84:87], v[132:135]
  ds_read_b64_tr_b16 v[194:195], v26 offset:26624
  v_mfma_f32_16x16x32_bf16 v[140:143], v[164:167], v[84:87], v[140:143]
  ds_read_b64_tr_b16 v[196:197], v27 offset:24576
  v_mfma_f32_16x16x32_bf16 v[136:139], v[164:167], v[80:83], v[136:139]
  ds_read_b64_tr_b16 v[198:199], v27 offset:26624
  v_mfma_f32_16x16x32_bf16 v[144:147], v[168:171], v[80:83], v[144:147]
  ds_read_b64_tr_b16 v[200:201], v28 offset:24576
  v_mfma_f32_16x16x32_bf16 v[148:151], v[168:171], v[84:87], v[148:151]
  ds_read_b64_tr_b16 v[202:203], v28 offset:26624
  v_mfma_f32_16x16x32_bf16 v[156:159], v[172:175], v[84:87], v[156:159]
  ds_read_b64_tr_b16 v[204:205], v29 offset:24576
  v_mfma_f32_16x16x32_bf16 v[152:155], v[172:175], v[80:83], v[152:155]
  ds_read_b64_tr_b16 v[206:207], v29 offset:26624
  s_waitcnt vmcnt(4) lgkmcnt(8)
  v_mfma_f32_16x16x32_bf16 v[128:131], v[176:179], v[88:91], v[128:131]
  ds_read_b64_tr_b16 v[208:209], v26 offset:28672
  v_mfma_f32_16x16x32_bf16 v[132:135], v[176:179], v[92:95], v[132:135]
  ds_read_b64_tr_b16 v[210:211], v26 offset:30720
  v_mfma_f32_16x16x32_bf16 v[140:143], v[180:183], v[92:95], v[140:143]
  ds_read_b64_tr_b16 v[212:213], v27 offset:28672
  v_mfma_f32_16x16x32_bf16 v[136:139], v[180:183], v[88:91], v[136:139]
  ds_read_b64_tr_b16 v[214:215], v27 offset:30720
  v_mfma_f32_16x16x32_bf16 v[144:147], v[184:187], v[88:91], v[144:147]
  ds_read_b64_tr_b16 v[216:217], v28 offset:28672
  v_mfma_f32_16x16x32_bf16 v[148:151], v[184:187], v[92:95], v[148:151]
  ds_read_b64_tr_b16 v[218:219], v28 offset:30720
  v_mfma_f32_16x16x32_bf16 v[156:159], v[188:191], v[92:95], v[156:159]
  ds_read_b64_tr_b16 v[220:221], v29 offset:28672
  v_mfma_f32_16x16x32_bf16 v[152:155], v[188:191], v[88:91], v[152:155]
  ds_read_b64_tr_b16 v[222:223], v29 offset:30720
  s_waitcnt vmcnt(2) lgkmcnt(8)
  v_mfma_f32_16x16x32_bf16 v[128:131], v[192:195], v[224:227], v[128:131]
  ds_read_b64_tr_b16 v[160:161], v6 offset:0
  v_mfma_f32_16x16x32_bf16 v[132:135], v[192:195], v[228:231], v[132:135]
  ds_read_b64_tr_b16 v[162:163], v6 offset:2048
  v_mfma_f32_16x16x32_bf16 v[140:143], v[196:199], v[228:231], v[140:143]
  ds_read_b64_tr_b16 v[164:165], v7 offset:0
  v_mfma_f32_16x16x32_bf16 v[136:139], v[196:199], v[224:227], v[136:139]
  ds_read_b64_tr_b16 v[166:167], v7 offset:2048
  v_mfma_f32_16x16x32_bf16 v[144:147], v[200:203], v[224:227], v[144:147]
  ds_read_b64_tr_b16 v[168:169], v8 offset:0
  v_mfma_f32_16x16x32_bf16 v[148:151], v[200:203], v[228:231], v[148:151]
  ds_read_b64_tr_b16 v[170:171], v8 offset:2048
  v_mfma_f32_16x16x32_bf16 v[156:159], v[204:207], v[228:231], v[156:159]
  ds_read_b64_tr_b16 v[172:173], v9 offset:0
  v_mfma_f32_16x16x32_bf16 v[152:155], v[204:207], v[224:227], v[152:155]
  ds_read_b64_tr_b16 v[174:175], v9 offset:2048
  s_waitcnt vmcnt(0) lgkmcnt(8)
  s_barrier
  v_mfma_f32_16x16x32_bf16 v[128:131], v[208:211], v[232:235], v[128:131]
  ds_read_b64_tr_b16 v[176:177], v6 offset:4096
  v_mfma_f32_16x16x32_bf16 v[132:135], v[208:211], v[236:239], v[132:135]
  ds_read_b64_tr_b16 v[178:179], v6 offset:6144
  v_mfma_f32_16x16x32_bf16 v[140:143], v[212:215], v[236:239], v[140:143]
  ds_read_b64_tr_b16 v[180:181], v7 offset:4096
  v_mfma_f32_16x16x32_bf16 v[136:139], v[212:215], v[232:235], v[136:139]
  ds_read_b64_tr_b16 v[182:183], v7 offset:6144
  v_mfma_f32_16x16x32_bf16 v[144:147], v[216:219], v[232:235], v[144:147]
  ds_read_b64_tr_b16 v[184:185], v8 offset:4096
  v_mfma_f32_16x16x32_bf16 v[148:151], v[216:219], v[236:239], v[148:151]
  ds_read_b64_tr_b16 v[186:187], v8 offset:6144
  v_mfma_f32_16x16x32_bf16 v[156:159], v[220:223], v[236:239], v[156:159]
  ds_read_b64_tr_b16 v[188:189], v9 offset:4096
  v_mfma_f32_16x16x32_bf16 v[152:155], v[220:223], v[232:235], v[152:155]
  ds_read_b64_tr_b16 v[190:191], v9 offset:6144
  s_waitcnt lgkmcnt(8)
  v_mfma_f32_16x16x32_bf16 v[96:99], v[160:163], v[240:243], v[96:99]
  ds_read_b64_tr_b16 v[192:193], v6 offset:8192
  v_mfma_f32_16x16x32_bf16 v[100:103], v[160:163], v[244:247], v[100:103]
  ds_read_b64_tr_b16 v[194:195], v6 offset:10240
  v_mfma_f32_16x16x32_bf16 v[108:111], v[164:167], v[244:247], v[108:111]
  ds_read_b64_tr_b16 v[196:197], v7 offset:8192
  v_cvt_pk_bf16_f32 v128, v128, v129
  v_mfma_f32_16x16x32_bf16 v[104:107], v[164:167], v[240:243], v[104:107]
  ds_read_b64_tr_b16 v[198:199], v7 offset:10240
  v_cvt_pk_bf16_f32 v129, v130, v131
  v_mfma_f32_16x16x32_bf16 v[112:115], v[168:171], v[240:243], v[112:115]
  ds_read_b64_tr_b16 v[200:201], v8 offset:8192
  v_cvt_pk_bf16_f32 v130, v132, v133
  v_mfma_f32_16x16x32_bf16 v[116:119], v[168:171], v[244:247], v[116:119]
  ds_read_b64_tr_b16 v[202:203], v8 offset:10240
  v_cvt_pk_bf16_f32 v131, v134, v135
  v_mfma_f32_16x16x32_bf16 v[124:127], v[172:175], v[244:247], v[124:127]
  ds_read_b64_tr_b16 v[204:205], v9 offset:8192
  buffer_store_dwordx4 v[128:131], off, s[60:63], s4 offset:0 sc1
  v_mfma_f32_16x16x32_bf16 v[120:123], v[172:175], v[240:243], v[120:123]
  ds_read_b64_tr_b16 v[206:207], v9 offset:10240
  s_waitcnt lgkmcnt(8)
  v_mfma_f32_16x16x32_bf16 v[96:99], v[176:179], v[248:251], v[96:99]
  ds_read_b64_tr_b16 v[208:209], v6 offset:12288
  v_cvt_pk_bf16_f32 v132, v136, v137
  v_mfma_f32_16x16x32_bf16 v[100:103], v[176:179], v[252:255], v[100:103]
  ds_read_b64_tr_b16 v[210:211], v6 offset:14336
  v_cvt_pk_bf16_f32 v133, v138, v139
  v_mfma_f32_16x16x32_bf16 v[108:111], v[180:183], v[252:255], v[108:111]
  ds_read_b64_tr_b16 v[212:213], v7 offset:12288
  v_cvt_pk_bf16_f32 v134, v140, v141
  v_mfma_f32_16x16x32_bf16 v[104:107], v[180:183], v[248:251], v[104:107]
  ds_read_b64_tr_b16 v[214:215], v7 offset:14336
  v_cvt_pk_bf16_f32 v135, v142, v143
  v_mfma_f32_16x16x32_bf16 v[112:115], v[184:187], v[248:251], v[112:115]
  ds_read_b64_tr_b16 v[216:217], v8 offset:12288
  buffer_store_dwordx4 v[132:135], off, s[60:63], s4 offset:1024 sc1
  v_mfma_f32_16x16x32_bf16 v[116:119], v[184:187], v[252:255], v[116:119]
  ds_read_b64_tr_b16 v[218:219], v8 offset:14336
  v_readlane_b32 s51, v15, 23
  v_mfma_f32_16x16x32_bf16 v[124:127], v[188:191], v[252:255], v[124:127]
  ds_read_b64_tr_b16 v[220:221], v9 offset:12288
  v_cvt_pk_bf16_f32 v136, v144, v145
  v_mfma_f32_16x16x32_bf16 v[120:123], v[188:191], v[248:251], v[120:123]
  ds_read_b64_tr_b16 v[222:223], v9 offset:14336
  s_waitcnt lgkmcnt(8)
  v_mfma_f32_16x16x32_bf16 v[96:99], v[192:195], v[32:35], v[96:99]
  ds_read_b64_tr_b16 v[160:161], v6 offset:16384
  buffer_load_dwordx4 v[240:243], off, s[36:39], s51 offset:0 sc1
  v_mfma_f32_16x16x32_bf16 v[100:103], v[192:195], v[36:39], v[100:103]
  ds_read_b64_tr_b16 v[162:163], v6 offset:18432
  v_cvt_pk_bf16_f32 v137, v146, v147
  v_mfma_f32_16x16x32_bf16 v[108:111], v[196:199], v[36:39], v[108:111]
  ds_read_b64_tr_b16 v[164:165], v7 offset:16384
  v_cvt_pk_bf16_f32 v138, v148, v149
  v_mfma_f32_16x16x32_bf16 v[104:107], v[196:199], v[32:35], v[104:107]
  ds_read_b64_tr_b16 v[166:167], v7 offset:18432
  v_cvt_pk_bf16_f32 v139, v150, v151
  v_mfma_f32_16x16x32_bf16 v[112:115], v[200:203], v[32:35], v[112:115]
  ds_read_b64_tr_b16 v[168:169], v8 offset:16384
  buffer_load_dwordx4 v[244:247], off, s[64:67], s51 offset:0 sc1
  v_mfma_f32_16x16x32_bf16 v[116:119], v[200:203], v[36:39], v[116:119]
  ds_read_b64_tr_b16 v[170:171], v8 offset:18432
  buffer_store_dwordx4 v[136:139], off, s[60:63], s4 offset:2048 sc1
  v_mfma_f32_16x16x32_bf16 v[124:127], v[204:207], v[36:39], v[124:127]
  ds_read_b64_tr_b16 v[172:173], v9 offset:16384
  v_cvt_pk_bf16_f32 v140, v152, v153
  v_mfma_f32_16x16x32_bf16 v[120:123], v[204:207], v[32:35], v[120:123]
  ds_read_b64_tr_b16 v[174:175], v9 offset:18432
  s_waitcnt lgkmcnt(8)
  v_mfma_f32_16x16x32_bf16 v[96:99], v[208:211], v[40:43], v[96:99]
  ds_read_b64_tr_b16 v[176:177], v6 offset:20480
  buffer_load_dwordx4 v[248:251], off, s[36:39], s51 offset:1024 sc1
  v_mfma_f32_16x16x32_bf16 v[100:103], v[208:211], v[44:47], v[100:103]
  ds_read_b64_tr_b16 v[178:179], v6 offset:22528
  v_cvt_pk_bf16_f32 v141, v154, v155
  v_mfma_f32_16x16x32_bf16 v[108:111], v[212:215], v[44:47], v[108:111]
  ds_read_b64_tr_b16 v[180:181], v7 offset:20480
  v_cvt_pk_bf16_f32 v142, v156, v157
  v_mfma_f32_16x16x32_bf16 v[104:107], v[212:215], v[40:43], v[104:107]
  ds_read_b64_tr_b16 v[182:183], v7 offset:22528
  v_cvt_pk_bf16_f32 v143, v158, v159
  v_mfma_f32_16x16x32_bf16 v[112:115], v[216:219], v[40:43], v[112:115]
  ds_read_b64_tr_b16 v[184:185], v8 offset:20480
  buffer_load_dwordx4 v[252:255], off, s[64:67], s51 offset:1024 sc1
  v_mfma_f32_16x16x32_bf16 v[116:119], v[216:219], v[44:47], v[116:119]
  ds_read_b64_tr_b16 v[186:187], v8 offset:22528
  buffer_store_dwordx4 v[140:143], off, s[60:63], s4 offset:3072 sc1
  v_mfma_f32_16x16x32_bf16 v[124:127], v[220:223], v[44:47], v[124:127]
  ds_read_b64_tr_b16 v[188:189], v9 offset:20480
  v_readlane_b32 s48, v15, 24
  v_mfma_f32_16x16x32_bf16 v[120:123], v[220:223], v[40:43], v[120:123]
  ds_read_b64_tr_b16 v[190:191], v9 offset:22528
  s_waitcnt lgkmcnt(8)
  v_mfma_f32_16x16x32_bf16 v[96:99], v[160:163], v[48:51], v[96:99]
  ds_read_b64_tr_b16 v[192:193], v6 offset:24576
  v_mfma_f32_16x16x32_bf16 v[100:103], v[160:163], v[52:55], v[100:103]
  buffer_load_dwordx4 v[32:35], off, s[36:39], s48 offset:0 sc1
  v_mfma_f32_16x16x32_bf16 v[108:111], v[164:167], v[52:55], v[108:111]
  ds_read_b64_tr_b16 v[194:195], v6 offset:26624
  ds_read_b64_tr_b16 v[196:197], v7 offset:24576
  v_mfma_f32_16x16x32_bf16 v[104:107], v[164:167], v[48:51], v[104:107]
  ds_read_b64_tr_b16 v[198:199], v7 offset:26624
  v_mfma_f32_16x16x32_bf16 v[112:115], v[168:171], v[48:51], v[112:115]
  ds_read_b64_tr_b16 v[200:201], v8 offset:24576
  v_mfma_f32_16x16x32_bf16 v[116:119], v[168:171], v[52:55], v[116:119]
  buffer_load_dwordx4 v[36:39], off, s[64:67], s48 offset:0 sc1
  v_mfma_f32_16x16x32_bf16 v[124:127], v[172:175], v[52:55], v[124:127]
  ds_read_b64_tr_b16 v[202:203], v8 offset:26624
  ds_read_b64_tr_b16 v[204:205], v9 offset:24576
  v_mfma_f32_16x16x32_bf16 v[120:123], v[172:175], v[48:51], v[120:123]
  ds_read_b64_tr_b16 v[206:207], v9 offset:26624
  s_waitcnt lgkmcnt(8)
  v_mfma_f32_16x16x32_bf16 v[96:99], v[176:179], v[56:59], v[96:99]
  ds_read_b64_tr_b16 v[208:209], v6 offset:28672
  v_mfma_f32_16x16x32_bf16 v[100:103], v[176:179], v[60:63], v[100:103]
  buffer_load_dwordx4 v[40:43], off, s[36:39], s48 offset:1024 sc1
  v_mfma_f32_16x16x32_bf16 v[108:111], v[180:183], v[60:63], v[108:111]
  ds_read_b64_tr_b16 v[210:211], v6 offset:30720
  ds_read_b64_tr_b16 v[212:213], v7 offset:28672
  v_mfma_f32_16x16x32_bf16 v[104:107], v[180:183], v[56:59], v[104:107]
  ds_read_b64_tr_b16 v[214:215], v7 offset:30720
  v_mfma_f32_16x16x32_bf16 v[112:115], v[184:187], v[56:59], v[112:115]
  ds_read_b64_tr_b16 v[216:217], v8 offset:28672
  v_mfma_f32_16x16x32_bf16 v[116:119], v[184:187], v[60:63], v[116:119]
  buffer_load_dwordx4 v[44:47], off, s[64:67], s48 offset:1024 sc1
  v_mfma_f32_16x16x32_bf16 v[124:127], v[188:191], v[60:63], v[124:127]
  ds_read_b64_tr_b16 v[218:219], v8 offset:30720
  ds_read_b64_tr_b16 v[220:221], v9 offset:28672
  v_mfma_f32_16x16x32_bf16 v[120:123], v[188:191], v[56:59], v[120:123]
  ds_read_b64_tr_b16 v[222:223], v9 offset:30720
  s_waitcnt lgkmcnt(8)
  v_mfma_f32_16x16x32_bf16 v[96:99], v[192:195], v[64:67], v[96:99]
  ds_read_b64_tr_b16 v[160:161], v6 offset:32768
  v_readlane_b32 s49, v15, 25
  v_mfma_f32_16x16x32_bf16 v[100:103], v[192:195], v[68:71], v[100:103]
  ds_read_b64_tr_b16 v[162:163], v6 offset:34816
  v_mfma_f32_16x16x32_bf16 v[108:111], v[196:199], v[68:71], v[108:111]
  ds_read_b64_tr_b16 v[164:165], v7 offset:32768
  v_mfma_f32_16x16x32_bf16 v[104:107], v[196:199], v[64:67], v[104:107]
  buffer_load_dwordx4 v[48:51], off, s[36:39], s49 offset:0 sc1
  v_mfma_f32_16x16x32_bf16 v[112:115], v[200:203], v[64:67], v[112:115]
  ds_read_b64_tr_b16 v[166:167], v7 offset:34816
  ds_read_b64_tr_b16 v[168:169], v8 offset:32768
  v_mfma_f32_16x16x32_bf16 v[116:119], v[200:203], v[68:71], v[116:119]
  ds_read_b64_tr_b16 v[170:171], v8 offset:34816
  v_mfma_f32_16x16x32_bf16 v[124:127], v[204:207], v[68:71], v[124:127]
  ds_read_b64_tr_b16 v[172:173], v9 offset:32768
  v_mfma_f32_16x16x32_bf16 v[120:123], v[204:207], v[64:67], v[120:123]
  ds_read_b64_tr_b16 v[174:175], v9 offset:34816
  s_waitcnt lgkmcnt(8)
  s_barrier
  v_mfma_f32_16x16x32_bf16 v[96:99], v[208:211], v[72:75], v[96:99]
  buffer_load_dwordx4 v[52:55], off, s[64:67], s49 offset:0 sc1
  v_mfma_f32_16x16x32_bf16 v[100:103], v[208:211], v[76:79], v[100:103]
  ds_read_b64_tr_b16 v[176:177], v6 offset:36864
  ds_read_b64_tr_b16 v[178:179], v6 offset:38912
  v_mfma_f32_16x16x32_bf16 v[108:111], v[212:215], v[76:79], v[108:111]
  ds_read_b64_tr_b16 v[180:181], v7 offset:36864
  v_mfma_f32_16x16x32_bf16 v[104:107], v[212:215], v[72:75], v[104:107]
  ds_read_b64_tr_b16 v[182:183], v7 offset:38912
  v_mfma_f32_16x16x32_bf16 v[112:115], v[216:219], v[72:75], v[112:115]
  buffer_load_dwordx4 v[56:59], off, s[36:39], s49 offset:1024 sc1
  v_mfma_f32_16x16x32_bf16 v[116:119], v[216:219], v[76:79], v[116:119]
  ds_read_b64_tr_b16 v[184:185], v8 offset:36864
  ds_read_b64_tr_b16 v[186:187], v8 offset:38912
  v_mfma_f32_16x16x32_bf16 v[124:127], v[220:223], v[76:79], v[124:127]
  ds_read_b64_tr_b16 v[188:189], v9 offset:36864
  v_mfma_f32_16x16x32_bf16 v[120:123], v[220:223], v[72:75], v[120:123]
  ds_read_b64_tr_b16 v[190:191], v9 offset:38912
  s_waitcnt lgkmcnt(8)
  v_mfma_f32_16x16x32_bf16 v[96:99], v[160:163], v[80:83], v[96:99]
  ds_read_b64_tr_b16 v[192:193], v6 offset:40960
  buffer_load_dwordx4 v[60:63], off, s[64:67], s49 offset:1024 sc1
  v_mfma_f32_16x16x32_bf16 v[100:103], v[160:163], v[84:87], v[100:103]
  ds_read_b64_tr_b16 v[194:195], v6 offset:43008
  s_waitcnt vmcnt(8)
  v_mfma_f32_16x16x32_bf16 v[108:111], v[164:167], v[84:87], v[108:111]
  ds_read_b64_tr_b16 v[196:197], v7 offset:40960
  v_readlane_b32 s50, v15, 26
  v_mfma_f32_16x16x32_bf16 v[104:107], v[164:167], v[80:83], v[104:107]
  buffer_store_dword v19, off, s[52:55], s6 sc1
  v_mfma_f32_16x16x32_bf16 v[112:115], v[168:171], v[80:83], v[112:115]
  ds_read_b64_tr_b16 v[198:199], v7 offset:43008
  ds_read_b64_tr_b16 v[200:201], v8 offset:40960
  v_mfma_f32_16x16x32_bf16 v[116:119], v[168:171], v[84:87], v[116:119]
  buffer_load_dwordx4 v[64:67], off, s[36:39], s50 offset:0 sc1
  v_mfma_f32_16x16x32_bf16 v[124:127], v[172:175], v[84:87], v[124:127]
  ds_read_b64_tr_b16 v[202:203], v8 offset:43008
  ds_read_b64_tr_b16 v[204:205], v9 offset:40960
  v_mfma_f32_16x16x32_bf16 v[120:123], v[172:175], v[80:83], v[120:123]
  ds_read_b64_tr_b16 v[206:207], v9 offset:43008
  s_waitcnt lgkmcnt(8)
  v_mfma_f32_16x16x32_bf16 v[96:99], v[176:179], v[88:91], v[96:99]
  ds_read_b64_tr_b16 v[208:209], v6 offset:45056
  v_mfma_f32_16x16x32_bf16 v[100:103], v[176:179], v[92:95], v[100:103]
  buffer_load_dwordx4 v[68:71], off, s[64:67], s50 offset:0 sc1
  v_mfma_f32_16x16x32_bf16 v[108:111], v[180:183], v[92:95], v[108:111]
  ds_read_b64_tr_b16 v[210:211], v6 offset:47104
  ds_read_b64_tr_b16 v[212:213], v7 offset:45056
  v_mfma_f32_16x16x32_bf16 v[104:107], v[180:183], v[88:91], v[104:107]
  ds_read_b64_tr_b16 v[214:215], v7 offset:47104
  v_mfma_f32_16x16x32_bf16 v[112:115], v[184:187], v[88:91], v[112:115]
  ds_read_b64_tr_b16 v[216:217], v8 offset:45056
  v_mfma_f32_16x16x32_bf16 v[116:119], v[184:187], v[92:95], v[116:119]
  buffer_load_dwordx4 v[72:75], off, s[36:39], s50 offset:1024 sc1
  v_mfma_f32_16x16x32_bf16 v[124:127], v[188:191], v[92:95], v[124:127]
  ds_read_b64_tr_b16 v[218:219], v8 offset:47104
  ds_read_b64_tr_b16 v[220:221], v9 offset:45056
  v_mfma_f32_16x16x32_bf16 v[120:123], v[188:191], v[88:91], v[120:123]
  ds_read_b64_tr_b16 v[222:223], v9 offset:47104
  s_waitcnt lgkmcnt(8)
  v_mfma_f32_16x16x32_bf16 v[96:99], v[192:195], v[224:227], v[96:99]
  ds_read_b64_tr_b16 v[160:161], v6 offset:49152
  v_mfma_f32_16x16x32_bf16 v[100:103], v[192:195], v[228:231], v[100:103]
  buffer_load_dwordx4 v[76:79], off, s[64:67], s50 offset:1024 sc1
  v_mfma_f32_16x16x32_bf16 v[108:111], v[196:199], v[228:231], v[108:111]
  ds_read_b64_tr_b16 v[162:163], v6 offset:51200
  ds_read_b64_tr_b16 v[164:165], v7 offset:49152
  v_mfma_f32_16x16x32_bf16 v[104:107], v[196:199], v[224:227], v[104:107]
  ds_read_b64_tr_b16 v[166:167], v7 offset:51200
  v_readlane_b32 s51, v15, 27
  v_mfma_f32_16x16x32_bf16 v[112:115], v[200:203], v[224:227], v[112:115]
  ds_read_b64_tr_b16 v[168:169], v8 offset:49152
  v_mfma_f32_16x16x32_bf16 v[116:119], v[200:203], v[228:231], v[116:119]
  ds_read_b64_tr_b16 v[170:171], v8 offset:51200
  ds_read_b64_tr_b16 v[172:173], v9 offset:49152
  v_mfma_f32_16x16x32_bf16 v[124:127], v[204:207], v[228:231], v[124:127]
  buffer_load_dwordx4 v[80:83], off, s[36:39], s51 offset:0 sc1
  v_mfma_f32_16x16x32_bf16 v[120:123], v[204:207], v[224:227], v[120:123]
  ds_read_b64_tr_b16 v[174:175], v9 offset:51200
  s_waitcnt lgkmcnt(8)
  v_mfma_f32_16x16x32_bf16 v[96:99], v[208:211], v[232:235], v[96:99]
  ds_read_b64_tr_b16 v[176:177], v6 offset:53248
  v_mfma_f32_16x16x32_bf16 v[100:103], v[208:211], v[236:239], v[100:103]
  ds_read_b64_tr_b16 v[178:179], v6 offset:55296
  v_mfma_f32_16x16x32_bf16 v[108:111], v[212:215], v[236:239], v[108:111]
  buffer_load_dwordx4 v[84:87], off, s[64:67], s51 offset:0 sc1
  v_mfma_f32_16x16x32_bf16 v[104:107], v[212:215], v[232:235], v[104:107]
  ds_read_b64_tr_b16 v[180:181], v7 offset:53248
  ds_read_b64_tr_b16 v[182:183], v7 offset:55296
  v_mfma_f32_16x16x32_bf16 v[112:115], v[216:219], v[232:235], v[112:115]
  ds_read_b64_tr_b16 v[184:185], v8 offset:53248
  v_mfma_f32_16x16x32_bf16 v[116:119], v[216:219], v[236:239], v[116:119]
  ds_read_b64_tr_b16 v[186:187], v8 offset:55296
  ds_read_b64_tr_b16 v[188:189], v9 offset:53248
  v_mfma_f32_16x16x32_bf16 v[124:127], v[220:223], v[236:239], v[124:127]
  buffer_load_dwordx4 v[88:91], off, s[36:39], s51 offset:1024 sc1
  v_mfma_f32_16x16x32_bf16 v[120:123], v[220:223], v[232:235], v[120:123]
  ds_read_b64_tr_b16 v[190:191], v9 offset:55296
  s_waitcnt lgkmcnt(8)
  v_mfma_f32_16x16x32_bf16 v[96:99], v[160:163], v[240:243], v[96:99]
  ds_read_b64_tr_b16 v[192:193], v6 offset:57344
  v_mfma_f32_16x16x32_bf16 v[100:103], v[160:163], v[244:247], v[100:103]
  ds_read_b64_tr_b16 v[194:195], v6 offset:59392
  v_mfma_f32_16x16x32_bf16 v[108:111], v[164:167], v[244:247], v[108:111]
  buffer_load_dwordx4 v[92:95], off, s[64:67], s51 offset:1024 sc1
  v_mfma_f32_16x16x32_bf16 v[104:107], v[164:167], v[240:243], v[104:107]
  ds_read_b64_tr_b16 v[196:197], v7 offset:57344
  ds_read_b64_tr_b16 v[198:199], v7 offset:59392
  v_mfma_f32_16x16x32_bf16 v[112:115], v[168:171], v[240:243], v[112:115]
  ds_read_b64_tr_b16 v[200:201], v8 offset:57344
  v_readlane_b32 s48, v15, 28
  v_mfma_f32_16x16x32_bf16 v[116:119], v[168:171], v[244:247], v[116:119]
  ds_read_b64_tr_b16 v[202:203], v8 offset:59392
  v_mfma_f32_16x16x32_bf16 v[124:127], v[172:175], v[244:247], v[124:127]
  ds_read_b64_tr_b16 v[204:205], v9 offset:57344
  v_mfma_f32_16x16x32_bf16 v[120:123], v[172:175], v[240:243], v[120:123]
  ds_read_b64_tr_b16 v[206:207], v9 offset:59392
  s_waitcnt lgkmcnt(8)
  v_mfma_f32_16x16x32_bf16 v[96:99], v[176:179], v[248:251], v[96:99]
  buffer_load_dwordx4 v[224:227], off, s[36:39], s48 offset:0 sc1
  v_mfma_f32_16x16x32_bf16 v[100:103], v[176:179], v[252:255], v[100:103]
  ds_read_b64_tr_b16 v[208:209], v6 offset:61440
  ds_read_b64_tr_b16 v[210:211], v6 offset:63488
  v_mfma_f32_16x16x32_bf16 v[108:111], v[180:183], v[252:255], v[108:111]
  ds_read_b64_tr_b16 v[212:213], v7 offset:61440
  v_mfma_f32_16x16x32_bf16 v[104:107], v[180:183], v[248:251], v[104:107]
  ds_read_b64_tr_b16 v[214:215], v7 offset:63488
  v_mfma_f32_16x16x32_bf16 v[112:115], v[184:187], v[248:251], v[112:115]
  buffer_load_dwordx4 v[228:231], off, s[64:67], s48 offset:0 sc1
  v_mfma_f32_16x16x32_bf16 v[116:119], v[184:187], v[252:255], v[116:119]
  ds_read_b64_tr_b16 v[216:217], v8 offset:61440
  ds_read_b64_tr_b16 v[218:219], v8 offset:63488
  v_mfma_f32_16x16x32_bf16 v[124:127], v[188:191], v[252:255], v[124:127]
  ds_read_b64_tr_b16 v[220:221], v9 offset:61440
  v_mfma_f32_16x16x32_bf16 v[120:123], v[188:191], v[248:251], v[120:123]
  ds_read_b64_tr_b16 v[222:223], v9 offset:63488
  s_waitcnt vmcnt(17) lgkmcnt(8)
  v_mfma_f32_16x16x32_bf16 v[96:99], v[192:195], v[32:35], v[96:99]
  buffer_load_dwordx4 v[232:235], off, s[36:39], s48 offset:1024 sc1
  v_mfma_f32_16x16x32_bf16 v[100:103], v[192:195], v[36:39], v[100:103]
  ds_read_b64_tr_b16 v[160:161], v20 offset:0
  ds_read_b64_tr_b16 v[162:163], v20 offset:2048
  v_mfma_f32_16x16x32_bf16 v[108:111], v[196:199], v[36:39], v[108:111]
  ds_read_b64_tr_b16 v[164:165], v21 offset:0
  v_mfma_f32_16x16x32_bf16 v[104:107], v[196:199], v[32:35], v[104:107]
  ds_read_b64_tr_b16 v[166:167], v21 offset:2048
  v_mfma_f32_16x16x32_bf16 v[112:115], v[200:203], v[32:35], v[112:115]
  buffer_load_dwordx4 v[236:239], off, s[64:67], s48 offset:1024 sc1
  v_mfma_f32_16x16x32_bf16 v[116:119], v[200:203], v[36:39], v[116:119]
  ds_read_b64_tr_b16 v[168:169], v22 offset:0
  ds_read_b64_tr_b16 v[170:171], v22 offset:2048
  v_mfma_f32_16x16x32_bf16 v[124:127], v[204:207], v[36:39], v[124:127]
  ds_read_b64_tr_b16 v[172:173], v23 offset:0
  v_readlane_b32 s49, v15, 29
  v_mfma_f32_16x16x32_bf16 v[120:123], v[204:207], v[32:35], v[120:123]
  ds_read_b64_tr_b16 v[174:175], v23 offset:2048
  s_waitcnt vmcnt(17) lgkmcnt(8)
  v_mfma_f32_16x16x32_bf16 v[96:99], v[208:211], v[40:43], v[96:99]
  ds_read_b64_tr_b16 v[176:177], v20 offset:4096
  v_mfma_f32_16x16x32_bf16 v[100:103], v[208:211], v[44:47], v[100:103]
  buffer_load_dwordx4 v[240:243], off, s[36:39], s49 offset:0 sc1
  v_mfma_f32_16x16x32_bf16 v[108:111], v[212:215], v[44:47], v[108:111]
  ds_read_b64_tr_b16 v[178:179], v20 offset:6144
  ds_read_b64_tr_b16 v[180:181], v21 offset:4096
  v_mfma_f32_16x16x32_bf16 v[104:107], v[212:215], v[40:43], v[104:107]
  ds_read_b64_tr_b16 v[182:183], v21 offset:6144
  v_mfma_f32_16x16x32_bf16 v[112:115], v[216:219], v[40:43], v[112:115]
  ds_read_b64_tr_b16 v[184:185], v22 offset:4096
  v_mfma_f32_16x16x32_bf16 v[116:119], v[216:219], v[44:47], v[116:119]
  buffer_load_dwordx4 v[244:247], off, s[64:67], s49 offset:0 sc1
  v_mfma_f32_16x16x32_bf16 v[124:127], v[220:223], v[44:47], v[124:127]
  ds_read_b64_tr_b16 v[186:187], v22 offset:6144
  ds_read_b64_tr_b16 v[188:189], v23 offset:4096
  v_mfma_f32_16x16x32_bf16 v[120:123], v[220:223], v[40:43], v[120:123]
  ds_read_b64_tr_b16 v[190:191], v23 offset:6144
  s_waitcnt vmcnt(17) lgkmcnt(8)
  v_mfma_f32_16x16x32_bf16 v[96:99], v[160:163], v[48:51], v[96:99]
  ds_read_b64_tr_b16 v[192:193], v20 offset:8192
  v_mfma_f32_16x16x32_bf16 v[100:103], v[160:163], v[52:55], v[100:103]
  buffer_load_dwordx4 v[248:251], off, s[36:39], s49 offset:1024 sc1
  v_mfma_f32_16x16x32_bf16 v[108:111], v[164:167], v[52:55], v[108:111]
  ds_read_b64_tr_b16 v[194:195], v20 offset:10240
  ds_read_b64_tr_b16 v[196:197], v21 offset:8192
  v_mfma_f32_16x16x32_bf16 v[104:107], v[164:167], v[48:51], v[104:107]
  ds_read_b64_tr_b16 v[198:199], v21 offset:10240
  v_mfma_f32_16x16x32_bf16 v[112:115], v[168:171], v[48:51], v[112:115]
  ds_read_b64_tr_b16 v[200:201], v22 offset:8192
  v_mfma_f32_16x16x32_bf16 v[116:119], v[168:171], v[52:55], v[116:119]
  buffer_load_dwordx4 v[252:255], off, s[64:67], s49 offset:1024 sc1
  v_mfma_f32_16x16x32_bf16 v[124:127], v[172:175], v[52:55], v[124:127]
  ds_read_b64_tr_b16 v[202:203], v22 offset:10240
  ds_read_b64_tr_b16 v[204:205], v23 offset:8192
  v_mfma_f32_16x16x32_bf16 v[120:123], v[172:175], v[48:51], v[120:123]
  ds_read_b64_tr_b16 v[206:207], v23 offset:10240
  s_waitcnt vmcnt(17) lgkmcnt(8)
  v_mfma_f32_16x16x32_bf16 v[96:99], v[176:179], v[56:59], v[96:99]
  ds_read_b64_tr_b16 v[208:209], v20 offset:12288
  v_readlane_b32 s50, v15, 30
  v_mfma_f32_16x16x32_bf16 v[100:103], v[176:179], v[60:63], v[100:103]
  ds_read_b64_tr_b16 v[210:211], v20 offset:14336
  v_mfma_f32_16x16x32_bf16 v[108:111], v[180:183], v[60:63], v[108:111]
  ds_read_b64_tr_b16 v[212:213], v21 offset:12288
  v_mfma_f32_16x16x32_bf16 v[104:107], v[180:183], v[56:59], v[104:107]
  buffer_load_dwordx4 v[32:35], off, s[36:39], s50 offset:0 sc1
  v_mfma_f32_16x16x32_bf16 v[112:115], v[184:187], v[56:59], v[112:115]
  ds_read_b64_tr_b16 v[214:215], v21 offset:14336
  ds_read_b64_tr_b16 v[216:217], v22 offset:12288
  v_mfma_f32_16x16x32_bf16 v[116:119], v[184:187], v[60:63], v[116:119]
  ds_read_b64_tr_b16 v[218:219], v22 offset:14336
  v_mfma_f32_16x16x32_bf16 v[124:127], v[188:191], v[60:63], v[124:127]
  ds_read_b64_tr_b16 v[220:221], v23 offset:12288
  v_mfma_f32_16x16x32_bf16 v[120:123], v[188:191], v[56:59], v[120:123]
  ds_read_b64_tr_b16 v[222:223], v23 offset:14336
  s_waitcnt vmcnt(15) lgkmcnt(8)
  v_mfma_f32_16x16x32_bf16 v[96:99], v[192:195], v[64:67], v[96:99]
  buffer_load_dwordx4 v[36:39], off, s[64:67], s50 offset:0 sc1
  v_mfma_f32_16x16x32_bf16 v[100:103], v[192:195], v[68:71], v[100:103]
  ds_read_b64_tr_b16 v[160:161], v20 offset:16384
  ds_read_b64_tr_b16 v[162:163], v20 offset:18432
  v_mfma_f32_16x16x32_bf16 v[108:111], v[196:199], v[68:71], v[108:111]
  ds_read_b64_tr_b16 v[164:165], v21 offset:16384
  v_mfma_f32_16x16x32_bf16 v[104:107], v[196:199], v[64:67], v[104:107]
  ds_read_b64_tr_b16 v[166:167], v21 offset:18432
  v_mfma_f32_16x16x32_bf16 v[112:115], v[200:203], v[64:67], v[112:115]
  buffer_load_dwordx4 v[40:43], off, s[36:39], s50 offset:1024 sc1
  v_mfma_f32_16x16x32_bf16 v[116:119], v[200:203], v[68:71], v[116:119]
  ds_read_b64_tr_b16 v[168:169], v22 offset:16384
  ds_read_b64_tr_b16 v[170:171], v22 offset:18432
  v_mfma_f32_16x16x32_bf16 v[124:127], v[204:207], v[68:71], v[124:127]
  ds_read_b64_tr_b16 v[172:173], v23 offset:16384
  v_mfma_f32_16x16x32_bf16 v[120:123], v[204:207], v[64:67], v[120:123]
  ds_read_b64_tr_b16 v[174:175], v23 offset:18432
  s_waitcnt vmcnt(15) lgkmcnt(8)
  v_mfma_f32_16x16x32_bf16 v[96:99], v[208:211], v[72:75], v[96:99]
  buffer_load_dwordx4 v[44:47], off, s[64:67], s50 offset:1024 sc1
  v_mfma_f32_16x16x32_bf16 v[100:103], v[208:211], v[76:79], v[100:103]
  ds_read_b64_tr_b16 v[176:177], v20 offset:20480
  ds_read_b64_tr_b16 v[178:179], v20 offset:22528
  v_mfma_f32_16x16x32_bf16 v[108:111], v[212:215], v[76:79], v[108:111]
  ds_read_b64_tr_b16 v[180:181], v21 offset:20480
  v_readlane_b32 s51, v15, 31
  v_mfma_f32_16x16x32_bf16 v[104:107], v[212:215], v[72:75], v[104:107]
  ds_read_b64_tr_b16 v[182:183], v21 offset:22528
  v_mfma_f32_16x16x32_bf16 v[112:115], v[216:219], v[72:75], v[112:115]
  ds_read_b64_tr_b16 v[184:185], v22 offset:20480
  v_mfma_f32_16x16x32_bf16 v[116:119], v[216:219], v[76:79], v[116:119]
  buffer_load_dwordx4 v[48:51], off, s[36:39], s51 offset:0 sc1
  v_mfma_f32_16x16x32_bf16 v[124:127], v[220:223], v[76:79], v[124:127]
  ds_read_b64_tr_b16 v[186:187], v22 offset:22528
  ds_read_b64_tr_b16 v[188:189], v23 offset:20480
  v_mfma_f32_16x16x32_bf16 v[120:123], v[220:223], v[72:75], v[120:123]
  ds_read_b64_tr_b16 v[190:191], v23 offset:22528
  s_waitcnt vmcnt(15) lgkmcnt(8)
  v_mfma_f32_16x16x32_bf16 v[96:99], v[160:163], v[80:83], v[96:99]
  ds_read_b64_tr_b16 v[192:193], v20 offset:24576
  v_mfma_f32_16x16x32_bf16 v[100:103], v[160:163], v[84:87], v[100:103]
  buffer_load_dwordx4 v[52:55], off, s[64:67], s51 offset:0 sc1
  v_mfma_f32_16x16x32_bf16 v[108:111], v[164:167], v[84:87], v[108:111]
  ds_read_b64_tr_b16 v[194:195], v20 offset:26624
  ds_read_b64_tr_b16 v[196:197], v21 offset:24576
  v_mfma_f32_16x16x32_bf16 v[104:107], v[164:167], v[80:83], v[104:107]
  ds_read_b64_tr_b16 v[198:199], v21 offset:26624
  v_mfma_f32_16x16x32_bf16 v[112:115], v[168:171], v[80:83], v[112:115]
  ds_read_b64_tr_b16 v[200:201], v22 offset:24576
  v_mfma_f32_16x16x32_bf16 v[116:119], v[168:171], v[84:87], v[116:119]
  buffer_load_dwordx4 v[56:59], off, s[36:39], s51 offset:1024 sc1
  v_mfma_f32_16x16x32_bf16 v[124:127], v[172:175], v[84:87], v[124:127]
  ds_read_b64_tr_b16 v[202:203], v22 offset:26624
  ds_read_b64_tr_b16 v[204:205], v23 offset:24576
  v_mfma_f32_16x16x32_bf16 v[120:123], v[172:175], v[80:83], v[120:123]
  ds_read_b64_tr_b16 v[206:207], v23 offset:26624
  s_waitcnt vmcnt(15) lgkmcnt(8)
  s_barrier
  v_mfma_f32_16x16x32_bf16 v[96:99], v[176:179], v[88:91], v[96:99]
  ds_read_b64_tr_b16 v[208:209], v20 offset:28672
  buffer_load_dwordx4 v[144:147], off, s[60:63], s5 offset:0 sc1
  v_mfma_f32_16x16x32_bf16 v[100:103], v[176:179], v[92:95], v[100:103]
  ds_read_b64_tr_b16 v[210:211], v20 offset:30720
  buffer_load_dwordx4 v[60:63], off, s[64:67], s51 offset:1024 sc1
  v_mfma_f32_16x16x32_bf16 v[108:111], v[180:183], v[92:95], v[108:111]
  ds_read_b64_tr_b16 v[212:213], v21 offset:28672
  buffer_load_dwordx4 v[148:151], off, s[60:63], s5 offset:1024 sc1
  v_mfma_f32_16x16x32_bf16 v[104:107], v[180:183], v[88:91], v[104:107]
  ds_read_b64_tr_b16 v[214:215], v21 offset:30720
  v_readlane_b32 s48, v15, 32
  v_mfma_f32_16x16x32_bf16 v[112:115], v[184:187], v[88:91], v[112:115]
  buffer_load_dwordx4 v[152:155], off, s[60:63], s5 offset:2048 sc1
  v_mfma_f32_16x16x32_bf16 v[116:119], v[184:187], v[92:95], v[116:119]
  ds_read_b64_tr_b16 v[216:217], v22 offset:28672
  ds_read_b64_tr_b16 v[218:219], v22 offset:30720
  v_mfma_f32_16x16x32_bf16 v[124:127], v[188:191], v[92:95], v[124:127]
  ds_read_b64_tr_b16 v[220:221], v23 offset:28672
  buffer_load_dwordx4 v[64:67], off, s[36:39], s48 offset:0 sc1
  v_mfma_f32_16x16x32_bf16 v[120:123], v[188:191], v[88:91], v[120:123]
  ds_read_b64_tr_b16 v[222:223], v23 offset:30720
  s_waitcnt vmcnt(18) lgkmcnt(8)
  v_mfma_f32_16x16x32_bf16 v[96:99], v[192:195], v[224:227], v[96:99]
  buffer_load_dwordx4 v[156:159], off, s[60:63], s5 offset:3072 sc1
  v_mfma_f32_16x16x32_bf16 v[100:103], v[192:195], v[228:231], v[100:103]
  ds_read_b64_tr_b16 v[160:161], v20 offset:32768
  ds_read_b64_tr_b16 v[162:163], v20 offset:34816
  v_mfma_f32_16x16x32_bf16 v[108:111], v[196:199], v[228:231], v[108:111]
  buffer_load_dwordx4 v[68:71], off, s[64:67], s48 offset:0 sc1
  v_mfma_f32_16x16x32_bf16 v[104:107], v[196:199], v[224:227], v[104:107]
  ds_read_b64_tr_b16 v[164:165], v21 offset:32768
  ds_read_b64_tr_b16 v[166:167], v21 offset:34816
  v_mfma_f32_16x16x32_bf16 v[112:115], v[200:203], v[224:227], v[112:115]
  ds_read_b64_tr_b16 v[168:169], v22 offset:32768
  v_mfma_f32_16x16x32_bf16 v[116:119], v[200:203], v[228:231], v[116:119]
  ds_read_b64_tr_b16 v[170:171], v22 offset:34816
  ds_read_b64_tr_b16 v[172:173], v23 offset:32768
  v_mfma_f32_16x16x32_bf16 v[124:127], v[204:207], v[228:231], v[124:127]
  buffer_load_dwordx4 v[72:75], off, s[36:39], s48 offset:1024 sc1
  v_mfma_f32_16x16x32_bf16 v[120:123], v[204:207], v[224:227], v[120:123]
  ds_read_b64_tr_b16 v[174:175], v23 offset:34816
  s_waitcnt vmcnt(19) lgkmcnt(8)
  v_mfma_f32_16x16x32_bf16 v[96:99], v[208:211], v[232:235], v[96:99]
  ds_read_b64_tr_b16 v[176:177], v20 offset:36864
  v_mfma_f32_16x16x32_bf16 v[100:103], v[208:211], v[236:239], v[100:103]
  ds_read_b64_tr_b16 v[178:179], v20 offset:38912
  v_mfma_f32_16x16x32_bf16 v[108:111], v[212:215], v[236:239], v[108:111]
  buffer_load_dwordx4 v[76:79], off, s[64:67], s48 offset:1024 sc1
  v_mfma_f32_16x16x32_bf16 v[104:107], v[212:215], v[232:235], v[104:107]
  ds_read_b64_tr_b16 v[180:181], v21 offset:36864
  ds_read_b64_tr_b16 v[182:183], v21 offset:38912
  v_mfma_f32_16x16x32_bf16 v[112:115], v[216:219], v[232:235], v[112:115]
  ds_read_b64_tr_b16 v[184:185], v22 offset:36864
  v_mfma_f32_16x16x32_bf16 v[116:119], v[216:219], v[236:239], v[116:119]
  ds_read_b64_tr_b16 v[186:187], v22 offset:38912
  v_mfma_f32_16x16x32_bf16 v[124:127], v[220:223], v[236:239], v[124:127]
  ds_read_b64_tr_b16 v[188:189], v23 offset:36864
  v_mfma_f32_16x16x32_bf16 v[120:123], v[220:223], v[232:235], v[120:123]
  ds_read_b64_tr_b16 v[190:191], v23 offset:38912
  s_waitcnt vmcnt(18) lgkmcnt(8)
  v_mfma_f32_16x16x32_bf16 v[96:99], v[160:163], v[240:243], v[96:99]
  ds_read_b64_tr_b16 v[192:193], v20 offset:40960
  v_mfma_f32_16x16x32_bf16 v[100:103], v[160:163], v[244:247], v[100:103]
  ds_read_b64_tr_b16 v[194:195], v20 offset:43008
  v_mfma_f32_16x16x32_bf16 v[108:111], v[164:167], v[244:247], v[108:111]
  ds_read_b64_tr_b16 v[196:197], v21 offset:40960
  v_mfma_f32_16x16x32_bf16 v[104:107], v[164:167], v[240:243], v[104:107]
  ds_read_b64_tr_b16 v[198:199], v21 offset:43008
  v_mfma_f32_16x16x32_bf16 v[112:115], v[168:171], v[240:243], v[112:115]
  ds_read_b64_tr_b16 v[200:201], v22 offset:40960
  v_mfma_f32_16x16x32_bf16 v[116:119], v[168:171], v[244:247], v[116:119]
  ds_read_b64_tr_b16 v[202:203], v22 offset:43008
  v_mfma_f32_16x16x32_bf16 v[124:127], v[172:175], v[244:247], v[124:127]
  ds_read_b64_tr_b16 v[204:205], v23 offset:40960
  v_mfma_f32_16x16x32_bf16 v[120:123], v[172:175], v[240:243], v[120:123]
  ds_read_b64_tr_b16 v[206:207], v23 offset:43008
  s_waitcnt vmcnt(16) lgkmcnt(8)
  v_mfma_f32_16x16x32_bf16 v[96:99], v[176:179], v[248:251], v[96:99]
  ds_read_b64_tr_b16 v[208:209], v20 offset:45056
  v_mfma_f32_16x16x32_bf16 v[100:103], v[176:179], v[252:255], v[100:103]
  ds_read_b64_tr_b16 v[210:211], v20 offset:47104
  v_mfma_f32_16x16x32_bf16 v[108:111], v[180:183], v[252:255], v[108:111]
  ds_read_b64_tr_b16 v[212:213], v21 offset:45056
  v_mfma_f32_16x16x32_bf16 v[104:107], v[180:183], v[248:251], v[104:107]
  ds_read_b64_tr_b16 v[214:215], v21 offset:47104
  v_mfma_f32_16x16x32_bf16 v[112:115], v[184:187], v[248:251], v[112:115]
  ds_read_b64_tr_b16 v[216:217], v22 offset:45056
  v_mfma_f32_16x16x32_bf16 v[116:119], v[184:187], v[252:255], v[116:119]
  ds_read_b64_tr_b16 v[218:219], v22 offset:47104
  v_mfma_f32_16x16x32_bf16 v[124:127], v[188:191], v[252:255], v[124:127]
  ds_read_b64_tr_b16 v[220:221], v23 offset:45056
  v_mfma_f32_16x16x32_bf16 v[120:123], v[188:191], v[248:251], v[120:123]
  ds_read_b64_tr_b16 v[222:223], v23 offset:47104
  s_waitcnt vmcnt(14) lgkmcnt(8)
  v_mfma_f32_16x16x32_bf16 v[96:99], v[192:195], v[32:35], v[96:99]
  ds_read_b64_tr_b16 v[160:161], v20 offset:49152
  v_mfma_f32_16x16x32_bf16 v[100:103], v[192:195], v[36:39], v[100:103]
  ds_read_b64_tr_b16 v[162:163], v20 offset:51200
  v_mfma_f32_16x16x32_bf16 v[108:111], v[196:199], v[36:39], v[108:111]
  ds_read_b64_tr_b16 v[164:165], v21 offset:49152
  v_mfma_f32_16x16x32_bf16 v[104:107], v[196:199], v[32:35], v[104:107]
  ds_read_b64_tr_b16 v[166:167], v21 offset:51200
  v_mfma_f32_16x16x32_bf16 v[112:115], v[200:203], v[32:35], v[112:115]
  ds_read_b64_tr_b16 v[168:169], v22 offset:49152
  v_mfma_f32_16x16x32_bf16 v[116:119], v[200:203], v[36:39], v[116:119]
  ds_read_b64_tr_b16 v[170:171], v22 offset:51200
  v_mfma_f32_16x16x32_bf16 v[124:127], v[204:207], v[36:39], v[124:127]
  ds_read_b64_tr_b16 v[172:173], v23 offset:49152
  v_mfma_f32_16x16x32_bf16 v[120:123], v[204:207], v[32:35], v[120:123]
  ds_read_b64_tr_b16 v[174:175], v23 offset:51200
  s_waitcnt vmcnt(12) lgkmcnt(8)
  v_mfma_f32_16x16x32_bf16 v[96:99], v[208:211], v[40:43], v[96:99]
  ds_read_b64_tr_b16 v[176:177], v20 offset:53248
  v_mfma_f32_16x16x32_bf16 v[100:103], v[208:211], v[44:47], v[100:103]
  ds_read_b64_tr_b16 v[178:179], v20 offset:55296
  v_mfma_f32_16x16x32_bf16 v[108:111], v[212:215], v[44:47], v[108:111]
  ds_read_b64_tr_b16 v[180:181], v21 offset:53248
  v_mfma_f32_16x16x32_bf16 v[104:107], v[212:215], v[40:43], v[104:107]
  ds_read_b64_tr_b16 v[182:183], v21 offset:55296
  v_mfma_f32_16x16x32_bf16 v[112:115], v[216:219], v[40:43], v[112:115]
  ds_read_b64_tr_b16 v[184:185], v22 offset:53248
  v_mfma_f32_16x16x32_bf16 v[116:119], v[216:219], v[44:47], v[116:119]
  ds_read_b64_tr_b16 v[186:187], v22 offset:55296
  v_mfma_f32_16x16x32_bf16 v[124:127], v[220:223], v[44:47], v[124:127]
  ds_read_b64_tr_b16 v[188:189], v23 offset:53248
  v_mfma_f32_16x16x32_bf16 v[120:123], v[220:223], v[40:43], v[120:123]
  ds_read_b64_tr_b16 v[190:191], v23 offset:55296
  s_waitcnt vmcnt(10) lgkmcnt(8)
  v_mfma_f32_16x16x32_bf16 v[96:99], v[160:163], v[48:51], v[96:99]
  ds_read_b64_tr_b16 v[192:193], v20 offset:57344
  s_waitcnt vmcnt(3)
  v_mfma_f32_16x16x32_bf16 v[100:103], v[160:163], v[52:55], v[100:103]
  ds_read_b64_tr_b16 v[194:195], v20 offset:59392
  v_lshlrev_b32 v128, 16, v144
  v_mfma_f32_16x16x32_bf16 v[108:111], v[164:167], v[52:55], v[108:111]
  ds_read_b64_tr_b16 v[196:197], v21 offset:57344
  v_and_b32 v129, s11, v144
  v_mfma_f32_16x16x32_bf16 v[104:107], v[164:167], v[48:51], v[104:107]
  ds_read_b64_tr_b16 v[198:199], v21 offset:59392
  v_lshlrev_b32 v130, 16, v145
  v_mfma_f32_16x16x32_bf16 v[112:115], v[168:171], v[48:51], v[112:115]
  ds_read_b64_tr_b16 v[200:201], v22 offset:57344
  v_and_b32 v131, s11, v145
  v_mfma_f32_16x16x32_bf16 v[116:119], v[168:171], v[52:55], v[116:119]
  ds_read_b64_tr_b16 v[202:203], v22 offset:59392
  v_lshlrev_b32 v132, 16, v146
  v_mfma_f32_16x16x32_bf16 v[124:127], v[172:175], v[52:55], v[124:127]
  ds_read_b64_tr_b16 v[204:205], v23 offset:57344
  v_and_b32 v133, s11, v146
  v_mfma_f32_16x16x32_bf16 v[120:123], v[172:175], v[48:51], v[120:123]
  ds_read_b64_tr_b16 v[206:207], v23 offset:59392
  s_waitcnt lgkmcnt(8)
  v_mfma_f32_16x16x32_bf16 v[96:99], v[176:179], v[56:59], v[96:99]
  ds_read_b64_tr_b16 v[208:209], v20 offset:61440
  v_lshlrev_b32 v134, 16, v147
  v_mfma_f32_16x16x32_bf16 v[100:103], v[176:179], v[60:63], v[100:103]
  ds_read_b64_tr_b16 v[210:211], v20 offset:63488
  v_and_b32 v135, s11, v147
  v_mfma_f32_16x16x32_bf16 v[108:111], v[180:183], v[60:63], v[108:111]
  ds_read_b64_tr_b16 v[212:213], v21 offset:61440
  v_lshlrev_b32 v136, 16, v148
  v_mfma_f32_16x16x32_bf16 v[104:107], v[180:183], v[56:59], v[104:107]
  ds_read_b64_tr_b16 v[214:215], v21 offset:63488
  v_and_b32 v137, s11, v148
  v_mfma_f32_16x16x32_bf16 v[112:115], v[184:187], v[56:59], v[112:115]
  ds_read_b64_tr_b16 v[216:217], v22 offset:61440
  v_lshlrev_b32 v138, 16, v149
  v_mfma_f32_16x16x32_bf16 v[116:119], v[184:187], v[60:63], v[116:119]
  ds_read_b64_tr_b16 v[218:219], v22 offset:63488
  v_and_b32 v139, s11, v149
  v_mfma_f32_16x16x32_bf16 v[124:127], v[188:191], v[60:63], v[124:127]
  ds_read_b64_tr_b16 v[220:221], v23 offset:61440
  v_lshlrev_b32 v140, 16, v150
  v_mfma_f32_16x16x32_bf16 v[120:123], v[188:191], v[56:59], v[120:123]
  ds_read_b64_tr_b16 v[222:223], v23 offset:63488
  s_waitcnt vmcnt(2) lgkmcnt(8)
  v_mfma_f32_16x16x32_bf16 v[96:99], v[192:195], v[64:67], v[96:99]
  v_mov_b32 v20, 0
  v_mov_b32 v21, 0
  v_mfma_f32_16x16x32_bf16 v[100:103], v[192:195], v[68:71], v[100:103]
  v_mov_b32 v22, 0
  v_mov_b32 v23, 0
  v_mfma_f32_16x16x32_bf16 v[108:111], v[196:199], v[68:71], v[108:111]
  v_and_b32 v141, s11, v150
  v_lshlrev_b32 v142, 16, v151
  v_and_b32 v143, s11, v151
  v_mfma_f32_16x16x32_bf16 v[104:107], v[196:199], v[64:67], v[104:107]
  v_lshlrev_b32 v144, 16, v152
  v_and_b32 v145, s11, v152
  v_lshlrev_b32 v146, 16, v153
  v_mfma_f32_16x16x32_bf16 v[112:115], v[200:203], v[64:67], v[112:115]
  v_and_b32 v147, s11, v153
  v_lshlrev_b32 v148, 16, v154
  v_and_b32 v149, s11, v154
  v_mfma_f32_16x16x32_bf16 v[116:119], v[200:203], v[68:71], v[116:119]
  v_lshlrev_b32 v150, 16, v155
  v_and_b32 v151, s11, v155
  v_lshlrev_b32 v152, 16, v156
  v_mfma_f32_16x16x32_bf16 v[124:127], v[204:207], v[68:71], v[124:127]
  v_and_b32 v153, s11, v156
  v_lshlrev_b32 v154, 16, v157
  v_and_b32 v155, s11, v157
  v_mfma_f32_16x16x32_bf16 v[120:123], v[204:207], v[64:67], v[120:123]
  s_waitcnt vmcnt(0) lgkmcnt(0)
  v_lshlrev_b32 v156, 16, v158
  v_and_b32 v157, s11, v158
  v_mfma_f32_16x16x32_bf16 v[96:99], v[208:211], v[72:75], v[96:99]
  v_lshlrev_b32 v158, 16, v159
  v_and_b32 v159, s11, v159
  v_mfma_f32_16x16x32_bf16 v[100:103], v[208:211], v[76:79], v[100:103]
  v_mfma_f32_16x16x32_bf16 v[108:111], v[212:215], v[76:79], v[108:111]
  v_mfma_f32_16x16x32_bf16 v[104:107], v[212:215], v[72:75], v[104:107]
  v_mfma_f32_16x16x32_bf16 v[112:115], v[216:219], v[72:75], v[112:115]
  v_mfma_f32_16x16x32_bf16 v[116:119], v[216:219], v[76:79], v[116:119]
  v_mfma_f32_16x16x32_bf16 v[124:127], v[220:223], v[76:79], v[124:127]
  v_mfma_f32_16x16x32_bf16 v[120:123], v[220:223], v[72:75], v[120:123]
  s_lshl_b32 s3, s7, 4
  s_mov_b32 s10, 0x3f803f80
  s_lshl_b32 s4, s7, 3
  s_add_u32 s5, s3, s4
  v_xor_b32 v6, 32, v4
  v_xor_b32 v7, 64, v4
  v_xor_b32 v8, 96, v4
  v_xor_b32 v9, 64, v12
  v_pk_add_f32 v[96:97], v[96:97], v[128:129]
  v_pk_add_f32 v[98:99], v[98:99], v[130:131]
  v_cvt_pk_bf16_f32 v240, v96, v97
  v_cvt_pk_bf16_f32 v241, v98, v99
  v_pk_add_f32 v[104:105], v[104:105], v[136:137]
  v_pk_add_f32 v[106:107], v[106:107], v[138:139]
  v_cvt_pk_bf16_f32 v242, v104, v105
  v_cvt_pk_bf16_f32 v243, v106, v107
  ds_write_b64 v4, v[240:241] offset:0
  ds_write_b64 v6, v[242:243] offset:0
  v_pk_add_f32 v[112:113], v[112:113], v[144:145]
  v_pk_add_f32 v[114:115], v[114:115], v[146:147]
  v_cvt_pk_bf16_f32 v244, v112, v113
  v_cvt_pk_bf16_f32 v245, v114, v115
  v_pk_add_f32 v[120:121], v[120:121], v[152:153]
  v_pk_add_f32 v[122:123], v[122:123], v[154:155]
  v_cvt_pk_bf16_f32 v246, v120, v121
  v_cvt_pk_bf16_f32 v247, v122, v123
  ds_write_b64 v7, v[244:245] offset:0
  ds_write_b64 v8, v[246:247] offset:0
  ds_read_b128 v[32:35], v5 offset:0
  ds_read_b128 v[36:39], v5 offset:1024
  v_pk_add_f32 v[100:101], v[100:101], v[132:133]
  v_pk_add_f32 v[102:103], v[102:103], v[134:135]
  v_cvt_pk_bf16_f32 v248, v100, v101
  v_cvt_pk_bf16_f32 v249, v102, v103
  v_pk_add_f32 v[108:109], v[108:109], v[140:141]
  v_pk_add_f32 v[110:111], v[110:111], v[142:143]
  v_cvt_pk_bf16_f32 v250, v108, v109
  v_cvt_pk_bf16_f32 v251, v110, v111
  ds_write_b64 v4, v[248:249] offset:2048
  ds_write_b64 v6, v[250:251] offset:2048
  v_pk_add_f32 v[116:117], v[116:117], v[148:149]
  v_pk_add_f32 v[118:119], v[118:119], v[150:151]
  v_cvt_pk_bf16_f32 v252, v116, v117
  v_cvt_pk_bf16_f32 v253, v118, v119
  v_pk_add_f32 v[124:125], v[124:125], v[156:157]
  v_pk_add_f32 v[126:127], v[126:127], v[158:159]
  v_cvt_pk_bf16_f32 v254, v124, v125
  v_cvt_pk_bf16_f32 v255, v126, v127
  ds_write_b64 v7, v[252:253] offset:2048
  ds_write_b64 v8, v[254:255] offset:2048
  ds_read_b128 v[40:43], v5 offset:2048
  ds_read_b128 v[44:47], v5 offset:3072
  s_waitcnt lgkmcnt(7)
  buffer_store_dwordx4 v[32:35], v12, s[44:47], 0 offen sc1
  s_waitcnt lgkmcnt(6)
  buffer_store_dwordx4 v[36:39], v9, s[44:47], s4 offen sc1
  s_waitcnt lgkmcnt(1)
  buffer_store_dwordx4 v[40:43], v12, s[44:47], s3 offen sc1
  s_waitcnt lgkmcnt(0)
  buffer_store_dwordx4 v[44:47], v9, s[44:47], s5 offen sc1
  s_cmp_eq_u32 s96, 1
  s_cbranch_scc1 L_w2_end
  v_dot2_f32_bf16 v20, v240, s10, v20
  v_dot2_f32_bf16 v22, v240, v240, v22
  v_dot2_f32_bf16 v20, v241, s10, v20
  v_dot2_f32_bf16 v22, v241, v241, v22
  v_dot2_f32_bf16 v20, v242, s10, v20
  v_dot2_f32_bf16 v22, v242, v242, v22
  v_dot2_f32_bf16 v20, v243, s10, v20
  v_dot2_f32_bf16 v22, v243, v243, v22
  v_dot2_f32_bf16 v20, v244, s10, v20
  v_dot2_f32_bf16 v22, v244, v244, v22
  v_dot2_f32_bf16 v20, v245, s10, v20
  v_dot2_f32_bf16 v22, v245, v245, v22
  v_dot2_f32_bf16 v20, v246, s10, v20
  v_dot2_f32_bf16 v22, v246, v246, v22
  v_dot2_f32_bf16 v20, v247, s10, v20
  v_dot2_f32_bf16 v22, v247, v247, v22
  v_dot2_f32_bf16 v21, v248, s10, v21
  v_dot2_f32_bf16 v23, v248, v248, v23
  v_dot2_f32_bf16 v21, v249, s10, v21
  v_dot2_f32_bf16 v23, v249, v249, v23
  v_dot2_f32_bf16 v21, v250, s10, v21
  v_dot2_f32_bf16 v23, v250, v250, v23
  v_dot2_f32_bf16 v21, v251, s10, v21
  v_dot2_f32_bf16 v23, v251, v251, v23
  v_dot2_f32_bf16 v21, v252, s10, v21
  v_dot2_f32_bf16 v23, v252, v252, v23
  v_dot2_f32_bf16 v21, v253, s10, v21
  v_dot2_f32_bf16 v23, v253, v253, v23
  v_dot2_f32_bf16 v21, v254, s10, v21
  v_dot2_f32_bf16 v23, v254, v254, v23
  v_dot2_f32_bf16 v21, v255, s10, v21
  v_dot2_f32_bf16 v23, v255, v255, v23
  s_nop 2
  v_permlane32_swap_b32 v20, v21
  v_permlane32_swap_b32 v22, v23
  v_add_f32 v20, v20, v21
  v_add_f32 v22, v22, v23
  s_nop 1
  v_permlane16_swap_b32 v20, v22
  v_add_f32 v20, v20, v22
  buffer_store_dword v20, v18, s[56:59], 0 offen sc1
  s_waitcnt vmcnt(0) lgkmcnt(0)
  s_barrier
  s_mov_b32 s96, 1
  s_add_u32 s12, s22, 33554432
  s_addc_u32 s13, s23, 0
  s_add_u32 s34, s22, 67108864
  s_addc_u32 s35, s23, 0
  s_add_u32 s97, s97, 1
  s_branch L_attn_body
L_w2_c1:
```

```asm
; @launch grid=(256,1,1) block=(512,1,1) lds=163840
.amdgcn_target "amdgcn-amd-amdhsa--gfx950"
.text
.globl interleave_layers__sliding_local_dilated__dense_activation_gelu__prompt_kernel
.p2align 12
.fill 832, 4, 0xbf800000
.type interleave_layers__sliding_local_dilated__dense_activation_gelu__prompt_kernel,@function
interleave_layers__sliding_local_dilated__dense_activation_gelu__prompt_kernel:
L_attn_c0:
  s_load_dwordx4 s[16:19], s[0:1], 0
  s_load_dwordx2 s[20:21], s[0:1], 16
  s_load_dwordx2 s[22:23], s[0:1], 80
  s_load_dwordx8 s[24:31], s[0:1], 32
  s_load_dwordx2 s[32:33], s[0:1], 64
  s_load_dwordx2 s[34:35], s[0:1], 80
  s_load_dwordx2 s[12:13], s[0:1], 0
  s_load_dwordx2 s[64:65], s[0:1], 72
  s_mov_b32 s96, 0
  s_mov_b32 s97, 0
L_attn_body:
  s_cmp_ge_u32 s2, 256
  s_cbranch_scc1 L_attn_end
  v_lshrrev_b32 v2, 6, v0
  v_and_b32 v1, 63, v0
  v_readfirstlane_b32 s70, v2
  s_and_b32 s3, s2, 7
  s_lshr_b32 s99, s2, 3
  s_and_b32 s5, s3, 1
  s_lshl_b32 s5, s5, 3
  s_and_b32 s6, s99, 7
  s_add_u32 s68, s5, s6
  s_lshr_b32 s5, s3, 1
  s_lshl_b32 s5, s5, 2
  s_lshr_b32 s6, s99, 3
  s_add_u32 s69, s5, s6
  s_cmp_eq_u32 s96, 0
  s_cbranch_scc1 L_attn_map
  s_and_b32 s3, s2, 7
  s_and_b32 s5, s3, 3
  s_lshl_b32 s5, s5, 2
  s_and_b32 s6, s99, 3
  s_add_u32 s68, s5, s6
  s_lshr_b32 s5, s3, 2
  s_lshl_b32 s5, s5, 3
  s_lshr_b32 s6, s99, 2
  s_add_u32 s69, s5, s6
L_attn_map:
  s_cmp_lt_u32 s70, 4
  s_cbranch_scc1 L_attn_compute
L_attn_loader:
  s_add_u32 s8, s70, s69
  s_and_b32 s8, s8, 3
  s_add_u32 s9, s70, s68
  s_and_b32 s9, s9, 3
  s_lshl_b32 s76, s8, 12
  s_lshl_b32 s77, s9, 11
  s_add_u32 s77, s77, 16384
  s_lshl_b32 s11, s68, 7
  v_and_b32 v10, 7, v1
  v_lshrrev_b32 v3, 3, v1
  s_lshr_b32 s10, s76, 7
  s_lshl_b32 s3, s68, 7
  s_add_u32 s10, s10, s3
  v_add_u32 v3, s10, v3
  s_cmp_eq_u32 s96, 1
  s_cselect_b32 s5, 128, 0
  s_add_u32 s5, s5, 2048
  s_lshl_b32 s6, s5, 3
  v_mul_u32_u24 v3, s5, v3
  v_lshrrev_b32 v2, 4, v1
  v_xor_b32 v4, v2, v10
  v_lshl_add_u32 v4, v4, 4, v3
  v_add_u32 v3, s6, v3
  v_add_u32 v5, 4, v2
  v_xor_b32 v5, v5, v10
  v_lshl_add_u32 v5, v5, 4, v3
  v_add_u32 v3, s6, v3
  v_xor_b32 v6, v2, v10
  v_lshl_add_u32 v6, v6, 4, v3
  v_add_u32 v3, s6, v3
  v_add_u32 v7, 4, v2
  v_xor_b32 v7, v7, v10
  v_lshl_add_u32 v7, v7, 4, v3
  v_lshrrev_b32 v3, 3, v1
  s_lshl_b32 s10, s9, 4
  v_add_u32 v3, s10, v3
  v_mul_u32_u24 v3, 6144, v3
  v_lshrrev_b32 v2, 3, v1
  v_and_b32 v2, 2, v2
  v_xor_b32 v2, v2, v10
  s_mul_i32 s10, s69, 128
  v_add_u32 v3, s10, v3
  v_lshl_add_u32 v8, v2, 4, v3
  v_xor_b32 v2, 4, v2
  v_add_u32 v3, 49152, v3
  v_lshl_add_u32 v9, v2, 4, v3
  s_and_b32 s10, s70, 3
  s_lshl_b32 s78, s10, 9
  s_add_u32 s78, s78, 40960
  s_lshl_b32 s14, s10, 2
  s_add_u32 s14, s14, s11
  s_sub_u32 s14, s14, 16
  v_lshrrev_b32 v3, 3, v1
  v_add_u32 v3, s14, v3
  v_max_i32 v3, 0, v3
  v_mul_u32_u24 v3, s5, v3
  s_lshl_b32 s14, s10, 1
  v_lshrrev_b32 v2, 4, v1
  v_add_u32 v2, s14, v2
  v_and_b32 v2, 7, v2
  v_xor_b32 v2, v2, v10
  v_lshl_add_u32 v28, v2, 4, v3
  s_cmp_eq_u32 s10, 0
  s_cselect_b32 s14, 0xffffff00, -1
  s_mov_b32 s15, 0
  s_mov_b32 s75, 0
  s_add_u32 s100, s68, s69
  s_mov_b32 s101, -1
  s_add_u32 s3, s68, s69
  s_and_b32 s3, s3, 3
  s_mov_b32 s100, 0x75463102
  s_mov_b32 s101, 0xfdceb98a
  s_cmp_eq_u32 s3, 1
  s_cselect_b32 s100, 0x65742130, s100
  s_cselect_b32 s101, 0xedfca9b8, s101
  s_cmp_eq_u32 s3, 2
  s_cselect_b32 s100, 0x68532410, s100
  s_cselect_b32 s101, 0xfedbac97, s101
  s_cmp_eq_u32 s3, 3
  s_cselect_b32 s100, 0x96435210, s100
  s_cselect_b32 s101, 0xfecbda87, s101
  s_mov_b32 s91, s69
  s_and_b32 s92, s69, 3
  s_add_u32 s92, s92, 1
  s_and_b32 s73, s100, 15
  s_cmp_eq_u32 s73, s91
  s_cselect_b32 s74, 4, 0
  s_lshr_b64 s[100:101], s[100:101], s74
  s_and_b32 s73, s100, 15
  s_sub_u32 s92, s92, 1
  s_cselect_b32 s73, s91, s73
  s_cselect_b32 s74, 0, 4
  s_lshr_b64 s[100:101], s[100:101], s74
  s_mul_i32 s74, s73, 393216
  s_lshl_b32 s73, s73, 7
  s_waitcnt lgkmcnt(0)
  s_mov_b32 s36, s12
  s_and_b32 s37, s13, 0xffff
  s_mov_b32 s38, 4194304
  s_mov_b32 s39, 0x00020000
  s_cmp_eq_u32 s96, 1
  s_cselect_b32 s38, 128, 0
  s_add_u32 s38, s38, 2048
  s_lshl_b32 s38, s38, 11
  s_mov_b32 s40, s18
  s_and_b32 s41, s19, 0xffff
  s_mov_b32 s42, 6291456
  s_mov_b32 s43, 0x00020000
  s_cmp_lg_u32 s96, 0
  s_cbranch_scc1 L_attn_ld1
  s_mov_b32 s48, s28
  s_and_b32 s49, s29, 0xffff
  s_mov_b32 s50, 7340032
  s_mov_b32 s51, 0x00020000
  s_cmp_eq_u32 s96, 0
  s_cselect_b32 s50, s50, 0
  s_and_b32 s3, s70, 3
  s_lshl_b32 s4, s2, 2
  s_add_u32 s3, s3, s4
  s_mul_i32 s98, s3, 3584
  s_add_u32 s98, s98, 0
  s_add_u32 s3, s75, s76
  s_add_u32 m0, s3, 0
  s_nop 0
  buffer_load_dwordx4 v4, s[36:39], s73 offen lds
  s_add_u32 m0, s3, 1024
  s_nop 0
  buffer_load_dwordx4 v5, s[36:39], s73 offen lds
  s_add_u32 m0, s3, 2048
  s_nop 0
  buffer_load_dwordx4 v6, s[36:39], s73 offen lds
  s_add_u32 m0, s3, 3072
  s_nop 0
  buffer_load_dwordx4 v7, s[36:39], s73 offen lds
  s_add_u32 m0, s78, s75
  s_mov_b64 exec, s[14:15]
  buffer_load_dwordx4 v28, s[36:39], s73 offen lds
  s_mov_b64 exec, -1
  s_add_u32 s3, s75, s77
  s_add_u32 m0, s3, 0
  s_add_u32 s4, s74, 0
  buffer_load_dwordx4 v8, s[40:43], s4 offen lds
  s_add_u32 m0, s3, 1024
  s_nop 0
  buffer_load_dwordx4 v9, s[40:43], s4 offen lds
  s_add_u32 m0, s3, 8192
  s_add_u32 s4, s74, 2048
  buffer_load_dwordx4 v8, s[40:43], s4 offen lds
  s_add_u32 m0, s3, 9216
  s_nop 0
  buffer_load_dwordx4 v9, s[40:43], s4 offen lds
  s_add_u32 m0, s3, 16384
  s_add_u32 s4, s74, 4096
  buffer_load_dwordx4 v8, s[40:43], s4 offen lds
  s_add_u32 m0, s3, 17408
  s_nop 0
  buffer_load_dwordx4 v9, s[40:43], s4 offen lds
  s_and_b32 s73, s100, 15
  s_cmp_eq_u32 s73, s91
  s_cselect_b32 s74, 4, 0
  s_lshr_b64 s[100:101], s[100:101], s74
  s_and_b32 s73, s100, 15
  s_sub_u32 s92, s92, 1
  s_cselect_b32 s73, s91, s73
  s_cselect_b32 s74, 0, 4
  s_lshr_b64 s[100:101], s[100:101], s74
  s_mul_i32 s74, s73, 393216
  s_lshl_b32 s73, s73, 7
  s_add_u32 s75, s75, 43008
  s_cmp_eq_u32 s75, 129024
  s_cselect_b32 s75, 0, s75
  s_add_u32 s3, s75, s76
  s_add_u32 m0, s3, 0
  s_nop 0
  buffer_load_dwordx4 v4, s[36:39], s73 offen lds
  s_add_u32 m0, s3, 1024
  s_nop 0
  buffer_load_dwordx4 v5, s[36:39], s73 offen lds
  s_add_u32 m0, s3, 2048
  s_nop 0
  buffer_load_dwordx4 v6, s[36:39], s73 offen lds
  s_add_u32 m0, s3, 3072
  s_nop 0
  buffer_load_dwordx4 v7, s[36:39], s73 offen lds
  s_add_u32 m0, s78, s75
  s_mov_b64 exec, s[14:15]
  buffer_load_dwordx4 v28, s[36:39], s73 offen lds
  s_mov_b64 exec, -1
  s_add_u32 s3, s75, s77
  s_add_u32 m0, s3, 0
  s_add_u32 s4, s74, 0
  buffer_load_dwordx4 v8, s[40:43], s4 offen lds
  s_add_u32 m0, s3, 1024
  s_nop 0
  buffer_load_dwordx4 v9, s[40:43], s4 offen lds
  s_add_u32 m0, s3, 8192
  s_add_u32 s4, s74, 2048
  buffer_load_dwordx4 v8, s[40:43], s4 offen lds
  s_add_u32 m0, s3, 9216
  s_nop 0
  buffer_load_dwordx4 v9, s[40:43], s4 offen lds
  s_add_u32 m0, s3, 16384
  s_add_u32 s4, s74, 4096
  buffer_load_dwordx4 v8, s[40:43], s4 offen lds
  s_add_u32 m0, s3, 17408
  s_nop 0
  buffer_load_dwordx4 v9, s[40:43], s4 offen lds
  s_and_b32 s73, s100, 15
  s_cmp_eq_u32 s73, s91
  s_cselect_b32 s74, 4, 0
  s_lshr_b64 s[100:101], s[100:101], s74
  s_and_b32 s73, s100, 15
  s_sub_u32 s92, s92, 1
  s_cselect_b32 s73, s91, s73
  s_cselect_b32 s74, 0, 4
  s_lshr_b64 s[100:101], s[100:101], s74
  s_mul_i32 s74, s73, 393216
  s_lshl_b32 s73, s73, 7
  s_add_u32 s75, s75, 43008
  s_cmp_eq_u32 s75, 129024
  s_cselect_b32 s75, 0, s75
  s_mov_b32 s52, s24
  s_and_b32 s53, s25, 0xffff
  s_mov_b32 s54, 7340032
  s_mov_b32 s55, 0x00020000
  s_min_u32 s3, s2, 223
  s_mul_i32 s4, s3, 4682
  s_lshr_b32 s4, s4, 16
  s_mul_i32 s5, s4, 14
  s_sub_u32 s3, s3, s5
  s_lshl_b32 s3, s3, 2
  s_and_b32 s5, s70, 3
  s_add_u32 s3, s3, s5
  s_mul_i32 s5, s4, 458752
  s_lshl_b32 s8, s3, 7
  s_add_u32 s95, s5, s8
  s_lshl_b32 s9, s4, 14
  s_lshl_b32 s8, s3, 8
  s_add_u32 s94, s9, s8
  v_lshrrev_b32 v2, 3, v1
  v_mul_u32_u24 v2, 7168, v2
  v_and_b32 v3, 7, v1
  v_lshl_add_u32 v26, v3, 4, v2
  s_and_b32 s3, s70, 3
  s_lshl_b32 s4, s2, 2
  s_add_u32 s3, s3, s4
  s_sub_u32 s4, 384, s40
  s_and_b32 s4, s4, 0x380
  s_mul_i32 s5, s3, 6144
  s_add_u32 s5, s5, s4
  s_buffer_load_dword s84, s[40:43], s5 offset:0
  s_buffer_load_dword s84, s[40:43], s5 offset:64
  s_buffer_load_dword s84, s[40:43], s5 offset:1024
  s_buffer_load_dword s84, s[40:43], s5 offset:1088
  s_buffer_load_dword s84, s[40:43], s5 offset:2048
  s_buffer_load_dword s84, s[40:43], s5 offset:2112
  s_buffer_load_dword s84, s[40:43], s5 offset:3072
  s_buffer_load_dword s84, s[40:43], s5 offset:3136
  s_buffer_load_dword s84, s[40:43], s5 offset:4096
  s_buffer_load_dword s84, s[40:43], s5 offset:4160
  s_buffer_load_dword s84, s[40:43], s5 offset:5120
  s_buffer_load_dword s84, s[40:43], s5 offset:5184
  s_add_u32 s56, s22, 24903680
  s_addc_u32 s57, s23, 0
  s_and_b32 s57, s57, 0xffff
  s_mov_b32 s58, 262144
  s_mov_b32 s59, 0x00020000
  s_and_b32 s3, s70, 3
  s_lshl2_add_u32 s4, s68, s3
  s_lshl_b32 s4, s4, 8
  v_lshrrev_b32 v2, 4, v1
  v_and_b32 v3, 15, v1
  v_lshl_add_u32 v3, v3, 4, s4
  v_lshl_add_u32 v18, v2, 14, v3
  s_lshl_b32 s4, s68, 5
  s_add_u32 s4, s4, s3
  s_sub_u32 s4, s4, 4
  s_max_i32 s4, s4, 0
  s_lshl_b32 s4, s4, 5
  v_lshrrev_b32 v2, 2, v1
  v_and_b32 v3, 3, v1
  v_lshl_add_u32 v3, v3, 3, s4
  v_lshl_add_u32 v19, v2, 14, v3
  s_lshl_b32 s3, s68, 2
  s_sub_u32 s3, s3, 4
  v_and_b32 v20, 7, v1
  v_add_u32 v20, s3, v20
  v_max_i32 v20, 0, v20
  v_lshlrev_b32 v20, 2, v20
  s_and_b32 s65, s65, 0xffff
  s_mov_b32 s66, 256
  s_mov_b32 s67, 0x00020000
  s_waitcnt vmcnt(11)
  s_barrier
  s_add_u32 s3, s75, s76
  s_add_u32 m0, s3, 0
  s_nop 0
  buffer_load_dwordx4 v4, s[36:39], s73 offen lds
  s_add_u32 m0, s3, 1024
  s_nop 0
  buffer_load_dwordx4 v5, s[36:39], s73 offen lds
  s_add_u32 m0, s3, 2048
  s_nop 0
  buffer_load_dwordx4 v6, s[36:39], s73 offen lds
  s_add_u32 m0, s3, 3072
  s_nop 0
  buffer_load_dwordx4 v7, s[36:39], s73 offen lds
  s_add_u32 m0, s78, s75
  s_mov_b64 exec, s[14:15]
  buffer_load_dwordx4 v28, s[36:39], s73 offen lds
  s_mov_b64 exec, -1
  s_add_u32 s3, s75, s77
  s_add_u32 m0, s3, 0
  s_add_u32 s4, s74, 0
  buffer_load_dwordx4 v8, s[40:43], s4 offen lds
  s_add_u32 m0, s3, 1024
  s_nop 0
  buffer_load_dwordx4 v9, s[40:43], s4 offen lds
  s_add_u32 m0, s3, 8192
  s_add_u32 s4, s74, 2048
  buffer_load_dwordx4 v8, s[40:43], s4 offen lds
  s_add_u32 m0, s3, 9216
  s_nop 0
  buffer_load_dwordx4 v9, s[40:43], s4 offen lds
  s_add_u32 m0, s3, 16384
  s_add_u32 s4, s74, 4096
  buffer_load_dwordx4 v8, s[40:43], s4 offen lds
  s_add_u32 m0, s3, 17408
  s_nop 0
  buffer_load_dwordx4 v9, s[40:43], s4 offen lds
  s_and_b32 s73, s100, 15
  s_cmp_eq_u32 s73, s91
  s_cselect_b32 s74, 4, 0
  s_lshr_b64 s[100:101], s[100:101], s74
  s_and_b32 s73, s100, 15
  s_sub_u32 s92, s92, 1
  s_cselect_b32 s73, s91, s73
  s_cselect_b32 s74, 0, 4
  s_lshr_b64 s[100:101], s[100:101], s74
  s_mul_i32 s74, s73, 393216
  s_lshl_b32 s73, s73, 7
  s_add_u32 s75, s75, 43008
  s_cmp_eq_u32 s75, 129024
  s_cselect_b32 s75, 0, s75
  s_buffer_load_dword s84, s[48:51], s98 offset:0
  s_buffer_load_dword s84, s[48:51], s98 offset:64
  s_buffer_load_dword s84, s[48:51], s98 offset:128
  s_buffer_load_dword s84, s[48:51], s98 offset:192
  s_add_u32 s98, s98, 256
  buffer_load_dwordx4 v[64:67], v26, s[52:55], s95 offen
  s_add_u32 s95, s95, 57344
  buffer_load_dwordx4 v[68:71], v26, s[52:55], s95 offen
  s_add_u32 s95, s95, 57344
  s_waitcnt vmcnt(13)
  s_barrier
  s_add_u32 s3, s75, s76
  s_add_u32 m0, s3, 0
  s_nop 0
  buffer_load_dwordx4 v4, s[36:39], s73 offen lds
  s_add_u32 m0, s3, 1024
  s_nop 0
  buffer_load_dwordx4 v5, s[36:39], s73 offen lds
  s_add_u32 m0, s3, 2048
  s_nop 0
  buffer_load_dwordx4 v6, s[36:39], s73 offen lds
  s_add_u32 m0, s3, 3072
  s_nop 0
  buffer_load_dwordx4 v7, s[36:39], s73 offen lds
  s_add_u32 m0, s78, s75
  s_mov_b64 exec, s[14:15]
  buffer_load_dwordx4 v28, s[36:39], s73 offen lds
  s_mov_b64 exec, -1
  s_add_u32 s3, s75, s77
  s_add_u32 m0, s3, 0
  s_add_u32 s4, s74, 0
  buffer_load_dwordx4 v8, s[40:43], s4 offen lds
  s_add_u32 m0, s3, 1024
  s_nop 0
  buffer_load_dwordx4 v9, s[40:43], s4 offen lds
  s_add_u32 m0, s3, 8192
  s_add_u32 s4, s74, 2048
  buffer_load_dwordx4 v8, s[40:43], s4 offen lds
  s_add_u32 m0, s3, 9216
  s_nop 0
  buffer_load_dwordx4 v9, s[40:43], s4 offen lds
  s_add_u32 m0, s3, 16384
  s_add_u32 s4, s74, 4096
  buffer_load_dwordx4 v8, s[40:43], s4 offen lds
  s_add_u32 m0, s3, 17408
  s_nop 0
  buffer_load_dwordx4 v9, s[40:43], s4 offen lds
  s_and_b32 s73, s100, 15
  s_cmp_eq_u32 s73, s91
  s_cselect_b32 s74, 4, 0
  s_lshr_b64 s[100:101], s[100:101], s74
  s_and_b32 s73, s100, 15
  s_sub_u32 s92, s92, 1
  s_cselect_b32 s73, s91, s73
  s_cselect_b32 s74, 0, 4
  s_lshr_b64 s[100:101], s[100:101], s74
  s_mul_i32 s74, s73, 393216
  s_lshl_b32 s73, s73, 7
  s_add_u32 s75, s75, 43008
  s_cmp_eq_u32 s75, 129024
  s_cselect_b32 s75, 0, s75
  s_buffer_load_dword s84, s[48:51], s98 offset:0
  s_buffer_load_dword s84, s[48:51], s98 offset:64
  s_buffer_load_dword s84, s[48:51], s98 offset:128
  s_buffer_load_dword s84, s[48:51], s98 offset:192
  s_add_u32 s98, s98, 256
  buffer_load_dwordx4 v[72:75], v26, s[52:55], s95 offen
  s_add_u32 s95, s95, 57344
  buffer_load_dwordx4 v[76:79], v26, s[52:55], s95 offen
  s_add_u32 s95, s95, 57344
  s_waitcnt vmcnt(15)
  s_barrier
  s_add_u32 s3, s75, s76
  s_add_u32 m0, s3, 0
  s_nop 0
  buffer_load_dwordx4 v4, s[36:39], s73 offen lds
  s_add_u32 m0, s3, 1024
  s_nop 0
  buffer_load_dwordx4 v5, s[36:39], s73 offen lds
  s_add_u32 m0, s3, 2048
  s_nop 0
  buffer_load_dwordx4 v6, s[36:39], s73 offen lds
  s_add_u32 m0, s3, 3072
  s_nop 0
  buffer_load_dwordx4 v7, s[36:39], s73 offen lds
  s_add_u32 m0, s78, s75
  s_mov_b64 exec, s[14:15]
  buffer_load_dwordx4 v28, s[36:39], s73 offen lds
  s_mov_b64 exec, -1
  s_add_u32 s3, s75, s77
  s_add_u32 m0, s3, 0
  s_add_u32 s4, s74, 0
  buffer_load_dwordx4 v8, s[40:43], s4 offen lds
  s_add_u32 m0, s3, 1024
  s_nop 0
  buffer_load_dwordx4 v9, s[40:43], s4 offen lds
  s_add_u32 m0, s3, 8192
  s_add_u32 s4, s74, 2048
  buffer_load_dwordx4 v8, s[40:43], s4 offen lds
  s_add_u32 m0, s3, 9216
  s_nop 0
  buffer_load_dwordx4 v9, s[40:43], s4 offen lds
  s_add_u32 m0, s3, 16384
  s_add_u32 s4, s74, 4096
  buffer_load_dwordx4 v8, s[40:43], s4 offen lds
  s_add_u32 m0, s3, 17408
  s_nop 0
  buffer_load_dwordx4 v9, s[40:43], s4 offen lds
  s_and_b32 s73, s100, 15
  s_cmp_eq_u32 s73, s91
  s_cselect_b32 s74, 4, 0
  s_lshr_b64 s[100:101], s[100:101], s74
  s_and_b32 s73, s100, 15
  s_sub_u32 s92, s92, 1
  s_cselect_b32 s73, s91, s73
  s_cselect_b32 s74, 0, 4
  s_lshr_b64 s[100:101], s[100:101], s74
  s_mul_i32 s74, s73, 393216
  s_lshl_b32 s73, s73, 7
  s_add_u32 s75, s75, 43008
  s_cmp_eq_u32 s75, 129024
  s_cselect_b32 s75, 0, s75
  s_buffer_load_dword s84, s[48:51], s98 offset:0
  s_buffer_load_dword s84, s[48:51], s98 offset:64
  s_buffer_load_dword s84, s[48:51], s98 offset:128
  s_buffer_load_dword s84, s[48:51], s98 offset:192
  s_add_u32 s98, s98, 256
  buffer_load_dwordx4 v[80:83], v26, s[52:55], s95 offen
  s_add_u32 s95, s95, 57344
  buffer_load_dwordx4 v[84:87], v26, s[52:55], s95 offen
  s_add_u32 s95, s95, 57344
  s_waitcnt vmcnt(15)
  s_barrier
  s_add_u32 s3, s75, s76
  s_add_u32 m0, s3, 0
  s_nop 0
  buffer_load_dwordx4 v4, s[36:39], s73 offen lds
  s_add_u32 m0, s3, 1024
  s_nop 0
  buffer_load_dwordx4 v5, s[36:39], s73 offen lds
  s_add_u32 m0, s3, 2048
  s_nop 0
  buffer_load_dwordx4 v6, s[36:39], s73 offen lds
  s_add_u32 m0, s3, 3072
  s_nop 0
  buffer_load_dwordx4 v7, s[36:39], s73 offen lds
  s_add_u32 m0, s78, s75
  s_mov_b64 exec, s[14:15]
  buffer_load_dwordx4 v28, s[36:39], s73 offen lds
  s_mov_b64 exec, -1
  s_add_u32 s3, s75, s77
  s_add_u32 m0, s3, 0
  s_add_u32 s4, s74, 0
  buffer_load_dwordx4 v8, s[40:43], s4 offen lds
  s_add_u32 m0, s3, 1024
  s_nop 0
  buffer_load_dwordx4 v9, s[40:43], s4 offen lds
  s_add_u32 m0, s3, 8192
  s_add_u32 s4, s74, 2048
  buffer_load_dwordx4 v8, s[40:43], s4 offen lds
  s_add_u32 m0, s3, 9216
  s_nop 0
  buffer_load_dwordx4 v9, s[40:43], s4 offen lds
  s_add_u32 m0, s3, 16384
  s_add_u32 s4, s74, 4096
  buffer_load_dwordx4 v8, s[40:43], s4 offen lds
  s_add_u32 m0, s3, 17408
  s_nop 0
  buffer_load_dwordx4 v9, s[40:43], s4 offen lds
  s_and_b32 s73, s100, 15
  s_cmp_eq_u32 s73, s91
  s_cselect_b32 s74, 4, 0
  s_lshr_b64 s[100:101], s[100:101], s74
  s_and_b32 s73, s100, 15
  s_sub_u32 s92, s92, 1
  s_cselect_b32 s73, s91, s73
  s_cselect_b32 s74, 0, 4
  s_lshr_b64 s[100:101], s[100:101], s74
  s_mul_i32 s74, s73, 393216
  s_lshl_b32 s73, s73, 7
  s_add_u32 s75, s75, 43008
  s_cmp_eq_u32 s75, 129024
  s_cselect_b32 s75, 0, s75
  s_buffer_load_dword s84, s[48:51], s98 offset:0
  s_buffer_load_dword s84, s[48:51], s98 offset:64
  s_buffer_load_dword s84, s[48:51], s98 offset:128
  s_buffer_load_dword s84, s[48:51], s98 offset:192
  s_add_u32 s98, s98, 256
  buffer_load_dwordx4 v[88:91], v26, s[52:55], s95 offen
  s_add_u32 s95, s95, 57344
  buffer_load_dwordx4 v[92:95], v26, s[52:55], s95 offen
  s_waitcnt vmcnt(15)
  s_barrier
  s_add_u32 s3, s75, s76
  s_add_u32 m0, s3, 0
  s_nop 0
  buffer_load_dwordx4 v4, s[36:39], s73 offen lds
  s_add_u32 m0, s3, 1024
  s_nop 0
  buffer_load_dwordx4 v5, s[36:39], s73 offen lds
  s_add_u32 m0, s3, 2048
  s_nop 0
  buffer_load_dwordx4 v6, s[36:39], s73 offen lds
  s_add_u32 m0, s3, 3072
  s_nop 0
  buffer_load_dwordx4 v7, s[36:39], s73 offen lds
  s_add_u32 m0, s78, s75
  s_mov_b64 exec, s[14:15]
  buffer_load_dwordx4 v28, s[36:39], s73 offen lds
  s_mov_b64 exec, -1
  s_add_u32 s3, s75, s77
  s_add_u32 m0, s3, 0
  s_add_u32 s4, s74, 0
  buffer_load_dwordx4 v8, s[40:43], s4 offen lds
  s_add_u32 m0, s3, 1024
  s_nop 0
  buffer_load_dwordx4 v9, s[40:43], s4 offen lds
  s_add_u32 m0, s3, 8192
  s_add_u32 s4, s74, 2048
  buffer_load_dwordx4 v8, s[40:43], s4 offen lds
  s_add_u32 m0, s3, 9216
  s_nop 0
  buffer_load_dwordx4 v9, s[40:43], s4 offen lds
  s_add_u32 m0, s3, 16384
  s_add_u32 s4, s74, 4096
  buffer_load_dwordx4 v8, s[40:43], s4 offen lds
  s_add_u32 m0, s3, 17408
  s_nop 0
  buffer_load_dwordx4 v9, s[40:43], s4 offen lds
  s_and_b32 s73, s100, 15
  s_cmp_eq_u32 s73, s91
  s_cselect_b32 s74, 4, 0
  s_lshr_b64 s[100:101], s[100:101], s74
  s_and_b32 s73, s100, 15
  s_sub_u32 s92, s92, 1
  s_cselect_b32 s73, s91, s73
  s_cselect_b32 s74, 0, 4
  s_lshr_b64 s[100:101], s[100:101], s74
  s_mul_i32 s74, s73, 393216
  s_lshl_b32 s73, s73, 7
  s_add_u32 s75, s75, 43008
  s_cmp_eq_u32 s75, 129024
  s_cselect_b32 s75, 0, s75
  s_buffer_load_dword s84, s[48:51], s98 offset:0
  s_buffer_load_dword s84, s[48:51], s98 offset:64
  s_buffer_load_dword s84, s[48:51], s98 offset:128
  s_buffer_load_dword s84, s[48:51], s98 offset:192
  s_add_u32 s98, s98, 256
  s_waitcnt vmcnt(13)
  s_barrier
  s_mov_b32 s79, 6
L_attn0_ld1:
  s_add_u32 s3, s75, s76
  s_add_u32 m0, s3, 0
  s_nop 0
  buffer_load_dwordx4 v4, s[36:39], s73 offen lds
  s_add_u32 m0, s3, 1024
  s_nop 0
  buffer_load_dwordx4 v5, s[36:39], s73 offen lds
  s_add_u32 m0, s3, 2048
  s_nop 0
  buffer_load_dwordx4 v6, s[36:39], s73 offen lds
  s_add_u32 m0, s3, 3072
  s_nop 0
  buffer_load_dwordx4 v7, s[36:39], s73 offen lds
  s_add_u32 m0, s78, s75
  s_mov_b64 exec, s[14:15]
  buffer_load_dwordx4 v28, s[36:39], s73 offen lds
  s_mov_b64 exec, -1
  s_add_u32 s3, s75, s77
  s_add_u32 m0, s3, 0
  s_add_u32 s4, s74, 0
  buffer_load_dwordx4 v8, s[40:43], s4 offen lds
  s_add_u32 m0, s3, 1024
  s_nop 0
  buffer_load_dwordx4 v9, s[40:43], s4 offen lds
  s_add_u32 m0, s3, 8192
  s_add_u32 s4, s74, 2048
  buffer_load_dwordx4 v8, s[40:43], s4 offen lds
  s_add_u32 m0, s3, 9216
  s_nop 0
  buffer_load_dwordx4 v9, s[40:43], s4 offen lds
  s_add_u32 m0, s3, 16384
  s_add_u32 s4, s74, 4096
  buffer_load_dwordx4 v8, s[40:43], s4 offen lds
  s_add_u32 m0, s3, 17408
  s_nop 0
  buffer_load_dwordx4 v9, s[40:43], s4 offen lds
  s_and_b32 s73, s100, 15
  s_cmp_eq_u32 s73, s91
  s_cselect_b32 s74, 4, 0
  s_lshr_b64 s[100:101], s[100:101], s74
  s_and_b32 s73, s100, 15
  s_sub_u32 s92, s92, 1
  s_cselect_b32 s73, s91, s73
  s_cselect_b32 s74, 0, 4
  s_lshr_b64 s[100:101], s[100:101], s74
  s_mul_i32 s74, s73, 393216
  s_lshl_b32 s73, s73, 7
  s_add_u32 s75, s75, 43008
  s_cmp_eq_u32 s75, 129024
  s_cselect_b32 s75, 0, s75
  s_buffer_load_dword s84, s[48:51], s98 offset:0
  s_buffer_load_dword s84, s[48:51], s98 offset:64
  s_buffer_load_dword s84, s[48:51], s98 offset:128
  s_buffer_load_dword s84, s[48:51], s98 offset:192
  s_add_u32 s98, s98, 256
  s_waitcnt vmcnt(11)
  s_barrier
  s_sub_u32 s79, s79, 1
  s_cmp_lg_u32 s79, 0
  s_cbranch_scc1 L_attn0_ld1
  s_add_u32 s3, s75, s76
  s_add_u32 m0, s3, 0
  s_nop 0
  buffer_load_dwordx4 v4, s[36:39], s73 offen lds
  s_add_u32 m0, s3, 1024
  s_nop 0
  buffer_load_dwordx4 v5, s[36:39], s73 offen lds
  s_add_u32 m0, s3, 2048
  s_nop 0
  buffer_load_dwordx4 v6, s[36:39], s73 offen lds
  s_add_u32 m0, s3, 3072
  s_nop 0
  buffer_load_dwordx4 v7, s[36:39], s73 offen lds
  s_add_u32 m0, s78, s75
  s_mov_b64 exec, s[14:15]
  buffer_load_dwordx4 v28, s[36:39], s73 offen lds
  s_mov_b64 exec, -1
  s_add_u32 s3, s75, s77
  s_add_u32 m0, s3, 0
  s_add_u32 s4, s74, 0
  buffer_load_dwordx4 v8, s[40:43], s4 offen lds
  s_add_u32 m0, s3, 1024
  s_nop 0
  buffer_load_dwordx4 v9, s[40:43], s4 offen lds
  s_add_u32 m0, s3, 8192
  s_add_u32 s4, s74, 2048
  buffer_load_dwordx4 v8, s[40:43], s4 offen lds
  s_add_u32 m0, s3, 9216
  s_nop 0
  buffer_load_dwordx4 v9, s[40:43], s4 offen lds
  s_add_u32 m0, s3, 16384
  s_add_u32 s4, s74, 4096
  buffer_load_dwordx4 v8, s[40:43], s4 offen lds
  s_add_u32 m0, s3, 17408
  s_nop 0
  buffer_load_dwordx4 v9, s[40:43], s4 offen lds
  s_and_b32 s73, s100, 15
  s_cmp_eq_u32 s73, s91
  s_cselect_b32 s74, 4, 0
  s_lshr_b64 s[100:101], s[100:101], s74
  s_and_b32 s73, s100, 15
  s_sub_u32 s92, s92, 1
  s_cselect_b32 s73, s91, s73
  s_cselect_b32 s74, 0, 4
  s_lshr_b64 s[100:101], s[100:101], s74
  s_mul_i32 s74, s73, 393216
  s_lshl_b32 s73, s73, 7
  s_add_u32 s75, s75, 43008
  s_cmp_eq_u32 s75, 129024
  s_cselect_b32 s75, 0, s75
  s_buffer_load_dword s84, s[48:51], s98 offset:0
  s_buffer_load_dword s84, s[48:51], s98 offset:64
  s_buffer_load_dword s84, s[48:51], s98 offset:128
  s_buffer_load_dword s84, s[48:51], s98 offset:192
  s_add_u32 s98, s98, 256
  buffer_load_dword v21, v20, s[64:67], 0 offen sc1
  s_waitcnt vmcnt(12)
  s_barrier
  s_add_u32 s3, s75, s76
  s_add_u32 m0, s3, 0
  s_nop 0
  buffer_load_dwordx4 v4, s[36:39], s73 offen lds
  s_add_u32 m0, s3, 1024
  s_nop 0
  buffer_load_dwordx4 v5, s[36:39], s73 offen lds
  s_add_u32 m0, s3, 2048
  s_nop 0
  buffer_load_dwordx4 v6, s[36:39], s73 offen lds
  s_add_u32 m0, s3, 3072
  s_nop 0
  buffer_load_dwordx4 v7, s[36:39], s73 offen lds
  s_add_u32 m0, s78, s75
  s_mov_b64 exec, s[14:15]
  buffer_load_dwordx4 v28, s[36:39], s73 offen lds
  s_mov_b64 exec, -1
  s_add_u32 s3, s75, s77
  s_add_u32 m0, s3, 0
  s_add_u32 s4, s74, 0
  buffer_load_dwordx4 v8, s[40:43], s4 offen lds
  s_add_u32 m0, s3, 1024
  s_nop 0
  buffer_load_dwordx4 v9, s[40:43], s4 offen lds
  s_add_u32 m0, s3, 8192
  s_add_u32 s4, s74, 2048
  buffer_load_dwordx4 v8, s[40:43], s4 offen lds
  s_add_u32 m0, s3, 9216
  s_nop 0
  buffer_load_dwordx4 v9, s[40:43], s4 offen lds
  s_add_u32 m0, s3, 16384
  s_add_u32 s4, s74, 4096
  buffer_load_dwordx4 v8, s[40:43], s4 offen lds
  s_add_u32 m0, s3, 17408
  s_nop 0
  buffer_load_dwordx4 v9, s[40:43], s4 offen lds
  s_and_b32 s73, s100, 15
  s_cmp_eq_u32 s73, s91
  s_cselect_b32 s74, 4, 0
  s_lshr_b64 s[100:101], s[100:101], s74
  s_and_b32 s73, s100, 15
  s_sub_u32 s92, s92, 1
  s_cselect_b32 s73, s91, s73
  s_cselect_b32 s74, 0, 4
  s_lshr_b64 s[100:101], s[100:101], s74
  s_mul_i32 s74, s73, 393216
  s_lshl_b32 s73, s73, 7
  s_add_u32 s75, s75, 43008
  s_cmp_eq_u32 s75, 129024
  s_cselect_b32 s75, 0, s75
  s_buffer_load_dword s84, s[48:51], s98 offset:0
  s_buffer_load_dword s84, s[48:51], s98 offset:64
  s_buffer_load_dword s84, s[48:51], s98 offset:128
  s_buffer_load_dword s84, s[48:51], s98 offset:192
  s_add_u32 s98, s98, 256
  s_waitcnt vmcnt(12)
  s_barrier
  s_add_u32 s3, s75, s76
  s_add_u32 m0, s3, 0
  s_nop 0
  buffer_load_dwordx4 v4, s[36:39], s73 offen lds
  s_add_u32 m0, s3, 1024
  s_nop 0
  buffer_load_dwordx4 v5, s[36:39], s73 offen lds
  s_add_u32 m0, s3, 2048
  s_nop 0
  buffer_load_dwordx4 v6, s[36:39], s73 offen lds
  s_add_u32 m0, s3, 3072
  s_nop 0
  buffer_load_dwordx4 v7, s[36:39], s73 offen lds
  s_add_u32 m0, s78, s75
  s_mov_b64 exec, s[14:15]
  buffer_load_dwordx4 v28, s[36:39], s73 offen lds
  s_mov_b64 exec, -1
  s_add_u32 s3, s75, s77
  s_add_u32 m0, s3, 0
  s_add_u32 s4, s74, 0
  buffer_load_dwordx4 v8, s[40:43], s4 offen lds
  s_add_u32 m0, s3, 1024
  s_nop 0
  buffer_load_dwordx4 v9, s[40:43], s4 offen lds
  s_add_u32 m0, s3, 8192
  s_add_u32 s4, s74, 2048
  buffer_load_dwordx4 v8, s[40:43], s4 offen lds
  s_add_u32 m0, s3, 9216
  s_nop 0
  buffer_load_dwordx4 v9, s[40:43], s4 offen lds
  s_add_u32 m0, s3, 16384
  s_add_u32 s4, s74, 4096
  buffer_load_dwordx4 v8, s[40:43], s4 offen lds
  s_add_u32 m0, s3, 17408
  s_nop 0
  buffer_load_dwordx4 v9, s[40:43], s4 offen lds
  s_and_b32 s73, s100, 15
  s_cmp_eq_u32 s73, s91
  s_cselect_b32 s74, 4, 0
  s_lshr_b64 s[100:101], s[100:101], s74
  s_and_b32 s73, s100, 15
  s_sub_u32 s92, s92, 1
  s_cselect_b32 s73, s91, s73
  s_cselect_b32 s74, 0, 4
  s_lshr_b64 s[100:101], s[100:101], s74
  s_mul_i32 s74, s73, 393216
  s_lshl_b32 s73, s73, 7
  s_add_u32 s75, s75, 43008
  s_cmp_eq_u32 s75, 129024
  s_cselect_b32 s75, 0, s75
  s_buffer_load_dword s84, s[48:51], s98 offset:0
  s_buffer_load_dword s84, s[48:51], s98 offset:64
  s_buffer_load_dword s84, s[48:51], s98 offset:128
  s_buffer_load_dword s84, s[48:51], s98 offset:192
  s_add_u32 s98, s98, 256
  s_waitcnt vmcnt(11)
  s_barrier
  s_mov_b32 s5, 0x100000
  L_attn_dchk:
  v_cmp_ne_u32 vcc, 0x01010101, v21
  s_cbranch_vccz L_attn_dok
  s_sub_u32 s5, s5, 1
  buffer_load_dword v21, v20, s[64:67], 0 offen sc1
  s_waitcnt vmcnt(0)
  s_cbranch_scc0 L_attn_dchk
  L_attn_dok:
  buffer_load_dwordx4 v[32:35], v18, s[56:59], 0 offen
  s_mov_b32 s3, 65536
  buffer_load_dwordx4 v[36:39], v18, s[56:59], s3 offen
  s_mov_b32 s3, 131072
  buffer_load_dwordx4 v[40:43], v18, s[56:59], s3 offen
  s_mov_b32 s3, 196608
  buffer_load_dwordx4 v[44:47], v18, s[56:59], s3 offen
  buffer_load_dwordx2 v[48:49], v19, s[56:59], 0 offen
  s_mov_b32 s60, s20
  s_and_b32 s61, s21, 0xffff
  s_mov_b32 s62, 2097152
  s_mov_b32 s63, 0x00020000
  s_and_b32 s3, s70, 3
  s_mul_i32 s3, s3, 8
  s_mul_i32 s4, s99, 32
  s_add_u32 s3, s3, s4
  v_lshrrev_b32 v2, 3, v1
  v_add_u32 v2, s3, v2
  v_mul_u32_u24 v2, 2048, v2
  v_and_b32 v3, 7, v1
  v_lshl_add_u32 v2, v3, 8, v2
  s_and_b32 s3, s2, 7
  s_lshr_b32 s3, s3, 2
  s_mul_i32 s3, s3, 128
  buffer_load_dword v96, v2, s[60:63], s3 offen
  s_waitcnt vmcnt(6)
  s_barrier
  s_mov_b32 s79, 0x4000
  s_waitcnt vmcnt(1)
L_attn_schk:
  v_pk_add_f32 v[32:33], v[32:33], v[36:37]
  v_pk_add_f32 v[34:35], v[34:35], v[38:39]
  v_pk_add_f32 v[40:41], v[40:41], v[44:45]
  v_pk_add_f32 v[42:43], v[42:43], v[46:47]
  v_pk_add_f32 v[32:33], v[32:33], v[40:41]
  v_pk_add_f32 v[34:35], v[34:35], v[42:43]
  s_nop 1
  v_permlane32_swap_b32 v32, v34
  v_permlane32_swap_b32 v33, v35
  v_pk_add_f32 v[32:33], v[32:33], v[34:35]
  v_cmp_u_f32 vcc, v32, v33
  v_cmp_u_f32 s[4:5], v48, v49
  s_or_b64 s[4:5], vcc, s[4:5]
  s_cbranch_scc0 L_attn_sok
  s_sub_u32 s79, s79, 1
  s_cbranch_scc1 L_attn_sok
  buffer_load_dwordx4 v[32:35], v18, s[56:59], 0 offen sc1
  s_mov_b32 s3, 65536
  buffer_load_dwordx4 v[36:39], v18, s[56:59], s3 offen sc1
  s_mov_b32 s3, 131072
  buffer_load_dwordx4 v[40:43], v18, s[56:59], s3 offen sc1
  s_mov_b32 s3, 196608
  buffer_load_dwordx4 v[44:47], v18, s[56:59], s3 offen sc1
  buffer_load_dwordx2 v[48:49], v19, s[56:59], 0 offen sc1
  s_waitcnt vmcnt(0)
  s_branch L_attn_schk
L_attn_sok:
  v_mov_b32 v34, v32
  v_mov_b32 v35, v33
  s_nop 0
  v_permlane16_swap_b32 v32, v34
  v_permlane16_swap_b32 v33, v35
  v_pk_add_f32 v[32:33], v[32:33], v[34:35]
  v_mul_f32 v32, 0x3a800000, v32
  v_mul_f32 v33, 0x3a800000, v33
  v_fma_f32 v33, -v32, v32, v33
  v_max_f32 v33, 0, v33
  v_add_f32 v33, 0x3727c5ac, v33
  v_rsq_f32 v33, v33
  s_nop 0
  s_and_b32 s3, s70, 3
  s_lshl_b32 s5, s3, 7
  s_add_u32 s5, s5, 129088
  v_and_b32 v3, 15, v1
  v_lshrrev_b32 v2, 5, v1
  v_lshl_add_u32 v2, v3, 1, v2
  v_lshl_add_u32 v2, v2, 2, s5
  ds_write2_b32 v2, v32, v33 offset0:0 offset1:160
  v_mov_b32 v50, v48
  v_mov_b32 v51, v49
  s_nop 0
  v_permlane32_swap_b32 v48, v50
  v_permlane32_swap_b32 v49, v51
  v_pk_add_f32 v[48:49], v[48:49], v[50:51]
  v_mov_b32 v50, v48
  v_mov_b32 v51, v49
  s_nop 0
  v_permlane16_swap_b32 v48, v50
  v_permlane16_swap_b32 v49, v51
  v_pk_add_f32 v[48:49], v[48:49], v[50:51]
  s_nop 1
  v_add_f32_dpp v48, v48, v48 row_ror:8 row_mask:0xf bank_mask:0xf
  v_add_f32_dpp v49, v49, v49 row_ror:8 row_mask:0xf bank_mask:0xf
  s_nop 1
  v_add_f32_dpp v48, v48, v48 row_ror:4 row_mask:0xf bank_mask:0xf
  v_add_f32_dpp v49, v49, v49 row_ror:4 row_mask:0xf bank_mask:0xf
  v_mul_f32 v48, 0x3a800000, v48
  v_mul_f32 v49, 0x3a800000, v49
  v_fma_f32 v49, -v48, v48, v49
  v_max_f32 v49, 0, v49
  v_add_f32 v49, 0x3727c5ac, v49
  v_rsq_f32 v49, v49
  s_nop 0
  s_lshl_b32 s5, s3, 4
  s_add_u32 s5, s5, 129024
  v_and_b32 v3, 3, v1
  v_lshl_add_u32 v2, v3, 2, s5
  ds_write2_b32 v2, v48, v49 offset0:0 offset1:160
  s_waitcnt lgkmcnt(0)
  s_barrier
  s_barrier
  s_branch L_attn_ldend
L_attn_ld1:
  s_add_u32 s3, s68, s69
  s_and_b32 s3, s3, 3
  s_mov_b32 s100, 0x68532410
  s_mov_b32 s101, 0xfedbac97
  s_cmp_eq_u32 s3, 1
  s_cselect_b32 s100, 0x96435210, s100
  s_cselect_b32 s101, 0xfecbda87, s101
  s_cmp_eq_u32 s3, 2
  s_cselect_b32 s100, 0x75463210, s100
  s_cselect_b32 s101, 0xfdceb98a, s101
  s_cmp_eq_u32 s3, 3
  s_cselect_b32 s100, 0x65743210, s100
  s_cselect_b32 s101, 0xedfca9b8, s101
  s_add_u32 s56, s22, 24379392
  s_addc_u32 s57, s23, 0
  s_and_b32 s57, s57, 0xffff
  s_mov_b32 s58, 262144
  s_mov_b32 s59, 0x00020000
  s_and_b32 s3, s70, 3
  s_lshl2_add_u32 s4, s68, s3
  s_lshl_b32 s4, s4, 8
  v_lshrrev_b32 v2, 4, v1
  v_and_b32 v3, 15, v1
  v_lshl_add_u32 v3, v3, 4, s4
  v_lshl_add_u32 v18, v2, 14, v3
  s_lshl_b32 s4, s68, 5
  s_add_u32 s4, s4, s3
  s_sub_u32 s4, s4, 4
  s_max_i32 s4, s4, 0
  s_lshl_b32 s4, s4, 5
  v_lshrrev_b32 v2, 2, v1
  v_and_b32 v3, 3, v1
  v_lshl_add_u32 v3, v3, 3, s4
  v_lshl_add_u32 v19, v2, 14, v3
  s_add_u32 s64, s22, 41943040
  s_addc_u32 s65, s23, 0
  s_and_b32 s65, s65, 0xffff
  s_mov_b32 s66, 524288
  s_mov_b32 s67, 0x00020000
  v_and_b32 v30, 3, v1
  v_lshlrev_b32 v30, 6, v30
  s_mov_b32 s79, 0x100000
  s_cmp_lg_u32 s70, 4
  s_cbranch_scc1 L_attn_xgo
  s_setprio 3
L_attn_xpoll:
  buffer_load_dword v12, v30, s[64:67], s86 offen sc1
  s_sub_u32 s79, s79, 1
  s_cbranch_scc1 L_attn_xgo
  s_waitcnt vmcnt(0)
  v_cmp_ne_u32 vcc, 1, v12
  s_cbranch_vccnz L_attn_xpoll
L_attn_xgo:
  s_setprio 0
  s_barrier
  s_lshr_b32 s3, s69, 3
  s_and_b32 s73, s69, 7
  s_lshl1_add_u32 s91, s73, s3
  s_mul_i32 s74, s91, 393216
  s_lshl_b32 s73, s91, 7
  s_mov_b32 s88, s73
  s_add_u32 m0, s77, 0
  s_add_u32 s4, s74, 0
  buffer_load_dwordx4 v8, s[40:43], s4 offen lds
  s_add_u32 m0, s77, 1024
  s_nop 0
  buffer_load_dwordx4 v9, s[40:43], s4 offen lds
  s_add_u32 m0, s77, 8192
  s_add_u32 s4, s74, 2048
  buffer_load_dwordx4 v8, s[40:43], s4 offen lds
  s_add_u32 m0, s77, 9216
  s_nop 0
  buffer_load_dwordx4 v9, s[40:43], s4 offen lds
  s_add_u32 m0, s77, 16384
  s_add_u32 s4, s74, 4096
  buffer_load_dwordx4 v8, s[40:43], s4 offen lds
  s_add_u32 m0, s77, 17408
  s_nop 0
  buffer_load_dwordx4 v9, s[40:43], s4 offen lds
  s_and_b32 s73, s100, 15
  s_cmp_eq_u32 s73, s91
  s_cselect_b32 s74, 4, 0
  s_lshr_b64 s[100:101], s[100:101], s74
  s_and_b32 s73, s100, 15
  s_lshr_b64 s[100:101], s[100:101], 4
  s_mul_i32 s74, s73, 393216
  s_lshl_b32 s73, s73, 7
  s_mov_b32 s75, 0
  s_add_u32 s44, s22, 41943040
  s_addc_u32 s45, s23, 0
  s_and_b32 s45, s45, 0xffff
  s_mov_b32 s46, 524288
  s_mov_b32 s47, 0x00020000
  s_lshl4_add_u32 s3, s97, s68
  s_and_b32 s4, s69, 15
  s_lshl4_add_u32 s3, s3, s4
  s_lshl_b32 s3, s3, 7
  s_sub_u32 s3, s3, 32768
  v_lshlrev_b32 v11, 7, v1
  s_cmp_eq_u32 s68, 0
  s_cselect_b32 s4, 15, 31
  v_and_b32 v2, 16, v1
  v_lshl_add_u32 v11, v2, 2, v11
  v_and_b32 v2, s4, v1
  v_lshlrev_b32 v2, 2, v2
  v_mov_b32 v3, 1
  s_mov_b32 s79, 0x100000
  s_waitcnt vmcnt(0)
  s_cmp_lg_u32 s70, 4
  s_barrier
  s_cbranch_scc1 L_attn_nofl
  s_mov_b32 exec_lo, 0xffffffff
  s_mov_b32 exec_hi, 0
  buffer_store_dword v3, v11, s[44:47], s87 offen sc1
  s_mov_b64 exec, -1
L_attn_nofl:
  s_mov_b32 s5, s3
  s_mov_b32 s89, s73
  s_add_u32 m0, s77, 43008
  s_add_u32 s4, s74, 0
  buffer_load_dwordx4 v8, s[40:43], s4 offen lds
  s_add_u32 m0, s77, 44032
  s_nop 0
  buffer_load_dwordx4 v9, s[40:43], s4 offen lds
  s_add_u32 m0, s77, 51200
  s_add_u32 s4, s74, 2048
  buffer_load_dwordx4 v8, s[40:43], s4 offen lds
  s_add_u32 m0, s77, 52224
  s_nop 0
  buffer_load_dwordx4 v9, s[40:43], s4 offen lds
  s_add_u32 m0, s77, 59392
  s_add_u32 s4, s74, 4096
  buffer_load_dwordx4 v8, s[40:43], s4 offen lds
  s_add_u32 m0, s77, 60416
  s_nop 0
  buffer_load_dwordx4 v9, s[40:43], s4 offen lds
  s_and_b32 s73, s100, 15
  s_cmp_eq_u32 s73, s91
  s_cselect_b32 s74, 4, 0
  s_lshr_b64 s[100:101], s[100:101], s74
  s_and_b32 s73, s100, 15
  s_lshr_b64 s[100:101], s[100:101], 4
  s_mul_i32 s74, s73, 393216
  s_lshl_b32 s73, s73, 7
  s_mov_b32 s90, s73
  s_add_u32 m0, s77, 86016
  s_add_u32 s4, s74, 0
  buffer_load_dwordx4 v8, s[40:43], s4 offen lds
  s_add_u32 m0, s77, 87040
  s_nop 0
  buffer_load_dwordx4 v9, s[40:43], s4 offen lds
  s_add_u32 m0, s77, 94208
  s_add_u32 s4, s74, 2048
  buffer_load_dwordx4 v8, s[40:43], s4 offen lds
  s_add_u32 m0, s77, 95232
  s_nop 0
  buffer_load_dwordx4 v9, s[40:43], s4 offen lds
  s_add_u32 m0, s77, 102400
  s_add_u32 s4, s74, 4096
  buffer_load_dwordx4 v8, s[40:43], s4 offen lds
  s_add_u32 m0, s77, 103424
  s_nop 0
  buffer_load_dwordx4 v9, s[40:43], s4 offen lds
  s_and_b32 s73, s100, 15
  s_cmp_eq_u32 s73, s91
  s_cselect_b32 s74, 4, 0
  s_lshr_b64 s[100:101], s[100:101], s74
  s_and_b32 s73, s100, 15
  s_lshr_b64 s[100:101], s[100:101], 4
  s_mul_i32 s74, s73, 393216
  s_lshl_b32 s73, s73, 7
  s_mov_b32 s3, s5
  s_cmp_lg_u32 s70, 4
  s_cbranch_scc1 L_attn_dep
L_attn_poll:
  buffer_load_dword v3, v2, s[44:47], s3 offen sc1
  s_sub_u32 s79, s79, 1
  s_cbranch_scc1 L_attn_dep
  s_waitcnt vmcnt(0)
  v_cmp_ne_u32 vcc, 1, v3
  s_cbranch_vccnz L_attn_poll
L_attn_dep:
  s_barrier
  s_add_u32 m0, s78, 89344
  s_mov_b64 exec, s[14:15]
  buffer_load_dwordx4 v28, s[36:39], s88 offen lds
  s_mov_b64 exec, -1
  s_add_u32 m0, s76, 43008
  s_nop 0
  buffer_load_dwordx4 v4, s[36:39], s89 offen lds
  s_add_u32 m0, s76, 44032
  s_nop 0
  buffer_load_dwordx4 v5, s[36:39], s89 offen lds
  s_add_u32 m0, s76, 45056
  s_nop 0
  buffer_load_dwordx4 v6, s[36:39], s89 offen lds
  s_add_u32 m0, s76, 46080
  s_nop 0
  buffer_load_dwordx4 v7, s[36:39], s89 offen lds
  s_add_u32 m0, s78, 43008
  s_mov_b64 exec, s[14:15]
  buffer_load_dwordx4 v28, s[36:39], s89 offen lds
  s_mov_b64 exec, -1
  s_add_u32 m0, s76, 86016
  s_nop 0
  buffer_load_dwordx4 v4, s[36:39], s90 offen lds
  s_add_u32 m0, s76, 87040
  s_nop 0
  buffer_load_dwordx4 v5, s[36:39], s90 offen lds
  s_add_u32 m0, s76, 88064
  s_nop 0
  buffer_load_dwordx4 v6, s[36:39], s90 offen lds
  s_add_u32 m0, s76, 89088
  s_nop 0
  buffer_load_dwordx4 v7, s[36:39], s90 offen lds
  s_add_u32 m0, s78, 86016
  s_mov_b64 exec, s[14:15]
  buffer_load_dwordx4 v28, s[36:39], s90 offen lds
  s_mov_b64 exec, -1
  s_waitcnt vmcnt(5)
  s_barrier
  s_mov_b32 s79, 12
L_attn1_ld1:
  s_add_u32 s3, s75, s76
  s_add_u32 m0, s3, 0
  s_nop 0
  buffer_load_dwordx4 v4, s[36:39], s73 offen lds
  s_add_u32 m0, s3, 1024
  s_nop 0
  buffer_load_dwordx4 v5, s[36:39], s73 offen lds
  s_add_u32 m0, s3, 2048
  s_nop 0
  buffer_load_dwordx4 v6, s[36:39], s73 offen lds
  s_add_u32 m0, s3, 3072
  s_nop 0
  buffer_load_dwordx4 v7, s[36:39], s73 offen lds
  s_add_u32 m0, s78, s75
  s_mov_b64 exec, s[14:15]
  buffer_load_dwordx4 v28, s[36:39], s73 offen lds
  s_mov_b64 exec, -1
  s_add_u32 s3, s75, s77
  s_add_u32 m0, s3, 0
  s_add_u32 s4, s74, 0
  buffer_load_dwordx4 v8, s[40:43], s4 offen lds
  s_add_u32 m0, s3, 1024
  s_nop 0
  buffer_load_dwordx4 v9, s[40:43], s4 offen lds
  s_add_u32 m0, s3, 8192
  s_add_u32 s4, s74, 2048
  buffer_load_dwordx4 v8, s[40:43], s4 offen lds
  s_add_u32 m0, s3, 9216
  s_nop 0
  buffer_load_dwordx4 v9, s[40:43], s4 offen lds
  s_add_u32 m0, s3, 16384
  s_add_u32 s4, s74, 4096
  buffer_load_dwordx4 v8, s[40:43], s4 offen lds
  s_add_u32 m0, s3, 17408
  s_nop 0
  buffer_load_dwordx4 v9, s[40:43], s4 offen lds
  s_and_b32 s73, s100, 15
  s_cmp_eq_u32 s73, s91
  s_cselect_b32 s74, 4, 0
  s_lshr_b64 s[100:101], s[100:101], s74
  s_and_b32 s73, s100, 15
  s_lshr_b64 s[100:101], s[100:101], 4
  s_mul_i32 s74, s73, 393216
  s_lshl_b32 s73, s73, 7
  s_add_u32 s75, s75, 43008
  s_cmp_eq_u32 s75, 129024
  s_cselect_b32 s75, 0, s75
  s_waitcnt vmcnt(11)
  s_barrier
  s_sub_u32 s79, s79, 1
  s_cmp_lg_u32 s79, 0
  s_cbranch_scc1 L_attn1_ld1
  s_add_u32 s3, s75, s76
  s_add_u32 m0, s3, 0
  s_nop 0
  buffer_load_dwordx4 v4, s[36:39], s73 offen lds
  s_add_u32 m0, s3, 1024
  s_nop 0
  buffer_load_dwordx4 v5, s[36:39], s73 offen lds
  s_add_u32 m0, s3, 2048
  s_nop 0
  buffer_load_dwordx4 v6, s[36:39], s73 offen lds
  s_add_u32 m0, s3, 3072
  s_nop 0
  buffer_load_dwordx4 v7, s[36:39], s73 offen lds
  s_add_u32 m0, s78, s75
  s_mov_b64 exec, s[14:15]
  buffer_load_dwordx4 v28, s[36:39], s73 offen lds
  s_mov_b64 exec, -1
  s_add_u32 s3, s75, s77
  s_add_u32 m0, s3, 0
  s_add_u32 s4, s74, 0
  buffer_load_dwordx4 v8, s[40:43], s4 offen lds
  s_add_u32 m0, s3, 1024
  s_nop 0
  buffer_load_dwordx4 v9, s[40:43], s4 offen lds
  s_add_u32 m0, s3, 8192
  s_add_u32 s4, s74, 2048
  buffer_load_dwordx4 v8, s[40:43], s4 offen lds
  s_add_u32 m0, s3, 9216
  s_nop 0
  buffer_load_dwordx4 v9, s[40:43], s4 offen lds
  s_add_u32 m0, s3, 16384
  s_add_u32 s4, s74, 4096
  buffer_load_dwordx4 v8, s[40:43], s4 offen lds
  s_add_u32 m0, s3, 17408
  s_nop 0
  buffer_load_dwordx4 v9, s[40:43], s4 offen lds
  s_and_b32 s73, s100, 15
  s_cmp_eq_u32 s73, s91
  s_cselect_b32 s74, 4, 0
  s_lshr_b64 s[100:101], s[100:101], s74
  s_and_b32 s73, s100, 15
  s_lshr_b64 s[100:101], s[100:101], 4
  s_mul_i32 s74, s73, 393216
  s_lshl_b32 s73, s73, 7
  s_add_u32 s75, s75, 43008
  s_cmp_eq_u32 s75, 129024
  s_cselect_b32 s75, 0, s75
  s_mov_b32 s60, s20
  s_and_b32 s61, s21, 0xffff
  s_mov_b32 s62, 2097152
  s_mov_b32 s63, 0x00020000
  s_and_b32 s3, s70, 3
  s_mul_i32 s3, s3, 8
  s_mul_i32 s4, s99, 32
  s_add_u32 s3, s3, s4
  v_lshrrev_b32 v2, 3, v1
  v_add_u32 v2, s3, v2
  v_mul_u32_u24 v2, 2048, v2
  v_and_b32 v3, 7, v1
  v_lshl_add_u32 v2, v3, 8, v2
  s_and_b32 s3, s2, 7
  s_lshr_b32 s3, s3, 2
  s_mul_i32 s3, s3, 128
  buffer_load_dword v96, v2, s[60:63], s3 offen
  s_waitcnt vmcnt(12)
  s_barrier
  buffer_load_dwordx4 v[32:35], v18, s[56:59], 0 offen
  s_mov_b32 s3, 65536
  buffer_load_dwordx4 v[36:39], v18, s[56:59], s3 offen
  s_mov_b32 s3, 131072
  buffer_load_dwordx4 v[40:43], v18, s[56:59], s3 offen
  s_mov_b32 s3, 196608
  buffer_load_dwordx4 v[44:47], v18, s[56:59], s3 offen
  buffer_load_dwordx2 v[48:49], v19, s[56:59], 0 offen
  s_waitcnt vmcnt(6)
  s_barrier
  s_waitcnt vmcnt(0)
  v_pk_add_f32 v[32:33], v[32:33], v[36:37]
  v_pk_add_f32 v[34:35], v[34:35], v[38:39]
  v_pk_add_f32 v[40:41], v[40:41], v[44:45]
  v_pk_add_f32 v[42:43], v[42:43], v[46:47]
  v_pk_add_f32 v[32:33], v[32:33], v[40:41]
  v_pk_add_f32 v[34:35], v[34:35], v[42:43]
  s_nop 1
  v_permlane32_swap_b32 v32, v34
  v_permlane32_swap_b32 v33, v35
  v_pk_add_f32 v[32:33], v[32:33], v[34:35]
  v_mov_b32 v34, v32
  v_mov_b32 v35, v33
  s_nop 0
  v_permlane16_swap_b32 v32, v34
  v_permlane16_swap_b32 v33, v35
  v_pk_add_f32 v[32:33], v[32:33], v[34:35]
  v_mul_f32 v32, 0x3a800000, v32
  v_mul_f32 v33, 0x3a800000, v33
  v_fma_f32 v33, -v32, v32, v33
  v_max_f32 v33, 0, v33
  v_add_f32 v33, 0x3727c5ac, v33
  v_rsq_f32 v33, v33
  s_nop 0
  s_and_b32 s3, s70, 3
  s_lshl_b32 s5, s3, 7
  s_add_u32 s5, s5, 129088
  v_and_b32 v3, 15, v1
  v_lshrrev_b32 v2, 5, v1
  v_lshl_add_u32 v2, v3, 1, v2
  v_lshl_add_u32 v2, v2, 2, s5
  ds_write2_b32 v2, v32, v33 offset0:0 offset1:160
  v_mov_b32 v50, v48
  v_mov_b32 v51, v49
  s_nop 0
  v_permlane32_swap_b32 v48, v50
  v_permlane32_swap_b32 v49, v51
  v_pk_add_f32 v[48:49], v[48:49], v[50:51]
  v_mov_b32 v50, v48
  v_mov_b32 v51, v49
  s_nop 0
  v_permlane16_swap_b32 v48, v50
  v_permlane16_swap_b32 v49, v51
  v_pk_add_f32 v[48:49], v[48:49], v[50:51]
  s_nop 1
  v_add_f32_dpp v48, v48, v48 row_ror:8 row_mask:0xf bank_mask:0xf
  v_add_f32_dpp v49, v49, v49 row_ror:8 row_mask:0xf bank_mask:0xf
  s_nop 1
  v_add_f32_dpp v48, v48, v48 row_ror:4 row_mask:0xf bank_mask:0xf
  v_add_f32_dpp v49, v49, v49 row_ror:4 row_mask:0xf bank_mask:0xf
  v_mul_f32 v48, 0x3a800000, v48
  v_mul_f32 v49, 0x3a800000, v49
  v_fma_f32 v49, -v48, v48, v49
  v_max_f32 v49, 0, v49
  v_add_f32 v49, 0x3727c5ac, v49
  v_rsq_f32 v49, v49
  s_nop 0
  s_lshl_b32 s5, s3, 4
  s_add_u32 s5, s5, 129024
  v_and_b32 v3, 3, v1
  v_lshl_add_u32 v2, v3, 2, s5
  ds_write2_b32 v2, v48, v49 offset0:0 offset1:160
  s_waitcnt lgkmcnt(0)
  s_barrier
  s_barrier
L_attn_ldend:
  s_lshl_b32 s87, s97, 15
  s_lshl_b32 s4, s68, 11
  s_add_u32 s87, s87, s4
  s_lshl_b32 s4, s69, 2
  s_add_u32 s87, s87, s4
  s_add_u32 s97, s97, 1
  s_branch L_wo_body
L_attn_end:
  s_endpgm
.fill 1021, 4, 0xbf800000
L_attn_compute:
  s_cmp_lg_u32 s96, 0
  s_cbranch_scc1 L_pfc1_skip
  s_getpc_b64 s[4:5]
L_pfc1:
  s_lshl_b32 s3, s99, 2
  s_add_u32 s3, s3, s70
  s_mul_i32 s3, s3, 320
  s_min_u32 s3, s3, L_w2_c1-L_attn_c0-320
  s_add_i32 s3, s3, L_attn_c0-L_pfc1
  s_ashr_i32 s6, s3, 31
  s_add_u32 s4, s4, s3
  s_addc_u32 s5, s5, s6
  s_load_dword s40, s[4:5], 0
  s_load_dword s40, s[4:5], 64
  s_load_dword s40, s[4:5], 128
  s_load_dword s40, s[4:5], 192
  s_load_dword s40, s[4:5], 256
L_pfc1_skip:
  s_and_b32 s71, s70, 1
  s_lshr_b32 s72, s70, 1
  v_and_b32 v3, 31, v1
  v_lshlrev_b32 v3, 2, v3
  v_add_u32 v3, 40960, v3
  v_mov_b32 v236, 0x3f803f80
  v_mov_b32 v237, 0x3f803f80
  v_mov_b32 v238, 0x3f803f80
  v_mov_b32 v239, 0x3f803f80
  ds_write_b32 v3, v236
  ds_write_b32 v3, v236 offset:43008
  v_add_u32 v3, 86016, v3
  ds_write_b32 v3, v236
  ds_write_b32 v3, v236 offset:3328
  v_and_b32 v3, 15, v1
  v_lshrrev_b32 v2, 4, v1
  v_lshrrev_b32 v33, 1, v3
  s_lshl_b32 s8, s71, 13
  v_xor_b32 v4, v2, v33
  v_lshlrev_b32 v4, 4, v4
  v_lshl_add_u32 v4, v3, 7, v4
  v_add_u32 v8, 40960, v4
  v_add_u32 v4, s8, v4
  v_add_u32 v5, 4, v2
  v_xor_b32 v5, v5, v33
  v_lshlrev_b32 v5, 4, v5
  v_lshl_add_u32 v5, v3, 7, v5
  v_add_u32 v9, 40960, v5
  v_add_u32 v5, s8, v5
  v_bfe_u32 v34, v1, 2, 2
  v_lshl_add_u32 v34, v2, 3, v34
  v_lshlrev_b32 v34, 7, v34
  v_and_b32 v33, 3, v1
  v_lshl_add_u32 v34, v33, 3, v34
  v_bfe_u32 v33, v1, 3, 2
  v_lshl_add_u32 v34, v33, 5, v34
  s_lshl_b32 s8, s70, 5
  v_xor_b32 v34, s8, v34
  v_add_u32 v6, 16384, v34
  v_xor_b32 v7, 32, v6
  s_mov_b32 s75, 0
  v_add_u32_e64 v10, s75, v4
  v_add_u32_e64 v11, s75, v5
  v_add_u32_e64 v12, s75, v6
  v_add_u32_e64 v13, s75, v7
  v_add_u32_e64 v14, s75, v8
  v_add_u32_e64 v15, s75, v9
  s_add_u32 s75, s75, 43008
  s_cmp_eq_u32 s75, 129024
  s_cselect_b32 s75, 0, s75
  s_and_b32 s79, s69, 3
  s_add_u32 s79, s79, 1
  s_mul_i32 s98, s96, 3
  s_cmp_eq_u32 s96, 0
  s_cbranch_scc1 L_attn_nog
  s_mov_b32 s79, 15
  ds_read_b128 v[32:35], v10 offset:0
  ds_read_b128 v[36:39], v10 offset:2048
  ds_read_b128 v[40:43], v10 offset:4096
  ds_read_b128 v[44:47], v10 offset:6144
  ds_read_b64_tr_b16 v[52:53], v12 offset:0
  ds_read_b64_tr_b16 v[54:55], v12 offset:512
  ds_read_b64_tr_b16 v[56:57], v13 offset:0
  ds_read_b64_tr_b16 v[58:59], v13 offset:512
  ds_read_b64_tr_b16 v[60:61], v12 offset:8192
  ds_read_b64_tr_b16 v[62:63], v12 offset:8704
  ds_read_b64_tr_b16 v[64:65], v13 offset:8192
  ds_read_b64_tr_b16 v[66:67], v13 offset:8704
  ds_read_b64_tr_b16 v[68:69], v12 offset:16384
  ds_read_b64_tr_b16 v[70:71], v12 offset:16896
  ds_read_b64_tr_b16 v[72:73], v13 offset:16384
  ds_read_b64_tr_b16 v[74:75], v13 offset:16896
  s_waitcnt lgkmcnt(0)
  v_mfma_f32_16x16x32_bf16 v[128:131], v[52:55], v[32:35], 0
  ds_read_b128 v[76:79], v11 offset:0
  v_mfma_f32_16x16x32_bf16 v[132:135], v[52:55], v[36:39], 0
  ds_read_b128 v[80:83], v11 offset:2048
  v_mfma_f32_16x16x32_bf16 v[136:139], v[52:55], v[40:43], 0
  ds_read_b128 v[84:87], v11 offset:4096
  v_mfma_f32_16x16x32_bf16 v[140:143], v[52:55], v[44:47], 0
  ds_read_b128 v[88:91], v11 offset:6144
  v_mfma_f32_16x16x32_bf16 v[156:159], v[56:59], v[44:47], 0
  ds_read_b64_tr_b16 v[96:97], v12 offset:4096
  v_mfma_f32_16x16x32_bf16 v[152:155], v[56:59], v[40:43], 0
  ds_read_b64_tr_b16 v[98:99], v12 offset:4608
  v_mfma_f32_16x16x32_bf16 v[148:151], v[56:59], v[36:39], 0
  ds_read_b64_tr_b16 v[100:101], v13 offset:4096
  v_mfma_f32_16x16x32_bf16 v[144:147], v[56:59], v[32:35], 0
  ds_read_b64_tr_b16 v[102:103], v13 offset:4608
  v_mfma_f32_16x16x32_bf16 v[160:163], v[60:63], v[32:35], 0
  ds_read_b64_tr_b16 v[104:105], v12 offset:12288
  v_mfma_f32_16x16x32_bf16 v[164:167], v[60:63], v[36:39], 0
  ds_read_b64_tr_b16 v[106:107], v12 offset:12800
  v_mfma_f32_16x16x32_bf16 v[168:171], v[60:63], v[40:43], 0
  ds_read_b64_tr_b16 v[108:109], v13 offset:12288
  v_mfma_f32_16x16x32_bf16 v[172:175], v[60:63], v[44:47], 0
  ds_read_b64_tr_b16 v[110:111], v13 offset:12800
  v_mfma_f32_16x16x32_bf16 v[188:191], v[64:67], v[44:47], 0
  ds_read_b64_tr_b16 v[112:113], v12 offset:20480
  v_mfma_f32_16x16x32_bf16 v[184:187], v[64:67], v[40:43], 0
  ds_read_b64_tr_b16 v[114:115], v12 offset:20992
  v_mfma_f32_16x16x32_bf16 v[180:183], v[64:67], v[36:39], 0
  ds_read_b64_tr_b16 v[116:117], v13 offset:20480
  v_mfma_f32_16x16x32_bf16 v[176:179], v[64:67], v[32:35], 0
  ds_read_b64_tr_b16 v[118:119], v13 offset:20992
  v_mfma_f32_16x16x32_bf16 v[192:195], v[32:35], v[68:71], 0
  v_add_u32_e64 v10, s75, v4
  v_mfma_f32_16x16x32_bf16 v[196:199], v[36:39], v[68:71], 0
  v_add_u32_e64 v11, s75, v5
  v_mfma_f32_16x16x32_bf16 v[200:203], v[40:43], v[68:71], 0
  v_add_u32_e64 v12, s75, v6
  v_mfma_f32_16x16x32_bf16 v[204:207], v[44:47], v[68:71], 0
  v_add_u32_e64 v13, s75, v7
  v_mfma_f32_16x16x32_bf16 v[220:223], v[44:47], v[72:75], 0
  v_add_u32_e64 v14, s75, v8
  v_mfma_f32_16x16x32_bf16 v[216:219], v[40:43], v[72:75], 0
  v_add_u32_e64 v15, s75, v9
  v_mfma_f32_16x16x32_bf16 v[212:215], v[36:39], v[72:75], 0
  s_add_u32 s75, s75, 43008
  v_mfma_f32_16x16x32_bf16 v[208:211], v[32:35], v[72:75], 0
  s_cmp_eq_u32 s75, 129024
  s_cselect_b32 s75, 0, s75
  s_waitcnt lgkmcnt(0)
  v_mfma_f32_16x16x32_bf16 v[128:131], v[96:99], v[76:79], v[128:131]
  v_mfma_f32_16x16x32_bf16 v[132:135], v[96:99], v[80:83], v[132:135]
  v_mfma_f32_16x16x32_bf16 v[136:139], v[96:99], v[84:87], v[136:139]
  v_mfma_f32_16x16x32_bf16 v[140:143], v[96:99], v[88:91], v[140:143]
  v_mfma_f32_16x16x32_bf16 v[156:159], v[100:103], v[88:91], v[156:159]
  v_mfma_f32_16x16x32_bf16 v[152:155], v[100:103], v[84:87], v[152:155]
  v_mfma_f32_16x16x32_bf16 v[148:151], v[100:103], v[80:83], v[148:151]
  v_mfma_f32_16x16x32_bf16 v[144:147], v[100:103], v[76:79], v[144:147]
  v_mfma_f32_16x16x32_bf16 v[160:163], v[104:107], v[76:79], v[160:163]
  v_mfma_f32_16x16x32_bf16 v[164:167], v[104:107], v[80:83], v[164:167]
  v_mfma_f32_16x16x32_bf16 v[168:171], v[104:107], v[84:87], v[168:171]
  v_mfma_f32_16x16x32_bf16 v[172:175], v[104:107], v[88:91], v[172:175]
  v_mfma_f32_16x16x32_bf16 v[188:191], v[108:111], v[88:91], v[188:191]
  v_mfma_f32_16x16x32_bf16 v[184:187], v[108:111], v[84:87], v[184:187]
  v_mfma_f32_16x16x32_bf16 v[180:183], v[108:111], v[80:83], v[180:183]
  v_mfma_f32_16x16x32_bf16 v[176:179], v[108:111], v[76:79], v[176:179]
  v_mfma_f32_16x16x32_bf16 v[192:195], v[76:79], v[112:115], v[192:195]
  v_mfma_f32_16x16x32_bf16 v[196:199], v[80:83], v[112:115], v[196:199]
  v_mfma_f32_16x16x32_bf16 v[200:203], v[84:87], v[112:115], v[200:203]
  v_mfma_f32_16x16x32_bf16 v[204:207], v[88:91], v[112:115], v[204:207]
  v_mfma_f32_16x16x32_bf16 v[220:223], v[88:91], v[116:119], v[220:223]
  v_mfma_f32_16x16x32_bf16 v[216:219], v[84:87], v[116:119], v[216:219]
  v_mfma_f32_16x16x32_bf16 v[212:215], v[80:83], v[116:119], v[212:215]
  v_mfma_f32_16x16x32_bf16 v[208:211], v[76:79], v[116:119], v[208:211]
  s_barrier
  v_mov_b32 v76, v52
  v_mov_b32 v77, v53
  v_mov_b32 v78, v54
  v_mov_b32 v79, v55
  v_mov_b32 v80, v60
  v_mov_b32 v81, v61
  v_mov_b32 v82, v62
  v_mov_b32 v83, v63
  v_mov_b32 v84, v68
  v_mov_b32 v85, v69
  v_mov_b32 v86, v70
  v_mov_b32 v87, v71
L_attn_nog:
  v_and_b32 v35, 1, v2
  v_xor_b32 v35, s71, v35
  s_lshl_b32 s8, s68, 7
  s_lshl_b32 s9, s71, 6
  s_add_u32 s8, s8, s9
  s_mul_i32 s10, s8, 7
  s_lshl2_add_u32 s11, s69, s72
  s_add_u32 s10, s10, s11
  s_lshl_b32 s10, s10, 10
  v_lshl_add_u32 v31, v1, 4, s10
  s_mul_i32 s10, s72, 14336
  s_add_u32 s10, s10, 1024
  s_lshl_b32 s11, s71, 10
  s_add_u32 s4, s10, s11
  s_sub_u32 s5, s10, s11
  s_mul_i32 s6, s71, 6144
  v_lshl_add_u32 v16, v1, 4, s4
  v_add_u32 v17, s6, v16
  v_lshl_add_u32 v18, v1, 4, s5
  v_add_u32 v18, s6, v18
  v_lshl_add_u32 v19, v2, 8, s4
  v_lshl_add_u32 v20, v2, 8, s5
  v_lshl_add_u32 v21, v3, 4, s4
  v_lshl_add_u32 v22, v3, 4, s5
  s_lshl_b32 s10, s71, 8
  s_add_u32 s10, s10, 129024
  v_lshl_add_u32 v23, v3, 2, s10
  v_lshl_add_u32 v24, v2, 4, s10
  v_and_b32 v33, 1, v3
  v_cmp_eq_u32 s[48:49], 1, v33
  v_lshl_add_u32 v34, v2, 2, v33
  v_add_u32 v35, 2, v34
  v_cmp_gt_u32 s[50:51], v34, v3
  v_cmp_gt_u32 s[52:53], v35, v3
  v_mov_b32 v36, 0xffff
  v_mov_b32 v37, 0xffff0000
  v_cndmask_b32 v36, v36, v37, s[48:49]
  s_add_u32 s10, s10, 704
  v_lshl_add_u32 v34, v34, 2, s10
  v_lshl_add_u32 v35, v35, 2, s10
  v_subrev_u32 v38, 64, v34
  v_subrev_u32 v39, 64, v35
  v_cndmask_b32 v25, v34, v38, s[50:51]
  v_cndmask_b32 v26, v35, v39, s[52:53]
  v_cndmask_b32 v27, 0, v36, s[50:51]
  v_cndmask_b32 v29, 0, v36, s[52:53]
  v_xor_b32 v28, v27, v36
  v_xor_b32 v30, v29, v36
  s_cmp_eq_u32 s8, 0
  s_cselect_b64 s[54:55], s[50:51], 0
  s_cselect_b64 s[14:15], s[52:53], 0
  s_cmp_lg_u32 s96, 0
  s_cbranch_scc1 L_attn_nozero
  v_mov_b32 v122, 0
  v_mov_b32 v123, 0
  v_mov_b32 v124, 0
  v_mov_b32 v125, 0
  v_mov_b32 v126, 0
  v_mov_b32 v127, 0
  v_mov_b32 v128, 0
  v_mov_b32 v129, 0
  v_mov_b32 v130, 0
  v_mov_b32 v131, 0
  v_mov_b32 v132, 0
  v_mov_b32 v133, 0
  v_mov_b32 v134, 0
  v_mov_b32 v135, 0
  v_mov_b32 v136, 0
  v_mov_b32 v137, 0
  v_mov_b32 v138, 0
  v_mov_b32 v139, 0
  v_mov_b32 v140, 0
  v_mov_b32 v141, 0
  v_mov_b32 v142, 0
  v_mov_b32 v143, 0
  v_mov_b32 v144, 0
  v_mov_b32 v145, 0
  v_mov_b32 v146, 0
  v_mov_b32 v147, 0
  v_mov_b32 v148, 0
  v_mov_b32 v149, 0
  v_mov_b32 v150, 0
  v_mov_b32 v151, 0
  v_mov_b32 v152, 0
  v_mov_b32 v153, 0
  v_mov_b32 v154, 0
  v_mov_b32 v155, 0
  v_mov_b32 v156, 0
  v_mov_b32 v157, 0
  v_mov_b32 v158, 0
  v_mov_b32 v159, 0
  v_mov_b32 v160, 0
  v_mov_b32 v161, 0
  v_mov_b32 v162, 0
  v_mov_b32 v163, 0
  v_mov_b32 v164, 0
  v_mov_b32 v165, 0
  v_mov_b32 v166, 0
  v_mov_b32 v167, 0
  v_mov_b32 v168, 0
  v_mov_b32 v169, 0
  v_mov_b32 v170, 0
  v_mov_b32 v171, 0
  v_mov_b32 v172, 0
  v_mov_b32 v173, 0
  v_mov_b32 v174, 0
  v_mov_b32 v175, 0
  v_mov_b32 v176, 0
  v_mov_b32 v177, 0
  v_mov_b32 v178, 0
  v_mov_b32 v179, 0
  v_mov_b32 v180, 0
  v_mov_b32 v181, 0
  v_mov_b32 v182, 0
  v_mov_b32 v183, 0
  v_mov_b32 v184, 0
  v_mov_b32 v185, 0
  v_mov_b32 v186, 0
  v_mov_b32 v187, 0
  v_mov_b32 v188, 0
  v_mov_b32 v189, 0
  v_mov_b32 v190, 0
  v_mov_b32 v191, 0
  v_mov_b32 v192, 0
  v_mov_b32 v193, 0
  v_mov_b32 v194, 0
  v_mov_b32 v195, 0
  v_mov_b32 v196, 0
  v_mov_b32 v197, 0
  v_mov_b32 v198, 0
  v_mov_b32 v199, 0
  v_mov_b32 v200, 0
  v_mov_b32 v201, 0
  v_mov_b32 v202, 0
  v_mov_b32 v203, 0
  v_mov_b32 v204, 0
  v_mov_b32 v205, 0
  v_mov_b32 v206, 0
  v_mov_b32 v207, 0
  v_mov_b32 v208, 0
  v_mov_b32 v209, 0
  v_mov_b32 v210, 0
  v_mov_b32 v211, 0
  v_mov_b32 v212, 0
  v_mov_b32 v213, 0
  v_mov_b32 v214, 0
  v_mov_b32 v215, 0
  v_mov_b32 v216, 0
  v_mov_b32 v217, 0
  v_mov_b32 v218, 0
  v_mov_b32 v219, 0
  v_mov_b32 v220, 0
  v_mov_b32 v221, 0
  v_mov_b32 v222, 0
  v_mov_b32 v223, 0
  v_mov_b32 v224, 0
  v_mov_b32 v225, 0
  v_mov_b32 v226, 0
  v_mov_b32 v227, 0
  v_mov_b32 v228, 0
  v_mov_b32 v229, 0
  v_mov_b32 v230, 0
  v_mov_b32 v231, 0
  v_mov_b32 v232, 0
  v_mov_b32 v233, 0
  v_mov_b32 v234, 0
  v_mov_b32 v235, 0
  s_waitcnt lgkmcnt(0)
  s_lshl_b32 s3, s72, 5
  s_add_u32 s3, s3, s8
  s_lshl_b32 s4, s69, 14
  s_lshl3_add_u32 s3, s3, s4
  v_lshrrev_b32 v121, 1, v2
  v_lshl_add_u32 v121, v121, 4, v3
  v_and_b32 v120, 1, v2
  v_lshl_add_u32 v121, v121, 1, v120
  v_lshl_add_u32 v120, v121, 2, s3
  s_add_u32 s56, s22, 24903680
  s_addc_u32 s57, s23, 0
  s_and_b32 s57, s57, 0xffff
  s_mov_b32 s58, 262144
  s_mov_b32 s59, 0x00020000
  s_add_u32 s60, s22, 41943040
  s_addc_u32 s61, s23, 0
  s_and_b32 s61, s61, 0xffff
  s_mov_b32 s62, 524288
  s_mov_b32 s63, 0x00020000
  s_lshl_b32 s3, s2, 11
  s_cmp_lg_u32 s70, 0
  s_cbranch_scc1 L_attn_noclr
  s_lshl_b32 s5, s68, 10
  s_add_u32 s4, s4, s5
  v_lshlrev_b32 v121, 4, v1
  v_mov_b32 v40, -1
  v_mov_b32 v41, -1
  v_mov_b32 v42, -1
  v_mov_b32 v43, -1
  buffer_store_dwordx4 v[40:43], v121, s[56:59], s4 offen sc1
  buffer_store_dwordx4 v[128:131], v121, s[60:63], s3 offen offset:0 sc1
  buffer_store_dwordx4 v[128:131], v121, s[60:63], s3 offen offset:1024 sc1
  v_mov_b32 v126, 1
L_attn_noclr:
  s_and_b32 s65, s65, 0xffff
  s_mov_b32 s66, 256
  s_mov_b32 s67, 0x00020000
  s_mov_b32 s7, 0x3f803f80
L_attn_nozero:
  s_waitcnt lgkmcnt(0)
  s_add_u32 s44, s34, 8439808
  s_addc_u32 s45, s35, 0
  s_and_b32 s45, s45, 0xffff
  s_mov_b32 s46, 14628864
  s_mov_b32 s47, 0x00020000
  s_cmp_eq_u32 s96, 0
  s_barrier
  s_cbranch_scc1 L_attn_first
  ds_read_b128 v[88:91], v14 offset:46336
  ds_read_b128 v[92:95], v15 offset:46336
  ds_read_b128 v[32:35], v10 offset:0
  ds_read_b128 v[36:39], v10 offset:2048
  ds_read_b128 v[40:43], v10 offset:4096
  ds_read_b128 v[44:47], v10 offset:6144
  ds_read_b128 v[48:51], v14
  ds_read_b64_tr_b16 v[52:53], v12 offset:0
  ds_read_b64_tr_b16 v[54:55], v12 offset:512
  ds_read_b64_tr_b16 v[56:57], v13 offset:0
  ds_read_b64_tr_b16 v[58:59], v13 offset:512
  ds_read_b64_tr_b16 v[60:61], v12 offset:8192
  ds_read_b64_tr_b16 v[62:63], v12 offset:8704
  ds_read_b64_tr_b16 v[64:65], v13 offset:8192
  ds_read_b64_tr_b16 v[66:67], v13 offset:8704
  ds_read_b64_tr_b16 v[68:69], v12 offset:16384
  ds_read_b64_tr_b16 v[70:71], v12 offset:16896
  ds_read_b64_tr_b16 v[72:73], v13 offset:16384
  ds_read_b64_tr_b16 v[74:75], v13 offset:16896
  s_waitcnt lgkmcnt(15)
  v_mfma_f32_16x16x32_bf16 v[224:227], v[76:79], v[88:91], 0
  v_mfma_f32_16x16x32_bf16 v[228:231], v[80:83], v[88:91], 0
  v_mfma_f32_16x16x32_bf16 v[232:235], v[88:91], v[84:87], 0
  v_mfma_f32_16x16x32_bf16 v[224:227], v[96:99], v[92:95], v[224:227]
  v_mfma_f32_16x16x32_bf16 v[228:231], v[104:107], v[92:95], v[228:231]
  v_mfma_f32_16x16x32_bf16 v[232:235], v[92:95], v[112:115], v[232:235]
  s_waitcnt lgkmcnt(0)
  s_branch L_attn_loop
L_attn_first:
  ds_read_b128 v[32:35], v10 offset:0
  ds_read_b128 v[36:39], v10 offset:2048
  ds_read_b128 v[40:43], v10 offset:4096
  ds_read_b128 v[44:47], v10 offset:6144
  ds_read_b128 v[48:51], v14
  ds_read_b64_tr_b16 v[52:53], v12 offset:0
  ds_read_b64_tr_b16 v[54:55], v12 offset:512
  ds_read_b64_tr_b16 v[56:57], v13 offset:0
  ds_read_b64_tr_b16 v[58:59], v13 offset:512
  ds_read_b64_tr_b16 v[60:61], v12 offset:8192
  ds_read_b64_tr_b16 v[62:63], v12 offset:8704
  ds_read_b64_tr_b16 v[64:65], v13 offset:8192
  ds_read_b64_tr_b16 v[66:67], v13 offset:8704
  ds_read_b64_tr_b16 v[68:69], v12 offset:16384
  ds_read_b64_tr_b16 v[70:71], v12 offset:16896
  ds_read_b64_tr_b16 v[72:73], v13 offset:16384
  ds_read_b64_tr_b16 v[74:75], v13 offset:16896
.p2align 5
  s_nop 0
  s_nop 0
  s_nop 0
  s_waitcnt lgkmcnt(0)
L_attn_loop:
  v_mfma_f32_16x16x32_bf16 v[128:131], v[52:55], v[32:35], v[128:131]
  ds_read_b128 v[76:79], v11 offset:0
  v_mfma_f32_16x16x32_bf16 v[132:135], v[52:55], v[36:39], v[132:135]
  ds_read_b128 v[80:83], v11 offset:2048
  v_mfma_f32_16x16x32_bf16 v[136:139], v[52:55], v[40:43], v[136:139]
  ds_read_b128 v[84:87], v11 offset:4096
  v_mfma_f32_16x16x32_bf16 v[140:143], v[52:55], v[44:47], v[140:143]
  ds_read_b128 v[88:91], v11 offset:6144
  v_mfma_f32_16x16x32_bf16 v[224:227], v[52:55], v[48:51], v[224:227]
  ds_read_b128 v[92:95], v15
  v_mfma_f32_16x16x32_bf16 v[156:159], v[56:59], v[44:47], v[156:159]
  ds_read_b64_tr_b16 v[96:97], v12 offset:4096
  v_mfma_f32_16x16x32_bf16 v[152:155], v[56:59], v[40:43], v[152:155]
  ds_read_b64_tr_b16 v[98:99], v12 offset:4608
  v_mfma_f32_16x16x32_bf16 v[148:151], v[56:59], v[36:39], v[148:151]
  ds_read_b64_tr_b16 v[100:101], v13 offset:4096
  v_mfma_f32_16x16x32_bf16 v[144:147], v[56:59], v[32:35], v[144:147]
  ds_read_b64_tr_b16 v[102:103], v13 offset:4608
  v_mfma_f32_16x16x32_bf16 v[160:163], v[60:63], v[32:35], v[160:163]
  ds_read_b64_tr_b16 v[104:105], v12 offset:12288
  v_mfma_f32_16x16x32_bf16 v[164:167], v[60:63], v[36:39], v[164:167]
  ds_read_b64_tr_b16 v[106:107], v12 offset:12800
  v_mfma_f32_16x16x32_bf16 v[168:171], v[60:63], v[40:43], v[168:171]
  ds_read_b64_tr_b16 v[108:109], v13 offset:12288
  v_mfma_f32_16x16x32_bf16 v[172:175], v[60:63], v[44:47], v[172:175]
  ds_read_b64_tr_b16 v[110:111], v13 offset:12800
  v_mfma_f32_16x16x32_bf16 v[228:231], v[60:63], v[48:51], v[228:231]
  ds_read_b64_tr_b16 v[112:113], v12 offset:20480
  v_mfma_f32_16x16x32_bf16 v[188:191], v[64:67], v[44:47], v[188:191]
  ds_read_b64_tr_b16 v[114:115], v12 offset:20992
  v_mfma_f32_16x16x32_bf16 v[184:187], v[64:67], v[40:43], v[184:187]
  ds_read_b64_tr_b16 v[116:117], v13 offset:20480
  v_mfma_f32_16x16x32_bf16 v[180:183], v[64:67], v[36:39], v[180:183]
  ds_read_b64_tr_b16 v[118:119], v13 offset:20992
  v_mfma_f32_16x16x32_bf16 v[176:179], v[64:67], v[32:35], v[176:179]
  v_add_u32_e64 v10, s75, v4
  v_mfma_f32_16x16x32_bf16 v[192:195], v[32:35], v[68:71], v[192:195]
  v_add_u32_e64 v11, s75, v5
  v_mfma_f32_16x16x32_bf16 v[196:199], v[36:39], v[68:71], v[196:199]
  v_add_u32_e64 v12, s75, v6
  v_mfma_f32_16x16x32_bf16 v[200:203], v[40:43], v[68:71], v[200:203]
  v_add_u32_e64 v13, s75, v7
  v_mfma_f32_16x16x32_bf16 v[204:207], v[44:47], v[68:71], v[204:207]
  v_add_u32_e64 v14, s75, v8
  v_mfma_f32_16x16x32_bf16 v[232:235], v[48:51], v[68:71], v[232:235]
  v_add_u32_e64 v15, s75, v9
  v_mfma_f32_16x16x32_bf16 v[220:223], v[44:47], v[72:75], v[220:223]
  s_add_u32 s75, s75, 43008
  v_mfma_f32_16x16x32_bf16 v[216:219], v[40:43], v[72:75], v[216:219]
  s_cmp_eq_u32 s75, 129024
  v_mfma_f32_16x16x32_bf16 v[212:215], v[36:39], v[72:75], v[212:215]
  s_cselect_b32 s75, 0, s75
  s_sub_u32 s79, s79, 1
  v_mfma_f32_16x16x32_bf16 v[208:211], v[32:35], v[72:75], v[208:211]
  s_waitcnt lgkmcnt(0)
  s_barrier
  v_mfma_f32_16x16x32_bf16 v[128:131], v[96:99], v[76:79], v[128:131]
  ds_read_b128 v[32:35], v10 offset:0
  v_mfma_f32_16x16x32_bf16 v[132:135], v[96:99], v[80:83], v[132:135]
  ds_read_b128 v[36:39], v10 offset:2048
  v_mfma_f32_16x16x32_bf16 v[136:139], v[96:99], v[84:87], v[136:139]
  ds_read_b128 v[40:43], v10 offset:4096
  v_mfma_f32_16x16x32_bf16 v[140:143], v[96:99], v[88:91], v[140:143]
  ds_read_b128 v[44:47], v10 offset:6144
  v_mfma_f32_16x16x32_bf16 v[224:227], v[96:99], v[92:95], v[224:227]
  ds_read_b128 v[48:51], v14
  v_mfma_f32_16x16x32_bf16 v[156:159], v[100:103], v[88:91], v[156:159]
  ds_read_b64_tr_b16 v[52:53], v12 offset:0
  v_mfma_f32_16x16x32_bf16 v[152:155], v[100:103], v[84:87], v[152:155]
  ds_read_b64_tr_b16 v[54:55], v12 offset:512
  v_mfma_f32_16x16x32_bf16 v[148:151], v[100:103], v[80:83], v[148:151]
  ds_read_b64_tr_b16 v[56:57], v13 offset:0
  v_mfma_f32_16x16x32_bf16 v[144:147], v[100:103], v[76:79], v[144:147]
  ds_read_b64_tr_b16 v[58:59], v13 offset:512
  v_mfma_f32_16x16x32_bf16 v[160:163], v[104:107], v[76:79], v[160:163]
  ds_read_b64_tr_b16 v[60:61], v12 offset:8192
  v_mfma_f32_16x16x32_bf16 v[164:167], v[104:107], v[80:83], v[164:167]
  ds_read_b64_tr_b16 v[62:63], v12 offset:8704
  v_mfma_f32_16x16x32_bf16 v[168:171], v[104:107], v[84:87], v[168:171]
  ds_read_b64_tr_b16 v[64:65], v13 offset:8192
  v_mfma_f32_16x16x32_bf16 v[172:175], v[104:107], v[88:91], v[172:175]
  ds_read_b64_tr_b16 v[66:67], v13 offset:8704
  v_mfma_f32_16x16x32_bf16 v[228:231], v[104:107], v[92:95], v[228:231]
  ds_read_b64_tr_b16 v[68:69], v12 offset:16384
  v_mfma_f32_16x16x32_bf16 v[188:191], v[108:111], v[88:91], v[188:191]
  ds_read_b64_tr_b16 v[70:71], v12 offset:16896
  v_mfma_f32_16x16x32_bf16 v[184:187], v[108:111], v[84:87], v[184:187]
  ds_read_b64_tr_b16 v[72:73], v13 offset:16384
  v_mfma_f32_16x16x32_bf16 v[180:183], v[108:111], v[80:83], v[180:183]
  ds_read_b64_tr_b16 v[74:75], v13 offset:16896
  v_mfma_f32_16x16x32_bf16 v[176:179], v[108:111], v[76:79], v[176:179]
  s_cmp_lg_u32 s79, 0
  s_nop 0
  v_mfma_f32_16x16x32_bf16 v[192:195], v[76:79], v[112:115], v[192:195]
  v_mfma_f32_16x16x32_bf16 v[196:199], v[80:83], v[112:115], v[196:199]
  v_mfma_f32_16x16x32_bf16 v[200:203], v[84:87], v[112:115], v[200:203]
  v_mfma_f32_16x16x32_bf16 v[204:207], v[88:91], v[112:115], v[204:207]
  v_mfma_f32_16x16x32_bf16 v[232:235], v[92:95], v[112:115], v[232:235]
  v_mfma_f32_16x16x32_bf16 v[220:223], v[88:91], v[116:119], v[220:223]
  v_mfma_f32_16x16x32_bf16 v[216:219], v[84:87], v[116:119], v[216:219]
  v_mfma_f32_16x16x32_bf16 v[212:215], v[80:83], v[116:119], v[212:215]
  v_mfma_f32_16x16x32_bf16 v[208:211], v[76:79], v[116:119], v[208:211]
  s_waitcnt lgkmcnt(0)
  s_cbranch_scc1 L_attn_loop
L_attn_lend:
  s_add_u32 s98, s98, 1
  s_cmp_gt_u32 s98, 3
  s_cbranch_scc1 L_attn_exit
  s_cmp_lg_u32 s98, 1
  s_cbranch_scc1 L_attn_hook0
  s_mov_b32 s79, 1
  s_cmp_lg_u32 s72, 0
  s_cbranch_scc1 L_attn_dot0
  v_dot2_f32_bf16 v122, v32, s7, v122
  v_dot2_f32_bf16 v124, v32, v32, v124
  v_dot2_f32_bf16 v123, v36, s7, v123
  v_dot2_f32_bf16 v125, v36, v36, v125
  v_dot2_f32_bf16 v122, v33, s7, v122
  v_dot2_f32_bf16 v124, v33, v33, v124
  v_dot2_f32_bf16 v123, v37, s7, v123
  v_dot2_f32_bf16 v125, v37, v37, v125
  v_dot2_f32_bf16 v122, v34, s7, v122
  v_dot2_f32_bf16 v124, v34, v34, v124
  v_dot2_f32_bf16 v123, v38, s7, v123
  v_dot2_f32_bf16 v125, v38, v38, v125
  v_dot2_f32_bf16 v122, v35, s7, v122
  v_dot2_f32_bf16 v124, v35, v35, v124
  v_dot2_f32_bf16 v123, v39, s7, v123
  v_dot2_f32_bf16 v125, v39, v39, v125
  s_branch L_attn_dote0
  L_attn_dot0:
  v_dot2_f32_bf16 v122, v40, s7, v122
  v_dot2_f32_bf16 v124, v40, v40, v124
  v_dot2_f32_bf16 v123, v44, s7, v123
  v_dot2_f32_bf16 v125, v44, v44, v125
  v_dot2_f32_bf16 v122, v41, s7, v122
  v_dot2_f32_bf16 v124, v41, v41, v124
  v_dot2_f32_bf16 v123, v45, s7, v123
  v_dot2_f32_bf16 v125, v45, v45, v125
  v_dot2_f32_bf16 v122, v42, s7, v122
  v_dot2_f32_bf16 v124, v42, v42, v124
  v_dot2_f32_bf16 v123, v46, s7, v123
  v_dot2_f32_bf16 v125, v46, v46, v125
  v_dot2_f32_bf16 v122, v43, s7, v122
  v_dot2_f32_bf16 v124, v43, v43, v124
  v_dot2_f32_bf16 v123, v47, s7, v123
  v_dot2_f32_bf16 v125, v47, v47, v125
  L_attn_dote0:
  s_cmp_lg_u32 s70, 0
  s_cbranch_scc1 L_attn_loop
  s_waitcnt vmcnt(0)
  s_lshl4_add_u32 s3, s68, s69
  s_mov_b64 exec, 1
  buffer_store_byte v126, off, s[64:67], s3 sc1
  s_mov_b64 exec, -1
  s_branch L_attn_loop
L_attn_hook0:
  s_cmp_lg_u32 s98, 2
  s_cbranch_scc1 L_attn_hook1
  s_and_b32 s79, s69, 3
  s_add_u32 s79, s79, 1
  s_sub_u32 s79, 13, s79
  s_cmp_lg_u32 s72, 0
  s_cbranch_scc1 L_attn_dot1
  v_dot2_f32_bf16 v122, v76, s7, v122
  v_dot2_f32_bf16 v124, v76, v76, v124
  v_dot2_f32_bf16 v123, v80, s7, v123
  v_dot2_f32_bf16 v125, v80, v80, v125
  v_dot2_f32_bf16 v122, v77, s7, v122
  v_dot2_f32_bf16 v124, v77, v77, v124
  v_dot2_f32_bf16 v123, v81, s7, v123
  v_dot2_f32_bf16 v125, v81, v81, v125
  v_dot2_f32_bf16 v122, v78, s7, v122
  v_dot2_f32_bf16 v124, v78, v78, v124
  v_dot2_f32_bf16 v123, v82, s7, v123
  v_dot2_f32_bf16 v125, v82, v82, v125
  v_dot2_f32_bf16 v122, v79, s7, v122
  v_dot2_f32_bf16 v124, v79, v79, v124
  v_dot2_f32_bf16 v123, v83, s7, v123
  v_dot2_f32_bf16 v125, v83, v83, v125
  s_branch L_attn_dote1
  L_attn_dot1:
  v_dot2_f32_bf16 v122, v84, s7, v122
  v_dot2_f32_bf16 v124, v84, v84, v124
  v_dot2_f32_bf16 v123, v88, s7, v123
  v_dot2_f32_bf16 v125, v88, v88, v125
  v_dot2_f32_bf16 v122, v85, s7, v122
  v_dot2_f32_bf16 v124, v85, v85, v124
  v_dot2_f32_bf16 v123, v89, s7, v123
  v_dot2_f32_bf16 v125, v89, v89, v125
  v_dot2_f32_bf16 v122, v86, s7, v122
  v_dot2_f32_bf16 v124, v86, v86, v124
  v_dot2_f32_bf16 v123, v90, s7, v123
  v_dot2_f32_bf16 v125, v90, v90, v125
  v_dot2_f32_bf16 v122, v87, s7, v122
  v_dot2_f32_bf16 v124, v87, v87, v124
  v_dot2_f32_bf16 v123, v91, s7, v123
  v_dot2_f32_bf16 v125, v91, v91, v125
  L_attn_dote1:
  s_nop 2
  v_permlane32_swap_b32 v122, v123
  v_permlane32_swap_b32 v124, v125
  v_add_f32 v122, v122, v123
  v_add_f32 v124, v124, v125
  s_nop 0
  s_nop 0
  v_permlane16_swap_b32 v122, v124
  v_add_f32 v122, v122, v124
  buffer_store_dword v122, v120, s[56:59], 0 offen sc1
  s_branch L_attn_loop
L_attn_hook1:
  s_mov_b32 s79, 2
  s_mov_b32 s36, s16
  s_and_b32 s37, s17, 0xffff
  s_mov_b32 s38, 4194304
  s_mov_b32 s39, 0x00020000
  s_and_b32 s3, s2, 3
  s_and_b32 s4, s99, 3
  s_lshl2_add_u32 s3, s3, s4
  s_lshl2_add_u32 s3, s3, s70
  s_lshl_b32 s3, s3, 16
  s_bfe_u32 s4, s2, 0x10002
  s_lshr_b32 s5, s99, 2
  s_lshl1_add_u32 s4, s5, s4
  s_lshl_b32 s4, s4, 7
  s_add_u32 s3, s3, s4
  s_add_u32 s4, s3, 32768
  v_and_b32 v122, 15, v1
  v_lshlrev_b32 v123, 1, v1
  v_and_b32 v123, 32, v123
  v_lshl_add_u32 v122, v122, 11, v123
  v_lshrrev_b32 v123, 1, v1
  v_and_b32 v123, 16, v123
  v_add_u32 v122, v122, v123
  buffer_load_dwordx4 v[240:243], v122, s[36:39], s3 offen offset:0
  buffer_load_dwordx4 v[244:247], v122, s[36:39], s3 offen offset:64
  buffer_load_dwordx4 v[248:251], v122, s[36:39], s4 offen offset:0
  buffer_load_dwordx4 v[252:255], v122, s[36:39], s4 offen offset:64
  s_branch L_attn_loop
L_attn_exit:
  ds_read2_b32 v[66:67], v23 offset0:0 offset1:160
  ds_read2_b32 v[68:69], v23 offset0:16 offset1:176
  ds_read2_b32 v[70:71], v23 offset0:32 offset1:192
  ds_read2_b32 v[72:73], v23 offset0:48 offset1:208
  ds_read2_b32 v[74:75], v23 offset0:64 offset1:224
  ds_read2_b32 v[76:77], v25 offset0:0 offset1:16
  ds_read2_b32 v[80:81], v26 offset0:0 offset1:16
  ds_read2_b32 v[78:79], v25 offset0:32 offset1:48
  ds_read2_b32 v[82:83], v26 offset0:32 offset1:48
  ds_write_b128 v16, v[224:227] offset:0
  ds_write_b128 v16, v[228:231] offset:2048
  ds_write_b128 v16, v[232:235] offset:4096
  s_cmp_eq_u32 s71, 1
  s_cbranch_scc1 L_attn_nop3
  ds_write_b128 v16, v[172:175] offset:8192
  ds_write_b128 v16, v[188:191] offset:9216
  ds_write_b128 v16, v[204:207] offset:10240
  ds_write_b128 v16, v[220:223] offset:11264
L_attn_nop3:
  ds_read_b128 v[84:87], v24 offset:0
  ds_read_b128 v[104:107], v24 offset:640
  ds_read_b128 v[88:91], v24 offset:64
  ds_read_b128 v[108:111], v24 offset:704
  ds_read_b128 v[92:95], v24 offset:128
  ds_read_b128 v[112:115], v24 offset:768
  ds_read_b128 v[96:99], v24 offset:192
  ds_read_b128 v[116:119], v24 offset:832
  ds_read_b128 v[100:103], v24 offset:256
  ds_read_b128 v[120:123], v24 offset:896
  s_waitcnt lgkmcnt(10)
  s_barrier
  ds_read_b128 v[48:51], v19 offset:0
  ds_read_b128 v[52:55], v20 offset:1024
  ds_read_b128 v[56:59], v19 offset:2048
  ds_read_b128 v[60:63], v20 offset:3072
  ds_read_b32 v64, v21 offset:4096
  ds_read_b32 v65, v22 offset:5120
  ds_read_b128 v[32:35], v17 offset:2048
  ds_read_b128 v[36:39], v18 offset:3072
  ds_read_b128 v[40:43], v17 offset:4096
  ds_read_b128 v[44:47], v18 offset:5120
  v_mul_f32 v69, 0x3e8293ee, v69
  v_mul_f32 v71, 0x3e8293ee, v71
  v_mul_f32 v73, 0x3e8293ee, v73
  v_mul_f32 v75, 0x3e8293ee, v75
  v_mul_f32 v76, v76, v69
  v_mul_f32 v80, v80, v69
  v_mul_f32 v77, v77, v71
  v_mul_f32 v81, v81, v71
  v_mul_f32 v78, v78, v73
  v_mul_f32 v82, v82, v73
  v_mul_f32 v79, v79, v75
  v_mul_f32 v83, v83, v75
  s_waitcnt lgkmcnt(6)
  v_pk_fma_f32 v[128:129], v[48:49], v[68:69], v[128:129] op_sel:[0,0,0] op_sel_hi:[1,0,1] neg_lo:[0,1,0] neg_hi:[0,1,0]
  v_pk_fma_f32 v[130:131], v[50:51], v[68:69], v[130:131] op_sel:[0,0,0] op_sel_hi:[1,0,1] neg_lo:[0,1,0] neg_hi:[0,1,0]
  v_pk_fma_f32 v[144:145], v[52:53], v[68:69], v[144:145] op_sel:[0,0,0] op_sel_hi:[1,0,1] neg_lo:[0,1,0] neg_hi:[0,1,0]
  v_pk_fma_f32 v[146:147], v[54:55], v[68:69], v[146:147] op_sel:[0,0,0] op_sel_hi:[1,0,1] neg_lo:[0,1,0] neg_hi:[0,1,0]
  v_cvt_pk_bf16_f32 v128, v128, v129
  v_cvt_pk_bf16_f32 v129, v130, v131
  v_cvt_pk_bf16_f32 v130, v144, v145
  v_cvt_pk_bf16_f32 v131, v146, v147
  v_pk_fma_f32 v[160:161], v[56:57], v[68:69], v[160:161] op_sel:[0,0,0] op_sel_hi:[1,0,1] neg_lo:[0,1,0] neg_hi:[0,1,0]
  v_pk_fma_f32 v[162:163], v[58:59], v[68:69], v[162:163] op_sel:[0,0,0] op_sel_hi:[1,0,1] neg_lo:[0,1,0] neg_hi:[0,1,0]
  v_pk_fma_f32 v[176:177], v[60:61], v[68:69], v[176:177] op_sel:[0,0,0] op_sel_hi:[1,0,1] neg_lo:[0,1,0] neg_hi:[0,1,0]
  v_pk_fma_f32 v[178:179], v[62:63], v[68:69], v[178:179] op_sel:[0,0,0] op_sel_hi:[1,0,1] neg_lo:[0,1,0] neg_hi:[0,1,0]
  v_cvt_pk_bf16_f32 v160, v160, v161
  v_cvt_pk_bf16_f32 v161, v162, v163
  v_cvt_pk_bf16_f32 v162, v176, v177
  v_cvt_pk_bf16_f32 v163, v178, v179
  v_pk_fma_f32 v[132:133], v[48:49], v[70:71], v[132:133] op_sel:[0,0,0] op_sel_hi:[1,0,1] neg_lo:[0,1,0] neg_hi:[0,1,0]
  v_pk_fma_f32 v[134:135], v[50:51], v[70:71], v[134:135] op_sel:[0,0,0] op_sel_hi:[1,0,1] neg_lo:[0,1,0] neg_hi:[0,1,0]
  v_pk_fma_f32 v[148:149], v[52:53], v[70:71], v[148:149] op_sel:[0,0,0] op_sel_hi:[1,0,1] neg_lo:[0,1,0] neg_hi:[0,1,0]
  v_pk_fma_f32 v[150:151], v[54:55], v[70:71], v[150:151] op_sel:[0,0,0] op_sel_hi:[1,0,1] neg_lo:[0,1,0] neg_hi:[0,1,0]
  v_cvt_pk_bf16_f32 v132, v132, v133
  v_cvt_pk_bf16_f32 v133, v134, v135
  v_cvt_pk_bf16_f32 v134, v148, v149
  v_cvt_pk_bf16_f32 v135, v150, v151
  v_pk_fma_f32 v[164:165], v[56:57], v[70:71], v[164:165] op_sel:[0,0,0] op_sel_hi:[1,0,1] neg_lo:[0,1,0] neg_hi:[0,1,0]
  v_pk_fma_f32 v[166:167], v[58:59], v[70:71], v[166:167] op_sel:[0,0,0] op_sel_hi:[1,0,1] neg_lo:[0,1,0] neg_hi:[0,1,0]
  v_pk_fma_f32 v[180:181], v[60:61], v[70:71], v[180:181] op_sel:[0,0,0] op_sel_hi:[1,0,1] neg_lo:[0,1,0] neg_hi:[0,1,0]
  v_pk_fma_f32 v[182:183], v[62:63], v[70:71], v[182:183] op_sel:[0,0,0] op_sel_hi:[1,0,1] neg_lo:[0,1,0] neg_hi:[0,1,0]
  v_cvt_pk_bf16_f32 v164, v164, v165
  v_cvt_pk_bf16_f32 v165, v166, v167
  v_cvt_pk_bf16_f32 v166, v180, v181
  v_cvt_pk_bf16_f32 v167, v182, v183
  v_mfma_f32_16x16x32_bf16 v[144:147], v[160:163], v[128:131], 0
  v_pk_fma_f32 v[136:137], v[48:49], v[72:73], v[136:137] op_sel:[0,0,0] op_sel_hi:[1,0,1] neg_lo:[0,1,0] neg_hi:[0,1,0]
  v_pk_fma_f32 v[138:139], v[50:51], v[72:73], v[138:139] op_sel:[0,0,0] op_sel_hi:[1,0,1] neg_lo:[0,1,0] neg_hi:[0,1,0]
  v_pk_fma_f32 v[152:153], v[52:53], v[72:73], v[152:153] op_sel:[0,0,0] op_sel_hi:[1,0,1] neg_lo:[0,1,0] neg_hi:[0,1,0]
  v_pk_fma_f32 v[154:155], v[54:55], v[72:73], v[154:155] op_sel:[0,0,0] op_sel_hi:[1,0,1] neg_lo:[0,1,0] neg_hi:[0,1,0]
  v_cvt_pk_bf16_f32 v136, v136, v137
  v_cvt_pk_bf16_f32 v137, v138, v139
  v_cvt_pk_bf16_f32 v138, v152, v153
  v_cvt_pk_bf16_f32 v139, v154, v155
  v_pk_fma_f32 v[168:169], v[56:57], v[72:73], v[168:169] op_sel:[0,0,0] op_sel_hi:[1,0,1] neg_lo:[0,1,0] neg_hi:[0,1,0]
  v_pk_fma_f32 v[170:171], v[58:59], v[72:73], v[170:171] op_sel:[0,0,0] op_sel_hi:[1,0,1] neg_lo:[0,1,0] neg_hi:[0,1,0]
  v_pk_fma_f32 v[184:185], v[60:61], v[72:73], v[184:185] op_sel:[0,0,0] op_sel_hi:[1,0,1] neg_lo:[0,1,0] neg_hi:[0,1,0]
  v_pk_fma_f32 v[186:187], v[62:63], v[72:73], v[186:187] op_sel:[0,0,0] op_sel_hi:[1,0,1] neg_lo:[0,1,0] neg_hi:[0,1,0]
  v_cvt_pk_bf16_f32 v168, v168, v169
  v_cvt_pk_bf16_f32 v169, v170, v171
  v_cvt_pk_bf16_f32 v170, v184, v185
  v_cvt_pk_bf16_f32 v171, v186, v187
  v_mfma_f32_16x16x32_bf16 v[148:151], v[164:167], v[132:135], 0
  v_mfma_f32_16x16x32_bf16 v[180:183], v[160:163], v[132:135], 0
  v_pk_fma_f32 v[140:141], v[48:49], v[74:75], v[140:141] op_sel:[0,0,0] op_sel_hi:[1,0,1] neg_lo:[0,1,0] neg_hi:[0,1,0]
  v_pk_fma_f32 v[142:143], v[50:51], v[74:75], v[142:143] op_sel:[0,0,0] op_sel_hi:[1,0,1] neg_lo:[0,1,0] neg_hi:[0,1,0]
  v_pk_fma_f32 v[156:157], v[52:53], v[74:75], v[156:157] op_sel:[0,0,0] op_sel_hi:[1,0,1] neg_lo:[0,1,0] neg_hi:[0,1,0]
  v_pk_fma_f32 v[158:159], v[54:55], v[74:75], v[158:159] op_sel:[0,0,0] op_sel_hi:[1,0,1] neg_lo:[0,1,0] neg_hi:[0,1,0]
  v_cvt_pk_bf16_f32 v140, v140, v141
  v_cvt_pk_bf16_f32 v141, v142, v143
  v_cvt_pk_bf16_f32 v142, v156, v157
  v_cvt_pk_bf16_f32 v143, v158, v159
  v_pk_fma_f32 v[172:173], v[56:57], v[74:75], v[172:173] op_sel:[0,0,0] op_sel_hi:[1,0,1] neg_lo:[0,1,0] neg_hi:[0,1,0]
  v_pk_fma_f32 v[174:175], v[58:59], v[74:75], v[174:175] op_sel:[0,0,0] op_sel_hi:[1,0,1] neg_lo:[0,1,0] neg_hi:[0,1,0]
  v_pk_fma_f32 v[188:189], v[60:61], v[74:75], v[188:189] op_sel:[0,0,0] op_sel_hi:[1,0,1] neg_lo:[0,1,0] neg_hi:[0,1,0]
  v_pk_fma_f32 v[190:191], v[62:63], v[74:75], v[190:191] op_sel:[0,0,0] op_sel_hi:[1,0,1] neg_lo:[0,1,0] neg_hi:[0,1,0]
  v_cvt_pk_bf16_f32 v172, v172, v173
  v_cvt_pk_bf16_f32 v173, v174, v175
  v_cvt_pk_bf16_f32 v174, v188, v189
  v_cvt_pk_bf16_f32 v175, v190, v191
  s_waitcnt lgkmcnt(0)
  v_pk_fma_f32 v[32:33], v[56:57], v[66:67], v[32:33] op_sel:[0,0,0] op_sel_hi:[1,0,1] neg_lo:[0,1,0] neg_hi:[0,1,0]
  v_pk_fma_f32 v[34:35], v[58:59], v[66:67], v[34:35] op_sel:[0,0,0] op_sel_hi:[1,0,1] neg_lo:[0,1,0] neg_hi:[0,1,0]
  v_pk_fma_f32 v[36:37], v[60:61], v[66:67], v[36:37] op_sel:[0,0,0] op_sel_hi:[1,0,1] neg_lo:[0,1,0] neg_hi:[0,1,0]
  v_pk_fma_f32 v[38:39], v[62:63], v[66:67], v[38:39] op_sel:[0,0,0] op_sel_hi:[1,0,1] neg_lo:[0,1,0] neg_hi:[0,1,0]
  v_cvt_pk_bf16_f32 v32, v32, v33
  v_cvt_pk_bf16_f32 v33, v34, v35
  v_cvt_pk_bf16_f32 v34, v36, v37
  v_cvt_pk_bf16_f32 v35, v38, v39
  v_mfma_f32_16x16x32_bf16 v[152:155], v[168:171], v[136:139], 0
  v_mfma_f32_16x16x32_bf16 v[184:187], v[164:167], v[136:139], 0
  v_mfma_f32_16x16x32_bf16 v[156:159], v[172:175], v[140:143], 0
  v_mfma_f32_16x16x32_bf16 v[188:191], v[168:171], v[140:143], 0
  v_mfma_f32_16x16x32_bf16 v[176:179], v[32:35], v[128:131], 0
  v_pk_fma_f32 v[40:41], v[84:85], v[64:65], v[40:41] op_sel:[0,0,0] op_sel_hi:[1,0,1] neg_lo:[1,0,0] neg_hi:[1,0,0]
  v_pk_fma_f32 v[42:43], v[86:87], v[64:65], v[42:43] op_sel:[0,0,0] op_sel_hi:[1,0,1] neg_lo:[1,0,0] neg_hi:[1,0,0]
  v_pk_mul_f32 v[40:41], v[40:41], v[104:105]
  v_pk_mul_f32 v[42:43], v[42:43], v[106:107]
  v_cvt_pk_bf16_f32 v4, v40, v41
  v_cvt_pk_bf16_f32 v5, v42, v43
  v_pk_fma_f32 v[192:193], v[88:89], v[64:65], v[192:193] op_sel:[0,0,0] op_sel_hi:[1,0,1] neg_lo:[1,0,0] neg_hi:[1,0,0]
  v_pk_fma_f32 v[194:195], v[90:91], v[64:65], v[194:195] op_sel:[0,0,0] op_sel_hi:[1,0,1] neg_lo:[1,0,0] neg_hi:[1,0,0]
  v_pk_mul_f32 v[192:193], v[192:193], v[108:109]
  v_pk_mul_f32 v[194:195], v[194:195], v[110:111]
  v_cvt_pk_bf16_f32 v6, v192, v193
  v_cvt_pk_bf16_f32 v7, v194, v195
  v_pk_fma_f32 v[196:197], v[92:93], v[64:65], v[196:197] op_sel:[0,0,0] op_sel_hi:[1,0,1] neg_lo:[1,0,0] neg_hi:[1,0,0]
  v_pk_fma_f32 v[198:199], v[94:95], v[64:65], v[198:199] op_sel:[0,0,0] op_sel_hi:[1,0,1] neg_lo:[1,0,0] neg_hi:[1,0,0]
  v_pk_mul_f32 v[196:197], v[196:197], v[112:113]
  v_pk_mul_f32 v[198:199], v[198:199], v[114:115]
  v_cvt_pk_bf16_f32 v8, v196, v197
  v_cvt_pk_bf16_f32 v9, v198, v199
  v_pk_fma_f32 v[200:201], v[96:97], v[64:65], v[200:201] op_sel:[0,0,0] op_sel_hi:[1,0,1] neg_lo:[1,0,0] neg_hi:[1,0,0]
  v_pk_fma_f32 v[202:203], v[98:99], v[64:65], v[202:203] op_sel:[0,0,0] op_sel_hi:[1,0,1] neg_lo:[1,0,0] neg_hi:[1,0,0]
  v_pk_mul_f32 v[200:201], v[200:201], v[116:117]
  v_pk_mul_f32 v[202:203], v[202:203], v[118:119]
  v_cvt_pk_bf16_f32 v10, v200, v201
  v_cvt_pk_bf16_f32 v11, v202, v203
  v_pk_fma_f32 v[204:205], v[100:101], v[64:65], v[204:205] op_sel:[0,0,0] op_sel_hi:[1,0,1] neg_lo:[1,0,0] neg_hi:[1,0,0]
  v_pk_fma_f32 v[206:207], v[102:103], v[64:65], v[206:207] op_sel:[0,0,0] op_sel_hi:[1,0,1] neg_lo:[1,0,0] neg_hi:[1,0,0]
  v_pk_mul_f32 v[204:205], v[204:205], v[120:121]
  v_pk_mul_f32 v[206:207], v[206:207], v[122:123]
  v_cvt_pk_bf16_f32 v12, v204, v205
  v_cvt_pk_bf16_f32 v13, v206, v207
  v_pk_fma_f32 v[44:45], v[84:85], v[64:65], v[44:45] op_sel:[0,1,0] op_sel_hi:[1,1,1] neg_lo:[1,0,0] neg_hi:[1,0,0]
  v_pk_fma_f32 v[46:47], v[86:87], v[64:65], v[46:47] op_sel:[0,1,0] op_sel_hi:[1,1,1] neg_lo:[1,0,0] neg_hi:[1,0,0]
  v_pk_mul_f32 v[44:45], v[44:45], v[104:105]
  v_pk_mul_f32 v[46:47], v[46:47], v[106:107]
  v_cvt_pk_bf16_f32 v224, v44, v45
  v_cvt_pk_bf16_f32 v225, v46, v47
  v_pk_fma_f32 v[208:209], v[88:89], v[64:65], v[208:209] op_sel:[0,1,0] op_sel_hi:[1,1,1] neg_lo:[1,0,0] neg_hi:[1,0,0]
  v_pk_fma_f32 v[210:211], v[90:91], v[64:65], v[210:211] op_sel:[0,1,0] op_sel_hi:[1,1,1] neg_lo:[1,0,0] neg_hi:[1,0,0]
  v_pk_mul_f32 v[208:209], v[208:209], v[108:109]
  v_pk_mul_f32 v[210:211], v[210:211], v[110:111]
  v_cvt_pk_bf16_f32 v226, v208, v209
  v_cvt_pk_bf16_f32 v227, v210, v211
  v_pk_fma_f32 v[212:213], v[92:93], v[64:65], v[212:213] op_sel:[0,1,0] op_sel_hi:[1,1,1] neg_lo:[1,0,0] neg_hi:[1,0,0]
  v_pk_fma_f32 v[214:215], v[94:95], v[64:65], v[214:215] op_sel:[0,1,0] op_sel_hi:[1,1,1] neg_lo:[1,0,0] neg_hi:[1,0,0]
  v_pk_mul_f32 v[212:213], v[212:213], v[112:113]
  v_pk_mul_f32 v[214:215], v[214:215], v[114:115]
  v_cvt_pk_bf16_f32 v228, v212, v213
  v_cvt_pk_bf16_f32 v229, v214, v215
  v_pk_fma_f32 v[216:217], v[96:97], v[64:65], v[216:217] op_sel:[0,1,0] op_sel_hi:[1,1,1] neg_lo:[1,0,0] neg_hi:[1,0,0]
  v_pk_fma_f32 v[218:219], v[98:99], v[64:65], v[218:219] op_sel:[0,1,0] op_sel_hi:[1,1,1] neg_lo:[1,0,0] neg_hi:[1,0,0]
  v_pk_mul_f32 v[216:217], v[216:217], v[116:117]
  v_pk_mul_f32 v[218:219], v[218:219], v[118:119]
  v_cvt_pk_bf16_f32 v230, v216, v217
  v_cvt_pk_bf16_f32 v231, v218, v219
  v_pk_fma_f32 v[220:221], v[100:101], v[64:65], v[220:221] op_sel:[0,1,0] op_sel_hi:[1,1,1] neg_lo:[1,0,0] neg_hi:[1,0,0]
  v_pk_fma_f32 v[222:223], v[102:103], v[64:65], v[222:223] op_sel:[0,1,0] op_sel_hi:[1,1,1] neg_lo:[1,0,0] neg_hi:[1,0,0]
  v_pk_mul_f32 v[220:221], v[220:221], v[120:121]
  v_pk_mul_f32 v[222:223], v[222:223], v[122:123]
  v_cvt_pk_bf16_f32 v232, v220, v221
  v_cvt_pk_bf16_f32 v233, v222, v223
  v_cndmask_b32 v148, v148, v149, s[48:49]
  v_cndmask_b32 v180, v180, v181, s[48:49]
  v_cndmask_b32 v150, v150, v151, s[48:49]
  v_cndmask_b32 v182, v182, v183, s[48:49]
  v_cndmask_b32 v36, v148, v180, s[50:51]
  v_cndmask_b32 v37, v150, v182, s[52:53]
  v_mul_f32 v36, v36, v77
  v_mul_f32 v37, v37, v81
  v_cndmask_b32 v152, v152, v153, s[48:49]
  v_cndmask_b32 v184, v184, v185, s[48:49]
  v_cndmask_b32 v154, v154, v155, s[48:49]
  v_cndmask_b32 v186, v186, v187, s[48:49]
  v_cndmask_b32 v40, v152, v184, s[50:51]
  v_cndmask_b32 v41, v154, v186, s[52:53]
  v_mul_f32 v40, v40, v78
  v_mul_f32 v41, v41, v82
  v_cndmask_b32 v156, v156, v157, s[48:49]
  v_cndmask_b32 v188, v188, v189, s[48:49]
  v_cndmask_b32 v158, v158, v159, s[48:49]
  v_cndmask_b32 v190, v190, v191, s[48:49]
  v_cndmask_b32 v44, v156, v188, s[50:51]
  v_cndmask_b32 v45, v158, v190, s[52:53]
  v_mul_f32 v44, v44, v79
  v_mul_f32 v45, v45, v83
  v_cndmask_b32 v144, v144, v145, s[48:49]
  v_cndmask_b32 v176, v176, v177, s[48:49]
  v_cndmask_b32 v146, v146, v147, s[48:49]
  v_cndmask_b32 v178, v178, v179, s[48:49]
  v_cndmask_b32 v32, v144, v176, s[50:51]
  v_cndmask_b32 v33, v146, v178, s[52:53]
  v_mul_f32 v32, v32, v76
  v_mul_f32 v33, v33, v80
  v_mov_b32 v48, 0xceabfb8f
  v_cndmask_b32 v32, v32, v48, s[54:55]
  v_cndmask_b32 v33, v33, v48, s[14:15]
  v_max_f32 v34, v32, v33
  v_max_f32 v38, v36, v37
  v_max_f32 v42, v40, v41
  v_max_f32 v46, v44, v45
  v_mov_b32 v35, v34
  v_mov_b32 v39, v38
  v_mov_b32 v43, v42
  v_mov_b32 v47, v46
  v_permlane32_swap_b32 v34, v35
  v_permlane32_swap_b32 v38, v39
  v_permlane32_swap_b32 v42, v43
  v_permlane32_swap_b32 v46, v47
  v_max_f32 v34, v34, v35
  v_max_f32 v38, v38, v39
  v_max_f32 v42, v42, v43
  v_max_f32 v46, v46, v47
  v_mov_b32 v35, v34
  v_mov_b32 v39, v38
  v_mov_b32 v43, v42
  v_mov_b32 v47, v46
  v_permlane16_swap_b32 v34, v35
  v_permlane16_swap_b32 v38, v39
  v_permlane16_swap_b32 v42, v43
  v_permlane16_swap_b32 v46, v47
  v_max_f32 v34, v34, v35
  v_max_f32 v38, v38, v39
  v_max_f32 v42, v42, v43
  v_max_f32 v46, v46, v47
  v_sub_f32 v32, v32, v34
  v_sub_f32 v33, v33, v34
  v_sub_f32 v36, v36, v38
  v_sub_f32 v37, v37, v38
  v_sub_f32 v40, v40, v42
  v_sub_f32 v41, v41, v42
  v_sub_f32 v44, v44, v46
  v_sub_f32 v45, v45, v46
  v_exp_f32 v32, v32
  v_exp_f32 v33, v33
  v_exp_f32 v36, v36
  v_exp_f32 v37, v37
  v_exp_f32 v40, v40
  v_exp_f32 v41, v41
  v_exp_f32 v44, v44
  v_exp_f32 v45, v45
  v_cvt_pk_bf16_f32 v32, v32, v32
  v_cvt_pk_bf16_f32 v33, v33, v33
  v_and_b32 v128, v32, v27
  v_and_b32 v129, v33, v29
  v_and_b32 v130, v32, v28
  v_and_b32 v131, v33, v30
  v_cvt_pk_bf16_f32 v36, v36, v36
  v_cvt_pk_bf16_f32 v37, v37, v37
  v_and_b32 v132, v36, v27
  v_and_b32 v133, v37, v29
  v_and_b32 v134, v36, v28
  v_and_b32 v135, v37, v30
  v_mfma_f32_16x16x32_bf16 v[144:147], v[236:239], v[128:131], 0
  v_mfma_f32_16x16x32_bf16 v[192:195], v[4:7], v[128:131], 0
  v_mfma_f32_16x16x32_bf16 v[208:211], v[224:227], v[128:131], 0
  v_cvt_pk_bf16_f32 v40, v40, v40
  v_cvt_pk_bf16_f32 v41, v41, v41
  v_and_b32 v136, v40, v27
  v_and_b32 v137, v41, v29
  v_and_b32 v138, v40, v28
  v_and_b32 v139, v41, v30
  v_mfma_f32_16x16x32_bf16 v[148:151], v[236:239], v[132:135], 0
  v_mfma_f32_16x16x32_bf16 v[196:199], v[6:9], v[132:135], 0
  v_mfma_f32_16x16x32_bf16 v[212:215], v[226:229], v[132:135], 0
  v_cvt_pk_bf16_f32 v44, v44, v44
  v_cvt_pk_bf16_f32 v45, v45, v45
  v_and_b32 v140, v44, v27
  v_and_b32 v141, v45, v29
  v_and_b32 v142, v44, v28
  v_and_b32 v143, v45, v30
  v_mfma_f32_16x16x32_bf16 v[152:155], v[236:239], v[136:139], 0
  v_mfma_f32_16x16x32_bf16 v[200:203], v[8:11], v[136:139], 0
  v_mfma_f32_16x16x32_bf16 v[216:219], v[228:231], v[136:139], 0
  v_mfma_f32_16x16x32_bf16 v[156:159], v[236:239], v[140:143], 0
  v_mfma_f32_16x16x32_bf16 v[204:207], v[10:13], v[140:143], 0
  v_mfma_f32_16x16x32_bf16 v[220:223], v[230:233], v[140:143], 0
  s_cmp_eq_u32 s71, 1
  s_cbranch_scc1 L_attn_out1
  v_rcp_f32 v144, v144
  s_mov_b32 s3, 0
  v_pk_mul_f32 v[192:193], v[192:193], v[144:145] op_sel_hi:[1,0]
  v_pk_mul_f32 v[194:195], v[194:195], v[144:145] op_sel_hi:[1,0]
  v_pk_mul_f32 v[208:209], v[208:209], v[144:145] op_sel_hi:[1,0]
  v_pk_mul_f32 v[210:211], v[210:211], v[144:145] op_sel_hi:[1,0]
  v_cvt_pk_bf16_f32 v48, v192, v193
  v_cvt_pk_bf16_f32 v49, v194, v195
  v_cvt_pk_bf16_f32 v50, v208, v209
  v_cvt_pk_bf16_f32 v51, v210, v211
  buffer_store_dwordx4 v[48:51], v31, s[44:47], s3 offen sc1
  v_rcp_f32 v148, v148
  s_mov_b32 s3, 114688
  v_pk_mul_f32 v[196:197], v[196:197], v[148:149] op_sel_hi:[1,0]
  v_pk_mul_f32 v[198:199], v[198:199], v[148:149] op_sel_hi:[1,0]
  v_pk_mul_f32 v[212:213], v[212:213], v[148:149] op_sel_hi:[1,0]
  v_pk_mul_f32 v[214:215], v[214:215], v[148:149] op_sel_hi:[1,0]
  v_cvt_pk_bf16_f32 v52, v196, v197
  v_cvt_pk_bf16_f32 v53, v198, v199
  v_cvt_pk_bf16_f32 v54, v212, v213
  v_cvt_pk_bf16_f32 v55, v214, v215
  buffer_store_dwordx4 v[52:55], v31, s[44:47], s3 offen sc1
  v_rcp_f32 v152, v152
  s_mov_b32 s3, 229376
  v_pk_mul_f32 v[200:201], v[200:201], v[152:153] op_sel_hi:[1,0]
  v_pk_mul_f32 v[202:203], v[202:203], v[152:153] op_sel_hi:[1,0]
  v_pk_mul_f32 v[216:217], v[216:217], v[152:153] op_sel_hi:[1,0]
  v_pk_mul_f32 v[218:219], v[218:219], v[152:153] op_sel_hi:[1,0]
  v_cvt_pk_bf16_f32 v56, v200, v201
  v_cvt_pk_bf16_f32 v57, v202, v203
  v_cvt_pk_bf16_f32 v58, v216, v217
  v_cvt_pk_bf16_f32 v59, v218, v219
  buffer_store_dwordx4 v[56:59], v31, s[44:47], s3 offen sc1
  v_rcp_f32 v156, v156
  s_mov_b32 s3, 344064
  v_pk_mul_f32 v[204:205], v[204:205], v[156:157] op_sel_hi:[1,0]
  v_pk_mul_f32 v[206:207], v[206:207], v[156:157] op_sel_hi:[1,0]
  v_pk_mul_f32 v[220:221], v[220:221], v[156:157] op_sel_hi:[1,0]
  v_pk_mul_f32 v[222:223], v[222:223], v[156:157] op_sel_hi:[1,0]
  v_cvt_pk_bf16_f32 v60, v204, v205
  v_cvt_pk_bf16_f32 v61, v206, v207
  v_cvt_pk_bf16_f32 v62, v220, v221
  v_cvt_pk_bf16_f32 v63, v222, v223
  buffer_store_dwordx4 v[60:63], v31, s[44:47], s3 offen sc1
  s_branch L_attn_out2
L_attn_out1:
  v_rcp_f32 v144, v144
  s_mov_b32 s3, 0
  v_pk_mul_f32 v[192:193], v[192:193], v[144:145] op_sel_hi:[1,0]
  v_pk_mul_f32 v[194:195], v[194:195], v[144:145] op_sel_hi:[1,0]
  v_pk_mul_f32 v[208:209], v[208:209], v[144:145] op_sel_hi:[1,0]
  v_pk_mul_f32 v[210:211], v[210:211], v[144:145] op_sel_hi:[1,0]
  v_cvt_pk_bf16_f32 v50, v192, v193
  v_cvt_pk_bf16_f32 v51, v194, v195
  v_cvt_pk_bf16_f32 v48, v208, v209
  v_cvt_pk_bf16_f32 v49, v210, v211
  buffer_store_dwordx4 v[48:51], v31, s[44:47], s3 offen sc1
  v_rcp_f32 v148, v148
  s_mov_b32 s3, 114688
  v_pk_mul_f32 v[196:197], v[196:197], v[148:149] op_sel_hi:[1,0]
  v_pk_mul_f32 v[198:199], v[198:199], v[148:149] op_sel_hi:[1,0]
  v_pk_mul_f32 v[212:213], v[212:213], v[148:149] op_sel_hi:[1,0]
  v_pk_mul_f32 v[214:215], v[214:215], v[148:149] op_sel_hi:[1,0]
  v_cvt_pk_bf16_f32 v54, v196, v197
  v_cvt_pk_bf16_f32 v55, v198, v199
  v_cvt_pk_bf16_f32 v52, v212, v213
  v_cvt_pk_bf16_f32 v53, v214, v215
  buffer_store_dwordx4 v[52:55], v31, s[44:47], s3 offen sc1
  v_rcp_f32 v152, v152
  s_mov_b32 s3, 229376
  v_pk_mul_f32 v[200:201], v[200:201], v[152:153] op_sel_hi:[1,0]
  v_pk_mul_f32 v[202:203], v[202:203], v[152:153] op_sel_hi:[1,0]
  v_pk_mul_f32 v[216:217], v[216:217], v[152:153] op_sel_hi:[1,0]
  v_pk_mul_f32 v[218:219], v[218:219], v[152:153] op_sel_hi:[1,0]
  v_cvt_pk_bf16_f32 v58, v200, v201
  v_cvt_pk_bf16_f32 v59, v202, v203
  v_cvt_pk_bf16_f32 v56, v216, v217
  v_cvt_pk_bf16_f32 v57, v218, v219
  buffer_store_dwordx4 v[56:59], v31, s[44:47], s3 offen sc1
  v_rcp_f32 v156, v156
  s_mov_b32 s3, 344064
  v_pk_mul_f32 v[204:205], v[204:205], v[156:157] op_sel_hi:[1,0]
  v_pk_mul_f32 v[206:207], v[206:207], v[156:157] op_sel_hi:[1,0]
  v_pk_mul_f32 v[220:221], v[220:221], v[156:157] op_sel_hi:[1,0]
  v_pk_mul_f32 v[222:223], v[222:223], v[156:157] op_sel_hi:[1,0]
  v_cvt_pk_bf16_f32 v62, v204, v205
  v_cvt_pk_bf16_f32 v63, v206, v207
  v_cvt_pk_bf16_f32 v60, v220, v221
  v_cvt_pk_bf16_f32 v61, v222, v223
  buffer_store_dwordx4 v[60:63], v31, s[44:47], s3 offen sc1
L_attn_out2:
  s_waitcnt vmcnt(0) lgkmcnt(0)
  s_barrier
  s_add_u32 s97, s97, 1
  s_branch L_wo_body
.section .rodata,"a"
.p2align 6
.amdhsa_kernel interleave_layers__sliding_local_dilated__dense_activation_gelu__prompt_kernel
  .amdhsa_next_free_vgpr 256
  .amdhsa_next_free_sgpr 102
  .amdhsa_accum_offset 256
  .amdhsa_group_segment_fixed_size 0
  .amdhsa_kernarg_size 88
  .amdhsa_user_sgpr_count 2
  .amdhsa_user_sgpr_kernarg_segment_ptr 1
  .amdhsa_system_sgpr_workgroup_id_x 1
  .amdhsa_float_denorm_mode_32 3
  .amdhsa_float_denorm_mode_16_64 3
.end_amdhsa_kernel
.text
L_attn_c1:
L_wo_c0:
L_wo_body:
  s_cmp_ge_u32 s2, 256
  s_cbranch_scc1 L_wo_end
  v_lshrrev_b32 v2, 6, v0
  v_and_b32 v1, 63, v0
  v_readfirstlane_b32 s70, v2
  s_and_b32 s3, s2, 7
  s_lshr_b32 s99, s2, 3
  s_and_b32 s5, s3, 3
  s_lshl_b32 s5, s5, 2
  s_and_b32 s6, s99, 3
  s_add_u32 s68, s5, s6
  s_lshr_b32 s5, s3, 2
  s_lshr_b32 s78, s99, 2
  s_lshl1_add_u32 s69, s78, s5
  s_add_u32 s3, s68, s78
  s_lshl_b32 s3, s3, 3
  s_lshl_b32 s85, 0xffff02, s3
  s_sub_u32 s3, 0, s3
  s_lshr_b32 s3, 0xffff02, s3
  s_or_b32 s85, s85, s3
  s_cmp_lt_u32 s70, 4
  s_cbranch_scc1 L_wo_compute
L_wo_loader:
  s_add_u32 s3, s96, s70
  s_cmp_lg_u32 s3, 4
  s_cbranch_scc1 L_wo_chk0
  s_load_dwordx2 s[64:65], s[0:1], 72
  s_waitcnt lgkmcnt(0)
  s_and_b32 s65, s65, 0xffff
  s_mov_b32 s66, 256
  s_mov_b32 s67, 0x00020000
  v_lshlrev_b32 v17, 2, v1
  buffer_load_dword v12, v17, s[64:67], 0 offen sc1
L_wo_chk0:
  s_cmp_lg_u32 s96, 0
  s_cbranch_scc1 L_wo_nofirst
  s_waitcnt vmcnt(1)
  s_mov_b32 s7, 0xffff0000
  v_lshlrev_b32 v32, 16, v64
  v_and_b32 v33, s7, v64
  v_lshlrev_b32 v34, 16, v65
  v_and_b32 v35, s7, v65
  v_lshlrev_b32 v36, 16, v66
  v_and_b32 v37, s7, v66
  v_lshlrev_b32 v38, 16, v67
  v_and_b32 v39, s7, v67
  v_lshlrev_b32 v40, 16, v68
  v_and_b32 v41, s7, v68
  v_pk_add_f32 v[32:33], v[32:33], v[40:41]
  v_lshlrev_b32 v40, 16, v69
  v_and_b32 v41, s7, v69
  v_pk_add_f32 v[34:35], v[34:35], v[40:41]
  v_lshlrev_b32 v40, 16, v70
  v_and_b32 v41, s7, v70
  v_pk_add_f32 v[36:37], v[36:37], v[40:41]
  v_lshlrev_b32 v40, 16, v71
  v_and_b32 v41, s7, v71
  v_pk_add_f32 v[38:39], v[38:39], v[40:41]
  v_lshlrev_b32 v40, 16, v72
  v_and_b32 v41, s7, v72
  v_pk_add_f32 v[32:33], v[32:33], v[40:41]
  v_lshlrev_b32 v40, 16, v73
  v_and_b32 v41, s7, v73
  v_pk_add_f32 v[34:35], v[34:35], v[40:41]
  v_lshlrev_b32 v40, 16, v74
  v_and_b32 v41, s7, v74
  v_pk_add_f32 v[36:37], v[36:37], v[40:41]
  v_lshlrev_b32 v40, 16, v75
  v_and_b32 v41, s7, v75
  v_pk_add_f32 v[38:39], v[38:39], v[40:41]
  v_lshlrev_b32 v40, 16, v76
  v_and_b32 v41, s7, v76
  v_pk_add_f32 v[32:33], v[32:33], v[40:41]
  v_lshlrev_b32 v40, 16, v77
  v_and_b32 v41, s7, v77
  v_pk_add_f32 v[34:35], v[34:35], v[40:41]
  v_lshlrev_b32 v40, 16, v78
  v_and_b32 v41, s7, v78
  v_pk_add_f32 v[36:37], v[36:37], v[40:41]
  v_lshlrev_b32 v40, 16, v79
  v_and_b32 v41, s7, v79
  v_pk_add_f32 v[38:39], v[38:39], v[40:41]
  v_lshlrev_b32 v40, 16, v80
  v_and_b32 v41, s7, v80
  v_pk_add_f32 v[32:33], v[32:33], v[40:41]
  v_lshlrev_b32 v40, 16, v81
  v_and_b32 v41, s7, v81
  v_pk_add_f32 v[34:35], v[34:35], v[40:41]
  v_lshlrev_b32 v40, 16, v82
  v_and_b32 v41, s7, v82
  v_pk_add_f32 v[36:37], v[36:37], v[40:41]
  v_lshlrev_b32 v40, 16, v83
  v_and_b32 v41, s7, v83
  v_pk_add_f32 v[38:39], v[38:39], v[40:41]
  v_lshlrev_b32 v40, 16, v84
  v_and_b32 v41, s7, v84
  v_pk_add_f32 v[32:33], v[32:33], v[40:41]
  v_lshlrev_b32 v40, 16, v85
  v_and_b32 v41, s7, v85
  v_pk_add_f32 v[34:35], v[34:35], v[40:41]
  v_lshlrev_b32 v40, 16, v86
  v_and_b32 v41, s7, v86
  v_pk_add_f32 v[36:37], v[36:37], v[40:41]
  v_lshlrev_b32 v40, 16, v87
  v_and_b32 v41, s7, v87
  v_pk_add_f32 v[38:39], v[38:39], v[40:41]
  v_lshlrev_b32 v40, 16, v88
  v_and_b32 v41, s7, v88
  v_pk_add_f32 v[32:33], v[32:33], v[40:41]
  v_lshlrev_b32 v40, 16, v89
  v_and_b32 v41, s7, v89
  v_pk_add_f32 v[34:35], v[34:35], v[40:41]
  v_lshlrev_b32 v40, 16, v90
  v_and_b32 v41, s7, v90
  v_pk_add_f32 v[36:37], v[36:37], v[40:41]
  v_lshlrev_b32 v40, 16, v91
  v_and_b32 v41, s7, v91
  v_pk_add_f32 v[38:39], v[38:39], v[40:41]
  v_lshlrev_b32 v40, 16, v92
  v_and_b32 v41, s7, v92
  v_pk_add_f32 v[32:33], v[32:33], v[40:41]
  v_lshlrev_b32 v40, 16, v93
  v_and_b32 v41, s7, v93
  v_pk_add_f32 v[34:35], v[34:35], v[40:41]
  v_lshlrev_b32 v40, 16, v94
  v_and_b32 v41, s7, v94
  v_pk_add_f32 v[36:37], v[36:37], v[40:41]
  v_lshlrev_b32 v40, 16, v95
  v_and_b32 v41, s7, v95
  v_pk_add_f32 v[38:39], v[38:39], v[40:41]
  s_add_u32 s52, s22, 24641536
  s_addc_u32 s53, s23, 0
  s_and_b32 s53, s53, 0xffff
  s_mov_b32 s54, 262144
  s_mov_b32 s55, 0x00020000
  v_permlane32_swap_b32 v32, v36
  v_permlane32_swap_b32 v33, v37
  v_permlane32_swap_b32 v34, v38
  v_permlane32_swap_b32 v35, v39
  v_add_f32 v32, v32, v36
  v_add_f32 v33, v33, v37
  v_add_f32 v34, v34, v38
  v_add_f32 v35, v35, v39
  v_and_b32 v2, 7, v1
  v_lshlrev_b32 v2, 5, v2
  v_permlane16_swap_b32 v32, v34
  v_permlane16_swap_b32 v33, v35
  v_add_f32 v32, v32, v34
  v_add_f32 v33, v33, v35
  v_lshrrev_b32 v3, 4, v1
  v_lshl_add_u32 v2, v3, 3, v2
  v_add_f32_dpp v32, v32, v32 row_ror:8 row_mask:0xf bank_mask:0xf
  v_add_f32_dpp v33, v33, v33 row_ror:8 row_mask:0xf bank_mask:0xf
  buffer_store_dwordx2 v[32:33], v2, s[52:55], s94 offen sc1
L_wo_nofirst:
  v_and_b32 v2, 3, v1
  v_lshlrev_b32 v2, 3, v2
  v_bfe_i32 v16, s85, v2, 8
  s_and_b32 s3, s68, 3
  s_mul_i32 s4, s3, 4
  v_add3_u32 v3, v16, v1, s4
  v_and_b32 v3, 15, v3
  v_lshlrev_b32 v16, 17, v3
  s_add_u32 s9, s70, s68
  s_and_b32 s9, s9, 3
  s_lshl_b32 s77, s9, 11
  v_and_b32 v10, 7, v1
  v_lshrrev_b32 v3, 3, v1
  s_lshl_b32 s10, s9, 4
  v_add_u32 v3, s10, v3
  v_mul_u32_u24 v3, 2048, v3
  v_lshrrev_b32 v2, 3, v1
  v_and_b32 v2, 6, v2
  v_xor_b32 v2, v2, v10
  s_lshl_b32 s10, s69, 7
  v_add_u32 v3, s10, v3
  v_lshl_add_u32 v8, v2, 4, v3
  v_add_u32 v3, 16384, v3
  v_lshl_add_u32 v9, v2, 4, v3
  s_mov_b32 s40, s20
  s_and_b32 s41, s21, 0xffff
  s_mov_b32 s42, 2097152
  s_mov_b32 s43, 0x00020000
  v_readlane_b32 s74, v16, 0
  s_add_u32 m0, s77, 28672
  s_add_u32 s4, s74, 0
  buffer_load_dwordx4 v8, s[40:43], s4 offen lds
  s_add_u32 m0, s77, 29696
  s_nop 0
  buffer_load_dwordx4 v9, s[40:43], s4 offen lds
  v_readlane_b32 s74, v16, 1
  s_add_u32 m0, s77, 36864
  s_add_u32 s4, s74, 0
  buffer_load_dwordx4 v8, s[40:43], s4 offen lds
  s_add_u32 m0, s77, 37888
  s_nop 0
  buffer_load_dwordx4 v9, s[40:43], s4 offen lds
  v_readlane_b32 s74, v16, 2
  s_add_u32 m0, s77, 45056
  s_add_u32 s4, s74, 0
  buffer_load_dwordx4 v8, s[40:43], s4 offen lds
  s_add_u32 m0, s77, 46080
  s_nop 0
  buffer_load_dwordx4 v9, s[40:43], s4 offen lds
  v_readlane_b32 s74, v16, 3
  s_add_u32 m0, s77, 53248
  s_add_u32 s4, s74, 0
  buffer_load_dwordx4 v8, s[40:43], s4 offen lds
  s_add_u32 m0, s77, 54272
  s_nop 0
  buffer_load_dwordx4 v9, s[40:43], s4 offen lds
  v_readlane_b32 s74, v16, 4
  s_add_u32 m0, s77, 61440
  s_add_u32 s4, s74, 0
  buffer_load_dwordx4 v8, s[40:43], s4 offen lds
  s_add_u32 m0, s77, 62464
  s_nop 0
  buffer_load_dwordx4 v9, s[40:43], s4 offen lds
  v_readlane_b32 s74, v16, 5
  s_add_u32 m0, s77, 69632
  s_add_u32 s4, s74, 0
  buffer_load_dwordx4 v8, s[40:43], s4 offen lds
  s_add_u32 m0, s77, 70656
  s_nop 0
  buffer_load_dwordx4 v9, s[40:43], s4 offen lds
  s_waitcnt vmcnt(12)
  s_add_u32 s3, s96, s70
  s_cmp_lg_u32 s3, 4
  s_cbranch_scc1 L_wo_chk1
  v_cmp_ne_u32 vcc, 0x01010101, v12
  s_cbranch_vccz L_wo_chk1
  s_load_dwordx2 s[64:65], s[0:1], 72
  s_waitcnt lgkmcnt(0)
  s_and_b32 s65, s65, 0xffff
  s_mov_b32 s66, 256
  s_mov_b32 s67, 0x00020000
  v_lshlrev_b32 v17, 2, v1
  s_mov_b32 s79, 0x100000
L_wo_chkl:
  buffer_load_dword v12, v17, s[64:67], 0 offen sc1
  s_sub_u32 s79, s79, 1
  s_cbranch_scc1 L_wo_chk1
  s_waitcnt vmcnt(0)
  v_cmp_ne_u32 vcc, 0x01010101, v12
  s_cbranch_vccnz L_wo_chkl
L_wo_chk1:
  s_add_u32 s44, s22, 41943040
  s_addc_u32 s45, s23, 0
  s_and_b32 s45, s45, 0xffff
  s_mov_b32 s46, 524288
  s_mov_b32 s47, 0x00020000
  s_lshl4_add_u32 s3, s97, s68
  s_and_b32 s4, s69, 15
  s_lshl4_add_u32 s3, s3, s4
  s_lshl_b32 s3, s3, 7
  s_sub_u32 s3, s3, 32768
  v_lshlrev_b32 v11, 7, v1
  v_and_b32 v2, 15, v1
  v_lshlrev_b32 v2, 2, v2
  v_mov_b32 v3, 1
  s_mov_b32 s79, 0x100000
  s_cmp_lg_u32 s70, 4
  s_barrier
  s_cbranch_scc1 L_wo_nofl
  s_mov_b32 exec_lo, 0xffff
  s_mov_b32 exec_hi, 0
  buffer_store_dword v3, v11, s[44:47], s87 offen sc1
  s_mov_b64 exec, -1
L_wo_nofl:
  s_mov_b32 s5, s3
  v_readlane_b32 s74, v16, 6
  s_add_u32 m0, s77, 77824
  s_add_u32 s4, s74, 0
  buffer_load_dwordx4 v8, s[40:43], s4 offen lds
  s_add_u32 m0, s77, 78848
  s_nop 0
  buffer_load_dwordx4 v9, s[40:43], s4 offen lds
  v_readlane_b32 s74, v16, 7
  s_add_u32 m0, s77, 86016
  s_add_u32 s4, s74, 0
  buffer_load_dwordx4 v8, s[40:43], s4 offen lds
  s_add_u32 m0, s77, 87040
  s_nop 0
  buffer_load_dwordx4 v9, s[40:43], s4 offen lds
  v_readlane_b32 s74, v16, 8
  s_add_u32 m0, s77, 94208
  s_add_u32 s4, s74, 0
  buffer_load_dwordx4 v8, s[40:43], s4 offen lds
  s_add_u32 m0, s77, 95232
  s_nop 0
  buffer_load_dwordx4 v9, s[40:43], s4 offen lds
  v_readlane_b32 s74, v16, 9
  s_add_u32 m0, s77, 102400
  s_add_u32 s4, s74, 0
  buffer_load_dwordx4 v8, s[40:43], s4 offen lds
  s_add_u32 m0, s77, 103424
  s_nop 0
  buffer_load_dwordx4 v9, s[40:43], s4 offen lds
  v_readlane_b32 s74, v16, 10
  s_add_u32 m0, s77, 110592
  s_add_u32 s4, s74, 0
  buffer_load_dwordx4 v8, s[40:43], s4 offen lds
  s_add_u32 m0, s77, 111616
  s_nop 0
  buffer_load_dwordx4 v9, s[40:43], s4 offen lds
  v_readlane_b32 s74, v16, 11
  s_add_u32 m0, s77, 118784
  s_add_u32 s4, s74, 0
  buffer_load_dwordx4 v8, s[40:43], s4 offen lds
  s_add_u32 m0, s77, 119808
  s_nop 0
  buffer_load_dwordx4 v9, s[40:43], s4 offen lds
  v_readlane_b32 s74, v16, 12
  s_add_u32 m0, s77, 131072
  s_add_u32 s4, s74, 0
  buffer_load_dwordx4 v8, s[40:43], s4 offen lds
  s_add_u32 m0, s77, 132096
  s_nop 0
  buffer_load_dwordx4 v9, s[40:43], s4 offen lds
  v_readlane_b32 s74, v16, 13
  s_add_u32 m0, s77, 139264
  s_add_u32 s4, s74, 0
  buffer_load_dwordx4 v8, s[40:43], s4 offen lds
  s_add_u32 m0, s77, 140288
  s_nop 0
  buffer_load_dwordx4 v9, s[40:43], s4 offen lds
  v_readlane_b32 s74, v16, 14
  s_add_u32 m0, s77, 147456
  s_add_u32 s4, s74, 0
  buffer_load_dwordx4 v8, s[40:43], s4 offen lds
  s_add_u32 m0, s77, 148480
  s_nop 0
  buffer_load_dwordx4 v9, s[40:43], s4 offen lds
  v_readlane_b32 s74, v16, 15
  s_add_u32 m0, s77, 155648
  s_add_u32 s4, s74, 0
  buffer_load_dwordx4 v8, s[40:43], s4 offen lds
  s_add_u32 m0, s77, 156672
  s_nop 0
  buffer_load_dwordx4 v9, s[40:43], s4 offen lds
  s_mov_b32 s3, s5
  s_cmp_lg_u32 s70, 4
  s_cbranch_scc1 L_wo_dep
L_wo_poll:
  buffer_load_dword v3, v2, s[44:47], s3 offen sc1
  s_sub_u32 s79, s79, 1
  s_cbranch_scc1 L_wo_dep
  s_waitcnt vmcnt(0)
  v_cmp_ne_u32 vcc, 1, v3
  s_cbranch_vccnz L_wo_poll
L_wo_dep:
  s_waitcnt vmcnt(20) lgkmcnt(0)
  s_barrier
  s_waitcnt vmcnt(2)
  s_barrier
  s_lshl_b32 s87, s97, 15
  s_lshl_b32 s4, s68, 11
  s_add_u32 s87, s87, s4
  s_lshl_b32 s4, s69, 2
  s_add_u32 s87, s87, s4
  s_add_u32 s97, s97, 1
  s_branch L_w1_body
L_wo_end:
  s_endpgm
L_wo_compute:
  v_and_b32 v2, 3, v1
  v_lshlrev_b32 v2, 3, v2
  v_bfe_i32 v15, s85, v2, 8
  s_and_b32 s3, s68, 3
  s_mul_i32 s4, s3, 4
  v_add3_u32 v3, v15, v1, s4
  v_and_b32 v3, 15, v3
  v_lshlrev_b32 v15, 12, v3
  v_and_b32 v3, 15, v1
  v_lshrrev_b32 v2, 4, v1
  s_lshl_b32 s8, s68, 7
  s_lshl_b32 s9, s70, 5
  s_add_u32 s8, s8, s9
  s_mul_i32 s9, s8, 7168
  v_add_u32 v13, s8, v3
  s_lshl_b32 s10, s69, 7
  v_lshl_add_u32 v14, v2, 3, s10
  v_and_b32 v16, 1, v2
  v_lshrrev_b32 v17, 1, v2
  v_lshlrev_b32 v16, 4, v1
  s_add_u32 s9, s8, s69
  s_lshl_b32 s9, s9, 11
  v_add_u32 v12, s9, v16
  s_lshl_b32 s9, s70, 12
  v_add_u32 v19, s9, v16
  v_lshl_add_u32 v18, v17, 4, v13
  v_lshlrev_b32 v18, 3, v18
  v_and_b32 v16, 1, v2
  v_lshl_add_u32 v18, v16, 2, v18
  s_lshl_b32 s10, s69, 14
  v_add_u32 v18, s10, v18
  v_lshrrev_b32 v6, 2, v1
  v_lshlrev_b32 v6, 7, v6
  v_and_b32 v17, 3, v1
  v_lshl_add_u32 v6, v17, 3, v6
  v_bfe_u32 v17, v1, 3, 2
  v_lshl_add_u32 v6, v17, 5, v6
  v_xor_b32 v7, 32, v6
  v_xor_b32 v8, 64, v6
  v_xor_b32 v9, 96, v6
  s_mov_b32 s11, 0xffff0000
  s_add_u32 s36, s34, 8439808
  s_addc_u32 s37, s35, 0
  s_and_b32 s37, s37, 0xffff
  s_mov_b32 s38, 4194304
  s_mov_b32 s39, 0x00020000
  s_add_u32 s44, s34, 4194304
  s_addc_u32 s45, s35, 0
  s_and_b32 s45, s45, 0xffff
  s_mov_b32 s46, 4194304
  s_mov_b32 s47, 0x00020000
  s_add_u32 s56, s34, 24117248
  s_addc_u32 s57, s35, 0
  s_and_b32 s57, s57, 0xffff
  s_mov_b32 s58, 262144
  s_mov_b32 s59, 0x00020000
  s_mul_i32 s9, s8, 7168
  s_add_u32 s36, s36, s9
  s_addc_u32 s37, s37, 0x100000
  s_add_u32 s64, s36, 114688
  s_addc_u32 s65, s37, 0
  s_mov_b32 s38, 63488
  s_mov_b32 s39, 0x00800000
  s_mov_b32 s66, 63488
  s_mov_b32 s67, 0x00800000
  s_cmp_lg_u32 s96, 0
  s_cbranch_scc1 L_pfc2_skip
  s_getpc_b64 s[4:5]
L_pfc2:
  s_lshl_b32 s3, s99, 2
  s_add_u32 s3, s3, s70
  s_mul_i32 s3, s3, 128
  s_min_u32 s3, s3, L_w1_c1-L_w1_c0-128
  s_add_i32 s3, s3, L_w1_c0-L_pfc2
  s_ashr_i32 s6, s3, 31
  s_add_u32 s4, s4, s3
  s_addc_u32 s5, s5, s6
  s_load_dword s40, s[4:5], 0
  s_load_dword s40, s[4:5], 64
L_pfc2_skip:
  v_add_u32 v26, 155648, v6
  v_add_u32 v27, 155648, v7
  v_add_u32 v28, 155648, v8
  v_add_u32 v29, 155648, v9
  v_add_u32 v20, 94208, v6
  v_add_u32 v21, 94208, v7
  v_add_u32 v22, 94208, v8
  v_add_u32 v23, 94208, v9
  v_add_u32 v6, 28672, v6
  v_add_u32 v7, 28672, v7
  v_add_u32 v8, 28672, v8
  v_add_u32 v9, 28672, v9
  v_readlane_b32 s48, v15, 0
  v_readlane_b32 s49, v15, 1
  v_readlane_b32 s50, v15, 2
  s_cmp_lg_u32 s96, 0
  s_cbranch_scc1 L_wo_nosw
  v_permlane16_swap_b32 v240, v242
  v_permlane16_swap_b32 v241, v243
  v_permlane16_swap_b32 v244, v246
  v_permlane16_swap_b32 v245, v247
  v_permlane16_swap_b32 v248, v250
  v_permlane16_swap_b32 v249, v251
  v_permlane16_swap_b32 v252, v254
  v_permlane16_swap_b32 v253, v255
L_wo_nosw:
  s_waitcnt lgkmcnt(0)
  s_barrier
  buffer_load_dwordx4 v[32:35], off, s[36:39], s48 offset:0
  buffer_load_dwordx4 v[36:39], off, s[64:67], s48 offset:0
  buffer_load_dwordx4 v[40:43], off, s[36:39], s48 offset:1024
  buffer_load_dwordx4 v[44:47], off, s[64:67], s48 offset:1024
  buffer_load_dwordx4 v[48:51], off, s[36:39], s49 offset:0
  buffer_load_dwordx4 v[52:55], off, s[64:67], s49 offset:0
  buffer_load_dwordx4 v[56:59], off, s[36:39], s49 offset:1024
  buffer_load_dwordx4 v[60:63], off, s[64:67], s49 offset:1024
  buffer_load_dwordx4 v[64:67], off, s[36:39], s50 offset:0
  buffer_load_dwordx4 v[68:71], off, s[64:67], s50 offset:0
  buffer_load_dwordx4 v[72:75], off, s[36:39], s50 offset:1024
  buffer_load_dwordx4 v[76:79], off, s[64:67], s50 offset:1024
  ds_read_b64_tr_b16 v[160:161], v6 offset:0
  ds_read_b64_tr_b16 v[162:163], v6 offset:2048
  ds_read_b64_tr_b16 v[164:165], v7 offset:0
  ds_read_b64_tr_b16 v[166:167], v7 offset:2048
  ds_read_b64_tr_b16 v[168:169], v8 offset:0
  ds_read_b64_tr_b16 v[170:171], v8 offset:2048
  ds_read_b64_tr_b16 v[172:173], v9 offset:0
  ds_read_b64_tr_b16 v[174:175], v9 offset:2048
  ds_read_b64_tr_b16 v[176:177], v6 offset:4096
  ds_read_b64_tr_b16 v[178:179], v6 offset:6144
  ds_read_b64_tr_b16 v[180:181], v7 offset:4096
  ds_read_b64_tr_b16 v[182:183], v7 offset:6144
  ds_read_b64_tr_b16 v[184:185], v8 offset:4096
  ds_read_b64_tr_b16 v[186:187], v8 offset:6144
  ds_read_b64_tr_b16 v[188:189], v9 offset:4096
  ds_read_b64_tr_b16 v[190:191], v9 offset:6144
  v_lshlrev_b32 v96, 16, v240
  v_and_b32 v97, s11, v240
  v_lshlrev_b32 v98, 16, v241
  v_and_b32 v99, s11, v241
  v_lshlrev_b32 v100, 16, v248
  v_and_b32 v101, s11, v248
  v_lshlrev_b32 v102, 16, v249
  v_and_b32 v103, s11, v249
  v_lshlrev_b32 v104, 16, v242
  v_and_b32 v105, s11, v242
  v_lshlrev_b32 v106, 16, v243
  v_and_b32 v107, s11, v243
  v_lshlrev_b32 v108, 16, v250
  v_and_b32 v109, s11, v250
  v_lshlrev_b32 v110, 16, v251
  v_and_b32 v111, s11, v251
  v_lshlrev_b32 v112, 16, v244
  v_and_b32 v113, s11, v244
  v_lshlrev_b32 v114, 16, v245
  v_and_b32 v115, s11, v245
  v_lshlrev_b32 v116, 16, v252
  v_and_b32 v117, s11, v252
  v_lshlrev_b32 v118, 16, v253
  v_and_b32 v119, s11, v253
  v_lshlrev_b32 v120, 16, v246
  v_and_b32 v121, s11, v246
  v_lshlrev_b32 v122, 16, v247
  v_and_b32 v123, s11, v247
  v_lshlrev_b32 v124, 16, v254
  v_and_b32 v125, s11, v254
  v_lshlrev_b32 v126, 16, v255
  v_and_b32 v127, s11, v255
  s_waitcnt vmcnt(10) lgkmcnt(8)
  v_mfma_f32_16x16x32_bf16 v[96:99], v[160:163], v[32:35], v[96:99]
  ds_read_b64_tr_b16 v[192:193], v6 offset:8192
  v_readlane_b32 s51, v15, 3
  v_mfma_f32_16x16x32_bf16 v[100:103], v[160:163], v[36:39], v[100:103]
  ds_read_b64_tr_b16 v[194:195], v6 offset:10240
  v_mfma_f32_16x16x32_bf16 v[108:111], v[164:167], v[36:39], v[108:111]
  ds_read_b64_tr_b16 v[196:197], v7 offset:8192
  v_mfma_f32_16x16x32_bf16 v[104:107], v[164:167], v[32:35], v[104:107]
  buffer_load_dwordx4 v[80:83], off, s[36:39], s51 offset:0
  v_mfma_f32_16x16x32_bf16 v[112:115], v[168:171], v[32:35], v[112:115]
  ds_read_b64_tr_b16 v[198:199], v7 offset:10240
  ds_read_b64_tr_b16 v[200:201], v8 offset:8192
  v_mfma_f32_16x16x32_bf16 v[116:119], v[168:171], v[36:39], v[116:119]
  ds_read_b64_tr_b16 v[202:203], v8 offset:10240
  ds_read_b64_tr_b16 v[204:205], v9 offset:8192
  v_mfma_f32_16x16x32_bf16 v[124:127], v[172:175], v[36:39], v[124:127]
  buffer_load_dwordx4 v[84:87], off, s[64:67], s51 offset:0
  v_mfma_f32_16x16x32_bf16 v[120:123], v[172:175], v[32:35], v[120:123]
  ds_read_b64_tr_b16 v[206:207], v9 offset:10240
  s_waitcnt vmcnt(10) lgkmcnt(8)
  v_mfma_f32_16x16x32_bf16 v[96:99], v[176:179], v[40:43], v[96:99]
  ds_read_b64_tr_b16 v[208:209], v6 offset:12288
  v_mfma_f32_16x16x32_bf16 v[100:103], v[176:179], v[44:47], v[100:103]
  buffer_load_dwordx4 v[88:91], off, s[36:39], s51 offset:1024
  v_mfma_f32_16x16x32_bf16 v[108:111], v[180:183], v[44:47], v[108:111]
  ds_read_b64_tr_b16 v[210:211], v6 offset:14336
  ds_read_b64_tr_b16 v[212:213], v7 offset:12288
  v_mfma_f32_16x16x32_bf16 v[104:107], v[180:183], v[40:43], v[104:107]
  ds_read_b64_tr_b16 v[214:215], v7 offset:14336
  ds_read_b64_tr_b16 v[216:217], v8 offset:12288
  v_mfma_f32_16x16x32_bf16 v[112:115], v[184:187], v[40:43], v[112:115]
  buffer_load_dwordx4 v[92:95], off, s[64:67], s51 offset:1024
  v_mfma_f32_16x16x32_bf16 v[116:119], v[184:187], v[44:47], v[116:119]
  ds_read_b64_tr_b16 v[218:219], v8 offset:14336
  v_readlane_b32 s48, v15, 4
  v_mfma_f32_16x16x32_bf16 v[124:127], v[188:191], v[44:47], v[124:127]
  ds_read_b64_tr_b16 v[220:221], v9 offset:12288
  v_mfma_f32_16x16x32_bf16 v[120:123], v[188:191], v[40:43], v[120:123]
  ds_read_b64_tr_b16 v[222:223], v9 offset:14336
  s_waitcnt vmcnt(10) lgkmcnt(8)
  v_mfma_f32_16x16x32_bf16 v[96:99], v[192:195], v[48:51], v[96:99]
  buffer_load_dwordx4 v[32:35], off, s[36:39], s48 offset:0
  v_mfma_f32_16x16x32_bf16 v[100:103], v[192:195], v[52:55], v[100:103]
  ds_read_b64_tr_b16 v[160:161], v6 offset:16384
  ds_read_b64_tr_b16 v[162:163], v6 offset:18432
  v_mfma_f32_16x16x32_bf16 v[108:111], v[196:199], v[52:55], v[108:111]
  ds_read_b64_tr_b16 v[164:165], v7 offset:16384
  v_mfma_f32_16x16x32_bf16 v[104:107], v[196:199], v[48:51], v[104:107]
  buffer_load_dwordx4 v[36:39], off, s[64:67], s48 offset:0
  v_mfma_f32_16x16x32_bf16 v[112:115], v[200:203], v[48:51], v[112:115]
  ds_read_b64_tr_b16 v[166:167], v7 offset:18432
  ds_read_b64_tr_b16 v[168:169], v8 offset:16384
  v_mfma_f32_16x16x32_bf16 v[116:119], v[200:203], v[52:55], v[116:119]
  ds_read_b64_tr_b16 v[170:171], v8 offset:18432
  ds_read_b64_tr_b16 v[172:173], v9 offset:16384
  v_mfma_f32_16x16x32_bf16 v[124:127], v[204:207], v[52:55], v[124:127]
  buffer_load_dwordx4 v[40:43], off, s[36:39], s48 offset:1024
  v_mfma_f32_16x16x32_bf16 v[120:123], v[204:207], v[48:51], v[120:123]
  ds_read_b64_tr_b16 v[174:175], v9 offset:18432
  s_waitcnt vmcnt(11) lgkmcnt(8)
  v_mfma_f32_16x16x32_bf16 v[96:99], v[208:211], v[56:59], v[96:99]
  ds_read_b64_tr_b16 v[176:177], v6 offset:20480
  v_mfma_f32_16x16x32_bf16 v[100:103], v[208:211], v[60:63], v[100:103]
  buffer_load_dwordx4 v[44:47], off, s[64:67], s48 offset:1024
  v_mfma_f32_16x16x32_bf16 v[108:111], v[212:215], v[60:63], v[108:111]
  ds_read_b64_tr_b16 v[178:179], v6 offset:22528
  ds_read_b64_tr_b16 v[180:181], v7 offset:20480
  v_mfma_f32_16x16x32_bf16 v[104:107], v[212:215], v[56:59], v[104:107]
  ds_read_b64_tr_b16 v[182:183], v7 offset:22528
  v_mfma_f32_16x16x32_bf16 v[112:115], v[216:219], v[56:59], v[112:115]
  ds_read_b64_tr_b16 v[184:185], v8 offset:20480
  v_mfma_f32_16x16x32_bf16 v[116:119], v[216:219], v[60:63], v[116:119]
  ds_read_b64_tr_b16 v[186:187], v8 offset:22528
  v_readlane_b32 s49, v15, 5
  v_mfma_f32_16x16x32_bf16 v[124:127], v[220:223], v[60:63], v[124:127]
  ds_read_b64_tr_b16 v[188:189], v9 offset:20480
  v_mfma_f32_16x16x32_bf16 v[120:123], v[220:223], v[56:59], v[120:123]
  ds_read_b64_tr_b16 v[190:191], v9 offset:22528
  s_waitcnt vmcnt(10) lgkmcnt(8)
  v_mfma_f32_16x16x32_bf16 v[96:99], v[160:163], v[64:67], v[96:99]
  buffer_load_dwordx4 v[48:51], off, s[36:39], s49 offset:0
  v_mfma_f32_16x16x32_bf16 v[100:103], v[160:163], v[68:71], v[100:103]
  ds_read_b64_tr_b16 v[192:193], v6 offset:24576
  ds_read_b64_tr_b16 v[194:195], v6 offset:26624
  v_mfma_f32_16x16x32_bf16 v[108:111], v[164:167], v[68:71], v[108:111]
  ds_read_b64_tr_b16 v[196:197], v7 offset:24576
  v_mfma_f32_16x16x32_bf16 v[104:107], v[164:167], v[64:67], v[104:107]
  buffer_load_dwordx4 v[52:55], off, s[64:67], s49 offset:0
  v_mfma_f32_16x16x32_bf16 v[112:115], v[168:171], v[64:67], v[112:115]
  ds_read_b64_tr_b16 v[198:199], v7 offset:26624
  ds_read_b64_tr_b16 v[200:201], v8 offset:24576
  v_mfma_f32_16x16x32_bf16 v[116:119], v[168:171], v[68:71], v[116:119]
  ds_read_b64_tr_b16 v[202:203], v8 offset:26624
  ds_read_b64_tr_b16 v[204:205], v9 offset:24576
  v_mfma_f32_16x16x32_bf16 v[124:127], v[172:175], v[68:71], v[124:127]
  buffer_load_dwordx4 v[56:59], off, s[36:39], s49 offset:1024
  v_mfma_f32_16x16x32_bf16 v[120:123], v[172:175], v[64:67], v[120:123]
  ds_read_b64_tr_b16 v[206:207], v9 offset:26624
  s_waitcnt vmcnt(11) lgkmcnt(8)
  v_mfma_f32_16x16x32_bf16 v[96:99], v[176:179], v[72:75], v[96:99]
  ds_read_b64_tr_b16 v[208:209], v6 offset:28672
  v_mfma_f32_16x16x32_bf16 v[100:103], v[176:179], v[76:79], v[100:103]
  buffer_load_dwordx4 v[60:63], off, s[64:67], s49 offset:1024
  v_mfma_f32_16x16x32_bf16 v[108:111], v[180:183], v[76:79], v[108:111]
  ds_read_b64_tr_b16 v[210:211], v6 offset:30720
  ds_read_b64_tr_b16 v[212:213], v7 offset:28672
  v_mfma_f32_16x16x32_bf16 v[104:107], v[180:183], v[72:75], v[104:107]
  ds_read_b64_tr_b16 v[214:215], v7 offset:30720
  v_mfma_f32_16x16x32_bf16 v[112:115], v[184:187], v[72:75], v[112:115]
  ds_read_b64_tr_b16 v[216:217], v8 offset:28672
  v_mfma_f32_16x16x32_bf16 v[116:119], v[184:187], v[76:79], v[116:119]
  ds_read_b64_tr_b16 v[218:219], v8 offset:30720
  v_readlane_b32 s50, v15, 6
  v_mfma_f32_16x16x32_bf16 v[124:127], v[188:191], v[76:79], v[124:127]
  ds_read_b64_tr_b16 v[220:221], v9 offset:28672
  v_mfma_f32_16x16x32_bf16 v[120:123], v[188:191], v[72:75], v[120:123]
  ds_read_b64_tr_b16 v[222:223], v9 offset:30720
  s_waitcnt vmcnt(10) lgkmcnt(8)
  v_mfma_f32_16x16x32_bf16 v[96:99], v[192:195], v[80:83], v[96:99]
  buffer_load_dwordx4 v[64:67], off, s[36:39], s50 offset:0
  v_mfma_f32_16x16x32_bf16 v[100:103], v[192:195], v[84:87], v[100:103]
  ds_read_b64_tr_b16 v[160:161], v6 offset:32768
  ds_read_b64_tr_b16 v[162:163], v6 offset:34816
  v_mfma_f32_16x16x32_bf16 v[108:111], v[196:199], v[84:87], v[108:111]
  ds_read_b64_tr_b16 v[164:165], v7 offset:32768
  v_mfma_f32_16x16x32_bf16 v[104:107], v[196:199], v[80:83], v[104:107]
  buffer_load_dwordx4 v[68:71], off, s[64:67], s50 offset:0
  v_mfma_f32_16x16x32_bf16 v[112:115], v[200:203], v[80:83], v[112:115]
  ds_read_b64_tr_b16 v[166:167], v7 offset:34816
  ds_read_b64_tr_b16 v[168:169], v8 offset:32768
  v_mfma_f32_16x16x32_bf16 v[116:119], v[200:203], v[84:87], v[116:119]
  ds_read_b64_tr_b16 v[170:171], v8 offset:34816
  ds_read_b64_tr_b16 v[172:173], v9 offset:32768
  v_mfma_f32_16x16x32_bf16 v[124:127], v[204:207], v[84:87], v[124:127]
  buffer_load_dwordx4 v[72:75], off, s[36:39], s50 offset:1024
  v_mfma_f32_16x16x32_bf16 v[120:123], v[204:207], v[80:83], v[120:123]
  ds_read_b64_tr_b16 v[174:175], v9 offset:34816
  s_waitcnt vmcnt(11) lgkmcnt(8)
  v_mfma_f32_16x16x32_bf16 v[96:99], v[208:211], v[88:91], v[96:99]
  ds_read_b64_tr_b16 v[176:177], v6 offset:36864
  v_mfma_f32_16x16x32_bf16 v[100:103], v[208:211], v[92:95], v[100:103]
  buffer_load_dwordx4 v[76:79], off, s[64:67], s50 offset:1024
  v_mfma_f32_16x16x32_bf16 v[108:111], v[212:215], v[92:95], v[108:111]
  ds_read_b64_tr_b16 v[178:179], v6 offset:38912
  ds_read_b64_tr_b16 v[180:181], v7 offset:36864
  v_mfma_f32_16x16x32_bf16 v[104:107], v[212:215], v[88:91], v[104:107]
  ds_read_b64_tr_b16 v[182:183], v7 offset:38912
  v_mfma_f32_16x16x32_bf16 v[112:115], v[216:219], v[88:91], v[112:115]
  ds_read_b64_tr_b16 v[184:185], v8 offset:36864
  v_mfma_f32_16x16x32_bf16 v[116:119], v[216:219], v[92:95], v[116:119]
  ds_read_b64_tr_b16 v[186:187], v8 offset:38912
  v_readlane_b32 s51, v15, 7
  v_mfma_f32_16x16x32_bf16 v[124:127], v[220:223], v[92:95], v[124:127]
  ds_read_b64_tr_b16 v[188:189], v9 offset:36864
  v_mfma_f32_16x16x32_bf16 v[120:123], v[220:223], v[88:91], v[120:123]
  ds_read_b64_tr_b16 v[190:191], v9 offset:38912
  s_waitcnt vmcnt(10) lgkmcnt(8)
  v_mfma_f32_16x16x32_bf16 v[96:99], v[160:163], v[32:35], v[96:99]
  buffer_load_dwordx4 v[80:83], off, s[36:39], s51 offset:0
  v_mfma_f32_16x16x32_bf16 v[100:103], v[160:163], v[36:39], v[100:103]
  ds_read_b64_tr_b16 v[192:193], v6 offset:40960
  ds_read_b64_tr_b16 v[194:195], v6 offset:43008
  v_mfma_f32_16x16x32_bf16 v[108:111], v[164:167], v[36:39], v[108:111]
  ds_read_b64_tr_b16 v[196:197], v7 offset:40960
  v_mfma_f32_16x16x32_bf16 v[104:107], v[164:167], v[32:35], v[104:107]
  buffer_load_dwordx4 v[84:87], off, s[64:67], s51 offset:0
  v_mfma_f32_16x16x32_bf16 v[112:115], v[168:171], v[32:35], v[112:115]
  ds_read_b64_tr_b16 v[198:199], v7 offset:43008
  ds_read_b64_tr_b16 v[200:201], v8 offset:40960
  v_mfma_f32_16x16x32_bf16 v[116:119], v[168:171], v[36:39], v[116:119]
  ds_read_b64_tr_b16 v[202:203], v8 offset:43008
  ds_read_b64_tr_b16 v[204:205], v9 offset:40960
  v_mfma_f32_16x16x32_bf16 v[124:127], v[172:175], v[36:39], v[124:127]
  buffer_load_dwordx4 v[88:91], off, s[36:39], s51 offset:1024
  v_mfma_f32_16x16x32_bf16 v[120:123], v[172:175], v[32:35], v[120:123]
  ds_read_b64_tr_b16 v[206:207], v9 offset:43008
  s_waitcnt vmcnt(11) lgkmcnt(8)
  s_barrier
  v_mfma_f32_16x16x32_bf16 v[96:99], v[176:179], v[40:43], v[96:99]
  ds_read_b64_tr_b16 v[208:209], v6 offset:45056
  v_mfma_f32_16x16x32_bf16 v[100:103], v[176:179], v[44:47], v[100:103]
  buffer_load_dwordx4 v[92:95], off, s[64:67], s51 offset:1024
  v_mfma_f32_16x16x32_bf16 v[108:111], v[180:183], v[44:47], v[108:111]
  ds_read_b64_tr_b16 v[210:211], v6 offset:47104
  ds_read_b64_tr_b16 v[212:213], v7 offset:45056
  v_mfma_f32_16x16x32_bf16 v[104:107], v[180:183], v[40:43], v[104:107]
  ds_read_b64_tr_b16 v[214:215], v7 offset:47104
  v_mfma_f32_16x16x32_bf16 v[112:115], v[184:187], v[40:43], v[112:115]
  ds_read_b64_tr_b16 v[216:217], v8 offset:45056
  v_mfma_f32_16x16x32_bf16 v[116:119], v[184:187], v[44:47], v[116:119]
  ds_read_b64_tr_b16 v[218:219], v8 offset:47104
  v_readlane_b32 s48, v15, 8
  v_mfma_f32_16x16x32_bf16 v[124:127], v[188:191], v[44:47], v[124:127]
  ds_read_b64_tr_b16 v[220:221], v9 offset:45056
  v_mfma_f32_16x16x32_bf16 v[120:123], v[188:191], v[40:43], v[120:123]
  ds_read_b64_tr_b16 v[222:223], v9 offset:47104
  s_waitcnt vmcnt(10) lgkmcnt(8)
  v_mfma_f32_16x16x32_bf16 v[96:99], v[192:195], v[48:51], v[96:99]
  buffer_load_dwordx4 v[32:35], off, s[36:39], s48 offset:0
  v_mfma_f32_16x16x32_bf16 v[100:103], v[192:195], v[52:55], v[100:103]
  ds_read_b64_tr_b16 v[160:161], v6 offset:49152
  ds_read_b64_tr_b16 v[162:163], v6 offset:51200
  v_mfma_f32_16x16x32_bf16 v[108:111], v[196:199], v[52:55], v[108:111]
  ds_read_b64_tr_b16 v[164:165], v7 offset:49152
  v_mfma_f32_16x16x32_bf16 v[104:107], v[196:199], v[48:51], v[104:107]
  buffer_load_dwordx4 v[36:39], off, s[64:67], s48 offset:0
  v_mfma_f32_16x16x32_bf16 v[112:115], v[200:203], v[48:51], v[112:115]
  ds_read_b64_tr_b16 v[166:167], v7 offset:51200
  ds_read_b64_tr_b16 v[168:169], v8 offset:49152
  v_mfma_f32_16x16x32_bf16 v[116:119], v[200:203], v[52:55], v[116:119]
  ds_read_b64_tr_b16 v[170:171], v8 offset:51200
  ds_read_b64_tr_b16 v[172:173], v9 offset:49152
  v_mfma_f32_16x16x32_bf16 v[124:127], v[204:207], v[52:55], v[124:127]
  buffer_load_dwordx4 v[40:43], off, s[36:39], s48 offset:1024
  v_mfma_f32_16x16x32_bf16 v[120:123], v[204:207], v[48:51], v[120:123]
  ds_read_b64_tr_b16 v[174:175], v9 offset:51200
  s_waitcnt vmcnt(11) lgkmcnt(8)
  v_mfma_f32_16x16x32_bf16 v[96:99], v[208:211], v[56:59], v[96:99]
  ds_read_b64_tr_b16 v[176:177], v6 offset:53248
  v_mfma_f32_16x16x32_bf16 v[100:103], v[208:211], v[60:63], v[100:103]
  buffer_load_dwordx4 v[44:47], off, s[64:67], s48 offset:1024
  v_mfma_f32_16x16x32_bf16 v[108:111], v[212:215], v[60:63], v[108:111]
  ds_read_b64_tr_b16 v[178:179], v6 offset:55296
  ds_read_b64_tr_b16 v[180:181], v7 offset:53248
  v_mfma_f32_16x16x32_bf16 v[104:107], v[212:215], v[56:59], v[104:107]
  ds_read_b64_tr_b16 v[182:183], v7 offset:55296
  v_mfma_f32_16x16x32_bf16 v[112:115], v[216:219], v[56:59], v[112:115]
  ds_read_b64_tr_b16 v[184:185], v8 offset:53248
  v_mfma_f32_16x16x32_bf16 v[116:119], v[216:219], v[60:63], v[116:119]
  ds_read_b64_tr_b16 v[186:187], v8 offset:55296
  v_readlane_b32 s49, v15, 9
  v_mfma_f32_16x16x32_bf16 v[124:127], v[220:223], v[60:63], v[124:127]
  ds_read_b64_tr_b16 v[188:189], v9 offset:53248
  v_mfma_f32_16x16x32_bf16 v[120:123], v[220:223], v[56:59], v[120:123]
  ds_read_b64_tr_b16 v[190:191], v9 offset:55296
  s_waitcnt vmcnt(10) lgkmcnt(8)
  v_mfma_f32_16x16x32_bf16 v[96:99], v[160:163], v[64:67], v[96:99]
  buffer_load_dwordx4 v[48:51], off, s[36:39], s49 offset:0
  v_mfma_f32_16x16x32_bf16 v[100:103], v[160:163], v[68:71], v[100:103]
  ds_read_b64_tr_b16 v[192:193], v6 offset:57344
  ds_read_b64_tr_b16 v[194:195], v6 offset:59392
  v_mfma_f32_16x16x32_bf16 v[108:111], v[164:167], v[68:71], v[108:111]
  ds_read_b64_tr_b16 v[196:197], v7 offset:57344
  v_mfma_f32_16x16x32_bf16 v[104:107], v[164:167], v[64:67], v[104:107]
  buffer_load_dwordx4 v[52:55], off, s[64:67], s49 offset:0
  v_mfma_f32_16x16x32_bf16 v[112:115], v[168:171], v[64:67], v[112:115]
  ds_read_b64_tr_b16 v[198:199], v7 offset:59392
  ds_read_b64_tr_b16 v[200:201], v8 offset:57344
  v_mfma_f32_16x16x32_bf16 v[116:119], v[168:171], v[68:71], v[116:119]
  ds_read_b64_tr_b16 v[202:203], v8 offset:59392
  ds_read_b64_tr_b16 v[204:205], v9 offset:57344
  v_mfma_f32_16x16x32_bf16 v[124:127], v[172:175], v[68:71], v[124:127]
  buffer_load_dwordx4 v[56:59], off, s[36:39], s49 offset:1024
  v_mfma_f32_16x16x32_bf16 v[120:123], v[172:175], v[64:67], v[120:123]
  ds_read_b64_tr_b16 v[206:207], v9 offset:59392
  s_waitcnt vmcnt(11) lgkmcnt(8)
  v_mfma_f32_16x16x32_bf16 v[96:99], v[176:179], v[72:75], v[96:99]
  ds_read_b64_tr_b16 v[208:209], v6 offset:61440
  v_mfma_f32_16x16x32_bf16 v[100:103], v[176:179], v[76:79], v[100:103]
  buffer_load_dwordx4 v[60:63], off, s[64:67], s49 offset:1024
  v_mfma_f32_16x16x32_bf16 v[108:111], v[180:183], v[76:79], v[108:111]
  ds_read_b64_tr_b16 v[210:211], v6 offset:63488
  ds_read_b64_tr_b16 v[212:213], v7 offset:61440
  v_mfma_f32_16x16x32_bf16 v[104:107], v[180:183], v[72:75], v[104:107]
  ds_read_b64_tr_b16 v[214:215], v7 offset:63488
  v_mfma_f32_16x16x32_bf16 v[112:115], v[184:187], v[72:75], v[112:115]
  ds_read_b64_tr_b16 v[216:217], v8 offset:61440
  v_mfma_f32_16x16x32_bf16 v[116:119], v[184:187], v[76:79], v[116:119]
  ds_read_b64_tr_b16 v[218:219], v8 offset:63488
  v_readlane_b32 s50, v15, 10
  v_mfma_f32_16x16x32_bf16 v[124:127], v[188:191], v[76:79], v[124:127]
  ds_read_b64_tr_b16 v[220:221], v9 offset:61440
  v_mfma_f32_16x16x32_bf16 v[120:123], v[188:191], v[72:75], v[120:123]
  ds_read_b64_tr_b16 v[222:223], v9 offset:63488
  s_waitcnt vmcnt(10) lgkmcnt(8)
  v_mfma_f32_16x16x32_bf16 v[96:99], v[192:195], v[80:83], v[96:99]
  buffer_load_dwordx4 v[64:67], off, s[36:39], s50 offset:0
  v_mfma_f32_16x16x32_bf16 v[100:103], v[192:195], v[84:87], v[100:103]
  ds_read_b64_tr_b16 v[160:161], v20 offset:0
  ds_read_b64_tr_b16 v[162:163], v20 offset:2048
  v_mfma_f32_16x16x32_bf16 v[108:111], v[196:199], v[84:87], v[108:111]
  ds_read_b64_tr_b16 v[164:165], v21 offset:0
  v_mfma_f32_16x16x32_bf16 v[104:107], v[196:199], v[80:83], v[104:107]
  buffer_load_dwordx4 v[68:71], off, s[64:67], s50 offset:0
  v_mfma_f32_16x16x32_bf16 v[112:115], v[200:203], v[80:83], v[112:115]
  ds_read_b64_tr_b16 v[166:167], v21 offset:2048
  ds_read_b64_tr_b16 v[168:169], v22 offset:0
  v_mfma_f32_16x16x32_bf16 v[116:119], v[200:203], v[84:87], v[116:119]
  ds_read_b64_tr_b16 v[170:171], v22 offset:2048
  ds_read_b64_tr_b16 v[172:173], v23 offset:0
  v_mfma_f32_16x16x32_bf16 v[124:127], v[204:207], v[84:87], v[124:127]
  buffer_load_dwordx4 v[72:75], off, s[36:39], s50 offset:1024
  v_mfma_f32_16x16x32_bf16 v[120:123], v[204:207], v[80:83], v[120:123]
  ds_read_b64_tr_b16 v[174:175], v23 offset:2048
  s_waitcnt vmcnt(11) lgkmcnt(8)
  v_mfma_f32_16x16x32_bf16 v[96:99], v[208:211], v[88:91], v[96:99]
  ds_read_b64_tr_b16 v[176:177], v20 offset:4096
  v_mfma_f32_16x16x32_bf16 v[100:103], v[208:211], v[92:95], v[100:103]
  buffer_load_dwordx4 v[76:79], off, s[64:67], s50 offset:1024
  v_mfma_f32_16x16x32_bf16 v[108:111], v[212:215], v[92:95], v[108:111]
  ds_read_b64_tr_b16 v[178:179], v20 offset:6144
  ds_read_b64_tr_b16 v[180:181], v21 offset:4096
  v_mfma_f32_16x16x32_bf16 v[104:107], v[212:215], v[88:91], v[104:107]
  ds_read_b64_tr_b16 v[182:183], v21 offset:6144
  v_mfma_f32_16x16x32_bf16 v[112:115], v[216:219], v[88:91], v[112:115]
  ds_read_b64_tr_b16 v[184:185], v22 offset:4096
  v_mfma_f32_16x16x32_bf16 v[116:119], v[216:219], v[92:95], v[116:119]
  ds_read_b64_tr_b16 v[186:187], v22 offset:6144
  v_readlane_b32 s51, v15, 11
  v_mfma_f32_16x16x32_bf16 v[124:127], v[220:223], v[92:95], v[124:127]
  ds_read_b64_tr_b16 v[188:189], v23 offset:4096
  v_mfma_f32_16x16x32_bf16 v[120:123], v[220:223], v[88:91], v[120:123]
  ds_read_b64_tr_b16 v[190:191], v23 offset:6144
  s_waitcnt vmcnt(10) lgkmcnt(8)
  v_mfma_f32_16x16x32_bf16 v[96:99], v[160:163], v[32:35], v[96:99]
  buffer_load_dwordx4 v[80:83], off, s[36:39], s51 offset:0
  v_mfma_f32_16x16x32_bf16 v[100:103], v[160:163], v[36:39], v[100:103]
  ds_read_b64_tr_b16 v[192:193], v20 offset:8192
  ds_read_b64_tr_b16 v[194:195], v20 offset:10240
  v_mfma_f32_16x16x32_bf16 v[108:111], v[164:167], v[36:39], v[108:111]
  ds_read_b64_tr_b16 v[196:197], v21 offset:8192
  v_mfma_f32_16x16x32_bf16 v[104:107], v[164:167], v[32:35], v[104:107]
  buffer_load_dwordx4 v[84:87], off, s[64:67], s51 offset:0
  v_mfma_f32_16x16x32_bf16 v[112:115], v[168:171], v[32:35], v[112:115]
  ds_read_b64_tr_b16 v[198:199], v21 offset:10240
  ds_read_b64_tr_b16 v[200:201], v22 offset:8192
  v_mfma_f32_16x16x32_bf16 v[116:119], v[168:171], v[36:39], v[116:119]
  ds_read_b64_tr_b16 v[202:203], v22 offset:10240
  ds_read_b64_tr_b16 v[204:205], v23 offset:8192
  v_mfma_f32_16x16x32_bf16 v[124:127], v[172:175], v[36:39], v[124:127]
  buffer_load_dwordx4 v[88:91], off, s[36:39], s51 offset:1024
  v_mfma_f32_16x16x32_bf16 v[120:123], v[172:175], v[32:35], v[120:123]
  ds_read_b64_tr_b16 v[206:207], v23 offset:10240
  s_waitcnt vmcnt(11) lgkmcnt(8)
  v_mfma_f32_16x16x32_bf16 v[96:99], v[176:179], v[40:43], v[96:99]
  ds_read_b64_tr_b16 v[208:209], v20 offset:12288
  v_mfma_f32_16x16x32_bf16 v[100:103], v[176:179], v[44:47], v[100:103]
  buffer_load_dwordx4 v[92:95], off, s[64:67], s51 offset:1024
  v_mfma_f32_16x16x32_bf16 v[108:111], v[180:183], v[44:47], v[108:111]
  ds_read_b64_tr_b16 v[210:211], v20 offset:14336
  ds_read_b64_tr_b16 v[212:213], v21 offset:12288
  v_mfma_f32_16x16x32_bf16 v[104:107], v[180:183], v[40:43], v[104:107]
  ds_read_b64_tr_b16 v[214:215], v21 offset:14336
  v_mfma_f32_16x16x32_bf16 v[112:115], v[184:187], v[40:43], v[112:115]
  ds_read_b64_tr_b16 v[216:217], v22 offset:12288
  v_mfma_f32_16x16x32_bf16 v[116:119], v[184:187], v[44:47], v[116:119]
  ds_read_b64_tr_b16 v[218:219], v22 offset:14336
  v_readlane_b32 s48, v15, 12
  v_mfma_f32_16x16x32_bf16 v[124:127], v[188:191], v[44:47], v[124:127]
  ds_read_b64_tr_b16 v[220:221], v23 offset:12288
  v_mfma_f32_16x16x32_bf16 v[120:123], v[188:191], v[40:43], v[120:123]
  ds_read_b64_tr_b16 v[222:223], v23 offset:14336
  s_waitcnt vmcnt(10) lgkmcnt(8)
  v_mfma_f32_16x16x32_bf16 v[96:99], v[192:195], v[48:51], v[96:99]
  buffer_load_dwordx4 v[32:35], off, s[36:39], s48 offset:0
  v_mfma_f32_16x16x32_bf16 v[100:103], v[192:195], v[52:55], v[100:103]
  ds_read_b64_tr_b16 v[160:161], v20 offset:16384
  ds_read_b64_tr_b16 v[162:163], v20 offset:18432
  v_mfma_f32_16x16x32_bf16 v[108:111], v[196:199], v[52:55], v[108:111]
  ds_read_b64_tr_b16 v[164:165], v21 offset:16384
  v_mfma_f32_16x16x32_bf16 v[104:107], v[196:199], v[48:51], v[104:107]
  buffer_load_dwordx4 v[36:39], off, s[64:67], s48 offset:0
  v_mfma_f32_16x16x32_bf16 v[112:115], v[200:203], v[48:51], v[112:115]
  ds_read_b64_tr_b16 v[166:167], v21 offset:18432
  ds_read_b64_tr_b16 v[168:169], v22 offset:16384
  v_mfma_f32_16x16x32_bf16 v[116:119], v[200:203], v[52:55], v[116:119]
  ds_read_b64_tr_b16 v[170:171], v22 offset:18432
  ds_read_b64_tr_b16 v[172:173], v23 offset:16384
  v_mfma_f32_16x16x32_bf16 v[124:127], v[204:207], v[52:55], v[124:127]
  buffer_load_dwordx4 v[40:43], off, s[36:39], s48 offset:1024
  v_mfma_f32_16x16x32_bf16 v[120:123], v[204:207], v[48:51], v[120:123]
  ds_read_b64_tr_b16 v[174:175], v23 offset:18432
  s_waitcnt vmcnt(11) lgkmcnt(8)
  v_mfma_f32_16x16x32_bf16 v[96:99], v[208:211], v[56:59], v[96:99]
  ds_read_b64_tr_b16 v[176:177], v20 offset:20480
  v_mfma_f32_16x16x32_bf16 v[100:103], v[208:211], v[60:63], v[100:103]
  buffer_load_dwordx4 v[44:47], off, s[64:67], s48 offset:1024
  v_mfma_f32_16x16x32_bf16 v[108:111], v[212:215], v[60:63], v[108:111]
  ds_read_b64_tr_b16 v[178:179], v20 offset:22528
  ds_read_b64_tr_b16 v[180:181], v21 offset:20480
  v_mfma_f32_16x16x32_bf16 v[104:107], v[212:215], v[56:59], v[104:107]
  ds_read_b64_tr_b16 v[182:183], v21 offset:22528
  v_mfma_f32_16x16x32_bf16 v[112:115], v[216:219], v[56:59], v[112:115]
  ds_read_b64_tr_b16 v[184:185], v22 offset:20480
  v_mfma_f32_16x16x32_bf16 v[116:119], v[216:219], v[60:63], v[116:119]
  ds_read_b64_tr_b16 v[186:187], v22 offset:22528
  v_readlane_b32 s49, v15, 13
  v_mfma_f32_16x16x32_bf16 v[124:127], v[220:223], v[60:63], v[124:127]
  ds_read_b64_tr_b16 v[188:189], v23 offset:20480
  v_mfma_f32_16x16x32_bf16 v[120:123], v[220:223], v[56:59], v[120:123]
  ds_read_b64_tr_b16 v[190:191], v23 offset:22528
  s_waitcnt vmcnt(10) lgkmcnt(8)
  v_mfma_f32_16x16x32_bf16 v[96:99], v[160:163], v[64:67], v[96:99]
  buffer_load_dwordx4 v[48:51], off, s[36:39], s49 offset:0
  v_mfma_f32_16x16x32_bf16 v[100:103], v[160:163], v[68:71], v[100:103]
  ds_read_b64_tr_b16 v[192:193], v20 offset:24576
  ds_read_b64_tr_b16 v[194:195], v20 offset:26624
  v_mfma_f32_16x16x32_bf16 v[108:111], v[164:167], v[68:71], v[108:111]
  ds_read_b64_tr_b16 v[196:197], v21 offset:24576
  v_mfma_f32_16x16x32_bf16 v[104:107], v[164:167], v[64:67], v[104:107]
  buffer_load_dwordx4 v[52:55], off, s[64:67], s49 offset:0
  v_mfma_f32_16x16x32_bf16 v[112:115], v[168:171], v[64:67], v[112:115]
  ds_read_b64_tr_b16 v[198:199], v21 offset:26624
  ds_read_b64_tr_b16 v[200:201], v22 offset:24576
  v_mfma_f32_16x16x32_bf16 v[116:119], v[168:171], v[68:71], v[116:119]
  ds_read_b64_tr_b16 v[202:203], v22 offset:26624
  ds_read_b64_tr_b16 v[204:205], v23 offset:24576
  v_mfma_f32_16x16x32_bf16 v[124:127], v[172:175], v[68:71], v[124:127]
  buffer_load_dwordx4 v[56:59], off, s[36:39], s49 offset:1024
  v_mfma_f32_16x16x32_bf16 v[120:123], v[172:175], v[64:67], v[120:123]
  ds_read_b64_tr_b16 v[206:207], v23 offset:26624
  s_waitcnt vmcnt(11) lgkmcnt(8)
  v_mfma_f32_16x16x32_bf16 v[96:99], v[176:179], v[72:75], v[96:99]
  ds_read_b64_tr_b16 v[208:209], v20 offset:28672
  v_mfma_f32_16x16x32_bf16 v[100:103], v[176:179], v[76:79], v[100:103]
  buffer_load_dwordx4 v[60:63], off, s[64:67], s49 offset:1024
  v_mfma_f32_16x16x32_bf16 v[108:111], v[180:183], v[76:79], v[108:111]
  ds_read_b64_tr_b16 v[210:211], v20 offset:30720
  ds_read_b64_tr_b16 v[212:213], v21 offset:28672
  v_mfma_f32_16x16x32_bf16 v[104:107], v[180:183], v[72:75], v[104:107]
  ds_read_b64_tr_b16 v[214:215], v21 offset:30720
  v_mfma_f32_16x16x32_bf16 v[112:115], v[184:187], v[72:75], v[112:115]
  ds_read_b64_tr_b16 v[216:217], v22 offset:28672
  v_mfma_f32_16x16x32_bf16 v[116:119], v[184:187], v[76:79], v[116:119]
  ds_read_b64_tr_b16 v[218:219], v22 offset:30720
  v_readlane_b32 s50, v15, 14
  v_mfma_f32_16x16x32_bf16 v[124:127], v[188:191], v[76:79], v[124:127]
  ds_read_b64_tr_b16 v[220:221], v23 offset:28672
  v_mfma_f32_16x16x32_bf16 v[120:123], v[188:191], v[72:75], v[120:123]
  ds_read_b64_tr_b16 v[222:223], v23 offset:30720
  s_waitcnt vmcnt(10) lgkmcnt(8)
  v_mfma_f32_16x16x32_bf16 v[96:99], v[192:195], v[80:83], v[96:99]
  buffer_load_dwordx4 v[64:67], off, s[36:39], s50 offset:0
  v_mfma_f32_16x16x32_bf16 v[100:103], v[192:195], v[84:87], v[100:103]
  ds_read_b64_tr_b16 v[160:161], v20 offset:36864
  ds_read_b64_tr_b16 v[162:163], v20 offset:38912
  v_mfma_f32_16x16x32_bf16 v[108:111], v[196:199], v[84:87], v[108:111]
  ds_read_b64_tr_b16 v[164:165], v21 offset:36864
  v_mfma_f32_16x16x32_bf16 v[104:107], v[196:199], v[80:83], v[104:107]
  buffer_load_dwordx4 v[68:71], off, s[64:67], s50 offset:0
  v_mfma_f32_16x16x32_bf16 v[112:115], v[200:203], v[80:83], v[112:115]
  ds_read_b64_tr_b16 v[166:167], v21 offset:38912
  ds_read_b64_tr_b16 v[168:169], v22 offset:36864
  v_mfma_f32_16x16x32_bf16 v[116:119], v[200:203], v[84:87], v[116:119]
  ds_read_b64_tr_b16 v[170:171], v22 offset:38912
  ds_read_b64_tr_b16 v[172:173], v23 offset:36864
  v_mfma_f32_16x16x32_bf16 v[124:127], v[204:207], v[84:87], v[124:127]
  buffer_load_dwordx4 v[72:75], off, s[36:39], s50 offset:1024
  v_mfma_f32_16x16x32_bf16 v[120:123], v[204:207], v[80:83], v[120:123]
  ds_read_b64_tr_b16 v[174:175], v23 offset:38912
  s_waitcnt vmcnt(11) lgkmcnt(8)
  v_mfma_f32_16x16x32_bf16 v[96:99], v[208:211], v[88:91], v[96:99]
  ds_read_b64_tr_b16 v[176:177], v20 offset:40960
  v_mfma_f32_16x16x32_bf16 v[100:103], v[208:211], v[92:95], v[100:103]
  buffer_load_dwordx4 v[76:79], off, s[64:67], s50 offset:1024
  v_mfma_f32_16x16x32_bf16 v[108:111], v[212:215], v[92:95], v[108:111]
  ds_read_b64_tr_b16 v[178:179], v20 offset:43008
  ds_read_b64_tr_b16 v[180:181], v21 offset:40960
  v_mfma_f32_16x16x32_bf16 v[104:107], v[212:215], v[88:91], v[104:107]
  ds_read_b64_tr_b16 v[182:183], v21 offset:43008
  v_mfma_f32_16x16x32_bf16 v[112:115], v[216:219], v[88:91], v[112:115]
  ds_read_b64_tr_b16 v[184:185], v22 offset:40960
  v_mfma_f32_16x16x32_bf16 v[116:119], v[216:219], v[92:95], v[116:119]
  ds_read_b64_tr_b16 v[186:187], v22 offset:43008
  v_readlane_b32 s51, v15, 15
  v_mfma_f32_16x16x32_bf16 v[124:127], v[220:223], v[92:95], v[124:127]
  ds_read_b64_tr_b16 v[188:189], v23 offset:40960
  v_mfma_f32_16x16x32_bf16 v[120:123], v[220:223], v[88:91], v[120:123]
  ds_read_b64_tr_b16 v[190:191], v23 offset:43008
  s_waitcnt vmcnt(10) lgkmcnt(8)
  v_mfma_f32_16x16x32_bf16 v[96:99], v[160:163], v[32:35], v[96:99]
  buffer_load_dwordx4 v[80:83], off, s[36:39], s51 offset:0
  v_mfma_f32_16x16x32_bf16 v[100:103], v[160:163], v[36:39], v[100:103]
  ds_read_b64_tr_b16 v[192:193], v20 offset:45056
  ds_read_b64_tr_b16 v[194:195], v20 offset:47104
  v_mfma_f32_16x16x32_bf16 v[108:111], v[164:167], v[36:39], v[108:111]
  ds_read_b64_tr_b16 v[196:197], v21 offset:45056
  v_mfma_f32_16x16x32_bf16 v[104:107], v[164:167], v[32:35], v[104:107]
  buffer_load_dwordx4 v[84:87], off, s[64:67], s51 offset:0
  v_mfma_f32_16x16x32_bf16 v[112:115], v[168:171], v[32:35], v[112:115]
  ds_read_b64_tr_b16 v[198:199], v21 offset:47104
  ds_read_b64_tr_b16 v[200:201], v22 offset:45056
  v_mfma_f32_16x16x32_bf16 v[116:119], v[168:171], v[36:39], v[116:119]
  ds_read_b64_tr_b16 v[202:203], v22 offset:47104
  ds_read_b64_tr_b16 v[204:205], v23 offset:45056
  v_mfma_f32_16x16x32_bf16 v[124:127], v[172:175], v[36:39], v[124:127]
  buffer_load_dwordx4 v[88:91], off, s[36:39], s51 offset:1024
  v_mfma_f32_16x16x32_bf16 v[120:123], v[172:175], v[32:35], v[120:123]
  ds_read_b64_tr_b16 v[206:207], v23 offset:47104
  s_waitcnt vmcnt(11) lgkmcnt(8)
  v_mfma_f32_16x16x32_bf16 v[96:99], v[176:179], v[40:43], v[96:99]
  ds_read_b64_tr_b16 v[208:209], v20 offset:49152
  v_mfma_f32_16x16x32_bf16 v[100:103], v[176:179], v[44:47], v[100:103]
  buffer_load_dwordx4 v[92:95], off, s[64:67], s51 offset:1024
  v_mfma_f32_16x16x32_bf16 v[108:111], v[180:183], v[44:47], v[108:111]
  ds_read_b64_tr_b16 v[210:211], v20 offset:51200
  ds_read_b64_tr_b16 v[212:213], v21 offset:49152
  v_mfma_f32_16x16x32_bf16 v[104:107], v[180:183], v[40:43], v[104:107]
  ds_read_b64_tr_b16 v[214:215], v21 offset:51200
  v_mfma_f32_16x16x32_bf16 v[112:115], v[184:187], v[40:43], v[112:115]
  ds_read_b64_tr_b16 v[216:217], v22 offset:49152
  v_mfma_f32_16x16x32_bf16 v[116:119], v[184:187], v[44:47], v[116:119]
  ds_read_b64_tr_b16 v[218:219], v22 offset:51200
  v_mfma_f32_16x16x32_bf16 v[124:127], v[188:191], v[44:47], v[124:127]
  ds_read_b64_tr_b16 v[220:221], v23 offset:49152
  v_mfma_f32_16x16x32_bf16 v[120:123], v[188:191], v[40:43], v[120:123]
  ds_read_b64_tr_b16 v[222:223], v23 offset:51200
  s_waitcnt vmcnt(10) lgkmcnt(8)
  v_mfma_f32_16x16x32_bf16 v[96:99], v[192:195], v[48:51], v[96:99]
  ds_read_b64_tr_b16 v[160:161], v20 offset:53248
  v_mfma_f32_16x16x32_bf16 v[100:103], v[192:195], v[52:55], v[100:103]
  ds_read_b64_tr_b16 v[162:163], v20 offset:55296
  v_mfma_f32_16x16x32_bf16 v[108:111], v[196:199], v[52:55], v[108:111]
  ds_read_b64_tr_b16 v[164:165], v21 offset:53248
  v_mfma_f32_16x16x32_bf16 v[104:107], v[196:199], v[48:51], v[104:107]
  ds_read_b64_tr_b16 v[166:167], v21 offset:55296
  v_mfma_f32_16x16x32_bf16 v[112:115], v[200:203], v[48:51], v[112:115]
  ds_read_b64_tr_b16 v[168:169], v22 offset:53248
  v_mfma_f32_16x16x32_bf16 v[116:119], v[200:203], v[52:55], v[116:119]
  ds_read_b64_tr_b16 v[170:171], v22 offset:55296
  v_mfma_f32_16x16x32_bf16 v[124:127], v[204:207], v[52:55], v[124:127]
  ds_read_b64_tr_b16 v[172:173], v23 offset:53248
  v_mfma_f32_16x16x32_bf16 v[120:123], v[204:207], v[48:51], v[120:123]
  ds_read_b64_tr_b16 v[174:175], v23 offset:55296
  s_waitcnt vmcnt(8) lgkmcnt(8)
  s_barrier
  v_mfma_f32_16x16x32_bf16 v[96:99], v[208:211], v[56:59], v[96:99]
  ds_read_b64_tr_b16 v[176:177], v20 offset:57344
  v_mfma_f32_16x16x32_bf16 v[100:103], v[208:211], v[60:63], v[100:103]
  ds_read_b64_tr_b16 v[178:179], v20 offset:59392
  v_mfma_f32_16x16x32_bf16 v[108:111], v[212:215], v[60:63], v[108:111]
  ds_read_b64_tr_b16 v[180:181], v21 offset:57344
  v_mfma_f32_16x16x32_bf16 v[104:107], v[212:215], v[56:59], v[104:107]
  ds_read_b64_tr_b16 v[182:183], v21 offset:59392
  v_mfma_f32_16x16x32_bf16 v[112:115], v[216:219], v[56:59], v[112:115]
  ds_read_b64_tr_b16 v[184:185], v22 offset:57344
  v_mfma_f32_16x16x32_bf16 v[116:119], v[216:219], v[60:63], v[116:119]
  ds_read_b64_tr_b16 v[186:187], v22 offset:59392
  v_mfma_f32_16x16x32_bf16 v[124:127], v[220:223], v[60:63], v[124:127]
  ds_read_b64_tr_b16 v[188:189], v23 offset:57344
  v_mfma_f32_16x16x32_bf16 v[120:123], v[220:223], v[56:59], v[120:123]
  ds_read_b64_tr_b16 v[190:191], v23 offset:59392
  s_waitcnt vmcnt(6) lgkmcnt(8)
  v_mfma_f32_16x16x32_bf16 v[96:99], v[160:163], v[64:67], v[96:99]
  ds_read_b64_tr_b16 v[192:193], v26 offset:0
  v_mfma_f32_16x16x32_bf16 v[100:103], v[160:163], v[68:71], v[100:103]
  ds_read_b64_tr_b16 v[194:195], v26 offset:2048
  v_mfma_f32_16x16x32_bf16 v[108:111], v[164:167], v[68:71], v[108:111]
  ds_read_b64_tr_b16 v[196:197], v27 offset:0
  v_mfma_f32_16x16x32_bf16 v[104:107], v[164:167], v[64:67], v[104:107]
  ds_read_b64_tr_b16 v[198:199], v27 offset:2048
  v_mfma_f32_16x16x32_bf16 v[112:115], v[168:171], v[64:67], v[112:115]
  ds_read_b64_tr_b16 v[200:201], v28 offset:0
  v_mfma_f32_16x16x32_bf16 v[116:119], v[168:171], v[68:71], v[116:119]
  ds_read_b64_tr_b16 v[202:203], v28 offset:2048
  v_mfma_f32_16x16x32_bf16 v[124:127], v[172:175], v[68:71], v[124:127]
  ds_read_b64_tr_b16 v[204:205], v29 offset:0
  v_mfma_f32_16x16x32_bf16 v[120:123], v[172:175], v[64:67], v[120:123]
  ds_read_b64_tr_b16 v[206:207], v29 offset:2048
  s_waitcnt vmcnt(4) lgkmcnt(8)
  v_mfma_f32_16x16x32_bf16 v[96:99], v[176:179], v[72:75], v[96:99]
  ds_read_b64_tr_b16 v[208:209], v26 offset:4096
  v_mfma_f32_16x16x32_bf16 v[100:103], v[176:179], v[76:79], v[100:103]
  ds_read_b64_tr_b16 v[210:211], v26 offset:6144
  v_mfma_f32_16x16x32_bf16 v[108:111], v[180:183], v[76:79], v[108:111]
  ds_read_b64_tr_b16 v[212:213], v27 offset:4096
  v_mfma_f32_16x16x32_bf16 v[104:107], v[180:183], v[72:75], v[104:107]
  ds_read_b64_tr_b16 v[214:215], v27 offset:6144
  v_mfma_f32_16x16x32_bf16 v[112:115], v[184:187], v[72:75], v[112:115]
  ds_read_b64_tr_b16 v[216:217], v28 offset:4096
  v_mfma_f32_16x16x32_bf16 v[116:119], v[184:187], v[76:79], v[116:119]
  ds_read_b64_tr_b16 v[218:219], v28 offset:6144
  v_mfma_f32_16x16x32_bf16 v[124:127], v[188:191], v[76:79], v[124:127]
  ds_read_b64_tr_b16 v[220:221], v29 offset:4096
  v_mfma_f32_16x16x32_bf16 v[120:123], v[188:191], v[72:75], v[120:123]
  ds_read_b64_tr_b16 v[222:223], v29 offset:6144
  s_waitcnt vmcnt(2) lgkmcnt(8)
  v_mfma_f32_16x16x32_bf16 v[96:99], v[192:195], v[80:83], v[96:99]
  v_mov_b32 v20, 0
  v_mov_b32 v21, 0
  v_mfma_f32_16x16x32_bf16 v[100:103], v[192:195], v[84:87], v[100:103]
  v_mov_b32 v22, 0
  v_mov_b32 v23, 0
  v_mfma_f32_16x16x32_bf16 v[108:111], v[196:199], v[84:87], v[108:111]
  v_mfma_f32_16x16x32_bf16 v[104:107], v[196:199], v[80:83], v[104:107]
  v_mfma_f32_16x16x32_bf16 v[112:115], v[200:203], v[80:83], v[112:115]
  v_mfma_f32_16x16x32_bf16 v[116:119], v[200:203], v[84:87], v[116:119]
  v_mfma_f32_16x16x32_bf16 v[124:127], v[204:207], v[84:87], v[124:127]
  v_mfma_f32_16x16x32_bf16 v[120:123], v[204:207], v[80:83], v[120:123]
  s_waitcnt vmcnt(0) lgkmcnt(0)
  v_mfma_f32_16x16x32_bf16 v[96:99], v[208:211], v[88:91], v[96:99]
  v_mfma_f32_16x16x32_bf16 v[100:103], v[208:211], v[92:95], v[100:103]
  v_mfma_f32_16x16x32_bf16 v[108:111], v[212:215], v[92:95], v[108:111]
  v_mfma_f32_16x16x32_bf16 v[104:107], v[212:215], v[88:91], v[104:107]
  v_mfma_f32_16x16x32_bf16 v[112:115], v[216:219], v[88:91], v[112:115]
  v_mfma_f32_16x16x32_bf16 v[116:119], v[216:219], v[92:95], v[116:119]
  v_mfma_f32_16x16x32_bf16 v[124:127], v[220:223], v[92:95], v[124:127]
  v_mfma_f32_16x16x32_bf16 v[120:123], v[220:223], v[88:91], v[120:123]
  s_mov_b32 s3, 32768
  s_mov_b32 s10, 0x3f803f80
  s_nop 4
  v_cvt_pk_bf16_f32 v240, v96, v97
  v_cvt_pk_bf16_f32 v241, v98, v99
  v_cvt_pk_bf16_f32 v242, v104, v105
  v_cvt_pk_bf16_f32 v243, v106, v107
  buffer_store_dwordx4 v[240:243], v12, s[44:47], 0 offen offset:0 sc1
  ds_write_b128 v19, v[240:243] offset:0
  v_cvt_pk_bf16_f32 v244, v112, v113
  v_cvt_pk_bf16_f32 v245, v114, v115
  v_cvt_pk_bf16_f32 v246, v120, v121
  v_cvt_pk_bf16_f32 v247, v122, v123
  buffer_store_dwordx4 v[244:247], v12, s[44:47], 0 offen offset:1024 sc1
  ds_write_b128 v19, v[244:247] offset:1024
  v_cvt_pk_bf16_f32 v248, v100, v101
  v_cvt_pk_bf16_f32 v249, v102, v103
  v_cvt_pk_bf16_f32 v250, v108, v109
  v_cvt_pk_bf16_f32 v251, v110, v111
  buffer_store_dwordx4 v[248:251], v12, s[44:47], s3 offen offset:0 sc1
  ds_write_b128 v19, v[248:251] offset:2048
  v_cvt_pk_bf16_f32 v252, v116, v117
  v_cvt_pk_bf16_f32 v253, v118, v119
  v_cvt_pk_bf16_f32 v254, v124, v125
  v_cvt_pk_bf16_f32 v255, v126, v127
  buffer_store_dwordx4 v[252:255], v12, s[44:47], s3 offen offset:1024 sc1
  ds_write_b128 v19, v[252:255] offset:3072
  v_dot2_f32_bf16 v20, v240, s10, v20
  v_dot2_f32_bf16 v22, v240, v240, v22
  v_dot2_f32_bf16 v20, v241, s10, v20
  v_dot2_f32_bf16 v22, v241, v241, v22
  v_dot2_f32_bf16 v20, v242, s10, v20
  v_dot2_f32_bf16 v22, v242, v242, v22
  v_dot2_f32_bf16 v20, v243, s10, v20
  v_dot2_f32_bf16 v22, v243, v243, v22
  v_dot2_f32_bf16 v20, v244, s10, v20
  v_dot2_f32_bf16 v22, v244, v244, v22
  v_dot2_f32_bf16 v20, v245, s10, v20
  v_dot2_f32_bf16 v22, v245, v245, v22
  v_dot2_f32_bf16 v20, v246, s10, v20
  v_dot2_f32_bf16 v22, v246, v246, v22
  v_dot2_f32_bf16 v20, v247, s10, v20
  v_dot2_f32_bf16 v22, v247, v247, v22
  v_dot2_f32_bf16 v21, v248, s10, v21
  v_dot2_f32_bf16 v23, v248, v248, v23
  v_dot2_f32_bf16 v21, v249, s10, v21
  v_dot2_f32_bf16 v23, v249, v249, v23
  v_dot2_f32_bf16 v21, v250, s10, v21
  v_dot2_f32_bf16 v23, v250, v250, v23
  v_dot2_f32_bf16 v21, v251, s10, v21
  v_dot2_f32_bf16 v23, v251, v251, v23
  v_dot2_f32_bf16 v21, v252, s10, v21
  v_dot2_f32_bf16 v23, v252, v252, v23
  v_dot2_f32_bf16 v21, v253, s10, v21
  v_dot2_f32_bf16 v23, v253, v253, v23
  v_dot2_f32_bf16 v21, v254, s10, v21
  v_dot2_f32_bf16 v23, v254, v254, v23
  v_dot2_f32_bf16 v21, v255, s10, v21
  v_dot2_f32_bf16 v23, v255, v255, v23
  s_nop 2
  v_permlane32_swap_b32 v20, v21
  v_permlane32_swap_b32 v22, v23
  v_add_f32 v20, v20, v21
  v_add_f32 v22, v22, v23
  s_nop 1
  v_permlane16_swap_b32 v20, v22
  v_add_f32 v20, v20, v22
  buffer_store_dword v20, v18, s[56:59], 0 offen sc1
  s_waitcnt vmcnt(0) lgkmcnt(0)
  s_barrier
  s_add_u32 s97, s97, 1
  s_branch L_w1_body
L_wo_c1:
L_w1_c0:
L_w1_body:
  s_cmp_ge_u32 s2, 256
  s_cbranch_scc1 L_w1_end
  v_lshrrev_b32 v2, 6, v0
  v_and_b32 v1, 63, v0
  v_readfirstlane_b32 s70, v2
  s_and_b32 s3, s2, 7
  s_lshr_b32 s99, s2, 3
  s_and_b32 s5, s3, 3
  s_lshl_b32 s5, s5, 2
  s_and_b32 s6, s99, 3
  s_add_u32 s68, s5, s6
  s_lshr_b32 s5, s3, 2
  s_lshl_b32 s5, s5, 3
  s_lshr_b32 s6, s99, 2
  s_add_u32 s69, s5, s6
  s_cmp_lt_u32 s70, 4
  s_cbranch_scc1 L_w1_compute
L_w1_loader:
  s_add_u32 s8, s70, s69
  s_and_b32 s8, s8, 3
  s_add_u32 s9, s70, s68
  s_and_b32 s9, s9, 3
  s_lshl_b32 s76, s8, 12
  s_lshl_b32 s77, s9, 11
  s_add_u32 s77, s77, 16384
  s_lshl_b32 s11, s68, 7
  v_and_b32 v10, 7, v1
  s_lshr_b32 s10, s76, 11
  s_lshl_b32 s3, s68, 3
  s_add_u32 s10, s10, s3
  s_mul_i32 s10, s10, 32768
  v_lshl_add_u32 v4, v1, 4, s10
  v_add_u32 v5, 32768, v4
  v_lshrrev_b32 v3, 3, v1
  s_lshl_b32 s10, s9, 4
  v_add_u32 v3, s10, v3
  v_mul_u32_u24 v3, 7168, v3
  v_lshrrev_b32 v2, 3, v1
  v_and_b32 v2, 6, v2
  v_xor_b32 v2, v2, v10
  s_mul_i32 s10, s69, 128
  v_add_u32 v3, s10, v3
  v_lshl_add_u32 v8, v2, 4, v3
  v_add_u32 v3, 57344, v3
  v_lshl_add_u32 v9, v2, 4, v3
  v_lshrrev_b32 v3, 2, v1
  s_lshl_b32 s10, s9, 4
  v_add_u32 v3, s10, v3
  v_mul_u32_u24 v3, 7168, v3
  v_bfe_u32 v2, v1, 4, 1
  v_xor_b32 v2, v2, v1
  v_and_b32 v2, 3, v2
  s_lshl_b32 s10, s69, 6
  s_add_u32 s10, s10, 2048
  v_add_u32 v3, s10, v3
  v_lshl_add_u32 v28, v2, 4, v3
  s_lshl_b32 s78, s69, 7
  s_add_u32 s78, s78, 3072
  s_mov_b32 s75, 0
  s_add_u32 s100, s68, s69
  s_mov_b32 s101, -1
  s_add_u32 s3, s68, s69
  s_and_b32 s3, s3, 3
  s_mov_b32 s100, 0x68532410
  s_mov_b32 s101, 0xfedbac97
  s_cmp_eq_u32 s3, 1
  s_cselect_b32 s100, 0x96435210, s100
  s_cselect_b32 s101, 0xfecbda87, s101
  s_cmp_eq_u32 s3, 2
  s_cselect_b32 s100, 0x75463210, s100
  s_cselect_b32 s101, 0xfdceb98a, s101
  s_cmp_eq_u32 s3, 3
  s_cselect_b32 s100, 0x65743210, s100
  s_cselect_b32 s101, 0xedfca9b8, s101
  s_waitcnt lgkmcnt(0)
  s_mov_b32 s40, s24
  s_and_b32 s41, s25, 0xffff
  s_mov_b32 s42, 7340032
  s_mov_b32 s43, 0x00020000
  s_cmp_lg_u32 s96, 0
  s_cbranch_scc1 L_pfc3_skip
  s_getpc_b64 s[4:5]
L_pfc3:
  s_lshl_b32 s3, s99, 2
  s_add_u32 s3, s3, s70
  s_sub_u32 s3, s3, 4
  s_mul_i32 s3, s3, 192
  s_min_u32 s3, s3, L_w2_c1-L_w2_c0-192
  s_add_i32 s3, s3, L_w2_c0-L_pfc3
  s_ashr_i32 s6, s3, 31
  s_add_u32 s4, s4, s3
  s_addc_u32 s5, s5, s6
  s_load_dword s84, s[4:5], 0
  s_load_dword s84, s[4:5], 64
  s_load_dword s84, s[4:5], 128
L_pfc3_skip:
  s_add_u32 s36, s34, 4194304
  s_addc_u32 s37, s35, 0
  s_and_b32 s37, s37, 0xffff
  s_mov_b32 s38, 4194304
  s_mov_b32 s39, 0x00020000
  s_add_u32 s56, s34, 24117248
  s_addc_u32 s57, s35, 0
  s_and_b32 s57, s57, 0xffff
  s_mov_b32 s58, 262144
  s_mov_b32 s59, 0x00020000
  s_add_u32 s64, s22, 24641536
  s_addc_u32 s65, s23, 0
  s_and_b32 s65, s65, 0xffff
  s_mov_b32 s66, 262144
  s_mov_b32 s67, 0x00020000
  s_mov_b32 s52, s26
  s_and_b32 s53, s27, 0xffff
  s_mov_b32 s54, 7168
  s_mov_b32 s55, 0x00020000
  s_and_b32 s3, s70, 3
  s_lshl2_add_u32 s4, s68, s3
  s_lshl_b32 s4, s4, 8
  v_lshrrev_b32 v2, 4, v1
  v_and_b32 v3, 15, v1
  v_lshl_add_u32 v3, v3, 4, s4
  v_lshl_add_u32 v18, v2, 14, v3
  s_lshl_b32 s4, s69, 7
  s_lshl_b32 s5, s70, 6
  s_add_u32 s4, s4, s5
  s_add_u32 s4, s4, 1216
  s_lshl_b32 s5, s69, 6
  s_cmp_eq_u32 s70, 4
  s_cselect_b32 s4, s5, s4
  s_lshr_b32 s5, s5, 1
  s_add_u32 s5, s5, 1024
  s_cmp_eq_u32 s70, 7
  s_cselect_b32 s4, s5, s4
  v_and_b32 v3, 15, v1
  v_lshl_add_u32 v3, v3, 2, s4
  v_lshrrev_b32 v2, 4, v1
  v_add_lshl_u32 v23, v3, v2, 1
  v_lshlrev_b32 v3, 2, v3
  v_lshl_add_u32 v22, v2, 14, v3
  s_mov_b32 s60, s28
  s_and_b32 s61, s29, 0xffff
  s_mov_b32 s62, 7340032
  s_mov_b32 s63, 0x00020000
  s_cmp_eq_u32 s96, 0
  s_cselect_b32 s62, s62, 0
  s_and_b32 s3, s70, 3
  s_lshl_b32 s4, s2, 2
  s_add_u32 s3, s3, s4
  s_mul_i32 s98, s3, 3584
  s_add_u32 s98, s98, 3670016
  s_buffer_load_dword s84, s[60:63], s98 offset:0
  s_buffer_load_dword s84, s[60:63], s98 offset:64
  s_buffer_load_dword s84, s[60:63], s98 offset:128
  s_buffer_load_dword s84, s[60:63], s98 offset:192
  s_waitcnt vmcnt(0)
  s_barrier
  s_lshr_b32 s3, s69, 3
  s_and_b32 s73, s69, 7
  s_lshl1_add_u32 s91, s73, s3
  s_mul_i32 s74, s91, 458752
  s_lshl_b32 s73, s91, 11
  s_mov_b32 s88, s73
  s_add_u32 m0, s77, 0
  s_add_u32 s4, s74, 0
  buffer_load_dwordx4 v8, s[40:43], s4 offen lds
  s_add_u32 m0, s77, 1024
  s_nop 0
  buffer_load_dwordx4 v9, s[40:43], s4 offen lds
  s_add_u32 m0, s77, 8192
  s_add_u32 s4, s74, s78
  buffer_load_dwordx4 v8, s[40:43], s4 offen lds
  s_add_u32 m0, s77, 9216
  s_nop 0
  buffer_load_dwordx4 v9, s[40:43], s4 offen lds
  s_add_u32 m0, s77, 16384
  s_add_u32 s4, s4, 128
  buffer_load_dwordx4 v8, s[40:43], s4 offen lds
  s_add_u32 m0, s77, 17408
  s_nop 0
  buffer_load_dwordx4 v9, s[40:43], s4 offen lds
  s_add_u32 m0, s77, 24576
  s_nop 0
  buffer_load_dwordx4 v28, s[40:43], s74 offen lds
  s_and_b32 s73, s100, 15
  s_cmp_eq_u32 s73, s91
  s_cselect_b32 s74, 4, 0
  s_lshr_b64 s[100:101], s[100:101], s74
  s_and_b32 s73, s100, 15
  s_lshr_b64 s[100:101], s[100:101], 4
  s_mul_i32 s74, s73, 458752
  s_lshl_b32 s73, s73, 11
  s_add_u32 s3, s96, s70
  s_cmp_lg_u32 s3, 4
  s_cbranch_scc1 L_w1_chkNone
  s_add_u32 s44, s22, 41943040
  s_addc_u32 s45, s23, 0
  s_and_b32 s45, s45, 0xffff
  s_mov_b32 s46, 524288
  s_mov_b32 s47, 0x00020000
  v_lshrrev_b32 v2, 2, v1
  v_and_b32 v3, 3, v1
  v_lshlrev_b32 v2, 11, v2
  v_lshl_add_u32 v17, v3, 4, v2
  s_and_b32 s3, s69, 15
  s_lshl_b32 s3, s3, 7
  s_mov_b32 s79, 0x100000
L_w1_chkl:
  buffer_load_dwordx4 v[12:15], v17, s[44:47], s3 offen sc1
  s_sub_u32 s79, s79, 1
  s_cbranch_scc1 L_w1_chkNone
  s_waitcnt vmcnt(0)
  v_and_b32 v12, v12, v13
  v_and_b32 v14, v14, v15
  v_and_b32 v12, v12, v14
  v_cmp_ne_u32 vcc, 1, v12
  s_cbranch_vccnz L_w1_chkl
L_w1_chkNone:
  s_mov_b32 s75, 0
  s_add_u32 s44, s22, 41943040
  s_addc_u32 s45, s23, 0
  s_and_b32 s45, s45, 0xffff
  s_mov_b32 s46, 524288
  s_mov_b32 s47, 0x00020000
  s_lshl4_add_u32 s3, s97, s68
  s_and_b32 s4, s69, 15
  s_lshl4_add_u32 s3, s3, s4
  s_lshl_b32 s3, s3, 7
  s_sub_u32 s3, s3, 32768
  v_lshlrev_b32 v11, 7, v1
  v_and_b32 v2, 15, v1
  v_lshlrev_b32 v2, 2, v2
  s_getreg_b32 s4, hwreg(HW_REG_XCC_ID, 0, 4)
  v_add_u32 v3, 1, s4
  s_mov_b32 s79, 0x100000
  s_waitcnt vmcnt(0)
  s_cmp_lg_u32 s70, 4
  s_barrier
  s_cbranch_scc1 L_w1_nofl
  s_mov_b32 exec_lo, 0xffff
  s_mov_b32 exec_hi, 0
  buffer_store_dword v3, v11, s[44:47], s87 offen sc1
  s_mov_b64 exec, -1
L_w1_nofl:
  s_mov_b32 s5, s3
  s_mov_b32 s89, s73
  s_add_u32 m0, s77, 49152
  s_add_u32 s4, s74, 0
  buffer_load_dwordx4 v8, s[40:43], s4 offen lds
  s_add_u32 m0, s77, 50176
  s_nop 0
  buffer_load_dwordx4 v9, s[40:43], s4 offen lds
  s_add_u32 m0, s77, 57344
  s_add_u32 s4, s74, s78
  buffer_load_dwordx4 v8, s[40:43], s4 offen lds
  s_add_u32 m0, s77, 58368
  s_nop 0
  buffer_load_dwordx4 v9, s[40:43], s4 offen lds
  s_add_u32 m0, s77, 65536
  s_add_u32 s4, s4, 128
  buffer_load_dwordx4 v8, s[40:43], s4 offen lds
  s_add_u32 m0, s77, 66560
  s_nop 0
  buffer_load_dwordx4 v9, s[40:43], s4 offen lds
  s_add_u32 m0, s77, 73728
  s_nop 0
  buffer_load_dwordx4 v28, s[40:43], s74 offen lds
  s_and_b32 s73, s100, 15
  s_cmp_eq_u32 s73, s91
  s_cselect_b32 s74, 4, 0
  s_lshr_b64 s[100:101], s[100:101], s74
  s_and_b32 s73, s100, 15
  s_lshr_b64 s[100:101], s[100:101], 4
  s_mul_i32 s74, s73, 458752
  s_lshl_b32 s73, s73, 11
  s_mov_b32 s90, s73
  s_add_u32 m0, s77, 98304
  s_add_u32 s4, s74, 0
  buffer_load_dwordx4 v8, s[40:43], s4 offen lds
  s_add_u32 m0, s77, 99328
  s_nop 0
  buffer_load_dwordx4 v9, s[40:43], s4 offen lds
  s_add_u32 m0, s77, 106496
  s_add_u32 s4, s74, s78
  buffer_load_dwordx4 v8, s[40:43], s4 offen lds
  s_add_u32 m0, s77, 107520
  s_nop 0
  buffer_load_dwordx4 v9, s[40:43], s4 offen lds
  s_add_u32 m0, s77, 114688
  s_add_u32 s4, s4, 128
  buffer_load_dwordx4 v8, s[40:43], s4 offen lds
  s_add_u32 m0, s77, 115712
  s_nop 0
  buffer_load_dwordx4 v9, s[40:43], s4 offen lds
  s_add_u32 m0, s77, 122880
  s_nop 0
  buffer_load_dwordx4 v28, s[40:43], s74 offen lds
  s_and_b32 s73, s100, 15
  s_cmp_eq_u32 s73, s91
  s_cselect_b32 s74, 4, 0
  s_lshr_b64 s[100:101], s[100:101], s74
  s_and_b32 s73, s100, 15
  s_lshr_b64 s[100:101], s[100:101], 4
  s_mul_i32 s74, s73, 458752
  s_lshl_b32 s73, s73, 11
  s_mov_b32 s3, s5
  s_cmp_lg_u32 s70, 4
  s_cbranch_scc1 L_w1_dep
L_w1_poll:
  buffer_load_dword v27, v2, s[44:47], s3 offen sc1
  s_sub_u32 s79, s79, 1
  s_cbranch_scc1 L_w1_dep
  s_waitcnt vmcnt(0)
  v_cmp_eq_u32 vcc, 0, v27
  s_cbranch_vccnz L_w1_poll
L_w1_dep:
  s_barrier
  s_add_u32 m0, s76, 49152
  s_nop 0
  buffer_load_dwordx4 v4, s[36:39], s89 offen offset:0 lds
  buffer_load_dwordx4 v4, s[36:39], s89 offen offset:1024 lds
  s_add_u32 m0, s76, 51200
  s_nop 0
  buffer_load_dwordx4 v5, s[36:39], s89 offen offset:0 lds
  buffer_load_dwordx4 v5, s[36:39], s89 offen offset:1024 lds
  s_add_u32 m0, s76, 98304
  s_nop 0
  buffer_load_dwordx4 v4, s[36:39], s90 offen offset:0 lds
  buffer_load_dwordx4 v4, s[36:39], s90 offen offset:1024 lds
  s_add_u32 m0, s76, 100352
  s_nop 0
  buffer_load_dwordx4 v5, s[36:39], s90 offen offset:0 lds
  buffer_load_dwordx4 v5, s[36:39], s90 offen offset:1024 lds
  s_waitcnt vmcnt(4)
  s_barrier
  s_mov_b32 s79, 13
L_w1_ld1:
  s_add_u32 s3, s75, s76
  s_add_u32 m0, s3, 0
  s_nop 0
  buffer_load_dwordx4 v4, s[36:39], s73 offen offset:0 lds
  buffer_load_dwordx4 v4, s[36:39], s73 offen offset:1024 lds
  s_add_u32 m0, s3, 2048
  s_nop 0
  buffer_load_dwordx4 v5, s[36:39], s73 offen offset:0 lds
  buffer_load_dwordx4 v5, s[36:39], s73 offen offset:1024 lds
  s_add_u32 s3, s75, s77
  s_add_u32 m0, s3, 0
  s_add_u32 s4, s74, 0
  buffer_load_dwordx4 v8, s[40:43], s4 offen lds
  s_add_u32 m0, s3, 1024
  s_nop 0
  buffer_load_dwordx4 v9, s[40:43], s4 offen lds
  s_add_u32 m0, s3, 8192
  s_add_u32 s4, s74, s78
  buffer_load_dwordx4 v8, s[40:43], s4 offen lds
  s_add_u32 m0, s3, 9216
  s_nop 0
  buffer_load_dwordx4 v9, s[40:43], s4 offen lds
  s_add_u32 m0, s3, 16384
  s_add_u32 s4, s4, 128
  buffer_load_dwordx4 v8, s[40:43], s4 offen lds
  s_add_u32 m0, s3, 17408
  s_nop 0
  buffer_load_dwordx4 v9, s[40:43], s4 offen lds
  s_add_u32 m0, s3, 24576
  s_nop 0
  buffer_load_dwordx4 v28, s[40:43], s74 offen lds
  s_and_b32 s73, s100, 15
  s_cmp_eq_u32 s73, s91
  s_cselect_b32 s74, 4, 0
  s_lshr_b64 s[100:101], s[100:101], s74
  s_and_b32 s73, s100, 15
  s_lshr_b64 s[100:101], s[100:101], 4
  s_mul_i32 s74, s73, 458752
  s_lshl_b32 s73, s73, 11
  s_add_u32 s75, s75, 49152
  s_cmp_eq_u32 s75, 147456
  s_cselect_b32 s75, 0, s75
  s_buffer_load_dword s84, s[60:63], s98 offset:256
  s_buffer_load_dword s84, s[60:63], s98 offset:320
  s_buffer_load_dword s84, s[60:63], s98 offset:384
  s_buffer_load_dword s84, s[60:63], s98 offset:448
  s_add_u32 s98, s98, 256
  s_waitcnt vmcnt(11)
  s_barrier
  s_sub_u32 s79, s79, 1
  s_cmp_lg_u32 s79, 0
  s_cbranch_scc1 L_w1_ld1
  buffer_load_dwordx4 v[64:67], v22, s[64:67], 0 offen
  s_mov_b32 s3, 65536
  buffer_load_dwordx4 v[68:71], v22, s[64:67], s3 offen
  s_mov_b32 s3, 131072
  buffer_load_dwordx4 v[72:75], v22, s[64:67], s3 offen
  s_mov_b32 s3, 196608
  buffer_load_dwordx4 v[76:79], v22, s[64:67], s3 offen
  buffer_load_ushort v80, v23, s[52:55], 0 offen
  buffer_load_dwordx4 v[32:35], v18, s[56:59], 0 offen
  s_mov_b32 s3, 65536
  buffer_load_dwordx4 v[36:39], v18, s[56:59], s3 offen
  s_mov_b32 s3, 131072
  buffer_load_dwordx4 v[40:43], v18, s[56:59], s3 offen
  s_mov_b32 s3, 196608
  buffer_load_dwordx4 v[44:47], v18, s[56:59], s3 offen
  s_waitcnt vmcnt(9)
  s_barrier
  s_waitcnt vmcnt(0)
  v_pk_add_f32 v[32:33], v[32:33], v[36:37]
  v_pk_add_f32 v[34:35], v[34:35], v[38:39]
  v_pk_add_f32 v[40:41], v[40:41], v[44:45]
  v_pk_add_f32 v[42:43], v[42:43], v[46:47]
  v_pk_add_f32 v[32:33], v[32:33], v[40:41]
  v_pk_add_f32 v[34:35], v[34:35], v[42:43]
  s_nop 1
  v_permlane32_swap_b32 v32, v34
  v_permlane32_swap_b32 v33, v35
  v_pk_add_f32 v[32:33], v[32:33], v[34:35]
  v_mov_b32 v34, v32
  v_mov_b32 v35, v33
  s_nop 0
  v_permlane16_swap_b32 v32, v34
  v_permlane16_swap_b32 v33, v35
  v_pk_add_f32 v[32:33], v[32:33], v[34:35]
  v_mul_f32 v32, 0x3a800000, v32
  v_mul_f32 v33, 0x3a800000, v33
  v_fma_f32 v33, -v32, v32, v33
  v_max_f32 v33, 0, v33
  v_add_f32 v33, 0x3727c5ac, v33
  v_rsq_f32 v33, v33
  s_nop 0
  s_and_b32 s3, s70, 3
  s_lshl_b32 s5, s3, 7
  s_add_u32 s5, s5, 110656
  v_and_b32 v3, 15, v1
  v_lshrrev_b32 v2, 5, v1
  v_lshl_add_u32 v2, v3, 1, v2
  v_lshl_add_u32 v2, v2, 2, s5
  ds_write2_b32 v2, v32, v33 offset0:0 offset1:160
  v_pk_add_f32 v[64:65], v[64:65], v[68:69]
  v_pk_add_f32 v[66:67], v[66:67], v[70:71]
  v_pk_add_f32 v[72:73], v[72:73], v[76:77]
  v_pk_add_f32 v[74:75], v[74:75], v[78:79]
  v_pk_add_f32 v[64:65], v[64:65], v[72:73]
  v_pk_add_f32 v[66:67], v[66:67], v[74:75]
  s_nop 1
  v_permlane32_swap_b32 v64, v66
  v_permlane32_swap_b32 v65, v67
  v_pk_add_f32 v[64:65], v[64:65], v[66:67]
  v_lshlrev_b32 v80, 16, v80
  s_lshl_b32 s5, s3, 8
  s_add_u32 s5, s5, 111872
  v_permlane16_swap_b32 v64, v65
  v_lshrrev_b32 v2, 4, v1
  v_lshl_add_u32 v2, v3, 2, v2
  v_lshl_add_u32 v2, v2, 2, s5
  v_add_f32 v64, v64, v65
  ds_write2st64_b32 v2, v64, v80 offset0:0 offset1:4
  v_xor_b32_dpp v64, v27, v27 row_ror:2 row_mask:0xf bank_mask:0xf
  s_lshl2_add_u32 s5, s3, 110592
  v_cmp_ne_u32 vcc, 0, v64
  v_mov_b32 v2, s5
  s_or_b32 s92, vcc_lo, vcc_hi
  v_mov_b32 v64, s92
  ds_write_b32 v2, v64
  s_waitcnt lgkmcnt(0)
  s_barrier
  s_lshl_b32 s87, s97, 15
  s_lshl_b32 s4, s68, 11
  s_add_u32 s87, s87, s4
  s_lshl_b32 s4, s69, 2
  s_add_u32 s87, s87, s4
  s_add_u32 s97, s97, 1
  s_branch L_w2_body
L_w1_end:
  s_endpgm
L_w1_compute:
  s_and_b32 s71, s70, 1
  s_lshr_b32 s72, s70, 1
  v_and_b32 v3, 15, v1
  v_lshrrev_b32 v2, 4, v1
  s_lshl_b32 s8, s71, 13
  v_lshl_add_u32 v4, v1, 4, s8
  v_lshrrev_b32 v13, 2, v1
  v_lshlrev_b32 v13, 7, v13
  v_and_b32 v17, 3, v1
  v_lshl_add_u32 v13, v17, 3, v13
  v_bfe_u32 v17, v1, 3, 2
  v_lshl_add_u32 v13, v17, 5, v13
  s_lshl_b32 s9, s72, 6
  v_xor_b32 v13, s9, v13
  v_add_u32 v5, 16384, v13
  v_xor_b32 v6, 32, v5
  v_and_b32 v16, 1, v2
  v_lshrrev_b32 v17, 1, v2
  v_lshrrev_b32 v13, 2, v1
  v_and_b32 v14, 1, v1
  v_lshl_add_u32 v13, v13, 1, v14
  v_xor_b32 v14, s72, v16
  v_lshl_add_u32 v13, v13, 1, v14
  v_bfe_u32 v14, v1, 1, 1
  v_lshl_add_u32 v13, v13, 1, v14
  v_lshlrev_b32 v13, 3, v13
  v_add_u32 v7, 40960, v13
  s_mov_b32 s75, 0
  v_add_u32_e64 v20, s75, v4
  v_add_u32_e64 v21, s75, v5
  v_add_u32_e64 v22, s75, v6
  v_add_u32_e64 v23, s75, v7
  s_add_u32 s75, s75, 49152
  s_cmp_eq_u32 s75, 147456
  s_cselect_b32 s75, 0, s75
  s_mov_b32 s79, 15
  ds_read_b128 v[32:35], v20 offset:0
  ds_read_b128 v[36:39], v20 offset:2048
  ds_read_b128 v[40:43], v20 offset:4096
  ds_read_b128 v[44:47], v20 offset:6144
  ds_read_b64_tr_b16 v[48:49], v21 offset:0
  ds_read_b64_tr_b16 v[50:51], v21 offset:2048
  ds_read_b64_tr_b16 v[52:53], v22 offset:0
  ds_read_b64_tr_b16 v[54:55], v22 offset:2048
  ds_read_b64_tr_b16 v[56:57], v21 offset:8192
  ds_read_b64_tr_b16 v[58:59], v21 offset:10240
  ds_read_b64_tr_b16 v[60:61], v22 offset:8192
  ds_read_b64_tr_b16 v[62:63], v22 offset:10240
  ds_read_b64_tr_b16 v[64:65], v21 offset:16384
  ds_read_b64_tr_b16 v[66:67], v21 offset:18432
  ds_read_b64_tr_b16 v[68:69], v22 offset:16384
  ds_read_b64_tr_b16 v[70:71], v22 offset:18432
  ds_read_b64_tr_b16 v[72:73], v23 offset:0
  ds_read_b64_tr_b16 v[74:75], v23 offset:2048
  s_waitcnt lgkmcnt(0)
  v_mfma_f32_16x16x32_bf16 v[128:131], v[48:51], v[32:35], 0
  ds_read_b128 v[80:83], v20 offset:1024
  v_mfma_f32_16x16x32_bf16 v[132:135], v[48:51], v[36:39], 0
  ds_read_b128 v[84:87], v20 offset:3072
  v_mfma_f32_16x16x32_bf16 v[136:139], v[48:51], v[40:43], 0
  ds_read_b128 v[88:91], v20 offset:5120
  v_mfma_f32_16x16x32_bf16 v[140:143], v[48:51], v[44:47], 0
  ds_read_b128 v[92:95], v20 offset:7168
  v_mfma_f32_16x16x32_bf16 v[156:159], v[52:55], v[44:47], 0
  ds_read_b64_tr_b16 v[96:97], v21 offset:4096
  v_mfma_f32_16x16x32_bf16 v[152:155], v[52:55], v[40:43], 0
  ds_read_b64_tr_b16 v[98:99], v21 offset:6144
  v_mfma_f32_16x16x32_bf16 v[148:151], v[52:55], v[36:39], 0
  ds_read_b64_tr_b16 v[100:101], v22 offset:4096
  v_mfma_f32_16x16x32_bf16 v[144:147], v[52:55], v[32:35], 0
  ds_read_b64_tr_b16 v[102:103], v22 offset:6144
  v_mfma_f32_16x16x32_bf16 v[160:163], v[56:59], v[32:35], 0
  ds_read_b64_tr_b16 v[104:105], v21 offset:12288
  v_mfma_f32_16x16x32_bf16 v[164:167], v[56:59], v[36:39], 0
  ds_read_b64_tr_b16 v[106:107], v21 offset:14336
  v_mfma_f32_16x16x32_bf16 v[168:171], v[56:59], v[40:43], 0
  ds_read_b64_tr_b16 v[108:109], v22 offset:12288
  v_mfma_f32_16x16x32_bf16 v[172:175], v[56:59], v[44:47], 0
  ds_read_b64_tr_b16 v[110:111], v22 offset:14336
  v_mfma_f32_16x16x32_bf16 v[188:191], v[60:63], v[44:47], 0
  ds_read_b64_tr_b16 v[112:113], v21 offset:20480
  v_mfma_f32_16x16x32_bf16 v[184:187], v[60:63], v[40:43], 0
  ds_read_b64_tr_b16 v[114:115], v21 offset:22528
  v_mfma_f32_16x16x32_bf16 v[180:183], v[60:63], v[36:39], 0
  ds_read_b64_tr_b16 v[116:117], v22 offset:20480
  v_mfma_f32_16x16x32_bf16 v[176:179], v[60:63], v[32:35], 0
  ds_read_b64_tr_b16 v[118:119], v22 offset:22528
  v_mfma_f32_16x16x32_bf16 v[192:195], v[64:67], v[32:35], 0
  ds_read_b64_tr_b16 v[120:121], v23 offset:4096
  v_mfma_f32_16x16x32_bf16 v[196:199], v[64:67], v[36:39], 0
  ds_read_b64_tr_b16 v[122:123], v23 offset:6144
  v_mfma_f32_16x16x32_bf16 v[200:203], v[64:67], v[40:43], 0
  v_add_u32_e64 v20, s75, v4
  v_mfma_f32_16x16x32_bf16 v[204:207], v[64:67], v[44:47], 0
  v_add_u32_e64 v21, s75, v5
  v_mfma_f32_16x16x32_bf16 v[220:223], v[68:71], v[44:47], 0
  v_add_u32_e64 v22, s75, v6
  v_mfma_f32_16x16x32_bf16 v[216:219], v[68:71], v[40:43], 0
  v_add_u32_e64 v23, s75, v7
  v_mfma_f32_16x16x32_bf16 v[212:215], v[68:71], v[36:39], 0
  s_add_u32 s75, s75, 49152
  v_mfma_f32_16x16x32_bf16 v[208:211], v[68:71], v[32:35], 0
  s_cmp_eq_u32 s75, 147456
  v_mfma_f32_16x16x32_bf16 v[224:227], v[72:75], v[32:35], 0
  s_cselect_b32 s75, 0, s75
  v_mfma_f32_16x16x32_bf16 v[228:231], v[72:75], v[36:39], 0
  v_mfma_f32_16x16x32_bf16 v[232:235], v[72:75], v[40:43], 0
  v_mfma_f32_16x16x32_bf16 v[236:239], v[72:75], v[44:47], 0
  s_waitcnt lgkmcnt(0)
  v_mfma_f32_16x16x32_bf16 v[128:131], v[96:99], v[80:83], v[128:131]
  v_mfma_f32_16x16x32_bf16 v[132:135], v[96:99], v[84:87], v[132:135]
  v_mfma_f32_16x16x32_bf16 v[136:139], v[96:99], v[88:91], v[136:139]
  v_mfma_f32_16x16x32_bf16 v[140:143], v[96:99], v[92:95], v[140:143]
  v_mfma_f32_16x16x32_bf16 v[156:159], v[100:103], v[92:95], v[156:159]
  v_mfma_f32_16x16x32_bf16 v[152:155], v[100:103], v[88:91], v[152:155]
  v_mfma_f32_16x16x32_bf16 v[148:151], v[100:103], v[84:87], v[148:151]
  v_mfma_f32_16x16x32_bf16 v[144:147], v[100:103], v[80:83], v[144:147]
  v_mfma_f32_16x16x32_bf16 v[160:163], v[104:107], v[80:83], v[160:163]
  v_mfma_f32_16x16x32_bf16 v[164:167], v[104:107], v[84:87], v[164:167]
  v_mfma_f32_16x16x32_bf16 v[168:171], v[104:107], v[88:91], v[168:171]
  v_mfma_f32_16x16x32_bf16 v[172:175], v[104:107], v[92:95], v[172:175]
  v_mfma_f32_16x16x32_bf16 v[188:191], v[108:111], v[92:95], v[188:191]
  v_mfma_f32_16x16x32_bf16 v[184:187], v[108:111], v[88:91], v[184:187]
  v_mfma_f32_16x16x32_bf16 v[180:183], v[108:111], v[84:87], v[180:183]
  v_mfma_f32_16x16x32_bf16 v[176:179], v[108:111], v[80:83], v[176:179]
  v_mfma_f32_16x16x32_bf16 v[192:195], v[112:115], v[80:83], v[192:195]
  v_mfma_f32_16x16x32_bf16 v[196:199], v[112:115], v[84:87], v[196:199]
  v_mfma_f32_16x16x32_bf16 v[200:203], v[112:115], v[88:91], v[200:203]
  v_mfma_f32_16x16x32_bf16 v[204:207], v[112:115], v[92:95], v[204:207]
  v_mfma_f32_16x16x32_bf16 v[220:223], v[116:119], v[92:95], v[220:223]
  v_mfma_f32_16x16x32_bf16 v[216:219], v[116:119], v[88:91], v[216:219]
  v_mfma_f32_16x16x32_bf16 v[212:215], v[116:119], v[84:87], v[212:215]
  v_mfma_f32_16x16x32_bf16 v[208:211], v[116:119], v[80:83], v[208:211]
  v_mfma_f32_16x16x32_bf16 v[224:227], v[120:123], v[80:83], v[224:227]
  v_mfma_f32_16x16x32_bf16 v[228:231], v[120:123], v[84:87], v[228:231]
  v_mfma_f32_16x16x32_bf16 v[232:235], v[120:123], v[88:91], v[232:235]
  v_mfma_f32_16x16x32_bf16 v[236:239], v[120:123], v[92:95], v[236:239]
  s_lshl_b32 s8, s68, 7
  s_lshl_b32 s9, s71, 6
  s_add_u32 s8, s8, s9
  s_mul_i32 s8, s8, 7168
  v_lshlrev_b32 v14, 8, v17
  v_lshl_add_u32 v14, v3, 4, v14
  s_lshl3_add_u32 s9, s71, s72
  s_lshl_b32 s9, s9, 10
  s_add_u32 s9, s9, 114688
  v_lshl_add_u32 v18, v1, 4, s9
  s_mov_b32 s52, s30
  s_and_b32 s53, s31, 0xffff
  s_mov_b32 s54, 2048
  s_mov_b32 s55, 0x00020000
  s_lshr_b32 s9, s69, 3
  s_and_b32 s10, s69, 7
  s_lshl1_add_u32 s9, s10, s9
  s_lshl_b32 s9, s9, 7
  v_lshl_add_u32 v19, v2, 3, s9
  v_add_u32 v14, s8, v14
  s_lshl_b32 s10, s69, 11
  s_lshl_b32 s9, s72, 10
  s_add_u32 s9, s9, s10
  v_lshl_add_u32 v12, v1, 4, s8
  v_add_u32 v12, s9, v12
  v_lshl_add_u32 v17, v16, 2, v17
  v_mul_u32_u24 v16, 114688, v16
  s_lshr_b32 s9, s9, 1
  v_add3_u32 v13, v16, v14, s9
  s_lshl_b32 s9, s71, 8
  s_add_u32 s9, s9, 110656
  v_lshl_add_u32 v14, v3, 2, s9
  s_lshl_b32 s9, s72, 7
  s_add_u32 s9, s9, 111872
  v_lshl_add_u32 v15, v2, 4, s9
  s_lshl_b32 s9, s72, 5
  s_add_u32 s9, s9, 111872
  v_lshl_add_u32 v16, v17, 4, s9
  v_mov_b32 v17, 110592
  s_add_u32 s44, s34, 8388608
  s_addc_u32 s45, s35, 0
  s_and_b32 s45, s45, 0xffff
  s_mov_b32 s46, 14680064
  s_mov_b32 s47, 0x00020000
  s_lshr_b32 s3, s69, 3
  s_and_b32 s78, s69, 7
  s_lshl1_add_u32 s69, s78, s3
  s_add_u32 s3, s68, s78
  s_and_b32 s3, s3, 3
  s_mov_b32 s4, 0x1616160
  s_cmp_eq_u32 s3, 1
  s_cselect_b32 s4, 0x5858580, s4
  s_cmp_eq_u32 s3, 2
  s_cselect_b32 s4, 0x16161600, s4
  s_cmp_eq_u32 s3, 3
  s_cselect_b32 s4, 0x58585800, s4
  v_subrev_u32 v2, 3, v1
  v_min_u32 v2, 16, v2
  v_lshlrev_b32 v3, 1, v2
  v_bfe_i32 v30, s4, v3, 2
  v_sub_u32 v30, v1, v30
  v_subrev_u32 v30, 7, v30
  v_ashrrev_i32 v3, 1, v30
  v_cmp_eq_u32 vcc, s78, v3
  s_and_b32 s3, s69, 1
  v_or_b32 v2, 14, v30
  v_cndmask_b32 v2, v30, v2, vcc
  v_cmp_gt_i32 vcc, 0, v30
  s_lshl2_add_u32 s4, s3, 20
  v_add_u32 v30, s4, v30
  s_lshl4_add_u32 s4, s3, 24
  v_add_u32 v2, s4, v2
  v_cndmask_b32 v30, v2, v30, vcc
  s_and_b32 s5, s68, 3
  s_mul_i32 s5, s5, 3
  s_sub_u32 s5, s5, 23
  v_add_u32 v3, s5, v1
  v_subrev_u32 v2, 10, v3
  v_min_u32 v3, v3, v2
  v_subrev_u32 v2, 10, v3
  v_min_u32 v3, v3, v2
  v_cmp_gt_u32 vcc, 23, v1
  s_sub_u32 s5, s3, 46
  v_lshl_add_u32 v2, v1, 1, s5
  v_cndmask_b32 v3, v3, v2, vcc
  s_add_u32 s5, s78, 3
  v_ashrrev_i32 v2, 1, v3
  v_add_u32 v2, s5, v2
  v_and_b32 v2, 7, v2
  v_cmp_gt_u32 vcc, 21, v1
  v_and_b32 v3, 1, v3
  v_lshl_add_u32 v3, v3, 3, v2
  v_cndmask_b32 v3, v3, v30, vcc
  v_lshlrev_b32 v30, 11, v3
  s_barrier
  v_and_b32 v3, 15, v1
  v_lshrrev_b32 v2, 4, v1
  s_lshl_b32 s8, s68, 7
  s_lshl_b32 s9, s70, 5
  s_add_u32 s8, s8, s9
  v_add_u32 v76, s8, v3
  s_lshl_b32 s14, s69, 7
  v_lshrrev_b32 v79, 1, v2
  v_lshlrev_b32 v26, 3, v3
  v_and_b32 v26, 0x70, v26
  v_lshlrev_b32 v78, 3, v2
  v_xor_b32 v26, v26, v78
  v_lshl_add_u32 v26, v3, 7, v26
  s_lshl_b32 s3, s70, 12
  v_add_u32 v26, s3, v26
  v_lshl_add_u32 v27, v1, 4, s3
  s_cmp_eq_u32 s96, 0
  s_cselect_b32 s7, 128, 0
  s_add_u32 s7, s7, 2048
  v_xor_b32 v78, v1, v2
  v_and_b32 v78, 7, v78
  v_lshl_add_u32 v78, v78, 4, s14
  v_lshrrev_b32 v77, 3, v1
  v_add_u32 v77, s8, v77
  v_mad_u32_u24 v28, v77, s7, v78
  v_lshl_add_u32 v29, v79, 4, v76
  v_lshlrev_b32 v29, 3, v29
  v_and_b32 v78, 1, v2
  v_lshl_add_u32 v29, v78, 2, v29
  s_lshl_b32 s14, s69, 14
  v_add_u32 v29, s14, v29
  v_lshrrev_b32 v8, 2, v1
  v_lshlrev_b32 v8, 7, v8
  v_and_b32 v79, 3, v1
  v_lshl_add_u32 v8, v79, 3, v8
  v_bfe_u32 v79, v1, 3, 2
  v_lshl_add_u32 v8, v79, 5, v8
  s_mov_b32 s11, 0xffff0000
  s_add_u32 s36, s34, 8388608
  s_addc_u32 s37, s35, 0
  s_and_b32 s37, s37, 0xffff
  s_mov_b32 s40, s32
  s_and_b32 s41, s33, 0xffff
  s_mov_b32 s43, 0x00020000
  s_add_u32 s48, s22, 33554432
  s_addc_u32 s49, s23, 0
  s_and_b32 s49, s49, 0xffff
  s_cmp_eq_u32 s96, 0
  s_cselect_b64 s[40:41], s[48:49], s[40:41]
  s_lshl_b32 s42, s7, 11
  s_add_u32 s56, s34, 24379392
  s_addc_u32 s57, s35, 0
  s_and_b32 s57, s57, 0xffff
  s_mov_b32 s58, 262144
  s_mov_b32 s59, 0x00020000
  s_mul_i32 s9, s8, 7168
  s_add_u32 s36, s36, s9
  s_addc_u32 s37, s37, 0x100000
  s_add_u32 s64, s36, 114688
  s_addc_u32 s65, s37, 0
  s_mov_b32 s38, 114688
  s_mov_b32 s39, 0x00800000
  s_mov_b32 s66, 114688
  s_mov_b32 s67, 0x00800000
  s_add_u32 s60, s34, 25165824
  s_addc_u32 s61, s35, 0
  s_and_b32 s61, s61, 0xffff
  s_mov_b32 s62, 4194304
  s_or_b32 s61, s61, 0x100000
  s_mov_b32 s63, 0x00800000
  s_lshl4_add_u32 s4, s68, s69
  s_lshl2_add_u32 s4, s4, s70
  s_add_u32 s6, s96, 4
  s_lshl_b32 s6, s6, 10
  s_add_u32 s6, s6, s4
  s_lshl_b32 s6, s6, 6
  s_lshl_b32 s4, s4, 12
  s_xor_b32 s5, s4, 16384
  v_readlane_b32 s51, v30, 3
  v_readlane_b32 s48, v30, 4
  v_readlane_b32 s49, v30, 5
  s_barrier
  ds_read_b128 v[32:35], v20 offset:0
  ds_read_b128 v[36:39], v20 offset:2048
  ds_read_b128 v[40:43], v20 offset:4096
  ds_read_b128 v[44:47], v20 offset:6144
  ds_read_b64_tr_b16 v[48:49], v21 offset:0
  ds_read_b64_tr_b16 v[50:51], v21 offset:2048
  ds_read_b64_tr_b16 v[52:53], v22 offset:0
  ds_read_b64_tr_b16 v[54:55], v22 offset:2048
  ds_read_b64_tr_b16 v[56:57], v21 offset:8192
  ds_read_b64_tr_b16 v[58:59], v21 offset:10240
  ds_read_b64_tr_b16 v[60:61], v22 offset:8192
  ds_read_b64_tr_b16 v[62:63], v22 offset:10240
  ds_read_b64_tr_b16 v[64:65], v21 offset:16384
  ds_read_b64_tr_b16 v[66:67], v21 offset:18432
  ds_read_b64_tr_b16 v[68:69], v22 offset:16384
  ds_read_b64_tr_b16 v[70:71], v22 offset:18432
  ds_read_b64_tr_b16 v[72:73], v23 offset:0
  ds_read_b64_tr_b16 v[74:75], v23 offset:2048
.p2align 5
  s_nop 0
  s_nop 0
  s_nop 0
  s_waitcnt lgkmcnt(0)
L_w1_loop:
  v_mfma_f32_16x16x32_bf16 v[128:131], v[48:51], v[32:35], v[128:131]
  ds_read_b128 v[80:83], v20 offset:1024
  v_mfma_f32_16x16x32_bf16 v[132:135], v[48:51], v[36:39], v[132:135]
  ds_read_b128 v[84:87], v20 offset:3072
  v_mfma_f32_16x16x32_bf16 v[136:139], v[48:51], v[40:43], v[136:139]
  ds_read_b128 v[88:91], v20 offset:5120
  v_mfma_f32_16x16x32_bf16 v[140:143], v[48:51], v[44:47], v[140:143]
  ds_read_b128 v[92:95], v20 offset:7168
  v_mfma_f32_16x16x32_bf16 v[156:159], v[52:55], v[44:47], v[156:159]
  ds_read_b64_tr_b16 v[96:97], v21 offset:4096
  v_mfma_f32_16x16x32_bf16 v[152:155], v[52:55], v[40:43], v[152:155]
  ds_read_b64_tr_b16 v[98:99], v21 offset:6144
  v_mfma_f32_16x16x32_bf16 v[148:151], v[52:55], v[36:39], v[148:151]
  ds_read_b64_tr_b16 v[100:101], v22 offset:4096
  v_mfma_f32_16x16x32_bf16 v[144:147], v[52:55], v[32:35], v[144:147]
  ds_read_b64_tr_b16 v[102:103], v22 offset:6144
  v_mfma_f32_16x16x32_bf16 v[160:163], v[56:59], v[32:35], v[160:163]
  ds_read_b64_tr_b16 v[104:105], v21 offset:12288
  v_mfma_f32_16x16x32_bf16 v[164:167], v[56:59], v[36:39], v[164:167]
  ds_read_b64_tr_b16 v[106:107], v21 offset:14336
  v_mfma_f32_16x16x32_bf16 v[168:171], v[56:59], v[40:43], v[168:171]
  ds_read_b64_tr_b16 v[108:109], v22 offset:12288
  v_mfma_f32_16x16x32_bf16 v[172:175], v[56:59], v[44:47], v[172:175]
  ds_read_b64_tr_b16 v[110:111], v22 offset:14336
  v_mfma_f32_16x16x32_bf16 v[188:191], v[60:63], v[44:47], v[188:191]
  ds_read_b64_tr_b16 v[112:113], v21 offset:20480
  v_mfma_f32_16x16x32_bf16 v[184:187], v[60:63], v[40:43], v[184:187]
  ds_read_b64_tr_b16 v[114:115], v21 offset:22528
  v_mfma_f32_16x16x32_bf16 v[180:183], v[60:63], v[36:39], v[180:183]
  ds_read_b64_tr_b16 v[116:117], v22 offset:20480
  v_mfma_f32_16x16x32_bf16 v[176:179], v[60:63], v[32:35], v[176:179]
  ds_read_b64_tr_b16 v[118:119], v22 offset:22528
  v_mfma_f32_16x16x32_bf16 v[192:195], v[64:67], v[32:35], v[192:195]
  ds_read_b64_tr_b16 v[120:121], v23 offset:4096
  v_mfma_f32_16x16x32_bf16 v[196:199], v[64:67], v[36:39], v[196:199]
  ds_read_b64_tr_b16 v[122:123], v23 offset:6144
  v_mfma_f32_16x16x32_bf16 v[200:203], v[64:67], v[40:43], v[200:203]
  v_add_u32_e64 v20, s75, v4
  v_mfma_f32_16x16x32_bf16 v[204:207], v[64:67], v[44:47], v[204:207]
  v_add_u32_e64 v21, s75, v5
  v_mfma_f32_16x16x32_bf16 v[220:223], v[68:71], v[44:47], v[220:223]
  v_add_u32_e64 v22, s75, v6
  v_mfma_f32_16x16x32_bf16 v[216:219], v[68:71], v[40:43], v[216:219]
  v_add_u32_e64 v23, s75, v7
  v_mfma_f32_16x16x32_bf16 v[212:215], v[68:71], v[36:39], v[212:215]
  s_add_u32 s75, s75, 49152
  v_mfma_f32_16x16x32_bf16 v[208:211], v[68:71], v[32:35], v[208:211]
  s_cmp_eq_u32 s75, 147456
  v_mfma_f32_16x16x32_bf16 v[224:227], v[72:75], v[32:35], v[224:227]
  s_cselect_b32 s75, 0, s75
  s_sub_u32 s79, s79, 1
  v_mfma_f32_16x16x32_bf16 v[228:231], v[72:75], v[36:39], v[228:231]
  v_mfma_f32_16x16x32_bf16 v[232:235], v[72:75], v[40:43], v[232:235]
  v_mfma_f32_16x16x32_bf16 v[236:239], v[72:75], v[44:47], v[236:239]
  s_waitcnt lgkmcnt(0)
  s_barrier
  v_mfma_f32_16x16x32_bf16 v[128:131], v[96:99], v[80:83], v[128:131]
  ds_read_b128 v[32:35], v20 offset:0
  v_mfma_f32_16x16x32_bf16 v[132:135], v[96:99], v[84:87], v[132:135]
  ds_read_b128 v[36:39], v20 offset:2048
  v_mfma_f32_16x16x32_bf16 v[136:139], v[96:99], v[88:91], v[136:139]
  ds_read_b128 v[40:43], v20 offset:4096
  v_mfma_f32_16x16x32_bf16 v[140:143], v[96:99], v[92:95], v[140:143]
  ds_read_b128 v[44:47], v20 offset:6144
  v_mfma_f32_16x16x32_bf16 v[156:159], v[100:103], v[92:95], v[156:159]
  ds_read_b64_tr_b16 v[48:49], v21 offset:0
  v_mfma_f32_16x16x32_bf16 v[152:155], v[100:103], v[88:91], v[152:155]
  ds_read_b64_tr_b16 v[50:51], v21 offset:2048
  v_mfma_f32_16x16x32_bf16 v[148:151], v[100:103], v[84:87], v[148:151]
  ds_read_b64_tr_b16 v[52:53], v22 offset:0
  v_mfma_f32_16x16x32_bf16 v[144:147], v[100:103], v[80:83], v[144:147]
  ds_read_b64_tr_b16 v[54:55], v22 offset:2048
  v_mfma_f32_16x16x32_bf16 v[160:163], v[104:107], v[80:83], v[160:163]
  ds_read_b64_tr_b16 v[56:57], v21 offset:8192
  v_mfma_f32_16x16x32_bf16 v[164:167], v[104:107], v[84:87], v[164:167]
  ds_read_b64_tr_b16 v[58:59], v21 offset:10240
  v_mfma_f32_16x16x32_bf16 v[168:171], v[104:107], v[88:91], v[168:171]
  ds_read_b64_tr_b16 v[60:61], v22 offset:8192
  v_mfma_f32_16x16x32_bf16 v[172:175], v[104:107], v[92:95], v[172:175]
  ds_read_b64_tr_b16 v[62:63], v22 offset:10240
  v_mfma_f32_16x16x32_bf16 v[188:191], v[108:111], v[92:95], v[188:191]
  ds_read_b64_tr_b16 v[64:65], v21 offset:16384
  v_mfma_f32_16x16x32_bf16 v[184:187], v[108:111], v[88:91], v[184:187]
  ds_read_b64_tr_b16 v[66:67], v21 offset:18432
  v_mfma_f32_16x16x32_bf16 v[180:183], v[108:111], v[84:87], v[180:183]
  ds_read_b64_tr_b16 v[68:69], v22 offset:16384
  v_mfma_f32_16x16x32_bf16 v[176:179], v[108:111], v[80:83], v[176:179]
  ds_read_b64_tr_b16 v[70:71], v22 offset:18432
  v_mfma_f32_16x16x32_bf16 v[192:195], v[112:115], v[80:83], v[192:195]
  ds_read_b64_tr_b16 v[72:73], v23 offset:0
  v_mfma_f32_16x16x32_bf16 v[196:199], v[112:115], v[84:87], v[196:199]
  ds_read_b64_tr_b16 v[74:75], v23 offset:2048
  v_mfma_f32_16x16x32_bf16 v[200:203], v[112:115], v[88:91], v[200:203]
  s_cmp_lg_u32 s79, 0
  s_nop 0
  v_mfma_f32_16x16x32_bf16 v[204:207], v[112:115], v[92:95], v[204:207]
  v_mfma_f32_16x16x32_bf16 v[220:223], v[116:119], v[92:95], v[220:223]
  v_mfma_f32_16x16x32_bf16 v[216:219], v[116:119], v[88:91], v[216:219]
  v_mfma_f32_16x16x32_bf16 v[212:215], v[116:119], v[84:87], v[212:215]
  v_mfma_f32_16x16x32_bf16 v[208:211], v[116:119], v[80:83], v[208:211]
  v_mfma_f32_16x16x32_bf16 v[224:227], v[120:123], v[80:83], v[224:227]
  v_mfma_f32_16x16x32_bf16 v[228:231], v[120:123], v[84:87], v[228:231]
  v_mfma_f32_16x16x32_bf16 v[232:235], v[120:123], v[88:91], v[232:235]
  v_mfma_f32_16x16x32_bf16 v[236:239], v[120:123], v[92:95], v[236:239]
  s_waitcnt lgkmcnt(0)
  s_cbranch_scc1 L_w1_loop
L_w1_lend:
L_w1_exit:
  ds_read2_b32 v[88:89], v14 offset0:0 offset1:160
  ds_read2_b32 v[90:91], v14 offset0:16 offset1:176
  ds_read2_b32 v[92:93], v14 offset0:32 offset1:192
  ds_read2_b32 v[94:95], v14 offset0:48 offset1:208
  ds_read_b128 v[32:35], v15 offset:0
  ds_read_b128 v[60:63], v15 offset:1024
  ds_read_b128 v[36:39], v15 offset:64
  ds_read_b128 v[64:67], v15 offset:1088
  ds_read_b128 v[40:43], v15 offset:256
  ds_read_b128 v[68:71], v15 offset:1280
  ds_read_b128 v[44:47], v15 offset:320
  ds_read_b128 v[72:75], v15 offset:1344
  ds_read_b128 v[48:51], v15 offset:512
  ds_read_b128 v[76:79], v15 offset:1536
  ds_read_b128 v[52:55], v15 offset:576
  ds_read_b128 v[80:83], v15 offset:1600
  ds_read_b128 v[56:59], v16 offset:768
  ds_read_b128 v[84:87], v16 offset:1792
  ds_read_b32 v17, v17
  buffer_load_dwordx2 v[10:11], v19, s[52:55], 0 offen offset:0
  buffer_load_dwordx2 v[24:25], v19, s[52:55], 0 offen offset:32
  buffer_load_dwordx2 v[124:125], v19, s[52:55], 0 offen offset:64
  buffer_load_dwordx2 v[126:127], v19, s[52:55], 0 offen offset:96
  v_mov_b32 v96, 0xc0135761
  v_mov_b32 v97, 0xbdd2d3e8
  v_mov_b32 v98, 1.0
  s_waitcnt lgkmcnt(0)
  v_readfirstlane_b32 s98, v17
  v_mul_f32 v88, v88, v89
  v_mul_f32 v90, v90, v91
  v_mul_f32 v92, v92, v93
  v_mul_f32 v94, v94, v95
  s_cmp_lg_u32 s98, 0
  s_cselect_b32 s98, 34603008, 0
  s_add_u32 s44, s44, s98
  s_addc_u32 s45, s45, 0
  s_add_u32 s36, s36, s98
  s_addc_u32 s37, s37, 0
  s_add_u32 s64, s64, s98
  s_addc_u32 s65, s65, 0
  v_pk_fma_f32 v[100:101], v[32:33], v[88:89], v[60:61] op_sel:[0,0,0] op_sel_hi:[1,0,1] neg_lo:[0,1,0] neg_hi:[0,1,0]
  v_pk_fma_f32 v[102:103], v[34:35], v[88:89], v[62:63] op_sel:[0,0,0] op_sel_hi:[1,0,1] neg_lo:[0,1,0] neg_hi:[0,1,0]
  v_pk_fma_f32 v[128:129], v[128:129], v[88:89], v[100:101] op_sel:[0,1,0] op_sel_hi:[1,1,1]
  v_pk_fma_f32 v[130:131], v[130:131], v[88:89], v[102:103] op_sel:[0,1,0] op_sel_hi:[1,1,1]
  v_pk_mul_f32 v[100:101], v[128:129], v[128:129]
  v_pk_mul_f32 v[102:103], v[130:131], v[130:131]
  v_pk_fma_f32 v[100:101], v[100:101], v[96:97], v[96:97] op_sel:[0,1,0] op_sel_hi:[1,1,0]
  v_pk_fma_f32 v[102:103], v[102:103], v[96:97], v[96:97] op_sel:[0,1,0] op_sel_hi:[1,1,0]
  v_pk_mul_f32 v[100:101], v[100:101], v[128:129]
  v_pk_mul_f32 v[102:103], v[102:103], v[130:131]
  v_exp_f32 v100, v100
  v_exp_f32 v101, v101
  v_exp_f32 v102, v102
  v_exp_f32 v103, v103
  v_pk_add_f32 v[100:101], v[100:101], v[98:99] op_sel_hi:[1,0]
  v_pk_add_f32 v[102:103], v[102:103], v[98:99] op_sel_hi:[1,0]
  v_rcp_f32 v100, v100
  v_rcp_f32 v101, v101
  v_rcp_f32 v102, v102
  v_rcp_f32 v103, v103
  v_pk_mul_f32 v[128:129], v[128:129], v[100:101]
  v_pk_mul_f32 v[130:131], v[130:131], v[102:103]
  v_cvt_pk_bf16_f32 v108, v128, v129
  v_cvt_pk_bf16_f32 v109, v130, v131
  v_pk_fma_f32 v[104:105], v[36:37], v[88:89], v[64:65] op_sel:[0,0,0] op_sel_hi:[1,0,1] neg_lo:[0,1,0] neg_hi:[0,1,0]
  v_pk_fma_f32 v[106:107], v[38:39], v[88:89], v[66:67] op_sel:[0,0,0] op_sel_hi:[1,0,1] neg_lo:[0,1,0] neg_hi:[0,1,0]
  v_pk_fma_f32 v[144:145], v[144:145], v[88:89], v[104:105] op_sel:[0,1,0] op_sel_hi:[1,1,1]
  v_pk_fma_f32 v[146:147], v[146:147], v[88:89], v[106:107] op_sel:[0,1,0] op_sel_hi:[1,1,1]
  v_pk_mul_f32 v[104:105], v[144:145], v[144:145]
  v_pk_mul_f32 v[106:107], v[146:147], v[146:147]
  v_pk_fma_f32 v[104:105], v[104:105], v[96:97], v[96:97] op_sel:[0,1,0] op_sel_hi:[1,1,0]
  v_pk_fma_f32 v[106:107], v[106:107], v[96:97], v[96:97] op_sel:[0,1,0] op_sel_hi:[1,1,0]
  v_pk_mul_f32 v[104:105], v[104:105], v[144:145]
  v_pk_mul_f32 v[106:107], v[106:107], v[146:147]
  v_exp_f32 v104, v104
  v_exp_f32 v105, v105
  v_exp_f32 v106, v106
  v_exp_f32 v107, v107
  v_pk_add_f32 v[104:105], v[104:105], v[98:99] op_sel_hi:[1,0]
  v_pk_add_f32 v[106:107], v[106:107], v[98:99] op_sel_hi:[1,0]
  v_rcp_f32 v104, v104
  v_rcp_f32 v105, v105
  v_rcp_f32 v106, v106
  v_rcp_f32 v107, v107
  v_pk_mul_f32 v[144:145], v[144:145], v[104:105]
  v_pk_mul_f32 v[146:147], v[146:147], v[106:107]
  v_cvt_pk_bf16_f32 v110, v144, v145
  v_cvt_pk_bf16_f32 v111, v146, v147
  s_mov_b32 s3, 0
  buffer_store_dwordx4 v[108:111], v12, s[44:47], s3 offen sc1
  ds_write_b128 v18, v[108:111] offset:32768
  v_pk_fma_f32 v[100:101], v[32:33], v[90:91], v[60:61] op_sel:[0,0,0] op_sel_hi:[1,0,1] neg_lo:[0,1,0] neg_hi:[0,1,0]
  v_pk_fma_f32 v[102:103], v[34:35], v[90:91], v[62:63] op_sel:[0,0,0] op_sel_hi:[1,0,1] neg_lo:[0,1,0] neg_hi:[0,1,0]
  v_pk_fma_f32 v[132:133], v[132:133], v[90:91], v[100:101] op_sel:[0,1,0] op_sel_hi:[1,1,1]
  v_pk_fma_f32 v[134:135], v[134:135], v[90:91], v[102:103] op_sel:[0,1,0] op_sel_hi:[1,1,1]
  v_pk_mul_f32 v[100:101], v[132:133], v[132:133]
  v_pk_mul_f32 v[102:103], v[134:135], v[134:135]
  v_pk_fma_f32 v[100:101], v[100:101], v[96:97], v[96:97] op_sel:[0,1,0] op_sel_hi:[1,1,0]
  v_pk_fma_f32 v[102:103], v[102:103], v[96:97], v[96:97] op_sel:[0,1,0] op_sel_hi:[1,1,0]
  v_pk_mul_f32 v[100:101], v[100:101], v[132:133]
  v_pk_mul_f32 v[102:103], v[102:103], v[134:135]
  v_exp_f32 v100, v100
  v_exp_f32 v101, v101
  v_exp_f32 v102, v102
  v_exp_f32 v103, v103
  v_pk_add_f32 v[100:101], v[100:101], v[98:99] op_sel_hi:[1,0]
  v_pk_add_f32 v[102:103], v[102:103], v[98:99] op_sel_hi:[1,0]
  v_rcp_f32 v100, v100
  v_rcp_f32 v101, v101
  v_rcp_f32 v102, v102
  v_rcp_f32 v103, v103
  v_pk_mul_f32 v[132:133], v[132:133], v[100:101]
  v_pk_mul_f32 v[134:135], v[134:135], v[102:103]
  v_cvt_pk_bf16_f32 v112, v132, v133
  v_cvt_pk_bf16_f32 v113, v134, v135
  v_pk_fma_f32 v[104:105], v[36:37], v[90:91], v[64:65] op_sel:[0,0,0] op_sel_hi:[1,0,1] neg_lo:[0,1,0] neg_hi:[0,1,0]
  v_pk_fma_f32 v[106:107], v[38:39], v[90:91], v[66:67] op_sel:[0,0,0] op_sel_hi:[1,0,1] neg_lo:[0,1,0] neg_hi:[0,1,0]
  v_pk_fma_f32 v[148:149], v[148:149], v[90:91], v[104:105] op_sel:[0,1,0] op_sel_hi:[1,1,1]
  v_pk_fma_f32 v[150:151], v[150:151], v[90:91], v[106:107] op_sel:[0,1,0] op_sel_hi:[1,1,1]
  v_pk_mul_f32 v[104:105], v[148:149], v[148:149]
  v_pk_mul_f32 v[106:107], v[150:151], v[150:151]
  v_pk_fma_f32 v[104:105], v[104:105], v[96:97], v[96:97] op_sel:[0,1,0] op_sel_hi:[1,1,0]
  v_pk_fma_f32 v[106:107], v[106:107], v[96:97], v[96:97] op_sel:[0,1,0] op_sel_hi:[1,1,0]
  v_pk_mul_f32 v[104:105], v[104:105], v[148:149]
  v_pk_mul_f32 v[106:107], v[106:107], v[150:151]
  v_exp_f32 v104, v104
  v_exp_f32 v105, v105
  v_exp_f32 v106, v106
  v_exp_f32 v107, v107
  v_pk_add_f32 v[104:105], v[104:105], v[98:99] op_sel_hi:[1,0]
  v_pk_add_f32 v[106:107], v[106:107], v[98:99] op_sel_hi:[1,0]
  v_rcp_f32 v104, v104
  v_rcp_f32 v105, v105
  v_rcp_f32 v106, v106
  v_rcp_f32 v107, v107
  v_pk_mul_f32 v[148:149], v[148:149], v[104:105]
  v_pk_mul_f32 v[150:151], v[150:151], v[106:107]
  v_cvt_pk_bf16_f32 v114, v148, v149
  v_cvt_pk_bf16_f32 v115, v150, v151
  s_mov_b32 s3, 114688
  buffer_store_dwordx4 v[112:115], v12, s[44:47], s3 offen sc1
  ds_write_b128 v18, v[112:115] offset:34816
  v_pk_fma_f32 v[100:101], v[32:33], v[92:93], v[60:61] op_sel:[0,0,0] op_sel_hi:[1,0,1] neg_lo:[0,1,0] neg_hi:[0,1,0]
  v_pk_fma_f32 v[102:103], v[34:35], v[92:93], v[62:63] op_sel:[0,0,0] op_sel_hi:[1,0,1] neg_lo:[0,1,0] neg_hi:[0,1,0]
  v_pk_fma_f32 v[136:137], v[136:137], v[92:93], v[100:101] op_sel:[0,1,0] op_sel_hi:[1,1,1]
  v_pk_fma_f32 v[138:139], v[138:139], v[92:93], v[102:103] op_sel:[0,1,0] op_sel_hi:[1,1,1]
  v_pk_mul_f32 v[100:101], v[136:137], v[136:137]
  v_pk_mul_f32 v[102:103], v[138:139], v[138:139]
  v_pk_fma_f32 v[100:101], v[100:101], v[96:97], v[96:97] op_sel:[0,1,0] op_sel_hi:[1,1,0]
  v_pk_fma_f32 v[102:103], v[102:103], v[96:97], v[96:97] op_sel:[0,1,0] op_sel_hi:[1,1,0]
  v_pk_mul_f32 v[100:101], v[100:101], v[136:137]
  v_pk_mul_f32 v[102:103], v[102:103], v[138:139]
  v_exp_f32 v100, v100
  v_exp_f32 v101, v101
  v_exp_f32 v102, v102
  v_exp_f32 v103, v103
  v_pk_add_f32 v[100:101], v[100:101], v[98:99] op_sel_hi:[1,0]
  v_pk_add_f32 v[102:103], v[102:103], v[98:99] op_sel_hi:[1,0]
  v_rcp_f32 v100, v100
  v_rcp_f32 v101, v101
  v_rcp_f32 v102, v102
  v_rcp_f32 v103, v103
  v_pk_mul_f32 v[136:137], v[136:137], v[100:101]
  v_pk_mul_f32 v[138:139], v[138:139], v[102:103]
  v_cvt_pk_bf16_f32 v116, v136, v137
  v_cvt_pk_bf16_f32 v117, v138, v139
  v_pk_fma_f32 v[104:105], v[36:37], v[92:93], v[64:65] op_sel:[0,0,0] op_sel_hi:[1,0,1] neg_lo:[0,1,0] neg_hi:[0,1,0]
  v_pk_fma_f32 v[106:107], v[38:39], v[92:93], v[66:67] op_sel:[0,0,0] op_sel_hi:[1,0,1] neg_lo:[0,1,0] neg_hi:[0,1,0]
  v_pk_fma_f32 v[152:153], v[152:153], v[92:93], v[104:105] op_sel:[0,1,0] op_sel_hi:[1,1,1]
  v_pk_fma_f32 v[154:155], v[154:155], v[92:93], v[106:107] op_sel:[0,1,0] op_sel_hi:[1,1,1]
  v_pk_mul_f32 v[104:105], v[152:153], v[152:153]
  v_pk_mul_f32 v[106:107], v[154:155], v[154:155]
  v_pk_fma_f32 v[104:105], v[104:105], v[96:97], v[96:97] op_sel:[0,1,0] op_sel_hi:[1,1,0]
  v_pk_fma_f32 v[106:107], v[106:107], v[96:97], v[96:97] op_sel:[0,1,0] op_sel_hi:[1,1,0]
  v_pk_mul_f32 v[104:105], v[104:105], v[152:153]
  v_pk_mul_f32 v[106:107], v[106:107], v[154:155]
  v_exp_f32 v104, v104
  v_exp_f32 v105, v105
  v_exp_f32 v106, v106
  v_exp_f32 v107, v107
  v_pk_add_f32 v[104:105], v[104:105], v[98:99] op_sel_hi:[1,0]
  v_pk_add_f32 v[106:107], v[106:107], v[98:99] op_sel_hi:[1,0]
  v_rcp_f32 v104, v104
  v_rcp_f32 v105, v105
  v_rcp_f32 v106, v106
  v_rcp_f32 v107, v107
  v_pk_mul_f32 v[152:153], v[152:153], v[104:105]
  v_pk_mul_f32 v[154:155], v[154:155], v[106:107]
  v_cvt_pk_bf16_f32 v118, v152, v153
  v_cvt_pk_bf16_f32 v119, v154, v155
  s_mov_b32 s3, 229376
  buffer_store_dwordx4 v[116:119], v12, s[44:47], s3 offen sc1
  ds_write_b128 v18, v[116:119] offset:36864
  v_pk_fma_f32 v[100:101], v[32:33], v[94:95], v[60:61] op_sel:[0,0,0] op_sel_hi:[1,0,1] neg_lo:[0,1,0] neg_hi:[0,1,0]
  v_pk_fma_f32 v[102:103], v[34:35], v[94:95], v[62:63] op_sel:[0,0,0] op_sel_hi:[1,0,1] neg_lo:[0,1,0] neg_hi:[0,1,0]
  v_pk_fma_f32 v[140:141], v[140:141], v[94:95], v[100:101] op_sel:[0,1,0] op_sel_hi:[1,1,1]
  v_pk_fma_f32 v[142:143], v[142:143], v[94:95], v[102:103] op_sel:[0,1,0] op_sel_hi:[1,1,1]
  v_pk_mul_f32 v[100:101], v[140:141], v[140:141]
  v_pk_mul_f32 v[102:103], v[142:143], v[142:143]
  v_pk_fma_f32 v[100:101], v[100:101], v[96:97], v[96:97] op_sel:[0,1,0] op_sel_hi:[1,1,0]
  v_pk_fma_f32 v[102:103], v[102:103], v[96:97], v[96:97] op_sel:[0,1,0] op_sel_hi:[1,1,0]
  v_pk_mul_f32 v[100:101], v[100:101], v[140:141]
  v_pk_mul_f32 v[102:103], v[102:103], v[142:143]
  v_exp_f32 v100, v100
  v_exp_f32 v101, v101
  v_exp_f32 v102, v102
  v_exp_f32 v103, v103
  v_pk_add_f32 v[100:101], v[100:101], v[98:99] op_sel_hi:[1,0]
  v_pk_add_f32 v[102:103], v[102:103], v[98:99] op_sel_hi:[1,0]
  v_rcp_f32 v100, v100
  v_rcp_f32 v101, v101
  v_rcp_f32 v102, v102
  v_rcp_f32 v103, v103
  v_pk_mul_f32 v[140:141], v[140:141], v[100:101]
  v_pk_mul_f32 v[142:143], v[142:143], v[102:103]
  v_cvt_pk_bf16_f32 v120, v140, v141
  v_cvt_pk_bf16_f32 v121, v142, v143
  v_pk_fma_f32 v[104:105], v[36:37], v[94:95], v[64:65] op_sel:[0,0,0] op_sel_hi:[1,0,1] neg_lo:[0,1,0] neg_hi:[0,1,0]
  v_pk_fma_f32 v[106:107], v[38:39], v[94:95], v[66:67] op_sel:[0,0,0] op_sel_hi:[1,0,1] neg_lo:[0,1,0] neg_hi:[0,1,0]
  v_pk_fma_f32 v[156:157], v[156:157], v[94:95], v[104:105] op_sel:[0,1,0] op_sel_hi:[1,1,1]
  v_pk_fma_f32 v[158:159], v[158:159], v[94:95], v[106:107] op_sel:[0,1,0] op_sel_hi:[1,1,1]
  v_pk_mul_f32 v[104:105], v[156:157], v[156:157]
  v_pk_mul_f32 v[106:107], v[158:159], v[158:159]
  v_pk_fma_f32 v[104:105], v[104:105], v[96:97], v[96:97] op_sel:[0,1,0] op_sel_hi:[1,1,0]
  v_pk_fma_f32 v[106:107], v[106:107], v[96:97], v[96:97] op_sel:[0,1,0] op_sel_hi:[1,1,0]
  v_pk_mul_f32 v[104:105], v[104:105], v[156:157]
  v_pk_mul_f32 v[106:107], v[106:107], v[158:159]
  v_exp_f32 v104, v104
  v_exp_f32 v105, v105
  v_exp_f32 v106, v106
  v_exp_f32 v107, v107
  v_pk_add_f32 v[104:105], v[104:105], v[98:99] op_sel_hi:[1,0]
  v_pk_add_f32 v[106:107], v[106:107], v[98:99] op_sel_hi:[1,0]
  v_rcp_f32 v104, v104
  v_rcp_f32 v105, v105
  v_rcp_f32 v106, v106
  v_rcp_f32 v107, v107
  v_pk_mul_f32 v[156:157], v[156:157], v[104:105]
  v_pk_mul_f32 v[158:159], v[158:159], v[106:107]
  v_cvt_pk_bf16_f32 v122, v156, v157
  v_cvt_pk_bf16_f32 v123, v158, v159
  s_mov_b32 s3, 344064
  buffer_store_dwordx4 v[120:123], v12, s[44:47], s3 offen sc1
  ds_write_b128 v18, v[120:123] offset:38912
  v_pk_fma_f32 v[100:101], v[56:57], v[88:89], v[84:85] op_sel:[0,0,0] op_sel_hi:[1,0,1] neg_lo:[0,1,0] neg_hi:[0,1,0]
  v_pk_fma_f32 v[102:103], v[58:59], v[88:89], v[86:87] op_sel:[0,0,0] op_sel_hi:[1,0,1] neg_lo:[0,1,0] neg_hi:[0,1,0]
  v_pk_fma_f32 v[224:225], v[224:225], v[88:89], v[100:101] op_sel:[0,1,0] op_sel_hi:[1,1,1]
  v_pk_fma_f32 v[226:227], v[226:227], v[88:89], v[102:103] op_sel:[0,1,0] op_sel_hi:[1,1,1]
  v_pk_mul_f32 v[100:101], v[224:225], v[224:225]
  v_pk_mul_f32 v[102:103], v[226:227], v[226:227]
  v_pk_fma_f32 v[100:101], v[100:101], v[96:97], v[96:97] op_sel:[0,1,0] op_sel_hi:[1,1,0]
  v_pk_fma_f32 v[102:103], v[102:103], v[96:97], v[96:97] op_sel:[0,1,0] op_sel_hi:[1,1,0]
  v_pk_mul_f32 v[100:101], v[100:101], v[224:225]
  v_pk_mul_f32 v[102:103], v[102:103], v[226:227]
  v_exp_f32 v100, v100
  v_exp_f32 v101, v101
  v_exp_f32 v102, v102
  v_exp_f32 v103, v103
  v_pk_add_f32 v[100:101], v[100:101], v[98:99] op_sel_hi:[1,0]
  v_pk_add_f32 v[102:103], v[102:103], v[98:99] op_sel_hi:[1,0]
  v_rcp_f32 v100, v100
  v_rcp_f32 v101, v101
  v_rcp_f32 v102, v102
  v_rcp_f32 v103, v103
  v_pk_mul_f32 v[224:225], v[224:225], v[100:101]
  v_pk_mul_f32 v[226:227], v[226:227], v[102:103]
  v_cvt_pk_bf16_f32 v108, v224, v225
  v_cvt_pk_bf16_f32 v109, v226, v227
  v_pk_fma_f32 v[100:101], v[56:57], v[90:91], v[84:85] op_sel:[0,0,0] op_sel_hi:[1,0,1] neg_lo:[0,1,0] neg_hi:[0,1,0]
  v_pk_fma_f32 v[102:103], v[58:59], v[90:91], v[86:87] op_sel:[0,0,0] op_sel_hi:[1,0,1] neg_lo:[0,1,0] neg_hi:[0,1,0]
  v_pk_fma_f32 v[228:229], v[228:229], v[90:91], v[100:101] op_sel:[0,1,0] op_sel_hi:[1,1,1]
  v_pk_fma_f32 v[230:231], v[230:231], v[90:91], v[102:103] op_sel:[0,1,0] op_sel_hi:[1,1,1]
  v_pk_mul_f32 v[100:101], v[228:229], v[228:229]
  v_pk_mul_f32 v[102:103], v[230:231], v[230:231]
  v_pk_fma_f32 v[100:101], v[100:101], v[96:97], v[96:97] op_sel:[0,1,0] op_sel_hi:[1,1,0]
  v_pk_fma_f32 v[102:103], v[102:103], v[96:97], v[96:97] op_sel:[0,1,0] op_sel_hi:[1,1,0]
  v_pk_mul_f32 v[100:101], v[100:101], v[228:229]
  v_pk_mul_f32 v[102:103], v[102:103], v[230:231]
  v_exp_f32 v100, v100
  v_exp_f32 v101, v101
  v_exp_f32 v102, v102
  v_exp_f32 v103, v103
  v_pk_add_f32 v[100:101], v[100:101], v[98:99] op_sel_hi:[1,0]
  v_pk_add_f32 v[102:103], v[102:103], v[98:99] op_sel_hi:[1,0]
  v_rcp_f32 v100, v100
  v_rcp_f32 v101, v101
  v_rcp_f32 v102, v102
  v_rcp_f32 v103, v103
  v_pk_mul_f32 v[228:229], v[228:229], v[100:101]
  v_pk_mul_f32 v[230:231], v[230:231], v[102:103]
  v_cvt_pk_bf16_f32 v110, v228, v229
  v_cvt_pk_bf16_f32 v111, v230, v231
  s_mov_b32 s3, 32768
  s_nop 0
  v_permlane16_swap_b32 v108, v110
  v_permlane16_swap_b32 v109, v111
  buffer_store_dwordx4 v[108:111], v13, s[44:47], s3 offen sc1
  v_pk_fma_f32 v[100:101], v[56:57], v[92:93], v[84:85] op_sel:[0,0,0] op_sel_hi:[1,0,1] neg_lo:[0,1,0] neg_hi:[0,1,0]
  v_pk_fma_f32 v[102:103], v[58:59], v[92:93], v[86:87] op_sel:[0,0,0] op_sel_hi:[1,0,1] neg_lo:[0,1,0] neg_hi:[0,1,0]
  v_pk_fma_f32 v[232:233], v[232:233], v[92:93], v[100:101] op_sel:[0,1,0] op_sel_hi:[1,1,1]
  v_pk_fma_f32 v[234:235], v[234:235], v[92:93], v[102:103] op_sel:[0,1,0] op_sel_hi:[1,1,1]
  v_pk_mul_f32 v[100:101], v[232:233], v[232:233]
  v_pk_mul_f32 v[102:103], v[234:235], v[234:235]
  v_pk_fma_f32 v[100:101], v[100:101], v[96:97], v[96:97] op_sel:[0,1,0] op_sel_hi:[1,1,0]
  v_pk_fma_f32 v[102:103], v[102:103], v[96:97], v[96:97] op_sel:[0,1,0] op_sel_hi:[1,1,0]
  v_pk_mul_f32 v[100:101], v[100:101], v[232:233]
  v_pk_mul_f32 v[102:103], v[102:103], v[234:235]
  v_exp_f32 v100, v100
  v_exp_f32 v101, v101
  v_exp_f32 v102, v102
  v_exp_f32 v103, v103
  v_pk_add_f32 v[100:101], v[100:101], v[98:99] op_sel_hi:[1,0]
  v_pk_add_f32 v[102:103], v[102:103], v[98:99] op_sel_hi:[1,0]
  v_rcp_f32 v100, v100
  v_rcp_f32 v101, v101
  v_rcp_f32 v102, v102
  v_rcp_f32 v103, v103
  v_pk_mul_f32 v[232:233], v[232:233], v[100:101]
  v_pk_mul_f32 v[234:235], v[234:235], v[102:103]
  v_cvt_pk_bf16_f32 v112, v232, v233
  v_cvt_pk_bf16_f32 v113, v234, v235
  v_pk_fma_f32 v[100:101], v[56:57], v[94:95], v[84:85] op_sel:[0,0,0] op_sel_hi:[1,0,1] neg_lo:[0,1,0] neg_hi:[0,1,0]
  v_pk_fma_f32 v[102:103], v[58:59], v[94:95], v[86:87] op_sel:[0,0,0] op_sel_hi:[1,0,1] neg_lo:[0,1,0] neg_hi:[0,1,0]
  v_pk_fma_f32 v[236:237], v[236:237], v[94:95], v[100:101] op_sel:[0,1,0] op_sel_hi:[1,1,1]
  v_pk_fma_f32 v[238:239], v[238:239], v[94:95], v[102:103] op_sel:[0,1,0] op_sel_hi:[1,1,1]
  v_pk_mul_f32 v[100:101], v[236:237], v[236:237]
  v_pk_mul_f32 v[102:103], v[238:239], v[238:239]
  v_pk_fma_f32 v[100:101], v[100:101], v[96:97], v[96:97] op_sel:[0,1,0] op_sel_hi:[1,1,0]
  v_pk_fma_f32 v[102:103], v[102:103], v[96:97], v[96:97] op_sel:[0,1,0] op_sel_hi:[1,1,0]
  v_pk_mul_f32 v[100:101], v[100:101], v[236:237]
  v_pk_mul_f32 v[102:103], v[102:103], v[238:239]
  v_exp_f32 v100, v100
  v_exp_f32 v101, v101
  v_exp_f32 v102, v102
  v_exp_f32 v103, v103
  v_pk_add_f32 v[100:101], v[100:101], v[98:99] op_sel_hi:[1,0]
  v_pk_add_f32 v[102:103], v[102:103], v[98:99] op_sel_hi:[1,0]
  v_rcp_f32 v100, v100
  v_rcp_f32 v101, v101
  v_rcp_f32 v102, v102
  v_rcp_f32 v103, v103
  v_pk_mul_f32 v[236:237], v[236:237], v[100:101]
  v_pk_mul_f32 v[238:239], v[238:239], v[102:103]
  v_cvt_pk_bf16_f32 v114, v236, v237
  v_cvt_pk_bf16_f32 v115, v238, v239
  s_mov_b32 s3, 262144
  s_nop 0
  v_permlane16_swap_b32 v112, v114
  v_permlane16_swap_b32 v113, v115
  buffer_store_dwordx4 v[112:115], v13, s[44:47], s3 offen sc1
  v_pk_fma_f32 v[100:101], v[40:41], v[88:89], v[68:69] op_sel:[0,0,0] op_sel_hi:[1,0,1] neg_lo:[0,1,0] neg_hi:[0,1,0]
  v_pk_fma_f32 v[102:103], v[42:43], v[88:89], v[70:71] op_sel:[0,0,0] op_sel_hi:[1,0,1] neg_lo:[0,1,0] neg_hi:[0,1,0]
  v_pk_fma_f32 v[160:161], v[160:161], v[88:89], v[100:101] op_sel:[0,1,0] op_sel_hi:[1,1,1]
  v_pk_fma_f32 v[162:163], v[162:163], v[88:89], v[102:103] op_sel:[0,1,0] op_sel_hi:[1,1,1]
  v_pk_mul_f32 v[100:101], v[160:161], v[160:161]
  v_pk_mul_f32 v[102:103], v[162:163], v[162:163]
  v_pk_fma_f32 v[100:101], v[100:101], v[96:97], v[96:97] op_sel:[0,1,0] op_sel_hi:[1,1,0]
  v_pk_fma_f32 v[102:103], v[102:103], v[96:97], v[96:97] op_sel:[0,1,0] op_sel_hi:[1,1,0]
  v_pk_mul_f32 v[100:101], v[100:101], v[160:161]
  v_pk_mul_f32 v[102:103], v[102:103], v[162:163]
  v_exp_f32 v100, v100
  v_exp_f32 v101, v101
  v_exp_f32 v102, v102
  v_exp_f32 v103, v103
  v_pk_add_f32 v[100:101], v[100:101], v[98:99] op_sel_hi:[1,0]
  v_pk_add_f32 v[102:103], v[102:103], v[98:99] op_sel_hi:[1,0]
  v_rcp_f32 v100, v100
  v_rcp_f32 v101, v101
  v_rcp_f32 v102, v102
  v_rcp_f32 v103, v103
  v_pk_mul_f32 v[160:161], v[160:161], v[100:101]
  v_pk_mul_f32 v[162:163], v[162:163], v[102:103]
  v_cvt_pk_bf16_f32 v116, v160, v161
  v_cvt_pk_bf16_f32 v117, v162, v163
  v_pk_fma_f32 v[104:105], v[44:45], v[88:89], v[72:73] op_sel:[0,0,0] op_sel_hi:[1,0,1] neg_lo:[0,1,0] neg_hi:[0,1,0]
  v_pk_fma_f32 v[106:107], v[46:47], v[88:89], v[74:75] op_sel:[0,0,0] op_sel_hi:[1,0,1] neg_lo:[0,1,0] neg_hi:[0,1,0]
  v_pk_fma_f32 v[176:177], v[176:177], v[88:89], v[104:105] op_sel:[0,1,0] op_sel_hi:[1,1,1]
  v_pk_fma_f32 v[178:179], v[178:179], v[88:89], v[106:107] op_sel:[0,1,0] op_sel_hi:[1,1,1]
  v_pk_mul_f32 v[104:105], v[176:177], v[176:177]
  v_pk_mul_f32 v[106:107], v[178:179], v[178:179]
  v_pk_fma_f32 v[104:105], v[104:105], v[96:97], v[96:97] op_sel:[0,1,0] op_sel_hi:[1,1,0]
  v_pk_fma_f32 v[106:107], v[106:107], v[96:97], v[96:97] op_sel:[0,1,0] op_sel_hi:[1,1,0]
  v_pk_mul_f32 v[104:105], v[104:105], v[176:177]
  v_pk_mul_f32 v[106:107], v[106:107], v[178:179]
  v_exp_f32 v104, v104
  v_exp_f32 v105, v105
  v_exp_f32 v106, v106
  v_exp_f32 v107, v107
  v_pk_add_f32 v[104:105], v[104:105], v[98:99] op_sel_hi:[1,0]
  v_pk_add_f32 v[106:107], v[106:107], v[98:99] op_sel_hi:[1,0]
  v_rcp_f32 v104, v104
  v_rcp_f32 v105, v105
  v_rcp_f32 v106, v106
  v_rcp_f32 v107, v107
  v_pk_mul_f32 v[176:177], v[176:177], v[104:105]
  v_pk_mul_f32 v[178:179], v[178:179], v[106:107]
  v_cvt_pk_bf16_f32 v118, v176, v177
  v_cvt_pk_bf16_f32 v119, v178, v179
  s_add_u32 s3, s10, 49152
  buffer_store_dwordx4 v[116:119], v12, s[44:47], s3 offen sc1
  ds_write_b128 v18, v[116:119] offset:0
  v_pk_fma_f32 v[100:101], v[40:41], v[90:91], v[68:69] op_sel:[0,0,0] op_sel_hi:[1,0,1] neg_lo:[0,1,0] neg_hi:[0,1,0]
  v_pk_fma_f32 v[102:103], v[42:43], v[90:91], v[70:71] op_sel:[0,0,0] op_sel_hi:[1,0,1] neg_lo:[0,1,0] neg_hi:[0,1,0]
  v_pk_fma_f32 v[164:165], v[164:165], v[90:91], v[100:101] op_sel:[0,1,0] op_sel_hi:[1,1,1]
  v_pk_fma_f32 v[166:167], v[166:167], v[90:91], v[102:103] op_sel:[0,1,0] op_sel_hi:[1,1,1]
  v_pk_mul_f32 v[100:101], v[164:165], v[164:165]
  v_pk_mul_f32 v[102:103], v[166:167], v[166:167]
  v_pk_fma_f32 v[100:101], v[100:101], v[96:97], v[96:97] op_sel:[0,1,0] op_sel_hi:[1,1,0]
  v_pk_fma_f32 v[102:103], v[102:103], v[96:97], v[96:97] op_sel:[0,1,0] op_sel_hi:[1,1,0]
  v_pk_mul_f32 v[100:101], v[100:101], v[164:165]
  v_pk_mul_f32 v[102:103], v[102:103], v[166:167]
  v_exp_f32 v100, v100
  v_exp_f32 v101, v101
  v_exp_f32 v102, v102
  v_exp_f32 v103, v103
  v_pk_add_f32 v[100:101], v[100:101], v[98:99] op_sel_hi:[1,0]
  v_pk_add_f32 v[102:103], v[102:103], v[98:99] op_sel_hi:[1,0]
  v_rcp_f32 v100, v100
  v_rcp_f32 v101, v101
  v_rcp_f32 v102, v102
  v_rcp_f32 v103, v103
  v_pk_mul_f32 v[164:165], v[164:165], v[100:101]
  v_pk_mul_f32 v[166:167], v[166:167], v[102:103]
  v_cvt_pk_bf16_f32 v120, v164, v165
  v_cvt_pk_bf16_f32 v121, v166, v167
  v_pk_fma_f32 v[104:105], v[44:45], v[90:91], v[72:73] op_sel:[0,0,0] op_sel_hi:[1,0,1] neg_lo:[0,1,0] neg_hi:[0,1,0]
  v_pk_fma_f32 v[106:107], v[46:47], v[90:91], v[74:75] op_sel:[0,0,0] op_sel_hi:[1,0,1] neg_lo:[0,1,0] neg_hi:[0,1,0]
  v_pk_fma_f32 v[180:181], v[180:181], v[90:91], v[104:105] op_sel:[0,1,0] op_sel_hi:[1,1,1]
  v_pk_fma_f32 v[182:183], v[182:183], v[90:91], v[106:107] op_sel:[0,1,0] op_sel_hi:[1,1,1]
  v_pk_mul_f32 v[104:105], v[180:181], v[180:181]
  v_pk_mul_f32 v[106:107], v[182:183], v[182:183]
  v_pk_fma_f32 v[104:105], v[104:105], v[96:97], v[96:97] op_sel:[0,1,0] op_sel_hi:[1,1,0]
  v_pk_fma_f32 v[106:107], v[106:107], v[96:97], v[96:97] op_sel:[0,1,0] op_sel_hi:[1,1,0]
  v_pk_mul_f32 v[104:105], v[104:105], v[180:181]
  v_pk_mul_f32 v[106:107], v[106:107], v[182:183]
  v_exp_f32 v104, v104
  v_exp_f32 v105, v105
  v_exp_f32 v106, v106
  v_exp_f32 v107, v107
  v_pk_add_f32 v[104:105], v[104:105], v[98:99] op_sel_hi:[1,0]
  v_pk_add_f32 v[106:107], v[106:107], v[98:99] op_sel_hi:[1,0]
  v_rcp_f32 v104, v104
  v_rcp_f32 v105, v105
  v_rcp_f32 v106, v106
  v_rcp_f32 v107, v107
  v_pk_mul_f32 v[180:181], v[180:181], v[104:105]
  v_pk_mul_f32 v[182:183], v[182:183], v[106:107]
  v_cvt_pk_bf16_f32 v122, v180, v181
  v_cvt_pk_bf16_f32 v123, v182, v183
  s_add_u32 s3, s10, 163840
  buffer_store_dwordx4 v[120:123], v12, s[44:47], s3 offen sc1
  ds_write_b128 v18, v[120:123] offset:2048
  v_pk_fma_f32 v[100:101], v[40:41], v[92:93], v[68:69] op_sel:[0,0,0] op_sel_hi:[1,0,1] neg_lo:[0,1,0] neg_hi:[0,1,0]
  v_pk_fma_f32 v[102:103], v[42:43], v[92:93], v[70:71] op_sel:[0,0,0] op_sel_hi:[1,0,1] neg_lo:[0,1,0] neg_hi:[0,1,0]
  v_pk_fma_f32 v[168:169], v[168:169], v[92:93], v[100:101] op_sel:[0,1,0] op_sel_hi:[1,1,1]
  v_pk_fma_f32 v[170:171], v[170:171], v[92:93], v[102:103] op_sel:[0,1,0] op_sel_hi:[1,1,1]
  v_pk_mul_f32 v[100:101], v[168:169], v[168:169]
  v_pk_mul_f32 v[102:103], v[170:171], v[170:171]
  v_pk_fma_f32 v[100:101], v[100:101], v[96:97], v[96:97] op_sel:[0,1,0] op_sel_hi:[1,1,0]
  v_pk_fma_f32 v[102:103], v[102:103], v[96:97], v[96:97] op_sel:[0,1,0] op_sel_hi:[1,1,0]
  v_pk_mul_f32 v[100:101], v[100:101], v[168:169]
  v_pk_mul_f32 v[102:103], v[102:103], v[170:171]
  v_exp_f32 v100, v100
  v_exp_f32 v101, v101
  v_exp_f32 v102, v102
  v_exp_f32 v103, v103
  v_pk_add_f32 v[100:101], v[100:101], v[98:99] op_sel_hi:[1,0]
  v_pk_add_f32 v[102:103], v[102:103], v[98:99] op_sel_hi:[1,0]
  v_rcp_f32 v100, v100
  v_rcp_f32 v101, v101
  v_rcp_f32 v102, v102
  v_rcp_f32 v103, v103
  v_pk_mul_f32 v[168:169], v[168:169], v[100:101]
  v_pk_mul_f32 v[170:171], v[170:171], v[102:103]
  v_cvt_pk_bf16_f32 v108, v168, v169
  v_cvt_pk_bf16_f32 v109, v170, v171
  v_pk_fma_f32 v[104:105], v[44:45], v[92:93], v[72:73] op_sel:[0,0,0] op_sel_hi:[1,0,1] neg_lo:[0,1,0] neg_hi:[0,1,0]
  v_pk_fma_f32 v[106:107], v[46:47], v[92:93], v[74:75] op_sel:[0,0,0] op_sel_hi:[1,0,1] neg_lo:[0,1,0] neg_hi:[0,1,0]
  v_pk_fma_f32 v[184:185], v[184:185], v[92:93], v[104:105] op_sel:[0,1,0] op_sel_hi:[1,1,1]
  v_pk_fma_f32 v[186:187], v[186:187], v[92:93], v[106:107] op_sel:[0,1,0] op_sel_hi:[1,1,1]
  v_pk_mul_f32 v[104:105], v[184:185], v[184:185]
  v_pk_mul_f32 v[106:107], v[186:187], v[186:187]
  v_pk_fma_f32 v[104:105], v[104:105], v[96:97], v[96:97] op_sel:[0,1,0] op_sel_hi:[1,1,0]
  v_pk_fma_f32 v[106:107], v[106:107], v[96:97], v[96:97] op_sel:[0,1,0] op_sel_hi:[1,1,0]
  v_pk_mul_f32 v[104:105], v[104:105], v[184:185]
  v_pk_mul_f32 v[106:107], v[106:107], v[186:187]
  v_exp_f32 v104, v104
  v_exp_f32 v105, v105
  v_exp_f32 v106, v106
  v_exp_f32 v107, v107
  v_pk_add_f32 v[104:105], v[104:105], v[98:99] op_sel_hi:[1,0]
  v_pk_add_f32 v[106:107], v[106:107], v[98:99] op_sel_hi:[1,0]
  v_rcp_f32 v104, v104
  v_rcp_f32 v105, v105
  v_rcp_f32 v106, v106
  v_rcp_f32 v107, v107
  v_pk_mul_f32 v[184:185], v[184:185], v[104:105]
  v_pk_mul_f32 v[186:187], v[186:187], v[106:107]
  v_cvt_pk_bf16_f32 v110, v184, v185
  v_cvt_pk_bf16_f32 v111, v186, v187
  s_add_u32 s3, s10, 278528
  buffer_store_dwordx4 v[108:111], v12, s[44:47], s3 offen sc1
  ds_write_b128 v18, v[108:111] offset:4096
  v_pk_fma_f32 v[100:101], v[40:41], v[94:95], v[68:69] op_sel:[0,0,0] op_sel_hi:[1,0,1] neg_lo:[0,1,0] neg_hi:[0,1,0]
  v_pk_fma_f32 v[102:103], v[42:43], v[94:95], v[70:71] op_sel:[0,0,0] op_sel_hi:[1,0,1] neg_lo:[0,1,0] neg_hi:[0,1,0]
  v_pk_fma_f32 v[172:173], v[172:173], v[94:95], v[100:101] op_sel:[0,1,0] op_sel_hi:[1,1,1]
  v_pk_fma_f32 v[174:175], v[174:175], v[94:95], v[102:103] op_sel:[0,1,0] op_sel_hi:[1,1,1]
  v_pk_mul_f32 v[100:101], v[172:173], v[172:173]
  v_pk_mul_f32 v[102:103], v[174:175], v[174:175]
  v_pk_fma_f32 v[100:101], v[100:101], v[96:97], v[96:97] op_sel:[0,1,0] op_sel_hi:[1,1,0]
  v_pk_fma_f32 v[102:103], v[102:103], v[96:97], v[96:97] op_sel:[0,1,0] op_sel_hi:[1,1,0]
  v_pk_mul_f32 v[100:101], v[100:101], v[172:173]
  v_pk_mul_f32 v[102:103], v[102:103], v[174:175]
  v_exp_f32 v100, v100
  v_exp_f32 v101, v101
  v_exp_f32 v102, v102
  v_exp_f32 v103, v103
  v_pk_add_f32 v[100:101], v[100:101], v[98:99] op_sel_hi:[1,0]
  v_pk_add_f32 v[102:103], v[102:103], v[98:99] op_sel_hi:[1,0]
  v_rcp_f32 v100, v100
  v_rcp_f32 v101, v101
  v_rcp_f32 v102, v102
  v_rcp_f32 v103, v103
  v_pk_mul_f32 v[172:173], v[172:173], v[100:101]
  v_pk_mul_f32 v[174:175], v[174:175], v[102:103]
  v_cvt_pk_bf16_f32 v112, v172, v173
  v_cvt_pk_bf16_f32 v113, v174, v175
  v_pk_fma_f32 v[104:105], v[44:45], v[94:95], v[72:73] op_sel:[0,0,0] op_sel_hi:[1,0,1] neg_lo:[0,1,0] neg_hi:[0,1,0]
  v_pk_fma_f32 v[106:107], v[46:47], v[94:95], v[74:75] op_sel:[0,0,0] op_sel_hi:[1,0,1] neg_lo:[0,1,0] neg_hi:[0,1,0]
  v_pk_fma_f32 v[188:189], v[188:189], v[94:95], v[104:105] op_sel:[0,1,0] op_sel_hi:[1,1,1]
  v_pk_fma_f32 v[190:191], v[190:191], v[94:95], v[106:107] op_sel:[0,1,0] op_sel_hi:[1,1,1]
  v_pk_mul_f32 v[104:105], v[188:189], v[188:189]
  v_pk_mul_f32 v[106:107], v[190:191], v[190:191]
  v_pk_fma_f32 v[104:105], v[104:105], v[96:97], v[96:97] op_sel:[0,1,0] op_sel_hi:[1,1,0]
  v_pk_fma_f32 v[106:107], v[106:107], v[96:97], v[96:97] op_sel:[0,1,0] op_sel_hi:[1,1,0]
  v_pk_mul_f32 v[104:105], v[104:105], v[188:189]
  v_pk_mul_f32 v[106:107], v[106:107], v[190:191]
  v_exp_f32 v104, v104
  v_exp_f32 v105, v105
  v_exp_f32 v106, v106
  v_exp_f32 v107, v107
  v_pk_add_f32 v[104:105], v[104:105], v[98:99] op_sel_hi:[1,0]
  v_pk_add_f32 v[106:107], v[106:107], v[98:99] op_sel_hi:[1,0]
  v_rcp_f32 v104, v104
  v_rcp_f32 v105, v105
  v_rcp_f32 v106, v106
  v_rcp_f32 v107, v107
  v_pk_mul_f32 v[188:189], v[188:189], v[104:105]
  v_pk_mul_f32 v[190:191], v[190:191], v[106:107]
  v_cvt_pk_bf16_f32 v114, v188, v189
  v_cvt_pk_bf16_f32 v115, v190, v191
  s_add_u32 s3, s10, 393216
  buffer_store_dwordx4 v[112:115], v12, s[44:47], s3 offen sc1
  ds_write_b128 v18, v[112:115] offset:6144
  v_pk_fma_f32 v[100:101], v[48:49], v[88:89], v[76:77] op_sel:[0,0,0] op_sel_hi:[1,0,1] neg_lo:[0,1,0] neg_hi:[0,1,0]
  v_pk_fma_f32 v[102:103], v[50:51], v[88:89], v[78:79] op_sel:[0,0,0] op_sel_hi:[1,0,1] neg_lo:[0,1,0] neg_hi:[0,1,0]
  v_pk_fma_f32 v[192:193], v[192:193], v[88:89], v[100:101] op_sel:[0,1,0] op_sel_hi:[1,1,1]
  v_pk_fma_f32 v[194:195], v[194:195], v[88:89], v[102:103] op_sel:[0,1,0] op_sel_hi:[1,1,1]
  v_pk_mul_f32 v[100:101], v[192:193], v[192:193]
  v_pk_mul_f32 v[102:103], v[194:195], v[194:195]
  v_pk_fma_f32 v[100:101], v[100:101], v[96:97], v[96:97] op_sel:[0,1,0] op_sel_hi:[1,1,0]
  v_pk_fma_f32 v[102:103], v[102:103], v[96:97], v[96:97] op_sel:[0,1,0] op_sel_hi:[1,1,0]
  v_pk_mul_f32 v[100:101], v[100:101], v[192:193]
  v_pk_mul_f32 v[102:103], v[102:103], v[194:195]
  v_exp_f32 v100, v100
  v_exp_f32 v101, v101
  v_exp_f32 v102, v102
  v_exp_f32 v103, v103
  v_pk_add_f32 v[100:101], v[100:101], v[98:99] op_sel_hi:[1,0]
  v_pk_add_f32 v[102:103], v[102:103], v[98:99] op_sel_hi:[1,0]
  v_rcp_f32 v100, v100
  v_rcp_f32 v101, v101
  v_rcp_f32 v102, v102
  v_rcp_f32 v103, v103
  v_pk_mul_f32 v[192:193], v[192:193], v[100:101]
  v_pk_mul_f32 v[194:195], v[194:195], v[102:103]
  v_cvt_pk_bf16_f32 v116, v192, v193
  v_cvt_pk_bf16_f32 v117, v194, v195
  v_pk_fma_f32 v[104:105], v[52:53], v[88:89], v[80:81] op_sel:[0,0,0] op_sel_hi:[1,0,1] neg_lo:[0,1,0] neg_hi:[0,1,0]
  v_pk_fma_f32 v[106:107], v[54:55], v[88:89], v[82:83] op_sel:[0,0,0] op_sel_hi:[1,0,1] neg_lo:[0,1,0] neg_hi:[0,1,0]
  v_pk_fma_f32 v[208:209], v[208:209], v[88:89], v[104:105] op_sel:[0,1,0] op_sel_hi:[1,1,1]
  v_pk_fma_f32 v[210:211], v[210:211], v[88:89], v[106:107] op_sel:[0,1,0] op_sel_hi:[1,1,1]
  v_pk_mul_f32 v[104:105], v[208:209], v[208:209]
  v_pk_mul_f32 v[106:107], v[210:211], v[210:211]
  v_pk_fma_f32 v[104:105], v[104:105], v[96:97], v[96:97] op_sel:[0,1,0] op_sel_hi:[1,1,0]
  v_pk_fma_f32 v[106:107], v[106:107], v[96:97], v[96:97] op_sel:[0,1,0] op_sel_hi:[1,1,0]
  v_pk_mul_f32 v[104:105], v[104:105], v[208:209]
  v_pk_mul_f32 v[106:107], v[106:107], v[210:211]
  v_exp_f32 v104, v104
  v_exp_f32 v105, v105
  v_exp_f32 v106, v106
  v_exp_f32 v107, v107
  v_pk_add_f32 v[104:105], v[104:105], v[98:99] op_sel_hi:[1,0]
  v_pk_add_f32 v[106:107], v[106:107], v[98:99] op_sel_hi:[1,0]
  v_rcp_f32 v104, v104
  v_rcp_f32 v105, v105
  v_rcp_f32 v106, v106
  v_rcp_f32 v107, v107
  v_pk_mul_f32 v[208:209], v[208:209], v[104:105]
  v_pk_mul_f32 v[210:211], v[210:211], v[106:107]
  v_cvt_pk_bf16_f32 v118, v208, v209
  v_cvt_pk_bf16_f32 v119, v210, v211
  s_add_u32 s3, s10, 51200
  buffer_store_dwordx4 v[116:119], v12, s[44:47], s3 offen
  ds_write_b128 v18, v[116:119] offset:16384
  v_pk_fma_f32 v[100:101], v[48:49], v[90:91], v[76:77] op_sel:[0,0,0] op_sel_hi:[1,0,1] neg_lo:[0,1,0] neg_hi:[0,1,0]
  v_pk_fma_f32 v[102:103], v[50:51], v[90:91], v[78:79] op_sel:[0,0,0] op_sel_hi:[1,0,1] neg_lo:[0,1,0] neg_hi:[0,1,0]
  v_pk_fma_f32 v[196:197], v[196:197], v[90:91], v[100:101] op_sel:[0,1,0] op_sel_hi:[1,1,1]
  v_pk_fma_f32 v[198:199], v[198:199], v[90:91], v[102:103] op_sel:[0,1,0] op_sel_hi:[1,1,1]
  v_pk_mul_f32 v[100:101], v[196:197], v[196:197]
  v_pk_mul_f32 v[102:103], v[198:199], v[198:199]
  v_pk_fma_f32 v[100:101], v[100:101], v[96:97], v[96:97] op_sel:[0,1,0] op_sel_hi:[1,1,0]
  v_pk_fma_f32 v[102:103], v[102:103], v[96:97], v[96:97] op_sel:[0,1,0] op_sel_hi:[1,1,0]
  v_pk_mul_f32 v[100:101], v[100:101], v[196:197]
  v_pk_mul_f32 v[102:103], v[102:103], v[198:199]
  v_exp_f32 v100, v100
  v_exp_f32 v101, v101
  v_exp_f32 v102, v102
  v_exp_f32 v103, v103
  v_pk_add_f32 v[100:101], v[100:101], v[98:99] op_sel_hi:[1,0]
  v_pk_add_f32 v[102:103], v[102:103], v[98:99] op_sel_hi:[1,0]
  v_rcp_f32 v100, v100
  v_rcp_f32 v101, v101
  v_rcp_f32 v102, v102
  v_rcp_f32 v103, v103
  v_pk_mul_f32 v[196:197], v[196:197], v[100:101]
  v_pk_mul_f32 v[198:199], v[198:199], v[102:103]
  v_cvt_pk_bf16_f32 v120, v196, v197
  v_cvt_pk_bf16_f32 v121, v198, v199
  v_pk_fma_f32 v[104:105], v[52:53], v[90:91], v[80:81] op_sel:[0,0,0] op_sel_hi:[1,0,1] neg_lo:[0,1,0] neg_hi:[0,1,0]
  v_pk_fma_f32 v[106:107], v[54:55], v[90:91], v[82:83] op_sel:[0,0,0] op_sel_hi:[1,0,1] neg_lo:[0,1,0] neg_hi:[0,1,0]
  v_pk_fma_f32 v[212:213], v[212:213], v[90:91], v[104:105] op_sel:[0,1,0] op_sel_hi:[1,1,1]
  v_pk_fma_f32 v[214:215], v[214:215], v[90:91], v[106:107] op_sel:[0,1,0] op_sel_hi:[1,1,1]
  v_pk_mul_f32 v[104:105], v[212:213], v[212:213]
  v_pk_mul_f32 v[106:107], v[214:215], v[214:215]
  v_pk_fma_f32 v[104:105], v[104:105], v[96:97], v[96:97] op_sel:[0,1,0] op_sel_hi:[1,1,0]
  v_pk_fma_f32 v[106:107], v[106:107], v[96:97], v[96:97] op_sel:[0,1,0] op_sel_hi:[1,1,0]
  v_pk_mul_f32 v[104:105], v[104:105], v[212:213]
  v_pk_mul_f32 v[106:107], v[106:107], v[214:215]
  v_exp_f32 v104, v104
  v_exp_f32 v105, v105
  v_exp_f32 v106, v106
  v_exp_f32 v107, v107
  v_pk_add_f32 v[104:105], v[104:105], v[98:99] op_sel_hi:[1,0]
  v_pk_add_f32 v[106:107], v[106:107], v[98:99] op_sel_hi:[1,0]
  v_rcp_f32 v104, v104
  v_rcp_f32 v105, v105
  v_rcp_f32 v106, v106
  v_rcp_f32 v107, v107
  v_pk_mul_f32 v[212:213], v[212:213], v[104:105]
  v_pk_mul_f32 v[214:215], v[214:215], v[106:107]
  v_cvt_pk_bf16_f32 v122, v212, v213
  v_cvt_pk_bf16_f32 v123, v214, v215
  s_add_u32 s3, s10, 165888
  buffer_store_dwordx4 v[120:123], v12, s[44:47], s3 offen
  ds_write_b128 v18, v[120:123] offset:18432
  v_pk_fma_f32 v[100:101], v[48:49], v[92:93], v[76:77] op_sel:[0,0,0] op_sel_hi:[1,0,1] neg_lo:[0,1,0] neg_hi:[0,1,0]
  v_pk_fma_f32 v[102:103], v[50:51], v[92:93], v[78:79] op_sel:[0,0,0] op_sel_hi:[1,0,1] neg_lo:[0,1,0] neg_hi:[0,1,0]
  v_pk_fma_f32 v[200:201], v[200:201], v[92:93], v[100:101] op_sel:[0,1,0] op_sel_hi:[1,1,1]
  v_pk_fma_f32 v[202:203], v[202:203], v[92:93], v[102:103] op_sel:[0,1,0] op_sel_hi:[1,1,1]
  v_pk_mul_f32 v[100:101], v[200:201], v[200:201]
  v_pk_mul_f32 v[102:103], v[202:203], v[202:203]
  v_pk_fma_f32 v[100:101], v[100:101], v[96:97], v[96:97] op_sel:[0,1,0] op_sel_hi:[1,1,0]
  v_pk_fma_f32 v[102:103], v[102:103], v[96:97], v[96:97] op_sel:[0,1,0] op_sel_hi:[1,1,0]
  v_pk_mul_f32 v[100:101], v[100:101], v[200:201]
  v_pk_mul_f32 v[102:103], v[102:103], v[202:203]
  v_exp_f32 v100, v100
  v_exp_f32 v101, v101
  v_exp_f32 v102, v102
  v_exp_f32 v103, v103
  v_pk_add_f32 v[100:101], v[100:101], v[98:99] op_sel_hi:[1,0]
  v_pk_add_f32 v[102:103], v[102:103], v[98:99] op_sel_hi:[1,0]
  v_rcp_f32 v100, v100
  v_rcp_f32 v101, v101
  v_rcp_f32 v102, v102
  v_rcp_f32 v103, v103
  v_pk_mul_f32 v[200:201], v[200:201], v[100:101]
  v_pk_mul_f32 v[202:203], v[202:203], v[102:103]
  v_cvt_pk_bf16_f32 v108, v200, v201
  v_cvt_pk_bf16_f32 v109, v202, v203
  v_pk_fma_f32 v[104:105], v[52:53], v[92:93], v[80:81] op_sel:[0,0,0] op_sel_hi:[1,0,1] neg_lo:[0,1,0] neg_hi:[0,1,0]
  v_pk_fma_f32 v[106:107], v[54:55], v[92:93], v[82:83] op_sel:[0,0,0] op_sel_hi:[1,0,1] neg_lo:[0,1,0] neg_hi:[0,1,0]
  v_pk_fma_f32 v[216:217], v[216:217], v[92:93], v[104:105] op_sel:[0,1,0] op_sel_hi:[1,1,1]
  v_pk_fma_f32 v[218:219], v[218:219], v[92:93], v[106:107] op_sel:[0,1,0] op_sel_hi:[1,1,1]
  v_pk_mul_f32 v[104:105], v[216:217], v[216:217]
  v_pk_mul_f32 v[106:107], v[218:219], v[218:219]
  v_pk_fma_f32 v[104:105], v[104:105], v[96:97], v[96:97] op_sel:[0,1,0] op_sel_hi:[1,1,0]
  v_pk_fma_f32 v[106:107], v[106:107], v[96:97], v[96:97] op_sel:[0,1,0] op_sel_hi:[1,1,0]
  v_pk_mul_f32 v[104:105], v[104:105], v[216:217]
  v_pk_mul_f32 v[106:107], v[106:107], v[218:219]
  v_exp_f32 v104, v104
  v_exp_f32 v105, v105
  v_exp_f32 v106, v106
  v_exp_f32 v107, v107
  v_pk_add_f32 v[104:105], v[104:105], v[98:99] op_sel_hi:[1,0]
  v_pk_add_f32 v[106:107], v[106:107], v[98:99] op_sel_hi:[1,0]
  v_rcp_f32 v104, v104
  v_rcp_f32 v105, v105
  v_rcp_f32 v106, v106
  v_rcp_f32 v107, v107
  v_pk_mul_f32 v[216:217], v[216:217], v[104:105]
  v_pk_mul_f32 v[218:219], v[218:219], v[106:107]
  v_cvt_pk_bf16_f32 v110, v216, v217
  v_cvt_pk_bf16_f32 v111, v218, v219
  s_add_u32 s3, s10, 280576
  buffer_store_dwordx4 v[108:111], v12, s[44:47], s3 offen
  ds_write_b128 v18, v[108:111] offset:20480
  v_pk_fma_f32 v[100:101], v[48:49], v[94:95], v[76:77] op_sel:[0,0,0] op_sel_hi:[1,0,1] neg_lo:[0,1,0] neg_hi:[0,1,0]
  v_pk_fma_f32 v[102:103], v[50:51], v[94:95], v[78:79] op_sel:[0,0,0] op_sel_hi:[1,0,1] neg_lo:[0,1,0] neg_hi:[0,1,0]
  v_pk_fma_f32 v[204:205], v[204:205], v[94:95], v[100:101] op_sel:[0,1,0] op_sel_hi:[1,1,1]
  v_pk_fma_f32 v[206:207], v[206:207], v[94:95], v[102:103] op_sel:[0,1,0] op_sel_hi:[1,1,1]
  v_pk_mul_f32 v[100:101], v[204:205], v[204:205]
  v_pk_mul_f32 v[102:103], v[206:207], v[206:207]
  v_pk_fma_f32 v[100:101], v[100:101], v[96:97], v[96:97] op_sel:[0,1,0] op_sel_hi:[1,1,0]
  v_pk_fma_f32 v[102:103], v[102:103], v[96:97], v[96:97] op_sel:[0,1,0] op_sel_hi:[1,1,0]
  v_pk_mul_f32 v[100:101], v[100:101], v[204:205]
  v_pk_mul_f32 v[102:103], v[102:103], v[206:207]
  v_exp_f32 v100, v100
  v_exp_f32 v101, v101
  v_exp_f32 v102, v102
  v_exp_f32 v103, v103
  v_pk_add_f32 v[100:101], v[100:101], v[98:99] op_sel_hi:[1,0]
  v_pk_add_f32 v[102:103], v[102:103], v[98:99] op_sel_hi:[1,0]
  v_rcp_f32 v100, v100
  v_rcp_f32 v101, v101
  v_rcp_f32 v102, v102
  v_rcp_f32 v103, v103
  v_pk_mul_f32 v[204:205], v[204:205], v[100:101]
  v_pk_mul_f32 v[206:207], v[206:207], v[102:103]
  v_cvt_pk_bf16_f32 v112, v204, v205
  v_cvt_pk_bf16_f32 v113, v206, v207
  v_pk_fma_f32 v[104:105], v[52:53], v[94:95], v[80:81] op_sel:[0,0,0] op_sel_hi:[1,0,1] neg_lo:[0,1,0] neg_hi:[0,1,0]
  v_pk_fma_f32 v[106:107], v[54:55], v[94:95], v[82:83] op_sel:[0,0,0] op_sel_hi:[1,0,1] neg_lo:[0,1,0] neg_hi:[0,1,0]
  v_pk_fma_f32 v[220:221], v[220:221], v[94:95], v[104:105] op_sel:[0,1,0] op_sel_hi:[1,1,1]
  v_pk_fma_f32 v[222:223], v[222:223], v[94:95], v[106:107] op_sel:[0,1,0] op_sel_hi:[1,1,1]
  v_pk_mul_f32 v[104:105], v[220:221], v[220:221]
  v_pk_mul_f32 v[106:107], v[222:223], v[222:223]
  v_pk_fma_f32 v[104:105], v[104:105], v[96:97], v[96:97] op_sel:[0,1,0] op_sel_hi:[1,1,0]
  v_pk_fma_f32 v[106:107], v[106:107], v[96:97], v[96:97] op_sel:[0,1,0] op_sel_hi:[1,1,0]
  v_pk_mul_f32 v[104:105], v[104:105], v[220:221]
  v_pk_mul_f32 v[106:107], v[106:107], v[222:223]
  v_exp_f32 v104, v104
  v_exp_f32 v105, v105
  v_exp_f32 v106, v106
  v_exp_f32 v107, v107
  v_pk_add_f32 v[104:105], v[104:105], v[98:99] op_sel_hi:[1,0]
  v_pk_add_f32 v[106:107], v[106:107], v[98:99] op_sel_hi:[1,0]
  v_rcp_f32 v104, v104
  v_rcp_f32 v105, v105
  v_rcp_f32 v106, v106
  v_rcp_f32 v107, v107
  v_pk_mul_f32 v[220:221], v[220:221], v[104:105]
  v_pk_mul_f32 v[222:223], v[222:223], v[106:107]
  v_cvt_pk_bf16_f32 v114, v220, v221
  v_cvt_pk_bf16_f32 v115, v222, v223
  s_add_u32 s3, s10, 395264
  buffer_store_dwordx4 v[112:115], v12, s[44:47], s3 offen
  ds_write_b128 v18, v[112:115] offset:22528
  v_add_u32 v2, 114688, v27
  v_mov_b32 v6, v8
  v_xor_b32 v7, 32, v8
  v_xor_b32 v9, 96, v8
  v_xor_b32 v8, 64, v8
  s_waitcnt vmcnt(14)
  v_lshlrev_b32 v216, 16, v10
  v_and_b32 v217, s11, v10
  v_lshlrev_b32 v218, 16, v11
  v_and_b32 v219, s11, v11
  v_lshlrev_b32 v96, 16, v240
  v_and_b32 v97, s11, v240
  v_pk_add_f32 v[96:97], v[96:97], v[216:217]
  v_lshlrev_b32 v98, 16, v241
  v_and_b32 v99, s11, v241
  v_pk_add_f32 v[98:99], v[98:99], v[218:219]
  v_lshlrev_b32 v100, 16, v248
  v_and_b32 v101, s11, v248
  v_pk_add_f32 v[100:101], v[100:101], v[216:217]
  v_lshlrev_b32 v102, 16, v249
  v_and_b32 v103, s11, v249
  v_pk_add_f32 v[102:103], v[102:103], v[218:219]
  v_lshlrev_b32 v216, 16, v24
  v_and_b32 v217, s11, v24
  v_lshlrev_b32 v218, 16, v25
  v_and_b32 v219, s11, v25
  v_lshlrev_b32 v104, 16, v242
  v_and_b32 v105, s11, v242
  v_pk_add_f32 v[104:105], v[104:105], v[216:217]
  v_lshlrev_b32 v106, 16, v243
  v_and_b32 v107, s11, v243
  v_pk_add_f32 v[106:107], v[106:107], v[218:219]
  v_lshlrev_b32 v108, 16, v250
  v_and_b32 v109, s11, v250
  v_pk_add_f32 v[108:109], v[108:109], v[216:217]
  v_lshlrev_b32 v110, 16, v251
  v_and_b32 v111, s11, v251
  v_pk_add_f32 v[110:111], v[110:111], v[218:219]
  v_lshlrev_b32 v216, 16, v124
  v_and_b32 v217, s11, v124
  v_lshlrev_b32 v218, 16, v125
  v_and_b32 v219, s11, v125
  v_lshlrev_b32 v112, 16, v244
  v_and_b32 v113, s11, v244
  v_pk_add_f32 v[112:113], v[112:113], v[216:217]
  v_lshlrev_b32 v114, 16, v245
  v_and_b32 v115, s11, v245
  v_pk_add_f32 v[114:115], v[114:115], v[218:219]
  v_lshlrev_b32 v116, 16, v252
  v_and_b32 v117, s11, v252
  v_pk_add_f32 v[116:117], v[116:117], v[216:217]
  v_lshlrev_b32 v118, 16, v253
  v_and_b32 v119, s11, v253
  v_pk_add_f32 v[118:119], v[118:119], v[218:219]
  v_lshlrev_b32 v216, 16, v126
  v_and_b32 v217, s11, v126
  v_lshlrev_b32 v218, 16, v127
  v_and_b32 v219, s11, v127
  v_lshlrev_b32 v120, 16, v246
  v_and_b32 v121, s11, v246
  v_pk_add_f32 v[120:121], v[120:121], v[216:217]
  v_lshlrev_b32 v122, 16, v247
  v_and_b32 v123, s11, v247
  v_pk_add_f32 v[122:123], v[122:123], v[218:219]
  v_lshlrev_b32 v124, 16, v254
  v_and_b32 v125, s11, v254
  v_pk_add_f32 v[124:125], v[124:125], v[216:217]
  v_lshlrev_b32 v126, 16, v255
  v_and_b32 v127, s11, v255
  v_pk_add_f32 v[126:127], v[126:127], v[218:219]
  s_waitcnt vmcnt(0) lgkmcnt(0)
  s_barrier
  s_add_u32 s97, s97, 1
  s_branch L_w2_compute
L_w1_c1:
L_w2_c0:
L_w2_body:
  s_cmp_ge_u32 s2, 256
  s_cbranch_scc1 L_w2_end
  v_lshrrev_b32 v2, 6, v0
  v_and_b32 v1, 63, v0
  v_readfirstlane_b32 s70, v2
  s_and_b32 s3, s2, 7
  s_lshr_b32 s99, s2, 3
  s_and_b32 s5, s3, 3
  s_lshl_b32 s5, s5, 2
  s_and_b32 s6, s99, 3
  s_add_u32 s68, s5, s6
  s_lshr_b32 s5, s3, 2
  s_lshr_b32 s78, s99, 2
  s_lshl1_add_u32 s69, s78, s5
  s_add_u32 s3, s68, s78
  s_lshl_b32 s3, s3, 3
  s_lshl_b32 s85, 0xffff02, s3
  s_sub_u32 s3, 0, s3
  s_lshr_b32 s3, 0xffff02, s3
  s_or_b32 s85, s85, s3
L_w2_loader:
  s_add_u32 s3, s68, s78
  s_and_b32 s3, s3, 3
  s_mov_b32 s4, 0x1616160
  s_cmp_eq_u32 s3, 1
  s_cselect_b32 s4, 0x5858580, s4
  s_cmp_eq_u32 s3, 2
  s_cselect_b32 s4, 0x16161600, s4
  s_cmp_eq_u32 s3, 3
  s_cselect_b32 s4, 0x58585800, s4
  v_subrev_u32 v2, 3, v1
  v_min_u32 v2, 16, v2
  v_lshlrev_b32 v3, 1, v2
  v_bfe_i32 v16, s4, v3, 2
  v_sub_u32 v16, v1, v16
  v_subrev_u32 v16, 7, v16
  v_ashrrev_i32 v3, 1, v16
  v_cmp_eq_u32 vcc, s78, v3
  s_and_b32 s3, s69, 1
  v_or_b32 v2, 14, v16
  v_cndmask_b32 v2, v16, v2, vcc
  v_cmp_gt_i32 vcc, 0, v16
  s_lshl2_add_u32 s4, s3, 20
  v_add_u32 v16, s4, v16
  s_lshl4_add_u32 s4, s3, 24
  v_add_u32 v2, s4, v2
  v_cndmask_b32 v16, v2, v16, vcc
  s_and_b32 s5, s68, 3
  s_mul_i32 s5, s5, 3
  s_sub_u32 s5, s5, 23
  v_add_u32 v3, s5, v1
  v_subrev_u32 v2, 10, v3
  v_min_u32 v3, v3, v2
  v_subrev_u32 v2, 10, v3
  v_min_u32 v3, v3, v2
  v_cmp_gt_u32 vcc, 23, v1
  s_sub_u32 s5, s3, 46
  v_lshl_add_u32 v2, v1, 1, s5
  v_cndmask_b32 v3, v3, v2, vcc
  s_add_u32 s5, s78, 3
  v_ashrrev_i32 v2, 1, v3
  v_add_u32 v2, s5, v2
  v_and_b32 v2, 7, v2
  v_and_b32 v3, 1, v3
  v_cmp_gt_u32 vcc, 21, v1
  v_lshl_add_u32 v3, v3, 3, v2
  s_lshl1_add_u32 s4, s78, s4
  s_lshl3_add_u32 s3, s3, s78
  v_cndmask_b32 v3, v3, v16, vcc
  v_writelane_b32 v3, s4, 0
  s_add_u32 s4, s4, 1
  v_writelane_b32 v3, s3, 2
  v_writelane_b32 v3, s4, 1
  v_lshlrev_b32 v16, 17, v3
  s_add_u32 s9, s70, s68
  s_and_b32 s9, s9, 3
  s_lshl_b32 s77, s9, 11
  v_and_b32 v10, 7, v1
  v_lshrrev_b32 v3, 3, v1
  s_lshl_b32 s10, s9, 4
  v_add_u32 v3, s10, v3
  v_mul_u32_u24 v3, 2048, v3
  v_lshrrev_b32 v2, 3, v1
  v_and_b32 v2, 6, v2
  v_xor_b32 v2, v2, v10
  s_lshl_b32 s10, s69, 7
  v_add_u32 v3, s10, v3
  v_lshl_add_u32 v8, v2, 4, v3
  v_add_u32 v3, 16384, v3
  v_lshl_add_u32 v9, v2, 4, v3
  s_mov_b32 s40, s28
  s_and_b32 s41, s29, 0xffff
  s_mov_b32 s42, 7340032
  s_mov_b32 s43, 0x00020000
  s_bitcmp1_b32 s69, 0
  s_mov_b32 s76, 128
  s_cselect_b32 s76, -128, s76
  v_readlane_b32 s74, v16, 0
  s_add_u32 m0, s77, 0
  s_add_u32 s4, s74, s76
  buffer_load_dwordx4 v8, s[40:43], s4 offen lds
  s_add_u32 m0, s77, 1024
  s_nop 0
  buffer_load_dwordx4 v9, s[40:43], s4 offen lds
  s_add_u32 m0, s77, 8192
  s_add_u32 s4, s74, 0
  buffer_load_dwordx4 v8, s[40:43], s4 offen lds
  s_add_u32 m0, s77, 9216
  s_nop 0
  buffer_load_dwordx4 v9, s[40:43], s4 offen lds
  v_readlane_b32 s74, v16, 1
  s_add_u32 m0, s77, 16384
  s_add_u32 s4, s74, s76
  buffer_load_dwordx4 v8, s[40:43], s4 offen lds
  s_add_u32 m0, s77, 17408
  s_nop 0
  buffer_load_dwordx4 v9, s[40:43], s4 offen lds
  s_add_u32 m0, s77, 24576
  s_add_u32 s4, s74, 0
  buffer_load_dwordx4 v8, s[40:43], s4 offen lds
  s_add_u32 m0, s77, 25600
  s_nop 0
  buffer_load_dwordx4 v9, s[40:43], s4 offen lds
  v_readlane_b32 s74, v16, 2
  s_add_u32 m0, s77, 32768
  s_add_u32 s4, s74, s76
  buffer_load_dwordx4 v8, s[40:43], s4 offen lds
  s_add_u32 m0, s77, 33792
  s_nop 0
  buffer_load_dwordx4 v9, s[40:43], s4 offen lds
  s_add_u32 m0, s77, 40960
  s_add_u32 s4, s74, 0
  buffer_load_dwordx4 v8, s[40:43], s4 offen lds
  s_add_u32 m0, s77, 41984
  s_nop 0
  buffer_load_dwordx4 v9, s[40:43], s4 offen lds
  v_readlane_b32 s74, v16, 3
  s_add_u32 m0, s77, 49152
  s_add_u32 s4, s74, s76
  buffer_load_dwordx4 v8, s[40:43], s4 offen lds
  s_add_u32 m0, s77, 50176
  s_nop 0
  buffer_load_dwordx4 v9, s[40:43], s4 offen lds
  s_add_u32 m0, s77, 57344
  s_add_u32 s4, s74, 0
  buffer_load_dwordx4 v8, s[40:43], s4 offen lds
  s_add_u32 m0, s77, 58368
  s_nop 0
  buffer_load_dwordx4 v9, s[40:43], s4 offen lds
  v_readlane_b32 s74, v16, 4
  s_add_u32 m0, s77, 65536
  s_add_u32 s4, s74, s76
  buffer_load_dwordx4 v8, s[40:43], s4 offen lds
  s_add_u32 m0, s77, 66560
  s_nop 0
  buffer_load_dwordx4 v9, s[40:43], s4 offen lds
  s_add_u32 m0, s77, 73728
  s_add_u32 s4, s74, 0
  buffer_load_dwordx4 v8, s[40:43], s4 offen lds
  s_add_u32 m0, s77, 74752
  s_nop 0
  buffer_load_dwordx4 v9, s[40:43], s4 offen lds
  s_add_u32 s44, s22, 41943040
  s_addc_u32 s45, s23, 0
  s_and_b32 s45, s45, 0xffff
  s_mov_b32 s46, 524288
  s_mov_b32 s47, 0x00020000
  s_lshl4_add_u32 s3, s97, s68
  s_and_b32 s4, s69, 15
  s_lshl4_add_u32 s3, s3, s4
  s_lshl_b32 s3, s3, 7
  s_sub_u32 s86, s3, 32768
  v_lshlrev_b32 v11, 7, v1
  v_and_b32 v2, 15, v1
  v_lshlrev_b32 v2, 2, v2
  s_cmp_lg_u32 s70, 4
  s_waitcnt vmcnt(14)
  s_cbranch_scc1 L_w2_nofl
  v_readlane_b32 s74, v16, 5
  s_add_u32 m0, s77, 81920
  s_add_u32 s4, s74, s76
  buffer_load_dwordx4 v8, s[40:43], s4 offen lds
  s_add_u32 m0, s77, 82944
  s_nop 0
  buffer_load_dwordx4 v9, s[40:43], s4 offen lds
  s_add_u32 m0, s77, 90112
  s_add_u32 s4, s74, 0
  buffer_load_dwordx4 v8, s[40:43], s4 offen lds
  s_add_u32 m0, s77, 91136
  s_nop 0
  buffer_load_dwordx4 v9, s[40:43], s4 offen lds
  v_readlane_b32 s74, v16, 6
  s_add_u32 m0, s77, 98304
  s_add_u32 s4, s74, s76
  buffer_load_dwordx4 v8, s[40:43], s4 offen lds
  s_add_u32 m0, s77, 99328
  s_nop 0
  buffer_load_dwordx4 v9, s[40:43], s4 offen lds
  v_mov_b32 v3, 1
  s_mov_b32 s79, 0x100000
  s_or_b32 s4, s2, 0xe0
  s_lshl4_add_u32 s4, s4, s96
  s_lshl_b32 s4, s4, 7
  s_lshl2_add_u32 s5, s78, s4
  s_cmp_eq_u32 s92, 0
  s_cselect_b32 s3, s4, s86
  s_cselect_b32 s4, 28, 60
  v_and_b32 v13, s4, v2
  buffer_load_dword v12, v13, s[44:47], s3 offen sc1
  s_setprio 3
  s_barrier
  s_cbranch_scc0 L_w2_wb
L_w2_wbd:
  s_mov_b64 exec, 1
  buffer_store_dword v3, off, s[44:47], s5
  s_mov_b64 exec, -1
L_w2_poll:
  buffer_load_dword v12, v13, s[44:47], s3 offen sc1
  s_sub_u32 s79, s79, 1
  s_cbranch_scc1 L_w2_dep
  s_waitcnt vmcnt(0)
  v_cmp_ne_u32 vcc, 1, v12
  s_cbranch_vccnz L_w2_poll
L_w2_dep:
  s_barrier
  s_setprio 0
  s_mov_b64 exec, 0xffff
  buffer_store_dword v3, v11, s[44:47], s87 offen sc1
  s_mov_b64 exec, -1
  s_branch L_w2_go
L_w2_nofl:
  s_barrier
  v_readlane_b32 s74, v16, 5
  s_add_u32 m0, s77, 81920
  s_add_u32 s4, s74, s76
  buffer_load_dwordx4 v8, s[40:43], s4 offen lds
  s_add_u32 m0, s77, 82944
  s_nop 0
  buffer_load_dwordx4 v9, s[40:43], s4 offen lds
  s_add_u32 m0, s77, 90112
  s_add_u32 s4, s74, 0
  buffer_load_dwordx4 v8, s[40:43], s4 offen lds
  s_add_u32 m0, s77, 91136
  s_nop 0
  buffer_load_dwordx4 v9, s[40:43], s4 offen lds
  v_readlane_b32 s74, v16, 6
  s_add_u32 m0, s77, 98304
  s_add_u32 s4, s74, s76
  buffer_load_dwordx4 v8, s[40:43], s4 offen lds
  s_add_u32 m0, s77, 99328
  s_nop 0
  buffer_load_dwordx4 v9, s[40:43], s4 offen lds
  s_waitcnt vmcnt(8)
  s_barrier
L_w2_go:
  s_add_u32 m0, s77, 106496
  s_add_u32 s4, s74, 0
  buffer_load_dwordx4 v8, s[40:43], s4 offen lds
  s_add_u32 m0, s77, 107520
  s_nop 0
  buffer_load_dwordx4 v9, s[40:43], s4 offen lds
  s_waitcnt vmcnt(4)
  v_readlane_b32 s74, v16, 7
  s_add_u32 m0, s77, 114688
  s_add_u32 s4, s74, s76
  buffer_load_dwordx4 v8, s[40:43], s4 offen lds
  s_add_u32 m0, s77, 115712
  s_nop 0
  buffer_load_dwordx4 v9, s[40:43], s4 offen lds
  s_waitcnt vmcnt(4)
  s_add_u32 m0, s77, 122880
  s_add_u32 s4, s74, 0
  buffer_load_dwordx4 v8, s[40:43], s4 offen lds
  s_add_u32 m0, s77, 123904
  s_nop 0
  buffer_load_dwordx4 v9, s[40:43], s4 offen lds
  s_waitcnt vmcnt(4)
  v_readlane_b32 s74, v16, 8
  s_add_u32 m0, s77, 131072
  s_add_u32 s4, s74, s76
  buffer_load_dwordx4 v8, s[40:43], s4 offen lds
  s_add_u32 m0, s77, 132096
  s_nop 0
  buffer_load_dwordx4 v9, s[40:43], s4 offen lds
  s_waitcnt vmcnt(4)
  s_add_u32 m0, s77, 139264
  s_add_u32 s4, s74, 0
  buffer_load_dwordx4 v8, s[40:43], s4 offen lds
  s_add_u32 m0, s77, 140288
  s_nop 0
  buffer_load_dwordx4 v9, s[40:43], s4 offen lds
  s_waitcnt vmcnt(4)
  v_readlane_b32 s74, v16, 9
  s_add_u32 m0, s77, 147456
  s_add_u32 s4, s74, s76
  buffer_load_dwordx4 v8, s[40:43], s4 offen lds
  s_add_u32 m0, s77, 148480
  s_nop 0
  buffer_load_dwordx4 v9, s[40:43], s4 offen lds
  s_waitcnt vmcnt(12)
  s_barrier
  s_add_u32 m0, s77, 155648
  s_add_u32 s4, s74, 0
  buffer_load_dwordx4 v8, s[40:43], s4 offen lds
  s_add_u32 m0, s77, 156672
  s_nop 0
  buffer_load_dwordx4 v9, s[40:43], s4 offen lds
  s_waitcnt vmcnt(4)
  v_readlane_b32 s74, v16, 10
  s_add_u32 m0, s77, 0
  s_add_u32 s4, s74, s76
  buffer_load_dwordx4 v8, s[40:43], s4 offen lds
  s_add_u32 m0, s77, 1024
  s_nop 0
  buffer_load_dwordx4 v9, s[40:43], s4 offen lds
  s_waitcnt vmcnt(4)
  s_add_u32 m0, s77, 8192
  s_add_u32 s4, s74, 0
  buffer_load_dwordx4 v8, s[40:43], s4 offen lds
  s_add_u32 m0, s77, 9216
  s_nop 0
  buffer_load_dwordx4 v9, s[40:43], s4 offen lds
  s_waitcnt vmcnt(4)
  v_readlane_b32 s74, v16, 11
  s_add_u32 m0, s77, 16384
  s_add_u32 s4, s74, s76
  buffer_load_dwordx4 v8, s[40:43], s4 offen lds
  s_add_u32 m0, s77, 17408
  s_nop 0
  buffer_load_dwordx4 v9, s[40:43], s4 offen lds
  s_waitcnt vmcnt(12)
  s_barrier
  s_add_u32 m0, s77, 24576
  s_add_u32 s4, s74, 0
  buffer_load_dwordx4 v8, s[40:43], s4 offen lds
  s_add_u32 m0, s77, 25600
  s_nop 0
  buffer_load_dwordx4 v9, s[40:43], s4 offen lds
  s_waitcnt vmcnt(4)
  v_readlane_b32 s74, v16, 12
  s_add_u32 m0, s77, 32768
  s_add_u32 s4, s74, s76
  buffer_load_dwordx4 v8, s[40:43], s4 offen lds
  s_add_u32 m0, s77, 33792
  s_nop 0
  buffer_load_dwordx4 v9, s[40:43], s4 offen lds
  s_waitcnt vmcnt(4)
  s_add_u32 m0, s77, 40960
  s_add_u32 s4, s74, 0
  buffer_load_dwordx4 v8, s[40:43], s4 offen lds
  s_add_u32 m0, s77, 41984
  s_nop 0
  buffer_load_dwordx4 v9, s[40:43], s4 offen lds
  s_waitcnt vmcnt(4)
  v_readlane_b32 s74, v16, 13
  s_add_u32 m0, s77, 49152
  s_add_u32 s4, s74, s76
  buffer_load_dwordx4 v8, s[40:43], s4 offen lds
  s_add_u32 m0, s77, 50176
  s_nop 0
  buffer_load_dwordx4 v9, s[40:43], s4 offen lds
  s_waitcnt vmcnt(12)
  s_barrier
  s_add_u32 m0, s77, 57344
  s_add_u32 s4, s74, 0
  buffer_load_dwordx4 v8, s[40:43], s4 offen lds
  s_add_u32 m0, s77, 58368
  s_nop 0
  buffer_load_dwordx4 v9, s[40:43], s4 offen lds
  s_waitcnt vmcnt(4)
  v_readlane_b32 s74, v16, 14
  s_add_u32 m0, s77, 65536
  s_add_u32 s4, s74, s76
  buffer_load_dwordx4 v8, s[40:43], s4 offen lds
  s_add_u32 m0, s77, 66560
  s_nop 0
  buffer_load_dwordx4 v9, s[40:43], s4 offen lds
  s_waitcnt vmcnt(4)
  s_add_u32 m0, s77, 73728
  s_add_u32 s4, s74, 0
  buffer_load_dwordx4 v8, s[40:43], s4 offen lds
  s_add_u32 m0, s77, 74752
  s_nop 0
  buffer_load_dwordx4 v9, s[40:43], s4 offen lds
  s_waitcnt vmcnt(4)
  v_readlane_b32 s74, v16, 15
  s_add_u32 m0, s77, 81920
  s_add_u32 s4, s74, s76
  buffer_load_dwordx4 v8, s[40:43], s4 offen lds
  s_add_u32 m0, s77, 82944
  s_nop 0
  buffer_load_dwordx4 v9, s[40:43], s4 offen lds
  s_waitcnt vmcnt(12)
  s_barrier
  s_add_u32 m0, s77, 90112
  s_add_u32 s4, s74, 0
  buffer_load_dwordx4 v8, s[40:43], s4 offen lds
  s_add_u32 m0, s77, 91136
  s_nop 0
  buffer_load_dwordx4 v9, s[40:43], s4 offen lds
  s_waitcnt vmcnt(4)
  v_readlane_b32 s74, v16, 16
  s_add_u32 m0, s77, 98304
  s_add_u32 s4, s74, s76
  buffer_load_dwordx4 v8, s[40:43], s4 offen lds
  s_add_u32 m0, s77, 99328
  s_nop 0
  buffer_load_dwordx4 v9, s[40:43], s4 offen lds
  s_waitcnt vmcnt(4)
  s_add_u32 m0, s77, 106496
  s_add_u32 s4, s74, 0
  buffer_load_dwordx4 v8, s[40:43], s4 offen lds
  s_add_u32 m0, s77, 107520
  s_nop 0
  buffer_load_dwordx4 v9, s[40:43], s4 offen lds
  s_waitcnt vmcnt(4)
  v_readlane_b32 s74, v16, 17
  s_add_u32 m0, s77, 114688
  s_add_u32 s4, s74, s76
  buffer_load_dwordx4 v8, s[40:43], s4 offen lds
  s_add_u32 m0, s77, 115712
  s_nop 0
  buffer_load_dwordx4 v9, s[40:43], s4 offen lds
  s_waitcnt vmcnt(12)
  s_barrier
  v_readlane_b32 s74, v16, 18
  s_add_u32 m0, s77, 122880
  s_add_u32 s4, s74, s76
  buffer_load_dwordx4 v8, s[40:43], s4 offen lds
  s_add_u32 m0, s77, 123904
  s_nop 0
  buffer_load_dwordx4 v9, s[40:43], s4 offen lds
  s_waitcnt vmcnt(4)
  v_readlane_b32 s74, v16, 19
  s_add_u32 m0, s77, 131072
  s_add_u32 s4, s74, s76
  buffer_load_dwordx4 v8, s[40:43], s4 offen lds
  s_add_u32 m0, s77, 132096
  s_nop 0
  buffer_load_dwordx4 v9, s[40:43], s4 offen lds
  s_waitcnt vmcnt(4)
  s_cmp_eq_u32 s70, 4
  s_cselect_b32 s46, s46, 0
  buffer_load_dword v3, v2, s[44:47], s86 offen sc1
  v_readlane_b32 s74, v16, 20
  s_add_u32 m0, s77, 139264
  s_add_u32 s4, s74, s76
  buffer_load_dwordx4 v8, s[40:43], s4 offen lds
  s_add_u32 m0, s77, 140288
  s_nop 0
  buffer_load_dwordx4 v9, s[40:43], s4 offen lds
  s_waitcnt vmcnt(4)
  v_readlane_b32 s74, v16, 21
  s_add_u32 m0, s77, 147456
  s_add_u32 s4, s74, s76
  buffer_load_dwordx4 v8, s[40:43], s4 offen lds
  s_add_u32 m0, s77, 148480
  s_nop 0
  buffer_load_dwordx4 v9, s[40:43], s4 offen lds
  s_mov_b32 s79, 0x100000
  s_cmp_lg_u32 s70, 4
  s_cbranch_scc1 L_w2l_dep
  s_waitcnt vmcnt(4)
  v_cmp_ne_u32 vcc, 1, v3
  s_cbranch_vccz L_w2l_dep
L_w2l_poll:
  buffer_load_dword v3, v2, s[44:47], s86 offen sc1
  s_sub_u32 s79, s79, 1
  s_cbranch_scc1 L_w2l_dep
  s_waitcnt vmcnt(0)
  v_cmp_ne_u32 vcc, 1, v3
  s_cbranch_vccnz L_w2l_poll
L_w2l_dep:
  s_waitcnt vmcnt(13)
  s_barrier
  v_readlane_b32 s74, v16, 22
  s_add_u32 m0, s77, 155648
  s_add_u32 s4, s74, s76
  buffer_load_dwordx4 v8, s[40:43], s4 offen lds
  s_add_u32 m0, s77, 156672
  s_nop 0
  buffer_load_dwordx4 v9, s[40:43], s4 offen lds
  s_waitcnt vmcnt(4)
  v_readlane_b32 s74, v16, 17
  s_add_u32 m0, s77, 0
  s_add_u32 s4, s74, 0
  buffer_load_dwordx4 v8, s[40:43], s4 offen lds
  s_add_u32 m0, s77, 1024
  s_nop 0
  buffer_load_dwordx4 v9, s[40:43], s4 offen lds
  s_waitcnt vmcnt(4)
  v_readlane_b32 s74, v16, 18
  s_add_u32 m0, s77, 8192
  s_add_u32 s4, s74, 0
  buffer_load_dwordx4 v8, s[40:43], s4 offen lds
  s_add_u32 m0, s77, 9216
  s_nop 0
  buffer_load_dwordx4 v9, s[40:43], s4 offen lds
  s_waitcnt vmcnt(4)
  v_readlane_b32 s74, v16, 19
  s_add_u32 m0, s77, 16384
  s_add_u32 s4, s74, 0
  buffer_load_dwordx4 v8, s[40:43], s4 offen lds
  s_add_u32 m0, s77, 17408
  s_nop 0
  buffer_load_dwordx4 v9, s[40:43], s4 offen lds
  s_waitcnt vmcnt(13)
  s_barrier
  v_readlane_b32 s74, v16, 20
  s_add_u32 m0, s77, 24576
  s_add_u32 s4, s74, 0
  buffer_load_dwordx4 v8, s[40:43], s4 offen lds
  s_add_u32 m0, s77, 25600
  s_nop 0
  buffer_load_dwordx4 v9, s[40:43], s4 offen lds
  s_waitcnt vmcnt(30)
  v_readlane_b32 s74, v16, 21
  s_add_u32 m0, s77, 32768
  s_add_u32 s4, s74, 0
  buffer_load_dwordx4 v8, s[40:43], s4 offen lds
  s_add_u32 m0, s77, 33792
  s_nop 0
  buffer_load_dwordx4 v9, s[40:43], s4 offen lds
  s_waitcnt vmcnt(30)
  v_readlane_b32 s74, v16, 22
  s_add_u32 m0, s77, 40960
  s_add_u32 s4, s74, 0
  buffer_load_dwordx4 v8, s[40:43], s4 offen lds
  s_add_u32 m0, s77, 41984
  s_nop 0
  buffer_load_dwordx4 v9, s[40:43], s4 offen lds
  s_waitcnt vmcnt(30)
  v_readlane_b32 s74, v16, 23
  s_add_u32 m0, s77, 49152
  s_add_u32 s4, s74, 0
  buffer_load_dwordx4 v8, s[40:43], s4 offen lds
  s_add_u32 m0, s77, 50176
  s_nop 0
  buffer_load_dwordx4 v9, s[40:43], s4 offen lds
  s_waitcnt vmcnt(30)
  v_readlane_b32 s74, v16, 24
  s_add_u32 m0, s77, 57344
  s_add_u32 s4, s74, 0
  buffer_load_dwordx4 v8, s[40:43], s4 offen lds
  s_add_u32 m0, s77, 58368
  s_nop 0
  buffer_load_dwordx4 v9, s[40:43], s4 offen lds
  s_waitcnt vmcnt(30)
  v_readlane_b32 s74, v16, 25
  s_add_u32 m0, s77, 65536
  s_add_u32 s4, s74, 0
  buffer_load_dwordx4 v8, s[40:43], s4 offen lds
  s_add_u32 m0, s77, 66560
  s_nop 0
  buffer_load_dwordx4 v9, s[40:43], s4 offen lds
  s_waitcnt vmcnt(30)
  v_readlane_b32 s74, v16, 26
  s_add_u32 m0, s77, 73728
  s_add_u32 s4, s74, 0
  buffer_load_dwordx4 v8, s[40:43], s4 offen lds
  s_add_u32 m0, s77, 74752
  s_nop 0
  buffer_load_dwordx4 v9, s[40:43], s4 offen lds
  s_waitcnt vmcnt(30)
  v_readlane_b32 s74, v16, 27
  s_add_u32 m0, s77, 81920
  s_add_u32 s4, s74, 0
  buffer_load_dwordx4 v8, s[40:43], s4 offen lds
  s_add_u32 m0, s77, 82944
  s_nop 0
  buffer_load_dwordx4 v9, s[40:43], s4 offen lds
  s_waitcnt vmcnt(30)
  v_readlane_b32 s74, v16, 28
  s_add_u32 m0, s77, 90112
  s_add_u32 s4, s74, 0
  buffer_load_dwordx4 v8, s[40:43], s4 offen lds
  s_add_u32 m0, s77, 91136
  s_nop 0
  buffer_load_dwordx4 v9, s[40:43], s4 offen lds
  s_waitcnt vmcnt(22)
  s_barrier
  v_readlane_b32 s74, v16, 29
  s_add_u32 m0, s77, 98304
  s_add_u32 s4, s74, 0
  buffer_load_dwordx4 v8, s[40:43], s4 offen lds
  s_add_u32 m0, s77, 99328
  s_nop 0
  buffer_load_dwordx4 v9, s[40:43], s4 offen lds
  s_waitcnt vmcnt(30)
  v_readlane_b32 s74, v16, 30
  s_add_u32 m0, s77, 106496
  s_add_u32 s4, s74, 0
  buffer_load_dwordx4 v8, s[40:43], s4 offen lds
  s_add_u32 m0, s77, 107520
  s_nop 0
  buffer_load_dwordx4 v9, s[40:43], s4 offen lds
  s_waitcnt vmcnt(30)
  v_readlane_b32 s74, v16, 31
  s_add_u32 m0, s77, 114688
  s_add_u32 s4, s74, 0
  buffer_load_dwordx4 v8, s[40:43], s4 offen lds
  s_add_u32 m0, s77, 115712
  s_nop 0
  buffer_load_dwordx4 v9, s[40:43], s4 offen lds
  s_waitcnt vmcnt(30)
  v_readlane_b32 s74, v16, 32
  s_add_u32 m0, s77, 122880
  s_add_u32 s4, s74, 0
  buffer_load_dwordx4 v8, s[40:43], s4 offen lds
  s_add_u32 m0, s77, 123904
  s_nop 0
  buffer_load_dwordx4 v9, s[40:43], s4 offen lds
  s_waitcnt vmcnt(22)
  s_barrier
  s_add_u32 s64, s22, 41943040
  s_addc_u32 s65, s23, 0
  s_and_b32 s65, s65, 0xffff
  s_mov_b32 s66, 524288
  s_mov_b32 s67, 0x00020000
  s_lshl4_add_u32 s6, s68, s69
  s_xor_b32 s6, s6, 1
  s_add_u32 s7, s96, 4
  s_lshl_b32 s7, s7, 8
  s_add_u32 s6, s6, s7
  s_lshl_b32 s86, s6, 8
  v_and_b32 v2, 3, v1
  v_lshlrev_b32 v30, 6, v2
  s_mov_b32 s79, 0x100000
  s_waitcnt vmcnt(0)
  s_barrier
  s_cmp_eq_u32 s96, 0
  s_cbranch_scc1 L_w2_zskip
  s_cmp_lg_u32 s70, 4
  s_cbranch_scc1 L_w2_xgo
  s_setprio 3
L_w2_xpoll:
  buffer_load_dword v5, v30, s[64:67], s86 offen sc1
  s_sub_u32 s79, s79, 1
  s_cbranch_scc1 L_w2_xgo
  s_waitcnt vmcnt(0)
  v_cmp_ne_u32 vcc, 1, v5
  s_cbranch_vccnz L_w2_xpoll
L_w2_xgo:
  s_setprio 0
  s_waitcnt vmcnt(0)
  s_barrier
L_w2_zskip:
  s_cmp_eq_u32 s96, 1
  s_cbranch_scc1 L_w2_end
  s_lshl_b32 s87, s97, 15
  s_lshl_b32 s4, s68, 11
  s_add_u32 s87, s87, s4
  s_lshl_b32 s4, s69, 2
  s_add_u32 s87, s87, s4
  s_mov_b32 s96, 1
  s_add_u32 s12, s22, 33554432
  s_addc_u32 s13, s23, 0
  s_add_u32 s34, s22, 67108864
  s_addc_u32 s35, s23, 0
  s_add_u32 s97, s97, 1
  s_branch L_attn_body
L_w2_wb:
  buffer_wbl2 sc1
  s_waitcnt vmcnt(0)
  s_mov_b64 exec, 0xffff
  buffer_store_dword v3, v11, s[44:47], s87 offen sc1
  s_branch L_w2_wbd
L_w2_end:
  s_endpgm
L_w2_compute:
  ds_read_b128 v[32:35], v2 offset:0
  ds_read_b128 v[36:39], v2 offset:2048
  ds_read_b64_tr_b16 v[160:161], v6 offset:0
  ds_read_b64_tr_b16 v[162:163], v6 offset:2048
  ds_read_b64_tr_b16 v[164:165], v7 offset:0
  ds_read_b64_tr_b16 v[166:167], v7 offset:2048
  ds_read_b64_tr_b16 v[168:169], v8 offset:0
  ds_read_b64_tr_b16 v[170:171], v8 offset:2048
  ds_read_b64_tr_b16 v[172:173], v9 offset:0
  ds_read_b64_tr_b16 v[174:175], v9 offset:2048
  ds_read_b128 v[40:43], v2 offset:1024
  ds_read_b128 v[44:47], v2 offset:3072
  ds_read_b64_tr_b16 v[176:177], v6 offset:4096
  ds_read_b64_tr_b16 v[178:179], v6 offset:6144
  ds_read_b64_tr_b16 v[180:181], v7 offset:4096
  ds_read_b64_tr_b16 v[182:183], v7 offset:6144
  ds_read_b64_tr_b16 v[184:185], v8 offset:4096
  ds_read_b64_tr_b16 v[186:187], v8 offset:6144
  ds_read_b64_tr_b16 v[188:189], v9 offset:4096
  ds_read_b64_tr_b16 v[190:191], v9 offset:6144
  ds_read_b128 v[48:51], v2 offset:16384
  ds_read_b128 v[52:55], v2 offset:18432
  ds_read_b128 v[56:59], v2 offset:17408
  ds_read_b128 v[60:63], v2 offset:19456
  ds_read_b128 v[64:67], v2 offset:32768
  ds_read_b128 v[68:71], v2 offset:34816
  ds_read_b128 v[72:75], v2 offset:33792
  ds_read_b128 v[76:79], v2 offset:35840
  s_waitcnt lgkmcnt(15)
  v_mfma_f32_16x16x32_bf16 v[128:131], v[160:163], v[32:35], 0
  ds_read_b64_tr_b16 v[192:193], v6 offset:8192
  v_mov_b32 v4, v26
  v_mfma_f32_16x16x32_bf16 v[132:135], v[160:163], v[36:39], 0
  ds_read_b64_tr_b16 v[194:195], v6 offset:10240
  v_mov_b32 v5, v27
  v_mfma_f32_16x16x32_bf16 v[140:143], v[164:167], v[36:39], 0
  ds_read_b64_tr_b16 v[196:197], v7 offset:8192
  v_mov_b32 v12, v28
  v_mfma_f32_16x16x32_bf16 v[136:139], v[164:167], v[32:35], 0
  ds_read_b64_tr_b16 v[198:199], v7 offset:10240
  v_mov_b32 v18, v29
  v_mfma_f32_16x16x32_bf16 v[144:147], v[168:171], v[32:35], 0
  ds_read_b64_tr_b16 v[200:201], v8 offset:8192
  v_mov_b32 v19, 1
  v_mfma_f32_16x16x32_bf16 v[148:151], v[168:171], v[36:39], 0
  ds_read_b64_tr_b16 v[202:203], v8 offset:10240
  v_add_u32 v20, 65536, v6
  v_mfma_f32_16x16x32_bf16 v[156:159], v[172:175], v[36:39], 0
  ds_read_b64_tr_b16 v[204:205], v9 offset:8192
  v_add_u32 v21, 65536, v7
  v_mfma_f32_16x16x32_bf16 v[152:155], v[172:175], v[32:35], 0
  ds_read_b64_tr_b16 v[206:207], v9 offset:10240
  s_waitcnt lgkmcnt(15)
  v_mfma_f32_16x16x32_bf16 v[128:131], v[176:179], v[40:43], v[128:131]
  ds_read_b64_tr_b16 v[208:209], v6 offset:12288
  v_add_u32 v22, 65536, v8
  v_mfma_f32_16x16x32_bf16 v[132:135], v[176:179], v[44:47], v[132:135]
  ds_read_b64_tr_b16 v[210:211], v6 offset:14336
  v_add_u32 v23, 65536, v9
  v_mfma_f32_16x16x32_bf16 v[140:143], v[180:183], v[44:47], v[140:143]
  ds_read_b64_tr_b16 v[212:213], v7 offset:12288
  v_add_u32 v26, 131072, v6
  v_mfma_f32_16x16x32_bf16 v[136:139], v[180:183], v[40:43], v[136:139]
  ds_read_b64_tr_b16 v[214:215], v7 offset:14336
  v_add_u32 v27, 131072, v7
  v_mfma_f32_16x16x32_bf16 v[144:147], v[184:187], v[40:43], v[144:147]
  ds_read_b64_tr_b16 v[216:217], v8 offset:12288
  v_add_u32 v28, 131072, v8
  v_mfma_f32_16x16x32_bf16 v[148:151], v[184:187], v[44:47], v[148:151]
  ds_read_b64_tr_b16 v[218:219], v8 offset:14336
  v_add_u32 v29, 131072, v9
  v_mfma_f32_16x16x32_bf16 v[156:159], v[188:191], v[44:47], v[156:159]
  ds_read_b64_tr_b16 v[220:221], v9 offset:12288
  s_add_u32 s52, s22, 41943040
  v_mfma_f32_16x16x32_bf16 v[152:155], v[188:191], v[40:43], v[152:155]
  ds_read_b64_tr_b16 v[222:223], v9 offset:14336
  s_waitcnt lgkmcnt(8)
  v_mfma_f32_16x16x32_bf16 v[96:99], v[192:195], v[32:35], v[96:99]
  ds_read_b64_tr_b16 v[160:161], v6 offset:16384
  s_addc_u32 s53, s23, 0
  v_mfma_f32_16x16x32_bf16 v[100:103], v[192:195], v[36:39], v[100:103]
  ds_read_b64_tr_b16 v[162:163], v6 offset:18432
  s_and_b32 s53, s53, 0xffff
  v_mfma_f32_16x16x32_bf16 v[108:111], v[196:199], v[36:39], v[108:111]
  ds_read_b64_tr_b16 v[164:165], v7 offset:16384
  s_mov_b32 s54, 524288
  v_mfma_f32_16x16x32_bf16 v[104:107], v[196:199], v[32:35], v[104:107]
  ds_read_b64_tr_b16 v[166:167], v7 offset:18432
  s_mov_b32 s55, 0x00020000
  v_mfma_f32_16x16x32_bf16 v[112:115], v[200:203], v[32:35], v[112:115]
  ds_read_b64_tr_b16 v[168:169], v8 offset:16384
  v_mfma_f32_16x16x32_bf16 v[116:119], v[200:203], v[36:39], v[116:119]
  ds_read_b64_tr_b16 v[170:171], v8 offset:18432
  v_mfma_f32_16x16x32_bf16 v[124:127], v[204:207], v[36:39], v[124:127]
  ds_read_b64_tr_b16 v[172:173], v9 offset:16384
  v_mfma_f32_16x16x32_bf16 v[120:123], v[204:207], v[32:35], v[120:123]
  ds_read_b64_tr_b16 v[174:175], v9 offset:18432
  s_waitcnt lgkmcnt(8)
  s_barrier
  buffer_load_dwordx4 v[80:83], off, s[36:39], s51 offset:0 sc1
  buffer_load_dwordx4 v[84:87], off, s[64:67], s51 offset:0 sc1
  buffer_load_dwordx4 v[88:91], off, s[36:39], s51 offset:1024 sc1
  buffer_load_dwordx4 v[92:95], off, s[64:67], s51 offset:1024 sc1
  buffer_load_dwordx4 v[224:227], off, s[36:39], s48 offset:0 sc1
  buffer_load_dwordx4 v[228:231], off, s[64:67], s48 offset:0 sc1
  buffer_load_dwordx4 v[232:235], off, s[36:39], s48 offset:1024 sc1
  buffer_load_dwordx4 v[236:239], off, s[64:67], s48 offset:1024 sc1
  buffer_load_dwordx4 v[240:243], off, s[36:39], s49 offset:0 sc1
  buffer_load_dwordx4 v[244:247], off, s[64:67], s49 offset:0 sc1
  buffer_load_dwordx4 v[248:251], off, s[36:39], s49 offset:1024 sc1
  buffer_load_dwordx4 v[252:255], off, s[64:67], s49 offset:1024 sc1
  v_mfma_f32_16x16x32_bf16 v[96:99], v[208:211], v[40:43], v[96:99]
  ds_read_b64_tr_b16 v[176:177], v6 offset:20480
  v_mfma_f32_16x16x32_bf16 v[100:103], v[208:211], v[44:47], v[100:103]
  ds_read_b64_tr_b16 v[178:179], v6 offset:22528
  v_mfma_f32_16x16x32_bf16 v[108:111], v[212:215], v[44:47], v[108:111]
  ds_read_b64_tr_b16 v[180:181], v7 offset:20480
  v_mfma_f32_16x16x32_bf16 v[104:107], v[212:215], v[40:43], v[104:107]
  ds_read_b64_tr_b16 v[182:183], v7 offset:22528
  v_mfma_f32_16x16x32_bf16 v[112:115], v[216:219], v[40:43], v[112:115]
  ds_read_b64_tr_b16 v[184:185], v8 offset:20480
  v_mfma_f32_16x16x32_bf16 v[116:119], v[216:219], v[44:47], v[116:119]
  ds_read_b64_tr_b16 v[186:187], v8 offset:22528
  v_readlane_b32 s50, v30, 6
  v_mfma_f32_16x16x32_bf16 v[124:127], v[220:223], v[44:47], v[124:127]
  ds_read_b64_tr_b16 v[188:189], v9 offset:20480
  v_mfma_f32_16x16x32_bf16 v[120:123], v[220:223], v[40:43], v[120:123]
  ds_read_b64_tr_b16 v[190:191], v9 offset:22528
  s_waitcnt lgkmcnt(8)
  v_mfma_f32_16x16x32_bf16 v[128:131], v[160:163], v[48:51], v[128:131]
  buffer_load_dwordx4 v[32:35], off, s[36:39], s50 offset:0 sc1
  v_mfma_f32_16x16x32_bf16 v[132:135], v[160:163], v[52:55], v[132:135]
  ds_read_b64_tr_b16 v[192:193], v6 offset:24576
  ds_read_b64_tr_b16 v[194:195], v6 offset:26624
  v_mfma_f32_16x16x32_bf16 v[140:143], v[164:167], v[52:55], v[140:143]
  ds_read_b64_tr_b16 v[196:197], v7 offset:24576
  v_mfma_f32_16x16x32_bf16 v[136:139], v[164:167], v[48:51], v[136:139]
  buffer_load_dwordx4 v[36:39], off, s[64:67], s50 offset:0 sc1
  v_mfma_f32_16x16x32_bf16 v[144:147], v[168:171], v[48:51], v[144:147]
  ds_read_b64_tr_b16 v[198:199], v7 offset:26624
  ds_read_b64_tr_b16 v[200:201], v8 offset:24576
  v_mfma_f32_16x16x32_bf16 v[148:151], v[168:171], v[52:55], v[148:151]
  ds_read_b64_tr_b16 v[202:203], v8 offset:26624
  ds_read_b64_tr_b16 v[204:205], v9 offset:24576
  v_mfma_f32_16x16x32_bf16 v[156:159], v[172:175], v[52:55], v[156:159]
  buffer_load_dwordx4 v[40:43], off, s[36:39], s50 offset:1024 sc1
  v_mfma_f32_16x16x32_bf16 v[152:155], v[172:175], v[48:51], v[152:155]
  ds_read_b64_tr_b16 v[206:207], v9 offset:26624
  s_waitcnt lgkmcnt(8)
  v_mfma_f32_16x16x32_bf16 v[128:131], v[176:179], v[56:59], v[128:131]
  ds_read_b64_tr_b16 v[208:209], v6 offset:28672
  v_mfma_f32_16x16x32_bf16 v[132:135], v[176:179], v[60:63], v[132:135]
  buffer_load_dwordx4 v[44:47], off, s[64:67], s50 offset:1024 sc1
  v_mfma_f32_16x16x32_bf16 v[140:143], v[180:183], v[60:63], v[140:143]
  ds_read_b64_tr_b16 v[210:211], v6 offset:30720
  ds_read_b64_tr_b16 v[212:213], v7 offset:28672
  v_mfma_f32_16x16x32_bf16 v[136:139], v[180:183], v[56:59], v[136:139]
  ds_read_b64_tr_b16 v[214:215], v7 offset:30720
  v_mfma_f32_16x16x32_bf16 v[144:147], v[184:187], v[56:59], v[144:147]
  ds_read_b64_tr_b16 v[216:217], v8 offset:28672
  v_mfma_f32_16x16x32_bf16 v[148:151], v[184:187], v[60:63], v[148:151]
  ds_read_b64_tr_b16 v[218:219], v8 offset:30720
  v_mfma_f32_16x16x32_bf16 v[156:159], v[188:191], v[60:63], v[156:159]
  ds_read_b64_tr_b16 v[220:221], v9 offset:28672
  v_mfma_f32_16x16x32_bf16 v[152:155], v[188:191], v[56:59], v[152:155]
  ds_read_b64_tr_b16 v[222:223], v9 offset:30720
  s_waitcnt lgkmcnt(8)
  v_mfma_f32_16x16x32_bf16 v[96:99], v[192:195], v[48:51], v[96:99]
  ds_read_b64_tr_b16 v[160:161], v6 offset:32768
  v_mfma_f32_16x16x32_bf16 v[100:103], v[192:195], v[52:55], v[100:103]
  ds_read_b64_tr_b16 v[162:163], v6 offset:34816
  v_mfma_f32_16x16x32_bf16 v[108:111], v[196:199], v[52:55], v[108:111]
  ds_read_b64_tr_b16 v[164:165], v7 offset:32768
  v_mfma_f32_16x16x32_bf16 v[104:107], v[196:199], v[48:51], v[104:107]
  ds_read_b64_tr_b16 v[166:167], v7 offset:34816
  v_mfma_f32_16x16x32_bf16 v[112:115], v[200:203], v[48:51], v[112:115]
  ds_read_b64_tr_b16 v[168:169], v8 offset:32768
  v_mfma_f32_16x16x32_bf16 v[116:119], v[200:203], v[52:55], v[116:119]
  ds_read_b64_tr_b16 v[170:171], v8 offset:34816
  v_mfma_f32_16x16x32_bf16 v[124:127], v[204:207], v[52:55], v[124:127]
  ds_read_b64_tr_b16 v[172:173], v9 offset:32768
  v_mfma_f32_16x16x32_bf16 v[120:123], v[204:207], v[48:51], v[120:123]
  ds_read_b64_tr_b16 v[174:175], v9 offset:34816
  s_waitcnt lgkmcnt(8)
  v_mfma_f32_16x16x32_bf16 v[96:99], v[208:211], v[56:59], v[96:99]
  ds_read_b64_tr_b16 v[176:177], v6 offset:36864
  v_mfma_f32_16x16x32_bf16 v[100:103], v[208:211], v[60:63], v[100:103]
  ds_read_b64_tr_b16 v[178:179], v6 offset:38912
  v_mfma_f32_16x16x32_bf16 v[108:111], v[212:215], v[60:63], v[108:111]
  ds_read_b64_tr_b16 v[180:181], v7 offset:36864
  v_mfma_f32_16x16x32_bf16 v[104:107], v[212:215], v[56:59], v[104:107]
  ds_read_b64_tr_b16 v[182:183], v7 offset:38912
  v_mfma_f32_16x16x32_bf16 v[112:115], v[216:219], v[56:59], v[112:115]
  ds_read_b64_tr_b16 v[184:185], v8 offset:36864
  v_mfma_f32_16x16x32_bf16 v[116:119], v[216:219], v[60:63], v[116:119]
  ds_read_b64_tr_b16 v[186:187], v8 offset:38912
  v_readlane_b32 s51, v30, 7
  v_mfma_f32_16x16x32_bf16 v[124:127], v[220:223], v[60:63], v[124:127]
  ds_read_b64_tr_b16 v[188:189], v9 offset:36864
  v_mfma_f32_16x16x32_bf16 v[120:123], v[220:223], v[56:59], v[120:123]
  ds_read_b64_tr_b16 v[190:191], v9 offset:38912
  s_waitcnt lgkmcnt(8)
  v_mfma_f32_16x16x32_bf16 v[128:131], v[160:163], v[64:67], v[128:131]
  buffer_load_dwordx4 v[48:51], off, s[36:39], s51 offset:0 sc1
  v_mfma_f32_16x16x32_bf16 v[132:135], v[160:163], v[68:71], v[132:135]
  ds_read_b64_tr_b16 v[192:193], v6 offset:40960
  ds_read_b64_tr_b16 v[194:195], v6 offset:43008
  v_mfma_f32_16x16x32_bf16 v[140:143], v[164:167], v[68:71], v[140:143]
  ds_read_b64_tr_b16 v[196:197], v7 offset:40960
  v_mfma_f32_16x16x32_bf16 v[136:139], v[164:167], v[64:67], v[136:139]
  buffer_load_dwordx4 v[52:55], off, s[64:67], s51 offset:0 sc1
  v_mfma_f32_16x16x32_bf16 v[144:147], v[168:171], v[64:67], v[144:147]
  ds_read_b64_tr_b16 v[198:199], v7 offset:43008
  ds_read_b64_tr_b16 v[200:201], v8 offset:40960
  v_mfma_f32_16x16x32_bf16 v[148:151], v[168:171], v[68:71], v[148:151]
  ds_read_b64_tr_b16 v[202:203], v8 offset:43008
  ds_read_b64_tr_b16 v[204:205], v9 offset:40960
  v_mfma_f32_16x16x32_bf16 v[156:159], v[172:175], v[68:71], v[156:159]
  buffer_load_dwordx4 v[56:59], off, s[36:39], s51 offset:1024 sc1
  v_mfma_f32_16x16x32_bf16 v[152:155], v[172:175], v[64:67], v[152:155]
  ds_read_b64_tr_b16 v[206:207], v9 offset:43008
  s_waitcnt lgkmcnt(8)
  v_mfma_f32_16x16x32_bf16 v[128:131], v[176:179], v[72:75], v[128:131]
  ds_read_b64_tr_b16 v[208:209], v6 offset:45056
  v_mfma_f32_16x16x32_bf16 v[132:135], v[176:179], v[76:79], v[132:135]
  buffer_load_dwordx4 v[60:63], off, s[64:67], s51 offset:1024 sc1
  v_mfma_f32_16x16x32_bf16 v[140:143], v[180:183], v[76:79], v[140:143]
  ds_read_b64_tr_b16 v[210:211], v6 offset:47104
  ds_read_b64_tr_b16 v[212:213], v7 offset:45056
  v_mfma_f32_16x16x32_bf16 v[136:139], v[180:183], v[72:75], v[136:139]
  ds_read_b64_tr_b16 v[214:215], v7 offset:47104
  v_mfma_f32_16x16x32_bf16 v[144:147], v[184:187], v[72:75], v[144:147]
  ds_read_b64_tr_b16 v[216:217], v8 offset:45056
  v_mfma_f32_16x16x32_bf16 v[148:151], v[184:187], v[76:79], v[148:151]
  ds_read_b64_tr_b16 v[218:219], v8 offset:47104
  v_mfma_f32_16x16x32_bf16 v[156:159], v[188:191], v[76:79], v[156:159]
  ds_read_b64_tr_b16 v[220:221], v9 offset:45056
  v_mfma_f32_16x16x32_bf16 v[152:155], v[188:191], v[72:75], v[152:155]
  ds_read_b64_tr_b16 v[222:223], v9 offset:47104
  s_waitcnt lgkmcnt(8)
  v_mfma_f32_16x16x32_bf16 v[96:99], v[192:195], v[64:67], v[96:99]
  ds_read_b64_tr_b16 v[160:161], v6 offset:49152
  v_mfma_f32_16x16x32_bf16 v[100:103], v[192:195], v[68:71], v[100:103]
  ds_read_b64_tr_b16 v[162:163], v6 offset:51200
  v_mfma_f32_16x16x32_bf16 v[108:111], v[196:199], v[68:71], v[108:111]
  ds_read_b64_tr_b16 v[164:165], v7 offset:49152
  v_mfma_f32_16x16x32_bf16 v[104:107], v[196:199], v[64:67], v[104:107]
  ds_read_b64_tr_b16 v[166:167], v7 offset:51200
  v_mfma_f32_16x16x32_bf16 v[112:115], v[200:203], v[64:67], v[112:115]
  ds_read_b64_tr_b16 v[168:169], v8 offset:49152
  v_mfma_f32_16x16x32_bf16 v[116:119], v[200:203], v[68:71], v[116:119]
  ds_read_b64_tr_b16 v[170:171], v8 offset:51200
  v_mfma_f32_16x16x32_bf16 v[124:127], v[204:207], v[68:71], v[124:127]
  ds_read_b64_tr_b16 v[172:173], v9 offset:49152
  v_mfma_f32_16x16x32_bf16 v[120:123], v[204:207], v[64:67], v[120:123]
  ds_read_b64_tr_b16 v[174:175], v9 offset:51200
  s_waitcnt lgkmcnt(8)
  v_mfma_f32_16x16x32_bf16 v[96:99], v[208:211], v[72:75], v[96:99]
  ds_read_b64_tr_b16 v[176:177], v6 offset:53248
  v_mfma_f32_16x16x32_bf16 v[100:103], v[208:211], v[76:79], v[100:103]
  ds_read_b64_tr_b16 v[178:179], v6 offset:55296
  v_mfma_f32_16x16x32_bf16 v[108:111], v[212:215], v[76:79], v[108:111]
  ds_read_b64_tr_b16 v[180:181], v7 offset:53248
  v_mfma_f32_16x16x32_bf16 v[104:107], v[212:215], v[72:75], v[104:107]
  ds_read_b64_tr_b16 v[182:183], v7 offset:55296
  v_mfma_f32_16x16x32_bf16 v[112:115], v[216:219], v[72:75], v[112:115]
  ds_read_b64_tr_b16 v[184:185], v8 offset:53248
  v_mfma_f32_16x16x32_bf16 v[116:119], v[216:219], v[76:79], v[116:119]
  ds_read_b64_tr_b16 v[186:187], v8 offset:55296
  v_readlane_b32 s48, v30, 8
  v_mfma_f32_16x16x32_bf16 v[124:127], v[220:223], v[76:79], v[124:127]
  ds_read_b64_tr_b16 v[188:189], v9 offset:53248
  v_mfma_f32_16x16x32_bf16 v[120:123], v[220:223], v[72:75], v[120:123]
  ds_read_b64_tr_b16 v[190:191], v9 offset:55296
  s_waitcnt vmcnt(18) lgkmcnt(8)
  v_mfma_f32_16x16x32_bf16 v[128:131], v[160:163], v[80:83], v[128:131]
  buffer_load_dwordx4 v[64:67], off, s[36:39], s48 offset:0 sc1
  v_mfma_f32_16x16x32_bf16 v[132:135], v[160:163], v[84:87], v[132:135]
  ds_read_b64_tr_b16 v[192:193], v6 offset:57344
  ds_read_b64_tr_b16 v[194:195], v6 offset:59392
  v_mfma_f32_16x16x32_bf16 v[140:143], v[164:167], v[84:87], v[140:143]
  ds_read_b64_tr_b16 v[196:197], v7 offset:57344
  v_mfma_f32_16x16x32_bf16 v[136:139], v[164:167], v[80:83], v[136:139]
  ds_read_b64_tr_b16 v[198:199], v7 offset:59392
  v_mfma_f32_16x16x32_bf16 v[144:147], v[168:171], v[80:83], v[144:147]
  ds_read_b64_tr_b16 v[200:201], v8 offset:57344
  v_mfma_f32_16x16x32_bf16 v[148:151], v[168:171], v[84:87], v[148:151]
  ds_read_b64_tr_b16 v[202:203], v8 offset:59392
  ds_read_b64_tr_b16 v[204:205], v9 offset:57344
  v_mfma_f32_16x16x32_bf16 v[156:159], v[172:175], v[84:87], v[156:159]
  buffer_load_dwordx4 v[68:71], off, s[64:67], s48 offset:0 sc1
  v_mfma_f32_16x16x32_bf16 v[152:155], v[172:175], v[80:83], v[152:155]
  ds_read_b64_tr_b16 v[206:207], v9 offset:59392
  s_waitcnt vmcnt(18) lgkmcnt(8)
  v_mfma_f32_16x16x32_bf16 v[128:131], v[176:179], v[88:91], v[128:131]
  ds_read_b64_tr_b16 v[208:209], v6 offset:61440
  v_mfma_f32_16x16x32_bf16 v[132:135], v[176:179], v[92:95], v[132:135]
  ds_read_b64_tr_b16 v[210:211], v6 offset:63488
  v_mfma_f32_16x16x32_bf16 v[140:143], v[180:183], v[92:95], v[140:143]
  ds_read_b64_tr_b16 v[212:213], v7 offset:61440
  v_mfma_f32_16x16x32_bf16 v[136:139], v[180:183], v[88:91], v[136:139]
  ds_read_b64_tr_b16 v[214:215], v7 offset:63488
  v_mfma_f32_16x16x32_bf16 v[144:147], v[184:187], v[88:91], v[144:147]
  buffer_load_dwordx4 v[72:75], off, s[36:39], s48 offset:1024 sc1
  v_mfma_f32_16x16x32_bf16 v[148:151], v[184:187], v[92:95], v[148:151]
  ds_read_b64_tr_b16 v[216:217], v8 offset:61440
  ds_read_b64_tr_b16 v[218:219], v8 offset:63488
  v_mfma_f32_16x16x32_bf16 v[156:159], v[188:191], v[92:95], v[156:159]
  ds_read_b64_tr_b16 v[220:221], v9 offset:61440
  v_mfma_f32_16x16x32_bf16 v[152:155], v[188:191], v[88:91], v[152:155]
  ds_read_b64_tr_b16 v[222:223], v9 offset:63488
  s_waitcnt lgkmcnt(8)
  v_mfma_f32_16x16x32_bf16 v[96:99], v[192:195], v[80:83], v[96:99]
  ds_read_b64_tr_b16 v[160:161], v20 offset:0
  v_mfma_f32_16x16x32_bf16 v[100:103], v[192:195], v[84:87], v[100:103]
  ds_read_b64_tr_b16 v[162:163], v20 offset:2048
  v_mfma_f32_16x16x32_bf16 v[108:111], v[196:199], v[84:87], v[108:111]
  buffer_load_dwordx4 v[76:79], off, s[64:67], s48 offset:1024 sc1
  v_mfma_f32_16x16x32_bf16 v[104:107], v[196:199], v[80:83], v[104:107]
  ds_read_b64_tr_b16 v[164:165], v21 offset:0
  ds_read_b64_tr_b16 v[166:167], v21 offset:2048
  v_mfma_f32_16x16x32_bf16 v[112:115], v[200:203], v[80:83], v[112:115]
  ds_read_b64_tr_b16 v[168:169], v22 offset:0
  v_mfma_f32_16x16x32_bf16 v[116:119], v[200:203], v[84:87], v[116:119]
  ds_read_b64_tr_b16 v[170:171], v22 offset:2048
  v_mfma_f32_16x16x32_bf16 v[124:127], v[204:207], v[84:87], v[124:127]
  ds_read_b64_tr_b16 v[172:173], v23 offset:0
  v_mfma_f32_16x16x32_bf16 v[120:123], v[204:207], v[80:83], v[120:123]
  ds_read_b64_tr_b16 v[174:175], v23 offset:2048
  s_waitcnt lgkmcnt(8)
  s_barrier
  v_mfma_f32_16x16x32_bf16 v[96:99], v[208:211], v[88:91], v[96:99]
  ds_read_b64_tr_b16 v[176:177], v20 offset:4096
  v_mfma_f32_16x16x32_bf16 v[100:103], v[208:211], v[92:95], v[100:103]
  ds_read_b64_tr_b16 v[178:179], v20 offset:6144
  v_mfma_f32_16x16x32_bf16 v[108:111], v[212:215], v[92:95], v[108:111]
  ds_read_b64_tr_b16 v[180:181], v21 offset:4096
  v_mfma_f32_16x16x32_bf16 v[104:107], v[212:215], v[88:91], v[104:107]
  ds_read_b64_tr_b16 v[182:183], v21 offset:6144
  v_mfma_f32_16x16x32_bf16 v[112:115], v[216:219], v[88:91], v[112:115]
  ds_read_b64_tr_b16 v[184:185], v22 offset:4096
  v_mfma_f32_16x16x32_bf16 v[116:119], v[216:219], v[92:95], v[116:119]
  ds_read_b64_tr_b16 v[186:187], v22 offset:6144
  v_readlane_b32 s49, v30, 9
  v_mfma_f32_16x16x32_bf16 v[124:127], v[220:223], v[92:95], v[124:127]
  ds_read_b64_tr_b16 v[188:189], v23 offset:4096
  v_mfma_f32_16x16x32_bf16 v[120:123], v[220:223], v[88:91], v[120:123]
  ds_read_b64_tr_b16 v[190:191], v23 offset:6144
  s_waitcnt vmcnt(18) lgkmcnt(8)
  v_mfma_f32_16x16x32_bf16 v[128:131], v[160:163], v[224:227], v[128:131]
  buffer_load_dwordx4 v[80:83], off, s[36:39], s49 offset:0 sc1
  v_mfma_f32_16x16x32_bf16 v[132:135], v[160:163], v[228:231], v[132:135]
  ds_read_b64_tr_b16 v[192:193], v20 offset:8192
  ds_read_b64_tr_b16 v[194:195], v20 offset:10240
  v_mfma_f32_16x16x32_bf16 v[140:143], v[164:167], v[228:231], v[140:143]
  ds_read_b64_tr_b16 v[196:197], v21 offset:8192
  v_mfma_f32_16x16x32_bf16 v[136:139], v[164:167], v[224:227], v[136:139]
  ds_read_b64_tr_b16 v[198:199], v21 offset:10240
  v_mfma_f32_16x16x32_bf16 v[144:147], v[168:171], v[224:227], v[144:147]
  ds_read_b64_tr_b16 v[200:201], v22 offset:8192
  v_mfma_f32_16x16x32_bf16 v[148:151], v[168:171], v[228:231], v[148:151]
  ds_read_b64_tr_b16 v[202:203], v22 offset:10240
  ds_read_b64_tr_b16 v[204:205], v23 offset:8192
  v_mfma_f32_16x16x32_bf16 v[156:159], v[172:175], v[228:231], v[156:159]
  buffer_load_dwordx4 v[84:87], off, s[64:67], s49 offset:0 sc1
  v_mfma_f32_16x16x32_bf16 v[152:155], v[172:175], v[224:227], v[152:155]
  ds_read_b64_tr_b16 v[206:207], v23 offset:10240
  s_waitcnt vmcnt(18) lgkmcnt(8)
  v_mfma_f32_16x16x32_bf16 v[128:131], v[176:179], v[232:235], v[128:131]
  ds_read_b64_tr_b16 v[208:209], v20 offset:12288
  v_mfma_f32_16x16x32_bf16 v[132:135], v[176:179], v[236:239], v[132:135]
  ds_read_b64_tr_b16 v[210:211], v20 offset:14336
  v_mfma_f32_16x16x32_bf16 v[140:143], v[180:183], v[236:239], v[140:143]
  ds_read_b64_tr_b16 v[212:213], v21 offset:12288
  v_mfma_f32_16x16x32_bf16 v[136:139], v[180:183], v[232:235], v[136:139]
  ds_read_b64_tr_b16 v[214:215], v21 offset:14336
  v_mfma_f32_16x16x32_bf16 v[144:147], v[184:187], v[232:235], v[144:147]
  buffer_load_dwordx4 v[88:91], off, s[36:39], s49 offset:1024 sc1
  v_mfma_f32_16x16x32_bf16 v[148:151], v[184:187], v[236:239], v[148:151]
  ds_read_b64_tr_b16 v[216:217], v22 offset:12288
  ds_read_b64_tr_b16 v[218:219], v22 offset:14336
  v_mfma_f32_16x16x32_bf16 v[156:159], v[188:191], v[236:239], v[156:159]
  ds_read_b64_tr_b16 v[220:221], v23 offset:12288
  v_mfma_f32_16x16x32_bf16 v[152:155], v[188:191], v[232:235], v[152:155]
  ds_read_b64_tr_b16 v[222:223], v23 offset:14336
  s_waitcnt lgkmcnt(8)
  v_mfma_f32_16x16x32_bf16 v[96:99], v[192:195], v[224:227], v[96:99]
  ds_read_b64_tr_b16 v[160:161], v20 offset:16384
  v_mfma_f32_16x16x32_bf16 v[100:103], v[192:195], v[228:231], v[100:103]
  ds_read_b64_tr_b16 v[162:163], v20 offset:18432
  v_mfma_f32_16x16x32_bf16 v[108:111], v[196:199], v[228:231], v[108:111]
  buffer_load_dwordx4 v[92:95], off, s[64:67], s49 offset:1024 sc1
  v_mfma_f32_16x16x32_bf16 v[104:107], v[196:199], v[224:227], v[104:107]
  ds_read_b64_tr_b16 v[164:165], v21 offset:16384
  ds_read_b64_tr_b16 v[166:167], v21 offset:18432
  v_mfma_f32_16x16x32_bf16 v[112:115], v[200:203], v[224:227], v[112:115]
  ds_read_b64_tr_b16 v[168:169], v22 offset:16384
  v_mfma_f32_16x16x32_bf16 v[116:119], v[200:203], v[228:231], v[116:119]
  ds_read_b64_tr_b16 v[170:171], v22 offset:18432
  v_mfma_f32_16x16x32_bf16 v[124:127], v[204:207], v[228:231], v[124:127]
  ds_read_b64_tr_b16 v[172:173], v23 offset:16384
  v_mfma_f32_16x16x32_bf16 v[120:123], v[204:207], v[224:227], v[120:123]
  ds_read_b64_tr_b16 v[174:175], v23 offset:18432
  s_waitcnt lgkmcnt(8)
  v_mfma_f32_16x16x32_bf16 v[96:99], v[208:211], v[232:235], v[96:99]
  ds_read_b64_tr_b16 v[176:177], v20 offset:20480
  v_mfma_f32_16x16x32_bf16 v[100:103], v[208:211], v[236:239], v[100:103]
  ds_read_b64_tr_b16 v[178:179], v20 offset:22528
  v_mfma_f32_16x16x32_bf16 v[108:111], v[212:215], v[236:239], v[108:111]
  ds_read_b64_tr_b16 v[180:181], v21 offset:20480
  v_mfma_f32_16x16x32_bf16 v[104:107], v[212:215], v[232:235], v[104:107]
  ds_read_b64_tr_b16 v[182:183], v21 offset:22528
  v_mfma_f32_16x16x32_bf16 v[112:115], v[216:219], v[232:235], v[112:115]
  ds_read_b64_tr_b16 v[184:185], v22 offset:20480
  v_mfma_f32_16x16x32_bf16 v[116:119], v[216:219], v[236:239], v[116:119]
  ds_read_b64_tr_b16 v[186:187], v22 offset:22528
  v_readlane_b32 s50, v30, 10
  v_mfma_f32_16x16x32_bf16 v[124:127], v[220:223], v[236:239], v[124:127]
  ds_read_b64_tr_b16 v[188:189], v23 offset:20480
  v_mfma_f32_16x16x32_bf16 v[120:123], v[220:223], v[232:235], v[120:123]
  ds_read_b64_tr_b16 v[190:191], v23 offset:22528
  s_waitcnt vmcnt(18) lgkmcnt(8)
  v_mfma_f32_16x16x32_bf16 v[128:131], v[160:163], v[240:243], v[128:131]
  buffer_load_dwordx4 v[224:227], off, s[36:39], s50 offset:0 sc1
  v_mfma_f32_16x16x32_bf16 v[132:135], v[160:163], v[244:247], v[132:135]
  ds_read_b64_tr_b16 v[192:193], v20 offset:24576
  ds_read_b64_tr_b16 v[194:195], v20 offset:26624
  v_mfma_f32_16x16x32_bf16 v[140:143], v[164:167], v[244:247], v[140:143]
  ds_read_b64_tr_b16 v[196:197], v21 offset:24576
  v_mfma_f32_16x16x32_bf16 v[136:139], v[164:167], v[240:243], v[136:139]
  ds_read_b64_tr_b16 v[198:199], v21 offset:26624
  v_mfma_f32_16x16x32_bf16 v[144:147], v[168:171], v[240:243], v[144:147]
  ds_read_b64_tr_b16 v[200:201], v22 offset:24576
  v_mfma_f32_16x16x32_bf16 v[148:151], v[168:171], v[244:247], v[148:151]
  ds_read_b64_tr_b16 v[202:203], v22 offset:26624
  ds_read_b64_tr_b16 v[204:205], v23 offset:24576
  v_mfma_f32_16x16x32_bf16 v[156:159], v[172:175], v[244:247], v[156:159]
  buffer_load_dwordx4 v[228:231], off, s[64:67], s50 offset:0 sc1
  v_mfma_f32_16x16x32_bf16 v[152:155], v[172:175], v[240:243], v[152:155]
  ds_read_b64_tr_b16 v[206:207], v23 offset:26624
  s_waitcnt vmcnt(18) lgkmcnt(8)
  v_mfma_f32_16x16x32_bf16 v[128:131], v[176:179], v[248:251], v[128:131]
  ds_read_b64_tr_b16 v[208:209], v20 offset:28672
  v_mfma_f32_16x16x32_bf16 v[132:135], v[176:179], v[252:255], v[132:135]
  ds_read_b64_tr_b16 v[210:211], v20 offset:30720
  v_mfma_f32_16x16x32_bf16 v[140:143], v[180:183], v[252:255], v[140:143]
  ds_read_b64_tr_b16 v[212:213], v21 offset:28672
  v_mfma_f32_16x16x32_bf16 v[136:139], v[180:183], v[248:251], v[136:139]
  ds_read_b64_tr_b16 v[214:215], v21 offset:30720
  v_mfma_f32_16x16x32_bf16 v[144:147], v[184:187], v[248:251], v[144:147]
  buffer_load_dwordx4 v[232:235], off, s[36:39], s50 offset:1024 sc1
  v_mfma_f32_16x16x32_bf16 v[148:151], v[184:187], v[252:255], v[148:151]
  ds_read_b64_tr_b16 v[216:217], v22 offset:28672
  ds_read_b64_tr_b16 v[218:219], v22 offset:30720
  v_mfma_f32_16x16x32_bf16 v[156:159], v[188:191], v[252:255], v[156:159]
  ds_read_b64_tr_b16 v[220:221], v23 offset:28672
  v_mfma_f32_16x16x32_bf16 v[152:155], v[188:191], v[248:251], v[152:155]
  ds_read_b64_tr_b16 v[222:223], v23 offset:30720
  s_waitcnt lgkmcnt(8)
  v_mfma_f32_16x16x32_bf16 v[96:99], v[192:195], v[240:243], v[96:99]
  ds_read_b64_tr_b16 v[160:161], v20 offset:32768
  v_mfma_f32_16x16x32_bf16 v[100:103], v[192:195], v[244:247], v[100:103]
  ds_read_b64_tr_b16 v[162:163], v20 offset:34816
  v_mfma_f32_16x16x32_bf16 v[108:111], v[196:199], v[244:247], v[108:111]
  buffer_load_dwordx4 v[236:239], off, s[64:67], s50 offset:1024 sc1
  v_mfma_f32_16x16x32_bf16 v[104:107], v[196:199], v[240:243], v[104:107]
  ds_read_b64_tr_b16 v[164:165], v21 offset:32768
  ds_read_b64_tr_b16 v[166:167], v21 offset:34816
  v_mfma_f32_16x16x32_bf16 v[112:115], v[200:203], v[240:243], v[112:115]
  ds_read_b64_tr_b16 v[168:169], v22 offset:32768
  v_mfma_f32_16x16x32_bf16 v[116:119], v[200:203], v[244:247], v[116:119]
  ds_read_b64_tr_b16 v[170:171], v22 offset:34816
  v_mfma_f32_16x16x32_bf16 v[124:127], v[204:207], v[244:247], v[124:127]
  ds_read_b64_tr_b16 v[172:173], v23 offset:32768
  v_mfma_f32_16x16x32_bf16 v[120:123], v[204:207], v[240:243], v[120:123]
  ds_read_b64_tr_b16 v[174:175], v23 offset:34816
  s_waitcnt lgkmcnt(8)
  s_barrier
  v_mfma_f32_16x16x32_bf16 v[96:99], v[208:211], v[248:251], v[96:99]
  ds_read_b64_tr_b16 v[176:177], v20 offset:36864
  v_mfma_f32_16x16x32_bf16 v[100:103], v[208:211], v[252:255], v[100:103]
  ds_read_b64_tr_b16 v[178:179], v20 offset:38912
  v_mfma_f32_16x16x32_bf16 v[108:111], v[212:215], v[252:255], v[108:111]
  ds_read_b64_tr_b16 v[180:181], v21 offset:36864
  v_mfma_f32_16x16x32_bf16 v[104:107], v[212:215], v[248:251], v[104:107]
  ds_read_b64_tr_b16 v[182:183], v21 offset:38912
  v_mfma_f32_16x16x32_bf16 v[112:115], v[216:219], v[248:251], v[112:115]
  ds_read_b64_tr_b16 v[184:185], v22 offset:36864
  v_mfma_f32_16x16x32_bf16 v[116:119], v[216:219], v[252:255], v[116:119]
  ds_read_b64_tr_b16 v[186:187], v22 offset:38912
  v_readlane_b32 s51, v30, 11
  v_mfma_f32_16x16x32_bf16 v[124:127], v[220:223], v[252:255], v[124:127]
  ds_read_b64_tr_b16 v[188:189], v23 offset:36864
  v_mfma_f32_16x16x32_bf16 v[120:123], v[220:223], v[248:251], v[120:123]
  ds_read_b64_tr_b16 v[190:191], v23 offset:38912
  s_waitcnt vmcnt(18) lgkmcnt(8)
  v_mfma_f32_16x16x32_bf16 v[128:131], v[160:163], v[32:35], v[128:131]
  buffer_load_dwordx4 v[240:243], off, s[36:39], s51 offset:0 sc1
  v_mfma_f32_16x16x32_bf16 v[132:135], v[160:163], v[36:39], v[132:135]
  ds_read_b64_tr_b16 v[192:193], v20 offset:40960
  ds_read_b64_tr_b16 v[194:195], v20 offset:43008
  v_mfma_f32_16x16x32_bf16 v[140:143], v[164:167], v[36:39], v[140:143]
  ds_read_b64_tr_b16 v[196:197], v21 offset:40960
  v_mfma_f32_16x16x32_bf16 v[136:139], v[164:167], v[32:35], v[136:139]
  ds_read_b64_tr_b16 v[198:199], v21 offset:43008
  v_mfma_f32_16x16x32_bf16 v[144:147], v[168:171], v[32:35], v[144:147]
  ds_read_b64_tr_b16 v[200:201], v22 offset:40960
  v_mfma_f32_16x16x32_bf16 v[148:151], v[168:171], v[36:39], v[148:151]
  ds_read_b64_tr_b16 v[202:203], v22 offset:43008
  ds_read_b64_tr_b16 v[204:205], v23 offset:40960
  v_mfma_f32_16x16x32_bf16 v[156:159], v[172:175], v[36:39], v[156:159]
  buffer_load_dwordx4 v[244:247], off, s[64:67], s51 offset:0 sc1
  v_mfma_f32_16x16x32_bf16 v[152:155], v[172:175], v[32:35], v[152:155]
  ds_read_b64_tr_b16 v[206:207], v23 offset:43008
  s_waitcnt vmcnt(18) lgkmcnt(8)
  v_mfma_f32_16x16x32_bf16 v[128:131], v[176:179], v[40:43], v[128:131]
  ds_read_b64_tr_b16 v[208:209], v20 offset:45056
  v_mfma_f32_16x16x32_bf16 v[132:135], v[176:179], v[44:47], v[132:135]
  ds_read_b64_tr_b16 v[210:211], v20 offset:47104
  v_mfma_f32_16x16x32_bf16 v[140:143], v[180:183], v[44:47], v[140:143]
  ds_read_b64_tr_b16 v[212:213], v21 offset:45056
  v_mfma_f32_16x16x32_bf16 v[136:139], v[180:183], v[40:43], v[136:139]
  ds_read_b64_tr_b16 v[214:215], v21 offset:47104
  v_mfma_f32_16x16x32_bf16 v[144:147], v[184:187], v[40:43], v[144:147]
  buffer_load_dwordx4 v[248:251], off, s[36:39], s51 offset:1024 sc1
  v_mfma_f32_16x16x32_bf16 v[148:151], v[184:187], v[44:47], v[148:151]
  ds_read_b64_tr_b16 v[216:217], v22 offset:45056
  ds_read_b64_tr_b16 v[218:219], v22 offset:47104
  v_mfma_f32_16x16x32_bf16 v[156:159], v[188:191], v[44:47], v[156:159]
  ds_read_b64_tr_b16 v[220:221], v23 offset:45056
  v_mfma_f32_16x16x32_bf16 v[152:155], v[188:191], v[40:43], v[152:155]
  ds_read_b64_tr_b16 v[222:223], v23 offset:47104
  s_waitcnt lgkmcnt(8)
  v_mfma_f32_16x16x32_bf16 v[96:99], v[192:195], v[32:35], v[96:99]
  ds_read_b64_tr_b16 v[160:161], v20 offset:49152
  v_mfma_f32_16x16x32_bf16 v[100:103], v[192:195], v[36:39], v[100:103]
  ds_read_b64_tr_b16 v[162:163], v20 offset:51200
  v_mfma_f32_16x16x32_bf16 v[108:111], v[196:199], v[36:39], v[108:111]
  buffer_load_dwordx4 v[252:255], off, s[64:67], s51 offset:1024 sc1
  v_mfma_f32_16x16x32_bf16 v[104:107], v[196:199], v[32:35], v[104:107]
  ds_read_b64_tr_b16 v[164:165], v21 offset:49152
  ds_read_b64_tr_b16 v[166:167], v21 offset:51200
  v_mfma_f32_16x16x32_bf16 v[112:115], v[200:203], v[32:35], v[112:115]
  ds_read_b64_tr_b16 v[168:169], v22 offset:49152
  v_mfma_f32_16x16x32_bf16 v[116:119], v[200:203], v[36:39], v[116:119]
  ds_read_b64_tr_b16 v[170:171], v22 offset:51200
  v_mfma_f32_16x16x32_bf16 v[124:127], v[204:207], v[36:39], v[124:127]
  ds_read_b64_tr_b16 v[172:173], v23 offset:49152
  v_mfma_f32_16x16x32_bf16 v[120:123], v[204:207], v[32:35], v[120:123]
  ds_read_b64_tr_b16 v[174:175], v23 offset:51200
  s_waitcnt lgkmcnt(8)
  v_mfma_f32_16x16x32_bf16 v[96:99], v[208:211], v[40:43], v[96:99]
  ds_read_b64_tr_b16 v[176:177], v20 offset:53248
  v_mfma_f32_16x16x32_bf16 v[100:103], v[208:211], v[44:47], v[100:103]
  ds_read_b64_tr_b16 v[178:179], v20 offset:55296
  v_mfma_f32_16x16x32_bf16 v[108:111], v[212:215], v[44:47], v[108:111]
  ds_read_b64_tr_b16 v[180:181], v21 offset:53248
  v_mfma_f32_16x16x32_bf16 v[104:107], v[212:215], v[40:43], v[104:107]
  ds_read_b64_tr_b16 v[182:183], v21 offset:55296
  v_mfma_f32_16x16x32_bf16 v[112:115], v[216:219], v[40:43], v[112:115]
  ds_read_b64_tr_b16 v[184:185], v22 offset:53248
  v_mfma_f32_16x16x32_bf16 v[116:119], v[216:219], v[44:47], v[116:119]
  ds_read_b64_tr_b16 v[186:187], v22 offset:55296
  v_readlane_b32 s48, v30, 12
  v_mfma_f32_16x16x32_bf16 v[124:127], v[220:223], v[44:47], v[124:127]
  ds_read_b64_tr_b16 v[188:189], v23 offset:53248
  v_mfma_f32_16x16x32_bf16 v[120:123], v[220:223], v[40:43], v[120:123]
  ds_read_b64_tr_b16 v[190:191], v23 offset:55296
  s_waitcnt vmcnt(18) lgkmcnt(8)
  v_mfma_f32_16x16x32_bf16 v[128:131], v[160:163], v[48:51], v[128:131]
  buffer_load_dwordx4 v[32:35], off, s[36:39], s48 offset:0 sc1
  v_mfma_f32_16x16x32_bf16 v[132:135], v[160:163], v[52:55], v[132:135]
  ds_read_b64_tr_b16 v[192:193], v20 offset:57344
  ds_read_b64_tr_b16 v[194:195], v20 offset:59392
  v_mfma_f32_16x16x32_bf16 v[140:143], v[164:167], v[52:55], v[140:143]
  ds_read_b64_tr_b16 v[196:197], v21 offset:57344
  v_mfma_f32_16x16x32_bf16 v[136:139], v[164:167], v[48:51], v[136:139]
  ds_read_b64_tr_b16 v[198:199], v21 offset:59392
  v_mfma_f32_16x16x32_bf16 v[144:147], v[168:171], v[48:51], v[144:147]
  ds_read_b64_tr_b16 v[200:201], v22 offset:57344
  v_mfma_f32_16x16x32_bf16 v[148:151], v[168:171], v[52:55], v[148:151]
  ds_read_b64_tr_b16 v[202:203], v22 offset:59392
  ds_read_b64_tr_b16 v[204:205], v23 offset:57344
  v_mfma_f32_16x16x32_bf16 v[156:159], v[172:175], v[52:55], v[156:159]
  buffer_load_dwordx4 v[36:39], off, s[64:67], s48 offset:0 sc1
  v_mfma_f32_16x16x32_bf16 v[152:155], v[172:175], v[48:51], v[152:155]
  ds_read_b64_tr_b16 v[206:207], v23 offset:59392
  s_waitcnt vmcnt(18) lgkmcnt(8)
  v_mfma_f32_16x16x32_bf16 v[128:131], v[176:179], v[56:59], v[128:131]
  ds_read_b64_tr_b16 v[208:209], v20 offset:61440
  v_mfma_f32_16x16x32_bf16 v[132:135], v[176:179], v[60:63], v[132:135]
  ds_read_b64_tr_b16 v[210:211], v20 offset:63488
  v_mfma_f32_16x16x32_bf16 v[140:143], v[180:183], v[60:63], v[140:143]
  ds_read_b64_tr_b16 v[212:213], v21 offset:61440
  v_mfma_f32_16x16x32_bf16 v[136:139], v[180:183], v[56:59], v[136:139]
  ds_read_b64_tr_b16 v[214:215], v21 offset:63488
  v_mfma_f32_16x16x32_bf16 v[144:147], v[184:187], v[56:59], v[144:147]
  buffer_load_dwordx4 v[40:43], off, s[36:39], s48 offset:1024 sc1
  v_mfma_f32_16x16x32_bf16 v[148:151], v[184:187], v[60:63], v[148:151]
  ds_read_b64_tr_b16 v[216:217], v22 offset:61440
  ds_read_b64_tr_b16 v[218:219], v22 offset:63488
  v_mfma_f32_16x16x32_bf16 v[156:159], v[188:191], v[60:63], v[156:159]
  ds_read_b64_tr_b16 v[220:221], v23 offset:61440
  v_mfma_f32_16x16x32_bf16 v[152:155], v[188:191], v[56:59], v[152:155]
  ds_read_b64_tr_b16 v[222:223], v23 offset:63488
  s_waitcnt lgkmcnt(8)
  v_mfma_f32_16x16x32_bf16 v[96:99], v[192:195], v[48:51], v[96:99]
  ds_read_b64_tr_b16 v[160:161], v26 offset:0
  v_mfma_f32_16x16x32_bf16 v[100:103], v[192:195], v[52:55], v[100:103]
  ds_read_b64_tr_b16 v[162:163], v26 offset:2048
  v_mfma_f32_16x16x32_bf16 v[108:111], v[196:199], v[52:55], v[108:111]
  buffer_load_dwordx4 v[44:47], off, s[64:67], s48 offset:1024 sc1
  v_mfma_f32_16x16x32_bf16 v[104:107], v[196:199], v[48:51], v[104:107]
  ds_read_b64_tr_b16 v[164:165], v27 offset:0
  ds_read_b64_tr_b16 v[166:167], v27 offset:2048
  v_mfma_f32_16x16x32_bf16 v[112:115], v[200:203], v[48:51], v[112:115]
  ds_read_b64_tr_b16 v[168:169], v28 offset:0
  v_mfma_f32_16x16x32_bf16 v[116:119], v[200:203], v[52:55], v[116:119]
  ds_read_b64_tr_b16 v[170:171], v28 offset:2048
  v_mfma_f32_16x16x32_bf16 v[124:127], v[204:207], v[52:55], v[124:127]
  ds_read_b64_tr_b16 v[172:173], v29 offset:0
  v_mfma_f32_16x16x32_bf16 v[120:123], v[204:207], v[48:51], v[120:123]
  ds_read_b64_tr_b16 v[174:175], v29 offset:2048
  s_waitcnt lgkmcnt(8)
  s_barrier
  v_mfma_f32_16x16x32_bf16 v[96:99], v[208:211], v[56:59], v[96:99]
  ds_read_b64_tr_b16 v[176:177], v26 offset:4096
  v_mfma_f32_16x16x32_bf16 v[100:103], v[208:211], v[60:63], v[100:103]
  ds_read_b64_tr_b16 v[178:179], v26 offset:6144
  v_mfma_f32_16x16x32_bf16 v[108:111], v[212:215], v[60:63], v[108:111]
  ds_read_b64_tr_b16 v[180:181], v27 offset:4096
  v_mfma_f32_16x16x32_bf16 v[104:107], v[212:215], v[56:59], v[104:107]
  ds_read_b64_tr_b16 v[182:183], v27 offset:6144
  v_mfma_f32_16x16x32_bf16 v[112:115], v[216:219], v[56:59], v[112:115]
  ds_read_b64_tr_b16 v[184:185], v28 offset:4096
  v_mfma_f32_16x16x32_bf16 v[116:119], v[216:219], v[60:63], v[116:119]
  ds_read_b64_tr_b16 v[186:187], v28 offset:6144
  v_readlane_b32 s49, v30, 13
  v_mfma_f32_16x16x32_bf16 v[124:127], v[220:223], v[60:63], v[124:127]
  ds_read_b64_tr_b16 v[188:189], v29 offset:4096
  v_mfma_f32_16x16x32_bf16 v[120:123], v[220:223], v[56:59], v[120:123]
  ds_read_b64_tr_b16 v[190:191], v29 offset:6144
  s_waitcnt vmcnt(18) lgkmcnt(8)
  v_mfma_f32_16x16x32_bf16 v[128:131], v[160:163], v[64:67], v[128:131]
  buffer_load_dwordx4 v[48:51], off, s[36:39], s49 offset:0 sc1
  v_mfma_f32_16x16x32_bf16 v[132:135], v[160:163], v[68:71], v[132:135]
  ds_read_b64_tr_b16 v[192:193], v26 offset:8192
  ds_read_b64_tr_b16 v[194:195], v26 offset:10240
  v_mfma_f32_16x16x32_bf16 v[140:143], v[164:167], v[68:71], v[140:143]
  ds_read_b64_tr_b16 v[196:197], v27 offset:8192
  v_mfma_f32_16x16x32_bf16 v[136:139], v[164:167], v[64:67], v[136:139]
  ds_read_b64_tr_b16 v[198:199], v27 offset:10240
  v_mfma_f32_16x16x32_bf16 v[144:147], v[168:171], v[64:67], v[144:147]
  ds_read_b64_tr_b16 v[200:201], v28 offset:8192
  v_mfma_f32_16x16x32_bf16 v[148:151], v[168:171], v[68:71], v[148:151]
  ds_read_b64_tr_b16 v[202:203], v28 offset:10240
  ds_read_b64_tr_b16 v[204:205], v29 offset:8192
  v_mfma_f32_16x16x32_bf16 v[156:159], v[172:175], v[68:71], v[156:159]
  buffer_load_dwordx4 v[52:55], off, s[64:67], s49 offset:0 sc1
  v_mfma_f32_16x16x32_bf16 v[152:155], v[172:175], v[64:67], v[152:155]
  ds_read_b64_tr_b16 v[206:207], v29 offset:10240
  s_waitcnt vmcnt(18) lgkmcnt(8)
  v_mfma_f32_16x16x32_bf16 v[128:131], v[176:179], v[72:75], v[128:131]
  ds_read_b64_tr_b16 v[208:209], v26 offset:12288
  v_mfma_f32_16x16x32_bf16 v[132:135], v[176:179], v[76:79], v[132:135]
  ds_read_b64_tr_b16 v[210:211], v26 offset:14336
  v_mfma_f32_16x16x32_bf16 v[140:143], v[180:183], v[76:79], v[140:143]
  ds_read_b64_tr_b16 v[212:213], v27 offset:12288
  v_mfma_f32_16x16x32_bf16 v[136:139], v[180:183], v[72:75], v[136:139]
  ds_read_b64_tr_b16 v[214:215], v27 offset:14336
  v_mfma_f32_16x16x32_bf16 v[144:147], v[184:187], v[72:75], v[144:147]
  buffer_load_dwordx4 v[56:59], off, s[36:39], s49 offset:1024 sc1
  v_mfma_f32_16x16x32_bf16 v[148:151], v[184:187], v[76:79], v[148:151]
  ds_read_b64_tr_b16 v[216:217], v28 offset:12288
  ds_read_b64_tr_b16 v[218:219], v28 offset:14336
  v_mfma_f32_16x16x32_bf16 v[156:159], v[188:191], v[76:79], v[156:159]
  ds_read_b64_tr_b16 v[220:221], v29 offset:12288
  v_mfma_f32_16x16x32_bf16 v[152:155], v[188:191], v[72:75], v[152:155]
  ds_read_b64_tr_b16 v[222:223], v29 offset:14336
  s_waitcnt lgkmcnt(8)
  v_mfma_f32_16x16x32_bf16 v[96:99], v[192:195], v[64:67], v[96:99]
  ds_read_b64_tr_b16 v[160:161], v26 offset:16384
  v_mfma_f32_16x16x32_bf16 v[100:103], v[192:195], v[68:71], v[100:103]
  ds_read_b64_tr_b16 v[162:163], v26 offset:18432
  v_mfma_f32_16x16x32_bf16 v[108:111], v[196:199], v[68:71], v[108:111]
  buffer_load_dwordx4 v[60:63], off, s[64:67], s49 offset:1024 sc1
  v_mfma_f32_16x16x32_bf16 v[104:107], v[196:199], v[64:67], v[104:107]
  ds_read_b64_tr_b16 v[164:165], v27 offset:16384
  ds_read_b64_tr_b16 v[166:167], v27 offset:18432
  v_mfma_f32_16x16x32_bf16 v[112:115], v[200:203], v[64:67], v[112:115]
  ds_read_b64_tr_b16 v[168:169], v28 offset:16384
  v_mfma_f32_16x16x32_bf16 v[116:119], v[200:203], v[68:71], v[116:119]
  ds_read_b64_tr_b16 v[170:171], v28 offset:18432
  v_mfma_f32_16x16x32_bf16 v[124:127], v[204:207], v[68:71], v[124:127]
  ds_read_b64_tr_b16 v[172:173], v29 offset:16384
  v_mfma_f32_16x16x32_bf16 v[120:123], v[204:207], v[64:67], v[120:123]
  ds_read_b64_tr_b16 v[174:175], v29 offset:18432
  s_waitcnt lgkmcnt(8)
  v_mfma_f32_16x16x32_bf16 v[96:99], v[208:211], v[72:75], v[96:99]
  ds_read_b64_tr_b16 v[176:177], v26 offset:20480
  v_mfma_f32_16x16x32_bf16 v[100:103], v[208:211], v[76:79], v[100:103]
  ds_read_b64_tr_b16 v[178:179], v26 offset:22528
  v_mfma_f32_16x16x32_bf16 v[108:111], v[212:215], v[76:79], v[108:111]
  ds_read_b64_tr_b16 v[180:181], v27 offset:20480
  v_mfma_f32_16x16x32_bf16 v[104:107], v[212:215], v[72:75], v[104:107]
  ds_read_b64_tr_b16 v[182:183], v27 offset:22528
  v_mfma_f32_16x16x32_bf16 v[112:115], v[216:219], v[72:75], v[112:115]
  ds_read_b64_tr_b16 v[184:185], v28 offset:20480
  v_mfma_f32_16x16x32_bf16 v[116:119], v[216:219], v[76:79], v[116:119]
  ds_read_b64_tr_b16 v[186:187], v28 offset:22528
  v_readlane_b32 s50, v30, 14
  v_mfma_f32_16x16x32_bf16 v[124:127], v[220:223], v[76:79], v[124:127]
  ds_read_b64_tr_b16 v[188:189], v29 offset:20480
  v_mfma_f32_16x16x32_bf16 v[120:123], v[220:223], v[72:75], v[120:123]
  ds_read_b64_tr_b16 v[190:191], v29 offset:22528
  s_waitcnt vmcnt(18) lgkmcnt(8)
  v_mfma_f32_16x16x32_bf16 v[128:131], v[160:163], v[80:83], v[128:131]
  buffer_load_dwordx4 v[64:67], off, s[36:39], s50 offset:0 sc1
  v_mfma_f32_16x16x32_bf16 v[132:135], v[160:163], v[84:87], v[132:135]
  ds_read_b64_tr_b16 v[192:193], v26 offset:24576
  ds_read_b64_tr_b16 v[194:195], v26 offset:26624
  v_mfma_f32_16x16x32_bf16 v[140:143], v[164:167], v[84:87], v[140:143]
  ds_read_b64_tr_b16 v[196:197], v27 offset:24576
  v_mfma_f32_16x16x32_bf16 v[136:139], v[164:167], v[80:83], v[136:139]
  ds_read_b64_tr_b16 v[198:199], v27 offset:26624
  v_mfma_f32_16x16x32_bf16 v[144:147], v[168:171], v[80:83], v[144:147]
  ds_read_b64_tr_b16 v[200:201], v28 offset:24576
  v_mfma_f32_16x16x32_bf16 v[148:151], v[168:171], v[84:87], v[148:151]
  ds_read_b64_tr_b16 v[202:203], v28 offset:26624
  ds_read_b64_tr_b16 v[204:205], v29 offset:24576
  v_mfma_f32_16x16x32_bf16 v[156:159], v[172:175], v[84:87], v[156:159]
  buffer_load_dwordx4 v[68:71], off, s[64:67], s50 offset:0 sc1
  v_mfma_f32_16x16x32_bf16 v[152:155], v[172:175], v[80:83], v[152:155]
  ds_read_b64_tr_b16 v[206:207], v29 offset:26624
  s_waitcnt vmcnt(18) lgkmcnt(8)
  v_mfma_f32_16x16x32_bf16 v[128:131], v[176:179], v[88:91], v[128:131]
  ds_read_b64_tr_b16 v[208:209], v26 offset:28672
  v_mfma_f32_16x16x32_bf16 v[132:135], v[176:179], v[92:95], v[132:135]
  ds_read_b64_tr_b16 v[210:211], v26 offset:30720
  v_mfma_f32_16x16x32_bf16 v[140:143], v[180:183], v[92:95], v[140:143]
  ds_read_b64_tr_b16 v[212:213], v27 offset:28672
  v_mfma_f32_16x16x32_bf16 v[136:139], v[180:183], v[88:91], v[136:139]
  ds_read_b64_tr_b16 v[214:215], v27 offset:30720
  v_mfma_f32_16x16x32_bf16 v[144:147], v[184:187], v[88:91], v[144:147]
  buffer_load_dwordx4 v[72:75], off, s[36:39], s50 offset:1024 sc1
  v_mfma_f32_16x16x32_bf16 v[148:151], v[184:187], v[92:95], v[148:151]
  ds_read_b64_tr_b16 v[216:217], v28 offset:28672
  ds_read_b64_tr_b16 v[218:219], v28 offset:30720
  v_mfma_f32_16x16x32_bf16 v[156:159], v[188:191], v[92:95], v[156:159]
  ds_read_b64_tr_b16 v[220:221], v29 offset:28672
  v_mfma_f32_16x16x32_bf16 v[152:155], v[188:191], v[88:91], v[152:155]
  ds_read_b64_tr_b16 v[222:223], v29 offset:30720
  s_waitcnt lgkmcnt(8)
  v_mfma_f32_16x16x32_bf16 v[96:99], v[192:195], v[80:83], v[96:99]
  ds_read_b64_tr_b16 v[160:161], v6 offset:0
  v_mfma_f32_16x16x32_bf16 v[100:103], v[192:195], v[84:87], v[100:103]
  ds_read_b64_tr_b16 v[162:163], v6 offset:2048
  v_mfma_f32_16x16x32_bf16 v[108:111], v[196:199], v[84:87], v[108:111]
  buffer_load_dwordx4 v[76:79], off, s[64:67], s50 offset:1024 sc1
  v_mfma_f32_16x16x32_bf16 v[104:107], v[196:199], v[80:83], v[104:107]
  ds_read_b64_tr_b16 v[164:165], v7 offset:0
  ds_read_b64_tr_b16 v[166:167], v7 offset:2048
  v_mfma_f32_16x16x32_bf16 v[112:115], v[200:203], v[80:83], v[112:115]
  ds_read_b64_tr_b16 v[168:169], v8 offset:0
  v_mfma_f32_16x16x32_bf16 v[116:119], v[200:203], v[84:87], v[116:119]
  ds_read_b64_tr_b16 v[170:171], v8 offset:2048
  v_mfma_f32_16x16x32_bf16 v[124:127], v[204:207], v[84:87], v[124:127]
  ds_read_b64_tr_b16 v[172:173], v9 offset:0
  v_mfma_f32_16x16x32_bf16 v[120:123], v[204:207], v[80:83], v[120:123]
  ds_read_b64_tr_b16 v[174:175], v9 offset:2048
  s_waitcnt lgkmcnt(8)
  s_barrier
  v_mfma_f32_16x16x32_bf16 v[96:99], v[208:211], v[88:91], v[96:99]
  ds_read_b64_tr_b16 v[176:177], v6 offset:4096
  v_mfma_f32_16x16x32_bf16 v[100:103], v[208:211], v[92:95], v[100:103]
  ds_read_b64_tr_b16 v[178:179], v6 offset:6144
  v_mfma_f32_16x16x32_bf16 v[108:111], v[212:215], v[92:95], v[108:111]
  ds_read_b64_tr_b16 v[180:181], v7 offset:4096
  v_mfma_f32_16x16x32_bf16 v[104:107], v[212:215], v[88:91], v[104:107]
  ds_read_b64_tr_b16 v[182:183], v7 offset:6144
  v_mfma_f32_16x16x32_bf16 v[112:115], v[216:219], v[88:91], v[112:115]
  ds_read_b64_tr_b16 v[184:185], v8 offset:4096
  v_mfma_f32_16x16x32_bf16 v[116:119], v[216:219], v[92:95], v[116:119]
  ds_read_b64_tr_b16 v[186:187], v8 offset:6144
  v_readlane_b32 s51, v30, 15
  v_mfma_f32_16x16x32_bf16 v[124:127], v[220:223], v[92:95], v[124:127]
  ds_read_b64_tr_b16 v[188:189], v9 offset:4096
  v_mfma_f32_16x16x32_bf16 v[120:123], v[220:223], v[88:91], v[120:123]
  ds_read_b64_tr_b16 v[190:191], v9 offset:6144
  s_waitcnt vmcnt(18) lgkmcnt(8)
  v_mfma_f32_16x16x32_bf16 v[128:131], v[160:163], v[224:227], v[128:131]
  buffer_load_dwordx4 v[80:83], off, s[36:39], s51 offset:0 sc1
  v_mfma_f32_16x16x32_bf16 v[132:135], v[160:163], v[228:231], v[132:135]
  ds_read_b64_tr_b16 v[192:193], v6 offset:8192
  ds_read_b64_tr_b16 v[194:195], v6 offset:10240
  v_mfma_f32_16x16x32_bf16 v[140:143], v[164:167], v[228:231], v[140:143]
  ds_read_b64_tr_b16 v[196:197], v7 offset:8192
  v_mfma_f32_16x16x32_bf16 v[136:139], v[164:167], v[224:227], v[136:139]
  ds_read_b64_tr_b16 v[198:199], v7 offset:10240
  v_mfma_f32_16x16x32_bf16 v[144:147], v[168:171], v[224:227], v[144:147]
  ds_read_b64_tr_b16 v[200:201], v8 offset:8192
  v_mfma_f32_16x16x32_bf16 v[148:151], v[168:171], v[228:231], v[148:151]
  ds_read_b64_tr_b16 v[202:203], v8 offset:10240
  ds_read_b64_tr_b16 v[204:205], v9 offset:8192
  v_mfma_f32_16x16x32_bf16 v[156:159], v[172:175], v[228:231], v[156:159]
  buffer_load_dwordx4 v[84:87], off, s[64:67], s51 offset:0 sc1
  v_mfma_f32_16x16x32_bf16 v[152:155], v[172:175], v[224:227], v[152:155]
  ds_read_b64_tr_b16 v[206:207], v9 offset:10240
  s_waitcnt vmcnt(18) lgkmcnt(8)
  v_mfma_f32_16x16x32_bf16 v[128:131], v[176:179], v[232:235], v[128:131]
  ds_read_b64_tr_b16 v[208:209], v6 offset:12288
  v_mfma_f32_16x16x32_bf16 v[132:135], v[176:179], v[236:239], v[132:135]
  ds_read_b64_tr_b16 v[210:211], v6 offset:14336
  v_mfma_f32_16x16x32_bf16 v[140:143], v[180:183], v[236:239], v[140:143]
  ds_read_b64_tr_b16 v[212:213], v7 offset:12288
  v_mfma_f32_16x16x32_bf16 v[136:139], v[180:183], v[232:235], v[136:139]
  ds_read_b64_tr_b16 v[214:215], v7 offset:14336
  v_mfma_f32_16x16x32_bf16 v[144:147], v[184:187], v[232:235], v[144:147]
  buffer_load_dwordx4 v[88:91], off, s[36:39], s51 offset:1024 sc1
  v_mfma_f32_16x16x32_bf16 v[148:151], v[184:187], v[236:239], v[148:151]
  ds_read_b64_tr_b16 v[216:217], v8 offset:12288
  ds_read_b64_tr_b16 v[218:219], v8 offset:14336
  v_mfma_f32_16x16x32_bf16 v[156:159], v[188:191], v[236:239], v[156:159]
  ds_read_b64_tr_b16 v[220:221], v9 offset:12288
  v_mfma_f32_16x16x32_bf16 v[152:155], v[188:191], v[232:235], v[152:155]
  ds_read_b64_tr_b16 v[222:223], v9 offset:14336
  s_waitcnt lgkmcnt(8)
  v_mfma_f32_16x16x32_bf16 v[96:99], v[192:195], v[224:227], v[96:99]
  ds_read_b64_tr_b16 v[160:161], v6 offset:16384
  v_mfma_f32_16x16x32_bf16 v[100:103], v[192:195], v[228:231], v[100:103]
  ds_read_b64_tr_b16 v[162:163], v6 offset:18432
  v_mfma_f32_16x16x32_bf16 v[108:111], v[196:199], v[228:231], v[108:111]
  buffer_load_dwordx4 v[92:95], off, s[64:67], s51 offset:1024 sc1
  v_mfma_f32_16x16x32_bf16 v[104:107], v[196:199], v[224:227], v[104:107]
  ds_read_b64_tr_b16 v[164:165], v7 offset:16384
  ds_read_b64_tr_b16 v[166:167], v7 offset:18432
  v_mfma_f32_16x16x32_bf16 v[112:115], v[200:203], v[224:227], v[112:115]
  ds_read_b64_tr_b16 v[168:169], v8 offset:16384
  v_mfma_f32_16x16x32_bf16 v[116:119], v[200:203], v[228:231], v[116:119]
  ds_read_b64_tr_b16 v[170:171], v8 offset:18432
  v_mfma_f32_16x16x32_bf16 v[124:127], v[204:207], v[228:231], v[124:127]
  ds_read_b64_tr_b16 v[172:173], v9 offset:16384
  v_mfma_f32_16x16x32_bf16 v[120:123], v[204:207], v[224:227], v[120:123]
  ds_read_b64_tr_b16 v[174:175], v9 offset:18432
  s_waitcnt lgkmcnt(8)
  v_mfma_f32_16x16x32_bf16 v[96:99], v[208:211], v[232:235], v[96:99]
  ds_read_b64_tr_b16 v[176:177], v6 offset:20480
  v_mfma_f32_16x16x32_bf16 v[100:103], v[208:211], v[236:239], v[100:103]
  ds_read_b64_tr_b16 v[178:179], v6 offset:22528
  v_mfma_f32_16x16x32_bf16 v[108:111], v[212:215], v[236:239], v[108:111]
  ds_read_b64_tr_b16 v[180:181], v7 offset:20480
  v_mfma_f32_16x16x32_bf16 v[104:107], v[212:215], v[232:235], v[104:107]
  ds_read_b64_tr_b16 v[182:183], v7 offset:22528
  v_mfma_f32_16x16x32_bf16 v[112:115], v[216:219], v[232:235], v[112:115]
  ds_read_b64_tr_b16 v[184:185], v8 offset:20480
  v_mfma_f32_16x16x32_bf16 v[116:119], v[216:219], v[236:239], v[116:119]
  ds_read_b64_tr_b16 v[186:187], v8 offset:22528
  v_readlane_b32 s48, v30, 16
  v_mfma_f32_16x16x32_bf16 v[124:127], v[220:223], v[236:239], v[124:127]
  ds_read_b64_tr_b16 v[188:189], v9 offset:20480
  v_mfma_f32_16x16x32_bf16 v[120:123], v[220:223], v[232:235], v[120:123]
  ds_read_b64_tr_b16 v[190:191], v9 offset:22528
  s_waitcnt vmcnt(18) lgkmcnt(8)
  v_mfma_f32_16x16x32_bf16 v[128:131], v[160:163], v[240:243], v[128:131]
  buffer_load_dwordx4 v[224:227], off, s[36:39], s48 offset:0 sc1
  v_mfma_f32_16x16x32_bf16 v[132:135], v[160:163], v[244:247], v[132:135]
  ds_read_b64_tr_b16 v[192:193], v6 offset:24576
  ds_read_b64_tr_b16 v[194:195], v6 offset:26624
  v_mfma_f32_16x16x32_bf16 v[140:143], v[164:167], v[244:247], v[140:143]
  ds_read_b64_tr_b16 v[196:197], v7 offset:24576
  v_mfma_f32_16x16x32_bf16 v[136:139], v[164:167], v[240:243], v[136:139]
  ds_read_b64_tr_b16 v[198:199], v7 offset:26624
  v_mfma_f32_16x16x32_bf16 v[144:147], v[168:171], v[240:243], v[144:147]
  ds_read_b64_tr_b16 v[200:201], v8 offset:24576
  v_mfma_f32_16x16x32_bf16 v[148:151], v[168:171], v[244:247], v[148:151]
  ds_read_b64_tr_b16 v[202:203], v8 offset:26624
  ds_read_b64_tr_b16 v[204:205], v9 offset:24576
  v_mfma_f32_16x16x32_bf16 v[156:159], v[172:175], v[244:247], v[156:159]
  buffer_load_dwordx4 v[228:231], off, s[64:67], s48 offset:0 sc1
  v_mfma_f32_16x16x32_bf16 v[152:155], v[172:175], v[240:243], v[152:155]
  ds_read_b64_tr_b16 v[206:207], v9 offset:26624
  s_waitcnt vmcnt(18) lgkmcnt(8)
  v_mfma_f32_16x16x32_bf16 v[128:131], v[176:179], v[248:251], v[128:131]
  ds_read_b64_tr_b16 v[208:209], v6 offset:28672
  v_mfma_f32_16x16x32_bf16 v[132:135], v[176:179], v[252:255], v[132:135]
  ds_read_b64_tr_b16 v[210:211], v6 offset:30720
  v_mfma_f32_16x16x32_bf16 v[140:143], v[180:183], v[252:255], v[140:143]
  ds_read_b64_tr_b16 v[212:213], v7 offset:28672
  v_mfma_f32_16x16x32_bf16 v[136:139], v[180:183], v[248:251], v[136:139]
  ds_read_b64_tr_b16 v[214:215], v7 offset:30720
  v_mfma_f32_16x16x32_bf16 v[144:147], v[184:187], v[248:251], v[144:147]
  buffer_load_dwordx4 v[232:235], off, s[36:39], s48 offset:1024 sc1
  v_mfma_f32_16x16x32_bf16 v[148:151], v[184:187], v[252:255], v[148:151]
  ds_read_b64_tr_b16 v[216:217], v8 offset:28672
  ds_read_b64_tr_b16 v[218:219], v8 offset:30720
  v_mfma_f32_16x16x32_bf16 v[156:159], v[188:191], v[252:255], v[156:159]
  ds_read_b64_tr_b16 v[220:221], v9 offset:28672
  v_mfma_f32_16x16x32_bf16 v[152:155], v[188:191], v[248:251], v[152:155]
  ds_read_b64_tr_b16 v[222:223], v9 offset:30720
  s_waitcnt lgkmcnt(8)
  v_mfma_f32_16x16x32_bf16 v[96:99], v[192:195], v[240:243], v[96:99]
  ds_read_b64_tr_b16 v[160:161], v6 offset:32768
  v_mfma_f32_16x16x32_bf16 v[100:103], v[192:195], v[244:247], v[100:103]
  ds_read_b64_tr_b16 v[162:163], v6 offset:34816
  v_mfma_f32_16x16x32_bf16 v[108:111], v[196:199], v[244:247], v[108:111]
  buffer_load_dwordx4 v[236:239], off, s[64:67], s48 offset:1024 sc1
  v_mfma_f32_16x16x32_bf16 v[104:107], v[196:199], v[240:243], v[104:107]
  ds_read_b64_tr_b16 v[164:165], v7 offset:32768
  ds_read_b64_tr_b16 v[166:167], v7 offset:34816
  v_mfma_f32_16x16x32_bf16 v[112:115], v[200:203], v[240:243], v[112:115]
  ds_read_b64_tr_b16 v[168:169], v8 offset:32768
  v_mfma_f32_16x16x32_bf16 v[116:119], v[200:203], v[244:247], v[116:119]
  ds_read_b64_tr_b16 v[170:171], v8 offset:34816
  v_mfma_f32_16x16x32_bf16 v[124:127], v[204:207], v[244:247], v[124:127]
  ds_read_b64_tr_b16 v[172:173], v9 offset:32768
  v_mfma_f32_16x16x32_bf16 v[120:123], v[204:207], v[240:243], v[120:123]
  ds_read_b64_tr_b16 v[174:175], v9 offset:34816
  s_waitcnt lgkmcnt(8)
  s_barrier
  v_mfma_f32_16x16x32_bf16 v[96:99], v[208:211], v[248:251], v[96:99]
  ds_read_b64_tr_b16 v[176:177], v6 offset:36864
  v_mfma_f32_16x16x32_bf16 v[100:103], v[208:211], v[252:255], v[100:103]
  ds_read_b64_tr_b16 v[178:179], v6 offset:38912
  v_mfma_f32_16x16x32_bf16 v[108:111], v[212:215], v[252:255], v[108:111]
  ds_read_b64_tr_b16 v[180:181], v7 offset:36864
  v_mfma_f32_16x16x32_bf16 v[104:107], v[212:215], v[248:251], v[104:107]
  ds_read_b64_tr_b16 v[182:183], v7 offset:38912
  v_mfma_f32_16x16x32_bf16 v[112:115], v[216:219], v[248:251], v[112:115]
  ds_read_b64_tr_b16 v[184:185], v8 offset:36864
  v_mfma_f32_16x16x32_bf16 v[116:119], v[216:219], v[252:255], v[116:119]
  ds_read_b64_tr_b16 v[186:187], v8 offset:38912
  v_readlane_b32 s49, v30, 17
  v_mfma_f32_16x16x32_bf16 v[124:127], v[220:223], v[252:255], v[124:127]
  ds_read_b64_tr_b16 v[188:189], v9 offset:36864
  v_mfma_f32_16x16x32_bf16 v[120:123], v[220:223], v[248:251], v[120:123]
  ds_read_b64_tr_b16 v[190:191], v9 offset:38912
  s_waitcnt vmcnt(18) lgkmcnt(8)
  v_mfma_f32_16x16x32_bf16 v[128:131], v[160:163], v[32:35], v[128:131]
  buffer_load_dwordx4 v[240:243], off, s[36:39], s49 offset:0 sc1
  v_mfma_f32_16x16x32_bf16 v[132:135], v[160:163], v[36:39], v[132:135]
  ds_read_b64_tr_b16 v[192:193], v6 offset:40960
  ds_read_b64_tr_b16 v[194:195], v6 offset:43008
  v_mfma_f32_16x16x32_bf16 v[140:143], v[164:167], v[36:39], v[140:143]
  ds_read_b64_tr_b16 v[196:197], v7 offset:40960
  v_mfma_f32_16x16x32_bf16 v[136:139], v[164:167], v[32:35], v[136:139]
  ds_read_b64_tr_b16 v[198:199], v7 offset:43008
  v_mfma_f32_16x16x32_bf16 v[144:147], v[168:171], v[32:35], v[144:147]
  ds_read_b64_tr_b16 v[200:201], v8 offset:40960
  v_mfma_f32_16x16x32_bf16 v[148:151], v[168:171], v[36:39], v[148:151]
  ds_read_b64_tr_b16 v[202:203], v8 offset:43008
  ds_read_b64_tr_b16 v[204:205], v9 offset:40960
  v_mfma_f32_16x16x32_bf16 v[156:159], v[172:175], v[36:39], v[156:159]
  buffer_load_dwordx4 v[244:247], off, s[64:67], s49 offset:0 sc1
  v_mfma_f32_16x16x32_bf16 v[152:155], v[172:175], v[32:35], v[152:155]
  ds_read_b64_tr_b16 v[206:207], v9 offset:43008
  s_waitcnt vmcnt(18) lgkmcnt(8)
  v_mfma_f32_16x16x32_bf16 v[128:131], v[176:179], v[40:43], v[128:131]
  ds_read_b64_tr_b16 v[208:209], v6 offset:45056
  v_mfma_f32_16x16x32_bf16 v[132:135], v[176:179], v[44:47], v[132:135]
  ds_read_b64_tr_b16 v[210:211], v6 offset:47104
  v_mfma_f32_16x16x32_bf16 v[140:143], v[180:183], v[44:47], v[140:143]
  ds_read_b64_tr_b16 v[212:213], v7 offset:45056
  v_mfma_f32_16x16x32_bf16 v[136:139], v[180:183], v[40:43], v[136:139]
  ds_read_b64_tr_b16 v[214:215], v7 offset:47104
  v_mfma_f32_16x16x32_bf16 v[144:147], v[184:187], v[40:43], v[144:147]
  buffer_load_dwordx4 v[248:251], off, s[36:39], s49 offset:1024 sc1
  v_mfma_f32_16x16x32_bf16 v[148:151], v[184:187], v[44:47], v[148:151]
  ds_read_b64_tr_b16 v[216:217], v8 offset:45056
  ds_read_b64_tr_b16 v[218:219], v8 offset:47104
  v_mfma_f32_16x16x32_bf16 v[156:159], v[188:191], v[44:47], v[156:159]
  ds_read_b64_tr_b16 v[220:221], v9 offset:45056
  v_mfma_f32_16x16x32_bf16 v[152:155], v[188:191], v[40:43], v[152:155]
  ds_read_b64_tr_b16 v[222:223], v9 offset:47104
  s_waitcnt lgkmcnt(8)
  v_mfma_f32_16x16x32_bf16 v[96:99], v[192:195], v[32:35], v[96:99]
  ds_read_b64_tr_b16 v[160:161], v6 offset:49152
  v_mfma_f32_16x16x32_bf16 v[100:103], v[192:195], v[36:39], v[100:103]
  ds_read_b64_tr_b16 v[162:163], v6 offset:51200
  v_mfma_f32_16x16x32_bf16 v[108:111], v[196:199], v[36:39], v[108:111]
  buffer_load_dwordx4 v[252:255], off, s[64:67], s49 offset:1024 sc1
  v_mfma_f32_16x16x32_bf16 v[104:107], v[196:199], v[32:35], v[104:107]
  ds_read_b64_tr_b16 v[164:165], v7 offset:49152
  ds_read_b64_tr_b16 v[166:167], v7 offset:51200
  v_mfma_f32_16x16x32_bf16 v[112:115], v[200:203], v[32:35], v[112:115]
  ds_read_b64_tr_b16 v[168:169], v8 offset:49152
  v_mfma_f32_16x16x32_bf16 v[116:119], v[200:203], v[36:39], v[116:119]
  ds_read_b64_tr_b16 v[170:171], v8 offset:51200
  v_mfma_f32_16x16x32_bf16 v[124:127], v[204:207], v[36:39], v[124:127]
  ds_read_b64_tr_b16 v[172:173], v9 offset:49152
  v_mfma_f32_16x16x32_bf16 v[120:123], v[204:207], v[32:35], v[120:123]
  ds_read_b64_tr_b16 v[174:175], v9 offset:51200
  s_waitcnt lgkmcnt(8)
  v_mfma_f32_16x16x32_bf16 v[96:99], v[208:211], v[40:43], v[96:99]
  ds_read_b64_tr_b16 v[176:177], v6 offset:53248
  v_mfma_f32_16x16x32_bf16 v[100:103], v[208:211], v[44:47], v[100:103]
  ds_read_b64_tr_b16 v[178:179], v6 offset:55296
  v_mfma_f32_16x16x32_bf16 v[108:111], v[212:215], v[44:47], v[108:111]
  ds_read_b64_tr_b16 v[180:181], v7 offset:53248
  v_mfma_f32_16x16x32_bf16 v[104:107], v[212:215], v[40:43], v[104:107]
  ds_read_b64_tr_b16 v[182:183], v7 offset:55296
  v_mfma_f32_16x16x32_bf16 v[112:115], v[216:219], v[40:43], v[112:115]
  ds_read_b64_tr_b16 v[184:185], v8 offset:53248
  v_mfma_f32_16x16x32_bf16 v[116:119], v[216:219], v[44:47], v[116:119]
  ds_read_b64_tr_b16 v[186:187], v8 offset:55296
  v_readlane_b32 s50, v30, 18
  v_mfma_f32_16x16x32_bf16 v[124:127], v[220:223], v[44:47], v[124:127]
  ds_read_b64_tr_b16 v[188:189], v9 offset:53248
  v_mfma_f32_16x16x32_bf16 v[120:123], v[220:223], v[40:43], v[120:123]
  ds_read_b64_tr_b16 v[190:191], v9 offset:55296
  s_waitcnt vmcnt(18) lgkmcnt(8)
  v_mfma_f32_16x16x32_bf16 v[128:131], v[160:163], v[48:51], v[128:131]
  buffer_load_dwordx4 v[32:35], off, s[36:39], s50 offset:0 sc1
  v_mfma_f32_16x16x32_bf16 v[132:135], v[160:163], v[52:55], v[132:135]
  ds_read_b64_tr_b16 v[192:193], v6 offset:57344
  ds_read_b64_tr_b16 v[194:195], v6 offset:59392
  v_mfma_f32_16x16x32_bf16 v[140:143], v[164:167], v[52:55], v[140:143]
  ds_read_b64_tr_b16 v[196:197], v7 offset:57344
  v_mfma_f32_16x16x32_bf16 v[136:139], v[164:167], v[48:51], v[136:139]
  ds_read_b64_tr_b16 v[198:199], v7 offset:59392
  v_mfma_f32_16x16x32_bf16 v[144:147], v[168:171], v[48:51], v[144:147]
  ds_read_b64_tr_b16 v[200:201], v8 offset:57344
  v_mfma_f32_16x16x32_bf16 v[148:151], v[168:171], v[52:55], v[148:151]
  ds_read_b64_tr_b16 v[202:203], v8 offset:59392
  ds_read_b64_tr_b16 v[204:205], v9 offset:57344
  v_mfma_f32_16x16x32_bf16 v[156:159], v[172:175], v[52:55], v[156:159]
  buffer_load_dwordx4 v[36:39], off, s[64:67], s50 offset:0 sc1
  v_mfma_f32_16x16x32_bf16 v[152:155], v[172:175], v[48:51], v[152:155]
  ds_read_b64_tr_b16 v[206:207], v9 offset:59392
  s_waitcnt vmcnt(18) lgkmcnt(8)
  v_mfma_f32_16x16x32_bf16 v[128:131], v[176:179], v[56:59], v[128:131]
  ds_read_b64_tr_b16 v[208:209], v6 offset:61440
  v_mfma_f32_16x16x32_bf16 v[132:135], v[176:179], v[60:63], v[132:135]
  ds_read_b64_tr_b16 v[210:211], v6 offset:63488
  v_mfma_f32_16x16x32_bf16 v[140:143], v[180:183], v[60:63], v[140:143]
  ds_read_b64_tr_b16 v[212:213], v7 offset:61440
  v_mfma_f32_16x16x32_bf16 v[136:139], v[180:183], v[56:59], v[136:139]
  ds_read_b64_tr_b16 v[214:215], v7 offset:63488
  v_mfma_f32_16x16x32_bf16 v[144:147], v[184:187], v[56:59], v[144:147]
  buffer_load_dwordx4 v[40:43], off, s[36:39], s50 offset:1024 sc1
  v_mfma_f32_16x16x32_bf16 v[148:151], v[184:187], v[60:63], v[148:151]
  ds_read_b64_tr_b16 v[216:217], v8 offset:61440
  ds_read_b64_tr_b16 v[218:219], v8 offset:63488
  v_mfma_f32_16x16x32_bf16 v[156:159], v[188:191], v[60:63], v[156:159]
  ds_read_b64_tr_b16 v[220:221], v9 offset:61440
  v_mfma_f32_16x16x32_bf16 v[152:155], v[188:191], v[56:59], v[152:155]
  ds_read_b64_tr_b16 v[222:223], v9 offset:63488
  s_waitcnt lgkmcnt(8)
  v_mfma_f32_16x16x32_bf16 v[96:99], v[192:195], v[48:51], v[96:99]
  ds_read_b64_tr_b16 v[160:161], v20 offset:0
  v_mfma_f32_16x16x32_bf16 v[100:103], v[192:195], v[52:55], v[100:103]
  ds_read_b64_tr_b16 v[162:163], v20 offset:2048
  v_mfma_f32_16x16x32_bf16 v[108:111], v[196:199], v[52:55], v[108:111]
  buffer_load_dwordx4 v[44:47], off, s[64:67], s50 offset:1024 sc1
  v_mfma_f32_16x16x32_bf16 v[104:107], v[196:199], v[48:51], v[104:107]
  ds_read_b64_tr_b16 v[164:165], v21 offset:0
  ds_read_b64_tr_b16 v[166:167], v21 offset:2048
  v_mfma_f32_16x16x32_bf16 v[112:115], v[200:203], v[48:51], v[112:115]
  ds_read_b64_tr_b16 v[168:169], v22 offset:0
  v_mfma_f32_16x16x32_bf16 v[116:119], v[200:203], v[52:55], v[116:119]
  ds_read_b64_tr_b16 v[170:171], v22 offset:2048
  v_mfma_f32_16x16x32_bf16 v[124:127], v[204:207], v[52:55], v[124:127]
  ds_read_b64_tr_b16 v[172:173], v23 offset:0
  v_mfma_f32_16x16x32_bf16 v[120:123], v[204:207], v[48:51], v[120:123]
  ds_read_b64_tr_b16 v[174:175], v23 offset:2048
  s_waitcnt lgkmcnt(8)
  s_barrier
  v_mfma_f32_16x16x32_bf16 v[96:99], v[208:211], v[56:59], v[96:99]
  ds_read_b64_tr_b16 v[176:177], v20 offset:4096
  v_mfma_f32_16x16x32_bf16 v[100:103], v[208:211], v[60:63], v[100:103]
  ds_read_b64_tr_b16 v[178:179], v20 offset:6144
  v_mfma_f32_16x16x32_bf16 v[108:111], v[212:215], v[60:63], v[108:111]
  ds_read_b64_tr_b16 v[180:181], v21 offset:4096
  v_mfma_f32_16x16x32_bf16 v[104:107], v[212:215], v[56:59], v[104:107]
  ds_read_b64_tr_b16 v[182:183], v21 offset:6144
  v_mfma_f32_16x16x32_bf16 v[112:115], v[216:219], v[56:59], v[112:115]
  ds_read_b64_tr_b16 v[184:185], v22 offset:4096
  v_mfma_f32_16x16x32_bf16 v[116:119], v[216:219], v[60:63], v[116:119]
  ds_read_b64_tr_b16 v[186:187], v22 offset:6144
  v_readlane_b32 s51, v30, 19
  v_mfma_f32_16x16x32_bf16 v[124:127], v[220:223], v[60:63], v[124:127]
  ds_read_b64_tr_b16 v[188:189], v23 offset:4096
  v_mfma_f32_16x16x32_bf16 v[120:123], v[220:223], v[56:59], v[120:123]
  ds_read_b64_tr_b16 v[190:191], v23 offset:6144
  s_waitcnt vmcnt(18) lgkmcnt(8)
  v_mfma_f32_16x16x32_bf16 v[128:131], v[160:163], v[64:67], v[128:131]
  buffer_load_dwordx4 v[48:51], off, s[36:39], s51 offset:0 sc1
  v_mfma_f32_16x16x32_bf16 v[132:135], v[160:163], v[68:71], v[132:135]
  ds_read_b64_tr_b16 v[192:193], v20 offset:8192
  ds_read_b64_tr_b16 v[194:195], v20 offset:10240
  v_mfma_f32_16x16x32_bf16 v[140:143], v[164:167], v[68:71], v[140:143]
  ds_read_b64_tr_b16 v[196:197], v21 offset:8192
  v_mfma_f32_16x16x32_bf16 v[136:139], v[164:167], v[64:67], v[136:139]
  ds_read_b64_tr_b16 v[198:199], v21 offset:10240
  v_mfma_f32_16x16x32_bf16 v[144:147], v[168:171], v[64:67], v[144:147]
  ds_read_b64_tr_b16 v[200:201], v22 offset:8192
  v_mfma_f32_16x16x32_bf16 v[148:151], v[168:171], v[68:71], v[148:151]
  ds_read_b64_tr_b16 v[202:203], v22 offset:10240
  ds_read_b64_tr_b16 v[204:205], v23 offset:8192
  v_mfma_f32_16x16x32_bf16 v[156:159], v[172:175], v[68:71], v[156:159]
  buffer_load_dwordx4 v[52:55], off, s[64:67], s51 offset:0 sc1
  v_mfma_f32_16x16x32_bf16 v[152:155], v[172:175], v[64:67], v[152:155]
  ds_read_b64_tr_b16 v[206:207], v23 offset:10240
  s_waitcnt vmcnt(18) lgkmcnt(8)
  v_mfma_f32_16x16x32_bf16 v[128:131], v[176:179], v[72:75], v[128:131]
  ds_read_b64_tr_b16 v[208:209], v20 offset:12288
  v_mfma_f32_16x16x32_bf16 v[132:135], v[176:179], v[76:79], v[132:135]
  ds_read_b64_tr_b16 v[210:211], v20 offset:14336
  v_mfma_f32_16x16x32_bf16 v[140:143], v[180:183], v[76:79], v[140:143]
  ds_read_b64_tr_b16 v[212:213], v21 offset:12288
  v_mfma_f32_16x16x32_bf16 v[136:139], v[180:183], v[72:75], v[136:139]
  ds_read_b64_tr_b16 v[214:215], v21 offset:14336
  v_mfma_f32_16x16x32_bf16 v[144:147], v[184:187], v[72:75], v[144:147]
  buffer_load_dwordx4 v[56:59], off, s[36:39], s51 offset:1024 sc1
  v_mfma_f32_16x16x32_bf16 v[148:151], v[184:187], v[76:79], v[148:151]
  ds_read_b64_tr_b16 v[216:217], v22 offset:12288
  ds_read_b64_tr_b16 v[218:219], v22 offset:14336
  v_mfma_f32_16x16x32_bf16 v[156:159], v[188:191], v[76:79], v[156:159]
  ds_read_b64_tr_b16 v[220:221], v23 offset:12288
  v_mfma_f32_16x16x32_bf16 v[152:155], v[188:191], v[72:75], v[152:155]
  ds_read_b64_tr_b16 v[222:223], v23 offset:14336
  s_waitcnt lgkmcnt(8)
  v_mfma_f32_16x16x32_bf16 v[96:99], v[192:195], v[64:67], v[96:99]
  ds_read_b64_tr_b16 v[160:161], v20 offset:16384
  v_mfma_f32_16x16x32_bf16 v[100:103], v[192:195], v[68:71], v[100:103]
  ds_read_b64_tr_b16 v[162:163], v20 offset:18432
  v_mfma_f32_16x16x32_bf16 v[108:111], v[196:199], v[68:71], v[108:111]
  buffer_load_dwordx4 v[60:63], off, s[64:67], s51 offset:1024 sc1
  v_mfma_f32_16x16x32_bf16 v[104:107], v[196:199], v[64:67], v[104:107]
  ds_read_b64_tr_b16 v[164:165], v21 offset:16384
  ds_read_b64_tr_b16 v[166:167], v21 offset:18432
  v_mfma_f32_16x16x32_bf16 v[112:115], v[200:203], v[64:67], v[112:115]
  ds_read_b64_tr_b16 v[168:169], v22 offset:16384
  v_mfma_f32_16x16x32_bf16 v[116:119], v[200:203], v[68:71], v[116:119]
  ds_read_b64_tr_b16 v[170:171], v22 offset:18432
  v_mfma_f32_16x16x32_bf16 v[124:127], v[204:207], v[68:71], v[124:127]
  ds_read_b64_tr_b16 v[172:173], v23 offset:16384
  v_mfma_f32_16x16x32_bf16 v[120:123], v[204:207], v[64:67], v[120:123]
  ds_read_b64_tr_b16 v[174:175], v23 offset:18432
  s_waitcnt lgkmcnt(8)
  v_mfma_f32_16x16x32_bf16 v[96:99], v[208:211], v[72:75], v[96:99]
  ds_read_b64_tr_b16 v[176:177], v20 offset:20480
  v_mfma_f32_16x16x32_bf16 v[100:103], v[208:211], v[76:79], v[100:103]
  ds_read_b64_tr_b16 v[178:179], v20 offset:22528
  v_mfma_f32_16x16x32_bf16 v[108:111], v[212:215], v[76:79], v[108:111]
  ds_read_b64_tr_b16 v[180:181], v21 offset:20480
  v_mfma_f32_16x16x32_bf16 v[104:107], v[212:215], v[72:75], v[104:107]
  ds_read_b64_tr_b16 v[182:183], v21 offset:22528
  v_mfma_f32_16x16x32_bf16 v[112:115], v[216:219], v[72:75], v[112:115]
  ds_read_b64_tr_b16 v[184:185], v22 offset:20480
  v_mfma_f32_16x16x32_bf16 v[116:119], v[216:219], v[76:79], v[116:119]
  ds_read_b64_tr_b16 v[186:187], v22 offset:22528
  v_readlane_b32 s48, v30, 20
  v_mfma_f32_16x16x32_bf16 v[124:127], v[220:223], v[76:79], v[124:127]
  ds_read_b64_tr_b16 v[188:189], v23 offset:20480
  v_mfma_f32_16x16x32_bf16 v[120:123], v[220:223], v[72:75], v[120:123]
  ds_read_b64_tr_b16 v[190:191], v23 offset:22528
  s_waitcnt vmcnt(18) lgkmcnt(8)
  v_mfma_f32_16x16x32_bf16 v[128:131], v[160:163], v[80:83], v[128:131]
  buffer_load_dwordx4 v[64:67], off, s[36:39], s48 offset:0 sc1
  v_mfma_f32_16x16x32_bf16 v[132:135], v[160:163], v[84:87], v[132:135]
  ds_read_b64_tr_b16 v[192:193], v20 offset:24576
  ds_read_b64_tr_b16 v[194:195], v20 offset:26624
  v_mfma_f32_16x16x32_bf16 v[140:143], v[164:167], v[84:87], v[140:143]
  ds_read_b64_tr_b16 v[196:197], v21 offset:24576
  v_mfma_f32_16x16x32_bf16 v[136:139], v[164:167], v[80:83], v[136:139]
  ds_read_b64_tr_b16 v[198:199], v21 offset:26624
  v_mfma_f32_16x16x32_bf16 v[144:147], v[168:171], v[80:83], v[144:147]
  ds_read_b64_tr_b16 v[200:201], v22 offset:24576
  v_mfma_f32_16x16x32_bf16 v[148:151], v[168:171], v[84:87], v[148:151]
  ds_read_b64_tr_b16 v[202:203], v22 offset:26624
  ds_read_b64_tr_b16 v[204:205], v23 offset:24576
  v_mfma_f32_16x16x32_bf16 v[156:159], v[172:175], v[84:87], v[156:159]
  buffer_load_dwordx4 v[68:71], off, s[64:67], s48 offset:0 sc1
  v_mfma_f32_16x16x32_bf16 v[152:155], v[172:175], v[80:83], v[152:155]
  ds_read_b64_tr_b16 v[206:207], v23 offset:26624
  s_waitcnt vmcnt(18) lgkmcnt(8)
  v_mfma_f32_16x16x32_bf16 v[128:131], v[176:179], v[88:91], v[128:131]
  ds_read_b64_tr_b16 v[208:209], v20 offset:28672
  v_mfma_f32_16x16x32_bf16 v[132:135], v[176:179], v[92:95], v[132:135]
  ds_read_b64_tr_b16 v[210:211], v20 offset:30720
  v_mfma_f32_16x16x32_bf16 v[140:143], v[180:183], v[92:95], v[140:143]
  ds_read_b64_tr_b16 v[212:213], v21 offset:28672
  v_mfma_f32_16x16x32_bf16 v[136:139], v[180:183], v[88:91], v[136:139]
  ds_read_b64_tr_b16 v[214:215], v21 offset:30720
  v_mfma_f32_16x16x32_bf16 v[144:147], v[184:187], v[88:91], v[144:147]
  buffer_load_dwordx4 v[72:75], off, s[36:39], s48 offset:1024 sc1
  v_mfma_f32_16x16x32_bf16 v[148:151], v[184:187], v[92:95], v[148:151]
  ds_read_b64_tr_b16 v[216:217], v22 offset:28672
  ds_read_b64_tr_b16 v[218:219], v22 offset:30720
  v_mfma_f32_16x16x32_bf16 v[156:159], v[188:191], v[92:95], v[156:159]
  ds_read_b64_tr_b16 v[220:221], v23 offset:28672
  v_mfma_f32_16x16x32_bf16 v[152:155], v[188:191], v[88:91], v[152:155]
  ds_read_b64_tr_b16 v[222:223], v23 offset:30720
  s_waitcnt lgkmcnt(8)
  v_mfma_f32_16x16x32_bf16 v[96:99], v[192:195], v[80:83], v[96:99]
  ds_read_b64_tr_b16 v[160:161], v20 offset:32768
  v_mfma_f32_16x16x32_bf16 v[100:103], v[192:195], v[84:87], v[100:103]
  ds_read_b64_tr_b16 v[162:163], v20 offset:34816
  v_mfma_f32_16x16x32_bf16 v[108:111], v[196:199], v[84:87], v[108:111]
  buffer_load_dwordx4 v[76:79], off, s[64:67], s48 offset:1024 sc1
  v_mfma_f32_16x16x32_bf16 v[104:107], v[196:199], v[80:83], v[104:107]
  ds_read_b64_tr_b16 v[164:165], v21 offset:32768
  ds_read_b64_tr_b16 v[166:167], v21 offset:34816
  v_mfma_f32_16x16x32_bf16 v[112:115], v[200:203], v[80:83], v[112:115]
  ds_read_b64_tr_b16 v[168:169], v22 offset:32768
  v_mfma_f32_16x16x32_bf16 v[116:119], v[200:203], v[84:87], v[116:119]
  ds_read_b64_tr_b16 v[170:171], v22 offset:34816
  v_mfma_f32_16x16x32_bf16 v[124:127], v[204:207], v[84:87], v[124:127]
  ds_read_b64_tr_b16 v[172:173], v23 offset:32768
  v_mfma_f32_16x16x32_bf16 v[120:123], v[204:207], v[80:83], v[120:123]
  ds_read_b64_tr_b16 v[174:175], v23 offset:34816
  s_waitcnt lgkmcnt(8)
  s_barrier
  v_mfma_f32_16x16x32_bf16 v[96:99], v[208:211], v[88:91], v[96:99]
  ds_read_b64_tr_b16 v[176:177], v20 offset:36864
  v_mfma_f32_16x16x32_bf16 v[100:103], v[208:211], v[92:95], v[100:103]
  ds_read_b64_tr_b16 v[178:179], v20 offset:38912
  v_mfma_f32_16x16x32_bf16 v[108:111], v[212:215], v[92:95], v[108:111]
  ds_read_b64_tr_b16 v[180:181], v21 offset:36864
  v_mfma_f32_16x16x32_bf16 v[104:107], v[212:215], v[88:91], v[104:107]
  ds_read_b64_tr_b16 v[182:183], v21 offset:38912
  v_mfma_f32_16x16x32_bf16 v[112:115], v[216:219], v[88:91], v[112:115]
  ds_read_b64_tr_b16 v[184:185], v22 offset:36864
  v_mfma_f32_16x16x32_bf16 v[116:119], v[216:219], v[92:95], v[116:119]
  ds_read_b64_tr_b16 v[186:187], v22 offset:38912
  v_readlane_b32 s49, v30, 21
  v_mfma_f32_16x16x32_bf16 v[124:127], v[220:223], v[92:95], v[124:127]
  ds_read_b64_tr_b16 v[188:189], v23 offset:36864
  v_mfma_f32_16x16x32_bf16 v[120:123], v[220:223], v[88:91], v[120:123]
  ds_read_b64_tr_b16 v[190:191], v23 offset:38912
  s_waitcnt vmcnt(18) lgkmcnt(8)
  v_mfma_f32_16x16x32_bf16 v[128:131], v[160:163], v[224:227], v[128:131]
  buffer_load_dwordx4 v[80:83], off, s[36:39], s49 offset:0 sc1
  v_mfma_f32_16x16x32_bf16 v[132:135], v[160:163], v[228:231], v[132:135]
  ds_read_b64_tr_b16 v[192:193], v20 offset:40960
  ds_read_b64_tr_b16 v[194:195], v20 offset:43008
  v_mfma_f32_16x16x32_bf16 v[140:143], v[164:167], v[228:231], v[140:143]
  ds_read_b64_tr_b16 v[196:197], v21 offset:40960
  v_mfma_f32_16x16x32_bf16 v[136:139], v[164:167], v[224:227], v[136:139]
  ds_read_b64_tr_b16 v[198:199], v21 offset:43008
  v_mfma_f32_16x16x32_bf16 v[144:147], v[168:171], v[224:227], v[144:147]
  ds_read_b64_tr_b16 v[200:201], v22 offset:40960
  v_mfma_f32_16x16x32_bf16 v[148:151], v[168:171], v[228:231], v[148:151]
  ds_read_b64_tr_b16 v[202:203], v22 offset:43008
  ds_read_b64_tr_b16 v[204:205], v23 offset:40960
  v_mfma_f32_16x16x32_bf16 v[156:159], v[172:175], v[228:231], v[156:159]
  buffer_load_dwordx4 v[84:87], off, s[64:67], s49 offset:0 sc1
  v_mfma_f32_16x16x32_bf16 v[152:155], v[172:175], v[224:227], v[152:155]
  ds_read_b64_tr_b16 v[206:207], v23 offset:43008
  s_waitcnt vmcnt(18) lgkmcnt(8)
  v_mfma_f32_16x16x32_bf16 v[128:131], v[176:179], v[232:235], v[128:131]
  ds_read_b64_tr_b16 v[208:209], v20 offset:45056
  v_mfma_f32_16x16x32_bf16 v[132:135], v[176:179], v[236:239], v[132:135]
  ds_read_b64_tr_b16 v[210:211], v20 offset:47104
  v_mfma_f32_16x16x32_bf16 v[140:143], v[180:183], v[236:239], v[140:143]
  ds_read_b64_tr_b16 v[212:213], v21 offset:45056
  v_mfma_f32_16x16x32_bf16 v[136:139], v[180:183], v[232:235], v[136:139]
  ds_read_b64_tr_b16 v[214:215], v21 offset:47104
  v_mfma_f32_16x16x32_bf16 v[144:147], v[184:187], v[232:235], v[144:147]
  buffer_load_dwordx4 v[88:91], off, s[36:39], s49 offset:1024 sc1
  v_mfma_f32_16x16x32_bf16 v[148:151], v[184:187], v[236:239], v[148:151]
  ds_read_b64_tr_b16 v[216:217], v22 offset:45056
  ds_read_b64_tr_b16 v[218:219], v22 offset:47104
  v_mfma_f32_16x16x32_bf16 v[156:159], v[188:191], v[236:239], v[156:159]
  ds_read_b64_tr_b16 v[220:221], v23 offset:45056
  v_mfma_f32_16x16x32_bf16 v[152:155], v[188:191], v[232:235], v[152:155]
  ds_read_b64_tr_b16 v[222:223], v23 offset:47104
  s_waitcnt lgkmcnt(8)
  v_mfma_f32_16x16x32_bf16 v[96:99], v[192:195], v[224:227], v[96:99]
  ds_read_b64_tr_b16 v[160:161], v20 offset:49152
  v_mfma_f32_16x16x32_bf16 v[100:103], v[192:195], v[228:231], v[100:103]
  ds_read_b64_tr_b16 v[162:163], v20 offset:51200
  v_mfma_f32_16x16x32_bf16 v[108:111], v[196:199], v[228:231], v[108:111]
  buffer_load_dwordx4 v[92:95], off, s[64:67], s49 offset:1024 sc1
  v_mfma_f32_16x16x32_bf16 v[104:107], v[196:199], v[224:227], v[104:107]
  ds_read_b64_tr_b16 v[164:165], v21 offset:49152
  ds_read_b64_tr_b16 v[166:167], v21 offset:51200
  v_mfma_f32_16x16x32_bf16 v[112:115], v[200:203], v[224:227], v[112:115]
  ds_read_b64_tr_b16 v[168:169], v22 offset:49152
  v_mfma_f32_16x16x32_bf16 v[116:119], v[200:203], v[228:231], v[116:119]
  ds_read_b64_tr_b16 v[170:171], v22 offset:51200
  v_mfma_f32_16x16x32_bf16 v[124:127], v[204:207], v[228:231], v[124:127]
  ds_read_b64_tr_b16 v[172:173], v23 offset:49152
  v_mfma_f32_16x16x32_bf16 v[120:123], v[204:207], v[224:227], v[120:123]
  ds_read_b64_tr_b16 v[174:175], v23 offset:51200
  s_waitcnt lgkmcnt(8)
  v_mfma_f32_16x16x32_bf16 v[96:99], v[208:211], v[232:235], v[96:99]
  ds_read_b64_tr_b16 v[176:177], v20 offset:53248
  v_mfma_f32_16x16x32_bf16 v[100:103], v[208:211], v[236:239], v[100:103]
  ds_read_b64_tr_b16 v[178:179], v20 offset:55296
  v_mfma_f32_16x16x32_bf16 v[108:111], v[212:215], v[236:239], v[108:111]
  ds_read_b64_tr_b16 v[180:181], v21 offset:53248
  v_mfma_f32_16x16x32_bf16 v[104:107], v[212:215], v[232:235], v[104:107]
  ds_read_b64_tr_b16 v[182:183], v21 offset:55296
  v_mfma_f32_16x16x32_bf16 v[112:115], v[216:219], v[232:235], v[112:115]
  ds_read_b64_tr_b16 v[184:185], v22 offset:53248
  v_mfma_f32_16x16x32_bf16 v[116:119], v[216:219], v[236:239], v[116:119]
  ds_read_b64_tr_b16 v[186:187], v22 offset:55296
  v_readlane_b32 s50, v30, 22
  v_mfma_f32_16x16x32_bf16 v[124:127], v[220:223], v[236:239], v[124:127]
  ds_read_b64_tr_b16 v[188:189], v23 offset:53248
  v_mfma_f32_16x16x32_bf16 v[120:123], v[220:223], v[232:235], v[120:123]
  ds_read_b64_tr_b16 v[190:191], v23 offset:55296
  s_waitcnt vmcnt(18) lgkmcnt(8)
  v_mfma_f32_16x16x32_bf16 v[128:131], v[160:163], v[240:243], v[128:131]
  buffer_load_dwordx4 v[224:227], off, s[36:39], s50 offset:0 sc1
  v_mfma_f32_16x16x32_bf16 v[132:135], v[160:163], v[244:247], v[132:135]
  ds_read_b64_tr_b16 v[192:193], v20 offset:57344
  ds_read_b64_tr_b16 v[194:195], v20 offset:59392
  v_mfma_f32_16x16x32_bf16 v[140:143], v[164:167], v[244:247], v[140:143]
  ds_read_b64_tr_b16 v[196:197], v21 offset:57344
  v_mfma_f32_16x16x32_bf16 v[136:139], v[164:167], v[240:243], v[136:139]
  ds_read_b64_tr_b16 v[198:199], v21 offset:59392
  v_mfma_f32_16x16x32_bf16 v[144:147], v[168:171], v[240:243], v[144:147]
  ds_read_b64_tr_b16 v[200:201], v22 offset:57344
  v_mfma_f32_16x16x32_bf16 v[148:151], v[168:171], v[244:247], v[148:151]
  ds_read_b64_tr_b16 v[202:203], v22 offset:59392
  ds_read_b64_tr_b16 v[204:205], v23 offset:57344
  v_mfma_f32_16x16x32_bf16 v[156:159], v[172:175], v[244:247], v[156:159]
  buffer_load_dwordx4 v[228:231], off, s[64:67], s50 offset:0 sc1
  v_mfma_f32_16x16x32_bf16 v[152:155], v[172:175], v[240:243], v[152:155]
  ds_read_b64_tr_b16 v[206:207], v23 offset:59392
  s_waitcnt vmcnt(18) lgkmcnt(8)
  v_mfma_f32_16x16x32_bf16 v[128:131], v[176:179], v[248:251], v[128:131]
  ds_read_b64_tr_b16 v[208:209], v20 offset:61440
  v_mfma_f32_16x16x32_bf16 v[132:135], v[176:179], v[252:255], v[132:135]
  ds_read_b64_tr_b16 v[210:211], v20 offset:63488
  v_mfma_f32_16x16x32_bf16 v[140:143], v[180:183], v[252:255], v[140:143]
  ds_read_b64_tr_b16 v[212:213], v21 offset:61440
  v_mfma_f32_16x16x32_bf16 v[136:139], v[180:183], v[248:251], v[136:139]
  ds_read_b64_tr_b16 v[214:215], v21 offset:63488
  v_mfma_f32_16x16x32_bf16 v[144:147], v[184:187], v[248:251], v[144:147]
  buffer_load_dwordx4 v[232:235], off, s[36:39], s50 offset:1024 sc1
  v_mfma_f32_16x16x32_bf16 v[148:151], v[184:187], v[252:255], v[148:151]
  ds_read_b64_tr_b16 v[216:217], v22 offset:61440
  ds_read_b64_tr_b16 v[218:219], v22 offset:63488
  v_mfma_f32_16x16x32_bf16 v[156:159], v[188:191], v[252:255], v[156:159]
  ds_read_b64_tr_b16 v[220:221], v23 offset:61440
  v_mfma_f32_16x16x32_bf16 v[152:155], v[188:191], v[248:251], v[152:155]
  ds_read_b64_tr_b16 v[222:223], v23 offset:63488
  s_waitcnt vmcnt(17) lgkmcnt(8)
  v_mfma_f32_16x16x32_bf16 v[128:131], v[192:195], v[32:35], v[128:131]
  ds_read_b64_tr_b16 v[160:161], v26 offset:0
  v_mfma_f32_16x16x32_bf16 v[132:135], v[192:195], v[36:39], v[132:135]
  ds_read_b64_tr_b16 v[162:163], v26 offset:2048
  v_mfma_f32_16x16x32_bf16 v[140:143], v[196:199], v[36:39], v[140:143]
  buffer_load_dwordx4 v[236:239], off, s[64:67], s50 offset:1024 sc1
  v_mfma_f32_16x16x32_bf16 v[136:139], v[196:199], v[32:35], v[136:139]
  ds_read_b64_tr_b16 v[164:165], v27 offset:0
  ds_read_b64_tr_b16 v[166:167], v27 offset:2048
  v_mfma_f32_16x16x32_bf16 v[144:147], v[200:203], v[32:35], v[144:147]
  ds_read_b64_tr_b16 v[168:169], v28 offset:0
  v_mfma_f32_16x16x32_bf16 v[148:151], v[200:203], v[36:39], v[148:151]
  ds_read_b64_tr_b16 v[170:171], v28 offset:2048
  v_mfma_f32_16x16x32_bf16 v[156:159], v[204:207], v[36:39], v[156:159]
  ds_read_b64_tr_b16 v[172:173], v29 offset:0
  v_mfma_f32_16x16x32_bf16 v[152:155], v[204:207], v[32:35], v[152:155]
  ds_read_b64_tr_b16 v[174:175], v29 offset:2048
  s_waitcnt vmcnt(16) lgkmcnt(8)
  s_barrier
  v_mfma_f32_16x16x32_bf16 v[128:131], v[208:211], v[40:43], v[128:131]
  ds_read_b64_tr_b16 v[176:177], v26 offset:4096
  v_mfma_f32_16x16x32_bf16 v[132:135], v[208:211], v[44:47], v[132:135]
  ds_read_b64_tr_b16 v[178:179], v26 offset:6144
  v_mfma_f32_16x16x32_bf16 v[140:143], v[212:215], v[44:47], v[140:143]
  ds_read_b64_tr_b16 v[180:181], v27 offset:4096
  v_mfma_f32_16x16x32_bf16 v[136:139], v[212:215], v[40:43], v[136:139]
  ds_read_b64_tr_b16 v[182:183], v27 offset:6144
  v_mfma_f32_16x16x32_bf16 v[144:147], v[216:219], v[40:43], v[144:147]
  ds_read_b64_tr_b16 v[184:185], v28 offset:4096
  v_mfma_f32_16x16x32_bf16 v[148:151], v[216:219], v[44:47], v[148:151]
  ds_read_b64_tr_b16 v[186:187], v28 offset:6144
  v_mfma_f32_16x16x32_bf16 v[156:159], v[220:223], v[44:47], v[156:159]
  ds_read_b64_tr_b16 v[188:189], v29 offset:4096
  v_mfma_f32_16x16x32_bf16 v[152:155], v[220:223], v[40:43], v[152:155]
  ds_read_b64_tr_b16 v[190:191], v29 offset:6144
  s_waitcnt vmcnt(14) lgkmcnt(8)
  v_mfma_f32_16x16x32_bf16 v[128:131], v[160:163], v[48:51], v[128:131]
  ds_read_b64_tr_b16 v[192:193], v26 offset:8192
  v_mfma_f32_16x16x32_bf16 v[132:135], v[160:163], v[52:55], v[132:135]
  ds_read_b64_tr_b16 v[194:195], v26 offset:10240
  v_mfma_f32_16x16x32_bf16 v[140:143], v[164:167], v[52:55], v[140:143]
  ds_read_b64_tr_b16 v[196:197], v27 offset:8192
  v_mfma_f32_16x16x32_bf16 v[136:139], v[164:167], v[48:51], v[136:139]
  ds_read_b64_tr_b16 v[198:199], v27 offset:10240
  v_mfma_f32_16x16x32_bf16 v[144:147], v[168:171], v[48:51], v[144:147]
  ds_read_b64_tr_b16 v[200:201], v28 offset:8192
  v_mfma_f32_16x16x32_bf16 v[148:151], v[168:171], v[52:55], v[148:151]
  ds_read_b64_tr_b16 v[202:203], v28 offset:10240
  v_mfma_f32_16x16x32_bf16 v[156:159], v[172:175], v[52:55], v[156:159]
  ds_read_b64_tr_b16 v[204:205], v29 offset:8192
  v_mfma_f32_16x16x32_bf16 v[152:155], v[172:175], v[48:51], v[152:155]
  ds_read_b64_tr_b16 v[206:207], v29 offset:10240
  s_waitcnt vmcnt(12) lgkmcnt(8)
  v_mfma_f32_16x16x32_bf16 v[128:131], v[176:179], v[56:59], v[128:131]
  ds_read_b64_tr_b16 v[208:209], v26 offset:12288
  v_mfma_f32_16x16x32_bf16 v[132:135], v[176:179], v[60:63], v[132:135]
  ds_read_b64_tr_b16 v[210:211], v26 offset:14336
  v_mfma_f32_16x16x32_bf16 v[140:143], v[180:183], v[60:63], v[140:143]
  ds_read_b64_tr_b16 v[212:213], v27 offset:12288
  v_mfma_f32_16x16x32_bf16 v[136:139], v[180:183], v[56:59], v[136:139]
  ds_read_b64_tr_b16 v[214:215], v27 offset:14336
  v_mfma_f32_16x16x32_bf16 v[144:147], v[184:187], v[56:59], v[144:147]
  ds_read_b64_tr_b16 v[216:217], v28 offset:12288
  v_mfma_f32_16x16x32_bf16 v[148:151], v[184:187], v[60:63], v[148:151]
  ds_read_b64_tr_b16 v[218:219], v28 offset:14336
  v_mfma_f32_16x16x32_bf16 v[156:159], v[188:191], v[60:63], v[156:159]
  ds_read_b64_tr_b16 v[220:221], v29 offset:12288
  v_mfma_f32_16x16x32_bf16 v[152:155], v[188:191], v[56:59], v[152:155]
  ds_read_b64_tr_b16 v[222:223], v29 offset:14336
  s_waitcnt vmcnt(10) lgkmcnt(8)
  v_mfma_f32_16x16x32_bf16 v[128:131], v[192:195], v[64:67], v[128:131]
  ds_read_b64_tr_b16 v[160:161], v26 offset:16384
  v_mfma_f32_16x16x32_bf16 v[132:135], v[192:195], v[68:71], v[132:135]
  ds_read_b64_tr_b16 v[162:163], v26 offset:18432
  v_mfma_f32_16x16x32_bf16 v[140:143], v[196:199], v[68:71], v[140:143]
  ds_read_b64_tr_b16 v[164:165], v27 offset:16384
  v_mfma_f32_16x16x32_bf16 v[136:139], v[196:199], v[64:67], v[136:139]
  ds_read_b64_tr_b16 v[166:167], v27 offset:18432
  v_mfma_f32_16x16x32_bf16 v[144:147], v[200:203], v[64:67], v[144:147]
  ds_read_b64_tr_b16 v[168:169], v28 offset:16384
  v_mfma_f32_16x16x32_bf16 v[148:151], v[200:203], v[68:71], v[148:151]
  ds_read_b64_tr_b16 v[170:171], v28 offset:18432
  v_mfma_f32_16x16x32_bf16 v[156:159], v[204:207], v[68:71], v[156:159]
  ds_read_b64_tr_b16 v[172:173], v29 offset:16384
  v_mfma_f32_16x16x32_bf16 v[152:155], v[204:207], v[64:67], v[152:155]
  ds_read_b64_tr_b16 v[174:175], v29 offset:18432
  s_waitcnt vmcnt(8) lgkmcnt(8)
  v_mfma_f32_16x16x32_bf16 v[128:131], v[208:211], v[72:75], v[128:131]
  ds_read_b64_tr_b16 v[176:177], v26 offset:20480
  v_mfma_f32_16x16x32_bf16 v[132:135], v[208:211], v[76:79], v[132:135]
  ds_read_b64_tr_b16 v[178:179], v26 offset:22528
  v_mfma_f32_16x16x32_bf16 v[140:143], v[212:215], v[76:79], v[140:143]
  ds_read_b64_tr_b16 v[180:181], v27 offset:20480
  v_mfma_f32_16x16x32_bf16 v[136:139], v[212:215], v[72:75], v[136:139]
  ds_read_b64_tr_b16 v[182:183], v27 offset:22528
  v_mfma_f32_16x16x32_bf16 v[144:147], v[216:219], v[72:75], v[144:147]
  ds_read_b64_tr_b16 v[184:185], v28 offset:20480
  v_mfma_f32_16x16x32_bf16 v[148:151], v[216:219], v[76:79], v[148:151]
  ds_read_b64_tr_b16 v[186:187], v28 offset:22528
  v_mfma_f32_16x16x32_bf16 v[156:159], v[220:223], v[76:79], v[156:159]
  ds_read_b64_tr_b16 v[188:189], v29 offset:20480
  v_mfma_f32_16x16x32_bf16 v[152:155], v[220:223], v[72:75], v[152:155]
  ds_read_b64_tr_b16 v[190:191], v29 offset:22528
  s_waitcnt vmcnt(6) lgkmcnt(8)
  v_mfma_f32_16x16x32_bf16 v[128:131], v[160:163], v[80:83], v[128:131]
  ds_read_b64_tr_b16 v[192:193], v26 offset:24576
  v_mfma_f32_16x16x32_bf16 v[132:135], v[160:163], v[84:87], v[132:135]
  ds_read_b64_tr_b16 v[194:195], v26 offset:26624
  v_mfma_f32_16x16x32_bf16 v[140:143], v[164:167], v[84:87], v[140:143]
  ds_read_b64_tr_b16 v[196:197], v27 offset:24576
  v_mfma_f32_16x16x32_bf16 v[136:139], v[164:167], v[80:83], v[136:139]
  ds_read_b64_tr_b16 v[198:199], v27 offset:26624
  v_mfma_f32_16x16x32_bf16 v[144:147], v[168:171], v[80:83], v[144:147]
  ds_read_b64_tr_b16 v[200:201], v28 offset:24576
  v_mfma_f32_16x16x32_bf16 v[148:151], v[168:171], v[84:87], v[148:151]
  ds_read_b64_tr_b16 v[202:203], v28 offset:26624
  v_mfma_f32_16x16x32_bf16 v[156:159], v[172:175], v[84:87], v[156:159]
  ds_read_b64_tr_b16 v[204:205], v29 offset:24576
  v_mfma_f32_16x16x32_bf16 v[152:155], v[172:175], v[80:83], v[152:155]
  ds_read_b64_tr_b16 v[206:207], v29 offset:26624
  s_waitcnt vmcnt(4) lgkmcnt(8)
  v_mfma_f32_16x16x32_bf16 v[128:131], v[176:179], v[88:91], v[128:131]
  ds_read_b64_tr_b16 v[208:209], v26 offset:28672
  v_mfma_f32_16x16x32_bf16 v[132:135], v[176:179], v[92:95], v[132:135]
  ds_read_b64_tr_b16 v[210:211], v26 offset:30720
  v_mfma_f32_16x16x32_bf16 v[140:143], v[180:183], v[92:95], v[140:143]
  ds_read_b64_tr_b16 v[212:213], v27 offset:28672
  v_mfma_f32_16x16x32_bf16 v[136:139], v[180:183], v[88:91], v[136:139]
  ds_read_b64_tr_b16 v[214:215], v27 offset:30720
  v_mfma_f32_16x16x32_bf16 v[144:147], v[184:187], v[88:91], v[144:147]
  ds_read_b64_tr_b16 v[216:217], v28 offset:28672
  v_mfma_f32_16x16x32_bf16 v[148:151], v[184:187], v[92:95], v[148:151]
  ds_read_b64_tr_b16 v[218:219], v28 offset:30720
  v_mfma_f32_16x16x32_bf16 v[156:159], v[188:191], v[92:95], v[156:159]
  ds_read_b64_tr_b16 v[220:221], v29 offset:28672
  v_mfma_f32_16x16x32_bf16 v[152:155], v[188:191], v[88:91], v[152:155]
  ds_read_b64_tr_b16 v[222:223], v29 offset:30720
  s_waitcnt vmcnt(2) lgkmcnt(8)
  v_mfma_f32_16x16x32_bf16 v[128:131], v[192:195], v[224:227], v[128:131]
  ds_read_b64_tr_b16 v[160:161], v6 offset:0
  v_mfma_f32_16x16x32_bf16 v[132:135], v[192:195], v[228:231], v[132:135]
  ds_read_b64_tr_b16 v[162:163], v6 offset:2048
  v_mfma_f32_16x16x32_bf16 v[140:143], v[196:199], v[228:231], v[140:143]
  ds_read_b64_tr_b16 v[164:165], v7 offset:0
  v_mfma_f32_16x16x32_bf16 v[136:139], v[196:199], v[224:227], v[136:139]
  ds_read_b64_tr_b16 v[166:167], v7 offset:2048
  v_mfma_f32_16x16x32_bf16 v[144:147], v[200:203], v[224:227], v[144:147]
  ds_read_b64_tr_b16 v[168:169], v8 offset:0
  v_mfma_f32_16x16x32_bf16 v[148:151], v[200:203], v[228:231], v[148:151]
  ds_read_b64_tr_b16 v[170:171], v8 offset:2048
  v_mfma_f32_16x16x32_bf16 v[156:159], v[204:207], v[228:231], v[156:159]
  ds_read_b64_tr_b16 v[172:173], v9 offset:0
  v_mfma_f32_16x16x32_bf16 v[152:155], v[204:207], v[224:227], v[152:155]
  ds_read_b64_tr_b16 v[174:175], v9 offset:2048
  s_waitcnt vmcnt(0) lgkmcnt(8)
  s_barrier
  v_mfma_f32_16x16x32_bf16 v[128:131], v[208:211], v[232:235], v[128:131]
  ds_read_b64_tr_b16 v[176:177], v6 offset:4096
  v_mfma_f32_16x16x32_bf16 v[132:135], v[208:211], v[236:239], v[132:135]
  ds_read_b64_tr_b16 v[178:179], v6 offset:6144
  v_mfma_f32_16x16x32_bf16 v[140:143], v[212:215], v[236:239], v[140:143]
  ds_read_b64_tr_b16 v[180:181], v7 offset:4096
  v_mfma_f32_16x16x32_bf16 v[136:139], v[212:215], v[232:235], v[136:139]
  ds_read_b64_tr_b16 v[182:183], v7 offset:6144
  v_mfma_f32_16x16x32_bf16 v[144:147], v[216:219], v[232:235], v[144:147]
  ds_read_b64_tr_b16 v[184:185], v8 offset:4096
  v_mfma_f32_16x16x32_bf16 v[148:151], v[216:219], v[236:239], v[148:151]
  ds_read_b64_tr_b16 v[186:187], v8 offset:6144
  v_mfma_f32_16x16x32_bf16 v[156:159], v[220:223], v[236:239], v[156:159]
  ds_read_b64_tr_b16 v[188:189], v9 offset:4096
  v_mfma_f32_16x16x32_bf16 v[152:155], v[220:223], v[232:235], v[152:155]
  ds_read_b64_tr_b16 v[190:191], v9 offset:6144
  s_waitcnt lgkmcnt(8)
  v_mfma_f32_16x16x32_bf16 v[96:99], v[160:163], v[240:243], v[96:99]
  ds_read_b64_tr_b16 v[192:193], v6 offset:8192
  v_mfma_f32_16x16x32_bf16 v[100:103], v[160:163], v[244:247], v[100:103]
  ds_read_b64_tr_b16 v[194:195], v6 offset:10240
  v_mfma_f32_16x16x32_bf16 v[108:111], v[164:167], v[244:247], v[108:111]
  ds_read_b64_tr_b16 v[196:197], v7 offset:8192
  v_cvt_pk_bf16_f32 v128, v128, v129
  v_mfma_f32_16x16x32_bf16 v[104:107], v[164:167], v[240:243], v[104:107]
  ds_read_b64_tr_b16 v[198:199], v7 offset:10240
  v_cvt_pk_bf16_f32 v129, v130, v131
  v_mfma_f32_16x16x32_bf16 v[112:115], v[168:171], v[240:243], v[112:115]
  ds_read_b64_tr_b16 v[200:201], v8 offset:8192
  v_cvt_pk_bf16_f32 v130, v132, v133
  v_mfma_f32_16x16x32_bf16 v[116:119], v[168:171], v[244:247], v[116:119]
  ds_read_b64_tr_b16 v[202:203], v8 offset:10240
  v_cvt_pk_bf16_f32 v131, v134, v135
  v_mfma_f32_16x16x32_bf16 v[124:127], v[172:175], v[244:247], v[124:127]
  ds_read_b64_tr_b16 v[204:205], v9 offset:8192
  buffer_store_dwordx4 v[128:131], off, s[60:63], s4 offset:0 sc1
  v_mfma_f32_16x16x32_bf16 v[120:123], v[172:175], v[240:243], v[120:123]
  ds_read_b64_tr_b16 v[206:207], v9 offset:10240
  s_waitcnt lgkmcnt(8)
  v_mfma_f32_16x16x32_bf16 v[96:99], v[176:179], v[248:251], v[96:99]
  ds_read_b64_tr_b16 v[208:209], v6 offset:12288
  v_cvt_pk_bf16_f32 v132, v136, v137
  v_mfma_f32_16x16x32_bf16 v[100:103], v[176:179], v[252:255], v[100:103]
  ds_read_b64_tr_b16 v[210:211], v6 offset:14336
  v_cvt_pk_bf16_f32 v133, v138, v139
  v_mfma_f32_16x16x32_bf16 v[108:111], v[180:183], v[252:255], v[108:111]
  ds_read_b64_tr_b16 v[212:213], v7 offset:12288
  v_cvt_pk_bf16_f32 v134, v140, v141
  v_mfma_f32_16x16x32_bf16 v[104:107], v[180:183], v[248:251], v[104:107]
  ds_read_b64_tr_b16 v[214:215], v7 offset:14336
  v_cvt_pk_bf16_f32 v135, v142, v143
  v_mfma_f32_16x16x32_bf16 v[112:115], v[184:187], v[248:251], v[112:115]
  ds_read_b64_tr_b16 v[216:217], v8 offset:12288
  buffer_store_dwordx4 v[132:135], off, s[60:63], s4 offset:1024 sc1
  v_mfma_f32_16x16x32_bf16 v[116:119], v[184:187], v[252:255], v[116:119]
  ds_read_b64_tr_b16 v[218:219], v8 offset:14336
  v_readlane_b32 s51, v30, 23
  v_mfma_f32_16x16x32_bf16 v[124:127], v[188:191], v[252:255], v[124:127]
  ds_read_b64_tr_b16 v[220:221], v9 offset:12288
  v_cvt_pk_bf16_f32 v136, v144, v145
  v_mfma_f32_16x16x32_bf16 v[120:123], v[188:191], v[248:251], v[120:123]
  ds_read_b64_tr_b16 v[222:223], v9 offset:14336
  s_waitcnt lgkmcnt(8)
  v_mfma_f32_16x16x32_bf16 v[96:99], v[192:195], v[32:35], v[96:99]
  ds_read_b64_tr_b16 v[160:161], v6 offset:16384
  buffer_load_dwordx4 v[240:243], off, s[36:39], s51 offset:0 sc1
  v_mfma_f32_16x16x32_bf16 v[100:103], v[192:195], v[36:39], v[100:103]
  ds_read_b64_tr_b16 v[162:163], v6 offset:18432
  v_cvt_pk_bf16_f32 v137, v146, v147
  v_mfma_f32_16x16x32_bf16 v[108:111], v[196:199], v[36:39], v[108:111]
  ds_read_b64_tr_b16 v[164:165], v7 offset:16384
  v_cvt_pk_bf16_f32 v138, v148, v149
  v_mfma_f32_16x16x32_bf16 v[104:107], v[196:199], v[32:35], v[104:107]
  ds_read_b64_tr_b16 v[166:167], v7 offset:18432
  v_cvt_pk_bf16_f32 v139, v150, v151
  v_mfma_f32_16x16x32_bf16 v[112:115], v[200:203], v[32:35], v[112:115]
  ds_read_b64_tr_b16 v[168:169], v8 offset:16384
  buffer_load_dwordx4 v[244:247], off, s[64:67], s51 offset:0 sc1
  v_mfma_f32_16x16x32_bf16 v[116:119], v[200:203], v[36:39], v[116:119]
  ds_read_b64_tr_b16 v[170:171], v8 offset:18432
  buffer_store_dwordx4 v[136:139], off, s[60:63], s4 offset:2048 sc1
  v_mfma_f32_16x16x32_bf16 v[124:127], v[204:207], v[36:39], v[124:127]
  ds_read_b64_tr_b16 v[172:173], v9 offset:16384
  v_cvt_pk_bf16_f32 v140, v152, v153
  v_mfma_f32_16x16x32_bf16 v[120:123], v[204:207], v[32:35], v[120:123]
  ds_read_b64_tr_b16 v[174:175], v9 offset:18432
  s_waitcnt lgkmcnt(8)
  v_mfma_f32_16x16x32_bf16 v[96:99], v[208:211], v[40:43], v[96:99]
  ds_read_b64_tr_b16 v[176:177], v6 offset:20480
  buffer_load_dwordx4 v[248:251], off, s[36:39], s51 offset:1024 sc1
  v_mfma_f32_16x16x32_bf16 v[100:103], v[208:211], v[44:47], v[100:103]
  ds_read_b64_tr_b16 v[178:179], v6 offset:22528
  v_cvt_pk_bf16_f32 v141, v154, v155
  v_mfma_f32_16x16x32_bf16 v[108:111], v[212:215], v[44:47], v[108:111]
  ds_read_b64_tr_b16 v[180:181], v7 offset:20480
  v_cvt_pk_bf16_f32 v142, v156, v157
  v_mfma_f32_16x16x32_bf16 v[104:107], v[212:215], v[40:43], v[104:107]
  ds_read_b64_tr_b16 v[182:183], v7 offset:22528
  v_cvt_pk_bf16_f32 v143, v158, v159
  v_mfma_f32_16x16x32_bf16 v[112:115], v[216:219], v[40:43], v[112:115]
  ds_read_b64_tr_b16 v[184:185], v8 offset:20480
  buffer_load_dwordx4 v[252:255], off, s[64:67], s51 offset:1024 sc1
  v_mfma_f32_16x16x32_bf16 v[116:119], v[216:219], v[44:47], v[116:119]
  ds_read_b64_tr_b16 v[186:187], v8 offset:22528
  buffer_store_dwordx4 v[140:143], off, s[60:63], s4 offset:3072 sc1
  v_mfma_f32_16x16x32_bf16 v[124:127], v[220:223], v[44:47], v[124:127]
  ds_read_b64_tr_b16 v[188:189], v9 offset:20480
  v_readlane_b32 s48, v30, 24
  v_mfma_f32_16x16x32_bf16 v[120:123], v[220:223], v[40:43], v[120:123]
  ds_read_b64_tr_b16 v[190:191], v9 offset:22528
  s_waitcnt lgkmcnt(8)
  v_mfma_f32_16x16x32_bf16 v[96:99], v[160:163], v[48:51], v[96:99]
  ds_read_b64_tr_b16 v[192:193], v6 offset:24576
  v_mfma_f32_16x16x32_bf16 v[100:103], v[160:163], v[52:55], v[100:103]
  buffer_load_dwordx4 v[32:35], off, s[36:39], s48 offset:0 sc1
  v_mfma_f32_16x16x32_bf16 v[108:111], v[164:167], v[52:55], v[108:111]
  ds_read_b64_tr_b16 v[194:195], v6 offset:26624
  ds_read_b64_tr_b16 v[196:197], v7 offset:24576
  v_mfma_f32_16x16x32_bf16 v[104:107], v[164:167], v[48:51], v[104:107]
  ds_read_b64_tr_b16 v[198:199], v7 offset:26624
  v_mfma_f32_16x16x32_bf16 v[112:115], v[168:171], v[48:51], v[112:115]
  ds_read_b64_tr_b16 v[200:201], v8 offset:24576
  v_mfma_f32_16x16x32_bf16 v[116:119], v[168:171], v[52:55], v[116:119]
  buffer_load_dwordx4 v[36:39], off, s[64:67], s48 offset:0 sc1
  v_mfma_f32_16x16x32_bf16 v[124:127], v[172:175], v[52:55], v[124:127]
  ds_read_b64_tr_b16 v[202:203], v8 offset:26624
  ds_read_b64_tr_b16 v[204:205], v9 offset:24576
  v_mfma_f32_16x16x32_bf16 v[120:123], v[172:175], v[48:51], v[120:123]
  ds_read_b64_tr_b16 v[206:207], v9 offset:26624
  s_waitcnt lgkmcnt(8)
  v_mfma_f32_16x16x32_bf16 v[96:99], v[176:179], v[56:59], v[96:99]
  ds_read_b64_tr_b16 v[208:209], v6 offset:28672
  v_mfma_f32_16x16x32_bf16 v[100:103], v[176:179], v[60:63], v[100:103]
  buffer_load_dwordx4 v[40:43], off, s[36:39], s48 offset:1024 sc1
  v_mfma_f32_16x16x32_bf16 v[108:111], v[180:183], v[60:63], v[108:111]
  ds_read_b64_tr_b16 v[210:211], v6 offset:30720
  ds_read_b64_tr_b16 v[212:213], v7 offset:28672
  v_mfma_f32_16x16x32_bf16 v[104:107], v[180:183], v[56:59], v[104:107]
  ds_read_b64_tr_b16 v[214:215], v7 offset:30720
  v_mfma_f32_16x16x32_bf16 v[112:115], v[184:187], v[56:59], v[112:115]
  ds_read_b64_tr_b16 v[216:217], v8 offset:28672
  v_mfma_f32_16x16x32_bf16 v[116:119], v[184:187], v[60:63], v[116:119]
  buffer_load_dwordx4 v[44:47], off, s[64:67], s48 offset:1024 sc1
  v_mfma_f32_16x16x32_bf16 v[124:127], v[188:191], v[60:63], v[124:127]
  ds_read_b64_tr_b16 v[218:219], v8 offset:30720
  ds_read_b64_tr_b16 v[220:221], v9 offset:28672
  v_mfma_f32_16x16x32_bf16 v[120:123], v[188:191], v[56:59], v[120:123]
  ds_read_b64_tr_b16 v[222:223], v9 offset:30720
  s_waitcnt lgkmcnt(8)
  v_mfma_f32_16x16x32_bf16 v[96:99], v[192:195], v[64:67], v[96:99]
  ds_read_b64_tr_b16 v[160:161], v6 offset:32768
  v_readlane_b32 s49, v30, 25
  v_mfma_f32_16x16x32_bf16 v[100:103], v[192:195], v[68:71], v[100:103]
  ds_read_b64_tr_b16 v[162:163], v6 offset:34816
  v_mfma_f32_16x16x32_bf16 v[108:111], v[196:199], v[68:71], v[108:111]
  ds_read_b64_tr_b16 v[164:165], v7 offset:32768
  v_mfma_f32_16x16x32_bf16 v[104:107], v[196:199], v[64:67], v[104:107]
  buffer_load_dwordx4 v[48:51], off, s[36:39], s49 offset:0 sc1
  v_mfma_f32_16x16x32_bf16 v[112:115], v[200:203], v[64:67], v[112:115]
  ds_read_b64_tr_b16 v[166:167], v7 offset:34816
  ds_read_b64_tr_b16 v[168:169], v8 offset:32768
  v_mfma_f32_16x16x32_bf16 v[116:119], v[200:203], v[68:71], v[116:119]
  ds_read_b64_tr_b16 v[170:171], v8 offset:34816
  v_mfma_f32_16x16x32_bf16 v[124:127], v[204:207], v[68:71], v[124:127]
  ds_read_b64_tr_b16 v[172:173], v9 offset:32768
  v_mfma_f32_16x16x32_bf16 v[120:123], v[204:207], v[64:67], v[120:123]
  ds_read_b64_tr_b16 v[174:175], v9 offset:34816
  s_waitcnt lgkmcnt(8)
  s_barrier
  v_mfma_f32_16x16x32_bf16 v[96:99], v[208:211], v[72:75], v[96:99]
  buffer_load_dwordx4 v[52:55], off, s[64:67], s49 offset:0 sc1
  v_mfma_f32_16x16x32_bf16 v[100:103], v[208:211], v[76:79], v[100:103]
  ds_read_b64_tr_b16 v[176:177], v6 offset:36864
  ds_read_b64_tr_b16 v[178:179], v6 offset:38912
  v_mfma_f32_16x16x32_bf16 v[108:111], v[212:215], v[76:79], v[108:111]
  ds_read_b64_tr_b16 v[180:181], v7 offset:36864
  v_mfma_f32_16x16x32_bf16 v[104:107], v[212:215], v[72:75], v[104:107]
  ds_read_b64_tr_b16 v[182:183], v7 offset:38912
  v_mfma_f32_16x16x32_bf16 v[112:115], v[216:219], v[72:75], v[112:115]
  buffer_load_dwordx4 v[56:59], off, s[36:39], s49 offset:1024 sc1
  v_mfma_f32_16x16x32_bf16 v[116:119], v[216:219], v[76:79], v[116:119]
  ds_read_b64_tr_b16 v[184:185], v8 offset:36864
  ds_read_b64_tr_b16 v[186:187], v8 offset:38912
  v_mfma_f32_16x16x32_bf16 v[124:127], v[220:223], v[76:79], v[124:127]
  ds_read_b64_tr_b16 v[188:189], v9 offset:36864
  v_mfma_f32_16x16x32_bf16 v[120:123], v[220:223], v[72:75], v[120:123]
  ds_read_b64_tr_b16 v[190:191], v9 offset:38912
  s_waitcnt lgkmcnt(8)
  v_mfma_f32_16x16x32_bf16 v[96:99], v[160:163], v[80:83], v[96:99]
  ds_read_b64_tr_b16 v[192:193], v6 offset:40960
  buffer_load_dwordx4 v[60:63], off, s[64:67], s49 offset:1024 sc1
  v_mfma_f32_16x16x32_bf16 v[100:103], v[160:163], v[84:87], v[100:103]
  ds_read_b64_tr_b16 v[194:195], v6 offset:43008
  s_waitcnt vmcnt(8)
  v_mfma_f32_16x16x32_bf16 v[108:111], v[164:167], v[84:87], v[108:111]
  ds_read_b64_tr_b16 v[196:197], v7 offset:40960
  v_readlane_b32 s50, v30, 26
  v_mfma_f32_16x16x32_bf16 v[104:107], v[164:167], v[80:83], v[104:107]
  buffer_store_dword v19, off, s[52:55], s6 sc1
  v_mfma_f32_16x16x32_bf16 v[112:115], v[168:171], v[80:83], v[112:115]
  ds_read_b64_tr_b16 v[198:199], v7 offset:43008
  ds_read_b64_tr_b16 v[200:201], v8 offset:40960
  v_mfma_f32_16x16x32_bf16 v[116:119], v[168:171], v[84:87], v[116:119]
  buffer_load_dwordx4 v[64:67], off, s[36:39], s50 offset:0 sc1
  v_mfma_f32_16x16x32_bf16 v[124:127], v[172:175], v[84:87], v[124:127]
  ds_read_b64_tr_b16 v[202:203], v8 offset:43008
  ds_read_b64_tr_b16 v[204:205], v9 offset:40960
  v_mfma_f32_16x16x32_bf16 v[120:123], v[172:175], v[80:83], v[120:123]
  ds_read_b64_tr_b16 v[206:207], v9 offset:43008
  s_waitcnt lgkmcnt(8)
  v_mfma_f32_16x16x32_bf16 v[96:99], v[176:179], v[88:91], v[96:99]
  ds_read_b64_tr_b16 v[208:209], v6 offset:45056
  v_mfma_f32_16x16x32_bf16 v[100:103], v[176:179], v[92:95], v[100:103]
  buffer_load_dwordx4 v[68:71], off, s[64:67], s50 offset:0 sc1
  v_mfma_f32_16x16x32_bf16 v[108:111], v[180:183], v[92:95], v[108:111]
  ds_read_b64_tr_b16 v[210:211], v6 offset:47104
  ds_read_b64_tr_b16 v[212:213], v7 offset:45056
  v_mfma_f32_16x16x32_bf16 v[104:107], v[180:183], v[88:91], v[104:107]
  ds_read_b64_tr_b16 v[214:215], v7 offset:47104
  v_mfma_f32_16x16x32_bf16 v[112:115], v[184:187], v[88:91], v[112:115]
  ds_read_b64_tr_b16 v[216:217], v8 offset:45056
  v_mfma_f32_16x16x32_bf16 v[116:119], v[184:187], v[92:95], v[116:119]
  buffer_load_dwordx4 v[72:75], off, s[36:39], s50 offset:1024 sc1
  v_mfma_f32_16x16x32_bf16 v[124:127], v[188:191], v[92:95], v[124:127]
  ds_read_b64_tr_b16 v[218:219], v8 offset:47104
  ds_read_b64_tr_b16 v[220:221], v9 offset:45056
  v_mfma_f32_16x16x32_bf16 v[120:123], v[188:191], v[88:91], v[120:123]
  ds_read_b64_tr_b16 v[222:223], v9 offset:47104
  s_waitcnt lgkmcnt(8)
  v_mfma_f32_16x16x32_bf16 v[96:99], v[192:195], v[224:227], v[96:99]
  ds_read_b64_tr_b16 v[160:161], v6 offset:49152
  v_mfma_f32_16x16x32_bf16 v[100:103], v[192:195], v[228:231], v[100:103]
  buffer_load_dwordx4 v[76:79], off, s[64:67], s50 offset:1024 sc1
  v_mfma_f32_16x16x32_bf16 v[108:111], v[196:199], v[228:231], v[108:111]
  ds_read_b64_tr_b16 v[162:163], v6 offset:51200
  ds_read_b64_tr_b16 v[164:165], v7 offset:49152
  v_mfma_f32_16x16x32_bf16 v[104:107], v[196:199], v[224:227], v[104:107]
  ds_read_b64_tr_b16 v[166:167], v7 offset:51200
  v_readlane_b32 s51, v30, 27
  v_mfma_f32_16x16x32_bf16 v[112:115], v[200:203], v[224:227], v[112:115]
  ds_read_b64_tr_b16 v[168:169], v8 offset:49152
  v_mfma_f32_16x16x32_bf16 v[116:119], v[200:203], v[228:231], v[116:119]
  ds_read_b64_tr_b16 v[170:171], v8 offset:51200
  ds_read_b64_tr_b16 v[172:173], v9 offset:49152
  v_mfma_f32_16x16x32_bf16 v[124:127], v[204:207], v[228:231], v[124:127]
  buffer_load_dwordx4 v[80:83], off, s[36:39], s51 offset:0 sc1
  v_mfma_f32_16x16x32_bf16 v[120:123], v[204:207], v[224:227], v[120:123]
  ds_read_b64_tr_b16 v[174:175], v9 offset:51200
  s_waitcnt lgkmcnt(8)
  v_mfma_f32_16x16x32_bf16 v[96:99], v[208:211], v[232:235], v[96:99]
  ds_read_b64_tr_b16 v[176:177], v6 offset:53248
  v_mfma_f32_16x16x32_bf16 v[100:103], v[208:211], v[236:239], v[100:103]
  ds_read_b64_tr_b16 v[178:179], v6 offset:55296
  v_mfma_f32_16x16x32_bf16 v[108:111], v[212:215], v[236:239], v[108:111]
  buffer_load_dwordx4 v[84:87], off, s[64:67], s51 offset:0 sc1
  v_mfma_f32_16x16x32_bf16 v[104:107], v[212:215], v[232:235], v[104:107]
  ds_read_b64_tr_b16 v[180:181], v7 offset:53248
  ds_read_b64_tr_b16 v[182:183], v7 offset:55296
  v_mfma_f32_16x16x32_bf16 v[112:115], v[216:219], v[232:235], v[112:115]
  ds_read_b64_tr_b16 v[184:185], v8 offset:53248
  v_mfma_f32_16x16x32_bf16 v[116:119], v[216:219], v[236:239], v[116:119]
  ds_read_b64_tr_b16 v[186:187], v8 offset:55296
  ds_read_b64_tr_b16 v[188:189], v9 offset:53248
  v_mfma_f32_16x16x32_bf16 v[124:127], v[220:223], v[236:239], v[124:127]
  buffer_load_dwordx4 v[88:91], off, s[36:39], s51 offset:1024 sc1
  v_mfma_f32_16x16x32_bf16 v[120:123], v[220:223], v[232:235], v[120:123]
  ds_read_b64_tr_b16 v[190:191], v9 offset:55296
  s_waitcnt lgkmcnt(8)
  v_mfma_f32_16x16x32_bf16 v[96:99], v[160:163], v[240:243], v[96:99]
  ds_read_b64_tr_b16 v[192:193], v6 offset:57344
  v_mfma_f32_16x16x32_bf16 v[100:103], v[160:163], v[244:247], v[100:103]
  ds_read_b64_tr_b16 v[194:195], v6 offset:59392
  v_mfma_f32_16x16x32_bf16 v[108:111], v[164:167], v[244:247], v[108:111]
  buffer_load_dwordx4 v[92:95], off, s[64:67], s51 offset:1024 sc1
  v_mfma_f32_16x16x32_bf16 v[104:107], v[164:167], v[240:243], v[104:107]
  ds_read_b64_tr_b16 v[196:197], v7 offset:57344
  ds_read_b64_tr_b16 v[198:199], v7 offset:59392
  v_mfma_f32_16x16x32_bf16 v[112:115], v[168:171], v[240:243], v[112:115]
  ds_read_b64_tr_b16 v[200:201], v8 offset:57344
  v_readlane_b32 s48, v30, 28
  v_mfma_f32_16x16x32_bf16 v[116:119], v[168:171], v[244:247], v[116:119]
  ds_read_b64_tr_b16 v[202:203], v8 offset:59392
  v_mfma_f32_16x16x32_bf16 v[124:127], v[172:175], v[244:247], v[124:127]
  ds_read_b64_tr_b16 v[204:205], v9 offset:57344
  v_mfma_f32_16x16x32_bf16 v[120:123], v[172:175], v[240:243], v[120:123]
  ds_read_b64_tr_b16 v[206:207], v9 offset:59392
  s_waitcnt lgkmcnt(8)
  v_mfma_f32_16x16x32_bf16 v[96:99], v[176:179], v[248:251], v[96:99]
  buffer_load_dwordx4 v[224:227], off, s[36:39], s48 offset:0 sc1
  v_mfma_f32_16x16x32_bf16 v[100:103], v[176:179], v[252:255], v[100:103]
  ds_read_b64_tr_b16 v[208:209], v6 offset:61440
  ds_read_b64_tr_b16 v[210:211], v6 offset:63488
  v_mfma_f32_16x16x32_bf16 v[108:111], v[180:183], v[252:255], v[108:111]
  ds_read_b64_tr_b16 v[212:213], v7 offset:61440
  v_mfma_f32_16x16x32_bf16 v[104:107], v[180:183], v[248:251], v[104:107]
  ds_read_b64_tr_b16 v[214:215], v7 offset:63488
  v_mfma_f32_16x16x32_bf16 v[112:115], v[184:187], v[248:251], v[112:115]
  buffer_load_dwordx4 v[228:231], off, s[64:67], s48 offset:0 sc1
  v_mfma_f32_16x16x32_bf16 v[116:119], v[184:187], v[252:255], v[116:119]
  ds_read_b64_tr_b16 v[216:217], v8 offset:61440
  ds_read_b64_tr_b16 v[218:219], v8 offset:63488
  v_mfma_f32_16x16x32_bf16 v[124:127], v[188:191], v[252:255], v[124:127]
  ds_read_b64_tr_b16 v[220:221], v9 offset:61440
  v_mfma_f32_16x16x32_bf16 v[120:123], v[188:191], v[248:251], v[120:123]
  ds_read_b64_tr_b16 v[222:223], v9 offset:63488
  s_waitcnt vmcnt(17) lgkmcnt(8)
  v_mfma_f32_16x16x32_bf16 v[96:99], v[192:195], v[32:35], v[96:99]
  buffer_load_dwordx4 v[232:235], off, s[36:39], s48 offset:1024 sc1
  v_mfma_f32_16x16x32_bf16 v[100:103], v[192:195], v[36:39], v[100:103]
  ds_read_b64_tr_b16 v[160:161], v20 offset:0
  ds_read_b64_tr_b16 v[162:163], v20 offset:2048
  v_mfma_f32_16x16x32_bf16 v[108:111], v[196:199], v[36:39], v[108:111]
  ds_read_b64_tr_b16 v[164:165], v21 offset:0
  v_mfma_f32_16x16x32_bf16 v[104:107], v[196:199], v[32:35], v[104:107]
  ds_read_b64_tr_b16 v[166:167], v21 offset:2048
  v_mfma_f32_16x16x32_bf16 v[112:115], v[200:203], v[32:35], v[112:115]
  buffer_load_dwordx4 v[236:239], off, s[64:67], s48 offset:1024 sc1
  v_mfma_f32_16x16x32_bf16 v[116:119], v[200:203], v[36:39], v[116:119]
  ds_read_b64_tr_b16 v[168:169], v22 offset:0
  ds_read_b64_tr_b16 v[170:171], v22 offset:2048
  v_mfma_f32_16x16x32_bf16 v[124:127], v[204:207], v[36:39], v[124:127]
  ds_read_b64_tr_b16 v[172:173], v23 offset:0
  v_readlane_b32 s49, v30, 29
  v_mfma_f32_16x16x32_bf16 v[120:123], v[204:207], v[32:35], v[120:123]
  ds_read_b64_tr_b16 v[174:175], v23 offset:2048
  s_waitcnt vmcnt(17) lgkmcnt(8)
  v_mfma_f32_16x16x32_bf16 v[96:99], v[208:211], v[40:43], v[96:99]
  ds_read_b64_tr_b16 v[176:177], v20 offset:4096
  v_mfma_f32_16x16x32_bf16 v[100:103], v[208:211], v[44:47], v[100:103]
  buffer_load_dwordx4 v[240:243], off, s[36:39], s49 offset:0 sc1
  v_mfma_f32_16x16x32_bf16 v[108:111], v[212:215], v[44:47], v[108:111]
  ds_read_b64_tr_b16 v[178:179], v20 offset:6144
  ds_read_b64_tr_b16 v[180:181], v21 offset:4096
  v_mfma_f32_16x16x32_bf16 v[104:107], v[212:215], v[40:43], v[104:107]
  ds_read_b64_tr_b16 v[182:183], v21 offset:6144
  v_mfma_f32_16x16x32_bf16 v[112:115], v[216:219], v[40:43], v[112:115]
  ds_read_b64_tr_b16 v[184:185], v22 offset:4096
  v_mfma_f32_16x16x32_bf16 v[116:119], v[216:219], v[44:47], v[116:119]
  buffer_load_dwordx4 v[244:247], off, s[64:67], s49 offset:0 sc1
  v_mfma_f32_16x16x32_bf16 v[124:127], v[220:223], v[44:47], v[124:127]
  ds_read_b64_tr_b16 v[186:187], v22 offset:6144
  ds_read_b64_tr_b16 v[188:189], v23 offset:4096
  v_mfma_f32_16x16x32_bf16 v[120:123], v[220:223], v[40:43], v[120:123]
  ds_read_b64_tr_b16 v[190:191], v23 offset:6144
  s_waitcnt vmcnt(17) lgkmcnt(8)
  v_mfma_f32_16x16x32_bf16 v[96:99], v[160:163], v[48:51], v[96:99]
  ds_read_b64_tr_b16 v[192:193], v20 offset:8192
  v_mfma_f32_16x16x32_bf16 v[100:103], v[160:163], v[52:55], v[100:103]
  buffer_load_dwordx4 v[248:251], off, s[36:39], s49 offset:1024 sc1
  v_mfma_f32_16x16x32_bf16 v[108:111], v[164:167], v[52:55], v[108:111]
  ds_read_b64_tr_b16 v[194:195], v20 offset:10240
  ds_read_b64_tr_b16 v[196:197], v21 offset:8192
  v_mfma_f32_16x16x32_bf16 v[104:107], v[164:167], v[48:51], v[104:107]
  ds_read_b64_tr_b16 v[198:199], v21 offset:10240
  v_mfma_f32_16x16x32_bf16 v[112:115], v[168:171], v[48:51], v[112:115]
  ds_read_b64_tr_b16 v[200:201], v22 offset:8192
  v_mfma_f32_16x16x32_bf16 v[116:119], v[168:171], v[52:55], v[116:119]
  buffer_load_dwordx4 v[252:255], off, s[64:67], s49 offset:1024 sc1
  v_mfma_f32_16x16x32_bf16 v[124:127], v[172:175], v[52:55], v[124:127]
  ds_read_b64_tr_b16 v[202:203], v22 offset:10240
  ds_read_b64_tr_b16 v[204:205], v23 offset:8192
  v_mfma_f32_16x16x32_bf16 v[120:123], v[172:175], v[48:51], v[120:123]
  ds_read_b64_tr_b16 v[206:207], v23 offset:10240
  s_waitcnt vmcnt(17) lgkmcnt(8)
  v_mfma_f32_16x16x32_bf16 v[96:99], v[176:179], v[56:59], v[96:99]
  ds_read_b64_tr_b16 v[208:209], v20 offset:12288
  v_readlane_b32 s50, v30, 30
  v_mfma_f32_16x16x32_bf16 v[100:103], v[176:179], v[60:63], v[100:103]
  ds_read_b64_tr_b16 v[210:211], v20 offset:14336
  v_mfma_f32_16x16x32_bf16 v[108:111], v[180:183], v[60:63], v[108:111]
  ds_read_b64_tr_b16 v[212:213], v21 offset:12288
  v_mfma_f32_16x16x32_bf16 v[104:107], v[180:183], v[56:59], v[104:107]
  buffer_load_dwordx4 v[32:35], off, s[36:39], s50 offset:0 sc1
  v_mfma_f32_16x16x32_bf16 v[112:115], v[184:187], v[56:59], v[112:115]
  ds_read_b64_tr_b16 v[214:215], v21 offset:14336
  ds_read_b64_tr_b16 v[216:217], v22 offset:12288
  v_mfma_f32_16x16x32_bf16 v[116:119], v[184:187], v[60:63], v[116:119]
  ds_read_b64_tr_b16 v[218:219], v22 offset:14336
  v_mfma_f32_16x16x32_bf16 v[124:127], v[188:191], v[60:63], v[124:127]
  ds_read_b64_tr_b16 v[220:221], v23 offset:12288
  v_mfma_f32_16x16x32_bf16 v[120:123], v[188:191], v[56:59], v[120:123]
  ds_read_b64_tr_b16 v[222:223], v23 offset:14336
  s_waitcnt vmcnt(15) lgkmcnt(8)
  v_mfma_f32_16x16x32_bf16 v[96:99], v[192:195], v[64:67], v[96:99]
  buffer_load_dwordx4 v[36:39], off, s[64:67], s50 offset:0 sc1
  v_mfma_f32_16x16x32_bf16 v[100:103], v[192:195], v[68:71], v[100:103]
  ds_read_b64_tr_b16 v[160:161], v20 offset:16384
  ds_read_b64_tr_b16 v[162:163], v20 offset:18432
  v_mfma_f32_16x16x32_bf16 v[108:111], v[196:199], v[68:71], v[108:111]
  ds_read_b64_tr_b16 v[164:165], v21 offset:16384
  v_mfma_f32_16x16x32_bf16 v[104:107], v[196:199], v[64:67], v[104:107]
  ds_read_b64_tr_b16 v[166:167], v21 offset:18432
  v_mfma_f32_16x16x32_bf16 v[112:115], v[200:203], v[64:67], v[112:115]
  buffer_load_dwordx4 v[40:43], off, s[36:39], s50 offset:1024 sc1
  v_mfma_f32_16x16x32_bf16 v[116:119], v[200:203], v[68:71], v[116:119]
  ds_read_b64_tr_b16 v[168:169], v22 offset:16384
  ds_read_b64_tr_b16 v[170:171], v22 offset:18432
  v_mfma_f32_16x16x32_bf16 v[124:127], v[204:207], v[68:71], v[124:127]
  ds_read_b64_tr_b16 v[172:173], v23 offset:16384
  v_mfma_f32_16x16x32_bf16 v[120:123], v[204:207], v[64:67], v[120:123]
  ds_read_b64_tr_b16 v[174:175], v23 offset:18432
  s_waitcnt vmcnt(15) lgkmcnt(8)
  v_mfma_f32_16x16x32_bf16 v[96:99], v[208:211], v[72:75], v[96:99]
  buffer_load_dwordx4 v[44:47], off, s[64:67], s50 offset:1024 sc1
  v_mfma_f32_16x16x32_bf16 v[100:103], v[208:211], v[76:79], v[100:103]
  ds_read_b64_tr_b16 v[176:177], v20 offset:20480
  ds_read_b64_tr_b16 v[178:179], v20 offset:22528
  v_mfma_f32_16x16x32_bf16 v[108:111], v[212:215], v[76:79], v[108:111]
  ds_read_b64_tr_b16 v[180:181], v21 offset:20480
  v_readlane_b32 s51, v30, 31
  v_mfma_f32_16x16x32_bf16 v[104:107], v[212:215], v[72:75], v[104:107]
  ds_read_b64_tr_b16 v[182:183], v21 offset:22528
  v_mfma_f32_16x16x32_bf16 v[112:115], v[216:219], v[72:75], v[112:115]
  ds_read_b64_tr_b16 v[184:185], v22 offset:20480
  v_mfma_f32_16x16x32_bf16 v[116:119], v[216:219], v[76:79], v[116:119]
  buffer_load_dwordx4 v[48:51], off, s[36:39], s51 offset:0 sc1
  v_mfma_f32_16x16x32_bf16 v[124:127], v[220:223], v[76:79], v[124:127]
  ds_read_b64_tr_b16 v[186:187], v22 offset:22528
  ds_read_b64_tr_b16 v[188:189], v23 offset:20480
  v_mfma_f32_16x16x32_bf16 v[120:123], v[220:223], v[72:75], v[120:123]
  ds_read_b64_tr_b16 v[190:191], v23 offset:22528
  s_waitcnt vmcnt(15) lgkmcnt(8)
  v_mfma_f32_16x16x32_bf16 v[96:99], v[160:163], v[80:83], v[96:99]
  ds_read_b64_tr_b16 v[192:193], v20 offset:24576
  v_mfma_f32_16x16x32_bf16 v[100:103], v[160:163], v[84:87], v[100:103]
  buffer_load_dwordx4 v[52:55], off, s[64:67], s51 offset:0 sc1
  v_mfma_f32_16x16x32_bf16 v[108:111], v[164:167], v[84:87], v[108:111]
  ds_read_b64_tr_b16 v[194:195], v20 offset:26624
  ds_read_b64_tr_b16 v[196:197], v21 offset:24576
  v_mfma_f32_16x16x32_bf16 v[104:107], v[164:167], v[80:83], v[104:107]
  ds_read_b64_tr_b16 v[198:199], v21 offset:26624
  v_mfma_f32_16x16x32_bf16 v[112:115], v[168:171], v[80:83], v[112:115]
  ds_read_b64_tr_b16 v[200:201], v22 offset:24576
  v_mfma_f32_16x16x32_bf16 v[116:119], v[168:171], v[84:87], v[116:119]
  buffer_load_dwordx4 v[56:59], off, s[36:39], s51 offset:1024 sc1
  v_mfma_f32_16x16x32_bf16 v[124:127], v[172:175], v[84:87], v[124:127]
  ds_read_b64_tr_b16 v[202:203], v22 offset:26624
  ds_read_b64_tr_b16 v[204:205], v23 offset:24576
  v_mfma_f32_16x16x32_bf16 v[120:123], v[172:175], v[80:83], v[120:123]
  ds_read_b64_tr_b16 v[206:207], v23 offset:26624
  s_waitcnt vmcnt(15) lgkmcnt(8)
  s_barrier
  v_mfma_f32_16x16x32_bf16 v[96:99], v[176:179], v[88:91], v[96:99]
  ds_read_b64_tr_b16 v[208:209], v20 offset:28672
  buffer_load_dwordx4 v[144:147], off, s[60:63], s5 offset:0 sc1
  v_mfma_f32_16x16x32_bf16 v[100:103], v[176:179], v[92:95], v[100:103]
  ds_read_b64_tr_b16 v[210:211], v20 offset:30720
  buffer_load_dwordx4 v[60:63], off, s[64:67], s51 offset:1024 sc1
  v_mfma_f32_16x16x32_bf16 v[108:111], v[180:183], v[92:95], v[108:111]
  ds_read_b64_tr_b16 v[212:213], v21 offset:28672
  buffer_load_dwordx4 v[148:151], off, s[60:63], s5 offset:1024 sc1
  v_mfma_f32_16x16x32_bf16 v[104:107], v[180:183], v[88:91], v[104:107]
  ds_read_b64_tr_b16 v[214:215], v21 offset:30720
  v_readlane_b32 s48, v30, 32
  v_mfma_f32_16x16x32_bf16 v[112:115], v[184:187], v[88:91], v[112:115]
  buffer_load_dwordx4 v[152:155], off, s[60:63], s5 offset:2048 sc1
  v_mfma_f32_16x16x32_bf16 v[116:119], v[184:187], v[92:95], v[116:119]
  ds_read_b64_tr_b16 v[216:217], v22 offset:28672
  ds_read_b64_tr_b16 v[218:219], v22 offset:30720
  v_mfma_f32_16x16x32_bf16 v[124:127], v[188:191], v[92:95], v[124:127]
  ds_read_b64_tr_b16 v[220:221], v23 offset:28672
  buffer_load_dwordx4 v[64:67], off, s[36:39], s48 offset:0 sc1
  v_mfma_f32_16x16x32_bf16 v[120:123], v[188:191], v[88:91], v[120:123]
  ds_read_b64_tr_b16 v[222:223], v23 offset:30720
  s_waitcnt vmcnt(18) lgkmcnt(8)
  v_mfma_f32_16x16x32_bf16 v[96:99], v[192:195], v[224:227], v[96:99]
  buffer_load_dwordx4 v[156:159], off, s[60:63], s5 offset:3072 sc1
  v_mfma_f32_16x16x32_bf16 v[100:103], v[192:195], v[228:231], v[100:103]
  ds_read_b64_tr_b16 v[160:161], v20 offset:32768
  ds_read_b64_tr_b16 v[162:163], v20 offset:34816
  v_mfma_f32_16x16x32_bf16 v[108:111], v[196:199], v[228:231], v[108:111]
  buffer_load_dwordx4 v[68:71], off, s[64:67], s48 offset:0 sc1
  v_mfma_f32_16x16x32_bf16 v[104:107], v[196:199], v[224:227], v[104:107]
  ds_read_b64_tr_b16 v[164:165], v21 offset:32768
  ds_read_b64_tr_b16 v[166:167], v21 offset:34816
  v_mfma_f32_16x16x32_bf16 v[112:115], v[200:203], v[224:227], v[112:115]
  ds_read_b64_tr_b16 v[168:169], v22 offset:32768
  v_mfma_f32_16x16x32_bf16 v[116:119], v[200:203], v[228:231], v[116:119]
  ds_read_b64_tr_b16 v[170:171], v22 offset:34816
  ds_read_b64_tr_b16 v[172:173], v23 offset:32768
  v_mfma_f32_16x16x32_bf16 v[124:127], v[204:207], v[228:231], v[124:127]
  buffer_load_dwordx4 v[72:75], off, s[36:39], s48 offset:1024 sc1
  v_mfma_f32_16x16x32_bf16 v[120:123], v[204:207], v[224:227], v[120:123]
  ds_read_b64_tr_b16 v[174:175], v23 offset:34816
  s_waitcnt vmcnt(19) lgkmcnt(8)
  v_mfma_f32_16x16x32_bf16 v[96:99], v[208:211], v[232:235], v[96:99]
  ds_read_b64_tr_b16 v[176:177], v20 offset:36864
  v_mfma_f32_16x16x32_bf16 v[100:103], v[208:211], v[236:239], v[100:103]
  ds_read_b64_tr_b16 v[178:179], v20 offset:38912
  v_mfma_f32_16x16x32_bf16 v[108:111], v[212:215], v[236:239], v[108:111]
  buffer_load_dwordx4 v[76:79], off, s[64:67], s48 offset:1024 sc1
  v_mfma_f32_16x16x32_bf16 v[104:107], v[212:215], v[232:235], v[104:107]
  ds_read_b64_tr_b16 v[180:181], v21 offset:36864
  ds_read_b64_tr_b16 v[182:183], v21 offset:38912
  v_mfma_f32_16x16x32_bf16 v[112:115], v[216:219], v[232:235], v[112:115]
  ds_read_b64_tr_b16 v[184:185], v22 offset:36864
  v_mfma_f32_16x16x32_bf16 v[116:119], v[216:219], v[236:239], v[116:119]
  ds_read_b64_tr_b16 v[186:187], v22 offset:38912
  v_mfma_f32_16x16x32_bf16 v[124:127], v[220:223], v[236:239], v[124:127]
  ds_read_b64_tr_b16 v[188:189], v23 offset:36864
  v_mfma_f32_16x16x32_bf16 v[120:123], v[220:223], v[232:235], v[120:123]
  ds_read_b64_tr_b16 v[190:191], v23 offset:38912
  s_waitcnt vmcnt(18) lgkmcnt(8)
  v_mfma_f32_16x16x32_bf16 v[96:99], v[160:163], v[240:243], v[96:99]
  ds_read_b64_tr_b16 v[192:193], v20 offset:40960
  v_mfma_f32_16x16x32_bf16 v[100:103], v[160:163], v[244:247], v[100:103]
  ds_read_b64_tr_b16 v[194:195], v20 offset:43008
  v_mfma_f32_16x16x32_bf16 v[108:111], v[164:167], v[244:247], v[108:111]
  ds_read_b64_tr_b16 v[196:197], v21 offset:40960
  v_mfma_f32_16x16x32_bf16 v[104:107], v[164:167], v[240:243], v[104:107]
  ds_read_b64_tr_b16 v[198:199], v21 offset:43008
  v_mfma_f32_16x16x32_bf16 v[112:115], v[168:171], v[240:243], v[112:115]
  ds_read_b64_tr_b16 v[200:201], v22 offset:40960
  v_mfma_f32_16x16x32_bf16 v[116:119], v[168:171], v[244:247], v[116:119]
  ds_read_b64_tr_b16 v[202:203], v22 offset:43008
  v_mfma_f32_16x16x32_bf16 v[124:127], v[172:175], v[244:247], v[124:127]
  ds_read_b64_tr_b16 v[204:205], v23 offset:40960
  v_mfma_f32_16x16x32_bf16 v[120:123], v[172:175], v[240:243], v[120:123]
  ds_read_b64_tr_b16 v[206:207], v23 offset:43008
  s_waitcnt vmcnt(16) lgkmcnt(8)
  v_mfma_f32_16x16x32_bf16 v[96:99], v[176:179], v[248:251], v[96:99]
  ds_read_b64_tr_b16 v[208:209], v20 offset:45056
  v_mfma_f32_16x16x32_bf16 v[100:103], v[176:179], v[252:255], v[100:103]
  ds_read_b64_tr_b16 v[210:211], v20 offset:47104
  v_mfma_f32_16x16x32_bf16 v[108:111], v[180:183], v[252:255], v[108:111]
  ds_read_b64_tr_b16 v[212:213], v21 offset:45056
  v_mfma_f32_16x16x32_bf16 v[104:107], v[180:183], v[248:251], v[104:107]
  ds_read_b64_tr_b16 v[214:215], v21 offset:47104
  v_mfma_f32_16x16x32_bf16 v[112:115], v[184:187], v[248:251], v[112:115]
  ds_read_b64_tr_b16 v[216:217], v22 offset:45056
  v_mfma_f32_16x16x32_bf16 v[116:119], v[184:187], v[252:255], v[116:119]
  ds_read_b64_tr_b16 v[218:219], v22 offset:47104
  v_mfma_f32_16x16x32_bf16 v[124:127], v[188:191], v[252:255], v[124:127]
  ds_read_b64_tr_b16 v[220:221], v23 offset:45056
  v_mfma_f32_16x16x32_bf16 v[120:123], v[188:191], v[248:251], v[120:123]
  ds_read_b64_tr_b16 v[222:223], v23 offset:47104
  s_waitcnt vmcnt(14) lgkmcnt(8)
  v_mfma_f32_16x16x32_bf16 v[96:99], v[192:195], v[32:35], v[96:99]
  ds_read_b64_tr_b16 v[160:161], v20 offset:49152
  v_mfma_f32_16x16x32_bf16 v[100:103], v[192:195], v[36:39], v[100:103]
  ds_read_b64_tr_b16 v[162:163], v20 offset:51200
  v_mfma_f32_16x16x32_bf16 v[108:111], v[196:199], v[36:39], v[108:111]
  ds_read_b64_tr_b16 v[164:165], v21 offset:49152
  v_mfma_f32_16x16x32_bf16 v[104:107], v[196:199], v[32:35], v[104:107]
  ds_read_b64_tr_b16 v[166:167], v21 offset:51200
  v_mfma_f32_16x16x32_bf16 v[112:115], v[200:203], v[32:35], v[112:115]
  ds_read_b64_tr_b16 v[168:169], v22 offset:49152
  v_mfma_f32_16x16x32_bf16 v[116:119], v[200:203], v[36:39], v[116:119]
  ds_read_b64_tr_b16 v[170:171], v22 offset:51200
  v_mfma_f32_16x16x32_bf16 v[124:127], v[204:207], v[36:39], v[124:127]
  ds_read_b64_tr_b16 v[172:173], v23 offset:49152
  v_mfma_f32_16x16x32_bf16 v[120:123], v[204:207], v[32:35], v[120:123]
  ds_read_b64_tr_b16 v[174:175], v23 offset:51200
  s_waitcnt vmcnt(12) lgkmcnt(8)
  v_mfma_f32_16x16x32_bf16 v[96:99], v[208:211], v[40:43], v[96:99]
  ds_read_b64_tr_b16 v[176:177], v20 offset:53248
  v_mfma_f32_16x16x32_bf16 v[100:103], v[208:211], v[44:47], v[100:103]
  ds_read_b64_tr_b16 v[178:179], v20 offset:55296
  v_mfma_f32_16x16x32_bf16 v[108:111], v[212:215], v[44:47], v[108:111]
  ds_read_b64_tr_b16 v[180:181], v21 offset:53248
  v_mfma_f32_16x16x32_bf16 v[104:107], v[212:215], v[40:43], v[104:107]
  ds_read_b64_tr_b16 v[182:183], v21 offset:55296
  v_mfma_f32_16x16x32_bf16 v[112:115], v[216:219], v[40:43], v[112:115]
  ds_read_b64_tr_b16 v[184:185], v22 offset:53248
  v_mfma_f32_16x16x32_bf16 v[116:119], v[216:219], v[44:47], v[116:119]
  ds_read_b64_tr_b16 v[186:187], v22 offset:55296
  v_mfma_f32_16x16x32_bf16 v[124:127], v[220:223], v[44:47], v[124:127]
  ds_read_b64_tr_b16 v[188:189], v23 offset:53248
  v_mfma_f32_16x16x32_bf16 v[120:123], v[220:223], v[40:43], v[120:123]
  ds_read_b64_tr_b16 v[190:191], v23 offset:55296
  s_waitcnt vmcnt(10) lgkmcnt(8)
  v_mfma_f32_16x16x32_bf16 v[96:99], v[160:163], v[48:51], v[96:99]
  ds_read_b64_tr_b16 v[192:193], v20 offset:57344
  s_waitcnt vmcnt(3)
  v_mfma_f32_16x16x32_bf16 v[100:103], v[160:163], v[52:55], v[100:103]
  ds_read_b64_tr_b16 v[194:195], v20 offset:59392
  v_lshlrev_b32 v128, 16, v144
  v_mfma_f32_16x16x32_bf16 v[108:111], v[164:167], v[52:55], v[108:111]
  ds_read_b64_tr_b16 v[196:197], v21 offset:57344
  v_and_b32 v129, s11, v144
  v_mfma_f32_16x16x32_bf16 v[104:107], v[164:167], v[48:51], v[104:107]
  ds_read_b64_tr_b16 v[198:199], v21 offset:59392
  v_lshlrev_b32 v130, 16, v145
  v_mfma_f32_16x16x32_bf16 v[112:115], v[168:171], v[48:51], v[112:115]
  ds_read_b64_tr_b16 v[200:201], v22 offset:57344
  v_and_b32 v131, s11, v145
  v_mfma_f32_16x16x32_bf16 v[116:119], v[168:171], v[52:55], v[116:119]
  ds_read_b64_tr_b16 v[202:203], v22 offset:59392
  v_lshlrev_b32 v132, 16, v146
  v_mfma_f32_16x16x32_bf16 v[124:127], v[172:175], v[52:55], v[124:127]
  ds_read_b64_tr_b16 v[204:205], v23 offset:57344
  v_and_b32 v133, s11, v146
  v_mfma_f32_16x16x32_bf16 v[120:123], v[172:175], v[48:51], v[120:123]
  ds_read_b64_tr_b16 v[206:207], v23 offset:59392
  s_waitcnt lgkmcnt(8)
  v_mfma_f32_16x16x32_bf16 v[96:99], v[176:179], v[56:59], v[96:99]
  ds_read_b64_tr_b16 v[208:209], v20 offset:61440
  v_lshlrev_b32 v134, 16, v147
  v_mfma_f32_16x16x32_bf16 v[100:103], v[176:179], v[60:63], v[100:103]
  ds_read_b64_tr_b16 v[210:211], v20 offset:63488
  v_and_b32 v135, s11, v147
  v_mfma_f32_16x16x32_bf16 v[108:111], v[180:183], v[60:63], v[108:111]
  ds_read_b64_tr_b16 v[212:213], v21 offset:61440
  v_lshlrev_b32 v136, 16, v148
  v_mfma_f32_16x16x32_bf16 v[104:107], v[180:183], v[56:59], v[104:107]
  ds_read_b64_tr_b16 v[214:215], v21 offset:63488
  v_and_b32 v137, s11, v148
  v_mfma_f32_16x16x32_bf16 v[112:115], v[184:187], v[56:59], v[112:115]
  ds_read_b64_tr_b16 v[216:217], v22 offset:61440
  v_lshlrev_b32 v138, 16, v149
  v_mfma_f32_16x16x32_bf16 v[116:119], v[184:187], v[60:63], v[116:119]
  ds_read_b64_tr_b16 v[218:219], v22 offset:63488
  v_and_b32 v139, s11, v149
  v_mfma_f32_16x16x32_bf16 v[124:127], v[188:191], v[60:63], v[124:127]
  ds_read_b64_tr_b16 v[220:221], v23 offset:61440
  v_lshlrev_b32 v140, 16, v150
  v_mfma_f32_16x16x32_bf16 v[120:123], v[188:191], v[56:59], v[120:123]
  ds_read_b64_tr_b16 v[222:223], v23 offset:63488
  s_waitcnt vmcnt(2) lgkmcnt(8)
  v_mfma_f32_16x16x32_bf16 v[96:99], v[192:195], v[64:67], v[96:99]
  v_mov_b32 v20, 0
  v_mov_b32 v21, 0
  v_mfma_f32_16x16x32_bf16 v[100:103], v[192:195], v[68:71], v[100:103]
  v_mov_b32 v22, 0
  v_mov_b32 v23, 0
  v_mfma_f32_16x16x32_bf16 v[108:111], v[196:199], v[68:71], v[108:111]
  v_and_b32 v141, s11, v150
  v_lshlrev_b32 v142, 16, v151
  v_and_b32 v143, s11, v151
  v_mfma_f32_16x16x32_bf16 v[104:107], v[196:199], v[64:67], v[104:107]
  v_lshlrev_b32 v144, 16, v152
  v_and_b32 v145, s11, v152
  v_lshlrev_b32 v146, 16, v153
  v_mfma_f32_16x16x32_bf16 v[112:115], v[200:203], v[64:67], v[112:115]
  v_and_b32 v147, s11, v153
  v_lshlrev_b32 v148, 16, v154
  v_and_b32 v149, s11, v154
  v_mfma_f32_16x16x32_bf16 v[116:119], v[200:203], v[68:71], v[116:119]
  v_lshlrev_b32 v150, 16, v155
  v_and_b32 v151, s11, v155
  v_lshlrev_b32 v152, 16, v156
  v_mfma_f32_16x16x32_bf16 v[124:127], v[204:207], v[68:71], v[124:127]
  v_and_b32 v153, s11, v156
  v_lshlrev_b32 v154, 16, v157
  v_and_b32 v155, s11, v157
  v_mfma_f32_16x16x32_bf16 v[120:123], v[204:207], v[64:67], v[120:123]
  s_waitcnt vmcnt(0) lgkmcnt(0)
  v_lshlrev_b32 v156, 16, v158
  v_and_b32 v157, s11, v158
  v_mfma_f32_16x16x32_bf16 v[96:99], v[208:211], v[72:75], v[96:99]
  v_lshlrev_b32 v158, 16, v159
  v_and_b32 v159, s11, v159
  v_mfma_f32_16x16x32_bf16 v[100:103], v[208:211], v[76:79], v[100:103]
  v_mfma_f32_16x16x32_bf16 v[108:111], v[212:215], v[76:79], v[108:111]
  v_mfma_f32_16x16x32_bf16 v[104:107], v[212:215], v[72:75], v[104:107]
  v_mfma_f32_16x16x32_bf16 v[112:115], v[216:219], v[72:75], v[112:115]
  v_mfma_f32_16x16x32_bf16 v[116:119], v[216:219], v[76:79], v[116:119]
  v_mfma_f32_16x16x32_bf16 v[124:127], v[220:223], v[76:79], v[124:127]
  v_mfma_f32_16x16x32_bf16 v[120:123], v[220:223], v[72:75], v[120:123]
  s_lshl_b32 s3, s7, 4
  s_mov_b32 s10, 0x3f803f80
  s_lshl_b32 s4, s7, 3
  s_add_u32 s5, s3, s4
  v_xor_b32 v6, 32, v4
  v_xor_b32 v7, 64, v4
  v_xor_b32 v8, 96, v4
  v_xor_b32 v9, 64, v12
  v_pk_add_f32 v[96:97], v[96:97], v[128:129]
  v_pk_add_f32 v[98:99], v[98:99], v[130:131]
  v_cvt_pk_bf16_f32 v240, v96, v97
  v_cvt_pk_bf16_f32 v241, v98, v99
  v_pk_add_f32 v[104:105], v[104:105], v[136:137]
  v_pk_add_f32 v[106:107], v[106:107], v[138:139]
  v_cvt_pk_bf16_f32 v242, v104, v105
  v_cvt_pk_bf16_f32 v243, v106, v107
  ds_write_b64 v4, v[240:241] offset:0
  ds_write_b64 v6, v[242:243] offset:0
  v_pk_add_f32 v[112:113], v[112:113], v[144:145]
  v_pk_add_f32 v[114:115], v[114:115], v[146:147]
  v_cvt_pk_bf16_f32 v244, v112, v113
  v_cvt_pk_bf16_f32 v245, v114, v115
  v_pk_add_f32 v[120:121], v[120:121], v[152:153]
  v_pk_add_f32 v[122:123], v[122:123], v[154:155]
  v_cvt_pk_bf16_f32 v246, v120, v121
  v_cvt_pk_bf16_f32 v247, v122, v123
  ds_write_b64 v7, v[244:245] offset:0
  ds_write_b64 v8, v[246:247] offset:0
  ds_read_b128 v[32:35], v5 offset:0
  ds_read_b128 v[36:39], v5 offset:1024
  v_pk_add_f32 v[100:101], v[100:101], v[132:133]
  v_pk_add_f32 v[102:103], v[102:103], v[134:135]
  v_cvt_pk_bf16_f32 v248, v100, v101
  v_cvt_pk_bf16_f32 v249, v102, v103
  v_pk_add_f32 v[108:109], v[108:109], v[140:141]
  v_pk_add_f32 v[110:111], v[110:111], v[142:143]
  v_cvt_pk_bf16_f32 v250, v108, v109
  v_cvt_pk_bf16_f32 v251, v110, v111
  ds_write_b64 v4, v[248:249] offset:2048
  ds_write_b64 v6, v[250:251] offset:2048
  v_pk_add_f32 v[116:117], v[116:117], v[148:149]
  v_pk_add_f32 v[118:119], v[118:119], v[150:151]
  v_cvt_pk_bf16_f32 v252, v116, v117
  v_cvt_pk_bf16_f32 v253, v118, v119
  v_pk_add_f32 v[124:125], v[124:125], v[156:157]
  v_pk_add_f32 v[126:127], v[126:127], v[158:159]
  v_cvt_pk_bf16_f32 v254, v124, v125
  v_cvt_pk_bf16_f32 v255, v126, v127
  ds_write_b64 v7, v[252:253] offset:2048
  ds_write_b64 v8, v[254:255] offset:2048
  ds_read_b128 v[40:43], v5 offset:2048
  ds_read_b128 v[44:47], v5 offset:3072
  s_waitcnt lgkmcnt(7)
  buffer_store_dwordx4 v[32:35], v12, s[40:43], 0 offen sc1
  s_waitcnt lgkmcnt(6)
  buffer_store_dwordx4 v[36:39], v9, s[40:43], s4 offen sc1
  s_waitcnt lgkmcnt(1)
  buffer_store_dwordx4 v[40:43], v12, s[40:43], s3 offen sc1
  s_waitcnt lgkmcnt(0)
  buffer_store_dwordx4 v[44:47], v9, s[40:43], s5 offen sc1
  s_cmp_eq_u32 s96, 1
  s_cbranch_scc1 L_w2_end
  v_dot2_f32_bf16 v20, v240, s10, v20
  v_dot2_f32_bf16 v22, v240, v240, v22
  v_dot2_f32_bf16 v20, v241, s10, v20
  v_dot2_f32_bf16 v22, v241, v241, v22
  v_dot2_f32_bf16 v20, v242, s10, v20
  v_dot2_f32_bf16 v22, v242, v242, v22
  v_dot2_f32_bf16 v20, v243, s10, v20
  v_dot2_f32_bf16 v22, v243, v243, v22
  v_dot2_f32_bf16 v20, v244, s10, v20
  v_dot2_f32_bf16 v22, v244, v244, v22
  v_dot2_f32_bf16 v20, v245, s10, v20
  v_dot2_f32_bf16 v22, v245, v245, v22
  v_dot2_f32_bf16 v20, v246, s10, v20
  v_dot2_f32_bf16 v22, v246, v246, v22
  v_dot2_f32_bf16 v20, v247, s10, v20
  v_dot2_f32_bf16 v22, v247, v247, v22
  v_dot2_f32_bf16 v21, v248, s10, v21
  v_dot2_f32_bf16 v23, v248, v248, v23
  v_dot2_f32_bf16 v21, v249, s10, v21
  v_dot2_f32_bf16 v23, v249, v249, v23
  v_dot2_f32_bf16 v21, v250, s10, v21
  v_dot2_f32_bf16 v23, v250, v250, v23
  v_dot2_f32_bf16 v21, v251, s10, v21
  v_dot2_f32_bf16 v23, v251, v251, v23
  v_dot2_f32_bf16 v21, v252, s10, v21
  v_dot2_f32_bf16 v23, v252, v252, v23
  v_dot2_f32_bf16 v21, v253, s10, v21
  v_dot2_f32_bf16 v23, v253, v253, v23
  v_dot2_f32_bf16 v21, v254, s10, v21
  v_dot2_f32_bf16 v23, v254, v254, v23
  v_dot2_f32_bf16 v21, v255, s10, v21
  v_dot2_f32_bf16 v23, v255, v255, v23
  s_nop 2
  v_permlane32_swap_b32 v20, v21
  v_permlane32_swap_b32 v22, v23
  v_add_f32 v20, v20, v21
  v_add_f32 v22, v22, v23
  s_nop 1
  v_permlane16_swap_b32 v20, v22
  v_add_f32 v20, v20, v22
  buffer_store_dword v20, v18, s[56:59], 0 offen sc1
  s_waitcnt vmcnt(0) lgkmcnt(0)
  s_barrier
  s_mov_b32 s96, 1
  s_add_u32 s12, s22, 33554432
  s_addc_u32 s13, s23, 0
  s_add_u32 s34, s22, 67108864
  s_addc_u32 s35, s23, 0
  s_add_u32 s97, s97, 1
  s_branch L_attn_body
L_w2_c1:
```

```asm
; @launch grid=(256,1,1) block=(512,1,1) lds=163840
.amdgcn_target "amdgcn-amd-amdhsa--gfx950"
.text
.globl interleave_layers__sliding_local_dilated__dense_activation_gelu__prompt_kernel
.p2align 12
.fill 832, 4, 0xbf800000
.type interleave_layers__sliding_local_dilated__dense_activation_gelu__prompt_kernel,@function
interleave_layers__sliding_local_dilated__dense_activation_gelu__prompt_kernel:
L_attn_c0:
  s_load_dwordx4 s[16:19], s[0:1], 0
  s_load_dwordx2 s[20:21], s[0:1], 16
  s_load_dwordx2 s[22:23], s[0:1], 80
  s_load_dwordx8 s[24:31], s[0:1], 32
  s_load_dwordx2 s[32:33], s[0:1], 64
  s_load_dwordx2 s[34:35], s[0:1], 80
  s_load_dwordx2 s[12:13], s[0:1], 0
  s_load_dwordx2 s[64:65], s[0:1], 72
  s_mov_b32 s96, 0
  s_mov_b32 s97, 0
L_attn_body:
  s_cmp_ge_u32 s2, 256
  s_cbranch_scc1 L_attn_end
  v_lshrrev_b32 v2, 6, v0
  v_and_b32 v1, 63, v0
  v_readfirstlane_b32 s70, v2
  s_and_b32 s3, s2, 7
  s_lshr_b32 s99, s2, 3
  s_and_b32 s5, s3, 1
  s_lshl_b32 s5, s5, 3
  s_and_b32 s6, s99, 7
  s_add_u32 s68, s5, s6
  s_lshr_b32 s5, s3, 1
  s_lshl_b32 s5, s5, 2
  s_lshr_b32 s6, s99, 3
  s_add_u32 s69, s5, s6
  s_cmp_eq_u32 s96, 0
  s_cbranch_scc1 L_attn_map
  s_and_b32 s3, s2, 7
  s_and_b32 s5, s3, 3
  s_lshl_b32 s5, s5, 2
  s_and_b32 s6, s99, 3
  s_add_u32 s68, s5, s6
  s_lshr_b32 s5, s3, 2
  s_lshl_b32 s5, s5, 3
  s_lshr_b32 s6, s99, 2
  s_add_u32 s69, s5, s6
L_attn_map:
  s_cmp_lt_u32 s70, 4
  s_cbranch_scc1 L_attn_compute
L_attn_loader:
  s_add_u32 s8, s70, s69
  s_and_b32 s8, s8, 3
  s_add_u32 s9, s70, s68
  s_and_b32 s9, s9, 3
  s_lshl_b32 s76, s8, 12
  s_lshl_b32 s77, s9, 11
  s_add_u32 s77, s77, 16384
  s_lshl_b32 s11, s68, 7
  v_and_b32 v10, 7, v1
  v_lshrrev_b32 v3, 3, v1
  s_lshr_b32 s10, s76, 7
  s_lshl_b32 s3, s68, 7
  s_add_u32 s10, s10, s3
  v_add_u32 v3, s10, v3
  s_cmp_eq_u32 s96, 1
  s_cselect_b32 s5, 128, 0
  s_add_u32 s5, s5, 2048
  s_lshl_b32 s6, s5, 3
  v_mul_u32_u24 v3, s5, v3
  v_lshrrev_b32 v2, 4, v1
  v_xor_b32 v4, v2, v10
  v_lshl_add_u32 v4, v4, 4, v3
  v_add_u32 v3, s6, v3
  v_add_u32 v5, 4, v2
  v_xor_b32 v5, v5, v10
  v_lshl_add_u32 v5, v5, 4, v3
  v_add_u32 v3, s6, v3
  v_xor_b32 v6, v2, v10
  v_lshl_add_u32 v6, v6, 4, v3
  v_add_u32 v3, s6, v3
  v_add_u32 v7, 4, v2
  v_xor_b32 v7, v7, v10
  v_lshl_add_u32 v7, v7, 4, v3
  v_lshrrev_b32 v3, 3, v1
  s_lshl_b32 s10, s9, 4
  v_add_u32 v3, s10, v3
  v_mul_u32_u24 v3, 6144, v3
  v_lshrrev_b32 v2, 3, v1
  v_and_b32 v2, 2, v2
  v_xor_b32 v2, v2, v10
  s_mul_i32 s10, s69, 128
  v_add_u32 v3, s10, v3
  v_lshl_add_u32 v8, v2, 4, v3
  v_xor_b32 v2, 4, v2
  v_add_u32 v3, 49152, v3
  v_lshl_add_u32 v9, v2, 4, v3
  s_and_b32 s10, s70, 3
  s_lshl_b32 s78, s10, 9
  s_add_u32 s78, s78, 40960
  s_lshl_b32 s14, s10, 2
  s_add_u32 s14, s14, s11
  s_sub_u32 s14, s14, 16
  v_lshrrev_b32 v3, 3, v1
  v_add_u32 v3, s14, v3
  v_max_i32 v3, 0, v3
  v_mul_u32_u24 v3, s5, v3
  s_lshl_b32 s14, s10, 1
  v_lshrrev_b32 v2, 4, v1
  v_add_u32 v2, s14, v2
  v_and_b32 v2, 7, v2
  v_xor_b32 v2, v2, v10
  v_lshl_add_u32 v28, v2, 4, v3
  s_cmp_eq_u32 s10, 0
  s_cselect_b32 s14, 0xffffff00, -1
  s_mov_b32 s15, 0
  s_mov_b32 s75, 0
  s_add_u32 s100, s68, s69
  s_mov_b32 s101, -1
  s_add_u32 s3, s68, s69
  s_and_b32 s3, s3, 3
  s_mov_b32 s100, 0x75463102
  s_mov_b32 s101, 0xfdceb98a
  s_cmp_eq_u32 s3, 1
  s_cselect_b32 s100, 0x65742130, s100
  s_cselect_b32 s101, 0xedfca9b8, s101
  s_cmp_eq_u32 s3, 2
  s_cselect_b32 s100, 0x68532410, s100
  s_cselect_b32 s101, 0xfedbac97, s101
  s_cmp_eq_u32 s3, 3
  s_cselect_b32 s100, 0x96435210, s100
  s_cselect_b32 s101, 0xfecbda87, s101
  s_mov_b32 s91, s69
  s_and_b32 s92, s69, 3
  s_add_u32 s92, s92, 1
  s_and_b32 s73, s100, 15
  s_cmp_eq_u32 s73, s91
  s_cselect_b32 s74, 4, 0
  s_lshr_b64 s[100:101], s[100:101], s74
  s_and_b32 s73, s100, 15
  s_sub_u32 s92, s92, 1
  s_cselect_b32 s73, s91, s73
  s_cselect_b32 s74, 0, 4
  s_lshr_b64 s[100:101], s[100:101], s74
  s_mul_i32 s74, s73, 393216
  s_lshl_b32 s73, s73, 7
  s_waitcnt lgkmcnt(0)
  s_mov_b32 s36, s12
  s_and_b32 s37, s13, 0xffff
  s_mov_b32 s38, 4194304
  s_mov_b32 s39, 0x00020000
  s_cmp_eq_u32 s96, 1
  s_cselect_b32 s38, 128, 0
  s_add_u32 s38, s38, 2048
  s_lshl_b32 s38, s38, 11
  s_mov_b32 s40, s18
  s_and_b32 s41, s19, 0xffff
  s_mov_b32 s42, 6291456
  s_mov_b32 s43, 0x00020000
  s_cmp_lg_u32 s96, 0
  s_cbranch_scc1 L_attn_ld1
  s_mov_b32 s48, s28
  s_and_b32 s49, s29, 0xffff
  s_mov_b32 s50, 7340032
  s_mov_b32 s51, 0x00020000
  s_cmp_eq_u32 s96, 0
  s_cselect_b32 s50, s50, 0
  s_and_b32 s3, s70, 3
  s_lshl_b32 s4, s2, 2
  s_add_u32 s3, s3, s4
  s_mul_i32 s98, s3, 3584
  s_add_u32 s98, s98, 0
  s_add_u32 s3, s75, s76
  s_add_u32 m0, s3, 0
  s_nop 0
  buffer_load_dwordx4 v4, s[36:39], s73 offen lds
  s_add_u32 m0, s3, 1024
  s_nop 0
  buffer_load_dwordx4 v5, s[36:39], s73 offen lds
  s_add_u32 m0, s3, 2048
  s_nop 0
  buffer_load_dwordx4 v6, s[36:39], s73 offen lds
  s_add_u32 m0, s3, 3072
  s_nop 0
  buffer_load_dwordx4 v7, s[36:39], s73 offen lds
  s_add_u32 m0, s78, s75
  s_mov_b64 exec, s[14:15]
  buffer_load_dwordx4 v28, s[36:39], s73 offen lds
  s_mov_b64 exec, -1
  s_add_u32 s3, s75, s77
  s_add_u32 m0, s3, 0
  s_add_u32 s4, s74, 0
  buffer_load_dwordx4 v8, s[40:43], s4 offen lds
  s_add_u32 m0, s3, 1024
  s_nop 0
  buffer_load_dwordx4 v9, s[40:43], s4 offen lds
  s_add_u32 m0, s3, 8192
  s_add_u32 s4, s74, 2048
  buffer_load_dwordx4 v8, s[40:43], s4 offen lds
  s_add_u32 m0, s3, 9216
  s_nop 0
  buffer_load_dwordx4 v9, s[40:43], s4 offen lds
  s_add_u32 m0, s3, 16384
  s_add_u32 s4, s74, 4096
  buffer_load_dwordx4 v8, s[40:43], s4 offen lds
  s_add_u32 m0, s3, 17408
  s_nop 0
  buffer_load_dwordx4 v9, s[40:43], s4 offen lds
  s_and_b32 s73, s100, 15
  s_cmp_eq_u32 s73, s91
  s_cselect_b32 s74, 4, 0
  s_lshr_b64 s[100:101], s[100:101], s74
  s_and_b32 s73, s100, 15
  s_sub_u32 s92, s92, 1
  s_cselect_b32 s73, s91, s73
  s_cselect_b32 s74, 0, 4
  s_lshr_b64 s[100:101], s[100:101], s74
  s_mul_i32 s74, s73, 393216
  s_lshl_b32 s73, s73, 7
  s_add_u32 s75, s75, 43008
  s_cmp_eq_u32 s75, 129024
  s_cselect_b32 s75, 0, s75
  s_add_u32 s3, s75, s76
  s_add_u32 m0, s3, 0
  s_nop 0
  buffer_load_dwordx4 v4, s[36:39], s73 offen lds
  s_add_u32 m0, s3, 1024
  s_nop 0
  buffer_load_dwordx4 v5, s[36:39], s73 offen lds
  s_add_u32 m0, s3, 2048
  s_nop 0
  buffer_load_dwordx4 v6, s[36:39], s73 offen lds
  s_add_u32 m0, s3, 3072
  s_nop 0
  buffer_load_dwordx4 v7, s[36:39], s73 offen lds
  s_add_u32 m0, s78, s75
  s_mov_b64 exec, s[14:15]
  buffer_load_dwordx4 v28, s[36:39], s73 offen lds
  s_mov_b64 exec, -1
  s_add_u32 s3, s75, s77
  s_add_u32 m0, s3, 0
  s_add_u32 s4, s74, 0
  buffer_load_dwordx4 v8, s[40:43], s4 offen lds
  s_add_u32 m0, s3, 1024
  s_nop 0
  buffer_load_dwordx4 v9, s[40:43], s4 offen lds
  s_add_u32 m0, s3, 8192
  s_add_u32 s4, s74, 2048
  buffer_load_dwordx4 v8, s[40:43], s4 offen lds
  s_add_u32 m0, s3, 9216
  s_nop 0
  buffer_load_dwordx4 v9, s[40:43], s4 offen lds
  s_add_u32 m0, s3, 16384
  s_add_u32 s4, s74, 4096
  buffer_load_dwordx4 v8, s[40:43], s4 offen lds
  s_add_u32 m0, s3, 17408
  s_nop 0
  buffer_load_dwordx4 v9, s[40:43], s4 offen lds
  s_and_b32 s73, s100, 15
  s_cmp_eq_u32 s73, s91
  s_cselect_b32 s74, 4, 0
  s_lshr_b64 s[100:101], s[100:101], s74
  s_and_b32 s73, s100, 15
  s_sub_u32 s92, s92, 1
  s_cselect_b32 s73, s91, s73
  s_cselect_b32 s74, 0, 4
  s_lshr_b64 s[100:101], s[100:101], s74
  s_mul_i32 s74, s73, 393216
  s_lshl_b32 s73, s73, 7
  s_add_u32 s75, s75, 43008
  s_cmp_eq_u32 s75, 129024
  s_cselect_b32 s75, 0, s75
  s_mov_b32 s52, s24
  s_and_b32 s53, s25, 0xffff
  s_mov_b32 s54, 7340032
  s_mov_b32 s55, 0x00020000
  s_min_u32 s3, s2, 223
  s_mul_i32 s4, s3, 4682
  s_lshr_b32 s4, s4, 16
  s_mul_i32 s5, s4, 14
  s_sub_u32 s3, s3, s5
  s_lshl_b32 s3, s3, 2
  s_and_b32 s5, s70, 3
  s_add_u32 s3, s3, s5
  s_mul_i32 s5, s4, 458752
  s_lshl_b32 s8, s3, 7
  s_add_u32 s95, s5, s8
  s_lshl_b32 s9, s4, 14
  s_lshl_b32 s8, s3, 8
  s_add_u32 s94, s9, s8
  v_lshrrev_b32 v2, 3, v1
  v_mul_u32_u24 v2, 7168, v2
  v_and_b32 v3, 7, v1
  v_lshl_add_u32 v26, v3, 4, v2
  s_and_b32 s3, s70, 3
  s_lshl_b32 s4, s2, 2
  s_add_u32 s3, s3, s4
  s_sub_u32 s4, 384, s40
  s_and_b32 s4, s4, 0x380
  s_mul_i32 s5, s3, 6144
  s_add_u32 s5, s5, s4
  s_buffer_load_dword s84, s[40:43], s5 offset:0
  s_buffer_load_dword s84, s[40:43], s5 offset:64
  s_buffer_load_dword s84, s[40:43], s5 offset:1024
  s_buffer_load_dword s84, s[40:43], s5 offset:1088
  s_buffer_load_dword s84, s[40:43], s5 offset:2048
  s_buffer_load_dword s84, s[40:43], s5 offset:2112
  s_buffer_load_dword s84, s[40:43], s5 offset:3072
  s_buffer_load_dword s84, s[40:43], s5 offset:3136
  s_buffer_load_dword s84, s[40:43], s5 offset:4096
  s_buffer_load_dword s84, s[40:43], s5 offset:4160
  s_buffer_load_dword s84, s[40:43], s5 offset:5120
  s_buffer_load_dword s84, s[40:43], s5 offset:5184
  s_add_u32 s56, s22, 24903680
  s_addc_u32 s57, s23, 0
  s_and_b32 s57, s57, 0xffff
  s_mov_b32 s58, 262144
  s_mov_b32 s59, 0x00020000
  s_and_b32 s3, s70, 3
  s_lshl2_add_u32 s4, s68, s3
  s_lshl_b32 s4, s4, 8
  v_lshrrev_b32 v2, 4, v1
  v_and_b32 v3, 15, v1
  v_lshl_add_u32 v3, v3, 4, s4
  v_lshl_add_u32 v18, v2, 14, v3
  s_lshl_b32 s4, s68, 5
  s_add_u32 s4, s4, s3
  s_sub_u32 s4, s4, 4
  s_max_i32 s4, s4, 0
  s_lshl_b32 s4, s4, 5
  v_lshrrev_b32 v2, 2, v1
  v_and_b32 v3, 3, v1
  v_lshl_add_u32 v3, v3, 3, s4
  v_lshl_add_u32 v19, v2, 14, v3
  s_lshl_b32 s3, s68, 2
  s_sub_u32 s3, s3, 4
  v_and_b32 v20, 7, v1
  v_add_u32 v20, s3, v20
  v_max_i32 v20, 0, v20
  v_lshlrev_b32 v20, 2, v20
  s_and_b32 s65, s65, 0xffff
  s_mov_b32 s66, 256
  s_mov_b32 s67, 0x00020000
  s_waitcnt vmcnt(11)
  s_barrier
  s_add_u32 s3, s75, s76
  s_add_u32 m0, s3, 0
  s_nop 0
  buffer_load_dwordx4 v4, s[36:39], s73 offen lds
  s_add_u32 m0, s3, 1024
  s_nop 0
  buffer_load_dwordx4 v5, s[36:39], s73 offen lds
  s_add_u32 m0, s3, 2048
  s_nop 0
  buffer_load_dwordx4 v6, s[36:39], s73 offen lds
  s_add_u32 m0, s3, 3072
  s_nop 0
  buffer_load_dwordx4 v7, s[36:39], s73 offen lds
  s_add_u32 m0, s78, s75
  s_mov_b64 exec, s[14:15]
  buffer_load_dwordx4 v28, s[36:39], s73 offen lds
  s_mov_b64 exec, -1
  s_add_u32 s3, s75, s77
  s_add_u32 m0, s3, 0
  s_add_u32 s4, s74, 0
  buffer_load_dwordx4 v8, s[40:43], s4 offen lds
  s_add_u32 m0, s3, 1024
  s_nop 0
  buffer_load_dwordx4 v9, s[40:43], s4 offen lds
  s_add_u32 m0, s3, 8192
  s_add_u32 s4, s74, 2048
  buffer_load_dwordx4 v8, s[40:43], s4 offen lds
  s_add_u32 m0, s3, 9216
  s_nop 0
  buffer_load_dwordx4 v9, s[40:43], s4 offen lds
  s_add_u32 m0, s3, 16384
  s_add_u32 s4, s74, 4096
  buffer_load_dwordx4 v8, s[40:43], s4 offen lds
  s_add_u32 m0, s3, 17408
  s_nop 0
  buffer_load_dwordx4 v9, s[40:43], s4 offen lds
  s_and_b32 s73, s100, 15
  s_cmp_eq_u32 s73, s91
  s_cselect_b32 s74, 4, 0
  s_lshr_b64 s[100:101], s[100:101], s74
  s_and_b32 s73, s100, 15
  s_sub_u32 s92, s92, 1
  s_cselect_b32 s73, s91, s73
  s_cselect_b32 s74, 0, 4
  s_lshr_b64 s[100:101], s[100:101], s74
  s_mul_i32 s74, s73, 393216
  s_lshl_b32 s73, s73, 7
  s_add_u32 s75, s75, 43008
  s_cmp_eq_u32 s75, 129024
  s_cselect_b32 s75, 0, s75
  s_buffer_load_dword s84, s[48:51], s98 offset:0
  s_buffer_load_dword s84, s[48:51], s98 offset:64
  s_buffer_load_dword s84, s[48:51], s98 offset:128
  s_buffer_load_dword s84, s[48:51], s98 offset:192
  s_add_u32 s98, s98, 256
  buffer_load_dwordx4 v[64:67], v26, s[52:55], s95 offen
  s_add_u32 s95, s95, 57344
  buffer_load_dwordx4 v[68:71], v26, s[52:55], s95 offen
  s_add_u32 s95, s95, 57344
  s_waitcnt vmcnt(13)
  s_barrier
  s_add_u32 s3, s75, s76
  s_add_u32 m0, s3, 0
  s_nop 0
  buffer_load_dwordx4 v4, s[36:39], s73 offen lds
  s_add_u32 m0, s3, 1024
  s_nop 0
  buffer_load_dwordx4 v5, s[36:39], s73 offen lds
  s_add_u32 m0, s3, 2048
  s_nop 0
  buffer_load_dwordx4 v6, s[36:39], s73 offen lds
  s_add_u32 m0, s3, 3072
  s_nop 0
  buffer_load_dwordx4 v7, s[36:39], s73 offen lds
  s_add_u32 m0, s78, s75
  s_mov_b64 exec, s[14:15]
  buffer_load_dwordx4 v28, s[36:39], s73 offen lds
  s_mov_b64 exec, -1
  s_add_u32 s3, s75, s77
  s_add_u32 m0, s3, 0
  s_add_u32 s4, s74, 0
  buffer_load_dwordx4 v8, s[40:43], s4 offen lds
  s_add_u32 m0, s3, 1024
  s_nop 0
  buffer_load_dwordx4 v9, s[40:43], s4 offen lds
  s_add_u32 m0, s3, 8192
  s_add_u32 s4, s74, 2048
  buffer_load_dwordx4 v8, s[40:43], s4 offen lds
  s_add_u32 m0, s3, 9216
  s_nop 0
  buffer_load_dwordx4 v9, s[40:43], s4 offen lds
  s_add_u32 m0, s3, 16384
  s_add_u32 s4, s74, 4096
  buffer_load_dwordx4 v8, s[40:43], s4 offen lds
  s_add_u32 m0, s3, 17408
  s_nop 0
  buffer_load_dwordx4 v9, s[40:43], s4 offen lds
  s_and_b32 s73, s100, 15
  s_cmp_eq_u32 s73, s91
  s_cselect_b32 s74, 4, 0
  s_lshr_b64 s[100:101], s[100:101], s74
  s_and_b32 s73, s100, 15
  s_sub_u32 s92, s92, 1
  s_cselect_b32 s73, s91, s73
  s_cselect_b32 s74, 0, 4
  s_lshr_b64 s[100:101], s[100:101], s74
  s_mul_i32 s74, s73, 393216
  s_lshl_b32 s73, s73, 7
  s_add_u32 s75, s75, 43008
  s_cmp_eq_u32 s75, 129024
  s_cselect_b32 s75, 0, s75
  s_buffer_load_dword s84, s[48:51], s98 offset:0
  s_buffer_load_dword s84, s[48:51], s98 offset:64
  s_buffer_load_dword s84, s[48:51], s98 offset:128
  s_buffer_load_dword s84, s[48:51], s98 offset:192
  s_add_u32 s98, s98, 256
  buffer_load_dwordx4 v[72:75], v26, s[52:55], s95 offen
  s_add_u32 s95, s95, 57344
  buffer_load_dwordx4 v[76:79], v26, s[52:55], s95 offen
  s_add_u32 s95, s95, 57344
  s_waitcnt vmcnt(15)
  s_barrier
  s_add_u32 s3, s75, s76
  s_add_u32 m0, s3, 0
  s_nop 0
  buffer_load_dwordx4 v4, s[36:39], s73 offen lds
  s_add_u32 m0, s3, 1024
  s_nop 0
  buffer_load_dwordx4 v5, s[36:39], s73 offen lds
  s_add_u32 m0, s3, 2048
  s_nop 0
  buffer_load_dwordx4 v6, s[36:39], s73 offen lds
  s_add_u32 m0, s3, 3072
  s_nop 0
  buffer_load_dwordx4 v7, s[36:39], s73 offen lds
  s_add_u32 m0, s78, s75
  s_mov_b64 exec, s[14:15]
  buffer_load_dwordx4 v28, s[36:39], s73 offen lds
  s_mov_b64 exec, -1
  s_add_u32 s3, s75, s77
  s_add_u32 m0, s3, 0
  s_add_u32 s4, s74, 0
  buffer_load_dwordx4 v8, s[40:43], s4 offen lds
  s_add_u32 m0, s3, 1024
  s_nop 0
  buffer_load_dwordx4 v9, s[40:43], s4 offen lds
  s_add_u32 m0, s3, 8192
  s_add_u32 s4, s74, 2048
  buffer_load_dwordx4 v8, s[40:43], s4 offen lds
  s_add_u32 m0, s3, 9216
  s_nop 0
  buffer_load_dwordx4 v9, s[40:43], s4 offen lds
  s_add_u32 m0, s3, 16384
  s_add_u32 s4, s74, 4096
  buffer_load_dwordx4 v8, s[40:43], s4 offen lds
  s_add_u32 m0, s3, 17408
  s_nop 0
  buffer_load_dwordx4 v9, s[40:43], s4 offen lds
  s_and_b32 s73, s100, 15
  s_cmp_eq_u32 s73, s91
  s_cselect_b32 s74, 4, 0
  s_lshr_b64 s[100:101], s[100:101], s74
  s_and_b32 s73, s100, 15
  s_sub_u32 s92, s92, 1
  s_cselect_b32 s73, s91, s73
  s_cselect_b32 s74, 0, 4
  s_lshr_b64 s[100:101], s[100:101], s74
  s_mul_i32 s74, s73, 393216
  s_lshl_b32 s73, s73, 7
  s_add_u32 s75, s75, 43008
  s_cmp_eq_u32 s75, 129024
  s_cselect_b32 s75, 0, s75
  s_buffer_load_dword s84, s[48:51], s98 offset:0
  s_buffer_load_dword s84, s[48:51], s98 offset:64
  s_buffer_load_dword s84, s[48:51], s98 offset:128
  s_buffer_load_dword s84, s[48:51], s98 offset:192
  s_add_u32 s98, s98, 256
  buffer_load_dwordx4 v[80:83], v26, s[52:55], s95 offen
  s_add_u32 s95, s95, 57344
  buffer_load_dwordx4 v[84:87], v26, s[52:55], s95 offen
  s_add_u32 s95, s95, 57344
  s_waitcnt vmcnt(15)
  s_barrier
  s_add_u32 s3, s75, s76
  s_add_u32 m0, s3, 0
  s_nop 0
  buffer_load_dwordx4 v4, s[36:39], s73 offen lds
  s_add_u32 m0, s3, 1024
  s_nop 0
  buffer_load_dwordx4 v5, s[36:39], s73 offen lds
  s_add_u32 m0, s3, 2048
  s_nop 0
  buffer_load_dwordx4 v6, s[36:39], s73 offen lds
  s_add_u32 m0, s3, 3072
  s_nop 0
  buffer_load_dwordx4 v7, s[36:39], s73 offen lds
  s_add_u32 m0, s78, s75
  s_mov_b64 exec, s[14:15]
  buffer_load_dwordx4 v28, s[36:39], s73 offen lds
  s_mov_b64 exec, -1
  s_add_u32 s3, s75, s77
  s_add_u32 m0, s3, 0
  s_add_u32 s4, s74, 0
  buffer_load_dwordx4 v8, s[40:43], s4 offen lds
  s_add_u32 m0, s3, 1024
  s_nop 0
  buffer_load_dwordx4 v9, s[40:43], s4 offen lds
  s_add_u32 m0, s3, 8192
  s_add_u32 s4, s74, 2048
  buffer_load_dwordx4 v8, s[40:43], s4 offen lds
  s_add_u32 m0, s3, 9216
  s_nop 0
  buffer_load_dwordx4 v9, s[40:43], s4 offen lds
  s_add_u32 m0, s3, 16384
  s_add_u32 s4, s74, 4096
  buffer_load_dwordx4 v8, s[40:43], s4 offen lds
  s_add_u32 m0, s3, 17408
  s_nop 0
  buffer_load_dwordx4 v9, s[40:43], s4 offen lds
  s_and_b32 s73, s100, 15
  s_cmp_eq_u32 s73, s91
  s_cselect_b32 s74, 4, 0
  s_lshr_b64 s[100:101], s[100:101], s74
  s_and_b32 s73, s100, 15
  s_sub_u32 s92, s92, 1
  s_cselect_b32 s73, s91, s73
  s_cselect_b32 s74, 0, 4
  s_lshr_b64 s[100:101], s[100:101], s74
  s_mul_i32 s74, s73, 393216
  s_lshl_b32 s73, s73, 7
  s_add_u32 s75, s75, 43008
  s_cmp_eq_u32 s75, 129024
  s_cselect_b32 s75, 0, s75
  s_buffer_load_dword s84, s[48:51], s98 offset:0
  s_buffer_load_dword s84, s[48:51], s98 offset:64
  s_buffer_load_dword s84, s[48:51], s98 offset:128
  s_buffer_load_dword s84, s[48:51], s98 offset:192
  s_add_u32 s98, s98, 256
  buffer_load_dwordx4 v[88:91], v26, s[52:55], s95 offen
  s_add_u32 s95, s95, 57344
  buffer_load_dwordx4 v[92:95], v26, s[52:55], s95 offen
  s_waitcnt vmcnt(15)
  s_barrier
  s_add_u32 s3, s75, s76
  s_add_u32 m0, s3, 0
  s_nop 0
  buffer_load_dwordx4 v4, s[36:39], s73 offen lds
  s_add_u32 m0, s3, 1024
  s_nop 0
  buffer_load_dwordx4 v5, s[36:39], s73 offen lds
  s_add_u32 m0, s3, 2048
  s_nop 0
  buffer_load_dwordx4 v6, s[36:39], s73 offen lds
  s_add_u32 m0, s3, 3072
  s_nop 0
  buffer_load_dwordx4 v7, s[36:39], s73 offen lds
  s_add_u32 m0, s78, s75
  s_mov_b64 exec, s[14:15]
  buffer_load_dwordx4 v28, s[36:39], s73 offen lds
  s_mov_b64 exec, -1
  s_add_u32 s3, s75, s77
  s_add_u32 m0, s3, 0
  s_add_u32 s4, s74, 0
  buffer_load_dwordx4 v8, s[40:43], s4 offen lds
  s_add_u32 m0, s3, 1024
  s_nop 0
  buffer_load_dwordx4 v9, s[40:43], s4 offen lds
  s_add_u32 m0, s3, 8192
  s_add_u32 s4, s74, 2048
  buffer_load_dwordx4 v8, s[40:43], s4 offen lds
  s_add_u32 m0, s3, 9216
  s_nop 0
  buffer_load_dwordx4 v9, s[40:43], s4 offen lds
  s_add_u32 m0, s3, 16384
  s_add_u32 s4, s74, 4096
  buffer_load_dwordx4 v8, s[40:43], s4 offen lds
  s_add_u32 m0, s3, 17408
  s_nop 0
  buffer_load_dwordx4 v9, s[40:43], s4 offen lds
  s_and_b32 s73, s100, 15
  s_cmp_eq_u32 s73, s91
  s_cselect_b32 s74, 4, 0
  s_lshr_b64 s[100:101], s[100:101], s74
  s_and_b32 s73, s100, 15
  s_sub_u32 s92, s92, 1
  s_cselect_b32 s73, s91, s73
  s_cselect_b32 s74, 0, 4
  s_lshr_b64 s[100:101], s[100:101], s74
  s_mul_i32 s74, s73, 393216
  s_lshl_b32 s73, s73, 7
  s_add_u32 s75, s75, 43008
  s_cmp_eq_u32 s75, 129024
  s_cselect_b32 s75, 0, s75
  s_buffer_load_dword s84, s[48:51], s98 offset:0
  s_buffer_load_dword s84, s[48:51], s98 offset:64
  s_buffer_load_dword s84, s[48:51], s98 offset:128
  s_buffer_load_dword s84, s[48:51], s98 offset:192
  s_add_u32 s98, s98, 256
  s_waitcnt vmcnt(13)
  s_barrier
  s_mov_b32 s79, 6
L_attn0_ld1:
  s_add_u32 s3, s75, s76
  s_add_u32 m0, s3, 0
  s_nop 0
  buffer_load_dwordx4 v4, s[36:39], s73 offen lds
  s_add_u32 m0, s3, 1024
  s_nop 0
  buffer_load_dwordx4 v5, s[36:39], s73 offen lds
  s_add_u32 m0, s3, 2048
  s_nop 0
  buffer_load_dwordx4 v6, s[36:39], s73 offen lds
  s_add_u32 m0, s3, 3072
  s_nop 0
  buffer_load_dwordx4 v7, s[36:39], s73 offen lds
  s_add_u32 m0, s78, s75
  s_mov_b64 exec, s[14:15]
  buffer_load_dwordx4 v28, s[36:39], s73 offen lds
  s_mov_b64 exec, -1
  s_add_u32 s3, s75, s77
  s_add_u32 m0, s3, 0
  s_add_u32 s4, s74, 0
  buffer_load_dwordx4 v8, s[40:43], s4 offen lds
  s_add_u32 m0, s3, 1024
  s_nop 0
  buffer_load_dwordx4 v9, s[40:43], s4 offen lds
  s_add_u32 m0, s3, 8192
  s_add_u32 s4, s74, 2048
  buffer_load_dwordx4 v8, s[40:43], s4 offen lds
  s_add_u32 m0, s3, 9216
  s_nop 0
  buffer_load_dwordx4 v9, s[40:43], s4 offen lds
  s_add_u32 m0, s3, 16384
  s_add_u32 s4, s74, 4096
  buffer_load_dwordx4 v8, s[40:43], s4 offen lds
  s_add_u32 m0, s3, 17408
  s_nop 0
  buffer_load_dwordx4 v9, s[40:43], s4 offen lds
  s_and_b32 s73, s100, 15
  s_cmp_eq_u32 s73, s91
  s_cselect_b32 s74, 4, 0
  s_lshr_b64 s[100:101], s[100:101], s74
  s_and_b32 s73, s100, 15
  s_sub_u32 s92, s92, 1
  s_cselect_b32 s73, s91, s73
  s_cselect_b32 s74, 0, 4
  s_lshr_b64 s[100:101], s[100:101], s74
  s_mul_i32 s74, s73, 393216
  s_lshl_b32 s73, s73, 7
  s_add_u32 s75, s75, 43008
  s_cmp_eq_u32 s75, 129024
  s_cselect_b32 s75, 0, s75
  s_buffer_load_dword s84, s[48:51], s98 offset:0
  s_buffer_load_dword s84, s[48:51], s98 offset:64
  s_buffer_load_dword s84, s[48:51], s98 offset:128
  s_buffer_load_dword s84, s[48:51], s98 offset:192
  s_add_u32 s98, s98, 256
  s_waitcnt vmcnt(11)
  s_barrier
  s_sub_u32 s79, s79, 1
  s_cmp_lg_u32 s79, 0
  s_cbranch_scc1 L_attn0_ld1
  s_add_u32 s3, s75, s76
  s_add_u32 m0, s3, 0
  s_nop 0
  buffer_load_dwordx4 v4, s[36:39], s73 offen lds
  s_add_u32 m0, s3, 1024
  s_nop 0
  buffer_load_dwordx4 v5, s[36:39], s73 offen lds
  s_add_u32 m0, s3, 2048
  s_nop 0
  buffer_load_dwordx4 v6, s[36:39], s73 offen lds
  s_add_u32 m0, s3, 3072
  s_nop 0
  buffer_load_dwordx4 v7, s[36:39], s73 offen lds
  s_add_u32 m0, s78, s75
  s_mov_b64 exec, s[14:15]
  buffer_load_dwordx4 v28, s[36:39], s73 offen lds
  s_mov_b64 exec, -1
  s_add_u32 s3, s75, s77
  s_add_u32 m0, s3, 0
  s_add_u32 s4, s74, 0
  buffer_load_dwordx4 v8, s[40:43], s4 offen lds
  s_add_u32 m0, s3, 1024
  s_nop 0
  buffer_load_dwordx4 v9, s[40:43], s4 offen lds
  s_add_u32 m0, s3, 8192
  s_add_u32 s4, s74, 2048
  buffer_load_dwordx4 v8, s[40:43], s4 offen lds
  s_add_u32 m0, s3, 9216
  s_nop 0
  buffer_load_dwordx4 v9, s[40:43], s4 offen lds
  s_add_u32 m0, s3, 16384
  s_add_u32 s4, s74, 4096
  buffer_load_dwordx4 v8, s[40:43], s4 offen lds
  s_add_u32 m0, s3, 17408
  s_nop 0
  buffer_load_dwordx4 v9, s[40:43], s4 offen lds
  s_and_b32 s73, s100, 15
  s_cmp_eq_u32 s73, s91
  s_cselect_b32 s74, 4, 0
  s_lshr_b64 s[100:101], s[100:101], s74
  s_and_b32 s73, s100, 15
  s_sub_u32 s92, s92, 1
  s_cselect_b32 s73, s91, s73
  s_cselect_b32 s74, 0, 4
  s_lshr_b64 s[100:101], s[100:101], s74
  s_mul_i32 s74, s73, 393216
  s_lshl_b32 s73, s73, 7
  s_add_u32 s75, s75, 43008
  s_cmp_eq_u32 s75, 129024
  s_cselect_b32 s75, 0, s75
  s_buffer_load_dword s84, s[48:51], s98 offset:0
  s_buffer_load_dword s84, s[48:51], s98 offset:64
  s_buffer_load_dword s84, s[48:51], s98 offset:128
  s_buffer_load_dword s84, s[48:51], s98 offset:192
  s_add_u32 s98, s98, 256
  buffer_load_dword v21, v20, s[64:67], 0 offen sc1
  s_waitcnt vmcnt(12)
  s_barrier
  s_add_u32 s3, s75, s76
  s_add_u32 m0, s3, 0
  s_nop 0
  buffer_load_dwordx4 v4, s[36:39], s73 offen lds
  s_add_u32 m0, s3, 1024
  s_nop 0
  buffer_load_dwordx4 v5, s[36:39], s73 offen lds
  s_add_u32 m0, s3, 2048
  s_nop 0
  buffer_load_dwordx4 v6, s[36:39], s73 offen lds
  s_add_u32 m0, s3, 3072
  s_nop 0
  buffer_load_dwordx4 v7, s[36:39], s73 offen lds
  s_add_u32 m0, s78, s75
  s_mov_b64 exec, s[14:15]
  buffer_load_dwordx4 v28, s[36:39], s73 offen lds
  s_mov_b64 exec, -1
  s_add_u32 s3, s75, s77
  s_add_u32 m0, s3, 0
  s_add_u32 s4, s74, 0
  buffer_load_dwordx4 v8, s[40:43], s4 offen lds
  s_add_u32 m0, s3, 1024
  s_nop 0
  buffer_load_dwordx4 v9, s[40:43], s4 offen lds
  s_add_u32 m0, s3, 8192
  s_add_u32 s4, s74, 2048
  buffer_load_dwordx4 v8, s[40:43], s4 offen lds
  s_add_u32 m0, s3, 9216
  s_nop 0
  buffer_load_dwordx4 v9, s[40:43], s4 offen lds
  s_add_u32 m0, s3, 16384
  s_add_u32 s4, s74, 4096
  buffer_load_dwordx4 v8, s[40:43], s4 offen lds
  s_add_u32 m0, s3, 17408
  s_nop 0
  buffer_load_dwordx4 v9, s[40:43], s4 offen lds
  s_and_b32 s73, s100, 15
  s_cmp_eq_u32 s73, s91
  s_cselect_b32 s74, 4, 0
  s_lshr_b64 s[100:101], s[100:101], s74
  s_and_b32 s73, s100, 15
  s_sub_u32 s92, s92, 1
  s_cselect_b32 s73, s91, s73
  s_cselect_b32 s74, 0, 4
  s_lshr_b64 s[100:101], s[100:101], s74
  s_mul_i32 s74, s73, 393216
  s_lshl_b32 s73, s73, 7
  s_add_u32 s75, s75, 43008
  s_cmp_eq_u32 s75, 129024
  s_cselect_b32 s75, 0, s75
  s_buffer_load_dword s84, s[48:51], s98 offset:0
  s_buffer_load_dword s84, s[48:51], s98 offset:64
  s_buffer_load_dword s84, s[48:51], s98 offset:128
  s_buffer_load_dword s84, s[48:51], s98 offset:192
  s_add_u32 s98, s98, 256
  s_waitcnt vmcnt(12)
  s_barrier
  s_add_u32 s3, s75, s76
  s_add_u32 m0, s3, 0
  s_nop 0
  buffer_load_dwordx4 v4, s[36:39], s73 offen lds
  s_add_u32 m0, s3, 1024
  s_nop 0
  buffer_load_dwordx4 v5, s[36:39], s73 offen lds
  s_add_u32 m0, s3, 2048
  s_nop 0
  buffer_load_dwordx4 v6, s[36:39], s73 offen lds
  s_add_u32 m0, s3, 3072
  s_nop 0
  buffer_load_dwordx4 v7, s[36:39], s73 offen lds
  s_add_u32 m0, s78, s75
  s_mov_b64 exec, s[14:15]
  buffer_load_dwordx4 v28, s[36:39], s73 offen lds
  s_mov_b64 exec, -1
  s_add_u32 s3, s75, s77
  s_add_u32 m0, s3, 0
  s_add_u32 s4, s74, 0
  buffer_load_dwordx4 v8, s[40:43], s4 offen lds
  s_add_u32 m0, s3, 1024
  s_nop 0
  buffer_load_dwordx4 v9, s[40:43], s4 offen lds
  s_add_u32 m0, s3, 8192
  s_add_u32 s4, s74, 2048
  buffer_load_dwordx4 v8, s[40:43], s4 offen lds
  s_add_u32 m0, s3, 9216
  s_nop 0
  buffer_load_dwordx4 v9, s[40:43], s4 offen lds
  s_add_u32 m0, s3, 16384
  s_add_u32 s4, s74, 4096
  buffer_load_dwordx4 v8, s[40:43], s4 offen lds
  s_add_u32 m0, s3, 17408
  s_nop 0
  buffer_load_dwordx4 v9, s[40:43], s4 offen lds
  s_and_b32 s73, s100, 15
  s_cmp_eq_u32 s73, s91
  s_cselect_b32 s74, 4, 0
  s_lshr_b64 s[100:101], s[100:101], s74
  s_and_b32 s73, s100, 15
  s_sub_u32 s92, s92, 1
  s_cselect_b32 s73, s91, s73
  s_cselect_b32 s74, 0, 4
  s_lshr_b64 s[100:101], s[100:101], s74
  s_mul_i32 s74, s73, 393216
  s_lshl_b32 s73, s73, 7
  s_add_u32 s75, s75, 43008
  s_cmp_eq_u32 s75, 129024
  s_cselect_b32 s75, 0, s75
  s_buffer_load_dword s84, s[48:51], s98 offset:0
  s_buffer_load_dword s84, s[48:51], s98 offset:64
  s_buffer_load_dword s84, s[48:51], s98 offset:128
  s_buffer_load_dword s84, s[48:51], s98 offset:192
  s_add_u32 s98, s98, 256
  s_waitcnt vmcnt(11)
  s_barrier
  s_mov_b32 s5, 0x100000
  L_attn_dchk:
  v_or_b32 v13, 0xfefefefe, v21
  v_cmp_ne_u32 vcc, -1, v13
  s_cbranch_vccz L_attn_dok
  s_sub_u32 s5, s5, 1
  buffer_load_dword v21, v20, s[64:67], 0 offen sc1
  s_waitcnt vmcnt(0)
  s_cbranch_scc0 L_attn_dchk
  L_attn_dok:
  buffer_load_dwordx4 v[32:35], v18, s[56:59], 0 offen
  s_mov_b32 s3, 65536
  buffer_load_dwordx4 v[36:39], v18, s[56:59], s3 offen
  s_mov_b32 s3, 131072
  buffer_load_dwordx4 v[40:43], v18, s[56:59], s3 offen
  s_mov_b32 s3, 196608
  buffer_load_dwordx4 v[44:47], v18, s[56:59], s3 offen
  buffer_load_dwordx2 v[48:49], v19, s[56:59], 0 offen
  s_mov_b32 s60, s20
  s_and_b32 s61, s21, 0xffff
  s_mov_b32 s62, 2097152
  s_mov_b32 s63, 0x00020000
  s_and_b32 s3, s70, 3
  s_mul_i32 s3, s3, 8
  s_mul_i32 s4, s99, 32
  s_add_u32 s3, s3, s4
  v_lshrrev_b32 v2, 3, v1
  v_add_u32 v2, s3, v2
  v_mul_u32_u24 v2, 2048, v2
  v_and_b32 v3, 7, v1
  v_lshl_add_u32 v2, v3, 8, v2
  s_and_b32 s3, s2, 7
  s_lshr_b32 s3, s3, 2
  s_mul_i32 s3, s3, 128
  buffer_load_dword v96, v2, s[60:63], s3 offen
  s_waitcnt vmcnt(6)
  s_barrier
  s_mov_b32 s79, 0x4000
  s_waitcnt vmcnt(1)
L_attn_schk:
  v_add_f32 v32, v32, v36
  v_add_f32 v33, v33, v37
  v_add_f32 v34, v34, v38
  v_add_f32 v35, v35, v39
  v_add_f32 v40, v40, v44
  v_add_f32 v41, v41, v45
  v_add_f32 v42, v42, v46
  v_add_f32 v43, v43, v47
  v_add_f32 v32, v32, v40
  v_add_f32 v33, v33, v41
  v_add_f32 v34, v34, v42
  v_add_f32 v35, v35, v43
  s_nop 1
  v_permlane32_swap_b32 v32, v34
  v_permlane32_swap_b32 v33, v35
  v_add_f32 v32, v32, v34
  v_add_f32 v33, v33, v35
  v_cmp_u_f32 vcc, v32, v33
  v_cmp_u_f32 s[4:5], v48, v49
  s_or_b64 s[4:5], vcc, s[4:5]
  s_cbranch_scc0 L_attn_sok
  s_sub_u32 s79, s79, 1
  s_cbranch_scc1 L_attn_sok
  buffer_load_dwordx4 v[32:35], v18, s[56:59], 0 offen sc1
  s_mov_b32 s3, 65536
  buffer_load_dwordx4 v[36:39], v18, s[56:59], s3 offen sc1
  s_mov_b32 s3, 131072
  buffer_load_dwordx4 v[40:43], v18, s[56:59], s3 offen sc1
  s_mov_b32 s3, 196608
  buffer_load_dwordx4 v[44:47], v18, s[56:59], s3 offen sc1
  buffer_load_dwordx2 v[48:49], v19, s[56:59], 0 offen sc1
  s_waitcnt vmcnt(0)
  s_branch L_attn_schk
L_attn_sok:
  v_mov_b32 v34, v32
  v_mov_b32 v35, v33
  s_nop 0
  v_permlane16_swap_b32 v32, v34
  v_permlane16_swap_b32 v33, v35
  v_add_f32 v32, v32, v34
  v_add_f32 v33, v33, v35
  v_mul_f32 v32, 0x3a800000, v32
  v_mul_f32 v33, 0x3a800000, v33
  v_fma_f32 v33, -v32, v32, v33
  v_max_f32 v33, 0, v33
  v_add_f32 v33, 0x3727c5ac, v33
  v_rsq_f32 v33, v33
  s_nop 0
  s_and_b32 s3, s70, 3
  s_lshl_b32 s5, s3, 7
  s_add_u32 s5, s5, 129088
  v_and_b32 v3, 15, v1
  v_lshrrev_b32 v2, 5, v1
  v_lshl_add_u32 v2, v3, 1, v2
  v_lshl_add_u32 v2, v2, 2, s5
  ds_write2_b32 v2, v32, v33 offset0:0 offset1:160
  v_mov_b32 v50, v48
  v_mov_b32 v51, v49
  s_nop 0
  v_permlane32_swap_b32 v48, v50
  v_permlane32_swap_b32 v49, v51
  v_add_f32 v48, v48, v50
  v_add_f32 v49, v49, v51
  v_mov_b32 v50, v48
  v_mov_b32 v51, v49
  s_nop 0
  v_permlane16_swap_b32 v48, v50
  v_permlane16_swap_b32 v49, v51
  v_add_f32 v48, v48, v50
  v_add_f32 v49, v49, v51
  s_nop 1
  v_add_f32_dpp v48, v48, v48 row_ror:8 row_mask:0xf bank_mask:0xf
  v_add_f32_dpp v49, v49, v49 row_ror:8 row_mask:0xf bank_mask:0xf
  s_nop 1
  v_add_f32_dpp v48, v48, v48 row_ror:4 row_mask:0xf bank_mask:0xf
  v_add_f32_dpp v49, v49, v49 row_ror:4 row_mask:0xf bank_mask:0xf
  v_mul_f32 v48, 0x3a800000, v48
  v_mul_f32 v49, 0x3a800000, v49
  v_fma_f32 v49, -v48, v48, v49
  v_max_f32 v49, 0, v49
  v_add_f32 v49, 0x3727c5ac, v49
  v_rsq_f32 v49, v49
  s_nop 0
  s_lshl_b32 s5, s3, 4
  s_add_u32 s5, s5, 129024
  v_and_b32 v3, 3, v1
  v_lshl_add_u32 v2, v3, 2, s5
  ds_write2_b32 v2, v48, v49 offset0:0 offset1:160
  s_waitcnt lgkmcnt(0)
  s_barrier
  s_barrier
  s_branch L_attn_ldend
L_attn_ld1:
  s_add_u32 s3, s68, s69
  s_and_b32 s3, s3, 3
  s_mov_b32 s100, 0x68532410
  s_mov_b32 s101, 0xfedbac97
  s_cmp_eq_u32 s3, 1
  s_cselect_b32 s100, 0x96435210, s100
  s_cselect_b32 s101, 0xfecbda87, s101
  s_cmp_eq_u32 s3, 2
  s_cselect_b32 s100, 0x75463210, s100
  s_cselect_b32 s101, 0xfdceb98a, s101
  s_cmp_eq_u32 s3, 3
  s_cselect_b32 s100, 0x65743210, s100
  s_cselect_b32 s101, 0xedfca9b8, s101
  s_add_u32 s56, s22, 24379392
  s_addc_u32 s57, s23, 0
  s_and_b32 s57, s57, 0xffff
  s_mov_b32 s58, 262144
  s_mov_b32 s59, 0x00020000
  s_and_b32 s3, s70, 3
  s_lshl2_add_u32 s4, s68, s3
  s_lshl_b32 s4, s4, 8
  v_lshrrev_b32 v2, 4, v1
  v_and_b32 v3, 15, v1
  v_lshl_add_u32 v3, v3, 4, s4
  v_lshl_add_u32 v18, v2, 14, v3
  s_lshl_b32 s4, s68, 5
  s_add_u32 s4, s4, s3
  s_sub_u32 s4, s4, 4
  s_max_i32 s4, s4, 0
  s_lshl_b32 s4, s4, 5
  v_lshrrev_b32 v2, 2, v1
  v_and_b32 v3, 3, v1
  v_lshl_add_u32 v3, v3, 3, s4
  v_lshl_add_u32 v19, v2, 14, v3
  s_add_u32 s64, s22, 41943040
  s_addc_u32 s65, s23, 0
  s_and_b32 s65, s65, 0xffff
  s_mov_b32 s66, 524288
  s_mov_b32 s67, 0x00020000
  v_and_b32 v30, 3, v1
  v_lshlrev_b32 v30, 6, v30
  s_mov_b32 s79, 0x100000
  s_cmp_lg_u32 s70, 4
  s_cbranch_scc1 L_attn_xgo
  s_setprio 3
L_attn_xpoll:
  buffer_load_dword v12, v30, s[64:67], s86 offen sc1
  s_sub_u32 s79, s79, 1
  s_cbranch_scc1 L_attn_xgo
  s_waitcnt vmcnt(0)
  v_cmp_ne_u32 vcc, 1, v12
  s_cbranch_vccnz L_attn_xpoll
L_attn_xgo:
  s_setprio 0
  s_barrier
  s_lshr_b32 s3, s69, 3
  s_and_b32 s73, s69, 7
  s_lshl1_add_u32 s91, s73, s3
  s_mul_i32 s74, s91, 393216
  s_lshl_b32 s73, s91, 7
  s_mov_b32 s88, s73
  s_add_u32 m0, s77, 0
  s_add_u32 s4, s74, 0
  buffer_load_dwordx4 v8, s[40:43], s4 offen lds
  s_add_u32 m0, s77, 1024
  s_nop 0
  buffer_load_dwordx4 v9, s[40:43], s4 offen lds
  s_add_u32 m0, s77, 8192
  s_add_u32 s4, s74, 2048
  buffer_load_dwordx4 v8, s[40:43], s4 offen lds
  s_add_u32 m0, s77, 9216
  s_nop 0
  buffer_load_dwordx4 v9, s[40:43], s4 offen lds
  s_add_u32 m0, s77, 16384
  s_add_u32 s4, s74, 4096
  buffer_load_dwordx4 v8, s[40:43], s4 offen lds
  s_add_u32 m0, s77, 17408
  s_nop 0
  buffer_load_dwordx4 v9, s[40:43], s4 offen lds
  s_and_b32 s73, s100, 15
  s_cmp_eq_u32 s73, s91
  s_cselect_b32 s74, 4, 0
  s_lshr_b64 s[100:101], s[100:101], s74
  s_and_b32 s73, s100, 15
  s_lshr_b64 s[100:101], s[100:101], 4
  s_mul_i32 s74, s73, 393216
  s_lshl_b32 s73, s73, 7
  s_mov_b32 s75, 0
  s_add_u32 s44, s22, 41943040
  s_addc_u32 s45, s23, 0
  s_and_b32 s45, s45, 0xffff
  s_mov_b32 s46, 524288
  s_mov_b32 s47, 0x00020000
  s_lshl4_add_u32 s3, s97, s68
  s_and_b32 s4, s69, 15
  s_lshl4_add_u32 s3, s3, s4
  s_lshl_b32 s3, s3, 7
  s_sub_u32 s3, s3, 32768
  v_lshlrev_b32 v11, 7, v1
  s_cmp_eq_u32 s68, 0
  s_cselect_b32 s4, 15, 31
  v_and_b32 v2, 16, v1
  v_lshl_add_u32 v11, v2, 2, v11
  v_and_b32 v2, s4, v1
  v_lshlrev_b32 v2, 2, v2
  v_mov_b32 v3, 1
  s_mov_b32 s79, 0x100000
  s_waitcnt vmcnt(0)
  s_cmp_lg_u32 s70, 4
  s_barrier
  s_cbranch_scc1 L_attn_nofl
  s_mov_b32 exec_lo, 0xffffffff
  s_mov_b32 exec_hi, 0
  buffer_store_dword v3, v11, s[44:47], s87 offen sc1
  s_mov_b64 exec, -1
L_attn_nofl:
  s_mov_b32 s5, s3
  s_mov_b32 s89, s73
  s_add_u32 m0, s77, 43008
  s_add_u32 s4, s74, 0
  buffer_load_dwordx4 v8, s[40:43], s4 offen lds
  s_add_u32 m0, s77, 44032
  s_nop 0
  buffer_load_dwordx4 v9, s[40:43], s4 offen lds
  s_add_u32 m0, s77, 51200
  s_add_u32 s4, s74, 2048
  buffer_load_dwordx4 v8, s[40:43], s4 offen lds
  s_add_u32 m0, s77, 52224
  s_nop 0
  buffer_load_dwordx4 v9, s[40:43], s4 offen lds
  s_add_u32 m0, s77, 59392
  s_add_u32 s4, s74, 4096
  buffer_load_dwordx4 v8, s[40:43], s4 offen lds
  s_add_u32 m0, s77, 60416
  s_nop 0
  buffer_load_dwordx4 v9, s[40:43], s4 offen lds
  s_and_b32 s73, s100, 15
  s_cmp_eq_u32 s73, s91
  s_cselect_b32 s74, 4, 0
  s_lshr_b64 s[100:101], s[100:101], s74
  s_and_b32 s73, s100, 15
  s_lshr_b64 s[100:101], s[100:101], 4
  s_mul_i32 s74, s73, 393216
  s_lshl_b32 s73, s73, 7
  s_mov_b32 s90, s73
  s_add_u32 m0, s77, 86016
  s_add_u32 s4, s74, 0
  buffer_load_dwordx4 v8, s[40:43], s4 offen lds
  s_add_u32 m0, s77, 87040
  s_nop 0
  buffer_load_dwordx4 v9, s[40:43], s4 offen lds
  s_add_u32 m0, s77, 94208
  s_add_u32 s4, s74, 2048
  buffer_load_dwordx4 v8, s[40:43], s4 offen lds
  s_add_u32 m0, s77, 95232
  s_nop 0
  buffer_load_dwordx4 v9, s[40:43], s4 offen lds
  s_add_u32 m0, s77, 102400
  s_add_u32 s4, s74, 4096
  buffer_load_dwordx4 v8, s[40:43], s4 offen lds
  s_add_u32 m0, s77, 103424
  s_nop 0
  buffer_load_dwordx4 v9, s[40:43], s4 offen lds
  s_and_b32 s73, s100, 15
  s_cmp_eq_u32 s73, s91
  s_cselect_b32 s74, 4, 0
  s_lshr_b64 s[100:101], s[100:101], s74
  s_and_b32 s73, s100, 15
  s_lshr_b64 s[100:101], s[100:101], 4
  s_mul_i32 s74, s73, 393216
  s_lshl_b32 s73, s73, 7
  s_mov_b32 s3, s5
  s_cmp_lg_u32 s70, 4
  s_cbranch_scc1 L_attn_dep
L_attn_poll:
  buffer_load_dword v3, v2, s[44:47], s3 offen sc1
  s_sub_u32 s79, s79, 1
  s_cbranch_scc1 L_attn_dep
  s_waitcnt vmcnt(0)
  v_cmp_ne_u32 vcc, 1, v3
  s_cbranch_vccnz L_attn_poll
L_attn_dep:
  s_barrier
  s_add_u32 m0, s78, 89344
  s_mov_b64 exec, s[14:15]
  buffer_load_dwordx4 v28, s[36:39], s88 offen lds
  s_mov_b64 exec, -1
  s_add_u32 m0, s76, 43008
  s_nop 0
  buffer_load_dwordx4 v4, s[36:39], s89 offen lds
  s_add_u32 m0, s76, 44032
  s_nop 0
  buffer_load_dwordx4 v5, s[36:39], s89 offen lds
  s_add_u32 m0, s76, 45056
  s_nop 0
  buffer_load_dwordx4 v6, s[36:39], s89 offen lds
  s_add_u32 m0, s76, 46080
  s_nop 0
  buffer_load_dwordx4 v7, s[36:39], s89 offen lds
  s_add_u32 m0, s78, 43008
  s_mov_b64 exec, s[14:15]
  buffer_load_dwordx4 v28, s[36:39], s89 offen lds
  s_mov_b64 exec, -1
  s_add_u32 m0, s76, 86016
  s_nop 0
  buffer_load_dwordx4 v4, s[36:39], s90 offen lds
  s_add_u32 m0, s76, 87040
  s_nop 0
  buffer_load_dwordx4 v5, s[36:39], s90 offen lds
  s_add_u32 m0, s76, 88064
  s_nop 0
  buffer_load_dwordx4 v6, s[36:39], s90 offen lds
  s_add_u32 m0, s76, 89088
  s_nop 0
  buffer_load_dwordx4 v7, s[36:39], s90 offen lds
  s_add_u32 m0, s78, 86016
  s_mov_b64 exec, s[14:15]
  buffer_load_dwordx4 v28, s[36:39], s90 offen lds
  s_mov_b64 exec, -1
  s_waitcnt vmcnt(5)
  s_barrier
  s_mov_b32 s79, 12
L_attn1_ld1:
  s_add_u32 s3, s75, s76
  s_add_u32 m0, s3, 0
  s_nop 0
  buffer_load_dwordx4 v4, s[36:39], s73 offen lds
  s_add_u32 m0, s3, 1024
  s_nop 0
  buffer_load_dwordx4 v5, s[36:39], s73 offen lds
  s_add_u32 m0, s3, 2048
  s_nop 0
  buffer_load_dwordx4 v6, s[36:39], s73 offen lds
  s_add_u32 m0, s3, 3072
  s_nop 0
  buffer_load_dwordx4 v7, s[36:39], s73 offen lds
  s_add_u32 m0, s78, s75
  s_mov_b64 exec, s[14:15]
  buffer_load_dwordx4 v28, s[36:39], s73 offen lds
  s_mov_b64 exec, -1
  s_add_u32 s3, s75, s77
  s_add_u32 m0, s3, 0
  s_add_u32 s4, s74, 0
  buffer_load_dwordx4 v8, s[40:43], s4 offen lds
  s_add_u32 m0, s3, 1024
  s_nop 0
  buffer_load_dwordx4 v9, s[40:43], s4 offen lds
  s_add_u32 m0, s3, 8192
  s_add_u32 s4, s74, 2048
  buffer_load_dwordx4 v8, s[40:43], s4 offen lds
  s_add_u32 m0, s3, 9216
  s_nop 0
  buffer_load_dwordx4 v9, s[40:43], s4 offen lds
  s_add_u32 m0, s3, 16384
  s_add_u32 s4, s74, 4096
  buffer_load_dwordx4 v8, s[40:43], s4 offen lds
  s_add_u32 m0, s3, 17408
  s_nop 0
  buffer_load_dwordx4 v9, s[40:43], s4 offen lds
  s_and_b32 s73, s100, 15
  s_cmp_eq_u32 s73, s91
  s_cselect_b32 s74, 4, 0
  s_lshr_b64 s[100:101], s[100:101], s74
  s_and_b32 s73, s100, 15
  s_lshr_b64 s[100:101], s[100:101], 4
  s_mul_i32 s74, s73, 393216
  s_lshl_b32 s73, s73, 7
  s_add_u32 s75, s75, 43008
  s_cmp_eq_u32 s75, 129024
  s_cselect_b32 s75, 0, s75
  s_waitcnt vmcnt(11)
  s_barrier
  s_sub_u32 s79, s79, 1
  s_cmp_lg_u32 s79, 0
  s_cbranch_scc1 L_attn1_ld1
  s_add_u32 s3, s75, s76
  s_add_u32 m0, s3, 0
  s_nop 0
  buffer_load_dwordx4 v4, s[36:39], s73 offen lds
  s_add_u32 m0, s3, 1024
  s_nop 0
  buffer_load_dwordx4 v5, s[36:39], s73 offen lds
  s_add_u32 m0, s3, 2048
  s_nop 0
  buffer_load_dwordx4 v6, s[36:39], s73 offen lds
  s_add_u32 m0, s3, 3072
  s_nop 0
  buffer_load_dwordx4 v7, s[36:39], s73 offen lds
  s_add_u32 m0, s78, s75
  s_mov_b64 exec, s[14:15]
  buffer_load_dwordx4 v28, s[36:39], s73 offen lds
  s_mov_b64 exec, -1
  s_add_u32 s3, s75, s77
  s_add_u32 m0, s3, 0
  s_add_u32 s4, s74, 0
  buffer_load_dwordx4 v8, s[40:43], s4 offen lds
  s_add_u32 m0, s3, 1024
  s_nop 0
  buffer_load_dwordx4 v9, s[40:43], s4 offen lds
  s_add_u32 m0, s3, 8192
  s_add_u32 s4, s74, 2048
  buffer_load_dwordx4 v8, s[40:43], s4 offen lds
  s_add_u32 m0, s3, 9216
  s_nop 0
  buffer_load_dwordx4 v9, s[40:43], s4 offen lds
  s_add_u32 m0, s3, 16384
  s_add_u32 s4, s74, 4096
  buffer_load_dwordx4 v8, s[40:43], s4 offen lds
  s_add_u32 m0, s3, 17408
  s_nop 0
  buffer_load_dwordx4 v9, s[40:43], s4 offen lds
  s_and_b32 s73, s100, 15
  s_cmp_eq_u32 s73, s91
  s_cselect_b32 s74, 4, 0
  s_lshr_b64 s[100:101], s[100:101], s74
  s_and_b32 s73, s100, 15
  s_lshr_b64 s[100:101], s[100:101], 4
  s_mul_i32 s74, s73, 393216
  s_lshl_b32 s73, s73, 7
  s_add_u32 s75, s75, 43008
  s_cmp_eq_u32 s75, 129024
  s_cselect_b32 s75, 0, s75
  s_mov_b32 s60, s20
  s_and_b32 s61, s21, 0xffff
  s_mov_b32 s62, 2097152
  s_mov_b32 s63, 0x00020000
  s_and_b32 s3, s70, 3
  s_mul_i32 s3, s3, 8
  s_mul_i32 s4, s99, 32
  s_add_u32 s3, s3, s4
  v_lshrrev_b32 v2, 3, v1
  v_add_u32 v2, s3, v2
  v_mul_u32_u24 v2, 2048, v2
  v_and_b32 v3, 7, v1
  v_lshl_add_u32 v2, v3, 8, v2
  s_and_b32 s3, s2, 7
  s_lshr_b32 s3, s3, 2
  s_mul_i32 s3, s3, 128
  buffer_load_dword v96, v2, s[60:63], s3 offen
  s_waitcnt vmcnt(12)
  s_barrier
  buffer_load_dwordx4 v[32:35], v18, s[56:59], 0 offen
  s_mov_b32 s3, 65536
  buffer_load_dwordx4 v[36:39], v18, s[56:59], s3 offen
  s_mov_b32 s3, 131072
  buffer_load_dwordx4 v[40:43], v18, s[56:59], s3 offen
  s_mov_b32 s3, 196608
  buffer_load_dwordx4 v[44:47], v18, s[56:59], s3 offen
  buffer_load_dwordx2 v[48:49], v19, s[56:59], 0 offen
  s_waitcnt vmcnt(6)
  s_barrier
  s_waitcnt vmcnt(0)
  v_add_f32 v32, v32, v36
  v_add_f32 v33, v33, v37
  v_add_f32 v34, v34, v38
  v_add_f32 v35, v35, v39
  v_add_f32 v40, v40, v44
  v_add_f32 v41, v41, v45
  v_add_f32 v42, v42, v46
  v_add_f32 v43, v43, v47
  v_add_f32 v32, v32, v40
  v_add_f32 v33, v33, v41
  v_add_f32 v34, v34, v42
  v_add_f32 v35, v35, v43
  s_nop 1
  v_permlane32_swap_b32 v32, v34
  v_permlane32_swap_b32 v33, v35
  v_add_f32 v32, v32, v34
  v_add_f32 v33, v33, v35
  v_mov_b32 v34, v32
  v_mov_b32 v35, v33
  s_nop 0
  v_permlane16_swap_b32 v32, v34
  v_permlane16_swap_b32 v33, v35
  v_add_f32 v32, v32, v34
  v_add_f32 v33, v33, v35
  v_mul_f32 v32, 0x3a800000, v32
  v_mul_f32 v33, 0x3a800000, v33
  v_fma_f32 v33, -v32, v32, v33
  v_max_f32 v33, 0, v33
  v_add_f32 v33, 0x3727c5ac, v33
  v_rsq_f32 v33, v33
  s_nop 0
  s_and_b32 s3, s70, 3
  s_lshl_b32 s5, s3, 7
  s_add_u32 s5, s5, 129088
  v_and_b32 v3, 15, v1
  v_lshrrev_b32 v2, 5, v1
  v_lshl_add_u32 v2, v3, 1, v2
  v_lshl_add_u32 v2, v2, 2, s5
  ds_write2_b32 v2, v32, v33 offset0:0 offset1:160
  v_mov_b32 v50, v48
  v_mov_b32 v51, v49
  s_nop 0
  v_permlane32_swap_b32 v48, v50
  v_permlane32_swap_b32 v49, v51
  v_add_f32 v48, v48, v50
  v_add_f32 v49, v49, v51
  v_mov_b32 v50, v48
  v_mov_b32 v51, v49
  s_nop 0
  v_permlane16_swap_b32 v48, v50
  v_permlane16_swap_b32 v49, v51
  v_add_f32 v48, v48, v50
  v_add_f32 v49, v49, v51
  s_nop 1
  v_add_f32_dpp v48, v48, v48 row_ror:8 row_mask:0xf bank_mask:0xf
  v_add_f32_dpp v49, v49, v49 row_ror:8 row_mask:0xf bank_mask:0xf
  s_nop 1
  v_add_f32_dpp v48, v48, v48 row_ror:4 row_mask:0xf bank_mask:0xf
  v_add_f32_dpp v49, v49, v49 row_ror:4 row_mask:0xf bank_mask:0xf
  v_mul_f32 v48, 0x3a800000, v48
  v_mul_f32 v49, 0x3a800000, v49
  v_fma_f32 v49, -v48, v48, v49
  v_max_f32 v49, 0, v49
  v_add_f32 v49, 0x3727c5ac, v49
  v_rsq_f32 v49, v49
  s_nop 0
  s_lshl_b32 s5, s3, 4
  s_add_u32 s5, s5, 129024
  v_and_b32 v3, 3, v1
  v_lshl_add_u32 v2, v3, 2, s5
  ds_write2_b32 v2, v48, v49 offset0:0 offset1:160
  s_waitcnt lgkmcnt(0)
  s_barrier
  s_barrier
L_attn_ldend:
  s_lshl_b32 s87, s97, 15
  s_lshl_b32 s4, s68, 11
  s_add_u32 s87, s87, s4
  s_lshl_b32 s4, s69, 2
  s_add_u32 s87, s87, s4
  s_add_u32 s97, s97, 1
  s_branch L_wo_body
L_attn_end:
  s_endpgm
.fill 1020, 4, 0xbf800000
L_attn_compute:
  s_cmp_lg_u32 s96, 0
  s_cbranch_scc1 L_pfc1_skip
  s_getpc_b64 s[4:5]
L_pfc1:
  s_lshl_b32 s3, s99, 2
  s_add_u32 s3, s3, s70
  s_mul_i32 s3, s3, 320
  s_min_u32 s3, s3, L_w2_c1-L_attn_c0-320
  s_add_i32 s3, s3, L_attn_c0-L_pfc1
  s_ashr_i32 s6, s3, 31
  s_add_u32 s4, s4, s3
  s_addc_u32 s5, s5, s6
  s_load_dword s40, s[4:5], 0
  s_load_dword s40, s[4:5], 64
  s_load_dword s40, s[4:5], 128
  s_load_dword s40, s[4:5], 192
  s_load_dword s40, s[4:5], 256
L_pfc1_skip:
  s_and_b32 s71, s70, 1
  s_lshr_b32 s72, s70, 1
  v_and_b32 v3, 31, v1
  v_lshlrev_b32 v3, 2, v3
  v_add_u32 v3, 40960, v3
  v_mov_b32 v236, 0x3f803f80
  v_mov_b32 v237, 0x3f803f80
  v_mov_b32 v238, 0x3f803f80
  v_mov_b32 v239, 0x3f803f80
  ds_write_b32 v3, v236
  ds_write_b32 v3, v236 offset:43008
  v_add_u32 v3, 86016, v3
  ds_write_b32 v3, v236
  ds_write_b32 v3, v236 offset:3328
  v_and_b32 v3, 15, v1
  v_lshrrev_b32 v2, 4, v1
  v_lshrrev_b32 v33, 1, v3
  s_lshl_b32 s8, s71, 13
  v_xor_b32 v4, v2, v33
  v_lshlrev_b32 v4, 4, v4
  v_lshl_add_u32 v4, v3, 7, v4
  v_add_u32 v8, 40960, v4
  v_add_u32 v4, s8, v4
  v_add_u32 v5, 4, v2
  v_xor_b32 v5, v5, v33
  v_lshlrev_b32 v5, 4, v5
  v_lshl_add_u32 v5, v3, 7, v5
  v_add_u32 v9, 40960, v5
  v_add_u32 v5, s8, v5
  v_bfe_u32 v34, v1, 2, 2
  v_lshl_add_u32 v34, v2, 3, v34
  v_lshlrev_b32 v34, 7, v34
  v_and_b32 v33, 3, v1
  v_lshl_add_u32 v34, v33, 3, v34
  v_bfe_u32 v33, v1, 3, 2
  v_lshl_add_u32 v34, v33, 5, v34
  s_lshl_b32 s8, s70, 5
  v_xor_b32 v34, s8, v34
  v_add_u32 v6, 16384, v34
  v_xor_b32 v7, 32, v6
  s_mov_b32 s75, 0
  v_add_u32_e64 v10, s75, v4
  v_add_u32_e64 v11, s75, v5
  v_add_u32_e64 v12, s75, v6
  v_add_u32_e64 v13, s75, v7
  v_add_u32_e64 v14, s75, v8
  v_add_u32_e64 v15, s75, v9
  s_add_u32 s75, s75, 43008
  s_cmp_eq_u32 s75, 129024
  s_cselect_b32 s75, 0, s75
  s_and_b32 s79, s69, 3
  s_add_u32 s79, s79, 1
  s_mul_i32 s98, s96, 3
  s_cmp_eq_u32 s96, 0
  s_cbranch_scc1 L_attn_nog
  s_mov_b32 s79, 15
  ds_read_b128 v[32:35], v10 offset:0
  ds_read_b128 v[36:39], v10 offset:2048
  ds_read_b128 v[40:43], v10 offset:4096
  ds_read_b128 v[44:47], v10 offset:6144
  ds_read_b64_tr_b16 v[52:53], v12 offset:0
  ds_read_b64_tr_b16 v[54:55], v12 offset:512
  ds_read_b64_tr_b16 v[56:57], v13 offset:0
  ds_read_b64_tr_b16 v[58:59], v13 offset:512
  ds_read_b64_tr_b16 v[60:61], v12 offset:8192
  ds_read_b64_tr_b16 v[62:63], v12 offset:8704
  ds_read_b64_tr_b16 v[64:65], v13 offset:8192
  ds_read_b64_tr_b16 v[66:67], v13 offset:8704
  ds_read_b64_tr_b16 v[68:69], v12 offset:16384
  ds_read_b64_tr_b16 v[70:71], v12 offset:16896
  ds_read_b64_tr_b16 v[72:73], v13 offset:16384
  ds_read_b64_tr_b16 v[74:75], v13 offset:16896
  s_waitcnt lgkmcnt(0)
  v_mfma_f32_16x16x32_bf16 v[128:131], v[52:55], v[32:35], 0
  ds_read_b128 v[76:79], v11 offset:0
  v_mfma_f32_16x16x32_bf16 v[132:135], v[52:55], v[36:39], 0
  ds_read_b128 v[80:83], v11 offset:2048
  v_mfma_f32_16x16x32_bf16 v[136:139], v[52:55], v[40:43], 0
  ds_read_b128 v[84:87], v11 offset:4096
  v_mfma_f32_16x16x32_bf16 v[140:143], v[52:55], v[44:47], 0
  ds_read_b128 v[88:91], v11 offset:6144
  v_mfma_f32_16x16x32_bf16 v[156:159], v[56:59], v[44:47], 0
  ds_read_b64_tr_b16 v[96:97], v12 offset:4096
  v_mfma_f32_16x16x32_bf16 v[152:155], v[56:59], v[40:43], 0
  ds_read_b64_tr_b16 v[98:99], v12 offset:4608
  v_mfma_f32_16x16x32_bf16 v[148:151], v[56:59], v[36:39], 0
  ds_read_b64_tr_b16 v[100:101], v13 offset:4096
  v_mfma_f32_16x16x32_bf16 v[144:147], v[56:59], v[32:35], 0
  ds_read_b64_tr_b16 v[102:103], v13 offset:4608
  v_mfma_f32_16x16x32_bf16 v[160:163], v[60:63], v[32:35], 0
  ds_read_b64_tr_b16 v[104:105], v12 offset:12288
  v_mfma_f32_16x16x32_bf16 v[164:167], v[60:63], v[36:39], 0
  ds_read_b64_tr_b16 v[106:107], v12 offset:12800
  v_mfma_f32_16x16x32_bf16 v[168:171], v[60:63], v[40:43], 0
  ds_read_b64_tr_b16 v[108:109], v13 offset:12288
  v_mfma_f32_16x16x32_bf16 v[172:175], v[60:63], v[44:47], 0
  ds_read_b64_tr_b16 v[110:111], v13 offset:12800
  v_mfma_f32_16x16x32_bf16 v[188:191], v[64:67], v[44:47], 0
  ds_read_b64_tr_b16 v[112:113], v12 offset:20480
  v_mfma_f32_16x16x32_bf16 v[184:187], v[64:67], v[40:43], 0
  ds_read_b64_tr_b16 v[114:115], v12 offset:20992
  v_mfma_f32_16x16x32_bf16 v[180:183], v[64:67], v[36:39], 0
  ds_read_b64_tr_b16 v[116:117], v13 offset:20480
  v_mfma_f32_16x16x32_bf16 v[176:179], v[64:67], v[32:35], 0
  ds_read_b64_tr_b16 v[118:119], v13 offset:20992
  v_mfma_f32_16x16x32_bf16 v[192:195], v[32:35], v[68:71], 0
  v_add_u32_e64 v10, s75, v4
  v_mfma_f32_16x16x32_bf16 v[196:199], v[36:39], v[68:71], 0
  v_add_u32_e64 v11, s75, v5
  v_mfma_f32_16x16x32_bf16 v[200:203], v[40:43], v[68:71], 0
  v_add_u32_e64 v12, s75, v6
  v_mfma_f32_16x16x32_bf16 v[204:207], v[44:47], v[68:71], 0
  v_add_u32_e64 v13, s75, v7
  v_mfma_f32_16x16x32_bf16 v[220:223], v[44:47], v[72:75], 0
  v_add_u32_e64 v14, s75, v8
  v_mfma_f32_16x16x32_bf16 v[216:219], v[40:43], v[72:75], 0
  v_add_u32_e64 v15, s75, v9
  v_mfma_f32_16x16x32_bf16 v[212:215], v[36:39], v[72:75], 0
  s_add_u32 s75, s75, 43008
  v_mfma_f32_16x16x32_bf16 v[208:211], v[32:35], v[72:75], 0
  s_cmp_eq_u32 s75, 129024
  s_cselect_b32 s75, 0, s75
  s_waitcnt lgkmcnt(0)
  v_mfma_f32_16x16x32_bf16 v[128:131], v[96:99], v[76:79], v[128:131]
  v_mfma_f32_16x16x32_bf16 v[132:135], v[96:99], v[80:83], v[132:135]
  v_mfma_f32_16x16x32_bf16 v[136:139], v[96:99], v[84:87], v[136:139]
  v_mfma_f32_16x16x32_bf16 v[140:143], v[96:99], v[88:91], v[140:143]
  v_mfma_f32_16x16x32_bf16 v[156:159], v[100:103], v[88:91], v[156:159]
  v_mfma_f32_16x16x32_bf16 v[152:155], v[100:103], v[84:87], v[152:155]
  v_mfma_f32_16x16x32_bf16 v[148:151], v[100:103], v[80:83], v[148:151]
  v_mfma_f32_16x16x32_bf16 v[144:147], v[100:103], v[76:79], v[144:147]
  v_mfma_f32_16x16x32_bf16 v[160:163], v[104:107], v[76:79], v[160:163]
  v_mfma_f32_16x16x32_bf16 v[164:167], v[104:107], v[80:83], v[164:167]
  v_mfma_f32_16x16x32_bf16 v[168:171], v[104:107], v[84:87], v[168:171]
  v_mfma_f32_16x16x32_bf16 v[172:175], v[104:107], v[88:91], v[172:175]
  v_mfma_f32_16x16x32_bf16 v[188:191], v[108:111], v[88:91], v[188:191]
  v_mfma_f32_16x16x32_bf16 v[184:187], v[108:111], v[84:87], v[184:187]
  v_mfma_f32_16x16x32_bf16 v[180:183], v[108:111], v[80:83], v[180:183]
  v_mfma_f32_16x16x32_bf16 v[176:179], v[108:111], v[76:79], v[176:179]
  v_mfma_f32_16x16x32_bf16 v[192:195], v[76:79], v[112:115], v[192:195]
  v_mfma_f32_16x16x32_bf16 v[196:199], v[80:83], v[112:115], v[196:199]
  v_mfma_f32_16x16x32_bf16 v[200:203], v[84:87], v[112:115], v[200:203]
  v_mfma_f32_16x16x32_bf16 v[204:207], v[88:91], v[112:115], v[204:207]
  v_mfma_f32_16x16x32_bf16 v[220:223], v[88:91], v[116:119], v[220:223]
  v_mfma_f32_16x16x32_bf16 v[216:219], v[84:87], v[116:119], v[216:219]
  v_mfma_f32_16x16x32_bf16 v[212:215], v[80:83], v[116:119], v[212:215]
  v_mfma_f32_16x16x32_bf16 v[208:211], v[76:79], v[116:119], v[208:211]
  s_barrier
  v_mov_b32 v76, v52
  v_mov_b32 v77, v53
  v_mov_b32 v78, v54
  v_mov_b32 v79, v55
  v_mov_b32 v80, v60
  v_mov_b32 v81, v61
  v_mov_b32 v82, v62
  v_mov_b32 v83, v63
  v_mov_b32 v84, v68
  v_mov_b32 v85, v69
  v_mov_b32 v86, v70
  v_mov_b32 v87, v71
L_attn_nog:
  v_and_b32 v35, 1, v2
  v_xor_b32 v35, s71, v35
  s_lshl_b32 s8, s68, 7
  s_lshl_b32 s9, s71, 6
  s_add_u32 s8, s8, s9
  s_mul_i32 s10, s8, 7
  s_lshl2_add_u32 s11, s69, s72
  s_add_u32 s10, s10, s11
  s_lshl_b32 s10, s10, 10
  v_lshl_add_u32 v31, v1, 4, s10
  s_mul_i32 s10, s72, 14336
  s_add_u32 s10, s10, 1024
  s_lshl_b32 s11, s71, 10
  s_add_u32 s4, s10, s11
  s_sub_u32 s5, s10, s11
  s_mul_i32 s6, s71, 6144
  v_lshl_add_u32 v16, v1, 4, s4
  v_add_u32 v17, s6, v16
  v_lshl_add_u32 v18, v1, 4, s5
  v_add_u32 v18, s6, v18
  v_lshl_add_u32 v19, v2, 8, s4
  v_lshl_add_u32 v20, v2, 8, s5
  v_lshl_add_u32 v21, v3, 4, s4
  v_lshl_add_u32 v22, v3, 4, s5
  s_lshl_b32 s10, s71, 8
  s_add_u32 s10, s10, 129024
  v_lshl_add_u32 v23, v3, 2, s10
  v_lshl_add_u32 v24, v2, 4, s10
  v_and_b32 v33, 1, v3
  v_cmp_eq_u32 s[48:49], 1, v33
  v_lshl_add_u32 v34, v2, 2, v33
  v_add_u32 v35, 2, v34
  v_cmp_gt_u32 s[50:51], v34, v3
  v_cmp_gt_u32 s[52:53], v35, v3
  v_mov_b32 v36, 0xffff
  v_mov_b32 v37, 0xffff0000
  v_cndmask_b32 v36, v36, v37, s[48:49]
  s_add_u32 s10, s10, 704
  v_lshl_add_u32 v34, v34, 2, s10
  v_lshl_add_u32 v35, v35, 2, s10
  v_subrev_u32 v38, 64, v34
  v_subrev_u32 v39, 64, v35
  v_cndmask_b32 v25, v34, v38, s[50:51]
  v_cndmask_b32 v26, v35, v39, s[52:53]
  v_cndmask_b32 v27, 0, v36, s[50:51]
  v_cndmask_b32 v29, 0, v36, s[52:53]
  v_xor_b32 v28, v27, v36
  v_xor_b32 v30, v29, v36
  s_cmp_eq_u32 s8, 0
  s_cselect_b64 s[54:55], s[50:51], 0
  s_cselect_b64 s[14:15], s[52:53], 0
  s_cmp_lg_u32 s96, 0
  s_cbranch_scc1 L_attn_nozero
  v_mov_b32 v122, 0
  v_mov_b32 v123, 0
  v_mov_b32 v124, 0
  v_mov_b32 v125, 0
  v_mov_b32 v126, 0
  v_mov_b32 v127, 0
  v_mov_b32 v128, 0
  v_mov_b32 v129, 0
  v_mov_b32 v130, 0
  v_mov_b32 v131, 0
  v_mov_b32 v132, 0
  v_mov_b32 v133, 0
  v_mov_b32 v134, 0
  v_mov_b32 v135, 0
  v_mov_b32 v136, 0
  v_mov_b32 v137, 0
  v_mov_b32 v138, 0
  v_mov_b32 v139, 0
  v_mov_b32 v140, 0
  v_mov_b32 v141, 0
  v_mov_b32 v142, 0
  v_mov_b32 v143, 0
  v_mov_b32 v144, 0
  v_mov_b32 v145, 0
  v_mov_b32 v146, 0
  v_mov_b32 v147, 0
  v_mov_b32 v148, 0
  v_mov_b32 v149, 0
  v_mov_b32 v150, 0
  v_mov_b32 v151, 0
  v_mov_b32 v152, 0
  v_mov_b32 v153, 0
  v_mov_b32 v154, 0
  v_mov_b32 v155, 0
  v_mov_b32 v156, 0
  v_mov_b32 v157, 0
  v_mov_b32 v158, 0
  v_mov_b32 v159, 0
  v_mov_b32 v160, 0
  v_mov_b32 v161, 0
  v_mov_b32 v162, 0
  v_mov_b32 v163, 0
  v_mov_b32 v164, 0
  v_mov_b32 v165, 0
  v_mov_b32 v166, 0
  v_mov_b32 v167, 0
  v_mov_b32 v168, 0
  v_mov_b32 v169, 0
  v_mov_b32 v170, 0
  v_mov_b32 v171, 0
  v_mov_b32 v172, 0
  v_mov_b32 v173, 0
  v_mov_b32 v174, 0
  v_mov_b32 v175, 0
  v_mov_b32 v176, 0
  v_mov_b32 v177, 0
  v_mov_b32 v178, 0
  v_mov_b32 v179, 0
  v_mov_b32 v180, 0
  v_mov_b32 v181, 0
  v_mov_b32 v182, 0
  v_mov_b32 v183, 0
  v_mov_b32 v184, 0
  v_mov_b32 v185, 0
  v_mov_b32 v186, 0
  v_mov_b32 v187, 0
  v_mov_b32 v188, 0
  v_mov_b32 v189, 0
  v_mov_b32 v190, 0
  v_mov_b32 v191, 0
  v_mov_b32 v192, 0
  v_mov_b32 v193, 0
  v_mov_b32 v194, 0
  v_mov_b32 v195, 0
  v_mov_b32 v196, 0
  v_mov_b32 v197, 0
  v_mov_b32 v198, 0
  v_mov_b32 v199, 0
  v_mov_b32 v200, 0
  v_mov_b32 v201, 0
  v_mov_b32 v202, 0
  v_mov_b32 v203, 0
  v_mov_b32 v204, 0
  v_mov_b32 v205, 0
  v_mov_b32 v206, 0
  v_mov_b32 v207, 0
  v_mov_b32 v208, 0
  v_mov_b32 v209, 0
  v_mov_b32 v210, 0
  v_mov_b32 v211, 0
  v_mov_b32 v212, 0
  v_mov_b32 v213, 0
  v_mov_b32 v214, 0
  v_mov_b32 v215, 0
  v_mov_b32 v216, 0
  v_mov_b32 v217, 0
  v_mov_b32 v218, 0
  v_mov_b32 v219, 0
  v_mov_b32 v220, 0
  v_mov_b32 v221, 0
  v_mov_b32 v222, 0
  v_mov_b32 v223, 0
  v_mov_b32 v224, 0
  v_mov_b32 v225, 0
  v_mov_b32 v226, 0
  v_mov_b32 v227, 0
  v_mov_b32 v228, 0
  v_mov_b32 v229, 0
  v_mov_b32 v230, 0
  v_mov_b32 v231, 0
  v_mov_b32 v232, 0
  v_mov_b32 v233, 0
  v_mov_b32 v234, 0
  v_mov_b32 v235, 0
  s_waitcnt lgkmcnt(0)
  s_lshl_b32 s3, s72, 5
  s_add_u32 s3, s3, s8
  s_lshl_b32 s4, s69, 14
  s_lshl3_add_u32 s3, s3, s4
  v_lshrrev_b32 v121, 1, v2
  v_lshl_add_u32 v121, v121, 4, v3
  v_and_b32 v120, 1, v2
  v_lshl_add_u32 v121, v121, 1, v120
  v_lshl_add_u32 v120, v121, 2, s3
  s_add_u32 s56, s22, 24903680
  s_addc_u32 s57, s23, 0
  s_and_b32 s57, s57, 0xffff
  s_mov_b32 s58, 262144
  s_mov_b32 s59, 0x00020000
  s_add_u32 s60, s22, 41943040
  s_addc_u32 s61, s23, 0
  s_and_b32 s61, s61, 0xffff
  s_mov_b32 s62, 524288
  s_mov_b32 s63, 0x00020000
  s_lshl_b32 s3, s2, 11
  s_cmp_lg_u32 s70, 0
  s_cbranch_scc1 L_attn_noclr
  s_lshl_b32 s5, s68, 10
  s_add_u32 s4, s4, s5
  v_lshlrev_b32 v121, 4, v1
  v_mov_b32 v40, -1
  v_mov_b32 v41, -1
  v_mov_b32 v42, -1
  v_mov_b32 v43, -1
  buffer_store_dwordx4 v[40:43], v121, s[56:59], s4 offen sc1
  buffer_store_dwordx4 v[128:131], v121, s[60:63], s3 offen offset:0 sc1
  buffer_store_dwordx4 v[128:131], v121, s[60:63], s3 offen offset:1024 sc1
  v_mov_b32 v126, 1
L_attn_noclr:
  s_and_b32 s65, s65, 0xffff
  s_mov_b32 s66, 256
  s_mov_b32 s67, 0x00020000
  s_mov_b32 s7, 0x3f803f80
L_attn_nozero:
  s_waitcnt lgkmcnt(0)
  s_add_u32 s44, s34, 8439808
  s_addc_u32 s45, s35, 0
  s_and_b32 s45, s45, 0xffff
  s_mov_b32 s46, 14628864
  s_mov_b32 s47, 0x00020000
  s_cmp_eq_u32 s96, 0
  s_barrier
  s_cbranch_scc1 L_attn_first
  ds_read_b128 v[88:91], v14 offset:46336
  ds_read_b128 v[92:95], v15 offset:46336
  ds_read_b128 v[32:35], v10 offset:0
  ds_read_b128 v[36:39], v10 offset:2048
  ds_read_b128 v[40:43], v10 offset:4096
  ds_read_b128 v[44:47], v10 offset:6144
  ds_read_b128 v[48:51], v14
  ds_read_b64_tr_b16 v[52:53], v12 offset:0
  ds_read_b64_tr_b16 v[54:55], v12 offset:512
  ds_read_b64_tr_b16 v[56:57], v13 offset:0
  ds_read_b64_tr_b16 v[58:59], v13 offset:512
  ds_read_b64_tr_b16 v[60:61], v12 offset:8192
  ds_read_b64_tr_b16 v[62:63], v12 offset:8704
  ds_read_b64_tr_b16 v[64:65], v13 offset:8192
  ds_read_b64_tr_b16 v[66:67], v13 offset:8704
  ds_read_b64_tr_b16 v[68:69], v12 offset:16384
  ds_read_b64_tr_b16 v[70:71], v12 offset:16896
  ds_read_b64_tr_b16 v[72:73], v13 offset:16384
  ds_read_b64_tr_b16 v[74:75], v13 offset:16896
  s_waitcnt lgkmcnt(15)
  v_mfma_f32_16x16x32_bf16 v[224:227], v[76:79], v[88:91], 0
  v_mfma_f32_16x16x32_bf16 v[228:231], v[80:83], v[88:91], 0
  v_mfma_f32_16x16x32_bf16 v[232:235], v[88:91], v[84:87], 0
  v_mfma_f32_16x16x32_bf16 v[224:227], v[96:99], v[92:95], v[224:227]
  v_mfma_f32_16x16x32_bf16 v[228:231], v[104:107], v[92:95], v[228:231]
  v_mfma_f32_16x16x32_bf16 v[232:235], v[92:95], v[112:115], v[232:235]
  s_waitcnt lgkmcnt(0)
  s_branch L_attn_loop
L_attn_first:
  ds_read_b128 v[32:35], v10 offset:0
  ds_read_b128 v[36:39], v10 offset:2048
  ds_read_b128 v[40:43], v10 offset:4096
  ds_read_b128 v[44:47], v10 offset:6144
  ds_read_b128 v[48:51], v14
  ds_read_b64_tr_b16 v[52:53], v12 offset:0
  ds_read_b64_tr_b16 v[54:55], v12 offset:512
  ds_read_b64_tr_b16 v[56:57], v13 offset:0
  ds_read_b64_tr_b16 v[58:59], v13 offset:512
  ds_read_b64_tr_b16 v[60:61], v12 offset:8192
  ds_read_b64_tr_b16 v[62:63], v12 offset:8704
  ds_read_b64_tr_b16 v[64:65], v13 offset:8192
  ds_read_b64_tr_b16 v[66:67], v13 offset:8704
  ds_read_b64_tr_b16 v[68:69], v12 offset:16384
  ds_read_b64_tr_b16 v[70:71], v12 offset:16896
  ds_read_b64_tr_b16 v[72:73], v13 offset:16384
  ds_read_b64_tr_b16 v[74:75], v13 offset:16896
.p2align 5
  s_nop 0
  s_nop 0
  s_nop 0
  s_waitcnt lgkmcnt(0)
L_attn_loop:
  v_mfma_f32_16x16x32_bf16 v[128:131], v[52:55], v[32:35], v[128:131]
  ds_read_b128 v[76:79], v11 offset:0
  v_mfma_f32_16x16x32_bf16 v[132:135], v[52:55], v[36:39], v[132:135]
  ds_read_b128 v[80:83], v11 offset:2048
  v_mfma_f32_16x16x32_bf16 v[136:139], v[52:55], v[40:43], v[136:139]
  ds_read_b128 v[84:87], v11 offset:4096
  v_mfma_f32_16x16x32_bf16 v[140:143], v[52:55], v[44:47], v[140:143]
  ds_read_b128 v[88:91], v11 offset:6144
  v_mfma_f32_16x16x32_bf16 v[224:227], v[52:55], v[48:51], v[224:227]
  ds_read_b128 v[92:95], v15
  v_mfma_f32_16x16x32_bf16 v[156:159], v[56:59], v[44:47], v[156:159]
  ds_read_b64_tr_b16 v[96:97], v12 offset:4096
  v_mfma_f32_16x16x32_bf16 v[152:155], v[56:59], v[40:43], v[152:155]
  ds_read_b64_tr_b16 v[98:99], v12 offset:4608
  v_mfma_f32_16x16x32_bf16 v[148:151], v[56:59], v[36:39], v[148:151]
  ds_read_b64_tr_b16 v[100:101], v13 offset:4096
  v_mfma_f32_16x16x32_bf16 v[144:147], v[56:59], v[32:35], v[144:147]
  ds_read_b64_tr_b16 v[102:103], v13 offset:4608
  v_mfma_f32_16x16x32_bf16 v[160:163], v[60:63], v[32:35], v[160:163]
  ds_read_b64_tr_b16 v[104:105], v12 offset:12288
  v_mfma_f32_16x16x32_bf16 v[164:167], v[60:63], v[36:39], v[164:167]
  ds_read_b64_tr_b16 v[106:107], v12 offset:12800
  v_mfma_f32_16x16x32_bf16 v[168:171], v[60:63], v[40:43], v[168:171]
  ds_read_b64_tr_b16 v[108:109], v13 offset:12288
  v_mfma_f32_16x16x32_bf16 v[172:175], v[60:63], v[44:47], v[172:175]
  ds_read_b64_tr_b16 v[110:111], v13 offset:12800
  v_mfma_f32_16x16x32_bf16 v[228:231], v[60:63], v[48:51], v[228:231]
  ds_read_b64_tr_b16 v[112:113], v12 offset:20480
  v_mfma_f32_16x16x32_bf16 v[188:191], v[64:67], v[44:47], v[188:191]
  ds_read_b64_tr_b16 v[114:115], v12 offset:20992
  v_mfma_f32_16x16x32_bf16 v[184:187], v[64:67], v[40:43], v[184:187]
  ds_read_b64_tr_b16 v[116:117], v13 offset:20480
  v_mfma_f32_16x16x32_bf16 v[180:183], v[64:67], v[36:39], v[180:183]
  ds_read_b64_tr_b16 v[118:119], v13 offset:20992
  v_mfma_f32_16x16x32_bf16 v[176:179], v[64:67], v[32:35], v[176:179]
  v_add_u32_e64 v10, s75, v4
  v_mfma_f32_16x16x32_bf16 v[192:195], v[32:35], v[68:71], v[192:195]
  v_add_u32_e64 v11, s75, v5
  v_mfma_f32_16x16x32_bf16 v[196:199], v[36:39], v[68:71], v[196:199]
  v_add_u32_e64 v12, s75, v6
  v_mfma_f32_16x16x32_bf16 v[200:203], v[40:43], v[68:71], v[200:203]
  v_add_u32_e64 v13, s75, v7
  v_mfma_f32_16x16x32_bf16 v[204:207], v[44:47], v[68:71], v[204:207]
  v_add_u32_e64 v14, s75, v8
  v_mfma_f32_16x16x32_bf16 v[232:235], v[48:51], v[68:71], v[232:235]
  v_add_u32_e64 v15, s75, v9
  v_mfma_f32_16x16x32_bf16 v[220:223], v[44:47], v[72:75], v[220:223]
  s_add_u32 s75, s75, 43008
  v_mfma_f32_16x16x32_bf16 v[216:219], v[40:43], v[72:75], v[216:219]
  s_cmp_eq_u32 s75, 129024
  v_mfma_f32_16x16x32_bf16 v[212:215], v[36:39], v[72:75], v[212:215]
  s_cselect_b32 s75, 0, s75
  s_sub_u32 s79, s79, 1
  v_mfma_f32_16x16x32_bf16 v[208:211], v[32:35], v[72:75], v[208:211]
  s_waitcnt lgkmcnt(0)
  s_barrier
  v_mfma_f32_16x16x32_bf16 v[128:131], v[96:99], v[76:79], v[128:131]
  ds_read_b128 v[32:35], v10 offset:0
  v_mfma_f32_16x16x32_bf16 v[132:135], v[96:99], v[80:83], v[132:135]
  ds_read_b128 v[36:39], v10 offset:2048
  v_mfma_f32_16x16x32_bf16 v[136:139], v[96:99], v[84:87], v[136:139]
  ds_read_b128 v[40:43], v10 offset:4096
  v_mfma_f32_16x16x32_bf16 v[140:143], v[96:99], v[88:91], v[140:143]
  ds_read_b128 v[44:47], v10 offset:6144
  v_mfma_f32_16x16x32_bf16 v[224:227], v[96:99], v[92:95], v[224:227]
  ds_read_b128 v[48:51], v14
  v_mfma_f32_16x16x32_bf16 v[156:159], v[100:103], v[88:91], v[156:159]
  ds_read_b64_tr_b16 v[52:53], v12 offset:0
  v_mfma_f32_16x16x32_bf16 v[152:155], v[100:103], v[84:87], v[152:155]
  ds_read_b64_tr_b16 v[54:55], v12 offset:512
  v_mfma_f32_16x16x32_bf16 v[148:151], v[100:103], v[80:83], v[148:151]
  ds_read_b64_tr_b16 v[56:57], v13 offset:0
  v_mfma_f32_16x16x32_bf16 v[144:147], v[100:103], v[76:79], v[144:147]
  ds_read_b64_tr_b16 v[58:59], v13 offset:512
  v_mfma_f32_16x16x32_bf16 v[160:163], v[104:107], v[76:79], v[160:163]
  ds_read_b64_tr_b16 v[60:61], v12 offset:8192
  v_mfma_f32_16x16x32_bf16 v[164:167], v[104:107], v[80:83], v[164:167]
  ds_read_b64_tr_b16 v[62:63], v12 offset:8704
  v_mfma_f32_16x16x32_bf16 v[168:171], v[104:107], v[84:87], v[168:171]
  ds_read_b64_tr_b16 v[64:65], v13 offset:8192
  v_mfma_f32_16x16x32_bf16 v[172:175], v[104:107], v[88:91], v[172:175]
  ds_read_b64_tr_b16 v[66:67], v13 offset:8704
  v_mfma_f32_16x16x32_bf16 v[228:231], v[104:107], v[92:95], v[228:231]
  ds_read_b64_tr_b16 v[68:69], v12 offset:16384
  v_mfma_f32_16x16x32_bf16 v[188:191], v[108:111], v[88:91], v[188:191]
  ds_read_b64_tr_b16 v[70:71], v12 offset:16896
  v_mfma_f32_16x16x32_bf16 v[184:187], v[108:111], v[84:87], v[184:187]
  ds_read_b64_tr_b16 v[72:73], v13 offset:16384
  v_mfma_f32_16x16x32_bf16 v[180:183], v[108:111], v[80:83], v[180:183]
  ds_read_b64_tr_b16 v[74:75], v13 offset:16896
  v_mfma_f32_16x16x32_bf16 v[176:179], v[108:111], v[76:79], v[176:179]
  s_cmp_lg_u32 s79, 0
  s_nop 0
  v_mfma_f32_16x16x32_bf16 v[192:195], v[76:79], v[112:115], v[192:195]
  v_mfma_f32_16x16x32_bf16 v[196:199], v[80:83], v[112:115], v[196:199]
  v_mfma_f32_16x16x32_bf16 v[200:203], v[84:87], v[112:115], v[200:203]
  v_mfma_f32_16x16x32_bf16 v[204:207], v[88:91], v[112:115], v[204:207]
  v_mfma_f32_16x16x32_bf16 v[232:235], v[92:95], v[112:115], v[232:235]
  v_mfma_f32_16x16x32_bf16 v[220:223], v[88:91], v[116:119], v[220:223]
  v_mfma_f32_16x16x32_bf16 v[216:219], v[84:87], v[116:119], v[216:219]
  v_mfma_f32_16x16x32_bf16 v[212:215], v[80:83], v[116:119], v[212:215]
  v_mfma_f32_16x16x32_bf16 v[208:211], v[76:79], v[116:119], v[208:211]
  s_waitcnt lgkmcnt(0)
  s_cbranch_scc1 L_attn_loop
L_attn_lend:
  s_add_u32 s98, s98, 1
  s_cmp_gt_u32 s98, 3
  s_cbranch_scc1 L_attn_exit
  s_cmp_lg_u32 s98, 1
  s_cbranch_scc1 L_attn_hook0
  s_mov_b32 s79, 1
  s_cmp_lg_u32 s72, 0
  s_cbranch_scc1 L_attn_dot0
  v_dot2_f32_bf16 v122, v32, s7, v122
  v_dot2_f32_bf16 v124, v32, v32, v124
  v_dot2_f32_bf16 v123, v36, s7, v123
  v_dot2_f32_bf16 v125, v36, v36, v125
  v_dot2_f32_bf16 v122, v33, s7, v122
  v_dot2_f32_bf16 v124, v33, v33, v124
  v_dot2_f32_bf16 v123, v37, s7, v123
  v_dot2_f32_bf16 v125, v37, v37, v125
  v_dot2_f32_bf16 v122, v34, s7, v122
  v_dot2_f32_bf16 v124, v34, v34, v124
  v_dot2_f32_bf16 v123, v38, s7, v123
  v_dot2_f32_bf16 v125, v38, v38, v125
  v_dot2_f32_bf16 v122, v35, s7, v122
  v_dot2_f32_bf16 v124, v35, v35, v124
  v_dot2_f32_bf16 v123, v39, s7, v123
  v_dot2_f32_bf16 v125, v39, v39, v125
  s_branch L_attn_dote0
  L_attn_dot0:
  v_dot2_f32_bf16 v122, v40, s7, v122
  v_dot2_f32_bf16 v124, v40, v40, v124
  v_dot2_f32_bf16 v123, v44, s7, v123
  v_dot2_f32_bf16 v125, v44, v44, v125
  v_dot2_f32_bf16 v122, v41, s7, v122
  v_dot2_f32_bf16 v124, v41, v41, v124
  v_dot2_f32_bf16 v123, v45, s7, v123
  v_dot2_f32_bf16 v125, v45, v45, v125
  v_dot2_f32_bf16 v122, v42, s7, v122
  v_dot2_f32_bf16 v124, v42, v42, v124
  v_dot2_f32_bf16 v123, v46, s7, v123
  v_dot2_f32_bf16 v125, v46, v46, v125
  v_dot2_f32_bf16 v122, v43, s7, v122
  v_dot2_f32_bf16 v124, v43, v43, v124
  v_dot2_f32_bf16 v123, v47, s7, v123
  v_dot2_f32_bf16 v125, v47, v47, v125
  L_attn_dote0:
  s_cmp_lg_u32 s70, 0
  s_cbranch_scc1 L_attn_loop
  s_waitcnt vmcnt(0)
  s_lshl4_add_u32 s3, s68, s69
  s_mov_b64 exec, 1
  buffer_store_byte v126, off, s[64:67], s3 sc1
  s_mov_b64 exec, -1
  s_branch L_attn_loop
L_attn_hook0:
  s_cmp_lg_u32 s98, 2
  s_cbranch_scc1 L_attn_hook1
  s_and_b32 s79, s69, 3
  s_add_u32 s79, s79, 1
  s_sub_u32 s79, 13, s79
  s_cmp_lg_u32 s72, 0
  s_cbranch_scc1 L_attn_dot1
  v_dot2_f32_bf16 v122, v76, s7, v122
  v_dot2_f32_bf16 v124, v76, v76, v124
  v_dot2_f32_bf16 v123, v80, s7, v123
  v_dot2_f32_bf16 v125, v80, v80, v125
  v_dot2_f32_bf16 v122, v77, s7, v122
  v_dot2_f32_bf16 v124, v77, v77, v124
  v_dot2_f32_bf16 v123, v81, s7, v123
  v_dot2_f32_bf16 v125, v81, v81, v125
  v_dot2_f32_bf16 v122, v78, s7, v122
  v_dot2_f32_bf16 v124, v78, v78, v124
  v_dot2_f32_bf16 v123, v82, s7, v123
  v_dot2_f32_bf16 v125, v82, v82, v125
  v_dot2_f32_bf16 v122, v79, s7, v122
  v_dot2_f32_bf16 v124, v79, v79, v124
  v_dot2_f32_bf16 v123, v83, s7, v123
  v_dot2_f32_bf16 v125, v83, v83, v125
  s_branch L_attn_dote1
  L_attn_dot1:
  v_dot2_f32_bf16 v122, v84, s7, v122
  v_dot2_f32_bf16 v124, v84, v84, v124
  v_dot2_f32_bf16 v123, v88, s7, v123
  v_dot2_f32_bf16 v125, v88, v88, v125
  v_dot2_f32_bf16 v122, v85, s7, v122
  v_dot2_f32_bf16 v124, v85, v85, v124
  v_dot2_f32_bf16 v123, v89, s7, v123
  v_dot2_f32_bf16 v125, v89, v89, v125
  v_dot2_f32_bf16 v122, v86, s7, v122
  v_dot2_f32_bf16 v124, v86, v86, v124
  v_dot2_f32_bf16 v123, v90, s7, v123
  v_dot2_f32_bf16 v125, v90, v90, v125
  v_dot2_f32_bf16 v122, v87, s7, v122
  v_dot2_f32_bf16 v124, v87, v87, v124
  v_dot2_f32_bf16 v123, v91, s7, v123
  v_dot2_f32_bf16 v125, v91, v91, v125
  L_attn_dote1:
  s_nop 2
  v_permlane32_swap_b32 v122, v123
  v_permlane32_swap_b32 v124, v125
  v_add_f32 v122, v122, v123
  v_add_f32 v124, v124, v125
  s_nop 0
  s_nop 0
  v_permlane16_swap_b32 v122, v124
  v_add_f32 v122, v122, v124
  buffer_store_dword v122, v120, s[56:59], 0 offen sc1
  s_branch L_attn_loop
L_attn_hook1:
  s_mov_b32 s79, 2
  s_mov_b32 s36, s16
  s_and_b32 s37, s17, 0xffff
  s_mov_b32 s38, 4194304
  s_mov_b32 s39, 0x00020000
  s_and_b32 s3, s2, 3
  s_and_b32 s4, s99, 3
  s_lshl2_add_u32 s3, s3, s4
  s_lshl2_add_u32 s3, s3, s70
  s_lshl_b32 s3, s3, 16
  s_bfe_u32 s4, s2, 0x10002
  s_lshr_b32 s5, s99, 2
  s_lshl1_add_u32 s4, s5, s4
  s_lshl_b32 s4, s4, 7
  s_add_u32 s3, s3, s4
  s_add_u32 s4, s3, 32768
  v_and_b32 v122, 15, v1
  v_lshlrev_b32 v123, 1, v1
  v_and_b32 v123, 32, v123
  v_lshl_add_u32 v122, v122, 11, v123
  v_lshrrev_b32 v123, 1, v1
  v_and_b32 v123, 16, v123
  v_add_u32 v122, v122, v123
  buffer_load_dwordx4 v[240:243], v122, s[36:39], s3 offen offset:0
  buffer_load_dwordx4 v[244:247], v122, s[36:39], s3 offen offset:64
  buffer_load_dwordx4 v[248:251], v122, s[36:39], s4 offen offset:0
  buffer_load_dwordx4 v[252:255], v122, s[36:39], s4 offen offset:64
  s_branch L_attn_loop
L_attn_exit:
  ds_read2_b32 v[66:67], v23 offset0:0 offset1:160
  ds_read2_b32 v[68:69], v23 offset0:16 offset1:176
  ds_read2_b32 v[70:71], v23 offset0:32 offset1:192
  ds_read2_b32 v[72:73], v23 offset0:48 offset1:208
  ds_read2_b32 v[74:75], v23 offset0:64 offset1:224
  ds_read2_b32 v[76:77], v25 offset0:0 offset1:16
  ds_read2_b32 v[80:81], v26 offset0:0 offset1:16
  ds_read2_b32 v[78:79], v25 offset0:32 offset1:48
  ds_read2_b32 v[82:83], v26 offset0:32 offset1:48
  ds_write_b128 v16, v[224:227] offset:0
  ds_write_b128 v16, v[228:231] offset:2048
  ds_write_b128 v16, v[232:235] offset:4096
  s_cmp_eq_u32 s71, 1
  s_cbranch_scc1 L_attn_nop3
  ds_write_b128 v16, v[172:175] offset:8192
  ds_write_b128 v16, v[188:191] offset:9216
  ds_write_b128 v16, v[204:207] offset:10240
  ds_write_b128 v16, v[220:223] offset:11264
L_attn_nop3:
  ds_read_b128 v[84:87], v24 offset:0
  ds_read_b128 v[104:107], v24 offset:640
  ds_read_b128 v[88:91], v24 offset:64
  ds_read_b128 v[108:111], v24 offset:704
  ds_read_b128 v[92:95], v24 offset:128
  ds_read_b128 v[112:115], v24 offset:768
  ds_read_b128 v[96:99], v24 offset:192
  ds_read_b128 v[116:119], v24 offset:832
  ds_read_b128 v[100:103], v24 offset:256
  ds_read_b128 v[120:123], v24 offset:896
  s_waitcnt lgkmcnt(10)
  s_barrier
  ds_read_b128 v[48:51], v19 offset:0
  ds_read_b128 v[52:55], v20 offset:1024
  ds_read_b128 v[56:59], v19 offset:2048
  ds_read_b128 v[60:63], v20 offset:3072
  ds_read_b32 v64, v21 offset:4096
  ds_read_b32 v65, v22 offset:5120
  ds_read_b128 v[32:35], v17 offset:2048
  ds_read_b128 v[36:39], v18 offset:3072
  ds_read_b128 v[40:43], v17 offset:4096
  ds_read_b128 v[44:47], v18 offset:5120
  v_mul_f32 v69, 0x3e8293ee, v69
  v_mul_f32 v71, 0x3e8293ee, v71
  v_mul_f32 v73, 0x3e8293ee, v73
  v_mul_f32 v75, 0x3e8293ee, v75
  v_mul_f32 v76, v76, v69
  v_mul_f32 v80, v80, v69
  v_mul_f32 v77, v77, v71
  v_mul_f32 v81, v81, v71
  v_mul_f32 v78, v78, v73
  v_mul_f32 v82, v82, v73
  v_mul_f32 v79, v79, v75
  v_mul_f32 v83, v83, v75
  s_waitcnt lgkmcnt(6)
  v_pk_fma_f32 v[128:129], v[48:49], v[68:69], v[128:129] op_sel:[0,0,0] op_sel_hi:[1,0,1] neg_lo:[0,1,0] neg_hi:[0,1,0]
  v_pk_fma_f32 v[130:131], v[50:51], v[68:69], v[130:131] op_sel:[0,0,0] op_sel_hi:[1,0,1] neg_lo:[0,1,0] neg_hi:[0,1,0]
  v_pk_fma_f32 v[144:145], v[52:53], v[68:69], v[144:145] op_sel:[0,0,0] op_sel_hi:[1,0,1] neg_lo:[0,1,0] neg_hi:[0,1,0]
  v_pk_fma_f32 v[146:147], v[54:55], v[68:69], v[146:147] op_sel:[0,0,0] op_sel_hi:[1,0,1] neg_lo:[0,1,0] neg_hi:[0,1,0]
  v_cvt_pk_bf16_f32 v128, v128, v129
  v_cvt_pk_bf16_f32 v129, v130, v131
  v_cvt_pk_bf16_f32 v130, v144, v145
  v_cvt_pk_bf16_f32 v131, v146, v147
  v_pk_fma_f32 v[160:161], v[56:57], v[68:69], v[160:161] op_sel:[0,0,0] op_sel_hi:[1,0,1] neg_lo:[0,1,0] neg_hi:[0,1,0]
  v_pk_fma_f32 v[162:163], v[58:59], v[68:69], v[162:163] op_sel:[0,0,0] op_sel_hi:[1,0,1] neg_lo:[0,1,0] neg_hi:[0,1,0]
  v_pk_fma_f32 v[176:177], v[60:61], v[68:69], v[176:177] op_sel:[0,0,0] op_sel_hi:[1,0,1] neg_lo:[0,1,0] neg_hi:[0,1,0]
  v_pk_fma_f32 v[178:179], v[62:63], v[68:69], v[178:179] op_sel:[0,0,0] op_sel_hi:[1,0,1] neg_lo:[0,1,0] neg_hi:[0,1,0]
  v_cvt_pk_bf16_f32 v160, v160, v161
  v_cvt_pk_bf16_f32 v161, v162, v163
  v_cvt_pk_bf16_f32 v162, v176, v177
  v_cvt_pk_bf16_f32 v163, v178, v179
  v_pk_fma_f32 v[132:133], v[48:49], v[70:71], v[132:133] op_sel:[0,0,0] op_sel_hi:[1,0,1] neg_lo:[0,1,0] neg_hi:[0,1,0]
  v_pk_fma_f32 v[134:135], v[50:51], v[70:71], v[134:135] op_sel:[0,0,0] op_sel_hi:[1,0,1] neg_lo:[0,1,0] neg_hi:[0,1,0]
  v_pk_fma_f32 v[148:149], v[52:53], v[70:71], v[148:149] op_sel:[0,0,0] op_sel_hi:[1,0,1] neg_lo:[0,1,0] neg_hi:[0,1,0]
  v_pk_fma_f32 v[150:151], v[54:55], v[70:71], v[150:151] op_sel:[0,0,0] op_sel_hi:[1,0,1] neg_lo:[0,1,0] neg_hi:[0,1,0]
  v_cvt_pk_bf16_f32 v132, v132, v133
  v_cvt_pk_bf16_f32 v133, v134, v135
  v_cvt_pk_bf16_f32 v134, v148, v149
  v_cvt_pk_bf16_f32 v135, v150, v151
  v_pk_fma_f32 v[164:165], v[56:57], v[70:71], v[164:165] op_sel:[0,0,0] op_sel_hi:[1,0,1] neg_lo:[0,1,0] neg_hi:[0,1,0]
  v_pk_fma_f32 v[166:167], v[58:59], v[70:71], v[166:167] op_sel:[0,0,0] op_sel_hi:[1,0,1] neg_lo:[0,1,0] neg_hi:[0,1,0]
  v_pk_fma_f32 v[180:181], v[60:61], v[70:71], v[180:181] op_sel:[0,0,0] op_sel_hi:[1,0,1] neg_lo:[0,1,0] neg_hi:[0,1,0]
  v_pk_fma_f32 v[182:183], v[62:63], v[70:71], v[182:183] op_sel:[0,0,0] op_sel_hi:[1,0,1] neg_lo:[0,1,0] neg_hi:[0,1,0]
  v_cvt_pk_bf16_f32 v164, v164, v165
  v_cvt_pk_bf16_f32 v165, v166, v167
  v_cvt_pk_bf16_f32 v166, v180, v181
  v_cvt_pk_bf16_f32 v167, v182, v183
  v_mfma_f32_16x16x32_bf16 v[144:147], v[160:163], v[128:131], 0
  v_pk_fma_f32 v[136:137], v[48:49], v[72:73], v[136:137] op_sel:[0,0,0] op_sel_hi:[1,0,1] neg_lo:[0,1,0] neg_hi:[0,1,0]
  v_pk_fma_f32 v[138:139], v[50:51], v[72:73], v[138:139] op_sel:[0,0,0] op_sel_hi:[1,0,1] neg_lo:[0,1,0] neg_hi:[0,1,0]
  v_pk_fma_f32 v[152:153], v[52:53], v[72:73], v[152:153] op_sel:[0,0,0] op_sel_hi:[1,0,1] neg_lo:[0,1,0] neg_hi:[0,1,0]
  v_pk_fma_f32 v[154:155], v[54:55], v[72:73], v[154:155] op_sel:[0,0,0] op_sel_hi:[1,0,1] neg_lo:[0,1,0] neg_hi:[0,1,0]
  v_cvt_pk_bf16_f32 v136, v136, v137
  v_cvt_pk_bf16_f32 v137, v138, v139
  v_cvt_pk_bf16_f32 v138, v152, v153
  v_cvt_pk_bf16_f32 v139, v154, v155
  v_pk_fma_f32 v[168:169], v[56:57], v[72:73], v[168:169] op_sel:[0,0,0] op_sel_hi:[1,0,1] neg_lo:[0,1,0] neg_hi:[0,1,0]
  v_pk_fma_f32 v[170:171], v[58:59], v[72:73], v[170:171] op_sel:[0,0,0] op_sel_hi:[1,0,1] neg_lo:[0,1,0] neg_hi:[0,1,0]
  v_pk_fma_f32 v[184:185], v[60:61], v[72:73], v[184:185] op_sel:[0,0,0] op_sel_hi:[1,0,1] neg_lo:[0,1,0] neg_hi:[0,1,0]
  v_pk_fma_f32 v[186:187], v[62:63], v[72:73], v[186:187] op_sel:[0,0,0] op_sel_hi:[1,0,1] neg_lo:[0,1,0] neg_hi:[0,1,0]
  v_cvt_pk_bf16_f32 v168, v168, v169
  v_cvt_pk_bf16_f32 v169, v170, v171
  v_cvt_pk_bf16_f32 v170, v184, v185
  v_cvt_pk_bf16_f32 v171, v186, v187
  v_mfma_f32_16x16x32_bf16 v[148:151], v[164:167], v[132:135], 0
  v_mfma_f32_16x16x32_bf16 v[180:183], v[160:163], v[132:135], 0
  v_pk_fma_f32 v[140:141], v[48:49], v[74:75], v[140:141] op_sel:[0,0,0] op_sel_hi:[1,0,1] neg_lo:[0,1,0] neg_hi:[0,1,0]
  v_pk_fma_f32 v[142:143], v[50:51], v[74:75], v[142:143] op_sel:[0,0,0] op_sel_hi:[1,0,1] neg_lo:[0,1,0] neg_hi:[0,1,0]
  v_pk_fma_f32 v[156:157], v[52:53], v[74:75], v[156:157] op_sel:[0,0,0] op_sel_hi:[1,0,1] neg_lo:[0,1,0] neg_hi:[0,1,0]
  v_pk_fma_f32 v[158:159], v[54:55], v[74:75], v[158:159] op_sel:[0,0,0] op_sel_hi:[1,0,1] neg_lo:[0,1,0] neg_hi:[0,1,0]
  v_cvt_pk_bf16_f32 v140, v140, v141
  v_cvt_pk_bf16_f32 v141, v142, v143
  v_cvt_pk_bf16_f32 v142, v156, v157
  v_cvt_pk_bf16_f32 v143, v158, v159
  v_pk_fma_f32 v[172:173], v[56:57], v[74:75], v[172:173] op_sel:[0,0,0] op_sel_hi:[1,0,1] neg_lo:[0,1,0] neg_hi:[0,1,0]
  v_pk_fma_f32 v[174:175], v[58:59], v[74:75], v[174:175] op_sel:[0,0,0] op_sel_hi:[1,0,1] neg_lo:[0,1,0] neg_hi:[0,1,0]
  v_pk_fma_f32 v[188:189], v[60:61], v[74:75], v[188:189] op_sel:[0,0,0] op_sel_hi:[1,0,1] neg_lo:[0,1,0] neg_hi:[0,1,0]
  v_pk_fma_f32 v[190:191], v[62:63], v[74:75], v[190:191] op_sel:[0,0,0] op_sel_hi:[1,0,1] neg_lo:[0,1,0] neg_hi:[0,1,0]
  v_cvt_pk_bf16_f32 v172, v172, v173
  v_cvt_pk_bf16_f32 v173, v174, v175
  v_cvt_pk_bf16_f32 v174, v188, v189
  v_cvt_pk_bf16_f32 v175, v190, v191
  s_waitcnt lgkmcnt(0)
  v_pk_fma_f32 v[32:33], v[56:57], v[66:67], v[32:33] op_sel:[0,0,0] op_sel_hi:[1,0,1] neg_lo:[0,1,0] neg_hi:[0,1,0]
  v_pk_fma_f32 v[34:35], v[58:59], v[66:67], v[34:35] op_sel:[0,0,0] op_sel_hi:[1,0,1] neg_lo:[0,1,0] neg_hi:[0,1,0]
  v_pk_fma_f32 v[36:37], v[60:61], v[66:67], v[36:37] op_sel:[0,0,0] op_sel_hi:[1,0,1] neg_lo:[0,1,0] neg_hi:[0,1,0]
  v_pk_fma_f32 v[38:39], v[62:63], v[66:67], v[38:39] op_sel:[0,0,0] op_sel_hi:[1,0,1] neg_lo:[0,1,0] neg_hi:[0,1,0]
  v_cvt_pk_bf16_f32 v32, v32, v33
  v_cvt_pk_bf16_f32 v33, v34, v35
  v_cvt_pk_bf16_f32 v34, v36, v37
  v_cvt_pk_bf16_f32 v35, v38, v39
  v_mfma_f32_16x16x32_bf16 v[152:155], v[168:171], v[136:139], 0
  v_mfma_f32_16x16x32_bf16 v[184:187], v[164:167], v[136:139], 0
  v_mfma_f32_16x16x32_bf16 v[156:159], v[172:175], v[140:143], 0
  v_mfma_f32_16x16x32_bf16 v[188:191], v[168:171], v[140:143], 0
  v_mfma_f32_16x16x32_bf16 v[176:179], v[32:35], v[128:131], 0
  v_pk_fma_f32 v[40:41], v[84:85], v[64:65], v[40:41] op_sel:[0,0,0] op_sel_hi:[1,0,1] neg_lo:[1,0,0] neg_hi:[1,0,0]
  v_pk_fma_f32 v[42:43], v[86:87], v[64:65], v[42:43] op_sel:[0,0,0] op_sel_hi:[1,0,1] neg_lo:[1,0,0] neg_hi:[1,0,0]
  v_pk_mul_f32 v[40:41], v[40:41], v[104:105]
  v_pk_mul_f32 v[42:43], v[42:43], v[106:107]
  v_cvt_pk_bf16_f32 v4, v40, v41
  v_cvt_pk_bf16_f32 v5, v42, v43
  v_pk_fma_f32 v[192:193], v[88:89], v[64:65], v[192:193] op_sel:[0,0,0] op_sel_hi:[1,0,1] neg_lo:[1,0,0] neg_hi:[1,0,0]
  v_pk_fma_f32 v[194:195], v[90:91], v[64:65], v[194:195] op_sel:[0,0,0] op_sel_hi:[1,0,1] neg_lo:[1,0,0] neg_hi:[1,0,0]
  v_pk_mul_f32 v[192:193], v[192:193], v[108:109]
  v_pk_mul_f32 v[194:195], v[194:195], v[110:111]
  v_cvt_pk_bf16_f32 v6, v192, v193
  v_cvt_pk_bf16_f32 v7, v194, v195
  v_pk_fma_f32 v[196:197], v[92:93], v[64:65], v[196:197] op_sel:[0,0,0] op_sel_hi:[1,0,1] neg_lo:[1,0,0] neg_hi:[1,0,0]
  v_pk_fma_f32 v[198:199], v[94:95], v[64:65], v[198:199] op_sel:[0,0,0] op_sel_hi:[1,0,1] neg_lo:[1,0,0] neg_hi:[1,0,0]
  v_pk_mul_f32 v[196:197], v[196:197], v[112:113]
  v_pk_mul_f32 v[198:199], v[198:199], v[114:115]
  v_cvt_pk_bf16_f32 v8, v196, v197
  v_cvt_pk_bf16_f32 v9, v198, v199
  v_pk_fma_f32 v[200:201], v[96:97], v[64:65], v[200:201] op_sel:[0,0,0] op_sel_hi:[1,0,1] neg_lo:[1,0,0] neg_hi:[1,0,0]
  v_pk_fma_f32 v[202:203], v[98:99], v[64:65], v[202:203] op_sel:[0,0,0] op_sel_hi:[1,0,1] neg_lo:[1,0,0] neg_hi:[1,0,0]
  v_pk_mul_f32 v[200:201], v[200:201], v[116:117]
  v_pk_mul_f32 v[202:203], v[202:203], v[118:119]
  v_cvt_pk_bf16_f32 v10, v200, v201
  v_cvt_pk_bf16_f32 v11, v202, v203
  v_pk_fma_f32 v[204:205], v[100:101], v[64:65], v[204:205] op_sel:[0,0,0] op_sel_hi:[1,0,1] neg_lo:[1,0,0] neg_hi:[1,0,0]
  v_pk_fma_f32 v[206:207], v[102:103], v[64:65], v[206:207] op_sel:[0,0,0] op_sel_hi:[1,0,1] neg_lo:[1,0,0] neg_hi:[1,0,0]
  v_pk_mul_f32 v[204:205], v[204:205], v[120:121]
  v_pk_mul_f32 v[206:207], v[206:207], v[122:123]
  v_cvt_pk_bf16_f32 v12, v204, v205
  v_cvt_pk_bf16_f32 v13, v206, v207
  v_pk_fma_f32 v[44:45], v[84:85], v[64:65], v[44:45] op_sel:[0,1,0] op_sel_hi:[1,1,1] neg_lo:[1,0,0] neg_hi:[1,0,0]
  v_pk_fma_f32 v[46:47], v[86:87], v[64:65], v[46:47] op_sel:[0,1,0] op_sel_hi:[1,1,1] neg_lo:[1,0,0] neg_hi:[1,0,0]
  v_pk_mul_f32 v[44:45], v[44:45], v[104:105]
  v_pk_mul_f32 v[46:47], v[46:47], v[106:107]
  v_cvt_pk_bf16_f32 v224, v44, v45
  v_cvt_pk_bf16_f32 v225, v46, v47
  v_pk_fma_f32 v[208:209], v[88:89], v[64:65], v[208:209] op_sel:[0,1,0] op_sel_hi:[1,1,1] neg_lo:[1,0,0] neg_hi:[1,0,0]
  v_pk_fma_f32 v[210:211], v[90:91], v[64:65], v[210:211] op_sel:[0,1,0] op_sel_hi:[1,1,1] neg_lo:[1,0,0] neg_hi:[1,0,0]
  v_pk_mul_f32 v[208:209], v[208:209], v[108:109]
  v_pk_mul_f32 v[210:211], v[210:211], v[110:111]
  v_cvt_pk_bf16_f32 v226, v208, v209
  v_cvt_pk_bf16_f32 v227, v210, v211
  v_pk_fma_f32 v[212:213], v[92:93], v[64:65], v[212:213] op_sel:[0,1,0] op_sel_hi:[1,1,1] neg_lo:[1,0,0] neg_hi:[1,0,0]
  v_pk_fma_f32 v[214:215], v[94:95], v[64:65], v[214:215] op_sel:[0,1,0] op_sel_hi:[1,1,1] neg_lo:[1,0,0] neg_hi:[1,0,0]
  v_pk_mul_f32 v[212:213], v[212:213], v[112:113]
  v_pk_mul_f32 v[214:215], v[214:215], v[114:115]
  v_cvt_pk_bf16_f32 v228, v212, v213
  v_cvt_pk_bf16_f32 v229, v214, v215
  v_pk_fma_f32 v[216:217], v[96:97], v[64:65], v[216:217] op_sel:[0,1,0] op_sel_hi:[1,1,1] neg_lo:[1,0,0] neg_hi:[1,0,0]
  v_pk_fma_f32 v[218:219], v[98:99], v[64:65], v[218:219] op_sel:[0,1,0] op_sel_hi:[1,1,1] neg_lo:[1,0,0] neg_hi:[1,0,0]
  v_pk_mul_f32 v[216:217], v[216:217], v[116:117]
  v_pk_mul_f32 v[218:219], v[218:219], v[118:119]
  v_cvt_pk_bf16_f32 v230, v216, v217
  v_cvt_pk_bf16_f32 v231, v218, v219
  v_pk_fma_f32 v[220:221], v[100:101], v[64:65], v[220:221] op_sel:[0,1,0] op_sel_hi:[1,1,1] neg_lo:[1,0,0] neg_hi:[1,0,0]
  v_pk_fma_f32 v[222:223], v[102:103], v[64:65], v[222:223] op_sel:[0,1,0] op_sel_hi:[1,1,1] neg_lo:[1,0,0] neg_hi:[1,0,0]
  v_pk_mul_f32 v[220:221], v[220:221], v[120:121]
  v_pk_mul_f32 v[222:223], v[222:223], v[122:123]
  v_cvt_pk_bf16_f32 v232, v220, v221
  v_cvt_pk_bf16_f32 v233, v222, v223
  v_cndmask_b32 v148, v148, v149, s[48:49]
  v_cndmask_b32 v180, v180, v181, s[48:49]
  v_cndmask_b32 v150, v150, v151, s[48:49]
  v_cndmask_b32 v182, v182, v183, s[48:49]
  v_cndmask_b32 v36, v148, v180, s[50:51]
  v_cndmask_b32 v37, v150, v182, s[52:53]
  v_mul_f32 v36, v36, v77
  v_mul_f32 v37, v37, v81
  v_cndmask_b32 v152, v152, v153, s[48:49]
  v_cndmask_b32 v184, v184, v185, s[48:49]
  v_cndmask_b32 v154, v154, v155, s[48:49]
  v_cndmask_b32 v186, v186, v187, s[48:49]
  v_cndmask_b32 v40, v152, v184, s[50:51]
  v_cndmask_b32 v41, v154, v186, s[52:53]
  v_mul_f32 v40, v40, v78
  v_mul_f32 v41, v41, v82
  v_cndmask_b32 v156, v156, v157, s[48:49]
  v_cndmask_b32 v188, v188, v189, s[48:49]
  v_cndmask_b32 v158, v158, v159, s[48:49]
  v_cndmask_b32 v190, v190, v191, s[48:49]
  v_cndmask_b32 v44, v156, v188, s[50:51]
  v_cndmask_b32 v45, v158, v190, s[52:53]
  v_mul_f32 v44, v44, v79
  v_mul_f32 v45, v45, v83
  v_cndmask_b32 v144, v144, v145, s[48:49]
  v_cndmask_b32 v176, v176, v177, s[48:49]
  v_cndmask_b32 v146, v146, v147, s[48:49]
  v_cndmask_b32 v178, v178, v179, s[48:49]
  v_cndmask_b32 v32, v144, v176, s[50:51]
  v_cndmask_b32 v33, v146, v178, s[52:53]
  v_mul_f32 v32, v32, v76
  v_mul_f32 v33, v33, v80
  v_mov_b32 v48, 0xceabfb8f
  v_cndmask_b32 v32, v32, v48, s[54:55]
  v_cndmask_b32 v33, v33, v48, s[14:15]
  v_max_f32 v34, v32, v33
  v_max_f32 v38, v36, v37
  v_max_f32 v42, v40, v41
  v_max_f32 v46, v44, v45
  v_mov_b32 v35, v34
  v_mov_b32 v39, v38
  v_mov_b32 v43, v42
  v_mov_b32 v47, v46
  v_permlane32_swap_b32 v34, v35
  v_permlane32_swap_b32 v38, v39
  v_permlane32_swap_b32 v42, v43
  v_permlane32_swap_b32 v46, v47
  v_max_f32 v34, v34, v35
  v_max_f32 v38, v38, v39
  v_max_f32 v42, v42, v43
  v_max_f32 v46, v46, v47
  v_mov_b32 v35, v34
  v_mov_b32 v39, v38
  v_mov_b32 v43, v42
  v_mov_b32 v47, v46
  v_permlane16_swap_b32 v34, v35
  v_permlane16_swap_b32 v38, v39
  v_permlane16_swap_b32 v42, v43
  v_permlane16_swap_b32 v46, v47
  v_max_f32 v34, v34, v35
  v_max_f32 v38, v38, v39
  v_max_f32 v42, v42, v43
  v_max_f32 v46, v46, v47
  v_sub_f32 v32, v32, v34
  v_sub_f32 v33, v33, v34
  v_sub_f32 v36, v36, v38
  v_sub_f32 v37, v37, v38
  v_sub_f32 v40, v40, v42
  v_sub_f32 v41, v41, v42
  v_sub_f32 v44, v44, v46
  v_sub_f32 v45, v45, v46
  v_exp_f32 v32, v32
  v_exp_f32 v33, v33
  v_exp_f32 v36, v36
  v_exp_f32 v37, v37
  v_exp_f32 v40, v40
  v_exp_f32 v41, v41
  v_exp_f32 v44, v44
  v_exp_f32 v45, v45
  v_cvt_pk_bf16_f32 v32, v32, v32
  v_cvt_pk_bf16_f32 v33, v33, v33
  v_and_b32 v128, v32, v27
  v_and_b32 v129, v33, v29
  v_and_b32 v130, v32, v28
  v_and_b32 v131, v33, v30
  v_cvt_pk_bf16_f32 v36, v36, v36
  v_cvt_pk_bf16_f32 v37, v37, v37
  v_and_b32 v132, v36, v27
  v_and_b32 v133, v37, v29
  v_and_b32 v134, v36, v28
  v_and_b32 v135, v37, v30
  v_mfma_f32_16x16x32_bf16 v[144:147], v[236:239], v[128:131], 0
  v_mfma_f32_16x16x32_bf16 v[192:195], v[4:7], v[128:131], 0
  v_mfma_f32_16x16x32_bf16 v[208:211], v[224:227], v[128:131], 0
  v_cvt_pk_bf16_f32 v40, v40, v40
  v_cvt_pk_bf16_f32 v41, v41, v41
  v_and_b32 v136, v40, v27
  v_and_b32 v137, v41, v29
  v_and_b32 v138, v40, v28
  v_and_b32 v139, v41, v30
  v_mfma_f32_16x16x32_bf16 v[148:151], v[236:239], v[132:135], 0
  v_mfma_f32_16x16x32_bf16 v[196:199], v[6:9], v[132:135], 0
  v_mfma_f32_16x16x32_bf16 v[212:215], v[226:229], v[132:135], 0
  v_cvt_pk_bf16_f32 v44, v44, v44
  v_cvt_pk_bf16_f32 v45, v45, v45
  v_and_b32 v140, v44, v27
  v_and_b32 v141, v45, v29
  v_and_b32 v142, v44, v28
  v_and_b32 v143, v45, v30
  v_mfma_f32_16x16x32_bf16 v[152:155], v[236:239], v[136:139], 0
  v_mfma_f32_16x16x32_bf16 v[200:203], v[8:11], v[136:139], 0
  v_mfma_f32_16x16x32_bf16 v[216:219], v[228:231], v[136:139], 0
  v_mfma_f32_16x16x32_bf16 v[156:159], v[236:239], v[140:143], 0
  v_mfma_f32_16x16x32_bf16 v[204:207], v[10:13], v[140:143], 0
  v_mfma_f32_16x16x32_bf16 v[220:223], v[230:233], v[140:143], 0
  s_cmp_eq_u32 s71, 1
  s_cbranch_scc1 L_attn_out1
  v_rcp_f32 v144, v144
  s_mov_b32 s3, 0
  v_pk_mul_f32 v[192:193], v[192:193], v[144:145] op_sel_hi:[1,0]
  v_pk_mul_f32 v[194:195], v[194:195], v[144:145] op_sel_hi:[1,0]
  v_pk_mul_f32 v[208:209], v[208:209], v[144:145] op_sel_hi:[1,0]
  v_pk_mul_f32 v[210:211], v[210:211], v[144:145] op_sel_hi:[1,0]
  v_cvt_pk_bf16_f32 v48, v192, v193
  v_cvt_pk_bf16_f32 v49, v194, v195
  v_cvt_pk_bf16_f32 v50, v208, v209
  v_cvt_pk_bf16_f32 v51, v210, v211
  buffer_store_dwordx4 v[48:51], v31, s[44:47], s3 offen sc1
  v_rcp_f32 v148, v148
  s_mov_b32 s3, 114688
  v_pk_mul_f32 v[196:197], v[196:197], v[148:149] op_sel_hi:[1,0]
  v_pk_mul_f32 v[198:199], v[198:199], v[148:149] op_sel_hi:[1,0]
  v_pk_mul_f32 v[212:213], v[212:213], v[148:149] op_sel_hi:[1,0]
  v_pk_mul_f32 v[214:215], v[214:215], v[148:149] op_sel_hi:[1,0]
  v_cvt_pk_bf16_f32 v52, v196, v197
  v_cvt_pk_bf16_f32 v53, v198, v199
  v_cvt_pk_bf16_f32 v54, v212, v213
  v_cvt_pk_bf16_f32 v55, v214, v215
  buffer_store_dwordx4 v[52:55], v31, s[44:47], s3 offen sc1
  v_rcp_f32 v152, v152
  s_mov_b32 s3, 229376
  v_pk_mul_f32 v[200:201], v[200:201], v[152:153] op_sel_hi:[1,0]
  v_pk_mul_f32 v[202:203], v[202:203], v[152:153] op_sel_hi:[1,0]
  v_pk_mul_f32 v[216:217], v[216:217], v[152:153] op_sel_hi:[1,0]
  v_pk_mul_f32 v[218:219], v[218:219], v[152:153] op_sel_hi:[1,0]
  v_cvt_pk_bf16_f32 v56, v200, v201
  v_cvt_pk_bf16_f32 v57, v202, v203
  v_cvt_pk_bf16_f32 v58, v216, v217
  v_cvt_pk_bf16_f32 v59, v218, v219
  buffer_store_dwordx4 v[56:59], v31, s[44:47], s3 offen sc1
  v_rcp_f32 v156, v156
  s_mov_b32 s3, 344064
  v_pk_mul_f32 v[204:205], v[204:205], v[156:157] op_sel_hi:[1,0]
  v_pk_mul_f32 v[206:207], v[206:207], v[156:157] op_sel_hi:[1,0]
  v_pk_mul_f32 v[220:221], v[220:221], v[156:157] op_sel_hi:[1,0]
  v_pk_mul_f32 v[222:223], v[222:223], v[156:157] op_sel_hi:[1,0]
  v_cvt_pk_bf16_f32 v60, v204, v205
  v_cvt_pk_bf16_f32 v61, v206, v207
  v_cvt_pk_bf16_f32 v62, v220, v221
  v_cvt_pk_bf16_f32 v63, v222, v223
  buffer_store_dwordx4 v[60:63], v31, s[44:47], s3 offen sc1
  s_branch L_attn_out2
L_attn_out1:
  v_rcp_f32 v144, v144
  s_mov_b32 s3, 0
  v_pk_mul_f32 v[192:193], v[192:193], v[144:145] op_sel_hi:[1,0]
  v_pk_mul_f32 v[194:195], v[194:195], v[144:145] op_sel_hi:[1,0]
  v_pk_mul_f32 v[208:209], v[208:209], v[144:145] op_sel_hi:[1,0]
  v_pk_mul_f32 v[210:211], v[210:211], v[144:145] op_sel_hi:[1,0]
  v_cvt_pk_bf16_f32 v50, v192, v193
  v_cvt_pk_bf16_f32 v51, v194, v195
  v_cvt_pk_bf16_f32 v48, v208, v209
  v_cvt_pk_bf16_f32 v49, v210, v211
  buffer_store_dwordx4 v[48:51], v31, s[44:47], s3 offen sc1
  v_rcp_f32 v148, v148
  s_mov_b32 s3, 114688
  v_pk_mul_f32 v[196:197], v[196:197], v[148:149] op_sel_hi:[1,0]
  v_pk_mul_f32 v[198:199], v[198:199], v[148:149] op_sel_hi:[1,0]
  v_pk_mul_f32 v[212:213], v[212:213], v[148:149] op_sel_hi:[1,0]
  v_pk_mul_f32 v[214:215], v[214:215], v[148:149] op_sel_hi:[1,0]
  v_cvt_pk_bf16_f32 v54, v196, v197
  v_cvt_pk_bf16_f32 v55, v198, v199
  v_cvt_pk_bf16_f32 v52, v212, v213
  v_cvt_pk_bf16_f32 v53, v214, v215
  buffer_store_dwordx4 v[52:55], v31, s[44:47], s3 offen sc1
  v_rcp_f32 v152, v152
  s_mov_b32 s3, 229376
  v_pk_mul_f32 v[200:201], v[200:201], v[152:153] op_sel_hi:[1,0]
  v_pk_mul_f32 v[202:203], v[202:203], v[152:153] op_sel_hi:[1,0]
  v_pk_mul_f32 v[216:217], v[216:217], v[152:153] op_sel_hi:[1,0]
  v_pk_mul_f32 v[218:219], v[218:219], v[152:153] op_sel_hi:[1,0]
  v_cvt_pk_bf16_f32 v58, v200, v201
  v_cvt_pk_bf16_f32 v59, v202, v203
  v_cvt_pk_bf16_f32 v56, v216, v217
  v_cvt_pk_bf16_f32 v57, v218, v219
  buffer_store_dwordx4 v[56:59], v31, s[44:47], s3 offen sc1
  v_rcp_f32 v156, v156
  s_mov_b32 s3, 344064
  v_pk_mul_f32 v[204:205], v[204:205], v[156:157] op_sel_hi:[1,0]
  v_pk_mul_f32 v[206:207], v[206:207], v[156:157] op_sel_hi:[1,0]
  v_pk_mul_f32 v[220:221], v[220:221], v[156:157] op_sel_hi:[1,0]
  v_pk_mul_f32 v[222:223], v[222:223], v[156:157] op_sel_hi:[1,0]
  v_cvt_pk_bf16_f32 v62, v204, v205
  v_cvt_pk_bf16_f32 v63, v206, v207
  v_cvt_pk_bf16_f32 v60, v220, v221
  v_cvt_pk_bf16_f32 v61, v222, v223
  buffer_store_dwordx4 v[60:63], v31, s[44:47], s3 offen sc1
L_attn_out2:
  s_waitcnt vmcnt(0) lgkmcnt(0)
  s_barrier
  s_add_u32 s97, s97, 1
  s_branch L_wo_body
.section .rodata,"a"
.p2align 6
.amdhsa_kernel interleave_layers__sliding_local_dilated__dense_activation_gelu__prompt_kernel
  .amdhsa_next_free_vgpr 256
  .amdhsa_next_free_sgpr 102
  .amdhsa_accum_offset 256
  .amdhsa_group_segment_fixed_size 0
  .amdhsa_kernarg_size 88
  .amdhsa_user_sgpr_count 2
  .amdhsa_user_sgpr_kernarg_segment_ptr 1
  .amdhsa_system_sgpr_workgroup_id_x 1
  .amdhsa_float_denorm_mode_32 3
  .amdhsa_float_denorm_mode_16_64 3
.end_amdhsa_kernel
.text
L_attn_c1:
L_wo_c0:
L_wo_body:
  s_cmp_ge_u32 s2, 256
  s_cbranch_scc1 L_wo_end
  v_lshrrev_b32 v2, 6, v0
  v_and_b32 v1, 63, v0
  v_readfirstlane_b32 s70, v2
  s_and_b32 s3, s2, 7
  s_lshr_b32 s99, s2, 3
  s_and_b32 s5, s3, 3
  s_lshl_b32 s5, s5, 2
  s_and_b32 s6, s99, 3
  s_add_u32 s68, s5, s6
  s_lshr_b32 s5, s3, 2
  s_lshr_b32 s78, s99, 2
  s_lshl1_add_u32 s69, s78, s5
  s_add_u32 s3, s68, s78
  s_lshl_b32 s3, s3, 3
  s_lshl_b32 s85, 0xffff02, s3
  s_sub_u32 s3, 0, s3
  s_lshr_b32 s3, 0xffff02, s3
  s_or_b32 s85, s85, s3
  s_cmp_lt_u32 s70, 4
  s_cbranch_scc1 L_wo_compute
L_wo_loader:
  s_add_u32 s3, s96, s70
  s_cmp_lg_u32 s3, 4
  s_cbranch_scc1 L_wo_chk0
  s_load_dwordx2 s[64:65], s[0:1], 72
  s_waitcnt lgkmcnt(0)
  s_and_b32 s65, s65, 0xffff
  s_mov_b32 s66, 256
  s_mov_b32 s67, 0x00020000
  v_lshlrev_b32 v17, 2, v1
  buffer_load_dword v12, v17, s[64:67], 0 offen sc1
L_wo_chk0:
  s_cmp_lg_u32 s96, 0
  s_cbranch_scc1 L_wo_nofirst
  s_waitcnt vmcnt(1)
  s_mov_b32 s7, 0xffff0000
  v_lshlrev_b32 v32, 16, v64
  v_and_b32 v33, s7, v64
  v_lshlrev_b32 v34, 16, v65
  v_and_b32 v35, s7, v65
  v_lshlrev_b32 v36, 16, v66
  v_and_b32 v37, s7, v66
  v_lshlrev_b32 v38, 16, v67
  v_and_b32 v39, s7, v67
  v_lshlrev_b32 v40, 16, v68
  v_and_b32 v41, s7, v68
  v_pk_add_f32 v[32:33], v[32:33], v[40:41]
  v_lshlrev_b32 v40, 16, v69
  v_and_b32 v41, s7, v69
  v_pk_add_f32 v[34:35], v[34:35], v[40:41]
  v_lshlrev_b32 v40, 16, v70
  v_and_b32 v41, s7, v70
  v_pk_add_f32 v[36:37], v[36:37], v[40:41]
  v_lshlrev_b32 v40, 16, v71
  v_and_b32 v41, s7, v71
  v_pk_add_f32 v[38:39], v[38:39], v[40:41]
  v_lshlrev_b32 v40, 16, v72
  v_and_b32 v41, s7, v72
  v_pk_add_f32 v[32:33], v[32:33], v[40:41]
  v_lshlrev_b32 v40, 16, v73
  v_and_b32 v41, s7, v73
  v_pk_add_f32 v[34:35], v[34:35], v[40:41]
  v_lshlrev_b32 v40, 16, v74
  v_and_b32 v41, s7, v74
  v_pk_add_f32 v[36:37], v[36:37], v[40:41]
  v_lshlrev_b32 v40, 16, v75
  v_and_b32 v41, s7, v75
  v_pk_add_f32 v[38:39], v[38:39], v[40:41]
  v_lshlrev_b32 v40, 16, v76
  v_and_b32 v41, s7, v76
  v_pk_add_f32 v[32:33], v[32:33], v[40:41]
  v_lshlrev_b32 v40, 16, v77
  v_and_b32 v41, s7, v77
  v_pk_add_f32 v[34:35], v[34:35], v[40:41]
  v_lshlrev_b32 v40, 16, v78
  v_and_b32 v41, s7, v78
  v_pk_add_f32 v[36:37], v[36:37], v[40:41]
  v_lshlrev_b32 v40, 16, v79
  v_and_b32 v41, s7, v79
  v_pk_add_f32 v[38:39], v[38:39], v[40:41]
  v_lshlrev_b32 v40, 16, v80
  v_and_b32 v41, s7, v80
  v_pk_add_f32 v[32:33], v[32:33], v[40:41]
  v_lshlrev_b32 v40, 16, v81
  v_and_b32 v41, s7, v81
  v_pk_add_f32 v[34:35], v[34:35], v[40:41]
  v_lshlrev_b32 v40, 16, v82
  v_and_b32 v41, s7, v82
  v_pk_add_f32 v[36:37], v[36:37], v[40:41]
  v_lshlrev_b32 v40, 16, v83
  v_and_b32 v41, s7, v83
  v_pk_add_f32 v[38:39], v[38:39], v[40:41]
  v_lshlrev_b32 v40, 16, v84
  v_and_b32 v41, s7, v84
  v_pk_add_f32 v[32:33], v[32:33], v[40:41]
  v_lshlrev_b32 v40, 16, v85
  v_and_b32 v41, s7, v85
  v_pk_add_f32 v[34:35], v[34:35], v[40:41]
  v_lshlrev_b32 v40, 16, v86
  v_and_b32 v41, s7, v86
  v_pk_add_f32 v[36:37], v[36:37], v[40:41]
  v_lshlrev_b32 v40, 16, v87
  v_and_b32 v41, s7, v87
  v_pk_add_f32 v[38:39], v[38:39], v[40:41]
  v_lshlrev_b32 v40, 16, v88
  v_and_b32 v41, s7, v88
  v_pk_add_f32 v[32:33], v[32:33], v[40:41]
  v_lshlrev_b32 v40, 16, v89
  v_and_b32 v41, s7, v89
  v_pk_add_f32 v[34:35], v[34:35], v[40:41]
  v_lshlrev_b32 v40, 16, v90
  v_and_b32 v41, s7, v90
  v_pk_add_f32 v[36:37], v[36:37], v[40:41]
  v_lshlrev_b32 v40, 16, v91
  v_and_b32 v41, s7, v91
  v_pk_add_f32 v[38:39], v[38:39], v[40:41]
  v_lshlrev_b32 v40, 16, v92
  v_and_b32 v41, s7, v92
  v_pk_add_f32 v[32:33], v[32:33], v[40:41]
  v_lshlrev_b32 v40, 16, v93
  v_and_b32 v41, s7, v93
  v_pk_add_f32 v[34:35], v[34:35], v[40:41]
  v_lshlrev_b32 v40, 16, v94
  v_and_b32 v41, s7, v94
  v_pk_add_f32 v[36:37], v[36:37], v[40:41]
  v_lshlrev_b32 v40, 16, v95
  v_and_b32 v41, s7, v95
  v_pk_add_f32 v[38:39], v[38:39], v[40:41]
  s_add_u32 s52, s22, 24641536
  s_addc_u32 s53, s23, 0
  s_and_b32 s53, s53, 0xffff
  s_mov_b32 s54, 262144
  s_mov_b32 s55, 0x00020000
  v_permlane32_swap_b32 v32, v36
  v_permlane32_swap_b32 v33, v37
  v_permlane32_swap_b32 v34, v38
  v_permlane32_swap_b32 v35, v39
  v_add_f32 v32, v32, v36
  v_add_f32 v33, v33, v37
  v_add_f32 v34, v34, v38
  v_add_f32 v35, v35, v39
  v_and_b32 v2, 7, v1
  v_lshlrev_b32 v2, 5, v2
  v_permlane16_swap_b32 v32, v34
  v_permlane16_swap_b32 v33, v35
  v_add_f32 v32, v32, v34
  v_add_f32 v33, v33, v35
  v_lshrrev_b32 v3, 4, v1
  v_lshl_add_u32 v2, v3, 3, v2
  v_add_f32_dpp v32, v32, v32 row_ror:8 row_mask:0xf bank_mask:0xf
  v_add_f32_dpp v33, v33, v33 row_ror:8 row_mask:0xf bank_mask:0xf
  buffer_store_dwordx2 v[32:33], v2, s[52:55], s94 offen sc1
L_wo_nofirst:
  v_and_b32 v2, 3, v1
  v_lshlrev_b32 v2, 3, v2
  v_bfe_i32 v16, s85, v2, 8
  s_and_b32 s3, s68, 3
  s_mul_i32 s4, s3, 4
  v_add3_u32 v3, v16, v1, s4
  v_and_b32 v3, 15, v3
  v_lshlrev_b32 v16, 17, v3
  s_add_u32 s9, s70, s68
  s_and_b32 s9, s9, 3
  s_lshl_b32 s77, s9, 11
  v_and_b32 v10, 7, v1
  v_lshrrev_b32 v3, 3, v1
  s_lshl_b32 s10, s9, 4
  v_add_u32 v3, s10, v3
  v_mul_u32_u24 v3, 2048, v3
  v_lshrrev_b32 v2, 3, v1
  v_and_b32 v2, 6, v2
  v_xor_b32 v2, v2, v10
  s_lshl_b32 s10, s69, 7
  v_add_u32 v3, s10, v3
  v_lshl_add_u32 v8, v2, 4, v3
  v_add_u32 v3, 16384, v3
  v_lshl_add_u32 v9, v2, 4, v3
  s_mov_b32 s40, s20
  s_and_b32 s41, s21, 0xffff
  s_mov_b32 s42, 2097152
  s_mov_b32 s43, 0x00020000
  v_readlane_b32 s74, v16, 0
  s_add_u32 m0, s77, 28672
  s_add_u32 s4, s74, 0
  buffer_load_dwordx4 v8, s[40:43], s4 offen lds
  s_add_u32 m0, s77, 29696
  s_nop 0
  buffer_load_dwordx4 v9, s[40:43], s4 offen lds
  v_readlane_b32 s74, v16, 1
  s_add_u32 m0, s77, 36864
  s_add_u32 s4, s74, 0
  buffer_load_dwordx4 v8, s[40:43], s4 offen lds
  s_add_u32 m0, s77, 37888
  s_nop 0
  buffer_load_dwordx4 v9, s[40:43], s4 offen lds
  v_readlane_b32 s74, v16, 2
  s_add_u32 m0, s77, 45056
  s_add_u32 s4, s74, 0
  buffer_load_dwordx4 v8, s[40:43], s4 offen lds
  s_add_u32 m0, s77, 46080
  s_nop 0
  buffer_load_dwordx4 v9, s[40:43], s4 offen lds
  v_readlane_b32 s74, v16, 3
  s_add_u32 m0, s77, 53248
  s_add_u32 s4, s74, 0
  buffer_load_dwordx4 v8, s[40:43], s4 offen lds
  s_add_u32 m0, s77, 54272
  s_nop 0
  buffer_load_dwordx4 v9, s[40:43], s4 offen lds
  v_readlane_b32 s74, v16, 4
  s_add_u32 m0, s77, 61440
  s_add_u32 s4, s74, 0
  buffer_load_dwordx4 v8, s[40:43], s4 offen lds
  s_add_u32 m0, s77, 62464
  s_nop 0
  buffer_load_dwordx4 v9, s[40:43], s4 offen lds
  v_readlane_b32 s74, v16, 5
  s_add_u32 m0, s77, 69632
  s_add_u32 s4, s74, 0
  buffer_load_dwordx4 v8, s[40:43], s4 offen lds
  s_add_u32 m0, s77, 70656
  s_nop 0
  buffer_load_dwordx4 v9, s[40:43], s4 offen lds
  s_waitcnt vmcnt(12)
  s_add_u32 s3, s96, s70
  s_cmp_lg_u32 s3, 4
  s_cbranch_scc1 L_wo_chk1
  v_cmp_ne_u32 vcc, 0x01010101, v12
  s_cbranch_vccz L_wo_chk1
  s_load_dwordx2 s[64:65], s[0:1], 72
  s_waitcnt lgkmcnt(0)
  s_and_b32 s65, s65, 0xffff
  s_mov_b32 s66, 256
  s_mov_b32 s67, 0x00020000
  v_lshlrev_b32 v17, 2, v1
  s_mov_b32 s79, 0x100000
L_wo_chkl:
  buffer_load_dword v12, v17, s[64:67], 0 offen sc1
  s_sub_u32 s79, s79, 1
  s_cbranch_scc1 L_wo_chk1
  s_waitcnt vmcnt(0)
  v_cmp_ne_u32 vcc, 0x01010101, v12
  s_cbranch_vccnz L_wo_chkl
L_wo_chk1:
  s_add_u32 s44, s22, 41943040
  s_addc_u32 s45, s23, 0
  s_and_b32 s45, s45, 0xffff
  s_mov_b32 s46, 524288
  s_mov_b32 s47, 0x00020000
  s_lshl4_add_u32 s3, s97, s68
  s_and_b32 s4, s69, 15
  s_lshl4_add_u32 s3, s3, s4
  s_lshl_b32 s3, s3, 7
  s_sub_u32 s3, s3, 32768
  v_lshlrev_b32 v11, 7, v1
  v_and_b32 v2, 15, v1
  v_lshlrev_b32 v2, 2, v2
  v_mov_b32 v3, 1
  s_mov_b32 s79, 0x100000
  s_cmp_lg_u32 s70, 4
  s_barrier
  s_cbranch_scc1 L_wo_nofl
  s_mov_b32 exec_lo, 0xffff
  s_mov_b32 exec_hi, 0
  buffer_store_dword v3, v11, s[44:47], s87 offen sc1
  s_mov_b64 exec, -1
L_wo_nofl:
  s_mov_b32 s5, s3
  v_readlane_b32 s74, v16, 6
  s_add_u32 m0, s77, 77824
  s_add_u32 s4, s74, 0
  buffer_load_dwordx4 v8, s[40:43], s4 offen lds
  s_add_u32 m0, s77, 78848
  s_nop 0
  buffer_load_dwordx4 v9, s[40:43], s4 offen lds
  v_readlane_b32 s74, v16, 7
  s_add_u32 m0, s77, 86016
  s_add_u32 s4, s74, 0
  buffer_load_dwordx4 v8, s[40:43], s4 offen lds
  s_add_u32 m0, s77, 87040
  s_nop 0
  buffer_load_dwordx4 v9, s[40:43], s4 offen lds
  v_readlane_b32 s74, v16, 8
  s_add_u32 m0, s77, 94208
  s_add_u32 s4, s74, 0
  buffer_load_dwordx4 v8, s[40:43], s4 offen lds
  s_add_u32 m0, s77, 95232
  s_nop 0
  buffer_load_dwordx4 v9, s[40:43], s4 offen lds
  v_readlane_b32 s74, v16, 9
  s_add_u32 m0, s77, 102400
  s_add_u32 s4, s74, 0
  buffer_load_dwordx4 v8, s[40:43], s4 offen lds
  s_add_u32 m0, s77, 103424
  s_nop 0
  buffer_load_dwordx4 v9, s[40:43], s4 offen lds
  v_readlane_b32 s74, v16, 10
  s_add_u32 m0, s77, 110592
  s_add_u32 s4, s74, 0
  buffer_load_dwordx4 v8, s[40:43], s4 offen lds
  s_add_u32 m0, s77, 111616
  s_nop 0
  buffer_load_dwordx4 v9, s[40:43], s4 offen lds
  v_readlane_b32 s74, v16, 11
  s_add_u32 m0, s77, 118784
  s_add_u32 s4, s74, 0
  buffer_load_dwordx4 v8, s[40:43], s4 offen lds
  s_add_u32 m0, s77, 119808
  s_nop 0
  buffer_load_dwordx4 v9, s[40:43], s4 offen lds
  v_readlane_b32 s74, v16, 12
  s_add_u32 m0, s77, 131072
  s_add_u32 s4, s74, 0
  buffer_load_dwordx4 v8, s[40:43], s4 offen lds
  s_add_u32 m0, s77, 132096
  s_nop 0
  buffer_load_dwordx4 v9, s[40:43], s4 offen lds
  v_readlane_b32 s74, v16, 13
  s_add_u32 m0, s77, 139264
  s_add_u32 s4, s74, 0
  buffer_load_dwordx4 v8, s[40:43], s4 offen lds
  s_add_u32 m0, s77, 140288
  s_nop 0
  buffer_load_dwordx4 v9, s[40:43], s4 offen lds
  v_readlane_b32 s74, v16, 14
  s_add_u32 m0, s77, 147456
  s_add_u32 s4, s74, 0
  buffer_load_dwordx4 v8, s[40:43], s4 offen lds
  s_add_u32 m0, s77, 148480
  s_nop 0
  buffer_load_dwordx4 v9, s[40:43], s4 offen lds
  v_readlane_b32 s74, v16, 15
  s_add_u32 m0, s77, 155648
  s_add_u32 s4, s74, 0
  buffer_load_dwordx4 v8, s[40:43], s4 offen lds
  s_add_u32 m0, s77, 156672
  s_nop 0
  buffer_load_dwordx4 v9, s[40:43], s4 offen lds
  s_mov_b32 s3, s5
  s_cmp_lg_u32 s70, 4
  s_cbranch_scc1 L_wo_dep
L_wo_poll:
  buffer_load_dword v3, v2, s[44:47], s3 offen sc1
  s_sub_u32 s79, s79, 1
  s_cbranch_scc1 L_wo_dep
  s_waitcnt vmcnt(0)
  v_cmp_ne_u32 vcc, 1, v3
  s_cbranch_vccnz L_wo_poll
L_wo_dep:
  s_waitcnt vmcnt(20) lgkmcnt(0)
  s_barrier
  s_waitcnt vmcnt(2)
  s_barrier
  s_lshl_b32 s87, s97, 15
  s_lshl_b32 s4, s68, 11
  s_add_u32 s87, s87, s4
  s_lshl_b32 s4, s69, 2
  s_add_u32 s87, s87, s4
  s_add_u32 s97, s97, 1
  s_branch L_w1_body
L_wo_end:
  s_endpgm
L_wo_compute:
  v_and_b32 v2, 3, v1
  v_lshlrev_b32 v2, 3, v2
  v_bfe_i32 v15, s85, v2, 8
  s_and_b32 s3, s68, 3
  s_mul_i32 s4, s3, 4
  v_add3_u32 v3, v15, v1, s4
  v_and_b32 v3, 15, v3
  v_lshlrev_b32 v15, 12, v3
  v_and_b32 v3, 15, v1
  v_lshrrev_b32 v2, 4, v1
  s_lshl_b32 s8, s68, 7
  s_lshl_b32 s9, s70, 5
  s_add_u32 s8, s8, s9
  s_mul_i32 s9, s8, 7168
  v_add_u32 v13, s8, v3
  s_lshl_b32 s10, s69, 7
  v_lshl_add_u32 v14, v2, 3, s10
  v_and_b32 v16, 1, v2
  v_lshrrev_b32 v17, 1, v2
  v_lshlrev_b32 v16, 4, v1
  s_add_u32 s9, s8, s69
  s_lshl_b32 s9, s9, 11
  v_add_u32 v12, s9, v16
  s_lshl_b32 s9, s70, 12
  v_add_u32 v19, s9, v16
  v_lshl_add_u32 v18, v17, 4, v13
  v_lshlrev_b32 v18, 3, v18
  v_and_b32 v16, 1, v2
  v_lshl_add_u32 v18, v16, 2, v18
  s_lshl_b32 s10, s69, 14
  v_add_u32 v18, s10, v18
  v_lshrrev_b32 v6, 2, v1
  v_lshlrev_b32 v6, 7, v6
  v_and_b32 v17, 3, v1
  v_lshl_add_u32 v6, v17, 3, v6
  v_bfe_u32 v17, v1, 3, 2
  v_lshl_add_u32 v6, v17, 5, v6
  v_xor_b32 v7, 32, v6
  v_xor_b32 v8, 64, v6
  v_xor_b32 v9, 96, v6
  s_mov_b32 s11, 0xffff0000
  s_add_u32 s36, s34, 8439808
  s_addc_u32 s37, s35, 0
  s_and_b32 s37, s37, 0xffff
  s_mov_b32 s38, 4194304
  s_mov_b32 s39, 0x00020000
  s_add_u32 s44, s34, 4194304
  s_addc_u32 s45, s35, 0
  s_and_b32 s45, s45, 0xffff
  s_mov_b32 s46, 4194304
  s_mov_b32 s47, 0x00020000
  s_add_u32 s56, s34, 24117248
  s_addc_u32 s57, s35, 0
  s_and_b32 s57, s57, 0xffff
  s_mov_b32 s58, 262144
  s_mov_b32 s59, 0x00020000
  s_mul_i32 s9, s8, 7168
  s_add_u32 s36, s36, s9
  s_addc_u32 s37, s37, 0x100000
  s_add_u32 s64, s36, 114688
  s_addc_u32 s65, s37, 0
  s_mov_b32 s38, 63488
  s_mov_b32 s39, 0x00800000
  s_mov_b32 s66, 63488
  s_mov_b32 s67, 0x00800000
  s_cmp_lg_u32 s96, 0
  s_cbranch_scc1 L_pfc2_skip
  s_getpc_b64 s[4:5]
L_pfc2:
  s_lshl_b32 s3, s99, 2
  s_add_u32 s3, s3, s70
  s_mul_i32 s3, s3, 128
  s_min_u32 s3, s3, L_w1_c1-L_w1_c0-128
  s_add_i32 s3, s3, L_w1_c0-L_pfc2
  s_ashr_i32 s6, s3, 31
  s_add_u32 s4, s4, s3
  s_addc_u32 s5, s5, s6
  s_load_dword s40, s[4:5], 0
  s_load_dword s40, s[4:5], 64
L_pfc2_skip:
  v_add_u32 v26, 155648, v6
  v_add_u32 v27, 155648, v7
  v_add_u32 v28, 155648, v8
  v_add_u32 v29, 155648, v9
  v_add_u32 v20, 94208, v6
  v_add_u32 v21, 94208, v7
  v_add_u32 v22, 94208, v8
  v_add_u32 v23, 94208, v9
  v_add_u32 v6, 28672, v6
  v_add_u32 v7, 28672, v7
  v_add_u32 v8, 28672, v8
  v_add_u32 v9, 28672, v9
  v_readlane_b32 s48, v15, 0
  v_readlane_b32 s49, v15, 1
  v_readlane_b32 s50, v15, 2
  s_cmp_lg_u32 s96, 0
  s_cbranch_scc1 L_wo_nosw
  v_permlane16_swap_b32 v240, v242
  v_permlane16_swap_b32 v241, v243
  v_permlane16_swap_b32 v244, v246
  v_permlane16_swap_b32 v245, v247
  v_permlane16_swap_b32 v248, v250
  v_permlane16_swap_b32 v249, v251
  v_permlane16_swap_b32 v252, v254
  v_permlane16_swap_b32 v253, v255
L_wo_nosw:
  s_waitcnt lgkmcnt(0)
  s_barrier
  buffer_load_dwordx4 v[32:35], off, s[36:39], s48 offset:0
  buffer_load_dwordx4 v[36:39], off, s[64:67], s48 offset:0
  buffer_load_dwordx4 v[40:43], off, s[36:39], s48 offset:1024
  buffer_load_dwordx4 v[44:47], off, s[64:67], s48 offset:1024
  buffer_load_dwordx4 v[48:51], off, s[36:39], s49 offset:0
  buffer_load_dwordx4 v[52:55], off, s[64:67], s49 offset:0
  buffer_load_dwordx4 v[56:59], off, s[36:39], s49 offset:1024
  buffer_load_dwordx4 v[60:63], off, s[64:67], s49 offset:1024
  buffer_load_dwordx4 v[64:67], off, s[36:39], s50 offset:0
  buffer_load_dwordx4 v[68:71], off, s[64:67], s50 offset:0
  buffer_load_dwordx4 v[72:75], off, s[36:39], s50 offset:1024
  buffer_load_dwordx4 v[76:79], off, s[64:67], s50 offset:1024
  ds_read_b64_tr_b16 v[160:161], v6 offset:0
  ds_read_b64_tr_b16 v[162:163], v6 offset:2048
  ds_read_b64_tr_b16 v[164:165], v7 offset:0
  ds_read_b64_tr_b16 v[166:167], v7 offset:2048
  ds_read_b64_tr_b16 v[168:169], v8 offset:0
  ds_read_b64_tr_b16 v[170:171], v8 offset:2048
  ds_read_b64_tr_b16 v[172:173], v9 offset:0
  ds_read_b64_tr_b16 v[174:175], v9 offset:2048
  ds_read_b64_tr_b16 v[176:177], v6 offset:4096
  ds_read_b64_tr_b16 v[178:179], v6 offset:6144
  ds_read_b64_tr_b16 v[180:181], v7 offset:4096
  ds_read_b64_tr_b16 v[182:183], v7 offset:6144
  ds_read_b64_tr_b16 v[184:185], v8 offset:4096
  ds_read_b64_tr_b16 v[186:187], v8 offset:6144
  ds_read_b64_tr_b16 v[188:189], v9 offset:4096
  ds_read_b64_tr_b16 v[190:191], v9 offset:6144
  v_lshlrev_b32 v96, 16, v240
  v_and_b32 v97, s11, v240
  v_lshlrev_b32 v98, 16, v241
  v_and_b32 v99, s11, v241
  v_lshlrev_b32 v100, 16, v248
  v_and_b32 v101, s11, v248
  v_lshlrev_b32 v102, 16, v249
  v_and_b32 v103, s11, v249
  v_lshlrev_b32 v104, 16, v242
  v_and_b32 v105, s11, v242
  v_lshlrev_b32 v106, 16, v243
  v_and_b32 v107, s11, v243
  v_lshlrev_b32 v108, 16, v250
  v_and_b32 v109, s11, v250
  v_lshlrev_b32 v110, 16, v251
  v_and_b32 v111, s11, v251
  v_lshlrev_b32 v112, 16, v244
  v_and_b32 v113, s11, v244
  v_lshlrev_b32 v114, 16, v245
  v_and_b32 v115, s11, v245
  v_lshlrev_b32 v116, 16, v252
  v_and_b32 v117, s11, v252
  v_lshlrev_b32 v118, 16, v253
  v_and_b32 v119, s11, v253
  v_lshlrev_b32 v120, 16, v246
  v_and_b32 v121, s11, v246
  v_lshlrev_b32 v122, 16, v247
  v_and_b32 v123, s11, v247
  v_lshlrev_b32 v124, 16, v254
  v_and_b32 v125, s11, v254
  v_lshlrev_b32 v126, 16, v255
  v_and_b32 v127, s11, v255
  s_waitcnt vmcnt(10) lgkmcnt(8)
  v_mfma_f32_16x16x32_bf16 v[96:99], v[160:163], v[32:35], v[96:99]
  ds_read_b64_tr_b16 v[192:193], v6 offset:8192
  v_readlane_b32 s51, v15, 3
  v_mfma_f32_16x16x32_bf16 v[100:103], v[160:163], v[36:39], v[100:103]
  ds_read_b64_tr_b16 v[194:195], v6 offset:10240
  v_mfma_f32_16x16x32_bf16 v[108:111], v[164:167], v[36:39], v[108:111]
  ds_read_b64_tr_b16 v[196:197], v7 offset:8192
  v_mfma_f32_16x16x32_bf16 v[104:107], v[164:167], v[32:35], v[104:107]
  buffer_load_dwordx4 v[80:83], off, s[36:39], s51 offset:0
  v_mfma_f32_16x16x32_bf16 v[112:115], v[168:171], v[32:35], v[112:115]
  ds_read_b64_tr_b16 v[198:199], v7 offset:10240
  ds_read_b64_tr_b16 v[200:201], v8 offset:8192
  v_mfma_f32_16x16x32_bf16 v[116:119], v[168:171], v[36:39], v[116:119]
  ds_read_b64_tr_b16 v[202:203], v8 offset:10240
  ds_read_b64_tr_b16 v[204:205], v9 offset:8192
  v_mfma_f32_16x16x32_bf16 v[124:127], v[172:175], v[36:39], v[124:127]
  buffer_load_dwordx4 v[84:87], off, s[64:67], s51 offset:0
  v_mfma_f32_16x16x32_bf16 v[120:123], v[172:175], v[32:35], v[120:123]
  ds_read_b64_tr_b16 v[206:207], v9 offset:10240
  s_waitcnt vmcnt(10) lgkmcnt(8)
  v_mfma_f32_16x16x32_bf16 v[96:99], v[176:179], v[40:43], v[96:99]
  ds_read_b64_tr_b16 v[208:209], v6 offset:12288
  v_mfma_f32_16x16x32_bf16 v[100:103], v[176:179], v[44:47], v[100:103]
  buffer_load_dwordx4 v[88:91], off, s[36:39], s51 offset:1024
  v_mfma_f32_16x16x32_bf16 v[108:111], v[180:183], v[44:47], v[108:111]
  ds_read_b64_tr_b16 v[210:211], v6 offset:14336
  ds_read_b64_tr_b16 v[212:213], v7 offset:12288
  v_mfma_f32_16x16x32_bf16 v[104:107], v[180:183], v[40:43], v[104:107]
  ds_read_b64_tr_b16 v[214:215], v7 offset:14336
  ds_read_b64_tr_b16 v[216:217], v8 offset:12288
  v_mfma_f32_16x16x32_bf16 v[112:115], v[184:187], v[40:43], v[112:115]
  buffer_load_dwordx4 v[92:95], off, s[64:67], s51 offset:1024
  v_mfma_f32_16x16x32_bf16 v[116:119], v[184:187], v[44:47], v[116:119]
  ds_read_b64_tr_b16 v[218:219], v8 offset:14336
  v_readlane_b32 s48, v15, 4
  v_mfma_f32_16x16x32_bf16 v[124:127], v[188:191], v[44:47], v[124:127]
  ds_read_b64_tr_b16 v[220:221], v9 offset:12288
  v_mfma_f32_16x16x32_bf16 v[120:123], v[188:191], v[40:43], v[120:123]
  ds_read_b64_tr_b16 v[222:223], v9 offset:14336
  s_waitcnt vmcnt(10) lgkmcnt(8)
  v_mfma_f32_16x16x32_bf16 v[96:99], v[192:195], v[48:51], v[96:99]
  buffer_load_dwordx4 v[32:35], off, s[36:39], s48 offset:0
  v_mfma_f32_16x16x32_bf16 v[100:103], v[192:195], v[52:55], v[100:103]
  ds_read_b64_tr_b16 v[160:161], v6 offset:16384
  ds_read_b64_tr_b16 v[162:163], v6 offset:18432
  v_mfma_f32_16x16x32_bf16 v[108:111], v[196:199], v[52:55], v[108:111]
  ds_read_b64_tr_b16 v[164:165], v7 offset:16384
  v_mfma_f32_16x16x32_bf16 v[104:107], v[196:199], v[48:51], v[104:107]
  buffer_load_dwordx4 v[36:39], off, s[64:67], s48 offset:0
  v_mfma_f32_16x16x32_bf16 v[112:115], v[200:203], v[48:51], v[112:115]
  ds_read_b64_tr_b16 v[166:167], v7 offset:18432
  ds_read_b64_tr_b16 v[168:169], v8 offset:16384
  v_mfma_f32_16x16x32_bf16 v[116:119], v[200:203], v[52:55], v[116:119]
  ds_read_b64_tr_b16 v[170:171], v8 offset:18432
  ds_read_b64_tr_b16 v[172:173], v9 offset:16384
  v_mfma_f32_16x16x32_bf16 v[124:127], v[204:207], v[52:55], v[124:127]
  buffer_load_dwordx4 v[40:43], off, s[36:39], s48 offset:1024
  v_mfma_f32_16x16x32_bf16 v[120:123], v[204:207], v[48:51], v[120:123]
  ds_read_b64_tr_b16 v[174:175], v9 offset:18432
  s_waitcnt vmcnt(11) lgkmcnt(8)
  v_mfma_f32_16x16x32_bf16 v[96:99], v[208:211], v[56:59], v[96:99]
  ds_read_b64_tr_b16 v[176:177], v6 offset:20480
  v_mfma_f32_16x16x32_bf16 v[100:103], v[208:211], v[60:63], v[100:103]
  buffer_load_dwordx4 v[44:47], off, s[64:67], s48 offset:1024
  v_mfma_f32_16x16x32_bf16 v[108:111], v[212:215], v[60:63], v[108:111]
  ds_read_b64_tr_b16 v[178:179], v6 offset:22528
  ds_read_b64_tr_b16 v[180:181], v7 offset:20480
  v_mfma_f32_16x16x32_bf16 v[104:107], v[212:215], v[56:59], v[104:107]
  ds_read_b64_tr_b16 v[182:183], v7 offset:22528
  v_mfma_f32_16x16x32_bf16 v[112:115], v[216:219], v[56:59], v[112:115]
  ds_read_b64_tr_b16 v[184:185], v8 offset:20480
  v_mfma_f32_16x16x32_bf16 v[116:119], v[216:219], v[60:63], v[116:119]
  ds_read_b64_tr_b16 v[186:187], v8 offset:22528
  v_readlane_b32 s49, v15, 5
  v_mfma_f32_16x16x32_bf16 v[124:127], v[220:223], v[60:63], v[124:127]
  ds_read_b64_tr_b16 v[188:189], v9 offset:20480
  v_mfma_f32_16x16x32_bf16 v[120:123], v[220:223], v[56:59], v[120:123]
  ds_read_b64_tr_b16 v[190:191], v9 offset:22528
  s_waitcnt vmcnt(10) lgkmcnt(8)
  v_mfma_f32_16x16x32_bf16 v[96:99], v[160:163], v[64:67], v[96:99]
  buffer_load_dwordx4 v[48:51], off, s[36:39], s49 offset:0
  v_mfma_f32_16x16x32_bf16 v[100:103], v[160:163], v[68:71], v[100:103]
  ds_read_b64_tr_b16 v[192:193], v6 offset:24576
  ds_read_b64_tr_b16 v[194:195], v6 offset:26624
  v_mfma_f32_16x16x32_bf16 v[108:111], v[164:167], v[68:71], v[108:111]
  ds_read_b64_tr_b16 v[196:197], v7 offset:24576
  v_mfma_f32_16x16x32_bf16 v[104:107], v[164:167], v[64:67], v[104:107]
  buffer_load_dwordx4 v[52:55], off, s[64:67], s49 offset:0
  v_mfma_f32_16x16x32_bf16 v[112:115], v[168:171], v[64:67], v[112:115]
  ds_read_b64_tr_b16 v[198:199], v7 offset:26624
  ds_read_b64_tr_b16 v[200:201], v8 offset:24576
  v_mfma_f32_16x16x32_bf16 v[116:119], v[168:171], v[68:71], v[116:119]
  ds_read_b64_tr_b16 v[202:203], v8 offset:26624
  ds_read_b64_tr_b16 v[204:205], v9 offset:24576
  v_mfma_f32_16x16x32_bf16 v[124:127], v[172:175], v[68:71], v[124:127]
  buffer_load_dwordx4 v[56:59], off, s[36:39], s49 offset:1024
  v_mfma_f32_16x16x32_bf16 v[120:123], v[172:175], v[64:67], v[120:123]
  ds_read_b64_tr_b16 v[206:207], v9 offset:26624
  s_waitcnt vmcnt(11) lgkmcnt(8)
  v_mfma_f32_16x16x32_bf16 v[96:99], v[176:179], v[72:75], v[96:99]
  ds_read_b64_tr_b16 v[208:209], v6 offset:28672
  v_mfma_f32_16x16x32_bf16 v[100:103], v[176:179], v[76:79], v[100:103]
  buffer_load_dwordx4 v[60:63], off, s[64:67], s49 offset:1024
  v_mfma_f32_16x16x32_bf16 v[108:111], v[180:183], v[76:79], v[108:111]
  ds_read_b64_tr_b16 v[210:211], v6 offset:30720
  ds_read_b64_tr_b16 v[212:213], v7 offset:28672
  v_mfma_f32_16x16x32_bf16 v[104:107], v[180:183], v[72:75], v[104:107]
  ds_read_b64_tr_b16 v[214:215], v7 offset:30720
  v_mfma_f32_16x16x32_bf16 v[112:115], v[184:187], v[72:75], v[112:115]
  ds_read_b64_tr_b16 v[216:217], v8 offset:28672
  v_mfma_f32_16x16x32_bf16 v[116:119], v[184:187], v[76:79], v[116:119]
  ds_read_b64_tr_b16 v[218:219], v8 offset:30720
  v_readlane_b32 s50, v15, 6
  v_mfma_f32_16x16x32_bf16 v[124:127], v[188:191], v[76:79], v[124:127]
  ds_read_b64_tr_b16 v[220:221], v9 offset:28672
  v_mfma_f32_16x16x32_bf16 v[120:123], v[188:191], v[72:75], v[120:123]
  ds_read_b64_tr_b16 v[222:223], v9 offset:30720
  s_waitcnt vmcnt(10) lgkmcnt(8)
  v_mfma_f32_16x16x32_bf16 v[96:99], v[192:195], v[80:83], v[96:99]
  buffer_load_dwordx4 v[64:67], off, s[36:39], s50 offset:0
  v_mfma_f32_16x16x32_bf16 v[100:103], v[192:195], v[84:87], v[100:103]
  ds_read_b64_tr_b16 v[160:161], v6 offset:32768
  ds_read_b64_tr_b16 v[162:163], v6 offset:34816
  v_mfma_f32_16x16x32_bf16 v[108:111], v[196:199], v[84:87], v[108:111]
  ds_read_b64_tr_b16 v[164:165], v7 offset:32768
  v_mfma_f32_16x16x32_bf16 v[104:107], v[196:199], v[80:83], v[104:107]
  buffer_load_dwordx4 v[68:71], off, s[64:67], s50 offset:0
  v_mfma_f32_16x16x32_bf16 v[112:115], v[200:203], v[80:83], v[112:115]
  ds_read_b64_tr_b16 v[166:167], v7 offset:34816
  ds_read_b64_tr_b16 v[168:169], v8 offset:32768
  v_mfma_f32_16x16x32_bf16 v[116:119], v[200:203], v[84:87], v[116:119]
  ds_read_b64_tr_b16 v[170:171], v8 offset:34816
  ds_read_b64_tr_b16 v[172:173], v9 offset:32768
  v_mfma_f32_16x16x32_bf16 v[124:127], v[204:207], v[84:87], v[124:127]
  buffer_load_dwordx4 v[72:75], off, s[36:39], s50 offset:1024
  v_mfma_f32_16x16x32_bf16 v[120:123], v[204:207], v[80:83], v[120:123]
  ds_read_b64_tr_b16 v[174:175], v9 offset:34816
  s_waitcnt vmcnt(11) lgkmcnt(8)
  v_mfma_f32_16x16x32_bf16 v[96:99], v[208:211], v[88:91], v[96:99]
  ds_read_b64_tr_b16 v[176:177], v6 offset:36864
  v_mfma_f32_16x16x32_bf16 v[100:103], v[208:211], v[92:95], v[100:103]
  buffer_load_dwordx4 v[76:79], off, s[64:67], s50 offset:1024
  v_mfma_f32_16x16x32_bf16 v[108:111], v[212:215], v[92:95], v[108:111]
  ds_read_b64_tr_b16 v[178:179], v6 offset:38912
  ds_read_b64_tr_b16 v[180:181], v7 offset:36864
  v_mfma_f32_16x16x32_bf16 v[104:107], v[212:215], v[88:91], v[104:107]
  ds_read_b64_tr_b16 v[182:183], v7 offset:38912
  v_mfma_f32_16x16x32_bf16 v[112:115], v[216:219], v[88:91], v[112:115]
  ds_read_b64_tr_b16 v[184:185], v8 offset:36864
  v_mfma_f32_16x16x32_bf16 v[116:119], v[216:219], v[92:95], v[116:119]
  ds_read_b64_tr_b16 v[186:187], v8 offset:38912
  v_readlane_b32 s51, v15, 7
  v_mfma_f32_16x16x32_bf16 v[124:127], v[220:223], v[92:95], v[124:127]
  ds_read_b64_tr_b16 v[188:189], v9 offset:36864
  v_mfma_f32_16x16x32_bf16 v[120:123], v[220:223], v[88:91], v[120:123]
  ds_read_b64_tr_b16 v[190:191], v9 offset:38912
  s_waitcnt vmcnt(10) lgkmcnt(8)
  v_mfma_f32_16x16x32_bf16 v[96:99], v[160:163], v[32:35], v[96:99]
  buffer_load_dwordx4 v[80:83], off, s[36:39], s51 offset:0
  v_mfma_f32_16x16x32_bf16 v[100:103], v[160:163], v[36:39], v[100:103]
  ds_read_b64_tr_b16 v[192:193], v6 offset:40960
  ds_read_b64_tr_b16 v[194:195], v6 offset:43008
  v_mfma_f32_16x16x32_bf16 v[108:111], v[164:167], v[36:39], v[108:111]
  ds_read_b64_tr_b16 v[196:197], v7 offset:40960
  v_mfma_f32_16x16x32_bf16 v[104:107], v[164:167], v[32:35], v[104:107]
  buffer_load_dwordx4 v[84:87], off, s[64:67], s51 offset:0
  v_mfma_f32_16x16x32_bf16 v[112:115], v[168:171], v[32:35], v[112:115]
  ds_read_b64_tr_b16 v[198:199], v7 offset:43008
  ds_read_b64_tr_b16 v[200:201], v8 offset:40960
  v_mfma_f32_16x16x32_bf16 v[116:119], v[168:171], v[36:39], v[116:119]
  ds_read_b64_tr_b16 v[202:203], v8 offset:43008
  ds_read_b64_tr_b16 v[204:205], v9 offset:40960
  v_mfma_f32_16x16x32_bf16 v[124:127], v[172:175], v[36:39], v[124:127]
  buffer_load_dwordx4 v[88:91], off, s[36:39], s51 offset:1024
  v_mfma_f32_16x16x32_bf16 v[120:123], v[172:175], v[32:35], v[120:123]
  ds_read_b64_tr_b16 v[206:207], v9 offset:43008
  s_waitcnt vmcnt(11) lgkmcnt(8)
  s_barrier
  v_mfma_f32_16x16x32_bf16 v[96:99], v[176:179], v[40:43], v[96:99]
  ds_read_b64_tr_b16 v[208:209], v6 offset:45056
  v_mfma_f32_16x16x32_bf16 v[100:103], v[176:179], v[44:47], v[100:103]
  buffer_load_dwordx4 v[92:95], off, s[64:67], s51 offset:1024
  v_mfma_f32_16x16x32_bf16 v[108:111], v[180:183], v[44:47], v[108:111]
  ds_read_b64_tr_b16 v[210:211], v6 offset:47104
  ds_read_b64_tr_b16 v[212:213], v7 offset:45056
  v_mfma_f32_16x16x32_bf16 v[104:107], v[180:183], v[40:43], v[104:107]
  ds_read_b64_tr_b16 v[214:215], v7 offset:47104
  v_mfma_f32_16x16x32_bf16 v[112:115], v[184:187], v[40:43], v[112:115]
  ds_read_b64_tr_b16 v[216:217], v8 offset:45056
  v_mfma_f32_16x16x32_bf16 v[116:119], v[184:187], v[44:47], v[116:119]
  ds_read_b64_tr_b16 v[218:219], v8 offset:47104
  v_readlane_b32 s48, v15, 8
  v_mfma_f32_16x16x32_bf16 v[124:127], v[188:191], v[44:47], v[124:127]
  ds_read_b64_tr_b16 v[220:221], v9 offset:45056
  v_mfma_f32_16x16x32_bf16 v[120:123], v[188:191], v[40:43], v[120:123]
  ds_read_b64_tr_b16 v[222:223], v9 offset:47104
  s_waitcnt vmcnt(10) lgkmcnt(8)
  v_mfma_f32_16x16x32_bf16 v[96:99], v[192:195], v[48:51], v[96:99]
  buffer_load_dwordx4 v[32:35], off, s[36:39], s48 offset:0
  v_mfma_f32_16x16x32_bf16 v[100:103], v[192:195], v[52:55], v[100:103]
  ds_read_b64_tr_b16 v[160:161], v6 offset:49152
  ds_read_b64_tr_b16 v[162:163], v6 offset:51200
  v_mfma_f32_16x16x32_bf16 v[108:111], v[196:199], v[52:55], v[108:111]
  ds_read_b64_tr_b16 v[164:165], v7 offset:49152
  v_mfma_f32_16x16x32_bf16 v[104:107], v[196:199], v[48:51], v[104:107]
  buffer_load_dwordx4 v[36:39], off, s[64:67], s48 offset:0
  v_mfma_f32_16x16x32_bf16 v[112:115], v[200:203], v[48:51], v[112:115]
  ds_read_b64_tr_b16 v[166:167], v7 offset:51200
  ds_read_b64_tr_b16 v[168:169], v8 offset:49152
  v_mfma_f32_16x16x32_bf16 v[116:119], v[200:203], v[52:55], v[116:119]
  ds_read_b64_tr_b16 v[170:171], v8 offset:51200
  ds_read_b64_tr_b16 v[172:173], v9 offset:49152
  v_mfma_f32_16x16x32_bf16 v[124:127], v[204:207], v[52:55], v[124:127]
  buffer_load_dwordx4 v[40:43], off, s[36:39], s48 offset:1024
  v_mfma_f32_16x16x32_bf16 v[120:123], v[204:207], v[48:51], v[120:123]
  ds_read_b64_tr_b16 v[174:175], v9 offset:51200
  s_waitcnt vmcnt(11) lgkmcnt(8)
  v_mfma_f32_16x16x32_bf16 v[96:99], v[208:211], v[56:59], v[96:99]
  ds_read_b64_tr_b16 v[176:177], v6 offset:53248
  v_mfma_f32_16x16x32_bf16 v[100:103], v[208:211], v[60:63], v[100:103]
  buffer_load_dwordx4 v[44:47], off, s[64:67], s48 offset:1024
  v_mfma_f32_16x16x32_bf16 v[108:111], v[212:215], v[60:63], v[108:111]
  ds_read_b64_tr_b16 v[178:179], v6 offset:55296
  ds_read_b64_tr_b16 v[180:181], v7 offset:53248
  v_mfma_f32_16x16x32_bf16 v[104:107], v[212:215], v[56:59], v[104:107]
  ds_read_b64_tr_b16 v[182:183], v7 offset:55296
  v_mfma_f32_16x16x32_bf16 v[112:115], v[216:219], v[56:59], v[112:115]
  ds_read_b64_tr_b16 v[184:185], v8 offset:53248
  v_mfma_f32_16x16x32_bf16 v[116:119], v[216:219], v[60:63], v[116:119]
  ds_read_b64_tr_b16 v[186:187], v8 offset:55296
  v_readlane_b32 s49, v15, 9
  v_mfma_f32_16x16x32_bf16 v[124:127], v[220:223], v[60:63], v[124:127]
  ds_read_b64_tr_b16 v[188:189], v9 offset:53248
  v_mfma_f32_16x16x32_bf16 v[120:123], v[220:223], v[56:59], v[120:123]
  ds_read_b64_tr_b16 v[190:191], v9 offset:55296
  s_waitcnt vmcnt(10) lgkmcnt(8)
  v_mfma_f32_16x16x32_bf16 v[96:99], v[160:163], v[64:67], v[96:99]
  buffer_load_dwordx4 v[48:51], off, s[36:39], s49 offset:0
  v_mfma_f32_16x16x32_bf16 v[100:103], v[160:163], v[68:71], v[100:103]
  ds_read_b64_tr_b16 v[192:193], v6 offset:57344
  ds_read_b64_tr_b16 v[194:195], v6 offset:59392
  v_mfma_f32_16x16x32_bf16 v[108:111], v[164:167], v[68:71], v[108:111]
  ds_read_b64_tr_b16 v[196:197], v7 offset:57344
  v_mfma_f32_16x16x32_bf16 v[104:107], v[164:167], v[64:67], v[104:107]
  buffer_load_dwordx4 v[52:55], off, s[64:67], s49 offset:0
  v_mfma_f32_16x16x32_bf16 v[112:115], v[168:171], v[64:67], v[112:115]
  ds_read_b64_tr_b16 v[198:199], v7 offset:59392
  ds_read_b64_tr_b16 v[200:201], v8 offset:57344
  v_mfma_f32_16x16x32_bf16 v[116:119], v[168:171], v[68:71], v[116:119]
  ds_read_b64_tr_b16 v[202:203], v8 offset:59392
  ds_read_b64_tr_b16 v[204:205], v9 offset:57344
  v_mfma_f32_16x16x32_bf16 v[124:127], v[172:175], v[68:71], v[124:127]
  buffer_load_dwordx4 v[56:59], off, s[36:39], s49 offset:1024
  v_mfma_f32_16x16x32_bf16 v[120:123], v[172:175], v[64:67], v[120:123]
  ds_read_b64_tr_b16 v[206:207], v9 offset:59392
  s_waitcnt vmcnt(11) lgkmcnt(8)
  v_mfma_f32_16x16x32_bf16 v[96:99], v[176:179], v[72:75], v[96:99]
  ds_read_b64_tr_b16 v[208:209], v6 offset:61440
  v_mfma_f32_16x16x32_bf16 v[100:103], v[176:179], v[76:79], v[100:103]
  buffer_load_dwordx4 v[60:63], off, s[64:67], s49 offset:1024
  v_mfma_f32_16x16x32_bf16 v[108:111], v[180:183], v[76:79], v[108:111]
  ds_read_b64_tr_b16 v[210:211], v6 offset:63488
  ds_read_b64_tr_b16 v[212:213], v7 offset:61440
  v_mfma_f32_16x16x32_bf16 v[104:107], v[180:183], v[72:75], v[104:107]
  ds_read_b64_tr_b16 v[214:215], v7 offset:63488
  v_mfma_f32_16x16x32_bf16 v[112:115], v[184:187], v[72:75], v[112:115]
  ds_read_b64_tr_b16 v[216:217], v8 offset:61440
  v_mfma_f32_16x16x32_bf16 v[116:119], v[184:187], v[76:79], v[116:119]
  ds_read_b64_tr_b16 v[218:219], v8 offset:63488
  v_readlane_b32 s50, v15, 10
  v_mfma_f32_16x16x32_bf16 v[124:127], v[188:191], v[76:79], v[124:127]
  ds_read_b64_tr_b16 v[220:221], v9 offset:61440
  v_mfma_f32_16x16x32_bf16 v[120:123], v[188:191], v[72:75], v[120:123]
  ds_read_b64_tr_b16 v[222:223], v9 offset:63488
  s_waitcnt vmcnt(10) lgkmcnt(8)
  v_mfma_f32_16x16x32_bf16 v[96:99], v[192:195], v[80:83], v[96:99]
  buffer_load_dwordx4 v[64:67], off, s[36:39], s50 offset:0
  v_mfma_f32_16x16x32_bf16 v[100:103], v[192:195], v[84:87], v[100:103]
  ds_read_b64_tr_b16 v[160:161], v20 offset:0
  ds_read_b64_tr_b16 v[162:163], v20 offset:2048
  v_mfma_f32_16x16x32_bf16 v[108:111], v[196:199], v[84:87], v[108:111]
  ds_read_b64_tr_b16 v[164:165], v21 offset:0
  v_mfma_f32_16x16x32_bf16 v[104:107], v[196:199], v[80:83], v[104:107]
  buffer_load_dwordx4 v[68:71], off, s[64:67], s50 offset:0
  v_mfma_f32_16x16x32_bf16 v[112:115], v[200:203], v[80:83], v[112:115]
  ds_read_b64_tr_b16 v[166:167], v21 offset:2048
  ds_read_b64_tr_b16 v[168:169], v22 offset:0
  v_mfma_f32_16x16x32_bf16 v[116:119], v[200:203], v[84:87], v[116:119]
  ds_read_b64_tr_b16 v[170:171], v22 offset:2048
  ds_read_b64_tr_b16 v[172:173], v23 offset:0
  v_mfma_f32_16x16x32_bf16 v[124:127], v[204:207], v[84:87], v[124:127]
  buffer_load_dwordx4 v[72:75], off, s[36:39], s50 offset:1024
  v_mfma_f32_16x16x32_bf16 v[120:123], v[204:207], v[80:83], v[120:123]
  ds_read_b64_tr_b16 v[174:175], v23 offset:2048
  s_waitcnt vmcnt(11) lgkmcnt(8)
  v_mfma_f32_16x16x32_bf16 v[96:99], v[208:211], v[88:91], v[96:99]
  ds_read_b64_tr_b16 v[176:177], v20 offset:4096
  v_mfma_f32_16x16x32_bf16 v[100:103], v[208:211], v[92:95], v[100:103]
  buffer_load_dwordx4 v[76:79], off, s[64:67], s50 offset:1024
  v_mfma_f32_16x16x32_bf16 v[108:111], v[212:215], v[92:95], v[108:111]
  ds_read_b64_tr_b16 v[178:179], v20 offset:6144
  ds_read_b64_tr_b16 v[180:181], v21 offset:4096
  v_mfma_f32_16x16x32_bf16 v[104:107], v[212:215], v[88:91], v[104:107]
  ds_read_b64_tr_b16 v[182:183], v21 offset:6144
  v_mfma_f32_16x16x32_bf16 v[112:115], v[216:219], v[88:91], v[112:115]
  ds_read_b64_tr_b16 v[184:185], v22 offset:4096
  v_mfma_f32_16x16x32_bf16 v[116:119], v[216:219], v[92:95], v[116:119]
  ds_read_b64_tr_b16 v[186:187], v22 offset:6144
  v_readlane_b32 s51, v15, 11
  v_mfma_f32_16x16x32_bf16 v[124:127], v[220:223], v[92:95], v[124:127]
  ds_read_b64_tr_b16 v[188:189], v23 offset:4096
  v_mfma_f32_16x16x32_bf16 v[120:123], v[220:223], v[88:91], v[120:123]
  ds_read_b64_tr_b16 v[190:191], v23 offset:6144
  s_waitcnt vmcnt(10) lgkmcnt(8)
  v_mfma_f32_16x16x32_bf16 v[96:99], v[160:163], v[32:35], v[96:99]
  buffer_load_dwordx4 v[80:83], off, s[36:39], s51 offset:0
  v_mfma_f32_16x16x32_bf16 v[100:103], v[160:163], v[36:39], v[100:103]
  ds_read_b64_tr_b16 v[192:193], v20 offset:8192
  ds_read_b64_tr_b16 v[194:195], v20 offset:10240
  v_mfma_f32_16x16x32_bf16 v[108:111], v[164:167], v[36:39], v[108:111]
  ds_read_b64_tr_b16 v[196:197], v21 offset:8192
  v_mfma_f32_16x16x32_bf16 v[104:107], v[164:167], v[32:35], v[104:107]
  buffer_load_dwordx4 v[84:87], off, s[64:67], s51 offset:0
  v_mfma_f32_16x16x32_bf16 v[112:115], v[168:171], v[32:35], v[112:115]
  ds_read_b64_tr_b16 v[198:199], v21 offset:10240
  ds_read_b64_tr_b16 v[200:201], v22 offset:8192
  v_mfma_f32_16x16x32_bf16 v[116:119], v[168:171], v[36:39], v[116:119]
  ds_read_b64_tr_b16 v[202:203], v22 offset:10240
  ds_read_b64_tr_b16 v[204:205], v23 offset:8192
  v_mfma_f32_16x16x32_bf16 v[124:127], v[172:175], v[36:39], v[124:127]
  buffer_load_dwordx4 v[88:91], off, s[36:39], s51 offset:1024
  v_mfma_f32_16x16x32_bf16 v[120:123], v[172:175], v[32:35], v[120:123]
  ds_read_b64_tr_b16 v[206:207], v23 offset:10240
  s_waitcnt vmcnt(11) lgkmcnt(8)
  v_mfma_f32_16x16x32_bf16 v[96:99], v[176:179], v[40:43], v[96:99]
  ds_read_b64_tr_b16 v[208:209], v20 offset:12288
  v_mfma_f32_16x16x32_bf16 v[100:103], v[176:179], v[44:47], v[100:103]
  buffer_load_dwordx4 v[92:95], off, s[64:67], s51 offset:1024
  v_mfma_f32_16x16x32_bf16 v[108:111], v[180:183], v[44:47], v[108:111]
  ds_read_b64_tr_b16 v[210:211], v20 offset:14336
  ds_read_b64_tr_b16 v[212:213], v21 offset:12288
  v_mfma_f32_16x16x32_bf16 v[104:107], v[180:183], v[40:43], v[104:107]
  ds_read_b64_tr_b16 v[214:215], v21 offset:14336
  v_mfma_f32_16x16x32_bf16 v[112:115], v[184:187], v[40:43], v[112:115]
  ds_read_b64_tr_b16 v[216:217], v22 offset:12288
  v_mfma_f32_16x16x32_bf16 v[116:119], v[184:187], v[44:47], v[116:119]
  ds_read_b64_tr_b16 v[218:219], v22 offset:14336
  v_readlane_b32 s48, v15, 12
  v_mfma_f32_16x16x32_bf16 v[124:127], v[188:191], v[44:47], v[124:127]
  ds_read_b64_tr_b16 v[220:221], v23 offset:12288
  v_mfma_f32_16x16x32_bf16 v[120:123], v[188:191], v[40:43], v[120:123]
  ds_read_b64_tr_b16 v[222:223], v23 offset:14336
  s_waitcnt vmcnt(10) lgkmcnt(8)
  v_mfma_f32_16x16x32_bf16 v[96:99], v[192:195], v[48:51], v[96:99]
  buffer_load_dwordx4 v[32:35], off, s[36:39], s48 offset:0
  v_mfma_f32_16x16x32_bf16 v[100:103], v[192:195], v[52:55], v[100:103]
  ds_read_b64_tr_b16 v[160:161], v20 offset:16384
  ds_read_b64_tr_b16 v[162:163], v20 offset:18432
  v_mfma_f32_16x16x32_bf16 v[108:111], v[196:199], v[52:55], v[108:111]
  ds_read_b64_tr_b16 v[164:165], v21 offset:16384
  v_mfma_f32_16x16x32_bf16 v[104:107], v[196:199], v[48:51], v[104:107]
  buffer_load_dwordx4 v[36:39], off, s[64:67], s48 offset:0
  v_mfma_f32_16x16x32_bf16 v[112:115], v[200:203], v[48:51], v[112:115]
  ds_read_b64_tr_b16 v[166:167], v21 offset:18432
  ds_read_b64_tr_b16 v[168:169], v22 offset:16384
  v_mfma_f32_16x16x32_bf16 v[116:119], v[200:203], v[52:55], v[116:119]
  ds_read_b64_tr_b16 v[170:171], v22 offset:18432
  ds_read_b64_tr_b16 v[172:173], v23 offset:16384
  v_mfma_f32_16x16x32_bf16 v[124:127], v[204:207], v[52:55], v[124:127]
  buffer_load_dwordx4 v[40:43], off, s[36:39], s48 offset:1024
  v_mfma_f32_16x16x32_bf16 v[120:123], v[204:207], v[48:51], v[120:123]
  ds_read_b64_tr_b16 v[174:175], v23 offset:18432
  s_waitcnt vmcnt(11) lgkmcnt(8)
  v_mfma_f32_16x16x32_bf16 v[96:99], v[208:211], v[56:59], v[96:99]
  ds_read_b64_tr_b16 v[176:177], v20 offset:20480
  v_mfma_f32_16x16x32_bf16 v[100:103], v[208:211], v[60:63], v[100:103]
  buffer_load_dwordx4 v[44:47], off, s[64:67], s48 offset:1024
  v_mfma_f32_16x16x32_bf16 v[108:111], v[212:215], v[60:63], v[108:111]
  ds_read_b64_tr_b16 v[178:179], v20 offset:22528
  ds_read_b64_tr_b16 v[180:181], v21 offset:20480
  v_mfma_f32_16x16x32_bf16 v[104:107], v[212:215], v[56:59], v[104:107]
  ds_read_b64_tr_b16 v[182:183], v21 offset:22528
  v_mfma_f32_16x16x32_bf16 v[112:115], v[216:219], v[56:59], v[112:115]
  ds_read_b64_tr_b16 v[184:185], v22 offset:20480
  v_mfma_f32_16x16x32_bf16 v[116:119], v[216:219], v[60:63], v[116:119]
  ds_read_b64_tr_b16 v[186:187], v22 offset:22528
  v_readlane_b32 s49, v15, 13
  v_mfma_f32_16x16x32_bf16 v[124:127], v[220:223], v[60:63], v[124:127]
  ds_read_b64_tr_b16 v[188:189], v23 offset:20480
  v_mfma_f32_16x16x32_bf16 v[120:123], v[220:223], v[56:59], v[120:123]
  ds_read_b64_tr_b16 v[190:191], v23 offset:22528
  s_waitcnt vmcnt(10) lgkmcnt(8)
  v_mfma_f32_16x16x32_bf16 v[96:99], v[160:163], v[64:67], v[96:99]
  buffer_load_dwordx4 v[48:51], off, s[36:39], s49 offset:0
  v_mfma_f32_16x16x32_bf16 v[100:103], v[160:163], v[68:71], v[100:103]
  ds_read_b64_tr_b16 v[192:193], v20 offset:24576
  ds_read_b64_tr_b16 v[194:195], v20 offset:26624
  v_mfma_f32_16x16x32_bf16 v[108:111], v[164:167], v[68:71], v[108:111]
  ds_read_b64_tr_b16 v[196:197], v21 offset:24576
  v_mfma_f32_16x16x32_bf16 v[104:107], v[164:167], v[64:67], v[104:107]
  buffer_load_dwordx4 v[52:55], off, s[64:67], s49 offset:0
  v_mfma_f32_16x16x32_bf16 v[112:115], v[168:171], v[64:67], v[112:115]
  ds_read_b64_tr_b16 v[198:199], v21 offset:26624
  ds_read_b64_tr_b16 v[200:201], v22 offset:24576
  v_mfma_f32_16x16x32_bf16 v[116:119], v[168:171], v[68:71], v[116:119]
  ds_read_b64_tr_b16 v[202:203], v22 offset:26624
  ds_read_b64_tr_b16 v[204:205], v23 offset:24576
  v_mfma_f32_16x16x32_bf16 v[124:127], v[172:175], v[68:71], v[124:127]
  buffer_load_dwordx4 v[56:59], off, s[36:39], s49 offset:1024
  v_mfma_f32_16x16x32_bf16 v[120:123], v[172:175], v[64:67], v[120:123]
  ds_read_b64_tr_b16 v[206:207], v23 offset:26624
  s_waitcnt vmcnt(11) lgkmcnt(8)
  v_mfma_f32_16x16x32_bf16 v[96:99], v[176:179], v[72:75], v[96:99]
  ds_read_b64_tr_b16 v[208:209], v20 offset:28672
  v_mfma_f32_16x16x32_bf16 v[100:103], v[176:179], v[76:79], v[100:103]
  buffer_load_dwordx4 v[60:63], off, s[64:67], s49 offset:1024
  v_mfma_f32_16x16x32_bf16 v[108:111], v[180:183], v[76:79], v[108:111]
  ds_read_b64_tr_b16 v[210:211], v20 offset:30720
  ds_read_b64_tr_b16 v[212:213], v21 offset:28672
  v_mfma_f32_16x16x32_bf16 v[104:107], v[180:183], v[72:75], v[104:107]
  ds_read_b64_tr_b16 v[214:215], v21 offset:30720
  v_mfma_f32_16x16x32_bf16 v[112:115], v[184:187], v[72:75], v[112:115]
  ds_read_b64_tr_b16 v[216:217], v22 offset:28672
  v_mfma_f32_16x16x32_bf16 v[116:119], v[184:187], v[76:79], v[116:119]
  ds_read_b64_tr_b16 v[218:219], v22 offset:30720
  v_readlane_b32 s50, v15, 14
  v_mfma_f32_16x16x32_bf16 v[124:127], v[188:191], v[76:79], v[124:127]
  ds_read_b64_tr_b16 v[220:221], v23 offset:28672
  v_mfma_f32_16x16x32_bf16 v[120:123], v[188:191], v[72:75], v[120:123]
  ds_read_b64_tr_b16 v[222:223], v23 offset:30720
  s_waitcnt vmcnt(10) lgkmcnt(8)
  v_mfma_f32_16x16x32_bf16 v[96:99], v[192:195], v[80:83], v[96:99]
  buffer_load_dwordx4 v[64:67], off, s[36:39], s50 offset:0
  v_mfma_f32_16x16x32_bf16 v[100:103], v[192:195], v[84:87], v[100:103]
  ds_read_b64_tr_b16 v[160:161], v20 offset:36864
  ds_read_b64_tr_b16 v[162:163], v20 offset:38912
  v_mfma_f32_16x16x32_bf16 v[108:111], v[196:199], v[84:87], v[108:111]
  ds_read_b64_tr_b16 v[164:165], v21 offset:36864
  v_mfma_f32_16x16x32_bf16 v[104:107], v[196:199], v[80:83], v[104:107]
  buffer_load_dwordx4 v[68:71], off, s[64:67], s50 offset:0
  v_mfma_f32_16x16x32_bf16 v[112:115], v[200:203], v[80:83], v[112:115]
  ds_read_b64_tr_b16 v[166:167], v21 offset:38912
  ds_read_b64_tr_b16 v[168:169], v22 offset:36864
  v_mfma_f32_16x16x32_bf16 v[116:119], v[200:203], v[84:87], v[116:119]
  ds_read_b64_tr_b16 v[170:171], v22 offset:38912
  ds_read_b64_tr_b16 v[172:173], v23 offset:36864
  v_mfma_f32_16x16x32_bf16 v[124:127], v[204:207], v[84:87], v[124:127]
  buffer_load_dwordx4 v[72:75], off, s[36:39], s50 offset:1024
  v_mfma_f32_16x16x32_bf16 v[120:123], v[204:207], v[80:83], v[120:123]
  ds_read_b64_tr_b16 v[174:175], v23 offset:38912
  s_waitcnt vmcnt(11) lgkmcnt(8)
  v_mfma_f32_16x16x32_bf16 v[96:99], v[208:211], v[88:91], v[96:99]
  ds_read_b64_tr_b16 v[176:177], v20 offset:40960
  v_mfma_f32_16x16x32_bf16 v[100:103], v[208:211], v[92:95], v[100:103]
  buffer_load_dwordx4 v[76:79], off, s[64:67], s50 offset:1024
  v_mfma_f32_16x16x32_bf16 v[108:111], v[212:215], v[92:95], v[108:111]
  ds_read_b64_tr_b16 v[178:179], v20 offset:43008
  ds_read_b64_tr_b16 v[180:181], v21 offset:40960
  v_mfma_f32_16x16x32_bf16 v[104:107], v[212:215], v[88:91], v[104:107]
  ds_read_b64_tr_b16 v[182:183], v21 offset:43008
  v_mfma_f32_16x16x32_bf16 v[112:115], v[216:219], v[88:91], v[112:115]
  ds_read_b64_tr_b16 v[184:185], v22 offset:40960
  v_mfma_f32_16x16x32_bf16 v[116:119], v[216:219], v[92:95], v[116:119]
  ds_read_b64_tr_b16 v[186:187], v22 offset:43008
  v_readlane_b32 s51, v15, 15
  v_mfma_f32_16x16x32_bf16 v[124:127], v[220:223], v[92:95], v[124:127]
  ds_read_b64_tr_b16 v[188:189], v23 offset:40960
  v_mfma_f32_16x16x32_bf16 v[120:123], v[220:223], v[88:91], v[120:123]
  ds_read_b64_tr_b16 v[190:191], v23 offset:43008
  s_waitcnt vmcnt(10) lgkmcnt(8)
  v_mfma_f32_16x16x32_bf16 v[96:99], v[160:163], v[32:35], v[96:99]
  buffer_load_dwordx4 v[80:83], off, s[36:39], s51 offset:0
  v_mfma_f32_16x16x32_bf16 v[100:103], v[160:163], v[36:39], v[100:103]
  ds_read_b64_tr_b16 v[192:193], v20 offset:45056
  ds_read_b64_tr_b16 v[194:195], v20 offset:47104
  v_mfma_f32_16x16x32_bf16 v[108:111], v[164:167], v[36:39], v[108:111]
  ds_read_b64_tr_b16 v[196:197], v21 offset:45056
  v_mfma_f32_16x16x32_bf16 v[104:107], v[164:167], v[32:35], v[104:107]
  buffer_load_dwordx4 v[84:87], off, s[64:67], s51 offset:0
  v_mfma_f32_16x16x32_bf16 v[112:115], v[168:171], v[32:35], v[112:115]
  ds_read_b64_tr_b16 v[198:199], v21 offset:47104
  ds_read_b64_tr_b16 v[200:201], v22 offset:45056
  v_mfma_f32_16x16x32_bf16 v[116:119], v[168:171], v[36:39], v[116:119]
  ds_read_b64_tr_b16 v[202:203], v22 offset:47104
  ds_read_b64_tr_b16 v[204:205], v23 offset:45056
  v_mfma_f32_16x16x32_bf16 v[124:127], v[172:175], v[36:39], v[124:127]
  buffer_load_dwordx4 v[88:91], off, s[36:39], s51 offset:1024
  v_mfma_f32_16x16x32_bf16 v[120:123], v[172:175], v[32:35], v[120:123]
  ds_read_b64_tr_b16 v[206:207], v23 offset:47104
  s_waitcnt vmcnt(11) lgkmcnt(8)
  v_mfma_f32_16x16x32_bf16 v[96:99], v[176:179], v[40:43], v[96:99]
  ds_read_b64_tr_b16 v[208:209], v20 offset:49152
  v_mfma_f32_16x16x32_bf16 v[100:103], v[176:179], v[44:47], v[100:103]
  buffer_load_dwordx4 v[92:95], off, s[64:67], s51 offset:1024
  v_mfma_f32_16x16x32_bf16 v[108:111], v[180:183], v[44:47], v[108:111]
  ds_read_b64_tr_b16 v[210:211], v20 offset:51200
  ds_read_b64_tr_b16 v[212:213], v21 offset:49152
  v_mfma_f32_16x16x32_bf16 v[104:107], v[180:183], v[40:43], v[104:107]
  ds_read_b64_tr_b16 v[214:215], v21 offset:51200
  v_mfma_f32_16x16x32_bf16 v[112:115], v[184:187], v[40:43], v[112:115]
  ds_read_b64_tr_b16 v[216:217], v22 offset:49152
  v_mfma_f32_16x16x32_bf16 v[116:119], v[184:187], v[44:47], v[116:119]
  ds_read_b64_tr_b16 v[218:219], v22 offset:51200
  v_mfma_f32_16x16x32_bf16 v[124:127], v[188:191], v[44:47], v[124:127]
  ds_read_b64_tr_b16 v[220:221], v23 offset:49152
  v_mfma_f32_16x16x32_bf16 v[120:123], v[188:191], v[40:43], v[120:123]
  ds_read_b64_tr_b16 v[222:223], v23 offset:51200
  s_waitcnt vmcnt(10) lgkmcnt(8)
  v_mfma_f32_16x16x32_bf16 v[96:99], v[192:195], v[48:51], v[96:99]
  ds_read_b64_tr_b16 v[160:161], v20 offset:53248
  v_mfma_f32_16x16x32_bf16 v[100:103], v[192:195], v[52:55], v[100:103]
  ds_read_b64_tr_b16 v[162:163], v20 offset:55296
  v_mfma_f32_16x16x32_bf16 v[108:111], v[196:199], v[52:55], v[108:111]
  ds_read_b64_tr_b16 v[164:165], v21 offset:53248
  v_mfma_f32_16x16x32_bf16 v[104:107], v[196:199], v[48:51], v[104:107]
  ds_read_b64_tr_b16 v[166:167], v21 offset:55296
  v_mfma_f32_16x16x32_bf16 v[112:115], v[200:203], v[48:51], v[112:115]
  ds_read_b64_tr_b16 v[168:169], v22 offset:53248
  v_mfma_f32_16x16x32_bf16 v[116:119], v[200:203], v[52:55], v[116:119]
  ds_read_b64_tr_b16 v[170:171], v22 offset:55296
  v_mfma_f32_16x16x32_bf16 v[124:127], v[204:207], v[52:55], v[124:127]
  ds_read_b64_tr_b16 v[172:173], v23 offset:53248
  v_mfma_f32_16x16x32_bf16 v[120:123], v[204:207], v[48:51], v[120:123]
  ds_read_b64_tr_b16 v[174:175], v23 offset:55296
  s_waitcnt vmcnt(8) lgkmcnt(8)
  s_barrier
  v_mfma_f32_16x16x32_bf16 v[96:99], v[208:211], v[56:59], v[96:99]
  ds_read_b64_tr_b16 v[176:177], v20 offset:57344
  v_mfma_f32_16x16x32_bf16 v[100:103], v[208:211], v[60:63], v[100:103]
  ds_read_b64_tr_b16 v[178:179], v20 offset:59392
  v_mfma_f32_16x16x32_bf16 v[108:111], v[212:215], v[60:63], v[108:111]
  ds_read_b64_tr_b16 v[180:181], v21 offset:57344
  v_mfma_f32_16x16x32_bf16 v[104:107], v[212:215], v[56:59], v[104:107]
  ds_read_b64_tr_b16 v[182:183], v21 offset:59392
  v_mfma_f32_16x16x32_bf16 v[112:115], v[216:219], v[56:59], v[112:115]
  ds_read_b64_tr_b16 v[184:185], v22 offset:57344
  v_mfma_f32_16x16x32_bf16 v[116:119], v[216:219], v[60:63], v[116:119]
  ds_read_b64_tr_b16 v[186:187], v22 offset:59392
  v_mfma_f32_16x16x32_bf16 v[124:127], v[220:223], v[60:63], v[124:127]
  ds_read_b64_tr_b16 v[188:189], v23 offset:57344
  v_mfma_f32_16x16x32_bf16 v[120:123], v[220:223], v[56:59], v[120:123]
  ds_read_b64_tr_b16 v[190:191], v23 offset:59392
  s_waitcnt vmcnt(6) lgkmcnt(8)
  v_mfma_f32_16x16x32_bf16 v[96:99], v[160:163], v[64:67], v[96:99]
  ds_read_b64_tr_b16 v[192:193], v26 offset:0
  v_mfma_f32_16x16x32_bf16 v[100:103], v[160:163], v[68:71], v[100:103]
  ds_read_b64_tr_b16 v[194:195], v26 offset:2048
  v_mfma_f32_16x16x32_bf16 v[108:111], v[164:167], v[68:71], v[108:111]
  ds_read_b64_tr_b16 v[196:197], v27 offset:0
  v_mfma_f32_16x16x32_bf16 v[104:107], v[164:167], v[64:67], v[104:107]
  ds_read_b64_tr_b16 v[198:199], v27 offset:2048
  v_mfma_f32_16x16x32_bf16 v[112:115], v[168:171], v[64:67], v[112:115]
  ds_read_b64_tr_b16 v[200:201], v28 offset:0
  v_mfma_f32_16x16x32_bf16 v[116:119], v[168:171], v[68:71], v[116:119]
  ds_read_b64_tr_b16 v[202:203], v28 offset:2048
  v_mfma_f32_16x16x32_bf16 v[124:127], v[172:175], v[68:71], v[124:127]
  ds_read_b64_tr_b16 v[204:205], v29 offset:0
  v_mfma_f32_16x16x32_bf16 v[120:123], v[172:175], v[64:67], v[120:123]
  ds_read_b64_tr_b16 v[206:207], v29 offset:2048
  s_waitcnt vmcnt(4) lgkmcnt(8)
  v_mfma_f32_16x16x32_bf16 v[96:99], v[176:179], v[72:75], v[96:99]
  ds_read_b64_tr_b16 v[208:209], v26 offset:4096
  v_mfma_f32_16x16x32_bf16 v[100:103], v[176:179], v[76:79], v[100:103]
  ds_read_b64_tr_b16 v[210:211], v26 offset:6144
  v_mfma_f32_16x16x32_bf16 v[108:111], v[180:183], v[76:79], v[108:111]
  ds_read_b64_tr_b16 v[212:213], v27 offset:4096
  v_mfma_f32_16x16x32_bf16 v[104:107], v[180:183], v[72:75], v[104:107]
  ds_read_b64_tr_b16 v[214:215], v27 offset:6144
  v_mfma_f32_16x16x32_bf16 v[112:115], v[184:187], v[72:75], v[112:115]
  ds_read_b64_tr_b16 v[216:217], v28 offset:4096
  v_mfma_f32_16x16x32_bf16 v[116:119], v[184:187], v[76:79], v[116:119]
  ds_read_b64_tr_b16 v[218:219], v28 offset:6144
  v_mfma_f32_16x16x32_bf16 v[124:127], v[188:191], v[76:79], v[124:127]
  ds_read_b64_tr_b16 v[220:221], v29 offset:4096
  v_mfma_f32_16x16x32_bf16 v[120:123], v[188:191], v[72:75], v[120:123]
  ds_read_b64_tr_b16 v[222:223], v29 offset:6144
  s_waitcnt vmcnt(2) lgkmcnt(8)
  v_mfma_f32_16x16x32_bf16 v[96:99], v[192:195], v[80:83], v[96:99]
  v_mov_b32 v20, 0
  v_mov_b32 v21, 0
  v_mfma_f32_16x16x32_bf16 v[100:103], v[192:195], v[84:87], v[100:103]
  v_mov_b32 v22, 0
  v_mov_b32 v23, 0
  v_mfma_f32_16x16x32_bf16 v[108:111], v[196:199], v[84:87], v[108:111]
  v_mfma_f32_16x16x32_bf16 v[104:107], v[196:199], v[80:83], v[104:107]
  v_mfma_f32_16x16x32_bf16 v[112:115], v[200:203], v[80:83], v[112:115]
  v_mfma_f32_16x16x32_bf16 v[116:119], v[200:203], v[84:87], v[116:119]
  v_mfma_f32_16x16x32_bf16 v[124:127], v[204:207], v[84:87], v[124:127]
  v_mfma_f32_16x16x32_bf16 v[120:123], v[204:207], v[80:83], v[120:123]
  s_waitcnt vmcnt(0) lgkmcnt(0)
  v_mfma_f32_16x16x32_bf16 v[96:99], v[208:211], v[88:91], v[96:99]
  v_mfma_f32_16x16x32_bf16 v[100:103], v[208:211], v[92:95], v[100:103]
  v_mfma_f32_16x16x32_bf16 v[108:111], v[212:215], v[92:95], v[108:111]
  v_mfma_f32_16x16x32_bf16 v[104:107], v[212:215], v[88:91], v[104:107]
  v_mfma_f32_16x16x32_bf16 v[112:115], v[216:219], v[88:91], v[112:115]
  v_mfma_f32_16x16x32_bf16 v[116:119], v[216:219], v[92:95], v[116:119]
  v_mfma_f32_16x16x32_bf16 v[124:127], v[220:223], v[92:95], v[124:127]
  v_mfma_f32_16x16x32_bf16 v[120:123], v[220:223], v[88:91], v[120:123]
  s_mov_b32 s3, 32768
  s_mov_b32 s10, 0x3f803f80
  s_nop 4
  v_cvt_pk_bf16_f32 v240, v96, v97
  v_cvt_pk_bf16_f32 v241, v98, v99
  v_cvt_pk_bf16_f32 v242, v104, v105
  v_cvt_pk_bf16_f32 v243, v106, v107
  buffer_store_dwordx4 v[240:243], v12, s[44:47], 0 offen offset:0 sc1
  ds_write_b128 v19, v[240:243] offset:0
  v_cvt_pk_bf16_f32 v244, v112, v113
  v_cvt_pk_bf16_f32 v245, v114, v115
  v_cvt_pk_bf16_f32 v246, v120, v121
  v_cvt_pk_bf16_f32 v247, v122, v123
  buffer_store_dwordx4 v[244:247], v12, s[44:47], 0 offen offset:1024 sc1
  ds_write_b128 v19, v[244:247] offset:1024
  v_cvt_pk_bf16_f32 v248, v100, v101
  v_cvt_pk_bf16_f32 v249, v102, v103
  v_cvt_pk_bf16_f32 v250, v108, v109
  v_cvt_pk_bf16_f32 v251, v110, v111
  buffer_store_dwordx4 v[248:251], v12, s[44:47], s3 offen offset:0 sc1
  ds_write_b128 v19, v[248:251] offset:2048
  v_cvt_pk_bf16_f32 v252, v116, v117
  v_cvt_pk_bf16_f32 v253, v118, v119
  v_cvt_pk_bf16_f32 v254, v124, v125
  v_cvt_pk_bf16_f32 v255, v126, v127
  buffer_store_dwordx4 v[252:255], v12, s[44:47], s3 offen offset:1024 sc1
  ds_write_b128 v19, v[252:255] offset:3072
  v_dot2_f32_bf16 v20, v240, s10, v20
  v_dot2_f32_bf16 v22, v240, v240, v22
  v_dot2_f32_bf16 v20, v241, s10, v20
  v_dot2_f32_bf16 v22, v241, v241, v22
  v_dot2_f32_bf16 v20, v242, s10, v20
  v_dot2_f32_bf16 v22, v242, v242, v22
  v_dot2_f32_bf16 v20, v243, s10, v20
  v_dot2_f32_bf16 v22, v243, v243, v22
  v_dot2_f32_bf16 v20, v244, s10, v20
  v_dot2_f32_bf16 v22, v244, v244, v22
  v_dot2_f32_bf16 v20, v245, s10, v20
  v_dot2_f32_bf16 v22, v245, v245, v22
  v_dot2_f32_bf16 v20, v246, s10, v20
  v_dot2_f32_bf16 v22, v246, v246, v22
  v_dot2_f32_bf16 v20, v247, s10, v20
  v_dot2_f32_bf16 v22, v247, v247, v22
  v_dot2_f32_bf16 v21, v248, s10, v21
  v_dot2_f32_bf16 v23, v248, v248, v23
  v_dot2_f32_bf16 v21, v249, s10, v21
  v_dot2_f32_bf16 v23, v249, v249, v23
  v_dot2_f32_bf16 v21, v250, s10, v21
  v_dot2_f32_bf16 v23, v250, v250, v23
  v_dot2_f32_bf16 v21, v251, s10, v21
  v_dot2_f32_bf16 v23, v251, v251, v23
  v_dot2_f32_bf16 v21, v252, s10, v21
  v_dot2_f32_bf16 v23, v252, v252, v23
  v_dot2_f32_bf16 v21, v253, s10, v21
  v_dot2_f32_bf16 v23, v253, v253, v23
  v_dot2_f32_bf16 v21, v254, s10, v21
  v_dot2_f32_bf16 v23, v254, v254, v23
  v_dot2_f32_bf16 v21, v255, s10, v21
  v_dot2_f32_bf16 v23, v255, v255, v23
  s_nop 2
  v_permlane32_swap_b32 v20, v21
  v_permlane32_swap_b32 v22, v23
  v_add_f32 v20, v20, v21
  v_add_f32 v22, v22, v23
  s_nop 1
  v_permlane16_swap_b32 v20, v22
  v_add_f32 v20, v20, v22
  buffer_store_dword v20, v18, s[56:59], 0 offen sc1
  s_waitcnt vmcnt(0) lgkmcnt(0)
  s_barrier
  s_add_u32 s97, s97, 1
  s_branch L_w1_body
L_wo_c1:
L_w1_c0:
L_w1_body:
  s_cmp_ge_u32 s2, 256
  s_cbranch_scc1 L_w1_end
  v_lshrrev_b32 v2, 6, v0
  v_and_b32 v1, 63, v0
  v_readfirstlane_b32 s70, v2
  s_and_b32 s3, s2, 7
  s_lshr_b32 s99, s2, 3
  s_and_b32 s5, s3, 3
  s_lshl_b32 s5, s5, 2
  s_and_b32 s6, s99, 3
  s_add_u32 s68, s5, s6
  s_lshr_b32 s5, s3, 2
  s_lshl_b32 s5, s5, 3
  s_lshr_b32 s6, s99, 2
  s_add_u32 s69, s5, s6
  s_cmp_lt_u32 s70, 4
  s_cbranch_scc1 L_w1_compute
L_w1_loader:
  s_add_u32 s8, s70, s69
  s_and_b32 s8, s8, 3
  s_add_u32 s9, s70, s68
  s_and_b32 s9, s9, 3
  s_lshl_b32 s76, s8, 12
  s_lshl_b32 s77, s9, 11
  s_add_u32 s77, s77, 16384
  s_lshl_b32 s11, s68, 7
  v_and_b32 v10, 7, v1
  s_lshr_b32 s10, s76, 11
  s_lshl_b32 s3, s68, 3
  s_add_u32 s10, s10, s3
  s_mul_i32 s10, s10, 32768
  v_lshl_add_u32 v4, v1, 4, s10
  v_add_u32 v5, 32768, v4
  v_lshrrev_b32 v3, 3, v1
  s_lshl_b32 s10, s9, 4
  v_add_u32 v3, s10, v3
  v_mul_u32_u24 v3, 7168, v3
  v_lshrrev_b32 v2, 3, v1
  v_and_b32 v2, 6, v2
  v_xor_b32 v2, v2, v10
  s_mul_i32 s10, s69, 128
  v_add_u32 v3, s10, v3
  v_lshl_add_u32 v8, v2, 4, v3
  v_add_u32 v3, 57344, v3
  v_lshl_add_u32 v9, v2, 4, v3
  v_lshrrev_b32 v3, 2, v1
  s_lshl_b32 s10, s9, 4
  v_add_u32 v3, s10, v3
  v_mul_u32_u24 v3, 7168, v3
  v_bfe_u32 v2, v1, 4, 1
  v_xor_b32 v2, v2, v1
  v_and_b32 v2, 3, v2
  s_lshl_b32 s10, s69, 6
  s_add_u32 s10, s10, 2048
  v_add_u32 v3, s10, v3
  v_lshl_add_u32 v28, v2, 4, v3
  s_lshl_b32 s78, s69, 7
  s_add_u32 s78, s78, 3072
  s_mov_b32 s75, 0
  s_add_u32 s100, s68, s69
  s_mov_b32 s101, -1
  s_add_u32 s3, s68, s69
  s_and_b32 s3, s3, 3
  s_mov_b32 s100, 0x68532410
  s_mov_b32 s101, 0xfedbac97
  s_cmp_eq_u32 s3, 1
  s_cselect_b32 s100, 0x96435210, s100
  s_cselect_b32 s101, 0xfecbda87, s101
  s_cmp_eq_u32 s3, 2
  s_cselect_b32 s100, 0x75463210, s100
  s_cselect_b32 s101, 0xfdceb98a, s101
  s_cmp_eq_u32 s3, 3
  s_cselect_b32 s100, 0x65743210, s100
  s_cselect_b32 s101, 0xedfca9b8, s101
  s_waitcnt lgkmcnt(0)
  s_mov_b32 s40, s24
  s_and_b32 s41, s25, 0xffff
  s_mov_b32 s42, 7340032
  s_mov_b32 s43, 0x00020000
  s_cmp_lg_u32 s96, 0
  s_cbranch_scc1 L_pfc3_skip
  s_getpc_b64 s[4:5]
L_pfc3:
  s_lshl_b32 s3, s99, 2
  s_add_u32 s3, s3, s70
  s_sub_u32 s3, s3, 4
  s_mul_i32 s3, s3, 192
  s_min_u32 s3, s3, L_w2_c1-L_w2_c0-192
  s_add_i32 s3, s3, L_w2_c0-L_pfc3
  s_ashr_i32 s6, s3, 31
  s_add_u32 s4, s4, s3
  s_addc_u32 s5, s5, s6
  s_load_dword s84, s[4:5], 0
  s_load_dword s84, s[4:5], 64
  s_load_dword s84, s[4:5], 128
L_pfc3_skip:
  s_add_u32 s36, s34, 4194304
  s_addc_u32 s37, s35, 0
  s_and_b32 s37, s37, 0xffff
  s_mov_b32 s38, 4194304
  s_mov_b32 s39, 0x00020000
  s_add_u32 s56, s34, 24117248
  s_addc_u32 s57, s35, 0
  s_and_b32 s57, s57, 0xffff
  s_mov_b32 s58, 262144
  s_mov_b32 s59, 0x00020000
  s_add_u32 s64, s22, 24641536
  s_addc_u32 s65, s23, 0
  s_and_b32 s65, s65, 0xffff
  s_mov_b32 s66, 262144
  s_mov_b32 s67, 0x00020000
  s_mov_b32 s52, s26
  s_and_b32 s53, s27, 0xffff
  s_mov_b32 s54, 7168
  s_mov_b32 s55, 0x00020000
  s_and_b32 s3, s70, 3
  s_lshl2_add_u32 s4, s68, s3
  s_lshl_b32 s4, s4, 8
  v_lshrrev_b32 v2, 4, v1
  v_and_b32 v3, 15, v1
  v_lshl_add_u32 v3, v3, 4, s4
  v_lshl_add_u32 v18, v2, 14, v3
  s_lshl_b32 s4, s69, 7
  s_lshl_b32 s5, s70, 6
  s_add_u32 s4, s4, s5
  s_add_u32 s4, s4, 1216
  s_lshl_b32 s5, s69, 6
  s_cmp_eq_u32 s70, 4
  s_cselect_b32 s4, s5, s4
  s_lshr_b32 s5, s5, 1
  s_add_u32 s5, s5, 1024
  s_cmp_eq_u32 s70, 7
  s_cselect_b32 s4, s5, s4
  v_and_b32 v3, 15, v1
  v_lshl_add_u32 v3, v3, 2, s4
  v_lshrrev_b32 v2, 4, v1
  v_add_lshl_u32 v23, v3, v2, 1
  v_lshlrev_b32 v3, 2, v3
  v_lshl_add_u32 v22, v2, 14, v3
  s_mov_b32 s60, s28
  s_and_b32 s61, s29, 0xffff
  s_mov_b32 s62, 7340032
  s_mov_b32 s63, 0x00020000
  s_cmp_eq_u32 s96, 0
  s_cselect_b32 s62, s62, 0
  s_and_b32 s3, s70, 3
  s_lshl_b32 s4, s2, 2
  s_add_u32 s3, s3, s4
  s_mul_i32 s98, s3, 3584
  s_add_u32 s98, s98, 3670016
  s_buffer_load_dword s84, s[60:63], s98 offset:0
  s_buffer_load_dword s84, s[60:63], s98 offset:64
  s_buffer_load_dword s84, s[60:63], s98 offset:128
  s_buffer_load_dword s84, s[60:63], s98 offset:192
  s_waitcnt vmcnt(0)
  s_barrier
  s_lshr_b32 s3, s69, 3
  s_and_b32 s73, s69, 7
  s_lshl1_add_u32 s91, s73, s3
  s_mul_i32 s74, s91, 458752
  s_lshl_b32 s73, s91, 11
  s_mov_b32 s88, s73
  s_add_u32 m0, s77, 0
  s_add_u32 s4, s74, 0
  buffer_load_dwordx4 v8, s[40:43], s4 offen lds
  s_add_u32 m0, s77, 1024
  s_nop 0
  buffer_load_dwordx4 v9, s[40:43], s4 offen lds
  s_add_u32 m0, s77, 8192
  s_add_u32 s4, s74, s78
  buffer_load_dwordx4 v8, s[40:43], s4 offen lds
  s_add_u32 m0, s77, 9216
  s_nop 0
  buffer_load_dwordx4 v9, s[40:43], s4 offen lds
  s_add_u32 m0, s77, 16384
  s_add_u32 s4, s4, 128
  buffer_load_dwordx4 v8, s[40:43], s4 offen lds
  s_add_u32 m0, s77, 17408
  s_nop 0
  buffer_load_dwordx4 v9, s[40:43], s4 offen lds
  s_add_u32 m0, s77, 24576
  s_nop 0
  buffer_load_dwordx4 v28, s[40:43], s74 offen lds
  s_and_b32 s73, s100, 15
  s_cmp_eq_u32 s73, s91
  s_cselect_b32 s74, 4, 0
  s_lshr_b64 s[100:101], s[100:101], s74
  s_and_b32 s73, s100, 15
  s_lshr_b64 s[100:101], s[100:101], 4
  s_mul_i32 s74, s73, 458752
  s_lshl_b32 s73, s73, 11
  s_add_u32 s3, s96, s70
  s_cmp_lg_u32 s3, 4
  s_cbranch_scc1 L_w1_chkNone
  s_add_u32 s44, s22, 41943040
  s_addc_u32 s45, s23, 0
  s_and_b32 s45, s45, 0xffff
  s_mov_b32 s46, 524288
  s_mov_b32 s47, 0x00020000
  v_lshrrev_b32 v2, 2, v1
  v_and_b32 v3, 3, v1
  v_lshlrev_b32 v2, 11, v2
  v_lshl_add_u32 v17, v3, 4, v2
  s_and_b32 s3, s69, 15
  s_lshl_b32 s3, s3, 7
  s_mov_b32 s79, 0x100000
L_w1_chkl:
  buffer_load_dwordx4 v[12:15], v17, s[44:47], s3 offen sc1
  s_sub_u32 s79, s79, 1
  s_cbranch_scc1 L_w1_chkNone
  s_waitcnt vmcnt(0)
  v_and_b32 v12, v12, v13
  v_and_b32 v14, v14, v15
  v_and_b32 v12, v12, v14
  v_cmp_ne_u32 vcc, 1, v12
  s_cbranch_vccnz L_w1_chkl
L_w1_chkNone:
  s_mov_b32 s75, 0
  s_add_u32 s44, s22, 41943040
  s_addc_u32 s45, s23, 0
  s_and_b32 s45, s45, 0xffff
  s_mov_b32 s46, 524288
  s_mov_b32 s47, 0x00020000
  s_lshl4_add_u32 s3, s97, s68
  s_and_b32 s4, s69, 15
  s_lshl4_add_u32 s3, s3, s4
  s_lshl_b32 s3, s3, 7
  s_sub_u32 s3, s3, 32768
  v_lshlrev_b32 v11, 7, v1
  v_and_b32 v2, 15, v1
  v_lshlrev_b32 v2, 2, v2
  s_getreg_b32 s4, hwreg(HW_REG_XCC_ID, 0, 4)
  v_add_u32 v3, 1, s4
  s_mov_b32 s79, 0x100000
  s_waitcnt vmcnt(0)
  s_cmp_lg_u32 s70, 4
  s_barrier
  s_cbranch_scc1 L_w1_nofl
  s_mov_b32 exec_lo, 0xffff
  s_mov_b32 exec_hi, 0
  buffer_store_dword v3, v11, s[44:47], s87 offen sc1
  s_mov_b64 exec, -1
L_w1_nofl:
  s_mov_b32 s5, s3
  s_mov_b32 s89, s73
  s_add_u32 m0, s77, 49152
  s_add_u32 s4, s74, 0
  buffer_load_dwordx4 v8, s[40:43], s4 offen lds
  s_add_u32 m0, s77, 50176
  s_nop 0
  buffer_load_dwordx4 v9, s[40:43], s4 offen lds
  s_add_u32 m0, s77, 57344
  s_add_u32 s4, s74, s78
  buffer_load_dwordx4 v8, s[40:43], s4 offen lds
  s_add_u32 m0, s77, 58368
  s_nop 0
  buffer_load_dwordx4 v9, s[40:43], s4 offen lds
  s_add_u32 m0, s77, 65536
  s_add_u32 s4, s4, 128
  buffer_load_dwordx4 v8, s[40:43], s4 offen lds
  s_add_u32 m0, s77, 66560
  s_nop 0
  buffer_load_dwordx4 v9, s[40:43], s4 offen lds
  s_add_u32 m0, s77, 73728
  s_nop 0
  buffer_load_dwordx4 v28, s[40:43], s74 offen lds
  s_and_b32 s73, s100, 15
  s_cmp_eq_u32 s73, s91
  s_cselect_b32 s74, 4, 0
  s_lshr_b64 s[100:101], s[100:101], s74
  s_and_b32 s73, s100, 15
  s_lshr_b64 s[100:101], s[100:101], 4
  s_mul_i32 s74, s73, 458752
  s_lshl_b32 s73, s73, 11
  s_mov_b32 s90, s73
  s_add_u32 m0, s77, 98304
  s_add_u32 s4, s74, 0
  buffer_load_dwordx4 v8, s[40:43], s4 offen lds
  s_add_u32 m0, s77, 99328
  s_nop 0
  buffer_load_dwordx4 v9, s[40:43], s4 offen lds
  s_add_u32 m0, s77, 106496
  s_add_u32 s4, s74, s78
  buffer_load_dwordx4 v8, s[40:43], s4 offen lds
  s_add_u32 m0, s77, 107520
  s_nop 0
  buffer_load_dwordx4 v9, s[40:43], s4 offen lds
  s_add_u32 m0, s77, 114688
  s_add_u32 s4, s4, 128
  buffer_load_dwordx4 v8, s[40:43], s4 offen lds
  s_add_u32 m0, s77, 115712
  s_nop 0
  buffer_load_dwordx4 v9, s[40:43], s4 offen lds
  s_add_u32 m0, s77, 122880
  s_nop 0
  buffer_load_dwordx4 v28, s[40:43], s74 offen lds
  s_and_b32 s73, s100, 15
  s_cmp_eq_u32 s73, s91
  s_cselect_b32 s74, 4, 0
  s_lshr_b64 s[100:101], s[100:101], s74
  s_and_b32 s73, s100, 15
  s_lshr_b64 s[100:101], s[100:101], 4
  s_mul_i32 s74, s73, 458752
  s_lshl_b32 s73, s73, 11
  s_mov_b32 s3, s5
  s_cmp_lg_u32 s70, 4
  s_cbranch_scc1 L_w1_dep
L_w1_poll:
  buffer_load_dword v27, v2, s[44:47], s3 offen sc1
  s_sub_u32 s79, s79, 1
  s_cbranch_scc1 L_w1_dep
  s_waitcnt vmcnt(0)
  v_cmp_eq_u32 vcc, 0, v27
  s_cbranch_vccnz L_w1_poll
L_w1_dep:
  s_barrier
  s_add_u32 m0, s76, 49152
  s_nop 0
  buffer_load_dwordx4 v4, s[36:39], s89 offen offset:0 lds
  buffer_load_dwordx4 v4, s[36:39], s89 offen offset:1024 lds
  s_add_u32 m0, s76, 51200
  s_nop 0
  buffer_load_dwordx4 v5, s[36:39], s89 offen offset:0 lds
  buffer_load_dwordx4 v5, s[36:39], s89 offen offset:1024 lds
  s_add_u32 m0, s76, 98304
  s_nop 0
  buffer_load_dwordx4 v4, s[36:39], s90 offen offset:0 lds
  buffer_load_dwordx4 v4, s[36:39], s90 offen offset:1024 lds
  s_add_u32 m0, s76, 100352
  s_nop 0
  buffer_load_dwordx4 v5, s[36:39], s90 offen offset:0 lds
  buffer_load_dwordx4 v5, s[36:39], s90 offen offset:1024 lds
  s_waitcnt vmcnt(4)
  s_barrier
  s_mov_b32 s79, 13
L_w1_ld1:
  s_add_u32 s3, s75, s76
  s_add_u32 m0, s3, 0
  s_nop 0
  buffer_load_dwordx4 v4, s[36:39], s73 offen offset:0 lds
  buffer_load_dwordx4 v4, s[36:39], s73 offen offset:1024 lds
  s_add_u32 m0, s3, 2048
  s_nop 0
  buffer_load_dwordx4 v5, s[36:39], s73 offen offset:0 lds
  buffer_load_dwordx4 v5, s[36:39], s73 offen offset:1024 lds
  s_add_u32 s3, s75, s77
  s_add_u32 m0, s3, 0
  s_add_u32 s4, s74, 0
  buffer_load_dwordx4 v8, s[40:43], s4 offen lds
  s_add_u32 m0, s3, 1024
  s_nop 0
  buffer_load_dwordx4 v9, s[40:43], s4 offen lds
  s_add_u32 m0, s3, 8192
  s_add_u32 s4, s74, s78
  buffer_load_dwordx4 v8, s[40:43], s4 offen lds
  s_add_u32 m0, s3, 9216
  s_nop 0
  buffer_load_dwordx4 v9, s[40:43], s4 offen lds
  s_add_u32 m0, s3, 16384
  s_add_u32 s4, s4, 128
  buffer_load_dwordx4 v8, s[40:43], s4 offen lds
  s_add_u32 m0, s3, 17408
  s_nop 0
  buffer_load_dwordx4 v9, s[40:43], s4 offen lds
  s_add_u32 m0, s3, 24576
  s_nop 0
  buffer_load_dwordx4 v28, s[40:43], s74 offen lds
  s_and_b32 s73, s100, 15
  s_cmp_eq_u32 s73, s91
  s_cselect_b32 s74, 4, 0
  s_lshr_b64 s[100:101], s[100:101], s74
  s_and_b32 s73, s100, 15
  s_lshr_b64 s[100:101], s[100:101], 4
  s_mul_i32 s74, s73, 458752
  s_lshl_b32 s73, s73, 11
  s_add_u32 s75, s75, 49152
  s_cmp_eq_u32 s75, 147456
  s_cselect_b32 s75, 0, s75
  s_buffer_load_dword s84, s[60:63], s98 offset:256
  s_buffer_load_dword s84, s[60:63], s98 offset:320
  s_buffer_load_dword s84, s[60:63], s98 offset:384
  s_buffer_load_dword s84, s[60:63], s98 offset:448
  s_add_u32 s98, s98, 256
  s_waitcnt vmcnt(11)
  s_barrier
  s_sub_u32 s79, s79, 1
  s_cmp_lg_u32 s79, 0
  s_cbranch_scc1 L_w1_ld1
  buffer_load_dwordx4 v[32:35], v18, s[56:59], 0 offen
  s_mov_b32 s3, 65536
  buffer_load_dwordx4 v[36:39], v18, s[56:59], s3 offen
  s_mov_b32 s3, 131072
  buffer_load_dwordx4 v[40:43], v18, s[56:59], s3 offen
  s_mov_b32 s3, 196608
  buffer_load_dwordx4 v[44:47], v18, s[56:59], s3 offen
  s_cmp_lg_u32 s96, 0
  s_cbranch_scc1 L_w1_cl
  buffer_load_dwordx4 v[64:67], v22, s[64:67], 0 offen
  s_mov_b32 s3, 65536
  buffer_load_dwordx4 v[68:71], v22, s[64:67], s3 offen
  s_mov_b32 s3, 131072
  buffer_load_dwordx4 v[72:75], v22, s[64:67], s3 offen
  s_mov_b32 s3, 196608
  buffer_load_dwordx4 v[76:79], v22, s[64:67], s3 offen
  buffer_load_ushort v80, v23, s[52:55], 0 offen
  s_branch L_w1_cle
  L_w1_cl:
  s_waitcnt vmcnt(4)
  L_w1_cle:
  s_waitcnt vmcnt(9)
  s_barrier
  s_waitcnt vmcnt(0)
  s_cmp_lg_u32 s96, 0
  s_cbranch_scc1 L_w1_cp
  s_and_b32 s3, s70, 3
  s_lshl_b32 s5, s3, 9
  s_add_u32 s5, s5, 106496
  v_lshrrev_b32 v2, 5, v1
  v_and_b32 v3, 15, v1
  v_lshl_add_u32 v2, v3, 1, v2
  v_lshl_add_u32 v205, v2, 4, s5
  v_add_f32 v64, v64, v68
  v_add_f32 v65, v65, v69
  v_add_f32 v66, v66, v70
  v_add_f32 v67, v67, v71
  v_add_f32 v72, v72, v76
  v_add_f32 v73, v73, v77
  v_add_f32 v74, v74, v78
  v_add_f32 v75, v75, v79
  v_add_f32 v64, v64, v72
  v_add_f32 v65, v65, v73
  v_add_f32 v66, v66, v74
  v_add_f32 v67, v67, v75
  s_nop 1
  v_permlane32_swap_b32 v64, v66
  v_permlane32_swap_b32 v65, v67
  v_add_f32 v64, v64, v66
  v_add_f32 v65, v65, v67
  v_lshl_or_b32 v203, v80, 16, v80
  s_lshl_b32 s5, s3, 10
  s_add_u32 s5, s5, 110592
  v_permlane16_swap_b32 v64, v65
  v_lshrrev_b32 v2, 4, v1
  v_lshl_add_u32 v2, v3, 2, v2
  v_lshl_add_u32 v204, v2, 4, s5
  v_add_f32 v64, v64, v65
  v_cvt_pk_bf16_f32 v200, v64, v64
  v_and_b32 v65, 0xffff0000, v200
  v_sub_f32 v65, v64, v65
  v_cvt_pk_bf16_f32 v201, v64, v65
  v_and_b32 v202, 0xffff0000, v201
  v_sub_f32 v65, v65, v202
  v_cvt_pk_bf16_f32 v202, v65, v64
  v_mov_b32 v200, v201
  L_w1_cp:
  ds_write_b128 v204, v[200:203]
  v_add_f32 v32, v32, v36
  v_add_f32 v33, v33, v37
  v_add_f32 v34, v34, v38
  v_add_f32 v35, v35, v39
  v_add_f32 v40, v40, v44
  v_add_f32 v41, v41, v45
  v_add_f32 v42, v42, v46
  v_add_f32 v43, v43, v47
  v_add_f32 v32, v32, v40
  v_add_f32 v33, v33, v41
  v_add_f32 v34, v34, v42
  v_add_f32 v35, v35, v43
  s_nop 1
  v_permlane32_swap_b32 v32, v34
  v_permlane32_swap_b32 v33, v35
  v_add_f32 v32, v32, v34
  v_add_f32 v33, v33, v35
  v_mov_b32 v34, v32
  v_mov_b32 v35, v33
  s_nop 0
  v_permlane16_swap_b32 v32, v34
  v_permlane16_swap_b32 v33, v35
  v_add_f32 v32, v32, v34
  v_add_f32 v33, v33, v35
  v_mul_f32 v32, 0x3a800000, v32
  v_mul_f32 v33, 0x3a800000, v33
  v_fma_f32 v33, -v32, v32, v33
  v_max_f32 v33, 0, v33
  v_add_f32 v33, 0x3727c5ac, v33
  v_rsq_f32 v34, v33
  v_mul_f32 v32, -0.5, v32
  v_cvt_pk_bf16_f32 v36, v32, v32
  v_and_b32 v35, 0xffff0000, v36
  v_sub_f32 v35, v32, v35
  v_cvt_pk_bf16_f32 v37, v35, v35
  v_and_b32 v38, 0xffff0000, v37
  v_sub_f32 v35, v35, v38
  v_cvt_pk_bf16_f32 v38, v32, v35
  v_mul_f32 v42, v33, v34
  v_mul_f32 v40, 0xc0135761, v34
  v_mul_f32 v34, v34, v34
  v_mul_f32 v33, 0.5, v42
  v_mul_f32 v34, 0x3d372713, v34
  v_cvt_pk_bf16_f32 v35, v33, v33
  v_mul_f32 v41, v40, v34
  v_and_b32 v35, 0xffff0000, v35
  v_xor_b32_dpp v43, v27, v27 row_ror:2 row_mask:0xf bank_mask:0xf
  v_sub_f32 v35, v33, v35
  v_cmp_ne_u32 vcc, 0, v43
  v_cvt_pk_bf16_f32 v39, v33, v35
  s_or_b32 s92, vcc_lo, vcc_hi
  v_mov_b32 v43, s92
  ds_write_b128 v205, v[36:39]
  ds_write_b128 v205, v[40:43] offset:2048
  s_waitcnt lgkmcnt(0)
  s_barrier
  s_lshl_b32 s87, s97, 15
  s_lshl_b32 s4, s68, 11
  s_add_u32 s87, s87, s4
  s_lshl_b32 s4, s69, 2
  s_add_u32 s87, s87, s4
  s_add_u32 s97, s97, 1
  s_branch L_w2_body
L_w1_end:
  s_endpgm
L_w1_compute:
  s_and_b32 s71, s70, 1
  s_lshr_b32 s72, s70, 1
  v_and_b32 v3, 15, v1
  v_lshrrev_b32 v2, 4, v1
  s_lshl_b32 s8, s71, 13
  v_lshl_add_u32 v4, v1, 4, s8
  v_lshrrev_b32 v13, 2, v1
  v_lshlrev_b32 v13, 7, v13
  v_and_b32 v17, 3, v1
  v_lshl_add_u32 v13, v17, 3, v13
  v_bfe_u32 v17, v1, 3, 2
  v_lshl_add_u32 v13, v17, 5, v13
  s_lshl_b32 s9, s72, 6
  v_xor_b32 v13, s9, v13
  v_add_u32 v5, 16384, v13
  v_xor_b32 v6, 32, v5
  v_and_b32 v16, 1, v2
  v_lshrrev_b32 v17, 1, v2
  v_lshrrev_b32 v13, 2, v1
  v_and_b32 v14, 1, v1
  v_lshl_add_u32 v13, v13, 1, v14
  v_xor_b32 v14, s72, v16
  v_lshl_add_u32 v13, v13, 1, v14
  v_bfe_u32 v14, v1, 1, 1
  v_lshl_add_u32 v13, v13, 1, v14
  v_lshlrev_b32 v13, 3, v13
  v_add_u32 v7, 40960, v13
  s_mov_b32 s75, 0
  v_add_u32_e64 v20, s75, v4
  v_add_u32_e64 v21, s75, v5
  v_add_u32_e64 v22, s75, v6
  v_add_u32_e64 v23, s75, v7
  s_add_u32 s75, s75, 49152
  s_cmp_eq_u32 s75, 147456
  s_cselect_b32 s75, 0, s75
  s_mov_b32 s79, 15
  ds_read_b128 v[32:35], v20 offset:0
  ds_read_b128 v[36:39], v20 offset:2048
  ds_read_b128 v[40:43], v20 offset:4096
  ds_read_b128 v[44:47], v20 offset:6144
  ds_read_b64_tr_b16 v[48:49], v21 offset:0
  ds_read_b64_tr_b16 v[50:51], v21 offset:2048
  ds_read_b64_tr_b16 v[52:53], v22 offset:0
  ds_read_b64_tr_b16 v[54:55], v22 offset:2048
  ds_read_b64_tr_b16 v[56:57], v21 offset:8192
  ds_read_b64_tr_b16 v[58:59], v21 offset:10240
  ds_read_b64_tr_b16 v[60:61], v22 offset:8192
  ds_read_b64_tr_b16 v[62:63], v22 offset:10240
  ds_read_b64_tr_b16 v[64:65], v21 offset:16384
  ds_read_b64_tr_b16 v[66:67], v21 offset:18432
  ds_read_b64_tr_b16 v[68:69], v22 offset:16384
  ds_read_b64_tr_b16 v[70:71], v22 offset:18432
  ds_read_b64_tr_b16 v[72:73], v23 offset:0
  ds_read_b64_tr_b16 v[74:75], v23 offset:2048
  s_waitcnt lgkmcnt(0)
  v_mfma_f32_16x16x32_bf16 v[128:131], v[48:51], v[32:35], 0
  ds_read_b128 v[80:83], v20 offset:1024
  v_mfma_f32_16x16x32_bf16 v[132:135], v[48:51], v[36:39], 0
  ds_read_b128 v[84:87], v20 offset:3072
  v_mfma_f32_16x16x32_bf16 v[136:139], v[48:51], v[40:43], 0
  ds_read_b128 v[88:91], v20 offset:5120
  v_mfma_f32_16x16x32_bf16 v[140:143], v[48:51], v[44:47], 0
  ds_read_b128 v[92:95], v20 offset:7168
  v_mfma_f32_16x16x32_bf16 v[156:159], v[52:55], v[44:47], 0
  ds_read_b64_tr_b16 v[96:97], v21 offset:4096
  v_mfma_f32_16x16x32_bf16 v[152:155], v[52:55], v[40:43], 0
  ds_read_b64_tr_b16 v[98:99], v21 offset:6144
  v_mfma_f32_16x16x32_bf16 v[148:151], v[52:55], v[36:39], 0
  ds_read_b64_tr_b16 v[100:101], v22 offset:4096
  v_mfma_f32_16x16x32_bf16 v[144:147], v[52:55], v[32:35], 0
  ds_read_b64_tr_b16 v[102:103], v22 offset:6144
  v_mfma_f32_16x16x32_bf16 v[160:163], v[56:59], v[32:35], 0
  ds_read_b64_tr_b16 v[104:105], v21 offset:12288
  v_mfma_f32_16x16x32_bf16 v[164:167], v[56:59], v[36:39], 0
  ds_read_b64_tr_b16 v[106:107], v21 offset:14336
  v_mfma_f32_16x16x32_bf16 v[168:171], v[56:59], v[40:43], 0
  ds_read_b64_tr_b16 v[108:109], v22 offset:12288
  v_mfma_f32_16x16x32_bf16 v[172:175], v[56:59], v[44:47], 0
  ds_read_b64_tr_b16 v[110:111], v22 offset:14336
  v_mfma_f32_16x16x32_bf16 v[188:191], v[60:63], v[44:47], 0
  ds_read_b64_tr_b16 v[112:113], v21 offset:20480
  v_mfma_f32_16x16x32_bf16 v[184:187], v[60:63], v[40:43], 0
  ds_read_b64_tr_b16 v[114:115], v21 offset:22528
  v_mfma_f32_16x16x32_bf16 v[180:183], v[60:63], v[36:39], 0
  ds_read_b64_tr_b16 v[116:117], v22 offset:20480
  v_mfma_f32_16x16x32_bf16 v[176:179], v[60:63], v[32:35], 0
  ds_read_b64_tr_b16 v[118:119], v22 offset:22528
  v_mfma_f32_16x16x32_bf16 v[192:195], v[64:67], v[32:35], 0
  ds_read_b64_tr_b16 v[120:121], v23 offset:4096
  v_mfma_f32_16x16x32_bf16 v[196:199], v[64:67], v[36:39], 0
  ds_read_b64_tr_b16 v[122:123], v23 offset:6144
  v_mfma_f32_16x16x32_bf16 v[200:203], v[64:67], v[40:43], 0
  v_add_u32_e64 v20, s75, v4
  v_mfma_f32_16x16x32_bf16 v[204:207], v[64:67], v[44:47], 0
  v_add_u32_e64 v21, s75, v5
  v_mfma_f32_16x16x32_bf16 v[220:223], v[68:71], v[44:47], 0
  v_add_u32_e64 v22, s75, v6
  v_mfma_f32_16x16x32_bf16 v[216:219], v[68:71], v[40:43], 0
  v_add_u32_e64 v23, s75, v7
  v_mfma_f32_16x16x32_bf16 v[212:215], v[68:71], v[36:39], 0
  s_add_u32 s75, s75, 49152
  v_mfma_f32_16x16x32_bf16 v[208:211], v[68:71], v[32:35], 0
  s_cmp_eq_u32 s75, 147456
  v_mfma_f32_16x16x32_bf16 v[224:227], v[72:75], v[32:35], 0
  s_cselect_b32 s75, 0, s75
  v_mfma_f32_16x16x32_bf16 v[228:231], v[72:75], v[36:39], 0
  v_mfma_f32_16x16x32_bf16 v[232:235], v[72:75], v[40:43], 0
  v_mfma_f32_16x16x32_bf16 v[236:239], v[72:75], v[44:47], 0
  s_waitcnt lgkmcnt(0)
  v_mfma_f32_16x16x32_bf16 v[128:131], v[96:99], v[80:83], v[128:131]
  v_mfma_f32_16x16x32_bf16 v[132:135], v[96:99], v[84:87], v[132:135]
  v_mfma_f32_16x16x32_bf16 v[136:139], v[96:99], v[88:91], v[136:139]
  v_mfma_f32_16x16x32_bf16 v[140:143], v[96:99], v[92:95], v[140:143]
  v_mfma_f32_16x16x32_bf16 v[156:159], v[100:103], v[92:95], v[156:159]
  v_mfma_f32_16x16x32_bf16 v[152:155], v[100:103], v[88:91], v[152:155]
  v_mfma_f32_16x16x32_bf16 v[148:151], v[100:103], v[84:87], v[148:151]
  v_mfma_f32_16x16x32_bf16 v[144:147], v[100:103], v[80:83], v[144:147]
  v_mfma_f32_16x16x32_bf16 v[160:163], v[104:107], v[80:83], v[160:163]
  v_mfma_f32_16x16x32_bf16 v[164:167], v[104:107], v[84:87], v[164:167]
  v_mfma_f32_16x16x32_bf16 v[168:171], v[104:107], v[88:91], v[168:171]
  v_mfma_f32_16x16x32_bf16 v[172:175], v[104:107], v[92:95], v[172:175]
  v_mfma_f32_16x16x32_bf16 v[188:191], v[108:111], v[92:95], v[188:191]
  v_mfma_f32_16x16x32_bf16 v[184:187], v[108:111], v[88:91], v[184:187]
  v_mfma_f32_16x16x32_bf16 v[180:183], v[108:111], v[84:87], v[180:183]
  v_mfma_f32_16x16x32_bf16 v[176:179], v[108:111], v[80:83], v[176:179]
  v_mfma_f32_16x16x32_bf16 v[192:195], v[112:115], v[80:83], v[192:195]
  v_mfma_f32_16x16x32_bf16 v[196:199], v[112:115], v[84:87], v[196:199]
  v_mfma_f32_16x16x32_bf16 v[200:203], v[112:115], v[88:91], v[200:203]
  v_mfma_f32_16x16x32_bf16 v[204:207], v[112:115], v[92:95], v[204:207]
  v_mfma_f32_16x16x32_bf16 v[220:223], v[116:119], v[92:95], v[220:223]
  v_mfma_f32_16x16x32_bf16 v[216:219], v[116:119], v[88:91], v[216:219]
  v_mfma_f32_16x16x32_bf16 v[212:215], v[116:119], v[84:87], v[212:215]
  v_mfma_f32_16x16x32_bf16 v[208:211], v[116:119], v[80:83], v[208:211]
  v_mfma_f32_16x16x32_bf16 v[224:227], v[120:123], v[80:83], v[224:227]
  v_mfma_f32_16x16x32_bf16 v[228:231], v[120:123], v[84:87], v[228:231]
  v_mfma_f32_16x16x32_bf16 v[232:235], v[120:123], v[88:91], v[232:235]
  v_mfma_f32_16x16x32_bf16 v[236:239], v[120:123], v[92:95], v[236:239]
  s_lshl_b32 s8, s68, 7
  s_lshl_b32 s9, s71, 6
  s_add_u32 s8, s8, s9
  s_mul_i32 s8, s8, 7168
  v_lshlrev_b32 v14, 8, v17
  v_lshl_add_u32 v14, v3, 4, v14
  s_lshl3_add_u32 s9, s71, s72
  s_lshl_b32 s9, s9, 10
  s_add_u32 s9, s9, 114688
  v_lshl_add_u32 v18, v1, 4, s9
  s_mov_b32 s52, s30
  s_and_b32 s53, s31, 0xffff
  s_mov_b32 s54, 2048
  s_mov_b32 s55, 0x00020000
  s_lshr_b32 s9, s69, 3
  s_and_b32 s10, s69, 7
  s_lshl1_add_u32 s9, s10, s9
  s_lshl_b32 s9, s9, 7
  v_lshl_add_u32 v19, v2, 3, s9
  v_add_u32 v14, s8, v14
  s_lshl_b32 s10, s69, 11
  s_lshl_b32 s9, s72, 10
  s_add_u32 s9, s9, s10
  v_lshl_add_u32 v12, v1, 4, s8
  v_add_u32 v12, s9, v12
  v_mul_u32_u24 v16, 114688, v16
  s_lshr_b32 s9, s9, 1
  v_add3_u32 v13, v16, v14, s9
  s_lshl_b32 s9, s71, 10
  s_add_u32 s9, s9, 106496
  v_lshl_add_u32 v14, v3, 4, s9
  s_lshl_b32 s9, s72, 9
  s_add_u32 s9, s9, 110592
  v_lshl_add_u32 v15, v3, 4, s9
  v_bfe_u32 v16, v1, 2, 1
  v_bfe_u32 v17, v1, 3, 1
  v_lshl_add_u32 v17, v16, 2, v17
  v_and_b32 v16, 3, v1
  v_lshl_add_u32 v17, v17, 2, v16
  s_lshl_b32 s9, s72, 7
  s_add_u32 s9, s9, 110592
  v_lshl_add_u32 v16, v17, 4, s9
  v_bfe_u32 v17, v1, 4, 1
  v_lshl_add_u32 v14, v17, 3, v14
  v_lshl_add_u32 v15, v17, 3, v15
  v_lshl_add_u32 v16, v17, 3, v16
  v_mov_b32 v17, 108556
  s_add_u32 s44, s34, 8388608
  s_addc_u32 s45, s35, 0
  s_and_b32 s45, s45, 0xffff
  s_mov_b32 s46, 14680064
  s_mov_b32 s47, 0x00020000
  s_lshr_b32 s3, s69, 3
  s_and_b32 s78, s69, 7
  s_lshl1_add_u32 s69, s78, s3
  s_add_u32 s3, s68, s78
  s_and_b32 s3, s3, 3
  s_mov_b32 s4, 0x1616160
  s_cmp_eq_u32 s3, 1
  s_cselect_b32 s4, 0x5858580, s4
  s_cmp_eq_u32 s3, 2
  s_cselect_b32 s4, 0x16161600, s4
  s_cmp_eq_u32 s3, 3
  s_cselect_b32 s4, 0x58585800, s4
  v_subrev_u32 v2, 3, v1
  v_min_u32 v2, 16, v2
  v_lshlrev_b32 v3, 1, v2
  v_bfe_i32 v30, s4, v3, 2
  v_sub_u32 v30, v1, v30
  v_subrev_u32 v30, 7, v30
  v_ashrrev_i32 v3, 1, v30
  v_cmp_eq_u32 vcc, s78, v3
  s_and_b32 s3, s69, 1
  v_or_b32 v2, 14, v30
  v_cndmask_b32 v2, v30, v2, vcc
  v_cmp_gt_i32 vcc, 0, v30
  s_lshl2_add_u32 s4, s3, 20
  v_add_u32 v30, s4, v30
  s_lshl4_add_u32 s4, s3, 24
  v_add_u32 v2, s4, v2
  v_cndmask_b32 v30, v2, v30, vcc
  s_and_b32 s5, s68, 3
  s_mul_i32 s5, s5, 3
  s_sub_u32 s5, s5, 23
  v_add_u32 v3, s5, v1
  v_subrev_u32 v2, 10, v3
  v_min_u32 v3, v3, v2
  v_subrev_u32 v2, 10, v3
  v_min_u32 v3, v3, v2
  v_cmp_gt_u32 vcc, 23, v1
  s_sub_u32 s5, s3, 46
  v_lshl_add_u32 v2, v1, 1, s5
  v_cndmask_b32 v3, v3, v2, vcc
  s_add_u32 s5, s78, 3
  v_ashrrev_i32 v2, 1, v3
  v_add_u32 v2, s5, v2
  v_and_b32 v2, 7, v2
  v_cmp_gt_u32 vcc, 21, v1
  v_and_b32 v3, 1, v3
  v_lshl_add_u32 v3, v3, 3, v2
  v_cndmask_b32 v3, v3, v30, vcc
  v_lshlrev_b32 v30, 11, v3
  s_barrier
  v_and_b32 v3, 15, v1
  v_lshrrev_b32 v2, 4, v1
  s_lshl_b32 s8, s68, 7
  s_lshl_b32 s9, s70, 5
  s_add_u32 s8, s8, s9
  v_add_u32 v76, s8, v3
  s_lshl_b32 s14, s69, 7
  v_lshrrev_b32 v79, 1, v2
  v_lshlrev_b32 v26, 3, v3
  v_and_b32 v26, 0x70, v26
  v_lshlrev_b32 v78, 3, v2
  v_xor_b32 v26, v26, v78
  v_lshl_add_u32 v26, v3, 7, v26
  s_lshl_b32 s3, s70, 12
  v_add_u32 v26, s3, v26
  v_lshl_add_u32 v27, v1, 4, s3
  s_cmp_eq_u32 s96, 0
  s_cselect_b32 s7, 128, 0
  s_add_u32 s7, s7, 2048
  v_xor_b32 v78, v1, v2
  v_and_b32 v78, 7, v78
  v_lshl_add_u32 v78, v78, 4, s14
  v_lshrrev_b32 v77, 3, v1
  v_add_u32 v77, s8, v77
  v_mad_u32_u24 v28, v77, s7, v78
  v_lshl_add_u32 v29, v79, 4, v76
  v_lshlrev_b32 v29, 3, v29
  v_and_b32 v78, 1, v2
  v_lshl_add_u32 v29, v78, 2, v29
  s_lshl_b32 s14, s69, 14
  v_add_u32 v29, s14, v29
  v_lshrrev_b32 v8, 2, v1
  v_lshlrev_b32 v8, 7, v8
  v_and_b32 v79, 3, v1
  v_lshl_add_u32 v8, v79, 3, v8
  v_bfe_u32 v79, v1, 3, 2
  v_lshl_add_u32 v8, v79, 5, v8
  s_mov_b32 s11, 0xffff0000
  s_add_u32 s36, s34, 8388608
  s_addc_u32 s37, s35, 0
  s_and_b32 s37, s37, 0xffff
  s_mov_b32 s40, s32
  s_and_b32 s41, s33, 0xffff
  s_mov_b32 s43, 0x00020000
  s_add_u32 s48, s22, 33554432
  s_addc_u32 s49, s23, 0
  s_and_b32 s49, s49, 0xffff
  s_cmp_eq_u32 s96, 0
  s_cselect_b64 s[40:41], s[48:49], s[40:41]
  s_lshl_b32 s42, s7, 11
  s_add_u32 s56, s34, 24379392
  s_addc_u32 s57, s35, 0
  s_and_b32 s57, s57, 0xffff
  s_mov_b32 s58, 262144
  s_mov_b32 s59, 0x00020000
  s_mul_i32 s9, s8, 7168
  s_add_u32 s36, s36, s9
  s_addc_u32 s37, s37, 0x100000
  s_add_u32 s64, s36, 114688
  s_addc_u32 s65, s37, 0
  s_mov_b32 s38, 114688
  s_mov_b32 s39, 0x00800000
  s_mov_b32 s66, 114688
  s_mov_b32 s67, 0x00800000
  s_add_u32 s60, s34, 25165824
  s_addc_u32 s61, s35, 0
  s_and_b32 s61, s61, 0xffff
  s_mov_b32 s62, 4194304
  s_or_b32 s61, s61, 0x100000
  s_mov_b32 s63, 0x00800000
  s_lshl4_add_u32 s4, s68, s69
  s_lshl2_add_u32 s4, s4, s70
  s_add_u32 s6, s96, 4
  s_lshl_b32 s6, s6, 10
  s_add_u32 s6, s6, s4
  s_lshl_b32 s6, s6, 6
  s_lshl_b32 s4, s4, 12
  s_xor_b32 s5, s4, 16384
  v_readlane_b32 s51, v30, 3
  v_readlane_b32 s48, v30, 4
  v_readlane_b32 s49, v30, 5
  s_barrier
  ds_read_b128 v[32:35], v20 offset:0
  ds_read_b128 v[36:39], v20 offset:2048
  ds_read_b128 v[40:43], v20 offset:4096
  ds_read_b128 v[44:47], v20 offset:6144
  ds_read_b64_tr_b16 v[48:49], v21 offset:0
  ds_read_b64_tr_b16 v[50:51], v21 offset:2048
  ds_read_b64_tr_b16 v[52:53], v22 offset:0
  ds_read_b64_tr_b16 v[54:55], v22 offset:2048
  ds_read_b64_tr_b16 v[56:57], v21 offset:8192
  ds_read_b64_tr_b16 v[58:59], v21 offset:10240
  ds_read_b64_tr_b16 v[60:61], v22 offset:8192
  ds_read_b64_tr_b16 v[62:63], v22 offset:10240
  ds_read_b64_tr_b16 v[64:65], v21 offset:16384
  ds_read_b64_tr_b16 v[66:67], v21 offset:18432
  ds_read_b64_tr_b16 v[68:69], v22 offset:16384
  ds_read_b64_tr_b16 v[70:71], v22 offset:18432
  ds_read_b64_tr_b16 v[72:73], v23 offset:0
  ds_read_b64_tr_b16 v[74:75], v23 offset:2048
.p2align 5
  s_nop 0
  s_nop 0
  s_nop 0
  s_waitcnt lgkmcnt(0)
L_w1_loop:
  v_mfma_f32_16x16x32_bf16 v[128:131], v[48:51], v[32:35], v[128:131]
  ds_read_b128 v[80:83], v20 offset:1024
  v_mfma_f32_16x16x32_bf16 v[132:135], v[48:51], v[36:39], v[132:135]
  ds_read_b128 v[84:87], v20 offset:3072
  v_mfma_f32_16x16x32_bf16 v[136:139], v[48:51], v[40:43], v[136:139]
  ds_read_b128 v[88:91], v20 offset:5120
  v_mfma_f32_16x16x32_bf16 v[140:143], v[48:51], v[44:47], v[140:143]
  ds_read_b128 v[92:95], v20 offset:7168
  v_mfma_f32_16x16x32_bf16 v[156:159], v[52:55], v[44:47], v[156:159]
  ds_read_b64_tr_b16 v[96:97], v21 offset:4096
  v_mfma_f32_16x16x32_bf16 v[152:155], v[52:55], v[40:43], v[152:155]
  ds_read_b64_tr_b16 v[98:99], v21 offset:6144
  v_mfma_f32_16x16x32_bf16 v[148:151], v[52:55], v[36:39], v[148:151]
  ds_read_b64_tr_b16 v[100:101], v22 offset:4096
  v_mfma_f32_16x16x32_bf16 v[144:147], v[52:55], v[32:35], v[144:147]
  ds_read_b64_tr_b16 v[102:103], v22 offset:6144
  v_mfma_f32_16x16x32_bf16 v[160:163], v[56:59], v[32:35], v[160:163]
  ds_read_b64_tr_b16 v[104:105], v21 offset:12288
  v_mfma_f32_16x16x32_bf16 v[164:167], v[56:59], v[36:39], v[164:167]
  ds_read_b64_tr_b16 v[106:107], v21 offset:14336
  v_mfma_f32_16x16x32_bf16 v[168:171], v[56:59], v[40:43], v[168:171]
  ds_read_b64_tr_b16 v[108:109], v22 offset:12288
  v_mfma_f32_16x16x32_bf16 v[172:175], v[56:59], v[44:47], v[172:175]
  ds_read_b64_tr_b16 v[110:111], v22 offset:14336
  v_mfma_f32_16x16x32_bf16 v[188:191], v[60:63], v[44:47], v[188:191]
  ds_read_b64_tr_b16 v[112:113], v21 offset:20480
  v_mfma_f32_16x16x32_bf16 v[184:187], v[60:63], v[40:43], v[184:187]
  ds_read_b64_tr_b16 v[114:115], v21 offset:22528
  v_mfma_f32_16x16x32_bf16 v[180:183], v[60:63], v[36:39], v[180:183]
  ds_read_b64_tr_b16 v[116:117], v22 offset:20480
  v_mfma_f32_16x16x32_bf16 v[176:179], v[60:63], v[32:35], v[176:179]
  ds_read_b64_tr_b16 v[118:119], v22 offset:22528
  v_mfma_f32_16x16x32_bf16 v[192:195], v[64:67], v[32:35], v[192:195]
  ds_read_b64_tr_b16 v[120:121], v23 offset:4096
  v_mfma_f32_16x16x32_bf16 v[196:199], v[64:67], v[36:39], v[196:199]
  ds_read_b64_tr_b16 v[122:123], v23 offset:6144
  v_mfma_f32_16x16x32_bf16 v[200:203], v[64:67], v[40:43], v[200:203]
  v_add_u32_e64 v20, s75, v4
  v_mfma_f32_16x16x32_bf16 v[204:207], v[64:67], v[44:47], v[204:207]
  v_add_u32_e64 v21, s75, v5
  v_mfma_f32_16x16x32_bf16 v[220:223], v[68:71], v[44:47], v[220:223]
  v_add_u32_e64 v22, s75, v6
  v_mfma_f32_16x16x32_bf16 v[216:219], v[68:71], v[40:43], v[216:219]
  v_add_u32_e64 v23, s75, v7
  v_mfma_f32_16x16x32_bf16 v[212:215], v[68:71], v[36:39], v[212:215]
  s_add_u32 s75, s75, 49152
  v_mfma_f32_16x16x32_bf16 v[208:211], v[68:71], v[32:35], v[208:211]
  s_cmp_eq_u32 s75, 147456
  v_mfma_f32_16x16x32_bf16 v[224:227], v[72:75], v[32:35], v[224:227]
  s_cselect_b32 s75, 0, s75
  s_sub_u32 s79, s79, 1
  v_mfma_f32_16x16x32_bf16 v[228:231], v[72:75], v[36:39], v[228:231]
  v_mfma_f32_16x16x32_bf16 v[232:235], v[72:75], v[40:43], v[232:235]
  v_mfma_f32_16x16x32_bf16 v[236:239], v[72:75], v[44:47], v[236:239]
  s_waitcnt lgkmcnt(0)
  s_barrier
  v_mfma_f32_16x16x32_bf16 v[128:131], v[96:99], v[80:83], v[128:131]
  ds_read_b128 v[32:35], v20 offset:0
  v_mfma_f32_16x16x32_bf16 v[132:135], v[96:99], v[84:87], v[132:135]
  ds_read_b128 v[36:39], v20 offset:2048
  v_mfma_f32_16x16x32_bf16 v[136:139], v[96:99], v[88:91], v[136:139]
  ds_read_b128 v[40:43], v20 offset:4096
  v_mfma_f32_16x16x32_bf16 v[140:143], v[96:99], v[92:95], v[140:143]
  ds_read_b128 v[44:47], v20 offset:6144
  v_mfma_f32_16x16x32_bf16 v[156:159], v[100:103], v[92:95], v[156:159]
  ds_read_b64_tr_b16 v[48:49], v21 offset:0
  v_mfma_f32_16x16x32_bf16 v[152:155], v[100:103], v[88:91], v[152:155]
  ds_read_b64_tr_b16 v[50:51], v21 offset:2048
  v_mfma_f32_16x16x32_bf16 v[148:151], v[100:103], v[84:87], v[148:151]
  ds_read_b64_tr_b16 v[52:53], v22 offset:0
  v_mfma_f32_16x16x32_bf16 v[144:147], v[100:103], v[80:83], v[144:147]
  ds_read_b64_tr_b16 v[54:55], v22 offset:2048
  v_mfma_f32_16x16x32_bf16 v[160:163], v[104:107], v[80:83], v[160:163]
  ds_read_b64_tr_b16 v[56:57], v21 offset:8192
  v_mfma_f32_16x16x32_bf16 v[164:167], v[104:107], v[84:87], v[164:167]
  ds_read_b64_tr_b16 v[58:59], v21 offset:10240
  v_mfma_f32_16x16x32_bf16 v[168:171], v[104:107], v[88:91], v[168:171]
  ds_read_b64_tr_b16 v[60:61], v22 offset:8192
  v_mfma_f32_16x16x32_bf16 v[172:175], v[104:107], v[92:95], v[172:175]
  ds_read_b64_tr_b16 v[62:63], v22 offset:10240
  v_mfma_f32_16x16x32_bf16 v[188:191], v[108:111], v[92:95], v[188:191]
  ds_read_b64_tr_b16 v[64:65], v21 offset:16384
  v_mfma_f32_16x16x32_bf16 v[184:187], v[108:111], v[88:91], v[184:187]
  ds_read_b64_tr_b16 v[66:67], v21 offset:18432
  v_mfma_f32_16x16x32_bf16 v[180:183], v[108:111], v[84:87], v[180:183]
  ds_read_b64_tr_b16 v[68:69], v22 offset:16384
  v_mfma_f32_16x16x32_bf16 v[176:179], v[108:111], v[80:83], v[176:179]
  ds_read_b64_tr_b16 v[70:71], v22 offset:18432
  v_mfma_f32_16x16x32_bf16 v[192:195], v[112:115], v[80:83], v[192:195]
  ds_read_b64_tr_b16 v[72:73], v23 offset:0
  v_mfma_f32_16x16x32_bf16 v[196:199], v[112:115], v[84:87], v[196:199]
  ds_read_b64_tr_b16 v[74:75], v23 offset:2048
  v_mfma_f32_16x16x32_bf16 v[200:203], v[112:115], v[88:91], v[200:203]
  s_cmp_lg_u32 s79, 0
  s_nop 0
  v_mfma_f32_16x16x32_bf16 v[204:207], v[112:115], v[92:95], v[204:207]
  v_mfma_f32_16x16x32_bf16 v[220:223], v[116:119], v[92:95], v[220:223]
  v_mfma_f32_16x16x32_bf16 v[216:219], v[116:119], v[88:91], v[216:219]
  v_mfma_f32_16x16x32_bf16 v[212:215], v[116:119], v[84:87], v[212:215]
  v_mfma_f32_16x16x32_bf16 v[208:211], v[116:119], v[80:83], v[208:211]
  v_mfma_f32_16x16x32_bf16 v[224:227], v[120:123], v[80:83], v[224:227]
  v_mfma_f32_16x16x32_bf16 v[228:231], v[120:123], v[84:87], v[228:231]
  v_mfma_f32_16x16x32_bf16 v[232:235], v[120:123], v[88:91], v[232:235]
  v_mfma_f32_16x16x32_bf16 v[236:239], v[120:123], v[92:95], v[236:239]
  s_waitcnt lgkmcnt(0)
  s_cbranch_scc1 L_w1_loop
L_w1_lend:
L_w1_exit:
  ds_read_b64 v[60:61], v14 offset:0
  ds_read_b64 v[32:33], v15 offset:0
  v_and_b32 v100, -9, v14
  ds_read_b64 v[36:37], v15 offset:256
  ds_read_b128 v[76:79], v100 offset:2048
  ds_read_b32 v17, v17
  ds_read_b64 v[64:65], v14 offset:256
  ds_read_b128 v[80:83], v100 offset:2304
  ds_read_b64 v[68:69], v14 offset:512
  ds_read_b128 v[84:87], v100 offset:2560
  ds_read_b64 v[72:73], v14 offset:768
  ds_read_b128 v[88:91], v100 offset:2816
  ds_read_b64 v[56:57], v16 offset:3072
  ds_read_b64 v[40:41], v15 offset:1024
  ds_read_b64 v[44:45], v15 offset:1280
  ds_read_b64 v[48:49], v15 offset:2048
  ds_read_b64 v[52:53], v15 offset:2304
  buffer_load_dwordx2 v[10:11], v19, s[52:55], 0 offen offset:0
  buffer_load_dwordx2 v[24:25], v19, s[52:55], 0 offen offset:32
  buffer_load_dwordx2 v[124:125], v19, s[52:55], 0 offen offset:64
  buffer_load_dwordx2 v[126:127], v19, s[52:55], 0 offen offset:96
  s_waitcnt lgkmcnt(14)
  v_mfma_f32_16x16x16_bf16 v[128:131], v[32:33], v[60:61], v[128:131]
  s_waitcnt lgkmcnt(11)
  v_readfirstlane_b32 s98, v17
  s_cmp_lg_u32 s98, 0
  s_cselect_b32 s98, 34603008, 0
  s_add_u32 s44, s44, s98
  s_addc_u32 s45, s45, 0
  s_add_u32 s36, s36, s98
  s_addc_u32 s37, s37, 0
  s_add_u32 s64, s64, s98
  s_addc_u32 s65, s65, 0
  v_pk_mul_f32 v[100:101], v[128:129], v[128:129]
  v_pk_mul_f32 v[102:103], v[130:131], v[130:131]
  v_pk_fma_f32 v[100:101], v[100:101], v[76:77], v[76:77] op_sel:[0,1,0] op_sel_hi:[1,1,0]
  v_pk_fma_f32 v[102:103], v[102:103], v[76:77], v[76:77] op_sel:[0,1,0] op_sel_hi:[1,1,0]
  v_pk_mul_f32 v[100:101], v[100:101], v[128:129]
  v_pk_mul_f32 v[102:103], v[102:103], v[130:131]
  v_mfma_f32_16x16x16_bf16 v[144:147], v[36:37], v[60:61], v[144:147]
  v_exp_f32 v100, v100
  v_exp_f32 v101, v101
  v_exp_f32 v102, v102
  v_exp_f32 v103, v103
  v_pk_fma_f32 v[100:101], v[100:101], v[78:79], v[78:79] op_sel_hi:[1,0,0]
  v_pk_fma_f32 v[102:103], v[102:103], v[78:79], v[78:79] op_sel_hi:[1,0,0]
  v_rcp_f32 v100, v100
  v_rcp_f32 v101, v101
  v_rcp_f32 v102, v102
  v_rcp_f32 v103, v103
  v_pk_mul_f32 v[128:129], v[128:129], v[100:101]
  v_pk_mul_f32 v[130:131], v[130:131], v[102:103]
  v_cvt_pk_bf16_f32 v108, v128, v129
  v_cvt_pk_bf16_f32 v109, v130, v131
  v_pk_mul_f32 v[104:105], v[144:145], v[144:145]
  v_pk_mul_f32 v[106:107], v[146:147], v[146:147]
  v_pk_fma_f32 v[104:105], v[104:105], v[76:77], v[76:77] op_sel:[0,1,0] op_sel_hi:[1,1,0]
  v_pk_fma_f32 v[106:107], v[106:107], v[76:77], v[76:77] op_sel:[0,1,0] op_sel_hi:[1,1,0]
  v_pk_mul_f32 v[104:105], v[104:105], v[144:145]
  v_pk_mul_f32 v[106:107], v[106:107], v[146:147]
  s_waitcnt lgkmcnt(0)
  v_mfma_f32_16x16x16_bf16 v[132:135], v[32:33], v[64:65], v[132:135]
  v_exp_f32 v104, v104
  v_exp_f32 v105, v105
  v_exp_f32 v106, v106
  v_exp_f32 v107, v107
  v_pk_fma_f32 v[104:105], v[104:105], v[78:79], v[78:79] op_sel_hi:[1,0,0]
  v_pk_fma_f32 v[106:107], v[106:107], v[78:79], v[78:79] op_sel_hi:[1,0,0]
  v_rcp_f32 v104, v104
  v_rcp_f32 v105, v105
  v_rcp_f32 v106, v106
  v_rcp_f32 v107, v107
  v_pk_mul_f32 v[144:145], v[144:145], v[104:105]
  v_pk_mul_f32 v[146:147], v[146:147], v[106:107]
  v_cvt_pk_bf16_f32 v110, v144, v145
  v_cvt_pk_bf16_f32 v111, v146, v147
  s_mov_b32 s3, 0
  buffer_store_dwordx4 v[108:111], v12, s[44:47], s3 offen sc1
  ds_write_b128 v18, v[108:111] offset:32768
  v_pk_mul_f32 v[100:101], v[132:133], v[132:133]
  v_pk_mul_f32 v[102:103], v[134:135], v[134:135]
  v_pk_fma_f32 v[100:101], v[100:101], v[80:81], v[80:81] op_sel:[0,1,0] op_sel_hi:[1,1,0]
  v_pk_fma_f32 v[102:103], v[102:103], v[80:81], v[80:81] op_sel:[0,1,0] op_sel_hi:[1,1,0]
  v_pk_mul_f32 v[100:101], v[100:101], v[132:133]
  v_pk_mul_f32 v[102:103], v[102:103], v[134:135]
  v_mfma_f32_16x16x16_bf16 v[148:151], v[36:37], v[64:65], v[148:151]
  v_exp_f32 v100, v100
  v_exp_f32 v101, v101
  v_exp_f32 v102, v102
  v_exp_f32 v103, v103
  v_pk_fma_f32 v[100:101], v[100:101], v[82:83], v[82:83] op_sel_hi:[1,0,0]
  v_pk_fma_f32 v[102:103], v[102:103], v[82:83], v[82:83] op_sel_hi:[1,0,0]
  v_rcp_f32 v100, v100
  v_rcp_f32 v101, v101
  v_rcp_f32 v102, v102
  v_rcp_f32 v103, v103
  v_pk_mul_f32 v[132:133], v[132:133], v[100:101]
  v_pk_mul_f32 v[134:135], v[134:135], v[102:103]
  v_cvt_pk_bf16_f32 v112, v132, v133
  v_cvt_pk_bf16_f32 v113, v134, v135
  v_pk_mul_f32 v[104:105], v[148:149], v[148:149]
  v_pk_mul_f32 v[106:107], v[150:151], v[150:151]
  v_pk_fma_f32 v[104:105], v[104:105], v[80:81], v[80:81] op_sel:[0,1,0] op_sel_hi:[1,1,0]
  v_pk_fma_f32 v[106:107], v[106:107], v[80:81], v[80:81] op_sel:[0,1,0] op_sel_hi:[1,1,0]
  v_pk_mul_f32 v[104:105], v[104:105], v[148:149]
  v_pk_mul_f32 v[106:107], v[106:107], v[150:151]
  v_mfma_f32_16x16x16_bf16 v[136:139], v[32:33], v[68:69], v[136:139]
  v_exp_f32 v104, v104
  v_exp_f32 v105, v105
  v_exp_f32 v106, v106
  v_exp_f32 v107, v107
  v_pk_fma_f32 v[104:105], v[104:105], v[82:83], v[82:83] op_sel_hi:[1,0,0]
  v_pk_fma_f32 v[106:107], v[106:107], v[82:83], v[82:83] op_sel_hi:[1,0,0]
  v_rcp_f32 v104, v104
  v_rcp_f32 v105, v105
  v_rcp_f32 v106, v106
  v_rcp_f32 v107, v107
  v_pk_mul_f32 v[148:149], v[148:149], v[104:105]
  v_pk_mul_f32 v[150:151], v[150:151], v[106:107]
  v_cvt_pk_bf16_f32 v114, v148, v149
  v_cvt_pk_bf16_f32 v115, v150, v151
  s_mov_b32 s3, 114688
  buffer_store_dwordx4 v[112:115], v12, s[44:47], s3 offen sc1
  ds_write_b128 v18, v[112:115] offset:34816
  v_pk_mul_f32 v[100:101], v[136:137], v[136:137]
  v_pk_mul_f32 v[102:103], v[138:139], v[138:139]
  v_pk_fma_f32 v[100:101], v[100:101], v[84:85], v[84:85] op_sel:[0,1,0] op_sel_hi:[1,1,0]
  v_pk_fma_f32 v[102:103], v[102:103], v[84:85], v[84:85] op_sel:[0,1,0] op_sel_hi:[1,1,0]
  v_pk_mul_f32 v[100:101], v[100:101], v[136:137]
  v_pk_mul_f32 v[102:103], v[102:103], v[138:139]
  v_mfma_f32_16x16x16_bf16 v[152:155], v[36:37], v[68:69], v[152:155]
  v_exp_f32 v100, v100
  v_exp_f32 v101, v101
  v_exp_f32 v102, v102
  v_exp_f32 v103, v103
  v_pk_fma_f32 v[100:101], v[100:101], v[86:87], v[86:87] op_sel_hi:[1,0,0]
  v_pk_fma_f32 v[102:103], v[102:103], v[86:87], v[86:87] op_sel_hi:[1,0,0]
  v_rcp_f32 v100, v100
  v_rcp_f32 v101, v101
  v_rcp_f32 v102, v102
  v_rcp_f32 v103, v103
  v_pk_mul_f32 v[136:137], v[136:137], v[100:101]
  v_pk_mul_f32 v[138:139], v[138:139], v[102:103]
  v_cvt_pk_bf16_f32 v116, v136, v137
  v_cvt_pk_bf16_f32 v117, v138, v139
  v_pk_mul_f32 v[104:105], v[152:153], v[152:153]
  v_pk_mul_f32 v[106:107], v[154:155], v[154:155]
  v_pk_fma_f32 v[104:105], v[104:105], v[84:85], v[84:85] op_sel:[0,1,0] op_sel_hi:[1,1,0]
  v_pk_fma_f32 v[106:107], v[106:107], v[84:85], v[84:85] op_sel:[0,1,0] op_sel_hi:[1,1,0]
  v_pk_mul_f32 v[104:105], v[104:105], v[152:153]
  v_pk_mul_f32 v[106:107], v[106:107], v[154:155]
  v_mfma_f32_16x16x16_bf16 v[140:143], v[32:33], v[72:73], v[140:143]
  v_exp_f32 v104, v104
  v_exp_f32 v105, v105
  v_exp_f32 v106, v106
  v_exp_f32 v107, v107
  v_pk_fma_f32 v[104:105], v[104:105], v[86:87], v[86:87] op_sel_hi:[1,0,0]
  v_pk_fma_f32 v[106:107], v[106:107], v[86:87], v[86:87] op_sel_hi:[1,0,0]
  v_rcp_f32 v104, v104
  v_rcp_f32 v105, v105
  v_rcp_f32 v106, v106
  v_rcp_f32 v107, v107
  v_pk_mul_f32 v[152:153], v[152:153], v[104:105]
  v_pk_mul_f32 v[154:155], v[154:155], v[106:107]
  v_cvt_pk_bf16_f32 v118, v152, v153
  v_cvt_pk_bf16_f32 v119, v154, v155
  s_mov_b32 s3, 229376
  buffer_store_dwordx4 v[116:119], v12, s[44:47], s3 offen sc1
  ds_write_b128 v18, v[116:119] offset:36864
  v_pk_mul_f32 v[100:101], v[140:141], v[140:141]
  v_pk_mul_f32 v[102:103], v[142:143], v[142:143]
  v_pk_fma_f32 v[100:101], v[100:101], v[88:89], v[88:89] op_sel:[0,1,0] op_sel_hi:[1,1,0]
  v_pk_fma_f32 v[102:103], v[102:103], v[88:89], v[88:89] op_sel:[0,1,0] op_sel_hi:[1,1,0]
  v_pk_mul_f32 v[100:101], v[100:101], v[140:141]
  v_pk_mul_f32 v[102:103], v[102:103], v[142:143]
  v_mfma_f32_16x16x16_bf16 v[156:159], v[36:37], v[72:73], v[156:159]
  v_exp_f32 v100, v100
  v_exp_f32 v101, v101
  v_exp_f32 v102, v102
  v_exp_f32 v103, v103
  v_pk_fma_f32 v[100:101], v[100:101], v[90:91], v[90:91] op_sel_hi:[1,0,0]
  v_pk_fma_f32 v[102:103], v[102:103], v[90:91], v[90:91] op_sel_hi:[1,0,0]
  v_rcp_f32 v100, v100
  v_rcp_f32 v101, v101
  v_rcp_f32 v102, v102
  v_rcp_f32 v103, v103
  v_pk_mul_f32 v[140:141], v[140:141], v[100:101]
  v_pk_mul_f32 v[142:143], v[142:143], v[102:103]
  v_cvt_pk_bf16_f32 v120, v140, v141
  v_cvt_pk_bf16_f32 v121, v142, v143
  v_pk_mul_f32 v[104:105], v[156:157], v[156:157]
  v_pk_mul_f32 v[106:107], v[158:159], v[158:159]
  v_pk_fma_f32 v[104:105], v[104:105], v[88:89], v[88:89] op_sel:[0,1,0] op_sel_hi:[1,1,0]
  v_pk_fma_f32 v[106:107], v[106:107], v[88:89], v[88:89] op_sel:[0,1,0] op_sel_hi:[1,1,0]
  v_pk_mul_f32 v[104:105], v[104:105], v[156:157]
  v_pk_mul_f32 v[106:107], v[106:107], v[158:159]
  v_mfma_f32_16x16x16_bf16 v[224:227], v[56:57], v[60:61], v[224:227]
  v_exp_f32 v104, v104
  v_exp_f32 v105, v105
  v_exp_f32 v106, v106
  v_exp_f32 v107, v107
  v_pk_fma_f32 v[104:105], v[104:105], v[90:91], v[90:91] op_sel_hi:[1,0,0]
  v_pk_fma_f32 v[106:107], v[106:107], v[90:91], v[90:91] op_sel_hi:[1,0,0]
  v_rcp_f32 v104, v104
  v_rcp_f32 v105, v105
  v_rcp_f32 v106, v106
  v_rcp_f32 v107, v107
  v_pk_mul_f32 v[156:157], v[156:157], v[104:105]
  v_pk_mul_f32 v[158:159], v[158:159], v[106:107]
  v_cvt_pk_bf16_f32 v122, v156, v157
  v_cvt_pk_bf16_f32 v123, v158, v159
  s_mov_b32 s3, 344064
  buffer_store_dwordx4 v[120:123], v12, s[44:47], s3 offen sc1
  ds_write_b128 v18, v[120:123] offset:38912
  v_pk_mul_f32 v[100:101], v[224:225], v[224:225]
  v_pk_mul_f32 v[102:103], v[226:227], v[226:227]
  v_pk_fma_f32 v[100:101], v[100:101], v[76:77], v[76:77] op_sel:[0,1,0] op_sel_hi:[1,1,0]
  v_pk_fma_f32 v[102:103], v[102:103], v[76:77], v[76:77] op_sel:[0,1,0] op_sel_hi:[1,1,0]
  v_pk_mul_f32 v[100:101], v[100:101], v[224:225]
  v_pk_mul_f32 v[102:103], v[102:103], v[226:227]
  v_mfma_f32_16x16x16_bf16 v[228:231], v[56:57], v[64:65], v[228:231]
  v_exp_f32 v100, v100
  v_exp_f32 v101, v101
  v_exp_f32 v102, v102
  v_exp_f32 v103, v103
  v_pk_fma_f32 v[100:101], v[100:101], v[78:79], v[78:79] op_sel_hi:[1,0,0]
  v_pk_fma_f32 v[102:103], v[102:103], v[78:79], v[78:79] op_sel_hi:[1,0,0]
  v_rcp_f32 v100, v100
  v_rcp_f32 v101, v101
  v_rcp_f32 v102, v102
  v_rcp_f32 v103, v103
  v_pk_mul_f32 v[224:225], v[224:225], v[100:101]
  v_pk_mul_f32 v[226:227], v[226:227], v[102:103]
  v_cvt_pk_bf16_f32 v108, v224, v225
  v_cvt_pk_bf16_f32 v109, v226, v227
  v_pk_mul_f32 v[100:101], v[228:229], v[228:229]
  v_pk_mul_f32 v[102:103], v[230:231], v[230:231]
  v_pk_fma_f32 v[100:101], v[100:101], v[80:81], v[80:81] op_sel:[0,1,0] op_sel_hi:[1,1,0]
  v_pk_fma_f32 v[102:103], v[102:103], v[80:81], v[80:81] op_sel:[0,1,0] op_sel_hi:[1,1,0]
  v_pk_mul_f32 v[100:101], v[100:101], v[228:229]
  v_pk_mul_f32 v[102:103], v[102:103], v[230:231]
  v_mfma_f32_16x16x16_bf16 v[232:235], v[56:57], v[68:69], v[232:235]
  v_exp_f32 v100, v100
  v_exp_f32 v101, v101
  v_exp_f32 v102, v102
  v_exp_f32 v103, v103
  v_pk_fma_f32 v[100:101], v[100:101], v[82:83], v[82:83] op_sel_hi:[1,0,0]
  v_pk_fma_f32 v[102:103], v[102:103], v[82:83], v[82:83] op_sel_hi:[1,0,0]
  v_rcp_f32 v100, v100
  v_rcp_f32 v101, v101
  v_rcp_f32 v102, v102
  v_rcp_f32 v103, v103
  v_pk_mul_f32 v[228:229], v[228:229], v[100:101]
  v_pk_mul_f32 v[230:231], v[230:231], v[102:103]
  v_cvt_pk_bf16_f32 v110, v228, v229
  v_cvt_pk_bf16_f32 v111, v230, v231
  s_mov_b32 s3, 32768
  s_nop 0
  v_permlane16_swap_b32 v108, v110
  v_permlane16_swap_b32 v109, v111
  buffer_store_dwordx4 v[108:111], v13, s[44:47], s3 offen sc1
  v_pk_mul_f32 v[100:101], v[232:233], v[232:233]
  v_pk_mul_f32 v[102:103], v[234:235], v[234:235]
  v_pk_fma_f32 v[100:101], v[100:101], v[84:85], v[84:85] op_sel:[0,1,0] op_sel_hi:[1,1,0]
  v_pk_fma_f32 v[102:103], v[102:103], v[84:85], v[84:85] op_sel:[0,1,0] op_sel_hi:[1,1,0]
  v_pk_mul_f32 v[100:101], v[100:101], v[232:233]
  v_pk_mul_f32 v[102:103], v[102:103], v[234:235]
  v_mfma_f32_16x16x16_bf16 v[236:239], v[56:57], v[72:73], v[236:239]
  v_exp_f32 v100, v100
  v_exp_f32 v101, v101
  v_exp_f32 v102, v102
  v_exp_f32 v103, v103
  v_pk_fma_f32 v[100:101], v[100:101], v[86:87], v[86:87] op_sel_hi:[1,0,0]
  v_pk_fma_f32 v[102:103], v[102:103], v[86:87], v[86:87] op_sel_hi:[1,0,0]
  v_rcp_f32 v100, v100
  v_rcp_f32 v101, v101
  v_rcp_f32 v102, v102
  v_rcp_f32 v103, v103
  v_pk_mul_f32 v[232:233], v[232:233], v[100:101]
  v_pk_mul_f32 v[234:235], v[234:235], v[102:103]
  v_cvt_pk_bf16_f32 v112, v232, v233
  v_cvt_pk_bf16_f32 v113, v234, v235
  v_pk_mul_f32 v[100:101], v[236:237], v[236:237]
  v_pk_mul_f32 v[102:103], v[238:239], v[238:239]
  v_pk_fma_f32 v[100:101], v[100:101], v[88:89], v[88:89] op_sel:[0,1,0] op_sel_hi:[1,1,0]
  v_pk_fma_f32 v[102:103], v[102:103], v[88:89], v[88:89] op_sel:[0,1,0] op_sel_hi:[1,1,0]
  v_pk_mul_f32 v[100:101], v[100:101], v[236:237]
  v_pk_mul_f32 v[102:103], v[102:103], v[238:239]
  v_mfma_f32_16x16x16_bf16 v[160:163], v[40:41], v[60:61], v[160:163]
  v_exp_f32 v100, v100
  v_exp_f32 v101, v101
  v_exp_f32 v102, v102
  v_exp_f32 v103, v103
  v_pk_fma_f32 v[100:101], v[100:101], v[90:91], v[90:91] op_sel_hi:[1,0,0]
  v_pk_fma_f32 v[102:103], v[102:103], v[90:91], v[90:91] op_sel_hi:[1,0,0]
  v_rcp_f32 v100, v100
  v_rcp_f32 v101, v101
  v_rcp_f32 v102, v102
  v_rcp_f32 v103, v103
  v_pk_mul_f32 v[236:237], v[236:237], v[100:101]
  v_pk_mul_f32 v[238:239], v[238:239], v[102:103]
  v_cvt_pk_bf16_f32 v114, v236, v237
  v_cvt_pk_bf16_f32 v115, v238, v239
  s_mov_b32 s3, 262144
  s_nop 0
  v_permlane16_swap_b32 v112, v114
  v_permlane16_swap_b32 v113, v115
  buffer_store_dwordx4 v[112:115], v13, s[44:47], s3 offen sc1
  v_pk_mul_f32 v[100:101], v[160:161], v[160:161]
  v_pk_mul_f32 v[102:103], v[162:163], v[162:163]
  v_pk_fma_f32 v[100:101], v[100:101], v[76:77], v[76:77] op_sel:[0,1,0] op_sel_hi:[1,1,0]
  v_pk_fma_f32 v[102:103], v[102:103], v[76:77], v[76:77] op_sel:[0,1,0] op_sel_hi:[1,1,0]
  v_pk_mul_f32 v[100:101], v[100:101], v[160:161]
  v_pk_mul_f32 v[102:103], v[102:103], v[162:163]
  v_mfma_f32_16x16x16_bf16 v[176:179], v[44:45], v[60:61], v[176:179]
  v_exp_f32 v100, v100
  v_exp_f32 v101, v101
  v_exp_f32 v102, v102
  v_exp_f32 v103, v103
  v_pk_fma_f32 v[100:101], v[100:101], v[78:79], v[78:79] op_sel_hi:[1,0,0]
  v_pk_fma_f32 v[102:103], v[102:103], v[78:79], v[78:79] op_sel_hi:[1,0,0]
  v_rcp_f32 v100, v100
  v_rcp_f32 v101, v101
  v_rcp_f32 v102, v102
  v_rcp_f32 v103, v103
  v_pk_mul_f32 v[160:161], v[160:161], v[100:101]
  v_pk_mul_f32 v[162:163], v[162:163], v[102:103]
  v_cvt_pk_bf16_f32 v116, v160, v161
  v_cvt_pk_bf16_f32 v117, v162, v163
  v_pk_mul_f32 v[104:105], v[176:177], v[176:177]
  v_pk_mul_f32 v[106:107], v[178:179], v[178:179]
  v_pk_fma_f32 v[104:105], v[104:105], v[76:77], v[76:77] op_sel:[0,1,0] op_sel_hi:[1,1,0]
  v_pk_fma_f32 v[106:107], v[106:107], v[76:77], v[76:77] op_sel:[0,1,0] op_sel_hi:[1,1,0]
  v_pk_mul_f32 v[104:105], v[104:105], v[176:177]
  v_pk_mul_f32 v[106:107], v[106:107], v[178:179]
  v_mfma_f32_16x16x16_bf16 v[164:167], v[40:41], v[64:65], v[164:167]
  v_exp_f32 v104, v104
  v_exp_f32 v105, v105
  v_exp_f32 v106, v106
  v_exp_f32 v107, v107
  v_pk_fma_f32 v[104:105], v[104:105], v[78:79], v[78:79] op_sel_hi:[1,0,0]
  v_pk_fma_f32 v[106:107], v[106:107], v[78:79], v[78:79] op_sel_hi:[1,0,0]
  v_rcp_f32 v104, v104
  v_rcp_f32 v105, v105
  v_rcp_f32 v106, v106
  v_rcp_f32 v107, v107
  v_pk_mul_f32 v[176:177], v[176:177], v[104:105]
  v_pk_mul_f32 v[178:179], v[178:179], v[106:107]
  v_cvt_pk_bf16_f32 v118, v176, v177
  v_cvt_pk_bf16_f32 v119, v178, v179
  s_add_u32 s3, s10, 49152
  buffer_store_dwordx4 v[116:119], v12, s[44:47], s3 offen sc1
  ds_write_b128 v18, v[116:119] offset:0
  v_pk_mul_f32 v[100:101], v[164:165], v[164:165]
  v_pk_mul_f32 v[102:103], v[166:167], v[166:167]
  v_pk_fma_f32 v[100:101], v[100:101], v[80:81], v[80:81] op_sel:[0,1,0] op_sel_hi:[1,1,0]
  v_pk_fma_f32 v[102:103], v[102:103], v[80:81], v[80:81] op_sel:[0,1,0] op_sel_hi:[1,1,0]
  v_pk_mul_f32 v[100:101], v[100:101], v[164:165]
  v_pk_mul_f32 v[102:103], v[102:103], v[166:167]
  v_mfma_f32_16x16x16_bf16 v[180:183], v[44:45], v[64:65], v[180:183]
  v_exp_f32 v100, v100
  v_exp_f32 v101, v101
  v_exp_f32 v102, v102
  v_exp_f32 v103, v103
  v_pk_fma_f32 v[100:101], v[100:101], v[82:83], v[82:83] op_sel_hi:[1,0,0]
  v_pk_fma_f32 v[102:103], v[102:103], v[82:83], v[82:83] op_sel_hi:[1,0,0]
  v_rcp_f32 v100, v100
  v_rcp_f32 v101, v101
  v_rcp_f32 v102, v102
  v_rcp_f32 v103, v103
  v_pk_mul_f32 v[164:165], v[164:165], v[100:101]
  v_pk_mul_f32 v[166:167], v[166:167], v[102:103]
  v_cvt_pk_bf16_f32 v120, v164, v165
  v_cvt_pk_bf16_f32 v121, v166, v167
  v_pk_mul_f32 v[104:105], v[180:181], v[180:181]
  v_pk_mul_f32 v[106:107], v[182:183], v[182:183]
  v_pk_fma_f32 v[104:105], v[104:105], v[80:81], v[80:81] op_sel:[0,1,0] op_sel_hi:[1,1,0]
  v_pk_fma_f32 v[106:107], v[106:107], v[80:81], v[80:81] op_sel:[0,1,0] op_sel_hi:[1,1,0]
  v_pk_mul_f32 v[104:105], v[104:105], v[180:181]
  v_pk_mul_f32 v[106:107], v[106:107], v[182:183]
  v_mfma_f32_16x16x16_bf16 v[168:171], v[40:41], v[68:69], v[168:171]
  v_exp_f32 v104, v104
  v_exp_f32 v105, v105
  v_exp_f32 v106, v106
  v_exp_f32 v107, v107
  v_pk_fma_f32 v[104:105], v[104:105], v[82:83], v[82:83] op_sel_hi:[1,0,0]
  v_pk_fma_f32 v[106:107], v[106:107], v[82:83], v[82:83] op_sel_hi:[1,0,0]
  v_rcp_f32 v104, v104
  v_rcp_f32 v105, v105
  v_rcp_f32 v106, v106
  v_rcp_f32 v107, v107
  v_pk_mul_f32 v[180:181], v[180:181], v[104:105]
  v_pk_mul_f32 v[182:183], v[182:183], v[106:107]
  v_cvt_pk_bf16_f32 v122, v180, v181
  v_cvt_pk_bf16_f32 v123, v182, v183
  s_add_u32 s3, s10, 163840
  buffer_store_dwordx4 v[120:123], v12, s[44:47], s3 offen sc1
  ds_write_b128 v18, v[120:123] offset:2048
  v_pk_mul_f32 v[100:101], v[168:169], v[168:169]
  v_pk_mul_f32 v[102:103], v[170:171], v[170:171]
  v_pk_fma_f32 v[100:101], v[100:101], v[84:85], v[84:85] op_sel:[0,1,0] op_sel_hi:[1,1,0]
  v_pk_fma_f32 v[102:103], v[102:103], v[84:85], v[84:85] op_sel:[0,1,0] op_sel_hi:[1,1,0]
  v_pk_mul_f32 v[100:101], v[100:101], v[168:169]
  v_pk_mul_f32 v[102:103], v[102:103], v[170:171]
  v_mfma_f32_16x16x16_bf16 v[184:187], v[44:45], v[68:69], v[184:187]
  v_exp_f32 v100, v100
  v_exp_f32 v101, v101
  v_exp_f32 v102, v102
  v_exp_f32 v103, v103
  v_pk_fma_f32 v[100:101], v[100:101], v[86:87], v[86:87] op_sel_hi:[1,0,0]
  v_pk_fma_f32 v[102:103], v[102:103], v[86:87], v[86:87] op_sel_hi:[1,0,0]
  v_rcp_f32 v100, v100
  v_rcp_f32 v101, v101
  v_rcp_f32 v102, v102
  v_rcp_f32 v103, v103
  v_pk_mul_f32 v[168:169], v[168:169], v[100:101]
  v_pk_mul_f32 v[170:171], v[170:171], v[102:103]
  v_cvt_pk_bf16_f32 v108, v168, v169
  v_cvt_pk_bf16_f32 v109, v170, v171
  v_pk_mul_f32 v[104:105], v[184:185], v[184:185]
  v_pk_mul_f32 v[106:107], v[186:187], v[186:187]
  v_pk_fma_f32 v[104:105], v[104:105], v[84:85], v[84:85] op_sel:[0,1,0] op_sel_hi:[1,1,0]
  v_pk_fma_f32 v[106:107], v[106:107], v[84:85], v[84:85] op_sel:[0,1,0] op_sel_hi:[1,1,0]
  v_pk_mul_f32 v[104:105], v[104:105], v[184:185]
  v_pk_mul_f32 v[106:107], v[106:107], v[186:187]
  v_mfma_f32_16x16x16_bf16 v[172:175], v[40:41], v[72:73], v[172:175]
  v_exp_f32 v104, v104
  v_exp_f32 v105, v105
  v_exp_f32 v106, v106
  v_exp_f32 v107, v107
  v_pk_fma_f32 v[104:105], v[104:105], v[86:87], v[86:87] op_sel_hi:[1,0,0]
  v_pk_fma_f32 v[106:107], v[106:107], v[86:87], v[86:87] op_sel_hi:[1,0,0]
  v_rcp_f32 v104, v104
  v_rcp_f32 v105, v105
  v_rcp_f32 v106, v106
  v_rcp_f32 v107, v107
  v_pk_mul_f32 v[184:185], v[184:185], v[104:105]
  v_pk_mul_f32 v[186:187], v[186:187], v[106:107]
  v_cvt_pk_bf16_f32 v110, v184, v185
  v_cvt_pk_bf16_f32 v111, v186, v187
  s_add_u32 s3, s10, 278528
  buffer_store_dwordx4 v[108:111], v12, s[44:47], s3 offen sc1
  ds_write_b128 v18, v[108:111] offset:4096
  v_pk_mul_f32 v[100:101], v[172:173], v[172:173]
  v_pk_mul_f32 v[102:103], v[174:175], v[174:175]
  v_pk_fma_f32 v[100:101], v[100:101], v[88:89], v[88:89] op_sel:[0,1,0] op_sel_hi:[1,1,0]
  v_pk_fma_f32 v[102:103], v[102:103], v[88:89], v[88:89] op_sel:[0,1,0] op_sel_hi:[1,1,0]
  v_pk_mul_f32 v[100:101], v[100:101], v[172:173]
  v_pk_mul_f32 v[102:103], v[102:103], v[174:175]
  v_mfma_f32_16x16x16_bf16 v[188:191], v[44:45], v[72:73], v[188:191]
  v_exp_f32 v100, v100
  v_exp_f32 v101, v101
  v_exp_f32 v102, v102
  v_exp_f32 v103, v103
  v_pk_fma_f32 v[100:101], v[100:101], v[90:91], v[90:91] op_sel_hi:[1,0,0]
  v_pk_fma_f32 v[102:103], v[102:103], v[90:91], v[90:91] op_sel_hi:[1,0,0]
  v_rcp_f32 v100, v100
  v_rcp_f32 v101, v101
  v_rcp_f32 v102, v102
  v_rcp_f32 v103, v103
  v_pk_mul_f32 v[172:173], v[172:173], v[100:101]
  v_pk_mul_f32 v[174:175], v[174:175], v[102:103]
  v_cvt_pk_bf16_f32 v112, v172, v173
  v_cvt_pk_bf16_f32 v113, v174, v175
  v_pk_mul_f32 v[104:105], v[188:189], v[188:189]
  v_pk_mul_f32 v[106:107], v[190:191], v[190:191]
  v_pk_fma_f32 v[104:105], v[104:105], v[88:89], v[88:89] op_sel:[0,1,0] op_sel_hi:[1,1,0]
  v_pk_fma_f32 v[106:107], v[106:107], v[88:89], v[88:89] op_sel:[0,1,0] op_sel_hi:[1,1,0]
  v_pk_mul_f32 v[104:105], v[104:105], v[188:189]
  v_pk_mul_f32 v[106:107], v[106:107], v[190:191]
  v_mfma_f32_16x16x16_bf16 v[192:195], v[48:49], v[60:61], v[192:195]
  v_exp_f32 v104, v104
  v_exp_f32 v105, v105
  v_exp_f32 v106, v106
  v_exp_f32 v107, v107
  v_pk_fma_f32 v[104:105], v[104:105], v[90:91], v[90:91] op_sel_hi:[1,0,0]
  v_pk_fma_f32 v[106:107], v[106:107], v[90:91], v[90:91] op_sel_hi:[1,0,0]
  v_rcp_f32 v104, v104
  v_rcp_f32 v105, v105
  v_rcp_f32 v106, v106
  v_rcp_f32 v107, v107
  v_pk_mul_f32 v[188:189], v[188:189], v[104:105]
  v_pk_mul_f32 v[190:191], v[190:191], v[106:107]
  v_cvt_pk_bf16_f32 v114, v188, v189
  v_cvt_pk_bf16_f32 v115, v190, v191
  s_add_u32 s3, s10, 393216
  buffer_store_dwordx4 v[112:115], v12, s[44:47], s3 offen sc1
  ds_write_b128 v18, v[112:115] offset:6144
  v_pk_mul_f32 v[100:101], v[192:193], v[192:193]
  v_pk_mul_f32 v[102:103], v[194:195], v[194:195]
  v_pk_fma_f32 v[100:101], v[100:101], v[76:77], v[76:77] op_sel:[0,1,0] op_sel_hi:[1,1,0]
  v_pk_fma_f32 v[102:103], v[102:103], v[76:77], v[76:77] op_sel:[0,1,0] op_sel_hi:[1,1,0]
  v_pk_mul_f32 v[100:101], v[100:101], v[192:193]
  v_pk_mul_f32 v[102:103], v[102:103], v[194:195]
  v_mfma_f32_16x16x16_bf16 v[208:211], v[52:53], v[60:61], v[208:211]
  v_exp_f32 v100, v100
  v_exp_f32 v101, v101
  v_exp_f32 v102, v102
  v_exp_f32 v103, v103
  v_pk_fma_f32 v[100:101], v[100:101], v[78:79], v[78:79] op_sel_hi:[1,0,0]
  v_pk_fma_f32 v[102:103], v[102:103], v[78:79], v[78:79] op_sel_hi:[1,0,0]
  v_rcp_f32 v100, v100
  v_rcp_f32 v101, v101
  v_rcp_f32 v102, v102
  v_rcp_f32 v103, v103
  v_pk_mul_f32 v[192:193], v[192:193], v[100:101]
  v_pk_mul_f32 v[194:195], v[194:195], v[102:103]
  v_cvt_pk_bf16_f32 v116, v192, v193
  v_cvt_pk_bf16_f32 v117, v194, v195
  v_pk_mul_f32 v[104:105], v[208:209], v[208:209]
  v_pk_mul_f32 v[106:107], v[210:211], v[210:211]
  v_pk_fma_f32 v[104:105], v[104:105], v[76:77], v[76:77] op_sel:[0,1,0] op_sel_hi:[1,1,0]
  v_pk_fma_f32 v[106:107], v[106:107], v[76:77], v[76:77] op_sel:[0,1,0] op_sel_hi:[1,1,0]
  v_pk_mul_f32 v[104:105], v[104:105], v[208:209]
  v_pk_mul_f32 v[106:107], v[106:107], v[210:211]
  v_mfma_f32_16x16x16_bf16 v[196:199], v[48:49], v[64:65], v[196:199]
  v_exp_f32 v104, v104
  v_exp_f32 v105, v105
  v_exp_f32 v106, v106
  v_exp_f32 v107, v107
  v_pk_fma_f32 v[104:105], v[104:105], v[78:79], v[78:79] op_sel_hi:[1,0,0]
  v_pk_fma_f32 v[106:107], v[106:107], v[78:79], v[78:79] op_sel_hi:[1,0,0]
  v_rcp_f32 v104, v104
  v_rcp_f32 v105, v105
  v_rcp_f32 v106, v106
  v_rcp_f32 v107, v107
  v_pk_mul_f32 v[208:209], v[208:209], v[104:105]
  v_pk_mul_f32 v[210:211], v[210:211], v[106:107]
  v_cvt_pk_bf16_f32 v118, v208, v209
  v_cvt_pk_bf16_f32 v119, v210, v211
  s_add_u32 s3, s10, 51200
  buffer_store_dwordx4 v[116:119], v12, s[44:47], s3 offen
  ds_write_b128 v18, v[116:119] offset:16384
  v_pk_mul_f32 v[100:101], v[196:197], v[196:197]
  v_pk_mul_f32 v[102:103], v[198:199], v[198:199]
  v_pk_fma_f32 v[100:101], v[100:101], v[80:81], v[80:81] op_sel:[0,1,0] op_sel_hi:[1,1,0]
  v_pk_fma_f32 v[102:103], v[102:103], v[80:81], v[80:81] op_sel:[0,1,0] op_sel_hi:[1,1,0]
  v_pk_mul_f32 v[100:101], v[100:101], v[196:197]
  v_pk_mul_f32 v[102:103], v[102:103], v[198:199]
  v_mfma_f32_16x16x16_bf16 v[212:215], v[52:53], v[64:65], v[212:215]
  v_exp_f32 v100, v100
  v_exp_f32 v101, v101
  v_exp_f32 v102, v102
  v_exp_f32 v103, v103
  v_pk_fma_f32 v[100:101], v[100:101], v[82:83], v[82:83] op_sel_hi:[1,0,0]
  v_pk_fma_f32 v[102:103], v[102:103], v[82:83], v[82:83] op_sel_hi:[1,0,0]
  v_rcp_f32 v100, v100
  v_rcp_f32 v101, v101
  v_rcp_f32 v102, v102
  v_rcp_f32 v103, v103
  v_pk_mul_f32 v[196:197], v[196:197], v[100:101]
  v_pk_mul_f32 v[198:199], v[198:199], v[102:103]
  v_cvt_pk_bf16_f32 v120, v196, v197
  v_cvt_pk_bf16_f32 v121, v198, v199
  v_pk_mul_f32 v[104:105], v[212:213], v[212:213]
  v_pk_mul_f32 v[106:107], v[214:215], v[214:215]
  v_pk_fma_f32 v[104:105], v[104:105], v[80:81], v[80:81] op_sel:[0,1,0] op_sel_hi:[1,1,0]
  v_pk_fma_f32 v[106:107], v[106:107], v[80:81], v[80:81] op_sel:[0,1,0] op_sel_hi:[1,1,0]
  v_pk_mul_f32 v[104:105], v[104:105], v[212:213]
  v_pk_mul_f32 v[106:107], v[106:107], v[214:215]
  v_mfma_f32_16x16x16_bf16 v[200:203], v[48:49], v[68:69], v[200:203]
  v_exp_f32 v104, v104
  v_exp_f32 v105, v105
  v_exp_f32 v106, v106
  v_exp_f32 v107, v107
  v_pk_fma_f32 v[104:105], v[104:105], v[82:83], v[82:83] op_sel_hi:[1,0,0]
  v_pk_fma_f32 v[106:107], v[106:107], v[82:83], v[82:83] op_sel_hi:[1,0,0]
  v_rcp_f32 v104, v104
  v_rcp_f32 v105, v105
  v_rcp_f32 v106, v106
  v_rcp_f32 v107, v107
  v_pk_mul_f32 v[212:213], v[212:213], v[104:105]
  v_pk_mul_f32 v[214:215], v[214:215], v[106:107]
  v_cvt_pk_bf16_f32 v122, v212, v213
  v_cvt_pk_bf16_f32 v123, v214, v215
  s_add_u32 s3, s10, 165888
  buffer_store_dwordx4 v[120:123], v12, s[44:47], s3 offen
  ds_write_b128 v18, v[120:123] offset:18432
  v_pk_mul_f32 v[100:101], v[200:201], v[200:201]
  v_pk_mul_f32 v[102:103], v[202:203], v[202:203]
  v_pk_fma_f32 v[100:101], v[100:101], v[84:85], v[84:85] op_sel:[0,1,0] op_sel_hi:[1,1,0]
  v_pk_fma_f32 v[102:103], v[102:103], v[84:85], v[84:85] op_sel:[0,1,0] op_sel_hi:[1,1,0]
  v_pk_mul_f32 v[100:101], v[100:101], v[200:201]
  v_pk_mul_f32 v[102:103], v[102:103], v[202:203]
  v_mfma_f32_16x16x16_bf16 v[216:219], v[52:53], v[68:69], v[216:219]
  v_exp_f32 v100, v100
  v_exp_f32 v101, v101
  v_exp_f32 v102, v102
  v_exp_f32 v103, v103
  v_pk_fma_f32 v[100:101], v[100:101], v[86:87], v[86:87] op_sel_hi:[1,0,0]
  v_pk_fma_f32 v[102:103], v[102:103], v[86:87], v[86:87] op_sel_hi:[1,0,0]
  v_rcp_f32 v100, v100
  v_rcp_f32 v101, v101
  v_rcp_f32 v102, v102
  v_rcp_f32 v103, v103
  v_pk_mul_f32 v[200:201], v[200:201], v[100:101]
  v_pk_mul_f32 v[202:203], v[202:203], v[102:103]
  v_cvt_pk_bf16_f32 v108, v200, v201
  v_cvt_pk_bf16_f32 v109, v202, v203
  v_pk_mul_f32 v[104:105], v[216:217], v[216:217]
  v_pk_mul_f32 v[106:107], v[218:219], v[218:219]
  v_pk_fma_f32 v[104:105], v[104:105], v[84:85], v[84:85] op_sel:[0,1,0] op_sel_hi:[1,1,0]
  v_pk_fma_f32 v[106:107], v[106:107], v[84:85], v[84:85] op_sel:[0,1,0] op_sel_hi:[1,1,0]
  v_pk_mul_f32 v[104:105], v[104:105], v[216:217]
  v_pk_mul_f32 v[106:107], v[106:107], v[218:219]
  v_mfma_f32_16x16x16_bf16 v[204:207], v[48:49], v[72:73], v[204:207]
  v_exp_f32 v104, v104
  v_exp_f32 v105, v105
  v_exp_f32 v106, v106
  v_exp_f32 v107, v107
  v_pk_fma_f32 v[104:105], v[104:105], v[86:87], v[86:87] op_sel_hi:[1,0,0]
  v_pk_fma_f32 v[106:107], v[106:107], v[86:87], v[86:87] op_sel_hi:[1,0,0]
  v_rcp_f32 v104, v104
  v_rcp_f32 v105, v105
  v_rcp_f32 v106, v106
  v_rcp_f32 v107, v107
  v_pk_mul_f32 v[216:217], v[216:217], v[104:105]
  v_pk_mul_f32 v[218:219], v[218:219], v[106:107]
  v_cvt_pk_bf16_f32 v110, v216, v217
  v_cvt_pk_bf16_f32 v111, v218, v219
  s_add_u32 s3, s10, 280576
  buffer_store_dwordx4 v[108:111], v12, s[44:47], s3 offen
  ds_write_b128 v18, v[108:111] offset:20480
  v_pk_mul_f32 v[100:101], v[204:205], v[204:205]
  v_pk_mul_f32 v[102:103], v[206:207], v[206:207]
  v_pk_fma_f32 v[100:101], v[100:101], v[88:89], v[88:89] op_sel:[0,1,0] op_sel_hi:[1,1,0]
  v_pk_fma_f32 v[102:103], v[102:103], v[88:89], v[88:89] op_sel:[0,1,0] op_sel_hi:[1,1,0]
  v_pk_mul_f32 v[100:101], v[100:101], v[204:205]
  v_pk_mul_f32 v[102:103], v[102:103], v[206:207]
  v_mfma_f32_16x16x16_bf16 v[220:223], v[52:53], v[72:73], v[220:223]
  v_exp_f32 v100, v100
  v_exp_f32 v101, v101
  v_exp_f32 v102, v102
  v_exp_f32 v103, v103
  v_pk_fma_f32 v[100:101], v[100:101], v[90:91], v[90:91] op_sel_hi:[1,0,0]
  v_pk_fma_f32 v[102:103], v[102:103], v[90:91], v[90:91] op_sel_hi:[1,0,0]
  v_rcp_f32 v100, v100
  v_rcp_f32 v101, v101
  v_rcp_f32 v102, v102
  v_rcp_f32 v103, v103
  v_pk_mul_f32 v[204:205], v[204:205], v[100:101]
  v_pk_mul_f32 v[206:207], v[206:207], v[102:103]
  v_cvt_pk_bf16_f32 v112, v204, v205
  v_cvt_pk_bf16_f32 v113, v206, v207
  v_pk_mul_f32 v[104:105], v[220:221], v[220:221]
  v_pk_mul_f32 v[106:107], v[222:223], v[222:223]
  v_pk_fma_f32 v[104:105], v[104:105], v[88:89], v[88:89] op_sel:[0,1,0] op_sel_hi:[1,1,0]
  v_pk_fma_f32 v[106:107], v[106:107], v[88:89], v[88:89] op_sel:[0,1,0] op_sel_hi:[1,1,0]
  v_pk_mul_f32 v[104:105], v[104:105], v[220:221]
  v_pk_mul_f32 v[106:107], v[106:107], v[222:223]
  v_exp_f32 v104, v104
  v_exp_f32 v105, v105
  v_exp_f32 v106, v106
  v_exp_f32 v107, v107
  v_pk_fma_f32 v[104:105], v[104:105], v[90:91], v[90:91] op_sel_hi:[1,0,0]
  v_pk_fma_f32 v[106:107], v[106:107], v[90:91], v[90:91] op_sel_hi:[1,0,0]
  v_rcp_f32 v104, v104
  v_rcp_f32 v105, v105
  v_rcp_f32 v106, v106
  v_rcp_f32 v107, v107
  v_pk_mul_f32 v[220:221], v[220:221], v[104:105]
  v_pk_mul_f32 v[222:223], v[222:223], v[106:107]
  v_cvt_pk_bf16_f32 v114, v220, v221
  v_cvt_pk_bf16_f32 v115, v222, v223
  s_add_u32 s3, s10, 395264
  buffer_store_dwordx4 v[112:115], v12, s[44:47], s3 offen
  ds_write_b128 v18, v[112:115] offset:22528
  v_add_u32 v2, 114688, v27
  v_mov_b32 v6, v8
  v_xor_b32 v7, 32, v8
  v_xor_b32 v9, 96, v8
  v_xor_b32 v8, 64, v8
  s_waitcnt vmcnt(14)
  v_lshlrev_b32 v216, 16, v10
  v_and_b32 v217, s11, v10
  v_lshlrev_b32 v218, 16, v11
  v_and_b32 v219, s11, v11
  v_lshlrev_b32 v96, 16, v240
  v_and_b32 v97, s11, v240
  v_pk_add_f32 v[96:97], v[96:97], v[216:217]
  v_lshlrev_b32 v98, 16, v241
  v_and_b32 v99, s11, v241
  v_pk_add_f32 v[98:99], v[98:99], v[218:219]
  v_lshlrev_b32 v100, 16, v248
  v_and_b32 v101, s11, v248
  v_pk_add_f32 v[100:101], v[100:101], v[216:217]
  v_lshlrev_b32 v102, 16, v249
  v_and_b32 v103, s11, v249
  v_pk_add_f32 v[102:103], v[102:103], v[218:219]
  v_lshlrev_b32 v216, 16, v24
  v_and_b32 v217, s11, v24
  v_lshlrev_b32 v218, 16, v25
  v_and_b32 v219, s11, v25
  v_lshlrev_b32 v104, 16, v242
  v_and_b32 v105, s11, v242
  v_pk_add_f32 v[104:105], v[104:105], v[216:217]
  v_lshlrev_b32 v106, 16, v243
  v_and_b32 v107, s11, v243
  v_pk_add_f32 v[106:107], v[106:107], v[218:219]
  v_lshlrev_b32 v108, 16, v250
  v_and_b32 v109, s11, v250
  v_pk_add_f32 v[108:109], v[108:109], v[216:217]
  v_lshlrev_b32 v110, 16, v251
  v_and_b32 v111, s11, v251
  v_pk_add_f32 v[110:111], v[110:111], v[218:219]
  v_lshlrev_b32 v216, 16, v124
  v_and_b32 v217, s11, v124
  v_lshlrev_b32 v218, 16, v125
  v_and_b32 v219, s11, v125
  v_lshlrev_b32 v112, 16, v244
  v_and_b32 v113, s11, v244
  v_pk_add_f32 v[112:113], v[112:113], v[216:217]
  v_lshlrev_b32 v114, 16, v245
  v_and_b32 v115, s11, v245
  v_pk_add_f32 v[114:115], v[114:115], v[218:219]
  v_lshlrev_b32 v116, 16, v252
  v_and_b32 v117, s11, v252
  v_pk_add_f32 v[116:117], v[116:117], v[216:217]
  v_lshlrev_b32 v118, 16, v253
  v_and_b32 v119, s11, v253
  v_pk_add_f32 v[118:119], v[118:119], v[218:219]
  v_lshlrev_b32 v216, 16, v126
  v_and_b32 v217, s11, v126
  v_lshlrev_b32 v218, 16, v127
  v_and_b32 v219, s11, v127
  v_lshlrev_b32 v120, 16, v246
  v_and_b32 v121, s11, v246
  v_pk_add_f32 v[120:121], v[120:121], v[216:217]
  v_lshlrev_b32 v122, 16, v247
  v_and_b32 v123, s11, v247
  v_pk_add_f32 v[122:123], v[122:123], v[218:219]
  v_lshlrev_b32 v124, 16, v254
  v_and_b32 v125, s11, v254
  v_pk_add_f32 v[124:125], v[124:125], v[216:217]
  v_lshlrev_b32 v126, 16, v255
  v_and_b32 v127, s11, v255
  v_pk_add_f32 v[126:127], v[126:127], v[218:219]
  s_waitcnt vmcnt(0) lgkmcnt(0)
  s_barrier
  s_add_u32 s97, s97, 1
  s_branch L_w2_compute
L_w1_c1:
L_w2_c0:
L_w2_body:
  s_cmp_ge_u32 s2, 256
  s_cbranch_scc1 L_w2_end
  v_lshrrev_b32 v2, 6, v0
  v_and_b32 v1, 63, v0
  v_readfirstlane_b32 s70, v2
  s_and_b32 s3, s2, 7
  s_lshr_b32 s99, s2, 3
  s_and_b32 s5, s3, 3
  s_lshl_b32 s5, s5, 2
  s_and_b32 s6, s99, 3
  s_add_u32 s68, s5, s6
  s_lshr_b32 s5, s3, 2
  s_lshr_b32 s78, s99, 2
  s_lshl1_add_u32 s69, s78, s5
  s_add_u32 s3, s68, s78
  s_lshl_b32 s3, s3, 3
  s_lshl_b32 s85, 0xffff02, s3
  s_sub_u32 s3, 0, s3
  s_lshr_b32 s3, 0xffff02, s3
  s_or_b32 s85, s85, s3
L_w2_loader:
  s_add_u32 s3, s68, s78
  s_and_b32 s3, s3, 3
  s_mov_b32 s4, 0x1616160
  s_cmp_eq_u32 s3, 1
  s_cselect_b32 s4, 0x5858580, s4
  s_cmp_eq_u32 s3, 2
  s_cselect_b32 s4, 0x16161600, s4
  s_cmp_eq_u32 s3, 3
  s_cselect_b32 s4, 0x58585800, s4
  v_subrev_u32 v2, 3, v1
  v_min_u32 v2, 16, v2
  v_lshlrev_b32 v3, 1, v2
  v_bfe_i32 v16, s4, v3, 2
  v_sub_u32 v16, v1, v16
  v_subrev_u32 v16, 7, v16
  v_ashrrev_i32 v3, 1, v16
  v_cmp_eq_u32 vcc, s78, v3
  s_and_b32 s3, s69, 1
  v_or_b32 v2, 14, v16
  v_cndmask_b32 v2, v16, v2, vcc
  v_cmp_gt_i32 vcc, 0, v16
  s_lshl2_add_u32 s4, s3, 20
  v_add_u32 v16, s4, v16
  s_lshl4_add_u32 s4, s3, 24
  v_add_u32 v2, s4, v2
  v_cndmask_b32 v16, v2, v16, vcc
  s_and_b32 s5, s68, 3
  s_mul_i32 s5, s5, 3
  s_sub_u32 s5, s5, 23
  v_add_u32 v3, s5, v1
  v_subrev_u32 v2, 10, v3
  v_min_u32 v3, v3, v2
  v_subrev_u32 v2, 10, v3
  v_min_u32 v3, v3, v2
  v_cmp_gt_u32 vcc, 23, v1
  s_sub_u32 s5, s3, 46
  v_lshl_add_u32 v2, v1, 1, s5
  v_cndmask_b32 v3, v3, v2, vcc
  s_add_u32 s5, s78, 3
  v_ashrrev_i32 v2, 1, v3
  v_add_u32 v2, s5, v2
  v_and_b32 v2, 7, v2
  v_and_b32 v3, 1, v3
  v_cmp_gt_u32 vcc, 21, v1
  v_lshl_add_u32 v3, v3, 3, v2
  s_lshl1_add_u32 s4, s78, s4
  s_lshl3_add_u32 s3, s3, s78
  v_cndmask_b32 v3, v3, v16, vcc
  v_writelane_b32 v3, s4, 0
  s_add_u32 s4, s4, 1
  v_writelane_b32 v3, s3, 2
  v_writelane_b32 v3, s4, 1
  v_lshlrev_b32 v16, 17, v3
  s_add_u32 s9, s70, s68
  s_and_b32 s9, s9, 3
  s_lshl_b32 s77, s9, 11
  v_and_b32 v10, 7, v1
  v_lshrrev_b32 v3, 3, v1
  s_lshl_b32 s10, s9, 4
  v_add_u32 v3, s10, v3
  v_mul_u32_u24 v3, 2048, v3
  v_lshrrev_b32 v2, 3, v1
  v_and_b32 v2, 6, v2
  v_xor_b32 v2, v2, v10
  s_lshl_b32 s10, s69, 7
  v_add_u32 v3, s10, v3
  v_lshl_add_u32 v8, v2, 4, v3
  v_add_u32 v3, 16384, v3
  v_lshl_add_u32 v9, v2, 4, v3
  s_mov_b32 s40, s28
  s_and_b32 s41, s29, 0xffff
  s_mov_b32 s42, 7340032
  s_mov_b32 s43, 0x00020000
  s_bitcmp1_b32 s69, 0
  s_mov_b32 s76, 128
  s_cselect_b32 s76, -128, s76
  v_readlane_b32 s74, v16, 0
  s_add_u32 m0, s77, 0
  s_add_u32 s4, s74, s76
  buffer_load_dwordx4 v8, s[40:43], s4 offen lds
  s_add_u32 m0, s77, 1024
  s_nop 0
  buffer_load_dwordx4 v9, s[40:43], s4 offen lds
  s_add_u32 m0, s77, 8192
  s_add_u32 s4, s74, 0
  buffer_load_dwordx4 v8, s[40:43], s4 offen lds
  s_add_u32 m0, s77, 9216
  s_nop 0
  buffer_load_dwordx4 v9, s[40:43], s4 offen lds
  v_readlane_b32 s74, v16, 1
  s_add_u32 m0, s77, 16384
  s_add_u32 s4, s74, s76
  buffer_load_dwordx4 v8, s[40:43], s4 offen lds
  s_add_u32 m0, s77, 17408
  s_nop 0
  buffer_load_dwordx4 v9, s[40:43], s4 offen lds
  s_add_u32 m0, s77, 24576
  s_add_u32 s4, s74, 0
  buffer_load_dwordx4 v8, s[40:43], s4 offen lds
  s_add_u32 m0, s77, 25600
  s_nop 0
  buffer_load_dwordx4 v9, s[40:43], s4 offen lds
  v_readlane_b32 s74, v16, 2
  s_add_u32 m0, s77, 32768
  s_add_u32 s4, s74, s76
  buffer_load_dwordx4 v8, s[40:43], s4 offen lds
  s_add_u32 m0, s77, 33792
  s_nop 0
  buffer_load_dwordx4 v9, s[40:43], s4 offen lds
  s_add_u32 m0, s77, 40960
  s_add_u32 s4, s74, 0
  buffer_load_dwordx4 v8, s[40:43], s4 offen lds
  s_add_u32 m0, s77, 41984
  s_nop 0
  buffer_load_dwordx4 v9, s[40:43], s4 offen lds
  v_readlane_b32 s74, v16, 3
  s_add_u32 m0, s77, 49152
  s_add_u32 s4, s74, s76
  buffer_load_dwordx4 v8, s[40:43], s4 offen lds
  s_add_u32 m0, s77, 50176
  s_nop 0
  buffer_load_dwordx4 v9, s[40:43], s4 offen lds
  s_add_u32 m0, s77, 57344
  s_add_u32 s4, s74, 0
  buffer_load_dwordx4 v8, s[40:43], s4 offen lds
  s_add_u32 m0, s77, 58368
  s_nop 0
  buffer_load_dwordx4 v9, s[40:43], s4 offen lds
  v_readlane_b32 s74, v16, 4
  s_add_u32 m0, s77, 65536
  s_add_u32 s4, s74, s76
  buffer_load_dwordx4 v8, s[40:43], s4 offen lds
  s_add_u32 m0, s77, 66560
  s_nop 0
  buffer_load_dwordx4 v9, s[40:43], s4 offen lds
  s_add_u32 m0, s77, 73728
  s_add_u32 s4, s74, 0
  buffer_load_dwordx4 v8, s[40:43], s4 offen lds
  s_add_u32 m0, s77, 74752
  s_nop 0
  buffer_load_dwordx4 v9, s[40:43], s4 offen lds
  s_add_u32 s44, s22, 41943040
  s_addc_u32 s45, s23, 0
  s_and_b32 s45, s45, 0xffff
  s_mov_b32 s46, 524288
  s_mov_b32 s47, 0x00020000
  s_lshl4_add_u32 s3, s97, s68
  s_and_b32 s4, s69, 15
  s_lshl4_add_u32 s3, s3, s4
  s_lshl_b32 s3, s3, 7
  s_sub_u32 s86, s3, 32768
  v_lshlrev_b32 v11, 7, v1
  v_and_b32 v2, 15, v1
  v_lshlrev_b32 v2, 2, v2
  s_cmp_lg_u32 s70, 4
  s_waitcnt vmcnt(14)
  s_cbranch_scc1 L_w2_nofl
  v_readlane_b32 s74, v16, 5
  s_add_u32 m0, s77, 81920
  s_add_u32 s4, s74, s76
  buffer_load_dwordx4 v8, s[40:43], s4 offen lds
  s_add_u32 m0, s77, 82944
  s_nop 0
  buffer_load_dwordx4 v9, s[40:43], s4 offen lds
  s_add_u32 m0, s77, 90112
  s_add_u32 s4, s74, 0
  buffer_load_dwordx4 v8, s[40:43], s4 offen lds
  s_add_u32 m0, s77, 91136
  s_nop 0
  buffer_load_dwordx4 v9, s[40:43], s4 offen lds
  v_readlane_b32 s74, v16, 6
  s_add_u32 m0, s77, 98304
  s_add_u32 s4, s74, s76
  buffer_load_dwordx4 v8, s[40:43], s4 offen lds
  s_add_u32 m0, s77, 99328
  s_nop 0
  buffer_load_dwordx4 v9, s[40:43], s4 offen lds
  v_mov_b32 v3, 1
  s_mov_b32 s79, 0x100000
  s_or_b32 s4, s2, 0xe0
  s_lshl4_add_u32 s4, s4, s97
  s_lshl_b32 s4, s4, 7
  s_lshl2_add_u32 s5, s78, s4
  s_cmp_eq_u32 s92, 0
  s_cselect_b32 s3, s4, s86
  s_cselect_b32 s4, 28, 60
  v_and_b32 v13, s4, v2
  buffer_load_dword v12, v13, s[44:47], s3 offen sc1
  s_setprio 3
  s_barrier
  s_cbranch_scc0 L_w2_wb
L_w2_wbd:
  s_mov_b64 exec, 1
  buffer_store_dword v3, off, s[44:47], s5
  s_mov_b64 exec, -1
L_w2_poll:
  buffer_load_dword v12, v13, s[44:47], s3 offen sc1
  s_sub_u32 s79, s79, 1
  s_cbranch_scc1 L_w2_dep
  s_waitcnt vmcnt(0)
  v_cmp_ne_u32 vcc, 1, v12
  s_cbranch_vccnz L_w2_poll
L_w2_dep:
  s_barrier
  s_setprio 0
  s_mov_b64 exec, 0xffff
  buffer_store_dword v3, v11, s[44:47], s87 offen sc1
  s_mov_b64 exec, -1
  s_branch L_w2_go
L_w2_nofl:
  s_barrier
  v_readlane_b32 s74, v16, 5
  s_add_u32 m0, s77, 81920
  s_add_u32 s4, s74, s76
  buffer_load_dwordx4 v8, s[40:43], s4 offen lds
  s_add_u32 m0, s77, 82944
  s_nop 0
  buffer_load_dwordx4 v9, s[40:43], s4 offen lds
  s_add_u32 m0, s77, 90112
  s_add_u32 s4, s74, 0
  buffer_load_dwordx4 v8, s[40:43], s4 offen lds
  s_add_u32 m0, s77, 91136
  s_nop 0
  buffer_load_dwordx4 v9, s[40:43], s4 offen lds
  v_readlane_b32 s74, v16, 6
  s_add_u32 m0, s77, 98304
  s_add_u32 s4, s74, s76
  buffer_load_dwordx4 v8, s[40:43], s4 offen lds
  s_add_u32 m0, s77, 99328
  s_nop 0
  buffer_load_dwordx4 v9, s[40:43], s4 offen lds
  s_waitcnt vmcnt(8)
  s_barrier
L_w2_go:
  s_add_u32 m0, s77, 106496
  s_add_u32 s4, s74, 0
  buffer_load_dwordx4 v8, s[40:43], s4 offen lds
  s_add_u32 m0, s77, 107520
  s_nop 0
  buffer_load_dwordx4 v9, s[40:43], s4 offen lds
  s_waitcnt vmcnt(4)
  v_readlane_b32 s74, v16, 7
  s_add_u32 m0, s77, 114688
  s_add_u32 s4, s74, s76
  buffer_load_dwordx4 v8, s[40:43], s4 offen lds
  s_add_u32 m0, s77, 115712
  s_nop 0
  buffer_load_dwordx4 v9, s[40:43], s4 offen lds
  s_waitcnt vmcnt(4)
  s_add_u32 m0, s77, 122880
  s_add_u32 s4, s74, 0
  buffer_load_dwordx4 v8, s[40:43], s4 offen lds
  s_add_u32 m0, s77, 123904
  s_nop 0
  buffer_load_dwordx4 v9, s[40:43], s4 offen lds
  s_waitcnt vmcnt(4)
  v_readlane_b32 s74, v16, 8
  s_add_u32 m0, s77, 131072
  s_add_u32 s4, s74, s76
  buffer_load_dwordx4 v8, s[40:43], s4 offen lds
  s_add_u32 m0, s77, 132096
  s_nop 0
  buffer_load_dwordx4 v9, s[40:43], s4 offen lds
  s_waitcnt vmcnt(4)
  s_add_u32 m0, s77, 139264
  s_add_u32 s4, s74, 0
  buffer_load_dwordx4 v8, s[40:43], s4 offen lds
  s_add_u32 m0, s77, 140288
  s_nop 0
  buffer_load_dwordx4 v9, s[40:43], s4 offen lds
  s_waitcnt vmcnt(4)
  v_readlane_b32 s74, v16, 9
  s_add_u32 m0, s77, 147456
  s_add_u32 s4, s74, s76
  buffer_load_dwordx4 v8, s[40:43], s4 offen lds
  s_add_u32 m0, s77, 148480
  s_nop 0
  buffer_load_dwordx4 v9, s[40:43], s4 offen lds
  s_waitcnt vmcnt(12)
  s_barrier
  s_add_u32 m0, s77, 155648
  s_add_u32 s4, s74, 0
  buffer_load_dwordx4 v8, s[40:43], s4 offen lds
  s_add_u32 m0, s77, 156672
  s_nop 0
  buffer_load_dwordx4 v9, s[40:43], s4 offen lds
  s_waitcnt vmcnt(4)
  v_readlane_b32 s74, v16, 10
  s_add_u32 m0, s77, 0
  s_add_u32 s4, s74, s76
  buffer_load_dwordx4 v8, s[40:43], s4 offen lds
  s_add_u32 m0, s77, 1024
  s_nop 0
  buffer_load_dwordx4 v9, s[40:43], s4 offen lds
  s_waitcnt vmcnt(4)
  s_add_u32 m0, s77, 8192
  s_add_u32 s4, s74, 0
  buffer_load_dwordx4 v8, s[40:43], s4 offen lds
  s_add_u32 m0, s77, 9216
  s_nop 0
  buffer_load_dwordx4 v9, s[40:43], s4 offen lds
  s_waitcnt vmcnt(4)
  v_readlane_b32 s74, v16, 11
  s_add_u32 m0, s77, 16384
  s_add_u32 s4, s74, s76
  buffer_load_dwordx4 v8, s[40:43], s4 offen lds
  s_add_u32 m0, s77, 17408
  s_nop 0
  buffer_load_dwordx4 v9, s[40:43], s4 offen lds
  s_waitcnt vmcnt(12)
  s_barrier
  s_add_u32 m0, s77, 24576
  s_add_u32 s4, s74, 0
  buffer_load_dwordx4 v8, s[40:43], s4 offen lds
  s_add_u32 m0, s77, 25600
  s_nop 0
  buffer_load_dwordx4 v9, s[40:43], s4 offen lds
  s_waitcnt vmcnt(4)
  v_readlane_b32 s74, v16, 12
  s_add_u32 m0, s77, 32768
  s_add_u32 s4, s74, s76
  buffer_load_dwordx4 v8, s[40:43], s4 offen lds
  s_add_u32 m0, s77, 33792
  s_nop 0
  buffer_load_dwordx4 v9, s[40:43], s4 offen lds
  s_waitcnt vmcnt(4)
  s_add_u32 m0, s77, 40960
  s_add_u32 s4, s74, 0
  buffer_load_dwordx4 v8, s[40:43], s4 offen lds
  s_add_u32 m0, s77, 41984
  s_nop 0
  buffer_load_dwordx4 v9, s[40:43], s4 offen lds
  s_waitcnt vmcnt(4)
  v_readlane_b32 s74, v16, 13
  s_add_u32 m0, s77, 49152
  s_add_u32 s4, s74, s76
  buffer_load_dwordx4 v8, s[40:43], s4 offen lds
  s_add_u32 m0, s77, 50176
  s_nop 0
  buffer_load_dwordx4 v9, s[40:43], s4 offen lds
  s_waitcnt vmcnt(12)
  s_barrier
  s_add_u32 m0, s77, 57344
  s_add_u32 s4, s74, 0
  buffer_load_dwordx4 v8, s[40:43], s4 offen lds
  s_add_u32 m0, s77, 58368
  s_nop 0
  buffer_load_dwordx4 v9, s[40:43], s4 offen lds
  s_waitcnt vmcnt(4)
  v_readlane_b32 s74, v16, 14
  s_add_u32 m0, s77, 65536
  s_add_u32 s4, s74, s76
  buffer_load_dwordx4 v8, s[40:43], s4 offen lds
  s_add_u32 m0, s77, 66560
  s_nop 0
  buffer_load_dwordx4 v9, s[40:43], s4 offen lds
  s_waitcnt vmcnt(4)
  s_add_u32 m0, s77, 73728
  s_add_u32 s4, s74, 0
  buffer_load_dwordx4 v8, s[40:43], s4 offen lds
  s_add_u32 m0, s77, 74752
  s_nop 0
  buffer_load_dwordx4 v9, s[40:43], s4 offen lds
  s_waitcnt vmcnt(4)
  v_readlane_b32 s74, v16, 15
  s_add_u32 m0, s77, 81920
  s_add_u32 s4, s74, s76
  buffer_load_dwordx4 v8, s[40:43], s4 offen lds
  s_add_u32 m0, s77, 82944
  s_nop 0
  buffer_load_dwordx4 v9, s[40:43], s4 offen lds
  s_waitcnt vmcnt(12)
  s_barrier
  s_add_u32 m0, s77, 90112
  s_add_u32 s4, s74, 0
  buffer_load_dwordx4 v8, s[40:43], s4 offen lds
  s_add_u32 m0, s77, 91136
  s_nop 0
  buffer_load_dwordx4 v9, s[40:43], s4 offen lds
  s_waitcnt vmcnt(4)
  v_readlane_b32 s74, v16, 16
  s_add_u32 m0, s77, 98304
  s_add_u32 s4, s74, s76
  buffer_load_dwordx4 v8, s[40:43], s4 offen lds
  s_add_u32 m0, s77, 99328
  s_nop 0
  buffer_load_dwordx4 v9, s[40:43], s4 offen lds
  s_waitcnt vmcnt(4)
  s_add_u32 m0, s77, 106496
  s_add_u32 s4, s74, 0
  buffer_load_dwordx4 v8, s[40:43], s4 offen lds
  s_add_u32 m0, s77, 107520
  s_nop 0
  buffer_load_dwordx4 v9, s[40:43], s4 offen lds
  s_waitcnt vmcnt(4)
  v_readlane_b32 s74, v16, 17
  s_add_u32 m0, s77, 114688
  s_add_u32 s4, s74, s76
  buffer_load_dwordx4 v8, s[40:43], s4 offen lds
  s_add_u32 m0, s77, 115712
  s_nop 0
  buffer_load_dwordx4 v9, s[40:43], s4 offen lds
  s_waitcnt vmcnt(12)
  s_barrier
  v_readlane_b32 s74, v16, 18
  s_add_u32 m0, s77, 122880
  s_add_u32 s4, s74, s76
  buffer_load_dwordx4 v8, s[40:43], s4 offen lds
  s_add_u32 m0, s77, 123904
  s_nop 0
  buffer_load_dwordx4 v9, s[40:43], s4 offen lds
  s_waitcnt vmcnt(4)
  v_readlane_b32 s74, v16, 19
  s_add_u32 m0, s77, 131072
  s_add_u32 s4, s74, s76
  buffer_load_dwordx4 v8, s[40:43], s4 offen lds
  s_add_u32 m0, s77, 132096
  s_nop 0
  buffer_load_dwordx4 v9, s[40:43], s4 offen lds
  s_waitcnt vmcnt(4)
  s_cmp_eq_u32 s70, 4
  s_cselect_b32 s46, s46, 0
  buffer_load_dword v3, v2, s[44:47], s86 offen sc1
  v_readlane_b32 s74, v16, 20
  s_add_u32 m0, s77, 139264
  s_add_u32 s4, s74, s76
  buffer_load_dwordx4 v8, s[40:43], s4 offen lds
  s_add_u32 m0, s77, 140288
  s_nop 0
  buffer_load_dwordx4 v9, s[40:43], s4 offen lds
  s_waitcnt vmcnt(4)
  v_readlane_b32 s74, v16, 21
  s_add_u32 m0, s77, 147456
  s_add_u32 s4, s74, s76
  buffer_load_dwordx4 v8, s[40:43], s4 offen lds
  s_add_u32 m0, s77, 148480
  s_nop 0
  buffer_load_dwordx4 v9, s[40:43], s4 offen lds
  s_mov_b32 s79, 0x100000
  s_cmp_lg_u32 s70, 4
  s_cbranch_scc1 L_w2l_dep
  s_waitcnt vmcnt(4)
  v_cmp_ne_u32 vcc, 1, v3
  s_cbranch_vccz L_w2l_dep
L_w2l_poll:
  buffer_load_dword v3, v2, s[44:47], s86 offen sc1
  s_sub_u32 s79, s79, 1
  s_cbranch_scc1 L_w2l_dep
  s_waitcnt vmcnt(0)
  v_cmp_ne_u32 vcc, 1, v3
  s_cbranch_vccnz L_w2l_poll
L_w2l_dep:
  s_waitcnt vmcnt(13)
  s_barrier
  v_readlane_b32 s74, v16, 22
  s_add_u32 m0, s77, 155648
  s_add_u32 s4, s74, s76
  buffer_load_dwordx4 v8, s[40:43], s4 offen lds
  s_add_u32 m0, s77, 156672
  s_nop 0
  buffer_load_dwordx4 v9, s[40:43], s4 offen lds
  s_waitcnt vmcnt(4)
  v_readlane_b32 s74, v16, 17
  s_add_u32 m0, s77, 0
  s_add_u32 s4, s74, 0
  buffer_load_dwordx4 v8, s[40:43], s4 offen lds
  s_add_u32 m0, s77, 1024
  s_nop 0
  buffer_load_dwordx4 v9, s[40:43], s4 offen lds
  s_waitcnt vmcnt(4)
  v_readlane_b32 s74, v16, 18
  s_add_u32 m0, s77, 8192
  s_add_u32 s4, s74, 0
  buffer_load_dwordx4 v8, s[40:43], s4 offen lds
  s_add_u32 m0, s77, 9216
  s_nop 0
  buffer_load_dwordx4 v9, s[40:43], s4 offen lds
  s_waitcnt vmcnt(4)
  v_readlane_b32 s74, v16, 19
  s_add_u32 m0, s77, 16384
  s_add_u32 s4, s74, 0
  buffer_load_dwordx4 v8, s[40:43], s4 offen lds
  s_add_u32 m0, s77, 17408
  s_nop 0
  buffer_load_dwordx4 v9, s[40:43], s4 offen lds
  s_waitcnt vmcnt(13)
  s_barrier
  v_readlane_b32 s74, v16, 20
  s_add_u32 m0, s77, 24576
  s_add_u32 s4, s74, 0
  buffer_load_dwordx4 v8, s[40:43], s4 offen lds
  s_add_u32 m0, s77, 25600
  s_nop 0
  buffer_load_dwordx4 v9, s[40:43], s4 offen lds
  s_waitcnt vmcnt(30)
  v_readlane_b32 s74, v16, 21
  s_add_u32 m0, s77, 32768
  s_add_u32 s4, s74, 0
  buffer_load_dwordx4 v8, s[40:43], s4 offen lds
  s_add_u32 m0, s77, 33792
  s_nop 0
  buffer_load_dwordx4 v9, s[40:43], s4 offen lds
  s_waitcnt vmcnt(30)
  v_readlane_b32 s74, v16, 22
  s_add_u32 m0, s77, 40960
  s_add_u32 s4, s74, 0
  buffer_load_dwordx4 v8, s[40:43], s4 offen lds
  s_add_u32 m0, s77, 41984
  s_nop 0
  buffer_load_dwordx4 v9, s[40:43], s4 offen lds
  s_waitcnt vmcnt(30)
  v_readlane_b32 s74, v16, 23
  s_add_u32 m0, s77, 49152
  s_add_u32 s4, s74, 0
  buffer_load_dwordx4 v8, s[40:43], s4 offen lds
  s_add_u32 m0, s77, 50176
  s_nop 0
  buffer_load_dwordx4 v9, s[40:43], s4 offen lds
  s_waitcnt vmcnt(30)
  v_readlane_b32 s74, v16, 24
  s_add_u32 m0, s77, 57344
  s_add_u32 s4, s74, 0
  buffer_load_dwordx4 v8, s[40:43], s4 offen lds
  s_add_u32 m0, s77, 58368
  s_nop 0
  buffer_load_dwordx4 v9, s[40:43], s4 offen lds
  s_waitcnt vmcnt(30)
  v_readlane_b32 s74, v16, 25
  s_add_u32 m0, s77, 65536
  s_add_u32 s4, s74, 0
  buffer_load_dwordx4 v8, s[40:43], s4 offen lds
  s_add_u32 m0, s77, 66560
  s_nop 0
  buffer_load_dwordx4 v9, s[40:43], s4 offen lds
  s_waitcnt vmcnt(30)
  v_readlane_b32 s74, v16, 26
  s_add_u32 m0, s77, 73728
  s_add_u32 s4, s74, 0
  buffer_load_dwordx4 v8, s[40:43], s4 offen lds
  s_add_u32 m0, s77, 74752
  s_nop 0
  buffer_load_dwordx4 v9, s[40:43], s4 offen lds
  s_waitcnt vmcnt(30)
  v_readlane_b32 s74, v16, 27
  s_add_u32 m0, s77, 81920
  s_add_u32 s4, s74, 0
  buffer_load_dwordx4 v8, s[40:43], s4 offen lds
  s_add_u32 m0, s77, 82944
  s_nop 0
  buffer_load_dwordx4 v9, s[40:43], s4 offen lds
  s_waitcnt vmcnt(30)
  v_readlane_b32 s74, v16, 28
  s_add_u32 m0, s77, 90112
  s_add_u32 s4, s74, 0
  buffer_load_dwordx4 v8, s[40:43], s4 offen lds
  s_add_u32 m0, s77, 91136
  s_nop 0
  buffer_load_dwordx4 v9, s[40:43], s4 offen lds
  s_waitcnt vmcnt(22)
  s_barrier
  v_readlane_b32 s74, v16, 29
  s_add_u32 m0, s77, 98304
  s_add_u32 s4, s74, 0
  buffer_load_dwordx4 v8, s[40:43], s4 offen lds
  s_add_u32 m0, s77, 99328
  s_nop 0
  buffer_load_dwordx4 v9, s[40:43], s4 offen lds
  s_waitcnt vmcnt(30)
  v_readlane_b32 s74, v16, 30
  s_add_u32 m0, s77, 106496
  s_add_u32 s4, s74, 0
  buffer_load_dwordx4 v8, s[40:43], s4 offen lds
  s_add_u32 m0, s77, 107520
  s_nop 0
  buffer_load_dwordx4 v9, s[40:43], s4 offen lds
  s_waitcnt vmcnt(30)
  v_readlane_b32 s74, v16, 31
  s_add_u32 m0, s77, 114688
  s_add_u32 s4, s74, 0
  buffer_load_dwordx4 v8, s[40:43], s4 offen lds
  s_add_u32 m0, s77, 115712
  s_nop 0
  buffer_load_dwordx4 v9, s[40:43], s4 offen lds
  s_waitcnt vmcnt(30)
  v_readlane_b32 s74, v16, 32
  s_add_u32 m0, s77, 122880
  s_add_u32 s4, s74, 0
  buffer_load_dwordx4 v8, s[40:43], s4 offen lds
  s_add_u32 m0, s77, 123904
  s_nop 0
  buffer_load_dwordx4 v9, s[40:43], s4 offen lds
  s_waitcnt vmcnt(22)
  s_barrier
  s_add_u32 s64, s22, 41943040
  s_addc_u32 s65, s23, 0
  s_and_b32 s65, s65, 0xffff
  s_mov_b32 s66, 524288
  s_mov_b32 s67, 0x00020000
  s_lshl4_add_u32 s6, s68, s69
  s_xor_b32 s6, s6, 1
  s_add_u32 s7, s96, 4
  s_lshl_b32 s7, s7, 8
  s_add_u32 s6, s6, s7
  s_lshl_b32 s86, s6, 8
  v_and_b32 v2, 3, v1
  v_lshlrev_b32 v30, 6, v2
  s_mov_b32 s79, 0x100000
  s_waitcnt vmcnt(0)
  s_barrier
  s_cmp_eq_u32 s96, 0
  s_cbranch_scc1 L_w2_zskip
  s_cmp_lg_u32 s70, 4
  s_cbranch_scc1 L_w2_xgo
  s_setprio 3
L_w2_xpoll:
  buffer_load_dword v5, v30, s[64:67], s86 offen sc1
  s_sub_u32 s79, s79, 1
  s_cbranch_scc1 L_w2_xgo
  s_waitcnt vmcnt(0)
  v_cmp_ne_u32 vcc, 1, v5
  s_cbranch_vccnz L_w2_xpoll
L_w2_xgo:
  s_setprio 0
  s_waitcnt vmcnt(0)
  s_barrier
L_w2_zskip:
  s_cmp_eq_u32 s96, 1
  s_cbranch_scc1 L_w2_end
  s_lshl_b32 s87, s97, 15
  s_lshl_b32 s4, s68, 11
  s_add_u32 s87, s87, s4
  s_lshl_b32 s4, s69, 2
  s_add_u32 s87, s87, s4
  s_mov_b32 s96, 1
  s_add_u32 s12, s22, 33554432
  s_addc_u32 s13, s23, 0
  s_add_u32 s34, s22, 67108864
  s_addc_u32 s35, s23, 0
  s_add_u32 s97, s97, 1
  s_branch L_attn_body
L_w2_wb:
  buffer_wbl2 sc1
  s_waitcnt vmcnt(0)
  s_mov_b64 exec, 0xffff
  buffer_store_dword v3, v11, s[44:47], s87 offen sc1
  s_branch L_w2_wbd
L_w2_end:
  s_endpgm
L_w2_compute:
  ds_read_b128 v[32:35], v2 offset:0
  ds_read_b128 v[36:39], v2 offset:2048
  ds_read_b64_tr_b16 v[160:161], v6 offset:0
  ds_read_b64_tr_b16 v[162:163], v6 offset:2048
  ds_read_b64_tr_b16 v[164:165], v7 offset:0
  ds_read_b64_tr_b16 v[166:167], v7 offset:2048
  ds_read_b64_tr_b16 v[168:169], v8 offset:0
  ds_read_b64_tr_b16 v[170:171], v8 offset:2048
  ds_read_b64_tr_b16 v[172:173], v9 offset:0
  ds_read_b64_tr_b16 v[174:175], v9 offset:2048
  ds_read_b128 v[40:43], v2 offset:1024
  ds_read_b128 v[44:47], v2 offset:3072
  ds_read_b64_tr_b16 v[176:177], v6 offset:4096
  ds_read_b64_tr_b16 v[178:179], v6 offset:6144
  ds_read_b64_tr_b16 v[180:181], v7 offset:4096
  ds_read_b64_tr_b16 v[182:183], v7 offset:6144
  ds_read_b64_tr_b16 v[184:185], v8 offset:4096
  ds_read_b64_tr_b16 v[186:187], v8 offset:6144
  ds_read_b64_tr_b16 v[188:189], v9 offset:4096
  ds_read_b64_tr_b16 v[190:191], v9 offset:6144
  ds_read_b128 v[48:51], v2 offset:16384
  ds_read_b128 v[52:55], v2 offset:18432
  ds_read_b128 v[56:59], v2 offset:17408
  ds_read_b128 v[60:63], v2 offset:19456
  ds_read_b128 v[64:67], v2 offset:32768
  ds_read_b128 v[68:71], v2 offset:34816
  ds_read_b128 v[72:75], v2 offset:33792
  ds_read_b128 v[76:79], v2 offset:35840
  s_waitcnt lgkmcnt(15)
  v_mfma_f32_16x16x32_bf16 v[128:131], v[160:163], v[32:35], 0
  ds_read_b64_tr_b16 v[192:193], v6 offset:8192
  v_mov_b32 v4, v26
  v_mfma_f32_16x16x32_bf16 v[132:135], v[160:163], v[36:39], 0
  ds_read_b64_tr_b16 v[194:195], v6 offset:10240
  v_mov_b32 v5, v27
  v_mfma_f32_16x16x32_bf16 v[140:143], v[164:167], v[36:39], 0
  ds_read_b64_tr_b16 v[196:197], v7 offset:8192
  v_mov_b32 v12, v28
  v_mfma_f32_16x16x32_bf16 v[136:139], v[164:167], v[32:35], 0
  ds_read_b64_tr_b16 v[198:199], v7 offset:10240
  v_mov_b32 v18, v29
  v_mfma_f32_16x16x32_bf16 v[144:147], v[168:171], v[32:35], 0
  ds_read_b64_tr_b16 v[200:201], v8 offset:8192
  v_mov_b32 v19, 1
  v_mfma_f32_16x16x32_bf16 v[148:151], v[168:171], v[36:39], 0
  ds_read_b64_tr_b16 v[202:203], v8 offset:10240
  v_add_u32 v20, 65536, v6
  v_mfma_f32_16x16x32_bf16 v[156:159], v[172:175], v[36:39], 0
  ds_read_b64_tr_b16 v[204:205], v9 offset:8192
  v_add_u32 v21, 65536, v7
  v_mfma_f32_16x16x32_bf16 v[152:155], v[172:175], v[32:35], 0
  ds_read_b64_tr_b16 v[206:207], v9 offset:10240
  s_waitcnt lgkmcnt(15)
  v_mfma_f32_16x16x32_bf16 v[128:131], v[176:179], v[40:43], v[128:131]
  ds_read_b64_tr_b16 v[208:209], v6 offset:12288
  v_add_u32 v22, 65536, v8
  v_mfma_f32_16x16x32_bf16 v[132:135], v[176:179], v[44:47], v[132:135]
  ds_read_b64_tr_b16 v[210:211], v6 offset:14336
  v_add_u32 v23, 65536, v9
  v_mfma_f32_16x16x32_bf16 v[140:143], v[180:183], v[44:47], v[140:143]
  ds_read_b64_tr_b16 v[212:213], v7 offset:12288
  v_add_u32 v26, 131072, v6
  v_mfma_f32_16x16x32_bf16 v[136:139], v[180:183], v[40:43], v[136:139]
  ds_read_b64_tr_b16 v[214:215], v7 offset:14336
  v_add_u32 v27, 131072, v7
  v_mfma_f32_16x16x32_bf16 v[144:147], v[184:187], v[40:43], v[144:147]
  ds_read_b64_tr_b16 v[216:217], v8 offset:12288
  v_add_u32 v28, 131072, v8
  v_mfma_f32_16x16x32_bf16 v[148:151], v[184:187], v[44:47], v[148:151]
  ds_read_b64_tr_b16 v[218:219], v8 offset:14336
  v_add_u32 v29, 131072, v9
  v_mfma_f32_16x16x32_bf16 v[156:159], v[188:191], v[44:47], v[156:159]
  ds_read_b64_tr_b16 v[220:221], v9 offset:12288
  s_add_u32 s52, s22, 41943040
  v_mfma_f32_16x16x32_bf16 v[152:155], v[188:191], v[40:43], v[152:155]
  ds_read_b64_tr_b16 v[222:223], v9 offset:14336
  s_waitcnt lgkmcnt(8)
  v_mfma_f32_16x16x32_bf16 v[96:99], v[192:195], v[32:35], v[96:99]
  ds_read_b64_tr_b16 v[160:161], v6 offset:16384
  s_addc_u32 s53, s23, 0
  v_mfma_f32_16x16x32_bf16 v[100:103], v[192:195], v[36:39], v[100:103]
  ds_read_b64_tr_b16 v[162:163], v6 offset:18432
  s_and_b32 s53, s53, 0xffff
  v_mfma_f32_16x16x32_bf16 v[108:111], v[196:199], v[36:39], v[108:111]
  ds_read_b64_tr_b16 v[164:165], v7 offset:16384
  s_mov_b32 s54, 524288
  v_mfma_f32_16x16x32_bf16 v[104:107], v[196:199], v[32:35], v[104:107]
  ds_read_b64_tr_b16 v[166:167], v7 offset:18432
  s_mov_b32 s55, 0x00020000
  v_mfma_f32_16x16x32_bf16 v[112:115], v[200:203], v[32:35], v[112:115]
  ds_read_b64_tr_b16 v[168:169], v8 offset:16384
  v_mfma_f32_16x16x32_bf16 v[116:119], v[200:203], v[36:39], v[116:119]
  ds_read_b64_tr_b16 v[170:171], v8 offset:18432
  v_mfma_f32_16x16x32_bf16 v[124:127], v[204:207], v[36:39], v[124:127]
  ds_read_b64_tr_b16 v[172:173], v9 offset:16384
  v_mfma_f32_16x16x32_bf16 v[120:123], v[204:207], v[32:35], v[120:123]
  ds_read_b64_tr_b16 v[174:175], v9 offset:18432
  s_waitcnt lgkmcnt(8)
  s_barrier
  buffer_load_dwordx4 v[80:83], off, s[36:39], s51 offset:0 sc1
  buffer_load_dwordx4 v[84:87], off, s[64:67], s51 offset:0 sc1
  buffer_load_dwordx4 v[88:91], off, s[36:39], s51 offset:1024 sc1
  buffer_load_dwordx4 v[92:95], off, s[64:67], s51 offset:1024 sc1
  buffer_load_dwordx4 v[224:227], off, s[36:39], s48 offset:0 sc1
  buffer_load_dwordx4 v[228:231], off, s[64:67], s48 offset:0 sc1
  buffer_load_dwordx4 v[232:235], off, s[36:39], s48 offset:1024 sc1
  buffer_load_dwordx4 v[236:239], off, s[64:67], s48 offset:1024 sc1
  buffer_load_dwordx4 v[240:243], off, s[36:39], s49 offset:0 sc1
  buffer_load_dwordx4 v[244:247], off, s[64:67], s49 offset:0 sc1
  buffer_load_dwordx4 v[248:251], off, s[36:39], s49 offset:1024 sc1
  buffer_load_dwordx4 v[252:255], off, s[64:67], s49 offset:1024 sc1
  v_mfma_f32_16x16x32_bf16 v[96:99], v[208:211], v[40:43], v[96:99]
  ds_read_b64_tr_b16 v[176:177], v6 offset:20480
  v_mfma_f32_16x16x32_bf16 v[100:103], v[208:211], v[44:47], v[100:103]
  ds_read_b64_tr_b16 v[178:179], v6 offset:22528
  v_mfma_f32_16x16x32_bf16 v[108:111], v[212:215], v[44:47], v[108:111]
  ds_read_b64_tr_b16 v[180:181], v7 offset:20480
  v_mfma_f32_16x16x32_bf16 v[104:107], v[212:215], v[40:43], v[104:107]
  ds_read_b64_tr_b16 v[182:183], v7 offset:22528
  v_mfma_f32_16x16x32_bf16 v[112:115], v[216:219], v[40:43], v[112:115]
  ds_read_b64_tr_b16 v[184:185], v8 offset:20480
  v_mfma_f32_16x16x32_bf16 v[116:119], v[216:219], v[44:47], v[116:119]
  ds_read_b64_tr_b16 v[186:187], v8 offset:22528
  v_readlane_b32 s50, v30, 6
  v_mfma_f32_16x16x32_bf16 v[124:127], v[220:223], v[44:47], v[124:127]
  ds_read_b64_tr_b16 v[188:189], v9 offset:20480
  v_mfma_f32_16x16x32_bf16 v[120:123], v[220:223], v[40:43], v[120:123]
  ds_read_b64_tr_b16 v[190:191], v9 offset:22528
  s_waitcnt lgkmcnt(8)
  v_mfma_f32_16x16x32_bf16 v[128:131], v[160:163], v[48:51], v[128:131]
  buffer_load_dwordx4 v[32:35], off, s[36:39], s50 offset:0 sc1
  v_mfma_f32_16x16x32_bf16 v[132:135], v[160:163], v[52:55], v[132:135]
  ds_read_b64_tr_b16 v[192:193], v6 offset:24576
  ds_read_b64_tr_b16 v[194:195], v6 offset:26624
  v_mfma_f32_16x16x32_bf16 v[140:143], v[164:167], v[52:55], v[140:143]
  ds_read_b64_tr_b16 v[196:197], v7 offset:24576
  v_mfma_f32_16x16x32_bf16 v[136:139], v[164:167], v[48:51], v[136:139]
  buffer_load_dwordx4 v[36:39], off, s[64:67], s50 offset:0 sc1
  v_mfma_f32_16x16x32_bf16 v[144:147], v[168:171], v[48:51], v[144:147]
  ds_read_b64_tr_b16 v[198:199], v7 offset:26624
  ds_read_b64_tr_b16 v[200:201], v8 offset:24576
  v_mfma_f32_16x16x32_bf16 v[148:151], v[168:171], v[52:55], v[148:151]
  ds_read_b64_tr_b16 v[202:203], v8 offset:26624
  ds_read_b64_tr_b16 v[204:205], v9 offset:24576
  v_mfma_f32_16x16x32_bf16 v[156:159], v[172:175], v[52:55], v[156:159]
  buffer_load_dwordx4 v[40:43], off, s[36:39], s50 offset:1024 sc1
  v_mfma_f32_16x16x32_bf16 v[152:155], v[172:175], v[48:51], v[152:155]
  ds_read_b64_tr_b16 v[206:207], v9 offset:26624
  s_waitcnt lgkmcnt(8)
  v_mfma_f32_16x16x32_bf16 v[128:131], v[176:179], v[56:59], v[128:131]
  ds_read_b64_tr_b16 v[208:209], v6 offset:28672
  v_mfma_f32_16x16x32_bf16 v[132:135], v[176:179], v[60:63], v[132:135]
  buffer_load_dwordx4 v[44:47], off, s[64:67], s50 offset:1024 sc1
  v_mfma_f32_16x16x32_bf16 v[140:143], v[180:183], v[60:63], v[140:143]
  ds_read_b64_tr_b16 v[210:211], v6 offset:30720
  ds_read_b64_tr_b16 v[212:213], v7 offset:28672
  v_mfma_f32_16x16x32_bf16 v[136:139], v[180:183], v[56:59], v[136:139]
  ds_read_b64_tr_b16 v[214:215], v7 offset:30720
  v_mfma_f32_16x16x32_bf16 v[144:147], v[184:187], v[56:59], v[144:147]
  ds_read_b64_tr_b16 v[216:217], v8 offset:28672
  v_mfma_f32_16x16x32_bf16 v[148:151], v[184:187], v[60:63], v[148:151]
  ds_read_b64_tr_b16 v[218:219], v8 offset:30720
  v_mfma_f32_16x16x32_bf16 v[156:159], v[188:191], v[60:63], v[156:159]
  ds_read_b64_tr_b16 v[220:221], v9 offset:28672
  v_mfma_f32_16x16x32_bf16 v[152:155], v[188:191], v[56:59], v[152:155]
  ds_read_b64_tr_b16 v[222:223], v9 offset:30720
  s_waitcnt lgkmcnt(8)
  v_mfma_f32_16x16x32_bf16 v[96:99], v[192:195], v[48:51], v[96:99]
  ds_read_b64_tr_b16 v[160:161], v6 offset:32768
  v_mfma_f32_16x16x32_bf16 v[100:103], v[192:195], v[52:55], v[100:103]
  ds_read_b64_tr_b16 v[162:163], v6 offset:34816
  v_mfma_f32_16x16x32_bf16 v[108:111], v[196:199], v[52:55], v[108:111]
  ds_read_b64_tr_b16 v[164:165], v7 offset:32768
  v_mfma_f32_16x16x32_bf16 v[104:107], v[196:199], v[48:51], v[104:107]
  ds_read_b64_tr_b16 v[166:167], v7 offset:34816
  v_mfma_f32_16x16x32_bf16 v[112:115], v[200:203], v[48:51], v[112:115]
  ds_read_b64_tr_b16 v[168:169], v8 offset:32768
  v_mfma_f32_16x16x32_bf16 v[116:119], v[200:203], v[52:55], v[116:119]
  ds_read_b64_tr_b16 v[170:171], v8 offset:34816
  v_mfma_f32_16x16x32_bf16 v[124:127], v[204:207], v[52:55], v[124:127]
  ds_read_b64_tr_b16 v[172:173], v9 offset:32768
  v_mfma_f32_16x16x32_bf16 v[120:123], v[204:207], v[48:51], v[120:123]
  ds_read_b64_tr_b16 v[174:175], v9 offset:34816
  s_waitcnt lgkmcnt(8)
  v_mfma_f32_16x16x32_bf16 v[96:99], v[208:211], v[56:59], v[96:99]
  ds_read_b64_tr_b16 v[176:177], v6 offset:36864
  v_mfma_f32_16x16x32_bf16 v[100:103], v[208:211], v[60:63], v[100:103]
  ds_read_b64_tr_b16 v[178:179], v6 offset:38912
  v_mfma_f32_16x16x32_bf16 v[108:111], v[212:215], v[60:63], v[108:111]
  ds_read_b64_tr_b16 v[180:181], v7 offset:36864
  v_mfma_f32_16x16x32_bf16 v[104:107], v[212:215], v[56:59], v[104:107]
  ds_read_b64_tr_b16 v[182:183], v7 offset:38912
  v_mfma_f32_16x16x32_bf16 v[112:115], v[216:219], v[56:59], v[112:115]
  ds_read_b64_tr_b16 v[184:185], v8 offset:36864
  v_mfma_f32_16x16x32_bf16 v[116:119], v[216:219], v[60:63], v[116:119]
  ds_read_b64_tr_b16 v[186:187], v8 offset:38912
  v_readlane_b32 s51, v30, 7
  v_mfma_f32_16x16x32_bf16 v[124:127], v[220:223], v[60:63], v[124:127]
  ds_read_b64_tr_b16 v[188:189], v9 offset:36864
  v_mfma_f32_16x16x32_bf16 v[120:123], v[220:223], v[56:59], v[120:123]
  ds_read_b64_tr_b16 v[190:191], v9 offset:38912
  s_waitcnt lgkmcnt(8)
  v_mfma_f32_16x16x32_bf16 v[128:131], v[160:163], v[64:67], v[128:131]
  buffer_load_dwordx4 v[48:51], off, s[36:39], s51 offset:0 sc1
  v_mfma_f32_16x16x32_bf16 v[132:135], v[160:163], v[68:71], v[132:135]
  ds_read_b64_tr_b16 v[192:193], v6 offset:40960
  ds_read_b64_tr_b16 v[194:195], v6 offset:43008
  v_mfma_f32_16x16x32_bf16 v[140:143], v[164:167], v[68:71], v[140:143]
  ds_read_b64_tr_b16 v[196:197], v7 offset:40960
  v_mfma_f32_16x16x32_bf16 v[136:139], v[164:167], v[64:67], v[136:139]
  buffer_load_dwordx4 v[52:55], off, s[64:67], s51 offset:0 sc1
  v_mfma_f32_16x16x32_bf16 v[144:147], v[168:171], v[64:67], v[144:147]
  ds_read_b64_tr_b16 v[198:199], v7 offset:43008
  ds_read_b64_tr_b16 v[200:201], v8 offset:40960
  v_mfma_f32_16x16x32_bf16 v[148:151], v[168:171], v[68:71], v[148:151]
  ds_read_b64_tr_b16 v[202:203], v8 offset:43008
  ds_read_b64_tr_b16 v[204:205], v9 offset:40960
  v_mfma_f32_16x16x32_bf16 v[156:159], v[172:175], v[68:71], v[156:159]
  buffer_load_dwordx4 v[56:59], off, s[36:39], s51 offset:1024 sc1
  v_mfma_f32_16x16x32_bf16 v[152:155], v[172:175], v[64:67], v[152:155]
  ds_read_b64_tr_b16 v[206:207], v9 offset:43008
  s_waitcnt lgkmcnt(8)
  v_mfma_f32_16x16x32_bf16 v[128:131], v[176:179], v[72:75], v[128:131]
  ds_read_b64_tr_b16 v[208:209], v6 offset:45056
  v_mfma_f32_16x16x32_bf16 v[132:135], v[176:179], v[76:79], v[132:135]
  buffer_load_dwordx4 v[60:63], off, s[64:67], s51 offset:1024 sc1
  v_mfma_f32_16x16x32_bf16 v[140:143], v[180:183], v[76:79], v[140:143]
  ds_read_b64_tr_b16 v[210:211], v6 offset:47104
  ds_read_b64_tr_b16 v[212:213], v7 offset:45056
  v_mfma_f32_16x16x32_bf16 v[136:139], v[180:183], v[72:75], v[136:139]
  ds_read_b64_tr_b16 v[214:215], v7 offset:47104
  v_mfma_f32_16x16x32_bf16 v[144:147], v[184:187], v[72:75], v[144:147]
  ds_read_b64_tr_b16 v[216:217], v8 offset:45056
  v_mfma_f32_16x16x32_bf16 v[148:151], v[184:187], v[76:79], v[148:151]
  ds_read_b64_tr_b16 v[218:219], v8 offset:47104
  v_mfma_f32_16x16x32_bf16 v[156:159], v[188:191], v[76:79], v[156:159]
  ds_read_b64_tr_b16 v[220:221], v9 offset:45056
  v_mfma_f32_16x16x32_bf16 v[152:155], v[188:191], v[72:75], v[152:155]
  ds_read_b64_tr_b16 v[222:223], v9 offset:47104
  s_waitcnt lgkmcnt(8)
  v_mfma_f32_16x16x32_bf16 v[96:99], v[192:195], v[64:67], v[96:99]
  ds_read_b64_tr_b16 v[160:161], v6 offset:49152
  v_mfma_f32_16x16x32_bf16 v[100:103], v[192:195], v[68:71], v[100:103]
  ds_read_b64_tr_b16 v[162:163], v6 offset:51200
  v_mfma_f32_16x16x32_bf16 v[108:111], v[196:199], v[68:71], v[108:111]
  ds_read_b64_tr_b16 v[164:165], v7 offset:49152
  v_mfma_f32_16x16x32_bf16 v[104:107], v[196:199], v[64:67], v[104:107]
  ds_read_b64_tr_b16 v[166:167], v7 offset:51200
  v_mfma_f32_16x16x32_bf16 v[112:115], v[200:203], v[64:67], v[112:115]
  ds_read_b64_tr_b16 v[168:169], v8 offset:49152
  v_mfma_f32_16x16x32_bf16 v[116:119], v[200:203], v[68:71], v[116:119]
  ds_read_b64_tr_b16 v[170:171], v8 offset:51200
  v_mfma_f32_16x16x32_bf16 v[124:127], v[204:207], v[68:71], v[124:127]
  ds_read_b64_tr_b16 v[172:173], v9 offset:49152
  v_mfma_f32_16x16x32_bf16 v[120:123], v[204:207], v[64:67], v[120:123]
  ds_read_b64_tr_b16 v[174:175], v9 offset:51200
  s_waitcnt lgkmcnt(8)
  v_mfma_f32_16x16x32_bf16 v[96:99], v[208:211], v[72:75], v[96:99]
  ds_read_b64_tr_b16 v[176:177], v6 offset:53248
  v_mfma_f32_16x16x32_bf16 v[100:103], v[208:211], v[76:79], v[100:103]
  ds_read_b64_tr_b16 v[178:179], v6 offset:55296
  v_mfma_f32_16x16x32_bf16 v[108:111], v[212:215], v[76:79], v[108:111]
  ds_read_b64_tr_b16 v[180:181], v7 offset:53248
  v_mfma_f32_16x16x32_bf16 v[104:107], v[212:215], v[72:75], v[104:107]
  ds_read_b64_tr_b16 v[182:183], v7 offset:55296
  v_mfma_f32_16x16x32_bf16 v[112:115], v[216:219], v[72:75], v[112:115]
  ds_read_b64_tr_b16 v[184:185], v8 offset:53248
  v_mfma_f32_16x16x32_bf16 v[116:119], v[216:219], v[76:79], v[116:119]
  ds_read_b64_tr_b16 v[186:187], v8 offset:55296
  v_readlane_b32 s48, v30, 8
  v_mfma_f32_16x16x32_bf16 v[124:127], v[220:223], v[76:79], v[124:127]
  ds_read_b64_tr_b16 v[188:189], v9 offset:53248
  v_mfma_f32_16x16x32_bf16 v[120:123], v[220:223], v[72:75], v[120:123]
  ds_read_b64_tr_b16 v[190:191], v9 offset:55296
  s_waitcnt vmcnt(18) lgkmcnt(8)
  v_mfma_f32_16x16x32_bf16 v[128:131], v[160:163], v[80:83], v[128:131]
  buffer_load_dwordx4 v[64:67], off, s[36:39], s48 offset:0 sc1
  v_mfma_f32_16x16x32_bf16 v[132:135], v[160:163], v[84:87], v[132:135]
  ds_read_b64_tr_b16 v[192:193], v6 offset:57344
  ds_read_b64_tr_b16 v[194:195], v6 offset:59392
  v_mfma_f32_16x16x32_bf16 v[140:143], v[164:167], v[84:87], v[140:143]
  ds_read_b64_tr_b16 v[196:197], v7 offset:57344
  v_mfma_f32_16x16x32_bf16 v[136:139], v[164:167], v[80:83], v[136:139]
  ds_read_b64_tr_b16 v[198:199], v7 offset:59392
  v_mfma_f32_16x16x32_bf16 v[144:147], v[168:171], v[80:83], v[144:147]
  ds_read_b64_tr_b16 v[200:201], v8 offset:57344
  v_mfma_f32_16x16x32_bf16 v[148:151], v[168:171], v[84:87], v[148:151]
  ds_read_b64_tr_b16 v[202:203], v8 offset:59392
  ds_read_b64_tr_b16 v[204:205], v9 offset:57344
  v_mfma_f32_16x16x32_bf16 v[156:159], v[172:175], v[84:87], v[156:159]
  buffer_load_dwordx4 v[68:71], off, s[64:67], s48 offset:0 sc1
  v_mfma_f32_16x16x32_bf16 v[152:155], v[172:175], v[80:83], v[152:155]
  ds_read_b64_tr_b16 v[206:207], v9 offset:59392
  s_waitcnt vmcnt(18) lgkmcnt(8)
  v_mfma_f32_16x16x32_bf16 v[128:131], v[176:179], v[88:91], v[128:131]
  ds_read_b64_tr_b16 v[208:209], v6 offset:61440
  v_mfma_f32_16x16x32_bf16 v[132:135], v[176:179], v[92:95], v[132:135]
  ds_read_b64_tr_b16 v[210:211], v6 offset:63488
  v_mfma_f32_16x16x32_bf16 v[140:143], v[180:183], v[92:95], v[140:143]
  ds_read_b64_tr_b16 v[212:213], v7 offset:61440
  v_mfma_f32_16x16x32_bf16 v[136:139], v[180:183], v[88:91], v[136:139]
  ds_read_b64_tr_b16 v[214:215], v7 offset:63488
  v_mfma_f32_16x16x32_bf16 v[144:147], v[184:187], v[88:91], v[144:147]
  buffer_load_dwordx4 v[72:75], off, s[36:39], s48 offset:1024 sc1
  v_mfma_f32_16x16x32_bf16 v[148:151], v[184:187], v[92:95], v[148:151]
  ds_read_b64_tr_b16 v[216:217], v8 offset:61440
  ds_read_b64_tr_b16 v[218:219], v8 offset:63488
  v_mfma_f32_16x16x32_bf16 v[156:159], v[188:191], v[92:95], v[156:159]
  ds_read_b64_tr_b16 v[220:221], v9 offset:61440
  v_mfma_f32_16x16x32_bf16 v[152:155], v[188:191], v[88:91], v[152:155]
  ds_read_b64_tr_b16 v[222:223], v9 offset:63488
  s_waitcnt lgkmcnt(8)
  v_mfma_f32_16x16x32_bf16 v[96:99], v[192:195], v[80:83], v[96:99]
  ds_read_b64_tr_b16 v[160:161], v20 offset:0
  v_mfma_f32_16x16x32_bf16 v[100:103], v[192:195], v[84:87], v[100:103]
  ds_read_b64_tr_b16 v[162:163], v20 offset:2048
  v_mfma_f32_16x16x32_bf16 v[108:111], v[196:199], v[84:87], v[108:111]
  buffer_load_dwordx4 v[76:79], off, s[64:67], s48 offset:1024 sc1
  v_mfma_f32_16x16x32_bf16 v[104:107], v[196:199], v[80:83], v[104:107]
  ds_read_b64_tr_b16 v[164:165], v21 offset:0
  ds_read_b64_tr_b16 v[166:167], v21 offset:2048
  v_mfma_f32_16x16x32_bf16 v[112:115], v[200:203], v[80:83], v[112:115]
  ds_read_b64_tr_b16 v[168:169], v22 offset:0
  v_mfma_f32_16x16x32_bf16 v[116:119], v[200:203], v[84:87], v[116:119]
  ds_read_b64_tr_b16 v[170:171], v22 offset:2048
  v_mfma_f32_16x16x32_bf16 v[124:127], v[204:207], v[84:87], v[124:127]
  ds_read_b64_tr_b16 v[172:173], v23 offset:0
  v_mfma_f32_16x16x32_bf16 v[120:123], v[204:207], v[80:83], v[120:123]
  ds_read_b64_tr_b16 v[174:175], v23 offset:2048
  s_waitcnt lgkmcnt(8)
  s_barrier
  v_mfma_f32_16x16x32_bf16 v[96:99], v[208:211], v[88:91], v[96:99]
  ds_read_b64_tr_b16 v[176:177], v20 offset:4096
  v_mfma_f32_16x16x32_bf16 v[100:103], v[208:211], v[92:95], v[100:103]
  ds_read_b64_tr_b16 v[178:179], v20 offset:6144
  v_mfma_f32_16x16x32_bf16 v[108:111], v[212:215], v[92:95], v[108:111]
  ds_read_b64_tr_b16 v[180:181], v21 offset:4096
  v_mfma_f32_16x16x32_bf16 v[104:107], v[212:215], v[88:91], v[104:107]
  ds_read_b64_tr_b16 v[182:183], v21 offset:6144
  v_mfma_f32_16x16x32_bf16 v[112:115], v[216:219], v[88:91], v[112:115]
  ds_read_b64_tr_b16 v[184:185], v22 offset:4096
  v_mfma_f32_16x16x32_bf16 v[116:119], v[216:219], v[92:95], v[116:119]
  ds_read_b64_tr_b16 v[186:187], v22 offset:6144
  v_readlane_b32 s49, v30, 9
  v_mfma_f32_16x16x32_bf16 v[124:127], v[220:223], v[92:95], v[124:127]
  ds_read_b64_tr_b16 v[188:189], v23 offset:4096
  v_mfma_f32_16x16x32_bf16 v[120:123], v[220:223], v[88:91], v[120:123]
  ds_read_b64_tr_b16 v[190:191], v23 offset:6144
  s_waitcnt vmcnt(18) lgkmcnt(8)
  v_mfma_f32_16x16x32_bf16 v[128:131], v[160:163], v[224:227], v[128:131]
  buffer_load_dwordx4 v[80:83], off, s[36:39], s49 offset:0 sc1
  v_mfma_f32_16x16x32_bf16 v[132:135], v[160:163], v[228:231], v[132:135]
  ds_read_b64_tr_b16 v[192:193], v20 offset:8192
  ds_read_b64_tr_b16 v[194:195], v20 offset:10240
  v_mfma_f32_16x16x32_bf16 v[140:143], v[164:167], v[228:231], v[140:143]
  ds_read_b64_tr_b16 v[196:197], v21 offset:8192
  v_mfma_f32_16x16x32_bf16 v[136:139], v[164:167], v[224:227], v[136:139]
  ds_read_b64_tr_b16 v[198:199], v21 offset:10240
  v_mfma_f32_16x16x32_bf16 v[144:147], v[168:171], v[224:227], v[144:147]
  ds_read_b64_tr_b16 v[200:201], v22 offset:8192
  v_mfma_f32_16x16x32_bf16 v[148:151], v[168:171], v[228:231], v[148:151]
  ds_read_b64_tr_b16 v[202:203], v22 offset:10240
  ds_read_b64_tr_b16 v[204:205], v23 offset:8192
  v_mfma_f32_16x16x32_bf16 v[156:159], v[172:175], v[228:231], v[156:159]
  buffer_load_dwordx4 v[84:87], off, s[64:67], s49 offset:0 sc1
  v_mfma_f32_16x16x32_bf16 v[152:155], v[172:175], v[224:227], v[152:155]
  ds_read_b64_tr_b16 v[206:207], v23 offset:10240
  s_waitcnt vmcnt(18) lgkmcnt(8)
  v_mfma_f32_16x16x32_bf16 v[128:131], v[176:179], v[232:235], v[128:131]
  ds_read_b64_tr_b16 v[208:209], v20 offset:12288
  v_mfma_f32_16x16x32_bf16 v[132:135], v[176:179], v[236:239], v[132:135]
  ds_read_b64_tr_b16 v[210:211], v20 offset:14336
  v_mfma_f32_16x16x32_bf16 v[140:143], v[180:183], v[236:239], v[140:143]
  ds_read_b64_tr_b16 v[212:213], v21 offset:12288
  v_mfma_f32_16x16x32_bf16 v[136:139], v[180:183], v[232:235], v[136:139]
  ds_read_b64_tr_b16 v[214:215], v21 offset:14336
  v_mfma_f32_16x16x32_bf16 v[144:147], v[184:187], v[232:235], v[144:147]
  buffer_load_dwordx4 v[88:91], off, s[36:39], s49 offset:1024 sc1
  v_mfma_f32_16x16x32_bf16 v[148:151], v[184:187], v[236:239], v[148:151]
  ds_read_b64_tr_b16 v[216:217], v22 offset:12288
  ds_read_b64_tr_b16 v[218:219], v22 offset:14336
  v_mfma_f32_16x16x32_bf16 v[156:159], v[188:191], v[236:239], v[156:159]
  ds_read_b64_tr_b16 v[220:221], v23 offset:12288
  v_mfma_f32_16x16x32_bf16 v[152:155], v[188:191], v[232:235], v[152:155]
  ds_read_b64_tr_b16 v[222:223], v23 offset:14336
  s_waitcnt lgkmcnt(8)
  v_mfma_f32_16x16x32_bf16 v[96:99], v[192:195], v[224:227], v[96:99]
  ds_read_b64_tr_b16 v[160:161], v20 offset:16384
  v_mfma_f32_16x16x32_bf16 v[100:103], v[192:195], v[228:231], v[100:103]
  ds_read_b64_tr_b16 v[162:163], v20 offset:18432
  v_mfma_f32_16x16x32_bf16 v[108:111], v[196:199], v[228:231], v[108:111]
  buffer_load_dwordx4 v[92:95], off, s[64:67], s49 offset:1024 sc1
  v_mfma_f32_16x16x32_bf16 v[104:107], v[196:199], v[224:227], v[104:107]
  ds_read_b64_tr_b16 v[164:165], v21 offset:16384
  ds_read_b64_tr_b16 v[166:167], v21 offset:18432
  v_mfma_f32_16x16x32_bf16 v[112:115], v[200:203], v[224:227], v[112:115]
  ds_read_b64_tr_b16 v[168:169], v22 offset:16384
  v_mfma_f32_16x16x32_bf16 v[116:119], v[200:203], v[228:231], v[116:119]
  ds_read_b64_tr_b16 v[170:171], v22 offset:18432
  v_mfma_f32_16x16x32_bf16 v[124:127], v[204:207], v[228:231], v[124:127]
  ds_read_b64_tr_b16 v[172:173], v23 offset:16384
  v_mfma_f32_16x16x32_bf16 v[120:123], v[204:207], v[224:227], v[120:123]
  ds_read_b64_tr_b16 v[174:175], v23 offset:18432
  s_waitcnt lgkmcnt(8)
  v_mfma_f32_16x16x32_bf16 v[96:99], v[208:211], v[232:235], v[96:99]
  ds_read_b64_tr_b16 v[176:177], v20 offset:20480
  v_mfma_f32_16x16x32_bf16 v[100:103], v[208:211], v[236:239], v[100:103]
  ds_read_b64_tr_b16 v[178:179], v20 offset:22528
  v_mfma_f32_16x16x32_bf16 v[108:111], v[212:215], v[236:239], v[108:111]
  ds_read_b64_tr_b16 v[180:181], v21 offset:20480
  v_mfma_f32_16x16x32_bf16 v[104:107], v[212:215], v[232:235], v[104:107]
  ds_read_b64_tr_b16 v[182:183], v21 offset:22528
  v_mfma_f32_16x16x32_bf16 v[112:115], v[216:219], v[232:235], v[112:115]
  ds_read_b64_tr_b16 v[184:185], v22 offset:20480
  v_mfma_f32_16x16x32_bf16 v[116:119], v[216:219], v[236:239], v[116:119]
  ds_read_b64_tr_b16 v[186:187], v22 offset:22528
  v_readlane_b32 s50, v30, 10
  v_mfma_f32_16x16x32_bf16 v[124:127], v[220:223], v[236:239], v[124:127]
  ds_read_b64_tr_b16 v[188:189], v23 offset:20480
  v_mfma_f32_16x16x32_bf16 v[120:123], v[220:223], v[232:235], v[120:123]
  ds_read_b64_tr_b16 v[190:191], v23 offset:22528
  s_waitcnt vmcnt(18) lgkmcnt(8)
  v_mfma_f32_16x16x32_bf16 v[128:131], v[160:163], v[240:243], v[128:131]
  buffer_load_dwordx4 v[224:227], off, s[36:39], s50 offset:0 sc1
  v_mfma_f32_16x16x32_bf16 v[132:135], v[160:163], v[244:247], v[132:135]
  ds_read_b64_tr_b16 v[192:193], v20 offset:24576
  ds_read_b64_tr_b16 v[194:195], v20 offset:26624
  v_mfma_f32_16x16x32_bf16 v[140:143], v[164:167], v[244:247], v[140:143]
  ds_read_b64_tr_b16 v[196:197], v21 offset:24576
  v_mfma_f32_16x16x32_bf16 v[136:139], v[164:167], v[240:243], v[136:139]
  ds_read_b64_tr_b16 v[198:199], v21 offset:26624
  v_mfma_f32_16x16x32_bf16 v[144:147], v[168:171], v[240:243], v[144:147]
  ds_read_b64_tr_b16 v[200:201], v22 offset:24576
  v_mfma_f32_16x16x32_bf16 v[148:151], v[168:171], v[244:247], v[148:151]
  ds_read_b64_tr_b16 v[202:203], v22 offset:26624
  ds_read_b64_tr_b16 v[204:205], v23 offset:24576
  v_mfma_f32_16x16x32_bf16 v[156:159], v[172:175], v[244:247], v[156:159]
  buffer_load_dwordx4 v[228:231], off, s[64:67], s50 offset:0 sc1
  v_mfma_f32_16x16x32_bf16 v[152:155], v[172:175], v[240:243], v[152:155]
  ds_read_b64_tr_b16 v[206:207], v23 offset:26624
  s_waitcnt vmcnt(18) lgkmcnt(8)
  v_mfma_f32_16x16x32_bf16 v[128:131], v[176:179], v[248:251], v[128:131]
  ds_read_b64_tr_b16 v[208:209], v20 offset:28672
  v_mfma_f32_16x16x32_bf16 v[132:135], v[176:179], v[252:255], v[132:135]
  ds_read_b64_tr_b16 v[210:211], v20 offset:30720
  v_mfma_f32_16x16x32_bf16 v[140:143], v[180:183], v[252:255], v[140:143]
  ds_read_b64_tr_b16 v[212:213], v21 offset:28672
  v_mfma_f32_16x16x32_bf16 v[136:139], v[180:183], v[248:251], v[136:139]
  ds_read_b64_tr_b16 v[214:215], v21 offset:30720
  v_mfma_f32_16x16x32_bf16 v[144:147], v[184:187], v[248:251], v[144:147]
  buffer_load_dwordx4 v[232:235], off, s[36:39], s50 offset:1024 sc1
  v_mfma_f32_16x16x32_bf16 v[148:151], v[184:187], v[252:255], v[148:151]
  ds_read_b64_tr_b16 v[216:217], v22 offset:28672
  ds_read_b64_tr_b16 v[218:219], v22 offset:30720
  v_mfma_f32_16x16x32_bf16 v[156:159], v[188:191], v[252:255], v[156:159]
  ds_read_b64_tr_b16 v[220:221], v23 offset:28672
  v_mfma_f32_16x16x32_bf16 v[152:155], v[188:191], v[248:251], v[152:155]
  ds_read_b64_tr_b16 v[222:223], v23 offset:30720
  s_waitcnt lgkmcnt(8)
  v_mfma_f32_16x16x32_bf16 v[96:99], v[192:195], v[240:243], v[96:99]
  ds_read_b64_tr_b16 v[160:161], v20 offset:32768
  v_mfma_f32_16x16x32_bf16 v[100:103], v[192:195], v[244:247], v[100:103]
  ds_read_b64_tr_b16 v[162:163], v20 offset:34816
  v_mfma_f32_16x16x32_bf16 v[108:111], v[196:199], v[244:247], v[108:111]
  buffer_load_dwordx4 v[236:239], off, s[64:67], s50 offset:1024 sc1
  v_mfma_f32_16x16x32_bf16 v[104:107], v[196:199], v[240:243], v[104:107]
  ds_read_b64_tr_b16 v[164:165], v21 offset:32768
  ds_read_b64_tr_b16 v[166:167], v21 offset:34816
  v_mfma_f32_16x16x32_bf16 v[112:115], v[200:203], v[240:243], v[112:115]
  ds_read_b64_tr_b16 v[168:169], v22 offset:32768
  v_mfma_f32_16x16x32_bf16 v[116:119], v[200:203], v[244:247], v[116:119]
  ds_read_b64_tr_b16 v[170:171], v22 offset:34816
  v_mfma_f32_16x16x32_bf16 v[124:127], v[204:207], v[244:247], v[124:127]
  ds_read_b64_tr_b16 v[172:173], v23 offset:32768
  v_mfma_f32_16x16x32_bf16 v[120:123], v[204:207], v[240:243], v[120:123]
  ds_read_b64_tr_b16 v[174:175], v23 offset:34816
  s_waitcnt lgkmcnt(8)
  s_barrier
  v_mfma_f32_16x16x32_bf16 v[96:99], v[208:211], v[248:251], v[96:99]
  ds_read_b64_tr_b16 v[176:177], v20 offset:36864
  v_mfma_f32_16x16x32_bf16 v[100:103], v[208:211], v[252:255], v[100:103]
  ds_read_b64_tr_b16 v[178:179], v20 offset:38912
  v_mfma_f32_16x16x32_bf16 v[108:111], v[212:215], v[252:255], v[108:111]
  ds_read_b64_tr_b16 v[180:181], v21 offset:36864
  v_mfma_f32_16x16x32_bf16 v[104:107], v[212:215], v[248:251], v[104:107]
  ds_read_b64_tr_b16 v[182:183], v21 offset:38912
  v_mfma_f32_16x16x32_bf16 v[112:115], v[216:219], v[248:251], v[112:115]
  ds_read_b64_tr_b16 v[184:185], v22 offset:36864
  v_mfma_f32_16x16x32_bf16 v[116:119], v[216:219], v[252:255], v[116:119]
  ds_read_b64_tr_b16 v[186:187], v22 offset:38912
  v_readlane_b32 s51, v30, 11
  v_mfma_f32_16x16x32_bf16 v[124:127], v[220:223], v[252:255], v[124:127]
  ds_read_b64_tr_b16 v[188:189], v23 offset:36864
  v_mfma_f32_16x16x32_bf16 v[120:123], v[220:223], v[248:251], v[120:123]
  ds_read_b64_tr_b16 v[190:191], v23 offset:38912
  s_waitcnt vmcnt(18) lgkmcnt(8)
  v_mfma_f32_16x16x32_bf16 v[128:131], v[160:163], v[32:35], v[128:131]
  buffer_load_dwordx4 v[240:243], off, s[36:39], s51 offset:0 sc1
  v_mfma_f32_16x16x32_bf16 v[132:135], v[160:163], v[36:39], v[132:135]
  ds_read_b64_tr_b16 v[192:193], v20 offset:40960
  ds_read_b64_tr_b16 v[194:195], v20 offset:43008
  v_mfma_f32_16x16x32_bf16 v[140:143], v[164:167], v[36:39], v[140:143]
  ds_read_b64_tr_b16 v[196:197], v21 offset:40960
  v_mfma_f32_16x16x32_bf16 v[136:139], v[164:167], v[32:35], v[136:139]
  ds_read_b64_tr_b16 v[198:199], v21 offset:43008
  v_mfma_f32_16x16x32_bf16 v[144:147], v[168:171], v[32:35], v[144:147]
  ds_read_b64_tr_b16 v[200:201], v22 offset:40960
  v_mfma_f32_16x16x32_bf16 v[148:151], v[168:171], v[36:39], v[148:151]
  ds_read_b64_tr_b16 v[202:203], v22 offset:43008
  ds_read_b64_tr_b16 v[204:205], v23 offset:40960
  v_mfma_f32_16x16x32_bf16 v[156:159], v[172:175], v[36:39], v[156:159]
  buffer_load_dwordx4 v[244:247], off, s[64:67], s51 offset:0 sc1
  v_mfma_f32_16x16x32_bf16 v[152:155], v[172:175], v[32:35], v[152:155]
  ds_read_b64_tr_b16 v[206:207], v23 offset:43008
  s_waitcnt vmcnt(18) lgkmcnt(8)
  v_mfma_f32_16x16x32_bf16 v[128:131], v[176:179], v[40:43], v[128:131]
  ds_read_b64_tr_b16 v[208:209], v20 offset:45056
  v_mfma_f32_16x16x32_bf16 v[132:135], v[176:179], v[44:47], v[132:135]
  ds_read_b64_tr_b16 v[210:211], v20 offset:47104
  v_mfma_f32_16x16x32_bf16 v[140:143], v[180:183], v[44:47], v[140:143]
  ds_read_b64_tr_b16 v[212:213], v21 offset:45056
  v_mfma_f32_16x16x32_bf16 v[136:139], v[180:183], v[40:43], v[136:139]
  ds_read_b64_tr_b16 v[214:215], v21 offset:47104
  v_mfma_f32_16x16x32_bf16 v[144:147], v[184:187], v[40:43], v[144:147]
  buffer_load_dwordx4 v[248:251], off, s[36:39], s51 offset:1024 sc1
  v_mfma_f32_16x16x32_bf16 v[148:151], v[184:187], v[44:47], v[148:151]
  ds_read_b64_tr_b16 v[216:217], v22 offset:45056
  ds_read_b64_tr_b16 v[218:219], v22 offset:47104
  v_mfma_f32_16x16x32_bf16 v[156:159], v[188:191], v[44:47], v[156:159]
  ds_read_b64_tr_b16 v[220:221], v23 offset:45056
  v_mfma_f32_16x16x32_bf16 v[152:155], v[188:191], v[40:43], v[152:155]
  ds_read_b64_tr_b16 v[222:223], v23 offset:47104
  s_waitcnt lgkmcnt(8)
  v_mfma_f32_16x16x32_bf16 v[96:99], v[192:195], v[32:35], v[96:99]
  ds_read_b64_tr_b16 v[160:161], v20 offset:49152
  v_mfma_f32_16x16x32_bf16 v[100:103], v[192:195], v[36:39], v[100:103]
  ds_read_b64_tr_b16 v[162:163], v20 offset:51200
  v_mfma_f32_16x16x32_bf16 v[108:111], v[196:199], v[36:39], v[108:111]
  buffer_load_dwordx4 v[252:255], off, s[64:67], s51 offset:1024 sc1
  v_mfma_f32_16x16x32_bf16 v[104:107], v[196:199], v[32:35], v[104:107]
  ds_read_b64_tr_b16 v[164:165], v21 offset:49152
  ds_read_b64_tr_b16 v[166:167], v21 offset:51200
  v_mfma_f32_16x16x32_bf16 v[112:115], v[200:203], v[32:35], v[112:115]
  ds_read_b64_tr_b16 v[168:169], v22 offset:49152
  v_mfma_f32_16x16x32_bf16 v[116:119], v[200:203], v[36:39], v[116:119]
  ds_read_b64_tr_b16 v[170:171], v22 offset:51200
  v_mfma_f32_16x16x32_bf16 v[124:127], v[204:207], v[36:39], v[124:127]
  ds_read_b64_tr_b16 v[172:173], v23 offset:49152
  v_mfma_f32_16x16x32_bf16 v[120:123], v[204:207], v[32:35], v[120:123]
  ds_read_b64_tr_b16 v[174:175], v23 offset:51200
  s_waitcnt lgkmcnt(8)
  v_mfma_f32_16x16x32_bf16 v[96:99], v[208:211], v[40:43], v[96:99]
  ds_read_b64_tr_b16 v[176:177], v20 offset:53248
  v_mfma_f32_16x16x32_bf16 v[100:103], v[208:211], v[44:47], v[100:103]
  ds_read_b64_tr_b16 v[178:179], v20 offset:55296
  v_mfma_f32_16x16x32_bf16 v[108:111], v[212:215], v[44:47], v[108:111]
  ds_read_b64_tr_b16 v[180:181], v21 offset:53248
  v_mfma_f32_16x16x32_bf16 v[104:107], v[212:215], v[40:43], v[104:107]
  ds_read_b64_tr_b16 v[182:183], v21 offset:55296
  v_mfma_f32_16x16x32_bf16 v[112:115], v[216:219], v[40:43], v[112:115]
  ds_read_b64_tr_b16 v[184:185], v22 offset:53248
  v_mfma_f32_16x16x32_bf16 v[116:119], v[216:219], v[44:47], v[116:119]
  ds_read_b64_tr_b16 v[186:187], v22 offset:55296
  v_readlane_b32 s48, v30, 12
  v_mfma_f32_16x16x32_bf16 v[124:127], v[220:223], v[44:47], v[124:127]
  ds_read_b64_tr_b16 v[188:189], v23 offset:53248
  v_mfma_f32_16x16x32_bf16 v[120:123], v[220:223], v[40:43], v[120:123]
  ds_read_b64_tr_b16 v[190:191], v23 offset:55296
  s_waitcnt vmcnt(18) lgkmcnt(8)
  v_mfma_f32_16x16x32_bf16 v[128:131], v[160:163], v[48:51], v[128:131]
  buffer_load_dwordx4 v[32:35], off, s[36:39], s48 offset:0 sc1
  v_mfma_f32_16x16x32_bf16 v[132:135], v[160:163], v[52:55], v[132:135]
  ds_read_b64_tr_b16 v[192:193], v20 offset:57344
  ds_read_b64_tr_b16 v[194:195], v20 offset:59392
  v_mfma_f32_16x16x32_bf16 v[140:143], v[164:167], v[52:55], v[140:143]
  ds_read_b64_tr_b16 v[196:197], v21 offset:57344
  v_mfma_f32_16x16x32_bf16 v[136:139], v[164:167], v[48:51], v[136:139]
  ds_read_b64_tr_b16 v[198:199], v21 offset:59392
  v_mfma_f32_16x16x32_bf16 v[144:147], v[168:171], v[48:51], v[144:147]
  ds_read_b64_tr_b16 v[200:201], v22 offset:57344
  v_mfma_f32_16x16x32_bf16 v[148:151], v[168:171], v[52:55], v[148:151]
  ds_read_b64_tr_b16 v[202:203], v22 offset:59392
  ds_read_b64_tr_b16 v[204:205], v23 offset:57344
  v_mfma_f32_16x16x32_bf16 v[156:159], v[172:175], v[52:55], v[156:159]
  buffer_load_dwordx4 v[36:39], off, s[64:67], s48 offset:0 sc1
  v_mfma_f32_16x16x32_bf16 v[152:155], v[172:175], v[48:51], v[152:155]
  ds_read_b64_tr_b16 v[206:207], v23 offset:59392
  s_waitcnt vmcnt(18) lgkmcnt(8)
  v_mfma_f32_16x16x32_bf16 v[128:131], v[176:179], v[56:59], v[128:131]
  ds_read_b64_tr_b16 v[208:209], v20 offset:61440
  v_mfma_f32_16x16x32_bf16 v[132:135], v[176:179], v[60:63], v[132:135]
  ds_read_b64_tr_b16 v[210:211], v20 offset:63488
  v_mfma_f32_16x16x32_bf16 v[140:143], v[180:183], v[60:63], v[140:143]
  ds_read_b64_tr_b16 v[212:213], v21 offset:61440
  v_mfma_f32_16x16x32_bf16 v[136:139], v[180:183], v[56:59], v[136:139]
  ds_read_b64_tr_b16 v[214:215], v21 offset:63488
  v_mfma_f32_16x16x32_bf16 v[144:147], v[184:187], v[56:59], v[144:147]
  buffer_load_dwordx4 v[40:43], off, s[36:39], s48 offset:1024 sc1
  v_mfma_f32_16x16x32_bf16 v[148:151], v[184:187], v[60:63], v[148:151]
  ds_read_b64_tr_b16 v[216:217], v22 offset:61440
  ds_read_b64_tr_b16 v[218:219], v22 offset:63488
  v_mfma_f32_16x16x32_bf16 v[156:159], v[188:191], v[60:63], v[156:159]
  ds_read_b64_tr_b16 v[220:221], v23 offset:61440
  v_mfma_f32_16x16x32_bf16 v[152:155], v[188:191], v[56:59], v[152:155]
  ds_read_b64_tr_b16 v[222:223], v23 offset:63488
  s_waitcnt lgkmcnt(8)
  v_mfma_f32_16x16x32_bf16 v[96:99], v[192:195], v[48:51], v[96:99]
  ds_read_b64_tr_b16 v[160:161], v26 offset:0
  v_mfma_f32_16x16x32_bf16 v[100:103], v[192:195], v[52:55], v[100:103]
  ds_read_b64_tr_b16 v[162:163], v26 offset:2048
  v_mfma_f32_16x16x32_bf16 v[108:111], v[196:199], v[52:55], v[108:111]
  buffer_load_dwordx4 v[44:47], off, s[64:67], s48 offset:1024 sc1
  v_mfma_f32_16x16x32_bf16 v[104:107], v[196:199], v[48:51], v[104:107]
  ds_read_b64_tr_b16 v[164:165], v27 offset:0
  ds_read_b64_tr_b16 v[166:167], v27 offset:2048
  v_mfma_f32_16x16x32_bf16 v[112:115], v[200:203], v[48:51], v[112:115]
  ds_read_b64_tr_b16 v[168:169], v28 offset:0
  v_mfma_f32_16x16x32_bf16 v[116:119], v[200:203], v[52:55], v[116:119]
  ds_read_b64_tr_b16 v[170:171], v28 offset:2048
  v_mfma_f32_16x16x32_bf16 v[124:127], v[204:207], v[52:55], v[124:127]
  ds_read_b64_tr_b16 v[172:173], v29 offset:0
  v_mfma_f32_16x16x32_bf16 v[120:123], v[204:207], v[48:51], v[120:123]
  ds_read_b64_tr_b16 v[174:175], v29 offset:2048
  s_waitcnt lgkmcnt(8)
  s_barrier
  v_mfma_f32_16x16x32_bf16 v[96:99], v[208:211], v[56:59], v[96:99]
  ds_read_b64_tr_b16 v[176:177], v26 offset:4096
  v_mfma_f32_16x16x32_bf16 v[100:103], v[208:211], v[60:63], v[100:103]
  ds_read_b64_tr_b16 v[178:179], v26 offset:6144
  v_mfma_f32_16x16x32_bf16 v[108:111], v[212:215], v[60:63], v[108:111]
  ds_read_b64_tr_b16 v[180:181], v27 offset:4096
  v_mfma_f32_16x16x32_bf16 v[104:107], v[212:215], v[56:59], v[104:107]
  ds_read_b64_tr_b16 v[182:183], v27 offset:6144
  v_mfma_f32_16x16x32_bf16 v[112:115], v[216:219], v[56:59], v[112:115]
  ds_read_b64_tr_b16 v[184:185], v28 offset:4096
  v_mfma_f32_16x16x32_bf16 v[116:119], v[216:219], v[60:63], v[116:119]
  ds_read_b64_tr_b16 v[186:187], v28 offset:6144
  v_readlane_b32 s49, v30, 13
  v_mfma_f32_16x16x32_bf16 v[124:127], v[220:223], v[60:63], v[124:127]
  ds_read_b64_tr_b16 v[188:189], v29 offset:4096
  v_mfma_f32_16x16x32_bf16 v[120:123], v[220:223], v[56:59], v[120:123]
  ds_read_b64_tr_b16 v[190:191], v29 offset:6144
  s_waitcnt vmcnt(18) lgkmcnt(8)
  v_mfma_f32_16x16x32_bf16 v[128:131], v[160:163], v[64:67], v[128:131]
  buffer_load_dwordx4 v[48:51], off, s[36:39], s49 offset:0 sc1
  v_mfma_f32_16x16x32_bf16 v[132:135], v[160:163], v[68:71], v[132:135]
  ds_read_b64_tr_b16 v[192:193], v26 offset:8192
  ds_read_b64_tr_b16 v[194:195], v26 offset:10240
  v_mfma_f32_16x16x32_bf16 v[140:143], v[164:167], v[68:71], v[140:143]
  ds_read_b64_tr_b16 v[196:197], v27 offset:8192
  v_mfma_f32_16x16x32_bf16 v[136:139], v[164:167], v[64:67], v[136:139]
  ds_read_b64_tr_b16 v[198:199], v27 offset:10240
  v_mfma_f32_16x16x32_bf16 v[144:147], v[168:171], v[64:67], v[144:147]
  ds_read_b64_tr_b16 v[200:201], v28 offset:8192
  v_mfma_f32_16x16x32_bf16 v[148:151], v[168:171], v[68:71], v[148:151]
  ds_read_b64_tr_b16 v[202:203], v28 offset:10240
  ds_read_b64_tr_b16 v[204:205], v29 offset:8192
  v_mfma_f32_16x16x32_bf16 v[156:159], v[172:175], v[68:71], v[156:159]
  buffer_load_dwordx4 v[52:55], off, s[64:67], s49 offset:0 sc1
  v_mfma_f32_16x16x32_bf16 v[152:155], v[172:175], v[64:67], v[152:155]
  ds_read_b64_tr_b16 v[206:207], v29 offset:10240
  s_waitcnt vmcnt(18) lgkmcnt(8)
  v_mfma_f32_16x16x32_bf16 v[128:131], v[176:179], v[72:75], v[128:131]
  ds_read_b64_tr_b16 v[208:209], v26 offset:12288
  v_mfma_f32_16x16x32_bf16 v[132:135], v[176:179], v[76:79], v[132:135]
  ds_read_b64_tr_b16 v[210:211], v26 offset:14336
  v_mfma_f32_16x16x32_bf16 v[140:143], v[180:183], v[76:79], v[140:143]
  ds_read_b64_tr_b16 v[212:213], v27 offset:12288
  v_mfma_f32_16x16x32_bf16 v[136:139], v[180:183], v[72:75], v[136:139]
  ds_read_b64_tr_b16 v[214:215], v27 offset:14336
  v_mfma_f32_16x16x32_bf16 v[144:147], v[184:187], v[72:75], v[144:147]
  buffer_load_dwordx4 v[56:59], off, s[36:39], s49 offset:1024 sc1
  v_mfma_f32_16x16x32_bf16 v[148:151], v[184:187], v[76:79], v[148:151]
  ds_read_b64_tr_b16 v[216:217], v28 offset:12288
  ds_read_b64_tr_b16 v[218:219], v28 offset:14336
  v_mfma_f32_16x16x32_bf16 v[156:159], v[188:191], v[76:79], v[156:159]
  ds_read_b64_tr_b16 v[220:221], v29 offset:12288
  v_mfma_f32_16x16x32_bf16 v[152:155], v[188:191], v[72:75], v[152:155]
  ds_read_b64_tr_b16 v[222:223], v29 offset:14336
  s_waitcnt lgkmcnt(8)
  v_mfma_f32_16x16x32_bf16 v[96:99], v[192:195], v[64:67], v[96:99]
  ds_read_b64_tr_b16 v[160:161], v26 offset:16384
  v_mfma_f32_16x16x32_bf16 v[100:103], v[192:195], v[68:71], v[100:103]
  ds_read_b64_tr_b16 v[162:163], v26 offset:18432
  v_mfma_f32_16x16x32_bf16 v[108:111], v[196:199], v[68:71], v[108:111]
  buffer_load_dwordx4 v[60:63], off, s[64:67], s49 offset:1024 sc1
  v_mfma_f32_16x16x32_bf16 v[104:107], v[196:199], v[64:67], v[104:107]
  ds_read_b64_tr_b16 v[164:165], v27 offset:16384
  ds_read_b64_tr_b16 v[166:167], v27 offset:18432
  v_mfma_f32_16x16x32_bf16 v[112:115], v[200:203], v[64:67], v[112:115]
  ds_read_b64_tr_b16 v[168:169], v28 offset:16384
  v_mfma_f32_16x16x32_bf16 v[116:119], v[200:203], v[68:71], v[116:119]
  ds_read_b64_tr_b16 v[170:171], v28 offset:18432
  v_mfma_f32_16x16x32_bf16 v[124:127], v[204:207], v[68:71], v[124:127]
  ds_read_b64_tr_b16 v[172:173], v29 offset:16384
  v_mfma_f32_16x16x32_bf16 v[120:123], v[204:207], v[64:67], v[120:123]
  ds_read_b64_tr_b16 v[174:175], v29 offset:18432
  s_waitcnt lgkmcnt(8)
  v_mfma_f32_16x16x32_bf16 v[96:99], v[208:211], v[72:75], v[96:99]
  ds_read_b64_tr_b16 v[176:177], v26 offset:20480
  v_mfma_f32_16x16x32_bf16 v[100:103], v[208:211], v[76:79], v[100:103]
  ds_read_b64_tr_b16 v[178:179], v26 offset:22528
  v_mfma_f32_16x16x32_bf16 v[108:111], v[212:215], v[76:79], v[108:111]
  ds_read_b64_tr_b16 v[180:181], v27 offset:20480
  v_mfma_f32_16x16x32_bf16 v[104:107], v[212:215], v[72:75], v[104:107]
  ds_read_b64_tr_b16 v[182:183], v27 offset:22528
  v_mfma_f32_16x16x32_bf16 v[112:115], v[216:219], v[72:75], v[112:115]
  ds_read_b64_tr_b16 v[184:185], v28 offset:20480
  v_mfma_f32_16x16x32_bf16 v[116:119], v[216:219], v[76:79], v[116:119]
  ds_read_b64_tr_b16 v[186:187], v28 offset:22528
  v_readlane_b32 s50, v30, 14
  v_mfma_f32_16x16x32_bf16 v[124:127], v[220:223], v[76:79], v[124:127]
  ds_read_b64_tr_b16 v[188:189], v29 offset:20480
  v_mfma_f32_16x16x32_bf16 v[120:123], v[220:223], v[72:75], v[120:123]
  ds_read_b64_tr_b16 v[190:191], v29 offset:22528
  s_waitcnt vmcnt(18) lgkmcnt(8)
  v_mfma_f32_16x16x32_bf16 v[128:131], v[160:163], v[80:83], v[128:131]
  buffer_load_dwordx4 v[64:67], off, s[36:39], s50 offset:0 sc1
  v_mfma_f32_16x16x32_bf16 v[132:135], v[160:163], v[84:87], v[132:135]
  ds_read_b64_tr_b16 v[192:193], v26 offset:24576
  ds_read_b64_tr_b16 v[194:195], v26 offset:26624
  v_mfma_f32_16x16x32_bf16 v[140:143], v[164:167], v[84:87], v[140:143]
  ds_read_b64_tr_b16 v[196:197], v27 offset:24576
  v_mfma_f32_16x16x32_bf16 v[136:139], v[164:167], v[80:83], v[136:139]
  ds_read_b64_tr_b16 v[198:199], v27 offset:26624
  v_mfma_f32_16x16x32_bf16 v[144:147], v[168:171], v[80:83], v[144:147]
  ds_read_b64_tr_b16 v[200:201], v28 offset:24576
  v_mfma_f32_16x16x32_bf16 v[148:151], v[168:171], v[84:87], v[148:151]
  ds_read_b64_tr_b16 v[202:203], v28 offset:26624
  ds_read_b64_tr_b16 v[204:205], v29 offset:24576
  v_mfma_f32_16x16x32_bf16 v[156:159], v[172:175], v[84:87], v[156:159]
  buffer_load_dwordx4 v[68:71], off, s[64:67], s50 offset:0 sc1
  v_mfma_f32_16x16x32_bf16 v[152:155], v[172:175], v[80:83], v[152:155]
  ds_read_b64_tr_b16 v[206:207], v29 offset:26624
  s_waitcnt vmcnt(18) lgkmcnt(8)
  v_mfma_f32_16x16x32_bf16 v[128:131], v[176:179], v[88:91], v[128:131]
  ds_read_b64_tr_b16 v[208:209], v26 offset:28672
  v_mfma_f32_16x16x32_bf16 v[132:135], v[176:179], v[92:95], v[132:135]
  ds_read_b64_tr_b16 v[210:211], v26 offset:30720
  v_mfma_f32_16x16x32_bf16 v[140:143], v[180:183], v[92:95], v[140:143]
  ds_read_b64_tr_b16 v[212:213], v27 offset:28672
  v_mfma_f32_16x16x32_bf16 v[136:139], v[180:183], v[88:91], v[136:139]
  ds_read_b64_tr_b16 v[214:215], v27 offset:30720
  v_mfma_f32_16x16x32_bf16 v[144:147], v[184:187], v[88:91], v[144:147]
  buffer_load_dwordx4 v[72:75], off, s[36:39], s50 offset:1024 sc1
  v_mfma_f32_16x16x32_bf16 v[148:151], v[184:187], v[92:95], v[148:151]
  ds_read_b64_tr_b16 v[216:217], v28 offset:28672
  ds_read_b64_tr_b16 v[218:219], v28 offset:30720
  v_mfma_f32_16x16x32_bf16 v[156:159], v[188:191], v[92:95], v[156:159]
  ds_read_b64_tr_b16 v[220:221], v29 offset:28672
  v_mfma_f32_16x16x32_bf16 v[152:155], v[188:191], v[88:91], v[152:155]
  ds_read_b64_tr_b16 v[222:223], v29 offset:30720
  s_waitcnt lgkmcnt(8)
  v_mfma_f32_16x16x32_bf16 v[96:99], v[192:195], v[80:83], v[96:99]
  ds_read_b64_tr_b16 v[160:161], v6 offset:0
  v_mfma_f32_16x16x32_bf16 v[100:103], v[192:195], v[84:87], v[100:103]
  ds_read_b64_tr_b16 v[162:163], v6 offset:2048
  v_mfma_f32_16x16x32_bf16 v[108:111], v[196:199], v[84:87], v[108:111]
  buffer_load_dwordx4 v[76:79], off, s[64:67], s50 offset:1024 sc1
  v_mfma_f32_16x16x32_bf16 v[104:107], v[196:199], v[80:83], v[104:107]
  ds_read_b64_tr_b16 v[164:165], v7 offset:0
  ds_read_b64_tr_b16 v[166:167], v7 offset:2048
  v_mfma_f32_16x16x32_bf16 v[112:115], v[200:203], v[80:83], v[112:115]
  ds_read_b64_tr_b16 v[168:169], v8 offset:0
  v_mfma_f32_16x16x32_bf16 v[116:119], v[200:203], v[84:87], v[116:119]
  ds_read_b64_tr_b16 v[170:171], v8 offset:2048
  v_mfma_f32_16x16x32_bf16 v[124:127], v[204:207], v[84:87], v[124:127]
  ds_read_b64_tr_b16 v[172:173], v9 offset:0
  v_mfma_f32_16x16x32_bf16 v[120:123], v[204:207], v[80:83], v[120:123]
  ds_read_b64_tr_b16 v[174:175], v9 offset:2048
  s_waitcnt lgkmcnt(8)
  s_barrier
  v_mfma_f32_16x16x32_bf16 v[96:99], v[208:211], v[88:91], v[96:99]
  ds_read_b64_tr_b16 v[176:177], v6 offset:4096
  v_mfma_f32_16x16x32_bf16 v[100:103], v[208:211], v[92:95], v[100:103]
  ds_read_b64_tr_b16 v[178:179], v6 offset:6144
  v_mfma_f32_16x16x32_bf16 v[108:111], v[212:215], v[92:95], v[108:111]
  ds_read_b64_tr_b16 v[180:181], v7 offset:4096
  v_mfma_f32_16x16x32_bf16 v[104:107], v[212:215], v[88:91], v[104:107]
  ds_read_b64_tr_b16 v[182:183], v7 offset:6144
  v_mfma_f32_16x16x32_bf16 v[112:115], v[216:219], v[88:91], v[112:115]
  ds_read_b64_tr_b16 v[184:185], v8 offset:4096
  v_mfma_f32_16x16x32_bf16 v[116:119], v[216:219], v[92:95], v[116:119]
  ds_read_b64_tr_b16 v[186:187], v8 offset:6144
  v_readlane_b32 s51, v30, 15
  v_mfma_f32_16x16x32_bf16 v[124:127], v[220:223], v[92:95], v[124:127]
  ds_read_b64_tr_b16 v[188:189], v9 offset:4096
  v_mfma_f32_16x16x32_bf16 v[120:123], v[220:223], v[88:91], v[120:123]
  ds_read_b64_tr_b16 v[190:191], v9 offset:6144
  s_waitcnt vmcnt(18) lgkmcnt(8)
  v_mfma_f32_16x16x32_bf16 v[128:131], v[160:163], v[224:227], v[128:131]
  buffer_load_dwordx4 v[80:83], off, s[36:39], s51 offset:0 sc1
  v_mfma_f32_16x16x32_bf16 v[132:135], v[160:163], v[228:231], v[132:135]
  ds_read_b64_tr_b16 v[192:193], v6 offset:8192
  ds_read_b64_tr_b16 v[194:195], v6 offset:10240
  v_mfma_f32_16x16x32_bf16 v[140:143], v[164:167], v[228:231], v[140:143]
  ds_read_b64_tr_b16 v[196:197], v7 offset:8192
  v_mfma_f32_16x16x32_bf16 v[136:139], v[164:167], v[224:227], v[136:139]
  ds_read_b64_tr_b16 v[198:199], v7 offset:10240
  v_mfma_f32_16x16x32_bf16 v[144:147], v[168:171], v[224:227], v[144:147]
  ds_read_b64_tr_b16 v[200:201], v8 offset:8192
  v_mfma_f32_16x16x32_bf16 v[148:151], v[168:171], v[228:231], v[148:151]
  ds_read_b64_tr_b16 v[202:203], v8 offset:10240
  ds_read_b64_tr_b16 v[204:205], v9 offset:8192
  v_mfma_f32_16x16x32_bf16 v[156:159], v[172:175], v[228:231], v[156:159]
  buffer_load_dwordx4 v[84:87], off, s[64:67], s51 offset:0 sc1
  v_mfma_f32_16x16x32_bf16 v[152:155], v[172:175], v[224:227], v[152:155]
  ds_read_b64_tr_b16 v[206:207], v9 offset:10240
  s_waitcnt vmcnt(18) lgkmcnt(8)
  v_mfma_f32_16x16x32_bf16 v[128:131], v[176:179], v[232:235], v[128:131]
  ds_read_b64_tr_b16 v[208:209], v6 offset:12288
  v_mfma_f32_16x16x32_bf16 v[132:135], v[176:179], v[236:239], v[132:135]
  ds_read_b64_tr_b16 v[210:211], v6 offset:14336
  v_mfma_f32_16x16x32_bf16 v[140:143], v[180:183], v[236:239], v[140:143]
  ds_read_b64_tr_b16 v[212:213], v7 offset:12288
  v_mfma_f32_16x16x32_bf16 v[136:139], v[180:183], v[232:235], v[136:139]
  ds_read_b64_tr_b16 v[214:215], v7 offset:14336
  v_mfma_f32_16x16x32_bf16 v[144:147], v[184:187], v[232:235], v[144:147]
  buffer_load_dwordx4 v[88:91], off, s[36:39], s51 offset:1024 sc1
  v_mfma_f32_16x16x32_bf16 v[148:151], v[184:187], v[236:239], v[148:151]
  ds_read_b64_tr_b16 v[216:217], v8 offset:12288
  ds_read_b64_tr_b16 v[218:219], v8 offset:14336
  v_mfma_f32_16x16x32_bf16 v[156:159], v[188:191], v[236:239], v[156:159]
  ds_read_b64_tr_b16 v[220:221], v9 offset:12288
  v_mfma_f32_16x16x32_bf16 v[152:155], v[188:191], v[232:235], v[152:155]
  ds_read_b64_tr_b16 v[222:223], v9 offset:14336
  s_waitcnt lgkmcnt(8)
  v_mfma_f32_16x16x32_bf16 v[96:99], v[192:195], v[224:227], v[96:99]
  ds_read_b64_tr_b16 v[160:161], v6 offset:16384
  v_mfma_f32_16x16x32_bf16 v[100:103], v[192:195], v[228:231], v[100:103]
  ds_read_b64_tr_b16 v[162:163], v6 offset:18432
  v_mfma_f32_16x16x32_bf16 v[108:111], v[196:199], v[228:231], v[108:111]
  buffer_load_dwordx4 v[92:95], off, s[64:67], s51 offset:1024 sc1
  v_mfma_f32_16x16x32_bf16 v[104:107], v[196:199], v[224:227], v[104:107]
  ds_read_b64_tr_b16 v[164:165], v7 offset:16384
  ds_read_b64_tr_b16 v[166:167], v7 offset:18432
  v_mfma_f32_16x16x32_bf16 v[112:115], v[200:203], v[224:227], v[112:115]
  ds_read_b64_tr_b16 v[168:169], v8 offset:16384
  v_mfma_f32_16x16x32_bf16 v[116:119], v[200:203], v[228:231], v[116:119]
  ds_read_b64_tr_b16 v[170:171], v8 offset:18432
  v_mfma_f32_16x16x32_bf16 v[124:127], v[204:207], v[228:231], v[124:127]
  ds_read_b64_tr_b16 v[172:173], v9 offset:16384
  v_mfma_f32_16x16x32_bf16 v[120:123], v[204:207], v[224:227], v[120:123]
  ds_read_b64_tr_b16 v[174:175], v9 offset:18432
  s_waitcnt lgkmcnt(8)
  v_mfma_f32_16x16x32_bf16 v[96:99], v[208:211], v[232:235], v[96:99]
  ds_read_b64_tr_b16 v[176:177], v6 offset:20480
  v_mfma_f32_16x16x32_bf16 v[100:103], v[208:211], v[236:239], v[100:103]
  ds_read_b64_tr_b16 v[178:179], v6 offset:22528
  v_mfma_f32_16x16x32_bf16 v[108:111], v[212:215], v[236:239], v[108:111]
  ds_read_b64_tr_b16 v[180:181], v7 offset:20480
  v_mfma_f32_16x16x32_bf16 v[104:107], v[212:215], v[232:235], v[104:107]
  ds_read_b64_tr_b16 v[182:183], v7 offset:22528
  v_mfma_f32_16x16x32_bf16 v[112:115], v[216:219], v[232:235], v[112:115]
  ds_read_b64_tr_b16 v[184:185], v8 offset:20480
  v_mfma_f32_16x16x32_bf16 v[116:119], v[216:219], v[236:239], v[116:119]
  ds_read_b64_tr_b16 v[186:187], v8 offset:22528
  v_readlane_b32 s48, v30, 16
  v_mfma_f32_16x16x32_bf16 v[124:127], v[220:223], v[236:239], v[124:127]
  ds_read_b64_tr_b16 v[188:189], v9 offset:20480
  v_mfma_f32_16x16x32_bf16 v[120:123], v[220:223], v[232:235], v[120:123]
  ds_read_b64_tr_b16 v[190:191], v9 offset:22528
  s_waitcnt vmcnt(18) lgkmcnt(8)
  v_mfma_f32_16x16x32_bf16 v[128:131], v[160:163], v[240:243], v[128:131]
  buffer_load_dwordx4 v[224:227], off, s[36:39], s48 offset:0 sc1
  v_mfma_f32_16x16x32_bf16 v[132:135], v[160:163], v[244:247], v[132:135]
  ds_read_b64_tr_b16 v[192:193], v6 offset:24576
  ds_read_b64_tr_b16 v[194:195], v6 offset:26624
  v_mfma_f32_16x16x32_bf16 v[140:143], v[164:167], v[244:247], v[140:143]
  ds_read_b64_tr_b16 v[196:197], v7 offset:24576
  v_mfma_f32_16x16x32_bf16 v[136:139], v[164:167], v[240:243], v[136:139]
  ds_read_b64_tr_b16 v[198:199], v7 offset:26624
  v_mfma_f32_16x16x32_bf16 v[144:147], v[168:171], v[240:243], v[144:147]
  ds_read_b64_tr_b16 v[200:201], v8 offset:24576
  v_mfma_f32_16x16x32_bf16 v[148:151], v[168:171], v[244:247], v[148:151]
  ds_read_b64_tr_b16 v[202:203], v8 offset:26624
  ds_read_b64_tr_b16 v[204:205], v9 offset:24576
  v_mfma_f32_16x16x32_bf16 v[156:159], v[172:175], v[244:247], v[156:159]
  buffer_load_dwordx4 v[228:231], off, s[64:67], s48 offset:0 sc1
  v_mfma_f32_16x16x32_bf16 v[152:155], v[172:175], v[240:243], v[152:155]
  ds_read_b64_tr_b16 v[206:207], v9 offset:26624
  s_waitcnt vmcnt(18) lgkmcnt(8)
  v_mfma_f32_16x16x32_bf16 v[128:131], v[176:179], v[248:251], v[128:131]
  ds_read_b64_tr_b16 v[208:209], v6 offset:28672
  v_mfma_f32_16x16x32_bf16 v[132:135], v[176:179], v[252:255], v[132:135]
  ds_read_b64_tr_b16 v[210:211], v6 offset:30720
  v_mfma_f32_16x16x32_bf16 v[140:143], v[180:183], v[252:255], v[140:143]
  ds_read_b64_tr_b16 v[212:213], v7 offset:28672
  v_mfma_f32_16x16x32_bf16 v[136:139], v[180:183], v[248:251], v[136:139]
  ds_read_b64_tr_b16 v[214:215], v7 offset:30720
  v_mfma_f32_16x16x32_bf16 v[144:147], v[184:187], v[248:251], v[144:147]
  buffer_load_dwordx4 v[232:235], off, s[36:39], s48 offset:1024 sc1
  v_mfma_f32_16x16x32_bf16 v[148:151], v[184:187], v[252:255], v[148:151]
  ds_read_b64_tr_b16 v[216:217], v8 offset:28672
  ds_read_b64_tr_b16 v[218:219], v8 offset:30720
  v_mfma_f32_16x16x32_bf16 v[156:159], v[188:191], v[252:255], v[156:159]
  ds_read_b64_tr_b16 v[220:221], v9 offset:28672
  v_mfma_f32_16x16x32_bf16 v[152:155], v[188:191], v[248:251], v[152:155]
  ds_read_b64_tr_b16 v[222:223], v9 offset:30720
  s_waitcnt lgkmcnt(8)
  v_mfma_f32_16x16x32_bf16 v[96:99], v[192:195], v[240:243], v[96:99]
  ds_read_b64_tr_b16 v[160:161], v6 offset:32768
  v_mfma_f32_16x16x32_bf16 v[100:103], v[192:195], v[244:247], v[100:103]
  ds_read_b64_tr_b16 v[162:163], v6 offset:34816
  v_mfma_f32_16x16x32_bf16 v[108:111], v[196:199], v[244:247], v[108:111]
  buffer_load_dwordx4 v[236:239], off, s[64:67], s48 offset:1024 sc1
  v_mfma_f32_16x16x32_bf16 v[104:107], v[196:199], v[240:243], v[104:107]
  ds_read_b64_tr_b16 v[164:165], v7 offset:32768
  ds_read_b64_tr_b16 v[166:167], v7 offset:34816
  v_mfma_f32_16x16x32_bf16 v[112:115], v[200:203], v[240:243], v[112:115]
  ds_read_b64_tr_b16 v[168:169], v8 offset:32768
  v_mfma_f32_16x16x32_bf16 v[116:119], v[200:203], v[244:247], v[116:119]
  ds_read_b64_tr_b16 v[170:171], v8 offset:34816
  v_mfma_f32_16x16x32_bf16 v[124:127], v[204:207], v[244:247], v[124:127]
  ds_read_b64_tr_b16 v[172:173], v9 offset:32768
  v_mfma_f32_16x16x32_bf16 v[120:123], v[204:207], v[240:243], v[120:123]
  ds_read_b64_tr_b16 v[174:175], v9 offset:34816
  s_waitcnt lgkmcnt(8)
  s_barrier
  v_mfma_f32_16x16x32_bf16 v[96:99], v[208:211], v[248:251], v[96:99]
  ds_read_b64_tr_b16 v[176:177], v6 offset:36864
  v_mfma_f32_16x16x32_bf16 v[100:103], v[208:211], v[252:255], v[100:103]
  ds_read_b64_tr_b16 v[178:179], v6 offset:38912
  v_mfma_f32_16x16x32_bf16 v[108:111], v[212:215], v[252:255], v[108:111]
  ds_read_b64_tr_b16 v[180:181], v7 offset:36864
  v_mfma_f32_16x16x32_bf16 v[104:107], v[212:215], v[248:251], v[104:107]
  ds_read_b64_tr_b16 v[182:183], v7 offset:38912
  v_mfma_f32_16x16x32_bf16 v[112:115], v[216:219], v[248:251], v[112:115]
  ds_read_b64_tr_b16 v[184:185], v8 offset:36864
  v_mfma_f32_16x16x32_bf16 v[116:119], v[216:219], v[252:255], v[116:119]
  ds_read_b64_tr_b16 v[186:187], v8 offset:38912
  v_readlane_b32 s49, v30, 17
  v_mfma_f32_16x16x32_bf16 v[124:127], v[220:223], v[252:255], v[124:127]
  ds_read_b64_tr_b16 v[188:189], v9 offset:36864
  v_mfma_f32_16x16x32_bf16 v[120:123], v[220:223], v[248:251], v[120:123]
  ds_read_b64_tr_b16 v[190:191], v9 offset:38912
  s_waitcnt vmcnt(18) lgkmcnt(8)
  v_mfma_f32_16x16x32_bf16 v[128:131], v[160:163], v[32:35], v[128:131]
  buffer_load_dwordx4 v[240:243], off, s[36:39], s49 offset:0 sc1
  v_mfma_f32_16x16x32_bf16 v[132:135], v[160:163], v[36:39], v[132:135]
  ds_read_b64_tr_b16 v[192:193], v6 offset:40960
  ds_read_b64_tr_b16 v[194:195], v6 offset:43008
  v_mfma_f32_16x16x32_bf16 v[140:143], v[164:167], v[36:39], v[140:143]
  ds_read_b64_tr_b16 v[196:197], v7 offset:40960
  v_mfma_f32_16x16x32_bf16 v[136:139], v[164:167], v[32:35], v[136:139]
  ds_read_b64_tr_b16 v[198:199], v7 offset:43008
  v_mfma_f32_16x16x32_bf16 v[144:147], v[168:171], v[32:35], v[144:147]
  ds_read_b64_tr_b16 v[200:201], v8 offset:40960
  v_mfma_f32_16x16x32_bf16 v[148:151], v[168:171], v[36:39], v[148:151]
  ds_read_b64_tr_b16 v[202:203], v8 offset:43008
  ds_read_b64_tr_b16 v[204:205], v9 offset:40960
  v_mfma_f32_16x16x32_bf16 v[156:159], v[172:175], v[36:39], v[156:159]
  buffer_load_dwordx4 v[244:247], off, s[64:67], s49 offset:0 sc1
  v_mfma_f32_16x16x32_bf16 v[152:155], v[172:175], v[32:35], v[152:155]
  ds_read_b64_tr_b16 v[206:207], v9 offset:43008
  s_waitcnt vmcnt(18) lgkmcnt(8)
  v_mfma_f32_16x16x32_bf16 v[128:131], v[176:179], v[40:43], v[128:131]
  ds_read_b64_tr_b16 v[208:209], v6 offset:45056
  v_mfma_f32_16x16x32_bf16 v[132:135], v[176:179], v[44:47], v[132:135]
  ds_read_b64_tr_b16 v[210:211], v6 offset:47104
  v_mfma_f32_16x16x32_bf16 v[140:143], v[180:183], v[44:47], v[140:143]
  ds_read_b64_tr_b16 v[212:213], v7 offset:45056
  v_mfma_f32_16x16x32_bf16 v[136:139], v[180:183], v[40:43], v[136:139]
  ds_read_b64_tr_b16 v[214:215], v7 offset:47104
  v_mfma_f32_16x16x32_bf16 v[144:147], v[184:187], v[40:43], v[144:147]
  buffer_load_dwordx4 v[248:251], off, s[36:39], s49 offset:1024 sc1
  v_mfma_f32_16x16x32_bf16 v[148:151], v[184:187], v[44:47], v[148:151]
  ds_read_b64_tr_b16 v[216:217], v8 offset:45056
  ds_read_b64_tr_b16 v[218:219], v8 offset:47104
  v_mfma_f32_16x16x32_bf16 v[156:159], v[188:191], v[44:47], v[156:159]
  ds_read_b64_tr_b16 v[220:221], v9 offset:45056
  v_mfma_f32_16x16x32_bf16 v[152:155], v[188:191], v[40:43], v[152:155]
  ds_read_b64_tr_b16 v[222:223], v9 offset:47104
  s_waitcnt lgkmcnt(8)
  v_mfma_f32_16x16x32_bf16 v[96:99], v[192:195], v[32:35], v[96:99]
  ds_read_b64_tr_b16 v[160:161], v6 offset:49152
  v_mfma_f32_16x16x32_bf16 v[100:103], v[192:195], v[36:39], v[100:103]
  ds_read_b64_tr_b16 v[162:163], v6 offset:51200
  v_mfma_f32_16x16x32_bf16 v[108:111], v[196:199], v[36:39], v[108:111]
  buffer_load_dwordx4 v[252:255], off, s[64:67], s49 offset:1024 sc1
  v_mfma_f32_16x16x32_bf16 v[104:107], v[196:199], v[32:35], v[104:107]
  ds_read_b64_tr_b16 v[164:165], v7 offset:49152
  ds_read_b64_tr_b16 v[166:167], v7 offset:51200
  v_mfma_f32_16x16x32_bf16 v[112:115], v[200:203], v[32:35], v[112:115]
  ds_read_b64_tr_b16 v[168:169], v8 offset:49152
  v_mfma_f32_16x16x32_bf16 v[116:119], v[200:203], v[36:39], v[116:119]
  ds_read_b64_tr_b16 v[170:171], v8 offset:51200
  v_mfma_f32_16x16x32_bf16 v[124:127], v[204:207], v[36:39], v[124:127]
  ds_read_b64_tr_b16 v[172:173], v9 offset:49152
  v_mfma_f32_16x16x32_bf16 v[120:123], v[204:207], v[32:35], v[120:123]
  ds_read_b64_tr_b16 v[174:175], v9 offset:51200
  s_waitcnt lgkmcnt(8)
  v_mfma_f32_16x16x32_bf16 v[96:99], v[208:211], v[40:43], v[96:99]
  ds_read_b64_tr_b16 v[176:177], v6 offset:53248
  v_mfma_f32_16x16x32_bf16 v[100:103], v[208:211], v[44:47], v[100:103]
  ds_read_b64_tr_b16 v[178:179], v6 offset:55296
  v_mfma_f32_16x16x32_bf16 v[108:111], v[212:215], v[44:47], v[108:111]
  ds_read_b64_tr_b16 v[180:181], v7 offset:53248
  v_mfma_f32_16x16x32_bf16 v[104:107], v[212:215], v[40:43], v[104:107]
  ds_read_b64_tr_b16 v[182:183], v7 offset:55296
  v_mfma_f32_16x16x32_bf16 v[112:115], v[216:219], v[40:43], v[112:115]
  ds_read_b64_tr_b16 v[184:185], v8 offset:53248
  v_mfma_f32_16x16x32_bf16 v[116:119], v[216:219], v[44:47], v[116:119]
  ds_read_b64_tr_b16 v[186:187], v8 offset:55296
  v_readlane_b32 s50, v30, 18
  v_mfma_f32_16x16x32_bf16 v[124:127], v[220:223], v[44:47], v[124:127]
  ds_read_b64_tr_b16 v[188:189], v9 offset:53248
  v_mfma_f32_16x16x32_bf16 v[120:123], v[220:223], v[40:43], v[120:123]
  ds_read_b64_tr_b16 v[190:191], v9 offset:55296
  s_waitcnt vmcnt(18) lgkmcnt(8)
  v_mfma_f32_16x16x32_bf16 v[128:131], v[160:163], v[48:51], v[128:131]
  buffer_load_dwordx4 v[32:35], off, s[36:39], s50 offset:0 sc1
  v_mfma_f32_16x16x32_bf16 v[132:135], v[160:163], v[52:55], v[132:135]
  ds_read_b64_tr_b16 v[192:193], v6 offset:57344
  ds_read_b64_tr_b16 v[194:195], v6 offset:59392
  v_mfma_f32_16x16x32_bf16 v[140:143], v[164:167], v[52:55], v[140:143]
  ds_read_b64_tr_b16 v[196:197], v7 offset:57344
  v_mfma_f32_16x16x32_bf16 v[136:139], v[164:167], v[48:51], v[136:139]
  ds_read_b64_tr_b16 v[198:199], v7 offset:59392
  v_mfma_f32_16x16x32_bf16 v[144:147], v[168:171], v[48:51], v[144:147]
  ds_read_b64_tr_b16 v[200:201], v8 offset:57344
  v_mfma_f32_16x16x32_bf16 v[148:151], v[168:171], v[52:55], v[148:151]
  ds_read_b64_tr_b16 v[202:203], v8 offset:59392
  ds_read_b64_tr_b16 v[204:205], v9 offset:57344
  v_mfma_f32_16x16x32_bf16 v[156:159], v[172:175], v[52:55], v[156:159]
  buffer_load_dwordx4 v[36:39], off, s[64:67], s50 offset:0 sc1
  v_mfma_f32_16x16x32_bf16 v[152:155], v[172:175], v[48:51], v[152:155]
  ds_read_b64_tr_b16 v[206:207], v9 offset:59392
  s_waitcnt vmcnt(18) lgkmcnt(8)
  v_mfma_f32_16x16x32_bf16 v[128:131], v[176:179], v[56:59], v[128:131]
  ds_read_b64_tr_b16 v[208:209], v6 offset:61440
  v_mfma_f32_16x16x32_bf16 v[132:135], v[176:179], v[60:63], v[132:135]
  ds_read_b64_tr_b16 v[210:211], v6 offset:63488
  v_mfma_f32_16x16x32_bf16 v[140:143], v[180:183], v[60:63], v[140:143]
  ds_read_b64_tr_b16 v[212:213], v7 offset:61440
  v_mfma_f32_16x16x32_bf16 v[136:139], v[180:183], v[56:59], v[136:139]
  ds_read_b64_tr_b16 v[214:215], v7 offset:63488
  v_mfma_f32_16x16x32_bf16 v[144:147], v[184:187], v[56:59], v[144:147]
  buffer_load_dwordx4 v[40:43], off, s[36:39], s50 offset:1024 sc1
  v_mfma_f32_16x16x32_bf16 v[148:151], v[184:187], v[60:63], v[148:151]
  ds_read_b64_tr_b16 v[216:217], v8 offset:61440
  ds_read_b64_tr_b16 v[218:219], v8 offset:63488
  v_mfma_f32_16x16x32_bf16 v[156:159], v[188:191], v[60:63], v[156:159]
  ds_read_b64_tr_b16 v[220:221], v9 offset:61440
  v_mfma_f32_16x16x32_bf16 v[152:155], v[188:191], v[56:59], v[152:155]
  ds_read_b64_tr_b16 v[222:223], v9 offset:63488
  s_waitcnt lgkmcnt(8)
  v_mfma_f32_16x16x32_bf16 v[96:99], v[192:195], v[48:51], v[96:99]
  ds_read_b64_tr_b16 v[160:161], v20 offset:0
  v_mfma_f32_16x16x32_bf16 v[100:103], v[192:195], v[52:55], v[100:103]
  ds_read_b64_tr_b16 v[162:163], v20 offset:2048
  v_mfma_f32_16x16x32_bf16 v[108:111], v[196:199], v[52:55], v[108:111]
  buffer_load_dwordx4 v[44:47], off, s[64:67], s50 offset:1024 sc1
  v_mfma_f32_16x16x32_bf16 v[104:107], v[196:199], v[48:51], v[104:107]
  ds_read_b64_tr_b16 v[164:165], v21 offset:0
  ds_read_b64_tr_b16 v[166:167], v21 offset:2048
  v_mfma_f32_16x16x32_bf16 v[112:115], v[200:203], v[48:51], v[112:115]
  ds_read_b64_tr_b16 v[168:169], v22 offset:0
  v_mfma_f32_16x16x32_bf16 v[116:119], v[200:203], v[52:55], v[116:119]
  ds_read_b64_tr_b16 v[170:171], v22 offset:2048
  v_mfma_f32_16x16x32_bf16 v[124:127], v[204:207], v[52:55], v[124:127]
  ds_read_b64_tr_b16 v[172:173], v23 offset:0
  v_mfma_f32_16x16x32_bf16 v[120:123], v[204:207], v[48:51], v[120:123]
  ds_read_b64_tr_b16 v[174:175], v23 offset:2048
  s_waitcnt lgkmcnt(8)
  s_barrier
  v_mfma_f32_16x16x32_bf16 v[96:99], v[208:211], v[56:59], v[96:99]
  ds_read_b64_tr_b16 v[176:177], v20 offset:4096
  v_mfma_f32_16x16x32_bf16 v[100:103], v[208:211], v[60:63], v[100:103]
  ds_read_b64_tr_b16 v[178:179], v20 offset:6144
  v_mfma_f32_16x16x32_bf16 v[108:111], v[212:215], v[60:63], v[108:111]
  ds_read_b64_tr_b16 v[180:181], v21 offset:4096
  v_mfma_f32_16x16x32_bf16 v[104:107], v[212:215], v[56:59], v[104:107]
  ds_read_b64_tr_b16 v[182:183], v21 offset:6144
  v_mfma_f32_16x16x32_bf16 v[112:115], v[216:219], v[56:59], v[112:115]
  ds_read_b64_tr_b16 v[184:185], v22 offset:4096
  v_mfma_f32_16x16x32_bf16 v[116:119], v[216:219], v[60:63], v[116:119]
  ds_read_b64_tr_b16 v[186:187], v22 offset:6144
  v_readlane_b32 s51, v30, 19
  v_mfma_f32_16x16x32_bf16 v[124:127], v[220:223], v[60:63], v[124:127]
  ds_read_b64_tr_b16 v[188:189], v23 offset:4096
  v_mfma_f32_16x16x32_bf16 v[120:123], v[220:223], v[56:59], v[120:123]
  ds_read_b64_tr_b16 v[190:191], v23 offset:6144
  s_waitcnt vmcnt(18) lgkmcnt(8)
  v_mfma_f32_16x16x32_bf16 v[128:131], v[160:163], v[64:67], v[128:131]
  buffer_load_dwordx4 v[48:51], off, s[36:39], s51 offset:0 sc1
  v_mfma_f32_16x16x32_bf16 v[132:135], v[160:163], v[68:71], v[132:135]
  ds_read_b64_tr_b16 v[192:193], v20 offset:8192
  ds_read_b64_tr_b16 v[194:195], v20 offset:10240
  v_mfma_f32_16x16x32_bf16 v[140:143], v[164:167], v[68:71], v[140:143]
  ds_read_b64_tr_b16 v[196:197], v21 offset:8192
  v_mfma_f32_16x16x32_bf16 v[136:139], v[164:167], v[64:67], v[136:139]
  ds_read_b64_tr_b16 v[198:199], v21 offset:10240
  v_mfma_f32_16x16x32_bf16 v[144:147], v[168:171], v[64:67], v[144:147]
  ds_read_b64_tr_b16 v[200:201], v22 offset:8192
  v_mfma_f32_16x16x32_bf16 v[148:151], v[168:171], v[68:71], v[148:151]
  ds_read_b64_tr_b16 v[202:203], v22 offset:10240
  ds_read_b64_tr_b16 v[204:205], v23 offset:8192
  v_mfma_f32_16x16x32_bf16 v[156:159], v[172:175], v[68:71], v[156:159]
  buffer_load_dwordx4 v[52:55], off, s[64:67], s51 offset:0 sc1
  v_mfma_f32_16x16x32_bf16 v[152:155], v[172:175], v[64:67], v[152:155]
  ds_read_b64_tr_b16 v[206:207], v23 offset:10240
  s_waitcnt vmcnt(18) lgkmcnt(8)
  v_mfma_f32_16x16x32_bf16 v[128:131], v[176:179], v[72:75], v[128:131]
  ds_read_b64_tr_b16 v[208:209], v20 offset:12288
  v_mfma_f32_16x16x32_bf16 v[132:135], v[176:179], v[76:79], v[132:135]
  ds_read_b64_tr_b16 v[210:211], v20 offset:14336
  v_mfma_f32_16x16x32_bf16 v[140:143], v[180:183], v[76:79], v[140:143]
  ds_read_b64_tr_b16 v[212:213], v21 offset:12288
  v_mfma_f32_16x16x32_bf16 v[136:139], v[180:183], v[72:75], v[136:139]
  ds_read_b64_tr_b16 v[214:215], v21 offset:14336
  v_mfma_f32_16x16x32_bf16 v[144:147], v[184:187], v[72:75], v[144:147]
  buffer_load_dwordx4 v[56:59], off, s[36:39], s51 offset:1024 sc1
  v_mfma_f32_16x16x32_bf16 v[148:151], v[184:187], v[76:79], v[148:151]
  ds_read_b64_tr_b16 v[216:217], v22 offset:12288
  ds_read_b64_tr_b16 v[218:219], v22 offset:14336
  v_mfma_f32_16x16x32_bf16 v[156:159], v[188:191], v[76:79], v[156:159]
  ds_read_b64_tr_b16 v[220:221], v23 offset:12288
  v_mfma_f32_16x16x32_bf16 v[152:155], v[188:191], v[72:75], v[152:155]
  ds_read_b64_tr_b16 v[222:223], v23 offset:14336
  s_waitcnt lgkmcnt(8)
  v_mfma_f32_16x16x32_bf16 v[96:99], v[192:195], v[64:67], v[96:99]
  ds_read_b64_tr_b16 v[160:161], v20 offset:16384
  v_mfma_f32_16x16x32_bf16 v[100:103], v[192:195], v[68:71], v[100:103]
  ds_read_b64_tr_b16 v[162:163], v20 offset:18432
  v_mfma_f32_16x16x32_bf16 v[108:111], v[196:199], v[68:71], v[108:111]
  buffer_load_dwordx4 v[60:63], off, s[64:67], s51 offset:1024 sc1
  v_mfma_f32_16x16x32_bf16 v[104:107], v[196:199], v[64:67], v[104:107]
  ds_read_b64_tr_b16 v[164:165], v21 offset:16384
  ds_read_b64_tr_b16 v[166:167], v21 offset:18432
  v_mfma_f32_16x16x32_bf16 v[112:115], v[200:203], v[64:67], v[112:115]
  ds_read_b64_tr_b16 v[168:169], v22 offset:16384
  v_mfma_f32_16x16x32_bf16 v[116:119], v[200:203], v[68:71], v[116:119]
  ds_read_b64_tr_b16 v[170:171], v22 offset:18432
  v_mfma_f32_16x16x32_bf16 v[124:127], v[204:207], v[68:71], v[124:127]
  ds_read_b64_tr_b16 v[172:173], v23 offset:16384
  v_mfma_f32_16x16x32_bf16 v[120:123], v[204:207], v[64:67], v[120:123]
  ds_read_b64_tr_b16 v[174:175], v23 offset:18432
  s_waitcnt lgkmcnt(8)
  v_mfma_f32_16x16x32_bf16 v[96:99], v[208:211], v[72:75], v[96:99]
  ds_read_b64_tr_b16 v[176:177], v20 offset:20480
  v_mfma_f32_16x16x32_bf16 v[100:103], v[208:211], v[76:79], v[100:103]
  ds_read_b64_tr_b16 v[178:179], v20 offset:22528
  v_mfma_f32_16x16x32_bf16 v[108:111], v[212:215], v[76:79], v[108:111]
  ds_read_b64_tr_b16 v[180:181], v21 offset:20480
  v_mfma_f32_16x16x32_bf16 v[104:107], v[212:215], v[72:75], v[104:107]
  ds_read_b64_tr_b16 v[182:183], v21 offset:22528
  v_mfma_f32_16x16x32_bf16 v[112:115], v[216:219], v[72:75], v[112:115]
  ds_read_b64_tr_b16 v[184:185], v22 offset:20480
  v_mfma_f32_16x16x32_bf16 v[116:119], v[216:219], v[76:79], v[116:119]
  ds_read_b64_tr_b16 v[186:187], v22 offset:22528
  v_readlane_b32 s48, v30, 20
  v_mfma_f32_16x16x32_bf16 v[124:127], v[220:223], v[76:79], v[124:127]
  ds_read_b64_tr_b16 v[188:189], v23 offset:20480
  v_mfma_f32_16x16x32_bf16 v[120:123], v[220:223], v[72:75], v[120:123]
  ds_read_b64_tr_b16 v[190:191], v23 offset:22528
  s_waitcnt vmcnt(18) lgkmcnt(8)
  v_mfma_f32_16x16x32_bf16 v[128:131], v[160:163], v[80:83], v[128:131]
  buffer_load_dwordx4 v[64:67], off, s[36:39], s48 offset:0 sc1
  v_mfma_f32_16x16x32_bf16 v[132:135], v[160:163], v[84:87], v[132:135]
  ds_read_b64_tr_b16 v[192:193], v20 offset:24576
  ds_read_b64_tr_b16 v[194:195], v20 offset:26624
  v_mfma_f32_16x16x32_bf16 v[140:143], v[164:167], v[84:87], v[140:143]
  ds_read_b64_tr_b16 v[196:197], v21 offset:24576
  v_mfma_f32_16x16x32_bf16 v[136:139], v[164:167], v[80:83], v[136:139]
  ds_read_b64_tr_b16 v[198:199], v21 offset:26624
  v_mfma_f32_16x16x32_bf16 v[144:147], v[168:171], v[80:83], v[144:147]
  ds_read_b64_tr_b16 v[200:201], v22 offset:24576
  v_mfma_f32_16x16x32_bf16 v[148:151], v[168:171], v[84:87], v[148:151]
  ds_read_b64_tr_b16 v[202:203], v22 offset:26624
  ds_read_b64_tr_b16 v[204:205], v23 offset:24576
  v_mfma_f32_16x16x32_bf16 v[156:159], v[172:175], v[84:87], v[156:159]
  buffer_load_dwordx4 v[68:71], off, s[64:67], s48 offset:0 sc1
  v_mfma_f32_16x16x32_bf16 v[152:155], v[172:175], v[80:83], v[152:155]
  ds_read_b64_tr_b16 v[206:207], v23 offset:26624
  s_waitcnt vmcnt(18) lgkmcnt(8)
  v_mfma_f32_16x16x32_bf16 v[128:131], v[176:179], v[88:91], v[128:131]
  ds_read_b64_tr_b16 v[208:209], v20 offset:28672
  v_mfma_f32_16x16x32_bf16 v[132:135], v[176:179], v[92:95], v[132:135]
  ds_read_b64_tr_b16 v[210:211], v20 offset:30720
  v_mfma_f32_16x16x32_bf16 v[140:143], v[180:183], v[92:95], v[140:143]
  ds_read_b64_tr_b16 v[212:213], v21 offset:28672
  v_mfma_f32_16x16x32_bf16 v[136:139], v[180:183], v[88:91], v[136:139]
  ds_read_b64_tr_b16 v[214:215], v21 offset:30720
  v_mfma_f32_16x16x32_bf16 v[144:147], v[184:187], v[88:91], v[144:147]
  buffer_load_dwordx4 v[72:75], off, s[36:39], s48 offset:1024 sc1
  v_mfma_f32_16x16x32_bf16 v[148:151], v[184:187], v[92:95], v[148:151]
  ds_read_b64_tr_b16 v[216:217], v22 offset:28672
  ds_read_b64_tr_b16 v[218:219], v22 offset:30720
  v_mfma_f32_16x16x32_bf16 v[156:159], v[188:191], v[92:95], v[156:159]
  ds_read_b64_tr_b16 v[220:221], v23 offset:28672
  v_mfma_f32_16x16x32_bf16 v[152:155], v[188:191], v[88:91], v[152:155]
  ds_read_b64_tr_b16 v[222:223], v23 offset:30720
  s_waitcnt lgkmcnt(8)
  v_mfma_f32_16x16x32_bf16 v[96:99], v[192:195], v[80:83], v[96:99]
  ds_read_b64_tr_b16 v[160:161], v20 offset:32768
  v_mfma_f32_16x16x32_bf16 v[100:103], v[192:195], v[84:87], v[100:103]
  ds_read_b64_tr_b16 v[162:163], v20 offset:34816
  v_mfma_f32_16x16x32_bf16 v[108:111], v[196:199], v[84:87], v[108:111]
  buffer_load_dwordx4 v[76:79], off, s[64:67], s48 offset:1024 sc1
  v_mfma_f32_16x16x32_bf16 v[104:107], v[196:199], v[80:83], v[104:107]
  ds_read_b64_tr_b16 v[164:165], v21 offset:32768
  ds_read_b64_tr_b16 v[166:167], v21 offset:34816
  v_mfma_f32_16x16x32_bf16 v[112:115], v[200:203], v[80:83], v[112:115]
  ds_read_b64_tr_b16 v[168:169], v22 offset:32768
  v_mfma_f32_16x16x32_bf16 v[116:119], v[200:203], v[84:87], v[116:119]
  ds_read_b64_tr_b16 v[170:171], v22 offset:34816
  v_mfma_f32_16x16x32_bf16 v[124:127], v[204:207], v[84:87], v[124:127]
  ds_read_b64_tr_b16 v[172:173], v23 offset:32768
  v_mfma_f32_16x16x32_bf16 v[120:123], v[204:207], v[80:83], v[120:123]
  ds_read_b64_tr_b16 v[174:175], v23 offset:34816
  s_waitcnt lgkmcnt(8)
  s_barrier
  v_mfma_f32_16x16x32_bf16 v[96:99], v[208:211], v[88:91], v[96:99]
  ds_read_b64_tr_b16 v[176:177], v20 offset:36864
  v_mfma_f32_16x16x32_bf16 v[100:103], v[208:211], v[92:95], v[100:103]
  ds_read_b64_tr_b16 v[178:179], v20 offset:38912
  v_mfma_f32_16x16x32_bf16 v[108:111], v[212:215], v[92:95], v[108:111]
  ds_read_b64_tr_b16 v[180:181], v21 offset:36864
  v_mfma_f32_16x16x32_bf16 v[104:107], v[212:215], v[88:91], v[104:107]
  ds_read_b64_tr_b16 v[182:183], v21 offset:38912
  v_mfma_f32_16x16x32_bf16 v[112:115], v[216:219], v[88:91], v[112:115]
  ds_read_b64_tr_b16 v[184:185], v22 offset:36864
  v_mfma_f32_16x16x32_bf16 v[116:119], v[216:219], v[92:95], v[116:119]
  ds_read_b64_tr_b16 v[186:187], v22 offset:38912
  v_readlane_b32 s49, v30, 21
  v_mfma_f32_16x16x32_bf16 v[124:127], v[220:223], v[92:95], v[124:127]
  ds_read_b64_tr_b16 v[188:189], v23 offset:36864
  v_mfma_f32_16x16x32_bf16 v[120:123], v[220:223], v[88:91], v[120:123]
  ds_read_b64_tr_b16 v[190:191], v23 offset:38912
  s_waitcnt vmcnt(18) lgkmcnt(8)
  v_mfma_f32_16x16x32_bf16 v[128:131], v[160:163], v[224:227], v[128:131]
  buffer_load_dwordx4 v[80:83], off, s[36:39], s49 offset:0 sc1
  v_mfma_f32_16x16x32_bf16 v[132:135], v[160:163], v[228:231], v[132:135]
  ds_read_b64_tr_b16 v[192:193], v20 offset:40960
  ds_read_b64_tr_b16 v[194:195], v20 offset:43008
  v_mfma_f32_16x16x32_bf16 v[140:143], v[164:167], v[228:231], v[140:143]
  ds_read_b64_tr_b16 v[196:197], v21 offset:40960
  v_mfma_f32_16x16x32_bf16 v[136:139], v[164:167], v[224:227], v[136:139]
  ds_read_b64_tr_b16 v[198:199], v21 offset:43008
  v_mfma_f32_16x16x32_bf16 v[144:147], v[168:171], v[224:227], v[144:147]
  ds_read_b64_tr_b16 v[200:201], v22 offset:40960
  v_mfma_f32_16x16x32_bf16 v[148:151], v[168:171], v[228:231], v[148:151]
  ds_read_b64_tr_b16 v[202:203], v22 offset:43008
  ds_read_b64_tr_b16 v[204:205], v23 offset:40960
  v_mfma_f32_16x16x32_bf16 v[156:159], v[172:175], v[228:231], v[156:159]
  buffer_load_dwordx4 v[84:87], off, s[64:67], s49 offset:0 sc1
  v_mfma_f32_16x16x32_bf16 v[152:155], v[172:175], v[224:227], v[152:155]
  ds_read_b64_tr_b16 v[206:207], v23 offset:43008
  s_waitcnt vmcnt(18) lgkmcnt(8)
  v_mfma_f32_16x16x32_bf16 v[128:131], v[176:179], v[232:235], v[128:131]
  ds_read_b64_tr_b16 v[208:209], v20 offset:45056
  v_mfma_f32_16x16x32_bf16 v[132:135], v[176:179], v[236:239], v[132:135]
  ds_read_b64_tr_b16 v[210:211], v20 offset:47104
  v_mfma_f32_16x16x32_bf16 v[140:143], v[180:183], v[236:239], v[140:143]
  ds_read_b64_tr_b16 v[212:213], v21 offset:45056
  v_mfma_f32_16x16x32_bf16 v[136:139], v[180:183], v[232:235], v[136:139]
  ds_read_b64_tr_b16 v[214:215], v21 offset:47104
  v_mfma_f32_16x16x32_bf16 v[144:147], v[184:187], v[232:235], v[144:147]
  buffer_load_dwordx4 v[88:91], off, s[36:39], s49 offset:1024 sc1
  v_mfma_f32_16x16x32_bf16 v[148:151], v[184:187], v[236:239], v[148:151]
  ds_read_b64_tr_b16 v[216:217], v22 offset:45056
  ds_read_b64_tr_b16 v[218:219], v22 offset:47104
  v_mfma_f32_16x16x32_bf16 v[156:159], v[188:191], v[236:239], v[156:159]
  ds_read_b64_tr_b16 v[220:221], v23 offset:45056
  v_mfma_f32_16x16x32_bf16 v[152:155], v[188:191], v[232:235], v[152:155]
  ds_read_b64_tr_b16 v[222:223], v23 offset:47104
  s_waitcnt lgkmcnt(8)
  v_mfma_f32_16x16x32_bf16 v[96:99], v[192:195], v[224:227], v[96:99]
  ds_read_b64_tr_b16 v[160:161], v20 offset:49152
  v_mfma_f32_16x16x32_bf16 v[100:103], v[192:195], v[228:231], v[100:103]
  ds_read_b64_tr_b16 v[162:163], v20 offset:51200
  v_mfma_f32_16x16x32_bf16 v[108:111], v[196:199], v[228:231], v[108:111]
  buffer_load_dwordx4 v[92:95], off, s[64:67], s49 offset:1024 sc1
  v_mfma_f32_16x16x32_bf16 v[104:107], v[196:199], v[224:227], v[104:107]
  ds_read_b64_tr_b16 v[164:165], v21 offset:49152
  ds_read_b64_tr_b16 v[166:167], v21 offset:51200
  v_mfma_f32_16x16x32_bf16 v[112:115], v[200:203], v[224:227], v[112:115]
  ds_read_b64_tr_b16 v[168:169], v22 offset:49152
  v_mfma_f32_16x16x32_bf16 v[116:119], v[200:203], v[228:231], v[116:119]
  ds_read_b64_tr_b16 v[170:171], v22 offset:51200
  v_mfma_f32_16x16x32_bf16 v[124:127], v[204:207], v[228:231], v[124:127]
  ds_read_b64_tr_b16 v[172:173], v23 offset:49152
  v_mfma_f32_16x16x32_bf16 v[120:123], v[204:207], v[224:227], v[120:123]
  ds_read_b64_tr_b16 v[174:175], v23 offset:51200
  s_waitcnt lgkmcnt(8)
  v_mfma_f32_16x16x32_bf16 v[96:99], v[208:211], v[232:235], v[96:99]
  ds_read_b64_tr_b16 v[176:177], v20 offset:53248
  v_mfma_f32_16x16x32_bf16 v[100:103], v[208:211], v[236:239], v[100:103]
  ds_read_b64_tr_b16 v[178:179], v20 offset:55296
  v_mfma_f32_16x16x32_bf16 v[108:111], v[212:215], v[236:239], v[108:111]
  ds_read_b64_tr_b16 v[180:181], v21 offset:53248
  v_mfma_f32_16x16x32_bf16 v[104:107], v[212:215], v[232:235], v[104:107]
  ds_read_b64_tr_b16 v[182:183], v21 offset:55296
  v_mfma_f32_16x16x32_bf16 v[112:115], v[216:219], v[232:235], v[112:115]
  ds_read_b64_tr_b16 v[184:185], v22 offset:53248
  v_mfma_f32_16x16x32_bf16 v[116:119], v[216:219], v[236:239], v[116:119]
  ds_read_b64_tr_b16 v[186:187], v22 offset:55296
  v_readlane_b32 s50, v30, 22
  v_mfma_f32_16x16x32_bf16 v[124:127], v[220:223], v[236:239], v[124:127]
  ds_read_b64_tr_b16 v[188:189], v23 offset:53248
  v_mfma_f32_16x16x32_bf16 v[120:123], v[220:223], v[232:235], v[120:123]
  ds_read_b64_tr_b16 v[190:191], v23 offset:55296
  s_waitcnt vmcnt(18) lgkmcnt(8)
  v_mfma_f32_16x16x32_bf16 v[128:131], v[160:163], v[240:243], v[128:131]
  buffer_load_dwordx4 v[224:227], off, s[36:39], s50 offset:0 sc1
  v_mfma_f32_16x16x32_bf16 v[132:135], v[160:163], v[244:247], v[132:135]
  ds_read_b64_tr_b16 v[192:193], v20 offset:57344
  ds_read_b64_tr_b16 v[194:195], v20 offset:59392
  v_mfma_f32_16x16x32_bf16 v[140:143], v[164:167], v[244:247], v[140:143]
  ds_read_b64_tr_b16 v[196:197], v21 offset:57344
  v_mfma_f32_16x16x32_bf16 v[136:139], v[164:167], v[240:243], v[136:139]
  ds_read_b64_tr_b16 v[198:199], v21 offset:59392
  v_mfma_f32_16x16x32_bf16 v[144:147], v[168:171], v[240:243], v[144:147]
  ds_read_b64_tr_b16 v[200:201], v22 offset:57344
  v_mfma_f32_16x16x32_bf16 v[148:151], v[168:171], v[244:247], v[148:151]
  ds_read_b64_tr_b16 v[202:203], v22 offset:59392
  ds_read_b64_tr_b16 v[204:205], v23 offset:57344
  v_mfma_f32_16x16x32_bf16 v[156:159], v[172:175], v[244:247], v[156:159]
  buffer_load_dwordx4 v[228:231], off, s[64:67], s50 offset:0 sc1
  v_mfma_f32_16x16x32_bf16 v[152:155], v[172:175], v[240:243], v[152:155]
  ds_read_b64_tr_b16 v[206:207], v23 offset:59392
  s_waitcnt vmcnt(18) lgkmcnt(8)
  v_mfma_f32_16x16x32_bf16 v[128:131], v[176:179], v[248:251], v[128:131]
  ds_read_b64_tr_b16 v[208:209], v20 offset:61440
  v_mfma_f32_16x16x32_bf16 v[132:135], v[176:179], v[252:255], v[132:135]
  ds_read_b64_tr_b16 v[210:211], v20 offset:63488
  v_mfma_f32_16x16x32_bf16 v[140:143], v[180:183], v[252:255], v[140:143]
  ds_read_b64_tr_b16 v[212:213], v21 offset:61440
  v_mfma_f32_16x16x32_bf16 v[136:139], v[180:183], v[248:251], v[136:139]
  ds_read_b64_tr_b16 v[214:215], v21 offset:63488
  v_mfma_f32_16x16x32_bf16 v[144:147], v[184:187], v[248:251], v[144:147]
  buffer_load_dwordx4 v[232:235], off, s[36:39], s50 offset:1024 sc1
  v_mfma_f32_16x16x32_bf16 v[148:151], v[184:187], v[252:255], v[148:151]
  ds_read_b64_tr_b16 v[216:217], v22 offset:61440
  ds_read_b64_tr_b16 v[218:219], v22 offset:63488
  v_mfma_f32_16x16x32_bf16 v[156:159], v[188:191], v[252:255], v[156:159]
  ds_read_b64_tr_b16 v[220:221], v23 offset:61440
  v_mfma_f32_16x16x32_bf16 v[152:155], v[188:191], v[248:251], v[152:155]
  ds_read_b64_tr_b16 v[222:223], v23 offset:63488
  s_waitcnt vmcnt(17) lgkmcnt(8)
  v_mfma_f32_16x16x32_bf16 v[128:131], v[192:195], v[32:35], v[128:131]
  ds_read_b64_tr_b16 v[160:161], v26 offset:0
  v_mfma_f32_16x16x32_bf16 v[132:135], v[192:195], v[36:39], v[132:135]
  ds_read_b64_tr_b16 v[162:163], v26 offset:2048
  v_mfma_f32_16x16x32_bf16 v[140:143], v[196:199], v[36:39], v[140:143]
  buffer_load_dwordx4 v[236:239], off, s[64:67], s50 offset:1024 sc1
  v_mfma_f32_16x16x32_bf16 v[136:139], v[196:199], v[32:35], v[136:139]
  ds_read_b64_tr_b16 v[164:165], v27 offset:0
  ds_read_b64_tr_b16 v[166:167], v27 offset:2048
  v_mfma_f32_16x16x32_bf16 v[144:147], v[200:203], v[32:35], v[144:147]
  ds_read_b64_tr_b16 v[168:169], v28 offset:0
  v_mfma_f32_16x16x32_bf16 v[148:151], v[200:203], v[36:39], v[148:151]
  ds_read_b64_tr_b16 v[170:171], v28 offset:2048
  v_mfma_f32_16x16x32_bf16 v[156:159], v[204:207], v[36:39], v[156:159]
  ds_read_b64_tr_b16 v[172:173], v29 offset:0
  v_mfma_f32_16x16x32_bf16 v[152:155], v[204:207], v[32:35], v[152:155]
  ds_read_b64_tr_b16 v[174:175], v29 offset:2048
  s_waitcnt vmcnt(16) lgkmcnt(8)
  s_barrier
  v_mfma_f32_16x16x32_bf16 v[128:131], v[208:211], v[40:43], v[128:131]
  ds_read_b64_tr_b16 v[176:177], v26 offset:4096
  v_mfma_f32_16x16x32_bf16 v[132:135], v[208:211], v[44:47], v[132:135]
  ds_read_b64_tr_b16 v[178:179], v26 offset:6144
  v_mfma_f32_16x16x32_bf16 v[140:143], v[212:215], v[44:47], v[140:143]
  ds_read_b64_tr_b16 v[180:181], v27 offset:4096
  v_mfma_f32_16x16x32_bf16 v[136:139], v[212:215], v[40:43], v[136:139]
  ds_read_b64_tr_b16 v[182:183], v27 offset:6144
  v_mfma_f32_16x16x32_bf16 v[144:147], v[216:219], v[40:43], v[144:147]
  ds_read_b64_tr_b16 v[184:185], v28 offset:4096
  v_mfma_f32_16x16x32_bf16 v[148:151], v[216:219], v[44:47], v[148:151]
  ds_read_b64_tr_b16 v[186:187], v28 offset:6144
  v_mfma_f32_16x16x32_bf16 v[156:159], v[220:223], v[44:47], v[156:159]
  ds_read_b64_tr_b16 v[188:189], v29 offset:4096
  v_mfma_f32_16x16x32_bf16 v[152:155], v[220:223], v[40:43], v[152:155]
  ds_read_b64_tr_b16 v[190:191], v29 offset:6144
  s_waitcnt vmcnt(14) lgkmcnt(8)
  v_mfma_f32_16x16x32_bf16 v[128:131], v[160:163], v[48:51], v[128:131]
  ds_read_b64_tr_b16 v[192:193], v26 offset:8192
  v_mfma_f32_16x16x32_bf16 v[132:135], v[160:163], v[52:55], v[132:135]
  ds_read_b64_tr_b16 v[194:195], v26 offset:10240
  v_mfma_f32_16x16x32_bf16 v[140:143], v[164:167], v[52:55], v[140:143]
  ds_read_b64_tr_b16 v[196:197], v27 offset:8192
  v_mfma_f32_16x16x32_bf16 v[136:139], v[164:167], v[48:51], v[136:139]
  ds_read_b64_tr_b16 v[198:199], v27 offset:10240
  v_mfma_f32_16x16x32_bf16 v[144:147], v[168:171], v[48:51], v[144:147]
  ds_read_b64_tr_b16 v[200:201], v28 offset:8192
  v_mfma_f32_16x16x32_bf16 v[148:151], v[168:171], v[52:55], v[148:151]
  ds_read_b64_tr_b16 v[202:203], v28 offset:10240
  v_mfma_f32_16x16x32_bf16 v[156:159], v[172:175], v[52:55], v[156:159]
  ds_read_b64_tr_b16 v[204:205], v29 offset:8192
  v_mfma_f32_16x16x32_bf16 v[152:155], v[172:175], v[48:51], v[152:155]
  ds_read_b64_tr_b16 v[206:207], v29 offset:10240
  s_waitcnt vmcnt(12) lgkmcnt(8)
  v_mfma_f32_16x16x32_bf16 v[128:131], v[176:179], v[56:59], v[128:131]
  ds_read_b64_tr_b16 v[208:209], v26 offset:12288
  v_mfma_f32_16x16x32_bf16 v[132:135], v[176:179], v[60:63], v[132:135]
  ds_read_b64_tr_b16 v[210:211], v26 offset:14336
  v_mfma_f32_16x16x32_bf16 v[140:143], v[180:183], v[60:63], v[140:143]
  ds_read_b64_tr_b16 v[212:213], v27 offset:12288
  v_mfma_f32_16x16x32_bf16 v[136:139], v[180:183], v[56:59], v[136:139]
  ds_read_b64_tr_b16 v[214:215], v27 offset:14336
  v_mfma_f32_16x16x32_bf16 v[144:147], v[184:187], v[56:59], v[144:147]
  ds_read_b64_tr_b16 v[216:217], v28 offset:12288
  v_mfma_f32_16x16x32_bf16 v[148:151], v[184:187], v[60:63], v[148:151]
  ds_read_b64_tr_b16 v[218:219], v28 offset:14336
  v_mfma_f32_16x16x32_bf16 v[156:159], v[188:191], v[60:63], v[156:159]
  ds_read_b64_tr_b16 v[220:221], v29 offset:12288
  v_mfma_f32_16x16x32_bf16 v[152:155], v[188:191], v[56:59], v[152:155]
  ds_read_b64_tr_b16 v[222:223], v29 offset:14336
  s_waitcnt vmcnt(10) lgkmcnt(8)
  v_mfma_f32_16x16x32_bf16 v[128:131], v[192:195], v[64:67], v[128:131]
  ds_read_b64_tr_b16 v[160:161], v26 offset:16384
  v_mfma_f32_16x16x32_bf16 v[132:135], v[192:195], v[68:71], v[132:135]
  ds_read_b64_tr_b16 v[162:163], v26 offset:18432
  v_mfma_f32_16x16x32_bf16 v[140:143], v[196:199], v[68:71], v[140:143]
  ds_read_b64_tr_b16 v[164:165], v27 offset:16384
  v_mfma_f32_16x16x32_bf16 v[136:139], v[196:199], v[64:67], v[136:139]
  ds_read_b64_tr_b16 v[166:167], v27 offset:18432
  v_mfma_f32_16x16x32_bf16 v[144:147], v[200:203], v[64:67], v[144:147]
  ds_read_b64_tr_b16 v[168:169], v28 offset:16384
  v_mfma_f32_16x16x32_bf16 v[148:151], v[200:203], v[68:71], v[148:151]
  ds_read_b64_tr_b16 v[170:171], v28 offset:18432
  v_mfma_f32_16x16x32_bf16 v[156:159], v[204:207], v[68:71], v[156:159]
  ds_read_b64_tr_b16 v[172:173], v29 offset:16384
  v_mfma_f32_16x16x32_bf16 v[152:155], v[204:207], v[64:67], v[152:155]
  ds_read_b64_tr_b16 v[174:175], v29 offset:18432
  s_waitcnt vmcnt(8) lgkmcnt(8)
  v_mfma_f32_16x16x32_bf16 v[128:131], v[208:211], v[72:75], v[128:131]
  ds_read_b64_tr_b16 v[176:177], v26 offset:20480
  v_mfma_f32_16x16x32_bf16 v[132:135], v[208:211], v[76:79], v[132:135]
  ds_read_b64_tr_b16 v[178:179], v26 offset:22528
  v_mfma_f32_16x16x32_bf16 v[140:143], v[212:215], v[76:79], v[140:143]
  ds_read_b64_tr_b16 v[180:181], v27 offset:20480
  v_mfma_f32_16x16x32_bf16 v[136:139], v[212:215], v[72:75], v[136:139]
  ds_read_b64_tr_b16 v[182:183], v27 offset:22528
  v_mfma_f32_16x16x32_bf16 v[144:147], v[216:219], v[72:75], v[144:147]
  ds_read_b64_tr_b16 v[184:185], v28 offset:20480
  v_mfma_f32_16x16x32_bf16 v[148:151], v[216:219], v[76:79], v[148:151]
  ds_read_b64_tr_b16 v[186:187], v28 offset:22528
  v_mfma_f32_16x16x32_bf16 v[156:159], v[220:223], v[76:79], v[156:159]
  ds_read_b64_tr_b16 v[188:189], v29 offset:20480
  v_mfma_f32_16x16x32_bf16 v[152:155], v[220:223], v[72:75], v[152:155]
  ds_read_b64_tr_b16 v[190:191], v29 offset:22528
  s_waitcnt vmcnt(6) lgkmcnt(8)
  v_mfma_f32_16x16x32_bf16 v[128:131], v[160:163], v[80:83], v[128:131]
  ds_read_b64_tr_b16 v[192:193], v26 offset:24576
  v_mfma_f32_16x16x32_bf16 v[132:135], v[160:163], v[84:87], v[132:135]
  ds_read_b64_tr_b16 v[194:195], v26 offset:26624
  v_mfma_f32_16x16x32_bf16 v[140:143], v[164:167], v[84:87], v[140:143]
  ds_read_b64_tr_b16 v[196:197], v27 offset:24576
  v_mfma_f32_16x16x32_bf16 v[136:139], v[164:167], v[80:83], v[136:139]
  ds_read_b64_tr_b16 v[198:199], v27 offset:26624
  v_mfma_f32_16x16x32_bf16 v[144:147], v[168:171], v[80:83], v[144:147]
  ds_read_b64_tr_b16 v[200:201], v28 offset:24576
  v_mfma_f32_16x16x32_bf16 v[148:151], v[168:171], v[84:87], v[148:151]
  ds_read_b64_tr_b16 v[202:203], v28 offset:26624
  v_mfma_f32_16x16x32_bf16 v[156:159], v[172:175], v[84:87], v[156:159]
  ds_read_b64_tr_b16 v[204:205], v29 offset:24576
  v_mfma_f32_16x16x32_bf16 v[152:155], v[172:175], v[80:83], v[152:155]
  ds_read_b64_tr_b16 v[206:207], v29 offset:26624
  s_waitcnt vmcnt(4) lgkmcnt(8)
  v_mfma_f32_16x16x32_bf16 v[128:131], v[176:179], v[88:91], v[128:131]
  ds_read_b64_tr_b16 v[208:209], v26 offset:28672
  v_mfma_f32_16x16x32_bf16 v[132:135], v[176:179], v[92:95], v[132:135]
  ds_read_b64_tr_b16 v[210:211], v26 offset:30720
  v_mfma_f32_16x16x32_bf16 v[140:143], v[180:183], v[92:95], v[140:143]
  ds_read_b64_tr_b16 v[212:213], v27 offset:28672
  v_mfma_f32_16x16x32_bf16 v[136:139], v[180:183], v[88:91], v[136:139]
  ds_read_b64_tr_b16 v[214:215], v27 offset:30720
  v_mfma_f32_16x16x32_bf16 v[144:147], v[184:187], v[88:91], v[144:147]
  ds_read_b64_tr_b16 v[216:217], v28 offset:28672
  v_mfma_f32_16x16x32_bf16 v[148:151], v[184:187], v[92:95], v[148:151]
  ds_read_b64_tr_b16 v[218:219], v28 offset:30720
  v_mfma_f32_16x16x32_bf16 v[156:159], v[188:191], v[92:95], v[156:159]
  ds_read_b64_tr_b16 v[220:221], v29 offset:28672
  v_mfma_f32_16x16x32_bf16 v[152:155], v[188:191], v[88:91], v[152:155]
  ds_read_b64_tr_b16 v[222:223], v29 offset:30720
  s_waitcnt vmcnt(2) lgkmcnt(8)
  v_mfma_f32_16x16x32_bf16 v[128:131], v[192:195], v[224:227], v[128:131]
  ds_read_b64_tr_b16 v[160:161], v6 offset:0
  v_mfma_f32_16x16x32_bf16 v[132:135], v[192:195], v[228:231], v[132:135]
  ds_read_b64_tr_b16 v[162:163], v6 offset:2048
  v_mfma_f32_16x16x32_bf16 v[140:143], v[196:199], v[228:231], v[140:143]
  ds_read_b64_tr_b16 v[164:165], v7 offset:0
  v_mfma_f32_16x16x32_bf16 v[136:139], v[196:199], v[224:227], v[136:139]
  ds_read_b64_tr_b16 v[166:167], v7 offset:2048
  v_mfma_f32_16x16x32_bf16 v[144:147], v[200:203], v[224:227], v[144:147]
  ds_read_b64_tr_b16 v[168:169], v8 offset:0
  v_mfma_f32_16x16x32_bf16 v[148:151], v[200:203], v[228:231], v[148:151]
  ds_read_b64_tr_b16 v[170:171], v8 offset:2048
  v_mfma_f32_16x16x32_bf16 v[156:159], v[204:207], v[228:231], v[156:159]
  ds_read_b64_tr_b16 v[172:173], v9 offset:0
  v_mfma_f32_16x16x32_bf16 v[152:155], v[204:207], v[224:227], v[152:155]
  ds_read_b64_tr_b16 v[174:175], v9 offset:2048
  s_waitcnt vmcnt(0) lgkmcnt(8)
  s_barrier
  v_mfma_f32_16x16x32_bf16 v[128:131], v[208:211], v[232:235], v[128:131]
  ds_read_b64_tr_b16 v[176:177], v6 offset:4096
  v_mfma_f32_16x16x32_bf16 v[132:135], v[208:211], v[236:239], v[132:135]
  ds_read_b64_tr_b16 v[178:179], v6 offset:6144
  v_mfma_f32_16x16x32_bf16 v[140:143], v[212:215], v[236:239], v[140:143]
  ds_read_b64_tr_b16 v[180:181], v7 offset:4096
  v_mfma_f32_16x16x32_bf16 v[136:139], v[212:215], v[232:235], v[136:139]
  ds_read_b64_tr_b16 v[182:183], v7 offset:6144
  v_mfma_f32_16x16x32_bf16 v[144:147], v[216:219], v[232:235], v[144:147]
  ds_read_b64_tr_b16 v[184:185], v8 offset:4096
  v_mfma_f32_16x16x32_bf16 v[148:151], v[216:219], v[236:239], v[148:151]
  ds_read_b64_tr_b16 v[186:187], v8 offset:6144
  v_mfma_f32_16x16x32_bf16 v[156:159], v[220:223], v[236:239], v[156:159]
  ds_read_b64_tr_b16 v[188:189], v9 offset:4096
  v_mfma_f32_16x16x32_bf16 v[152:155], v[220:223], v[232:235], v[152:155]
  ds_read_b64_tr_b16 v[190:191], v9 offset:6144
  s_waitcnt lgkmcnt(8)
  v_mfma_f32_16x16x32_bf16 v[96:99], v[160:163], v[240:243], v[96:99]
  ds_read_b64_tr_b16 v[192:193], v6 offset:8192
  v_mfma_f32_16x16x32_bf16 v[100:103], v[160:163], v[244:247], v[100:103]
  ds_read_b64_tr_b16 v[194:195], v6 offset:10240
  v_mfma_f32_16x16x32_bf16 v[108:111], v[164:167], v[244:247], v[108:111]
  ds_read_b64_tr_b16 v[196:197], v7 offset:8192
  v_cvt_pk_bf16_f32 v128, v128, v129
  v_mfma_f32_16x16x32_bf16 v[104:107], v[164:167], v[240:243], v[104:107]
  ds_read_b64_tr_b16 v[198:199], v7 offset:10240
  v_cvt_pk_bf16_f32 v129, v130, v131
  v_mfma_f32_16x16x32_bf16 v[112:115], v[168:171], v[240:243], v[112:115]
  ds_read_b64_tr_b16 v[200:201], v8 offset:8192
  v_cvt_pk_bf16_f32 v130, v132, v133
  v_mfma_f32_16x16x32_bf16 v[116:119], v[168:171], v[244:247], v[116:119]
  ds_read_b64_tr_b16 v[202:203], v8 offset:10240
  v_cvt_pk_bf16_f32 v131, v134, v135
  v_mfma_f32_16x16x32_bf16 v[124:127], v[172:175], v[244:247], v[124:127]
  ds_read_b64_tr_b16 v[204:205], v9 offset:8192
  buffer_store_dwordx4 v[128:131], off, s[60:63], s4 offset:0 sc1
  v_mfma_f32_16x16x32_bf16 v[120:123], v[172:175], v[240:243], v[120:123]
  ds_read_b64_tr_b16 v[206:207], v9 offset:10240
  s_waitcnt lgkmcnt(8)
  v_mfma_f32_16x16x32_bf16 v[96:99], v[176:179], v[248:251], v[96:99]
  ds_read_b64_tr_b16 v[208:209], v6 offset:12288
  v_cvt_pk_bf16_f32 v132, v136, v137
  v_mfma_f32_16x16x32_bf16 v[100:103], v[176:179], v[252:255], v[100:103]
  ds_read_b64_tr_b16 v[210:211], v6 offset:14336
  v_cvt_pk_bf16_f32 v133, v138, v139
  v_mfma_f32_16x16x32_bf16 v[108:111], v[180:183], v[252:255], v[108:111]
  ds_read_b64_tr_b16 v[212:213], v7 offset:12288
  v_cvt_pk_bf16_f32 v134, v140, v141
  v_mfma_f32_16x16x32_bf16 v[104:107], v[180:183], v[248:251], v[104:107]
  ds_read_b64_tr_b16 v[214:215], v7 offset:14336
  v_cvt_pk_bf16_f32 v135, v142, v143
  v_mfma_f32_16x16x32_bf16 v[112:115], v[184:187], v[248:251], v[112:115]
  ds_read_b64_tr_b16 v[216:217], v8 offset:12288
  buffer_store_dwordx4 v[132:135], off, s[60:63], s4 offset:1024 sc1
  v_mfma_f32_16x16x32_bf16 v[116:119], v[184:187], v[252:255], v[116:119]
  ds_read_b64_tr_b16 v[218:219], v8 offset:14336
  v_readlane_b32 s51, v30, 23
  v_mfma_f32_16x16x32_bf16 v[124:127], v[188:191], v[252:255], v[124:127]
  ds_read_b64_tr_b16 v[220:221], v9 offset:12288
  v_cvt_pk_bf16_f32 v136, v144, v145
  v_mfma_f32_16x16x32_bf16 v[120:123], v[188:191], v[248:251], v[120:123]
  ds_read_b64_tr_b16 v[222:223], v9 offset:14336
  s_waitcnt lgkmcnt(8)
  v_mfma_f32_16x16x32_bf16 v[96:99], v[192:195], v[32:35], v[96:99]
  ds_read_b64_tr_b16 v[160:161], v6 offset:16384
  buffer_load_dwordx4 v[240:243], off, s[36:39], s51 offset:0 sc1
  v_mfma_f32_16x16x32_bf16 v[100:103], v[192:195], v[36:39], v[100:103]
  ds_read_b64_tr_b16 v[162:163], v6 offset:18432
  v_cvt_pk_bf16_f32 v137, v146, v147
  v_mfma_f32_16x16x32_bf16 v[108:111], v[196:199], v[36:39], v[108:111]
  ds_read_b64_tr_b16 v[164:165], v7 offset:16384
  v_cvt_pk_bf16_f32 v138, v148, v149
  v_mfma_f32_16x16x32_bf16 v[104:107], v[196:199], v[32:35], v[104:107]
  ds_read_b64_tr_b16 v[166:167], v7 offset:18432
  v_cvt_pk_bf16_f32 v139, v150, v151
  v_mfma_f32_16x16x32_bf16 v[112:115], v[200:203], v[32:35], v[112:115]
  ds_read_b64_tr_b16 v[168:169], v8 offset:16384
  buffer_load_dwordx4 v[244:247], off, s[64:67], s51 offset:0 sc1
  v_mfma_f32_16x16x32_bf16 v[116:119], v[200:203], v[36:39], v[116:119]
  ds_read_b64_tr_b16 v[170:171], v8 offset:18432
  buffer_store_dwordx4 v[136:139], off, s[60:63], s4 offset:2048 sc1
  v_mfma_f32_16x16x32_bf16 v[124:127], v[204:207], v[36:39], v[124:127]
  ds_read_b64_tr_b16 v[172:173], v9 offset:16384
  v_cvt_pk_bf16_f32 v140, v152, v153
  v_mfma_f32_16x16x32_bf16 v[120:123], v[204:207], v[32:35], v[120:123]
  ds_read_b64_tr_b16 v[174:175], v9 offset:18432
  s_waitcnt lgkmcnt(8)
  v_mfma_f32_16x16x32_bf16 v[96:99], v[208:211], v[40:43], v[96:99]
  ds_read_b64_tr_b16 v[176:177], v6 offset:20480
  buffer_load_dwordx4 v[248:251], off, s[36:39], s51 offset:1024 sc1
  v_mfma_f32_16x16x32_bf16 v[100:103], v[208:211], v[44:47], v[100:103]
  ds_read_b64_tr_b16 v[178:179], v6 offset:22528
  v_cvt_pk_bf16_f32 v141, v154, v155
  v_mfma_f32_16x16x32_bf16 v[108:111], v[212:215], v[44:47], v[108:111]
  ds_read_b64_tr_b16 v[180:181], v7 offset:20480
  v_cvt_pk_bf16_f32 v142, v156, v157
  v_mfma_f32_16x16x32_bf16 v[104:107], v[212:215], v[40:43], v[104:107]
  ds_read_b64_tr_b16 v[182:183], v7 offset:22528
  v_cvt_pk_bf16_f32 v143, v158, v159
  v_mfma_f32_16x16x32_bf16 v[112:115], v[216:219], v[40:43], v[112:115]
  ds_read_b64_tr_b16 v[184:185], v8 offset:20480
  buffer_load_dwordx4 v[252:255], off, s[64:67], s51 offset:1024 sc1
  v_mfma_f32_16x16x32_bf16 v[116:119], v[216:219], v[44:47], v[116:119]
  ds_read_b64_tr_b16 v[186:187], v8 offset:22528
  buffer_store_dwordx4 v[140:143], off, s[60:63], s4 offset:3072 sc1
  v_mfma_f32_16x16x32_bf16 v[124:127], v[220:223], v[44:47], v[124:127]
  ds_read_b64_tr_b16 v[188:189], v9 offset:20480
  v_readlane_b32 s48, v30, 24
  v_mfma_f32_16x16x32_bf16 v[120:123], v[220:223], v[40:43], v[120:123]
  ds_read_b64_tr_b16 v[190:191], v9 offset:22528
  s_waitcnt lgkmcnt(8)
  v_mfma_f32_16x16x32_bf16 v[96:99], v[160:163], v[48:51], v[96:99]
  ds_read_b64_tr_b16 v[192:193], v6 offset:24576
  v_mfma_f32_16x16x32_bf16 v[100:103], v[160:163], v[52:55], v[100:103]
  buffer_load_dwordx4 v[32:35], off, s[36:39], s48 offset:0 sc1
  v_mfma_f32_16x16x32_bf16 v[108:111], v[164:167], v[52:55], v[108:111]
  ds_read_b64_tr_b16 v[194:195], v6 offset:26624
  ds_read_b64_tr_b16 v[196:197], v7 offset:24576
  v_mfma_f32_16x16x32_bf16 v[104:107], v[164:167], v[48:51], v[104:107]
  ds_read_b64_tr_b16 v[198:199], v7 offset:26624
  v_mfma_f32_16x16x32_bf16 v[112:115], v[168:171], v[48:51], v[112:115]
  ds_read_b64_tr_b16 v[200:201], v8 offset:24576
  v_mfma_f32_16x16x32_bf16 v[116:119], v[168:171], v[52:55], v[116:119]
  buffer_load_dwordx4 v[36:39], off, s[64:67], s48 offset:0 sc1
  v_mfma_f32_16x16x32_bf16 v[124:127], v[172:175], v[52:55], v[124:127]
  ds_read_b64_tr_b16 v[202:203], v8 offset:26624
  ds_read_b64_tr_b16 v[204:205], v9 offset:24576
  v_mfma_f32_16x16x32_bf16 v[120:123], v[172:175], v[48:51], v[120:123]
  ds_read_b64_tr_b16 v[206:207], v9 offset:26624
  s_waitcnt lgkmcnt(8)
  v_mfma_f32_16x16x32_bf16 v[96:99], v[176:179], v[56:59], v[96:99]
  ds_read_b64_tr_b16 v[208:209], v6 offset:28672
  v_mfma_f32_16x16x32_bf16 v[100:103], v[176:179], v[60:63], v[100:103]
  buffer_load_dwordx4 v[40:43], off, s[36:39], s48 offset:1024 sc1
  v_mfma_f32_16x16x32_bf16 v[108:111], v[180:183], v[60:63], v[108:111]
  ds_read_b64_tr_b16 v[210:211], v6 offset:30720
  ds_read_b64_tr_b16 v[212:213], v7 offset:28672
  v_mfma_f32_16x16x32_bf16 v[104:107], v[180:183], v[56:59], v[104:107]
  ds_read_b64_tr_b16 v[214:215], v7 offset:30720
  v_mfma_f32_16x16x32_bf16 v[112:115], v[184:187], v[56:59], v[112:115]
  ds_read_b64_tr_b16 v[216:217], v8 offset:28672
  v_mfma_f32_16x16x32_bf16 v[116:119], v[184:187], v[60:63], v[116:119]
  buffer_load_dwordx4 v[44:47], off, s[64:67], s48 offset:1024 sc1
  v_mfma_f32_16x16x32_bf16 v[124:127], v[188:191], v[60:63], v[124:127]
  ds_read_b64_tr_b16 v[218:219], v8 offset:30720
  ds_read_b64_tr_b16 v[220:221], v9 offset:28672
  v_mfma_f32_16x16x32_bf16 v[120:123], v[188:191], v[56:59], v[120:123]
  ds_read_b64_tr_b16 v[222:223], v9 offset:30720
  s_waitcnt lgkmcnt(8)
  v_mfma_f32_16x16x32_bf16 v[96:99], v[192:195], v[64:67], v[96:99]
  ds_read_b64_tr_b16 v[160:161], v6 offset:32768
  v_readlane_b32 s49, v30, 25
  v_mfma_f32_16x16x32_bf16 v[100:103], v[192:195], v[68:71], v[100:103]
  ds_read_b64_tr_b16 v[162:163], v6 offset:34816
  v_mfma_f32_16x16x32_bf16 v[108:111], v[196:199], v[68:71], v[108:111]
  ds_read_b64_tr_b16 v[164:165], v7 offset:32768
  v_mfma_f32_16x16x32_bf16 v[104:107], v[196:199], v[64:67], v[104:107]
  buffer_load_dwordx4 v[48:51], off, s[36:39], s49 offset:0 sc1
  v_mfma_f32_16x16x32_bf16 v[112:115], v[200:203], v[64:67], v[112:115]
  ds_read_b64_tr_b16 v[166:167], v7 offset:34816
  ds_read_b64_tr_b16 v[168:169], v8 offset:32768
  v_mfma_f32_16x16x32_bf16 v[116:119], v[200:203], v[68:71], v[116:119]
  ds_read_b64_tr_b16 v[170:171], v8 offset:34816
  v_mfma_f32_16x16x32_bf16 v[124:127], v[204:207], v[68:71], v[124:127]
  ds_read_b64_tr_b16 v[172:173], v9 offset:32768
  v_mfma_f32_16x16x32_bf16 v[120:123], v[204:207], v[64:67], v[120:123]
  ds_read_b64_tr_b16 v[174:175], v9 offset:34816
  s_waitcnt lgkmcnt(8)
  s_barrier
  v_mfma_f32_16x16x32_bf16 v[96:99], v[208:211], v[72:75], v[96:99]
  buffer_load_dwordx4 v[52:55], off, s[64:67], s49 offset:0 sc1
  v_mfma_f32_16x16x32_bf16 v[100:103], v[208:211], v[76:79], v[100:103]
  ds_read_b64_tr_b16 v[176:177], v6 offset:36864
  ds_read_b64_tr_b16 v[178:179], v6 offset:38912
  v_mfma_f32_16x16x32_bf16 v[108:111], v[212:215], v[76:79], v[108:111]
  ds_read_b64_tr_b16 v[180:181], v7 offset:36864
  v_mfma_f32_16x16x32_bf16 v[104:107], v[212:215], v[72:75], v[104:107]
  ds_read_b64_tr_b16 v[182:183], v7 offset:38912
  v_mfma_f32_16x16x32_bf16 v[112:115], v[216:219], v[72:75], v[112:115]
  buffer_load_dwordx4 v[56:59], off, s[36:39], s49 offset:1024 sc1
  v_mfma_f32_16x16x32_bf16 v[116:119], v[216:219], v[76:79], v[116:119]
  ds_read_b64_tr_b16 v[184:185], v8 offset:36864
  ds_read_b64_tr_b16 v[186:187], v8 offset:38912
  v_mfma_f32_16x16x32_bf16 v[124:127], v[220:223], v[76:79], v[124:127]
  ds_read_b64_tr_b16 v[188:189], v9 offset:36864
  v_mfma_f32_16x16x32_bf16 v[120:123], v[220:223], v[72:75], v[120:123]
  ds_read_b64_tr_b16 v[190:191], v9 offset:38912
  s_waitcnt lgkmcnt(8)
  v_mfma_f32_16x16x32_bf16 v[96:99], v[160:163], v[80:83], v[96:99]
  ds_read_b64_tr_b16 v[192:193], v6 offset:40960
  buffer_load_dwordx4 v[60:63], off, s[64:67], s49 offset:1024 sc1
  v_mfma_f32_16x16x32_bf16 v[100:103], v[160:163], v[84:87], v[100:103]
  ds_read_b64_tr_b16 v[194:195], v6 offset:43008
  s_waitcnt vmcnt(8)
  v_mfma_f32_16x16x32_bf16 v[108:111], v[164:167], v[84:87], v[108:111]
  ds_read_b64_tr_b16 v[196:197], v7 offset:40960
  v_readlane_b32 s50, v30, 26
  v_mfma_f32_16x16x32_bf16 v[104:107], v[164:167], v[80:83], v[104:107]
  buffer_store_dword v19, off, s[52:55], s6 sc1
  v_mfma_f32_16x16x32_bf16 v[112:115], v[168:171], v[80:83], v[112:115]
  ds_read_b64_tr_b16 v[198:199], v7 offset:43008
  ds_read_b64_tr_b16 v[200:201], v8 offset:40960
  v_mfma_f32_16x16x32_bf16 v[116:119], v[168:171], v[84:87], v[116:119]
  buffer_load_dwordx4 v[64:67], off, s[36:39], s50 offset:0 sc1
  v_mfma_f32_16x16x32_bf16 v[124:127], v[172:175], v[84:87], v[124:127]
  ds_read_b64_tr_b16 v[202:203], v8 offset:43008
  ds_read_b64_tr_b16 v[204:205], v9 offset:40960
  v_mfma_f32_16x16x32_bf16 v[120:123], v[172:175], v[80:83], v[120:123]
  ds_read_b64_tr_b16 v[206:207], v9 offset:43008
  s_waitcnt lgkmcnt(8)
  v_mfma_f32_16x16x32_bf16 v[96:99], v[176:179], v[88:91], v[96:99]
  ds_read_b64_tr_b16 v[208:209], v6 offset:45056
  v_mfma_f32_16x16x32_bf16 v[100:103], v[176:179], v[92:95], v[100:103]
  buffer_load_dwordx4 v[68:71], off, s[64:67], s50 offset:0 sc1
  v_mfma_f32_16x16x32_bf16 v[108:111], v[180:183], v[92:95], v[108:111]
  ds_read_b64_tr_b16 v[210:211], v6 offset:47104
  ds_read_b64_tr_b16 v[212:213], v7 offset:45056
  v_mfma_f32_16x16x32_bf16 v[104:107], v[180:183], v[88:91], v[104:107]
  ds_read_b64_tr_b16 v[214:215], v7 offset:47104
  v_mfma_f32_16x16x32_bf16 v[112:115], v[184:187], v[88:91], v[112:115]
  ds_read_b64_tr_b16 v[216:217], v8 offset:45056
  v_mfma_f32_16x16x32_bf16 v[116:119], v[184:187], v[92:95], v[116:119]
  buffer_load_dwordx4 v[72:75], off, s[36:39], s50 offset:1024 sc1
  v_mfma_f32_16x16x32_bf16 v[124:127], v[188:191], v[92:95], v[124:127]
  ds_read_b64_tr_b16 v[218:219], v8 offset:47104
  ds_read_b64_tr_b16 v[220:221], v9 offset:45056
  v_mfma_f32_16x16x32_bf16 v[120:123], v[188:191], v[88:91], v[120:123]
  ds_read_b64_tr_b16 v[222:223], v9 offset:47104
  s_waitcnt lgkmcnt(8)
  v_mfma_f32_16x16x32_bf16 v[96:99], v[192:195], v[224:227], v[96:99]
  ds_read_b64_tr_b16 v[160:161], v6 offset:49152
  v_mfma_f32_16x16x32_bf16 v[100:103], v[192:195], v[228:231], v[100:103]
  buffer_load_dwordx4 v[76:79], off, s[64:67], s50 offset:1024 sc1
  v_mfma_f32_16x16x32_bf16 v[108:111], v[196:199], v[228:231], v[108:111]
  ds_read_b64_tr_b16 v[162:163], v6 offset:51200
  ds_read_b64_tr_b16 v[164:165], v7 offset:49152
  v_mfma_f32_16x16x32_bf16 v[104:107], v[196:199], v[224:227], v[104:107]
  ds_read_b64_tr_b16 v[166:167], v7 offset:51200
  v_readlane_b32 s51, v30, 27
  v_mfma_f32_16x16x32_bf16 v[112:115], v[200:203], v[224:227], v[112:115]
  ds_read_b64_tr_b16 v[168:169], v8 offset:49152
  v_mfma_f32_16x16x32_bf16 v[116:119], v[200:203], v[228:231], v[116:119]
  ds_read_b64_tr_b16 v[170:171], v8 offset:51200
  ds_read_b64_tr_b16 v[172:173], v9 offset:49152
  v_mfma_f32_16x16x32_bf16 v[124:127], v[204:207], v[228:231], v[124:127]
  buffer_load_dwordx4 v[80:83], off, s[36:39], s51 offset:0 sc1
  v_mfma_f32_16x16x32_bf16 v[120:123], v[204:207], v[224:227], v[120:123]
  ds_read_b64_tr_b16 v[174:175], v9 offset:51200
  s_waitcnt lgkmcnt(8)
  v_mfma_f32_16x16x32_bf16 v[96:99], v[208:211], v[232:235], v[96:99]
  ds_read_b64_tr_b16 v[176:177], v6 offset:53248
  v_mfma_f32_16x16x32_bf16 v[100:103], v[208:211], v[236:239], v[100:103]
  ds_read_b64_tr_b16 v[178:179], v6 offset:55296
  v_mfma_f32_16x16x32_bf16 v[108:111], v[212:215], v[236:239], v[108:111]
  buffer_load_dwordx4 v[84:87], off, s[64:67], s51 offset:0 sc1
  v_mfma_f32_16x16x32_bf16 v[104:107], v[212:215], v[232:235], v[104:107]
  ds_read_b64_tr_b16 v[180:181], v7 offset:53248
  ds_read_b64_tr_b16 v[182:183], v7 offset:55296
  v_mfma_f32_16x16x32_bf16 v[112:115], v[216:219], v[232:235], v[112:115]
  ds_read_b64_tr_b16 v[184:185], v8 offset:53248
  v_mfma_f32_16x16x32_bf16 v[116:119], v[216:219], v[236:239], v[116:119]
  ds_read_b64_tr_b16 v[186:187], v8 offset:55296
  ds_read_b64_tr_b16 v[188:189], v9 offset:53248
  v_mfma_f32_16x16x32_bf16 v[124:127], v[220:223], v[236:239], v[124:127]
  buffer_load_dwordx4 v[88:91], off, s[36:39], s51 offset:1024 sc1
  v_mfma_f32_16x16x32_bf16 v[120:123], v[220:223], v[232:235], v[120:123]
  ds_read_b64_tr_b16 v[190:191], v9 offset:55296
  s_waitcnt lgkmcnt(8)
  v_mfma_f32_16x16x32_bf16 v[96:99], v[160:163], v[240:243], v[96:99]
  ds_read_b64_tr_b16 v[192:193], v6 offset:57344
  v_mfma_f32_16x16x32_bf16 v[100:103], v[160:163], v[244:247], v[100:103]
  ds_read_b64_tr_b16 v[194:195], v6 offset:59392
  v_mfma_f32_16x16x32_bf16 v[108:111], v[164:167], v[244:247], v[108:111]
  buffer_load_dwordx4 v[92:95], off, s[64:67], s51 offset:1024 sc1
  v_mfma_f32_16x16x32_bf16 v[104:107], v[164:167], v[240:243], v[104:107]
  ds_read_b64_tr_b16 v[196:197], v7 offset:57344
  ds_read_b64_tr_b16 v[198:199], v7 offset:59392
  v_mfma_f32_16x16x32_bf16 v[112:115], v[168:171], v[240:243], v[112:115]
  ds_read_b64_tr_b16 v[200:201], v8 offset:57344
  v_readlane_b32 s48, v30, 28
  v_mfma_f32_16x16x32_bf16 v[116:119], v[168:171], v[244:247], v[116:119]
  ds_read_b64_tr_b16 v[202:203], v8 offset:59392
  v_mfma_f32_16x16x32_bf16 v[124:127], v[172:175], v[244:247], v[124:127]
  ds_read_b64_tr_b16 v[204:205], v9 offset:57344
  v_mfma_f32_16x16x32_bf16 v[120:123], v[172:175], v[240:243], v[120:123]
  ds_read_b64_tr_b16 v[206:207], v9 offset:59392
  s_waitcnt lgkmcnt(8)
  v_mfma_f32_16x16x32_bf16 v[96:99], v[176:179], v[248:251], v[96:99]
  buffer_load_dwordx4 v[224:227], off, s[36:39], s48 offset:0 sc1
  v_mfma_f32_16x16x32_bf16 v[100:103], v[176:179], v[252:255], v[100:103]
  ds_read_b64_tr_b16 v[208:209], v6 offset:61440
  ds_read_b64_tr_b16 v[210:211], v6 offset:63488
  v_mfma_f32_16x16x32_bf16 v[108:111], v[180:183], v[252:255], v[108:111]
  ds_read_b64_tr_b16 v[212:213], v7 offset:61440
  v_mfma_f32_16x16x32_bf16 v[104:107], v[180:183], v[248:251], v[104:107]
  ds_read_b64_tr_b16 v[214:215], v7 offset:63488
  v_mfma_f32_16x16x32_bf16 v[112:115], v[184:187], v[248:251], v[112:115]
  buffer_load_dwordx4 v[228:231], off, s[64:67], s48 offset:0 sc1
  v_mfma_f32_16x16x32_bf16 v[116:119], v[184:187], v[252:255], v[116:119]
  ds_read_b64_tr_b16 v[216:217], v8 offset:61440
  ds_read_b64_tr_b16 v[218:219], v8 offset:63488
  v_mfma_f32_16x16x32_bf16 v[124:127], v[188:191], v[252:255], v[124:127]
  ds_read_b64_tr_b16 v[220:221], v9 offset:61440
  v_mfma_f32_16x16x32_bf16 v[120:123], v[188:191], v[248:251], v[120:123]
  ds_read_b64_tr_b16 v[222:223], v9 offset:63488
  s_waitcnt vmcnt(17) lgkmcnt(8)
  v_mfma_f32_16x16x32_bf16 v[96:99], v[192:195], v[32:35], v[96:99]
  buffer_load_dwordx4 v[232:235], off, s[36:39], s48 offset:1024 sc1
  v_mfma_f32_16x16x32_bf16 v[100:103], v[192:195], v[36:39], v[100:103]
  ds_read_b64_tr_b16 v[160:161], v20 offset:0
  ds_read_b64_tr_b16 v[162:163], v20 offset:2048
  v_mfma_f32_16x16x32_bf16 v[108:111], v[196:199], v[36:39], v[108:111]
  ds_read_b64_tr_b16 v[164:165], v21 offset:0
  v_mfma_f32_16x16x32_bf16 v[104:107], v[196:199], v[32:35], v[104:107]
  ds_read_b64_tr_b16 v[166:167], v21 offset:2048
  v_mfma_f32_16x16x32_bf16 v[112:115], v[200:203], v[32:35], v[112:115]
  buffer_load_dwordx4 v[236:239], off, s[64:67], s48 offset:1024 sc1
  v_mfma_f32_16x16x32_bf16 v[116:119], v[200:203], v[36:39], v[116:119]
  ds_read_b64_tr_b16 v[168:169], v22 offset:0
  ds_read_b64_tr_b16 v[170:171], v22 offset:2048
  v_mfma_f32_16x16x32_bf16 v[124:127], v[204:207], v[36:39], v[124:127]
  ds_read_b64_tr_b16 v[172:173], v23 offset:0
  v_readlane_b32 s49, v30, 29
  v_mfma_f32_16x16x32_bf16 v[120:123], v[204:207], v[32:35], v[120:123]
  ds_read_b64_tr_b16 v[174:175], v23 offset:2048
  s_waitcnt vmcnt(17) lgkmcnt(8)
  v_mfma_f32_16x16x32_bf16 v[96:99], v[208:211], v[40:43], v[96:99]
  ds_read_b64_tr_b16 v[176:177], v20 offset:4096
  v_mfma_f32_16x16x32_bf16 v[100:103], v[208:211], v[44:47], v[100:103]
  buffer_load_dwordx4 v[240:243], off, s[36:39], s49 offset:0 sc1
  v_mfma_f32_16x16x32_bf16 v[108:111], v[212:215], v[44:47], v[108:111]
  ds_read_b64_tr_b16 v[178:179], v20 offset:6144
  ds_read_b64_tr_b16 v[180:181], v21 offset:4096
  v_mfma_f32_16x16x32_bf16 v[104:107], v[212:215], v[40:43], v[104:107]
  ds_read_b64_tr_b16 v[182:183], v21 offset:6144
  v_mfma_f32_16x16x32_bf16 v[112:115], v[216:219], v[40:43], v[112:115]
  ds_read_b64_tr_b16 v[184:185], v22 offset:4096
  v_mfma_f32_16x16x32_bf16 v[116:119], v[216:219], v[44:47], v[116:119]
  buffer_load_dwordx4 v[244:247], off, s[64:67], s49 offset:0 sc1
  v_mfma_f32_16x16x32_bf16 v[124:127], v[220:223], v[44:47], v[124:127]
  ds_read_b64_tr_b16 v[186:187], v22 offset:6144
  ds_read_b64_tr_b16 v[188:189], v23 offset:4096
  v_mfma_f32_16x16x32_bf16 v[120:123], v[220:223], v[40:43], v[120:123]
  ds_read_b64_tr_b16 v[190:191], v23 offset:6144
  s_waitcnt vmcnt(17) lgkmcnt(8)
  v_mfma_f32_16x16x32_bf16 v[96:99], v[160:163], v[48:51], v[96:99]
  ds_read_b64_tr_b16 v[192:193], v20 offset:8192
  v_mfma_f32_16x16x32_bf16 v[100:103], v[160:163], v[52:55], v[100:103]
  buffer_load_dwordx4 v[248:251], off, s[36:39], s49 offset:1024 sc1
  v_mfma_f32_16x16x32_bf16 v[108:111], v[164:167], v[52:55], v[108:111]
  ds_read_b64_tr_b16 v[194:195], v20 offset:10240
  ds_read_b64_tr_b16 v[196:197], v21 offset:8192
  v_mfma_f32_16x16x32_bf16 v[104:107], v[164:167], v[48:51], v[104:107]
  ds_read_b64_tr_b16 v[198:199], v21 offset:10240
  v_mfma_f32_16x16x32_bf16 v[112:115], v[168:171], v[48:51], v[112:115]
  ds_read_b64_tr_b16 v[200:201], v22 offset:8192
  v_mfma_f32_16x16x32_bf16 v[116:119], v[168:171], v[52:55], v[116:119]
  buffer_load_dwordx4 v[252:255], off, s[64:67], s49 offset:1024 sc1
  v_mfma_f32_16x16x32_bf16 v[124:127], v[172:175], v[52:55], v[124:127]
  ds_read_b64_tr_b16 v[202:203], v22 offset:10240
  ds_read_b64_tr_b16 v[204:205], v23 offset:8192
  v_mfma_f32_16x16x32_bf16 v[120:123], v[172:175], v[48:51], v[120:123]
  ds_read_b64_tr_b16 v[206:207], v23 offset:10240
  s_waitcnt vmcnt(17) lgkmcnt(8)
  v_mfma_f32_16x16x32_bf16 v[96:99], v[176:179], v[56:59], v[96:99]
  ds_read_b64_tr_b16 v[208:209], v20 offset:12288
  v_readlane_b32 s50, v30, 30
  v_mfma_f32_16x16x32_bf16 v[100:103], v[176:179], v[60:63], v[100:103]
  ds_read_b64_tr_b16 v[210:211], v20 offset:14336
  v_mfma_f32_16x16x32_bf16 v[108:111], v[180:183], v[60:63], v[108:111]
  ds_read_b64_tr_b16 v[212:213], v21 offset:12288
  v_mfma_f32_16x16x32_bf16 v[104:107], v[180:183], v[56:59], v[104:107]
  buffer_load_dwordx4 v[32:35], off, s[36:39], s50 offset:0 sc1
  v_mfma_f32_16x16x32_bf16 v[112:115], v[184:187], v[56:59], v[112:115]
  ds_read_b64_tr_b16 v[214:215], v21 offset:14336
  ds_read_b64_tr_b16 v[216:217], v22 offset:12288
  v_mfma_f32_16x16x32_bf16 v[116:119], v[184:187], v[60:63], v[116:119]
  ds_read_b64_tr_b16 v[218:219], v22 offset:14336
  v_mfma_f32_16x16x32_bf16 v[124:127], v[188:191], v[60:63], v[124:127]
  ds_read_b64_tr_b16 v[220:221], v23 offset:12288
  v_mfma_f32_16x16x32_bf16 v[120:123], v[188:191], v[56:59], v[120:123]
  ds_read_b64_tr_b16 v[222:223], v23 offset:14336
  s_waitcnt vmcnt(15) lgkmcnt(8)
  v_mfma_f32_16x16x32_bf16 v[96:99], v[192:195], v[64:67], v[96:99]
  buffer_load_dwordx4 v[36:39], off, s[64:67], s50 offset:0 sc1
  v_mfma_f32_16x16x32_bf16 v[100:103], v[192:195], v[68:71], v[100:103]
  ds_read_b64_tr_b16 v[160:161], v20 offset:16384
  ds_read_b64_tr_b16 v[162:163], v20 offset:18432
  v_mfma_f32_16x16x32_bf16 v[108:111], v[196:199], v[68:71], v[108:111]
  ds_read_b64_tr_b16 v[164:165], v21 offset:16384
  v_mfma_f32_16x16x32_bf16 v[104:107], v[196:199], v[64:67], v[104:107]
  ds_read_b64_tr_b16 v[166:167], v21 offset:18432
  v_mfma_f32_16x16x32_bf16 v[112:115], v[200:203], v[64:67], v[112:115]
  buffer_load_dwordx4 v[40:43], off, s[36:39], s50 offset:1024 sc1
  v_mfma_f32_16x16x32_bf16 v[116:119], v[200:203], v[68:71], v[116:119]
  ds_read_b64_tr_b16 v[168:169], v22 offset:16384
  ds_read_b64_tr_b16 v[170:171], v22 offset:18432
  v_mfma_f32_16x16x32_bf16 v[124:127], v[204:207], v[68:71], v[124:127]
  ds_read_b64_tr_b16 v[172:173], v23 offset:16384
  v_mfma_f32_16x16x32_bf16 v[120:123], v[204:207], v[64:67], v[120:123]
  ds_read_b64_tr_b16 v[174:175], v23 offset:18432
  s_waitcnt vmcnt(15) lgkmcnt(8)
  v_mfma_f32_16x16x32_bf16 v[96:99], v[208:211], v[72:75], v[96:99]
  buffer_load_dwordx4 v[44:47], off, s[64:67], s50 offset:1024 sc1
  v_mfma_f32_16x16x32_bf16 v[100:103], v[208:211], v[76:79], v[100:103]
  ds_read_b64_tr_b16 v[176:177], v20 offset:20480
  ds_read_b64_tr_b16 v[178:179], v20 offset:22528
  v_mfma_f32_16x16x32_bf16 v[108:111], v[212:215], v[76:79], v[108:111]
  ds_read_b64_tr_b16 v[180:181], v21 offset:20480
  v_readlane_b32 s51, v30, 31
  v_mfma_f32_16x16x32_bf16 v[104:107], v[212:215], v[72:75], v[104:107]
  ds_read_b64_tr_b16 v[182:183], v21 offset:22528
  v_mfma_f32_16x16x32_bf16 v[112:115], v[216:219], v[72:75], v[112:115]
  ds_read_b64_tr_b16 v[184:185], v22 offset:20480
  v_mfma_f32_16x16x32_bf16 v[116:119], v[216:219], v[76:79], v[116:119]
  buffer_load_dwordx4 v[48:51], off, s[36:39], s51 offset:0 sc1
  v_mfma_f32_16x16x32_bf16 v[124:127], v[220:223], v[76:79], v[124:127]
  ds_read_b64_tr_b16 v[186:187], v22 offset:22528
  ds_read_b64_tr_b16 v[188:189], v23 offset:20480
  v_mfma_f32_16x16x32_bf16 v[120:123], v[220:223], v[72:75], v[120:123]
  ds_read_b64_tr_b16 v[190:191], v23 offset:22528
  s_waitcnt vmcnt(15) lgkmcnt(8)
  v_mfma_f32_16x16x32_bf16 v[96:99], v[160:163], v[80:83], v[96:99]
  ds_read_b64_tr_b16 v[192:193], v20 offset:24576
  v_mfma_f32_16x16x32_bf16 v[100:103], v[160:163], v[84:87], v[100:103]
  buffer_load_dwordx4 v[52:55], off, s[64:67], s51 offset:0 sc1
  v_mfma_f32_16x16x32_bf16 v[108:111], v[164:167], v[84:87], v[108:111]
  ds_read_b64_tr_b16 v[194:195], v20 offset:26624
  ds_read_b64_tr_b16 v[196:197], v21 offset:24576
  v_mfma_f32_16x16x32_bf16 v[104:107], v[164:167], v[80:83], v[104:107]
  ds_read_b64_tr_b16 v[198:199], v21 offset:26624
  v_mfma_f32_16x16x32_bf16 v[112:115], v[168:171], v[80:83], v[112:115]
  ds_read_b64_tr_b16 v[200:201], v22 offset:24576
  v_mfma_f32_16x16x32_bf16 v[116:119], v[168:171], v[84:87], v[116:119]
  buffer_load_dwordx4 v[56:59], off, s[36:39], s51 offset:1024 sc1
  v_mfma_f32_16x16x32_bf16 v[124:127], v[172:175], v[84:87], v[124:127]
  ds_read_b64_tr_b16 v[202:203], v22 offset:26624
  ds_read_b64_tr_b16 v[204:205], v23 offset:24576
  v_mfma_f32_16x16x32_bf16 v[120:123], v[172:175], v[80:83], v[120:123]
  ds_read_b64_tr_b16 v[206:207], v23 offset:26624
  s_waitcnt vmcnt(15) lgkmcnt(8)
  s_barrier
  v_mfma_f32_16x16x32_bf16 v[96:99], v[176:179], v[88:91], v[96:99]
  ds_read_b64_tr_b16 v[208:209], v20 offset:28672
  buffer_load_dwordx4 v[144:147], off, s[60:63], s5 offset:0 sc1
  v_mfma_f32_16x16x32_bf16 v[100:103], v[176:179], v[92:95], v[100:103]
  ds_read_b64_tr_b16 v[210:211], v20 offset:30720
  buffer_load_dwordx4 v[60:63], off, s[64:67], s51 offset:1024 sc1
  v_mfma_f32_16x16x32_bf16 v[108:111], v[180:183], v[92:95], v[108:111]
  ds_read_b64_tr_b16 v[212:213], v21 offset:28672
  buffer_load_dwordx4 v[148:151], off, s[60:63], s5 offset:1024 sc1
  v_mfma_f32_16x16x32_bf16 v[104:107], v[180:183], v[88:91], v[104:107]
  ds_read_b64_tr_b16 v[214:215], v21 offset:30720
  v_readlane_b32 s48, v30, 32
  v_mfma_f32_16x16x32_bf16 v[112:115], v[184:187], v[88:91], v[112:115]
  buffer_load_dwordx4 v[152:155], off, s[60:63], s5 offset:2048 sc1
  v_mfma_f32_16x16x32_bf16 v[116:119], v[184:187], v[92:95], v[116:119]
  ds_read_b64_tr_b16 v[216:217], v22 offset:28672
  ds_read_b64_tr_b16 v[218:219], v22 offset:30720
  v_mfma_f32_16x16x32_bf16 v[124:127], v[188:191], v[92:95], v[124:127]
  ds_read_b64_tr_b16 v[220:221], v23 offset:28672
  buffer_load_dwordx4 v[64:67], off, s[36:39], s48 offset:0 sc1
  v_mfma_f32_16x16x32_bf16 v[120:123], v[188:191], v[88:91], v[120:123]
  ds_read_b64_tr_b16 v[222:223], v23 offset:30720
  s_waitcnt vmcnt(18) lgkmcnt(8)
  v_mfma_f32_16x16x32_bf16 v[96:99], v[192:195], v[224:227], v[96:99]
  buffer_load_dwordx4 v[156:159], off, s[60:63], s5 offset:3072 sc1
  v_mfma_f32_16x16x32_bf16 v[100:103], v[192:195], v[228:231], v[100:103]
  ds_read_b64_tr_b16 v[160:161], v20 offset:32768
  ds_read_b64_tr_b16 v[162:163], v20 offset:34816
  v_mfma_f32_16x16x32_bf16 v[108:111], v[196:199], v[228:231], v[108:111]
  buffer_load_dwordx4 v[68:71], off, s[64:67], s48 offset:0 sc1
  v_mfma_f32_16x16x32_bf16 v[104:107], v[196:199], v[224:227], v[104:107]
  ds_read_b64_tr_b16 v[164:165], v21 offset:32768
  ds_read_b64_tr_b16 v[166:167], v21 offset:34816
  v_mfma_f32_16x16x32_bf16 v[112:115], v[200:203], v[224:227], v[112:115]
  ds_read_b64_tr_b16 v[168:169], v22 offset:32768
  v_mfma_f32_16x16x32_bf16 v[116:119], v[200:203], v[228:231], v[116:119]
  ds_read_b64_tr_b16 v[170:171], v22 offset:34816
  ds_read_b64_tr_b16 v[172:173], v23 offset:32768
  v_mfma_f32_16x16x32_bf16 v[124:127], v[204:207], v[228:231], v[124:127]
  buffer_load_dwordx4 v[72:75], off, s[36:39], s48 offset:1024 sc1
  v_mfma_f32_16x16x32_bf16 v[120:123], v[204:207], v[224:227], v[120:123]
  ds_read_b64_tr_b16 v[174:175], v23 offset:34816
  s_waitcnt vmcnt(19) lgkmcnt(8)
  v_mfma_f32_16x16x32_bf16 v[96:99], v[208:211], v[232:235], v[96:99]
  ds_read_b64_tr_b16 v[176:177], v20 offset:36864
  v_mfma_f32_16x16x32_bf16 v[100:103], v[208:211], v[236:239], v[100:103]
  ds_read_b64_tr_b16 v[178:179], v20 offset:38912
  v_mfma_f32_16x16x32_bf16 v[108:111], v[212:215], v[236:239], v[108:111]
  buffer_load_dwordx4 v[76:79], off, s[64:67], s48 offset:1024 sc1
  v_mfma_f32_16x16x32_bf16 v[104:107], v[212:215], v[232:235], v[104:107]
  ds_read_b64_tr_b16 v[180:181], v21 offset:36864
  ds_read_b64_tr_b16 v[182:183], v21 offset:38912
  v_mfma_f32_16x16x32_bf16 v[112:115], v[216:219], v[232:235], v[112:115]
  ds_read_b64_tr_b16 v[184:185], v22 offset:36864
  v_mfma_f32_16x16x32_bf16 v[116:119], v[216:219], v[236:239], v[116:119]
  ds_read_b64_tr_b16 v[186:187], v22 offset:38912
  v_mfma_f32_16x16x32_bf16 v[124:127], v[220:223], v[236:239], v[124:127]
  ds_read_b64_tr_b16 v[188:189], v23 offset:36864
  v_mfma_f32_16x16x32_bf16 v[120:123], v[220:223], v[232:235], v[120:123]
  ds_read_b64_tr_b16 v[190:191], v23 offset:38912
  s_waitcnt vmcnt(18) lgkmcnt(8)
  v_mfma_f32_16x16x32_bf16 v[96:99], v[160:163], v[240:243], v[96:99]
  ds_read_b64_tr_b16 v[192:193], v20 offset:40960
  v_mfma_f32_16x16x32_bf16 v[100:103], v[160:163], v[244:247], v[100:103]
  ds_read_b64_tr_b16 v[194:195], v20 offset:43008
  v_mfma_f32_16x16x32_bf16 v[108:111], v[164:167], v[244:247], v[108:111]
  ds_read_b64_tr_b16 v[196:197], v21 offset:40960
  v_mfma_f32_16x16x32_bf16 v[104:107], v[164:167], v[240:243], v[104:107]
  ds_read_b64_tr_b16 v[198:199], v21 offset:43008
  v_mfma_f32_16x16x32_bf16 v[112:115], v[168:171], v[240:243], v[112:115]
  ds_read_b64_tr_b16 v[200:201], v22 offset:40960
  v_mfma_f32_16x16x32_bf16 v[116:119], v[168:171], v[244:247], v[116:119]
  ds_read_b64_tr_b16 v[202:203], v22 offset:43008
  v_mfma_f32_16x16x32_bf16 v[124:127], v[172:175], v[244:247], v[124:127]
  ds_read_b64_tr_b16 v[204:205], v23 offset:40960
  v_mfma_f32_16x16x32_bf16 v[120:123], v[172:175], v[240:243], v[120:123]
  ds_read_b64_tr_b16 v[206:207], v23 offset:43008
  s_waitcnt vmcnt(16) lgkmcnt(8)
  v_mfma_f32_16x16x32_bf16 v[96:99], v[176:179], v[248:251], v[96:99]
  ds_read_b64_tr_b16 v[208:209], v20 offset:45056
  v_mfma_f32_16x16x32_bf16 v[100:103], v[176:179], v[252:255], v[100:103]
  ds_read_b64_tr_b16 v[210:211], v20 offset:47104
  v_mfma_f32_16x16x32_bf16 v[108:111], v[180:183], v[252:255], v[108:111]
  ds_read_b64_tr_b16 v[212:213], v21 offset:45056
  v_mfma_f32_16x16x32_bf16 v[104:107], v[180:183], v[248:251], v[104:107]
  ds_read_b64_tr_b16 v[214:215], v21 offset:47104
  v_mfma_f32_16x16x32_bf16 v[112:115], v[184:187], v[248:251], v[112:115]
  ds_read_b64_tr_b16 v[216:217], v22 offset:45056
  v_mfma_f32_16x16x32_bf16 v[116:119], v[184:187], v[252:255], v[116:119]
  ds_read_b64_tr_b16 v[218:219], v22 offset:47104
  v_mfma_f32_16x16x32_bf16 v[124:127], v[188:191], v[252:255], v[124:127]
  ds_read_b64_tr_b16 v[220:221], v23 offset:45056
  v_mfma_f32_16x16x32_bf16 v[120:123], v[188:191], v[248:251], v[120:123]
  ds_read_b64_tr_b16 v[222:223], v23 offset:47104
  s_waitcnt vmcnt(14) lgkmcnt(8)
  v_mfma_f32_16x16x32_bf16 v[96:99], v[192:195], v[32:35], v[96:99]
  ds_read_b64_tr_b16 v[160:161], v20 offset:49152
  v_mfma_f32_16x16x32_bf16 v[100:103], v[192:195], v[36:39], v[100:103]
  ds_read_b64_tr_b16 v[162:163], v20 offset:51200
  v_mfma_f32_16x16x32_bf16 v[108:111], v[196:199], v[36:39], v[108:111]
  ds_read_b64_tr_b16 v[164:165], v21 offset:49152
  v_mfma_f32_16x16x32_bf16 v[104:107], v[196:199], v[32:35], v[104:107]
  ds_read_b64_tr_b16 v[166:167], v21 offset:51200
  v_mfma_f32_16x16x32_bf16 v[112:115], v[200:203], v[32:35], v[112:115]
  ds_read_b64_tr_b16 v[168:169], v22 offset:49152
  v_mfma_f32_16x16x32_bf16 v[116:119], v[200:203], v[36:39], v[116:119]
  ds_read_b64_tr_b16 v[170:171], v22 offset:51200
  v_mfma_f32_16x16x32_bf16 v[124:127], v[204:207], v[36:39], v[124:127]
  ds_read_b64_tr_b16 v[172:173], v23 offset:49152
  v_mfma_f32_16x16x32_bf16 v[120:123], v[204:207], v[32:35], v[120:123]
  ds_read_b64_tr_b16 v[174:175], v23 offset:51200
  s_waitcnt vmcnt(12) lgkmcnt(8)
  v_mfma_f32_16x16x32_bf16 v[96:99], v[208:211], v[40:43], v[96:99]
  ds_read_b64_tr_b16 v[176:177], v20 offset:53248
  v_mfma_f32_16x16x32_bf16 v[100:103], v[208:211], v[44:47], v[100:103]
  ds_read_b64_tr_b16 v[178:179], v20 offset:55296
  v_mfma_f32_16x16x32_bf16 v[108:111], v[212:215], v[44:47], v[108:111]
  ds_read_b64_tr_b16 v[180:181], v21 offset:53248
  v_mfma_f32_16x16x32_bf16 v[104:107], v[212:215], v[40:43], v[104:107]
  ds_read_b64_tr_b16 v[182:183], v21 offset:55296
  v_mfma_f32_16x16x32_bf16 v[112:115], v[216:219], v[40:43], v[112:115]
  ds_read_b64_tr_b16 v[184:185], v22 offset:53248
  v_mfma_f32_16x16x32_bf16 v[116:119], v[216:219], v[44:47], v[116:119]
  ds_read_b64_tr_b16 v[186:187], v22 offset:55296
  v_mfma_f32_16x16x32_bf16 v[124:127], v[220:223], v[44:47], v[124:127]
  ds_read_b64_tr_b16 v[188:189], v23 offset:53248
  v_mfma_f32_16x16x32_bf16 v[120:123], v[220:223], v[40:43], v[120:123]
  ds_read_b64_tr_b16 v[190:191], v23 offset:55296
  s_waitcnt vmcnt(10) lgkmcnt(8)
  v_mfma_f32_16x16x32_bf16 v[96:99], v[160:163], v[48:51], v[96:99]
  ds_read_b64_tr_b16 v[192:193], v20 offset:57344
  s_waitcnt vmcnt(3)
  v_mfma_f32_16x16x32_bf16 v[100:103], v[160:163], v[52:55], v[100:103]
  ds_read_b64_tr_b16 v[194:195], v20 offset:59392
  v_lshlrev_b32 v128, 16, v144
  v_mfma_f32_16x16x32_bf16 v[108:111], v[164:167], v[52:55], v[108:111]
  ds_read_b64_tr_b16 v[196:197], v21 offset:57344
  v_and_b32 v129, s11, v144
  v_mfma_f32_16x16x32_bf16 v[104:107], v[164:167], v[48:51], v[104:107]
  ds_read_b64_tr_b16 v[198:199], v21 offset:59392
  v_lshlrev_b32 v130, 16, v145
  v_mfma_f32_16x16x32_bf16 v[112:115], v[168:171], v[48:51], v[112:115]
  ds_read_b64_tr_b16 v[200:201], v22 offset:57344
  v_and_b32 v131, s11, v145
  v_mfma_f32_16x16x32_bf16 v[116:119], v[168:171], v[52:55], v[116:119]
  ds_read_b64_tr_b16 v[202:203], v22 offset:59392
  v_lshlrev_b32 v132, 16, v146
  v_mfma_f32_16x16x32_bf16 v[124:127], v[172:175], v[52:55], v[124:127]
  ds_read_b64_tr_b16 v[204:205], v23 offset:57344
  v_and_b32 v133, s11, v146
  v_mfma_f32_16x16x32_bf16 v[120:123], v[172:175], v[48:51], v[120:123]
  ds_read_b64_tr_b16 v[206:207], v23 offset:59392
  s_waitcnt lgkmcnt(8)
  v_mfma_f32_16x16x32_bf16 v[96:99], v[176:179], v[56:59], v[96:99]
  ds_read_b64_tr_b16 v[208:209], v20 offset:61440
  v_lshlrev_b32 v134, 16, v147
  v_mfma_f32_16x16x32_bf16 v[100:103], v[176:179], v[60:63], v[100:103]
  ds_read_b64_tr_b16 v[210:211], v20 offset:63488
  v_and_b32 v135, s11, v147
  v_mfma_f32_16x16x32_bf16 v[108:111], v[180:183], v[60:63], v[108:111]
  ds_read_b64_tr_b16 v[212:213], v21 offset:61440
  v_lshlrev_b32 v136, 16, v148
  v_mfma_f32_16x16x32_bf16 v[104:107], v[180:183], v[56:59], v[104:107]
  ds_read_b64_tr_b16 v[214:215], v21 offset:63488
  v_and_b32 v137, s11, v148
  v_mfma_f32_16x16x32_bf16 v[112:115], v[184:187], v[56:59], v[112:115]
  ds_read_b64_tr_b16 v[216:217], v22 offset:61440
  v_lshlrev_b32 v138, 16, v149
  v_mfma_f32_16x16x32_bf16 v[116:119], v[184:187], v[60:63], v[116:119]
  ds_read_b64_tr_b16 v[218:219], v22 offset:63488
  v_and_b32 v139, s11, v149
  v_mfma_f32_16x16x32_bf16 v[124:127], v[188:191], v[60:63], v[124:127]
  ds_read_b64_tr_b16 v[220:221], v23 offset:61440
  v_lshlrev_b32 v140, 16, v150
  v_mfma_f32_16x16x32_bf16 v[120:123], v[188:191], v[56:59], v[120:123]
  ds_read_b64_tr_b16 v[222:223], v23 offset:63488
  s_waitcnt vmcnt(2) lgkmcnt(8)
  v_mfma_f32_16x16x32_bf16 v[96:99], v[192:195], v[64:67], v[96:99]
  v_mov_b32 v20, 0
  v_mov_b32 v21, 0
  v_mfma_f32_16x16x32_bf16 v[100:103], v[192:195], v[68:71], v[100:103]
  v_mov_b32 v22, 0
  v_mov_b32 v23, 0
  v_mfma_f32_16x16x32_bf16 v[108:111], v[196:199], v[68:71], v[108:111]
  v_and_b32 v141, s11, v150
  v_lshlrev_b32 v142, 16, v151
  v_and_b32 v143, s11, v151
  v_mfma_f32_16x16x32_bf16 v[104:107], v[196:199], v[64:67], v[104:107]
  v_lshlrev_b32 v144, 16, v152
  v_and_b32 v145, s11, v152
  v_lshlrev_b32 v146, 16, v153
  v_mfma_f32_16x16x32_bf16 v[112:115], v[200:203], v[64:67], v[112:115]
  v_and_b32 v147, s11, v153
  v_lshlrev_b32 v148, 16, v154
  v_and_b32 v149, s11, v154
  v_mfma_f32_16x16x32_bf16 v[116:119], v[200:203], v[68:71], v[116:119]
  v_lshlrev_b32 v150, 16, v155
  v_and_b32 v151, s11, v155
  v_lshlrev_b32 v152, 16, v156
  v_mfma_f32_16x16x32_bf16 v[124:127], v[204:207], v[68:71], v[124:127]
  v_and_b32 v153, s11, v156
  v_lshlrev_b32 v154, 16, v157
  v_and_b32 v155, s11, v157
  v_mfma_f32_16x16x32_bf16 v[120:123], v[204:207], v[64:67], v[120:123]
  s_waitcnt vmcnt(0) lgkmcnt(0)
  v_lshlrev_b32 v156, 16, v158
  v_and_b32 v157, s11, v158
  v_mfma_f32_16x16x32_bf16 v[96:99], v[208:211], v[72:75], v[96:99]
  v_lshlrev_b32 v158, 16, v159
  v_and_b32 v159, s11, v159
  v_mfma_f32_16x16x32_bf16 v[100:103], v[208:211], v[76:79], v[100:103]
  v_mfma_f32_16x16x32_bf16 v[108:111], v[212:215], v[76:79], v[108:111]
  v_mfma_f32_16x16x32_bf16 v[104:107], v[212:215], v[72:75], v[104:107]
  v_mfma_f32_16x16x32_bf16 v[112:115], v[216:219], v[72:75], v[112:115]
  v_mfma_f32_16x16x32_bf16 v[116:119], v[216:219], v[76:79], v[116:119]
  v_mfma_f32_16x16x32_bf16 v[124:127], v[220:223], v[76:79], v[124:127]
  v_mfma_f32_16x16x32_bf16 v[120:123], v[220:223], v[72:75], v[120:123]
  s_lshl_b32 s3, s7, 4
  s_mov_b32 s10, 0x3f803f80
  s_lshl_b32 s4, s7, 3
  s_add_u32 s5, s3, s4
  v_xor_b32 v6, 32, v4
  v_xor_b32 v7, 64, v4
  v_xor_b32 v8, 96, v4
  v_xor_b32 v9, 64, v12
  v_pk_add_f32 v[96:97], v[96:97], v[128:129]
  v_pk_add_f32 v[98:99], v[98:99], v[130:131]
  v_cvt_pk_bf16_f32 v240, v96, v97
  v_cvt_pk_bf16_f32 v241, v98, v99
  v_pk_add_f32 v[104:105], v[104:105], v[136:137]
  v_pk_add_f32 v[106:107], v[106:107], v[138:139]
  v_cvt_pk_bf16_f32 v242, v104, v105
  v_cvt_pk_bf16_f32 v243, v106, v107
  ds_write_b64 v4, v[240:241] offset:0
  ds_write_b64 v6, v[242:243] offset:0
  v_pk_add_f32 v[112:113], v[112:113], v[144:145]
  v_pk_add_f32 v[114:115], v[114:115], v[146:147]
  v_cvt_pk_bf16_f32 v244, v112, v113
  v_cvt_pk_bf16_f32 v245, v114, v115
  v_pk_add_f32 v[120:121], v[120:121], v[152:153]
  v_pk_add_f32 v[122:123], v[122:123], v[154:155]
  v_cvt_pk_bf16_f32 v246, v120, v121
  v_cvt_pk_bf16_f32 v247, v122, v123
  ds_write_b64 v7, v[244:245] offset:0
  ds_write_b64 v8, v[246:247] offset:0
  ds_read_b128 v[32:35], v5 offset:0
  ds_read_b128 v[36:39], v5 offset:1024
  v_pk_add_f32 v[100:101], v[100:101], v[132:133]
  v_pk_add_f32 v[102:103], v[102:103], v[134:135]
  v_cvt_pk_bf16_f32 v248, v100, v101
  v_cvt_pk_bf16_f32 v249, v102, v103
  v_pk_add_f32 v[108:109], v[108:109], v[140:141]
  v_pk_add_f32 v[110:111], v[110:111], v[142:143]
  v_cvt_pk_bf16_f32 v250, v108, v109
  v_cvt_pk_bf16_f32 v251, v110, v111
  ds_write_b64 v4, v[248:249] offset:2048
  ds_write_b64 v6, v[250:251] offset:2048
  v_pk_add_f32 v[116:117], v[116:117], v[148:149]
  v_pk_add_f32 v[118:119], v[118:119], v[150:151]
  v_cvt_pk_bf16_f32 v252, v116, v117
  v_cvt_pk_bf16_f32 v253, v118, v119
  v_pk_add_f32 v[124:125], v[124:125], v[156:157]
  v_pk_add_f32 v[126:127], v[126:127], v[158:159]
  v_cvt_pk_bf16_f32 v254, v124, v125
  v_cvt_pk_bf16_f32 v255, v126, v127
  ds_write_b64 v7, v[252:253] offset:2048
  ds_write_b64 v8, v[254:255] offset:2048
  ds_read_b128 v[40:43], v5 offset:2048
  ds_read_b128 v[44:47], v5 offset:3072
  s_waitcnt lgkmcnt(7)
  buffer_store_dwordx4 v[32:35], v12, s[40:43], 0 offen sc1
  s_waitcnt lgkmcnt(6)
  buffer_store_dwordx4 v[36:39], v9, s[40:43], s4 offen sc1
  s_waitcnt lgkmcnt(1)
  buffer_store_dwordx4 v[40:43], v12, s[40:43], s3 offen sc1
  s_waitcnt lgkmcnt(0)
  buffer_store_dwordx4 v[44:47], v9, s[40:43], s5 offen sc1
  s_cmp_eq_u32 s96, 1
  s_cbranch_scc1 L_w2_end
  v_dot2_f32_bf16 v20, v240, s10, v20
  v_dot2_f32_bf16 v22, v240, v240, v22
  v_dot2_f32_bf16 v20, v241, s10, v20
  v_dot2_f32_bf16 v22, v241, v241, v22
  v_dot2_f32_bf16 v20, v242, s10, v20
  v_dot2_f32_bf16 v22, v242, v242, v22
  v_dot2_f32_bf16 v20, v243, s10, v20
  v_dot2_f32_bf16 v22, v243, v243, v22
  v_dot2_f32_bf16 v20, v244, s10, v20
  v_dot2_f32_bf16 v22, v244, v244, v22
  v_dot2_f32_bf16 v20, v245, s10, v20
  v_dot2_f32_bf16 v22, v245, v245, v22
  v_dot2_f32_bf16 v20, v246, s10, v20
  v_dot2_f32_bf16 v22, v246, v246, v22
  v_dot2_f32_bf16 v20, v247, s10, v20
  v_dot2_f32_bf16 v22, v247, v247, v22
  v_dot2_f32_bf16 v21, v248, s10, v21
  v_dot2_f32_bf16 v23, v248, v248, v23
  v_dot2_f32_bf16 v21, v249, s10, v21
  v_dot2_f32_bf16 v23, v249, v249, v23
  v_dot2_f32_bf16 v21, v250, s10, v21
  v_dot2_f32_bf16 v23, v250, v250, v23
  v_dot2_f32_bf16 v21, v251, s10, v21
  v_dot2_f32_bf16 v23, v251, v251, v23
  v_dot2_f32_bf16 v21, v252, s10, v21
  v_dot2_f32_bf16 v23, v252, v252, v23
  v_dot2_f32_bf16 v21, v253, s10, v21
  v_dot2_f32_bf16 v23, v253, v253, v23
  v_dot2_f32_bf16 v21, v254, s10, v21
  v_dot2_f32_bf16 v23, v254, v254, v23
  v_dot2_f32_bf16 v21, v255, s10, v21
  v_dot2_f32_bf16 v23, v255, v255, v23
  s_nop 2
  v_permlane32_swap_b32 v20, v21
  v_permlane32_swap_b32 v22, v23
  v_add_f32 v20, v20, v21
  v_add_f32 v22, v22, v23
  s_nop 1
  v_permlane16_swap_b32 v20, v22
  v_add_f32 v20, v20, v22
  buffer_store_dword v20, v18, s[56:59], 0 offen sc1
  s_waitcnt vmcnt(0) lgkmcnt(0)
  s_barrier
  s_mov_b32 s96, 1
  s_add_u32 s12, s22, 33554432
  s_addc_u32 s13, s23, 0
  s_add_u32 s34, s22, 67108864
  s_addc_u32 s35, s23, 0
  s_add_u32 s97, s97, 1
  s_branch L_attn_body
L_w2_c1:
```

```asm
; @launch grid=(256,1,1) block=(512,1,1) lds=163840
.amdgcn_target "amdgcn-amd-amdhsa--gfx950"
.text
.globl interleave_layers__sliding_local_dilated__dense_activation_gelu__prompt_kernel
.p2align 12
.fill 832, 4, 0xbf810000
.type interleave_layers__sliding_local_dilated__dense_activation_gelu__prompt_kernel,@function
interleave_layers__sliding_local_dilated__dense_activation_gelu__prompt_kernel:
L_attn_c0:
  s_load_dwordx4 s[16:19], s[0:1], 0
  s_load_dwordx2 s[20:21], s[0:1], 16
  s_load_dwordx2 s[22:23], s[0:1], 80
  s_load_dwordx8 s[24:31], s[0:1], 32
  s_load_dwordx2 s[32:33], s[0:1], 64
  s_load_dwordx2 s[34:35], s[0:1], 80
  s_load_dwordx2 s[12:13], s[0:1], 0
  s_load_dwordx2 s[64:65], s[0:1], 72
  s_mov_b32 s96, 0
  s_mov_b32 s97, 0
L_attn_body:
  s_cmp_ge_u32 s2, 256
  s_cbranch_scc1 L_attn_end
  v_lshrrev_b32 v2, 6, v0
  v_and_b32 v1, 63, v0
  v_readfirstlane_b32 s70, v2
  s_and_b32 s3, s2, 7
  s_lshr_b32 s99, s2, 3
  s_and_b32 s5, s3, 1
  s_lshl_b32 s5, s5, 3
  s_and_b32 s6, s99, 7
  s_add_u32 s68, s5, s6
  s_lshr_b32 s5, s3, 1
  s_lshl_b32 s5, s5, 2
  s_lshr_b32 s6, s99, 3
  s_add_u32 s69, s5, s6
  s_cmp_eq_u32 s96, 0
  s_cbranch_scc1 L_attn_map
  s_and_b32 s3, s2, 7
  s_and_b32 s5, s3, 3
  s_lshl_b32 s5, s5, 2
  s_and_b32 s6, s99, 3
  s_add_u32 s68, s5, s6
  s_lshr_b32 s5, s3, 2
  s_lshl_b32 s5, s5, 3
  s_lshr_b32 s6, s99, 2
  s_add_u32 s69, s5, s6
L_attn_map:
  s_cmp_lt_u32 s70, 4
  s_cbranch_scc1 L_attn_compute
L_attn_loader:
  s_add_u32 s8, s70, s69
  s_and_b32 s8, s8, 3
  s_add_u32 s9, s70, s68
  s_and_b32 s9, s9, 3
  s_lshl_b32 s76, s8, 12
  s_lshl_b32 s77, s9, 11
  s_add_u32 s77, s77, 16384
  s_lshl_b32 s11, s68, 7
  v_and_b32 v10, 7, v1
  v_lshrrev_b32 v3, 3, v1
  s_lshr_b32 s10, s76, 7
  s_lshl_b32 s3, s68, 7
  s_add_u32 s10, s10, s3
  v_add_u32 v3, s10, v3
  s_cmp_eq_u32 s96, 1
  s_cselect_b32 s5, 128, 0
  s_add_u32 s5, s5, 2048
  s_lshl_b32 s6, s5, 3
  v_mul_u32_u24 v3, s5, v3
  v_lshrrev_b32 v2, 4, v1
  v_xor_b32 v4, v2, v10
  v_lshl_add_u32 v4, v4, 4, v3
  v_add_u32 v3, s6, v3
  v_add_u32 v5, 4, v2
  v_xor_b32 v5, v5, v10
  v_lshl_add_u32 v5, v5, 4, v3
  v_add_u32 v3, s6, v3
  v_xor_b32 v6, v2, v10
  v_lshl_add_u32 v6, v6, 4, v3
  v_add_u32 v3, s6, v3
  v_add_u32 v7, 4, v2
  v_xor_b32 v7, v7, v10
  v_lshl_add_u32 v7, v7, 4, v3
  v_lshrrev_b32 v3, 3, v1
  s_lshl_b32 s10, s9, 4
  v_add_u32 v3, s10, v3
  v_mul_u32_u24 v3, 6144, v3
  v_lshrrev_b32 v2, 3, v1
  v_and_b32 v2, 2, v2
  v_xor_b32 v2, v2, v10
  s_mul_i32 s10, s69, 128
  v_add_u32 v3, s10, v3
  v_lshl_add_u32 v8, v2, 4, v3
  v_xor_b32 v2, 4, v2
  v_add_u32 v3, 49152, v3
  v_lshl_add_u32 v9, v2, 4, v3
  s_and_b32 s10, s70, 3
  s_lshl_b32 s78, s10, 9
  s_add_u32 s78, s78, 40960
  s_lshl_b32 s14, s10, 2
  s_add_u32 s14, s14, s11
  s_sub_u32 s14, s14, 16
  v_lshrrev_b32 v3, 3, v1
  v_add_u32 v3, s14, v3
  v_max_i32 v3, 0, v3
  v_mul_u32_u24 v3, s5, v3
  s_lshl_b32 s14, s10, 1
  v_lshrrev_b32 v2, 4, v1
  v_add_u32 v2, s14, v2
  v_and_b32 v2, 7, v2
  v_xor_b32 v2, v2, v10
  v_lshl_add_u32 v28, v2, 4, v3
  s_cmp_eq_u32 s10, 0
  s_cselect_b32 s14, 0xffffff00, -1
  s_mov_b32 s15, 0
  s_mov_b32 s75, 0
  s_add_u32 s100, s68, s69
  s_mov_b32 s101, -1
  s_add_u32 s3, s68, s69
  s_and_b32 s3, s3, 3
  s_mov_b32 s100, 0x75463102
  s_mov_b32 s101, 0xfdceb98a
  s_cmp_eq_u32 s3, 1
  s_cselect_b32 s100, 0x65742130, s100
  s_cselect_b32 s101, 0xedfca9b8, s101
  s_cmp_eq_u32 s3, 2
  s_cselect_b32 s100, 0x68532410, s100
  s_cselect_b32 s101, 0xfedbac97, s101
  s_cmp_eq_u32 s3, 3
  s_cselect_b32 s100, 0x96435210, s100
  s_cselect_b32 s101, 0xfecbda87, s101
  s_mov_b32 s91, s69
  s_and_b32 s92, s69, 3
  s_add_u32 s92, s92, 1
  s_and_b32 s73, s100, 15
  s_cmp_eq_u32 s73, s91
  s_cselect_b32 s74, 4, 0
  s_lshr_b64 s[100:101], s[100:101], s74
  s_and_b32 s73, s100, 15
  s_sub_u32 s92, s92, 1
  s_cselect_b32 s73, s91, s73
  s_cselect_b32 s74, 0, 4
  s_lshr_b64 s[100:101], s[100:101], s74
  s_mul_i32 s74, s73, 393216
  s_lshl_b32 s73, s73, 7
  s_waitcnt lgkmcnt(0)
  s_mov_b32 s36, s12
  s_and_b32 s37, s13, 0xffff
  s_mov_b32 s38, 4194304
  s_mov_b32 s39, 0x00020000
  s_cmp_eq_u32 s96, 1
  s_cselect_b32 s38, 128, 0
  s_add_u32 s38, s38, 2048
  s_lshl_b32 s38, s38, 11
  s_mov_b32 s40, s18
  s_and_b32 s41, s19, 0xffff
  s_mov_b32 s42, 6291456
  s_mov_b32 s43, 0x00020000
  s_cmp_lg_u32 s96, 0
  s_cbranch_scc1 L_attn_ld1
  s_mov_b32 s48, s28
  s_and_b32 s49, s29, 0xffff
  s_mov_b32 s50, 7340032
  s_mov_b32 s51, 0x00020000
  s_cmp_eq_u32 s96, 0
  s_cselect_b32 s50, s50, 0
  s_and_b32 s3, s70, 3
  s_lshl_b32 s4, s2, 2
  s_add_u32 s3, s3, s4
  s_mul_i32 s98, s3, 3584
  s_add_u32 s98, s98, 0
  s_add_u32 s3, s75, s76
  s_add_u32 m0, s3, 0
  s_nop 0
  buffer_load_dwordx4 v4, s[36:39], s73 offen lds
  s_add_u32 m0, s3, 1024
  s_nop 0
  buffer_load_dwordx4 v5, s[36:39], s73 offen lds
  s_add_u32 m0, s3, 2048
  s_nop 0
  buffer_load_dwordx4 v6, s[36:39], s73 offen lds
  s_add_u32 m0, s3, 3072
  s_nop 0
  buffer_load_dwordx4 v7, s[36:39], s73 offen lds
  s_add_u32 m0, s78, s75
  s_mov_b64 exec, s[14:15]
  buffer_load_dwordx4 v28, s[36:39], s73 offen lds
  s_mov_b64 exec, -1
  s_add_u32 s3, s75, s77
  s_add_u32 m0, s3, 0
  s_add_u32 s4, s74, 0
  buffer_load_dwordx4 v8, s[40:43], s4 offen lds
  s_add_u32 m0, s3, 1024
  s_nop 0
  buffer_load_dwordx4 v9, s[40:43], s4 offen lds
  s_add_u32 m0, s3, 8192
  s_add_u32 s4, s74, 2048
  buffer_load_dwordx4 v8, s[40:43], s4 offen lds
  s_add_u32 m0, s3, 9216
  s_nop 0
  buffer_load_dwordx4 v9, s[40:43], s4 offen lds
  s_add_u32 m0, s3, 16384
  s_add_u32 s4, s74, 4096
  buffer_load_dwordx4 v8, s[40:43], s4 offen lds
  s_add_u32 m0, s3, 17408
  s_nop 0
  buffer_load_dwordx4 v9, s[40:43], s4 offen lds
  s_and_b32 s73, s100, 15
  s_cmp_eq_u32 s73, s91
  s_cselect_b32 s74, 4, 0
  s_lshr_b64 s[100:101], s[100:101], s74
  s_and_b32 s73, s100, 15
  s_sub_u32 s92, s92, 1
  s_cselect_b32 s73, s91, s73
  s_cselect_b32 s74, 0, 4
  s_lshr_b64 s[100:101], s[100:101], s74
  s_mul_i32 s74, s73, 393216
  s_lshl_b32 s73, s73, 7
  s_add_u32 s75, s75, 43008
  s_cmp_eq_u32 s75, 129024
  s_cselect_b32 s75, 0, s75
  s_add_u32 s3, s75, s76
  s_add_u32 m0, s3, 0
  s_nop 0
  buffer_load_dwordx4 v4, s[36:39], s73 offen lds
  s_add_u32 m0, s3, 1024
  s_nop 0
  buffer_load_dwordx4 v5, s[36:39], s73 offen lds
  s_add_u32 m0, s3, 2048
  s_nop 0
  buffer_load_dwordx4 v6, s[36:39], s73 offen lds
  s_add_u32 m0, s3, 3072
  s_nop 0
  buffer_load_dwordx4 v7, s[36:39], s73 offen lds
  s_add_u32 m0, s78, s75
  s_mov_b64 exec, s[14:15]
  buffer_load_dwordx4 v28, s[36:39], s73 offen lds
  s_mov_b64 exec, -1
  s_add_u32 s3, s75, s77
  s_add_u32 m0, s3, 0
  s_add_u32 s4, s74, 0
  buffer_load_dwordx4 v8, s[40:43], s4 offen lds
  s_add_u32 m0, s3, 1024
  s_nop 0
  buffer_load_dwordx4 v9, s[40:43], s4 offen lds
  s_add_u32 m0, s3, 8192
  s_add_u32 s4, s74, 2048
  buffer_load_dwordx4 v8, s[40:43], s4 offen lds
  s_add_u32 m0, s3, 9216
  s_nop 0
  buffer_load_dwordx4 v9, s[40:43], s4 offen lds
  s_add_u32 m0, s3, 16384
  s_add_u32 s4, s74, 4096
  buffer_load_dwordx4 v8, s[40:43], s4 offen lds
  s_add_u32 m0, s3, 17408
  s_nop 0
  buffer_load_dwordx4 v9, s[40:43], s4 offen lds
  s_and_b32 s73, s100, 15
  s_cmp_eq_u32 s73, s91
  s_cselect_b32 s74, 4, 0
  s_lshr_b64 s[100:101], s[100:101], s74
  s_and_b32 s73, s100, 15
  s_sub_u32 s92, s92, 1
  s_cselect_b32 s73, s91, s73
  s_cselect_b32 s74, 0, 4
  s_lshr_b64 s[100:101], s[100:101], s74
  s_mul_i32 s74, s73, 393216
  s_lshl_b32 s73, s73, 7
  s_add_u32 s75, s75, 43008
  s_cmp_eq_u32 s75, 129024
  s_cselect_b32 s75, 0, s75
  s_mov_b32 s52, s24
  s_and_b32 s53, s25, 0xffff
  s_mov_b32 s54, 7340032
  s_mov_b32 s55, 0x00020000
  s_min_u32 s3, s2, 223
  s_mul_i32 s4, s3, 4682
  s_lshr_b32 s4, s4, 16
  s_mul_i32 s5, s4, 14
  s_sub_u32 s3, s3, s5
  s_lshl_b32 s3, s3, 2
  s_and_b32 s5, s70, 3
  s_add_u32 s3, s3, s5
  s_mul_i32 s5, s4, 458752
  s_lshl_b32 s8, s3, 7
  s_add_u32 s95, s5, s8
  s_lshl_b32 s9, s4, 14
  s_lshl_b32 s8, s3, 8
  s_add_u32 s94, s9, s8
  v_lshrrev_b32 v2, 3, v1
  v_mul_u32_u24 v2, 7168, v2
  v_and_b32 v3, 7, v1
  v_lshl_add_u32 v26, v3, 4, v2
  s_and_b32 s3, s70, 3
  s_lshl_b32 s4, s2, 2
  s_add_u32 s3, s3, s4
  s_sub_u32 s4, 384, s40
  s_and_b32 s4, s4, 0x380
  s_mul_i32 s5, s3, 6144
  s_add_u32 s5, s5, s4
  s_buffer_load_dword s84, s[40:43], s5 offset:0
  s_buffer_load_dword s84, s[40:43], s5 offset:64
  s_buffer_load_dword s84, s[40:43], s5 offset:1024
  s_buffer_load_dword s84, s[40:43], s5 offset:1088
  s_buffer_load_dword s84, s[40:43], s5 offset:2048
  s_buffer_load_dword s84, s[40:43], s5 offset:2112
  s_buffer_load_dword s84, s[40:43], s5 offset:3072
  s_buffer_load_dword s84, s[40:43], s5 offset:3136
  s_buffer_load_dword s84, s[40:43], s5 offset:4096
  s_buffer_load_dword s84, s[40:43], s5 offset:4160
  s_buffer_load_dword s84, s[40:43], s5 offset:5120
  s_buffer_load_dword s84, s[40:43], s5 offset:5184
  s_add_u32 s56, s22, 24903680
  s_addc_u32 s57, s23, 0
  s_and_b32 s57, s57, 0xffff
  s_mov_b32 s58, 262144
  s_mov_b32 s59, 0x00020000
  s_and_b32 s3, s70, 3
  s_lshl2_add_u32 s4, s68, s3
  s_lshl_b32 s4, s4, 8
  v_lshrrev_b32 v2, 4, v1
  v_and_b32 v3, 15, v1
  v_lshl_add_u32 v3, v3, 4, s4
  v_lshl_add_u32 v18, v2, 14, v3
  s_lshl_b32 s4, s68, 5
  s_add_u32 s4, s4, s3
  s_sub_u32 s4, s4, 4
  s_max_i32 s4, s4, 0
  s_lshl_b32 s4, s4, 5
  v_lshrrev_b32 v2, 2, v1
  v_and_b32 v3, 3, v1
  v_lshl_add_u32 v3, v3, 3, s4
  v_lshl_add_u32 v19, v2, 14, v3
  s_lshl_b32 s3, s68, 2
  s_sub_u32 s3, s3, 4
  v_and_b32 v20, 7, v1
  v_add_u32 v20, s3, v20
  v_max_i32 v20, 0, v20
  v_lshlrev_b32 v20, 2, v20
  s_and_b32 s65, s65, 0xffff
  s_mov_b32 s66, 256
  s_mov_b32 s67, 0x00020000
  s_waitcnt vmcnt(11)
  s_barrier
  s_add_u32 s3, s75, s76
  s_add_u32 m0, s3, 0
  s_nop 0
  buffer_load_dwordx4 v4, s[36:39], s73 offen lds
  s_add_u32 m0, s3, 1024
  s_nop 0
  buffer_load_dwordx4 v5, s[36:39], s73 offen lds
  s_add_u32 m0, s3, 2048
  s_nop 0
  buffer_load_dwordx4 v6, s[36:39], s73 offen lds
  s_add_u32 m0, s3, 3072
  s_nop 0
  buffer_load_dwordx4 v7, s[36:39], s73 offen lds
  s_add_u32 m0, s78, s75
  s_mov_b64 exec, s[14:15]
  buffer_load_dwordx4 v28, s[36:39], s73 offen lds
  s_mov_b64 exec, -1
  s_add_u32 s3, s75, s77
  s_add_u32 m0, s3, 0
  s_add_u32 s4, s74, 0
  buffer_load_dwordx4 v8, s[40:43], s4 offen lds
  s_add_u32 m0, s3, 1024
  s_nop 0
  buffer_load_dwordx4 v9, s[40:43], s4 offen lds
  s_add_u32 m0, s3, 8192
  s_add_u32 s4, s74, 2048
  buffer_load_dwordx4 v8, s[40:43], s4 offen lds
  s_add_u32 m0, s3, 9216
  s_nop 0
  buffer_load_dwordx4 v9, s[40:43], s4 offen lds
  s_add_u32 m0, s3, 16384
  s_add_u32 s4, s74, 4096
  buffer_load_dwordx4 v8, s[40:43], s4 offen lds
  s_add_u32 m0, s3, 17408
  s_nop 0
  buffer_load_dwordx4 v9, s[40:43], s4 offen lds
  s_and_b32 s73, s100, 15
  s_cmp_eq_u32 s73, s91
  s_cselect_b32 s74, 4, 0
  s_lshr_b64 s[100:101], s[100:101], s74
  s_and_b32 s73, s100, 15
  s_sub_u32 s92, s92, 1
  s_cselect_b32 s73, s91, s73
  s_cselect_b32 s74, 0, 4
  s_lshr_b64 s[100:101], s[100:101], s74
  s_mul_i32 s74, s73, 393216
  s_lshl_b32 s73, s73, 7
  s_add_u32 s75, s75, 43008
  s_cmp_eq_u32 s75, 129024
  s_cselect_b32 s75, 0, s75
  s_buffer_load_dword s84, s[48:51], s98 offset:0
  s_buffer_load_dword s84, s[48:51], s98 offset:64
  s_buffer_load_dword s84, s[48:51], s98 offset:128
  s_buffer_load_dword s84, s[48:51], s98 offset:192
  s_add_u32 s98, s98, 256
  buffer_load_dwordx4 v[64:67], v26, s[52:55], s95 offen
  s_add_u32 s95, s95, 57344
  buffer_load_dwordx4 v[68:71], v26, s[52:55], s95 offen
  s_add_u32 s95, s95, 57344
  s_waitcnt vmcnt(13)
  s_barrier
  s_add_u32 s3, s75, s76
  s_add_u32 m0, s3, 0
  s_nop 0
  buffer_load_dwordx4 v4, s[36:39], s73 offen lds
  s_add_u32 m0, s3, 1024
  s_nop 0
  buffer_load_dwordx4 v5, s[36:39], s73 offen lds
  s_add_u32 m0, s3, 2048
  s_nop 0
  buffer_load_dwordx4 v6, s[36:39], s73 offen lds
  s_add_u32 m0, s3, 3072
  s_nop 0
  buffer_load_dwordx4 v7, s[36:39], s73 offen lds
  s_add_u32 m0, s78, s75
  s_mov_b64 exec, s[14:15]
  buffer_load_dwordx4 v28, s[36:39], s73 offen lds
  s_mov_b64 exec, -1
  s_add_u32 s3, s75, s77
  s_add_u32 m0, s3, 0
  s_add_u32 s4, s74, 0
  buffer_load_dwordx4 v8, s[40:43], s4 offen lds
  s_add_u32 m0, s3, 1024
  s_nop 0
  buffer_load_dwordx4 v9, s[40:43], s4 offen lds
  s_add_u32 m0, s3, 8192
  s_add_u32 s4, s74, 2048
  buffer_load_dwordx4 v8, s[40:43], s4 offen lds
  s_add_u32 m0, s3, 9216
  s_nop 0
  buffer_load_dwordx4 v9, s[40:43], s4 offen lds
  s_add_u32 m0, s3, 16384
  s_add_u32 s4, s74, 4096
  buffer_load_dwordx4 v8, s[40:43], s4 offen lds
  s_add_u32 m0, s3, 17408
  s_nop 0
  buffer_load_dwordx4 v9, s[40:43], s4 offen lds
  s_and_b32 s73, s100, 15
  s_cmp_eq_u32 s73, s91
  s_cselect_b32 s74, 4, 0
  s_lshr_b64 s[100:101], s[100:101], s74
  s_and_b32 s73, s100, 15
  s_sub_u32 s92, s92, 1
  s_cselect_b32 s73, s91, s73
  s_cselect_b32 s74, 0, 4
  s_lshr_b64 s[100:101], s[100:101], s74
  s_mul_i32 s74, s73, 393216
  s_lshl_b32 s73, s73, 7
  s_add_u32 s75, s75, 43008
  s_cmp_eq_u32 s75, 129024
  s_cselect_b32 s75, 0, s75
  s_buffer_load_dword s84, s[48:51], s98 offset:0
  s_buffer_load_dword s84, s[48:51], s98 offset:64
  s_buffer_load_dword s84, s[48:51], s98 offset:128
  s_buffer_load_dword s84, s[48:51], s98 offset:192
  s_add_u32 s98, s98, 256
  buffer_load_dwordx4 v[72:75], v26, s[52:55], s95 offen
  s_add_u32 s95, s95, 57344
  buffer_load_dwordx4 v[76:79], v26, s[52:55], s95 offen
  s_add_u32 s95, s95, 57344
  s_branch L_padl
.fill 200, 4, 0xbf810000
L_padl:
  s_waitcnt vmcnt(15)
  s_barrier
  s_add_u32 s3, s75, s76
  s_add_u32 m0, s3, 0
  s_nop 0
  buffer_load_dwordx4 v4, s[36:39], s73 offen lds
  s_add_u32 m0, s3, 1024
  s_nop 0
  buffer_load_dwordx4 v5, s[36:39], s73 offen lds
  s_add_u32 m0, s3, 2048
  s_nop 0
  buffer_load_dwordx4 v6, s[36:39], s73 offen lds
  s_add_u32 m0, s3, 3072
  s_nop 0
  buffer_load_dwordx4 v7, s[36:39], s73 offen lds
  s_add_u32 m0, s78, s75
  s_mov_b64 exec, s[14:15]
  buffer_load_dwordx4 v28, s[36:39], s73 offen lds
  s_mov_b64 exec, -1
  s_add_u32 s3, s75, s77
  s_add_u32 m0, s3, 0
  s_add_u32 s4, s74, 0
  buffer_load_dwordx4 v8, s[40:43], s4 offen lds
  s_add_u32 m0, s3, 1024
  s_nop 0
  buffer_load_dwordx4 v9, s[40:43], s4 offen lds
  s_add_u32 m0, s3, 8192
  s_add_u32 s4, s74, 2048
  buffer_load_dwordx4 v8, s[40:43], s4 offen lds
  s_add_u32 m0, s3, 9216
  s_nop 0
  buffer_load_dwordx4 v9, s[40:43], s4 offen lds
  s_add_u32 m0, s3, 16384
  s_add_u32 s4, s74, 4096
  buffer_load_dwordx4 v8, s[40:43], s4 offen lds
  s_add_u32 m0, s3, 17408
  s_nop 0
  buffer_load_dwordx4 v9, s[40:43], s4 offen lds
  s_and_b32 s73, s100, 15
  s_cmp_eq_u32 s73, s91
  s_cselect_b32 s74, 4, 0
  s_lshr_b64 s[100:101], s[100:101], s74
  s_and_b32 s73, s100, 15
  s_sub_u32 s92, s92, 1
  s_cselect_b32 s73, s91, s73
  s_cselect_b32 s74, 0, 4
  s_lshr_b64 s[100:101], s[100:101], s74
  s_mul_i32 s74, s73, 393216
  s_lshl_b32 s73, s73, 7
  s_add_u32 s75, s75, 43008
  s_cmp_eq_u32 s75, 129024
  s_cselect_b32 s75, 0, s75
  s_buffer_load_dword s84, s[48:51], s98 offset:0
  s_buffer_load_dword s84, s[48:51], s98 offset:64
  s_buffer_load_dword s84, s[48:51], s98 offset:128
  s_buffer_load_dword s84, s[48:51], s98 offset:192
  s_add_u32 s98, s98, 256
  buffer_load_dwordx4 v[80:83], v26, s[52:55], s95 offen
  s_add_u32 s95, s95, 57344
  buffer_load_dwordx4 v[84:87], v26, s[52:55], s95 offen
  s_add_u32 s95, s95, 57344
  s_waitcnt vmcnt(15)
  s_barrier
  s_add_u32 s3, s75, s76
  s_add_u32 m0, s3, 0
  s_nop 0
  buffer_load_dwordx4 v4, s[36:39], s73 offen lds
  s_add_u32 m0, s3, 1024
  s_nop 0
  buffer_load_dwordx4 v5, s[36:39], s73 offen lds
  s_add_u32 m0, s3, 2048
  s_nop 0
  buffer_load_dwordx4 v6, s[36:39], s73 offen lds
  s_add_u32 m0, s3, 3072
  s_nop 0
  buffer_load_dwordx4 v7, s[36:39], s73 offen lds
  s_add_u32 m0, s78, s75
  s_mov_b64 exec, s[14:15]
  buffer_load_dwordx4 v28, s[36:39], s73 offen lds
  s_mov_b64 exec, -1
  s_add_u32 s3, s75, s77
  s_add_u32 m0, s3, 0
  s_add_u32 s4, s74, 0
  buffer_load_dwordx4 v8, s[40:43], s4 offen lds
  s_add_u32 m0, s3, 1024
  s_nop 0
  buffer_load_dwordx4 v9, s[40:43], s4 offen lds
  s_add_u32 m0, s3, 8192
  s_add_u32 s4, s74, 2048
  buffer_load_dwordx4 v8, s[40:43], s4 offen lds
  s_add_u32 m0, s3, 9216
  s_nop 0
  buffer_load_dwordx4 v9, s[40:43], s4 offen lds
  s_add_u32 m0, s3, 16384
  s_add_u32 s4, s74, 4096
  buffer_load_dwordx4 v8, s[40:43], s4 offen lds
  s_add_u32 m0, s3, 17408
  s_nop 0
  buffer_load_dwordx4 v9, s[40:43], s4 offen lds
  s_and_b32 s73, s100, 15
  s_cmp_eq_u32 s73, s91
  s_cselect_b32 s74, 4, 0
  s_lshr_b64 s[100:101], s[100:101], s74
  s_and_b32 s73, s100, 15
  s_sub_u32 s92, s92, 1
  s_cselect_b32 s73, s91, s73
  s_cselect_b32 s74, 0, 4
  s_lshr_b64 s[100:101], s[100:101], s74
  s_mul_i32 s74, s73, 393216
  s_lshl_b32 s73, s73, 7
  s_add_u32 s75, s75, 43008
  s_cmp_eq_u32 s75, 129024
  s_cselect_b32 s75, 0, s75
  s_buffer_load_dword s84, s[48:51], s98 offset:0
  s_buffer_load_dword s84, s[48:51], s98 offset:64
  s_buffer_load_dword s84, s[48:51], s98 offset:128
  s_buffer_load_dword s84, s[48:51], s98 offset:192
  s_add_u32 s98, s98, 256
  buffer_load_dwordx4 v[88:91], v26, s[52:55], s95 offen
  s_add_u32 s95, s95, 57344
  buffer_load_dwordx4 v[92:95], v26, s[52:55], s95 offen
  s_waitcnt vmcnt(15)
  s_barrier
  s_add_u32 s3, s75, s76
  s_add_u32 m0, s3, 0
  s_nop 0
  buffer_load_dwordx4 v4, s[36:39], s73 offen lds
  s_add_u32 m0, s3, 1024
  s_nop 0
  buffer_load_dwordx4 v5, s[36:39], s73 offen lds
  s_add_u32 m0, s3, 2048
  s_nop 0
  buffer_load_dwordx4 v6, s[36:39], s73 offen lds
  s_add_u32 m0, s3, 3072
  s_nop 0
  buffer_load_dwordx4 v7, s[36:39], s73 offen lds
  s_add_u32 m0, s78, s75
  s_mov_b64 exec, s[14:15]
  buffer_load_dwordx4 v28, s[36:39], s73 offen lds
  s_mov_b64 exec, -1
  s_add_u32 s3, s75, s77
  s_add_u32 m0, s3, 0
  s_add_u32 s4, s74, 0
  buffer_load_dwordx4 v8, s[40:43], s4 offen lds
  s_add_u32 m0, s3, 1024
  s_nop 0
  buffer_load_dwordx4 v9, s[40:43], s4 offen lds
  s_add_u32 m0, s3, 8192
  s_add_u32 s4, s74, 2048
  buffer_load_dwordx4 v8, s[40:43], s4 offen lds
  s_add_u32 m0, s3, 9216
  s_nop 0
  buffer_load_dwordx4 v9, s[40:43], s4 offen lds
  s_add_u32 m0, s3, 16384
  s_add_u32 s4, s74, 4096
  buffer_load_dwordx4 v8, s[40:43], s4 offen lds
  s_add_u32 m0, s3, 17408
  s_nop 0
  buffer_load_dwordx4 v9, s[40:43], s4 offen lds
  s_and_b32 s73, s100, 15
  s_cmp_eq_u32 s73, s91
  s_cselect_b32 s74, 4, 0
  s_lshr_b64 s[100:101], s[100:101], s74
  s_and_b32 s73, s100, 15
  s_sub_u32 s92, s92, 1
  s_cselect_b32 s73, s91, s73
  s_cselect_b32 s74, 0, 4
  s_lshr_b64 s[100:101], s[100:101], s74
  s_mul_i32 s74, s73, 393216
  s_lshl_b32 s73, s73, 7
  s_add_u32 s75, s75, 43008
  s_cmp_eq_u32 s75, 129024
  s_cselect_b32 s75, 0, s75
  s_buffer_load_dword s84, s[48:51], s98 offset:0
  s_buffer_load_dword s84, s[48:51], s98 offset:64
  s_buffer_load_dword s84, s[48:51], s98 offset:128
  s_buffer_load_dword s84, s[48:51], s98 offset:192
  s_add_u32 s98, s98, 256
  s_waitcnt vmcnt(13)
  s_barrier
  s_mov_b32 s79, 8
L_attn0_ld1:
  s_add_u32 s3, s75, s76
  s_add_u32 m0, s3, 0
  s_nop 0
  buffer_load_dwordx4 v4, s[36:39], s73 offen lds
  s_add_u32 m0, s3, 1024
  s_nop 0
  buffer_load_dwordx4 v5, s[36:39], s73 offen lds
  s_add_u32 m0, s3, 2048
  s_nop 0
  buffer_load_dwordx4 v6, s[36:39], s73 offen lds
  s_add_u32 m0, s3, 3072
  s_nop 0
  buffer_load_dwordx4 v7, s[36:39], s73 offen lds
  s_add_u32 m0, s78, s75
  s_mov_b64 exec, s[14:15]
  buffer_load_dwordx4 v28, s[36:39], s73 offen lds
  s_mov_b64 exec, -1
  s_add_u32 s3, s75, s77
  s_add_u32 m0, s3, 0
  s_add_u32 s4, s74, 0
  buffer_load_dwordx4 v8, s[40:43], s4 offen lds
  s_add_u32 m0, s3, 1024
  s_nop 0
  buffer_load_dwordx4 v9, s[40:43], s4 offen lds
  s_add_u32 m0, s3, 8192
  s_add_u32 s4, s74, 2048
  buffer_load_dwordx4 v8, s[40:43], s4 offen lds
  s_add_u32 m0, s3, 9216
  s_nop 0
  buffer_load_dwordx4 v9, s[40:43], s4 offen lds
  s_add_u32 m0, s3, 16384
  s_add_u32 s4, s74, 4096
  buffer_load_dwordx4 v8, s[40:43], s4 offen lds
  s_add_u32 m0, s3, 17408
  s_nop 0
  buffer_load_dwordx4 v9, s[40:43], s4 offen lds
  s_and_b32 s73, s100, 15
  s_cmp_eq_u32 s73, s91
  s_cselect_b32 s74, 4, 0
  s_lshr_b64 s[100:101], s[100:101], s74
  s_and_b32 s73, s100, 15
  s_sub_u32 s92, s92, 1
  s_cselect_b32 s73, s91, s73
  s_cselect_b32 s74, 0, 4
  s_lshr_b64 s[100:101], s[100:101], s74
  s_mul_i32 s74, s73, 393216
  s_lshl_b32 s73, s73, 7
  s_add_u32 s75, s75, 43008
  s_cmp_eq_u32 s75, 129024
  s_cselect_b32 s75, 0, s75
  s_buffer_load_dword s84, s[48:51], s98 offset:0
  s_buffer_load_dword s84, s[48:51], s98 offset:64
  s_buffer_load_dword s84, s[48:51], s98 offset:128
  s_buffer_load_dword s84, s[48:51], s98 offset:192
  s_add_u32 s98, s98, 256
  s_waitcnt vmcnt(11)
  s_barrier
  s_sub_u32 s79, s79, 1
  s_cmp_lg_u32 s79, 0
  s_cbranch_scc1 L_attn0_ld1
  buffer_load_dword v21, v20, s[64:67], 0 offen sc1
  s_add_u32 s3, s75, s76
  s_add_u32 m0, s3, 0
  s_nop 0
  buffer_load_dwordx4 v4, s[36:39], s73 offen lds
  s_add_u32 m0, s3, 1024
  s_nop 0
  buffer_load_dwordx4 v5, s[36:39], s73 offen lds
  s_add_u32 m0, s3, 2048
  s_nop 0
  buffer_load_dwordx4 v6, s[36:39], s73 offen lds
  s_add_u32 m0, s3, 3072
  s_nop 0
  buffer_load_dwordx4 v7, s[36:39], s73 offen lds
  s_add_u32 m0, s78, s75
  s_mov_b64 exec, s[14:15]
  buffer_load_dwordx4 v28, s[36:39], s73 offen lds
  s_mov_b64 exec, -1
  s_add_u32 s3, s75, s77
  s_add_u32 m0, s3, 0
  s_add_u32 s4, s74, 0
  buffer_load_dwordx4 v8, s[40:43], s4 offen lds
  s_add_u32 m0, s3, 1024
  s_nop 0
  buffer_load_dwordx4 v9, s[40:43], s4 offen lds
  s_add_u32 m0, s3, 8192
  s_add_u32 s4, s74, 2048
  buffer_load_dwordx4 v8, s[40:43], s4 offen lds
  s_add_u32 m0, s3, 9216
  s_nop 0
  buffer_load_dwordx4 v9, s[40:43], s4 offen lds
  s_add_u32 m0, s3, 16384
  s_add_u32 s4, s74, 4096
  buffer_load_dwordx4 v8, s[40:43], s4 offen lds
  s_add_u32 m0, s3, 17408
  s_nop 0
  buffer_load_dwordx4 v9, s[40:43], s4 offen lds
  s_and_b32 s73, s100, 15
  s_cmp_eq_u32 s73, s91
  s_cselect_b32 s74, 4, 0
  s_lshr_b64 s[100:101], s[100:101], s74
  s_and_b32 s73, s100, 15
  s_sub_u32 s92, s92, 1
  s_cselect_b32 s73, s91, s73
  s_cselect_b32 s74, 0, 4
  s_lshr_b64 s[100:101], s[100:101], s74
  s_mul_i32 s74, s73, 393216
  s_lshl_b32 s73, s73, 7
  s_add_u32 s75, s75, 43008
  s_cmp_eq_u32 s75, 129024
  s_cselect_b32 s75, 0, s75
  s_buffer_load_dword s84, s[48:51], s98 offset:0
  s_buffer_load_dword s84, s[48:51], s98 offset:64
  s_buffer_load_dword s84, s[48:51], s98 offset:128
  s_buffer_load_dword s84, s[48:51], s98 offset:192
  s_add_u32 s98, s98, 256
  s_waitcnt vmcnt(12)
  s_barrier
  s_waitcnt vmcnt(11)
  s_mov_b32 s5, 0x100000
  L_attn_dchk:
  v_or_b32 v13, 0xfefefefe, v21
  v_cmp_ne_u32 vcc, -1, v13
  s_cbranch_vccz L_attn_dok
  s_sub_u32 s5, s5, 1
  buffer_load_dword v21, v20, s[64:67], 0 offen sc1
  s_waitcnt vmcnt(0)
  s_cbranch_scc0 L_attn_dchk
  L_attn_dok:
  buffer_load_dwordx4 v[32:35], v18, s[56:59], 0 offen
  s_mov_b32 s3, 65536
  buffer_load_dwordx4 v[36:39], v18, s[56:59], s3 offen
  s_mov_b32 s3, 131072
  buffer_load_dwordx4 v[40:43], v18, s[56:59], s3 offen
  s_mov_b32 s3, 196608
  buffer_load_dwordx4 v[44:47], v18, s[56:59], s3 offen
  buffer_load_dwordx2 v[48:49], v19, s[56:59], 0 offen
  s_mov_b32 s5, 0xffff0000
  v_lshlrev_b32 v100, 16, v64
  v_and_b32 v101, s5, v64
  v_lshlrev_b32 v102, 16, v65
  v_and_b32 v103, s5, v65
  v_lshlrev_b32 v104, 16, v66
  v_and_b32 v105, s5, v66
  v_lshlrev_b32 v106, 16, v67
  v_and_b32 v107, s5, v67
  v_lshlrev_b32 v108, 16, v68
  v_and_b32 v68, s5, v68
  v_add_f32 v100, v100, v108
  v_add_f32 v101, v101, v68
  v_lshlrev_b32 v108, 16, v69
  v_and_b32 v69, s5, v69
  v_add_f32 v102, v102, v108
  v_add_f32 v103, v103, v69
  v_lshlrev_b32 v108, 16, v70
  v_and_b32 v70, s5, v70
  v_add_f32 v104, v104, v108
  v_add_f32 v105, v105, v70
  v_lshlrev_b32 v108, 16, v71
  v_and_b32 v71, s5, v71
  v_add_f32 v106, v106, v108
  v_add_f32 v107, v107, v71
  v_lshlrev_b32 v108, 16, v72
  v_and_b32 v72, s5, v72
  v_add_f32 v100, v100, v108
  v_add_f32 v101, v101, v72
  v_lshlrev_b32 v108, 16, v73
  v_and_b32 v73, s5, v73
  v_add_f32 v102, v102, v108
  v_add_f32 v103, v103, v73
  v_lshlrev_b32 v108, 16, v74
  v_and_b32 v74, s5, v74
  v_add_f32 v104, v104, v108
  v_add_f32 v105, v105, v74
  v_lshlrev_b32 v108, 16, v75
  v_and_b32 v75, s5, v75
  v_add_f32 v106, v106, v108
  v_add_f32 v107, v107, v75
  v_lshlrev_b32 v108, 16, v76
  v_and_b32 v76, s5, v76
  v_add_f32 v100, v100, v108
  v_add_f32 v101, v101, v76
  v_lshlrev_b32 v108, 16, v77
  v_and_b32 v77, s5, v77
  v_add_f32 v102, v102, v108
  v_add_f32 v103, v103, v77
  v_lshlrev_b32 v108, 16, v78
  v_and_b32 v78, s5, v78
  v_add_f32 v104, v104, v108
  v_add_f32 v105, v105, v78
  v_lshlrev_b32 v108, 16, v79
  v_and_b32 v79, s5, v79
  v_add_f32 v106, v106, v108
  v_add_f32 v107, v107, v79
  s_mov_b32 s60, s20
  s_and_b32 s61, s21, 0xffff
  s_mov_b32 s62, 2097152
  s_mov_b32 s63, 0x00020000
  s_and_b32 s3, s70, 3
  s_mul_i32 s3, s3, 8
  s_mul_i32 s4, s99, 32
  s_add_u32 s3, s3, s4
  v_lshrrev_b32 v2, 3, v1
  v_add_u32 v2, s3, v2
  v_mul_u32_u24 v2, 2048, v2
  v_and_b32 v3, 7, v1
  v_lshl_add_u32 v2, v3, 8, v2
  s_and_b32 s3, s2, 7
  s_lshr_b32 s3, s3, 2
  s_mul_i32 s3, s3, 128
  buffer_load_dword v96, v2, s[60:63], s3 offen
  s_waitcnt vmcnt(6)
  s_barrier
  s_mov_b32 s79, 0x4000
  s_waitcnt vmcnt(1)
L_attn_schk:
  v_add_f32 v32, v32, v36
  v_add_f32 v33, v33, v37
  v_add_f32 v34, v34, v38
  v_add_f32 v35, v35, v39
  v_add_f32 v40, v40, v44
  v_add_f32 v41, v41, v45
  v_add_f32 v42, v42, v46
  v_add_f32 v43, v43, v47
  v_add_f32 v32, v32, v40
  v_add_f32 v33, v33, v41
  v_add_f32 v34, v34, v42
  v_add_f32 v35, v35, v43
  s_nop 1
  v_permlane32_swap_b32 v32, v34
  v_permlane32_swap_b32 v33, v35
  v_add_f32 v32, v32, v34
  v_add_f32 v33, v33, v35
  v_cmp_u_f32 vcc, v32, v33
  v_cmp_u_f32 s[4:5], v48, v49
  s_or_b64 s[4:5], vcc, s[4:5]
  s_cbranch_scc0 L_attn_sok
  s_sub_u32 s79, s79, 1
  s_cbranch_scc1 L_attn_sok
  buffer_load_dwordx4 v[32:35], v18, s[56:59], 0 offen sc1
  s_mov_b32 s3, 65536
  buffer_load_dwordx4 v[36:39], v18, s[56:59], s3 offen sc1
  s_mov_b32 s3, 131072
  buffer_load_dwordx4 v[40:43], v18, s[56:59], s3 offen sc1
  s_mov_b32 s3, 196608
  buffer_load_dwordx4 v[44:47], v18, s[56:59], s3 offen sc1
  buffer_load_dwordx2 v[48:49], v19, s[56:59], 0 offen sc1
  s_waitcnt vmcnt(0)
  s_branch L_attn_schk
L_attn_sok:
  v_mov_b32 v34, v32
  v_mov_b32 v35, v33
  s_nop 0
  v_permlane16_swap_b32 v32, v34
  v_permlane16_swap_b32 v33, v35
  v_add_f32 v32, v32, v34
  v_add_f32 v33, v33, v35
  v_mul_f32 v32, 0x3a800000, v32
  v_mul_f32 v33, 0x3a800000, v33
  v_fma_f32 v33, -v32, v32, v33
  v_max_f32 v33, 0, v33
  v_add_f32 v33, 0x3727c5ac, v33
  v_rsq_f32 v33, v33
  s_nop 0
  s_and_b32 s3, s70, 3
  s_lshl_b32 s5, s3, 7
  s_add_u32 s5, s5, 129088
  v_and_b32 v3, 15, v1
  v_lshrrev_b32 v2, 5, v1
  v_lshl_add_u32 v2, v3, 1, v2
  v_lshl_add_u32 v2, v2, 2, s5
  ds_write2_b32 v2, v32, v33 offset0:0 offset1:160
  v_mov_b32 v50, v48
  v_mov_b32 v51, v49
  s_nop 0
  v_permlane32_swap_b32 v48, v50
  v_permlane32_swap_b32 v49, v51
  v_add_f32 v48, v48, v50
  v_add_f32 v49, v49, v51
  v_mov_b32 v50, v48
  v_mov_b32 v51, v49
  s_nop 0
  v_permlane16_swap_b32 v48, v50
  v_permlane16_swap_b32 v49, v51
  v_add_f32 v48, v48, v50
  v_add_f32 v49, v49, v51
  s_nop 1
  v_add_f32_dpp v48, v48, v48 row_ror:8 row_mask:0xf bank_mask:0xf
  v_add_f32_dpp v49, v49, v49 row_ror:8 row_mask:0xf bank_mask:0xf
  s_nop 1
  v_add_f32_dpp v48, v48, v48 row_ror:4 row_mask:0xf bank_mask:0xf
  v_add_f32_dpp v49, v49, v49 row_ror:4 row_mask:0xf bank_mask:0xf
  v_mul_f32 v48, 0x3a800000, v48
  v_mul_f32 v49, 0x3a800000, v49
  v_fma_f32 v49, -v48, v48, v49
  v_max_f32 v49, 0, v49
  v_add_f32 v49, 0x3727c5ac, v49
  v_rsq_f32 v49, v49
  s_nop 0
  s_lshl_b32 s5, s3, 4
  s_add_u32 s5, s5, 129024
  v_and_b32 v3, 3, v1
  v_lshl_add_u32 v2, v3, 2, s5
  ds_write2_b32 v2, v48, v49 offset0:0 offset1:160
  s_mov_b32 s5, 0xffff0000
  v_lshlrev_b32 v108, 16, v80
  v_and_b32 v80, s5, v80
  v_add_f32 v100, v100, v108
  v_add_f32 v101, v101, v80
  v_lshlrev_b32 v108, 16, v81
  v_and_b32 v81, s5, v81
  v_add_f32 v102, v102, v108
  v_add_f32 v103, v103, v81
  v_lshlrev_b32 v108, 16, v82
  v_and_b32 v82, s5, v82
  v_add_f32 v104, v104, v108
  v_add_f32 v105, v105, v82
  v_lshlrev_b32 v108, 16, v83
  v_and_b32 v83, s5, v83
  v_add_f32 v106, v106, v108
  v_add_f32 v107, v107, v83
  v_lshlrev_b32 v108, 16, v84
  v_and_b32 v84, s5, v84
  v_add_f32 v100, v100, v108
  v_add_f32 v101, v101, v84
  v_lshlrev_b32 v108, 16, v85
  v_and_b32 v85, s5, v85
  v_add_f32 v102, v102, v108
  v_add_f32 v103, v103, v85
  v_lshlrev_b32 v108, 16, v86
  v_and_b32 v86, s5, v86
  v_add_f32 v104, v104, v108
  v_add_f32 v105, v105, v86
  v_lshlrev_b32 v108, 16, v87
  v_and_b32 v87, s5, v87
  v_add_f32 v106, v106, v108
  v_add_f32 v107, v107, v87
  v_lshlrev_b32 v108, 16, v88
  v_and_b32 v88, s5, v88
  v_add_f32 v100, v100, v108
  v_add_f32 v101, v101, v88
  v_lshlrev_b32 v108, 16, v89
  v_and_b32 v89, s5, v89
  v_add_f32 v102, v102, v108
  v_add_f32 v103, v103, v89
  v_lshlrev_b32 v108, 16, v90
  v_and_b32 v90, s5, v90
  v_add_f32 v104, v104, v108
  v_add_f32 v105, v105, v90
  v_lshlrev_b32 v108, 16, v91
  v_and_b32 v91, s5, v91
  v_add_f32 v106, v106, v108
  v_add_f32 v107, v107, v91
  v_lshlrev_b32 v108, 16, v92
  v_and_b32 v92, s5, v92
  v_add_f32 v100, v100, v108
  v_add_f32 v101, v101, v92
  v_lshlrev_b32 v108, 16, v93
  v_and_b32 v93, s5, v93
  v_add_f32 v102, v102, v108
  v_add_f32 v103, v103, v93
  v_lshlrev_b32 v108, 16, v94
  v_and_b32 v94, s5, v94
  v_add_f32 v104, v104, v108
  v_add_f32 v105, v105, v94
  v_lshlrev_b32 v108, 16, v95
  v_and_b32 v95, s5, v95
  v_add_f32 v106, v106, v108
  v_add_f32 v107, v107, v95
  s_add_u32 s52, s22, 24641536
  s_addc_u32 s53, s23, 0
  s_and_b32 s53, s53, 0xffff
  s_mov_b32 s54, 262144
  s_mov_b32 s55, 0x00020000
  v_permlane32_swap_b32 v100, v104
  v_permlane32_swap_b32 v101, v105
  v_permlane32_swap_b32 v102, v106
  v_permlane32_swap_b32 v103, v107
  v_add_f32 v100, v100, v104
  v_add_f32 v101, v101, v105
  v_add_f32 v102, v102, v106
  v_add_f32 v103, v103, v107
  v_and_b32 v2, 7, v1
  v_lshlrev_b32 v2, 5, v2
  v_permlane16_swap_b32 v100, v102
  v_permlane16_swap_b32 v101, v103
  v_add_f32 v100, v100, v102
  v_add_f32 v101, v101, v103
  v_lshrrev_b32 v3, 4, v1
  v_lshl_add_u32 v102, v3, 3, v2
  v_add_f32_dpp v100, v100, v100 row_ror:8 row_mask:0xf bank_mask:0xf
  v_add_f32_dpp v101, v101, v101 row_ror:8 row_mask:0xf bank_mask:0xf
  buffer_store_dwordx2 v[100:101], v102, s[52:55], s94 offen sc1
  s_waitcnt lgkmcnt(0)
  s_barrier
  s_branch L_attn_ldend
L_attn_ld1:
  s_add_u32 s3, s68, s69
  s_and_b32 s3, s3, 3
  s_mov_b32 s100, 0x68532410
  s_mov_b32 s101, 0xfedbac97
  s_cmp_eq_u32 s3, 1
  s_cselect_b32 s100, 0x96435210, s100
  s_cselect_b32 s101, 0xfecbda87, s101
  s_cmp_eq_u32 s3, 2
  s_cselect_b32 s100, 0x75463210, s100
  s_cselect_b32 s101, 0xfdceb98a, s101
  s_cmp_eq_u32 s3, 3
  s_cselect_b32 s100, 0x65743210, s100
  s_cselect_b32 s101, 0xedfca9b8, s101
  s_add_u32 s56, s22, 24379392
  s_addc_u32 s57, s23, 0
  s_and_b32 s57, s57, 0xffff
  s_mov_b32 s58, 262144
  s_mov_b32 s59, 0x00020000
  s_and_b32 s3, s70, 3
  s_lshl2_add_u32 s4, s68, s3
  s_lshl_b32 s4, s4, 8
  v_lshrrev_b32 v2, 4, v1
  v_and_b32 v3, 15, v1
  v_lshl_add_u32 v3, v3, 4, s4
  v_lshl_add_u32 v18, v2, 14, v3
  s_lshl_b32 s4, s68, 5
  s_add_u32 s4, s4, s3
  s_sub_u32 s4, s4, 4
  s_max_i32 s4, s4, 0
  s_lshl_b32 s4, s4, 5
  v_lshrrev_b32 v2, 2, v1
  v_and_b32 v3, 3, v1
  v_lshl_add_u32 v3, v3, 3, s4
  v_lshl_add_u32 v19, v2, 14, v3
  s_add_u32 s64, s22, 41943040
  s_addc_u32 s65, s23, 0
  s_and_b32 s65, s65, 0xffff
  s_mov_b32 s66, 524288
  s_mov_b32 s67, 0x00020000
  v_and_b32 v30, 3, v1
  v_lshlrev_b32 v30, 6, v30
  s_mov_b32 s79, 0x100000
  s_cmp_lg_u32 s70, 4
  s_cbranch_scc1 L_attn_xgo
  s_setprio 3
L_attn_xpoll:
  buffer_load_dword v12, v30, s[64:67], s86 offen sc1
  s_sub_u32 s79, s79, 1
  s_cbranch_scc1 L_attn_xgo
  s_waitcnt vmcnt(0)
  v_cmp_ne_u32 vcc, 1, v12
  s_cbranch_vccnz L_attn_xpoll
L_attn_xgo:
  s_setprio 0
  s_barrier
  s_lshr_b32 s3, s69, 3
  s_and_b32 s73, s69, 7
  s_lshl1_add_u32 s91, s73, s3
  s_mul_i32 s74, s91, 393216
  s_lshl_b32 s73, s91, 7
  s_mov_b32 s88, s73
  s_add_u32 m0, s77, 0
  s_add_u32 s4, s74, 0
  buffer_load_dwordx4 v8, s[40:43], s4 offen lds
  s_add_u32 m0, s77, 1024
  s_nop 0
  buffer_load_dwordx4 v9, s[40:43], s4 offen lds
  s_add_u32 m0, s77, 8192
  s_add_u32 s4, s74, 2048
  buffer_load_dwordx4 v8, s[40:43], s4 offen lds
  s_add_u32 m0, s77, 9216
  s_nop 0
  buffer_load_dwordx4 v9, s[40:43], s4 offen lds
  s_add_u32 m0, s77, 16384
  s_add_u32 s4, s74, 4096
  buffer_load_dwordx4 v8, s[40:43], s4 offen lds
  s_add_u32 m0, s77, 17408
  s_nop 0
  buffer_load_dwordx4 v9, s[40:43], s4 offen lds
  s_and_b32 s73, s100, 15
  s_cmp_eq_u32 s73, s91
  s_cselect_b32 s74, 4, 0
  s_lshr_b64 s[100:101], s[100:101], s74
  s_and_b32 s73, s100, 15
  s_lshr_b64 s[100:101], s[100:101], 4
  s_mul_i32 s74, s73, 393216
  s_lshl_b32 s73, s73, 7
  s_mov_b32 s75, 0
  s_add_u32 s44, s22, 41943040
  s_addc_u32 s45, s23, 0
  s_and_b32 s45, s45, 0xffff
  s_mov_b32 s46, 524288
  s_mov_b32 s47, 0x00020000
  s_lshl4_add_u32 s3, s97, s68
  s_and_b32 s4, s69, 15
  s_lshl4_add_u32 s3, s3, s4
  s_lshl_b32 s3, s3, 7
  s_sub_u32 s3, s3, 32768
  v_lshlrev_b32 v11, 7, v1
  s_cmp_eq_u32 s68, 0
  s_cselect_b32 s4, 15, 31
  v_and_b32 v2, 16, v1
  v_lshl_add_u32 v11, v2, 2, v11
  v_and_b32 v2, s4, v1
  v_lshlrev_b32 v2, 2, v2
  v_mov_b32 v3, 1
  s_mov_b32 s79, 0x100000
  s_waitcnt vmcnt(0)
  s_cmp_lg_u32 s70, 4
  s_barrier
  s_cbranch_scc1 L_attn_nofl
  s_mov_b32 exec_lo, 0xffffffff
  s_mov_b32 exec_hi, 0
  buffer_store_dword v3, v11, s[44:47], s87 offen sc1
  s_mov_b64 exec, -1
L_attn_nofl:
  s_mov_b32 s5, s3
  s_mov_b32 s89, s73
  s_add_u32 m0, s77, 43008
  s_add_u32 s4, s74, 0
  buffer_load_dwordx4 v8, s[40:43], s4 offen lds
  s_add_u32 m0, s77, 44032
  s_nop 0
  buffer_load_dwordx4 v9, s[40:43], s4 offen lds
  s_add_u32 m0, s77, 51200
  s_add_u32 s4, s74, 2048
  buffer_load_dwordx4 v8, s[40:43], s4 offen lds
  s_add_u32 m0, s77, 52224
  s_nop 0
  buffer_load_dwordx4 v9, s[40:43], s4 offen lds
  s_add_u32 m0, s77, 59392
  s_add_u32 s4, s74, 4096
  buffer_load_dwordx4 v8, s[40:43], s4 offen lds
  s_add_u32 m0, s77, 60416
  s_nop 0
  buffer_load_dwordx4 v9, s[40:43], s4 offen lds
  s_and_b32 s73, s100, 15
  s_cmp_eq_u32 s73, s91
  s_cselect_b32 s74, 4, 0
  s_lshr_b64 s[100:101], s[100:101], s74
  s_and_b32 s73, s100, 15
  s_lshr_b64 s[100:101], s[100:101], 4
  s_mul_i32 s74, s73, 393216
  s_lshl_b32 s73, s73, 7
  s_mov_b32 s90, s73
  s_add_u32 m0, s77, 86016
  s_add_u32 s4, s74, 0
  buffer_load_dwordx4 v8, s[40:43], s4 offen lds
  s_add_u32 m0, s77, 87040
  s_nop 0
  buffer_load_dwordx4 v9, s[40:43], s4 offen lds
  s_add_u32 m0, s77, 94208
  s_add_u32 s4, s74, 2048
  buffer_load_dwordx4 v8, s[40:43], s4 offen lds
  s_add_u32 m0, s77, 95232
  s_nop 0
  buffer_load_dwordx4 v9, s[40:43], s4 offen lds
  s_add_u32 m0, s77, 102400
  s_add_u32 s4, s74, 4096
  buffer_load_dwordx4 v8, s[40:43], s4 offen lds
  s_add_u32 m0, s77, 103424
  s_nop 0
  buffer_load_dwordx4 v9, s[40:43], s4 offen lds
  s_and_b32 s73, s100, 15
  s_cmp_eq_u32 s73, s91
  s_cselect_b32 s74, 4, 0
  s_lshr_b64 s[100:101], s[100:101], s74
  s_and_b32 s73, s100, 15
  s_lshr_b64 s[100:101], s[100:101], 4
  s_mul_i32 s74, s73, 393216
  s_lshl_b32 s73, s73, 7
  s_mov_b32 s3, s5
  s_cmp_lg_u32 s70, 4
  s_cbranch_scc1 L_attn_dep
L_attn_poll:
  buffer_load_dword v3, v2, s[44:47], s3 offen sc1
  s_sub_u32 s79, s79, 1
  s_cbranch_scc1 L_attn_dep
  s_waitcnt vmcnt(0)
  v_cmp_ne_u32 vcc, 1, v3
  s_cbranch_vccnz L_attn_poll
L_attn_dep:
  s_waitcnt vmcnt(6)
  s_barrier
  s_add_u32 m0, s78, 89344
  s_mov_b64 exec, s[14:15]
  buffer_load_dwordx4 v28, s[36:39], s88 offen lds
  s_mov_b64 exec, -1
  s_add_u32 m0, s76, 43008
  s_nop 0
  buffer_load_dwordx4 v4, s[36:39], s89 offen lds
  s_add_u32 m0, s76, 44032
  s_nop 0
  buffer_load_dwordx4 v5, s[36:39], s89 offen lds
  s_add_u32 m0, s76, 45056
  s_nop 0
  buffer_load_dwordx4 v6, s[36:39], s89 offen lds
  s_add_u32 m0, s76, 46080
  s_nop 0
  buffer_load_dwordx4 v7, s[36:39], s89 offen lds
  s_add_u32 m0, s78, 43008
  s_mov_b64 exec, s[14:15]
  buffer_load_dwordx4 v28, s[36:39], s89 offen lds
  s_mov_b64 exec, -1
  s_add_u32 m0, s76, 86016
  s_nop 0
  buffer_load_dwordx4 v4, s[36:39], s90 offen lds
  s_add_u32 m0, s76, 87040
  s_nop 0
  buffer_load_dwordx4 v5, s[36:39], s90 offen lds
  s_add_u32 m0, s76, 88064
  s_nop 0
  buffer_load_dwordx4 v6, s[36:39], s90 offen lds
  s_add_u32 m0, s76, 89088
  s_nop 0
  buffer_load_dwordx4 v7, s[36:39], s90 offen lds
  s_add_u32 m0, s78, 86016
  s_mov_b64 exec, s[14:15]
  buffer_load_dwordx4 v28, s[36:39], s90 offen lds
  s_mov_b64 exec, -1
  s_waitcnt vmcnt(5)
  s_barrier
  s_mov_b32 s79, 12
L_attn1_ld1:
  s_add_u32 s3, s75, s76
  s_add_u32 m0, s3, 0
  s_nop 0
  buffer_load_dwordx4 v4, s[36:39], s73 offen lds
  s_add_u32 m0, s3, 1024
  s_nop 0
  buffer_load_dwordx4 v5, s[36:39], s73 offen lds
  s_add_u32 m0, s3, 2048
  s_nop 0
  buffer_load_dwordx4 v6, s[36:39], s73 offen lds
  s_add_u32 m0, s3, 3072
  s_nop 0
  buffer_load_dwordx4 v7, s[36:39], s73 offen lds
  s_add_u32 m0, s78, s75
  s_mov_b64 exec, s[14:15]
  buffer_load_dwordx4 v28, s[36:39], s73 offen lds
  s_mov_b64 exec, -1
  s_add_u32 s3, s75, s77
  s_add_u32 m0, s3, 0
  s_add_u32 s4, s74, 0
  buffer_load_dwordx4 v8, s[40:43], s4 offen lds
  s_add_u32 m0, s3, 1024
  s_nop 0
  buffer_load_dwordx4 v9, s[40:43], s4 offen lds
  s_add_u32 m0, s3, 8192
  s_add_u32 s4, s74, 2048
  buffer_load_dwordx4 v8, s[40:43], s4 offen lds
  s_add_u32 m0, s3, 9216
  s_nop 0
  buffer_load_dwordx4 v9, s[40:43], s4 offen lds
  s_add_u32 m0, s3, 16384
  s_add_u32 s4, s74, 4096
  buffer_load_dwordx4 v8, s[40:43], s4 offen lds
  s_add_u32 m0, s3, 17408
  s_nop 0
  buffer_load_dwordx4 v9, s[40:43], s4 offen lds
  s_and_b32 s73, s100, 15
  s_cmp_eq_u32 s73, s91
  s_cselect_b32 s74, 4, 0
  s_lshr_b64 s[100:101], s[100:101], s74
  s_and_b32 s73, s100, 15
  s_lshr_b64 s[100:101], s[100:101], 4
  s_mul_i32 s74, s73, 393216
  s_lshl_b32 s73, s73, 7
  s_add_u32 s75, s75, 43008
  s_cmp_eq_u32 s75, 129024
  s_cselect_b32 s75, 0, s75
  s_waitcnt vmcnt(11)
  s_barrier
  s_sub_u32 s79, s79, 1
  s_cmp_lg_u32 s79, 0
  s_cbranch_scc1 L_attn1_ld1
  s_add_u32 s3, s75, s76
  s_add_u32 m0, s3, 0
  s_nop 0
  buffer_load_dwordx4 v4, s[36:39], s73 offen lds
  s_add_u32 m0, s3, 1024
  s_nop 0
  buffer_load_dwordx4 v5, s[36:39], s73 offen lds
  s_add_u32 m0, s3, 2048
  s_nop 0
  buffer_load_dwordx4 v6, s[36:39], s73 offen lds
  s_add_u32 m0, s3, 3072
  s_nop 0
  buffer_load_dwordx4 v7, s[36:39], s73 offen lds
  s_add_u32 m0, s78, s75
  s_mov_b64 exec, s[14:15]
  buffer_load_dwordx4 v28, s[36:39], s73 offen lds
  s_mov_b64 exec, -1
  s_add_u32 s3, s75, s77
  s_add_u32 m0, s3, 0
  s_add_u32 s4, s74, 0
  buffer_load_dwordx4 v8, s[40:43], s4 offen lds
  s_add_u32 m0, s3, 1024
  s_nop 0
  buffer_load_dwordx4 v9, s[40:43], s4 offen lds
  s_add_u32 m0, s3, 8192
  s_add_u32 s4, s74, 2048
  buffer_load_dwordx4 v8, s[40:43], s4 offen lds
  s_add_u32 m0, s3, 9216
  s_nop 0
  buffer_load_dwordx4 v9, s[40:43], s4 offen lds
  s_add_u32 m0, s3, 16384
  s_add_u32 s4, s74, 4096
  buffer_load_dwordx4 v8, s[40:43], s4 offen lds
  s_add_u32 m0, s3, 17408
  s_nop 0
  buffer_load_dwordx4 v9, s[40:43], s4 offen lds
  s_and_b32 s73, s100, 15
  s_cmp_eq_u32 s73, s91
  s_cselect_b32 s74, 4, 0
  s_lshr_b64 s[100:101], s[100:101], s74
  s_and_b32 s73, s100, 15
  s_lshr_b64 s[100:101], s[100:101], 4
  s_mul_i32 s74, s73, 393216
  s_lshl_b32 s73, s73, 7
  s_add_u32 s75, s75, 43008
  s_cmp_eq_u32 s75, 129024
  s_cselect_b32 s75, 0, s75
  s_mov_b32 s60, s20
  s_and_b32 s61, s21, 0xffff
  s_mov_b32 s62, 2097152
  s_mov_b32 s63, 0x00020000
  s_and_b32 s3, s70, 3
  s_mul_i32 s3, s3, 8
  s_mul_i32 s4, s99, 32
  s_add_u32 s3, s3, s4
  v_lshrrev_b32 v2, 3, v1
  v_add_u32 v2, s3, v2
  v_mul_u32_u24 v2, 2048, v2
  v_and_b32 v3, 7, v1
  v_lshl_add_u32 v2, v3, 8, v2
  s_and_b32 s3, s2, 7
  s_lshr_b32 s3, s3, 2
  s_mul_i32 s3, s3, 128
  buffer_load_dword v96, v2, s[60:63], s3 offen
  s_waitcnt vmcnt(12)
  s_barrier
  buffer_load_dwordx4 v[32:35], v18, s[56:59], 0 offen
  s_mov_b32 s3, 65536
  buffer_load_dwordx4 v[36:39], v18, s[56:59], s3 offen
  s_mov_b32 s3, 131072
  buffer_load_dwordx4 v[40:43], v18, s[56:59], s3 offen
  s_mov_b32 s3, 196608
  buffer_load_dwordx4 v[44:47], v18, s[56:59], s3 offen
  buffer_load_dwordx2 v[48:49], v19, s[56:59], 0 offen
  s_waitcnt vmcnt(6)
  s_barrier
  s_waitcnt vmcnt(0)
  v_add_f32 v32, v32, v36
  v_add_f32 v33, v33, v37
  v_add_f32 v34, v34, v38
  v_add_f32 v35, v35, v39
  v_add_f32 v40, v40, v44
  v_add_f32 v41, v41, v45
  v_add_f32 v42, v42, v46
  v_add_f32 v43, v43, v47
  v_add_f32 v32, v32, v40
  v_add_f32 v33, v33, v41
  v_add_f32 v34, v34, v42
  v_add_f32 v35, v35, v43
  s_nop 1
  v_permlane32_swap_b32 v32, v34
  v_permlane32_swap_b32 v33, v35
  v_add_f32 v32, v32, v34
  v_add_f32 v33, v33, v35
  v_mov_b32 v34, v32
  v_mov_b32 v35, v33
  s_nop 0
  v_permlane16_swap_b32 v32, v34
  v_permlane16_swap_b32 v33, v35
  v_add_f32 v32, v32, v34
  v_add_f32 v33, v33, v35
  v_mul_f32 v32, 0x3a800000, v32
  v_mul_f32 v33, 0x3a800000, v33
  v_fma_f32 v33, -v32, v32, v33
  v_max_f32 v33, 0, v33
  v_add_f32 v33, 0x3727c5ac, v33
  v_rsq_f32 v33, v33
  s_nop 0
  s_and_b32 s3, s70, 3
  s_lshl_b32 s5, s3, 7
  s_add_u32 s5, s5, 129088
  v_and_b32 v3, 15, v1
  v_lshrrev_b32 v2, 5, v1
  v_lshl_add_u32 v2, v3, 1, v2
  v_lshl_add_u32 v2, v2, 2, s5
  ds_write2_b32 v2, v32, v33 offset0:0 offset1:160
  v_mov_b32 v50, v48
  v_mov_b32 v51, v49
  s_nop 0
  v_permlane32_swap_b32 v48, v50
  v_permlane32_swap_b32 v49, v51
  v_add_f32 v48, v48, v50
  v_add_f32 v49, v49, v51
  v_mov_b32 v50, v48
  v_mov_b32 v51, v49
  s_nop 0
  v_permlane16_swap_b32 v48, v50
  v_permlane16_swap_b32 v49, v51
  v_add_f32 v48, v48, v50
  v_add_f32 v49, v49, v51
  s_nop 1
  v_add_f32_dpp v48, v48, v48 row_ror:8 row_mask:0xf bank_mask:0xf
  v_add_f32_dpp v49, v49, v49 row_ror:8 row_mask:0xf bank_mask:0xf
  s_nop 1
  v_add_f32_dpp v48, v48, v48 row_ror:4 row_mask:0xf bank_mask:0xf
  v_add_f32_dpp v49, v49, v49 row_ror:4 row_mask:0xf bank_mask:0xf
  v_mul_f32 v48, 0x3a800000, v48
  v_mul_f32 v49, 0x3a800000, v49
  v_fma_f32 v49, -v48, v48, v49
  v_max_f32 v49, 0, v49
  v_add_f32 v49, 0x3727c5ac, v49
  v_rsq_f32 v49, v49
  s_nop 0
  s_lshl_b32 s5, s3, 4
  s_add_u32 s5, s5, 129024
  v_and_b32 v3, 3, v1
  v_lshl_add_u32 v2, v3, 2, s5
  ds_write2_b32 v2, v48, v49 offset0:0 offset1:160
  s_waitcnt lgkmcnt(0)
  s_barrier
L_attn_ldend:
  s_lshl_b32 s87, s97, 15
  s_lshl_b32 s4, s68, 11
  s_add_u32 s87, s87, s4
  s_lshl_b32 s4, s69, 2
  s_add_u32 s87, s87, s4
  s_add_u32 s97, s97, 1
  s_branch L_wo_body
L_attn_end:
  s_endpgm
.fill 835, 4, 0xbf810000
L_attn_compute:
  s_cmp_lg_u32 s96, 0
  s_cbranch_scc1 L_pfc1_skip
  s_getpc_b64 s[4:5]
L_pfc1:
  s_lshl_b32 s3, s99, 2
  s_add_u32 s3, s3, s70
  s_mul_i32 s3, s3, 320
  s_min_u32 s3, s3, L_w2_c1-L_attn_c0-320
  s_add_i32 s3, s3, L_attn_c0-L_pfc1
  s_ashr_i32 s6, s3, 31
  s_add_u32 s4, s4, s3
  s_addc_u32 s5, s5, s6
  s_load_dword s40, s[4:5], 0
  s_load_dword s40, s[4:5], 64
  s_load_dword s40, s[4:5], 128
  s_load_dword s40, s[4:5], 192
  s_load_dword s40, s[4:5], 256
L_pfc1_skip:
  s_and_b32 s71, s70, 1
  s_lshr_b32 s72, s70, 1
  v_and_b32 v3, 31, v1
  v_lshlrev_b32 v3, 2, v3
  v_add_u32 v3, 40960, v3
  v_mov_b32 v236, 0x3f803f80
  v_mov_b32 v237, 0x3f803f80
  v_mov_b32 v238, 0x3f803f80
  v_mov_b32 v239, 0x3f803f80
  ds_write_b32 v3, v236
  ds_write_b32 v3, v236 offset:43008
  v_add_u32 v3, 86016, v3
  ds_write_b32 v3, v236
  ds_write_b32 v3, v236 offset:3328
  v_and_b32 v3, 15, v1
  v_lshrrev_b32 v2, 4, v1
  v_lshrrev_b32 v33, 1, v3
  s_lshl_b32 s8, s71, 13
  v_xor_b32 v4, v2, v33
  v_lshlrev_b32 v4, 4, v4
  v_lshl_add_u32 v4, v3, 7, v4
  v_add_u32 v8, 40960, v4
  v_add_u32 v4, s8, v4
  v_add_u32 v5, 4, v2
  v_xor_b32 v5, v5, v33
  v_lshlrev_b32 v5, 4, v5
  v_lshl_add_u32 v5, v3, 7, v5
  v_add_u32 v9, 40960, v5
  v_add_u32 v5, s8, v5
  v_bfe_u32 v34, v1, 2, 2
  v_lshl_add_u32 v34, v2, 3, v34
  v_lshlrev_b32 v34, 7, v34
  v_and_b32 v33, 3, v1
  v_lshl_add_u32 v34, v33, 3, v34
  v_bfe_u32 v33, v1, 3, 2
  v_lshl_add_u32 v34, v33, 5, v34
  s_lshl_b32 s8, s70, 5
  v_xor_b32 v34, s8, v34
  v_add_u32 v6, 16384, v34
  v_xor_b32 v7, 32, v6
  s_mov_b32 s75, 0
  v_add_u32_e64 v10, s75, v4
  v_add_u32_e64 v11, s75, v5
  v_add_u32_e64 v12, s75, v6
  v_add_u32_e64 v13, s75, v7
  v_add_u32_e64 v14, s75, v8
  v_add_u32_e64 v15, s75, v9
  s_add_u32 s75, s75, 43008
  s_cmp_eq_u32 s75, 129024
  s_cselect_b32 s75, 0, s75
  s_and_b32 s79, s69, 3
  s_add_u32 s79, s79, 1
  s_mul_i32 s98, s96, 2
  s_cmp_eq_u32 s96, 0
  s_cbranch_scc1 L_attn_nog
  s_mov_b32 s79, 14
  ds_read_b128 v[32:35], v10 offset:0
  ds_read_b128 v[36:39], v10 offset:2048
  ds_read_b128 v[40:43], v10 offset:4096
  ds_read_b128 v[44:47], v10 offset:6144
  ds_read_b64_tr_b16 v[52:53], v12 offset:0
  ds_read_b64_tr_b16 v[54:55], v12 offset:512
  ds_read_b64_tr_b16 v[56:57], v13 offset:0
  ds_read_b64_tr_b16 v[58:59], v13 offset:512
  ds_read_b64_tr_b16 v[60:61], v12 offset:8192
  ds_read_b64_tr_b16 v[62:63], v12 offset:8704
  ds_read_b64_tr_b16 v[64:65], v13 offset:8192
  ds_read_b64_tr_b16 v[66:67], v13 offset:8704
  ds_read_b64_tr_b16 v[68:69], v12 offset:16384
  ds_read_b64_tr_b16 v[70:71], v12 offset:16896
  ds_read_b64_tr_b16 v[72:73], v13 offset:16384
  ds_read_b64_tr_b16 v[74:75], v13 offset:16896
  s_waitcnt lgkmcnt(0)
  v_mfma_f32_16x16x32_bf16 v[128:131], v[52:55], v[32:35], 0
  ds_read_b128 v[76:79], v11 offset:0
  v_mfma_f32_16x16x32_bf16 v[132:135], v[52:55], v[36:39], 0
  ds_read_b128 v[80:83], v11 offset:2048
  v_mfma_f32_16x16x32_bf16 v[136:139], v[52:55], v[40:43], 0
  ds_read_b128 v[84:87], v11 offset:4096
  v_mfma_f32_16x16x32_bf16 v[140:143], v[52:55], v[44:47], 0
  ds_read_b128 v[88:91], v11 offset:6144
  v_mfma_f32_16x16x32_bf16 v[156:159], v[56:59], v[44:47], 0
  ds_read_b64_tr_b16 v[96:97], v12 offset:4096
  v_mfma_f32_16x16x32_bf16 v[152:155], v[56:59], v[40:43], 0
  ds_read_b64_tr_b16 v[98:99], v12 offset:4608
  v_mfma_f32_16x16x32_bf16 v[148:151], v[56:59], v[36:39], 0
  ds_read_b64_tr_b16 v[100:101], v13 offset:4096
  v_mfma_f32_16x16x32_bf16 v[144:147], v[56:59], v[32:35], 0
  ds_read_b64_tr_b16 v[102:103], v13 offset:4608
  v_mfma_f32_16x16x32_bf16 v[160:163], v[60:63], v[32:35], 0
  ds_read_b64_tr_b16 v[104:105], v12 offset:12288
  v_mfma_f32_16x16x32_bf16 v[164:167], v[60:63], v[36:39], 0
  ds_read_b64_tr_b16 v[106:107], v12 offset:12800
  v_mfma_f32_16x16x32_bf16 v[168:171], v[60:63], v[40:43], 0
  ds_read_b64_tr_b16 v[108:109], v13 offset:12288
  v_mfma_f32_16x16x32_bf16 v[172:175], v[60:63], v[44:47], 0
  ds_read_b64_tr_b16 v[110:111], v13 offset:12800
  v_mfma_f32_16x16x32_bf16 v[188:191], v[64:67], v[44:47], 0
  ds_read_b64_tr_b16 v[112:113], v12 offset:20480
  v_mfma_f32_16x16x32_bf16 v[184:187], v[64:67], v[40:43], 0
  ds_read_b64_tr_b16 v[114:115], v12 offset:20992
  v_mfma_f32_16x16x32_bf16 v[180:183], v[64:67], v[36:39], 0
  ds_read_b64_tr_b16 v[116:117], v13 offset:20480
  v_mfma_f32_16x16x32_bf16 v[176:179], v[64:67], v[32:35], 0
  ds_read_b64_tr_b16 v[118:119], v13 offset:20992
  v_mfma_f32_16x16x32_bf16 v[192:195], v[32:35], v[68:71], 0
  v_add_u32_e64 v10, s75, v4
  v_mfma_f32_16x16x32_bf16 v[196:199], v[36:39], v[68:71], 0
  v_add_u32_e64 v11, s75, v5
  v_mfma_f32_16x16x32_bf16 v[200:203], v[40:43], v[68:71], 0
  v_add_u32_e64 v12, s75, v6
  v_mfma_f32_16x16x32_bf16 v[204:207], v[44:47], v[68:71], 0
  v_add_u32_e64 v13, s75, v7
  v_mfma_f32_16x16x32_bf16 v[220:223], v[44:47], v[72:75], 0
  v_add_u32_e64 v14, s75, v8
  v_mfma_f32_16x16x32_bf16 v[216:219], v[40:43], v[72:75], 0
  v_add_u32_e64 v15, s75, v9
  v_mfma_f32_16x16x32_bf16 v[212:215], v[36:39], v[72:75], 0
  s_add_u32 s75, s75, 43008
  v_mfma_f32_16x16x32_bf16 v[208:211], v[32:35], v[72:75], 0
  s_cmp_eq_u32 s75, 129024
  s_cselect_b32 s75, 0, s75
  s_waitcnt lgkmcnt(0)
  v_mfma_f32_16x16x32_bf16 v[128:131], v[96:99], v[76:79], v[128:131]
  v_mfma_f32_16x16x32_bf16 v[132:135], v[96:99], v[80:83], v[132:135]
  v_mfma_f32_16x16x32_bf16 v[136:139], v[96:99], v[84:87], v[136:139]
  v_mfma_f32_16x16x32_bf16 v[140:143], v[96:99], v[88:91], v[140:143]
  v_mfma_f32_16x16x32_bf16 v[156:159], v[100:103], v[88:91], v[156:159]
  v_mfma_f32_16x16x32_bf16 v[152:155], v[100:103], v[84:87], v[152:155]
  v_mfma_f32_16x16x32_bf16 v[148:151], v[100:103], v[80:83], v[148:151]
  v_mfma_f32_16x16x32_bf16 v[144:147], v[100:103], v[76:79], v[144:147]
  v_mfma_f32_16x16x32_bf16 v[160:163], v[104:107], v[76:79], v[160:163]
  v_mfma_f32_16x16x32_bf16 v[164:167], v[104:107], v[80:83], v[164:167]
  v_mfma_f32_16x16x32_bf16 v[168:171], v[104:107], v[84:87], v[168:171]
  v_mfma_f32_16x16x32_bf16 v[172:175], v[104:107], v[88:91], v[172:175]
  v_mfma_f32_16x16x32_bf16 v[188:191], v[108:111], v[88:91], v[188:191]
  v_mfma_f32_16x16x32_bf16 v[184:187], v[108:111], v[84:87], v[184:187]
  v_mfma_f32_16x16x32_bf16 v[180:183], v[108:111], v[80:83], v[180:183]
  v_mfma_f32_16x16x32_bf16 v[176:179], v[108:111], v[76:79], v[176:179]
  v_mfma_f32_16x16x32_bf16 v[192:195], v[76:79], v[112:115], v[192:195]
  v_mfma_f32_16x16x32_bf16 v[196:199], v[80:83], v[112:115], v[196:199]
  v_mfma_f32_16x16x32_bf16 v[200:203], v[84:87], v[112:115], v[200:203]
  v_mfma_f32_16x16x32_bf16 v[204:207], v[88:91], v[112:115], v[204:207]
  v_mfma_f32_16x16x32_bf16 v[220:223], v[88:91], v[116:119], v[220:223]
  v_mfma_f32_16x16x32_bf16 v[216:219], v[84:87], v[116:119], v[216:219]
  v_mfma_f32_16x16x32_bf16 v[212:215], v[80:83], v[116:119], v[212:215]
  v_mfma_f32_16x16x32_bf16 v[208:211], v[76:79], v[116:119], v[208:211]
  s_barrier
  v_mov_b32 v76, v52
  v_mov_b32 v77, v53
  v_mov_b32 v78, v54
  v_mov_b32 v79, v55
  v_mov_b32 v80, v60
  v_mov_b32 v81, v61
  v_mov_b32 v82, v62
  v_mov_b32 v83, v63
  v_mov_b32 v84, v68
  v_mov_b32 v85, v69
  v_mov_b32 v86, v70
  v_mov_b32 v87, v71
  ds_read_b64_tr_b16 v[52:53], v12 offset:0
  ds_read_b64_tr_b16 v[54:55], v12 offset:512
  ds_read_b64_tr_b16 v[56:57], v13 offset:0
  ds_read_b64_tr_b16 v[58:59], v13 offset:512
  ds_read_b64_tr_b16 v[60:61], v12 offset:8192
  ds_read_b64_tr_b16 v[62:63], v12 offset:8704
  ds_read_b64_tr_b16 v[64:65], v13 offset:8192
  ds_read_b64_tr_b16 v[66:67], v13 offset:8704
  ds_read_b64_tr_b16 v[68:69], v12 offset:16384
  ds_read_b64_tr_b16 v[70:71], v12 offset:16896
  ds_read_b64_tr_b16 v[72:73], v13 offset:16384
  ds_read_b64_tr_b16 v[74:75], v13 offset:16896
L_attn_nog:
  v_and_b32 v35, 1, v2
  v_xor_b32 v35, s71, v35
  s_lshl_b32 s8, s68, 7
  s_lshl_b32 s9, s71, 6
  s_add_u32 s8, s8, s9
  s_mul_i32 s10, s8, 7
  s_lshl2_add_u32 s11, s69, s72
  s_add_u32 s10, s10, s11
  s_lshl_b32 s10, s10, 10
  v_lshl_add_u32 v31, v1, 4, s10
  s_mul_i32 s10, s72, 14336
  s_add_u32 s10, s10, 87040
  s_lshl_b32 s11, s71, 10
  s_add_u32 s4, s10, s11
  s_sub_u32 s5, s10, s11
  s_mul_i32 s6, s71, 6144
  v_lshl_add_u32 v16, v1, 4, s4
  v_add_u32 v17, s6, v16
  v_lshl_add_u32 v18, v1, 4, s5
  v_add_u32 v18, s6, v18
  v_lshl_add_u32 v19, v2, 8, s4
  v_lshl_add_u32 v20, v2, 8, s5
  v_lshl_add_u32 v21, v3, 4, s4
  v_lshl_add_u32 v22, v3, 4, s5
  s_lshl_b32 s10, s71, 8
  s_add_u32 s10, s10, 129024
  v_lshl_add_u32 v23, v3, 2, s10
  v_lshl_add_u32 v24, v2, 4, s10
  v_and_b32 v33, 1, v3
  v_cmp_eq_u32 s[48:49], 1, v33
  v_lshl_add_u32 v34, v2, 2, v33
  v_add_u32 v35, 2, v34
  v_cmp_gt_u32 s[50:51], v34, v3
  v_cmp_gt_u32 s[52:53], v35, v3
  v_mov_b32 v36, 0xffff
  v_mov_b32 v37, 0xffff0000
  v_cndmask_b32 v36, v36, v37, s[48:49]
  s_add_u32 s10, s10, 704
  v_lshl_add_u32 v34, v34, 2, s10
  v_lshl_add_u32 v35, v35, 2, s10
  v_subrev_u32 v38, 64, v34
  v_subrev_u32 v39, 64, v35
  v_cndmask_b32 v25, v34, v38, s[50:51]
  v_cndmask_b32 v26, v35, v39, s[52:53]
  v_cndmask_b32 v27, 0, v36, s[50:51]
  v_cndmask_b32 v29, 0, v36, s[52:53]
  v_xor_b32 v28, v27, v36
  v_xor_b32 v30, v29, v36
  s_cmp_eq_u32 s8, 0
  s_cselect_b64 s[54:55], s[50:51], 0
  s_cselect_b64 s[14:15], s[52:53], 0
  s_cmp_lg_u32 s96, 0
  s_cbranch_scc1 L_attn_nozero
  v_mov_b32 v122, 0
  v_mov_b32 v123, 0
  v_mov_b32 v124, 0
  v_mov_b32 v125, 0
  v_mov_b32 v126, 0
  v_mov_b32 v127, 0
  v_mov_b32 v128, 0
  v_mov_b32 v129, 0
  v_mov_b32 v130, 0
  v_mov_b32 v131, 0
  v_mov_b32 v132, 0
  v_mov_b32 v133, 0
  v_mov_b32 v134, 0
  v_mov_b32 v135, 0
  v_mov_b32 v136, 0
  v_mov_b32 v137, 0
  v_mov_b32 v138, 0
  v_mov_b32 v139, 0
  v_mov_b32 v140, 0
  v_mov_b32 v141, 0
  v_mov_b32 v142, 0
  v_mov_b32 v143, 0
  v_mov_b32 v144, 0
  v_mov_b32 v145, 0
  v_mov_b32 v146, 0
  v_mov_b32 v147, 0
  v_mov_b32 v148, 0
  v_mov_b32 v149, 0
  v_mov_b32 v150, 0
  v_mov_b32 v151, 0
  v_mov_b32 v152, 0
  v_mov_b32 v153, 0
  v_mov_b32 v154, 0
  v_mov_b32 v155, 0
  v_mov_b32 v156, 0
  v_mov_b32 v157, 0
  v_mov_b32 v158, 0
  v_mov_b32 v159, 0
  v_mov_b32 v160, 0
  v_mov_b32 v161, 0
  v_mov_b32 v162, 0
  v_mov_b32 v163, 0
  v_mov_b32 v164, 0
  v_mov_b32 v165, 0
  v_mov_b32 v166, 0
  v_mov_b32 v167, 0
  v_mov_b32 v168, 0
  v_mov_b32 v169, 0
  v_mov_b32 v170, 0
  v_mov_b32 v171, 0
  v_mov_b32 v172, 0
  v_mov_b32 v173, 0
  v_mov_b32 v174, 0
  v_mov_b32 v175, 0
  v_mov_b32 v176, 0
  v_mov_b32 v177, 0
  v_mov_b32 v178, 0
  v_mov_b32 v179, 0
  v_mov_b32 v180, 0
  v_mov_b32 v181, 0
  v_mov_b32 v182, 0
  v_mov_b32 v183, 0
  v_mov_b32 v184, 0
  v_mov_b32 v185, 0
  v_mov_b32 v186, 0
  v_mov_b32 v187, 0
  v_mov_b32 v188, 0
  v_mov_b32 v189, 0
  v_mov_b32 v190, 0
  v_mov_b32 v191, 0
  v_mov_b32 v192, 0
  v_mov_b32 v193, 0
  v_mov_b32 v194, 0
  v_mov_b32 v195, 0
  v_mov_b32 v196, 0
  v_mov_b32 v197, 0
  v_mov_b32 v198, 0
  v_mov_b32 v199, 0
  v_mov_b32 v200, 0
  v_mov_b32 v201, 0
  v_mov_b32 v202, 0
  v_mov_b32 v203, 0
  v_mov_b32 v204, 0
  v_mov_b32 v205, 0
  v_mov_b32 v206, 0
  v_mov_b32 v207, 0
  v_mov_b32 v208, 0
  v_mov_b32 v209, 0
  v_mov_b32 v210, 0
  v_mov_b32 v211, 0
  v_mov_b32 v212, 0
  v_mov_b32 v213, 0
  v_mov_b32 v214, 0
  v_mov_b32 v215, 0
  v_mov_b32 v216, 0
  v_mov_b32 v217, 0
  v_mov_b32 v218, 0
  v_mov_b32 v219, 0
  v_mov_b32 v220, 0
  v_mov_b32 v221, 0
  v_mov_b32 v222, 0
  v_mov_b32 v223, 0
  v_mov_b32 v224, 0
  v_mov_b32 v225, 0
  v_mov_b32 v226, 0
  v_mov_b32 v227, 0
  v_mov_b32 v228, 0
  v_mov_b32 v229, 0
  v_mov_b32 v230, 0
  v_mov_b32 v231, 0
  v_mov_b32 v232, 0
  v_mov_b32 v233, 0
  v_mov_b32 v234, 0
  v_mov_b32 v235, 0
  s_waitcnt lgkmcnt(0)
  s_lshl_b32 s3, s72, 5
  s_add_u32 s3, s3, s8
  s_lshl_b32 s4, s69, 14
  s_lshl3_add_u32 s3, s3, s4
  v_lshrrev_b32 v121, 1, v2
  v_lshl_add_u32 v121, v121, 4, v3
  v_and_b32 v120, 1, v2
  v_lshl_add_u32 v121, v121, 1, v120
  v_lshl_add_u32 v120, v121, 2, s3
  s_add_u32 s56, s22, 24903680
  s_addc_u32 s57, s23, 0
  s_and_b32 s57, s57, 0xffff
  s_mov_b32 s58, 262144
  s_mov_b32 s59, 0x00020000
  s_add_u32 s60, s22, 41943040
  s_addc_u32 s61, s23, 0
  s_and_b32 s61, s61, 0xffff
  s_mov_b32 s62, 524288
  s_mov_b32 s63, 0x00020000
  s_lshl_b32 s3, s2, 11
  s_cmp_lg_u32 s70, 0
  s_cbranch_scc1 L_attn_noclr
  s_lshl_b32 s5, s68, 10
  s_add_u32 s4, s4, s5
  v_lshlrev_b32 v121, 4, v1
  v_mov_b32 v40, -1
  v_mov_b32 v41, -1
  v_mov_b32 v42, -1
  v_mov_b32 v43, -1
  buffer_store_dwordx4 v[40:43], v121, s[56:59], s4 offen sc1
  buffer_store_dwordx4 v[128:131], v121, s[60:63], s3 offen offset:0 sc1
  buffer_store_dwordx4 v[128:131], v121, s[60:63], s3 offen offset:1024 sc1
  v_mov_b32 v126, 1
L_attn_noclr:
  s_and_b32 s65, s65, 0xffff
  s_mov_b32 s66, 256
  s_mov_b32 s67, 0x00020000
  s_mov_b32 s7, 0x3f803f80
L_attn_nozero:
  s_waitcnt lgkmcnt(0)
  s_mov_b32 s36, s16
  s_and_b32 s37, s17, 0xffff
  s_mov_b32 s38, 4194304
  s_mov_b32 s39, 0x00020000
  s_and_b32 s3, s2, 3
  s_and_b32 s4, s99, 3
  s_lshl2_add_u32 s3, s3, s4
  s_lshl2_add_u32 s3, s3, s70
  s_lshl_b32 s3, s3, 16
  s_bfe_u32 s4, s2, 0x10002
  s_lshr_b32 s5, s99, 2
  s_lshl1_add_u32 s4, s5, s4
  s_lshl_b32 s4, s4, 7
  s_add_u32 s42, s3, s4
  s_add_u32 s43, s42, 32768
  v_and_b32 v127, 15, v1
  v_lshlrev_b32 v33, 1, v1
  v_and_b32 v33, 32, v33
  v_lshl_add_u32 v127, v127, 11, v33
  v_lshrrev_b32 v33, 1, v1
  v_and_b32 v33, 16, v33
  v_add_u32 v127, v127, v33
  s_add_u32 s44, s34, 8439808
  s_addc_u32 s45, s35, 0
  s_and_b32 s45, s45, 0xffff
  s_mov_b32 s46, 14628864
  s_mov_b32 s47, 0x00020000
  s_cmp_eq_u32 s96, 0
  s_barrier
  s_cbranch_scc1 L_attn_first
  ds_read_b128 v[88:91], v14 offset:46336
  ds_read_b128 v[92:95], v15 offset:46336
  ds_read_b128 v[32:35], v10 offset:0
  ds_read_b128 v[36:39], v10 offset:2048
  ds_read_b128 v[40:43], v10 offset:4096
  ds_read_b128 v[44:47], v10 offset:6144
  ds_read_b128 v[48:51], v14
  s_waitcnt lgkmcnt(5)
  v_mfma_f32_16x16x32_bf16 v[224:227], v[76:79], v[88:91], 0
  v_mfma_f32_16x16x32_bf16 v[228:231], v[80:83], v[88:91], 0
  v_mfma_f32_16x16x32_bf16 v[232:235], v[88:91], v[84:87], 0
  v_mfma_f32_16x16x32_bf16 v[224:227], v[96:99], v[92:95], v[224:227]
  v_mfma_f32_16x16x32_bf16 v[228:231], v[104:107], v[92:95], v[228:231]
  v_mfma_f32_16x16x32_bf16 v[232:235], v[92:95], v[112:115], v[232:235]
  s_waitcnt lgkmcnt(0)
  s_branch L_attn_loop
L_attn_first:
  ds_read_b128 v[32:35], v10 offset:0
  ds_read_b128 v[36:39], v10 offset:2048
  ds_read_b128 v[40:43], v10 offset:4096
  ds_read_b128 v[44:47], v10 offset:6144
  ds_read_b128 v[48:51], v14
  ds_read_b64_tr_b16 v[52:53], v12 offset:0
  ds_read_b64_tr_b16 v[54:55], v12 offset:512
  ds_read_b64_tr_b16 v[56:57], v13 offset:0
  ds_read_b64_tr_b16 v[58:59], v13 offset:512
  ds_read_b64_tr_b16 v[60:61], v12 offset:8192
  ds_read_b64_tr_b16 v[62:63], v12 offset:8704
  ds_read_b64_tr_b16 v[64:65], v13 offset:8192
  ds_read_b64_tr_b16 v[66:67], v13 offset:8704
  ds_read_b64_tr_b16 v[68:69], v12 offset:16384
  ds_read_b64_tr_b16 v[70:71], v12 offset:16896
  ds_read_b64_tr_b16 v[72:73], v13 offset:16384
  ds_read_b64_tr_b16 v[74:75], v13 offset:16896
.p2align 5
  s_nop 0
  s_nop 0
  s_nop 0
  s_waitcnt lgkmcnt(0)
L_attn_loop:
  v_mfma_f32_16x16x32_bf16 v[128:131], v[52:55], v[32:35], v[128:131]
  ds_read_b128 v[76:79], v11 offset:0
  v_mfma_f32_16x16x32_bf16 v[132:135], v[52:55], v[36:39], v[132:135]
  ds_read_b128 v[80:83], v11 offset:2048
  v_mfma_f32_16x16x32_bf16 v[136:139], v[52:55], v[40:43], v[136:139]
  ds_read_b128 v[84:87], v11 offset:4096
  v_mfma_f32_16x16x32_bf16 v[140:143], v[52:55], v[44:47], v[140:143]
  ds_read_b128 v[88:91], v11 offset:6144
  v_mfma_f32_16x16x32_bf16 v[224:227], v[52:55], v[48:51], v[224:227]
  ds_read_b128 v[92:95], v15
  v_mfma_f32_16x16x32_bf16 v[156:159], v[56:59], v[44:47], v[156:159]
  ds_read_b64_tr_b16 v[96:97], v12 offset:4096
  v_mfma_f32_16x16x32_bf16 v[152:155], v[56:59], v[40:43], v[152:155]
  ds_read_b64_tr_b16 v[98:99], v12 offset:4608
  v_mfma_f32_16x16x32_bf16 v[148:151], v[56:59], v[36:39], v[148:151]
  ds_read_b64_tr_b16 v[100:101], v13 offset:4096
  v_mfma_f32_16x16x32_bf16 v[144:147], v[56:59], v[32:35], v[144:147]
  ds_read_b64_tr_b16 v[102:103], v13 offset:4608
  v_mfma_f32_16x16x32_bf16 v[160:163], v[60:63], v[32:35], v[160:163]
  ds_read_b64_tr_b16 v[104:105], v12 offset:12288
  v_mfma_f32_16x16x32_bf16 v[164:167], v[60:63], v[36:39], v[164:167]
  ds_read_b64_tr_b16 v[106:107], v12 offset:12800
  v_mfma_f32_16x16x32_bf16 v[168:171], v[60:63], v[40:43], v[168:171]
  ds_read_b64_tr_b16 v[108:109], v13 offset:12288
  v_mfma_f32_16x16x32_bf16 v[172:175], v[60:63], v[44:47], v[172:175]
  ds_read_b64_tr_b16 v[110:111], v13 offset:12800
  v_mfma_f32_16x16x32_bf16 v[228:231], v[60:63], v[48:51], v[228:231]
  ds_read_b64_tr_b16 v[112:113], v12 offset:20480
  v_mfma_f32_16x16x32_bf16 v[188:191], v[64:67], v[44:47], v[188:191]
  ds_read_b64_tr_b16 v[114:115], v12 offset:20992
  v_mfma_f32_16x16x32_bf16 v[184:187], v[64:67], v[40:43], v[184:187]
  ds_read_b64_tr_b16 v[116:117], v13 offset:20480
  v_mfma_f32_16x16x32_bf16 v[180:183], v[64:67], v[36:39], v[180:183]
  ds_read_b64_tr_b16 v[118:119], v13 offset:20992
  v_mfma_f32_16x16x32_bf16 v[176:179], v[64:67], v[32:35], v[176:179]
  v_add_u32_e64 v10, s75, v4
  v_mfma_f32_16x16x32_bf16 v[192:195], v[32:35], v[68:71], v[192:195]
  v_add_u32_e64 v11, s75, v5
  v_mfma_f32_16x16x32_bf16 v[196:199], v[36:39], v[68:71], v[196:199]
  v_add_u32_e64 v12, s75, v6
  v_mfma_f32_16x16x32_bf16 v[200:203], v[40:43], v[68:71], v[200:203]
  v_add_u32_e64 v13, s75, v7
  v_mfma_f32_16x16x32_bf16 v[204:207], v[44:47], v[68:71], v[204:207]
  v_add_u32_e64 v14, s75, v8
  v_mfma_f32_16x16x32_bf16 v[232:235], v[48:51], v[68:71], v[232:235]
  v_add_u32_e64 v15, s75, v9
  v_mfma_f32_16x16x32_bf16 v[220:223], v[44:47], v[72:75], v[220:223]
  s_add_u32 s75, s75, 43008
  v_mfma_f32_16x16x32_bf16 v[216:219], v[40:43], v[72:75], v[216:219]
  s_cmp_eq_u32 s75, 129024
  v_mfma_f32_16x16x32_bf16 v[212:215], v[36:39], v[72:75], v[212:215]
  s_cselect_b32 s75, 0, s75
  s_sub_u32 s79, s79, 1
  v_mfma_f32_16x16x32_bf16 v[208:211], v[32:35], v[72:75], v[208:211]
  s_waitcnt lgkmcnt(0)
  s_barrier
  v_mfma_f32_16x16x32_bf16 v[128:131], v[96:99], v[76:79], v[128:131]
  ds_read_b128 v[32:35], v10 offset:0
  v_mfma_f32_16x16x32_bf16 v[132:135], v[96:99], v[80:83], v[132:135]
  ds_read_b128 v[36:39], v10 offset:2048
  v_mfma_f32_16x16x32_bf16 v[136:139], v[96:99], v[84:87], v[136:139]
  ds_read_b128 v[40:43], v10 offset:4096
  v_mfma_f32_16x16x32_bf16 v[140:143], v[96:99], v[88:91], v[140:143]
  ds_read_b128 v[44:47], v10 offset:6144
  v_mfma_f32_16x16x32_bf16 v[224:227], v[96:99], v[92:95], v[224:227]
  ds_read_b128 v[48:51], v14
  v_mfma_f32_16x16x32_bf16 v[156:159], v[100:103], v[88:91], v[156:159]
  ds_read_b64_tr_b16 v[52:53], v12 offset:0
  v_mfma_f32_16x16x32_bf16 v[152:155], v[100:103], v[84:87], v[152:155]
  ds_read_b64_tr_b16 v[54:55], v12 offset:512
  v_mfma_f32_16x16x32_bf16 v[148:151], v[100:103], v[80:83], v[148:151]
  ds_read_b64_tr_b16 v[56:57], v13 offset:0
  v_mfma_f32_16x16x32_bf16 v[144:147], v[100:103], v[76:79], v[144:147]
  ds_read_b64_tr_b16 v[58:59], v13 offset:512
  v_mfma_f32_16x16x32_bf16 v[160:163], v[104:107], v[76:79], v[160:163]
  ds_read_b64_tr_b16 v[60:61], v12 offset:8192
  v_mfma_f32_16x16x32_bf16 v[164:167], v[104:107], v[80:83], v[164:167]
  ds_read_b64_tr_b16 v[62:63], v12 offset:8704
  v_mfma_f32_16x16x32_bf16 v[168:171], v[104:107], v[84:87], v[168:171]
  ds_read_b64_tr_b16 v[64:65], v13 offset:8192
  v_mfma_f32_16x16x32_bf16 v[172:175], v[104:107], v[88:91], v[172:175]
  ds_read_b64_tr_b16 v[66:67], v13 offset:8704
  v_mfma_f32_16x16x32_bf16 v[228:231], v[104:107], v[92:95], v[228:231]
  ds_read_b64_tr_b16 v[68:69], v12 offset:16384
  v_mfma_f32_16x16x32_bf16 v[188:191], v[108:111], v[88:91], v[188:191]
  ds_read_b64_tr_b16 v[70:71], v12 offset:16896
  v_mfma_f32_16x16x32_bf16 v[184:187], v[108:111], v[84:87], v[184:187]
  ds_read_b64_tr_b16 v[72:73], v13 offset:16384
  v_mfma_f32_16x16x32_bf16 v[180:183], v[108:111], v[80:83], v[180:183]
  ds_read_b64_tr_b16 v[74:75], v13 offset:16896
  v_mfma_f32_16x16x32_bf16 v[176:179], v[108:111], v[76:79], v[176:179]
  s_cmp_lg_u32 s79, 0
  s_nop 0
  v_mfma_f32_16x16x32_bf16 v[192:195], v[76:79], v[112:115], v[192:195]
  v_mfma_f32_16x16x32_bf16 v[196:199], v[80:83], v[112:115], v[196:199]
  v_mfma_f32_16x16x32_bf16 v[200:203], v[84:87], v[112:115], v[200:203]
  v_mfma_f32_16x16x32_bf16 v[204:207], v[88:91], v[112:115], v[204:207]
  v_mfma_f32_16x16x32_bf16 v[232:235], v[92:95], v[112:115], v[232:235]
  v_mfma_f32_16x16x32_bf16 v[220:223], v[88:91], v[116:119], v[220:223]
  v_mfma_f32_16x16x32_bf16 v[216:219], v[84:87], v[116:119], v[216:219]
  v_mfma_f32_16x16x32_bf16 v[212:215], v[80:83], v[116:119], v[212:215]
  v_mfma_f32_16x16x32_bf16 v[208:211], v[76:79], v[116:119], v[208:211]
  s_waitcnt lgkmcnt(0)
  s_cbranch_scc1 L_attn_loop
L_attn_lend:
  s_add_u32 s98, s98, 1
  s_cmp_gt_u32 s98, 2
  s_cbranch_scc1 L_attn_exit
  s_cmp_lg_u32 s98, 1
  s_cbranch_scc1 L_attn_hook0
  s_mov_b32 s79, 1
  s_cmp_lg_u32 s72, 0
  s_cbranch_scc1 L_attn_dot0
  v_dot2_f32_bf16 v122, v32, s7, v122
  v_dot2_f32_bf16 v124, v32, v32, v124
  v_dot2_f32_bf16 v123, v36, s7, v123
  v_dot2_f32_bf16 v125, v36, v36, v125
  v_dot2_f32_bf16 v122, v33, s7, v122
  v_dot2_f32_bf16 v124, v33, v33, v124
  v_dot2_f32_bf16 v123, v37, s7, v123
  v_dot2_f32_bf16 v125, v37, v37, v125
  v_dot2_f32_bf16 v122, v34, s7, v122
  v_dot2_f32_bf16 v124, v34, v34, v124
  v_dot2_f32_bf16 v123, v38, s7, v123
  v_dot2_f32_bf16 v125, v38, v38, v125
  v_dot2_f32_bf16 v122, v35, s7, v122
  v_dot2_f32_bf16 v124, v35, v35, v124
  v_dot2_f32_bf16 v123, v39, s7, v123
  v_dot2_f32_bf16 v125, v39, v39, v125
  s_branch L_attn_dote0
  L_attn_dot0:
  v_dot2_f32_bf16 v122, v40, s7, v122
  v_dot2_f32_bf16 v124, v40, v40, v124
  v_dot2_f32_bf16 v123, v44, s7, v123
  v_dot2_f32_bf16 v125, v44, v44, v125
  v_dot2_f32_bf16 v122, v41, s7, v122
  v_dot2_f32_bf16 v124, v41, v41, v124
  v_dot2_f32_bf16 v123, v45, s7, v123
  v_dot2_f32_bf16 v125, v45, v45, v125
  v_dot2_f32_bf16 v122, v42, s7, v122
  v_dot2_f32_bf16 v124, v42, v42, v124
  v_dot2_f32_bf16 v123, v46, s7, v123
  v_dot2_f32_bf16 v125, v46, v46, v125
  v_dot2_f32_bf16 v122, v43, s7, v122
  v_dot2_f32_bf16 v124, v43, v43, v124
  v_dot2_f32_bf16 v123, v47, s7, v123
  v_dot2_f32_bf16 v125, v47, v47, v125
  L_attn_dote0:
  s_cmp_lg_u32 s70, 0
  s_cbranch_scc1 L_attn_loop
  s_waitcnt vmcnt(0)
  s_lshl4_add_u32 s3, s68, s69
  s_mov_b64 exec, 1
  buffer_store_byte v126, off, s[64:67], s3 sc1
  s_mov_b64 exec, -1
  s_branch L_attn_loop
L_attn_hook0:
  s_and_b32 s79, s69, 3
  s_add_u32 s79, s79, 1
  s_sub_u32 s79, 14, s79
  s_cmp_lg_u32 s72, 0
  s_cbranch_scc1 L_attn_dot1
  v_dot2_f32_bf16 v122, v76, s7, v122
  v_dot2_f32_bf16 v124, v76, v76, v124
  v_dot2_f32_bf16 v123, v80, s7, v123
  v_dot2_f32_bf16 v125, v80, v80, v125
  v_dot2_f32_bf16 v122, v77, s7, v122
  v_dot2_f32_bf16 v124, v77, v77, v124
  v_dot2_f32_bf16 v123, v81, s7, v123
  v_dot2_f32_bf16 v125, v81, v81, v125
  v_dot2_f32_bf16 v122, v78, s7, v122
  v_dot2_f32_bf16 v124, v78, v78, v124
  v_dot2_f32_bf16 v123, v82, s7, v123
  v_dot2_f32_bf16 v125, v82, v82, v125
  v_dot2_f32_bf16 v122, v79, s7, v122
  v_dot2_f32_bf16 v124, v79, v79, v124
  v_dot2_f32_bf16 v123, v83, s7, v123
  v_dot2_f32_bf16 v125, v83, v83, v125
  s_branch L_attn_dote1
  L_attn_dot1:
  v_dot2_f32_bf16 v122, v84, s7, v122
  v_dot2_f32_bf16 v124, v84, v84, v124
  v_dot2_f32_bf16 v123, v88, s7, v123
  v_dot2_f32_bf16 v125, v88, v88, v125
  v_dot2_f32_bf16 v122, v85, s7, v122
  v_dot2_f32_bf16 v124, v85, v85, v124
  v_dot2_f32_bf16 v123, v89, s7, v123
  v_dot2_f32_bf16 v125, v89, v89, v125
  v_dot2_f32_bf16 v122, v86, s7, v122
  v_dot2_f32_bf16 v124, v86, v86, v124
  v_dot2_f32_bf16 v123, v90, s7, v123
  v_dot2_f32_bf16 v125, v90, v90, v125
  v_dot2_f32_bf16 v122, v87, s7, v122
  v_dot2_f32_bf16 v124, v87, v87, v124
  v_dot2_f32_bf16 v123, v91, s7, v123
  v_dot2_f32_bf16 v125, v91, v91, v125
  L_attn_dote1:
  s_nop 2
  v_permlane32_swap_b32 v122, v123
  v_permlane32_swap_b32 v124, v125
  v_add_f32 v122, v122, v123
  v_add_f32 v124, v124, v125
  s_nop 0
  s_nop 0
  v_permlane16_swap_b32 v122, v124
  v_add_f32 v122, v122, v124
  buffer_store_dword v122, v120, s[56:59], 0 offen sc1
  s_branch L_attn_loop
L_attn_exit:
  v_mfma_f32_16x16x32_bf16 v[224:227], v[52:55], v[48:51], v[224:227]
  ds_read_b128 v[92:95], v15
  s_mul_i32 s3, s71, -32768
  v_mfma_f32_16x16x32_bf16 v[228:231], v[60:63], v[48:51], v[228:231]
  ds_read_b64_tr_b16 v[96:97], v12 offset:4096
  v_add_u32 v10, s3, v16
  v_mfma_f32_16x16x32_bf16 v[172:175], v[60:63], v[44:47], v[172:175]
  ds_read_b64_tr_b16 v[98:99], v12 offset:4608
  v_mfma_f32_16x16x32_bf16 v[188:191], v[64:67], v[44:47], v[188:191]
  ds_read_b64_tr_b16 v[104:105], v12 offset:12288
  v_mfma_f32_16x16x32_bf16 v[232:235], v[48:51], v[68:71], v[232:235]
  ds_read_b64_tr_b16 v[106:107], v12 offset:12800
  v_mfma_f32_16x16x32_bf16 v[204:207], v[44:47], v[68:71], v[204:207]
  ds_read_b128 v[88:91], v11 offset:6144
  v_mfma_f32_16x16x32_bf16 v[220:223], v[44:47], v[72:75], v[220:223]
  ds_read_b64_tr_b16 v[108:109], v13 offset:12288
  v_mfma_f32_16x16x32_bf16 v[128:131], v[52:55], v[32:35], v[128:131]
  ds_read_b64_tr_b16 v[110:111], v13 offset:12800
  v_mfma_f32_16x16x32_bf16 v[132:135], v[52:55], v[36:39], v[132:135]
  ds_read_b64_tr_b16 v[112:113], v12 offset:20480
  v_mfma_f32_16x16x32_bf16 v[136:139], v[52:55], v[40:43], v[136:139]
  ds_read_b64_tr_b16 v[114:115], v12 offset:20992
  v_mfma_f32_16x16x32_bf16 v[140:143], v[52:55], v[44:47], v[140:143]
  ds_read_b64_tr_b16 v[116:117], v13 offset:20480
  v_mfma_f32_16x16x32_bf16 v[156:159], v[56:59], v[44:47], v[156:159]
  ds_read_b64_tr_b16 v[118:119], v13 offset:20992
  v_mfma_f32_16x16x32_bf16 v[152:155], v[56:59], v[40:43], v[152:155]
  ds_read_b128 v[76:79], v11 offset:0
  v_mfma_f32_16x16x32_bf16 v[148:151], v[56:59], v[36:39], v[148:151]
  ds_read_b128 v[80:83], v11 offset:2048
  s_waitcnt lgkmcnt(2)
  v_mfma_f32_16x16x32_bf16 v[224:227], v[96:99], v[92:95], v[224:227]
  ds_read_b128 v[84:87], v11 offset:4096
  v_mfma_f32_16x16x32_bf16 v[228:231], v[104:107], v[92:95], v[228:231]
  ds_read_b64_tr_b16 v[100:101], v13 offset:4096
  v_mfma_f32_16x16x32_bf16 v[172:175], v[104:107], v[88:91], v[172:175]
  ds_read_b64_tr_b16 v[102:103], v13 offset:4608
  v_mfma_f32_16x16x32_bf16 v[188:191], v[108:111], v[88:91], v[188:191]
  s_cmp_lg_u32 s96, 0
  v_mfma_f32_16x16x32_bf16 v[232:235], v[92:95], v[112:115], v[232:235]
  s_cbranch_scc1 L_attn_nores
  buffer_load_dwordx4 v[240:243], v127, s[36:39], s42 offen offset:0
  buffer_load_dwordx4 v[244:247], v127, s[36:39], s42 offen offset:64
  buffer_load_dwordx4 v[248:251], v127, s[36:39], s43 offen offset:0
  buffer_load_dwordx4 v[252:255], v127, s[36:39], s43 offen offset:64
  L_attn_nores:
  v_mfma_f32_16x16x32_bf16 v[204:207], v[88:91], v[112:115], v[204:207]
  v_mfma_f32_16x16x32_bf16 v[220:223], v[88:91], v[116:119], v[220:223]
  v_mfma_f32_16x16x32_bf16 v[144:147], v[56:59], v[32:35], v[144:147]
  ds_write_b128 v16, v[224:227] offset:0
  v_mfma_f32_16x16x32_bf16 v[160:163], v[60:63], v[32:35], v[160:163]
  v_mfma_f32_16x16x32_bf16 v[164:167], v[60:63], v[36:39], v[164:167]
  v_mfma_f32_16x16x32_bf16 v[168:171], v[60:63], v[40:43], v[168:171]
  ds_write_b128 v16, v[228:231] offset:2048
  v_mfma_f32_16x16x32_bf16 v[184:187], v[64:67], v[40:43], v[184:187]
  v_mfma_f32_16x16x32_bf16 v[180:183], v[64:67], v[36:39], v[180:183]
  v_mfma_f32_16x16x32_bf16 v[176:179], v[64:67], v[32:35], v[176:179]
  ds_write_b128 v10, v[172:175] offset:8192
  v_mfma_f32_16x16x32_bf16 v[192:195], v[32:35], v[68:71], v[192:195]
  v_mfma_f32_16x16x32_bf16 v[196:199], v[36:39], v[68:71], v[196:199]
  v_mfma_f32_16x16x32_bf16 v[200:203], v[40:43], v[68:71], v[200:203]
  ds_write_b128 v10, v[188:191] offset:9216
  v_mfma_f32_16x16x32_bf16 v[216:219], v[40:43], v[72:75], v[216:219]
  v_mfma_f32_16x16x32_bf16 v[212:215], v[36:39], v[72:75], v[212:215]
  v_mfma_f32_16x16x32_bf16 v[208:211], v[32:35], v[72:75], v[208:211]
  ds_write_b128 v16, v[232:235] offset:4096
  s_waitcnt lgkmcnt(5)
  v_mfma_f32_16x16x32_bf16 v[128:131], v[96:99], v[76:79], v[128:131]
  v_mfma_f32_16x16x32_bf16 v[132:135], v[96:99], v[80:83], v[132:135]
  v_mfma_f32_16x16x32_bf16 v[136:139], v[96:99], v[84:87], v[136:139]
  ds_write_b128 v10, v[204:207] offset:10240
  v_mfma_f32_16x16x32_bf16 v[140:143], v[96:99], v[88:91], v[140:143]
  v_mfma_f32_16x16x32_bf16 v[156:159], v[100:103], v[88:91], v[156:159]
  v_mfma_f32_16x16x32_bf16 v[152:155], v[100:103], v[84:87], v[152:155]
  ds_write_b128 v10, v[220:223] offset:11264
  v_mfma_f32_16x16x32_bf16 v[148:151], v[100:103], v[80:83], v[148:151]
  v_mfma_f32_16x16x32_bf16 v[144:147], v[100:103], v[76:79], v[144:147]
  v_mfma_f32_16x16x32_bf16 v[160:163], v[104:107], v[76:79], v[160:163]
  v_mfma_f32_16x16x32_bf16 v[164:167], v[104:107], v[80:83], v[164:167]
  v_mfma_f32_16x16x32_bf16 v[168:171], v[104:107], v[84:87], v[168:171]
  v_mfma_f32_16x16x32_bf16 v[184:187], v[108:111], v[84:87], v[184:187]
  s_waitcnt lgkmcnt(0)
  s_barrier
  v_mfma_f32_16x16x32_bf16 v[180:183], v[108:111], v[80:83], v[180:183]
  ds_read_b128 v[48:51], v19 offset:0
  ds_read_b128 v[52:55], v20 offset:1024
  v_mfma_f32_16x16x32_bf16 v[176:179], v[108:111], v[76:79], v[176:179]
  ds_read2_b32 v[68:69], v23 offset0:16 offset1:176
  ds_read_b128 v[56:59], v19 offset:2048
  v_mfma_f32_16x16x32_bf16 v[192:195], v[76:79], v[112:115], v[192:195]
  ds_read_b128 v[60:63], v20 offset:3072
  ds_read2_b32 v[70:71], v23 offset0:32 offset1:192
  v_mfma_f32_16x16x32_bf16 v[196:199], v[80:83], v[112:115], v[196:199]
  ds_read2_b32 v[72:73], v23 offset0:48 offset1:208
  ds_read2_b32 v[74:75], v23 offset0:64 offset1:224
  v_mfma_f32_16x16x32_bf16 v[200:203], v[84:87], v[112:115], v[200:203]
  ds_read2_b32 v[66:67], v23 offset0:0 offset1:160
  ds_read_b128 v[32:35], v17 offset:2048
  v_mfma_f32_16x16x32_bf16 v[216:219], v[84:87], v[116:119], v[216:219]
  ds_read_b128 v[36:39], v18 offset:3072
  ds_read_b128 v[40:43], v17 offset:4096
  v_mfma_f32_16x16x32_bf16 v[212:215], v[80:83], v[116:119], v[212:215]
  ds_read_b128 v[44:47], v18 offset:5120
  ds_read_b32 v64, v21 offset:4096
  v_mfma_f32_16x16x32_bf16 v[208:211], v[76:79], v[116:119], v[208:211]
  ds_read_b32 v65, v22 offset:5120
  ds_read2_b32 v[120:121], v25 offset0:0 offset1:16
  s_waitcnt lgkmcnt(11)
  v_pk_fma_f32 v[128:129], v[48:49], v[68:69], v[128:129] op_sel:[0,0,0] op_sel_hi:[1,0,1] neg_lo:[0,1,0] neg_hi:[0,1,0]
  v_pk_fma_f32 v[130:131], v[50:51], v[68:69], v[130:131] op_sel:[0,0,0] op_sel_hi:[1,0,1] neg_lo:[0,1,0] neg_hi:[0,1,0]
  v_pk_fma_f32 v[144:145], v[52:53], v[68:69], v[144:145] op_sel:[0,0,0] op_sel_hi:[1,0,1] neg_lo:[0,1,0] neg_hi:[0,1,0]
  v_pk_fma_f32 v[146:147], v[54:55], v[68:69], v[146:147] op_sel:[0,0,0] op_sel_hi:[1,0,1] neg_lo:[0,1,0] neg_hi:[0,1,0]
  v_cvt_pk_bf16_f32 v128, v128, v129
  v_cvt_pk_bf16_f32 v129, v130, v131
  v_cvt_pk_bf16_f32 v130, v144, v145
  v_cvt_pk_bf16_f32 v131, v146, v147
  ds_read2_b32 v[124:125], v26 offset0:0 offset1:16
  ds_read2_b32 v[122:123], v25 offset0:32 offset1:48
  ds_read2_b32 v[126:127], v26 offset0:32 offset1:48
  v_pk_fma_f32 v[160:161], v[56:57], v[68:69], v[160:161] op_sel:[0,0,0] op_sel_hi:[1,0,1] neg_lo:[0,1,0] neg_hi:[0,1,0]
  v_pk_fma_f32 v[162:163], v[58:59], v[68:69], v[162:163] op_sel:[0,0,0] op_sel_hi:[1,0,1] neg_lo:[0,1,0] neg_hi:[0,1,0]
  v_pk_fma_f32 v[176:177], v[60:61], v[68:69], v[176:177] op_sel:[0,0,0] op_sel_hi:[1,0,1] neg_lo:[0,1,0] neg_hi:[0,1,0]
  v_pk_fma_f32 v[178:179], v[62:63], v[68:69], v[178:179] op_sel:[0,0,0] op_sel_hi:[1,0,1] neg_lo:[0,1,0] neg_hi:[0,1,0]
  v_cvt_pk_bf16_f32 v160, v160, v161
  v_cvt_pk_bf16_f32 v161, v162, v163
  v_cvt_pk_bf16_f32 v162, v176, v177
  v_cvt_pk_bf16_f32 v163, v178, v179
  s_waitcnt lgkmcnt(11)
  ds_read_b128 v[76:79], v24 offset:0
  ds_read_b128 v[96:99], v24 offset:640
  ds_read_b128 v[80:83], v24 offset:64
  v_pk_fma_f32 v[132:133], v[48:49], v[70:71], v[132:133] op_sel:[0,0,0] op_sel_hi:[1,0,1] neg_lo:[0,1,0] neg_hi:[0,1,0]
  v_pk_fma_f32 v[134:135], v[50:51], v[70:71], v[134:135] op_sel:[0,0,0] op_sel_hi:[1,0,1] neg_lo:[0,1,0] neg_hi:[0,1,0]
  v_pk_fma_f32 v[148:149], v[52:53], v[70:71], v[148:149] op_sel:[0,0,0] op_sel_hi:[1,0,1] neg_lo:[0,1,0] neg_hi:[0,1,0]
  v_pk_fma_f32 v[150:151], v[54:55], v[70:71], v[150:151] op_sel:[0,0,0] op_sel_hi:[1,0,1] neg_lo:[0,1,0] neg_hi:[0,1,0]
  v_cvt_pk_bf16_f32 v132, v132, v133
  v_cvt_pk_bf16_f32 v133, v134, v135
  v_cvt_pk_bf16_f32 v134, v148, v149
  v_cvt_pk_bf16_f32 v135, v150, v151
  ds_read_b128 v[100:103], v24 offset:704
  ds_read_b128 v[84:87], v24 offset:128
  ds_read_b128 v[104:107], v24 offset:768
  v_pk_fma_f32 v[164:165], v[56:57], v[70:71], v[164:165] op_sel:[0,0,0] op_sel_hi:[1,0,1] neg_lo:[0,1,0] neg_hi:[0,1,0]
  v_pk_fma_f32 v[166:167], v[58:59], v[70:71], v[166:167] op_sel:[0,0,0] op_sel_hi:[1,0,1] neg_lo:[0,1,0] neg_hi:[0,1,0]
  v_pk_fma_f32 v[180:181], v[60:61], v[70:71], v[180:181] op_sel:[0,0,0] op_sel_hi:[1,0,1] neg_lo:[0,1,0] neg_hi:[0,1,0]
  v_pk_fma_f32 v[182:183], v[62:63], v[70:71], v[182:183] op_sel:[0,0,0] op_sel_hi:[1,0,1] neg_lo:[0,1,0] neg_hi:[0,1,0]
  v_cvt_pk_bf16_f32 v164, v164, v165
  v_cvt_pk_bf16_f32 v165, v166, v167
  v_cvt_pk_bf16_f32 v166, v180, v181
  v_cvt_pk_bf16_f32 v167, v182, v183
  ds_read_b128 v[88:91], v24 offset:192
  ds_read_b128 v[108:111], v24 offset:832
  ds_read_b128 v[92:95], v24 offset:256
  v_mfma_f32_16x16x32_bf16 v[144:147], v[160:163], v[128:131], 0
  v_pk_fma_f32 v[136:137], v[48:49], v[72:73], v[136:137] op_sel:[0,0,0] op_sel_hi:[1,0,1] neg_lo:[0,1,0] neg_hi:[0,1,0]
  v_pk_fma_f32 v[138:139], v[50:51], v[72:73], v[138:139] op_sel:[0,0,0] op_sel_hi:[1,0,1] neg_lo:[0,1,0] neg_hi:[0,1,0]
  v_pk_fma_f32 v[152:153], v[52:53], v[72:73], v[152:153] op_sel:[0,0,0] op_sel_hi:[1,0,1] neg_lo:[0,1,0] neg_hi:[0,1,0]
  v_pk_fma_f32 v[154:155], v[54:55], v[72:73], v[154:155] op_sel:[0,0,0] op_sel_hi:[1,0,1] neg_lo:[0,1,0] neg_hi:[0,1,0]
  v_cvt_pk_bf16_f32 v136, v136, v137
  v_cvt_pk_bf16_f32 v137, v138, v139
  v_cvt_pk_bf16_f32 v138, v152, v153
  v_cvt_pk_bf16_f32 v139, v154, v155
  ds_read_b128 v[112:115], v24 offset:896
  v_pk_fma_f32 v[168:169], v[56:57], v[72:73], v[168:169] op_sel:[0,0,0] op_sel_hi:[1,0,1] neg_lo:[0,1,0] neg_hi:[0,1,0]
  v_pk_fma_f32 v[170:171], v[58:59], v[72:73], v[170:171] op_sel:[0,0,0] op_sel_hi:[1,0,1] neg_lo:[0,1,0] neg_hi:[0,1,0]
  v_pk_fma_f32 v[184:185], v[60:61], v[72:73], v[184:185] op_sel:[0,0,0] op_sel_hi:[1,0,1] neg_lo:[0,1,0] neg_hi:[0,1,0]
  v_pk_fma_f32 v[186:187], v[62:63], v[72:73], v[186:187] op_sel:[0,0,0] op_sel_hi:[1,0,1] neg_lo:[0,1,0] neg_hi:[0,1,0]
  v_cvt_pk_bf16_f32 v168, v168, v169
  v_cvt_pk_bf16_f32 v169, v170, v171
  v_cvt_pk_bf16_f32 v170, v184, v185
  v_cvt_pk_bf16_f32 v171, v186, v187
  v_mfma_f32_16x16x32_bf16 v[148:151], v[164:167], v[132:135], 0
  v_mfma_f32_16x16x32_bf16 v[180:183], v[160:163], v[132:135], 0
  v_pk_fma_f32 v[140:141], v[48:49], v[74:75], v[140:141] op_sel:[0,0,0] op_sel_hi:[1,0,1] neg_lo:[0,1,0] neg_hi:[0,1,0]
  v_pk_fma_f32 v[142:143], v[50:51], v[74:75], v[142:143] op_sel:[0,0,0] op_sel_hi:[1,0,1] neg_lo:[0,1,0] neg_hi:[0,1,0]
  v_pk_fma_f32 v[156:157], v[52:53], v[74:75], v[156:157] op_sel:[0,0,0] op_sel_hi:[1,0,1] neg_lo:[0,1,0] neg_hi:[0,1,0]
  v_pk_fma_f32 v[158:159], v[54:55], v[74:75], v[158:159] op_sel:[0,0,0] op_sel_hi:[1,0,1] neg_lo:[0,1,0] neg_hi:[0,1,0]
  v_cvt_pk_bf16_f32 v140, v140, v141
  v_cvt_pk_bf16_f32 v141, v142, v143
  v_cvt_pk_bf16_f32 v142, v156, v157
  v_cvt_pk_bf16_f32 v143, v158, v159
  v_pk_fma_f32 v[172:173], v[56:57], v[74:75], v[172:173] op_sel:[0,0,0] op_sel_hi:[1,0,1] neg_lo:[0,1,0] neg_hi:[0,1,0]
  v_pk_fma_f32 v[174:175], v[58:59], v[74:75], v[174:175] op_sel:[0,0,0] op_sel_hi:[1,0,1] neg_lo:[0,1,0] neg_hi:[0,1,0]
  v_pk_fma_f32 v[188:189], v[60:61], v[74:75], v[188:189] op_sel:[0,0,0] op_sel_hi:[1,0,1] neg_lo:[0,1,0] neg_hi:[0,1,0]
  v_pk_fma_f32 v[190:191], v[62:63], v[74:75], v[190:191] op_sel:[0,0,0] op_sel_hi:[1,0,1] neg_lo:[0,1,0] neg_hi:[0,1,0]
  v_cvt_pk_bf16_f32 v172, v172, v173
  v_cvt_pk_bf16_f32 v173, v174, v175
  v_cvt_pk_bf16_f32 v174, v188, v189
  v_cvt_pk_bf16_f32 v175, v190, v191
  s_waitcnt lgkmcnt(0)
  v_pk_fma_f32 v[32:33], v[56:57], v[66:67], v[32:33] op_sel:[0,0,0] op_sel_hi:[1,0,1] neg_lo:[0,1,0] neg_hi:[0,1,0]
  v_pk_fma_f32 v[34:35], v[58:59], v[66:67], v[34:35] op_sel:[0,0,0] op_sel_hi:[1,0,1] neg_lo:[0,1,0] neg_hi:[0,1,0]
  v_pk_fma_f32 v[36:37], v[60:61], v[66:67], v[36:37] op_sel:[0,0,0] op_sel_hi:[1,0,1] neg_lo:[0,1,0] neg_hi:[0,1,0]
  v_pk_fma_f32 v[38:39], v[62:63], v[66:67], v[38:39] op_sel:[0,0,0] op_sel_hi:[1,0,1] neg_lo:[0,1,0] neg_hi:[0,1,0]
  v_cvt_pk_bf16_f32 v32, v32, v33
  v_cvt_pk_bf16_f32 v33, v34, v35
  v_cvt_pk_bf16_f32 v34, v36, v37
  v_cvt_pk_bf16_f32 v35, v38, v39
  v_mfma_f32_16x16x32_bf16 v[152:155], v[168:171], v[136:139], 0
  v_mfma_f32_16x16x32_bf16 v[184:187], v[164:167], v[136:139], 0
  v_mfma_f32_16x16x32_bf16 v[156:159], v[172:175], v[140:143], 0
  v_mfma_f32_16x16x32_bf16 v[188:191], v[168:171], v[140:143], 0
  v_mfma_f32_16x16x32_bf16 v[176:179], v[32:35], v[128:131], 0
  v_mul_f32 v69, 0x3e8293ee, v69
  v_mul_f32 v71, 0x3e8293ee, v71
  v_mul_f32 v73, 0x3e8293ee, v73
  v_mul_f32 v75, 0x3e8293ee, v75
  v_mul_f32 v120, v120, v69
  v_mul_f32 v124, v124, v69
  v_mul_f32 v121, v121, v71
  v_mul_f32 v125, v125, v71
  v_mul_f32 v122, v122, v73
  v_mul_f32 v126, v126, v73
  v_mul_f32 v123, v123, v75
  v_mul_f32 v127, v127, v75
  v_pk_fma_f32 v[40:41], v[76:77], v[64:65], v[40:41] op_sel:[0,0,0] op_sel_hi:[1,0,1] neg_lo:[1,0,0] neg_hi:[1,0,0]
  v_pk_fma_f32 v[42:43], v[78:79], v[64:65], v[42:43] op_sel:[0,0,0] op_sel_hi:[1,0,1] neg_lo:[1,0,0] neg_hi:[1,0,0]
  v_pk_mul_f32 v[40:41], v[40:41], v[96:97]
  v_pk_mul_f32 v[42:43], v[42:43], v[98:99]
  v_cvt_pk_bf16_f32 v4, v40, v41
  v_cvt_pk_bf16_f32 v5, v42, v43
  v_pk_fma_f32 v[192:193], v[80:81], v[64:65], v[192:193] op_sel:[0,0,0] op_sel_hi:[1,0,1] neg_lo:[1,0,0] neg_hi:[1,0,0]
  v_pk_fma_f32 v[194:195], v[82:83], v[64:65], v[194:195] op_sel:[0,0,0] op_sel_hi:[1,0,1] neg_lo:[1,0,0] neg_hi:[1,0,0]
  v_pk_mul_f32 v[192:193], v[192:193], v[100:101]
  v_pk_mul_f32 v[194:195], v[194:195], v[102:103]
  v_cvt_pk_bf16_f32 v6, v192, v193
  v_cvt_pk_bf16_f32 v7, v194, v195
  v_pk_fma_f32 v[196:197], v[84:85], v[64:65], v[196:197] op_sel:[0,0,0] op_sel_hi:[1,0,1] neg_lo:[1,0,0] neg_hi:[1,0,0]
  v_pk_fma_f32 v[198:199], v[86:87], v[64:65], v[198:199] op_sel:[0,0,0] op_sel_hi:[1,0,1] neg_lo:[1,0,0] neg_hi:[1,0,0]
  v_pk_mul_f32 v[196:197], v[196:197], v[104:105]
  v_pk_mul_f32 v[198:199], v[198:199], v[106:107]
  v_cvt_pk_bf16_f32 v8, v196, v197
  v_cvt_pk_bf16_f32 v9, v198, v199
  v_pk_fma_f32 v[200:201], v[88:89], v[64:65], v[200:201] op_sel:[0,0,0] op_sel_hi:[1,0,1] neg_lo:[1,0,0] neg_hi:[1,0,0]
  v_pk_fma_f32 v[202:203], v[90:91], v[64:65], v[202:203] op_sel:[0,0,0] op_sel_hi:[1,0,1] neg_lo:[1,0,0] neg_hi:[1,0,0]
  v_pk_mul_f32 v[200:201], v[200:201], v[108:109]
  v_pk_mul_f32 v[202:203], v[202:203], v[110:111]
  v_cvt_pk_bf16_f32 v10, v200, v201
  v_cvt_pk_bf16_f32 v11, v202, v203
  v_pk_fma_f32 v[204:205], v[92:93], v[64:65], v[204:205] op_sel:[0,0,0] op_sel_hi:[1,0,1] neg_lo:[1,0,0] neg_hi:[1,0,0]
  v_pk_fma_f32 v[206:207], v[94:95], v[64:65], v[206:207] op_sel:[0,0,0] op_sel_hi:[1,0,1] neg_lo:[1,0,0] neg_hi:[1,0,0]
  v_pk_mul_f32 v[204:205], v[204:205], v[112:113]
  v_pk_mul_f32 v[206:207], v[206:207], v[114:115]
  v_cvt_pk_bf16_f32 v12, v204, v205
  v_cvt_pk_bf16_f32 v13, v206, v207
  v_pk_fma_f32 v[44:45], v[76:77], v[64:65], v[44:45] op_sel:[0,1,0] op_sel_hi:[1,1,1] neg_lo:[1,0,0] neg_hi:[1,0,0]
  v_pk_fma_f32 v[46:47], v[78:79], v[64:65], v[46:47] op_sel:[0,1,0] op_sel_hi:[1,1,1] neg_lo:[1,0,0] neg_hi:[1,0,0]
  v_pk_mul_f32 v[44:45], v[44:45], v[96:97]
  v_pk_mul_f32 v[46:47], v[46:47], v[98:99]
  v_cvt_pk_bf16_f32 v224, v44, v45
  v_cvt_pk_bf16_f32 v225, v46, v47
  v_pk_fma_f32 v[208:209], v[80:81], v[64:65], v[208:209] op_sel:[0,1,0] op_sel_hi:[1,1,1] neg_lo:[1,0,0] neg_hi:[1,0,0]
  v_pk_fma_f32 v[210:211], v[82:83], v[64:65], v[210:211] op_sel:[0,1,0] op_sel_hi:[1,1,1] neg_lo:[1,0,0] neg_hi:[1,0,0]
  v_pk_mul_f32 v[208:209], v[208:209], v[100:101]
  v_pk_mul_f32 v[210:211], v[210:211], v[102:103]
  v_cvt_pk_bf16_f32 v226, v208, v209
  v_cvt_pk_bf16_f32 v227, v210, v211
  v_pk_fma_f32 v[212:213], v[84:85], v[64:65], v[212:213] op_sel:[0,1,0] op_sel_hi:[1,1,1] neg_lo:[1,0,0] neg_hi:[1,0,0]
  v_pk_fma_f32 v[214:215], v[86:87], v[64:65], v[214:215] op_sel:[0,1,0] op_sel_hi:[1,1,1] neg_lo:[1,0,0] neg_hi:[1,0,0]
  v_pk_mul_f32 v[212:213], v[212:213], v[104:105]
  v_pk_mul_f32 v[214:215], v[214:215], v[106:107]
  v_cvt_pk_bf16_f32 v228, v212, v213
  v_cvt_pk_bf16_f32 v229, v214, v215
  v_pk_fma_f32 v[216:217], v[88:89], v[64:65], v[216:217] op_sel:[0,1,0] op_sel_hi:[1,1,1] neg_lo:[1,0,0] neg_hi:[1,0,0]
  v_pk_fma_f32 v[218:219], v[90:91], v[64:65], v[218:219] op_sel:[0,1,0] op_sel_hi:[1,1,1] neg_lo:[1,0,0] neg_hi:[1,0,0]
  v_pk_mul_f32 v[216:217], v[216:217], v[108:109]
  v_pk_mul_f32 v[218:219], v[218:219], v[110:111]
  v_cvt_pk_bf16_f32 v230, v216, v217
  v_cvt_pk_bf16_f32 v231, v218, v219
  v_pk_fma_f32 v[220:221], v[92:93], v[64:65], v[220:221] op_sel:[0,1,0] op_sel_hi:[1,1,1] neg_lo:[1,0,0] neg_hi:[1,0,0]
  v_pk_fma_f32 v[222:223], v[94:95], v[64:65], v[222:223] op_sel:[0,1,0] op_sel_hi:[1,1,1] neg_lo:[1,0,0] neg_hi:[1,0,0]
  v_pk_mul_f32 v[220:221], v[220:221], v[112:113]
  v_pk_mul_f32 v[222:223], v[222:223], v[114:115]
  v_cvt_pk_bf16_f32 v232, v220, v221
  v_cvt_pk_bf16_f32 v233, v222, v223
  v_cndmask_b32 v148, v148, v149, s[48:49]
  v_cndmask_b32 v180, v180, v181, s[48:49]
  v_cndmask_b32 v150, v150, v151, s[48:49]
  v_cndmask_b32 v182, v182, v183, s[48:49]
  v_cndmask_b32 v36, v148, v180, s[50:51]
  v_cndmask_b32 v37, v150, v182, s[52:53]
  v_mul_f32 v36, v36, v121
  v_mul_f32 v37, v37, v125
  v_cndmask_b32 v152, v152, v153, s[48:49]
  v_cndmask_b32 v184, v184, v185, s[48:49]
  v_cndmask_b32 v154, v154, v155, s[48:49]
  v_cndmask_b32 v186, v186, v187, s[48:49]
  v_cndmask_b32 v40, v152, v184, s[50:51]
  v_cndmask_b32 v41, v154, v186, s[52:53]
  v_mul_f32 v40, v40, v122
  v_mul_f32 v41, v41, v126
  v_cndmask_b32 v156, v156, v157, s[48:49]
  v_cndmask_b32 v188, v188, v189, s[48:49]
  v_cndmask_b32 v158, v158, v159, s[48:49]
  v_cndmask_b32 v190, v190, v191, s[48:49]
  v_cndmask_b32 v44, v156, v188, s[50:51]
  v_cndmask_b32 v45, v158, v190, s[52:53]
  v_mul_f32 v44, v44, v123
  v_mul_f32 v45, v45, v127
  v_cndmask_b32 v144, v144, v145, s[48:49]
  v_cndmask_b32 v176, v176, v177, s[48:49]
  v_cndmask_b32 v146, v146, v147, s[48:49]
  v_cndmask_b32 v178, v178, v179, s[48:49]
  v_cndmask_b32 v32, v144, v176, s[50:51]
  v_cndmask_b32 v33, v146, v178, s[52:53]
  v_mul_f32 v32, v32, v120
  v_mul_f32 v33, v33, v124
  v_mov_b32 v48, 0xceabfb8f
  v_cndmask_b32 v32, v32, v48, s[54:55]
  v_cndmask_b32 v33, v33, v48, s[14:15]
  v_max_f32 v34, v32, v33
  v_max_f32 v38, v36, v37
  v_max_f32 v42, v40, v41
  v_max_f32 v46, v44, v45
  v_mov_b32 v35, v34
  v_mov_b32 v39, v38
  v_mov_b32 v43, v42
  v_mov_b32 v47, v46
  v_permlane32_swap_b32 v34, v35
  v_permlane32_swap_b32 v38, v39
  v_permlane32_swap_b32 v42, v43
  v_permlane32_swap_b32 v46, v47
  v_max_f32 v34, v34, v35
  v_max_f32 v38, v38, v39
  v_max_f32 v42, v42, v43
  v_max_f32 v46, v46, v47
  v_mov_b32 v35, v34
  v_mov_b32 v39, v38
  v_mov_b32 v43, v42
  v_mov_b32 v47, v46
  v_permlane16_swap_b32 v34, v35
  v_permlane16_swap_b32 v38, v39
  v_permlane16_swap_b32 v42, v43
  v_permlane16_swap_b32 v46, v47
  v_max_f32 v34, v34, v35
  v_max_f32 v38, v38, v39
  v_max_f32 v42, v42, v43
  v_max_f32 v46, v46, v47
  v_sub_f32 v32, v32, v34
  v_sub_f32 v33, v33, v34
  v_sub_f32 v36, v36, v38
  v_sub_f32 v37, v37, v38
  v_sub_f32 v40, v40, v42
  v_sub_f32 v41, v41, v42
  v_sub_f32 v44, v44, v46
  v_sub_f32 v45, v45, v46
  v_exp_f32 v32, v32
  v_exp_f32 v33, v33
  v_exp_f32 v36, v36
  v_exp_f32 v37, v37
  v_exp_f32 v40, v40
  v_exp_f32 v41, v41
  v_exp_f32 v44, v44
  v_exp_f32 v45, v45
  v_cvt_pk_bf16_f32 v32, v32, v32
  v_cvt_pk_bf16_f32 v33, v33, v33
  v_and_b32 v128, v32, v27
  v_and_b32 v129, v33, v29
  v_and_b32 v130, v32, v28
  v_and_b32 v131, v33, v30
  v_cvt_pk_bf16_f32 v36, v36, v36
  v_cvt_pk_bf16_f32 v37, v37, v37
  v_and_b32 v132, v36, v27
  v_and_b32 v133, v37, v29
  v_and_b32 v134, v36, v28
  v_and_b32 v135, v37, v30
  v_mfma_f32_16x16x32_bf16 v[144:147], v[236:239], v[128:131], 0
  v_mfma_f32_16x16x32_bf16 v[192:195], v[4:7], v[128:131], 0
  v_mfma_f32_16x16x32_bf16 v[208:211], v[224:227], v[128:131], 0
  v_cvt_pk_bf16_f32 v40, v40, v40
  v_cvt_pk_bf16_f32 v41, v41, v41
  v_and_b32 v136, v40, v27
  v_and_b32 v137, v41, v29
  v_and_b32 v138, v40, v28
  v_and_b32 v139, v41, v30
  v_mfma_f32_16x16x32_bf16 v[148:151], v[236:239], v[132:135], 0
  v_mfma_f32_16x16x32_bf16 v[196:199], v[6:9], v[132:135], 0
  v_mfma_f32_16x16x32_bf16 v[212:215], v[226:229], v[132:135], 0
  v_cvt_pk_bf16_f32 v44, v44, v44
  v_cvt_pk_bf16_f32 v45, v45, v45
  v_and_b32 v140, v44, v27
  v_and_b32 v141, v45, v29
  v_and_b32 v142, v44, v28
  v_and_b32 v143, v45, v30
  v_mfma_f32_16x16x32_bf16 v[152:155], v[236:239], v[136:139], 0
  v_mfma_f32_16x16x32_bf16 v[200:203], v[8:11], v[136:139], 0
  v_mfma_f32_16x16x32_bf16 v[216:219], v[228:231], v[136:139], 0
  v_mfma_f32_16x16x32_bf16 v[156:159], v[236:239], v[140:143], 0
  v_mfma_f32_16x16x32_bf16 v[204:207], v[10:13], v[140:143], 0
  v_mfma_f32_16x16x32_bf16 v[220:223], v[230:233], v[140:143], 0
  s_cmp_eq_u32 s71, 1
  s_cbranch_scc1 L_attn_out1
  v_rcp_f32 v144, v144
  s_mov_b32 s3, 0
  v_pk_mul_f32 v[192:193], v[192:193], v[144:145] op_sel_hi:[1,0]
  v_pk_mul_f32 v[194:195], v[194:195], v[144:145] op_sel_hi:[1,0]
  v_pk_mul_f32 v[208:209], v[208:209], v[144:145] op_sel_hi:[1,0]
  v_pk_mul_f32 v[210:211], v[210:211], v[144:145] op_sel_hi:[1,0]
  v_cvt_pk_bf16_f32 v48, v192, v193
  v_cvt_pk_bf16_f32 v49, v194, v195
  v_cvt_pk_bf16_f32 v50, v208, v209
  v_cvt_pk_bf16_f32 v51, v210, v211
  buffer_store_dwordx4 v[48:51], v31, s[44:47], s3 offen sc1
  v_rcp_f32 v148, v148
  s_mov_b32 s3, 114688
  v_pk_mul_f32 v[196:197], v[196:197], v[148:149] op_sel_hi:[1,0]
  v_pk_mul_f32 v[198:199], v[198:199], v[148:149] op_sel_hi:[1,0]
  v_pk_mul_f32 v[212:213], v[212:213], v[148:149] op_sel_hi:[1,0]
  v_pk_mul_f32 v[214:215], v[214:215], v[148:149] op_sel_hi:[1,0]
  v_cvt_pk_bf16_f32 v52, v196, v197
  v_cvt_pk_bf16_f32 v53, v198, v199
  v_cvt_pk_bf16_f32 v54, v212, v213
  v_cvt_pk_bf16_f32 v55, v214, v215
  buffer_store_dwordx4 v[52:55], v31, s[44:47], s3 offen sc1
  v_rcp_f32 v152, v152
  s_mov_b32 s3, 229376
  v_pk_mul_f32 v[200:201], v[200:201], v[152:153] op_sel_hi:[1,0]
  v_pk_mul_f32 v[202:203], v[202:203], v[152:153] op_sel_hi:[1,0]
  v_pk_mul_f32 v[216:217], v[216:217], v[152:153] op_sel_hi:[1,0]
  v_pk_mul_f32 v[218:219], v[218:219], v[152:153] op_sel_hi:[1,0]
  v_cvt_pk_bf16_f32 v56, v200, v201
  v_cvt_pk_bf16_f32 v57, v202, v203
  v_cvt_pk_bf16_f32 v58, v216, v217
  v_cvt_pk_bf16_f32 v59, v218, v219
  buffer_store_dwordx4 v[56:59], v31, s[44:47], s3 offen sc1
  v_rcp_f32 v156, v156
  s_mov_b32 s3, 344064
  v_pk_mul_f32 v[204:205], v[204:205], v[156:157] op_sel_hi:[1,0]
  v_pk_mul_f32 v[206:207], v[206:207], v[156:157] op_sel_hi:[1,0]
  v_pk_mul_f32 v[220:221], v[220:221], v[156:157] op_sel_hi:[1,0]
  v_pk_mul_f32 v[222:223], v[222:223], v[156:157] op_sel_hi:[1,0]
  v_cvt_pk_bf16_f32 v60, v204, v205
  v_cvt_pk_bf16_f32 v61, v206, v207
  v_cvt_pk_bf16_f32 v62, v220, v221
  v_cvt_pk_bf16_f32 v63, v222, v223
  buffer_store_dwordx4 v[60:63], v31, s[44:47], s3 offen sc1
  s_branch L_attn_out2
L_attn_out1:
  v_rcp_f32 v144, v144
  s_mov_b32 s3, 0
  v_pk_mul_f32 v[192:193], v[192:193], v[144:145] op_sel_hi:[1,0]
  v_pk_mul_f32 v[194:195], v[194:195], v[144:145] op_sel_hi:[1,0]
  v_pk_mul_f32 v[208:209], v[208:209], v[144:145] op_sel_hi:[1,0]
  v_pk_mul_f32 v[210:211], v[210:211], v[144:145] op_sel_hi:[1,0]
  v_cvt_pk_bf16_f32 v50, v192, v193
  v_cvt_pk_bf16_f32 v51, v194, v195
  v_cvt_pk_bf16_f32 v48, v208, v209
  v_cvt_pk_bf16_f32 v49, v210, v211
  buffer_store_dwordx4 v[48:51], v31, s[44:47], s3 offen sc1
  v_rcp_f32 v148, v148
  s_mov_b32 s3, 114688
  v_pk_mul_f32 v[196:197], v[196:197], v[148:149] op_sel_hi:[1,0]
  v_pk_mul_f32 v[198:199], v[198:199], v[148:149] op_sel_hi:[1,0]
  v_pk_mul_f32 v[212:213], v[212:213], v[148:149] op_sel_hi:[1,0]
  v_pk_mul_f32 v[214:215], v[214:215], v[148:149] op_sel_hi:[1,0]
  v_cvt_pk_bf16_f32 v54, v196, v197
  v_cvt_pk_bf16_f32 v55, v198, v199
  v_cvt_pk_bf16_f32 v52, v212, v213
  v_cvt_pk_bf16_f32 v53, v214, v215
  buffer_store_dwordx4 v[52:55], v31, s[44:47], s3 offen sc1
  v_rcp_f32 v152, v152
  s_mov_b32 s3, 229376
  v_pk_mul_f32 v[200:201], v[200:201], v[152:153] op_sel_hi:[1,0]
  v_pk_mul_f32 v[202:203], v[202:203], v[152:153] op_sel_hi:[1,0]
  v_pk_mul_f32 v[216:217], v[216:217], v[152:153] op_sel_hi:[1,0]
  v_pk_mul_f32 v[218:219], v[218:219], v[152:153] op_sel_hi:[1,0]
  v_cvt_pk_bf16_f32 v58, v200, v201
  v_cvt_pk_bf16_f32 v59, v202, v203
  v_cvt_pk_bf16_f32 v56, v216, v217
  v_cvt_pk_bf16_f32 v57, v218, v219
  buffer_store_dwordx4 v[56:59], v31, s[44:47], s3 offen sc1
  v_rcp_f32 v156, v156
  s_mov_b32 s3, 344064
  v_pk_mul_f32 v[204:205], v[204:205], v[156:157] op_sel_hi:[1,0]
  v_pk_mul_f32 v[206:207], v[206:207], v[156:157] op_sel_hi:[1,0]
  v_pk_mul_f32 v[220:221], v[220:221], v[156:157] op_sel_hi:[1,0]
  v_pk_mul_f32 v[222:223], v[222:223], v[156:157] op_sel_hi:[1,0]
  v_cvt_pk_bf16_f32 v62, v204, v205
  v_cvt_pk_bf16_f32 v63, v206, v207
  v_cvt_pk_bf16_f32 v60, v220, v221
  v_cvt_pk_bf16_f32 v61, v222, v223
  buffer_store_dwordx4 v[60:63], v31, s[44:47], s3 offen sc1
L_attn_out2:
  s_waitcnt vmcnt(0) lgkmcnt(0)
  s_barrier
  s_add_u32 s97, s97, 1
  s_branch L_wo_body
.section .rodata,"a"
.p2align 6
.amdhsa_kernel interleave_layers__sliding_local_dilated__dense_activation_gelu__prompt_kernel
  .amdhsa_next_free_vgpr 256
  .amdhsa_next_free_sgpr 102
  .amdhsa_accum_offset 256
  .amdhsa_group_segment_fixed_size 0
  .amdhsa_kernarg_size 88
  .amdhsa_user_sgpr_count 2
  .amdhsa_user_sgpr_kernarg_segment_ptr 1
  .amdhsa_system_sgpr_workgroup_id_x 1
  .amdhsa_float_denorm_mode_32 3
  .amdhsa_float_denorm_mode_16_64 3
.end_amdhsa_kernel
.text
L_attn_c1:
L_wo_c0:
L_wo_body:
  s_cmp_ge_u32 s2, 256
  s_cbranch_scc1 L_wo_end
  v_lshrrev_b32 v2, 6, v0
  v_and_b32 v1, 63, v0
  v_readfirstlane_b32 s70, v2
  s_and_b32 s3, s2, 7
  s_lshr_b32 s99, s2, 3
  s_and_b32 s5, s3, 3
  s_lshl_b32 s5, s5, 2
  s_and_b32 s6, s99, 3
  s_add_u32 s68, s5, s6
  s_lshr_b32 s5, s3, 2
  s_lshr_b32 s78, s99, 2
  s_lshl1_add_u32 s69, s78, s5
  s_add_u32 s3, s68, s78
  s_lshl_b32 s3, s3, 3
  s_lshl_b32 s85, 0xffff02, s3
  s_sub_u32 s3, 0, s3
  s_lshr_b32 s3, 0xffff02, s3
  s_or_b32 s85, s85, s3
  s_cmp_lt_u32 s70, 4
  s_cbranch_scc1 L_wo_compute
L_wo_loader:
  s_add_u32 s3, s96, s70
  s_cmp_lg_u32 s3, 4
  s_cbranch_scc1 L_wo_chk0
  s_load_dwordx2 s[64:65], s[0:1], 72
  s_waitcnt lgkmcnt(0)
  s_and_b32 s65, s65, 0xffff
  s_mov_b32 s66, 256
  s_mov_b32 s67, 0x00020000
  v_lshlrev_b32 v17, 2, v1
  buffer_load_dword v12, v17, s[64:67], 0 offen sc1
L_wo_chk0:
  v_and_b32 v2, 3, v1
  v_lshlrev_b32 v2, 3, v2
  v_bfe_i32 v16, s85, v2, 8
  s_and_b32 s3, s68, 3
  s_mul_i32 s4, s3, 4
  v_add3_u32 v3, v16, v1, s4
  v_and_b32 v3, 15, v3
  v_lshlrev_b32 v16, 17, v3
  s_add_u32 s9, s70, s68
  s_and_b32 s9, s9, 3
  s_lshl_b32 s77, s9, 11
  v_and_b32 v10, 7, v1
  v_lshrrev_b32 v3, 3, v1
  s_lshl_b32 s10, s9, 4
  v_add_u32 v3, s10, v3
  v_mul_u32_u24 v3, 2048, v3
  v_lshrrev_b32 v2, 3, v1
  v_and_b32 v2, 6, v2
  v_xor_b32 v2, v2, v10
  s_lshl_b32 s10, s69, 7
  v_add_u32 v3, s10, v3
  v_lshl_add_u32 v8, v2, 4, v3
  v_add_u32 v3, 16384, v3
  v_lshl_add_u32 v9, v2, 4, v3
  s_mov_b32 s40, s20
  s_and_b32 s41, s21, 0xffff
  s_mov_b32 s42, 2097152
  s_mov_b32 s43, 0x00020000
  v_readlane_b32 s74, v16, 0
  s_add_u32 m0, s77, 28672
  s_add_u32 s4, s74, 0
  buffer_load_dwordx4 v8, s[40:43], s4 offen lds
  s_add_u32 m0, s77, 29696
  s_nop 0
  buffer_load_dwordx4 v9, s[40:43], s4 offen lds
  v_readlane_b32 s74, v16, 1
  s_add_u32 m0, s77, 36864
  s_add_u32 s4, s74, 0
  buffer_load_dwordx4 v8, s[40:43], s4 offen lds
  s_add_u32 m0, s77, 37888
  s_nop 0
  buffer_load_dwordx4 v9, s[40:43], s4 offen lds
  v_readlane_b32 s74, v16, 2
  s_add_u32 m0, s77, 45056
  s_add_u32 s4, s74, 0
  buffer_load_dwordx4 v8, s[40:43], s4 offen lds
  s_add_u32 m0, s77, 46080
  s_nop 0
  buffer_load_dwordx4 v9, s[40:43], s4 offen lds
  v_readlane_b32 s74, v16, 3
  s_add_u32 m0, s77, 53248
  s_add_u32 s4, s74, 0
  buffer_load_dwordx4 v8, s[40:43], s4 offen lds
  s_add_u32 m0, s77, 54272
  s_nop 0
  buffer_load_dwordx4 v9, s[40:43], s4 offen lds
  v_readlane_b32 s74, v16, 4
  s_add_u32 m0, s77, 61440
  s_add_u32 s4, s74, 0
  buffer_load_dwordx4 v8, s[40:43], s4 offen lds
  s_add_u32 m0, s77, 62464
  s_nop 0
  buffer_load_dwordx4 v9, s[40:43], s4 offen lds
  v_readlane_b32 s74, v16, 5
  s_add_u32 m0, s77, 69632
  s_add_u32 s4, s74, 0
  buffer_load_dwordx4 v8, s[40:43], s4 offen lds
  s_add_u32 m0, s77, 70656
  s_nop 0
  buffer_load_dwordx4 v9, s[40:43], s4 offen lds
  s_waitcnt vmcnt(12)
  s_add_u32 s3, s96, s70
  s_cmp_lg_u32 s3, 4
  s_cbranch_scc1 L_wo_chk1
  v_cmp_ne_u32 vcc, 0x01010101, v12
  s_cbranch_vccz L_wo_chk1
  s_load_dwordx2 s[64:65], s[0:1], 72
  s_waitcnt lgkmcnt(0)
  s_and_b32 s65, s65, 0xffff
  s_mov_b32 s66, 256
  s_mov_b32 s67, 0x00020000
  v_lshlrev_b32 v17, 2, v1
  s_mov_b32 s79, 0x100000
L_wo_chkl:
  buffer_load_dword v12, v17, s[64:67], 0 offen sc1
  s_sub_u32 s79, s79, 1
  s_cbranch_scc1 L_wo_chk1
  s_waitcnt vmcnt(0)
  v_cmp_ne_u32 vcc, 0x01010101, v12
  s_cbranch_vccnz L_wo_chkl
L_wo_chk1:
  s_waitcnt vmcnt(12)
  s_add_u32 s44, s22, 41943040
  s_addc_u32 s45, s23, 0
  s_and_b32 s45, s45, 0xffff
  s_mov_b32 s46, 524288
  s_mov_b32 s47, 0x00020000
  s_lshl4_add_u32 s3, s97, s68
  s_and_b32 s4, s69, 15
  s_lshl4_add_u32 s3, s3, s4
  s_lshl_b32 s3, s3, 7
  s_sub_u32 s3, s3, 32768
  v_lshlrev_b32 v11, 7, v1
  v_and_b32 v2, 15, v1
  v_lshlrev_b32 v2, 2, v2
  v_mov_b32 v3, 1
  s_mov_b32 s79, 0x100000
  s_cmp_lg_u32 s70, 4
  s_barrier
  s_cbranch_scc1 L_wo_nofl
  s_mov_b32 exec_lo, 0xffff
  s_mov_b32 exec_hi, 0
  buffer_store_dword v3, v11, s[44:47], s87 offen sc1
  s_mov_b64 exec, -1
L_wo_nofl:
  s_mov_b32 s5, s3
  v_readlane_b32 s74, v16, 6
  s_add_u32 m0, s77, 77824
  s_add_u32 s4, s74, 0
  buffer_load_dwordx4 v8, s[40:43], s4 offen lds
  s_add_u32 m0, s77, 78848
  s_nop 0
  buffer_load_dwordx4 v9, s[40:43], s4 offen lds
  v_readlane_b32 s74, v16, 7
  s_add_u32 m0, s77, 86016
  s_add_u32 s4, s74, 0
  buffer_load_dwordx4 v8, s[40:43], s4 offen lds
  s_add_u32 m0, s77, 87040
  s_nop 0
  buffer_load_dwordx4 v9, s[40:43], s4 offen lds
  v_readlane_b32 s74, v16, 8
  s_add_u32 m0, s77, 94208
  s_add_u32 s4, s74, 0
  buffer_load_dwordx4 v8, s[40:43], s4 offen lds
  s_add_u32 m0, s77, 95232
  s_nop 0
  buffer_load_dwordx4 v9, s[40:43], s4 offen lds
  v_readlane_b32 s74, v16, 9
  s_add_u32 m0, s77, 102400
  s_add_u32 s4, s74, 0
  buffer_load_dwordx4 v8, s[40:43], s4 offen lds
  s_add_u32 m0, s77, 103424
  s_nop 0
  buffer_load_dwordx4 v9, s[40:43], s4 offen lds
  v_readlane_b32 s74, v16, 10
  s_add_u32 m0, s77, 110592
  s_add_u32 s4, s74, 0
  buffer_load_dwordx4 v8, s[40:43], s4 offen lds
  s_add_u32 m0, s77, 111616
  s_nop 0
  buffer_load_dwordx4 v9, s[40:43], s4 offen lds
  v_readlane_b32 s74, v16, 11
  s_add_u32 m0, s77, 118784
  s_add_u32 s4, s74, 0
  buffer_load_dwordx4 v8, s[40:43], s4 offen lds
  s_add_u32 m0, s77, 119808
  s_nop 0
  buffer_load_dwordx4 v9, s[40:43], s4 offen lds
  v_readlane_b32 s74, v16, 12
  s_add_u32 m0, s77, 131072
  s_add_u32 s4, s74, 0
  buffer_load_dwordx4 v8, s[40:43], s4 offen lds
  s_add_u32 m0, s77, 132096
  s_nop 0
  buffer_load_dwordx4 v9, s[40:43], s4 offen lds
  v_readlane_b32 s74, v16, 13
  s_add_u32 m0, s77, 139264
  s_add_u32 s4, s74, 0
  buffer_load_dwordx4 v8, s[40:43], s4 offen lds
  s_add_u32 m0, s77, 140288
  s_nop 0
  buffer_load_dwordx4 v9, s[40:43], s4 offen lds
  v_readlane_b32 s74, v16, 14
  s_add_u32 m0, s77, 147456
  s_add_u32 s4, s74, 0
  buffer_load_dwordx4 v8, s[40:43], s4 offen lds
  s_add_u32 m0, s77, 148480
  s_nop 0
  buffer_load_dwordx4 v9, s[40:43], s4 offen lds
  v_readlane_b32 s74, v16, 15
  s_add_u32 m0, s77, 155648
  s_add_u32 s4, s74, 0
  buffer_load_dwordx4 v8, s[40:43], s4 offen lds
  s_add_u32 m0, s77, 156672
  s_nop 0
  buffer_load_dwordx4 v9, s[40:43], s4 offen lds
  s_mov_b32 s3, s5
  s_cmp_lg_u32 s70, 4
  s_cbranch_scc1 L_wo_dep
L_wo_poll:
  buffer_load_dword v3, v2, s[44:47], s3 offen sc1
  s_sub_u32 s79, s79, 1
  s_cbranch_scc1 L_wo_dep
  s_waitcnt vmcnt(0)
  v_cmp_ne_u32 vcc, 1, v3
  s_cbranch_vccnz L_wo_poll
L_wo_dep:
  s_waitcnt vmcnt(20) lgkmcnt(0)
  s_barrier
  s_waitcnt vmcnt(2)
  s_barrier
  s_lshl_b32 s87, s97, 15
  s_lshl_b32 s4, s68, 11
  s_add_u32 s87, s87, s4
  s_lshl_b32 s4, s69, 2
  s_add_u32 s87, s87, s4
  s_add_u32 s97, s97, 1
  s_branch L_w1_body
L_wo_end:
  s_endpgm
L_wo_compute:
  v_and_b32 v2, 3, v1
  v_lshlrev_b32 v2, 3, v2
  v_bfe_i32 v15, s85, v2, 8
  s_and_b32 s3, s68, 3
  s_mul_i32 s4, s3, 4
  v_add3_u32 v3, v15, v1, s4
  v_and_b32 v3, 15, v3
  v_lshlrev_b32 v15, 12, v3
  v_and_b32 v3, 15, v1
  v_lshrrev_b32 v2, 4, v1
  s_lshl_b32 s8, s68, 7
  s_lshl_b32 s9, s70, 5
  s_add_u32 s8, s8, s9
  s_mul_i32 s9, s8, 7168
  v_add_u32 v13, s8, v3
  s_lshl_b32 s10, s69, 7
  v_lshl_add_u32 v14, v2, 3, s10
  v_and_b32 v16, 1, v2
  v_lshrrev_b32 v17, 1, v2
  v_lshlrev_b32 v16, 4, v1
  s_add_u32 s9, s8, s69
  s_lshl_b32 s9, s9, 11
  v_add_u32 v12, s9, v16
  s_lshl_b32 s9, s70, 12
  v_add_u32 v19, s9, v16
  v_bfe_u32 v16, v1, 2, 2
  v_xor_b32 v16, v16, v2
  v_lshl_add_u32 v18, v16, 17, v13
  s_lshl_b32 s10, s69, 14
  v_lshl_add_u32 v18, v18, 3, s10
  v_lshrrev_b32 v6, 2, v1
  v_lshlrev_b32 v6, 7, v6
  v_and_b32 v17, 3, v1
  v_lshl_add_u32 v6, v17, 3, v6
  v_bfe_u32 v17, v1, 3, 2
  v_lshl_add_u32 v6, v17, 5, v6
  v_xor_b32 v7, 32, v6
  v_xor_b32 v8, 64, v6
  v_xor_b32 v9, 96, v6
  s_mov_b32 s11, 0xffff0000
  s_add_u32 s36, s34, 8439808
  s_addc_u32 s37, s35, 0
  s_and_b32 s37, s37, 0xffff
  s_mov_b32 s38, 4194304
  s_mov_b32 s39, 0x00020000
  s_add_u32 s44, s34, 4194304
  s_addc_u32 s45, s35, 0
  s_and_b32 s45, s45, 0xffff
  s_mov_b32 s46, 4194304
  s_mov_b32 s47, 0x00020000
  s_add_u32 s56, s34, 24117248
  s_addc_u32 s57, s35, 0
  s_and_b32 s57, s57, 0xffff
  s_mov_b32 s58, 262144
  s_mov_b32 s59, 0x00020000
  s_mul_i32 s9, s8, 7168
  s_add_u32 s36, s36, s9
  s_addc_u32 s37, s37, 0x100000
  s_add_u32 s64, s36, 114688
  s_addc_u32 s65, s37, 0
  s_mov_b32 s38, 63488
  s_mov_b32 s39, 0x00800000
  s_mov_b32 s66, 63488
  s_mov_b32 s67, 0x00800000
  s_cmp_lg_u32 s96, 0
  s_cbranch_scc1 L_pfc2_skip
  s_getpc_b64 s[4:5]
L_pfc2:
  s_lshl_b32 s3, s99, 2
  s_add_u32 s3, s3, s70
  s_mul_i32 s3, s3, 128
  s_min_u32 s3, s3, L_w1_c1-L_w1_c0-128
  s_add_i32 s3, s3, L_w1_c0-L_pfc2
  s_ashr_i32 s6, s3, 31
  s_add_u32 s4, s4, s3
  s_addc_u32 s5, s5, s6
  s_load_dword s40, s[4:5], 0
  s_load_dword s40, s[4:5], 64
L_pfc2_skip:
  v_add_u32 v26, 155648, v6
  v_add_u32 v27, 155648, v7
  v_add_u32 v28, 155648, v8
  v_add_u32 v29, 155648, v9
  v_add_u32 v20, 94208, v6
  v_add_u32 v21, 94208, v7
  v_add_u32 v22, 94208, v8
  v_add_u32 v23, 94208, v9
  v_add_u32 v6, 28672, v6
  v_add_u32 v7, 28672, v7
  v_add_u32 v8, 28672, v8
  v_add_u32 v9, 28672, v9
  v_readlane_b32 s48, v15, 0
  v_readlane_b32 s49, v15, 1
  v_readlane_b32 s50, v15, 2
  s_cmp_lg_u32 s96, 0
  s_cbranch_scc1 L_wo_nosw
  v_permlane16_swap_b32 v240, v242
  v_permlane16_swap_b32 v241, v243
  v_permlane16_swap_b32 v244, v246
  v_permlane16_swap_b32 v245, v247
  v_permlane16_swap_b32 v248, v250
  v_permlane16_swap_b32 v249, v251
  v_permlane16_swap_b32 v252, v254
  v_permlane16_swap_b32 v253, v255
L_wo_nosw:
  s_waitcnt lgkmcnt(0)
  s_barrier
  buffer_load_dwordx4 v[32:35], off, s[36:39], s48 offset:0
  buffer_load_dwordx4 v[36:39], off, s[64:67], s48 offset:0
  buffer_load_dwordx4 v[40:43], off, s[36:39], s48 offset:1024
  buffer_load_dwordx4 v[44:47], off, s[64:67], s48 offset:1024
  buffer_load_dwordx4 v[48:51], off, s[36:39], s49 offset:0
  buffer_load_dwordx4 v[52:55], off, s[64:67], s49 offset:0
  buffer_load_dwordx4 v[56:59], off, s[36:39], s49 offset:1024
  buffer_load_dwordx4 v[60:63], off, s[64:67], s49 offset:1024
  buffer_load_dwordx4 v[64:67], off, s[36:39], s50 offset:0
  buffer_load_dwordx4 v[68:71], off, s[64:67], s50 offset:0
  buffer_load_dwordx4 v[72:75], off, s[36:39], s50 offset:1024
  buffer_load_dwordx4 v[76:79], off, s[64:67], s50 offset:1024
  ds_read_b64_tr_b16 v[160:161], v6 offset:0
  ds_read_b64_tr_b16 v[162:163], v6 offset:2048
  ds_read_b64_tr_b16 v[164:165], v7 offset:0
  ds_read_b64_tr_b16 v[166:167], v7 offset:2048
  ds_read_b64_tr_b16 v[168:169], v8 offset:0
  ds_read_b64_tr_b16 v[170:171], v8 offset:2048
  ds_read_b64_tr_b16 v[172:173], v9 offset:0
  ds_read_b64_tr_b16 v[174:175], v9 offset:2048
  ds_read_b64_tr_b16 v[176:177], v6 offset:4096
  ds_read_b64_tr_b16 v[178:179], v6 offset:6144
  ds_read_b64_tr_b16 v[180:181], v7 offset:4096
  ds_read_b64_tr_b16 v[182:183], v7 offset:6144
  ds_read_b64_tr_b16 v[184:185], v8 offset:4096
  ds_read_b64_tr_b16 v[186:187], v8 offset:6144
  ds_read_b64_tr_b16 v[188:189], v9 offset:4096
  ds_read_b64_tr_b16 v[190:191], v9 offset:6144
  v_lshlrev_b32 v96, 16, v240
  v_and_b32 v97, s11, v240
  v_lshlrev_b32 v98, 16, v241
  v_and_b32 v99, s11, v241
  v_lshlrev_b32 v100, 16, v248
  v_and_b32 v101, s11, v248
  v_lshlrev_b32 v102, 16, v249
  v_and_b32 v103, s11, v249
  v_lshlrev_b32 v104, 16, v242
  v_and_b32 v105, s11, v242
  v_lshlrev_b32 v106, 16, v243
  v_and_b32 v107, s11, v243
  v_lshlrev_b32 v108, 16, v250
  v_and_b32 v109, s11, v250
  v_lshlrev_b32 v110, 16, v251
  v_and_b32 v111, s11, v251
  v_lshlrev_b32 v112, 16, v244
  v_and_b32 v113, s11, v244
  v_lshlrev_b32 v114, 16, v245
  v_and_b32 v115, s11, v245
  v_lshlrev_b32 v116, 16, v252
  v_and_b32 v117, s11, v252
  v_lshlrev_b32 v118, 16, v253
  v_and_b32 v119, s11, v253
  v_lshlrev_b32 v120, 16, v246
  v_and_b32 v121, s11, v246
  v_lshlrev_b32 v122, 16, v247
  v_and_b32 v123, s11, v247
  v_lshlrev_b32 v124, 16, v254
  v_and_b32 v125, s11, v254
  v_lshlrev_b32 v126, 16, v255
  v_and_b32 v127, s11, v255
  s_waitcnt vmcnt(10) lgkmcnt(8)
  v_mfma_f32_16x16x32_bf16 v[96:99], v[160:163], v[32:35], v[96:99]
  ds_read_b64_tr_b16 v[192:193], v6 offset:8192
  v_readlane_b32 s51, v15, 3
  v_mfma_f32_16x16x32_bf16 v[100:103], v[160:163], v[36:39], v[100:103]
  ds_read_b64_tr_b16 v[194:195], v6 offset:10240
  v_mfma_f32_16x16x32_bf16 v[108:111], v[164:167], v[36:39], v[108:111]
  ds_read_b64_tr_b16 v[196:197], v7 offset:8192
  v_mfma_f32_16x16x32_bf16 v[104:107], v[164:167], v[32:35], v[104:107]
  buffer_load_dwordx4 v[80:83], off, s[36:39], s51 offset:0
  v_mfma_f32_16x16x32_bf16 v[112:115], v[168:171], v[32:35], v[112:115]
  ds_read_b64_tr_b16 v[198:199], v7 offset:10240
  ds_read_b64_tr_b16 v[200:201], v8 offset:8192
  v_mfma_f32_16x16x32_bf16 v[116:119], v[168:171], v[36:39], v[116:119]
  ds_read_b64_tr_b16 v[202:203], v8 offset:10240
  ds_read_b64_tr_b16 v[204:205], v9 offset:8192
  v_mfma_f32_16x16x32_bf16 v[124:127], v[172:175], v[36:39], v[124:127]
  buffer_load_dwordx4 v[84:87], off, s[64:67], s51 offset:0
  v_mfma_f32_16x16x32_bf16 v[120:123], v[172:175], v[32:35], v[120:123]
  ds_read_b64_tr_b16 v[206:207], v9 offset:10240
  s_waitcnt vmcnt(10) lgkmcnt(8)
  v_mfma_f32_16x16x32_bf16 v[96:99], v[176:179], v[40:43], v[96:99]
  ds_read_b64_tr_b16 v[208:209], v6 offset:12288
  v_mfma_f32_16x16x32_bf16 v[100:103], v[176:179], v[44:47], v[100:103]
  buffer_load_dwordx4 v[88:91], off, s[36:39], s51 offset:1024
  v_mfma_f32_16x16x32_bf16 v[108:111], v[180:183], v[44:47], v[108:111]
  ds_read_b64_tr_b16 v[210:211], v6 offset:14336
  ds_read_b64_tr_b16 v[212:213], v7 offset:12288
  v_mfma_f32_16x16x32_bf16 v[104:107], v[180:183], v[40:43], v[104:107]
  ds_read_b64_tr_b16 v[214:215], v7 offset:14336
  ds_read_b64_tr_b16 v[216:217], v8 offset:12288
  v_mfma_f32_16x16x32_bf16 v[112:115], v[184:187], v[40:43], v[112:115]
  buffer_load_dwordx4 v[92:95], off, s[64:67], s51 offset:1024
  v_mfma_f32_16x16x32_bf16 v[116:119], v[184:187], v[44:47], v[116:119]
  ds_read_b64_tr_b16 v[218:219], v8 offset:14336
  v_readlane_b32 s48, v15, 4
  v_mfma_f32_16x16x32_bf16 v[124:127], v[188:191], v[44:47], v[124:127]
  ds_read_b64_tr_b16 v[220:221], v9 offset:12288
  v_mfma_f32_16x16x32_bf16 v[120:123], v[188:191], v[40:43], v[120:123]
  ds_read_b64_tr_b16 v[222:223], v9 offset:14336
  s_waitcnt vmcnt(10) lgkmcnt(8)
  v_mfma_f32_16x16x32_bf16 v[96:99], v[192:195], v[48:51], v[96:99]
  buffer_load_dwordx4 v[32:35], off, s[36:39], s48 offset:0
  v_mfma_f32_16x16x32_bf16 v[100:103], v[192:195], v[52:55], v[100:103]
  ds_read_b64_tr_b16 v[160:161], v6 offset:16384
  ds_read_b64_tr_b16 v[162:163], v6 offset:18432
  v_mfma_f32_16x16x32_bf16 v[108:111], v[196:199], v[52:55], v[108:111]
  ds_read_b64_tr_b16 v[164:165], v7 offset:16384
  v_mfma_f32_16x16x32_bf16 v[104:107], v[196:199], v[48:51], v[104:107]
  buffer_load_dwordx4 v[36:39], off, s[64:67], s48 offset:0
  v_mfma_f32_16x16x32_bf16 v[112:115], v[200:203], v[48:51], v[112:115]
  ds_read_b64_tr_b16 v[166:167], v7 offset:18432
  ds_read_b64_tr_b16 v[168:169], v8 offset:16384
  v_mfma_f32_16x16x32_bf16 v[116:119], v[200:203], v[52:55], v[116:119]
  ds_read_b64_tr_b16 v[170:171], v8 offset:18432
  ds_read_b64_tr_b16 v[172:173], v9 offset:16384
  v_mfma_f32_16x16x32_bf16 v[124:127], v[204:207], v[52:55], v[124:127]
  buffer_load_dwordx4 v[40:43], off, s[36:39], s48 offset:1024
  v_mfma_f32_16x16x32_bf16 v[120:123], v[204:207], v[48:51], v[120:123]
  ds_read_b64_tr_b16 v[174:175], v9 offset:18432
  s_waitcnt vmcnt(11) lgkmcnt(8)
  v_mfma_f32_16x16x32_bf16 v[96:99], v[208:211], v[56:59], v[96:99]
  ds_read_b64_tr_b16 v[176:177], v6 offset:20480
  v_mfma_f32_16x16x32_bf16 v[100:103], v[208:211], v[60:63], v[100:103]
  buffer_load_dwordx4 v[44:47], off, s[64:67], s48 offset:1024
  v_mfma_f32_16x16x32_bf16 v[108:111], v[212:215], v[60:63], v[108:111]
  ds_read_b64_tr_b16 v[178:179], v6 offset:22528
  ds_read_b64_tr_b16 v[180:181], v7 offset:20480
  v_mfma_f32_16x16x32_bf16 v[104:107], v[212:215], v[56:59], v[104:107]
  ds_read_b64_tr_b16 v[182:183], v7 offset:22528
  v_mfma_f32_16x16x32_bf16 v[112:115], v[216:219], v[56:59], v[112:115]
  ds_read_b64_tr_b16 v[184:185], v8 offset:20480
  v_mfma_f32_16x16x32_bf16 v[116:119], v[216:219], v[60:63], v[116:119]
  ds_read_b64_tr_b16 v[186:187], v8 offset:22528
  v_readlane_b32 s49, v15, 5
  v_mfma_f32_16x16x32_bf16 v[124:127], v[220:223], v[60:63], v[124:127]
  ds_read_b64_tr_b16 v[188:189], v9 offset:20480
  v_mfma_f32_16x16x32_bf16 v[120:123], v[220:223], v[56:59], v[120:123]
  ds_read_b64_tr_b16 v[190:191], v9 offset:22528
  s_waitcnt vmcnt(10) lgkmcnt(8)
  v_mfma_f32_16x16x32_bf16 v[96:99], v[160:163], v[64:67], v[96:99]
  buffer_load_dwordx4 v[48:51], off, s[36:39], s49 offset:0
  v_mfma_f32_16x16x32_bf16 v[100:103], v[160:163], v[68:71], v[100:103]
  ds_read_b64_tr_b16 v[192:193], v6 offset:24576
  ds_read_b64_tr_b16 v[194:195], v6 offset:26624
  v_mfma_f32_16x16x32_bf16 v[108:111], v[164:167], v[68:71], v[108:111]
  ds_read_b64_tr_b16 v[196:197], v7 offset:24576
  v_mfma_f32_16x16x32_bf16 v[104:107], v[164:167], v[64:67], v[104:107]
  buffer_load_dwordx4 v[52:55], off, s[64:67], s49 offset:0
  v_mfma_f32_16x16x32_bf16 v[112:115], v[168:171], v[64:67], v[112:115]
  ds_read_b64_tr_b16 v[198:199], v7 offset:26624
  ds_read_b64_tr_b16 v[200:201], v8 offset:24576
  v_mfma_f32_16x16x32_bf16 v[116:119], v[168:171], v[68:71], v[116:119]
  ds_read_b64_tr_b16 v[202:203], v8 offset:26624
  ds_read_b64_tr_b16 v[204:205], v9 offset:24576
  v_mfma_f32_16x16x32_bf16 v[124:127], v[172:175], v[68:71], v[124:127]
  buffer_load_dwordx4 v[56:59], off, s[36:39], s49 offset:1024
  v_mfma_f32_16x16x32_bf16 v[120:123], v[172:175], v[64:67], v[120:123]
  ds_read_b64_tr_b16 v[206:207], v9 offset:26624
  s_waitcnt vmcnt(11) lgkmcnt(8)
  v_mfma_f32_16x16x32_bf16 v[96:99], v[176:179], v[72:75], v[96:99]
  ds_read_b64_tr_b16 v[208:209], v6 offset:28672
  v_mfma_f32_16x16x32_bf16 v[100:103], v[176:179], v[76:79], v[100:103]
  buffer_load_dwordx4 v[60:63], off, s[64:67], s49 offset:1024
  v_mfma_f32_16x16x32_bf16 v[108:111], v[180:183], v[76:79], v[108:111]
  ds_read_b64_tr_b16 v[210:211], v6 offset:30720
  ds_read_b64_tr_b16 v[212:213], v7 offset:28672
  v_mfma_f32_16x16x32_bf16 v[104:107], v[180:183], v[72:75], v[104:107]
  ds_read_b64_tr_b16 v[214:215], v7 offset:30720
  v_mfma_f32_16x16x32_bf16 v[112:115], v[184:187], v[72:75], v[112:115]
  ds_read_b64_tr_b16 v[216:217], v8 offset:28672
  v_mfma_f32_16x16x32_bf16 v[116:119], v[184:187], v[76:79], v[116:119]
  ds_read_b64_tr_b16 v[218:219], v8 offset:30720
  v_readlane_b32 s50, v15, 6
  v_mfma_f32_16x16x32_bf16 v[124:127], v[188:191], v[76:79], v[124:127]
  ds_read_b64_tr_b16 v[220:221], v9 offset:28672
  v_mfma_f32_16x16x32_bf16 v[120:123], v[188:191], v[72:75], v[120:123]
  ds_read_b64_tr_b16 v[222:223], v9 offset:30720
  s_waitcnt vmcnt(10) lgkmcnt(8)
  v_mfma_f32_16x16x32_bf16 v[96:99], v[192:195], v[80:83], v[96:99]
  buffer_load_dwordx4 v[64:67], off, s[36:39], s50 offset:0
  v_mfma_f32_16x16x32_bf16 v[100:103], v[192:195], v[84:87], v[100:103]
  ds_read_b64_tr_b16 v[160:161], v6 offset:32768
  ds_read_b64_tr_b16 v[162:163], v6 offset:34816
  v_mfma_f32_16x16x32_bf16 v[108:111], v[196:199], v[84:87], v[108:111]
  ds_read_b64_tr_b16 v[164:165], v7 offset:32768
  v_mfma_f32_16x16x32_bf16 v[104:107], v[196:199], v[80:83], v[104:107]
  buffer_load_dwordx4 v[68:71], off, s[64:67], s50 offset:0
  v_mfma_f32_16x16x32_bf16 v[112:115], v[200:203], v[80:83], v[112:115]
  ds_read_b64_tr_b16 v[166:167], v7 offset:34816
  ds_read_b64_tr_b16 v[168:169], v8 offset:32768
  v_mfma_f32_16x16x32_bf16 v[116:119], v[200:203], v[84:87], v[116:119]
  ds_read_b64_tr_b16 v[170:171], v8 offset:34816
  ds_read_b64_tr_b16 v[172:173], v9 offset:32768
  v_mfma_f32_16x16x32_bf16 v[124:127], v[204:207], v[84:87], v[124:127]
  buffer_load_dwordx4 v[72:75], off, s[36:39], s50 offset:1024
  v_mfma_f32_16x16x32_bf16 v[120:123], v[204:207], v[80:83], v[120:123]
  ds_read_b64_tr_b16 v[174:175], v9 offset:34816
  s_waitcnt vmcnt(11) lgkmcnt(8)
  v_mfma_f32_16x16x32_bf16 v[96:99], v[208:211], v[88:91], v[96:99]
  ds_read_b64_tr_b16 v[176:177], v6 offset:36864
  v_mfma_f32_16x16x32_bf16 v[100:103], v[208:211], v[92:95], v[100:103]
  buffer_load_dwordx4 v[76:79], off, s[64:67], s50 offset:1024
  v_mfma_f32_16x16x32_bf16 v[108:111], v[212:215], v[92:95], v[108:111]
  ds_read_b64_tr_b16 v[178:179], v6 offset:38912
  ds_read_b64_tr_b16 v[180:181], v7 offset:36864
  v_mfma_f32_16x16x32_bf16 v[104:107], v[212:215], v[88:91], v[104:107]
  ds_read_b64_tr_b16 v[182:183], v7 offset:38912
  v_mfma_f32_16x16x32_bf16 v[112:115], v[216:219], v[88:91], v[112:115]
  ds_read_b64_tr_b16 v[184:185], v8 offset:36864
  v_mfma_f32_16x16x32_bf16 v[116:119], v[216:219], v[92:95], v[116:119]
  ds_read_b64_tr_b16 v[186:187], v8 offset:38912
  v_readlane_b32 s51, v15, 7
  v_mfma_f32_16x16x32_bf16 v[124:127], v[220:223], v[92:95], v[124:127]
  ds_read_b64_tr_b16 v[188:189], v9 offset:36864
  v_mfma_f32_16x16x32_bf16 v[120:123], v[220:223], v[88:91], v[120:123]
  ds_read_b64_tr_b16 v[190:191], v9 offset:38912
  s_waitcnt vmcnt(10) lgkmcnt(8)
  v_mfma_f32_16x16x32_bf16 v[96:99], v[160:163], v[32:35], v[96:99]
  buffer_load_dwordx4 v[80:83], off, s[36:39], s51 offset:0
  v_mfma_f32_16x16x32_bf16 v[100:103], v[160:163], v[36:39], v[100:103]
  ds_read_b64_tr_b16 v[192:193], v6 offset:40960
  ds_read_b64_tr_b16 v[194:195], v6 offset:43008
  v_mfma_f32_16x16x32_bf16 v[108:111], v[164:167], v[36:39], v[108:111]
  ds_read_b64_tr_b16 v[196:197], v7 offset:40960
  v_mfma_f32_16x16x32_bf16 v[104:107], v[164:167], v[32:35], v[104:107]
  buffer_load_dwordx4 v[84:87], off, s[64:67], s51 offset:0
  v_mfma_f32_16x16x32_bf16 v[112:115], v[168:171], v[32:35], v[112:115]
  ds_read_b64_tr_b16 v[198:199], v7 offset:43008
  ds_read_b64_tr_b16 v[200:201], v8 offset:40960
  v_mfma_f32_16x16x32_bf16 v[116:119], v[168:171], v[36:39], v[116:119]
  ds_read_b64_tr_b16 v[202:203], v8 offset:43008
  ds_read_b64_tr_b16 v[204:205], v9 offset:40960
  v_mfma_f32_16x16x32_bf16 v[124:127], v[172:175], v[36:39], v[124:127]
  buffer_load_dwordx4 v[88:91], off, s[36:39], s51 offset:1024
  v_mfma_f32_16x16x32_bf16 v[120:123], v[172:175], v[32:35], v[120:123]
  ds_read_b64_tr_b16 v[206:207], v9 offset:43008
  s_waitcnt vmcnt(11) lgkmcnt(8)
  s_barrier
  v_mfma_f32_16x16x32_bf16 v[96:99], v[176:179], v[40:43], v[96:99]
  ds_read_b64_tr_b16 v[208:209], v6 offset:45056
  v_mfma_f32_16x16x32_bf16 v[100:103], v[176:179], v[44:47], v[100:103]
  buffer_load_dwordx4 v[92:95], off, s[64:67], s51 offset:1024
  v_mfma_f32_16x16x32_bf16 v[108:111], v[180:183], v[44:47], v[108:111]
  ds_read_b64_tr_b16 v[210:211], v6 offset:47104
  ds_read_b64_tr_b16 v[212:213], v7 offset:45056
  v_mfma_f32_16x16x32_bf16 v[104:107], v[180:183], v[40:43], v[104:107]
  ds_read_b64_tr_b16 v[214:215], v7 offset:47104
  v_mfma_f32_16x16x32_bf16 v[112:115], v[184:187], v[40:43], v[112:115]
  ds_read_b64_tr_b16 v[216:217], v8 offset:45056
  v_mfma_f32_16x16x32_bf16 v[116:119], v[184:187], v[44:47], v[116:119]
  ds_read_b64_tr_b16 v[218:219], v8 offset:47104
  v_readlane_b32 s48, v15, 8
  v_mfma_f32_16x16x32_bf16 v[124:127], v[188:191], v[44:47], v[124:127]
  ds_read_b64_tr_b16 v[220:221], v9 offset:45056
  v_mfma_f32_16x16x32_bf16 v[120:123], v[188:191], v[40:43], v[120:123]
  ds_read_b64_tr_b16 v[222:223], v9 offset:47104
  s_waitcnt vmcnt(10) lgkmcnt(8)
  v_mfma_f32_16x16x32_bf16 v[96:99], v[192:195], v[48:51], v[96:99]
  buffer_load_dwordx4 v[32:35], off, s[36:39], s48 offset:0
  v_mfma_f32_16x16x32_bf16 v[100:103], v[192:195], v[52:55], v[100:103]
  ds_read_b64_tr_b16 v[160:161], v6 offset:49152
  ds_read_b64_tr_b16 v[162:163], v6 offset:51200
  v_mfma_f32_16x16x32_bf16 v[108:111], v[196:199], v[52:55], v[108:111]
  ds_read_b64_tr_b16 v[164:165], v7 offset:49152
  v_mfma_f32_16x16x32_bf16 v[104:107], v[196:199], v[48:51], v[104:107]
  buffer_load_dwordx4 v[36:39], off, s[64:67], s48 offset:0
  v_mfma_f32_16x16x32_bf16 v[112:115], v[200:203], v[48:51], v[112:115]
  ds_read_b64_tr_b16 v[166:167], v7 offset:51200
  ds_read_b64_tr_b16 v[168:169], v8 offset:49152
  v_mfma_f32_16x16x32_bf16 v[116:119], v[200:203], v[52:55], v[116:119]
  ds_read_b64_tr_b16 v[170:171], v8 offset:51200
  ds_read_b64_tr_b16 v[172:173], v9 offset:49152
  v_mfma_f32_16x16x32_bf16 v[124:127], v[204:207], v[52:55], v[124:127]
  buffer_load_dwordx4 v[40:43], off, s[36:39], s48 offset:1024
  v_mfma_f32_16x16x32_bf16 v[120:123], v[204:207], v[48:51], v[120:123]
  ds_read_b64_tr_b16 v[174:175], v9 offset:51200
  s_waitcnt vmcnt(11) lgkmcnt(8)
  v_mfma_f32_16x16x32_bf16 v[96:99], v[208:211], v[56:59], v[96:99]
  ds_read_b64_tr_b16 v[176:177], v6 offset:53248
  v_mfma_f32_16x16x32_bf16 v[100:103], v[208:211], v[60:63], v[100:103]
  buffer_load_dwordx4 v[44:47], off, s[64:67], s48 offset:1024
  v_mfma_f32_16x16x32_bf16 v[108:111], v[212:215], v[60:63], v[108:111]
  ds_read_b64_tr_b16 v[178:179], v6 offset:55296
  ds_read_b64_tr_b16 v[180:181], v7 offset:53248
  v_mfma_f32_16x16x32_bf16 v[104:107], v[212:215], v[56:59], v[104:107]
  ds_read_b64_tr_b16 v[182:183], v7 offset:55296
  v_mfma_f32_16x16x32_bf16 v[112:115], v[216:219], v[56:59], v[112:115]
  ds_read_b64_tr_b16 v[184:185], v8 offset:53248
  v_mfma_f32_16x16x32_bf16 v[116:119], v[216:219], v[60:63], v[116:119]
  ds_read_b64_tr_b16 v[186:187], v8 offset:55296
  v_readlane_b32 s49, v15, 9
  v_mfma_f32_16x16x32_bf16 v[124:127], v[220:223], v[60:63], v[124:127]
  ds_read_b64_tr_b16 v[188:189], v9 offset:53248
  v_mfma_f32_16x16x32_bf16 v[120:123], v[220:223], v[56:59], v[120:123]
  ds_read_b64_tr_b16 v[190:191], v9 offset:55296
  s_waitcnt vmcnt(10) lgkmcnt(8)
  v_mfma_f32_16x16x32_bf16 v[96:99], v[160:163], v[64:67], v[96:99]
  buffer_load_dwordx4 v[48:51], off, s[36:39], s49 offset:0
  v_mfma_f32_16x16x32_bf16 v[100:103], v[160:163], v[68:71], v[100:103]
  ds_read_b64_tr_b16 v[192:193], v6 offset:57344
  ds_read_b64_tr_b16 v[194:195], v6 offset:59392
  v_mfma_f32_16x16x32_bf16 v[108:111], v[164:167], v[68:71], v[108:111]
  ds_read_b64_tr_b16 v[196:197], v7 offset:57344
  v_mfma_f32_16x16x32_bf16 v[104:107], v[164:167], v[64:67], v[104:107]
  buffer_load_dwordx4 v[52:55], off, s[64:67], s49 offset:0
  v_mfma_f32_16x16x32_bf16 v[112:115], v[168:171], v[64:67], v[112:115]
  ds_read_b64_tr_b16 v[198:199], v7 offset:59392
  ds_read_b64_tr_b16 v[200:201], v8 offset:57344
  v_mfma_f32_16x16x32_bf16 v[116:119], v[168:171], v[68:71], v[116:119]
  ds_read_b64_tr_b16 v[202:203], v8 offset:59392
  ds_read_b64_tr_b16 v[204:205], v9 offset:57344
  v_mfma_f32_16x16x32_bf16 v[124:127], v[172:175], v[68:71], v[124:127]
  buffer_load_dwordx4 v[56:59], off, s[36:39], s49 offset:1024
  v_mfma_f32_16x16x32_bf16 v[120:123], v[172:175], v[64:67], v[120:123]
  ds_read_b64_tr_b16 v[206:207], v9 offset:59392
  s_waitcnt vmcnt(11) lgkmcnt(8)
  v_mfma_f32_16x16x32_bf16 v[96:99], v[176:179], v[72:75], v[96:99]
  ds_read_b64_tr_b16 v[208:209], v6 offset:61440
  v_mfma_f32_16x16x32_bf16 v[100:103], v[176:179], v[76:79], v[100:103]
  buffer_load_dwordx4 v[60:63], off, s[64:67], s49 offset:1024
  v_mfma_f32_16x16x32_bf16 v[108:111], v[180:183], v[76:79], v[108:111]
  ds_read_b64_tr_b16 v[210:211], v6 offset:63488
  ds_read_b64_tr_b16 v[212:213], v7 offset:61440
  v_mfma_f32_16x16x32_bf16 v[104:107], v[180:183], v[72:75], v[104:107]
  ds_read_b64_tr_b16 v[214:215], v7 offset:63488
  v_mfma_f32_16x16x32_bf16 v[112:115], v[184:187], v[72:75], v[112:115]
  ds_read_b64_tr_b16 v[216:217], v8 offset:61440
  v_mfma_f32_16x16x32_bf16 v[116:119], v[184:187], v[76:79], v[116:119]
  ds_read_b64_tr_b16 v[218:219], v8 offset:63488
  v_readlane_b32 s50, v15, 10
  v_mfma_f32_16x16x32_bf16 v[124:127], v[188:191], v[76:79], v[124:127]
  ds_read_b64_tr_b16 v[220:221], v9 offset:61440
  v_mfma_f32_16x16x32_bf16 v[120:123], v[188:191], v[72:75], v[120:123]
  ds_read_b64_tr_b16 v[222:223], v9 offset:63488
  s_waitcnt vmcnt(10) lgkmcnt(8)
  v_mfma_f32_16x16x32_bf16 v[96:99], v[192:195], v[80:83], v[96:99]
  buffer_load_dwordx4 v[64:67], off, s[36:39], s50 offset:0
  v_mfma_f32_16x16x32_bf16 v[100:103], v[192:195], v[84:87], v[100:103]
  ds_read_b64_tr_b16 v[160:161], v20 offset:0
  ds_read_b64_tr_b16 v[162:163], v20 offset:2048
  v_mfma_f32_16x16x32_bf16 v[108:111], v[196:199], v[84:87], v[108:111]
  ds_read_b64_tr_b16 v[164:165], v21 offset:0
  v_mfma_f32_16x16x32_bf16 v[104:107], v[196:199], v[80:83], v[104:107]
  buffer_load_dwordx4 v[68:71], off, s[64:67], s50 offset:0
  v_mfma_f32_16x16x32_bf16 v[112:115], v[200:203], v[80:83], v[112:115]
  ds_read_b64_tr_b16 v[166:167], v21 offset:2048
  ds_read_b64_tr_b16 v[168:169], v22 offset:0
  v_mfma_f32_16x16x32_bf16 v[116:119], v[200:203], v[84:87], v[116:119]
  ds_read_b64_tr_b16 v[170:171], v22 offset:2048
  ds_read_b64_tr_b16 v[172:173], v23 offset:0
  v_mfma_f32_16x16x32_bf16 v[124:127], v[204:207], v[84:87], v[124:127]
  buffer_load_dwordx4 v[72:75], off, s[36:39], s50 offset:1024
  v_mfma_f32_16x16x32_bf16 v[120:123], v[204:207], v[80:83], v[120:123]
  ds_read_b64_tr_b16 v[174:175], v23 offset:2048
  s_waitcnt vmcnt(11) lgkmcnt(8)
  v_mfma_f32_16x16x32_bf16 v[96:99], v[208:211], v[88:91], v[96:99]
  ds_read_b64_tr_b16 v[176:177], v20 offset:4096
  v_mfma_f32_16x16x32_bf16 v[100:103], v[208:211], v[92:95], v[100:103]
  buffer_load_dwordx4 v[76:79], off, s[64:67], s50 offset:1024
  v_mfma_f32_16x16x32_bf16 v[108:111], v[212:215], v[92:95], v[108:111]
  ds_read_b64_tr_b16 v[178:179], v20 offset:6144
  ds_read_b64_tr_b16 v[180:181], v21 offset:4096
  v_mfma_f32_16x16x32_bf16 v[104:107], v[212:215], v[88:91], v[104:107]
  ds_read_b64_tr_b16 v[182:183], v21 offset:6144
  v_mfma_f32_16x16x32_bf16 v[112:115], v[216:219], v[88:91], v[112:115]
  ds_read_b64_tr_b16 v[184:185], v22 offset:4096
  v_mfma_f32_16x16x32_bf16 v[116:119], v[216:219], v[92:95], v[116:119]
  ds_read_b64_tr_b16 v[186:187], v22 offset:6144
  v_readlane_b32 s51, v15, 11
  v_mfma_f32_16x16x32_bf16 v[124:127], v[220:223], v[92:95], v[124:127]
  ds_read_b64_tr_b16 v[188:189], v23 offset:4096
  v_mfma_f32_16x16x32_bf16 v[120:123], v[220:223], v[88:91], v[120:123]
  ds_read_b64_tr_b16 v[190:191], v23 offset:6144
  s_waitcnt vmcnt(10) lgkmcnt(8)
  v_mfma_f32_16x16x32_bf16 v[96:99], v[160:163], v[32:35], v[96:99]
  buffer_load_dwordx4 v[80:83], off, s[36:39], s51 offset:0
  v_mfma_f32_16x16x32_bf16 v[100:103], v[160:163], v[36:39], v[100:103]
  ds_read_b64_tr_b16 v[192:193], v20 offset:8192
  ds_read_b64_tr_b16 v[194:195], v20 offset:10240
  v_mfma_f32_16x16x32_bf16 v[108:111], v[164:167], v[36:39], v[108:111]
  ds_read_b64_tr_b16 v[196:197], v21 offset:8192
  v_mfma_f32_16x16x32_bf16 v[104:107], v[164:167], v[32:35], v[104:107]
  buffer_load_dwordx4 v[84:87], off, s[64:67], s51 offset:0
  v_mfma_f32_16x16x32_bf16 v[112:115], v[168:171], v[32:35], v[112:115]
  ds_read_b64_tr_b16 v[198:199], v21 offset:10240
  ds_read_b64_tr_b16 v[200:201], v22 offset:8192
  v_mfma_f32_16x16x32_bf16 v[116:119], v[168:171], v[36:39], v[116:119]
  ds_read_b64_tr_b16 v[202:203], v22 offset:10240
  ds_read_b64_tr_b16 v[204:205], v23 offset:8192
  v_mfma_f32_16x16x32_bf16 v[124:127], v[172:175], v[36:39], v[124:127]
  buffer_load_dwordx4 v[88:91], off, s[36:39], s51 offset:1024
  v_mfma_f32_16x16x32_bf16 v[120:123], v[172:175], v[32:35], v[120:123]
  ds_read_b64_tr_b16 v[206:207], v23 offset:10240
  s_waitcnt vmcnt(11) lgkmcnt(8)
  v_mfma_f32_16x16x32_bf16 v[96:99], v[176:179], v[40:43], v[96:99]
  ds_read_b64_tr_b16 v[208:209], v20 offset:12288
  v_mfma_f32_16x16x32_bf16 v[100:103], v[176:179], v[44:47], v[100:103]
  buffer_load_dwordx4 v[92:95], off, s[64:67], s51 offset:1024
  v_mfma_f32_16x16x32_bf16 v[108:111], v[180:183], v[44:47], v[108:111]
  ds_read_b64_tr_b16 v[210:211], v20 offset:14336
  ds_read_b64_tr_b16 v[212:213], v21 offset:12288
  v_mfma_f32_16x16x32_bf16 v[104:107], v[180:183], v[40:43], v[104:107]
  ds_read_b64_tr_b16 v[214:215], v21 offset:14336
  v_mfma_f32_16x16x32_bf16 v[112:115], v[184:187], v[40:43], v[112:115]
  ds_read_b64_tr_b16 v[216:217], v22 offset:12288
  v_mfma_f32_16x16x32_bf16 v[116:119], v[184:187], v[44:47], v[116:119]
  ds_read_b64_tr_b16 v[218:219], v22 offset:14336
  v_readlane_b32 s48, v15, 12
  v_mfma_f32_16x16x32_bf16 v[124:127], v[188:191], v[44:47], v[124:127]
  ds_read_b64_tr_b16 v[220:221], v23 offset:12288
  v_mfma_f32_16x16x32_bf16 v[120:123], v[188:191], v[40:43], v[120:123]
  ds_read_b64_tr_b16 v[222:223], v23 offset:14336
  s_waitcnt vmcnt(10) lgkmcnt(8)
  v_mfma_f32_16x16x32_bf16 v[96:99], v[192:195], v[48:51], v[96:99]
  buffer_load_dwordx4 v[32:35], off, s[36:39], s48 offset:0
  v_mfma_f32_16x16x32_bf16 v[100:103], v[192:195], v[52:55], v[100:103]
  ds_read_b64_tr_b16 v[160:161], v20 offset:16384
  ds_read_b64_tr_b16 v[162:163], v20 offset:18432
  v_mfma_f32_16x16x32_bf16 v[108:111], v[196:199], v[52:55], v[108:111]
  ds_read_b64_tr_b16 v[164:165], v21 offset:16384
  v_mfma_f32_16x16x32_bf16 v[104:107], v[196:199], v[48:51], v[104:107]
  buffer_load_dwordx4 v[36:39], off, s[64:67], s48 offset:0
  v_mfma_f32_16x16x32_bf16 v[112:115], v[200:203], v[48:51], v[112:115]
  ds_read_b64_tr_b16 v[166:167], v21 offset:18432
  ds_read_b64_tr_b16 v[168:169], v22 offset:16384
  v_mfma_f32_16x16x32_bf16 v[116:119], v[200:203], v[52:55], v[116:119]
  ds_read_b64_tr_b16 v[170:171], v22 offset:18432
  ds_read_b64_tr_b16 v[172:173], v23 offset:16384
  v_mfma_f32_16x16x32_bf16 v[124:127], v[204:207], v[52:55], v[124:127]
  buffer_load_dwordx4 v[40:43], off, s[36:39], s48 offset:1024
  v_mfma_f32_16x16x32_bf16 v[120:123], v[204:207], v[48:51], v[120:123]
  ds_read_b64_tr_b16 v[174:175], v23 offset:18432
  s_waitcnt vmcnt(11) lgkmcnt(8)
  v_mfma_f32_16x16x32_bf16 v[96:99], v[208:211], v[56:59], v[96:99]
  ds_read_b64_tr_b16 v[176:177], v20 offset:20480
  v_mfma_f32_16x16x32_bf16 v[100:103], v[208:211], v[60:63], v[100:103]
  buffer_load_dwordx4 v[44:47], off, s[64:67], s48 offset:1024
  v_mfma_f32_16x16x32_bf16 v[108:111], v[212:215], v[60:63], v[108:111]
  ds_read_b64_tr_b16 v[178:179], v20 offset:22528
  ds_read_b64_tr_b16 v[180:181], v21 offset:20480
  v_mfma_f32_16x16x32_bf16 v[104:107], v[212:215], v[56:59], v[104:107]
  ds_read_b64_tr_b16 v[182:183], v21 offset:22528
  v_mfma_f32_16x16x32_bf16 v[112:115], v[216:219], v[56:59], v[112:115]
  ds_read_b64_tr_b16 v[184:185], v22 offset:20480
  v_mfma_f32_16x16x32_bf16 v[116:119], v[216:219], v[60:63], v[116:119]
  ds_read_b64_tr_b16 v[186:187], v22 offset:22528
  v_readlane_b32 s49, v15, 13
  v_mfma_f32_16x16x32_bf16 v[124:127], v[220:223], v[60:63], v[124:127]
  ds_read_b64_tr_b16 v[188:189], v23 offset:20480
  v_mfma_f32_16x16x32_bf16 v[120:123], v[220:223], v[56:59], v[120:123]
  ds_read_b64_tr_b16 v[190:191], v23 offset:22528
  s_waitcnt vmcnt(10) lgkmcnt(8)
  v_mfma_f32_16x16x32_bf16 v[96:99], v[160:163], v[64:67], v[96:99]
  buffer_load_dwordx4 v[48:51], off, s[36:39], s49 offset:0
  v_mfma_f32_16x16x32_bf16 v[100:103], v[160:163], v[68:71], v[100:103]
  ds_read_b64_tr_b16 v[192:193], v20 offset:24576
  ds_read_b64_tr_b16 v[194:195], v20 offset:26624
  v_mfma_f32_16x16x32_bf16 v[108:111], v[164:167], v[68:71], v[108:111]
  ds_read_b64_tr_b16 v[196:197], v21 offset:24576
  v_mfma_f32_16x16x32_bf16 v[104:107], v[164:167], v[64:67], v[104:107]
  buffer_load_dwordx4 v[52:55], off, s[64:67], s49 offset:0
  v_mfma_f32_16x16x32_bf16 v[112:115], v[168:171], v[64:67], v[112:115]
  ds_read_b64_tr_b16 v[198:199], v21 offset:26624
  ds_read_b64_tr_b16 v[200:201], v22 offset:24576
  v_mfma_f32_16x16x32_bf16 v[116:119], v[168:171], v[68:71], v[116:119]
  ds_read_b64_tr_b16 v[202:203], v22 offset:26624
  ds_read_b64_tr_b16 v[204:205], v23 offset:24576
  v_mfma_f32_16x16x32_bf16 v[124:127], v[172:175], v[68:71], v[124:127]
  buffer_load_dwordx4 v[56:59], off, s[36:39], s49 offset:1024
  v_mfma_f32_16x16x32_bf16 v[120:123], v[172:175], v[64:67], v[120:123]
  ds_read_b64_tr_b16 v[206:207], v23 offset:26624
  s_waitcnt vmcnt(11) lgkmcnt(8)
  v_mfma_f32_16x16x32_bf16 v[96:99], v[176:179], v[72:75], v[96:99]
  ds_read_b64_tr_b16 v[208:209], v20 offset:28672
  v_mfma_f32_16x16x32_bf16 v[100:103], v[176:179], v[76:79], v[100:103]
  buffer_load_dwordx4 v[60:63], off, s[64:67], s49 offset:1024
  v_mfma_f32_16x16x32_bf16 v[108:111], v[180:183], v[76:79], v[108:111]
  ds_read_b64_tr_b16 v[210:211], v20 offset:30720
  ds_read_b64_tr_b16 v[212:213], v21 offset:28672
  v_mfma_f32_16x16x32_bf16 v[104:107], v[180:183], v[72:75], v[104:107]
  ds_read_b64_tr_b16 v[214:215], v21 offset:30720
  v_mfma_f32_16x16x32_bf16 v[112:115], v[184:187], v[72:75], v[112:115]
  ds_read_b64_tr_b16 v[216:217], v22 offset:28672
  v_mfma_f32_16x16x32_bf16 v[116:119], v[184:187], v[76:79], v[116:119]
  ds_read_b64_tr_b16 v[218:219], v22 offset:30720
  v_readlane_b32 s50, v15, 14
  v_mfma_f32_16x16x32_bf16 v[124:127], v[188:191], v[76:79], v[124:127]
  ds_read_b64_tr_b16 v[220:221], v23 offset:28672
  v_mfma_f32_16x16x32_bf16 v[120:123], v[188:191], v[72:75], v[120:123]
  ds_read_b64_tr_b16 v[222:223], v23 offset:30720
  s_waitcnt vmcnt(10) lgkmcnt(8)
  v_mfma_f32_16x16x32_bf16 v[96:99], v[192:195], v[80:83], v[96:99]
  buffer_load_dwordx4 v[64:67], off, s[36:39], s50 offset:0
  v_mfma_f32_16x16x32_bf16 v[100:103], v[192:195], v[84:87], v[100:103]
  ds_read_b64_tr_b16 v[160:161], v20 offset:36864
  ds_read_b64_tr_b16 v[162:163], v20 offset:38912
  v_mfma_f32_16x16x32_bf16 v[108:111], v[196:199], v[84:87], v[108:111]
  ds_read_b64_tr_b16 v[164:165], v21 offset:36864
  v_mfma_f32_16x16x32_bf16 v[104:107], v[196:199], v[80:83], v[104:107]
  buffer_load_dwordx4 v[68:71], off, s[64:67], s50 offset:0
  v_mfma_f32_16x16x32_bf16 v[112:115], v[200:203], v[80:83], v[112:115]
  ds_read_b64_tr_b16 v[166:167], v21 offset:38912
  ds_read_b64_tr_b16 v[168:169], v22 offset:36864
  v_mfma_f32_16x16x32_bf16 v[116:119], v[200:203], v[84:87], v[116:119]
  ds_read_b64_tr_b16 v[170:171], v22 offset:38912
  ds_read_b64_tr_b16 v[172:173], v23 offset:36864
  v_mfma_f32_16x16x32_bf16 v[124:127], v[204:207], v[84:87], v[124:127]
  buffer_load_dwordx4 v[72:75], off, s[36:39], s50 offset:1024
  v_mfma_f32_16x16x32_bf16 v[120:123], v[204:207], v[80:83], v[120:123]
  ds_read_b64_tr_b16 v[174:175], v23 offset:38912
  s_waitcnt vmcnt(11) lgkmcnt(8)
  v_mfma_f32_16x16x32_bf16 v[96:99], v[208:211], v[88:91], v[96:99]
  ds_read_b64_tr_b16 v[176:177], v20 offset:40960
  v_mfma_f32_16x16x32_bf16 v[100:103], v[208:211], v[92:95], v[100:103]
  buffer_load_dwordx4 v[76:79], off, s[64:67], s50 offset:1024
  v_mfma_f32_16x16x32_bf16 v[108:111], v[212:215], v[92:95], v[108:111]
  ds_read_b64_tr_b16 v[178:179], v20 offset:43008
  ds_read_b64_tr_b16 v[180:181], v21 offset:40960
  v_mfma_f32_16x16x32_bf16 v[104:107], v[212:215], v[88:91], v[104:107]
  ds_read_b64_tr_b16 v[182:183], v21 offset:43008
  v_mfma_f32_16x16x32_bf16 v[112:115], v[216:219], v[88:91], v[112:115]
  ds_read_b64_tr_b16 v[184:185], v22 offset:40960
  v_mfma_f32_16x16x32_bf16 v[116:119], v[216:219], v[92:95], v[116:119]
  ds_read_b64_tr_b16 v[186:187], v22 offset:43008
  v_readlane_b32 s51, v15, 15
  v_mfma_f32_16x16x32_bf16 v[124:127], v[220:223], v[92:95], v[124:127]
  ds_read_b64_tr_b16 v[188:189], v23 offset:40960
  v_mfma_f32_16x16x32_bf16 v[120:123], v[220:223], v[88:91], v[120:123]
  ds_read_b64_tr_b16 v[190:191], v23 offset:43008
  s_waitcnt vmcnt(10) lgkmcnt(8)
  v_mfma_f32_16x16x32_bf16 v[96:99], v[160:163], v[32:35], v[96:99]
  buffer_load_dwordx4 v[80:83], off, s[36:39], s51 offset:0
  v_mfma_f32_16x16x32_bf16 v[100:103], v[160:163], v[36:39], v[100:103]
  ds_read_b64_tr_b16 v[192:193], v20 offset:45056
  ds_read_b64_tr_b16 v[194:195], v20 offset:47104
  v_mfma_f32_16x16x32_bf16 v[108:111], v[164:167], v[36:39], v[108:111]
  ds_read_b64_tr_b16 v[196:197], v21 offset:45056
  v_mfma_f32_16x16x32_bf16 v[104:107], v[164:167], v[32:35], v[104:107]
  buffer_load_dwordx4 v[84:87], off, s[64:67], s51 offset:0
  v_mfma_f32_16x16x32_bf16 v[112:115], v[168:171], v[32:35], v[112:115]
  ds_read_b64_tr_b16 v[198:199], v21 offset:47104
  ds_read_b64_tr_b16 v[200:201], v22 offset:45056
  v_mfma_f32_16x16x32_bf16 v[116:119], v[168:171], v[36:39], v[116:119]
  ds_read_b64_tr_b16 v[202:203], v22 offset:47104
  ds_read_b64_tr_b16 v[204:205], v23 offset:45056
  v_mfma_f32_16x16x32_bf16 v[124:127], v[172:175], v[36:39], v[124:127]
  buffer_load_dwordx4 v[88:91], off, s[36:39], s51 offset:1024
  v_mfma_f32_16x16x32_bf16 v[120:123], v[172:175], v[32:35], v[120:123]
  ds_read_b64_tr_b16 v[206:207], v23 offset:47104
  s_waitcnt vmcnt(11) lgkmcnt(8)
  v_mfma_f32_16x16x32_bf16 v[96:99], v[176:179], v[40:43], v[96:99]
  ds_read_b64_tr_b16 v[208:209], v20 offset:49152
  v_mfma_f32_16x16x32_bf16 v[100:103], v[176:179], v[44:47], v[100:103]
  buffer_load_dwordx4 v[92:95], off, s[64:67], s51 offset:1024
  v_mfma_f32_16x16x32_bf16 v[108:111], v[180:183], v[44:47], v[108:111]
  ds_read_b64_tr_b16 v[210:211], v20 offset:51200
  ds_read_b64_tr_b16 v[212:213], v21 offset:49152
  v_mfma_f32_16x16x32_bf16 v[104:107], v[180:183], v[40:43], v[104:107]
  ds_read_b64_tr_b16 v[214:215], v21 offset:51200
  v_mfma_f32_16x16x32_bf16 v[112:115], v[184:187], v[40:43], v[112:115]
  ds_read_b64_tr_b16 v[216:217], v22 offset:49152
  v_mfma_f32_16x16x32_bf16 v[116:119], v[184:187], v[44:47], v[116:119]
  ds_read_b64_tr_b16 v[218:219], v22 offset:51200
  v_mfma_f32_16x16x32_bf16 v[124:127], v[188:191], v[44:47], v[124:127]
  ds_read_b64_tr_b16 v[220:221], v23 offset:49152
  v_mfma_f32_16x16x32_bf16 v[120:123], v[188:191], v[40:43], v[120:123]
  ds_read_b64_tr_b16 v[222:223], v23 offset:51200
  s_waitcnt vmcnt(10) lgkmcnt(8)
  v_mfma_f32_16x16x32_bf16 v[96:99], v[192:195], v[48:51], v[96:99]
  ds_read_b64_tr_b16 v[160:161], v20 offset:53248
  v_mfma_f32_16x16x32_bf16 v[100:103], v[192:195], v[52:55], v[100:103]
  ds_read_b64_tr_b16 v[162:163], v20 offset:55296
  v_mfma_f32_16x16x32_bf16 v[108:111], v[196:199], v[52:55], v[108:111]
  ds_read_b64_tr_b16 v[164:165], v21 offset:53248
  v_mfma_f32_16x16x32_bf16 v[104:107], v[196:199], v[48:51], v[104:107]
  ds_read_b64_tr_b16 v[166:167], v21 offset:55296
  v_mfma_f32_16x16x32_bf16 v[112:115], v[200:203], v[48:51], v[112:115]
  ds_read_b64_tr_b16 v[168:169], v22 offset:53248
  v_mfma_f32_16x16x32_bf16 v[116:119], v[200:203], v[52:55], v[116:119]
  ds_read_b64_tr_b16 v[170:171], v22 offset:55296
  v_mfma_f32_16x16x32_bf16 v[124:127], v[204:207], v[52:55], v[124:127]
  ds_read_b64_tr_b16 v[172:173], v23 offset:53248
  v_mfma_f32_16x16x32_bf16 v[120:123], v[204:207], v[48:51], v[120:123]
  ds_read_b64_tr_b16 v[174:175], v23 offset:55296
  s_waitcnt vmcnt(8) lgkmcnt(8)
  s_barrier
  v_mfma_f32_16x16x32_bf16 v[96:99], v[208:211], v[56:59], v[96:99]
  ds_read_b64_tr_b16 v[176:177], v20 offset:57344
  v_mfma_f32_16x16x32_bf16 v[100:103], v[208:211], v[60:63], v[100:103]
  ds_read_b64_tr_b16 v[178:179], v20 offset:59392
  v_mfma_f32_16x16x32_bf16 v[108:111], v[212:215], v[60:63], v[108:111]
  ds_read_b64_tr_b16 v[180:181], v21 offset:57344
  v_mfma_f32_16x16x32_bf16 v[104:107], v[212:215], v[56:59], v[104:107]
  ds_read_b64_tr_b16 v[182:183], v21 offset:59392
  v_mfma_f32_16x16x32_bf16 v[112:115], v[216:219], v[56:59], v[112:115]
  ds_read_b64_tr_b16 v[184:185], v22 offset:57344
  v_mfma_f32_16x16x32_bf16 v[116:119], v[216:219], v[60:63], v[116:119]
  ds_read_b64_tr_b16 v[186:187], v22 offset:59392
  v_mfma_f32_16x16x32_bf16 v[124:127], v[220:223], v[60:63], v[124:127]
  ds_read_b64_tr_b16 v[188:189], v23 offset:57344
  v_mfma_f32_16x16x32_bf16 v[120:123], v[220:223], v[56:59], v[120:123]
  ds_read_b64_tr_b16 v[190:191], v23 offset:59392
  s_waitcnt vmcnt(6) lgkmcnt(8)
  v_mfma_f32_16x16x32_bf16 v[96:99], v[160:163], v[64:67], v[96:99]
  ds_read_b64_tr_b16 v[192:193], v26 offset:0
  v_mfma_f32_16x16x32_bf16 v[100:103], v[160:163], v[68:71], v[100:103]
  ds_read_b64_tr_b16 v[194:195], v26 offset:2048
  v_mfma_f32_16x16x32_bf16 v[108:111], v[164:167], v[68:71], v[108:111]
  ds_read_b64_tr_b16 v[196:197], v27 offset:0
  v_mfma_f32_16x16x32_bf16 v[104:107], v[164:167], v[64:67], v[104:107]
  ds_read_b64_tr_b16 v[198:199], v27 offset:2048
  v_mfma_f32_16x16x32_bf16 v[112:115], v[168:171], v[64:67], v[112:115]
  ds_read_b64_tr_b16 v[200:201], v28 offset:0
  v_mfma_f32_16x16x32_bf16 v[116:119], v[168:171], v[68:71], v[116:119]
  ds_read_b64_tr_b16 v[202:203], v28 offset:2048
  v_mfma_f32_16x16x32_bf16 v[124:127], v[172:175], v[68:71], v[124:127]
  ds_read_b64_tr_b16 v[204:205], v29 offset:0
  v_mfma_f32_16x16x32_bf16 v[120:123], v[172:175], v[64:67], v[120:123]
  ds_read_b64_tr_b16 v[206:207], v29 offset:2048
  s_waitcnt vmcnt(4) lgkmcnt(8)
  v_mfma_f32_16x16x32_bf16 v[96:99], v[176:179], v[72:75], v[96:99]
  ds_read_b64_tr_b16 v[208:209], v26 offset:4096
  v_mfma_f32_16x16x32_bf16 v[100:103], v[176:179], v[76:79], v[100:103]
  ds_read_b64_tr_b16 v[210:211], v26 offset:6144
  v_mfma_f32_16x16x32_bf16 v[108:111], v[180:183], v[76:79], v[108:111]
  ds_read_b64_tr_b16 v[212:213], v27 offset:4096
  v_mfma_f32_16x16x32_bf16 v[104:107], v[180:183], v[72:75], v[104:107]
  ds_read_b64_tr_b16 v[214:215], v27 offset:6144
  v_mfma_f32_16x16x32_bf16 v[112:115], v[184:187], v[72:75], v[112:115]
  ds_read_b64_tr_b16 v[216:217], v28 offset:4096
  v_mfma_f32_16x16x32_bf16 v[116:119], v[184:187], v[76:79], v[116:119]
  ds_read_b64_tr_b16 v[218:219], v28 offset:6144
  v_mfma_f32_16x16x32_bf16 v[124:127], v[188:191], v[76:79], v[124:127]
  ds_read_b64_tr_b16 v[220:221], v29 offset:4096
  v_mfma_f32_16x16x32_bf16 v[120:123], v[188:191], v[72:75], v[120:123]
  ds_read_b64_tr_b16 v[222:223], v29 offset:6144
  s_waitcnt vmcnt(2) lgkmcnt(8)
  v_mfma_f32_16x16x32_bf16 v[96:99], v[192:195], v[80:83], v[96:99]
  v_mov_b32 v20, 0x3f803f80
  v_mov_b32 v21, 0x3f803f80
  v_mfma_f32_16x16x32_bf16 v[100:103], v[192:195], v[84:87], v[100:103]
  v_mov_b32 v22, 0x3f803f80
  v_mov_b32 v23, 0x3f803f80
  v_mfma_f32_16x16x32_bf16 v[108:111], v[196:199], v[84:87], v[108:111]
  v_mfma_f32_16x16x32_bf16 v[104:107], v[196:199], v[80:83], v[104:107]
  v_mfma_f32_16x16x32_bf16 v[112:115], v[200:203], v[80:83], v[112:115]
  v_mfma_f32_16x16x32_bf16 v[116:119], v[200:203], v[84:87], v[116:119]
  v_mfma_f32_16x16x32_bf16 v[124:127], v[204:207], v[84:87], v[124:127]
  v_mfma_f32_16x16x32_bf16 v[120:123], v[204:207], v[80:83], v[120:123]
  s_waitcnt vmcnt(0) lgkmcnt(0)
  v_mfma_f32_16x16x32_bf16 v[96:99], v[208:211], v[88:91], v[96:99]
  s_mov_b32 vcc_lo, 0xaaaaaaaa
  s_mov_b32 vcc_hi, vcc_lo
  v_mfma_f32_16x16x32_bf16 v[104:107], v[212:215], v[88:91], v[104:107]
  s_mov_b32 s8, 0xcccccccc
  s_mov_b32 s9, s8
  v_mfma_f32_16x16x32_bf16 v[112:115], v[216:219], v[88:91], v[112:115]
  s_mov_b32 s3, 32768
  v_mfma_f32_16x16x32_bf16 v[120:123], v[220:223], v[88:91], v[120:123]
  v_cvt_pk_bf16_f32 v240, v96, v97
  v_cvt_pk_bf16_f32 v241, v98, v99
  v_mfma_f32_16x16x32_bf16 v[100:103], v[208:211], v[92:95], v[100:103]
  v_cvt_pk_bf16_f32 v242, v104, v105
  v_cvt_pk_bf16_f32 v243, v106, v107
  v_mfma_f32_16x16x32_bf16 v[108:111], v[212:215], v[92:95], v[108:111]
  buffer_store_dwordx4 v[240:243], v12, s[44:47], 0 offen offset:0 sc1
  ds_write_b128 v19, v[240:243] offset:0
  v_mfma_f32_16x16x32_bf16 v[116:119], v[216:219], v[92:95], v[116:119]
  v_cvt_pk_bf16_f32 v244, v112, v113
  v_cvt_pk_bf16_f32 v245, v114, v115
  v_mfma_f32_16x16x32_bf16 v[124:127], v[220:223], v[92:95], v[124:127]
  v_cvt_pk_bf16_f32 v246, v120, v121
  v_cvt_pk_bf16_f32 v247, v122, v123
  buffer_store_dwordx4 v[244:247], v12, s[44:47], 0 offen offset:1024 sc1
  ds_write_b128 v19, v[244:247] offset:1024
  v_mfma_f32_16x16x32_bf16 v[132:135], v[240:243], v[240:243], 0
  v_cvt_pk_bf16_f32 v248, v100, v101
  v_cvt_pk_bf16_f32 v249, v102, v103
  v_mfma_f32_16x16x32_bf16 v[128:131], v[20:23], v[240:243], 0
  v_cvt_pk_bf16_f32 v250, v108, v109
  v_cvt_pk_bf16_f32 v251, v110, v111
  v_mfma_f32_16x16x32_bf16 v[132:135], v[244:247], v[244:247], v[132:135]
  buffer_store_dwordx4 v[248:251], v12, s[44:47], s3 offen offset:0 sc1
  ds_write_b128 v19, v[248:251] offset:2048
  v_mfma_f32_16x16x32_bf16 v[128:131], v[20:23], v[244:247], v[128:131]
  v_cvt_pk_bf16_f32 v252, v116, v117
  v_cvt_pk_bf16_f32 v253, v118, v119
  v_mfma_f32_16x16x32_bf16 v[140:143], v[248:251], v[248:251], 0
  v_cvt_pk_bf16_f32 v254, v124, v125
  v_cvt_pk_bf16_f32 v255, v126, v127
  v_mfma_f32_16x16x32_bf16 v[136:139], v[20:23], v[248:251], 0
  buffer_store_dwordx4 v[252:255], v12, s[44:47], s3 offen offset:1024 sc1
  ds_write_b128 v19, v[252:255] offset:3072
  v_mfma_f32_16x16x32_bf16 v[140:143], v[252:255], v[252:255], v[140:143]
  v_mfma_f32_16x16x32_bf16 v[136:139], v[20:23], v[252:255], v[136:139]
  v_cndmask_b32 v132, v132, v133, vcc
  v_cndmask_b32 v134, v134, v135, vcc
  v_cndmask_b32 v129, v132, v134, s[8:9]
  buffer_store_dwordx2 v[128:129], v18, s[56:59], 0 offen offset:0 sc1
  s_nop 2
  v_cndmask_b32 v140, v140, v141, vcc
  v_cndmask_b32 v142, v142, v143, vcc
  v_cndmask_b32 v137, v140, v142, s[8:9]
  buffer_store_dwordx2 v[136:137], v18, s[56:59], 0 offen offset:128 sc1
  s_waitcnt vmcnt(0) lgkmcnt(0)
  s_barrier
  s_add_u32 s97, s97, 1
  s_branch L_w1_body
L_wo_c1:
L_w1_c0:
L_w1_body:
  s_cmp_ge_u32 s2, 256
  s_cbranch_scc1 L_w1_end
  v_lshrrev_b32 v2, 6, v0
  v_and_b32 v1, 63, v0
  v_readfirstlane_b32 s70, v2
  s_and_b32 s3, s2, 7
  s_lshr_b32 s99, s2, 3
  s_and_b32 s5, s3, 3
  s_lshl_b32 s5, s5, 2
  s_and_b32 s6, s99, 3
  s_add_u32 s68, s5, s6
  s_lshr_b32 s5, s3, 2
  s_lshl_b32 s5, s5, 3
  s_lshr_b32 s6, s99, 2
  s_add_u32 s69, s5, s6
  s_cmp_lt_u32 s70, 4
  s_cbranch_scc1 L_w1_compute
L_w1_loader:
  s_add_u32 s8, s70, s69
  s_and_b32 s8, s8, 3
  s_add_u32 s9, s70, s68
  s_and_b32 s9, s9, 3
  s_lshl_b32 s76, s8, 12
  s_lshl_b32 s77, s9, 11
  s_add_u32 s77, s77, 16384
  s_lshl_b32 s11, s68, 7
  v_and_b32 v10, 7, v1
  s_lshr_b32 s10, s76, 11
  s_lshl_b32 s3, s68, 3
  s_add_u32 s10, s10, s3
  s_mul_i32 s10, s10, 32768
  v_lshl_add_u32 v4, v1, 4, s10
  v_add_u32 v5, 32768, v4
  v_lshrrev_b32 v3, 3, v1
  s_lshl_b32 s10, s9, 4
  v_add_u32 v3, s10, v3
  v_mul_u32_u24 v3, 7168, v3
  v_lshrrev_b32 v2, 3, v1
  v_and_b32 v2, 6, v2
  v_xor_b32 v2, v2, v10
  s_mul_i32 s10, s69, 128
  v_add_u32 v3, s10, v3
  v_lshl_add_u32 v8, v2, 4, v3
  v_add_u32 v3, 57344, v3
  v_lshl_add_u32 v9, v2, 4, v3
  v_lshrrev_b32 v3, 2, v1
  s_lshl_b32 s10, s9, 4
  v_add_u32 v3, s10, v3
  v_mul_u32_u24 v3, 7168, v3
  v_bfe_u32 v2, v1, 4, 1
  v_xor_b32 v2, v2, v1
  v_and_b32 v2, 3, v2
  s_lshl_b32 s10, s69, 6
  s_add_u32 s10, s10, 2048
  v_add_u32 v3, s10, v3
  v_lshl_add_u32 v28, v2, 4, v3
  s_lshl_b32 s78, s69, 7
  s_add_u32 s78, s78, 3072
  s_mov_b32 s75, 0
  s_add_u32 s100, s68, s69
  s_mov_b32 s101, -1
  s_add_u32 s3, s68, s69
  s_and_b32 s3, s3, 3
  s_mov_b32 s100, 0x68532410
  s_mov_b32 s101, 0xfedbac97
  s_cmp_eq_u32 s3, 1
  s_cselect_b32 s100, 0x96435210, s100
  s_cselect_b32 s101, 0xfecbda87, s101
  s_cmp_eq_u32 s3, 2
  s_cselect_b32 s100, 0x75463210, s100
  s_cselect_b32 s101, 0xfdceb98a, s101
  s_cmp_eq_u32 s3, 3
  s_cselect_b32 s100, 0x65743210, s100
  s_cselect_b32 s101, 0xedfca9b8, s101
  s_waitcnt lgkmcnt(0)
  s_mov_b32 s40, s24
  s_and_b32 s41, s25, 0xffff
  s_mov_b32 s42, 7340032
  s_mov_b32 s43, 0x00020000
  s_cmp_lg_u32 s96, 0
  s_cbranch_scc1 L_pfc3_skip
  s_getpc_b64 s[4:5]
L_pfc3:
  s_lshl_b32 s3, s99, 2
  s_add_u32 s3, s3, s70
  s_sub_u32 s3, s3, 4
  s_mul_i32 s3, s3, 192
  s_min_u32 s3, s3, L_w2_c1-L_w2_c0-192
  s_add_i32 s3, s3, L_w2_c0-L_pfc3
  s_ashr_i32 s6, s3, 31
  s_add_u32 s4, s4, s3
  s_addc_u32 s5, s5, s6
  s_load_dword s84, s[4:5], 0
  s_load_dword s84, s[4:5], 64
  s_load_dword s84, s[4:5], 128
L_pfc3_skip:
  s_add_u32 s36, s34, 4194304
  s_addc_u32 s37, s35, 0
  s_and_b32 s37, s37, 0xffff
  s_mov_b32 s38, 4194304
  s_mov_b32 s39, 0x00020000
  s_add_u32 s56, s34, 24117248
  s_addc_u32 s57, s35, 0
  s_and_b32 s57, s57, 0xffff
  s_mov_b32 s58, 262144
  s_mov_b32 s59, 0x00020000
  s_add_u32 s64, s22, 24641536
  s_addc_u32 s65, s23, 0
  s_and_b32 s65, s65, 0xffff
  s_mov_b32 s66, 262144
  s_mov_b32 s67, 0x00020000
  s_mov_b32 s52, s26
  s_and_b32 s53, s27, 0xffff
  s_mov_b32 s54, 7168
  s_mov_b32 s55, 0x00020000
  s_and_b32 s3, s70, 3
  s_lshl2_add_u32 s4, s68, s3
  s_lshl_b32 s4, s4, 8
  v_lshrrev_b32 v2, 4, v1
  v_and_b32 v3, 15, v1
  v_lshl_add_u32 v3, v3, 4, s4
  v_lshl_add_u32 v18, v2, 14, v3
  s_lshl_b32 s4, s69, 7
  s_lshl_b32 s5, s70, 6
  s_add_u32 s4, s4, s5
  s_add_u32 s4, s4, 1216
  s_lshl_b32 s5, s69, 6
  s_cmp_eq_u32 s70, 4
  s_cselect_b32 s4, s5, s4
  s_lshr_b32 s5, s5, 1
  s_add_u32 s5, s5, 1024
  s_cmp_eq_u32 s70, 7
  s_cselect_b32 s4, s5, s4
  v_and_b32 v3, 15, v1
  v_lshl_add_u32 v3, v3, 2, s4
  v_lshrrev_b32 v2, 4, v1
  v_add_lshl_u32 v23, v3, v2, 1
  v_lshlrev_b32 v3, 2, v3
  v_lshl_add_u32 v22, v2, 14, v3
  s_mov_b32 s60, s28
  s_and_b32 s61, s29, 0xffff
  s_mov_b32 s62, 7340032
  s_mov_b32 s63, 0x00020000
  s_cmp_eq_u32 s96, 0
  s_cselect_b32 s62, s62, 0
  s_and_b32 s3, s70, 3
  s_lshl_b32 s4, s2, 2
  s_add_u32 s3, s3, s4
  s_mul_i32 s98, s3, 3584
  s_add_u32 s98, s98, 3670016
  s_buffer_load_dword s84, s[60:63], s98 offset:0
  s_buffer_load_dword s84, s[60:63], s98 offset:64
  s_buffer_load_dword s84, s[60:63], s98 offset:128
  s_buffer_load_dword s84, s[60:63], s98 offset:192
  s_waitcnt vmcnt(0)
  s_barrier
  s_lshr_b32 s3, s69, 3
  s_and_b32 s73, s69, 7
  s_lshl1_add_u32 s91, s73, s3
  s_mul_i32 s74, s91, 458752
  s_lshl_b32 s73, s91, 11
  s_mov_b32 s88, s73
  s_add_u32 m0, s77, 0
  s_add_u32 s4, s74, 0
  buffer_load_dwordx4 v8, s[40:43], s4 offen lds
  s_add_u32 m0, s77, 1024
  s_nop 0
  buffer_load_dwordx4 v9, s[40:43], s4 offen lds
  s_add_u32 m0, s77, 8192
  s_add_u32 s4, s74, s78
  buffer_load_dwordx4 v8, s[40:43], s4 offen lds
  s_add_u32 m0, s77, 9216
  s_nop 0
  buffer_load_dwordx4 v9, s[40:43], s4 offen lds
  s_add_u32 m0, s77, 16384
  s_add_u32 s4, s4, 128
  buffer_load_dwordx4 v8, s[40:43], s4 offen lds
  s_add_u32 m0, s77, 17408
  s_nop 0
  buffer_load_dwordx4 v9, s[40:43], s4 offen lds
  s_add_u32 m0, s77, 24576
  s_nop 0
  buffer_load_dwordx4 v28, s[40:43], s74 offen lds
  s_and_b32 s73, s100, 15
  s_cmp_eq_u32 s73, s91
  s_cselect_b32 s74, 4, 0
  s_lshr_b64 s[100:101], s[100:101], s74
  s_and_b32 s73, s100, 15
  s_lshr_b64 s[100:101], s[100:101], 4
  s_mul_i32 s74, s73, 458752
  s_lshl_b32 s73, s73, 11
  s_add_u32 s3, s96, s70
  s_cmp_lg_u32 s3, 4
  s_cbranch_scc1 L_w1_chkNone
  s_add_u32 s44, s22, 41943040
  s_addc_u32 s45, s23, 0
  s_and_b32 s45, s45, 0xffff
  s_mov_b32 s46, 524288
  s_mov_b32 s47, 0x00020000
  v_lshrrev_b32 v2, 2, v1
  v_and_b32 v3, 3, v1
  v_lshlrev_b32 v2, 11, v2
  v_lshl_add_u32 v17, v3, 4, v2
  s_and_b32 s3, s69, 15
  s_lshl_b32 s3, s3, 7
  s_mov_b32 s79, 0x100000
L_w1_chkl:
  buffer_load_dwordx4 v[12:15], v17, s[44:47], s3 offen sc1
  s_sub_u32 s79, s79, 1
  s_cbranch_scc1 L_w1_chkNone
  s_waitcnt vmcnt(0)
  v_and_b32 v12, v12, v13
  v_and_b32 v14, v14, v15
  v_and_b32 v12, v12, v14
  v_cmp_ne_u32 vcc, 1, v12
  s_cbranch_vccnz L_w1_chkl
L_w1_chkNone:
  s_mov_b32 s75, 0
  s_add_u32 s44, s22, 41943040
  s_addc_u32 s45, s23, 0
  s_and_b32 s45, s45, 0xffff
  s_mov_b32 s46, 524288
  s_mov_b32 s47, 0x00020000
  s_lshl4_add_u32 s3, s97, s68
  s_and_b32 s4, s69, 15
  s_lshl4_add_u32 s3, s3, s4
  s_lshl_b32 s3, s3, 7
  s_sub_u32 s3, s3, 32768
  v_lshlrev_b32 v11, 7, v1
  v_and_b32 v2, 15, v1
  v_lshlrev_b32 v2, 2, v2
  s_getreg_b32 s4, hwreg(HW_REG_XCC_ID, 0, 4)
  v_add_u32 v3, 1, s4
  s_mov_b32 s79, 0x100000
  s_waitcnt vmcnt(0)
  s_cmp_lg_u32 s70, 4
  s_barrier
  s_cbranch_scc1 L_w1_nofl
  s_mov_b32 exec_lo, 0xffff
  s_mov_b32 exec_hi, 0
  buffer_store_dword v3, v11, s[44:47], s87 offen sc1
  s_mov_b64 exec, -1
L_w1_nofl:
  s_mov_b32 s5, s3
  s_mov_b32 s89, s73
  s_add_u32 m0, s77, 49152
  s_add_u32 s4, s74, 0
  buffer_load_dwordx4 v8, s[40:43], s4 offen lds
  s_add_u32 m0, s77, 50176
  s_nop 0
  buffer_load_dwordx4 v9, s[40:43], s4 offen lds
  s_add_u32 m0, s77, 57344
  s_add_u32 s4, s74, s78
  buffer_load_dwordx4 v8, s[40:43], s4 offen lds
  s_add_u32 m0, s77, 58368
  s_nop 0
  buffer_load_dwordx4 v9, s[40:43], s4 offen lds
  s_add_u32 m0, s77, 65536
  s_add_u32 s4, s4, 128
  buffer_load_dwordx4 v8, s[40:43], s4 offen lds
  s_add_u32 m0, s77, 66560
  s_nop 0
  buffer_load_dwordx4 v9, s[40:43], s4 offen lds
  s_add_u32 m0, s77, 73728
  s_nop 0
  buffer_load_dwordx4 v28, s[40:43], s74 offen lds
  s_and_b32 s73, s100, 15
  s_cmp_eq_u32 s73, s91
  s_cselect_b32 s74, 4, 0
  s_lshr_b64 s[100:101], s[100:101], s74
  s_and_b32 s73, s100, 15
  s_lshr_b64 s[100:101], s[100:101], 4
  s_mul_i32 s74, s73, 458752
  s_lshl_b32 s73, s73, 11
  s_mov_b32 s90, s73
  s_add_u32 m0, s77, 98304
  s_add_u32 s4, s74, 0
  buffer_load_dwordx4 v8, s[40:43], s4 offen lds
  s_add_u32 m0, s77, 99328
  s_nop 0
  buffer_load_dwordx4 v9, s[40:43], s4 offen lds
  s_add_u32 m0, s77, 106496
  s_add_u32 s4, s74, s78
  buffer_load_dwordx4 v8, s[40:43], s4 offen lds
  s_add_u32 m0, s77, 107520
  s_nop 0
  buffer_load_dwordx4 v9, s[40:43], s4 offen lds
  s_add_u32 m0, s77, 114688
  s_add_u32 s4, s4, 128
  buffer_load_dwordx4 v8, s[40:43], s4 offen lds
  s_add_u32 m0, s77, 115712
  s_nop 0
  buffer_load_dwordx4 v9, s[40:43], s4 offen lds
  s_add_u32 m0, s77, 122880
  s_nop 0
  buffer_load_dwordx4 v28, s[40:43], s74 offen lds
  s_and_b32 s73, s100, 15
  s_cmp_eq_u32 s73, s91
  s_cselect_b32 s74, 4, 0
  s_lshr_b64 s[100:101], s[100:101], s74
  s_and_b32 s73, s100, 15
  s_lshr_b64 s[100:101], s[100:101], 4
  s_mul_i32 s74, s73, 458752
  s_lshl_b32 s73, s73, 11
  s_mov_b32 s3, s5
  s_cmp_lg_u32 s70, 4
  s_cbranch_scc1 L_w1_dep
L_w1_poll:
  buffer_load_dword v27, v2, s[44:47], s3 offen sc1
  s_sub_u32 s79, s79, 1
  s_cbranch_scc1 L_w1_dep
  s_waitcnt vmcnt(0)
  v_cmp_eq_u32 vcc, 0, v27
  s_cbranch_vccnz L_w1_poll
L_w1_dep:
  s_waitcnt vmcnt(7)
  s_barrier
  s_add_u32 m0, s76, 49152
  s_nop 0
  buffer_load_dwordx4 v4, s[36:39], s89 offen offset:0 lds
  buffer_load_dwordx4 v4, s[36:39], s89 offen offset:1024 lds
  s_add_u32 m0, s76, 51200
  s_nop 0
  buffer_load_dwordx4 v5, s[36:39], s89 offen offset:0 lds
  buffer_load_dwordx4 v5, s[36:39], s89 offen offset:1024 lds
  s_add_u32 m0, s76, 98304
  s_nop 0
  buffer_load_dwordx4 v4, s[36:39], s90 offen offset:0 lds
  buffer_load_dwordx4 v4, s[36:39], s90 offen offset:1024 lds
  s_add_u32 m0, s76, 100352
  s_nop 0
  buffer_load_dwordx4 v5, s[36:39], s90 offen offset:0 lds
  buffer_load_dwordx4 v5, s[36:39], s90 offen offset:1024 lds
  s_waitcnt vmcnt(4)
  s_barrier
  s_mov_b32 s79, 13
L_w1_ld1:
  s_add_u32 s3, s75, s76
  s_add_u32 m0, s3, 0
  s_nop 0
  buffer_load_dwordx4 v4, s[36:39], s73 offen offset:0 lds
  buffer_load_dwordx4 v4, s[36:39], s73 offen offset:1024 lds
  s_add_u32 m0, s3, 2048
  s_nop 0
  buffer_load_dwordx4 v5, s[36:39], s73 offen offset:0 lds
  buffer_load_dwordx4 v5, s[36:39], s73 offen offset:1024 lds
  s_add_u32 s3, s75, s77
  s_add_u32 m0, s3, 0
  s_add_u32 s4, s74, 0
  buffer_load_dwordx4 v8, s[40:43], s4 offen lds
  s_add_u32 m0, s3, 1024
  s_nop 0
  buffer_load_dwordx4 v9, s[40:43], s4 offen lds
  s_add_u32 m0, s3, 8192
  s_add_u32 s4, s74, s78
  buffer_load_dwordx4 v8, s[40:43], s4 offen lds
  s_add_u32 m0, s3, 9216
  s_nop 0
  buffer_load_dwordx4 v9, s[40:43], s4 offen lds
  s_add_u32 m0, s3, 16384
  s_add_u32 s4, s4, 128
  buffer_load_dwordx4 v8, s[40:43], s4 offen lds
  s_add_u32 m0, s3, 17408
  s_nop 0
  buffer_load_dwordx4 v9, s[40:43], s4 offen lds
  s_add_u32 m0, s3, 24576
  s_nop 0
  buffer_load_dwordx4 v28, s[40:43], s74 offen lds
  s_and_b32 s73, s100, 15
  s_cmp_eq_u32 s73, s91
  s_cselect_b32 s74, 4, 0
  s_lshr_b64 s[100:101], s[100:101], s74
  s_and_b32 s73, s100, 15
  s_lshr_b64 s[100:101], s[100:101], 4
  s_mul_i32 s74, s73, 458752
  s_lshl_b32 s73, s73, 11
  s_add_u32 s75, s75, 49152
  s_cmp_eq_u32 s75, 147456
  s_cselect_b32 s75, 0, s75
  s_buffer_load_dword s84, s[60:63], s98 offset:256
  s_buffer_load_dword s84, s[60:63], s98 offset:320
  s_buffer_load_dword s84, s[60:63], s98 offset:384
  s_buffer_load_dword s84, s[60:63], s98 offset:448
  s_add_u32 s98, s98, 256
  s_waitcnt vmcnt(11)
  s_barrier
  s_sub_u32 s79, s79, 1
  s_cmp_lg_u32 s79, 0
  s_cbranch_scc1 L_w1_ld1
  buffer_load_dwordx4 v[32:35], v18, s[56:59], 0 offen
  s_mov_b32 s3, 65536
  buffer_load_dwordx4 v[36:39], v18, s[56:59], s3 offen
  s_mov_b32 s3, 131072
  buffer_load_dwordx4 v[40:43], v18, s[56:59], s3 offen
  s_mov_b32 s3, 196608
  buffer_load_dwordx4 v[44:47], v18, s[56:59], s3 offen
  s_cmp_lg_u32 s96, 0
  s_cbranch_scc1 L_w1_cl
  buffer_load_dwordx4 v[64:67], v22, s[64:67], 0 offen
  s_mov_b32 s3, 65536
  buffer_load_dwordx4 v[68:71], v22, s[64:67], s3 offen
  s_mov_b32 s3, 131072
  buffer_load_dwordx4 v[72:75], v22, s[64:67], s3 offen
  s_mov_b32 s3, 196608
  buffer_load_dwordx4 v[76:79], v22, s[64:67], s3 offen
  buffer_load_ushort v80, v23, s[52:55], 0 offen
  s_branch L_w1_cle
  L_w1_cl:
  s_waitcnt vmcnt(4)
  L_w1_cle:
  s_waitcnt vmcnt(9)
  s_barrier
  s_waitcnt vmcnt(0)
  s_cmp_lg_u32 s96, 0
  s_cbranch_scc1 L_w1_cp
  s_and_b32 s3, s70, 3
  s_lshl_b32 s5, s3, 9
  s_add_u32 s5, s5, 106496
  v_lshrrev_b32 v2, 5, v1
  v_and_b32 v3, 15, v1
  v_lshl_add_u32 v2, v3, 1, v2
  v_lshl_add_u32 v205, v2, 4, s5
  v_add_f32 v64, v64, v68
  v_add_f32 v65, v65, v69
  v_add_f32 v66, v66, v70
  v_add_f32 v67, v67, v71
  v_add_f32 v72, v72, v76
  v_add_f32 v73, v73, v77
  v_add_f32 v74, v74, v78
  v_add_f32 v75, v75, v79
  v_add_f32 v64, v64, v72
  v_add_f32 v65, v65, v73
  v_add_f32 v66, v66, v74
  v_add_f32 v67, v67, v75
  s_nop 1
  v_permlane32_swap_b32 v64, v66
  v_permlane32_swap_b32 v65, v67
  v_add_f32 v64, v64, v66
  v_add_f32 v65, v65, v67
  v_lshl_or_b32 v203, v80, 16, v80
  s_lshl_b32 s5, s3, 10
  s_add_u32 s5, s5, 110592
  v_permlane16_swap_b32 v64, v65
  v_lshrrev_b32 v2, 4, v1
  v_lshl_add_u32 v2, v3, 2, v2
  v_lshl_add_u32 v204, v2, 4, s5
  v_add_f32 v64, v64, v65
  v_cvt_pk_bf16_f32 v200, v64, v64
  v_and_b32 v65, 0xffff0000, v200
  v_sub_f32 v65, v64, v65
  v_cvt_pk_bf16_f32 v201, v64, v65
  v_and_b32 v202, 0xffff0000, v201
  v_sub_f32 v65, v65, v202
  v_cvt_pk_bf16_f32 v202, v65, v64
  v_mov_b32 v200, v201
  L_w1_cp:
  ds_write_b128 v204, v[200:203]
  v_add_f32 v32, v32, v36
  v_add_f32 v33, v33, v37
  v_add_f32 v34, v34, v38
  v_add_f32 v35, v35, v39
  v_add_f32 v40, v40, v44
  v_add_f32 v41, v41, v45
  v_add_f32 v42, v42, v46
  v_add_f32 v43, v43, v47
  v_add_f32 v32, v32, v40
  v_add_f32 v33, v33, v41
  v_add_f32 v34, v34, v42
  v_add_f32 v35, v35, v43
  s_nop 1
  v_permlane32_swap_b32 v32, v34
  v_permlane32_swap_b32 v33, v35
  v_add_f32 v32, v32, v34
  v_add_f32 v33, v33, v35
  v_mov_b32 v34, v32
  v_mov_b32 v35, v33
  s_nop 0
  v_permlane16_swap_b32 v32, v34
  v_permlane16_swap_b32 v33, v35
  v_add_f32 v32, v32, v34
  v_add_f32 v33, v33, v35
  v_mul_f32 v32, 0x3a800000, v32
  v_mul_f32 v33, 0x3a800000, v33
  v_fma_f32 v33, -v32, v32, v33
  v_max_f32 v33, 0, v33
  v_add_f32 v33, 0x3727c5ac, v33
  v_rsq_f32 v34, v33
  v_mul_f32 v32, -0.5, v32
  v_cvt_pk_bf16_f32 v36, v32, v32
  v_and_b32 v35, 0xffff0000, v36
  v_sub_f32 v35, v32, v35
  v_cvt_pk_bf16_f32 v37, v35, v35
  v_and_b32 v38, 0xffff0000, v37
  v_sub_f32 v35, v35, v38
  v_cvt_pk_bf16_f32 v38, v32, v35
  v_mul_f32 v42, v33, v34
  v_mul_f32 v40, 0xc0135761, v34
  v_mul_f32 v34, v34, v34
  v_mul_f32 v33, 0.5, v42
  v_mul_f32 v34, 0x3d372713, v34
  v_cvt_pk_bf16_f32 v35, v33, v33
  v_mul_f32 v41, v40, v34
  v_and_b32 v35, 0xffff0000, v35
  v_xor_b32_dpp v43, v27, v27 row_ror:2 row_mask:0xf bank_mask:0xf
  v_sub_f32 v35, v33, v35
  v_cmp_ne_u32 vcc, 0, v43
  v_cvt_pk_bf16_f32 v39, v33, v35
  s_or_b32 s92, vcc_lo, vcc_hi
  v_mov_b32 v43, s92
  ds_write_b128 v205, v[36:39]
  ds_write_b128 v205, v[40:43] offset:2048
  s_waitcnt lgkmcnt(0)
  s_barrier
  s_lshl_b32 s87, s97, 15
  s_lshl_b32 s4, s68, 11
  s_add_u32 s87, s87, s4
  s_lshl_b32 s4, s69, 2
  s_add_u32 s87, s87, s4
  s_add_u32 s97, s97, 1
  s_branch L_w2_body
L_w1_end:
  s_endpgm
L_w1_compute:
  s_and_b32 s71, s70, 1
  s_lshr_b32 s72, s70, 1
  v_and_b32 v3, 15, v1
  v_lshrrev_b32 v2, 4, v1
  s_lshl_b32 s8, s71, 13
  v_lshl_add_u32 v4, v1, 4, s8
  v_lshrrev_b32 v13, 2, v1
  v_lshlrev_b32 v13, 7, v13
  v_and_b32 v17, 3, v1
  v_lshl_add_u32 v13, v17, 3, v13
  v_bfe_u32 v17, v1, 3, 2
  v_lshl_add_u32 v13, v17, 5, v13
  s_lshl_b32 s9, s72, 6
  v_xor_b32 v13, s9, v13
  v_add_u32 v5, 16384, v13
  v_xor_b32 v6, 32, v5
  v_and_b32 v16, 1, v2
  v_lshrrev_b32 v17, 1, v2
  v_lshrrev_b32 v13, 2, v1
  v_and_b32 v14, 1, v1
  v_lshl_add_u32 v13, v13, 1, v14
  v_xor_b32 v14, s72, v16
  v_lshl_add_u32 v13, v13, 1, v14
  v_bfe_u32 v14, v1, 1, 1
  v_lshl_add_u32 v13, v13, 1, v14
  v_lshlrev_b32 v13, 3, v13
  v_add_u32 v7, 40960, v13
  s_mov_b32 s75, 0
  v_add_u32_e64 v20, s75, v4
  v_add_u32_e64 v21, s75, v5
  v_add_u32_e64 v22, s75, v6
  v_add_u32_e64 v23, s75, v7
  s_add_u32 s75, s75, 49152
  s_cmp_eq_u32 s75, 147456
  s_cselect_b32 s75, 0, s75
  s_mov_b32 s79, 14
  ds_read_b128 v[32:35], v20 offset:0
  ds_read_b128 v[36:39], v20 offset:2048
  ds_read_b128 v[40:43], v20 offset:4096
  ds_read_b128 v[44:47], v20 offset:6144
  ds_read_b64_tr_b16 v[48:49], v21 offset:0
  ds_read_b64_tr_b16 v[50:51], v21 offset:2048
  ds_read_b64_tr_b16 v[52:53], v22 offset:0
  ds_read_b64_tr_b16 v[54:55], v22 offset:2048
  ds_read_b64_tr_b16 v[56:57], v21 offset:8192
  ds_read_b64_tr_b16 v[58:59], v21 offset:10240
  ds_read_b64_tr_b16 v[60:61], v22 offset:8192
  ds_read_b64_tr_b16 v[62:63], v22 offset:10240
  ds_read_b64_tr_b16 v[64:65], v21 offset:16384
  ds_read_b64_tr_b16 v[66:67], v21 offset:18432
  ds_read_b64_tr_b16 v[68:69], v22 offset:16384
  ds_read_b64_tr_b16 v[70:71], v22 offset:18432
  ds_read_b64_tr_b16 v[72:73], v23 offset:0
  ds_read_b64_tr_b16 v[74:75], v23 offset:2048
  s_waitcnt lgkmcnt(0)
  v_mfma_f32_16x16x32_bf16 v[128:131], v[48:51], v[32:35], 0
  ds_read_b128 v[80:83], v20 offset:1024
  v_mfma_f32_16x16x32_bf16 v[132:135], v[48:51], v[36:39], 0
  ds_read_b128 v[84:87], v20 offset:3072
  v_mfma_f32_16x16x32_bf16 v[136:139], v[48:51], v[40:43], 0
  ds_read_b128 v[88:91], v20 offset:5120
  v_mfma_f32_16x16x32_bf16 v[140:143], v[48:51], v[44:47], 0
  ds_read_b128 v[92:95], v20 offset:7168
  v_mfma_f32_16x16x32_bf16 v[156:159], v[52:55], v[44:47], 0
  ds_read_b64_tr_b16 v[96:97], v21 offset:4096
  v_mfma_f32_16x16x32_bf16 v[152:155], v[52:55], v[40:43], 0
  ds_read_b64_tr_b16 v[98:99], v21 offset:6144
  v_mfma_f32_16x16x32_bf16 v[148:151], v[52:55], v[36:39], 0
  ds_read_b64_tr_b16 v[100:101], v22 offset:4096
  v_mfma_f32_16x16x32_bf16 v[144:147], v[52:55], v[32:35], 0
  ds_read_b64_tr_b16 v[102:103], v22 offset:6144
  v_mfma_f32_16x16x32_bf16 v[160:163], v[56:59], v[32:35], 0
  ds_read_b64_tr_b16 v[104:105], v21 offset:12288
  v_mfma_f32_16x16x32_bf16 v[164:167], v[56:59], v[36:39], 0
  ds_read_b64_tr_b16 v[106:107], v21 offset:14336
  v_mfma_f32_16x16x32_bf16 v[168:171], v[56:59], v[40:43], 0
  ds_read_b64_tr_b16 v[108:109], v22 offset:12288
  v_mfma_f32_16x16x32_bf16 v[172:175], v[56:59], v[44:47], 0
  ds_read_b64_tr_b16 v[110:111], v22 offset:14336
  v_mfma_f32_16x16x32_bf16 v[188:191], v[60:63], v[44:47], 0
  ds_read_b64_tr_b16 v[112:113], v21 offset:20480
  v_mfma_f32_16x16x32_bf16 v[184:187], v[60:63], v[40:43], 0
  ds_read_b64_tr_b16 v[114:115], v21 offset:22528
  v_mfma_f32_16x16x32_bf16 v[180:183], v[60:63], v[36:39], 0
  ds_read_b64_tr_b16 v[116:117], v22 offset:20480
  v_mfma_f32_16x16x32_bf16 v[176:179], v[60:63], v[32:35], 0
  ds_read_b64_tr_b16 v[118:119], v22 offset:22528
  v_mfma_f32_16x16x32_bf16 v[192:195], v[64:67], v[32:35], 0
  ds_read_b64_tr_b16 v[120:121], v23 offset:4096
  v_mfma_f32_16x16x32_bf16 v[196:199], v[64:67], v[36:39], 0
  ds_read_b64_tr_b16 v[122:123], v23 offset:6144
  v_mfma_f32_16x16x32_bf16 v[200:203], v[64:67], v[40:43], 0
  v_add_u32_e64 v20, s75, v4
  v_mfma_f32_16x16x32_bf16 v[204:207], v[64:67], v[44:47], 0
  v_add_u32_e64 v21, s75, v5
  v_mfma_f32_16x16x32_bf16 v[220:223], v[68:71], v[44:47], 0
  v_add_u32_e64 v22, s75, v6
  v_mfma_f32_16x16x32_bf16 v[216:219], v[68:71], v[40:43], 0
  v_add_u32_e64 v23, s75, v7
  v_mfma_f32_16x16x32_bf16 v[212:215], v[68:71], v[36:39], 0
  s_add_u32 s75, s75, 49152
  v_mfma_f32_16x16x32_bf16 v[208:211], v[68:71], v[32:35], 0
  s_cmp_eq_u32 s75, 147456
  v_mfma_f32_16x16x32_bf16 v[224:227], v[72:75], v[32:35], 0
  s_cselect_b32 s75, 0, s75
  v_mfma_f32_16x16x32_bf16 v[228:231], v[72:75], v[36:39], 0
  v_mfma_f32_16x16x32_bf16 v[232:235], v[72:75], v[40:43], 0
  v_mfma_f32_16x16x32_bf16 v[236:239], v[72:75], v[44:47], 0
  s_waitcnt lgkmcnt(0)
  v_mfma_f32_16x16x32_bf16 v[128:131], v[96:99], v[80:83], v[128:131]
  v_mfma_f32_16x16x32_bf16 v[132:135], v[96:99], v[84:87], v[132:135]
  v_mfma_f32_16x16x32_bf16 v[136:139], v[96:99], v[88:91], v[136:139]
  v_mfma_f32_16x16x32_bf16 v[140:143], v[96:99], v[92:95], v[140:143]
  v_mfma_f32_16x16x32_bf16 v[156:159], v[100:103], v[92:95], v[156:159]
  v_mfma_f32_16x16x32_bf16 v[152:155], v[100:103], v[88:91], v[152:155]
  v_mfma_f32_16x16x32_bf16 v[148:151], v[100:103], v[84:87], v[148:151]
  v_mfma_f32_16x16x32_bf16 v[144:147], v[100:103], v[80:83], v[144:147]
  v_mfma_f32_16x16x32_bf16 v[160:163], v[104:107], v[80:83], v[160:163]
  v_mfma_f32_16x16x32_bf16 v[164:167], v[104:107], v[84:87], v[164:167]
  v_mfma_f32_16x16x32_bf16 v[168:171], v[104:107], v[88:91], v[168:171]
  v_mfma_f32_16x16x32_bf16 v[172:175], v[104:107], v[92:95], v[172:175]
  v_mfma_f32_16x16x32_bf16 v[188:191], v[108:111], v[92:95], v[188:191]
  v_mfma_f32_16x16x32_bf16 v[184:187], v[108:111], v[88:91], v[184:187]
  v_mfma_f32_16x16x32_bf16 v[180:183], v[108:111], v[84:87], v[180:183]
  v_mfma_f32_16x16x32_bf16 v[176:179], v[108:111], v[80:83], v[176:179]
  v_mfma_f32_16x16x32_bf16 v[192:195], v[112:115], v[80:83], v[192:195]
  v_mfma_f32_16x16x32_bf16 v[196:199], v[112:115], v[84:87], v[196:199]
  v_mfma_f32_16x16x32_bf16 v[200:203], v[112:115], v[88:91], v[200:203]
  v_mfma_f32_16x16x32_bf16 v[204:207], v[112:115], v[92:95], v[204:207]
  v_mfma_f32_16x16x32_bf16 v[220:223], v[116:119], v[92:95], v[220:223]
  v_mfma_f32_16x16x32_bf16 v[216:219], v[116:119], v[88:91], v[216:219]
  v_mfma_f32_16x16x32_bf16 v[212:215], v[116:119], v[84:87], v[212:215]
  v_mfma_f32_16x16x32_bf16 v[208:211], v[116:119], v[80:83], v[208:211]
  v_mfma_f32_16x16x32_bf16 v[224:227], v[120:123], v[80:83], v[224:227]
  v_mfma_f32_16x16x32_bf16 v[228:231], v[120:123], v[84:87], v[228:231]
  v_mfma_f32_16x16x32_bf16 v[232:235], v[120:123], v[88:91], v[232:235]
  v_mfma_f32_16x16x32_bf16 v[236:239], v[120:123], v[92:95], v[236:239]
  s_lshl_b32 s8, s68, 7
  s_lshl_b32 s9, s71, 6
  s_add_u32 s8, s8, s9
  s_mul_i32 s8, s8, 7168
  v_lshlrev_b32 v14, 8, v17
  v_lshl_add_u32 v14, v3, 4, v14
  s_lshl3_add_u32 s9, s71, s72
  s_lshl_b32 s9, s9, 10
  s_add_u32 s9, s9, 114688
  v_lshl_add_u32 v18, v1, 4, s9
  s_mov_b32 s52, s30
  s_and_b32 s53, s31, 0xffff
  s_mov_b32 s54, 2048
  s_mov_b32 s55, 0x00020000
  s_lshr_b32 s9, s69, 3
  s_and_b32 s10, s69, 7
  s_lshl1_add_u32 s9, s10, s9
  s_lshl_b32 s9, s9, 7
  v_lshl_add_u32 v19, v2, 3, s9
  v_add_u32 v14, s8, v14
  s_lshl_b32 s10, s69, 11
  s_lshl_b32 s9, s72, 10
  s_add_u32 s9, s9, s10
  v_lshl_add_u32 v12, v1, 4, s8
  v_add_u32 v12, s9, v12
  v_mul_u32_u24 v16, 114688, v16
  s_lshr_b32 s9, s9, 1
  v_add3_u32 v13, v16, v14, s9
  s_lshl_b32 s9, s71, 10
  s_add_u32 s9, s9, 106496
  v_lshl_add_u32 v14, v3, 4, s9
  s_lshl_b32 s9, s72, 9
  s_add_u32 s9, s9, 110592
  v_lshl_add_u32 v15, v3, 4, s9
  v_bfe_u32 v16, v1, 2, 1
  v_bfe_u32 v17, v1, 3, 1
  v_lshl_add_u32 v17, v16, 2, v17
  v_and_b32 v16, 3, v1
  v_lshl_add_u32 v17, v17, 2, v16
  s_lshl_b32 s9, s72, 7
  s_add_u32 s9, s9, 110592
  v_lshl_add_u32 v16, v17, 4, s9
  v_bfe_u32 v17, v1, 4, 1
  v_lshl_add_u32 v14, v17, 3, v14
  v_lshl_add_u32 v15, v17, 3, v15
  v_lshl_add_u32 v16, v17, 3, v16
  v_mov_b32 v17, 108556
  s_add_u32 s44, s34, 8388608
  s_addc_u32 s45, s35, 0
  s_and_b32 s45, s45, 0xffff
  s_mov_b32 s46, 14680064
  s_mov_b32 s47, 0x00020000
  s_lshr_b32 s3, s69, 3
  s_and_b32 s78, s69, 7
  s_lshl1_add_u32 s69, s78, s3
  s_add_u32 s3, s68, s78
  s_and_b32 s3, s3, 3
  s_mov_b32 s4, 0x1616160
  s_cmp_eq_u32 s3, 1
  s_cselect_b32 s4, 0x5858580, s4
  s_cmp_eq_u32 s3, 2
  s_cselect_b32 s4, 0x16161600, s4
  s_cmp_eq_u32 s3, 3
  s_cselect_b32 s4, 0x58585800, s4
  v_subrev_u32 v2, 3, v1
  v_min_u32 v2, 16, v2
  v_lshlrev_b32 v3, 1, v2
  v_bfe_i32 v30, s4, v3, 2
  v_sub_u32 v30, v1, v30
  v_subrev_u32 v30, 7, v30
  v_ashrrev_i32 v3, 1, v30
  v_cmp_eq_u32 vcc, s78, v3
  s_and_b32 s3, s69, 1
  v_or_b32 v2, 14, v30
  v_cndmask_b32 v2, v30, v2, vcc
  v_cmp_gt_i32 vcc, 0, v30
  s_lshl2_add_u32 s4, s3, 20
  v_add_u32 v30, s4, v30
  s_lshl4_add_u32 s4, s3, 24
  v_add_u32 v2, s4, v2
  v_cndmask_b32 v30, v2, v30, vcc
  s_and_b32 s5, s68, 3
  s_mul_i32 s5, s5, 3
  s_sub_u32 s5, s5, 23
  v_add_u32 v3, s5, v1
  v_subrev_u32 v2, 10, v3
  v_min_u32 v3, v3, v2
  v_subrev_u32 v2, 10, v3
  v_min_u32 v3, v3, v2
  v_cmp_gt_u32 vcc, 23, v1
  s_sub_u32 s5, s3, 46
  v_lshl_add_u32 v2, v1, 1, s5
  v_cndmask_b32 v3, v3, v2, vcc
  s_add_u32 s5, s78, 3
  v_ashrrev_i32 v2, 1, v3
  v_add_u32 v2, s5, v2
  v_and_b32 v2, 7, v2
  v_cmp_gt_u32 vcc, 21, v1
  v_and_b32 v3, 1, v3
  v_lshl_add_u32 v3, v3, 3, v2
  v_cndmask_b32 v3, v3, v30, vcc
  v_lshlrev_b32 v30, 11, v3
  s_barrier
  ds_read_b64_tr_b16 v[48:49], v21 offset:0
  ds_read_b64_tr_b16 v[50:51], v21 offset:2048
  ds_read_b64_tr_b16 v[52:53], v22 offset:0
  ds_read_b64_tr_b16 v[54:55], v22 offset:2048
  ds_read_b64_tr_b16 v[56:57], v21 offset:8192
  ds_read_b64_tr_b16 v[58:59], v21 offset:10240
  ds_read_b64_tr_b16 v[60:61], v22 offset:8192
  ds_read_b64_tr_b16 v[62:63], v22 offset:10240
  ds_read_b64_tr_b16 v[64:65], v21 offset:16384
  ds_read_b64_tr_b16 v[66:67], v21 offset:18432
  ds_read_b64_tr_b16 v[68:69], v22 offset:16384
  ds_read_b64_tr_b16 v[70:71], v22 offset:18432
  ds_read_b64_tr_b16 v[72:73], v23 offset:0
  ds_read_b64_tr_b16 v[74:75], v23 offset:2048
  v_and_b32 v3, 15, v1
  v_lshrrev_b32 v2, 4, v1
  s_lshl_b32 s8, s68, 7
  s_lshl_b32 s9, s70, 5
  s_add_u32 s8, s8, s9
  v_add_u32 v76, s8, v3
  s_lshl_b32 s14, s69, 7
  v_lshrrev_b32 v79, 1, v2
  v_lshlrev_b32 v26, 3, v3
  v_and_b32 v26, 0x70, v26
  v_lshlrev_b32 v78, 3, v2
  v_xor_b32 v26, v26, v78
  v_lshl_add_u32 v26, v3, 7, v26
  s_lshl_b32 s3, s70, 12
  v_add_u32 v26, s3, v26
  v_lshl_add_u32 v27, v1, 4, s3
  s_cmp_eq_u32 s96, 0
  s_cselect_b32 s7, 128, 0
  s_add_u32 s7, s7, 2048
  v_xor_b32 v78, v1, v2
  v_and_b32 v78, 7, v78
  v_lshl_add_u32 v78, v78, 4, s14
  v_lshrrev_b32 v77, 3, v1
  v_add_u32 v77, s8, v77
  v_mad_u32_u24 v28, v77, s7, v78
  v_bfe_u32 v78, v1, 2, 2
  v_xor_b32 v78, v78, v2
  v_lshl_add_u32 v29, v78, 17, v76
  s_lshl_b32 s14, s69, 14
  v_lshl_add_u32 v29, v29, 3, s14
  v_lshrrev_b32 v8, 2, v1
  v_lshlrev_b32 v8, 7, v8
  v_and_b32 v79, 3, v1
  v_lshl_add_u32 v8, v79, 3, v8
  v_bfe_u32 v79, v1, 3, 2
  v_lshl_add_u32 v8, v79, 5, v8
  s_mov_b32 s11, 0xffff0000
  s_add_u32 s36, s34, 8388608
  s_addc_u32 s37, s35, 0
  s_and_b32 s37, s37, 0xffff
  s_mov_b32 s40, s32
  s_and_b32 s41, s33, 0xffff
  s_mov_b32 s43, 0x00020000
  s_add_u32 s48, s22, 33554432
  s_addc_u32 s49, s23, 0
  s_and_b32 s49, s49, 0xffff
  s_cmp_eq_u32 s96, 0
  s_cselect_b64 s[40:41], s[48:49], s[40:41]
  s_lshl_b32 s42, s7, 11
  s_add_u32 s56, s34, 24379392
  s_addc_u32 s57, s35, 0
  s_and_b32 s57, s57, 0xffff
  s_mov_b32 s58, 262144
  s_mov_b32 s59, 0x00020000
  s_mul_i32 s9, s8, 7168
  s_add_u32 s36, s36, s9
  s_addc_u32 s37, s37, 0x100000
  s_add_u32 s64, s36, 114688
  s_addc_u32 s65, s37, 0
  s_mov_b32 s38, 114688
  s_mov_b32 s39, 0x00800000
  s_mov_b32 s66, 114688
  s_mov_b32 s67, 0x00800000
  s_add_u32 s60, s34, 25165824
  s_addc_u32 s61, s35, 0
  s_and_b32 s61, s61, 0xffff
  s_mov_b32 s62, 4194304
  s_or_b32 s61, s61, 0x100000
  s_mov_b32 s63, 0x00800000
  s_lshl4_add_u32 s4, s68, s69
  s_lshl2_add_u32 s4, s4, s70
  s_add_u32 s6, s96, 4
  s_lshl_b32 s6, s6, 10
  s_add_u32 s6, s6, s4
  s_lshl_b32 s6, s6, 6
  s_lshl_b32 s4, s4, 12
  s_xor_b32 s5, s4, 16384
  v_readlane_b32 s51, v30, 3
  v_readlane_b32 s48, v30, 4
  v_readlane_b32 s49, v30, 5
  s_barrier
  ds_read_b128 v[32:35], v20 offset:0
  ds_read_b128 v[36:39], v20 offset:2048
  ds_read_b128 v[40:43], v20 offset:4096
  ds_read_b128 v[44:47], v20 offset:6144
.p2align 5
  s_nop 0
  s_nop 0
  s_nop 0
  s_waitcnt lgkmcnt(0)
L_w1_loop:
  v_mfma_f32_16x16x32_bf16 v[128:131], v[48:51], v[32:35], v[128:131]
  ds_read_b128 v[80:83], v20 offset:1024
  v_mfma_f32_16x16x32_bf16 v[132:135], v[48:51], v[36:39], v[132:135]
  ds_read_b128 v[84:87], v20 offset:3072
  v_mfma_f32_16x16x32_bf16 v[136:139], v[48:51], v[40:43], v[136:139]
  ds_read_b128 v[88:91], v20 offset:5120
  v_mfma_f32_16x16x32_bf16 v[140:143], v[48:51], v[44:47], v[140:143]
  ds_read_b128 v[92:95], v20 offset:7168
  v_mfma_f32_16x16x32_bf16 v[156:159], v[52:55], v[44:47], v[156:159]
  ds_read_b64_tr_b16 v[96:97], v21 offset:4096
  v_mfma_f32_16x16x32_bf16 v[152:155], v[52:55], v[40:43], v[152:155]
  ds_read_b64_tr_b16 v[98:99], v21 offset:6144
  v_mfma_f32_16x16x32_bf16 v[148:151], v[52:55], v[36:39], v[148:151]
  ds_read_b64_tr_b16 v[100:101], v22 offset:4096
  v_mfma_f32_16x16x32_bf16 v[144:147], v[52:55], v[32:35], v[144:147]
  ds_read_b64_tr_b16 v[102:103], v22 offset:6144
  v_mfma_f32_16x16x32_bf16 v[160:163], v[56:59], v[32:35], v[160:163]
  ds_read_b64_tr_b16 v[104:105], v21 offset:12288
  v_mfma_f32_16x16x32_bf16 v[164:167], v[56:59], v[36:39], v[164:167]
  ds_read_b64_tr_b16 v[106:107], v21 offset:14336
  v_mfma_f32_16x16x32_bf16 v[168:171], v[56:59], v[40:43], v[168:171]
  ds_read_b64_tr_b16 v[108:109], v22 offset:12288
  v_mfma_f32_16x16x32_bf16 v[172:175], v[56:59], v[44:47], v[172:175]
  ds_read_b64_tr_b16 v[110:111], v22 offset:14336
  v_mfma_f32_16x16x32_bf16 v[188:191], v[60:63], v[44:47], v[188:191]
  ds_read_b64_tr_b16 v[112:113], v21 offset:20480
  v_mfma_f32_16x16x32_bf16 v[184:187], v[60:63], v[40:43], v[184:187]
  ds_read_b64_tr_b16 v[114:115], v21 offset:22528
  v_mfma_f32_16x16x32_bf16 v[180:183], v[60:63], v[36:39], v[180:183]
  ds_read_b64_tr_b16 v[116:117], v22 offset:20480
  v_mfma_f32_16x16x32_bf16 v[176:179], v[60:63], v[32:35], v[176:179]
  ds_read_b64_tr_b16 v[118:119], v22 offset:22528
  v_mfma_f32_16x16x32_bf16 v[192:195], v[64:67], v[32:35], v[192:195]
  ds_read_b64_tr_b16 v[120:121], v23 offset:4096
  v_mfma_f32_16x16x32_bf16 v[196:199], v[64:67], v[36:39], v[196:199]
  ds_read_b64_tr_b16 v[122:123], v23 offset:6144
  v_mfma_f32_16x16x32_bf16 v[200:203], v[64:67], v[40:43], v[200:203]
  v_add_u32_e64 v20, s75, v4
  v_mfma_f32_16x16x32_bf16 v[204:207], v[64:67], v[44:47], v[204:207]
  v_add_u32_e64 v21, s75, v5
  v_mfma_f32_16x16x32_bf16 v[220:223], v[68:71], v[44:47], v[220:223]
  v_add_u32_e64 v22, s75, v6
  v_mfma_f32_16x16x32_bf16 v[216:219], v[68:71], v[40:43], v[216:219]
  v_add_u32_e64 v23, s75, v7
  v_mfma_f32_16x16x32_bf16 v[212:215], v[68:71], v[36:39], v[212:215]
  s_add_u32 s75, s75, 49152
  v_mfma_f32_16x16x32_bf16 v[208:211], v[68:71], v[32:35], v[208:211]
  s_cmp_eq_u32 s75, 147456
  v_mfma_f32_16x16x32_bf16 v[224:227], v[72:75], v[32:35], v[224:227]
  s_cselect_b32 s75, 0, s75
  s_sub_u32 s79, s79, 1
  v_mfma_f32_16x16x32_bf16 v[228:231], v[72:75], v[36:39], v[228:231]
  v_mfma_f32_16x16x32_bf16 v[232:235], v[72:75], v[40:43], v[232:235]
  v_mfma_f32_16x16x32_bf16 v[236:239], v[72:75], v[44:47], v[236:239]
  s_waitcnt lgkmcnt(0)
  s_barrier
  v_mfma_f32_16x16x32_bf16 v[128:131], v[96:99], v[80:83], v[128:131]
  ds_read_b128 v[32:35], v20 offset:0
  v_mfma_f32_16x16x32_bf16 v[132:135], v[96:99], v[84:87], v[132:135]
  ds_read_b128 v[36:39], v20 offset:2048
  v_mfma_f32_16x16x32_bf16 v[136:139], v[96:99], v[88:91], v[136:139]
  ds_read_b128 v[40:43], v20 offset:4096
  v_mfma_f32_16x16x32_bf16 v[140:143], v[96:99], v[92:95], v[140:143]
  ds_read_b128 v[44:47], v20 offset:6144
  v_mfma_f32_16x16x32_bf16 v[156:159], v[100:103], v[92:95], v[156:159]
  ds_read_b64_tr_b16 v[48:49], v21 offset:0
  v_mfma_f32_16x16x32_bf16 v[152:155], v[100:103], v[88:91], v[152:155]
  ds_read_b64_tr_b16 v[50:51], v21 offset:2048
  v_mfma_f32_16x16x32_bf16 v[148:151], v[100:103], v[84:87], v[148:151]
  ds_read_b64_tr_b16 v[52:53], v22 offset:0
  v_mfma_f32_16x16x32_bf16 v[144:147], v[100:103], v[80:83], v[144:147]
  ds_read_b64_tr_b16 v[54:55], v22 offset:2048
  v_mfma_f32_16x16x32_bf16 v[160:163], v[104:107], v[80:83], v[160:163]
  ds_read_b64_tr_b16 v[56:57], v21 offset:8192
  v_mfma_f32_16x16x32_bf16 v[164:167], v[104:107], v[84:87], v[164:167]
  ds_read_b64_tr_b16 v[58:59], v21 offset:10240
  v_mfma_f32_16x16x32_bf16 v[168:171], v[104:107], v[88:91], v[168:171]
  ds_read_b64_tr_b16 v[60:61], v22 offset:8192
  v_mfma_f32_16x16x32_bf16 v[172:175], v[104:107], v[92:95], v[172:175]
  ds_read_b64_tr_b16 v[62:63], v22 offset:10240
  v_mfma_f32_16x16x32_bf16 v[188:191], v[108:111], v[92:95], v[188:191]
  ds_read_b64_tr_b16 v[64:65], v21 offset:16384
  v_mfma_f32_16x16x32_bf16 v[184:187], v[108:111], v[88:91], v[184:187]
  ds_read_b64_tr_b16 v[66:67], v21 offset:18432
  v_mfma_f32_16x16x32_bf16 v[180:183], v[108:111], v[84:87], v[180:183]
  ds_read_b64_tr_b16 v[68:69], v22 offset:16384
  v_mfma_f32_16x16x32_bf16 v[176:179], v[108:111], v[80:83], v[176:179]
  ds_read_b64_tr_b16 v[70:71], v22 offset:18432
  v_mfma_f32_16x16x32_bf16 v[192:195], v[112:115], v[80:83], v[192:195]
  ds_read_b64_tr_b16 v[72:73], v23 offset:0
  v_mfma_f32_16x16x32_bf16 v[196:199], v[112:115], v[84:87], v[196:199]
  ds_read_b64_tr_b16 v[74:75], v23 offset:2048
  v_mfma_f32_16x16x32_bf16 v[200:203], v[112:115], v[88:91], v[200:203]
  s_cmp_lg_u32 s79, 0
  s_nop 0
  v_mfma_f32_16x16x32_bf16 v[204:207], v[112:115], v[92:95], v[204:207]
  v_mfma_f32_16x16x32_bf16 v[220:223], v[116:119], v[92:95], v[220:223]
  v_mfma_f32_16x16x32_bf16 v[216:219], v[116:119], v[88:91], v[216:219]
  v_mfma_f32_16x16x32_bf16 v[212:215], v[116:119], v[84:87], v[212:215]
  v_mfma_f32_16x16x32_bf16 v[208:211], v[116:119], v[80:83], v[208:211]
  v_mfma_f32_16x16x32_bf16 v[224:227], v[120:123], v[80:83], v[224:227]
  v_mfma_f32_16x16x32_bf16 v[228:231], v[120:123], v[84:87], v[228:231]
  v_mfma_f32_16x16x32_bf16 v[232:235], v[120:123], v[88:91], v[232:235]
  v_mfma_f32_16x16x32_bf16 v[236:239], v[120:123], v[92:95], v[236:239]
  s_waitcnt lgkmcnt(0)
  s_cbranch_scc1 L_w1_loop
L_w1_lend:
L_w1_exit:
  v_mfma_f32_16x16x32_bf16 v[128:131], v[48:51], v[32:35], v[128:131]
  ds_read_b128 v[80:83], v20 offset:1024
  v_mfma_f32_16x16x32_bf16 v[132:135], v[48:51], v[36:39], v[132:135]
  ds_read_b128 v[84:87], v20 offset:3072
  v_mfma_f32_16x16x32_bf16 v[136:139], v[48:51], v[40:43], v[136:139]
  ds_read_b128 v[88:91], v20 offset:5120
  v_mfma_f32_16x16x32_bf16 v[140:143], v[48:51], v[44:47], v[140:143]
  ds_read_b128 v[92:95], v20 offset:7168
  v_mfma_f32_16x16x32_bf16 v[156:159], v[52:55], v[44:47], v[156:159]
  ds_read_b64_tr_b16 v[96:97], v21 offset:4096
  v_mfma_f32_16x16x32_bf16 v[152:155], v[52:55], v[40:43], v[152:155]
  ds_read_b64_tr_b16 v[98:99], v21 offset:6144
  v_mfma_f32_16x16x32_bf16 v[148:151], v[52:55], v[36:39], v[148:151]
  ds_read_b64_tr_b16 v[100:101], v22 offset:4096
  v_mfma_f32_16x16x32_bf16 v[144:147], v[52:55], v[32:35], v[144:147]
  ds_read_b64_tr_b16 v[102:103], v22 offset:6144
  v_mfma_f32_16x16x32_bf16 v[160:163], v[56:59], v[32:35], v[160:163]
  ds_read_b64_tr_b16 v[104:105], v21 offset:12288
  v_mfma_f32_16x16x32_bf16 v[164:167], v[56:59], v[36:39], v[164:167]
  ds_read_b64_tr_b16 v[106:107], v21 offset:14336
  v_mfma_f32_16x16x32_bf16 v[168:171], v[56:59], v[40:43], v[168:171]
  ds_read_b64_tr_b16 v[108:109], v22 offset:12288
  v_mfma_f32_16x16x32_bf16 v[172:175], v[56:59], v[44:47], v[172:175]
  ds_read_b64_tr_b16 v[110:111], v22 offset:14336
  v_mfma_f32_16x16x32_bf16 v[188:191], v[60:63], v[44:47], v[188:191]
  ds_read_b64_tr_b16 v[112:113], v21 offset:20480
  v_mfma_f32_16x16x32_bf16 v[184:187], v[60:63], v[40:43], v[184:187]
  ds_read_b64_tr_b16 v[114:115], v21 offset:22528
  v_mfma_f32_16x16x32_bf16 v[180:183], v[60:63], v[36:39], v[180:183]
  ds_read_b64_tr_b16 v[116:117], v22 offset:20480
  v_mfma_f32_16x16x32_bf16 v[176:179], v[60:63], v[32:35], v[176:179]
  ds_read_b64_tr_b16 v[118:119], v22 offset:22528
  v_mfma_f32_16x16x32_bf16 v[192:195], v[64:67], v[32:35], v[192:195]
  ds_read_b64_tr_b16 v[120:121], v23 offset:4096
  v_mfma_f32_16x16x32_bf16 v[196:199], v[64:67], v[36:39], v[196:199]
  ds_read_b64_tr_b16 v[122:123], v23 offset:6144
  v_mfma_f32_16x16x32_bf16 v[200:203], v[64:67], v[40:43], v[200:203]
  v_and_b32 v76, -9, v14
  v_mfma_f32_16x16x32_bf16 v[204:207], v[64:67], v[44:47], v[204:207]
  v_mfma_f32_16x16x32_bf16 v[220:223], v[68:71], v[44:47], v[220:223]
  v_mfma_f32_16x16x32_bf16 v[216:219], v[68:71], v[40:43], v[216:219]
  v_mfma_f32_16x16x32_bf16 v[212:215], v[68:71], v[36:39], v[212:215]
  v_mfma_f32_16x16x32_bf16 v[208:211], v[68:71], v[32:35], v[208:211]
  v_mfma_f32_16x16x32_bf16 v[224:227], v[72:75], v[32:35], v[224:227]
  v_mfma_f32_16x16x32_bf16 v[228:231], v[72:75], v[36:39], v[228:231]
  v_mfma_f32_16x16x32_bf16 v[232:235], v[72:75], v[40:43], v[232:235]
  v_mfma_f32_16x16x32_bf16 v[236:239], v[72:75], v[44:47], v[236:239]
  s_waitcnt lgkmcnt(0)
  s_barrier
  v_mfma_f32_16x16x32_bf16 v[128:131], v[96:99], v[80:83], v[128:131]
  ds_read_b64 v[46:47], v14 offset:0
  ds_read_b64 v[32:33], v15 offset:0
  v_mfma_f32_16x16x32_bf16 v[132:135], v[96:99], v[84:87], v[132:135]
  ds_read_b64 v[34:35], v15 offset:256
  ds_read_b128 v[56:59], v76 offset:2048
  v_mfma_f32_16x16x32_bf16 v[136:139], v[96:99], v[88:91], v[136:139]
  ds_read_b32 v17, v17
  ds_read_b64 v[48:49], v14 offset:256
  v_mfma_f32_16x16x32_bf16 v[140:143], v[96:99], v[92:95], v[140:143]
  ds_read_b128 v[60:63], v76 offset:2304
  ds_read_b64 v[50:51], v14 offset:512
  v_mfma_f32_16x16x32_bf16 v[156:159], v[100:103], v[92:95], v[156:159]
  ds_read_b128 v[64:67], v76 offset:2560
  ds_read_b64 v[52:53], v14 offset:768
  v_mfma_f32_16x16x32_bf16 v[152:155], v[100:103], v[88:91], v[152:155]
  ds_read_b128 v[68:71], v76 offset:2816
  ds_read_b64 v[44:45], v16 offset:3072
  v_mfma_f32_16x16x32_bf16 v[148:151], v[100:103], v[84:87], v[148:151]
  ds_read_b64 v[36:37], v15 offset:1024
  ds_read_b64 v[38:39], v15 offset:1280
  v_mfma_f32_16x16x32_bf16 v[144:147], v[100:103], v[80:83], v[144:147]
  ds_read_b64 v[40:41], v15 offset:2048
  ds_read_b64 v[42:43], v15 offset:2304
  v_mfma_f32_16x16x32_bf16 v[160:163], v[104:107], v[80:83], v[160:163]
  v_mfma_f32_16x16x32_bf16 v[164:167], v[104:107], v[84:87], v[164:167]
  buffer_load_dwordx2 v[10:11], v19, s[52:55], 0 offen offset:0
  v_mfma_f32_16x16x32_bf16 v[168:171], v[104:107], v[88:91], v[168:171]
  buffer_load_dwordx2 v[24:25], v19, s[52:55], 0 offen offset:32
  v_mfma_f32_16x16x32_bf16 v[172:175], v[104:107], v[92:95], v[172:175]
  buffer_load_dwordx2 v[124:125], v19, s[52:55], 0 offen offset:64
  v_mfma_f32_16x16x32_bf16 v[188:191], v[108:111], v[92:95], v[188:191]
  buffer_load_dwordx2 v[126:127], v19, s[52:55], 0 offen offset:96
  v_mfma_f32_16x16x32_bf16 v[184:187], v[108:111], v[88:91], v[184:187]
  v_mfma_f32_16x16x32_bf16 v[180:183], v[108:111], v[84:87], v[180:183]
  s_waitcnt lgkmcnt(0)
  v_mfma_f32_16x16x16_bf16 v[128:131], v[32:33], v[46:47], v[128:131]
  v_readfirstlane_b32 s98, v17
  v_mfma_f32_16x16x32_bf16 v[176:179], v[108:111], v[80:83], v[176:179]
  v_mfma_f32_16x16x32_bf16 v[192:195], v[112:115], v[80:83], v[192:195]
  s_cmp_lg_u32 s98, 0
  s_cselect_b32 s98, 34603008, 0
  v_mfma_f32_16x16x32_bf16 v[196:199], v[112:115], v[84:87], v[196:199]
  s_add_u32 s44, s44, s98
  s_addc_u32 s45, s45, 0
  v_mfma_f32_16x16x32_bf16 v[200:203], v[112:115], v[88:91], v[200:203]
  s_add_u32 s36, s36, s98
  s_addc_u32 s37, s37, 0
  v_mfma_f32_16x16x32_bf16 v[204:207], v[112:115], v[92:95], v[204:207]
  s_add_u32 s64, s64, s98
  s_addc_u32 s65, s65, 0
  v_mfma_f32_16x16x32_bf16 v[220:223], v[116:119], v[92:95], v[220:223]
  v_mfma_f32_16x16x32_bf16 v[216:219], v[116:119], v[88:91], v[216:219]
  v_mfma_f32_16x16x32_bf16 v[212:215], v[116:119], v[84:87], v[212:215]
  v_mfma_f32_16x16x32_bf16 v[208:211], v[116:119], v[80:83], v[208:211]
  v_mfma_f32_16x16x32_bf16 v[224:227], v[120:123], v[80:83], v[224:227]
  v_mfma_f32_16x16x32_bf16 v[228:231], v[120:123], v[84:87], v[228:231]
  v_mfma_f32_16x16x32_bf16 v[232:235], v[120:123], v[88:91], v[232:235]
  v_mfma_f32_16x16x32_bf16 v[236:239], v[120:123], v[92:95], v[236:239]
  v_pk_mul_f32 v[100:101], v[128:129], v[128:129]
  v_pk_mul_f32 v[102:103], v[130:131], v[130:131]
  v_pk_fma_f32 v[100:101], v[100:101], v[56:57], v[56:57] op_sel:[0,1,0] op_sel_hi:[1,1,0]
  v_pk_fma_f32 v[102:103], v[102:103], v[56:57], v[56:57] op_sel:[0,1,0] op_sel_hi:[1,1,0]
  v_pk_mul_f32 v[100:101], v[100:101], v[128:129]
  v_pk_mul_f32 v[102:103], v[102:103], v[130:131]
  v_mfma_f32_16x16x16_bf16 v[144:147], v[34:35], v[46:47], v[144:147]
  v_exp_f32 v100, v100
  v_exp_f32 v101, v101
  v_exp_f32 v102, v102
  v_exp_f32 v103, v103
  v_pk_fma_f32 v[100:101], v[100:101], v[58:59], v[58:59] op_sel_hi:[1,0,0]
  v_pk_fma_f32 v[102:103], v[102:103], v[58:59], v[58:59] op_sel_hi:[1,0,0]
  v_rcp_f32 v100, v100
  v_rcp_f32 v101, v101
  v_rcp_f32 v102, v102
  v_rcp_f32 v103, v103
  v_pk_mul_f32 v[128:129], v[128:129], v[100:101]
  v_pk_mul_f32 v[130:131], v[130:131], v[102:103]
  v_cvt_pk_bf16_f32 v108, v128, v129
  v_cvt_pk_bf16_f32 v109, v130, v131
  v_pk_mul_f32 v[104:105], v[144:145], v[144:145]
  v_pk_mul_f32 v[106:107], v[146:147], v[146:147]
  v_pk_fma_f32 v[104:105], v[104:105], v[56:57], v[56:57] op_sel:[0,1,0] op_sel_hi:[1,1,0]
  v_pk_fma_f32 v[106:107], v[106:107], v[56:57], v[56:57] op_sel:[0,1,0] op_sel_hi:[1,1,0]
  v_pk_mul_f32 v[104:105], v[104:105], v[144:145]
  v_pk_mul_f32 v[106:107], v[106:107], v[146:147]
  v_mfma_f32_16x16x16_bf16 v[132:135], v[32:33], v[48:49], v[132:135]
  v_exp_f32 v104, v104
  v_exp_f32 v105, v105
  v_exp_f32 v106, v106
  v_exp_f32 v107, v107
  v_pk_fma_f32 v[104:105], v[104:105], v[58:59], v[58:59] op_sel_hi:[1,0,0]
  v_pk_fma_f32 v[106:107], v[106:107], v[58:59], v[58:59] op_sel_hi:[1,0,0]
  v_rcp_f32 v104, v104
  v_rcp_f32 v105, v105
  v_rcp_f32 v106, v106
  v_rcp_f32 v107, v107
  v_pk_mul_f32 v[144:145], v[144:145], v[104:105]
  v_pk_mul_f32 v[146:147], v[146:147], v[106:107]
  v_cvt_pk_bf16_f32 v110, v144, v145
  v_cvt_pk_bf16_f32 v111, v146, v147
  s_mov_b32 s3, 0
  buffer_store_dwordx4 v[108:111], v12, s[44:47], s3 offen sc1
  ds_write_b128 v18, v[108:111] offset:32768
  v_pk_mul_f32 v[100:101], v[132:133], v[132:133]
  v_pk_mul_f32 v[102:103], v[134:135], v[134:135]
  v_pk_fma_f32 v[100:101], v[100:101], v[60:61], v[60:61] op_sel:[0,1,0] op_sel_hi:[1,1,0]
  v_pk_fma_f32 v[102:103], v[102:103], v[60:61], v[60:61] op_sel:[0,1,0] op_sel_hi:[1,1,0]
  v_pk_mul_f32 v[100:101], v[100:101], v[132:133]
  v_pk_mul_f32 v[102:103], v[102:103], v[134:135]
  v_mfma_f32_16x16x16_bf16 v[148:151], v[34:35], v[48:49], v[148:151]
  v_exp_f32 v100, v100
  v_exp_f32 v101, v101
  v_exp_f32 v102, v102
  v_exp_f32 v103, v103
  v_pk_fma_f32 v[100:101], v[100:101], v[62:63], v[62:63] op_sel_hi:[1,0,0]
  v_pk_fma_f32 v[102:103], v[102:103], v[62:63], v[62:63] op_sel_hi:[1,0,0]
  v_rcp_f32 v100, v100
  v_rcp_f32 v101, v101
  v_rcp_f32 v102, v102
  v_rcp_f32 v103, v103
  v_pk_mul_f32 v[132:133], v[132:133], v[100:101]
  v_pk_mul_f32 v[134:135], v[134:135], v[102:103]
  v_cvt_pk_bf16_f32 v112, v132, v133
  v_cvt_pk_bf16_f32 v113, v134, v135
  v_pk_mul_f32 v[104:105], v[148:149], v[148:149]
  v_pk_mul_f32 v[106:107], v[150:151], v[150:151]
  v_pk_fma_f32 v[104:105], v[104:105], v[60:61], v[60:61] op_sel:[0,1,0] op_sel_hi:[1,1,0]
  v_pk_fma_f32 v[106:107], v[106:107], v[60:61], v[60:61] op_sel:[0,1,0] op_sel_hi:[1,1,0]
  v_pk_mul_f32 v[104:105], v[104:105], v[148:149]
  v_pk_mul_f32 v[106:107], v[106:107], v[150:151]
  v_mfma_f32_16x16x16_bf16 v[136:139], v[32:33], v[50:51], v[136:139]
  v_exp_f32 v104, v104
  v_exp_f32 v105, v105
  v_exp_f32 v106, v106
  v_exp_f32 v107, v107
  v_pk_fma_f32 v[104:105], v[104:105], v[62:63], v[62:63] op_sel_hi:[1,0,0]
  v_pk_fma_f32 v[106:107], v[106:107], v[62:63], v[62:63] op_sel_hi:[1,0,0]
  v_rcp_f32 v104, v104
  v_rcp_f32 v105, v105
  v_rcp_f32 v106, v106
  v_rcp_f32 v107, v107
  v_pk_mul_f32 v[148:149], v[148:149], v[104:105]
  v_pk_mul_f32 v[150:151], v[150:151], v[106:107]
  v_cvt_pk_bf16_f32 v114, v148, v149
  v_cvt_pk_bf16_f32 v115, v150, v151
  s_mov_b32 s3, 114688
  buffer_store_dwordx4 v[112:115], v12, s[44:47], s3 offen sc1
  ds_write_b128 v18, v[112:115] offset:34816
  v_pk_mul_f32 v[100:101], v[136:137], v[136:137]
  v_pk_mul_f32 v[102:103], v[138:139], v[138:139]
  v_pk_fma_f32 v[100:101], v[100:101], v[64:65], v[64:65] op_sel:[0,1,0] op_sel_hi:[1,1,0]
  v_pk_fma_f32 v[102:103], v[102:103], v[64:65], v[64:65] op_sel:[0,1,0] op_sel_hi:[1,1,0]
  v_pk_mul_f32 v[100:101], v[100:101], v[136:137]
  v_pk_mul_f32 v[102:103], v[102:103], v[138:139]
  v_mfma_f32_16x16x16_bf16 v[152:155], v[34:35], v[50:51], v[152:155]
  v_exp_f32 v100, v100
  v_exp_f32 v101, v101
  v_exp_f32 v102, v102
  v_exp_f32 v103, v103
  v_pk_fma_f32 v[100:101], v[100:101], v[66:67], v[66:67] op_sel_hi:[1,0,0]
  v_pk_fma_f32 v[102:103], v[102:103], v[66:67], v[66:67] op_sel_hi:[1,0,0]
  v_rcp_f32 v100, v100
  v_rcp_f32 v101, v101
  v_rcp_f32 v102, v102
  v_rcp_f32 v103, v103
  v_pk_mul_f32 v[136:137], v[136:137], v[100:101]
  v_pk_mul_f32 v[138:139], v[138:139], v[102:103]
  v_cvt_pk_bf16_f32 v116, v136, v137
  v_cvt_pk_bf16_f32 v117, v138, v139
  v_pk_mul_f32 v[104:105], v[152:153], v[152:153]
  v_pk_mul_f32 v[106:107], v[154:155], v[154:155]
  v_pk_fma_f32 v[104:105], v[104:105], v[64:65], v[64:65] op_sel:[0,1,0] op_sel_hi:[1,1,0]
  v_pk_fma_f32 v[106:107], v[106:107], v[64:65], v[64:65] op_sel:[0,1,0] op_sel_hi:[1,1,0]
  v_pk_mul_f32 v[104:105], v[104:105], v[152:153]
  v_pk_mul_f32 v[106:107], v[106:107], v[154:155]
  v_mfma_f32_16x16x16_bf16 v[140:143], v[32:33], v[52:53], v[140:143]
  v_exp_f32 v104, v104
  v_exp_f32 v105, v105
  v_exp_f32 v106, v106
  v_exp_f32 v107, v107
  v_pk_fma_f32 v[104:105], v[104:105], v[66:67], v[66:67] op_sel_hi:[1,0,0]
  v_pk_fma_f32 v[106:107], v[106:107], v[66:67], v[66:67] op_sel_hi:[1,0,0]
  v_rcp_f32 v104, v104
  v_rcp_f32 v105, v105
  v_rcp_f32 v106, v106
  v_rcp_f32 v107, v107
  v_pk_mul_f32 v[152:153], v[152:153], v[104:105]
  v_pk_mul_f32 v[154:155], v[154:155], v[106:107]
  v_cvt_pk_bf16_f32 v118, v152, v153
  v_cvt_pk_bf16_f32 v119, v154, v155
  s_mov_b32 s3, 229376
  buffer_store_dwordx4 v[116:119], v12, s[44:47], s3 offen sc1
  ds_write_b128 v18, v[116:119] offset:36864
  v_pk_mul_f32 v[100:101], v[140:141], v[140:141]
  v_pk_mul_f32 v[102:103], v[142:143], v[142:143]
  v_pk_fma_f32 v[100:101], v[100:101], v[68:69], v[68:69] op_sel:[0,1,0] op_sel_hi:[1,1,0]
  v_pk_fma_f32 v[102:103], v[102:103], v[68:69], v[68:69] op_sel:[0,1,0] op_sel_hi:[1,1,0]
  v_pk_mul_f32 v[100:101], v[100:101], v[140:141]
  v_pk_mul_f32 v[102:103], v[102:103], v[142:143]
  v_mfma_f32_16x16x16_bf16 v[156:159], v[34:35], v[52:53], v[156:159]
  v_exp_f32 v100, v100
  v_exp_f32 v101, v101
  v_exp_f32 v102, v102
  v_exp_f32 v103, v103
  v_pk_fma_f32 v[100:101], v[100:101], v[70:71], v[70:71] op_sel_hi:[1,0,0]
  v_pk_fma_f32 v[102:103], v[102:103], v[70:71], v[70:71] op_sel_hi:[1,0,0]
  v_rcp_f32 v100, v100
  v_rcp_f32 v101, v101
  v_rcp_f32 v102, v102
  v_rcp_f32 v103, v103
  v_pk_mul_f32 v[140:141], v[140:141], v[100:101]
  v_pk_mul_f32 v[142:143], v[142:143], v[102:103]
  v_cvt_pk_bf16_f32 v120, v140, v141
  v_cvt_pk_bf16_f32 v121, v142, v143
  v_pk_mul_f32 v[104:105], v[156:157], v[156:157]
  v_pk_mul_f32 v[106:107], v[158:159], v[158:159]
  v_pk_fma_f32 v[104:105], v[104:105], v[68:69], v[68:69] op_sel:[0,1,0] op_sel_hi:[1,1,0]
  v_pk_fma_f32 v[106:107], v[106:107], v[68:69], v[68:69] op_sel:[0,1,0] op_sel_hi:[1,1,0]
  v_pk_mul_f32 v[104:105], v[104:105], v[156:157]
  v_pk_mul_f32 v[106:107], v[106:107], v[158:159]
  v_mfma_f32_16x16x16_bf16 v[224:227], v[44:45], v[46:47], v[224:227]
  v_exp_f32 v104, v104
  v_exp_f32 v105, v105
  v_exp_f32 v106, v106
  v_exp_f32 v107, v107
  v_pk_fma_f32 v[104:105], v[104:105], v[70:71], v[70:71] op_sel_hi:[1,0,0]
  v_pk_fma_f32 v[106:107], v[106:107], v[70:71], v[70:71] op_sel_hi:[1,0,0]
  v_rcp_f32 v104, v104
  v_rcp_f32 v105, v105
  v_rcp_f32 v106, v106
  v_rcp_f32 v107, v107
  v_pk_mul_f32 v[156:157], v[156:157], v[104:105]
  v_pk_mul_f32 v[158:159], v[158:159], v[106:107]
  v_cvt_pk_bf16_f32 v122, v156, v157
  v_cvt_pk_bf16_f32 v123, v158, v159
  s_mov_b32 s3, 344064
  buffer_store_dwordx4 v[120:123], v12, s[44:47], s3 offen sc1
  ds_write_b128 v18, v[120:123] offset:38912
  v_pk_mul_f32 v[100:101], v[224:225], v[224:225]
  v_pk_mul_f32 v[102:103], v[226:227], v[226:227]
  v_pk_fma_f32 v[100:101], v[100:101], v[56:57], v[56:57] op_sel:[0,1,0] op_sel_hi:[1,1,0]
  v_pk_fma_f32 v[102:103], v[102:103], v[56:57], v[56:57] op_sel:[0,1,0] op_sel_hi:[1,1,0]
  v_pk_mul_f32 v[100:101], v[100:101], v[224:225]
  v_pk_mul_f32 v[102:103], v[102:103], v[226:227]
  v_mfma_f32_16x16x16_bf16 v[228:231], v[44:45], v[48:49], v[228:231]
  v_exp_f32 v100, v100
  v_exp_f32 v101, v101
  v_exp_f32 v102, v102
  v_exp_f32 v103, v103
  v_pk_fma_f32 v[100:101], v[100:101], v[58:59], v[58:59] op_sel_hi:[1,0,0]
  v_pk_fma_f32 v[102:103], v[102:103], v[58:59], v[58:59] op_sel_hi:[1,0,0]
  v_rcp_f32 v100, v100
  v_rcp_f32 v101, v101
  v_rcp_f32 v102, v102
  v_rcp_f32 v103, v103
  v_pk_mul_f32 v[224:225], v[224:225], v[100:101]
  v_pk_mul_f32 v[226:227], v[226:227], v[102:103]
  v_cvt_pk_bf16_f32 v108, v224, v225
  v_cvt_pk_bf16_f32 v109, v226, v227
  v_pk_mul_f32 v[100:101], v[228:229], v[228:229]
  v_pk_mul_f32 v[102:103], v[230:231], v[230:231]
  v_pk_fma_f32 v[100:101], v[100:101], v[60:61], v[60:61] op_sel:[0,1,0] op_sel_hi:[1,1,0]
  v_pk_fma_f32 v[102:103], v[102:103], v[60:61], v[60:61] op_sel:[0,1,0] op_sel_hi:[1,1,0]
  v_pk_mul_f32 v[100:101], v[100:101], v[228:229]
  v_pk_mul_f32 v[102:103], v[102:103], v[230:231]
  v_mfma_f32_16x16x16_bf16 v[232:235], v[44:45], v[50:51], v[232:235]
  v_exp_f32 v100, v100
  v_exp_f32 v101, v101
  v_exp_f32 v102, v102
  v_exp_f32 v103, v103
  v_pk_fma_f32 v[100:101], v[100:101], v[62:63], v[62:63] op_sel_hi:[1,0,0]
  v_pk_fma_f32 v[102:103], v[102:103], v[62:63], v[62:63] op_sel_hi:[1,0,0]
  v_rcp_f32 v100, v100
  v_rcp_f32 v101, v101
  v_rcp_f32 v102, v102
  v_rcp_f32 v103, v103
  v_pk_mul_f32 v[228:229], v[228:229], v[100:101]
  v_pk_mul_f32 v[230:231], v[230:231], v[102:103]
  v_cvt_pk_bf16_f32 v110, v228, v229
  v_cvt_pk_bf16_f32 v111, v230, v231
  s_mov_b32 s3, 32768
  s_nop 0
  v_permlane16_swap_b32 v108, v110
  v_permlane16_swap_b32 v109, v111
  buffer_store_dwordx4 v[108:111], v13, s[44:47], s3 offen sc1
  v_pk_mul_f32 v[100:101], v[232:233], v[232:233]
  v_pk_mul_f32 v[102:103], v[234:235], v[234:235]
  v_pk_fma_f32 v[100:101], v[100:101], v[64:65], v[64:65] op_sel:[0,1,0] op_sel_hi:[1,1,0]
  v_pk_fma_f32 v[102:103], v[102:103], v[64:65], v[64:65] op_sel:[0,1,0] op_sel_hi:[1,1,0]
  v_pk_mul_f32 v[100:101], v[100:101], v[232:233]
  v_pk_mul_f32 v[102:103], v[102:103], v[234:235]
  v_mfma_f32_16x16x16_bf16 v[236:239], v[44:45], v[52:53], v[236:239]
  v_exp_f32 v100, v100
  v_exp_f32 v101, v101
  v_exp_f32 v102, v102
  v_exp_f32 v103, v103
  v_pk_fma_f32 v[100:101], v[100:101], v[66:67], v[66:67] op_sel_hi:[1,0,0]
  v_pk_fma_f32 v[102:103], v[102:103], v[66:67], v[66:67] op_sel_hi:[1,0,0]
  v_rcp_f32 v100, v100
  v_rcp_f32 v101, v101
  v_rcp_f32 v102, v102
  v_rcp_f32 v103, v103
  v_pk_mul_f32 v[232:233], v[232:233], v[100:101]
  v_pk_mul_f32 v[234:235], v[234:235], v[102:103]
  v_cvt_pk_bf16_f32 v112, v232, v233
  v_cvt_pk_bf16_f32 v113, v234, v235
  v_pk_mul_f32 v[100:101], v[236:237], v[236:237]
  v_pk_mul_f32 v[102:103], v[238:239], v[238:239]
  v_pk_fma_f32 v[100:101], v[100:101], v[68:69], v[68:69] op_sel:[0,1,0] op_sel_hi:[1,1,0]
  v_pk_fma_f32 v[102:103], v[102:103], v[68:69], v[68:69] op_sel:[0,1,0] op_sel_hi:[1,1,0]
  v_pk_mul_f32 v[100:101], v[100:101], v[236:237]
  v_pk_mul_f32 v[102:103], v[102:103], v[238:239]
  v_mfma_f32_16x16x16_bf16 v[160:163], v[36:37], v[46:47], v[160:163]
  v_exp_f32 v100, v100
  v_exp_f32 v101, v101
  v_exp_f32 v102, v102
  v_exp_f32 v103, v103
  v_pk_fma_f32 v[100:101], v[100:101], v[70:71], v[70:71] op_sel_hi:[1,0,0]
  v_pk_fma_f32 v[102:103], v[102:103], v[70:71], v[70:71] op_sel_hi:[1,0,0]
  v_rcp_f32 v100, v100
  v_rcp_f32 v101, v101
  v_rcp_f32 v102, v102
  v_rcp_f32 v103, v103
  v_pk_mul_f32 v[236:237], v[236:237], v[100:101]
  v_pk_mul_f32 v[238:239], v[238:239], v[102:103]
  v_cvt_pk_bf16_f32 v114, v236, v237
  v_cvt_pk_bf16_f32 v115, v238, v239
  s_mov_b32 s3, 262144
  s_nop 0
  v_permlane16_swap_b32 v112, v114
  v_permlane16_swap_b32 v113, v115
  buffer_store_dwordx4 v[112:115], v13, s[44:47], s3 offen sc1
  v_pk_mul_f32 v[100:101], v[160:161], v[160:161]
  v_pk_mul_f32 v[102:103], v[162:163], v[162:163]
  v_pk_fma_f32 v[100:101], v[100:101], v[56:57], v[56:57] op_sel:[0,1,0] op_sel_hi:[1,1,0]
  v_pk_fma_f32 v[102:103], v[102:103], v[56:57], v[56:57] op_sel:[0,1,0] op_sel_hi:[1,1,0]
  v_pk_mul_f32 v[100:101], v[100:101], v[160:161]
  v_pk_mul_f32 v[102:103], v[102:103], v[162:163]
  v_mfma_f32_16x16x16_bf16 v[176:179], v[38:39], v[46:47], v[176:179]
  v_exp_f32 v100, v100
  v_exp_f32 v101, v101
  v_exp_f32 v102, v102
  v_exp_f32 v103, v103
  v_pk_fma_f32 v[100:101], v[100:101], v[58:59], v[58:59] op_sel_hi:[1,0,0]
  v_pk_fma_f32 v[102:103], v[102:103], v[58:59], v[58:59] op_sel_hi:[1,0,0]
  v_rcp_f32 v100, v100
  v_rcp_f32 v101, v101
  v_rcp_f32 v102, v102
  v_rcp_f32 v103, v103
  v_pk_mul_f32 v[160:161], v[160:161], v[100:101]
  v_pk_mul_f32 v[162:163], v[162:163], v[102:103]
  v_cvt_pk_bf16_f32 v116, v160, v161
  v_cvt_pk_bf16_f32 v117, v162, v163
  v_pk_mul_f32 v[104:105], v[176:177], v[176:177]
  v_pk_mul_f32 v[106:107], v[178:179], v[178:179]
  v_pk_fma_f32 v[104:105], v[104:105], v[56:57], v[56:57] op_sel:[0,1,0] op_sel_hi:[1,1,0]
  v_pk_fma_f32 v[106:107], v[106:107], v[56:57], v[56:57] op_sel:[0,1,0] op_sel_hi:[1,1,0]
  v_pk_mul_f32 v[104:105], v[104:105], v[176:177]
  v_pk_mul_f32 v[106:107], v[106:107], v[178:179]
  v_mfma_f32_16x16x16_bf16 v[164:167], v[36:37], v[48:49], v[164:167]
  v_exp_f32 v104, v104
  v_exp_f32 v105, v105
  v_exp_f32 v106, v106
  v_exp_f32 v107, v107
  v_pk_fma_f32 v[104:105], v[104:105], v[58:59], v[58:59] op_sel_hi:[1,0,0]
  v_pk_fma_f32 v[106:107], v[106:107], v[58:59], v[58:59] op_sel_hi:[1,0,0]
  v_rcp_f32 v104, v104
  v_rcp_f32 v105, v105
  v_rcp_f32 v106, v106
  v_rcp_f32 v107, v107
  v_pk_mul_f32 v[176:177], v[176:177], v[104:105]
  v_pk_mul_f32 v[178:179], v[178:179], v[106:107]
  v_cvt_pk_bf16_f32 v118, v176, v177
  v_cvt_pk_bf16_f32 v119, v178, v179
  s_add_u32 s3, s10, 49152
  buffer_store_dwordx4 v[116:119], v12, s[44:47], s3 offen sc1
  ds_write_b128 v18, v[116:119] offset:0
  v_pk_mul_f32 v[100:101], v[164:165], v[164:165]
  v_pk_mul_f32 v[102:103], v[166:167], v[166:167]
  v_pk_fma_f32 v[100:101], v[100:101], v[60:61], v[60:61] op_sel:[0,1,0] op_sel_hi:[1,1,0]
  v_pk_fma_f32 v[102:103], v[102:103], v[60:61], v[60:61] op_sel:[0,1,0] op_sel_hi:[1,1,0]
  v_pk_mul_f32 v[100:101], v[100:101], v[164:165]
  v_pk_mul_f32 v[102:103], v[102:103], v[166:167]
  v_mfma_f32_16x16x16_bf16 v[180:183], v[38:39], v[48:49], v[180:183]
  v_exp_f32 v100, v100
  v_exp_f32 v101, v101
  v_exp_f32 v102, v102
  v_exp_f32 v103, v103
  v_pk_fma_f32 v[100:101], v[100:101], v[62:63], v[62:63] op_sel_hi:[1,0,0]
  v_pk_fma_f32 v[102:103], v[102:103], v[62:63], v[62:63] op_sel_hi:[1,0,0]
  v_rcp_f32 v100, v100
  v_rcp_f32 v101, v101
  v_rcp_f32 v102, v102
  v_rcp_f32 v103, v103
  v_pk_mul_f32 v[164:165], v[164:165], v[100:101]
  v_pk_mul_f32 v[166:167], v[166:167], v[102:103]
  v_cvt_pk_bf16_f32 v120, v164, v165
  v_cvt_pk_bf16_f32 v121, v166, v167
  v_pk_mul_f32 v[104:105], v[180:181], v[180:181]
  v_pk_mul_f32 v[106:107], v[182:183], v[182:183]
  v_pk_fma_f32 v[104:105], v[104:105], v[60:61], v[60:61] op_sel:[0,1,0] op_sel_hi:[1,1,0]
  v_pk_fma_f32 v[106:107], v[106:107], v[60:61], v[60:61] op_sel:[0,1,0] op_sel_hi:[1,1,0]
  v_pk_mul_f32 v[104:105], v[104:105], v[180:181]
  v_pk_mul_f32 v[106:107], v[106:107], v[182:183]
  v_mfma_f32_16x16x16_bf16 v[168:171], v[36:37], v[50:51], v[168:171]
  v_exp_f32 v104, v104
  v_exp_f32 v105, v105
  v_exp_f32 v106, v106
  v_exp_f32 v107, v107
  v_pk_fma_f32 v[104:105], v[104:105], v[62:63], v[62:63] op_sel_hi:[1,0,0]
  v_pk_fma_f32 v[106:107], v[106:107], v[62:63], v[62:63] op_sel_hi:[1,0,0]
  v_rcp_f32 v104, v104
  v_rcp_f32 v105, v105
  v_rcp_f32 v106, v106
  v_rcp_f32 v107, v107
  v_pk_mul_f32 v[180:181], v[180:181], v[104:105]
  v_pk_mul_f32 v[182:183], v[182:183], v[106:107]
  v_cvt_pk_bf16_f32 v122, v180, v181
  v_cvt_pk_bf16_f32 v123, v182, v183
  s_add_u32 s3, s10, 163840
  buffer_store_dwordx4 v[120:123], v12, s[44:47], s3 offen sc1
  ds_write_b128 v18, v[120:123] offset:2048
  v_pk_mul_f32 v[100:101], v[168:169], v[168:169]
  v_pk_mul_f32 v[102:103], v[170:171], v[170:171]
  v_pk_fma_f32 v[100:101], v[100:101], v[64:65], v[64:65] op_sel:[0,1,0] op_sel_hi:[1,1,0]
  v_pk_fma_f32 v[102:103], v[102:103], v[64:65], v[64:65] op_sel:[0,1,0] op_sel_hi:[1,1,0]
  v_pk_mul_f32 v[100:101], v[100:101], v[168:169]
  v_pk_mul_f32 v[102:103], v[102:103], v[170:171]
  v_mfma_f32_16x16x16_bf16 v[184:187], v[38:39], v[50:51], v[184:187]
  v_exp_f32 v100, v100
  v_exp_f32 v101, v101
  v_exp_f32 v102, v102
  v_exp_f32 v103, v103
  v_pk_fma_f32 v[100:101], v[100:101], v[66:67], v[66:67] op_sel_hi:[1,0,0]
  v_pk_fma_f32 v[102:103], v[102:103], v[66:67], v[66:67] op_sel_hi:[1,0,0]
  v_rcp_f32 v100, v100
  v_rcp_f32 v101, v101
  v_rcp_f32 v102, v102
  v_rcp_f32 v103, v103
  v_pk_mul_f32 v[168:169], v[168:169], v[100:101]
  v_pk_mul_f32 v[170:171], v[170:171], v[102:103]
  v_cvt_pk_bf16_f32 v108, v168, v169
  v_cvt_pk_bf16_f32 v109, v170, v171
  v_pk_mul_f32 v[104:105], v[184:185], v[184:185]
  v_pk_mul_f32 v[106:107], v[186:187], v[186:187]
  v_pk_fma_f32 v[104:105], v[104:105], v[64:65], v[64:65] op_sel:[0,1,0] op_sel_hi:[1,1,0]
  v_pk_fma_f32 v[106:107], v[106:107], v[64:65], v[64:65] op_sel:[0,1,0] op_sel_hi:[1,1,0]
  v_pk_mul_f32 v[104:105], v[104:105], v[184:185]
  v_pk_mul_f32 v[106:107], v[106:107], v[186:187]
  v_mfma_f32_16x16x16_bf16 v[172:175], v[36:37], v[52:53], v[172:175]
  v_exp_f32 v104, v104
  v_exp_f32 v105, v105
  v_exp_f32 v106, v106
  v_exp_f32 v107, v107
  v_pk_fma_f32 v[104:105], v[104:105], v[66:67], v[66:67] op_sel_hi:[1,0,0]
  v_pk_fma_f32 v[106:107], v[106:107], v[66:67], v[66:67] op_sel_hi:[1,0,0]
  v_rcp_f32 v104, v104
  v_rcp_f32 v105, v105
  v_rcp_f32 v106, v106
  v_rcp_f32 v107, v107
  v_pk_mul_f32 v[184:185], v[184:185], v[104:105]
  v_pk_mul_f32 v[186:187], v[186:187], v[106:107]
  v_cvt_pk_bf16_f32 v110, v184, v185
  v_cvt_pk_bf16_f32 v111, v186, v187
  s_add_u32 s3, s10, 278528
  buffer_store_dwordx4 v[108:111], v12, s[44:47], s3 offen sc1
  ds_write_b128 v18, v[108:111] offset:4096
  v_pk_mul_f32 v[100:101], v[172:173], v[172:173]
  v_pk_mul_f32 v[102:103], v[174:175], v[174:175]
  v_pk_fma_f32 v[100:101], v[100:101], v[68:69], v[68:69] op_sel:[0,1,0] op_sel_hi:[1,1,0]
  v_pk_fma_f32 v[102:103], v[102:103], v[68:69], v[68:69] op_sel:[0,1,0] op_sel_hi:[1,1,0]
  v_pk_mul_f32 v[100:101], v[100:101], v[172:173]
  v_pk_mul_f32 v[102:103], v[102:103], v[174:175]
  v_mfma_f32_16x16x16_bf16 v[188:191], v[38:39], v[52:53], v[188:191]
  v_exp_f32 v100, v100
  v_exp_f32 v101, v101
  v_exp_f32 v102, v102
  v_exp_f32 v103, v103
  v_pk_fma_f32 v[100:101], v[100:101], v[70:71], v[70:71] op_sel_hi:[1,0,0]
  v_pk_fma_f32 v[102:103], v[102:103], v[70:71], v[70:71] op_sel_hi:[1,0,0]
  v_rcp_f32 v100, v100
  v_rcp_f32 v101, v101
  v_rcp_f32 v102, v102
  v_rcp_f32 v103, v103
  v_pk_mul_f32 v[172:173], v[172:173], v[100:101]
  v_pk_mul_f32 v[174:175], v[174:175], v[102:103]
  v_cvt_pk_bf16_f32 v112, v172, v173
  v_cvt_pk_bf16_f32 v113, v174, v175
  v_pk_mul_f32 v[104:105], v[188:189], v[188:189]
  v_pk_mul_f32 v[106:107], v[190:191], v[190:191]
  v_pk_fma_f32 v[104:105], v[104:105], v[68:69], v[68:69] op_sel:[0,1,0] op_sel_hi:[1,1,0]
  v_pk_fma_f32 v[106:107], v[106:107], v[68:69], v[68:69] op_sel:[0,1,0] op_sel_hi:[1,1,0]
  v_pk_mul_f32 v[104:105], v[104:105], v[188:189]
  v_pk_mul_f32 v[106:107], v[106:107], v[190:191]
  v_mfma_f32_16x16x16_bf16 v[192:195], v[40:41], v[46:47], v[192:195]
  v_exp_f32 v104, v104
  v_exp_f32 v105, v105
  v_exp_f32 v106, v106
  v_exp_f32 v107, v107
  v_pk_fma_f32 v[104:105], v[104:105], v[70:71], v[70:71] op_sel_hi:[1,0,0]
  v_pk_fma_f32 v[106:107], v[106:107], v[70:71], v[70:71] op_sel_hi:[1,0,0]
  v_rcp_f32 v104, v104
  v_rcp_f32 v105, v105
  v_rcp_f32 v106, v106
  v_rcp_f32 v107, v107
  v_pk_mul_f32 v[188:189], v[188:189], v[104:105]
  v_pk_mul_f32 v[190:191], v[190:191], v[106:107]
  v_cvt_pk_bf16_f32 v114, v188, v189
  v_cvt_pk_bf16_f32 v115, v190, v191
  s_add_u32 s3, s10, 393216
  buffer_store_dwordx4 v[112:115], v12, s[44:47], s3 offen sc1
  ds_write_b128 v18, v[112:115] offset:6144
  v_pk_mul_f32 v[100:101], v[192:193], v[192:193]
  v_pk_mul_f32 v[102:103], v[194:195], v[194:195]
  v_pk_fma_f32 v[100:101], v[100:101], v[56:57], v[56:57] op_sel:[0,1,0] op_sel_hi:[1,1,0]
  v_pk_fma_f32 v[102:103], v[102:103], v[56:57], v[56:57] op_sel:[0,1,0] op_sel_hi:[1,1,0]
  v_pk_mul_f32 v[100:101], v[100:101], v[192:193]
  v_pk_mul_f32 v[102:103], v[102:103], v[194:195]
  v_mfma_f32_16x16x16_bf16 v[208:211], v[42:43], v[46:47], v[208:211]
  v_exp_f32 v100, v100
  v_exp_f32 v101, v101
  v_exp_f32 v102, v102
  v_exp_f32 v103, v103
  v_pk_fma_f32 v[100:101], v[100:101], v[58:59], v[58:59] op_sel_hi:[1,0,0]
  v_pk_fma_f32 v[102:103], v[102:103], v[58:59], v[58:59] op_sel_hi:[1,0,0]
  v_rcp_f32 v100, v100
  v_rcp_f32 v101, v101
  v_rcp_f32 v102, v102
  v_rcp_f32 v103, v103
  v_pk_mul_f32 v[192:193], v[192:193], v[100:101]
  v_pk_mul_f32 v[194:195], v[194:195], v[102:103]
  v_cvt_pk_bf16_f32 v116, v192, v193
  v_cvt_pk_bf16_f32 v117, v194, v195
  v_pk_mul_f32 v[104:105], v[208:209], v[208:209]
  v_pk_mul_f32 v[106:107], v[210:211], v[210:211]
  v_pk_fma_f32 v[104:105], v[104:105], v[56:57], v[56:57] op_sel:[0,1,0] op_sel_hi:[1,1,0]
  v_pk_fma_f32 v[106:107], v[106:107], v[56:57], v[56:57] op_sel:[0,1,0] op_sel_hi:[1,1,0]
  v_pk_mul_f32 v[104:105], v[104:105], v[208:209]
  v_pk_mul_f32 v[106:107], v[106:107], v[210:211]
  v_mfma_f32_16x16x16_bf16 v[196:199], v[40:41], v[48:49], v[196:199]
  v_exp_f32 v104, v104
  v_exp_f32 v105, v105
  v_exp_f32 v106, v106
  v_exp_f32 v107, v107
  v_pk_fma_f32 v[104:105], v[104:105], v[58:59], v[58:59] op_sel_hi:[1,0,0]
  v_pk_fma_f32 v[106:107], v[106:107], v[58:59], v[58:59] op_sel_hi:[1,0,0]
  v_rcp_f32 v104, v104
  v_rcp_f32 v105, v105
  v_rcp_f32 v106, v106
  v_rcp_f32 v107, v107
  v_pk_mul_f32 v[208:209], v[208:209], v[104:105]
  v_pk_mul_f32 v[210:211], v[210:211], v[106:107]
  v_cvt_pk_bf16_f32 v118, v208, v209
  v_cvt_pk_bf16_f32 v119, v210, v211
  s_add_u32 s3, s10, 51200
  buffer_store_dwordx4 v[116:119], v12, s[44:47], s3 offen
  ds_write_b128 v18, v[116:119] offset:16384
  v_pk_mul_f32 v[100:101], v[196:197], v[196:197]
  v_pk_mul_f32 v[102:103], v[198:199], v[198:199]
  v_pk_fma_f32 v[100:101], v[100:101], v[60:61], v[60:61] op_sel:[0,1,0] op_sel_hi:[1,1,0]
  v_pk_fma_f32 v[102:103], v[102:103], v[60:61], v[60:61] op_sel:[0,1,0] op_sel_hi:[1,1,0]
  v_pk_mul_f32 v[100:101], v[100:101], v[196:197]
  v_pk_mul_f32 v[102:103], v[102:103], v[198:199]
  v_mfma_f32_16x16x16_bf16 v[212:215], v[42:43], v[48:49], v[212:215]
  v_exp_f32 v100, v100
  v_exp_f32 v101, v101
  v_exp_f32 v102, v102
  v_exp_f32 v103, v103
  v_pk_fma_f32 v[100:101], v[100:101], v[62:63], v[62:63] op_sel_hi:[1,0,0]
  v_pk_fma_f32 v[102:103], v[102:103], v[62:63], v[62:63] op_sel_hi:[1,0,0]
  v_rcp_f32 v100, v100
  v_rcp_f32 v101, v101
  v_rcp_f32 v102, v102
  v_rcp_f32 v103, v103
  v_pk_mul_f32 v[196:197], v[196:197], v[100:101]
  v_pk_mul_f32 v[198:199], v[198:199], v[102:103]
  v_cvt_pk_bf16_f32 v120, v196, v197
  v_cvt_pk_bf16_f32 v121, v198, v199
  v_pk_mul_f32 v[104:105], v[212:213], v[212:213]
  v_pk_mul_f32 v[106:107], v[214:215], v[214:215]
  v_pk_fma_f32 v[104:105], v[104:105], v[60:61], v[60:61] op_sel:[0,1,0] op_sel_hi:[1,1,0]
  v_pk_fma_f32 v[106:107], v[106:107], v[60:61], v[60:61] op_sel:[0,1,0] op_sel_hi:[1,1,0]
  v_pk_mul_f32 v[104:105], v[104:105], v[212:213]
  v_pk_mul_f32 v[106:107], v[106:107], v[214:215]
  v_mfma_f32_16x16x16_bf16 v[200:203], v[40:41], v[50:51], v[200:203]
  v_exp_f32 v104, v104
  v_exp_f32 v105, v105
  v_exp_f32 v106, v106
  v_exp_f32 v107, v107
  v_pk_fma_f32 v[104:105], v[104:105], v[62:63], v[62:63] op_sel_hi:[1,0,0]
  v_pk_fma_f32 v[106:107], v[106:107], v[62:63], v[62:63] op_sel_hi:[1,0,0]
  v_rcp_f32 v104, v104
  v_rcp_f32 v105, v105
  v_rcp_f32 v106, v106
  v_rcp_f32 v107, v107
  v_pk_mul_f32 v[212:213], v[212:213], v[104:105]
  v_pk_mul_f32 v[214:215], v[214:215], v[106:107]
  v_cvt_pk_bf16_f32 v122, v212, v213
  v_cvt_pk_bf16_f32 v123, v214, v215
  s_add_u32 s3, s10, 165888
  buffer_store_dwordx4 v[120:123], v12, s[44:47], s3 offen
  ds_write_b128 v18, v[120:123] offset:18432
  v_pk_mul_f32 v[100:101], v[200:201], v[200:201]
  v_pk_mul_f32 v[102:103], v[202:203], v[202:203]
  v_pk_fma_f32 v[100:101], v[100:101], v[64:65], v[64:65] op_sel:[0,1,0] op_sel_hi:[1,1,0]
  v_pk_fma_f32 v[102:103], v[102:103], v[64:65], v[64:65] op_sel:[0,1,0] op_sel_hi:[1,1,0]
  v_pk_mul_f32 v[100:101], v[100:101], v[200:201]
  v_pk_mul_f32 v[102:103], v[102:103], v[202:203]
  v_mfma_f32_16x16x16_bf16 v[216:219], v[42:43], v[50:51], v[216:219]
  v_exp_f32 v100, v100
  v_exp_f32 v101, v101
  v_exp_f32 v102, v102
  v_exp_f32 v103, v103
  v_pk_fma_f32 v[100:101], v[100:101], v[66:67], v[66:67] op_sel_hi:[1,0,0]
  v_pk_fma_f32 v[102:103], v[102:103], v[66:67], v[66:67] op_sel_hi:[1,0,0]
  v_rcp_f32 v100, v100
  v_rcp_f32 v101, v101
  v_rcp_f32 v102, v102
  v_rcp_f32 v103, v103
  v_pk_mul_f32 v[200:201], v[200:201], v[100:101]
  v_pk_mul_f32 v[202:203], v[202:203], v[102:103]
  v_cvt_pk_bf16_f32 v108, v200, v201
  v_cvt_pk_bf16_f32 v109, v202, v203
  v_pk_mul_f32 v[104:105], v[216:217], v[216:217]
  v_pk_mul_f32 v[106:107], v[218:219], v[218:219]
  v_pk_fma_f32 v[104:105], v[104:105], v[64:65], v[64:65] op_sel:[0,1,0] op_sel_hi:[1,1,0]
  v_pk_fma_f32 v[106:107], v[106:107], v[64:65], v[64:65] op_sel:[0,1,0] op_sel_hi:[1,1,0]
  v_pk_mul_f32 v[104:105], v[104:105], v[216:217]
  v_pk_mul_f32 v[106:107], v[106:107], v[218:219]
  v_mfma_f32_16x16x16_bf16 v[204:207], v[40:41], v[52:53], v[204:207]
  v_exp_f32 v104, v104
  v_exp_f32 v105, v105
  v_exp_f32 v106, v106
  v_exp_f32 v107, v107
  v_pk_fma_f32 v[104:105], v[104:105], v[66:67], v[66:67] op_sel_hi:[1,0,0]
  v_pk_fma_f32 v[106:107], v[106:107], v[66:67], v[66:67] op_sel_hi:[1,0,0]
  v_rcp_f32 v104, v104
  v_rcp_f32 v105, v105
  v_rcp_f32 v106, v106
  v_rcp_f32 v107, v107
  v_pk_mul_f32 v[216:217], v[216:217], v[104:105]
  v_pk_mul_f32 v[218:219], v[218:219], v[106:107]
  v_cvt_pk_bf16_f32 v110, v216, v217
  v_cvt_pk_bf16_f32 v111, v218, v219
  s_add_u32 s3, s10, 280576
  buffer_store_dwordx4 v[108:111], v12, s[44:47], s3 offen
  ds_write_b128 v18, v[108:111] offset:20480
  v_pk_mul_f32 v[100:101], v[204:205], v[204:205]
  v_pk_mul_f32 v[102:103], v[206:207], v[206:207]
  v_pk_fma_f32 v[100:101], v[100:101], v[68:69], v[68:69] op_sel:[0,1,0] op_sel_hi:[1,1,0]
  v_pk_fma_f32 v[102:103], v[102:103], v[68:69], v[68:69] op_sel:[0,1,0] op_sel_hi:[1,1,0]
  v_pk_mul_f32 v[100:101], v[100:101], v[204:205]
  v_pk_mul_f32 v[102:103], v[102:103], v[206:207]
  v_mfma_f32_16x16x16_bf16 v[220:223], v[42:43], v[52:53], v[220:223]
  v_exp_f32 v100, v100
  v_exp_f32 v101, v101
  v_exp_f32 v102, v102
  v_exp_f32 v103, v103
  v_pk_fma_f32 v[100:101], v[100:101], v[70:71], v[70:71] op_sel_hi:[1,0,0]
  v_pk_fma_f32 v[102:103], v[102:103], v[70:71], v[70:71] op_sel_hi:[1,0,0]
  v_rcp_f32 v100, v100
  v_rcp_f32 v101, v101
  v_rcp_f32 v102, v102
  v_rcp_f32 v103, v103
  v_pk_mul_f32 v[204:205], v[204:205], v[100:101]
  v_pk_mul_f32 v[206:207], v[206:207], v[102:103]
  v_cvt_pk_bf16_f32 v112, v204, v205
  v_cvt_pk_bf16_f32 v113, v206, v207
  v_pk_mul_f32 v[104:105], v[220:221], v[220:221]
  v_pk_mul_f32 v[106:107], v[222:223], v[222:223]
  v_pk_fma_f32 v[104:105], v[104:105], v[68:69], v[68:69] op_sel:[0,1,0] op_sel_hi:[1,1,0]
  v_pk_fma_f32 v[106:107], v[106:107], v[68:69], v[68:69] op_sel:[0,1,0] op_sel_hi:[1,1,0]
  v_pk_mul_f32 v[104:105], v[104:105], v[220:221]
  v_pk_mul_f32 v[106:107], v[106:107], v[222:223]
  v_exp_f32 v104, v104
  v_exp_f32 v105, v105
  v_exp_f32 v106, v106
  v_exp_f32 v107, v107
  v_pk_fma_f32 v[104:105], v[104:105], v[70:71], v[70:71] op_sel_hi:[1,0,0]
  v_pk_fma_f32 v[106:107], v[106:107], v[70:71], v[70:71] op_sel_hi:[1,0,0]
  v_rcp_f32 v104, v104
  v_rcp_f32 v105, v105
  v_rcp_f32 v106, v106
  v_rcp_f32 v107, v107
  v_pk_mul_f32 v[220:221], v[220:221], v[104:105]
  v_pk_mul_f32 v[222:223], v[222:223], v[106:107]
  v_cvt_pk_bf16_f32 v114, v220, v221
  v_cvt_pk_bf16_f32 v115, v222, v223
  s_add_u32 s3, s10, 395264
  buffer_store_dwordx4 v[112:115], v12, s[44:47], s3 offen
  ds_write_b128 v18, v[112:115] offset:22528
  v_add_u32 v2, 114688, v27
  v_mov_b32 v6, v8
  v_xor_b32 v7, 32, v8
  v_xor_b32 v9, 96, v8
  v_xor_b32 v8, 64, v8
  s_waitcnt vmcnt(14)
  v_lshlrev_b32 v216, 16, v10
  v_and_b32 v217, s11, v10
  v_lshlrev_b32 v218, 16, v11
  v_and_b32 v219, s11, v11
  v_lshlrev_b32 v96, 16, v240
  v_and_b32 v97, s11, v240
  v_pk_add_f32 v[96:97], v[96:97], v[216:217]
  v_lshlrev_b32 v98, 16, v241
  v_and_b32 v99, s11, v241
  v_pk_add_f32 v[98:99], v[98:99], v[218:219]
  v_lshlrev_b32 v100, 16, v248
  v_and_b32 v101, s11, v248
  v_pk_add_f32 v[100:101], v[100:101], v[216:217]
  v_lshlrev_b32 v102, 16, v249
  v_and_b32 v103, s11, v249
  v_pk_add_f32 v[102:103], v[102:103], v[218:219]
  v_lshlrev_b32 v216, 16, v24
  v_and_b32 v217, s11, v24
  v_lshlrev_b32 v218, 16, v25
  v_and_b32 v219, s11, v25
  v_lshlrev_b32 v104, 16, v242
  v_and_b32 v105, s11, v242
  v_pk_add_f32 v[104:105], v[104:105], v[216:217]
  v_lshlrev_b32 v106, 16, v243
  v_and_b32 v107, s11, v243
  v_pk_add_f32 v[106:107], v[106:107], v[218:219]
  v_lshlrev_b32 v108, 16, v250
  v_and_b32 v109, s11, v250
  v_pk_add_f32 v[108:109], v[108:109], v[216:217]
  v_lshlrev_b32 v110, 16, v251
  v_and_b32 v111, s11, v251
  v_pk_add_f32 v[110:111], v[110:111], v[218:219]
  v_lshlrev_b32 v216, 16, v124
  v_and_b32 v217, s11, v124
  v_lshlrev_b32 v218, 16, v125
  v_and_b32 v219, s11, v125
  v_lshlrev_b32 v112, 16, v244
  v_and_b32 v113, s11, v244
  v_pk_add_f32 v[112:113], v[112:113], v[216:217]
  v_lshlrev_b32 v114, 16, v245
  v_and_b32 v115, s11, v245
  v_pk_add_f32 v[114:115], v[114:115], v[218:219]
  v_lshlrev_b32 v116, 16, v252
  v_and_b32 v117, s11, v252
  v_pk_add_f32 v[116:117], v[116:117], v[216:217]
  v_lshlrev_b32 v118, 16, v253
  v_and_b32 v119, s11, v253
  v_pk_add_f32 v[118:119], v[118:119], v[218:219]
  v_lshlrev_b32 v216, 16, v126
  v_and_b32 v217, s11, v126
  v_lshlrev_b32 v218, 16, v127
  v_and_b32 v219, s11, v127
  v_lshlrev_b32 v120, 16, v246
  v_and_b32 v121, s11, v246
  v_pk_add_f32 v[120:121], v[120:121], v[216:217]
  v_lshlrev_b32 v122, 16, v247
  v_and_b32 v123, s11, v247
  v_pk_add_f32 v[122:123], v[122:123], v[218:219]
  v_lshlrev_b32 v124, 16, v254
  v_and_b32 v125, s11, v254
  v_pk_add_f32 v[124:125], v[124:125], v[216:217]
  v_lshlrev_b32 v126, 16, v255
  v_and_b32 v127, s11, v255
  v_pk_add_f32 v[126:127], v[126:127], v[218:219]
  s_waitcnt vmcnt(0) lgkmcnt(0)
  s_barrier
  s_add_u32 s97, s97, 1
  s_branch L_w2_compute
L_w1_c1:
L_w2_c0:
L_w2_body:
  s_cmp_ge_u32 s2, 256
  s_cbranch_scc1 L_w2_end
  v_lshrrev_b32 v2, 6, v0
  v_and_b32 v1, 63, v0
  v_readfirstlane_b32 s70, v2
  s_and_b32 s3, s2, 7
  s_lshr_b32 s99, s2, 3
  s_and_b32 s5, s3, 3
  s_lshl_b32 s5, s5, 2
  s_and_b32 s6, s99, 3
  s_add_u32 s68, s5, s6
  s_lshr_b32 s5, s3, 2
  s_lshr_b32 s78, s99, 2
  s_lshl1_add_u32 s69, s78, s5
  s_add_u32 s3, s68, s78
  s_lshl_b32 s3, s3, 3
  s_lshl_b32 s85, 0xffff02, s3
  s_sub_u32 s3, 0, s3
  s_lshr_b32 s3, 0xffff02, s3
  s_or_b32 s85, s85, s3
L_w2_loader:
  s_add_u32 s3, s68, s78
  s_and_b32 s3, s3, 3
  s_mov_b32 s4, 0x1616160
  s_cmp_eq_u32 s3, 1
  s_cselect_b32 s4, 0x5858580, s4
  s_cmp_eq_u32 s3, 2
  s_cselect_b32 s4, 0x16161600, s4
  s_cmp_eq_u32 s3, 3
  s_cselect_b32 s4, 0x58585800, s4
  v_subrev_u32 v2, 3, v1
  v_min_u32 v2, 16, v2
  v_lshlrev_b32 v3, 1, v2
  v_bfe_i32 v16, s4, v3, 2
  v_sub_u32 v16, v1, v16
  v_subrev_u32 v16, 7, v16
  v_ashrrev_i32 v3, 1, v16
  v_cmp_eq_u32 vcc, s78, v3
  s_and_b32 s3, s69, 1
  v_or_b32 v2, 14, v16
  v_cndmask_b32 v2, v16, v2, vcc
  v_cmp_gt_i32 vcc, 0, v16
  s_lshl2_add_u32 s4, s3, 20
  v_add_u32 v16, s4, v16
  s_lshl4_add_u32 s4, s3, 24
  v_add_u32 v2, s4, v2
  v_cndmask_b32 v16, v2, v16, vcc
  s_and_b32 s5, s68, 3
  s_mul_i32 s5, s5, 3
  s_sub_u32 s5, s5, 23
  v_add_u32 v3, s5, v1
  v_subrev_u32 v2, 10, v3
  v_min_u32 v3, v3, v2
  v_subrev_u32 v2, 10, v3
  v_min_u32 v3, v3, v2
  v_cmp_gt_u32 vcc, 23, v1
  s_sub_u32 s5, s3, 46
  v_lshl_add_u32 v2, v1, 1, s5
  v_cndmask_b32 v3, v3, v2, vcc
  s_add_u32 s5, s78, 3
  v_ashrrev_i32 v2, 1, v3
  v_add_u32 v2, s5, v2
  v_and_b32 v2, 7, v2
  v_and_b32 v3, 1, v3
  v_cmp_gt_u32 vcc, 21, v1
  v_lshl_add_u32 v3, v3, 3, v2
  s_lshl1_add_u32 s4, s78, s4
  s_lshl3_add_u32 s3, s3, s78
  v_cndmask_b32 v3, v3, v16, vcc
  v_writelane_b32 v3, s4, 0
  s_add_u32 s4, s4, 1
  v_writelane_b32 v3, s3, 2
  v_writelane_b32 v3, s4, 1
  v_lshlrev_b32 v16, 17, v3
  s_add_u32 s9, s70, s68
  s_and_b32 s9, s9, 3
  s_lshl_b32 s77, s9, 11
  v_and_b32 v10, 7, v1
  v_lshrrev_b32 v3, 3, v1
  s_lshl_b32 s10, s9, 4
  v_add_u32 v3, s10, v3
  v_mul_u32_u24 v3, 2048, v3
  v_lshrrev_b32 v2, 3, v1
  v_and_b32 v2, 6, v2
  v_xor_b32 v2, v2, v10
  s_lshl_b32 s10, s69, 7
  v_add_u32 v3, s10, v3
  v_lshl_add_u32 v8, v2, 4, v3
  v_add_u32 v3, 16384, v3
  v_lshl_add_u32 v9, v2, 4, v3
  s_mov_b32 s40, s28
  s_and_b32 s41, s29, 0xffff
  s_mov_b32 s42, 7340032
  s_mov_b32 s43, 0x00020000
  s_bitcmp1_b32 s69, 0
  s_mov_b32 s76, 128
  s_cselect_b32 s76, -128, s76
  v_readlane_b32 s74, v16, 0
  s_add_u32 m0, s77, 0
  s_add_u32 s4, s74, s76
  buffer_load_dwordx4 v8, s[40:43], s4 offen lds
  s_add_u32 m0, s77, 1024
  s_nop 0
  buffer_load_dwordx4 v9, s[40:43], s4 offen lds
  s_add_u32 m0, s77, 8192
  s_add_u32 s4, s74, 0
  buffer_load_dwordx4 v8, s[40:43], s4 offen lds
  s_add_u32 m0, s77, 9216
  s_nop 0
  buffer_load_dwordx4 v9, s[40:43], s4 offen lds
  v_readlane_b32 s74, v16, 1
  s_add_u32 m0, s77, 16384
  s_add_u32 s4, s74, s76
  buffer_load_dwordx4 v8, s[40:43], s4 offen lds
  s_add_u32 m0, s77, 17408
  s_nop 0
  buffer_load_dwordx4 v9, s[40:43], s4 offen lds
  s_add_u32 m0, s77, 24576
  s_add_u32 s4, s74, 0
  buffer_load_dwordx4 v8, s[40:43], s4 offen lds
  s_add_u32 m0, s77, 25600
  s_nop 0
  buffer_load_dwordx4 v9, s[40:43], s4 offen lds
  v_readlane_b32 s74, v16, 2
  s_add_u32 m0, s77, 32768
  s_add_u32 s4, s74, s76
  buffer_load_dwordx4 v8, s[40:43], s4 offen lds
  s_add_u32 m0, s77, 33792
  s_nop 0
  buffer_load_dwordx4 v9, s[40:43], s4 offen lds
  s_add_u32 m0, s77, 40960
  s_add_u32 s4, s74, 0
  buffer_load_dwordx4 v8, s[40:43], s4 offen lds
  s_add_u32 m0, s77, 41984
  s_nop 0
  buffer_load_dwordx4 v9, s[40:43], s4 offen lds
  v_readlane_b32 s74, v16, 3
  s_add_u32 m0, s77, 49152
  s_add_u32 s4, s74, s76
  buffer_load_dwordx4 v8, s[40:43], s4 offen lds
  s_add_u32 m0, s77, 50176
  s_nop 0
  buffer_load_dwordx4 v9, s[40:43], s4 offen lds
  s_add_u32 m0, s77, 57344
  s_add_u32 s4, s74, 0
  buffer_load_dwordx4 v8, s[40:43], s4 offen lds
  s_add_u32 m0, s77, 58368
  s_nop 0
  buffer_load_dwordx4 v9, s[40:43], s4 offen lds
  v_readlane_b32 s74, v16, 4
  s_add_u32 m0, s77, 65536
  s_add_u32 s4, s74, s76
  buffer_load_dwordx4 v8, s[40:43], s4 offen lds
  s_add_u32 m0, s77, 66560
  s_nop 0
  buffer_load_dwordx4 v9, s[40:43], s4 offen lds
  s_add_u32 m0, s77, 73728
  s_add_u32 s4, s74, 0
  buffer_load_dwordx4 v8, s[40:43], s4 offen lds
  s_add_u32 m0, s77, 74752
  s_nop 0
  buffer_load_dwordx4 v9, s[40:43], s4 offen lds
  s_add_u32 s44, s22, 41943040
  s_addc_u32 s45, s23, 0
  s_and_b32 s45, s45, 0xffff
  s_mov_b32 s46, 524288
  s_mov_b32 s47, 0x00020000
  s_lshl4_add_u32 s3, s97, s68
  s_and_b32 s4, s69, 15
  s_lshl4_add_u32 s3, s3, s4
  s_lshl_b32 s3, s3, 7
  s_sub_u32 s86, s3, 32768
  v_lshlrev_b32 v11, 7, v1
  v_and_b32 v2, 15, v1
  v_lshlrev_b32 v2, 2, v2
  s_cmp_lg_u32 s70, 4
  s_waitcnt vmcnt(14)
  s_cbranch_scc1 L_w2_nofl
  v_readlane_b32 s74, v16, 5
  s_add_u32 m0, s77, 81920
  s_add_u32 s4, s74, s76
  buffer_load_dwordx4 v8, s[40:43], s4 offen lds
  s_add_u32 m0, s77, 82944
  s_nop 0
  buffer_load_dwordx4 v9, s[40:43], s4 offen lds
  s_add_u32 m0, s77, 90112
  s_add_u32 s4, s74, 0
  buffer_load_dwordx4 v8, s[40:43], s4 offen lds
  s_add_u32 m0, s77, 91136
  s_nop 0
  buffer_load_dwordx4 v9, s[40:43], s4 offen lds
  v_readlane_b32 s74, v16, 6
  s_add_u32 m0, s77, 98304
  s_add_u32 s4, s74, s76
  buffer_load_dwordx4 v8, s[40:43], s4 offen lds
  s_add_u32 m0, s77, 99328
  s_nop 0
  buffer_load_dwordx4 v9, s[40:43], s4 offen lds
  v_mov_b32 v3, 1
  s_mov_b32 s79, 0x100000
  s_or_b32 s4, s2, 0xe0
  s_lshl4_add_u32 s4, s4, s97
  s_lshl_b32 s4, s4, 7
  s_lshl2_add_u32 s5, s78, s4
  s_cmp_eq_u32 s92, 0
  s_cselect_b32 s3, s4, s86
  s_cselect_b32 s4, 28, 60
  v_and_b32 v13, s4, v2
  buffer_load_dword v12, v13, s[44:47], s3 offen sc1
  s_setprio 3
  s_barrier
  s_cbranch_scc0 L_w2_wb
L_w2_wbd:
  s_mov_b64 exec, 1
  buffer_store_dword v3, off, s[44:47], s5
  s_mov_b64 exec, -1
L_w2_poll:
  buffer_load_dword v12, v13, s[44:47], s3 offen sc1
  s_sub_u32 s79, s79, 1
  s_cbranch_scc1 L_w2_dep
  s_waitcnt vmcnt(0)
  v_cmp_ne_u32 vcc, 1, v12
  s_cbranch_vccnz L_w2_poll
L_w2_dep:
  s_barrier
  s_setprio 0
  s_mov_b64 exec, 0xffff
  buffer_store_dword v3, v11, s[44:47], s87 offen sc1
  s_mov_b64 exec, -1
  s_branch L_w2_go
L_w2_nofl:
  s_barrier
  v_readlane_b32 s74, v16, 5
  s_add_u32 m0, s77, 81920
  s_add_u32 s4, s74, s76
  buffer_load_dwordx4 v8, s[40:43], s4 offen lds
  s_add_u32 m0, s77, 82944
  s_nop 0
  buffer_load_dwordx4 v9, s[40:43], s4 offen lds
  s_add_u32 m0, s77, 90112
  s_add_u32 s4, s74, 0
  buffer_load_dwordx4 v8, s[40:43], s4 offen lds
  s_add_u32 m0, s77, 91136
  s_nop 0
  buffer_load_dwordx4 v9, s[40:43], s4 offen lds
  v_readlane_b32 s74, v16, 6
  s_add_u32 m0, s77, 98304
  s_add_u32 s4, s74, s76
  buffer_load_dwordx4 v8, s[40:43], s4 offen lds
  s_add_u32 m0, s77, 99328
  s_nop 0
  buffer_load_dwordx4 v9, s[40:43], s4 offen lds
  s_waitcnt vmcnt(8)
  s_barrier
L_w2_go:
  s_add_u32 m0, s77, 106496
  s_add_u32 s4, s74, 0
  buffer_load_dwordx4 v8, s[40:43], s4 offen lds
  s_add_u32 m0, s77, 107520
  s_nop 0
  buffer_load_dwordx4 v9, s[40:43], s4 offen lds
  s_waitcnt vmcnt(4)
  v_readlane_b32 s74, v16, 7
  s_add_u32 m0, s77, 114688
  s_add_u32 s4, s74, s76
  buffer_load_dwordx4 v8, s[40:43], s4 offen lds
  s_add_u32 m0, s77, 115712
  s_nop 0
  buffer_load_dwordx4 v9, s[40:43], s4 offen lds
  s_waitcnt vmcnt(4)
  s_add_u32 m0, s77, 122880
  s_add_u32 s4, s74, 0
  buffer_load_dwordx4 v8, s[40:43], s4 offen lds
  s_add_u32 m0, s77, 123904
  s_nop 0
  buffer_load_dwordx4 v9, s[40:43], s4 offen lds
  s_waitcnt vmcnt(4)
  v_readlane_b32 s74, v16, 8
  s_add_u32 m0, s77, 131072
  s_add_u32 s4, s74, s76
  buffer_load_dwordx4 v8, s[40:43], s4 offen lds
  s_add_u32 m0, s77, 132096
  s_nop 0
  buffer_load_dwordx4 v9, s[40:43], s4 offen lds
  s_waitcnt vmcnt(4)
  s_add_u32 m0, s77, 139264
  s_add_u32 s4, s74, 0
  buffer_load_dwordx4 v8, s[40:43], s4 offen lds
  s_add_u32 m0, s77, 140288
  s_nop 0
  buffer_load_dwordx4 v9, s[40:43], s4 offen lds
  s_waitcnt vmcnt(4)
  v_readlane_b32 s74, v16, 9
  s_add_u32 m0, s77, 147456
  s_add_u32 s4, s74, s76
  buffer_load_dwordx4 v8, s[40:43], s4 offen lds
  s_add_u32 m0, s77, 148480
  s_nop 0
  buffer_load_dwordx4 v9, s[40:43], s4 offen lds
  s_waitcnt vmcnt(12)
  s_barrier
  s_add_u32 m0, s77, 155648
  s_add_u32 s4, s74, 0
  buffer_load_dwordx4 v8, s[40:43], s4 offen lds
  s_add_u32 m0, s77, 156672
  s_nop 0
  buffer_load_dwordx4 v9, s[40:43], s4 offen lds
  s_waitcnt vmcnt(4)
  v_readlane_b32 s74, v16, 10
  s_add_u32 m0, s77, 0
  s_add_u32 s4, s74, s76
  buffer_load_dwordx4 v8, s[40:43], s4 offen lds
  s_add_u32 m0, s77, 1024
  s_nop 0
  buffer_load_dwordx4 v9, s[40:43], s4 offen lds
  s_waitcnt vmcnt(4)
  s_add_u32 m0, s77, 8192
  s_add_u32 s4, s74, 0
  buffer_load_dwordx4 v8, s[40:43], s4 offen lds
  s_add_u32 m0, s77, 9216
  s_nop 0
  buffer_load_dwordx4 v9, s[40:43], s4 offen lds
  s_waitcnt vmcnt(4)
  v_readlane_b32 s74, v16, 11
  s_add_u32 m0, s77, 16384
  s_add_u32 s4, s74, s76
  buffer_load_dwordx4 v8, s[40:43], s4 offen lds
  s_add_u32 m0, s77, 17408
  s_nop 0
  buffer_load_dwordx4 v9, s[40:43], s4 offen lds
  s_waitcnt vmcnt(12)
  s_barrier
  s_add_u32 m0, s77, 24576
  s_add_u32 s4, s74, 0
  buffer_load_dwordx4 v8, s[40:43], s4 offen lds
  s_add_u32 m0, s77, 25600
  s_nop 0
  buffer_load_dwordx4 v9, s[40:43], s4 offen lds
  s_waitcnt vmcnt(4)
  v_readlane_b32 s74, v16, 12
  s_add_u32 m0, s77, 32768
  s_add_u32 s4, s74, s76
  buffer_load_dwordx4 v8, s[40:43], s4 offen lds
  s_add_u32 m0, s77, 33792
  s_nop 0
  buffer_load_dwordx4 v9, s[40:43], s4 offen lds
  s_waitcnt vmcnt(4)
  s_add_u32 m0, s77, 40960
  s_add_u32 s4, s74, 0
  buffer_load_dwordx4 v8, s[40:43], s4 offen lds
  s_add_u32 m0, s77, 41984
  s_nop 0
  buffer_load_dwordx4 v9, s[40:43], s4 offen lds
  s_waitcnt vmcnt(4)
  v_readlane_b32 s74, v16, 13
  s_add_u32 m0, s77, 49152
  s_add_u32 s4, s74, s76
  buffer_load_dwordx4 v8, s[40:43], s4 offen lds
  s_add_u32 m0, s77, 50176
  s_nop 0
  buffer_load_dwordx4 v9, s[40:43], s4 offen lds
  s_waitcnt vmcnt(12)
  s_barrier
  s_add_u32 m0, s77, 57344
  s_add_u32 s4, s74, 0
  buffer_load_dwordx4 v8, s[40:43], s4 offen lds
  s_add_u32 m0, s77, 58368
  s_nop 0
  buffer_load_dwordx4 v9, s[40:43], s4 offen lds
  s_waitcnt vmcnt(4)
  v_readlane_b32 s74, v16, 14
  s_add_u32 m0, s77, 65536
  s_add_u32 s4, s74, s76
  buffer_load_dwordx4 v8, s[40:43], s4 offen lds
  s_add_u32 m0, s77, 66560
  s_nop 0
  buffer_load_dwordx4 v9, s[40:43], s4 offen lds
  s_waitcnt vmcnt(4)
  s_add_u32 m0, s77, 73728
  s_add_u32 s4, s74, 0
  buffer_load_dwordx4 v8, s[40:43], s4 offen lds
  s_add_u32 m0, s77, 74752
  s_nop 0
  buffer_load_dwordx4 v9, s[40:43], s4 offen lds
  s_waitcnt vmcnt(4)
  v_readlane_b32 s74, v16, 15
  s_add_u32 m0, s77, 81920
  s_add_u32 s4, s74, s76
  buffer_load_dwordx4 v8, s[40:43], s4 offen lds
  s_add_u32 m0, s77, 82944
  s_nop 0
  buffer_load_dwordx4 v9, s[40:43], s4 offen lds
  s_waitcnt vmcnt(12)
  s_barrier
  s_add_u32 m0, s77, 90112
  s_add_u32 s4, s74, 0
  buffer_load_dwordx4 v8, s[40:43], s4 offen lds
  s_add_u32 m0, s77, 91136
  s_nop 0
  buffer_load_dwordx4 v9, s[40:43], s4 offen lds
  s_waitcnt vmcnt(4)
  v_readlane_b32 s74, v16, 16
  s_add_u32 m0, s77, 98304
  s_add_u32 s4, s74, s76
  buffer_load_dwordx4 v8, s[40:43], s4 offen lds
  s_add_u32 m0, s77, 99328
  s_nop 0
  buffer_load_dwordx4 v9, s[40:43], s4 offen lds
  s_waitcnt vmcnt(4)
  s_add_u32 m0, s77, 106496
  s_add_u32 s4, s74, 0
  buffer_load_dwordx4 v8, s[40:43], s4 offen lds
  s_add_u32 m0, s77, 107520
  s_nop 0
  buffer_load_dwordx4 v9, s[40:43], s4 offen lds
  s_waitcnt vmcnt(4)
  v_readlane_b32 s74, v16, 17
  s_add_u32 m0, s77, 114688
  s_add_u32 s4, s74, s76
  buffer_load_dwordx4 v8, s[40:43], s4 offen lds
  s_add_u32 m0, s77, 115712
  s_nop 0
  buffer_load_dwordx4 v9, s[40:43], s4 offen lds
  s_waitcnt vmcnt(12)
  s_barrier
  v_readlane_b32 s74, v16, 18
  s_add_u32 m0, s77, 122880
  s_add_u32 s4, s74, s76
  buffer_load_dwordx4 v8, s[40:43], s4 offen lds
  s_add_u32 m0, s77, 123904
  s_nop 0
  buffer_load_dwordx4 v9, s[40:43], s4 offen lds
  s_waitcnt vmcnt(4)
  v_readlane_b32 s74, v16, 19
  s_add_u32 m0, s77, 131072
  s_add_u32 s4, s74, s76
  buffer_load_dwordx4 v8, s[40:43], s4 offen lds
  s_add_u32 m0, s77, 132096
  s_nop 0
  buffer_load_dwordx4 v9, s[40:43], s4 offen lds
  s_waitcnt vmcnt(4)
  s_cmp_eq_u32 s70, 4
  s_cselect_b32 s46, s46, 0
  buffer_load_dword v3, v2, s[44:47], s86 offen sc1
  v_readlane_b32 s74, v16, 20
  s_add_u32 m0, s77, 139264
  s_add_u32 s4, s74, s76
  buffer_load_dwordx4 v8, s[40:43], s4 offen lds
  s_add_u32 m0, s77, 140288
  s_nop 0
  buffer_load_dwordx4 v9, s[40:43], s4 offen lds
  s_waitcnt vmcnt(4)
  v_readlane_b32 s74, v16, 21
  s_add_u32 m0, s77, 147456
  s_add_u32 s4, s74, s76
  buffer_load_dwordx4 v8, s[40:43], s4 offen lds
  s_add_u32 m0, s77, 148480
  s_nop 0
  buffer_load_dwordx4 v9, s[40:43], s4 offen lds
  s_mov_b32 s79, 0x100000
  s_cmp_lg_u32 s70, 4
  s_cbranch_scc1 L_w2l_dep
  s_waitcnt vmcnt(4)
  v_cmp_ne_u32 vcc, 1, v3
  s_cbranch_vccz L_w2l_dep
L_w2l_poll:
  buffer_load_dword v3, v2, s[44:47], s86 offen sc1
  s_sub_u32 s79, s79, 1
  s_cbranch_scc1 L_w2l_dep
  s_waitcnt vmcnt(0)
  v_cmp_ne_u32 vcc, 1, v3
  s_cbranch_vccnz L_w2l_poll
L_w2l_dep:
  s_waitcnt vmcnt(13)
  s_barrier
  v_readlane_b32 s74, v16, 22
  s_add_u32 m0, s77, 155648
  s_add_u32 s4, s74, s76
  buffer_load_dwordx4 v8, s[40:43], s4 offen lds
  s_add_u32 m0, s77, 156672
  s_nop 0
  buffer_load_dwordx4 v9, s[40:43], s4 offen lds
  s_waitcnt vmcnt(4)
  v_readlane_b32 s74, v16, 17
  s_add_u32 m0, s77, 0
  s_add_u32 s4, s74, 0
  buffer_load_dwordx4 v8, s[40:43], s4 offen lds
  s_add_u32 m0, s77, 1024
  s_nop 0
  buffer_load_dwordx4 v9, s[40:43], s4 offen lds
  s_waitcnt vmcnt(4)
  v_readlane_b32 s74, v16, 18
  s_add_u32 m0, s77, 8192
  s_add_u32 s4, s74, 0
  buffer_load_dwordx4 v8, s[40:43], s4 offen lds
  s_add_u32 m0, s77, 9216
  s_nop 0
  buffer_load_dwordx4 v9, s[40:43], s4 offen lds
  s_waitcnt vmcnt(4)
  v_readlane_b32 s74, v16, 19
  s_add_u32 m0, s77, 16384
  s_add_u32 s4, s74, 0
  buffer_load_dwordx4 v8, s[40:43], s4 offen lds
  s_add_u32 m0, s77, 17408
  s_nop 0
  buffer_load_dwordx4 v9, s[40:43], s4 offen lds
  s_waitcnt vmcnt(13)
  s_barrier
  v_readlane_b32 s74, v16, 20
  s_add_u32 m0, s77, 24576
  s_add_u32 s4, s74, 0
  buffer_load_dwordx4 v8, s[40:43], s4 offen lds
  s_add_u32 m0, s77, 25600
  s_nop 0
  buffer_load_dwordx4 v9, s[40:43], s4 offen lds
  s_waitcnt vmcnt(30)
  v_readlane_b32 s74, v16, 21
  s_add_u32 m0, s77, 32768
  s_add_u32 s4, s74, 0
  buffer_load_dwordx4 v8, s[40:43], s4 offen lds
  s_add_u32 m0, s77, 33792
  s_nop 0
  buffer_load_dwordx4 v9, s[40:43], s4 offen lds
  s_waitcnt vmcnt(30)
  v_readlane_b32 s74, v16, 22
  s_add_u32 m0, s77, 40960
  s_add_u32 s4, s74, 0
  buffer_load_dwordx4 v8, s[40:43], s4 offen lds
  s_add_u32 m0, s77, 41984
  s_nop 0
  buffer_load_dwordx4 v9, s[40:43], s4 offen lds
  s_waitcnt vmcnt(30)
  v_readlane_b32 s74, v16, 23
  s_add_u32 m0, s77, 49152
  s_add_u32 s4, s74, 0
  buffer_load_dwordx4 v8, s[40:43], s4 offen lds
  s_add_u32 m0, s77, 50176
  s_nop 0
  buffer_load_dwordx4 v9, s[40:43], s4 offen lds
  s_waitcnt vmcnt(30)
  v_readlane_b32 s74, v16, 24
  s_add_u32 m0, s77, 57344
  s_add_u32 s4, s74, 0
  buffer_load_dwordx4 v8, s[40:43], s4 offen lds
  s_add_u32 m0, s77, 58368
  s_nop 0
  buffer_load_dwordx4 v9, s[40:43], s4 offen lds
  s_waitcnt vmcnt(30)
  v_readlane_b32 s74, v16, 25
  s_add_u32 m0, s77, 65536
  s_add_u32 s4, s74, 0
  buffer_load_dwordx4 v8, s[40:43], s4 offen lds
  s_add_u32 m0, s77, 66560
  s_nop 0
  buffer_load_dwordx4 v9, s[40:43], s4 offen lds
  s_waitcnt vmcnt(30)
  v_readlane_b32 s74, v16, 26
  s_add_u32 m0, s77, 73728
  s_add_u32 s4, s74, 0
  buffer_load_dwordx4 v8, s[40:43], s4 offen lds
  s_add_u32 m0, s77, 74752
  s_nop 0
  buffer_load_dwordx4 v9, s[40:43], s4 offen lds
  s_waitcnt vmcnt(30)
  v_readlane_b32 s74, v16, 27
  s_add_u32 m0, s77, 81920
  s_add_u32 s4, s74, 0
  buffer_load_dwordx4 v8, s[40:43], s4 offen lds
  s_add_u32 m0, s77, 82944
  s_nop 0
  buffer_load_dwordx4 v9, s[40:43], s4 offen lds
  s_waitcnt vmcnt(30)
  v_readlane_b32 s74, v16, 28
  s_add_u32 m0, s77, 90112
  s_add_u32 s4, s74, 0
  buffer_load_dwordx4 v8, s[40:43], s4 offen lds
  s_add_u32 m0, s77, 91136
  s_nop 0
  buffer_load_dwordx4 v9, s[40:43], s4 offen lds
  s_waitcnt vmcnt(22)
  s_barrier
  v_readlane_b32 s74, v16, 29
  s_add_u32 m0, s77, 98304
  s_add_u32 s4, s74, 0
  buffer_load_dwordx4 v8, s[40:43], s4 offen lds
  s_add_u32 m0, s77, 99328
  s_nop 0
  buffer_load_dwordx4 v9, s[40:43], s4 offen lds
  s_waitcnt vmcnt(30)
  v_readlane_b32 s74, v16, 30
  s_add_u32 m0, s77, 106496
  s_add_u32 s4, s74, 0
  buffer_load_dwordx4 v8, s[40:43], s4 offen lds
  s_add_u32 m0, s77, 107520
  s_nop 0
  buffer_load_dwordx4 v9, s[40:43], s4 offen lds
  s_waitcnt vmcnt(30)
  v_readlane_b32 s74, v16, 31
  s_add_u32 m0, s77, 114688
  s_add_u32 s4, s74, 0
  buffer_load_dwordx4 v8, s[40:43], s4 offen lds
  s_add_u32 m0, s77, 115712
  s_nop 0
  buffer_load_dwordx4 v9, s[40:43], s4 offen lds
  s_waitcnt vmcnt(30)
  v_readlane_b32 s74, v16, 32
  s_add_u32 m0, s77, 122880
  s_add_u32 s4, s74, 0
  buffer_load_dwordx4 v8, s[40:43], s4 offen lds
  s_add_u32 m0, s77, 123904
  s_nop 0
  buffer_load_dwordx4 v9, s[40:43], s4 offen lds
  s_waitcnt vmcnt(22)
  s_barrier
  s_add_u32 s64, s22, 41943040
  s_addc_u32 s65, s23, 0
  s_and_b32 s65, s65, 0xffff
  s_mov_b32 s66, 524288
  s_mov_b32 s67, 0x00020000
  s_lshl4_add_u32 s6, s68, s69
  s_xor_b32 s6, s6, 1
  s_add_u32 s7, s96, 4
  s_lshl_b32 s7, s7, 8
  s_add_u32 s6, s6, s7
  s_lshl_b32 s86, s6, 8
  v_and_b32 v2, 3, v1
  v_lshlrev_b32 v30, 6, v2
  s_mov_b32 s79, 0x100000
  s_waitcnt vmcnt(0)
  s_barrier
  s_cmp_eq_u32 s96, 0
  s_cbranch_scc1 L_w2_zskip
  s_cmp_lg_u32 s70, 4
  s_cbranch_scc1 L_w2_xgo
  s_setprio 3
L_w2_xpoll:
  buffer_load_dword v5, v30, s[64:67], s86 offen sc1
  s_sub_u32 s79, s79, 1
  s_cbranch_scc1 L_w2_xgo
  s_waitcnt vmcnt(0)
  v_cmp_ne_u32 vcc, 1, v5
  s_cbranch_vccnz L_w2_xpoll
L_w2_xgo:
  s_setprio 0
  s_waitcnt vmcnt(0)
  s_barrier
L_w2_zskip:
  s_cmp_eq_u32 s96, 1
  s_cbranch_scc1 L_w2_end
  s_lshl_b32 s87, s97, 15
  s_lshl_b32 s4, s68, 11
  s_add_u32 s87, s87, s4
  s_lshl_b32 s4, s69, 2
  s_add_u32 s87, s87, s4
  s_mov_b32 s96, 1
  s_add_u32 s12, s22, 33554432
  s_addc_u32 s13, s23, 0
  s_add_u32 s34, s22, 67108864
  s_addc_u32 s35, s23, 0
  s_add_u32 s97, s97, 1
  s_branch L_attn_body
L_w2_wb:
  buffer_wbl2 sc1
  s_waitcnt vmcnt(0)
  s_mov_b64 exec, 0xffff
  buffer_store_dword v3, v11, s[44:47], s87 offen sc1
  s_branch L_w2_wbd
L_w2_end:
  s_endpgm
L_w2_compute:
  ds_read_b128 v[32:35], v2 offset:0
  ds_read_b128 v[36:39], v2 offset:2048
  ds_read_b64_tr_b16 v[160:161], v6 offset:0
  ds_read_b64_tr_b16 v[162:163], v6 offset:2048
  ds_read_b64_tr_b16 v[164:165], v7 offset:0
  ds_read_b64_tr_b16 v[166:167], v7 offset:2048
  ds_read_b64_tr_b16 v[168:169], v8 offset:0
  ds_read_b64_tr_b16 v[170:171], v8 offset:2048
  ds_read_b64_tr_b16 v[172:173], v9 offset:0
  ds_read_b64_tr_b16 v[174:175], v9 offset:2048
  ds_read_b128 v[40:43], v2 offset:1024
  ds_read_b128 v[44:47], v2 offset:3072
  ds_read_b64_tr_b16 v[176:177], v6 offset:4096
  ds_read_b64_tr_b16 v[178:179], v6 offset:6144
  ds_read_b64_tr_b16 v[180:181], v7 offset:4096
  ds_read_b64_tr_b16 v[182:183], v7 offset:6144
  ds_read_b64_tr_b16 v[184:185], v8 offset:4096
  ds_read_b64_tr_b16 v[186:187], v8 offset:6144
  ds_read_b64_tr_b16 v[188:189], v9 offset:4096
  ds_read_b64_tr_b16 v[190:191], v9 offset:6144
  ds_read_b128 v[48:51], v2 offset:16384
  ds_read_b128 v[52:55], v2 offset:18432
  ds_read_b128 v[56:59], v2 offset:17408
  ds_read_b128 v[60:63], v2 offset:19456
  ds_read_b128 v[64:67], v2 offset:32768
  ds_read_b128 v[68:71], v2 offset:34816
  ds_read_b128 v[72:75], v2 offset:33792
  ds_read_b128 v[76:79], v2 offset:35840
  s_waitcnt lgkmcnt(15)
  v_mfma_f32_16x16x32_bf16 v[128:131], v[160:163], v[32:35], 0
  ds_read_b64_tr_b16 v[192:193], v6 offset:8192
  v_mov_b32 v4, v26
  v_mfma_f32_16x16x32_bf16 v[132:135], v[160:163], v[36:39], 0
  ds_read_b64_tr_b16 v[194:195], v6 offset:10240
  v_mov_b32 v5, v27
  v_mfma_f32_16x16x32_bf16 v[140:143], v[164:167], v[36:39], 0
  ds_read_b64_tr_b16 v[196:197], v7 offset:8192
  v_mov_b32 v12, v28
  v_mfma_f32_16x16x32_bf16 v[136:139], v[164:167], v[32:35], 0
  ds_read_b64_tr_b16 v[198:199], v7 offset:10240
  v_mov_b32 v18, v29
  v_mfma_f32_16x16x32_bf16 v[144:147], v[168:171], v[32:35], 0
  ds_read_b64_tr_b16 v[200:201], v8 offset:8192
  v_mov_b32 v19, 1
  v_mfma_f32_16x16x32_bf16 v[148:151], v[168:171], v[36:39], 0
  ds_read_b64_tr_b16 v[202:203], v8 offset:10240
  v_add_u32 v20, 65536, v6
  v_mfma_f32_16x16x32_bf16 v[156:159], v[172:175], v[36:39], 0
  ds_read_b64_tr_b16 v[204:205], v9 offset:8192
  v_add_u32 v21, 65536, v7
  v_mfma_f32_16x16x32_bf16 v[152:155], v[172:175], v[32:35], 0
  ds_read_b64_tr_b16 v[206:207], v9 offset:10240
  s_waitcnt lgkmcnt(15)
  v_mfma_f32_16x16x32_bf16 v[128:131], v[176:179], v[40:43], v[128:131]
  ds_read_b64_tr_b16 v[208:209], v6 offset:12288
  v_add_u32 v22, 65536, v8
  v_mfma_f32_16x16x32_bf16 v[132:135], v[176:179], v[44:47], v[132:135]
  ds_read_b64_tr_b16 v[210:211], v6 offset:14336
  v_add_u32 v23, 65536, v9
  v_mfma_f32_16x16x32_bf16 v[140:143], v[180:183], v[44:47], v[140:143]
  ds_read_b64_tr_b16 v[212:213], v7 offset:12288
  v_add_u32 v26, 131072, v6
  v_mfma_f32_16x16x32_bf16 v[136:139], v[180:183], v[40:43], v[136:139]
  ds_read_b64_tr_b16 v[214:215], v7 offset:14336
  v_add_u32 v27, 131072, v7
  v_mfma_f32_16x16x32_bf16 v[144:147], v[184:187], v[40:43], v[144:147]
  ds_read_b64_tr_b16 v[216:217], v8 offset:12288
  v_add_u32 v28, 131072, v8
  v_mfma_f32_16x16x32_bf16 v[148:151], v[184:187], v[44:47], v[148:151]
  ds_read_b64_tr_b16 v[218:219], v8 offset:14336
  v_add_u32 v29, 131072, v9
  v_mfma_f32_16x16x32_bf16 v[156:159], v[188:191], v[44:47], v[156:159]
  ds_read_b64_tr_b16 v[220:221], v9 offset:12288
  s_add_u32 s52, s22, 41943040
  v_mfma_f32_16x16x32_bf16 v[152:155], v[188:191], v[40:43], v[152:155]
  ds_read_b64_tr_b16 v[222:223], v9 offset:14336
  s_waitcnt lgkmcnt(8)
  v_mfma_f32_16x16x32_bf16 v[96:99], v[192:195], v[32:35], v[96:99]
  ds_read_b64_tr_b16 v[160:161], v6 offset:16384
  s_addc_u32 s53, s23, 0
  v_mfma_f32_16x16x32_bf16 v[100:103], v[192:195], v[36:39], v[100:103]
  ds_read_b64_tr_b16 v[162:163], v6 offset:18432
  s_and_b32 s53, s53, 0xffff
  v_mfma_f32_16x16x32_bf16 v[108:111], v[196:199], v[36:39], v[108:111]
  ds_read_b64_tr_b16 v[164:165], v7 offset:16384
  s_mov_b32 s54, 524288
  v_mfma_f32_16x16x32_bf16 v[104:107], v[196:199], v[32:35], v[104:107]
  ds_read_b64_tr_b16 v[166:167], v7 offset:18432
  s_mov_b32 s55, 0x00020000
  v_mfma_f32_16x16x32_bf16 v[112:115], v[200:203], v[32:35], v[112:115]
  ds_read_b64_tr_b16 v[168:169], v8 offset:16384
  v_mfma_f32_16x16x32_bf16 v[116:119], v[200:203], v[36:39], v[116:119]
  ds_read_b64_tr_b16 v[170:171], v8 offset:18432
  v_mfma_f32_16x16x32_bf16 v[124:127], v[204:207], v[36:39], v[124:127]
  ds_read_b64_tr_b16 v[172:173], v9 offset:16384
  v_mfma_f32_16x16x32_bf16 v[120:123], v[204:207], v[32:35], v[120:123]
  ds_read_b64_tr_b16 v[174:175], v9 offset:18432
  s_waitcnt lgkmcnt(8)
  s_barrier
  buffer_load_dwordx4 v[80:83], off, s[36:39], s51 offset:0 sc1
  buffer_load_dwordx4 v[84:87], off, s[64:67], s51 offset:0 sc1
  buffer_load_dwordx4 v[88:91], off, s[36:39], s51 offset:1024 sc1
  buffer_load_dwordx4 v[92:95], off, s[64:67], s51 offset:1024 sc1
  buffer_load_dwordx4 v[224:227], off, s[36:39], s48 offset:0 sc1
  buffer_load_dwordx4 v[228:231], off, s[64:67], s48 offset:0 sc1
  buffer_load_dwordx4 v[232:235], off, s[36:39], s48 offset:1024 sc1
  buffer_load_dwordx4 v[236:239], off, s[64:67], s48 offset:1024 sc1
  buffer_load_dwordx4 v[240:243], off, s[36:39], s49 offset:0 sc1
  buffer_load_dwordx4 v[244:247], off, s[64:67], s49 offset:0 sc1
  buffer_load_dwordx4 v[248:251], off, s[36:39], s49 offset:1024 sc1
  buffer_load_dwordx4 v[252:255], off, s[64:67], s49 offset:1024 sc1
  v_mfma_f32_16x16x32_bf16 v[96:99], v[208:211], v[40:43], v[96:99]
  ds_read_b64_tr_b16 v[176:177], v6 offset:20480
  v_mfma_f32_16x16x32_bf16 v[100:103], v[208:211], v[44:47], v[100:103]
  ds_read_b64_tr_b16 v[178:179], v6 offset:22528
  v_mfma_f32_16x16x32_bf16 v[108:111], v[212:215], v[44:47], v[108:111]
  ds_read_b64_tr_b16 v[180:181], v7 offset:20480
  v_mfma_f32_16x16x32_bf16 v[104:107], v[212:215], v[40:43], v[104:107]
  ds_read_b64_tr_b16 v[182:183], v7 offset:22528
  v_mfma_f32_16x16x32_bf16 v[112:115], v[216:219], v[40:43], v[112:115]
  ds_read_b64_tr_b16 v[184:185], v8 offset:20480
  v_mfma_f32_16x16x32_bf16 v[116:119], v[216:219], v[44:47], v[116:119]
  ds_read_b64_tr_b16 v[186:187], v8 offset:22528
  v_readlane_b32 s50, v30, 6
  v_mfma_f32_16x16x32_bf16 v[124:127], v[220:223], v[44:47], v[124:127]
  ds_read_b64_tr_b16 v[188:189], v9 offset:20480
  v_mfma_f32_16x16x32_bf16 v[120:123], v[220:223], v[40:43], v[120:123]
  ds_read_b64_tr_b16 v[190:191], v9 offset:22528
  s_waitcnt lgkmcnt(8)
  v_mfma_f32_16x16x32_bf16 v[128:131], v[160:163], v[48:51], v[128:131]
  buffer_load_dwordx4 v[32:35], off, s[36:39], s50 offset:0 sc1
  v_mfma_f32_16x16x32_bf16 v[132:135], v[160:163], v[52:55], v[132:135]
  ds_read_b64_tr_b16 v[192:193], v6 offset:24576
  ds_read_b64_tr_b16 v[194:195], v6 offset:26624
  v_mfma_f32_16x16x32_bf16 v[140:143], v[164:167], v[52:55], v[140:143]
  ds_read_b64_tr_b16 v[196:197], v7 offset:24576
  v_mfma_f32_16x16x32_bf16 v[136:139], v[164:167], v[48:51], v[136:139]
  buffer_load_dwordx4 v[36:39], off, s[64:67], s50 offset:0 sc1
  v_mfma_f32_16x16x32_bf16 v[144:147], v[168:171], v[48:51], v[144:147]
  ds_read_b64_tr_b16 v[198:199], v7 offset:26624
  ds_read_b64_tr_b16 v[200:201], v8 offset:24576
  v_mfma_f32_16x16x32_bf16 v[148:151], v[168:171], v[52:55], v[148:151]
  ds_read_b64_tr_b16 v[202:203], v8 offset:26624
  ds_read_b64_tr_b16 v[204:205], v9 offset:24576
  v_mfma_f32_16x16x32_bf16 v[156:159], v[172:175], v[52:55], v[156:159]
  buffer_load_dwordx4 v[40:43], off, s[36:39], s50 offset:1024 sc1
  v_mfma_f32_16x16x32_bf16 v[152:155], v[172:175], v[48:51], v[152:155]
  ds_read_b64_tr_b16 v[206:207], v9 offset:26624
  s_waitcnt lgkmcnt(8)
  v_mfma_f32_16x16x32_bf16 v[128:131], v[176:179], v[56:59], v[128:131]
  ds_read_b64_tr_b16 v[208:209], v6 offset:28672
  v_mfma_f32_16x16x32_bf16 v[132:135], v[176:179], v[60:63], v[132:135]
  buffer_load_dwordx4 v[44:47], off, s[64:67], s50 offset:1024 sc1
  v_mfma_f32_16x16x32_bf16 v[140:143], v[180:183], v[60:63], v[140:143]
  ds_read_b64_tr_b16 v[210:211], v6 offset:30720
  ds_read_b64_tr_b16 v[212:213], v7 offset:28672
  v_mfma_f32_16x16x32_bf16 v[136:139], v[180:183], v[56:59], v[136:139]
  ds_read_b64_tr_b16 v[214:215], v7 offset:30720
  v_mfma_f32_16x16x32_bf16 v[144:147], v[184:187], v[56:59], v[144:147]
  ds_read_b64_tr_b16 v[216:217], v8 offset:28672
  v_mfma_f32_16x16x32_bf16 v[148:151], v[184:187], v[60:63], v[148:151]
  ds_read_b64_tr_b16 v[218:219], v8 offset:30720
  v_mfma_f32_16x16x32_bf16 v[156:159], v[188:191], v[60:63], v[156:159]
  ds_read_b64_tr_b16 v[220:221], v9 offset:28672
  v_mfma_f32_16x16x32_bf16 v[152:155], v[188:191], v[56:59], v[152:155]
  ds_read_b64_tr_b16 v[222:223], v9 offset:30720
  s_waitcnt lgkmcnt(8)
  v_mfma_f32_16x16x32_bf16 v[96:99], v[192:195], v[48:51], v[96:99]
  ds_read_b64_tr_b16 v[160:161], v6 offset:32768
  v_mfma_f32_16x16x32_bf16 v[100:103], v[192:195], v[52:55], v[100:103]
  ds_read_b64_tr_b16 v[162:163], v6 offset:34816
  v_mfma_f32_16x16x32_bf16 v[108:111], v[196:199], v[52:55], v[108:111]
  ds_read_b64_tr_b16 v[164:165], v7 offset:32768
  v_mfma_f32_16x16x32_bf16 v[104:107], v[196:199], v[48:51], v[104:107]
  ds_read_b64_tr_b16 v[166:167], v7 offset:34816
  v_mfma_f32_16x16x32_bf16 v[112:115], v[200:203], v[48:51], v[112:115]
  ds_read_b64_tr_b16 v[168:169], v8 offset:32768
  v_mfma_f32_16x16x32_bf16 v[116:119], v[200:203], v[52:55], v[116:119]
  ds_read_b64_tr_b16 v[170:171], v8 offset:34816
  v_mfma_f32_16x16x32_bf16 v[124:127], v[204:207], v[52:55], v[124:127]
  ds_read_b64_tr_b16 v[172:173], v9 offset:32768
  v_mfma_f32_16x16x32_bf16 v[120:123], v[204:207], v[48:51], v[120:123]
  ds_read_b64_tr_b16 v[174:175], v9 offset:34816
  s_waitcnt lgkmcnt(8)
  v_mfma_f32_16x16x32_bf16 v[96:99], v[208:211], v[56:59], v[96:99]
  ds_read_b64_tr_b16 v[176:177], v6 offset:36864
  v_mfma_f32_16x16x32_bf16 v[100:103], v[208:211], v[60:63], v[100:103]
  ds_read_b64_tr_b16 v[178:179], v6 offset:38912
  v_mfma_f32_16x16x32_bf16 v[108:111], v[212:215], v[60:63], v[108:111]
  ds_read_b64_tr_b16 v[180:181], v7 offset:36864
  v_mfma_f32_16x16x32_bf16 v[104:107], v[212:215], v[56:59], v[104:107]
  ds_read_b64_tr_b16 v[182:183], v7 offset:38912
  v_mfma_f32_16x16x32_bf16 v[112:115], v[216:219], v[56:59], v[112:115]
  ds_read_b64_tr_b16 v[184:185], v8 offset:36864
  v_mfma_f32_16x16x32_bf16 v[116:119], v[216:219], v[60:63], v[116:119]
  ds_read_b64_tr_b16 v[186:187], v8 offset:38912
  v_readlane_b32 s51, v30, 7
  v_mfma_f32_16x16x32_bf16 v[124:127], v[220:223], v[60:63], v[124:127]
  ds_read_b64_tr_b16 v[188:189], v9 offset:36864
  v_mfma_f32_16x16x32_bf16 v[120:123], v[220:223], v[56:59], v[120:123]
  ds_read_b64_tr_b16 v[190:191], v9 offset:38912
  s_waitcnt lgkmcnt(8)
  v_mfma_f32_16x16x32_bf16 v[128:131], v[160:163], v[64:67], v[128:131]
  buffer_load_dwordx4 v[48:51], off, s[36:39], s51 offset:0 sc1
  v_mfma_f32_16x16x32_bf16 v[132:135], v[160:163], v[68:71], v[132:135]
  ds_read_b64_tr_b16 v[192:193], v6 offset:40960
  ds_read_b64_tr_b16 v[194:195], v6 offset:43008
  v_mfma_f32_16x16x32_bf16 v[140:143], v[164:167], v[68:71], v[140:143]
  ds_read_b64_tr_b16 v[196:197], v7 offset:40960
  v_mfma_f32_16x16x32_bf16 v[136:139], v[164:167], v[64:67], v[136:139]
  buffer_load_dwordx4 v[52:55], off, s[64:67], s51 offset:0 sc1
  v_mfma_f32_16x16x32_bf16 v[144:147], v[168:171], v[64:67], v[144:147]
  ds_read_b64_tr_b16 v[198:199], v7 offset:43008
  ds_read_b64_tr_b16 v[200:201], v8 offset:40960
  v_mfma_f32_16x16x32_bf16 v[148:151], v[168:171], v[68:71], v[148:151]
  ds_read_b64_tr_b16 v[202:203], v8 offset:43008
  ds_read_b64_tr_b16 v[204:205], v9 offset:40960
  v_mfma_f32_16x16x32_bf16 v[156:159], v[172:175], v[68:71], v[156:159]
  buffer_load_dwordx4 v[56:59], off, s[36:39], s51 offset:1024 sc1
  v_mfma_f32_16x16x32_bf16 v[152:155], v[172:175], v[64:67], v[152:155]
  ds_read_b64_tr_b16 v[206:207], v9 offset:43008
  s_waitcnt lgkmcnt(8)
  v_mfma_f32_16x16x32_bf16 v[128:131], v[176:179], v[72:75], v[128:131]
  ds_read_b64_tr_b16 v[208:209], v6 offset:45056
  v_mfma_f32_16x16x32_bf16 v[132:135], v[176:179], v[76:79], v[132:135]
  buffer_load_dwordx4 v[60:63], off, s[64:67], s51 offset:1024 sc1
  v_mfma_f32_16x16x32_bf16 v[140:143], v[180:183], v[76:79], v[140:143]
  ds_read_b64_tr_b16 v[210:211], v6 offset:47104
  ds_read_b64_tr_b16 v[212:213], v7 offset:45056
  v_mfma_f32_16x16x32_bf16 v[136:139], v[180:183], v[72:75], v[136:139]
  ds_read_b64_tr_b16 v[214:215], v7 offset:47104
  v_mfma_f32_16x16x32_bf16 v[144:147], v[184:187], v[72:75], v[144:147]
  ds_read_b64_tr_b16 v[216:217], v8 offset:45056
  v_mfma_f32_16x16x32_bf16 v[148:151], v[184:187], v[76:79], v[148:151]
  ds_read_b64_tr_b16 v[218:219], v8 offset:47104
  v_mfma_f32_16x16x32_bf16 v[156:159], v[188:191], v[76:79], v[156:159]
  ds_read_b64_tr_b16 v[220:221], v9 offset:45056
  v_mfma_f32_16x16x32_bf16 v[152:155], v[188:191], v[72:75], v[152:155]
  ds_read_b64_tr_b16 v[222:223], v9 offset:47104
  s_waitcnt lgkmcnt(8)
  v_mfma_f32_16x16x32_bf16 v[96:99], v[192:195], v[64:67], v[96:99]
  ds_read_b64_tr_b16 v[160:161], v6 offset:49152
  v_mfma_f32_16x16x32_bf16 v[100:103], v[192:195], v[68:71], v[100:103]
  ds_read_b64_tr_b16 v[162:163], v6 offset:51200
  v_mfma_f32_16x16x32_bf16 v[108:111], v[196:199], v[68:71], v[108:111]
  ds_read_b64_tr_b16 v[164:165], v7 offset:49152
  v_mfma_f32_16x16x32_bf16 v[104:107], v[196:199], v[64:67], v[104:107]
  ds_read_b64_tr_b16 v[166:167], v7 offset:51200
  v_mfma_f32_16x16x32_bf16 v[112:115], v[200:203], v[64:67], v[112:115]
  ds_read_b64_tr_b16 v[168:169], v8 offset:49152
  v_mfma_f32_16x16x32_bf16 v[116:119], v[200:203], v[68:71], v[116:119]
  ds_read_b64_tr_b16 v[170:171], v8 offset:51200
  v_mfma_f32_16x16x32_bf16 v[124:127], v[204:207], v[68:71], v[124:127]
  ds_read_b64_tr_b16 v[172:173], v9 offset:49152
  v_mfma_f32_16x16x32_bf16 v[120:123], v[204:207], v[64:67], v[120:123]
  ds_read_b64_tr_b16 v[174:175], v9 offset:51200
  s_waitcnt lgkmcnt(8)
  v_mfma_f32_16x16x32_bf16 v[96:99], v[208:211], v[72:75], v[96:99]
  ds_read_b64_tr_b16 v[176:177], v6 offset:53248
  v_mfma_f32_16x16x32_bf16 v[100:103], v[208:211], v[76:79], v[100:103]
  ds_read_b64_tr_b16 v[178:179], v6 offset:55296
  v_mfma_f32_16x16x32_bf16 v[108:111], v[212:215], v[76:79], v[108:111]
  ds_read_b64_tr_b16 v[180:181], v7 offset:53248
  v_mfma_f32_16x16x32_bf16 v[104:107], v[212:215], v[72:75], v[104:107]
  ds_read_b64_tr_b16 v[182:183], v7 offset:55296
  v_mfma_f32_16x16x32_bf16 v[112:115], v[216:219], v[72:75], v[112:115]
  ds_read_b64_tr_b16 v[184:185], v8 offset:53248
  v_mfma_f32_16x16x32_bf16 v[116:119], v[216:219], v[76:79], v[116:119]
  ds_read_b64_tr_b16 v[186:187], v8 offset:55296
  v_readlane_b32 s48, v30, 8
  v_mfma_f32_16x16x32_bf16 v[124:127], v[220:223], v[76:79], v[124:127]
  ds_read_b64_tr_b16 v[188:189], v9 offset:53248
  v_mfma_f32_16x16x32_bf16 v[120:123], v[220:223], v[72:75], v[120:123]
  ds_read_b64_tr_b16 v[190:191], v9 offset:55296
  s_waitcnt vmcnt(18) lgkmcnt(8)
  v_mfma_f32_16x16x32_bf16 v[128:131], v[160:163], v[80:83], v[128:131]
  buffer_load_dwordx4 v[64:67], off, s[36:39], s48 offset:0 sc1
  v_mfma_f32_16x16x32_bf16 v[132:135], v[160:163], v[84:87], v[132:135]
  ds_read_b64_tr_b16 v[192:193], v6 offset:57344
  ds_read_b64_tr_b16 v[194:195], v6 offset:59392
  v_mfma_f32_16x16x32_bf16 v[140:143], v[164:167], v[84:87], v[140:143]
  ds_read_b64_tr_b16 v[196:197], v7 offset:57344
  v_mfma_f32_16x16x32_bf16 v[136:139], v[164:167], v[80:83], v[136:139]
  ds_read_b64_tr_b16 v[198:199], v7 offset:59392
  v_mfma_f32_16x16x32_bf16 v[144:147], v[168:171], v[80:83], v[144:147]
  ds_read_b64_tr_b16 v[200:201], v8 offset:57344
  v_mfma_f32_16x16x32_bf16 v[148:151], v[168:171], v[84:87], v[148:151]
  ds_read_b64_tr_b16 v[202:203], v8 offset:59392
  ds_read_b64_tr_b16 v[204:205], v9 offset:57344
  v_mfma_f32_16x16x32_bf16 v[156:159], v[172:175], v[84:87], v[156:159]
  buffer_load_dwordx4 v[68:71], off, s[64:67], s48 offset:0 sc1
  v_mfma_f32_16x16x32_bf16 v[152:155], v[172:175], v[80:83], v[152:155]
  ds_read_b64_tr_b16 v[206:207], v9 offset:59392
  s_waitcnt vmcnt(18) lgkmcnt(8)
  v_mfma_f32_16x16x32_bf16 v[128:131], v[176:179], v[88:91], v[128:131]
  ds_read_b64_tr_b16 v[208:209], v6 offset:61440
  v_mfma_f32_16x16x32_bf16 v[132:135], v[176:179], v[92:95], v[132:135]
  ds_read_b64_tr_b16 v[210:211], v6 offset:63488
  v_mfma_f32_16x16x32_bf16 v[140:143], v[180:183], v[92:95], v[140:143]
  ds_read_b64_tr_b16 v[212:213], v7 offset:61440
  v_mfma_f32_16x16x32_bf16 v[136:139], v[180:183], v[88:91], v[136:139]
  ds_read_b64_tr_b16 v[214:215], v7 offset:63488
  v_mfma_f32_16x16x32_bf16 v[144:147], v[184:187], v[88:91], v[144:147]
  buffer_load_dwordx4 v[72:75], off, s[36:39], s48 offset:1024 sc1
  v_mfma_f32_16x16x32_bf16 v[148:151], v[184:187], v[92:95], v[148:151]
  ds_read_b64_tr_b16 v[216:217], v8 offset:61440
  ds_read_b64_tr_b16 v[218:219], v8 offset:63488
  v_mfma_f32_16x16x32_bf16 v[156:159], v[188:191], v[92:95], v[156:159]
  ds_read_b64_tr_b16 v[220:221], v9 offset:61440
  v_mfma_f32_16x16x32_bf16 v[152:155], v[188:191], v[88:91], v[152:155]
  ds_read_b64_tr_b16 v[222:223], v9 offset:63488
  s_waitcnt lgkmcnt(8)
  v_mfma_f32_16x16x32_bf16 v[96:99], v[192:195], v[80:83], v[96:99]
  ds_read_b64_tr_b16 v[160:161], v20 offset:0
  v_mfma_f32_16x16x32_bf16 v[100:103], v[192:195], v[84:87], v[100:103]
  ds_read_b64_tr_b16 v[162:163], v20 offset:2048
  v_mfma_f32_16x16x32_bf16 v[108:111], v[196:199], v[84:87], v[108:111]
  buffer_load_dwordx4 v[76:79], off, s[64:67], s48 offset:1024 sc1
  v_mfma_f32_16x16x32_bf16 v[104:107], v[196:199], v[80:83], v[104:107]
  ds_read_b64_tr_b16 v[164:165], v21 offset:0
  ds_read_b64_tr_b16 v[166:167], v21 offset:2048
  v_mfma_f32_16x16x32_bf16 v[112:115], v[200:203], v[80:83], v[112:115]
  ds_read_b64_tr_b16 v[168:169], v22 offset:0
  v_mfma_f32_16x16x32_bf16 v[116:119], v[200:203], v[84:87], v[116:119]
  ds_read_b64_tr_b16 v[170:171], v22 offset:2048
  v_mfma_f32_16x16x32_bf16 v[124:127], v[204:207], v[84:87], v[124:127]
  ds_read_b64_tr_b16 v[172:173], v23 offset:0
  v_mfma_f32_16x16x32_bf16 v[120:123], v[204:207], v[80:83], v[120:123]
  ds_read_b64_tr_b16 v[174:175], v23 offset:2048
  s_waitcnt lgkmcnt(8)
  s_barrier
  v_mfma_f32_16x16x32_bf16 v[96:99], v[208:211], v[88:91], v[96:99]
  ds_read_b64_tr_b16 v[176:177], v20 offset:4096
  v_mfma_f32_16x16x32_bf16 v[100:103], v[208:211], v[92:95], v[100:103]
  ds_read_b64_tr_b16 v[178:179], v20 offset:6144
  v_mfma_f32_16x16x32_bf16 v[108:111], v[212:215], v[92:95], v[108:111]
  ds_read_b64_tr_b16 v[180:181], v21 offset:4096
  v_mfma_f32_16x16x32_bf16 v[104:107], v[212:215], v[88:91], v[104:107]
  ds_read_b64_tr_b16 v[182:183], v21 offset:6144
  v_mfma_f32_16x16x32_bf16 v[112:115], v[216:219], v[88:91], v[112:115]
  ds_read_b64_tr_b16 v[184:185], v22 offset:4096
  v_mfma_f32_16x16x32_bf16 v[116:119], v[216:219], v[92:95], v[116:119]
  ds_read_b64_tr_b16 v[186:187], v22 offset:6144
  v_readlane_b32 s49, v30, 9
  v_mfma_f32_16x16x32_bf16 v[124:127], v[220:223], v[92:95], v[124:127]
  ds_read_b64_tr_b16 v[188:189], v23 offset:4096
  v_mfma_f32_16x16x32_bf16 v[120:123], v[220:223], v[88:91], v[120:123]
  ds_read_b64_tr_b16 v[190:191], v23 offset:6144
  s_waitcnt vmcnt(18) lgkmcnt(8)
  v_mfma_f32_16x16x32_bf16 v[128:131], v[160:163], v[224:227], v[128:131]
  buffer_load_dwordx4 v[80:83], off, s[36:39], s49 offset:0 sc1
  v_mfma_f32_16x16x32_bf16 v[132:135], v[160:163], v[228:231], v[132:135]
  ds_read_b64_tr_b16 v[192:193], v20 offset:8192
  ds_read_b64_tr_b16 v[194:195], v20 offset:10240
  v_mfma_f32_16x16x32_bf16 v[140:143], v[164:167], v[228:231], v[140:143]
  ds_read_b64_tr_b16 v[196:197], v21 offset:8192
  v_mfma_f32_16x16x32_bf16 v[136:139], v[164:167], v[224:227], v[136:139]
  ds_read_b64_tr_b16 v[198:199], v21 offset:10240
  v_mfma_f32_16x16x32_bf16 v[144:147], v[168:171], v[224:227], v[144:147]
  ds_read_b64_tr_b16 v[200:201], v22 offset:8192
  v_mfma_f32_16x16x32_bf16 v[148:151], v[168:171], v[228:231], v[148:151]
  ds_read_b64_tr_b16 v[202:203], v22 offset:10240
  ds_read_b64_tr_b16 v[204:205], v23 offset:8192
  v_mfma_f32_16x16x32_bf16 v[156:159], v[172:175], v[228:231], v[156:159]
  buffer_load_dwordx4 v[84:87], off, s[64:67], s49 offset:0 sc1
  v_mfma_f32_16x16x32_bf16 v[152:155], v[172:175], v[224:227], v[152:155]
  ds_read_b64_tr_b16 v[206:207], v23 offset:10240
  s_waitcnt vmcnt(18) lgkmcnt(8)
  v_mfma_f32_16x16x32_bf16 v[128:131], v[176:179], v[232:235], v[128:131]
  ds_read_b64_tr_b16 v[208:209], v20 offset:12288
  v_mfma_f32_16x16x32_bf16 v[132:135], v[176:179], v[236:239], v[132:135]
  ds_read_b64_tr_b16 v[210:211], v20 offset:14336
  v_mfma_f32_16x16x32_bf16 v[140:143], v[180:183], v[236:239], v[140:143]
  ds_read_b64_tr_b16 v[212:213], v21 offset:12288
  v_mfma_f32_16x16x32_bf16 v[136:139], v[180:183], v[232:235], v[136:139]
  ds_read_b64_tr_b16 v[214:215], v21 offset:14336
  v_mfma_f32_16x16x32_bf16 v[144:147], v[184:187], v[232:235], v[144:147]
  buffer_load_dwordx4 v[88:91], off, s[36:39], s49 offset:1024 sc1
  v_mfma_f32_16x16x32_bf16 v[148:151], v[184:187], v[236:239], v[148:151]
  ds_read_b64_tr_b16 v[216:217], v22 offset:12288
  ds_read_b64_tr_b16 v[218:219], v22 offset:14336
  v_mfma_f32_16x16x32_bf16 v[156:159], v[188:191], v[236:239], v[156:159]
  ds_read_b64_tr_b16 v[220:221], v23 offset:12288
  v_mfma_f32_16x16x32_bf16 v[152:155], v[188:191], v[232:235], v[152:155]
  ds_read_b64_tr_b16 v[222:223], v23 offset:14336
  s_waitcnt lgkmcnt(8)
  v_mfma_f32_16x16x32_bf16 v[96:99], v[192:195], v[224:227], v[96:99]
  ds_read_b64_tr_b16 v[160:161], v20 offset:16384
  v_mfma_f32_16x16x32_bf16 v[100:103], v[192:195], v[228:231], v[100:103]
  ds_read_b64_tr_b16 v[162:163], v20 offset:18432
  v_mfma_f32_16x16x32_bf16 v[108:111], v[196:199], v[228:231], v[108:111]
  buffer_load_dwordx4 v[92:95], off, s[64:67], s49 offset:1024 sc1
  v_mfma_f32_16x16x32_bf16 v[104:107], v[196:199], v[224:227], v[104:107]
  ds_read_b64_tr_b16 v[164:165], v21 offset:16384
  ds_read_b64_tr_b16 v[166:167], v21 offset:18432
  v_mfma_f32_16x16x32_bf16 v[112:115], v[200:203], v[224:227], v[112:115]
  ds_read_b64_tr_b16 v[168:169], v22 offset:16384
  v_mfma_f32_16x16x32_bf16 v[116:119], v[200:203], v[228:231], v[116:119]
  ds_read_b64_tr_b16 v[170:171], v22 offset:18432
  v_mfma_f32_16x16x32_bf16 v[124:127], v[204:207], v[228:231], v[124:127]
  ds_read_b64_tr_b16 v[172:173], v23 offset:16384
  v_mfma_f32_16x16x32_bf16 v[120:123], v[204:207], v[224:227], v[120:123]
  ds_read_b64_tr_b16 v[174:175], v23 offset:18432
  s_waitcnt lgkmcnt(8)
  v_mfma_f32_16x16x32_bf16 v[96:99], v[208:211], v[232:235], v[96:99]
  ds_read_b64_tr_b16 v[176:177], v20 offset:20480
  v_mfma_f32_16x16x32_bf16 v[100:103], v[208:211], v[236:239], v[100:103]
  ds_read_b64_tr_b16 v[178:179], v20 offset:22528
  v_mfma_f32_16x16x32_bf16 v[108:111], v[212:215], v[236:239], v[108:111]
  ds_read_b64_tr_b16 v[180:181], v21 offset:20480
  v_mfma_f32_16x16x32_bf16 v[104:107], v[212:215], v[232:235], v[104:107]
  ds_read_b64_tr_b16 v[182:183], v21 offset:22528
  v_mfma_f32_16x16x32_bf16 v[112:115], v[216:219], v[232:235], v[112:115]
  ds_read_b64_tr_b16 v[184:185], v22 offset:20480
  v_mfma_f32_16x16x32_bf16 v[116:119], v[216:219], v[236:239], v[116:119]
  ds_read_b64_tr_b16 v[186:187], v22 offset:22528
  v_readlane_b32 s50, v30, 10
  v_mfma_f32_16x16x32_bf16 v[124:127], v[220:223], v[236:239], v[124:127]
  ds_read_b64_tr_b16 v[188:189], v23 offset:20480
  v_mfma_f32_16x16x32_bf16 v[120:123], v[220:223], v[232:235], v[120:123]
  ds_read_b64_tr_b16 v[190:191], v23 offset:22528
  s_waitcnt vmcnt(18) lgkmcnt(8)
  v_mfma_f32_16x16x32_bf16 v[128:131], v[160:163], v[240:243], v[128:131]
  buffer_load_dwordx4 v[224:227], off, s[36:39], s50 offset:0 sc1
  v_mfma_f32_16x16x32_bf16 v[132:135], v[160:163], v[244:247], v[132:135]
  ds_read_b64_tr_b16 v[192:193], v20 offset:24576
  ds_read_b64_tr_b16 v[194:195], v20 offset:26624
  v_mfma_f32_16x16x32_bf16 v[140:143], v[164:167], v[244:247], v[140:143]
  ds_read_b64_tr_b16 v[196:197], v21 offset:24576
  v_mfma_f32_16x16x32_bf16 v[136:139], v[164:167], v[240:243], v[136:139]
  ds_read_b64_tr_b16 v[198:199], v21 offset:26624
  v_mfma_f32_16x16x32_bf16 v[144:147], v[168:171], v[240:243], v[144:147]
  ds_read_b64_tr_b16 v[200:201], v22 offset:24576
  v_mfma_f32_16x16x32_bf16 v[148:151], v[168:171], v[244:247], v[148:151]
  ds_read_b64_tr_b16 v[202:203], v22 offset:26624
  ds_read_b64_tr_b16 v[204:205], v23 offset:24576
  v_mfma_f32_16x16x32_bf16 v[156:159], v[172:175], v[244:247], v[156:159]
  buffer_load_dwordx4 v[228:231], off, s[64:67], s50 offset:0 sc1
  v_mfma_f32_16x16x32_bf16 v[152:155], v[172:175], v[240:243], v[152:155]
  ds_read_b64_tr_b16 v[206:207], v23 offset:26624
  s_waitcnt vmcnt(18) lgkmcnt(8)
  v_mfma_f32_16x16x32_bf16 v[128:131], v[176:179], v[248:251], v[128:131]
  ds_read_b64_tr_b16 v[208:209], v20 offset:28672
  v_mfma_f32_16x16x32_bf16 v[132:135], v[176:179], v[252:255], v[132:135]
  ds_read_b64_tr_b16 v[210:211], v20 offset:30720
  v_mfma_f32_16x16x32_bf16 v[140:143], v[180:183], v[252:255], v[140:143]
  ds_read_b64_tr_b16 v[212:213], v21 offset:28672
  v_mfma_f32_16x16x32_bf16 v[136:139], v[180:183], v[248:251], v[136:139]
  ds_read_b64_tr_b16 v[214:215], v21 offset:30720
  v_mfma_f32_16x16x32_bf16 v[144:147], v[184:187], v[248:251], v[144:147]
  buffer_load_dwordx4 v[232:235], off, s[36:39], s50 offset:1024 sc1
  v_mfma_f32_16x16x32_bf16 v[148:151], v[184:187], v[252:255], v[148:151]
  ds_read_b64_tr_b16 v[216:217], v22 offset:28672
  ds_read_b64_tr_b16 v[218:219], v22 offset:30720
  v_mfma_f32_16x16x32_bf16 v[156:159], v[188:191], v[252:255], v[156:159]
  ds_read_b64_tr_b16 v[220:221], v23 offset:28672
  v_mfma_f32_16x16x32_bf16 v[152:155], v[188:191], v[248:251], v[152:155]
  ds_read_b64_tr_b16 v[222:223], v23 offset:30720
  s_waitcnt lgkmcnt(8)
  v_mfma_f32_16x16x32_bf16 v[96:99], v[192:195], v[240:243], v[96:99]
  ds_read_b64_tr_b16 v[160:161], v20 offset:32768
  v_mfma_f32_16x16x32_bf16 v[100:103], v[192:195], v[244:247], v[100:103]
  ds_read_b64_tr_b16 v[162:163], v20 offset:34816
  v_mfma_f32_16x16x32_bf16 v[108:111], v[196:199], v[244:247], v[108:111]
  buffer_load_dwordx4 v[236:239], off, s[64:67], s50 offset:1024 sc1
  v_mfma_f32_16x16x32_bf16 v[104:107], v[196:199], v[240:243], v[104:107]
  ds_read_b64_tr_b16 v[164:165], v21 offset:32768
  ds_read_b64_tr_b16 v[166:167], v21 offset:34816
  v_mfma_f32_16x16x32_bf16 v[112:115], v[200:203], v[240:243], v[112:115]
  ds_read_b64_tr_b16 v[168:169], v22 offset:32768
  v_mfma_f32_16x16x32_bf16 v[116:119], v[200:203], v[244:247], v[116:119]
  ds_read_b64_tr_b16 v[170:171], v22 offset:34816
  v_mfma_f32_16x16x32_bf16 v[124:127], v[204:207], v[244:247], v[124:127]
  ds_read_b64_tr_b16 v[172:173], v23 offset:32768
  v_mfma_f32_16x16x32_bf16 v[120:123], v[204:207], v[240:243], v[120:123]
  ds_read_b64_tr_b16 v[174:175], v23 offset:34816
  s_waitcnt lgkmcnt(8)
  s_barrier
  v_mfma_f32_16x16x32_bf16 v[96:99], v[208:211], v[248:251], v[96:99]
  ds_read_b64_tr_b16 v[176:177], v20 offset:36864
  v_mfma_f32_16x16x32_bf16 v[100:103], v[208:211], v[252:255], v[100:103]
  ds_read_b64_tr_b16 v[178:179], v20 offset:38912
  v_mfma_f32_16x16x32_bf16 v[108:111], v[212:215], v[252:255], v[108:111]
  ds_read_b64_tr_b16 v[180:181], v21 offset:36864
  v_mfma_f32_16x16x32_bf16 v[104:107], v[212:215], v[248:251], v[104:107]
  ds_read_b64_tr_b16 v[182:183], v21 offset:38912
  v_mfma_f32_16x16x32_bf16 v[112:115], v[216:219], v[248:251], v[112:115]
  ds_read_b64_tr_b16 v[184:185], v22 offset:36864
  v_mfma_f32_16x16x32_bf16 v[116:119], v[216:219], v[252:255], v[116:119]
  ds_read_b64_tr_b16 v[186:187], v22 offset:38912
  v_readlane_b32 s51, v30, 11
  v_mfma_f32_16x16x32_bf16 v[124:127], v[220:223], v[252:255], v[124:127]
  ds_read_b64_tr_b16 v[188:189], v23 offset:36864
  v_mfma_f32_16x16x32_bf16 v[120:123], v[220:223], v[248:251], v[120:123]
  ds_read_b64_tr_b16 v[190:191], v23 offset:38912
  s_waitcnt vmcnt(18) lgkmcnt(8)
  v_mfma_f32_16x16x32_bf16 v[128:131], v[160:163], v[32:35], v[128:131]
  buffer_load_dwordx4 v[240:243], off, s[36:39], s51 offset:0 sc1
  v_mfma_f32_16x16x32_bf16 v[132:135], v[160:163], v[36:39], v[132:135]
  ds_read_b64_tr_b16 v[192:193], v20 offset:40960
  ds_read_b64_tr_b16 v[194:195], v20 offset:43008
  v_mfma_f32_16x16x32_bf16 v[140:143], v[164:167], v[36:39], v[140:143]
  ds_read_b64_tr_b16 v[196:197], v21 offset:40960
  v_mfma_f32_16x16x32_bf16 v[136:139], v[164:167], v[32:35], v[136:139]
  ds_read_b64_tr_b16 v[198:199], v21 offset:43008
  v_mfma_f32_16x16x32_bf16 v[144:147], v[168:171], v[32:35], v[144:147]
  ds_read_b64_tr_b16 v[200:201], v22 offset:40960
  v_mfma_f32_16x16x32_bf16 v[148:151], v[168:171], v[36:39], v[148:151]
  ds_read_b64_tr_b16 v[202:203], v22 offset:43008
  ds_read_b64_tr_b16 v[204:205], v23 offset:40960
  v_mfma_f32_16x16x32_bf16 v[156:159], v[172:175], v[36:39], v[156:159]
  buffer_load_dwordx4 v[244:247], off, s[64:67], s51 offset:0 sc1
  v_mfma_f32_16x16x32_bf16 v[152:155], v[172:175], v[32:35], v[152:155]
  ds_read_b64_tr_b16 v[206:207], v23 offset:43008
  s_waitcnt vmcnt(18) lgkmcnt(8)
  v_mfma_f32_16x16x32_bf16 v[128:131], v[176:179], v[40:43], v[128:131]
  ds_read_b64_tr_b16 v[208:209], v20 offset:45056
  v_mfma_f32_16x16x32_bf16 v[132:135], v[176:179], v[44:47], v[132:135]
  ds_read_b64_tr_b16 v[210:211], v20 offset:47104
  v_mfma_f32_16x16x32_bf16 v[140:143], v[180:183], v[44:47], v[140:143]
  ds_read_b64_tr_b16 v[212:213], v21 offset:45056
  v_mfma_f32_16x16x32_bf16 v[136:139], v[180:183], v[40:43], v[136:139]
  ds_read_b64_tr_b16 v[214:215], v21 offset:47104
  v_mfma_f32_16x16x32_bf16 v[144:147], v[184:187], v[40:43], v[144:147]
  buffer_load_dwordx4 v[248:251], off, s[36:39], s51 offset:1024 sc1
  v_mfma_f32_16x16x32_bf16 v[148:151], v[184:187], v[44:47], v[148:151]
  ds_read_b64_tr_b16 v[216:217], v22 offset:45056
  ds_read_b64_tr_b16 v[218:219], v22 offset:47104
  v_mfma_f32_16x16x32_bf16 v[156:159], v[188:191], v[44:47], v[156:159]
  ds_read_b64_tr_b16 v[220:221], v23 offset:45056
  v_mfma_f32_16x16x32_bf16 v[152:155], v[188:191], v[40:43], v[152:155]
  ds_read_b64_tr_b16 v[222:223], v23 offset:47104
  s_waitcnt lgkmcnt(8)
  v_mfma_f32_16x16x32_bf16 v[96:99], v[192:195], v[32:35], v[96:99]
  ds_read_b64_tr_b16 v[160:161], v20 offset:49152
  v_mfma_f32_16x16x32_bf16 v[100:103], v[192:195], v[36:39], v[100:103]
  ds_read_b64_tr_b16 v[162:163], v20 offset:51200
  v_mfma_f32_16x16x32_bf16 v[108:111], v[196:199], v[36:39], v[108:111]
  buffer_load_dwordx4 v[252:255], off, s[64:67], s51 offset:1024 sc1
  v_mfma_f32_16x16x32_bf16 v[104:107], v[196:199], v[32:35], v[104:107]
  ds_read_b64_tr_b16 v[164:165], v21 offset:49152
  ds_read_b64_tr_b16 v[166:167], v21 offset:51200
  v_mfma_f32_16x16x32_bf16 v[112:115], v[200:203], v[32:35], v[112:115]
  ds_read_b64_tr_b16 v[168:169], v22 offset:49152
  v_mfma_f32_16x16x32_bf16 v[116:119], v[200:203], v[36:39], v[116:119]
  ds_read_b64_tr_b16 v[170:171], v22 offset:51200
  v_mfma_f32_16x16x32_bf16 v[124:127], v[204:207], v[36:39], v[124:127]
  ds_read_b64_tr_b16 v[172:173], v23 offset:49152
  v_mfma_f32_16x16x32_bf16 v[120:123], v[204:207], v[32:35], v[120:123]
  ds_read_b64_tr_b16 v[174:175], v23 offset:51200
  s_waitcnt lgkmcnt(8)
  v_mfma_f32_16x16x32_bf16 v[96:99], v[208:211], v[40:43], v[96:99]
  ds_read_b64_tr_b16 v[176:177], v20 offset:53248
  v_mfma_f32_16x16x32_bf16 v[100:103], v[208:211], v[44:47], v[100:103]
  ds_read_b64_tr_b16 v[178:179], v20 offset:55296
  v_mfma_f32_16x16x32_bf16 v[108:111], v[212:215], v[44:47], v[108:111]
  ds_read_b64_tr_b16 v[180:181], v21 offset:53248
  v_mfma_f32_16x16x32_bf16 v[104:107], v[212:215], v[40:43], v[104:107]
  ds_read_b64_tr_b16 v[182:183], v21 offset:55296
  v_mfma_f32_16x16x32_bf16 v[112:115], v[216:219], v[40:43], v[112:115]
  ds_read_b64_tr_b16 v[184:185], v22 offset:53248
  v_mfma_f32_16x16x32_bf16 v[116:119], v[216:219], v[44:47], v[116:119]
  ds_read_b64_tr_b16 v[186:187], v22 offset:55296
  v_readlane_b32 s48, v30, 12
  v_mfma_f32_16x16x32_bf16 v[124:127], v[220:223], v[44:47], v[124:127]
  ds_read_b64_tr_b16 v[188:189], v23 offset:53248
  v_mfma_f32_16x16x32_bf16 v[120:123], v[220:223], v[40:43], v[120:123]
  ds_read_b64_tr_b16 v[190:191], v23 offset:55296
  s_waitcnt vmcnt(18) lgkmcnt(8)
  v_mfma_f32_16x16x32_bf16 v[128:131], v[160:163], v[48:51], v[128:131]
  buffer_load_dwordx4 v[32:35], off, s[36:39], s48 offset:0 sc1
  v_mfma_f32_16x16x32_bf16 v[132:135], v[160:163], v[52:55], v[132:135]
  ds_read_b64_tr_b16 v[192:193], v20 offset:57344
  ds_read_b64_tr_b16 v[194:195], v20 offset:59392
  v_mfma_f32_16x16x32_bf16 v[140:143], v[164:167], v[52:55], v[140:143]
  ds_read_b64_tr_b16 v[196:197], v21 offset:57344
  v_mfma_f32_16x16x32_bf16 v[136:139], v[164:167], v[48:51], v[136:139]
  ds_read_b64_tr_b16 v[198:199], v21 offset:59392
  v_mfma_f32_16x16x32_bf16 v[144:147], v[168:171], v[48:51], v[144:147]
  ds_read_b64_tr_b16 v[200:201], v22 offset:57344
  v_mfma_f32_16x16x32_bf16 v[148:151], v[168:171], v[52:55], v[148:151]
  ds_read_b64_tr_b16 v[202:203], v22 offset:59392
  ds_read_b64_tr_b16 v[204:205], v23 offset:57344
  v_mfma_f32_16x16x32_bf16 v[156:159], v[172:175], v[52:55], v[156:159]
  buffer_load_dwordx4 v[36:39], off, s[64:67], s48 offset:0 sc1
  v_mfma_f32_16x16x32_bf16 v[152:155], v[172:175], v[48:51], v[152:155]
  ds_read_b64_tr_b16 v[206:207], v23 offset:59392
  s_waitcnt vmcnt(18) lgkmcnt(8)
  v_mfma_f32_16x16x32_bf16 v[128:131], v[176:179], v[56:59], v[128:131]
  ds_read_b64_tr_b16 v[208:209], v20 offset:61440
  v_mfma_f32_16x16x32_bf16 v[132:135], v[176:179], v[60:63], v[132:135]
  ds_read_b64_tr_b16 v[210:211], v20 offset:63488
  v_mfma_f32_16x16x32_bf16 v[140:143], v[180:183], v[60:63], v[140:143]
  ds_read_b64_tr_b16 v[212:213], v21 offset:61440
  v_mfma_f32_16x16x32_bf16 v[136:139], v[180:183], v[56:59], v[136:139]
  ds_read_b64_tr_b16 v[214:215], v21 offset:63488
  v_mfma_f32_16x16x32_bf16 v[144:147], v[184:187], v[56:59], v[144:147]
  buffer_load_dwordx4 v[40:43], off, s[36:39], s48 offset:1024 sc1
  v_mfma_f32_16x16x32_bf16 v[148:151], v[184:187], v[60:63], v[148:151]
  ds_read_b64_tr_b16 v[216:217], v22 offset:61440
  ds_read_b64_tr_b16 v[218:219], v22 offset:63488
  v_mfma_f32_16x16x32_bf16 v[156:159], v[188:191], v[60:63], v[156:159]
  ds_read_b64_tr_b16 v[220:221], v23 offset:61440
  v_mfma_f32_16x16x32_bf16 v[152:155], v[188:191], v[56:59], v[152:155]
  ds_read_b64_tr_b16 v[222:223], v23 offset:63488
  s_waitcnt lgkmcnt(8)
  v_mfma_f32_16x16x32_bf16 v[96:99], v[192:195], v[48:51], v[96:99]
  ds_read_b64_tr_b16 v[160:161], v26 offset:0
  v_mfma_f32_16x16x32_bf16 v[100:103], v[192:195], v[52:55], v[100:103]
  ds_read_b64_tr_b16 v[162:163], v26 offset:2048
  v_mfma_f32_16x16x32_bf16 v[108:111], v[196:199], v[52:55], v[108:111]
  buffer_load_dwordx4 v[44:47], off, s[64:67], s48 offset:1024 sc1
  v_mfma_f32_16x16x32_bf16 v[104:107], v[196:199], v[48:51], v[104:107]
  ds_read_b64_tr_b16 v[164:165], v27 offset:0
  ds_read_b64_tr_b16 v[166:167], v27 offset:2048
  v_mfma_f32_16x16x32_bf16 v[112:115], v[200:203], v[48:51], v[112:115]
  ds_read_b64_tr_b16 v[168:169], v28 offset:0
  v_mfma_f32_16x16x32_bf16 v[116:119], v[200:203], v[52:55], v[116:119]
  ds_read_b64_tr_b16 v[170:171], v28 offset:2048
  v_mfma_f32_16x16x32_bf16 v[124:127], v[204:207], v[52:55], v[124:127]
  ds_read_b64_tr_b16 v[172:173], v29 offset:0
  v_mfma_f32_16x16x32_bf16 v[120:123], v[204:207], v[48:51], v[120:123]
  ds_read_b64_tr_b16 v[174:175], v29 offset:2048
  s_waitcnt lgkmcnt(8)
  s_barrier
  v_mfma_f32_16x16x32_bf16 v[96:99], v[208:211], v[56:59], v[96:99]
  ds_read_b64_tr_b16 v[176:177], v26 offset:4096
  v_mfma_f32_16x16x32_bf16 v[100:103], v[208:211], v[60:63], v[100:103]
  ds_read_b64_tr_b16 v[178:179], v26 offset:6144
  v_mfma_f32_16x16x32_bf16 v[108:111], v[212:215], v[60:63], v[108:111]
  ds_read_b64_tr_b16 v[180:181], v27 offset:4096
  v_mfma_f32_16x16x32_bf16 v[104:107], v[212:215], v[56:59], v[104:107]
  ds_read_b64_tr_b16 v[182:183], v27 offset:6144
  v_mfma_f32_16x16x32_bf16 v[112:115], v[216:219], v[56:59], v[112:115]
  ds_read_b64_tr_b16 v[184:185], v28 offset:4096
  v_mfma_f32_16x16x32_bf16 v[116:119], v[216:219], v[60:63], v[116:119]
  ds_read_b64_tr_b16 v[186:187], v28 offset:6144
  v_readlane_b32 s49, v30, 13
  v_mfma_f32_16x16x32_bf16 v[124:127], v[220:223], v[60:63], v[124:127]
  ds_read_b64_tr_b16 v[188:189], v29 offset:4096
  v_mfma_f32_16x16x32_bf16 v[120:123], v[220:223], v[56:59], v[120:123]
  ds_read_b64_tr_b16 v[190:191], v29 offset:6144
  s_waitcnt vmcnt(18) lgkmcnt(8)
  v_mfma_f32_16x16x32_bf16 v[128:131], v[160:163], v[64:67], v[128:131]
  buffer_load_dwordx4 v[48:51], off, s[36:39], s49 offset:0 sc1
  v_mfma_f32_16x16x32_bf16 v[132:135], v[160:163], v[68:71], v[132:135]
  ds_read_b64_tr_b16 v[192:193], v26 offset:8192
  ds_read_b64_tr_b16 v[194:195], v26 offset:10240
  v_mfma_f32_16x16x32_bf16 v[140:143], v[164:167], v[68:71], v[140:143]
  ds_read_b64_tr_b16 v[196:197], v27 offset:8192
  v_mfma_f32_16x16x32_bf16 v[136:139], v[164:167], v[64:67], v[136:139]
  ds_read_b64_tr_b16 v[198:199], v27 offset:10240
  v_mfma_f32_16x16x32_bf16 v[144:147], v[168:171], v[64:67], v[144:147]
  ds_read_b64_tr_b16 v[200:201], v28 offset:8192
  v_mfma_f32_16x16x32_bf16 v[148:151], v[168:171], v[68:71], v[148:151]
  ds_read_b64_tr_b16 v[202:203], v28 offset:10240
  ds_read_b64_tr_b16 v[204:205], v29 offset:8192
  v_mfma_f32_16x16x32_bf16 v[156:159], v[172:175], v[68:71], v[156:159]
  buffer_load_dwordx4 v[52:55], off, s[64:67], s49 offset:0 sc1
  v_mfma_f32_16x16x32_bf16 v[152:155], v[172:175], v[64:67], v[152:155]
  ds_read_b64_tr_b16 v[206:207], v29 offset:10240
  s_waitcnt vmcnt(18) lgkmcnt(8)
  v_mfma_f32_16x16x32_bf16 v[128:131], v[176:179], v[72:75], v[128:131]
  ds_read_b64_tr_b16 v[208:209], v26 offset:12288
  v_mfma_f32_16x16x32_bf16 v[132:135], v[176:179], v[76:79], v[132:135]
  ds_read_b64_tr_b16 v[210:211], v26 offset:14336
  v_mfma_f32_16x16x32_bf16 v[140:143], v[180:183], v[76:79], v[140:143]
  ds_read_b64_tr_b16 v[212:213], v27 offset:12288
  v_mfma_f32_16x16x32_bf16 v[136:139], v[180:183], v[72:75], v[136:139]
  ds_read_b64_tr_b16 v[214:215], v27 offset:14336
  v_mfma_f32_16x16x32_bf16 v[144:147], v[184:187], v[72:75], v[144:147]
  buffer_load_dwordx4 v[56:59], off, s[36:39], s49 offset:1024 sc1
  v_mfma_f32_16x16x32_bf16 v[148:151], v[184:187], v[76:79], v[148:151]
  ds_read_b64_tr_b16 v[216:217], v28 offset:12288
  ds_read_b64_tr_b16 v[218:219], v28 offset:14336
  v_mfma_f32_16x16x32_bf16 v[156:159], v[188:191], v[76:79], v[156:159]
  ds_read_b64_tr_b16 v[220:221], v29 offset:12288
  v_mfma_f32_16x16x32_bf16 v[152:155], v[188:191], v[72:75], v[152:155]
  ds_read_b64_tr_b16 v[222:223], v29 offset:14336
  s_waitcnt lgkmcnt(8)
  v_mfma_f32_16x16x32_bf16 v[96:99], v[192:195], v[64:67], v[96:99]
  ds_read_b64_tr_b16 v[160:161], v26 offset:16384
  v_mfma_f32_16x16x32_bf16 v[100:103], v[192:195], v[68:71], v[100:103]
  ds_read_b64_tr_b16 v[162:163], v26 offset:18432
  v_mfma_f32_16x16x32_bf16 v[108:111], v[196:199], v[68:71], v[108:111]
  buffer_load_dwordx4 v[60:63], off, s[64:67], s49 offset:1024 sc1
  v_mfma_f32_16x16x32_bf16 v[104:107], v[196:199], v[64:67], v[104:107]
  ds_read_b64_tr_b16 v[164:165], v27 offset:16384
  ds_read_b64_tr_b16 v[166:167], v27 offset:18432
  v_mfma_f32_16x16x32_bf16 v[112:115], v[200:203], v[64:67], v[112:115]
  ds_read_b64_tr_b16 v[168:169], v28 offset:16384
  v_mfma_f32_16x16x32_bf16 v[116:119], v[200:203], v[68:71], v[116:119]
  ds_read_b64_tr_b16 v[170:171], v28 offset:18432
  v_mfma_f32_16x16x32_bf16 v[124:127], v[204:207], v[68:71], v[124:127]
  ds_read_b64_tr_b16 v[172:173], v29 offset:16384
  v_mfma_f32_16x16x32_bf16 v[120:123], v[204:207], v[64:67], v[120:123]
  ds_read_b64_tr_b16 v[174:175], v29 offset:18432
  s_waitcnt lgkmcnt(8)
  v_mfma_f32_16x16x32_bf16 v[96:99], v[208:211], v[72:75], v[96:99]
  ds_read_b64_tr_b16 v[176:177], v26 offset:20480
  v_mfma_f32_16x16x32_bf16 v[100:103], v[208:211], v[76:79], v[100:103]
  ds_read_b64_tr_b16 v[178:179], v26 offset:22528
  v_mfma_f32_16x16x32_bf16 v[108:111], v[212:215], v[76:79], v[108:111]
  ds_read_b64_tr_b16 v[180:181], v27 offset:20480
  v_mfma_f32_16x16x32_bf16 v[104:107], v[212:215], v[72:75], v[104:107]
  ds_read_b64_tr_b16 v[182:183], v27 offset:22528
  v_mfma_f32_16x16x32_bf16 v[112:115], v[216:219], v[72:75], v[112:115]
  ds_read_b64_tr_b16 v[184:185], v28 offset:20480
  v_mfma_f32_16x16x32_bf16 v[116:119], v[216:219], v[76:79], v[116:119]
  ds_read_b64_tr_b16 v[186:187], v28 offset:22528
  v_readlane_b32 s50, v30, 14
  v_mfma_f32_16x16x32_bf16 v[124:127], v[220:223], v[76:79], v[124:127]
  ds_read_b64_tr_b16 v[188:189], v29 offset:20480
  v_mfma_f32_16x16x32_bf16 v[120:123], v[220:223], v[72:75], v[120:123]
  ds_read_b64_tr_b16 v[190:191], v29 offset:22528
  s_waitcnt vmcnt(18) lgkmcnt(8)
  v_mfma_f32_16x16x32_bf16 v[128:131], v[160:163], v[80:83], v[128:131]
  buffer_load_dwordx4 v[64:67], off, s[36:39], s50 offset:0 sc1
  v_mfma_f32_16x16x32_bf16 v[132:135], v[160:163], v[84:87], v[132:135]
  ds_read_b64_tr_b16 v[192:193], v26 offset:24576
  ds_read_b64_tr_b16 v[194:195], v26 offset:26624
  v_mfma_f32_16x16x32_bf16 v[140:143], v[164:167], v[84:87], v[140:143]
  ds_read_b64_tr_b16 v[196:197], v27 offset:24576
  v_mfma_f32_16x16x32_bf16 v[136:139], v[164:167], v[80:83], v[136:139]
  ds_read_b64_tr_b16 v[198:199], v27 offset:26624
  v_mfma_f32_16x16x32_bf16 v[144:147], v[168:171], v[80:83], v[144:147]
  ds_read_b64_tr_b16 v[200:201], v28 offset:24576
  v_mfma_f32_16x16x32_bf16 v[148:151], v[168:171], v[84:87], v[148:151]
  ds_read_b64_tr_b16 v[202:203], v28 offset:26624
  ds_read_b64_tr_b16 v[204:205], v29 offset:24576
  v_mfma_f32_16x16x32_bf16 v[156:159], v[172:175], v[84:87], v[156:159]
  buffer_load_dwordx4 v[68:71], off, s[64:67], s50 offset:0 sc1
  v_mfma_f32_16x16x32_bf16 v[152:155], v[172:175], v[80:83], v[152:155]
  ds_read_b64_tr_b16 v[206:207], v29 offset:26624
  s_waitcnt vmcnt(18) lgkmcnt(8)
  v_mfma_f32_16x16x32_bf16 v[128:131], v[176:179], v[88:91], v[128:131]
  ds_read_b64_tr_b16 v[208:209], v26 offset:28672
  v_mfma_f32_16x16x32_bf16 v[132:135], v[176:179], v[92:95], v[132:135]
  ds_read_b64_tr_b16 v[210:211], v26 offset:30720
  v_mfma_f32_16x16x32_bf16 v[140:143], v[180:183], v[92:95], v[140:143]
  ds_read_b64_tr_b16 v[212:213], v27 offset:28672
  v_mfma_f32_16x16x32_bf16 v[136:139], v[180:183], v[88:91], v[136:139]
  ds_read_b64_tr_b16 v[214:215], v27 offset:30720
  v_mfma_f32_16x16x32_bf16 v[144:147], v[184:187], v[88:91], v[144:147]
  buffer_load_dwordx4 v[72:75], off, s[36:39], s50 offset:1024 sc1
  v_mfma_f32_16x16x32_bf16 v[148:151], v[184:187], v[92:95], v[148:151]
  ds_read_b64_tr_b16 v[216:217], v28 offset:28672
  ds_read_b64_tr_b16 v[218:219], v28 offset:30720
  v_mfma_f32_16x16x32_bf16 v[156:159], v[188:191], v[92:95], v[156:159]
  ds_read_b64_tr_b16 v[220:221], v29 offset:28672
  v_mfma_f32_16x16x32_bf16 v[152:155], v[188:191], v[88:91], v[152:155]
  ds_read_b64_tr_b16 v[222:223], v29 offset:30720
  s_waitcnt lgkmcnt(8)
  v_mfma_f32_16x16x32_bf16 v[96:99], v[192:195], v[80:83], v[96:99]
  ds_read_b64_tr_b16 v[160:161], v6 offset:0
  v_mfma_f32_16x16x32_bf16 v[100:103], v[192:195], v[84:87], v[100:103]
  ds_read_b64_tr_b16 v[162:163], v6 offset:2048
  v_mfma_f32_16x16x32_bf16 v[108:111], v[196:199], v[84:87], v[108:111]
  buffer_load_dwordx4 v[76:79], off, s[64:67], s50 offset:1024 sc1
  v_mfma_f32_16x16x32_bf16 v[104:107], v[196:199], v[80:83], v[104:107]
  ds_read_b64_tr_b16 v[164:165], v7 offset:0
  ds_read_b64_tr_b16 v[166:167], v7 offset:2048
  v_mfma_f32_16x16x32_bf16 v[112:115], v[200:203], v[80:83], v[112:115]
  ds_read_b64_tr_b16 v[168:169], v8 offset:0
  v_mfma_f32_16x16x32_bf16 v[116:119], v[200:203], v[84:87], v[116:119]
  ds_read_b64_tr_b16 v[170:171], v8 offset:2048
  v_mfma_f32_16x16x32_bf16 v[124:127], v[204:207], v[84:87], v[124:127]
  ds_read_b64_tr_b16 v[172:173], v9 offset:0
  v_mfma_f32_16x16x32_bf16 v[120:123], v[204:207], v[80:83], v[120:123]
  ds_read_b64_tr_b16 v[174:175], v9 offset:2048
  s_waitcnt lgkmcnt(8)
  s_barrier
  v_mfma_f32_16x16x32_bf16 v[96:99], v[208:211], v[88:91], v[96:99]
  ds_read_b64_tr_b16 v[176:177], v6 offset:4096
  v_mfma_f32_16x16x32_bf16 v[100:103], v[208:211], v[92:95], v[100:103]
  ds_read_b64_tr_b16 v[178:179], v6 offset:6144
  v_mfma_f32_16x16x32_bf16 v[108:111], v[212:215], v[92:95], v[108:111]
  ds_read_b64_tr_b16 v[180:181], v7 offset:4096
  v_mfma_f32_16x16x32_bf16 v[104:107], v[212:215], v[88:91], v[104:107]
  ds_read_b64_tr_b16 v[182:183], v7 offset:6144
  v_mfma_f32_16x16x32_bf16 v[112:115], v[216:219], v[88:91], v[112:115]
  ds_read_b64_tr_b16 v[184:185], v8 offset:4096
  v_mfma_f32_16x16x32_bf16 v[116:119], v[216:219], v[92:95], v[116:119]
  ds_read_b64_tr_b16 v[186:187], v8 offset:6144
  v_readlane_b32 s51, v30, 15
  v_mfma_f32_16x16x32_bf16 v[124:127], v[220:223], v[92:95], v[124:127]
  ds_read_b64_tr_b16 v[188:189], v9 offset:4096
  v_mfma_f32_16x16x32_bf16 v[120:123], v[220:223], v[88:91], v[120:123]
  ds_read_b64_tr_b16 v[190:191], v9 offset:6144
  s_waitcnt vmcnt(18) lgkmcnt(8)
  v_mfma_f32_16x16x32_bf16 v[128:131], v[160:163], v[224:227], v[128:131]
  buffer_load_dwordx4 v[80:83], off, s[36:39], s51 offset:0 sc1
  v_mfma_f32_16x16x32_bf16 v[132:135], v[160:163], v[228:231], v[132:135]
  ds_read_b64_tr_b16 v[192:193], v6 offset:8192
  ds_read_b64_tr_b16 v[194:195], v6 offset:10240
  v_mfma_f32_16x16x32_bf16 v[140:143], v[164:167], v[228:231], v[140:143]
  ds_read_b64_tr_b16 v[196:197], v7 offset:8192
  v_mfma_f32_16x16x32_bf16 v[136:139], v[164:167], v[224:227], v[136:139]
  ds_read_b64_tr_b16 v[198:199], v7 offset:10240
  v_mfma_f32_16x16x32_bf16 v[144:147], v[168:171], v[224:227], v[144:147]
  ds_read_b64_tr_b16 v[200:201], v8 offset:8192
  v_mfma_f32_16x16x32_bf16 v[148:151], v[168:171], v[228:231], v[148:151]
  ds_read_b64_tr_b16 v[202:203], v8 offset:10240
  ds_read_b64_tr_b16 v[204:205], v9 offset:8192
  v_mfma_f32_16x16x32_bf16 v[156:159], v[172:175], v[228:231], v[156:159]
  buffer_load_dwordx4 v[84:87], off, s[64:67], s51 offset:0 sc1
  v_mfma_f32_16x16x32_bf16 v[152:155], v[172:175], v[224:227], v[152:155]
  ds_read_b64_tr_b16 v[206:207], v9 offset:10240
  s_waitcnt vmcnt(18) lgkmcnt(8)
  v_mfma_f32_16x16x32_bf16 v[128:131], v[176:179], v[232:235], v[128:131]
  ds_read_b64_tr_b16 v[208:209], v6 offset:12288
  v_mfma_f32_16x16x32_bf16 v[132:135], v[176:179], v[236:239], v[132:135]
  ds_read_b64_tr_b16 v[210:211], v6 offset:14336
  v_mfma_f32_16x16x32_bf16 v[140:143], v[180:183], v[236:239], v[140:143]
  ds_read_b64_tr_b16 v[212:213], v7 offset:12288
  v_mfma_f32_16x16x32_bf16 v[136:139], v[180:183], v[232:235], v[136:139]
  ds_read_b64_tr_b16 v[214:215], v7 offset:14336
  v_mfma_f32_16x16x32_bf16 v[144:147], v[184:187], v[232:235], v[144:147]
  buffer_load_dwordx4 v[88:91], off, s[36:39], s51 offset:1024 sc1
  v_mfma_f32_16x16x32_bf16 v[148:151], v[184:187], v[236:239], v[148:151]
  ds_read_b64_tr_b16 v[216:217], v8 offset:12288
  ds_read_b64_tr_b16 v[218:219], v8 offset:14336
  v_mfma_f32_16x16x32_bf16 v[156:159], v[188:191], v[236:239], v[156:159]
  ds_read_b64_tr_b16 v[220:221], v9 offset:12288
  v_mfma_f32_16x16x32_bf16 v[152:155], v[188:191], v[232:235], v[152:155]
  ds_read_b64_tr_b16 v[222:223], v9 offset:14336
  s_waitcnt lgkmcnt(8)
  v_mfma_f32_16x16x32_bf16 v[96:99], v[192:195], v[224:227], v[96:99]
  ds_read_b64_tr_b16 v[160:161], v6 offset:16384
  v_mfma_f32_16x16x32_bf16 v[100:103], v[192:195], v[228:231], v[100:103]
  ds_read_b64_tr_b16 v[162:163], v6 offset:18432
  v_mfma_f32_16x16x32_bf16 v[108:111], v[196:199], v[228:231], v[108:111]
  buffer_load_dwordx4 v[92:95], off, s[64:67], s51 offset:1024 sc1
  v_mfma_f32_16x16x32_bf16 v[104:107], v[196:199], v[224:227], v[104:107]
  ds_read_b64_tr_b16 v[164:165], v7 offset:16384
  ds_read_b64_tr_b16 v[166:167], v7 offset:18432
  v_mfma_f32_16x16x32_bf16 v[112:115], v[200:203], v[224:227], v[112:115]
  ds_read_b64_tr_b16 v[168:169], v8 offset:16384
  v_mfma_f32_16x16x32_bf16 v[116:119], v[200:203], v[228:231], v[116:119]
  ds_read_b64_tr_b16 v[170:171], v8 offset:18432
  v_mfma_f32_16x16x32_bf16 v[124:127], v[204:207], v[228:231], v[124:127]
  ds_read_b64_tr_b16 v[172:173], v9 offset:16384
  v_mfma_f32_16x16x32_bf16 v[120:123], v[204:207], v[224:227], v[120:123]
  ds_read_b64_tr_b16 v[174:175], v9 offset:18432
  s_waitcnt lgkmcnt(8)
  v_mfma_f32_16x16x32_bf16 v[96:99], v[208:211], v[232:235], v[96:99]
  ds_read_b64_tr_b16 v[176:177], v6 offset:20480
  v_mfma_f32_16x16x32_bf16 v[100:103], v[208:211], v[236:239], v[100:103]
  ds_read_b64_tr_b16 v[178:179], v6 offset:22528
  v_mfma_f32_16x16x32_bf16 v[108:111], v[212:215], v[236:239], v[108:111]
  ds_read_b64_tr_b16 v[180:181], v7 offset:20480
  v_mfma_f32_16x16x32_bf16 v[104:107], v[212:215], v[232:235], v[104:107]
  ds_read_b64_tr_b16 v[182:183], v7 offset:22528
  v_mfma_f32_16x16x32_bf16 v[112:115], v[216:219], v[232:235], v[112:115]
  ds_read_b64_tr_b16 v[184:185], v8 offset:20480
  v_mfma_f32_16x16x32_bf16 v[116:119], v[216:219], v[236:239], v[116:119]
  ds_read_b64_tr_b16 v[186:187], v8 offset:22528
  v_readlane_b32 s48, v30, 16
  v_mfma_f32_16x16x32_bf16 v[124:127], v[220:223], v[236:239], v[124:127]
  ds_read_b64_tr_b16 v[188:189], v9 offset:20480
  v_mfma_f32_16x16x32_bf16 v[120:123], v[220:223], v[232:235], v[120:123]
  ds_read_b64_tr_b16 v[190:191], v9 offset:22528
  s_waitcnt vmcnt(18) lgkmcnt(8)
  v_mfma_f32_16x16x32_bf16 v[128:131], v[160:163], v[240:243], v[128:131]
  buffer_load_dwordx4 v[224:227], off, s[36:39], s48 offset:0 sc1
  v_mfma_f32_16x16x32_bf16 v[132:135], v[160:163], v[244:247], v[132:135]
  ds_read_b64_tr_b16 v[192:193], v6 offset:24576
  ds_read_b64_tr_b16 v[194:195], v6 offset:26624
  v_mfma_f32_16x16x32_bf16 v[140:143], v[164:167], v[244:247], v[140:143]
  ds_read_b64_tr_b16 v[196:197], v7 offset:24576
  v_mfma_f32_16x16x32_bf16 v[136:139], v[164:167], v[240:243], v[136:139]
  ds_read_b64_tr_b16 v[198:199], v7 offset:26624
  v_mfma_f32_16x16x32_bf16 v[144:147], v[168:171], v[240:243], v[144:147]
  ds_read_b64_tr_b16 v[200:201], v8 offset:24576
  v_mfma_f32_16x16x32_bf16 v[148:151], v[168:171], v[244:247], v[148:151]
  ds_read_b64_tr_b16 v[202:203], v8 offset:26624
  ds_read_b64_tr_b16 v[204:205], v9 offset:24576
  v_mfma_f32_16x16x32_bf16 v[156:159], v[172:175], v[244:247], v[156:159]
  buffer_load_dwordx4 v[228:231], off, s[64:67], s48 offset:0 sc1
  v_mfma_f32_16x16x32_bf16 v[152:155], v[172:175], v[240:243], v[152:155]
  ds_read_b64_tr_b16 v[206:207], v9 offset:26624
  s_waitcnt vmcnt(18) lgkmcnt(8)
  v_mfma_f32_16x16x32_bf16 v[128:131], v[176:179], v[248:251], v[128:131]
  ds_read_b64_tr_b16 v[208:209], v6 offset:28672
  v_mfma_f32_16x16x32_bf16 v[132:135], v[176:179], v[252:255], v[132:135]
  ds_read_b64_tr_b16 v[210:211], v6 offset:30720
  v_mfma_f32_16x16x32_bf16 v[140:143], v[180:183], v[252:255], v[140:143]
  ds_read_b64_tr_b16 v[212:213], v7 offset:28672
  v_mfma_f32_16x16x32_bf16 v[136:139], v[180:183], v[248:251], v[136:139]
  ds_read_b64_tr_b16 v[214:215], v7 offset:30720
  v_mfma_f32_16x16x32_bf16 v[144:147], v[184:187], v[248:251], v[144:147]
  buffer_load_dwordx4 v[232:235], off, s[36:39], s48 offset:1024 sc1
  v_mfma_f32_16x16x32_bf16 v[148:151], v[184:187], v[252:255], v[148:151]
  ds_read_b64_tr_b16 v[216:217], v8 offset:28672
  ds_read_b64_tr_b16 v[218:219], v8 offset:30720
  v_mfma_f32_16x16x32_bf16 v[156:159], v[188:191], v[252:255], v[156:159]
  ds_read_b64_tr_b16 v[220:221], v9 offset:28672
  v_mfma_f32_16x16x32_bf16 v[152:155], v[188:191], v[248:251], v[152:155]
  ds_read_b64_tr_b16 v[222:223], v9 offset:30720
  s_waitcnt lgkmcnt(8)
  v_mfma_f32_16x16x32_bf16 v[96:99], v[192:195], v[240:243], v[96:99]
  ds_read_b64_tr_b16 v[160:161], v6 offset:32768
  v_mfma_f32_16x16x32_bf16 v[100:103], v[192:195], v[244:247], v[100:103]
  ds_read_b64_tr_b16 v[162:163], v6 offset:34816
  v_mfma_f32_16x16x32_bf16 v[108:111], v[196:199], v[244:247], v[108:111]
  buffer_load_dwordx4 v[236:239], off, s[64:67], s48 offset:1024 sc1
  v_mfma_f32_16x16x32_bf16 v[104:107], v[196:199], v[240:243], v[104:107]
  ds_read_b64_tr_b16 v[164:165], v7 offset:32768
  ds_read_b64_tr_b16 v[166:167], v7 offset:34816
  v_mfma_f32_16x16x32_bf16 v[112:115], v[200:203], v[240:243], v[112:115]
  ds_read_b64_tr_b16 v[168:169], v8 offset:32768
  v_mfma_f32_16x16x32_bf16 v[116:119], v[200:203], v[244:247], v[116:119]
  ds_read_b64_tr_b16 v[170:171], v8 offset:34816
  v_mfma_f32_16x16x32_bf16 v[124:127], v[204:207], v[244:247], v[124:127]
  ds_read_b64_tr_b16 v[172:173], v9 offset:32768
  v_mfma_f32_16x16x32_bf16 v[120:123], v[204:207], v[240:243], v[120:123]
  ds_read_b64_tr_b16 v[174:175], v9 offset:34816
  s_waitcnt lgkmcnt(8)
  s_barrier
  v_mfma_f32_16x16x32_bf16 v[96:99], v[208:211], v[248:251], v[96:99]
  ds_read_b64_tr_b16 v[176:177], v6 offset:36864
  v_mfma_f32_16x16x32_bf16 v[100:103], v[208:211], v[252:255], v[100:103]
  ds_read_b64_tr_b16 v[178:179], v6 offset:38912
  v_mfma_f32_16x16x32_bf16 v[108:111], v[212:215], v[252:255], v[108:111]
  ds_read_b64_tr_b16 v[180:181], v7 offset:36864
  v_mfma_f32_16x16x32_bf16 v[104:107], v[212:215], v[248:251], v[104:107]
  ds_read_b64_tr_b16 v[182:183], v7 offset:38912
  v_mfma_f32_16x16x32_bf16 v[112:115], v[216:219], v[248:251], v[112:115]
  ds_read_b64_tr_b16 v[184:185], v8 offset:36864
  v_mfma_f32_16x16x32_bf16 v[116:119], v[216:219], v[252:255], v[116:119]
  ds_read_b64_tr_b16 v[186:187], v8 offset:38912
  v_readlane_b32 s49, v30, 17
  v_mfma_f32_16x16x32_bf16 v[124:127], v[220:223], v[252:255], v[124:127]
  ds_read_b64_tr_b16 v[188:189], v9 offset:36864
  v_mfma_f32_16x16x32_bf16 v[120:123], v[220:223], v[248:251], v[120:123]
  ds_read_b64_tr_b16 v[190:191], v9 offset:38912
  s_waitcnt vmcnt(18) lgkmcnt(8)
  v_mfma_f32_16x16x32_bf16 v[128:131], v[160:163], v[32:35], v[128:131]
  buffer_load_dwordx4 v[240:243], off, s[36:39], s49 offset:0 sc1
  v_mfma_f32_16x16x32_bf16 v[132:135], v[160:163], v[36:39], v[132:135]
  ds_read_b64_tr_b16 v[192:193], v6 offset:40960
  ds_read_b64_tr_b16 v[194:195], v6 offset:43008
  v_mfma_f32_16x16x32_bf16 v[140:143], v[164:167], v[36:39], v[140:143]
  ds_read_b64_tr_b16 v[196:197], v7 offset:40960
  v_mfma_f32_16x16x32_bf16 v[136:139], v[164:167], v[32:35], v[136:139]
  ds_read_b64_tr_b16 v[198:199], v7 offset:43008
  v_mfma_f32_16x16x32_bf16 v[144:147], v[168:171], v[32:35], v[144:147]
  ds_read_b64_tr_b16 v[200:201], v8 offset:40960
  v_mfma_f32_16x16x32_bf16 v[148:151], v[168:171], v[36:39], v[148:151]
  ds_read_b64_tr_b16 v[202:203], v8 offset:43008
  ds_read_b64_tr_b16 v[204:205], v9 offset:40960
  v_mfma_f32_16x16x32_bf16 v[156:159], v[172:175], v[36:39], v[156:159]
  buffer_load_dwordx4 v[244:247], off, s[64:67], s49 offset:0 sc1
  v_mfma_f32_16x16x32_bf16 v[152:155], v[172:175], v[32:35], v[152:155]
  ds_read_b64_tr_b16 v[206:207], v9 offset:43008
  s_waitcnt vmcnt(18) lgkmcnt(8)
  v_mfma_f32_16x16x32_bf16 v[128:131], v[176:179], v[40:43], v[128:131]
  ds_read_b64_tr_b16 v[208:209], v6 offset:45056
  v_mfma_f32_16x16x32_bf16 v[132:135], v[176:179], v[44:47], v[132:135]
  ds_read_b64_tr_b16 v[210:211], v6 offset:47104
  v_mfma_f32_16x16x32_bf16 v[140:143], v[180:183], v[44:47], v[140:143]
  ds_read_b64_tr_b16 v[212:213], v7 offset:45056
  v_mfma_f32_16x16x32_bf16 v[136:139], v[180:183], v[40:43], v[136:139]
  ds_read_b64_tr_b16 v[214:215], v7 offset:47104
  v_mfma_f32_16x16x32_bf16 v[144:147], v[184:187], v[40:43], v[144:147]
  buffer_load_dwordx4 v[248:251], off, s[36:39], s49 offset:1024 sc1
  v_mfma_f32_16x16x32_bf16 v[148:151], v[184:187], v[44:47], v[148:151]
  ds_read_b64_tr_b16 v[216:217], v8 offset:45056
  ds_read_b64_tr_b16 v[218:219], v8 offset:47104
  v_mfma_f32_16x16x32_bf16 v[156:159], v[188:191], v[44:47], v[156:159]
  ds_read_b64_tr_b16 v[220:221], v9 offset:45056
  v_mfma_f32_16x16x32_bf16 v[152:155], v[188:191], v[40:43], v[152:155]
  ds_read_b64_tr_b16 v[222:223], v9 offset:47104
  s_waitcnt lgkmcnt(8)
  v_mfma_f32_16x16x32_bf16 v[96:99], v[192:195], v[32:35], v[96:99]
  ds_read_b64_tr_b16 v[160:161], v6 offset:49152
  v_mfma_f32_16x16x32_bf16 v[100:103], v[192:195], v[36:39], v[100:103]
  ds_read_b64_tr_b16 v[162:163], v6 offset:51200
  v_mfma_f32_16x16x32_bf16 v[108:111], v[196:199], v[36:39], v[108:111]
  buffer_load_dwordx4 v[252:255], off, s[64:67], s49 offset:1024 sc1
  v_mfma_f32_16x16x32_bf16 v[104:107], v[196:199], v[32:35], v[104:107]
  ds_read_b64_tr_b16 v[164:165], v7 offset:49152
  ds_read_b64_tr_b16 v[166:167], v7 offset:51200
  v_mfma_f32_16x16x32_bf16 v[112:115], v[200:203], v[32:35], v[112:115]
  ds_read_b64_tr_b16 v[168:169], v8 offset:49152
  v_mfma_f32_16x16x32_bf16 v[116:119], v[200:203], v[36:39], v[116:119]
  ds_read_b64_tr_b16 v[170:171], v8 offset:51200
  v_mfma_f32_16x16x32_bf16 v[124:127], v[204:207], v[36:39], v[124:127]
  ds_read_b64_tr_b16 v[172:173], v9 offset:49152
  v_mfma_f32_16x16x32_bf16 v[120:123], v[204:207], v[32:35], v[120:123]
  ds_read_b64_tr_b16 v[174:175], v9 offset:51200
  s_waitcnt lgkmcnt(8)
  v_mfma_f32_16x16x32_bf16 v[96:99], v[208:211], v[40:43], v[96:99]
  ds_read_b64_tr_b16 v[176:177], v6 offset:53248
  v_mfma_f32_16x16x32_bf16 v[100:103], v[208:211], v[44:47], v[100:103]
  ds_read_b64_tr_b16 v[178:179], v6 offset:55296
  v_mfma_f32_16x16x32_bf16 v[108:111], v[212:215], v[44:47], v[108:111]
  ds_read_b64_tr_b16 v[180:181], v7 offset:53248
  v_mfma_f32_16x16x32_bf16 v[104:107], v[212:215], v[40:43], v[104:107]
  ds_read_b64_tr_b16 v[182:183], v7 offset:55296
  v_mfma_f32_16x16x32_bf16 v[112:115], v[216:219], v[40:43], v[112:115]
  ds_read_b64_tr_b16 v[184:185], v8 offset:53248
  v_mfma_f32_16x16x32_bf16 v[116:119], v[216:219], v[44:47], v[116:119]
  ds_read_b64_tr_b16 v[186:187], v8 offset:55296
  v_readlane_b32 s50, v30, 18
  v_mfma_f32_16x16x32_bf16 v[124:127], v[220:223], v[44:47], v[124:127]
  ds_read_b64_tr_b16 v[188:189], v9 offset:53248
  v_mfma_f32_16x16x32_bf16 v[120:123], v[220:223], v[40:43], v[120:123]
  ds_read_b64_tr_b16 v[190:191], v9 offset:55296
  s_waitcnt vmcnt(18) lgkmcnt(8)
  v_mfma_f32_16x16x32_bf16 v[128:131], v[160:163], v[48:51], v[128:131]
  buffer_load_dwordx4 v[32:35], off, s[36:39], s50 offset:0 sc1
  v_mfma_f32_16x16x32_bf16 v[132:135], v[160:163], v[52:55], v[132:135]
  ds_read_b64_tr_b16 v[192:193], v6 offset:57344
  ds_read_b64_tr_b16 v[194:195], v6 offset:59392
  v_mfma_f32_16x16x32_bf16 v[140:143], v[164:167], v[52:55], v[140:143]
  ds_read_b64_tr_b16 v[196:197], v7 offset:57344
  v_mfma_f32_16x16x32_bf16 v[136:139], v[164:167], v[48:51], v[136:139]
  ds_read_b64_tr_b16 v[198:199], v7 offset:59392
  v_mfma_f32_16x16x32_bf16 v[144:147], v[168:171], v[48:51], v[144:147]
  ds_read_b64_tr_b16 v[200:201], v8 offset:57344
  v_mfma_f32_16x16x32_bf16 v[148:151], v[168:171], v[52:55], v[148:151]
  ds_read_b64_tr_b16 v[202:203], v8 offset:59392
  ds_read_b64_tr_b16 v[204:205], v9 offset:57344
  v_mfma_f32_16x16x32_bf16 v[156:159], v[172:175], v[52:55], v[156:159]
  buffer_load_dwordx4 v[36:39], off, s[64:67], s50 offset:0 sc1
  v_mfma_f32_16x16x32_bf16 v[152:155], v[172:175], v[48:51], v[152:155]
  ds_read_b64_tr_b16 v[206:207], v9 offset:59392
  s_waitcnt vmcnt(18) lgkmcnt(8)
  v_mfma_f32_16x16x32_bf16 v[128:131], v[176:179], v[56:59], v[128:131]
  ds_read_b64_tr_b16 v[208:209], v6 offset:61440
  v_mfma_f32_16x16x32_bf16 v[132:135], v[176:179], v[60:63], v[132:135]
  ds_read_b64_tr_b16 v[210:211], v6 offset:63488
  v_mfma_f32_16x16x32_bf16 v[140:143], v[180:183], v[60:63], v[140:143]
  ds_read_b64_tr_b16 v[212:213], v7 offset:61440
  v_mfma_f32_16x16x32_bf16 v[136:139], v[180:183], v[56:59], v[136:139]
  ds_read_b64_tr_b16 v[214:215], v7 offset:63488
  v_mfma_f32_16x16x32_bf16 v[144:147], v[184:187], v[56:59], v[144:147]
  buffer_load_dwordx4 v[40:43], off, s[36:39], s50 offset:1024 sc1
  v_mfma_f32_16x16x32_bf16 v[148:151], v[184:187], v[60:63], v[148:151]
  ds_read_b64_tr_b16 v[216:217], v8 offset:61440
  ds_read_b64_tr_b16 v[218:219], v8 offset:63488
  v_mfma_f32_16x16x32_bf16 v[156:159], v[188:191], v[60:63], v[156:159]
  ds_read_b64_tr_b16 v[220:221], v9 offset:61440
  v_mfma_f32_16x16x32_bf16 v[152:155], v[188:191], v[56:59], v[152:155]
  ds_read_b64_tr_b16 v[222:223], v9 offset:63488
  s_waitcnt lgkmcnt(8)
  v_mfma_f32_16x16x32_bf16 v[96:99], v[192:195], v[48:51], v[96:99]
  ds_read_b64_tr_b16 v[160:161], v20 offset:0
  v_mfma_f32_16x16x32_bf16 v[100:103], v[192:195], v[52:55], v[100:103]
  ds_read_b64_tr_b16 v[162:163], v20 offset:2048
  v_mfma_f32_16x16x32_bf16 v[108:111], v[196:199], v[52:55], v[108:111]
  buffer_load_dwordx4 v[44:47], off, s[64:67], s50 offset:1024 sc1
  v_mfma_f32_16x16x32_bf16 v[104:107], v[196:199], v[48:51], v[104:107]
  ds_read_b64_tr_b16 v[164:165], v21 offset:0
  ds_read_b64_tr_b16 v[166:167], v21 offset:2048
  v_mfma_f32_16x16x32_bf16 v[112:115], v[200:203], v[48:51], v[112:115]
  ds_read_b64_tr_b16 v[168:169], v22 offset:0
  v_mfma_f32_16x16x32_bf16 v[116:119], v[200:203], v[52:55], v[116:119]
  ds_read_b64_tr_b16 v[170:171], v22 offset:2048
  v_mfma_f32_16x16x32_bf16 v[124:127], v[204:207], v[52:55], v[124:127]
  ds_read_b64_tr_b16 v[172:173], v23 offset:0
  v_mfma_f32_16x16x32_bf16 v[120:123], v[204:207], v[48:51], v[120:123]
  ds_read_b64_tr_b16 v[174:175], v23 offset:2048
  s_waitcnt lgkmcnt(8)
  s_barrier
  v_mfma_f32_16x16x32_bf16 v[96:99], v[208:211], v[56:59], v[96:99]
  ds_read_b64_tr_b16 v[176:177], v20 offset:4096
  v_mfma_f32_16x16x32_bf16 v[100:103], v[208:211], v[60:63], v[100:103]
  ds_read_b64_tr_b16 v[178:179], v20 offset:6144
  v_mfma_f32_16x16x32_bf16 v[108:111], v[212:215], v[60:63], v[108:111]
  ds_read_b64_tr_b16 v[180:181], v21 offset:4096
  v_mfma_f32_16x16x32_bf16 v[104:107], v[212:215], v[56:59], v[104:107]
  ds_read_b64_tr_b16 v[182:183], v21 offset:6144
  v_mfma_f32_16x16x32_bf16 v[112:115], v[216:219], v[56:59], v[112:115]
  ds_read_b64_tr_b16 v[184:185], v22 offset:4096
  v_mfma_f32_16x16x32_bf16 v[116:119], v[216:219], v[60:63], v[116:119]
  ds_read_b64_tr_b16 v[186:187], v22 offset:6144
  v_readlane_b32 s51, v30, 19
  v_mfma_f32_16x16x32_bf16 v[124:127], v[220:223], v[60:63], v[124:127]
  ds_read_b64_tr_b16 v[188:189], v23 offset:4096
  v_mfma_f32_16x16x32_bf16 v[120:123], v[220:223], v[56:59], v[120:123]
  ds_read_b64_tr_b16 v[190:191], v23 offset:6144
  s_waitcnt vmcnt(18) lgkmcnt(8)
  v_mfma_f32_16x16x32_bf16 v[128:131], v[160:163], v[64:67], v[128:131]
  buffer_load_dwordx4 v[48:51], off, s[36:39], s51 offset:0 sc1
  v_mfma_f32_16x16x32_bf16 v[132:135], v[160:163], v[68:71], v[132:135]
  ds_read_b64_tr_b16 v[192:193], v20 offset:8192
  ds_read_b64_tr_b16 v[194:195], v20 offset:10240
  v_mfma_f32_16x16x32_bf16 v[140:143], v[164:167], v[68:71], v[140:143]
  ds_read_b64_tr_b16 v[196:197], v21 offset:8192
  v_mfma_f32_16x16x32_bf16 v[136:139], v[164:167], v[64:67], v[136:139]
  ds_read_b64_tr_b16 v[198:199], v21 offset:10240
  v_mfma_f32_16x16x32_bf16 v[144:147], v[168:171], v[64:67], v[144:147]
  ds_read_b64_tr_b16 v[200:201], v22 offset:8192
  v_mfma_f32_16x16x32_bf16 v[148:151], v[168:171], v[68:71], v[148:151]
  ds_read_b64_tr_b16 v[202:203], v22 offset:10240
  ds_read_b64_tr_b16 v[204:205], v23 offset:8192
  v_mfma_f32_16x16x32_bf16 v[156:159], v[172:175], v[68:71], v[156:159]
  buffer_load_dwordx4 v[52:55], off, s[64:67], s51 offset:0 sc1
  v_mfma_f32_16x16x32_bf16 v[152:155], v[172:175], v[64:67], v[152:155]
  ds_read_b64_tr_b16 v[206:207], v23 offset:10240
  s_waitcnt vmcnt(18) lgkmcnt(8)
  v_mfma_f32_16x16x32_bf16 v[128:131], v[176:179], v[72:75], v[128:131]
  ds_read_b64_tr_b16 v[208:209], v20 offset:12288
  v_mfma_f32_16x16x32_bf16 v[132:135], v[176:179], v[76:79], v[132:135]
  ds_read_b64_tr_b16 v[210:211], v20 offset:14336
  v_mfma_f32_16x16x32_bf16 v[140:143], v[180:183], v[76:79], v[140:143]
  ds_read_b64_tr_b16 v[212:213], v21 offset:12288
  v_mfma_f32_16x16x32_bf16 v[136:139], v[180:183], v[72:75], v[136:139]
  ds_read_b64_tr_b16 v[214:215], v21 offset:14336
  v_mfma_f32_16x16x32_bf16 v[144:147], v[184:187], v[72:75], v[144:147]
  buffer_load_dwordx4 v[56:59], off, s[36:39], s51 offset:1024 sc1
  v_mfma_f32_16x16x32_bf16 v[148:151], v[184:187], v[76:79], v[148:151]
  ds_read_b64_tr_b16 v[216:217], v22 offset:12288
  ds_read_b64_tr_b16 v[218:219], v22 offset:14336
  v_mfma_f32_16x16x32_bf16 v[156:159], v[188:191], v[76:79], v[156:159]
  ds_read_b64_tr_b16 v[220:221], v23 offset:12288
  v_mfma_f32_16x16x32_bf16 v[152:155], v[188:191], v[72:75], v[152:155]
  ds_read_b64_tr_b16 v[222:223], v23 offset:14336
  s_waitcnt lgkmcnt(8)
  v_mfma_f32_16x16x32_bf16 v[96:99], v[192:195], v[64:67], v[96:99]
  ds_read_b64_tr_b16 v[160:161], v20 offset:16384
  v_mfma_f32_16x16x32_bf16 v[100:103], v[192:195], v[68:71], v[100:103]
  ds_read_b64_tr_b16 v[162:163], v20 offset:18432
  v_mfma_f32_16x16x32_bf16 v[108:111], v[196:199], v[68:71], v[108:111]
  buffer_load_dwordx4 v[60:63], off, s[64:67], s51 offset:1024 sc1
  v_mfma_f32_16x16x32_bf16 v[104:107], v[196:199], v[64:67], v[104:107]
  ds_read_b64_tr_b16 v[164:165], v21 offset:16384
  ds_read_b64_tr_b16 v[166:167], v21 offset:18432
  v_mfma_f32_16x16x32_bf16 v[112:115], v[200:203], v[64:67], v[112:115]
  ds_read_b64_tr_b16 v[168:169], v22 offset:16384
  v_mfma_f32_16x16x32_bf16 v[116:119], v[200:203], v[68:71], v[116:119]
  ds_read_b64_tr_b16 v[170:171], v22 offset:18432
  v_mfma_f32_16x16x32_bf16 v[124:127], v[204:207], v[68:71], v[124:127]
  ds_read_b64_tr_b16 v[172:173], v23 offset:16384
  v_mfma_f32_16x16x32_bf16 v[120:123], v[204:207], v[64:67], v[120:123]
  ds_read_b64_tr_b16 v[174:175], v23 offset:18432
  s_waitcnt lgkmcnt(8)
  v_mfma_f32_16x16x32_bf16 v[96:99], v[208:211], v[72:75], v[96:99]
  ds_read_b64_tr_b16 v[176:177], v20 offset:20480
  v_mfma_f32_16x16x32_bf16 v[100:103], v[208:211], v[76:79], v[100:103]
  ds_read_b64_tr_b16 v[178:179], v20 offset:22528
  v_mfma_f32_16x16x32_bf16 v[108:111], v[212:215], v[76:79], v[108:111]
  ds_read_b64_tr_b16 v[180:181], v21 offset:20480
  v_mfma_f32_16x16x32_bf16 v[104:107], v[212:215], v[72:75], v[104:107]
  ds_read_b64_tr_b16 v[182:183], v21 offset:22528
  v_mfma_f32_16x16x32_bf16 v[112:115], v[216:219], v[72:75], v[112:115]
  ds_read_b64_tr_b16 v[184:185], v22 offset:20480
  v_mfma_f32_16x16x32_bf16 v[116:119], v[216:219], v[76:79], v[116:119]
  ds_read_b64_tr_b16 v[186:187], v22 offset:22528
  v_readlane_b32 s48, v30, 20
  v_mfma_f32_16x16x32_bf16 v[124:127], v[220:223], v[76:79], v[124:127]
  ds_read_b64_tr_b16 v[188:189], v23 offset:20480
  v_mfma_f32_16x16x32_bf16 v[120:123], v[220:223], v[72:75], v[120:123]
  ds_read_b64_tr_b16 v[190:191], v23 offset:22528
  s_waitcnt vmcnt(18) lgkmcnt(8)
  v_mfma_f32_16x16x32_bf16 v[128:131], v[160:163], v[80:83], v[128:131]
  buffer_load_dwordx4 v[64:67], off, s[36:39], s48 offset:0 sc1
  v_mfma_f32_16x16x32_bf16 v[132:135], v[160:163], v[84:87], v[132:135]
  ds_read_b64_tr_b16 v[192:193], v20 offset:24576
  ds_read_b64_tr_b16 v[194:195], v20 offset:26624
  v_mfma_f32_16x16x32_bf16 v[140:143], v[164:167], v[84:87], v[140:143]
  ds_read_b64_tr_b16 v[196:197], v21 offset:24576
  v_mfma_f32_16x16x32_bf16 v[136:139], v[164:167], v[80:83], v[136:139]
  ds_read_b64_tr_b16 v[198:199], v21 offset:26624
  v_mfma_f32_16x16x32_bf16 v[144:147], v[168:171], v[80:83], v[144:147]
  ds_read_b64_tr_b16 v[200:201], v22 offset:24576
  v_mfma_f32_16x16x32_bf16 v[148:151], v[168:171], v[84:87], v[148:151]
  ds_read_b64_tr_b16 v[202:203], v22 offset:26624
  ds_read_b64_tr_b16 v[204:205], v23 offset:24576
  v_mfma_f32_16x16x32_bf16 v[156:159], v[172:175], v[84:87], v[156:159]
  buffer_load_dwordx4 v[68:71], off, s[64:67], s48 offset:0 sc1
  v_mfma_f32_16x16x32_bf16 v[152:155], v[172:175], v[80:83], v[152:155]
  ds_read_b64_tr_b16 v[206:207], v23 offset:26624
  s_waitcnt vmcnt(18) lgkmcnt(8)
  v_mfma_f32_16x16x32_bf16 v[128:131], v[176:179], v[88:91], v[128:131]
  ds_read_b64_tr_b16 v[208:209], v20 offset:28672
  v_mfma_f32_16x16x32_bf16 v[132:135], v[176:179], v[92:95], v[132:135]
  ds_read_b64_tr_b16 v[210:211], v20 offset:30720
  v_mfma_f32_16x16x32_bf16 v[140:143], v[180:183], v[92:95], v[140:143]
  ds_read_b64_tr_b16 v[212:213], v21 offset:28672
  v_mfma_f32_16x16x32_bf16 v[136:139], v[180:183], v[88:91], v[136:139]
  ds_read_b64_tr_b16 v[214:215], v21 offset:30720
  v_mfma_f32_16x16x32_bf16 v[144:147], v[184:187], v[88:91], v[144:147]
  buffer_load_dwordx4 v[72:75], off, s[36:39], s48 offset:1024 sc1
  v_mfma_f32_16x16x32_bf16 v[148:151], v[184:187], v[92:95], v[148:151]
  ds_read_b64_tr_b16 v[216:217], v22 offset:28672
  ds_read_b64_tr_b16 v[218:219], v22 offset:30720
  v_mfma_f32_16x16x32_bf16 v[156:159], v[188:191], v[92:95], v[156:159]
  ds_read_b64_tr_b16 v[220:221], v23 offset:28672
  v_mfma_f32_16x16x32_bf16 v[152:155], v[188:191], v[88:91], v[152:155]
  ds_read_b64_tr_b16 v[222:223], v23 offset:30720
  s_waitcnt lgkmcnt(8)
  v_mfma_f32_16x16x32_bf16 v[96:99], v[192:195], v[80:83], v[96:99]
  ds_read_b64_tr_b16 v[160:161], v20 offset:32768
  v_mfma_f32_16x16x32_bf16 v[100:103], v[192:195], v[84:87], v[100:103]
  ds_read_b64_tr_b16 v[162:163], v20 offset:34816
  v_mfma_f32_16x16x32_bf16 v[108:111], v[196:199], v[84:87], v[108:111]
  buffer_load_dwordx4 v[76:79], off, s[64:67], s48 offset:1024 sc1
  v_mfma_f32_16x16x32_bf16 v[104:107], v[196:199], v[80:83], v[104:107]
  ds_read_b64_tr_b16 v[164:165], v21 offset:32768
  ds_read_b64_tr_b16 v[166:167], v21 offset:34816
  v_mfma_f32_16x16x32_bf16 v[112:115], v[200:203], v[80:83], v[112:115]
  ds_read_b64_tr_b16 v[168:169], v22 offset:32768
  v_mfma_f32_16x16x32_bf16 v[116:119], v[200:203], v[84:87], v[116:119]
  ds_read_b64_tr_b16 v[170:171], v22 offset:34816
  v_mfma_f32_16x16x32_bf16 v[124:127], v[204:207], v[84:87], v[124:127]
  ds_read_b64_tr_b16 v[172:173], v23 offset:32768
  v_mfma_f32_16x16x32_bf16 v[120:123], v[204:207], v[80:83], v[120:123]
  ds_read_b64_tr_b16 v[174:175], v23 offset:34816
  s_waitcnt lgkmcnt(8)
  s_barrier
  v_mfma_f32_16x16x32_bf16 v[96:99], v[208:211], v[88:91], v[96:99]
  ds_read_b64_tr_b16 v[176:177], v20 offset:36864
  v_mfma_f32_16x16x32_bf16 v[100:103], v[208:211], v[92:95], v[100:103]
  ds_read_b64_tr_b16 v[178:179], v20 offset:38912
  v_mfma_f32_16x16x32_bf16 v[108:111], v[212:215], v[92:95], v[108:111]
  ds_read_b64_tr_b16 v[180:181], v21 offset:36864
  v_mfma_f32_16x16x32_bf16 v[104:107], v[212:215], v[88:91], v[104:107]
  ds_read_b64_tr_b16 v[182:183], v21 offset:38912
  v_mfma_f32_16x16x32_bf16 v[112:115], v[216:219], v[88:91], v[112:115]
  ds_read_b64_tr_b16 v[184:185], v22 offset:36864
  v_mfma_f32_16x16x32_bf16 v[116:119], v[216:219], v[92:95], v[116:119]
  ds_read_b64_tr_b16 v[186:187], v22 offset:38912
  v_readlane_b32 s49, v30, 21
  v_mfma_f32_16x16x32_bf16 v[124:127], v[220:223], v[92:95], v[124:127]
  ds_read_b64_tr_b16 v[188:189], v23 offset:36864
  v_mfma_f32_16x16x32_bf16 v[120:123], v[220:223], v[88:91], v[120:123]
  ds_read_b64_tr_b16 v[190:191], v23 offset:38912
  s_waitcnt vmcnt(18) lgkmcnt(8)
  v_mfma_f32_16x16x32_bf16 v[128:131], v[160:163], v[224:227], v[128:131]
  buffer_load_dwordx4 v[80:83], off, s[36:39], s49 offset:0 sc1
  v_mfma_f32_16x16x32_bf16 v[132:135], v[160:163], v[228:231], v[132:135]
  ds_read_b64_tr_b16 v[192:193], v20 offset:40960
  ds_read_b64_tr_b16 v[194:195], v20 offset:43008
  v_mfma_f32_16x16x32_bf16 v[140:143], v[164:167], v[228:231], v[140:143]
  ds_read_b64_tr_b16 v[196:197], v21 offset:40960
  v_mfma_f32_16x16x32_bf16 v[136:139], v[164:167], v[224:227], v[136:139]
  ds_read_b64_tr_b16 v[198:199], v21 offset:43008
  v_mfma_f32_16x16x32_bf16 v[144:147], v[168:171], v[224:227], v[144:147]
  ds_read_b64_tr_b16 v[200:201], v22 offset:40960
  v_mfma_f32_16x16x32_bf16 v[148:151], v[168:171], v[228:231], v[148:151]
  ds_read_b64_tr_b16 v[202:203], v22 offset:43008
  ds_read_b64_tr_b16 v[204:205], v23 offset:40960
  v_mfma_f32_16x16x32_bf16 v[156:159], v[172:175], v[228:231], v[156:159]
  buffer_load_dwordx4 v[84:87], off, s[64:67], s49 offset:0 sc1
  v_mfma_f32_16x16x32_bf16 v[152:155], v[172:175], v[224:227], v[152:155]
  ds_read_b64_tr_b16 v[206:207], v23 offset:43008
  s_waitcnt vmcnt(18) lgkmcnt(8)
  v_mfma_f32_16x16x32_bf16 v[128:131], v[176:179], v[232:235], v[128:131]
  ds_read_b64_tr_b16 v[208:209], v20 offset:45056
  v_mfma_f32_16x16x32_bf16 v[132:135], v[176:179], v[236:239], v[132:135]
  ds_read_b64_tr_b16 v[210:211], v20 offset:47104
  v_mfma_f32_16x16x32_bf16 v[140:143], v[180:183], v[236:239], v[140:143]
  ds_read_b64_tr_b16 v[212:213], v21 offset:45056
  v_mfma_f32_16x16x32_bf16 v[136:139], v[180:183], v[232:235], v[136:139]
  ds_read_b64_tr_b16 v[214:215], v21 offset:47104
  v_mfma_f32_16x16x32_bf16 v[144:147], v[184:187], v[232:235], v[144:147]
  buffer_load_dwordx4 v[88:91], off, s[36:39], s49 offset:1024 sc1
  v_mfma_f32_16x16x32_bf16 v[148:151], v[184:187], v[236:239], v[148:151]
  ds_read_b64_tr_b16 v[216:217], v22 offset:45056
  ds_read_b64_tr_b16 v[218:219], v22 offset:47104
  v_mfma_f32_16x16x32_bf16 v[156:159], v[188:191], v[236:239], v[156:159]
  ds_read_b64_tr_b16 v[220:221], v23 offset:45056
  v_mfma_f32_16x16x32_bf16 v[152:155], v[188:191], v[232:235], v[152:155]
  ds_read_b64_tr_b16 v[222:223], v23 offset:47104
  s_waitcnt lgkmcnt(8)
  v_mfma_f32_16x16x32_bf16 v[96:99], v[192:195], v[224:227], v[96:99]
  ds_read_b64_tr_b16 v[160:161], v20 offset:49152
  v_mfma_f32_16x16x32_bf16 v[100:103], v[192:195], v[228:231], v[100:103]
  ds_read_b64_tr_b16 v[162:163], v20 offset:51200
  v_mfma_f32_16x16x32_bf16 v[108:111], v[196:199], v[228:231], v[108:111]
  buffer_load_dwordx4 v[92:95], off, s[64:67], s49 offset:1024 sc1
  v_mfma_f32_16x16x32_bf16 v[104:107], v[196:199], v[224:227], v[104:107]
  ds_read_b64_tr_b16 v[164:165], v21 offset:49152
  ds_read_b64_tr_b16 v[166:167], v21 offset:51200
  v_mfma_f32_16x16x32_bf16 v[112:115], v[200:203], v[224:227], v[112:115]
  ds_read_b64_tr_b16 v[168:169], v22 offset:49152
  v_mfma_f32_16x16x32_bf16 v[116:119], v[200:203], v[228:231], v[116:119]
  ds_read_b64_tr_b16 v[170:171], v22 offset:51200
  v_mfma_f32_16x16x32_bf16 v[124:127], v[204:207], v[228:231], v[124:127]
  ds_read_b64_tr_b16 v[172:173], v23 offset:49152
  v_mfma_f32_16x16x32_bf16 v[120:123], v[204:207], v[224:227], v[120:123]
  ds_read_b64_tr_b16 v[174:175], v23 offset:51200
  s_waitcnt lgkmcnt(8)
  v_mfma_f32_16x16x32_bf16 v[96:99], v[208:211], v[232:235], v[96:99]
  ds_read_b64_tr_b16 v[176:177], v20 offset:53248
  v_mfma_f32_16x16x32_bf16 v[100:103], v[208:211], v[236:239], v[100:103]
  ds_read_b64_tr_b16 v[178:179], v20 offset:55296
  v_mfma_f32_16x16x32_bf16 v[108:111], v[212:215], v[236:239], v[108:111]
  ds_read_b64_tr_b16 v[180:181], v21 offset:53248
  v_mfma_f32_16x16x32_bf16 v[104:107], v[212:215], v[232:235], v[104:107]
  ds_read_b64_tr_b16 v[182:183], v21 offset:55296
  v_mfma_f32_16x16x32_bf16 v[112:115], v[216:219], v[232:235], v[112:115]
  ds_read_b64_tr_b16 v[184:185], v22 offset:53248
  v_mfma_f32_16x16x32_bf16 v[116:119], v[216:219], v[236:239], v[116:119]
  ds_read_b64_tr_b16 v[186:187], v22 offset:55296
  v_readlane_b32 s50, v30, 22
  v_mfma_f32_16x16x32_bf16 v[124:127], v[220:223], v[236:239], v[124:127]
  ds_read_b64_tr_b16 v[188:189], v23 offset:53248
  v_mfma_f32_16x16x32_bf16 v[120:123], v[220:223], v[232:235], v[120:123]
  ds_read_b64_tr_b16 v[190:191], v23 offset:55296
  s_waitcnt vmcnt(18) lgkmcnt(8)
  v_mfma_f32_16x16x32_bf16 v[128:131], v[160:163], v[240:243], v[128:131]
  buffer_load_dwordx4 v[224:227], off, s[36:39], s50 offset:0 sc1
  v_mfma_f32_16x16x32_bf16 v[132:135], v[160:163], v[244:247], v[132:135]
  ds_read_b64_tr_b16 v[192:193], v20 offset:57344
  ds_read_b64_tr_b16 v[194:195], v20 offset:59392
  v_mfma_f32_16x16x32_bf16 v[140:143], v[164:167], v[244:247], v[140:143]
  ds_read_b64_tr_b16 v[196:197], v21 offset:57344
  v_mfma_f32_16x16x32_bf16 v[136:139], v[164:167], v[240:243], v[136:139]
  ds_read_b64_tr_b16 v[198:199], v21 offset:59392
  v_mfma_f32_16x16x32_bf16 v[144:147], v[168:171], v[240:243], v[144:147]
  ds_read_b64_tr_b16 v[200:201], v22 offset:57344
  v_mfma_f32_16x16x32_bf16 v[148:151], v[168:171], v[244:247], v[148:151]
  ds_read_b64_tr_b16 v[202:203], v22 offset:59392
  ds_read_b64_tr_b16 v[204:205], v23 offset:57344
  v_mfma_f32_16x16x32_bf16 v[156:159], v[172:175], v[244:247], v[156:159]
  buffer_load_dwordx4 v[228:231], off, s[64:67], s50 offset:0 sc1
  v_mfma_f32_16x16x32_bf16 v[152:155], v[172:175], v[240:243], v[152:155]
  ds_read_b64_tr_b16 v[206:207], v23 offset:59392
  s_waitcnt vmcnt(18) lgkmcnt(8)
  v_mfma_f32_16x16x32_bf16 v[128:131], v[176:179], v[248:251], v[128:131]
  ds_read_b64_tr_b16 v[208:209], v20 offset:61440
  v_mfma_f32_16x16x32_bf16 v[132:135], v[176:179], v[252:255], v[132:135]
  ds_read_b64_tr_b16 v[210:211], v20 offset:63488
  v_mfma_f32_16x16x32_bf16 v[140:143], v[180:183], v[252:255], v[140:143]
  ds_read_b64_tr_b16 v[212:213], v21 offset:61440
  v_mfma_f32_16x16x32_bf16 v[136:139], v[180:183], v[248:251], v[136:139]
  ds_read_b64_tr_b16 v[214:215], v21 offset:63488
  v_mfma_f32_16x16x32_bf16 v[144:147], v[184:187], v[248:251], v[144:147]
  buffer_load_dwordx4 v[232:235], off, s[36:39], s50 offset:1024 sc1
  v_mfma_f32_16x16x32_bf16 v[148:151], v[184:187], v[252:255], v[148:151]
  ds_read_b64_tr_b16 v[216:217], v22 offset:61440
  ds_read_b64_tr_b16 v[218:219], v22 offset:63488
  v_mfma_f32_16x16x32_bf16 v[156:159], v[188:191], v[252:255], v[156:159]
  ds_read_b64_tr_b16 v[220:221], v23 offset:61440
  v_mfma_f32_16x16x32_bf16 v[152:155], v[188:191], v[248:251], v[152:155]
  ds_read_b64_tr_b16 v[222:223], v23 offset:63488
  s_waitcnt vmcnt(17) lgkmcnt(8)
  v_mfma_f32_16x16x32_bf16 v[128:131], v[192:195], v[32:35], v[128:131]
  ds_read_b64_tr_b16 v[160:161], v26 offset:0
  v_mfma_f32_16x16x32_bf16 v[132:135], v[192:195], v[36:39], v[132:135]
  ds_read_b64_tr_b16 v[162:163], v26 offset:2048
  v_mfma_f32_16x16x32_bf16 v[140:143], v[196:199], v[36:39], v[140:143]
  buffer_load_dwordx4 v[236:239], off, s[64:67], s50 offset:1024 sc1
  v_mfma_f32_16x16x32_bf16 v[136:139], v[196:199], v[32:35], v[136:139]
  ds_read_b64_tr_b16 v[164:165], v27 offset:0
  ds_read_b64_tr_b16 v[166:167], v27 offset:2048
  v_mfma_f32_16x16x32_bf16 v[144:147], v[200:203], v[32:35], v[144:147]
  ds_read_b64_tr_b16 v[168:169], v28 offset:0
  v_mfma_f32_16x16x32_bf16 v[148:151], v[200:203], v[36:39], v[148:151]
  ds_read_b64_tr_b16 v[170:171], v28 offset:2048
  v_mfma_f32_16x16x32_bf16 v[156:159], v[204:207], v[36:39], v[156:159]
  ds_read_b64_tr_b16 v[172:173], v29 offset:0
  v_mfma_f32_16x16x32_bf16 v[152:155], v[204:207], v[32:35], v[152:155]
  ds_read_b64_tr_b16 v[174:175], v29 offset:2048
  s_waitcnt vmcnt(16) lgkmcnt(8)
  s_barrier
  v_mfma_f32_16x16x32_bf16 v[128:131], v[208:211], v[40:43], v[128:131]
  ds_read_b64_tr_b16 v[176:177], v26 offset:4096
  v_mfma_f32_16x16x32_bf16 v[132:135], v[208:211], v[44:47], v[132:135]
  ds_read_b64_tr_b16 v[178:179], v26 offset:6144
  v_mfma_f32_16x16x32_bf16 v[140:143], v[212:215], v[44:47], v[140:143]
  ds_read_b64_tr_b16 v[180:181], v27 offset:4096
  v_mfma_f32_16x16x32_bf16 v[136:139], v[212:215], v[40:43], v[136:139]
  ds_read_b64_tr_b16 v[182:183], v27 offset:6144
  v_mfma_f32_16x16x32_bf16 v[144:147], v[216:219], v[40:43], v[144:147]
  ds_read_b64_tr_b16 v[184:185], v28 offset:4096
  v_mfma_f32_16x16x32_bf16 v[148:151], v[216:219], v[44:47], v[148:151]
  ds_read_b64_tr_b16 v[186:187], v28 offset:6144
  v_mfma_f32_16x16x32_bf16 v[156:159], v[220:223], v[44:47], v[156:159]
  ds_read_b64_tr_b16 v[188:189], v29 offset:4096
  v_mfma_f32_16x16x32_bf16 v[152:155], v[220:223], v[40:43], v[152:155]
  ds_read_b64_tr_b16 v[190:191], v29 offset:6144
  s_waitcnt vmcnt(14) lgkmcnt(8)
  v_mfma_f32_16x16x32_bf16 v[128:131], v[160:163], v[48:51], v[128:131]
  ds_read_b64_tr_b16 v[192:193], v26 offset:8192
  v_mfma_f32_16x16x32_bf16 v[132:135], v[160:163], v[52:55], v[132:135]
  ds_read_b64_tr_b16 v[194:195], v26 offset:10240
  v_mfma_f32_16x16x32_bf16 v[140:143], v[164:167], v[52:55], v[140:143]
  ds_read_b64_tr_b16 v[196:197], v27 offset:8192
  v_mfma_f32_16x16x32_bf16 v[136:139], v[164:167], v[48:51], v[136:139]
  ds_read_b64_tr_b16 v[198:199], v27 offset:10240
  v_mfma_f32_16x16x32_bf16 v[144:147], v[168:171], v[48:51], v[144:147]
  ds_read_b64_tr_b16 v[200:201], v28 offset:8192
  v_mfma_f32_16x16x32_bf16 v[148:151], v[168:171], v[52:55], v[148:151]
  ds_read_b64_tr_b16 v[202:203], v28 offset:10240
  v_mfma_f32_16x16x32_bf16 v[156:159], v[172:175], v[52:55], v[156:159]
  ds_read_b64_tr_b16 v[204:205], v29 offset:8192
  v_mfma_f32_16x16x32_bf16 v[152:155], v[172:175], v[48:51], v[152:155]
  ds_read_b64_tr_b16 v[206:207], v29 offset:10240
  s_waitcnt vmcnt(12) lgkmcnt(8)
  v_mfma_f32_16x16x32_bf16 v[128:131], v[176:179], v[56:59], v[128:131]
  ds_read_b64_tr_b16 v[208:209], v26 offset:12288
  v_mfma_f32_16x16x32_bf16 v[132:135], v[176:179], v[60:63], v[132:135]
  ds_read_b64_tr_b16 v[210:211], v26 offset:14336
  v_mfma_f32_16x16x32_bf16 v[140:143], v[180:183], v[60:63], v[140:143]
  ds_read_b64_tr_b16 v[212:213], v27 offset:12288
  v_mfma_f32_16x16x32_bf16 v[136:139], v[180:183], v[56:59], v[136:139]
  ds_read_b64_tr_b16 v[214:215], v27 offset:14336
  v_mfma_f32_16x16x32_bf16 v[144:147], v[184:187], v[56:59], v[144:147]
  ds_read_b64_tr_b16 v[216:217], v28 offset:12288
  v_mfma_f32_16x16x32_bf16 v[148:151], v[184:187], v[60:63], v[148:151]
  ds_read_b64_tr_b16 v[218:219], v28 offset:14336
  v_mfma_f32_16x16x32_bf16 v[156:159], v[188:191], v[60:63], v[156:159]
  ds_read_b64_tr_b16 v[220:221], v29 offset:12288
  v_mfma_f32_16x16x32_bf16 v[152:155], v[188:191], v[56:59], v[152:155]
  ds_read_b64_tr_b16 v[222:223], v29 offset:14336
  s_waitcnt vmcnt(10) lgkmcnt(8)
  v_mfma_f32_16x16x32_bf16 v[128:131], v[192:195], v[64:67], v[128:131]
  ds_read_b64_tr_b16 v[160:161], v26 offset:16384
  v_mfma_f32_16x16x32_bf16 v[132:135], v[192:195], v[68:71], v[132:135]
  ds_read_b64_tr_b16 v[162:163], v26 offset:18432
  v_mfma_f32_16x16x32_bf16 v[140:143], v[196:199], v[68:71], v[140:143]
  ds_read_b64_tr_b16 v[164:165], v27 offset:16384
  v_mfma_f32_16x16x32_bf16 v[136:139], v[196:199], v[64:67], v[136:139]
  ds_read_b64_tr_b16 v[166:167], v27 offset:18432
  v_mfma_f32_16x16x32_bf16 v[144:147], v[200:203], v[64:67], v[144:147]
  ds_read_b64_tr_b16 v[168:169], v28 offset:16384
  v_mfma_f32_16x16x32_bf16 v[148:151], v[200:203], v[68:71], v[148:151]
  ds_read_b64_tr_b16 v[170:171], v28 offset:18432
  v_mfma_f32_16x16x32_bf16 v[156:159], v[204:207], v[68:71], v[156:159]
  ds_read_b64_tr_b16 v[172:173], v29 offset:16384
  v_mfma_f32_16x16x32_bf16 v[152:155], v[204:207], v[64:67], v[152:155]
  ds_read_b64_tr_b16 v[174:175], v29 offset:18432
  s_waitcnt vmcnt(8) lgkmcnt(8)
  v_mfma_f32_16x16x32_bf16 v[128:131], v[208:211], v[72:75], v[128:131]
  ds_read_b64_tr_b16 v[176:177], v26 offset:20480
  v_mfma_f32_16x16x32_bf16 v[132:135], v[208:211], v[76:79], v[132:135]
  ds_read_b64_tr_b16 v[178:179], v26 offset:22528
  v_mfma_f32_16x16x32_bf16 v[140:143], v[212:215], v[76:79], v[140:143]
  ds_read_b64_tr_b16 v[180:181], v27 offset:20480
  v_mfma_f32_16x16x32_bf16 v[136:139], v[212:215], v[72:75], v[136:139]
  ds_read_b64_tr_b16 v[182:183], v27 offset:22528
  v_mfma_f32_16x16x32_bf16 v[144:147], v[216:219], v[72:75], v[144:147]
  ds_read_b64_tr_b16 v[184:185], v28 offset:20480
  v_mfma_f32_16x16x32_bf16 v[148:151], v[216:219], v[76:79], v[148:151]
  ds_read_b64_tr_b16 v[186:187], v28 offset:22528
  v_mfma_f32_16x16x32_bf16 v[156:159], v[220:223], v[76:79], v[156:159]
  ds_read_b64_tr_b16 v[188:189], v29 offset:20480
  v_mfma_f32_16x16x32_bf16 v[152:155], v[220:223], v[72:75], v[152:155]
  ds_read_b64_tr_b16 v[190:191], v29 offset:22528
  s_waitcnt vmcnt(6) lgkmcnt(8)
  v_mfma_f32_16x16x32_bf16 v[128:131], v[160:163], v[80:83], v[128:131]
  ds_read_b64_tr_b16 v[192:193], v26 offset:24576
  v_mfma_f32_16x16x32_bf16 v[132:135], v[160:163], v[84:87], v[132:135]
  ds_read_b64_tr_b16 v[194:195], v26 offset:26624
  v_mfma_f32_16x16x32_bf16 v[140:143], v[164:167], v[84:87], v[140:143]
  ds_read_b64_tr_b16 v[196:197], v27 offset:24576
  v_mfma_f32_16x16x32_bf16 v[136:139], v[164:167], v[80:83], v[136:139]
  ds_read_b64_tr_b16 v[198:199], v27 offset:26624
  v_mfma_f32_16x16x32_bf16 v[144:147], v[168:171], v[80:83], v[144:147]
  ds_read_b64_tr_b16 v[200:201], v28 offset:24576
  v_mfma_f32_16x16x32_bf16 v[148:151], v[168:171], v[84:87], v[148:151]
  ds_read_b64_tr_b16 v[202:203], v28 offset:26624
  v_mfma_f32_16x16x32_bf16 v[156:159], v[172:175], v[84:87], v[156:159]
  ds_read_b64_tr_b16 v[204:205], v29 offset:24576
  v_mfma_f32_16x16x32_bf16 v[152:155], v[172:175], v[80:83], v[152:155]
  ds_read_b64_tr_b16 v[206:207], v29 offset:26624
  s_waitcnt vmcnt(4) lgkmcnt(8)
  v_mfma_f32_16x16x32_bf16 v[128:131], v[176:179], v[88:91], v[128:131]
  ds_read_b64_tr_b16 v[208:209], v26 offset:28672
  v_mfma_f32_16x16x32_bf16 v[132:135], v[176:179], v[92:95], v[132:135]
  ds_read_b64_tr_b16 v[210:211], v26 offset:30720
  v_mfma_f32_16x16x32_bf16 v[140:143], v[180:183], v[92:95], v[140:143]
  ds_read_b64_tr_b16 v[212:213], v27 offset:28672
  v_mfma_f32_16x16x32_bf16 v[136:139], v[180:183], v[88:91], v[136:139]
  ds_read_b64_tr_b16 v[214:215], v27 offset:30720
  v_mfma_f32_16x16x32_bf16 v[144:147], v[184:187], v[88:91], v[144:147]
  ds_read_b64_tr_b16 v[216:217], v28 offset:28672
  v_mfma_f32_16x16x32_bf16 v[148:151], v[184:187], v[92:95], v[148:151]
  ds_read_b64_tr_b16 v[218:219], v28 offset:30720
  v_mfma_f32_16x16x32_bf16 v[156:159], v[188:191], v[92:95], v[156:159]
  ds_read_b64_tr_b16 v[220:221], v29 offset:28672
  v_mfma_f32_16x16x32_bf16 v[152:155], v[188:191], v[88:91], v[152:155]
  ds_read_b64_tr_b16 v[222:223], v29 offset:30720
  s_waitcnt vmcnt(2) lgkmcnt(8)
  v_mfma_f32_16x16x32_bf16 v[128:131], v[192:195], v[224:227], v[128:131]
  ds_read_b64_tr_b16 v[160:161], v6 offset:0
  v_mfma_f32_16x16x32_bf16 v[132:135], v[192:195], v[228:231], v[132:135]
  ds_read_b64_tr_b16 v[162:163], v6 offset:2048
  v_mfma_f32_16x16x32_bf16 v[140:143], v[196:199], v[228:231], v[140:143]
  ds_read_b64_tr_b16 v[164:165], v7 offset:0
  v_mfma_f32_16x16x32_bf16 v[136:139], v[196:199], v[224:227], v[136:139]
  ds_read_b64_tr_b16 v[166:167], v7 offset:2048
  v_mfma_f32_16x16x32_bf16 v[144:147], v[200:203], v[224:227], v[144:147]
  ds_read_b64_tr_b16 v[168:169], v8 offset:0
  v_mfma_f32_16x16x32_bf16 v[148:151], v[200:203], v[228:231], v[148:151]
  ds_read_b64_tr_b16 v[170:171], v8 offset:2048
  v_mfma_f32_16x16x32_bf16 v[156:159], v[204:207], v[228:231], v[156:159]
  ds_read_b64_tr_b16 v[172:173], v9 offset:0
  v_mfma_f32_16x16x32_bf16 v[152:155], v[204:207], v[224:227], v[152:155]
  ds_read_b64_tr_b16 v[174:175], v9 offset:2048
  s_waitcnt vmcnt(0) lgkmcnt(8)
  s_barrier
  v_mfma_f32_16x16x32_bf16 v[128:131], v[208:211], v[232:235], v[128:131]
  ds_read_b64_tr_b16 v[176:177], v6 offset:4096
  v_mfma_f32_16x16x32_bf16 v[132:135], v[208:211], v[236:239], v[132:135]
  ds_read_b64_tr_b16 v[178:179], v6 offset:6144
  v_mfma_f32_16x16x32_bf16 v[140:143], v[212:215], v[236:239], v[140:143]
  ds_read_b64_tr_b16 v[180:181], v7 offset:4096
  v_mfma_f32_16x16x32_bf16 v[136:139], v[212:215], v[232:235], v[136:139]
  ds_read_b64_tr_b16 v[182:183], v7 offset:6144
  v_mfma_f32_16x16x32_bf16 v[144:147], v[216:219], v[232:235], v[144:147]
  ds_read_b64_tr_b16 v[184:185], v8 offset:4096
  v_mfma_f32_16x16x32_bf16 v[148:151], v[216:219], v[236:239], v[148:151]
  ds_read_b64_tr_b16 v[186:187], v8 offset:6144
  v_mfma_f32_16x16x32_bf16 v[156:159], v[220:223], v[236:239], v[156:159]
  ds_read_b64_tr_b16 v[188:189], v9 offset:4096
  v_mfma_f32_16x16x32_bf16 v[152:155], v[220:223], v[232:235], v[152:155]
  ds_read_b64_tr_b16 v[190:191], v9 offset:6144
  s_waitcnt lgkmcnt(8)
  v_mfma_f32_16x16x32_bf16 v[96:99], v[160:163], v[240:243], v[96:99]
  ds_read_b64_tr_b16 v[192:193], v6 offset:8192
  v_mfma_f32_16x16x32_bf16 v[100:103], v[160:163], v[244:247], v[100:103]
  ds_read_b64_tr_b16 v[194:195], v6 offset:10240
  v_mfma_f32_16x16x32_bf16 v[108:111], v[164:167], v[244:247], v[108:111]
  ds_read_b64_tr_b16 v[196:197], v7 offset:8192
  v_cvt_pk_bf16_f32 v128, v128, v129
  v_mfma_f32_16x16x32_bf16 v[104:107], v[164:167], v[240:243], v[104:107]
  ds_read_b64_tr_b16 v[198:199], v7 offset:10240
  v_cvt_pk_bf16_f32 v129, v130, v131
  v_mfma_f32_16x16x32_bf16 v[112:115], v[168:171], v[240:243], v[112:115]
  ds_read_b64_tr_b16 v[200:201], v8 offset:8192
  v_cvt_pk_bf16_f32 v130, v132, v133
  v_mfma_f32_16x16x32_bf16 v[116:119], v[168:171], v[244:247], v[116:119]
  ds_read_b64_tr_b16 v[202:203], v8 offset:10240
  v_cvt_pk_bf16_f32 v131, v134, v135
  v_mfma_f32_16x16x32_bf16 v[124:127], v[172:175], v[244:247], v[124:127]
  ds_read_b64_tr_b16 v[204:205], v9 offset:8192
  buffer_store_dwordx4 v[128:131], off, s[60:63], s4 offset:0 sc1
  v_mfma_f32_16x16x32_bf16 v[120:123], v[172:175], v[240:243], v[120:123]
  ds_read_b64_tr_b16 v[206:207], v9 offset:10240
  s_waitcnt lgkmcnt(8)
  v_mfma_f32_16x16x32_bf16 v[96:99], v[176:179], v[248:251], v[96:99]
  ds_read_b64_tr_b16 v[208:209], v6 offset:12288
  v_cvt_pk_bf16_f32 v132, v136, v137
  v_mfma_f32_16x16x32_bf16 v[100:103], v[176:179], v[252:255], v[100:103]
  ds_read_b64_tr_b16 v[210:211], v6 offset:14336
  v_cvt_pk_bf16_f32 v133, v138, v139
  v_mfma_f32_16x16x32_bf16 v[108:111], v[180:183], v[252:255], v[108:111]
  ds_read_b64_tr_b16 v[212:213], v7 offset:12288
  v_cvt_pk_bf16_f32 v134, v140, v141
  v_mfma_f32_16x16x32_bf16 v[104:107], v[180:183], v[248:251], v[104:107]
  ds_read_b64_tr_b16 v[214:215], v7 offset:14336
  v_cvt_pk_bf16_f32 v135, v142, v143
  v_mfma_f32_16x16x32_bf16 v[112:115], v[184:187], v[248:251], v[112:115]
  ds_read_b64_tr_b16 v[216:217], v8 offset:12288
  buffer_store_dwordx4 v[132:135], off, s[60:63], s4 offset:1024 sc1
  v_mfma_f32_16x16x32_bf16 v[116:119], v[184:187], v[252:255], v[116:119]
  ds_read_b64_tr_b16 v[218:219], v8 offset:14336
  v_readlane_b32 s51, v30, 23
  v_mfma_f32_16x16x32_bf16 v[124:127], v[188:191], v[252:255], v[124:127]
  ds_read_b64_tr_b16 v[220:221], v9 offset:12288
  v_cvt_pk_bf16_f32 v136, v144, v145
  v_mfma_f32_16x16x32_bf16 v[120:123], v[188:191], v[248:251], v[120:123]
  ds_read_b64_tr_b16 v[222:223], v9 offset:14336
  s_waitcnt lgkmcnt(8)
  v_mfma_f32_16x16x32_bf16 v[96:99], v[192:195], v[32:35], v[96:99]
  ds_read_b64_tr_b16 v[160:161], v6 offset:16384
  buffer_load_dwordx4 v[240:243], off, s[36:39], s51 offset:0 sc1
  v_mfma_f32_16x16x32_bf16 v[100:103], v[192:195], v[36:39], v[100:103]
  ds_read_b64_tr_b16 v[162:163], v6 offset:18432
  v_cvt_pk_bf16_f32 v137, v146, v147
  v_mfma_f32_16x16x32_bf16 v[108:111], v[196:199], v[36:39], v[108:111]
  ds_read_b64_tr_b16 v[164:165], v7 offset:16384
  v_cvt_pk_bf16_f32 v138, v148, v149
  v_mfma_f32_16x16x32_bf16 v[104:107], v[196:199], v[32:35], v[104:107]
  ds_read_b64_tr_b16 v[166:167], v7 offset:18432
  v_cvt_pk_bf16_f32 v139, v150, v151
  v_mfma_f32_16x16x32_bf16 v[112:115], v[200:203], v[32:35], v[112:115]
  ds_read_b64_tr_b16 v[168:169], v8 offset:16384
  buffer_load_dwordx4 v[244:247], off, s[64:67], s51 offset:0 sc1
  v_mfma_f32_16x16x32_bf16 v[116:119], v[200:203], v[36:39], v[116:119]
  ds_read_b64_tr_b16 v[170:171], v8 offset:18432
  buffer_store_dwordx4 v[136:139], off, s[60:63], s4 offset:2048 sc1
  v_mfma_f32_16x16x32_bf16 v[124:127], v[204:207], v[36:39], v[124:127]
  ds_read_b64_tr_b16 v[172:173], v9 offset:16384
  v_cvt_pk_bf16_f32 v140, v152, v153
  v_mfma_f32_16x16x32_bf16 v[120:123], v[204:207], v[32:35], v[120:123]
  ds_read_b64_tr_b16 v[174:175], v9 offset:18432
  s_waitcnt lgkmcnt(8)
  v_mfma_f32_16x16x32_bf16 v[96:99], v[208:211], v[40:43], v[96:99]
  ds_read_b64_tr_b16 v[176:177], v6 offset:20480
  buffer_load_dwordx4 v[248:251], off, s[36:39], s51 offset:1024 sc1
  v_mfma_f32_16x16x32_bf16 v[100:103], v[208:211], v[44:47], v[100:103]
  ds_read_b64_tr_b16 v[178:179], v6 offset:22528
  v_cvt_pk_bf16_f32 v141, v154, v155
  v_mfma_f32_16x16x32_bf16 v[108:111], v[212:215], v[44:47], v[108:111]
  ds_read_b64_tr_b16 v[180:181], v7 offset:20480
  v_cvt_pk_bf16_f32 v142, v156, v157
  v_mfma_f32_16x16x32_bf16 v[104:107], v[212:215], v[40:43], v[104:107]
  ds_read_b64_tr_b16 v[182:183], v7 offset:22528
  v_cvt_pk_bf16_f32 v143, v158, v159
  v_mfma_f32_16x16x32_bf16 v[112:115], v[216:219], v[40:43], v[112:115]
  ds_read_b64_tr_b16 v[184:185], v8 offset:20480
  buffer_load_dwordx4 v[252:255], off, s[64:67], s51 offset:1024 sc1
  v_mfma_f32_16x16x32_bf16 v[116:119], v[216:219], v[44:47], v[116:119]
  ds_read_b64_tr_b16 v[186:187], v8 offset:22528
  buffer_store_dwordx4 v[140:143], off, s[60:63], s4 offset:3072 sc1
  v_mfma_f32_16x16x32_bf16 v[124:127], v[220:223], v[44:47], v[124:127]
  ds_read_b64_tr_b16 v[188:189], v9 offset:20480
  v_readlane_b32 s48, v30, 24
  v_mfma_f32_16x16x32_bf16 v[120:123], v[220:223], v[40:43], v[120:123]
  ds_read_b64_tr_b16 v[190:191], v9 offset:22528
  s_waitcnt lgkmcnt(8)
  v_mfma_f32_16x16x32_bf16 v[96:99], v[160:163], v[48:51], v[96:99]
  ds_read_b64_tr_b16 v[192:193], v6 offset:24576
  v_mfma_f32_16x16x32_bf16 v[100:103], v[160:163], v[52:55], v[100:103]
  buffer_load_dwordx4 v[32:35], off, s[36:39], s48 offset:0 sc1
  v_mfma_f32_16x16x32_bf16 v[108:111], v[164:167], v[52:55], v[108:111]
  ds_read_b64_tr_b16 v[194:195], v6 offset:26624
  ds_read_b64_tr_b16 v[196:197], v7 offset:24576
  v_mfma_f32_16x16x32_bf16 v[104:107], v[164:167], v[48:51], v[104:107]
  ds_read_b64_tr_b16 v[198:199], v7 offset:26624
  v_mfma_f32_16x16x32_bf16 v[112:115], v[168:171], v[48:51], v[112:115]
  ds_read_b64_tr_b16 v[200:201], v8 offset:24576
  v_mfma_f32_16x16x32_bf16 v[116:119], v[168:171], v[52:55], v[116:119]
  buffer_load_dwordx4 v[36:39], off, s[64:67], s48 offset:0 sc1
  v_mfma_f32_16x16x32_bf16 v[124:127], v[172:175], v[52:55], v[124:127]
  ds_read_b64_tr_b16 v[202:203], v8 offset:26624
  ds_read_b64_tr_b16 v[204:205], v9 offset:24576
  v_mfma_f32_16x16x32_bf16 v[120:123], v[172:175], v[48:51], v[120:123]
  ds_read_b64_tr_b16 v[206:207], v9 offset:26624
  s_waitcnt lgkmcnt(8)
  v_mfma_f32_16x16x32_bf16 v[96:99], v[176:179], v[56:59], v[96:99]
  ds_read_b64_tr_b16 v[208:209], v6 offset:28672
  v_mfma_f32_16x16x32_bf16 v[100:103], v[176:179], v[60:63], v[100:103]
  buffer_load_dwordx4 v[40:43], off, s[36:39], s48 offset:1024 sc1
  v_mfma_f32_16x16x32_bf16 v[108:111], v[180:183], v[60:63], v[108:111]
  ds_read_b64_tr_b16 v[210:211], v6 offset:30720
  ds_read_b64_tr_b16 v[212:213], v7 offset:28672
  v_mfma_f32_16x16x32_bf16 v[104:107], v[180:183], v[56:59], v[104:107]
  ds_read_b64_tr_b16 v[214:215], v7 offset:30720
  v_mfma_f32_16x16x32_bf16 v[112:115], v[184:187], v[56:59], v[112:115]
  ds_read_b64_tr_b16 v[216:217], v8 offset:28672
  v_mfma_f32_16x16x32_bf16 v[116:119], v[184:187], v[60:63], v[116:119]
  buffer_load_dwordx4 v[44:47], off, s[64:67], s48 offset:1024 sc1
  v_mfma_f32_16x16x32_bf16 v[124:127], v[188:191], v[60:63], v[124:127]
  ds_read_b64_tr_b16 v[218:219], v8 offset:30720
  ds_read_b64_tr_b16 v[220:221], v9 offset:28672
  v_mfma_f32_16x16x32_bf16 v[120:123], v[188:191], v[56:59], v[120:123]
  ds_read_b64_tr_b16 v[222:223], v9 offset:30720
  s_waitcnt lgkmcnt(8)
  v_mfma_f32_16x16x32_bf16 v[96:99], v[192:195], v[64:67], v[96:99]
  ds_read_b64_tr_b16 v[160:161], v6 offset:32768
  v_readlane_b32 s49, v30, 25
  v_mfma_f32_16x16x32_bf16 v[100:103], v[192:195], v[68:71], v[100:103]
  ds_read_b64_tr_b16 v[162:163], v6 offset:34816
  v_mfma_f32_16x16x32_bf16 v[108:111], v[196:199], v[68:71], v[108:111]
  ds_read_b64_tr_b16 v[164:165], v7 offset:32768
  v_mfma_f32_16x16x32_bf16 v[104:107], v[196:199], v[64:67], v[104:107]
  buffer_load_dwordx4 v[48:51], off, s[36:39], s49 offset:0 sc1
  v_mfma_f32_16x16x32_bf16 v[112:115], v[200:203], v[64:67], v[112:115]
  ds_read_b64_tr_b16 v[166:167], v7 offset:34816
  ds_read_b64_tr_b16 v[168:169], v8 offset:32768
  v_mfma_f32_16x16x32_bf16 v[116:119], v[200:203], v[68:71], v[116:119]
  ds_read_b64_tr_b16 v[170:171], v8 offset:34816
  v_mfma_f32_16x16x32_bf16 v[124:127], v[204:207], v[68:71], v[124:127]
  ds_read_b64_tr_b16 v[172:173], v9 offset:32768
  v_mfma_f32_16x16x32_bf16 v[120:123], v[204:207], v[64:67], v[120:123]
  ds_read_b64_tr_b16 v[174:175], v9 offset:34816
  s_waitcnt lgkmcnt(8)
  s_barrier
  v_mfma_f32_16x16x32_bf16 v[96:99], v[208:211], v[72:75], v[96:99]
  buffer_load_dwordx4 v[52:55], off, s[64:67], s49 offset:0 sc1
  v_mfma_f32_16x16x32_bf16 v[100:103], v[208:211], v[76:79], v[100:103]
  ds_read_b64_tr_b16 v[176:177], v6 offset:36864
  ds_read_b64_tr_b16 v[178:179], v6 offset:38912
  v_mfma_f32_16x16x32_bf16 v[108:111], v[212:215], v[76:79], v[108:111]
  ds_read_b64_tr_b16 v[180:181], v7 offset:36864
  v_mfma_f32_16x16x32_bf16 v[104:107], v[212:215], v[72:75], v[104:107]
  ds_read_b64_tr_b16 v[182:183], v7 offset:38912
  v_mfma_f32_16x16x32_bf16 v[112:115], v[216:219], v[72:75], v[112:115]
  buffer_load_dwordx4 v[56:59], off, s[36:39], s49 offset:1024 sc1
  v_mfma_f32_16x16x32_bf16 v[116:119], v[216:219], v[76:79], v[116:119]
  ds_read_b64_tr_b16 v[184:185], v8 offset:36864
  ds_read_b64_tr_b16 v[186:187], v8 offset:38912
  v_mfma_f32_16x16x32_bf16 v[124:127], v[220:223], v[76:79], v[124:127]
  ds_read_b64_tr_b16 v[188:189], v9 offset:36864
  v_mfma_f32_16x16x32_bf16 v[120:123], v[220:223], v[72:75], v[120:123]
  ds_read_b64_tr_b16 v[190:191], v9 offset:38912
  s_waitcnt lgkmcnt(8)
  v_mfma_f32_16x16x32_bf16 v[96:99], v[160:163], v[80:83], v[96:99]
  ds_read_b64_tr_b16 v[192:193], v6 offset:40960
  buffer_load_dwordx4 v[60:63], off, s[64:67], s49 offset:1024 sc1
  v_mfma_f32_16x16x32_bf16 v[100:103], v[160:163], v[84:87], v[100:103]
  ds_read_b64_tr_b16 v[194:195], v6 offset:43008
  s_waitcnt vmcnt(8)
  v_mfma_f32_16x16x32_bf16 v[108:111], v[164:167], v[84:87], v[108:111]
  ds_read_b64_tr_b16 v[196:197], v7 offset:40960
  v_readlane_b32 s50, v30, 26
  v_mfma_f32_16x16x32_bf16 v[104:107], v[164:167], v[80:83], v[104:107]
  buffer_store_dword v19, off, s[52:55], s6 sc1
  v_mfma_f32_16x16x32_bf16 v[112:115], v[168:171], v[80:83], v[112:115]
  ds_read_b64_tr_b16 v[198:199], v7 offset:43008
  ds_read_b64_tr_b16 v[200:201], v8 offset:40960
  v_mfma_f32_16x16x32_bf16 v[116:119], v[168:171], v[84:87], v[116:119]
  buffer_load_dwordx4 v[64:67], off, s[36:39], s50 offset:0 sc1
  v_mfma_f32_16x16x32_bf16 v[124:127], v[172:175], v[84:87], v[124:127]
  ds_read_b64_tr_b16 v[202:203], v8 offset:43008
  ds_read_b64_tr_b16 v[204:205], v9 offset:40960
  v_mfma_f32_16x16x32_bf16 v[120:123], v[172:175], v[80:83], v[120:123]
  ds_read_b64_tr_b16 v[206:207], v9 offset:43008
  s_waitcnt lgkmcnt(8)
  v_mfma_f32_16x16x32_bf16 v[96:99], v[176:179], v[88:91], v[96:99]
  ds_read_b64_tr_b16 v[208:209], v6 offset:45056
  v_mfma_f32_16x16x32_bf16 v[100:103], v[176:179], v[92:95], v[100:103]
  buffer_load_dwordx4 v[68:71], off, s[64:67], s50 offset:0 sc1
  v_mfma_f32_16x16x32_bf16 v[108:111], v[180:183], v[92:95], v[108:111]
  ds_read_b64_tr_b16 v[210:211], v6 offset:47104
  ds_read_b64_tr_b16 v[212:213], v7 offset:45056
  v_mfma_f32_16x16x32_bf16 v[104:107], v[180:183], v[88:91], v[104:107]
  ds_read_b64_tr_b16 v[214:215], v7 offset:47104
  v_mfma_f32_16x16x32_bf16 v[112:115], v[184:187], v[88:91], v[112:115]
  ds_read_b64_tr_b16 v[216:217], v8 offset:45056
  v_mfma_f32_16x16x32_bf16 v[116:119], v[184:187], v[92:95], v[116:119]
  buffer_load_dwordx4 v[72:75], off, s[36:39], s50 offset:1024 sc1
  v_mfma_f32_16x16x32_bf16 v[124:127], v[188:191], v[92:95], v[124:127]
  ds_read_b64_tr_b16 v[218:219], v8 offset:47104
  ds_read_b64_tr_b16 v[220:221], v9 offset:45056
  v_mfma_f32_16x16x32_bf16 v[120:123], v[188:191], v[88:91], v[120:123]
  ds_read_b64_tr_b16 v[222:223], v9 offset:47104
  s_waitcnt lgkmcnt(8)
  v_mfma_f32_16x16x32_bf16 v[96:99], v[192:195], v[224:227], v[96:99]
  ds_read_b64_tr_b16 v[160:161], v6 offset:49152
  v_mfma_f32_16x16x32_bf16 v[100:103], v[192:195], v[228:231], v[100:103]
  buffer_load_dwordx4 v[76:79], off, s[64:67], s50 offset:1024 sc1
  v_mfma_f32_16x16x32_bf16 v[108:111], v[196:199], v[228:231], v[108:111]
  ds_read_b64_tr_b16 v[162:163], v6 offset:51200
  ds_read_b64_tr_b16 v[164:165], v7 offset:49152
  v_mfma_f32_16x16x32_bf16 v[104:107], v[196:199], v[224:227], v[104:107]
  ds_read_b64_tr_b16 v[166:167], v7 offset:51200
  v_readlane_b32 s51, v30, 27
  v_mfma_f32_16x16x32_bf16 v[112:115], v[200:203], v[224:227], v[112:115]
  ds_read_b64_tr_b16 v[168:169], v8 offset:49152
  v_mfma_f32_16x16x32_bf16 v[116:119], v[200:203], v[228:231], v[116:119]
  ds_read_b64_tr_b16 v[170:171], v8 offset:51200
  ds_read_b64_tr_b16 v[172:173], v9 offset:49152
  v_mfma_f32_16x16x32_bf16 v[124:127], v[204:207], v[228:231], v[124:127]
  buffer_load_dwordx4 v[80:83], off, s[36:39], s51 offset:0 sc1
  v_mfma_f32_16x16x32_bf16 v[120:123], v[204:207], v[224:227], v[120:123]
  ds_read_b64_tr_b16 v[174:175], v9 offset:51200
  s_waitcnt lgkmcnt(8)
  v_mfma_f32_16x16x32_bf16 v[96:99], v[208:211], v[232:235], v[96:99]
  ds_read_b64_tr_b16 v[176:177], v6 offset:53248
  v_mfma_f32_16x16x32_bf16 v[100:103], v[208:211], v[236:239], v[100:103]
  ds_read_b64_tr_b16 v[178:179], v6 offset:55296
  v_mfma_f32_16x16x32_bf16 v[108:111], v[212:215], v[236:239], v[108:111]
  buffer_load_dwordx4 v[84:87], off, s[64:67], s51 offset:0 sc1
  v_mfma_f32_16x16x32_bf16 v[104:107], v[212:215], v[232:235], v[104:107]
  ds_read_b64_tr_b16 v[180:181], v7 offset:53248
  ds_read_b64_tr_b16 v[182:183], v7 offset:55296
  v_mfma_f32_16x16x32_bf16 v[112:115], v[216:219], v[232:235], v[112:115]
  ds_read_b64_tr_b16 v[184:185], v8 offset:53248
  v_mfma_f32_16x16x32_bf16 v[116:119], v[216:219], v[236:239], v[116:119]
  ds_read_b64_tr_b16 v[186:187], v8 offset:55296
  ds_read_b64_tr_b16 v[188:189], v9 offset:53248
  v_mfma_f32_16x16x32_bf16 v[124:127], v[220:223], v[236:239], v[124:127]
  buffer_load_dwordx4 v[88:91], off, s[36:39], s51 offset:1024 sc1
  v_mfma_f32_16x16x32_bf16 v[120:123], v[220:223], v[232:235], v[120:123]
  ds_read_b64_tr_b16 v[190:191], v9 offset:55296
  s_waitcnt lgkmcnt(8)
  v_mfma_f32_16x16x32_bf16 v[96:99], v[160:163], v[240:243], v[96:99]
  ds_read_b64_tr_b16 v[192:193], v6 offset:57344
  v_mfma_f32_16x16x32_bf16 v[100:103], v[160:163], v[244:247], v[100:103]
  ds_read_b64_tr_b16 v[194:195], v6 offset:59392
  v_mfma_f32_16x16x32_bf16 v[108:111], v[164:167], v[244:247], v[108:111]
  buffer_load_dwordx4 v[92:95], off, s[64:67], s51 offset:1024 sc1
  v_mfma_f32_16x16x32_bf16 v[104:107], v[164:167], v[240:243], v[104:107]
  ds_read_b64_tr_b16 v[196:197], v7 offset:57344
  ds_read_b64_tr_b16 v[198:199], v7 offset:59392
  v_mfma_f32_16x16x32_bf16 v[112:115], v[168:171], v[240:243], v[112:115]
  ds_read_b64_tr_b16 v[200:201], v8 offset:57344
  v_readlane_b32 s48, v30, 28
  v_mfma_f32_16x16x32_bf16 v[116:119], v[168:171], v[244:247], v[116:119]
  ds_read_b64_tr_b16 v[202:203], v8 offset:59392
  v_mfma_f32_16x16x32_bf16 v[124:127], v[172:175], v[244:247], v[124:127]
  ds_read_b64_tr_b16 v[204:205], v9 offset:57344
  v_mfma_f32_16x16x32_bf16 v[120:123], v[172:175], v[240:243], v[120:123]
  ds_read_b64_tr_b16 v[206:207], v9 offset:59392
  s_waitcnt lgkmcnt(8)
  v_mfma_f32_16x16x32_bf16 v[96:99], v[176:179], v[248:251], v[96:99]
  buffer_load_dwordx4 v[224:227], off, s[36:39], s48 offset:0 sc1
  v_mfma_f32_16x16x32_bf16 v[100:103], v[176:179], v[252:255], v[100:103]
  ds_read_b64_tr_b16 v[208:209], v6 offset:61440
  ds_read_b64_tr_b16 v[210:211], v6 offset:63488
  v_mfma_f32_16x16x32_bf16 v[108:111], v[180:183], v[252:255], v[108:111]
  ds_read_b64_tr_b16 v[212:213], v7 offset:61440
  v_mfma_f32_16x16x32_bf16 v[104:107], v[180:183], v[248:251], v[104:107]
  ds_read_b64_tr_b16 v[214:215], v7 offset:63488
  v_mfma_f32_16x16x32_bf16 v[112:115], v[184:187], v[248:251], v[112:115]
  buffer_load_dwordx4 v[228:231], off, s[64:67], s48 offset:0 sc1
  v_mfma_f32_16x16x32_bf16 v[116:119], v[184:187], v[252:255], v[116:119]
  ds_read_b64_tr_b16 v[216:217], v8 offset:61440
  ds_read_b64_tr_b16 v[218:219], v8 offset:63488
  v_mfma_f32_16x16x32_bf16 v[124:127], v[188:191], v[252:255], v[124:127]
  ds_read_b64_tr_b16 v[220:221], v9 offset:61440
  v_mfma_f32_16x16x32_bf16 v[120:123], v[188:191], v[248:251], v[120:123]
  ds_read_b64_tr_b16 v[222:223], v9 offset:63488
  s_waitcnt vmcnt(17) lgkmcnt(8)
  v_mfma_f32_16x16x32_bf16 v[96:99], v[192:195], v[32:35], v[96:99]
  buffer_load_dwordx4 v[232:235], off, s[36:39], s48 offset:1024 sc1
  v_mfma_f32_16x16x32_bf16 v[100:103], v[192:195], v[36:39], v[100:103]
  ds_read_b64_tr_b16 v[160:161], v20 offset:0
  ds_read_b64_tr_b16 v[162:163], v20 offset:2048
  v_mfma_f32_16x16x32_bf16 v[108:111], v[196:199], v[36:39], v[108:111]
  ds_read_b64_tr_b16 v[164:165], v21 offset:0
  v_mfma_f32_16x16x32_bf16 v[104:107], v[196:199], v[32:35], v[104:107]
  ds_read_b64_tr_b16 v[166:167], v21 offset:2048
  v_mfma_f32_16x16x32_bf16 v[112:115], v[200:203], v[32:35], v[112:115]
  buffer_load_dwordx4 v[236:239], off, s[64:67], s48 offset:1024 sc1
  v_mfma_f32_16x16x32_bf16 v[116:119], v[200:203], v[36:39], v[116:119]
  ds_read_b64_tr_b16 v[168:169], v22 offset:0
  ds_read_b64_tr_b16 v[170:171], v22 offset:2048
  v_mfma_f32_16x16x32_bf16 v[124:127], v[204:207], v[36:39], v[124:127]
  ds_read_b64_tr_b16 v[172:173], v23 offset:0
  v_readlane_b32 s49, v30, 29
  v_mfma_f32_16x16x32_bf16 v[120:123], v[204:207], v[32:35], v[120:123]
  ds_read_b64_tr_b16 v[174:175], v23 offset:2048
  s_waitcnt vmcnt(17) lgkmcnt(8)
  v_mfma_f32_16x16x32_bf16 v[96:99], v[208:211], v[40:43], v[96:99]
  ds_read_b64_tr_b16 v[176:177], v20 offset:4096
  v_mfma_f32_16x16x32_bf16 v[100:103], v[208:211], v[44:47], v[100:103]
  buffer_load_dwordx4 v[240:243], off, s[36:39], s49 offset:0 sc1
  v_mfma_f32_16x16x32_bf16 v[108:111], v[212:215], v[44:47], v[108:111]
  ds_read_b64_tr_b16 v[178:179], v20 offset:6144
  ds_read_b64_tr_b16 v[180:181], v21 offset:4096
  v_mfma_f32_16x16x32_bf16 v[104:107], v[212:215], v[40:43], v[104:107]
  ds_read_b64_tr_b16 v[182:183], v21 offset:6144
  v_mfma_f32_16x16x32_bf16 v[112:115], v[216:219], v[40:43], v[112:115]
  ds_read_b64_tr_b16 v[184:185], v22 offset:4096
  v_mfma_f32_16x16x32_bf16 v[116:119], v[216:219], v[44:47], v[116:119]
  buffer_load_dwordx4 v[244:247], off, s[64:67], s49 offset:0 sc1
  v_mfma_f32_16x16x32_bf16 v[124:127], v[220:223], v[44:47], v[124:127]
  ds_read_b64_tr_b16 v[186:187], v22 offset:6144
  ds_read_b64_tr_b16 v[188:189], v23 offset:4096
  v_mfma_f32_16x16x32_bf16 v[120:123], v[220:223], v[40:43], v[120:123]
  ds_read_b64_tr_b16 v[190:191], v23 offset:6144
  s_waitcnt vmcnt(17) lgkmcnt(8)
  v_mfma_f32_16x16x32_bf16 v[96:99], v[160:163], v[48:51], v[96:99]
  ds_read_b64_tr_b16 v[192:193], v20 offset:8192
  v_mfma_f32_16x16x32_bf16 v[100:103], v[160:163], v[52:55], v[100:103]
  buffer_load_dwordx4 v[248:251], off, s[36:39], s49 offset:1024 sc1
  v_mfma_f32_16x16x32_bf16 v[108:111], v[164:167], v[52:55], v[108:111]
  ds_read_b64_tr_b16 v[194:195], v20 offset:10240
  ds_read_b64_tr_b16 v[196:197], v21 offset:8192
  v_mfma_f32_16x16x32_bf16 v[104:107], v[164:167], v[48:51], v[104:107]
  ds_read_b64_tr_b16 v[198:199], v21 offset:10240
  v_mfma_f32_16x16x32_bf16 v[112:115], v[168:171], v[48:51], v[112:115]
  ds_read_b64_tr_b16 v[200:201], v22 offset:8192
  v_mfma_f32_16x16x32_bf16 v[116:119], v[168:171], v[52:55], v[116:119]
  buffer_load_dwordx4 v[252:255], off, s[64:67], s49 offset:1024 sc1
  v_mfma_f32_16x16x32_bf16 v[124:127], v[172:175], v[52:55], v[124:127]
  ds_read_b64_tr_b16 v[202:203], v22 offset:10240
  ds_read_b64_tr_b16 v[204:205], v23 offset:8192
  v_mfma_f32_16x16x32_bf16 v[120:123], v[172:175], v[48:51], v[120:123]
  ds_read_b64_tr_b16 v[206:207], v23 offset:10240
  s_waitcnt vmcnt(17) lgkmcnt(8)
  v_mfma_f32_16x16x32_bf16 v[96:99], v[176:179], v[56:59], v[96:99]
  ds_read_b64_tr_b16 v[208:209], v20 offset:12288
  v_readlane_b32 s50, v30, 30
  v_mfma_f32_16x16x32_bf16 v[100:103], v[176:179], v[60:63], v[100:103]
  ds_read_b64_tr_b16 v[210:211], v20 offset:14336
  v_mfma_f32_16x16x32_bf16 v[108:111], v[180:183], v[60:63], v[108:111]
  ds_read_b64_tr_b16 v[212:213], v21 offset:12288
  v_mfma_f32_16x16x32_bf16 v[104:107], v[180:183], v[56:59], v[104:107]
  buffer_load_dwordx4 v[32:35], off, s[36:39], s50 offset:0 sc1
  v_mfma_f32_16x16x32_bf16 v[112:115], v[184:187], v[56:59], v[112:115]
  ds_read_b64_tr_b16 v[214:215], v21 offset:14336
  ds_read_b64_tr_b16 v[216:217], v22 offset:12288
  v_mfma_f32_16x16x32_bf16 v[116:119], v[184:187], v[60:63], v[116:119]
  ds_read_b64_tr_b16 v[218:219], v22 offset:14336
  v_mfma_f32_16x16x32_bf16 v[124:127], v[188:191], v[60:63], v[124:127]
  ds_read_b64_tr_b16 v[220:221], v23 offset:12288
  v_mfma_f32_16x16x32_bf16 v[120:123], v[188:191], v[56:59], v[120:123]
  ds_read_b64_tr_b16 v[222:223], v23 offset:14336
  s_waitcnt vmcnt(15) lgkmcnt(8)
  v_mfma_f32_16x16x32_bf16 v[96:99], v[192:195], v[64:67], v[96:99]
  buffer_load_dwordx4 v[36:39], off, s[64:67], s50 offset:0 sc1
  v_mfma_f32_16x16x32_bf16 v[100:103], v[192:195], v[68:71], v[100:103]
  ds_read_b64_tr_b16 v[160:161], v20 offset:16384
  ds_read_b64_tr_b16 v[162:163], v20 offset:18432
  v_mfma_f32_16x16x32_bf16 v[108:111], v[196:199], v[68:71], v[108:111]
  ds_read_b64_tr_b16 v[164:165], v21 offset:16384
  v_mfma_f32_16x16x32_bf16 v[104:107], v[196:199], v[64:67], v[104:107]
  ds_read_b64_tr_b16 v[166:167], v21 offset:18432
  v_mfma_f32_16x16x32_bf16 v[112:115], v[200:203], v[64:67], v[112:115]
  buffer_load_dwordx4 v[40:43], off, s[36:39], s50 offset:1024 sc1
  v_mfma_f32_16x16x32_bf16 v[116:119], v[200:203], v[68:71], v[116:119]
  ds_read_b64_tr_b16 v[168:169], v22 offset:16384
  ds_read_b64_tr_b16 v[170:171], v22 offset:18432
  v_mfma_f32_16x16x32_bf16 v[124:127], v[204:207], v[68:71], v[124:127]
  ds_read_b64_tr_b16 v[172:173], v23 offset:16384
  v_mfma_f32_16x16x32_bf16 v[120:123], v[204:207], v[64:67], v[120:123]
  ds_read_b64_tr_b16 v[174:175], v23 offset:18432
  s_waitcnt vmcnt(15) lgkmcnt(8)
  v_mfma_f32_16x16x32_bf16 v[96:99], v[208:211], v[72:75], v[96:99]
  buffer_load_dwordx4 v[44:47], off, s[64:67], s50 offset:1024 sc1
  v_mfma_f32_16x16x32_bf16 v[100:103], v[208:211], v[76:79], v[100:103]
  ds_read_b64_tr_b16 v[176:177], v20 offset:20480
  ds_read_b64_tr_b16 v[178:179], v20 offset:22528
  v_mfma_f32_16x16x32_bf16 v[108:111], v[212:215], v[76:79], v[108:111]
  ds_read_b64_tr_b16 v[180:181], v21 offset:20480
  v_readlane_b32 s51, v30, 31
  v_mfma_f32_16x16x32_bf16 v[104:107], v[212:215], v[72:75], v[104:107]
  ds_read_b64_tr_b16 v[182:183], v21 offset:22528
  v_mfma_f32_16x16x32_bf16 v[112:115], v[216:219], v[72:75], v[112:115]
  ds_read_b64_tr_b16 v[184:185], v22 offset:20480
  v_mfma_f32_16x16x32_bf16 v[116:119], v[216:219], v[76:79], v[116:119]
  buffer_load_dwordx4 v[48:51], off, s[36:39], s51 offset:0 sc1
  v_mfma_f32_16x16x32_bf16 v[124:127], v[220:223], v[76:79], v[124:127]
  ds_read_b64_tr_b16 v[186:187], v22 offset:22528
  ds_read_b64_tr_b16 v[188:189], v23 offset:20480
  v_mfma_f32_16x16x32_bf16 v[120:123], v[220:223], v[72:75], v[120:123]
  ds_read_b64_tr_b16 v[190:191], v23 offset:22528
  s_waitcnt vmcnt(15) lgkmcnt(8)
  v_mfma_f32_16x16x32_bf16 v[96:99], v[160:163], v[80:83], v[96:99]
  ds_read_b64_tr_b16 v[192:193], v20 offset:24576
  v_mfma_f32_16x16x32_bf16 v[100:103], v[160:163], v[84:87], v[100:103]
  buffer_load_dwordx4 v[52:55], off, s[64:67], s51 offset:0 sc1
  v_mfma_f32_16x16x32_bf16 v[108:111], v[164:167], v[84:87], v[108:111]
  ds_read_b64_tr_b16 v[194:195], v20 offset:26624
  ds_read_b64_tr_b16 v[196:197], v21 offset:24576
  v_mfma_f32_16x16x32_bf16 v[104:107], v[164:167], v[80:83], v[104:107]
  ds_read_b64_tr_b16 v[198:199], v21 offset:26624
  v_mfma_f32_16x16x32_bf16 v[112:115], v[168:171], v[80:83], v[112:115]
  ds_read_b64_tr_b16 v[200:201], v22 offset:24576
  v_mfma_f32_16x16x32_bf16 v[116:119], v[168:171], v[84:87], v[116:119]
  buffer_load_dwordx4 v[56:59], off, s[36:39], s51 offset:1024 sc1
  v_mfma_f32_16x16x32_bf16 v[124:127], v[172:175], v[84:87], v[124:127]
  ds_read_b64_tr_b16 v[202:203], v22 offset:26624
  ds_read_b64_tr_b16 v[204:205], v23 offset:24576
  v_mfma_f32_16x16x32_bf16 v[120:123], v[172:175], v[80:83], v[120:123]
  ds_read_b64_tr_b16 v[206:207], v23 offset:26624
  s_waitcnt vmcnt(15) lgkmcnt(8)
  s_barrier
  v_mfma_f32_16x16x32_bf16 v[96:99], v[176:179], v[88:91], v[96:99]
  ds_read_b64_tr_b16 v[208:209], v20 offset:28672
  buffer_load_dwordx4 v[144:147], off, s[60:63], s5 offset:0 sc1
  v_mfma_f32_16x16x32_bf16 v[100:103], v[176:179], v[92:95], v[100:103]
  ds_read_b64_tr_b16 v[210:211], v20 offset:30720
  buffer_load_dwordx4 v[60:63], off, s[64:67], s51 offset:1024 sc1
  v_mfma_f32_16x16x32_bf16 v[108:111], v[180:183], v[92:95], v[108:111]
  ds_read_b64_tr_b16 v[212:213], v21 offset:28672
  buffer_load_dwordx4 v[148:151], off, s[60:63], s5 offset:1024 sc1
  v_mfma_f32_16x16x32_bf16 v[104:107], v[180:183], v[88:91], v[104:107]
  ds_read_b64_tr_b16 v[214:215], v21 offset:30720
  v_readlane_b32 s48, v30, 32
  v_mfma_f32_16x16x32_bf16 v[112:115], v[184:187], v[88:91], v[112:115]
  buffer_load_dwordx4 v[152:155], off, s[60:63], s5 offset:2048 sc1
  v_mfma_f32_16x16x32_bf16 v[116:119], v[184:187], v[92:95], v[116:119]
  ds_read_b64_tr_b16 v[216:217], v22 offset:28672
  ds_read_b64_tr_b16 v[218:219], v22 offset:30720
  v_mfma_f32_16x16x32_bf16 v[124:127], v[188:191], v[92:95], v[124:127]
  ds_read_b64_tr_b16 v[220:221], v23 offset:28672
  buffer_load_dwordx4 v[64:67], off, s[36:39], s48 offset:0 sc1
  v_mfma_f32_16x16x32_bf16 v[120:123], v[188:191], v[88:91], v[120:123]
  ds_read_b64_tr_b16 v[222:223], v23 offset:30720
  s_waitcnt vmcnt(18) lgkmcnt(8)
  v_mfma_f32_16x16x32_bf16 v[96:99], v[192:195], v[224:227], v[96:99]
  buffer_load_dwordx4 v[156:159], off, s[60:63], s5 offset:3072 sc1
  v_mfma_f32_16x16x32_bf16 v[100:103], v[192:195], v[228:231], v[100:103]
  ds_read_b64_tr_b16 v[160:161], v20 offset:32768
  ds_read_b64_tr_b16 v[162:163], v20 offset:34816
  v_mfma_f32_16x16x32_bf16 v[108:111], v[196:199], v[228:231], v[108:111]
  buffer_load_dwordx4 v[68:71], off, s[64:67], s48 offset:0 sc1
  v_mfma_f32_16x16x32_bf16 v[104:107], v[196:199], v[224:227], v[104:107]
  ds_read_b64_tr_b16 v[164:165], v21 offset:32768
  ds_read_b64_tr_b16 v[166:167], v21 offset:34816
  v_mfma_f32_16x16x32_bf16 v[112:115], v[200:203], v[224:227], v[112:115]
  ds_read_b64_tr_b16 v[168:169], v22 offset:32768
  v_mfma_f32_16x16x32_bf16 v[116:119], v[200:203], v[228:231], v[116:119]
  ds_read_b64_tr_b16 v[170:171], v22 offset:34816
  ds_read_b64_tr_b16 v[172:173], v23 offset:32768
  v_mfma_f32_16x16x32_bf16 v[124:127], v[204:207], v[228:231], v[124:127]
  buffer_load_dwordx4 v[72:75], off, s[36:39], s48 offset:1024 sc1
  v_mfma_f32_16x16x32_bf16 v[120:123], v[204:207], v[224:227], v[120:123]
  ds_read_b64_tr_b16 v[174:175], v23 offset:34816
  s_waitcnt vmcnt(19) lgkmcnt(8)
  v_mfma_f32_16x16x32_bf16 v[96:99], v[208:211], v[232:235], v[96:99]
  ds_read_b64_tr_b16 v[176:177], v20 offset:36864
  v_mfma_f32_16x16x32_bf16 v[100:103], v[208:211], v[236:239], v[100:103]
  ds_read_b64_tr_b16 v[178:179], v20 offset:38912
  v_mfma_f32_16x16x32_bf16 v[108:111], v[212:215], v[236:239], v[108:111]
  buffer_load_dwordx4 v[76:79], off, s[64:67], s48 offset:1024 sc1
  v_mfma_f32_16x16x32_bf16 v[104:107], v[212:215], v[232:235], v[104:107]
  ds_read_b64_tr_b16 v[180:181], v21 offset:36864
  ds_read_b64_tr_b16 v[182:183], v21 offset:38912
  v_mfma_f32_16x16x32_bf16 v[112:115], v[216:219], v[232:235], v[112:115]
  ds_read_b64_tr_b16 v[184:185], v22 offset:36864
  v_mfma_f32_16x16x32_bf16 v[116:119], v[216:219], v[236:239], v[116:119]
  ds_read_b64_tr_b16 v[186:187], v22 offset:38912
  v_mfma_f32_16x16x32_bf16 v[124:127], v[220:223], v[236:239], v[124:127]
  ds_read_b64_tr_b16 v[188:189], v23 offset:36864
  v_mfma_f32_16x16x32_bf16 v[120:123], v[220:223], v[232:235], v[120:123]
  ds_read_b64_tr_b16 v[190:191], v23 offset:38912
  s_waitcnt vmcnt(18) lgkmcnt(8)
  v_mfma_f32_16x16x32_bf16 v[96:99], v[160:163], v[240:243], v[96:99]
  ds_read_b64_tr_b16 v[192:193], v20 offset:40960
  v_mfma_f32_16x16x32_bf16 v[100:103], v[160:163], v[244:247], v[100:103]
  ds_read_b64_tr_b16 v[194:195], v20 offset:43008
  v_mfma_f32_16x16x32_bf16 v[108:111], v[164:167], v[244:247], v[108:111]
  ds_read_b64_tr_b16 v[196:197], v21 offset:40960
  v_mfma_f32_16x16x32_bf16 v[104:107], v[164:167], v[240:243], v[104:107]
  ds_read_b64_tr_b16 v[198:199], v21 offset:43008
  v_mfma_f32_16x16x32_bf16 v[112:115], v[168:171], v[240:243], v[112:115]
  ds_read_b64_tr_b16 v[200:201], v22 offset:40960
  v_mfma_f32_16x16x32_bf16 v[116:119], v[168:171], v[244:247], v[116:119]
  ds_read_b64_tr_b16 v[202:203], v22 offset:43008
  v_mfma_f32_16x16x32_bf16 v[124:127], v[172:175], v[244:247], v[124:127]
  ds_read_b64_tr_b16 v[204:205], v23 offset:40960
  v_mfma_f32_16x16x32_bf16 v[120:123], v[172:175], v[240:243], v[120:123]
  ds_read_b64_tr_b16 v[206:207], v23 offset:43008
  s_waitcnt vmcnt(16) lgkmcnt(8)
  v_mfma_f32_16x16x32_bf16 v[96:99], v[176:179], v[248:251], v[96:99]
  ds_read_b64_tr_b16 v[208:209], v20 offset:45056
  v_mfma_f32_16x16x32_bf16 v[100:103], v[176:179], v[252:255], v[100:103]
  ds_read_b64_tr_b16 v[210:211], v20 offset:47104
  v_mfma_f32_16x16x32_bf16 v[108:111], v[180:183], v[252:255], v[108:111]
  ds_read_b64_tr_b16 v[212:213], v21 offset:45056
  v_mfma_f32_16x16x32_bf16 v[104:107], v[180:183], v[248:251], v[104:107]
  ds_read_b64_tr_b16 v[214:215], v21 offset:47104
  v_mfma_f32_16x16x32_bf16 v[112:115], v[184:187], v[248:251], v[112:115]
  ds_read_b64_tr_b16 v[216:217], v22 offset:45056
  v_mfma_f32_16x16x32_bf16 v[116:119], v[184:187], v[252:255], v[116:119]
  ds_read_b64_tr_b16 v[218:219], v22 offset:47104
  v_mfma_f32_16x16x32_bf16 v[124:127], v[188:191], v[252:255], v[124:127]
  ds_read_b64_tr_b16 v[220:221], v23 offset:45056
  v_mfma_f32_16x16x32_bf16 v[120:123], v[188:191], v[248:251], v[120:123]
  ds_read_b64_tr_b16 v[222:223], v23 offset:47104
  s_waitcnt vmcnt(14) lgkmcnt(8)
  v_mfma_f32_16x16x32_bf16 v[96:99], v[192:195], v[32:35], v[96:99]
  ds_read_b64_tr_b16 v[160:161], v20 offset:49152
  v_mfma_f32_16x16x32_bf16 v[100:103], v[192:195], v[36:39], v[100:103]
  ds_read_b64_tr_b16 v[162:163], v20 offset:51200
  v_mfma_f32_16x16x32_bf16 v[108:111], v[196:199], v[36:39], v[108:111]
  ds_read_b64_tr_b16 v[164:165], v21 offset:49152
  v_mfma_f32_16x16x32_bf16 v[104:107], v[196:199], v[32:35], v[104:107]
  ds_read_b64_tr_b16 v[166:167], v21 offset:51200
  v_mfma_f32_16x16x32_bf16 v[112:115], v[200:203], v[32:35], v[112:115]
  ds_read_b64_tr_b16 v[168:169], v22 offset:49152
  v_mfma_f32_16x16x32_bf16 v[116:119], v[200:203], v[36:39], v[116:119]
  ds_read_b64_tr_b16 v[170:171], v22 offset:51200
  v_mfma_f32_16x16x32_bf16 v[124:127], v[204:207], v[36:39], v[124:127]
  ds_read_b64_tr_b16 v[172:173], v23 offset:49152
  v_mfma_f32_16x16x32_bf16 v[120:123], v[204:207], v[32:35], v[120:123]
  ds_read_b64_tr_b16 v[174:175], v23 offset:51200
  s_waitcnt vmcnt(12) lgkmcnt(8)
  v_mfma_f32_16x16x32_bf16 v[96:99], v[208:211], v[40:43], v[96:99]
  ds_read_b64_tr_b16 v[176:177], v20 offset:53248
  v_mfma_f32_16x16x32_bf16 v[100:103], v[208:211], v[44:47], v[100:103]
  ds_read_b64_tr_b16 v[178:179], v20 offset:55296
  v_mfma_f32_16x16x32_bf16 v[108:111], v[212:215], v[44:47], v[108:111]
  ds_read_b64_tr_b16 v[180:181], v21 offset:53248
  v_mfma_f32_16x16x32_bf16 v[104:107], v[212:215], v[40:43], v[104:107]
  ds_read_b64_tr_b16 v[182:183], v21 offset:55296
  v_mfma_f32_16x16x32_bf16 v[112:115], v[216:219], v[40:43], v[112:115]
  ds_read_b64_tr_b16 v[184:185], v22 offset:53248
  v_mfma_f32_16x16x32_bf16 v[116:119], v[216:219], v[44:47], v[116:119]
  ds_read_b64_tr_b16 v[186:187], v22 offset:55296
  v_mfma_f32_16x16x32_bf16 v[124:127], v[220:223], v[44:47], v[124:127]
  ds_read_b64_tr_b16 v[188:189], v23 offset:53248
  v_mfma_f32_16x16x32_bf16 v[120:123], v[220:223], v[40:43], v[120:123]
  ds_read_b64_tr_b16 v[190:191], v23 offset:55296
  s_waitcnt vmcnt(10) lgkmcnt(8)
  v_mfma_f32_16x16x32_bf16 v[96:99], v[160:163], v[48:51], v[96:99]
  ds_read_b64_tr_b16 v[192:193], v20 offset:57344
  s_waitcnt vmcnt(3)
  v_mfma_f32_16x16x32_bf16 v[100:103], v[160:163], v[52:55], v[100:103]
  ds_read_b64_tr_b16 v[194:195], v20 offset:59392
  v_lshlrev_b32 v128, 16, v144
  v_mfma_f32_16x16x32_bf16 v[108:111], v[164:167], v[52:55], v[108:111]
  ds_read_b64_tr_b16 v[196:197], v21 offset:57344
  v_and_b32 v129, s11, v144
  v_mfma_f32_16x16x32_bf16 v[104:107], v[164:167], v[48:51], v[104:107]
  ds_read_b64_tr_b16 v[198:199], v21 offset:59392
  v_lshlrev_b32 v130, 16, v145
  v_mfma_f32_16x16x32_bf16 v[112:115], v[168:171], v[48:51], v[112:115]
  ds_read_b64_tr_b16 v[200:201], v22 offset:57344
  v_and_b32 v131, s11, v145
  v_mfma_f32_16x16x32_bf16 v[116:119], v[168:171], v[52:55], v[116:119]
  ds_read_b64_tr_b16 v[202:203], v22 offset:59392
  v_lshlrev_b32 v132, 16, v146
  v_mfma_f32_16x16x32_bf16 v[124:127], v[172:175], v[52:55], v[124:127]
  ds_read_b64_tr_b16 v[204:205], v23 offset:57344
  v_and_b32 v133, s11, v146
  v_mfma_f32_16x16x32_bf16 v[120:123], v[172:175], v[48:51], v[120:123]
  ds_read_b64_tr_b16 v[206:207], v23 offset:59392
  s_waitcnt lgkmcnt(8)
  v_mfma_f32_16x16x32_bf16 v[96:99], v[176:179], v[56:59], v[96:99]
  ds_read_b64_tr_b16 v[208:209], v20 offset:61440
  v_lshlrev_b32 v134, 16, v147
  v_mfma_f32_16x16x32_bf16 v[100:103], v[176:179], v[60:63], v[100:103]
  ds_read_b64_tr_b16 v[210:211], v20 offset:63488
  v_and_b32 v135, s11, v147
  v_mfma_f32_16x16x32_bf16 v[108:111], v[180:183], v[60:63], v[108:111]
  ds_read_b64_tr_b16 v[212:213], v21 offset:61440
  v_lshlrev_b32 v136, 16, v148
  v_mfma_f32_16x16x32_bf16 v[104:107], v[180:183], v[56:59], v[104:107]
  ds_read_b64_tr_b16 v[214:215], v21 offset:63488
  v_and_b32 v137, s11, v148
  v_mfma_f32_16x16x32_bf16 v[112:115], v[184:187], v[56:59], v[112:115]
  ds_read_b64_tr_b16 v[216:217], v22 offset:61440
  v_lshlrev_b32 v138, 16, v149
  v_mfma_f32_16x16x32_bf16 v[116:119], v[184:187], v[60:63], v[116:119]
  ds_read_b64_tr_b16 v[218:219], v22 offset:63488
  v_and_b32 v139, s11, v149
  v_mfma_f32_16x16x32_bf16 v[124:127], v[188:191], v[60:63], v[124:127]
  ds_read_b64_tr_b16 v[220:221], v23 offset:61440
  v_lshlrev_b32 v140, 16, v150
  v_mfma_f32_16x16x32_bf16 v[120:123], v[188:191], v[56:59], v[120:123]
  ds_read_b64_tr_b16 v[222:223], v23 offset:63488
  s_waitcnt vmcnt(2) lgkmcnt(8)
  v_mfma_f32_16x16x32_bf16 v[96:99], v[192:195], v[64:67], v[96:99]
  v_mov_b32 v20, 0x3f803f80
  v_mov_b32 v21, 0x3f803f80
  v_mfma_f32_16x16x32_bf16 v[100:103], v[192:195], v[68:71], v[100:103]
  v_mov_b32 v22, 0x3f803f80
  v_mov_b32 v23, 0x3f803f80
  v_mfma_f32_16x16x32_bf16 v[108:111], v[196:199], v[68:71], v[108:111]
  v_and_b32 v141, s11, v150
  v_lshlrev_b32 v142, 16, v151
  v_and_b32 v143, s11, v151
  v_mfma_f32_16x16x32_bf16 v[104:107], v[196:199], v[64:67], v[104:107]
  v_lshlrev_b32 v144, 16, v152
  v_and_b32 v145, s11, v152
  v_lshlrev_b32 v146, 16, v153
  v_mfma_f32_16x16x32_bf16 v[112:115], v[200:203], v[64:67], v[112:115]
  v_and_b32 v147, s11, v153
  v_lshlrev_b32 v148, 16, v154
  v_and_b32 v149, s11, v154
  v_mfma_f32_16x16x32_bf16 v[116:119], v[200:203], v[68:71], v[116:119]
  v_lshlrev_b32 v150, 16, v155
  v_and_b32 v151, s11, v155
  v_lshlrev_b32 v152, 16, v156
  v_mfma_f32_16x16x32_bf16 v[124:127], v[204:207], v[68:71], v[124:127]
  v_and_b32 v153, s11, v156
  v_lshlrev_b32 v154, 16, v157
  v_and_b32 v155, s11, v157
  v_mfma_f32_16x16x32_bf16 v[120:123], v[204:207], v[64:67], v[120:123]
  s_waitcnt vmcnt(0) lgkmcnt(0)
  v_lshlrev_b32 v156, 16, v158
  v_and_b32 v157, s11, v158
  v_mfma_f32_16x16x32_bf16 v[96:99], v[208:211], v[72:75], v[96:99]
  v_lshlrev_b32 v158, 16, v159
  v_and_b32 v159, s11, v159
  v_mfma_f32_16x16x32_bf16 v[100:103], v[208:211], v[76:79], v[100:103]
  v_mfma_f32_16x16x32_bf16 v[108:111], v[212:215], v[76:79], v[108:111]
  v_mfma_f32_16x16x32_bf16 v[104:107], v[212:215], v[72:75], v[104:107]
  v_mfma_f32_16x16x32_bf16 v[112:115], v[216:219], v[72:75], v[112:115]
  v_mfma_f32_16x16x32_bf16 v[116:119], v[216:219], v[76:79], v[116:119]
  v_mfma_f32_16x16x32_bf16 v[124:127], v[220:223], v[76:79], v[124:127]
  v_mfma_f32_16x16x32_bf16 v[120:123], v[220:223], v[72:75], v[120:123]
  s_lshl_b32 s3, s7, 4
  s_mov_b32 vcc_lo, 0xaaaaaaaa
  s_lshl_b32 s4, s7, 3
  s_add_u32 s5, s3, s4
  v_xor_b32 v6, 32, v4
  v_xor_b32 v7, 64, v4
  v_xor_b32 v8, 96, v4
  v_xor_b32 v9, 64, v12
  v_pk_add_f32 v[96:97], v[96:97], v[128:129]
  v_pk_add_f32 v[98:99], v[98:99], v[130:131]
  v_cvt_pk_bf16_f32 v240, v96, v97
  v_cvt_pk_bf16_f32 v241, v98, v99
  v_pk_add_f32 v[104:105], v[104:105], v[136:137]
  v_pk_add_f32 v[106:107], v[106:107], v[138:139]
  v_cvt_pk_bf16_f32 v242, v104, v105
  v_cvt_pk_bf16_f32 v243, v106, v107
  ds_write_b64 v4, v[240:241] offset:0
  ds_write_b64 v6, v[242:243] offset:0
  v_pk_add_f32 v[112:113], v[112:113], v[144:145]
  v_pk_add_f32 v[114:115], v[114:115], v[146:147]
  v_cvt_pk_bf16_f32 v244, v112, v113
  v_cvt_pk_bf16_f32 v245, v114, v115
  v_pk_add_f32 v[120:121], v[120:121], v[152:153]
  v_pk_add_f32 v[122:123], v[122:123], v[154:155]
  v_cvt_pk_bf16_f32 v246, v120, v121
  v_cvt_pk_bf16_f32 v247, v122, v123
  ds_write_b64 v7, v[244:245] offset:0
  ds_write_b64 v8, v[246:247] offset:0
  ds_read_b128 v[32:35], v5 offset:0
  ds_read_b128 v[36:39], v5 offset:1024
  v_pk_add_f32 v[100:101], v[100:101], v[132:133]
  v_pk_add_f32 v[102:103], v[102:103], v[134:135]
  v_cvt_pk_bf16_f32 v248, v100, v101
  v_cvt_pk_bf16_f32 v249, v102, v103
  v_pk_add_f32 v[108:109], v[108:109], v[140:141]
  v_pk_add_f32 v[110:111], v[110:111], v[142:143]
  v_cvt_pk_bf16_f32 v250, v108, v109
  v_cvt_pk_bf16_f32 v251, v110, v111
  ds_write_b64 v4, v[248:249] offset:2048
  ds_write_b64 v6, v[250:251] offset:2048
  v_pk_add_f32 v[116:117], v[116:117], v[148:149]
  v_pk_add_f32 v[118:119], v[118:119], v[150:151]
  v_cvt_pk_bf16_f32 v252, v116, v117
  v_cvt_pk_bf16_f32 v253, v118, v119
  v_pk_add_f32 v[124:125], v[124:125], v[156:157]
  v_pk_add_f32 v[126:127], v[126:127], v[158:159]
  v_cvt_pk_bf16_f32 v254, v124, v125
  v_cvt_pk_bf16_f32 v255, v126, v127
  ds_write_b64 v7, v[252:253] offset:2048
  ds_write_b64 v8, v[254:255] offset:2048
  ds_read_b128 v[40:43], v5 offset:2048
  ds_read_b128 v[44:47], v5 offset:3072
  s_waitcnt lgkmcnt(7)
  buffer_store_dwordx4 v[32:35], v12, s[40:43], 0 offen sc1
  s_waitcnt lgkmcnt(6)
  buffer_store_dwordx4 v[36:39], v9, s[40:43], s4 offen sc1
  v_mfma_f32_16x16x32_bf16 v[52:55], v[240:243], v[240:243], 0
  s_mov_b32 vcc_hi, vcc_lo
  v_mfma_f32_16x16x32_bf16 v[48:51], v[20:23], v[240:243], 0
  s_mov_b32 s8, 0xcccccccc
  v_mfma_f32_16x16x32_bf16 v[52:55], v[244:247], v[244:247], v[52:55]
  s_mov_b32 s9, s8
  v_mfma_f32_16x16x32_bf16 v[48:51], v[20:23], v[244:247], v[48:51]
  s_waitcnt lgkmcnt(1)
  buffer_store_dwordx4 v[40:43], v12, s[40:43], s3 offen sc1
  s_waitcnt lgkmcnt(0)
  buffer_store_dwordx4 v[44:47], v9, s[40:43], s5 offen sc1
  s_cmp_eq_u32 s96, 1
  s_cbranch_scc1 L_w2_end
  v_mfma_f32_16x16x32_bf16 v[60:63], v[248:251], v[248:251], 0
  v_mfma_f32_16x16x32_bf16 v[56:59], v[20:23], v[248:251], 0
  v_mfma_f32_16x16x32_bf16 v[60:63], v[252:255], v[252:255], v[60:63]
  v_mfma_f32_16x16x32_bf16 v[56:59], v[20:23], v[252:255], v[56:59]
  v_cndmask_b32 v52, v52, v53, vcc
  v_cndmask_b32 v54, v54, v55, vcc
  v_cndmask_b32 v49, v52, v54, s[8:9]
  buffer_store_dwordx2 v[48:49], v18, s[56:59], 0 offen offset:0 sc1
  s_nop 2
  v_cndmask_b32 v60, v60, v61, vcc
  v_cndmask_b32 v62, v62, v63, vcc
  v_cndmask_b32 v57, v60, v62, s[8:9]
  buffer_store_dwordx2 v[56:57], v18, s[56:59], 0 offen offset:128 sc1
  s_waitcnt vmcnt(0) lgkmcnt(0)
  s_barrier
  s_mov_b32 s96, 1
  s_add_u32 s12, s22, 33554432
  s_addc_u32 s13, s23, 0
  s_add_u32 s34, s22, 67108864
  s_addc_u32 s35, s23, 0
  s_add_u32 s97, s97, 1
  s_branch L_attn_body
L_w2_c1:
```

```asm
; @launch grid=(256,1,1) block=(512,1,1) lds=163840
.amdgcn_target "amdgcn-amd-amdhsa--gfx950"
.text
.globl interleave_layers__sliding_local_dilated__dense_activation_gelu__prompt_kernel
.p2align 12
.fill 832, 4, 0xbf810000
.type interleave_layers__sliding_local_dilated__dense_activation_gelu__prompt_kernel,@function
interleave_layers__sliding_local_dilated__dense_activation_gelu__prompt_kernel:
L_attn_c0:
  s_load_dwordx4 s[16:19], s[0:1], 0
  s_load_dwordx2 s[20:21], s[0:1], 16
  s_load_dwordx2 s[22:23], s[0:1], 80
  s_load_dwordx8 s[24:31], s[0:1], 32
  s_load_dwordx2 s[32:33], s[0:1], 64
  s_load_dwordx2 s[34:35], s[0:1], 80
  s_load_dwordx2 s[12:13], s[0:1], 0
  s_load_dwordx2 s[64:65], s[0:1], 72
  s_mov_b32 s96, 0
  s_mov_b32 s97, 0
L_attn_body:
  s_cmp_ge_u32 s2, 256
  s_cbranch_scc1 L_attn_end
  v_lshrrev_b32 v2, 6, v0
  v_and_b32 v1, 63, v0
  v_readfirstlane_b32 s70, v2
  s_and_b32 s3, s2, 7
  s_lshr_b32 s99, s2, 3
  s_and_b32 s5, s3, 1
  s_lshl_b32 s5, s5, 3
  s_and_b32 s6, s99, 7
  s_add_u32 s68, s5, s6
  s_lshr_b32 s5, s3, 1
  s_lshl_b32 s5, s5, 2
  s_lshr_b32 s6, s99, 3
  s_add_u32 s69, s5, s6
  s_cmp_eq_u32 s96, 0
  s_cbranch_scc1 L_attn_map
  s_and_b32 s3, s2, 7
  s_and_b32 s5, s3, 3
  s_lshl_b32 s5, s5, 2
  s_and_b32 s6, s99, 3
  s_add_u32 s68, s5, s6
  s_lshr_b32 s5, s3, 2
  s_lshl_b32 s5, s5, 3
  s_lshr_b32 s6, s99, 2
  s_add_u32 s69, s5, s6
L_attn_map:
  s_cmp_lt_u32 s70, 4
  s_cbranch_scc1 L_attn_compute
L_attn_loader:
  s_add_u32 s8, s70, s69
  s_and_b32 s8, s8, 3
  s_add_u32 s9, s70, s68
  s_and_b32 s9, s9, 3
  s_lshl_b32 s76, s8, 12
  s_lshl_b32 s77, s9, 11
  s_add_u32 s77, s77, 16384
  s_lshl_b32 s11, s68, 7
  v_and_b32 v10, 7, v1
  v_lshrrev_b32 v3, 3, v1
  s_lshr_b32 s10, s76, 7
  s_lshl_b32 s3, s68, 7
  s_add_u32 s10, s10, s3
  v_add_u32 v3, s10, v3
  s_cmp_eq_u32 s96, 1
  s_cselect_b32 s5, 128, 0
  s_add_u32 s5, s5, 2048
  s_lshl_b32 s6, s5, 3
  v_mul_u32_u24 v3, s5, v3
  v_lshrrev_b32 v2, 4, v1
  v_xor_b32 v4, v2, v10
  v_lshl_add_u32 v4, v4, 4, v3
  v_add_u32 v3, s6, v3
  v_add_u32 v5, 4, v2
  v_xor_b32 v5, v5, v10
  v_lshl_add_u32 v5, v5, 4, v3
  v_add_u32 v3, s6, v3
  v_xor_b32 v6, v2, v10
  v_lshl_add_u32 v6, v6, 4, v3
  v_add_u32 v3, s6, v3
  v_add_u32 v7, 4, v2
  v_xor_b32 v7, v7, v10
  v_lshl_add_u32 v7, v7, 4, v3
  v_lshrrev_b32 v3, 3, v1
  s_lshl_b32 s10, s9, 4
  v_add_u32 v3, s10, v3
  v_mul_u32_u24 v3, 6144, v3
  v_lshrrev_b32 v2, 3, v1
  v_and_b32 v2, 2, v2
  v_xor_b32 v2, v2, v10
  s_mul_i32 s10, s69, 128
  v_add_u32 v3, s10, v3
  v_lshl_add_u32 v8, v2, 4, v3
  v_xor_b32 v2, 4, v2
  v_add_u32 v3, 49152, v3
  v_lshl_add_u32 v9, v2, 4, v3
  s_and_b32 s10, s70, 3
  s_lshl_b32 s78, s10, 9
  s_add_u32 s78, s78, 40960
  s_lshl_b32 s14, s10, 2
  s_add_u32 s14, s14, s11
  s_sub_u32 s14, s14, 16
  v_lshrrev_b32 v3, 3, v1
  v_add_u32 v3, s14, v3
  v_max_i32 v3, 0, v3
  v_mul_u32_u24 v3, s5, v3
  s_lshl_b32 s14, s10, 1
  v_lshrrev_b32 v2, 4, v1
  v_add_u32 v2, s14, v2
  v_and_b32 v2, 7, v2
  v_xor_b32 v2, v2, v10
  v_lshl_add_u32 v28, v2, 4, v3
  s_cmp_eq_u32 s10, 0
  s_cselect_b32 s14, 0xffffff00, -1
  s_mov_b32 s15, 0
  s_mov_b32 s75, 0
  s_add_u32 s100, s68, s69
  s_mov_b32 s101, -1
  s_add_u32 s3, s68, s69
  s_and_b32 s3, s3, 3
  s_mov_b32 s100, 0x75463102
  s_mov_b32 s101, 0xfdceb98a
  s_cmp_eq_u32 s3, 1
  s_cselect_b32 s100, 0x65742130, s100
  s_cselect_b32 s101, 0xedfca9b8, s101
  s_cmp_eq_u32 s3, 2
  s_cselect_b32 s100, 0x68532410, s100
  s_cselect_b32 s101, 0xfedbac97, s101
  s_cmp_eq_u32 s3, 3
  s_cselect_b32 s100, 0x96435210, s100
  s_cselect_b32 s101, 0xfecbda87, s101
  s_mov_b32 s91, s69
  s_and_b32 s92, s69, 3
  s_add_u32 s92, s92, 1
  s_and_b32 s73, s100, 15
  s_cmp_eq_u32 s73, s91
  s_cselect_b32 s74, 4, 0
  s_lshr_b64 s[100:101], s[100:101], s74
  s_and_b32 s73, s100, 15
  s_sub_u32 s92, s92, 1
  s_cselect_b32 s73, s91, s73
  s_cselect_b32 s74, 0, 4
  s_lshr_b64 s[100:101], s[100:101], s74
  s_mul_i32 s74, s73, 393216
  s_lshl_b32 s73, s73, 7
  s_waitcnt lgkmcnt(0)
  s_mov_b32 s36, s12
  s_and_b32 s37, s13, 0xffff
  s_mov_b32 s38, 4194304
  s_mov_b32 s39, 0x00020000
  s_cmp_eq_u32 s96, 1
  s_cselect_b32 s38, 128, 0
  s_add_u32 s38, s38, 2048
  s_lshl_b32 s38, s38, 11
  s_mov_b32 s40, s18
  s_and_b32 s41, s19, 0xffff
  s_mov_b32 s42, 6291456
  s_mov_b32 s43, 0x00020000
  s_cmp_lg_u32 s96, 0
  s_cbranch_scc1 L_attn_ld1
  s_mov_b32 s48, s28
  s_and_b32 s49, s29, 0xffff
  s_mov_b32 s50, 7340032
  s_mov_b32 s51, 0x00020000
  s_cmp_eq_u32 s96, 0
  s_cselect_b32 s50, s50, 0
  s_and_b32 s3, s70, 3
  s_lshl_b32 s4, s2, 2
  s_add_u32 s3, s3, s4
  s_mul_i32 s98, s3, 3584
  s_add_u32 s98, s98, 0
  s_add_u32 s3, s75, s76
  s_add_u32 m0, s3, 0
  s_nop 0
  buffer_load_dwordx4 v4, s[36:39], s73 offen lds
  s_add_u32 m0, s3, 1024
  s_nop 0
  buffer_load_dwordx4 v5, s[36:39], s73 offen lds
  s_add_u32 m0, s3, 2048
  s_nop 0
  buffer_load_dwordx4 v6, s[36:39], s73 offen lds
  s_add_u32 m0, s3, 3072
  s_nop 0
  buffer_load_dwordx4 v7, s[36:39], s73 offen lds
  s_add_u32 m0, s78, s75
  s_mov_b64 exec, s[14:15]
  buffer_load_dwordx4 v28, s[36:39], s73 offen lds
  s_mov_b64 exec, -1
  s_add_u32 s3, s75, s77
  s_add_u32 m0, s3, 0
  s_add_u32 s4, s74, 0
  buffer_load_dwordx4 v8, s[40:43], s4 offen lds
  s_add_u32 m0, s3, 1024
  s_nop 0
  buffer_load_dwordx4 v9, s[40:43], s4 offen lds
  s_add_u32 m0, s3, 8192
  s_add_u32 s4, s74, 2048
  buffer_load_dwordx4 v8, s[40:43], s4 offen lds
  s_add_u32 m0, s3, 9216
  s_nop 0
  buffer_load_dwordx4 v9, s[40:43], s4 offen lds
  s_add_u32 m0, s3, 16384
  s_add_u32 s4, s74, 4096
  buffer_load_dwordx4 v8, s[40:43], s4 offen lds
  s_add_u32 m0, s3, 17408
  s_nop 0
  buffer_load_dwordx4 v9, s[40:43], s4 offen lds
  s_and_b32 s73, s100, 15
  s_cmp_eq_u32 s73, s91
  s_cselect_b32 s74, 4, 0
  s_lshr_b64 s[100:101], s[100:101], s74
  s_and_b32 s73, s100, 15
  s_sub_u32 s92, s92, 1
  s_cselect_b32 s73, s91, s73
  s_cselect_b32 s74, 0, 4
  s_lshr_b64 s[100:101], s[100:101], s74
  s_mul_i32 s74, s73, 393216
  s_lshl_b32 s73, s73, 7
  s_add_u32 s75, s75, 43008
  s_cmp_eq_u32 s75, 129024
  s_cselect_b32 s75, 0, s75
  s_add_u32 s3, s75, s76
  s_add_u32 m0, s3, 0
  s_nop 0
  buffer_load_dwordx4 v4, s[36:39], s73 offen lds
  s_add_u32 m0, s3, 1024
  s_nop 0
  buffer_load_dwordx4 v5, s[36:39], s73 offen lds
  s_add_u32 m0, s3, 2048
  s_nop 0
  buffer_load_dwordx4 v6, s[36:39], s73 offen lds
  s_add_u32 m0, s3, 3072
  s_nop 0
  buffer_load_dwordx4 v7, s[36:39], s73 offen lds
  s_add_u32 m0, s78, s75
  s_mov_b64 exec, s[14:15]
  buffer_load_dwordx4 v28, s[36:39], s73 offen lds
  s_mov_b64 exec, -1
  s_add_u32 s3, s75, s77
  s_add_u32 m0, s3, 0
  s_add_u32 s4, s74, 0
  buffer_load_dwordx4 v8, s[40:43], s4 offen lds
  s_add_u32 m0, s3, 1024
  s_nop 0
  buffer_load_dwordx4 v9, s[40:43], s4 offen lds
  s_add_u32 m0, s3, 8192
  s_add_u32 s4, s74, 2048
  buffer_load_dwordx4 v8, s[40:43], s4 offen lds
  s_add_u32 m0, s3, 9216
  s_nop 0
  buffer_load_dwordx4 v9, s[40:43], s4 offen lds
  s_add_u32 m0, s3, 16384
  s_add_u32 s4, s74, 4096
  buffer_load_dwordx4 v8, s[40:43], s4 offen lds
  s_add_u32 m0, s3, 17408
  s_nop 0
  buffer_load_dwordx4 v9, s[40:43], s4 offen lds
  s_and_b32 s73, s100, 15
  s_cmp_eq_u32 s73, s91
  s_cselect_b32 s74, 4, 0
  s_lshr_b64 s[100:101], s[100:101], s74
  s_and_b32 s73, s100, 15
  s_sub_u32 s92, s92, 1
  s_cselect_b32 s73, s91, s73
  s_cselect_b32 s74, 0, 4
  s_lshr_b64 s[100:101], s[100:101], s74
  s_mul_i32 s74, s73, 393216
  s_lshl_b32 s73, s73, 7
  s_add_u32 s75, s75, 43008
  s_cmp_eq_u32 s75, 129024
  s_cselect_b32 s75, 0, s75
  s_mov_b32 s52, s24
  s_and_b32 s53, s25, 0xffff
  s_mov_b32 s54, 7340032
  s_mov_b32 s55, 0x00020000
  s_min_u32 s3, s2, 223
  s_mul_i32 s4, s3, 4682
  s_lshr_b32 s4, s4, 16
  s_mul_i32 s5, s4, 14
  s_sub_u32 s3, s3, s5
  s_lshl_b32 s3, s3, 2
  s_and_b32 s5, s70, 3
  s_add_u32 s3, s3, s5
  s_mul_i32 s5, s4, 458752
  s_lshl_b32 s8, s3, 7
  s_add_u32 s95, s5, s8
  s_lshl_b32 s9, s4, 14
  s_lshl_b32 s8, s3, 8
  s_add_u32 s94, s9, s8
  v_lshrrev_b32 v2, 3, v1
  v_mul_u32_u24 v2, 7168, v2
  v_and_b32 v3, 7, v1
  v_lshl_add_u32 v26, v3, 4, v2
  s_and_b32 s3, s70, 3
  s_lshl_b32 s4, s2, 2
  s_add_u32 s3, s3, s4
  s_sub_u32 s4, 384, s40
  s_and_b32 s4, s4, 0x380
  s_mul_i32 s5, s3, 6144
  s_add_u32 s5, s5, s4
  s_buffer_load_dword s84, s[40:43], s5 offset:0
  s_buffer_load_dword s84, s[40:43], s5 offset:64
  s_buffer_load_dword s84, s[40:43], s5 offset:1024
  s_buffer_load_dword s84, s[40:43], s5 offset:1088
  s_buffer_load_dword s84, s[40:43], s5 offset:2048
  s_buffer_load_dword s84, s[40:43], s5 offset:2112
  s_buffer_load_dword s84, s[40:43], s5 offset:3072
  s_buffer_load_dword s84, s[40:43], s5 offset:3136
  s_buffer_load_dword s84, s[40:43], s5 offset:4096
  s_buffer_load_dword s84, s[40:43], s5 offset:4160
  s_buffer_load_dword s84, s[40:43], s5 offset:5120
  s_buffer_load_dword s84, s[40:43], s5 offset:5184
  s_add_u32 s56, s22, 23592960
  s_addc_u32 s57, s23, 0
  s_and_b32 s57, s57, 0xffff
  s_mov_b32 s58, 262144
  s_mov_b32 s59, 0x00020000
  s_and_b32 s3, s70, 3
  s_lshl2_add_u32 s4, s68, s3
  s_lshl_b32 s4, s4, 8
  v_lshrrev_b32 v2, 4, v1
  v_and_b32 v3, 15, v1
  v_lshl_add_u32 v3, v3, 4, s4
  v_lshl_add_u32 v18, v2, 14, v3
  s_lshl_b32 s4, s68, 5
  s_add_u32 s4, s4, s3
  s_sub_u32 s4, s4, 4
  s_max_i32 s4, s4, 0
  s_lshl_b32 s4, s4, 5
  v_lshrrev_b32 v2, 2, v1
  v_and_b32 v3, 3, v1
  v_lshl_add_u32 v3, v3, 3, s4
  v_lshl_add_u32 v19, v2, 14, v3
  s_lshl_b32 s3, s68, 2
  s_sub_u32 s3, s3, 4
  v_and_b32 v20, 7, v1
  v_add_u32 v20, s3, v20
  v_max_i32 v20, 0, v20
  v_lshlrev_b32 v20, 2, v20
  s_and_b32 s65, s65, 0xffff
  s_mov_b32 s66, 256
  s_mov_b32 s67, 0x00020000
  s_waitcnt vmcnt(11)
  s_barrier
  s_add_u32 s3, s75, s76
  s_add_u32 m0, s3, 0
  s_nop 0
  buffer_load_dwordx4 v4, s[36:39], s73 offen lds
  s_add_u32 m0, s3, 1024
  s_nop 0
  buffer_load_dwordx4 v5, s[36:39], s73 offen lds
  s_add_u32 m0, s3, 2048
  s_nop 0
  buffer_load_dwordx4 v6, s[36:39], s73 offen lds
  s_add_u32 m0, s3, 3072
  s_nop 0
  buffer_load_dwordx4 v7, s[36:39], s73 offen lds
  s_add_u32 m0, s78, s75
  s_mov_b64 exec, s[14:15]
  buffer_load_dwordx4 v28, s[36:39], s73 offen lds
  s_mov_b64 exec, -1
  s_add_u32 s3, s75, s77
  s_add_u32 m0, s3, 0
  s_add_u32 s4, s74, 0
  buffer_load_dwordx4 v8, s[40:43], s4 offen lds
  s_add_u32 m0, s3, 1024
  s_nop 0
  buffer_load_dwordx4 v9, s[40:43], s4 offen lds
  s_add_u32 m0, s3, 8192
  s_add_u32 s4, s74, 2048
  buffer_load_dwordx4 v8, s[40:43], s4 offen lds
  s_add_u32 m0, s3, 9216
  s_nop 0
  buffer_load_dwordx4 v9, s[40:43], s4 offen lds
  s_add_u32 m0, s3, 16384
  s_add_u32 s4, s74, 4096
  buffer_load_dwordx4 v8, s[40:43], s4 offen lds
  s_add_u32 m0, s3, 17408
  s_nop 0
  buffer_load_dwordx4 v9, s[40:43], s4 offen lds
  s_and_b32 s73, s100, 15
  s_cmp_eq_u32 s73, s91
  s_cselect_b32 s74, 4, 0
  s_lshr_b64 s[100:101], s[100:101], s74
  s_and_b32 s73, s100, 15
  s_sub_u32 s92, s92, 1
  s_cselect_b32 s73, s91, s73
  s_cselect_b32 s74, 0, 4
  s_lshr_b64 s[100:101], s[100:101], s74
  s_mul_i32 s74, s73, 393216
  s_lshl_b32 s73, s73, 7
  s_add_u32 s75, s75, 43008
  s_cmp_eq_u32 s75, 129024
  s_cselect_b32 s75, 0, s75
  s_buffer_load_dword s84, s[48:51], s98 offset:0
  s_buffer_load_dword s84, s[48:51], s98 offset:64
  s_buffer_load_dword s84, s[48:51], s98 offset:128
  s_buffer_load_dword s84, s[48:51], s98 offset:192
  s_add_u32 s98, s98, 256
  buffer_load_dwordx4 v[64:67], v26, s[52:55], s95 offen
  s_add_u32 s95, s95, 57344
  buffer_load_dwordx4 v[68:71], v26, s[52:55], s95 offen
  s_add_u32 s95, s95, 57344
  s_waitcnt vmcnt(13)
  s_barrier
  s_add_u32 s3, s75, s76
  s_add_u32 m0, s3, 0
  s_nop 0
  buffer_load_dwordx4 v4, s[36:39], s73 offen lds
  s_add_u32 m0, s3, 1024
  s_nop 0
  buffer_load_dwordx4 v5, s[36:39], s73 offen lds
  s_add_u32 m0, s3, 2048
  s_nop 0
  buffer_load_dwordx4 v6, s[36:39], s73 offen lds
  s_add_u32 m0, s3, 3072
  s_nop 0
  buffer_load_dwordx4 v7, s[36:39], s73 offen lds
  s_add_u32 m0, s78, s75
  s_mov_b64 exec, s[14:15]
  buffer_load_dwordx4 v28, s[36:39], s73 offen lds
  s_mov_b64 exec, -1
  s_add_u32 s3, s75, s77
  s_add_u32 m0, s3, 0
  s_add_u32 s4, s74, 0
  buffer_load_dwordx4 v8, s[40:43], s4 offen lds
  s_add_u32 m0, s3, 1024
  s_nop 0
  buffer_load_dwordx4 v9, s[40:43], s4 offen lds
  s_add_u32 m0, s3, 8192
  s_add_u32 s4, s74, 2048
  buffer_load_dwordx4 v8, s[40:43], s4 offen lds
  s_add_u32 m0, s3, 9216
  s_nop 0
  buffer_load_dwordx4 v9, s[40:43], s4 offen lds
  s_add_u32 m0, s3, 16384
  s_add_u32 s4, s74, 4096
  buffer_load_dwordx4 v8, s[40:43], s4 offen lds
  s_add_u32 m0, s3, 17408
  s_nop 0
  buffer_load_dwordx4 v9, s[40:43], s4 offen lds
  s_and_b32 s73, s100, 15
  s_cmp_eq_u32 s73, s91
  s_cselect_b32 s74, 4, 0
  s_lshr_b64 s[100:101], s[100:101], s74
  s_and_b32 s73, s100, 15
  s_sub_u32 s92, s92, 1
  s_cselect_b32 s73, s91, s73
  s_cselect_b32 s74, 0, 4
  s_lshr_b64 s[100:101], s[100:101], s74
  s_mul_i32 s74, s73, 393216
  s_lshl_b32 s73, s73, 7
  s_add_u32 s75, s75, 43008
  s_cmp_eq_u32 s75, 129024
  s_cselect_b32 s75, 0, s75
  s_buffer_load_dword s84, s[48:51], s98 offset:0
  s_buffer_load_dword s84, s[48:51], s98 offset:64
  s_buffer_load_dword s84, s[48:51], s98 offset:128
  s_buffer_load_dword s84, s[48:51], s98 offset:192
  s_add_u32 s98, s98, 256
  buffer_load_dwordx4 v[72:75], v26, s[52:55], s95 offen
  s_add_u32 s95, s95, 57344
  buffer_load_dwordx4 v[76:79], v26, s[52:55], s95 offen
  s_add_u32 s95, s95, 57344
  s_branch L_padl
.fill 200, 4, 0xbf810000
L_padl:
  s_waitcnt vmcnt(15)
  s_barrier
  s_add_u32 s3, s75, s76
  s_add_u32 m0, s3, 0
  s_nop 0
  buffer_load_dwordx4 v4, s[36:39], s73 offen lds
  s_add_u32 m0, s3, 1024
  s_nop 0
  buffer_load_dwordx4 v5, s[36:39], s73 offen lds
  s_add_u32 m0, s3, 2048
  s_nop 0
  buffer_load_dwordx4 v6, s[36:39], s73 offen lds
  s_add_u32 m0, s3, 3072
  s_nop 0
  buffer_load_dwordx4 v7, s[36:39], s73 offen lds
  s_add_u32 m0, s78, s75
  s_mov_b64 exec, s[14:15]
  buffer_load_dwordx4 v28, s[36:39], s73 offen lds
  s_mov_b64 exec, -1
  s_add_u32 s3, s75, s77
  s_add_u32 m0, s3, 0
  s_add_u32 s4, s74, 0
  buffer_load_dwordx4 v8, s[40:43], s4 offen lds
  s_add_u32 m0, s3, 1024
  s_nop 0
  buffer_load_dwordx4 v9, s[40:43], s4 offen lds
  s_add_u32 m0, s3, 8192
  s_add_u32 s4, s74, 2048
  buffer_load_dwordx4 v8, s[40:43], s4 offen lds
  s_add_u32 m0, s3, 9216
  s_nop 0
  buffer_load_dwordx4 v9, s[40:43], s4 offen lds
  s_add_u32 m0, s3, 16384
  s_add_u32 s4, s74, 4096
  buffer_load_dwordx4 v8, s[40:43], s4 offen lds
  s_add_u32 m0, s3, 17408
  s_nop 0
  buffer_load_dwordx4 v9, s[40:43], s4 offen lds
  s_and_b32 s73, s100, 15
  s_cmp_eq_u32 s73, s91
  s_cselect_b32 s74, 4, 0
  s_lshr_b64 s[100:101], s[100:101], s74
  s_and_b32 s73, s100, 15
  s_sub_u32 s92, s92, 1
  s_cselect_b32 s73, s91, s73
  s_cselect_b32 s74, 0, 4
  s_lshr_b64 s[100:101], s[100:101], s74
  s_mul_i32 s74, s73, 393216
  s_lshl_b32 s73, s73, 7
  s_add_u32 s75, s75, 43008
  s_cmp_eq_u32 s75, 129024
  s_cselect_b32 s75, 0, s75
  s_buffer_load_dword s84, s[48:51], s98 offset:0
  s_buffer_load_dword s84, s[48:51], s98 offset:64
  s_buffer_load_dword s84, s[48:51], s98 offset:128
  s_buffer_load_dword s84, s[48:51], s98 offset:192
  s_add_u32 s98, s98, 256
  buffer_load_dwordx4 v[80:83], v26, s[52:55], s95 offen
  s_add_u32 s95, s95, 57344
  buffer_load_dwordx4 v[84:87], v26, s[52:55], s95 offen
  s_add_u32 s95, s95, 57344
  s_waitcnt vmcnt(15)
  s_barrier
  s_add_u32 s3, s75, s76
  s_add_u32 m0, s3, 0
  s_nop 0
  buffer_load_dwordx4 v4, s[36:39], s73 offen lds
  s_add_u32 m0, s3, 1024
  s_nop 0
  buffer_load_dwordx4 v5, s[36:39], s73 offen lds
  s_add_u32 m0, s3, 2048
  s_nop 0
  buffer_load_dwordx4 v6, s[36:39], s73 offen lds
  s_add_u32 m0, s3, 3072
  s_nop 0
  buffer_load_dwordx4 v7, s[36:39], s73 offen lds
  s_add_u32 m0, s78, s75
  s_mov_b64 exec, s[14:15]
  buffer_load_dwordx4 v28, s[36:39], s73 offen lds
  s_mov_b64 exec, -1
  s_add_u32 s3, s75, s77
  s_add_u32 m0, s3, 0
  s_add_u32 s4, s74, 0
  buffer_load_dwordx4 v8, s[40:43], s4 offen lds
  s_add_u32 m0, s3, 1024
  s_nop 0
  buffer_load_dwordx4 v9, s[40:43], s4 offen lds
  s_add_u32 m0, s3, 8192
  s_add_u32 s4, s74, 2048
  buffer_load_dwordx4 v8, s[40:43], s4 offen lds
  s_add_u32 m0, s3, 9216
  s_nop 0
  buffer_load_dwordx4 v9, s[40:43], s4 offen lds
  s_add_u32 m0, s3, 16384
  s_add_u32 s4, s74, 4096
  buffer_load_dwordx4 v8, s[40:43], s4 offen lds
  s_add_u32 m0, s3, 17408
  s_nop 0
  buffer_load_dwordx4 v9, s[40:43], s4 offen lds
  s_and_b32 s73, s100, 15
  s_cmp_eq_u32 s73, s91
  s_cselect_b32 s74, 4, 0
  s_lshr_b64 s[100:101], s[100:101], s74
  s_and_b32 s73, s100, 15
  s_sub_u32 s92, s92, 1
  s_cselect_b32 s73, s91, s73
  s_cselect_b32 s74, 0, 4
  s_lshr_b64 s[100:101], s[100:101], s74
  s_mul_i32 s74, s73, 393216
  s_lshl_b32 s73, s73, 7
  s_add_u32 s75, s75, 43008
  s_cmp_eq_u32 s75, 129024
  s_cselect_b32 s75, 0, s75
  s_buffer_load_dword s84, s[48:51], s98 offset:0
  s_buffer_load_dword s84, s[48:51], s98 offset:64
  s_buffer_load_dword s84, s[48:51], s98 offset:128
  s_buffer_load_dword s84, s[48:51], s98 offset:192
  s_add_u32 s98, s98, 256
  buffer_load_dwordx4 v[88:91], v26, s[52:55], s95 offen
  s_add_u32 s95, s95, 57344
  buffer_load_dwordx4 v[92:95], v26, s[52:55], s95 offen
  s_waitcnt vmcnt(15)
  s_barrier
  s_add_u32 s3, s75, s76
  s_add_u32 m0, s3, 0
  s_nop 0
  buffer_load_dwordx4 v4, s[36:39], s73 offen lds
  s_add_u32 m0, s3, 1024
  s_nop 0
  buffer_load_dwordx4 v5, s[36:39], s73 offen lds
  s_add_u32 m0, s3, 2048
  s_nop 0
  buffer_load_dwordx4 v6, s[36:39], s73 offen lds
  s_add_u32 m0, s3, 3072
  s_nop 0
  buffer_load_dwordx4 v7, s[36:39], s73 offen lds
  s_add_u32 m0, s78, s75
  s_mov_b64 exec, s[14:15]
  buffer_load_dwordx4 v28, s[36:39], s73 offen lds
  s_mov_b64 exec, -1
  s_add_u32 s3, s75, s77
  s_add_u32 m0, s3, 0
  s_add_u32 s4, s74, 0
  buffer_load_dwordx4 v8, s[40:43], s4 offen lds
  s_add_u32 m0, s3, 1024
  s_nop 0
  buffer_load_dwordx4 v9, s[40:43], s4 offen lds
  s_add_u32 m0, s3, 8192
  s_add_u32 s4, s74, 2048
  buffer_load_dwordx4 v8, s[40:43], s4 offen lds
  s_add_u32 m0, s3, 9216
  s_nop 0
  buffer_load_dwordx4 v9, s[40:43], s4 offen lds
  s_add_u32 m0, s3, 16384
  s_add_u32 s4, s74, 4096
  buffer_load_dwordx4 v8, s[40:43], s4 offen lds
  s_add_u32 m0, s3, 17408
  s_nop 0
  buffer_load_dwordx4 v9, s[40:43], s4 offen lds
  s_and_b32 s73, s100, 15
  s_cmp_eq_u32 s73, s91
  s_cselect_b32 s74, 4, 0
  s_lshr_b64 s[100:101], s[100:101], s74
  s_and_b32 s73, s100, 15
  s_sub_u32 s92, s92, 1
  s_cselect_b32 s73, s91, s73
  s_cselect_b32 s74, 0, 4
  s_lshr_b64 s[100:101], s[100:101], s74
  s_mul_i32 s74, s73, 393216
  s_lshl_b32 s73, s73, 7
  s_add_u32 s75, s75, 43008
  s_cmp_eq_u32 s75, 129024
  s_cselect_b32 s75, 0, s75
  s_buffer_load_dword s84, s[48:51], s98 offset:0
  s_buffer_load_dword s84, s[48:51], s98 offset:64
  s_buffer_load_dword s84, s[48:51], s98 offset:128
  s_buffer_load_dword s84, s[48:51], s98 offset:192
  s_add_u32 s98, s98, 256
  s_waitcnt vmcnt(13)
  s_barrier
  s_mov_b32 s79, 8
L_attn0_ld1:
  s_add_u32 s3, s75, s76
  s_add_u32 m0, s3, 0
  s_nop 0
  buffer_load_dwordx4 v4, s[36:39], s73 offen lds
  s_add_u32 m0, s3, 1024
  s_nop 0
  buffer_load_dwordx4 v5, s[36:39], s73 offen lds
  s_add_u32 m0, s3, 2048
  s_nop 0
  buffer_load_dwordx4 v6, s[36:39], s73 offen lds
  s_add_u32 m0, s3, 3072
  s_nop 0
  buffer_load_dwordx4 v7, s[36:39], s73 offen lds
  s_add_u32 m0, s78, s75
  s_mov_b64 exec, s[14:15]
  buffer_load_dwordx4 v28, s[36:39], s73 offen lds
  s_mov_b64 exec, -1
  s_add_u32 s3, s75, s77
  s_add_u32 m0, s3, 0
  s_add_u32 s4, s74, 0
  buffer_load_dwordx4 v8, s[40:43], s4 offen lds
  s_add_u32 m0, s3, 1024
  s_nop 0
  buffer_load_dwordx4 v9, s[40:43], s4 offen lds
  s_add_u32 m0, s3, 8192
  s_add_u32 s4, s74, 2048
  buffer_load_dwordx4 v8, s[40:43], s4 offen lds
  s_add_u32 m0, s3, 9216
  s_nop 0
  buffer_load_dwordx4 v9, s[40:43], s4 offen lds
  s_add_u32 m0, s3, 16384
  s_add_u32 s4, s74, 4096
  buffer_load_dwordx4 v8, s[40:43], s4 offen lds
  s_add_u32 m0, s3, 17408
  s_nop 0
  buffer_load_dwordx4 v9, s[40:43], s4 offen lds
  s_and_b32 s73, s100, 15
  s_cmp_eq_u32 s73, s91
  s_cselect_b32 s74, 4, 0
  s_lshr_b64 s[100:101], s[100:101], s74
  s_and_b32 s73, s100, 15
  s_sub_u32 s92, s92, 1
  s_cselect_b32 s73, s91, s73
  s_cselect_b32 s74, 0, 4
  s_lshr_b64 s[100:101], s[100:101], s74
  s_mul_i32 s74, s73, 393216
  s_lshl_b32 s73, s73, 7
  s_add_u32 s75, s75, 43008
  s_cmp_eq_u32 s75, 129024
  s_cselect_b32 s75, 0, s75
  s_buffer_load_dword s84, s[48:51], s98 offset:0
  s_buffer_load_dword s84, s[48:51], s98 offset:64
  s_buffer_load_dword s84, s[48:51], s98 offset:128
  s_buffer_load_dword s84, s[48:51], s98 offset:192
  s_add_u32 s98, s98, 256
  s_waitcnt vmcnt(11)
  s_barrier
  s_sub_u32 s79, s79, 1
  s_cmp_lg_u32 s79, 0
  s_cbranch_scc1 L_attn0_ld1
  buffer_load_dword v21, v20, s[64:67], 0 offen sc1
  s_add_u32 s3, s75, s76
  s_add_u32 m0, s3, 0
  s_nop 0
  buffer_load_dwordx4 v4, s[36:39], s73 offen lds
  s_add_u32 m0, s3, 1024
  s_nop 0
  buffer_load_dwordx4 v5, s[36:39], s73 offen lds
  s_add_u32 m0, s3, 2048
  s_nop 0
  buffer_load_dwordx4 v6, s[36:39], s73 offen lds
  s_add_u32 m0, s3, 3072
  s_nop 0
  buffer_load_dwordx4 v7, s[36:39], s73 offen lds
  s_add_u32 m0, s78, s75
  s_mov_b64 exec, s[14:15]
  buffer_load_dwordx4 v28, s[36:39], s73 offen lds
  s_mov_b64 exec, -1
  s_add_u32 s3, s75, s77
  s_add_u32 m0, s3, 0
  s_add_u32 s4, s74, 0
  buffer_load_dwordx4 v8, s[40:43], s4 offen lds
  s_add_u32 m0, s3, 1024
  s_nop 0
  buffer_load_dwordx4 v9, s[40:43], s4 offen lds
  s_add_u32 m0, s3, 8192
  s_add_u32 s4, s74, 2048
  buffer_load_dwordx4 v8, s[40:43], s4 offen lds
  s_add_u32 m0, s3, 9216
  s_nop 0
  buffer_load_dwordx4 v9, s[40:43], s4 offen lds
  s_add_u32 m0, s3, 16384
  s_add_u32 s4, s74, 4096
  buffer_load_dwordx4 v8, s[40:43], s4 offen lds
  s_add_u32 m0, s3, 17408
  s_nop 0
  buffer_load_dwordx4 v9, s[40:43], s4 offen lds
  s_and_b32 s73, s100, 15
  s_cmp_eq_u32 s73, s91
  s_cselect_b32 s74, 4, 0
  s_lshr_b64 s[100:101], s[100:101], s74
  s_and_b32 s73, s100, 15
  s_sub_u32 s92, s92, 1
  s_cselect_b32 s73, s91, s73
  s_cselect_b32 s74, 0, 4
  s_lshr_b64 s[100:101], s[100:101], s74
  s_mul_i32 s74, s73, 393216
  s_lshl_b32 s73, s73, 7
  s_add_u32 s75, s75, 43008
  s_cmp_eq_u32 s75, 129024
  s_cselect_b32 s75, 0, s75
  s_buffer_load_dword s84, s[48:51], s98 offset:0
  s_buffer_load_dword s84, s[48:51], s98 offset:64
  s_buffer_load_dword s84, s[48:51], s98 offset:128
  s_buffer_load_dword s84, s[48:51], s98 offset:192
  s_add_u32 s98, s98, 256
  s_waitcnt vmcnt(12)
  s_barrier
  s_waitcnt vmcnt(11)
  s_mov_b32 s5, 0x100000
  L_attn_dchk:
  v_or_b32 v13, 0xfefefefe, v21
  v_cmp_ne_u32 vcc, -1, v13
  s_cbranch_vccz L_attn_dok
  s_sub_u32 s5, s5, 1
  buffer_load_dword v21, v20, s[64:67], 0 offen sc1
  s_waitcnt vmcnt(0)
  s_cbranch_scc0 L_attn_dchk
  L_attn_dok:
  buffer_load_dwordx4 v[32:35], v18, s[56:59], 0 offen
  s_mov_b32 s3, 65536
  buffer_load_dwordx4 v[36:39], v18, s[56:59], s3 offen
  s_mov_b32 s3, 131072
  buffer_load_dwordx4 v[40:43], v18, s[56:59], s3 offen
  s_mov_b32 s3, 196608
  buffer_load_dwordx4 v[44:47], v18, s[56:59], s3 offen
  buffer_load_dwordx2 v[48:49], v19, s[56:59], 0 offen
  s_mov_b32 s5, 0xffff0000
  v_lshlrev_b32 v100, 16, v64
  v_and_b32 v101, s5, v64
  v_lshlrev_b32 v102, 16, v65
  v_and_b32 v103, s5, v65
  v_lshlrev_b32 v104, 16, v66
  v_and_b32 v105, s5, v66
  v_lshlrev_b32 v106, 16, v67
  v_and_b32 v107, s5, v67
  v_lshlrev_b32 v108, 16, v68
  v_and_b32 v68, s5, v68
  v_add_f32 v100, v100, v108
  v_add_f32 v101, v101, v68
  v_lshlrev_b32 v108, 16, v69
  v_and_b32 v69, s5, v69
  v_add_f32 v102, v102, v108
  v_add_f32 v103, v103, v69
  v_lshlrev_b32 v108, 16, v70
  v_and_b32 v70, s5, v70
  v_add_f32 v104, v104, v108
  v_add_f32 v105, v105, v70
  v_lshlrev_b32 v108, 16, v71
  v_and_b32 v71, s5, v71
  v_add_f32 v106, v106, v108
  v_add_f32 v107, v107, v71
  v_lshlrev_b32 v108, 16, v72
  v_and_b32 v72, s5, v72
  v_add_f32 v100, v100, v108
  v_add_f32 v101, v101, v72
  v_lshlrev_b32 v108, 16, v73
  v_and_b32 v73, s5, v73
  v_add_f32 v102, v102, v108
  v_add_f32 v103, v103, v73
  v_lshlrev_b32 v108, 16, v74
  v_and_b32 v74, s5, v74
  v_add_f32 v104, v104, v108
  v_add_f32 v105, v105, v74
  v_lshlrev_b32 v108, 16, v75
  v_and_b32 v75, s5, v75
  v_add_f32 v106, v106, v108
  v_add_f32 v107, v107, v75
  v_lshlrev_b32 v108, 16, v76
  v_and_b32 v76, s5, v76
  v_add_f32 v100, v100, v108
  v_add_f32 v101, v101, v76
  v_lshlrev_b32 v108, 16, v77
  v_and_b32 v77, s5, v77
  v_add_f32 v102, v102, v108
  v_add_f32 v103, v103, v77
  v_lshlrev_b32 v108, 16, v78
  v_and_b32 v78, s5, v78
  v_add_f32 v104, v104, v108
  v_add_f32 v105, v105, v78
  v_lshlrev_b32 v108, 16, v79
  v_and_b32 v79, s5, v79
  v_add_f32 v106, v106, v108
  v_add_f32 v107, v107, v79
  s_mov_b32 s60, s20
  s_and_b32 s61, s21, 0xffff
  s_mov_b32 s62, 2097152
  s_mov_b32 s63, 0x00020000
  s_and_b32 s3, s70, 3
  s_mul_i32 s3, s3, 8
  s_mul_i32 s4, s99, 32
  s_add_u32 s3, s3, s4
  v_lshrrev_b32 v2, 3, v1
  v_add_u32 v2, s3, v2
  v_mul_u32_u24 v2, 2048, v2
  v_and_b32 v3, 7, v1
  v_lshl_add_u32 v2, v3, 8, v2
  s_and_b32 s3, s2, 7
  s_lshr_b32 s3, s3, 2
  s_mul_i32 s3, s3, 128
  buffer_load_dword v96, v2, s[60:63], s3 offen
  s_waitcnt vmcnt(6)
  s_barrier
  s_mov_b32 s79, 0x4000
  s_waitcnt vmcnt(1)
L_attn_schk:
  v_add_f32 v32, v32, v36
  v_add_f32 v33, v33, v37
  v_add_f32 v34, v34, v38
  v_add_f32 v35, v35, v39
  v_add_f32 v40, v40, v44
  v_add_f32 v41, v41, v45
  v_add_f32 v42, v42, v46
  v_add_f32 v43, v43, v47
  v_add_f32 v32, v32, v40
  v_add_f32 v33, v33, v41
  v_add_f32 v34, v34, v42
  v_add_f32 v35, v35, v43
  s_nop 1
  v_permlane32_swap_b32 v32, v34
  v_permlane32_swap_b32 v33, v35
  v_add_f32 v32, v32, v34
  v_add_f32 v33, v33, v35
  v_cmp_u_f32 vcc, v32, v33
  v_cmp_u_f32 s[4:5], v48, v49
  s_or_b64 s[4:5], vcc, s[4:5]
  s_cbranch_scc0 L_attn_sok
  s_sub_u32 s79, s79, 1
  s_cbranch_scc1 L_attn_sok
  buffer_load_dwordx4 v[32:35], v18, s[56:59], 0 offen sc1
  s_mov_b32 s3, 65536
  buffer_load_dwordx4 v[36:39], v18, s[56:59], s3 offen sc1
  s_mov_b32 s3, 131072
  buffer_load_dwordx4 v[40:43], v18, s[56:59], s3 offen sc1
  s_mov_b32 s3, 196608
  buffer_load_dwordx4 v[44:47], v18, s[56:59], s3 offen sc1
  buffer_load_dwordx2 v[48:49], v19, s[56:59], 0 offen sc1
  s_waitcnt vmcnt(0)
  s_branch L_attn_schk
L_attn_sok:
  v_mov_b32 v34, v32
  v_mov_b32 v35, v33
  s_nop 0
  v_permlane16_swap_b32 v32, v34
  v_permlane16_swap_b32 v33, v35
  v_add_f32 v32, v32, v34
  v_add_f32 v33, v33, v35
  v_mul_f32 v32, 0x3a800000, v32
  v_mul_f32 v33, 0x3a800000, v33
  v_fma_f32 v33, -v32, v32, v33
  v_max_f32 v33, 0, v33
  v_add_f32 v33, 0x3727c5ac, v33
  v_rsq_f32 v33, v33
  s_nop 0
  s_and_b32 s3, s70, 3
  s_lshl_b32 s5, s3, 7
  s_add_u32 s5, s5, 129088
  v_and_b32 v3, 15, v1
  v_lshrrev_b32 v2, 5, v1
  v_lshl_add_u32 v2, v3, 1, v2
  v_lshl_add_u32 v2, v2, 2, s5
  ds_write2_b32 v2, v32, v33 offset0:0 offset1:160
  v_mov_b32 v50, v48
  v_mov_b32 v51, v49
  s_nop 0
  v_permlane32_swap_b32 v48, v50
  v_permlane32_swap_b32 v49, v51
  v_add_f32 v48, v48, v50
  v_add_f32 v49, v49, v51
  v_mov_b32 v50, v48
  v_mov_b32 v51, v49
  s_nop 0
  v_permlane16_swap_b32 v48, v50
  v_permlane16_swap_b32 v49, v51
  v_add_f32 v48, v48, v50
  v_add_f32 v49, v49, v51
  s_nop 1
  v_add_f32_dpp v48, v48, v48 row_ror:8 row_mask:0xf bank_mask:0xf
  v_add_f32_dpp v49, v49, v49 row_ror:8 row_mask:0xf bank_mask:0xf
  s_nop 1
  v_add_f32_dpp v48, v48, v48 row_ror:4 row_mask:0xf bank_mask:0xf
  v_add_f32_dpp v49, v49, v49 row_ror:4 row_mask:0xf bank_mask:0xf
  v_mul_f32 v48, 0x3a800000, v48
  v_mul_f32 v49, 0x3a800000, v49
  v_fma_f32 v49, -v48, v48, v49
  v_max_f32 v49, 0, v49
  v_add_f32 v49, 0x3727c5ac, v49
  v_rsq_f32 v49, v49
  s_nop 0
  s_lshl_b32 s5, s3, 4
  s_add_u32 s5, s5, 129024
  v_and_b32 v3, 3, v1
  v_lshl_add_u32 v2, v3, 2, s5
  ds_write2_b32 v2, v48, v49 offset0:0 offset1:160
  s_mov_b32 s5, 0xffff0000
  v_lshlrev_b32 v108, 16, v80
  v_and_b32 v80, s5, v80
  v_add_f32 v100, v100, v108
  v_add_f32 v101, v101, v80
  v_lshlrev_b32 v108, 16, v81
  v_and_b32 v81, s5, v81
  v_add_f32 v102, v102, v108
  v_add_f32 v103, v103, v81
  v_lshlrev_b32 v108, 16, v82
  v_and_b32 v82, s5, v82
  v_add_f32 v104, v104, v108
  v_add_f32 v105, v105, v82
  v_lshlrev_b32 v108, 16, v83
  v_and_b32 v83, s5, v83
  v_add_f32 v106, v106, v108
  v_add_f32 v107, v107, v83
  v_lshlrev_b32 v108, 16, v84
  v_and_b32 v84, s5, v84
  v_add_f32 v100, v100, v108
  v_add_f32 v101, v101, v84
  v_lshlrev_b32 v108, 16, v85
  v_and_b32 v85, s5, v85
  v_add_f32 v102, v102, v108
  v_add_f32 v103, v103, v85
  v_lshlrev_b32 v108, 16, v86
  v_and_b32 v86, s5, v86
  v_add_f32 v104, v104, v108
  v_add_f32 v105, v105, v86
  v_lshlrev_b32 v108, 16, v87
  v_and_b32 v87, s5, v87
  v_add_f32 v106, v106, v108
  v_add_f32 v107, v107, v87
  v_lshlrev_b32 v108, 16, v88
  v_and_b32 v88, s5, v88
  v_add_f32 v100, v100, v108
  v_add_f32 v101, v101, v88
  v_lshlrev_b32 v108, 16, v89
  v_and_b32 v89, s5, v89
  v_add_f32 v102, v102, v108
  v_add_f32 v103, v103, v89
  v_lshlrev_b32 v108, 16, v90
  v_and_b32 v90, s5, v90
  v_add_f32 v104, v104, v108
  v_add_f32 v105, v105, v90
  v_lshlrev_b32 v108, 16, v91
  v_and_b32 v91, s5, v91
  v_add_f32 v106, v106, v108
  v_add_f32 v107, v107, v91
  v_lshlrev_b32 v108, 16, v92
  v_and_b32 v92, s5, v92
  v_add_f32 v100, v100, v108
  v_add_f32 v101, v101, v92
  v_lshlrev_b32 v108, 16, v93
  v_and_b32 v93, s5, v93
  v_add_f32 v102, v102, v108
  v_add_f32 v103, v103, v93
  v_lshlrev_b32 v108, 16, v94
  v_and_b32 v94, s5, v94
  v_add_f32 v104, v104, v108
  v_add_f32 v105, v105, v94
  v_lshlrev_b32 v108, 16, v95
  v_and_b32 v95, s5, v95
  v_add_f32 v106, v106, v108
  v_add_f32 v107, v107, v95
  s_add_u32 s52, s22, 24641536
  s_addc_u32 s53, s23, 0
  s_and_b32 s53, s53, 0xffff
  s_mov_b32 s54, 262144
  s_mov_b32 s55, 0x00020000
  v_permlane32_swap_b32 v100, v104
  v_permlane32_swap_b32 v101, v105
  v_permlane32_swap_b32 v102, v106
  v_permlane32_swap_b32 v103, v107
  v_add_f32 v100, v100, v104
  v_add_f32 v101, v101, v105
  v_add_f32 v102, v102, v106
  v_add_f32 v103, v103, v107
  v_and_b32 v2, 7, v1
  v_lshlrev_b32 v2, 5, v2
  v_permlane16_swap_b32 v100, v102
  v_permlane16_swap_b32 v101, v103
  v_add_f32 v100, v100, v102
  v_add_f32 v101, v101, v103
  v_lshrrev_b32 v3, 4, v1
  v_lshl_add_u32 v102, v3, 3, v2
  v_add_f32_dpp v100, v100, v100 row_ror:8 row_mask:0xf bank_mask:0xf
  v_add_f32_dpp v101, v101, v101 row_ror:8 row_mask:0xf bank_mask:0xf
  buffer_store_dwordx2 v[100:101], v102, s[52:55], s94 offen sc1
  s_waitcnt lgkmcnt(0)
  s_barrier
  s_branch L_attn_ldend
L_attn_ld1:
  s_add_u32 s3, s68, s69
  s_and_b32 s3, s3, 3
  s_mov_b32 s100, 0x68532410
  s_mov_b32 s101, 0xfedbac97
  s_cmp_eq_u32 s3, 1
  s_cselect_b32 s100, 0x96435210, s100
  s_cselect_b32 s101, 0xfecbda87, s101
  s_cmp_eq_u32 s3, 2
  s_cselect_b32 s100, 0x75463210, s100
  s_cselect_b32 s101, 0xfdceb98a, s101
  s_cmp_eq_u32 s3, 3
  s_cselect_b32 s100, 0x65743210, s100
  s_cselect_b32 s101, 0xedfca9b8, s101
  s_add_u32 s56, s22, 24379392
  s_addc_u32 s57, s23, 0
  s_and_b32 s57, s57, 0xffff
  s_mov_b32 s58, 262144
  s_mov_b32 s59, 0x00020000
  s_and_b32 s3, s70, 3
  s_lshl2_add_u32 s4, s68, s3
  s_lshl_b32 s4, s4, 8
  v_lshrrev_b32 v2, 4, v1
  v_and_b32 v3, 15, v1
  v_lshl_add_u32 v3, v3, 4, s4
  v_lshl_add_u32 v18, v2, 14, v3
  s_lshl_b32 s4, s68, 5
  s_add_u32 s4, s4, s3
  s_sub_u32 s4, s4, 4
  s_max_i32 s4, s4, 0
  s_lshl_b32 s4, s4, 5
  v_lshrrev_b32 v2, 2, v1
  v_and_b32 v3, 3, v1
  v_lshl_add_u32 v3, v3, 3, s4
  v_lshl_add_u32 v19, v2, 14, v3
  s_add_u32 s64, s22, 41943040
  s_addc_u32 s65, s23, 0
  s_and_b32 s65, s65, 0xffff
  s_mov_b32 s66, 524288
  s_mov_b32 s67, 0x00020000
  v_and_b32 v30, 3, v1
  v_lshlrev_b32 v30, 6, v30
  s_mov_b32 s79, 0x100000
  s_cmp_lg_u32 s70, 4
  s_cbranch_scc1 L_attn_xgo
  s_setprio 3
L_attn_xpoll:
  buffer_load_dword v12, v30, s[64:67], s86 offen sc1
  s_sub_u32 s79, s79, 1
  s_cbranch_scc1 L_attn_xgo
  s_waitcnt vmcnt(0)
  v_cmp_ne_u32 vcc, 1, v12
  s_cbranch_vccnz L_attn_xpoll
L_attn_xgo:
  s_setprio 0
  s_barrier
  s_lshr_b32 s3, s69, 3
  s_and_b32 s73, s69, 7
  s_lshl1_add_u32 s91, s73, s3
  s_mul_i32 s74, s91, 393216
  s_lshl_b32 s73, s91, 7
  s_mov_b32 s88, s73
  s_add_u32 m0, s77, 0
  s_add_u32 s4, s74, 0
  buffer_load_dwordx4 v8, s[40:43], s4 offen lds
  s_add_u32 m0, s77, 1024
  s_nop 0
  buffer_load_dwordx4 v9, s[40:43], s4 offen lds
  s_add_u32 m0, s77, 8192
  s_add_u32 s4, s74, 2048
  buffer_load_dwordx4 v8, s[40:43], s4 offen lds
  s_add_u32 m0, s77, 9216
  s_nop 0
  buffer_load_dwordx4 v9, s[40:43], s4 offen lds
  s_add_u32 m0, s77, 16384
  s_add_u32 s4, s74, 4096
  buffer_load_dwordx4 v8, s[40:43], s4 offen lds
  s_add_u32 m0, s77, 17408
  s_nop 0
  buffer_load_dwordx4 v9, s[40:43], s4 offen lds
  s_and_b32 s73, s100, 15
  s_cmp_eq_u32 s73, s91
  s_cselect_b32 s74, 4, 0
  s_lshr_b64 s[100:101], s[100:101], s74
  s_and_b32 s73, s100, 15
  s_lshr_b64 s[100:101], s[100:101], 4
  s_mul_i32 s74, s73, 393216
  s_lshl_b32 s73, s73, 7
  s_mov_b32 s75, 0
  s_add_u32 s44, s22, 41943040
  s_addc_u32 s45, s23, 0
  s_and_b32 s45, s45, 0xffff
  s_mov_b32 s46, 524288
  s_mov_b32 s47, 0x00020000
  s_lshl4_add_u32 s3, s97, s68
  s_and_b32 s4, s69, 15
  s_lshl4_add_u32 s3, s3, s4
  s_lshl_b32 s3, s3, 7
  s_sub_u32 s3, s3, 32768
  v_lshlrev_b32 v11, 7, v1
  s_cmp_eq_u32 s68, 0
  s_cselect_b32 s4, 15, 31
  v_and_b32 v2, 16, v1
  v_lshl_add_u32 v11, v2, 2, v11
  v_and_b32 v2, s4, v1
  v_lshlrev_b32 v2, 2, v2
  v_mov_b32 v3, 1
  s_mov_b32 s79, 0x100000
  s_waitcnt vmcnt(0)
  s_cmp_lg_u32 s70, 4
  s_barrier
  s_cbranch_scc1 L_attn_nofl
  s_mov_b32 exec_lo, 0xffffffff
  s_mov_b32 exec_hi, 0
  buffer_store_dword v3, v11, s[44:47], s87 offen sc1
  s_mov_b64 exec, -1
L_attn_nofl:
  s_mov_b32 s5, s3
  s_mov_b32 s89, s73
  s_add_u32 m0, s77, 43008
  s_add_u32 s4, s74, 0
  buffer_load_dwordx4 v8, s[40:43], s4 offen lds
  s_add_u32 m0, s77, 44032
  s_nop 0
  buffer_load_dwordx4 v9, s[40:43], s4 offen lds
  s_add_u32 m0, s77, 51200
  s_add_u32 s4, s74, 2048
  buffer_load_dwordx4 v8, s[40:43], s4 offen lds
  s_add_u32 m0, s77, 52224
  s_nop 0
  buffer_load_dwordx4 v9, s[40:43], s4 offen lds
  s_add_u32 m0, s77, 59392
  s_add_u32 s4, s74, 4096
  buffer_load_dwordx4 v8, s[40:43], s4 offen lds
  s_add_u32 m0, s77, 60416
  s_nop 0
  buffer_load_dwordx4 v9, s[40:43], s4 offen lds
  s_and_b32 s73, s100, 15
  s_cmp_eq_u32 s73, s91
  s_cselect_b32 s74, 4, 0
  s_lshr_b64 s[100:101], s[100:101], s74
  s_and_b32 s73, s100, 15
  s_lshr_b64 s[100:101], s[100:101], 4
  s_mul_i32 s74, s73, 393216
  s_lshl_b32 s73, s73, 7
  s_mov_b32 s90, s73
  s_add_u32 m0, s77, 86016
  s_add_u32 s4, s74, 0
  buffer_load_dwordx4 v8, s[40:43], s4 offen lds
  s_add_u32 m0, s77, 87040
  s_nop 0
  buffer_load_dwordx4 v9, s[40:43], s4 offen lds
  s_add_u32 m0, s77, 94208
  s_add_u32 s4, s74, 2048
  buffer_load_dwordx4 v8, s[40:43], s4 offen lds
  s_add_u32 m0, s77, 95232
  s_nop 0
  buffer_load_dwordx4 v9, s[40:43], s4 offen lds
  s_add_u32 m0, s77, 102400
  s_add_u32 s4, s74, 4096
  buffer_load_dwordx4 v8, s[40:43], s4 offen lds
  s_add_u32 m0, s77, 103424
  s_nop 0
  buffer_load_dwordx4 v9, s[40:43], s4 offen lds
  s_and_b32 s73, s100, 15
  s_cmp_eq_u32 s73, s91
  s_cselect_b32 s74, 4, 0
  s_lshr_b64 s[100:101], s[100:101], s74
  s_and_b32 s73, s100, 15
  s_lshr_b64 s[100:101], s[100:101], 4
  s_mul_i32 s74, s73, 393216
  s_lshl_b32 s73, s73, 7
  s_mov_b32 s3, s5
  s_cmp_lg_u32 s70, 4
  s_cbranch_scc1 L_attn_dep
L_attn_poll:
  buffer_load_dword v3, v2, s[44:47], s3 offen sc1
  s_sub_u32 s79, s79, 1
  s_cbranch_scc1 L_attn_dep
  s_waitcnt vmcnt(0)
  v_cmp_ne_u32 vcc, 1, v3
  s_cbranch_vccnz L_attn_poll
L_attn_dep:
  s_waitcnt vmcnt(6)
  s_barrier
  s_add_u32 m0, s78, 89344
  s_mov_b64 exec, s[14:15]
  buffer_load_dwordx4 v28, s[36:39], s88 offen lds
  s_mov_b64 exec, -1
  s_add_u32 m0, s76, 43008
  s_nop 0
  buffer_load_dwordx4 v4, s[36:39], s89 offen lds
  s_add_u32 m0, s76, 44032
  s_nop 0
  buffer_load_dwordx4 v5, s[36:39], s89 offen lds
  s_add_u32 m0, s76, 45056
  s_nop 0
  buffer_load_dwordx4 v6, s[36:39], s89 offen lds
  s_add_u32 m0, s76, 46080
  s_nop 0
  buffer_load_dwordx4 v7, s[36:39], s89 offen lds
  s_add_u32 m0, s78, 43008
  s_mov_b64 exec, s[14:15]
  buffer_load_dwordx4 v28, s[36:39], s89 offen lds
  s_mov_b64 exec, -1
  s_add_u32 m0, s76, 86016
  s_nop 0
  buffer_load_dwordx4 v4, s[36:39], s90 offen lds
  s_add_u32 m0, s76, 87040
  s_nop 0
  buffer_load_dwordx4 v5, s[36:39], s90 offen lds
  s_add_u32 m0, s76, 88064
  s_nop 0
  buffer_load_dwordx4 v6, s[36:39], s90 offen lds
  s_add_u32 m0, s76, 89088
  s_nop 0
  buffer_load_dwordx4 v7, s[36:39], s90 offen lds
  s_add_u32 m0, s78, 86016
  s_mov_b64 exec, s[14:15]
  buffer_load_dwordx4 v28, s[36:39], s90 offen lds
  s_mov_b64 exec, -1
  s_waitcnt vmcnt(5)
  s_barrier
  s_mov_b32 s79, 12
L_attn1_ld1:
  s_add_u32 s3, s75, s76
  s_add_u32 m0, s3, 0
  s_nop 0
  buffer_load_dwordx4 v4, s[36:39], s73 offen lds
  s_add_u32 m0, s3, 1024
  s_nop 0
  buffer_load_dwordx4 v5, s[36:39], s73 offen lds
  s_add_u32 m0, s3, 2048
  s_nop 0
  buffer_load_dwordx4 v6, s[36:39], s73 offen lds
  s_add_u32 m0, s3, 3072
  s_nop 0
  buffer_load_dwordx4 v7, s[36:39], s73 offen lds
  s_add_u32 m0, s78, s75
  s_mov_b64 exec, s[14:15]
  buffer_load_dwordx4 v28, s[36:39], s73 offen lds
  s_mov_b64 exec, -1
  s_add_u32 s3, s75, s77
  s_add_u32 m0, s3, 0
  s_add_u32 s4, s74, 0
  buffer_load_dwordx4 v8, s[40:43], s4 offen lds
  s_add_u32 m0, s3, 1024
  s_nop 0
  buffer_load_dwordx4 v9, s[40:43], s4 offen lds
  s_add_u32 m0, s3, 8192
  s_add_u32 s4, s74, 2048
  buffer_load_dwordx4 v8, s[40:43], s4 offen lds
  s_add_u32 m0, s3, 9216
  s_nop 0
  buffer_load_dwordx4 v9, s[40:43], s4 offen lds
  s_add_u32 m0, s3, 16384
  s_add_u32 s4, s74, 4096
  buffer_load_dwordx4 v8, s[40:43], s4 offen lds
  s_add_u32 m0, s3, 17408
  s_nop 0
  buffer_load_dwordx4 v9, s[40:43], s4 offen lds
  s_and_b32 s73, s100, 15
  s_cmp_eq_u32 s73, s91
  s_cselect_b32 s74, 4, 0
  s_lshr_b64 s[100:101], s[100:101], s74
  s_and_b32 s73, s100, 15
  s_lshr_b64 s[100:101], s[100:101], 4
  s_mul_i32 s74, s73, 393216
  s_lshl_b32 s73, s73, 7
  s_add_u32 s75, s75, 43008
  s_cmp_eq_u32 s75, 129024
  s_cselect_b32 s75, 0, s75
  s_waitcnt vmcnt(11)
  s_barrier
  s_sub_u32 s79, s79, 1
  s_cmp_lg_u32 s79, 0
  s_cbranch_scc1 L_attn1_ld1
  s_add_u32 s3, s75, s76
  s_add_u32 m0, s3, 0
  s_nop 0
  buffer_load_dwordx4 v4, s[36:39], s73 offen lds
  s_add_u32 m0, s3, 1024
  s_nop 0
  buffer_load_dwordx4 v5, s[36:39], s73 offen lds
  s_add_u32 m0, s3, 2048
  s_nop 0
  buffer_load_dwordx4 v6, s[36:39], s73 offen lds
  s_add_u32 m0, s3, 3072
  s_nop 0
  buffer_load_dwordx4 v7, s[36:39], s73 offen lds
  s_add_u32 m0, s78, s75
  s_mov_b64 exec, s[14:15]
  buffer_load_dwordx4 v28, s[36:39], s73 offen lds
  s_mov_b64 exec, -1
  s_add_u32 s3, s75, s77
  s_add_u32 m0, s3, 0
  s_add_u32 s4, s74, 0
  buffer_load_dwordx4 v8, s[40:43], s4 offen lds
  s_add_u32 m0, s3, 1024
  s_nop 0
  buffer_load_dwordx4 v9, s[40:43], s4 offen lds
  s_add_u32 m0, s3, 8192
  s_add_u32 s4, s74, 2048
  buffer_load_dwordx4 v8, s[40:43], s4 offen lds
  s_add_u32 m0, s3, 9216
  s_nop 0
  buffer_load_dwordx4 v9, s[40:43], s4 offen lds
  s_add_u32 m0, s3, 16384
  s_add_u32 s4, s74, 4096
  buffer_load_dwordx4 v8, s[40:43], s4 offen lds
  s_add_u32 m0, s3, 17408
  s_nop 0
  buffer_load_dwordx4 v9, s[40:43], s4 offen lds
  s_and_b32 s73, s100, 15
  s_cmp_eq_u32 s73, s91
  s_cselect_b32 s74, 4, 0
  s_lshr_b64 s[100:101], s[100:101], s74
  s_and_b32 s73, s100, 15
  s_lshr_b64 s[100:101], s[100:101], 4
  s_mul_i32 s74, s73, 393216
  s_lshl_b32 s73, s73, 7
  s_add_u32 s75, s75, 43008
  s_cmp_eq_u32 s75, 129024
  s_cselect_b32 s75, 0, s75
  s_mov_b32 s60, s20
  s_and_b32 s61, s21, 0xffff
  s_mov_b32 s62, 2097152
  s_mov_b32 s63, 0x00020000
  s_and_b32 s3, s70, 3
  s_mul_i32 s3, s3, 8
  s_mul_i32 s4, s99, 32
  s_add_u32 s3, s3, s4
  v_lshrrev_b32 v2, 3, v1
  v_add_u32 v2, s3, v2
  v_mul_u32_u24 v2, 2048, v2
  v_and_b32 v3, 7, v1
  v_lshl_add_u32 v2, v3, 8, v2
  s_and_b32 s3, s2, 7
  s_lshr_b32 s3, s3, 2
  s_mul_i32 s3, s3, 128
  buffer_load_dword v96, v2, s[60:63], s3 offen
  s_waitcnt vmcnt(12)
  s_barrier
  buffer_load_dwordx4 v[32:35], v18, s[56:59], 0 offen
  s_mov_b32 s3, 65536
  buffer_load_dwordx4 v[36:39], v18, s[56:59], s3 offen
  s_mov_b32 s3, 131072
  buffer_load_dwordx4 v[40:43], v18, s[56:59], s3 offen
  s_mov_b32 s3, 196608
  buffer_load_dwordx4 v[44:47], v18, s[56:59], s3 offen
  buffer_load_dwordx2 v[48:49], v19, s[56:59], 0 offen
  s_waitcnt vmcnt(6)
  s_barrier
  s_waitcnt vmcnt(0)
  v_add_f32 v32, v32, v36
  v_add_f32 v33, v33, v37
  v_add_f32 v34, v34, v38
  v_add_f32 v35, v35, v39
  v_add_f32 v40, v40, v44
  v_add_f32 v41, v41, v45
  v_add_f32 v42, v42, v46
  v_add_f32 v43, v43, v47
  v_add_f32 v32, v32, v40
  v_add_f32 v33, v33, v41
  v_add_f32 v34, v34, v42
  v_add_f32 v35, v35, v43
  s_nop 1
  v_permlane32_swap_b32 v32, v34
  v_permlane32_swap_b32 v33, v35
  v_add_f32 v32, v32, v34
  v_add_f32 v33, v33, v35
  v_mov_b32 v34, v32
  v_mov_b32 v35, v33
  s_nop 0
  v_permlane16_swap_b32 v32, v34
  v_permlane16_swap_b32 v33, v35
  v_add_f32 v32, v32, v34
  v_add_f32 v33, v33, v35
  v_mul_f32 v32, 0x3a800000, v32
  v_mul_f32 v33, 0x3a800000, v33
  v_fma_f32 v33, -v32, v32, v33
  v_max_f32 v33, 0, v33
  v_add_f32 v33, 0x3727c5ac, v33
  v_rsq_f32 v33, v33
  s_nop 0
  s_and_b32 s3, s70, 3
  s_lshl_b32 s5, s3, 7
  s_add_u32 s5, s5, 129088
  v_and_b32 v3, 15, v1
  v_lshrrev_b32 v2, 5, v1
  v_lshl_add_u32 v2, v3, 1, v2
  v_lshl_add_u32 v2, v2, 2, s5
  ds_write2_b32 v2, v32, v33 offset0:0 offset1:160
  v_mov_b32 v50, v48
  v_mov_b32 v51, v49
  s_nop 0
  v_permlane32_swap_b32 v48, v50
  v_permlane32_swap_b32 v49, v51
  v_add_f32 v48, v48, v50
  v_add_f32 v49, v49, v51
  v_mov_b32 v50, v48
  v_mov_b32 v51, v49
  s_nop 0
  v_permlane16_swap_b32 v48, v50
  v_permlane16_swap_b32 v49, v51
  v_add_f32 v48, v48, v50
  v_add_f32 v49, v49, v51
  s_nop 1
  v_add_f32_dpp v48, v48, v48 row_ror:8 row_mask:0xf bank_mask:0xf
  v_add_f32_dpp v49, v49, v49 row_ror:8 row_mask:0xf bank_mask:0xf
  s_nop 1
  v_add_f32_dpp v48, v48, v48 row_ror:4 row_mask:0xf bank_mask:0xf
  v_add_f32_dpp v49, v49, v49 row_ror:4 row_mask:0xf bank_mask:0xf
  v_mul_f32 v48, 0x3a800000, v48
  v_mul_f32 v49, 0x3a800000, v49
  v_fma_f32 v49, -v48, v48, v49
  v_max_f32 v49, 0, v49
  v_add_f32 v49, 0x3727c5ac, v49
  v_rsq_f32 v49, v49
  s_nop 0
  s_lshl_b32 s5, s3, 4
  s_add_u32 s5, s5, 129024
  v_and_b32 v3, 3, v1
  v_lshl_add_u32 v2, v3, 2, s5
  ds_write2_b32 v2, v48, v49 offset0:0 offset1:160
  s_waitcnt lgkmcnt(0)
  s_barrier
L_attn_ldend:
  s_lshl_b32 s87, s97, 15
  s_lshl_b32 s4, s68, 11
  s_add_u32 s87, s87, s4
  s_lshl_b32 s4, s69, 2
  s_add_u32 s87, s87, s4
  s_add_u32 s97, s97, 1
  s_branch L_wo_body
L_attn_end:
  s_endpgm
.fill 835, 4, 0xbf810000
L_attn_compute:
  s_cmp_lg_u32 s96, 0
  s_cbranch_scc1 L_pfc1_skip
  s_getpc_b64 s[4:5]
L_pfc1:
  s_lshl_b32 s3, s99, 2
  s_add_u32 s3, s3, s70
  s_mul_i32 s3, s3, 320
  s_min_u32 s3, s3, L_w2_c1-L_attn_c0-320
  s_add_i32 s3, s3, L_attn_c0-L_pfc1
  s_ashr_i32 s6, s3, 31
  s_add_u32 s4, s4, s3
  s_addc_u32 s5, s5, s6
  s_load_dword s40, s[4:5], 0
  s_load_dword s40, s[4:5], 64
  s_load_dword s40, s[4:5], 128
  s_load_dword s40, s[4:5], 192
  s_load_dword s40, s[4:5], 256
L_pfc1_skip:
  s_and_b32 s71, s70, 1
  s_lshr_b32 s72, s70, 1
  v_and_b32 v3, 31, v1
  v_lshlrev_b32 v3, 2, v3
  v_add_u32 v3, 40960, v3
  v_mov_b32 v236, 0x3f803f80
  v_mov_b32 v237, 0x3f803f80
  v_mov_b32 v238, 0x3f803f80
  v_mov_b32 v239, 0x3f803f80
  ds_write_b32 v3, v236
  ds_write_b32 v3, v236 offset:43008
  v_add_u32 v3, 86016, v3
  ds_write_b32 v3, v236
  ds_write_b32 v3, v236 offset:3328
  v_and_b32 v3, 15, v1
  v_lshrrev_b32 v2, 4, v1
  v_lshrrev_b32 v33, 1, v3
  s_lshl_b32 s8, s71, 13
  v_xor_b32 v4, v2, v33
  v_lshlrev_b32 v4, 4, v4
  v_lshl_add_u32 v4, v3, 7, v4
  v_add_u32 v8, 40960, v4
  v_add_u32 v4, s8, v4
  v_add_u32 v5, 4, v2
  v_xor_b32 v5, v5, v33
  v_lshlrev_b32 v5, 4, v5
  v_lshl_add_u32 v5, v3, 7, v5
  v_add_u32 v9, 40960, v5
  v_add_u32 v5, s8, v5
  v_bfe_u32 v34, v1, 2, 2
  v_lshl_add_u32 v34, v2, 3, v34
  v_lshlrev_b32 v34, 7, v34
  v_and_b32 v33, 3, v1
  v_lshl_add_u32 v34, v33, 3, v34
  v_bfe_u32 v33, v1, 3, 2
  v_lshl_add_u32 v34, v33, 5, v34
  s_lshl_b32 s8, s70, 5
  v_xor_b32 v34, s8, v34
  v_add_u32 v6, 16384, v34
  v_xor_b32 v7, 32, v6
  s_mov_b32 s75, 0
  v_add_u32_e64 v10, s75, v4
  v_add_u32_e64 v11, s75, v5
  v_add_u32_e64 v12, s75, v6
  v_add_u32_e64 v13, s75, v7
  v_add_u32_e64 v14, s75, v8
  v_add_u32_e64 v15, s75, v9
  s_add_u32 s75, s75, 43008
  s_cmp_eq_u32 s75, 129024
  s_cselect_b32 s75, 0, s75
  s_mov_b32 vcc_hi, 0
  s_and_b32 s79, s69, 3
  s_add_u32 s79, s79, 1
  s_mul_i32 s98, s96, 2
  s_cmp_eq_u32 s96, 0
  s_cbranch_scc1 L_attn_nog
  s_mov_b32 s79, 14
  ds_read_b128 v[32:35], v10 offset:0
  ds_read_b128 v[36:39], v10 offset:2048
  ds_read_b128 v[40:43], v10 offset:4096
  ds_read_b128 v[44:47], v10 offset:6144
  ds_read_b64_tr_b16 v[52:53], v12 offset:0
  ds_read_b64_tr_b16 v[54:55], v12 offset:512
  ds_read_b64_tr_b16 v[56:57], v13 offset:0
  ds_read_b64_tr_b16 v[58:59], v13 offset:512
  ds_read_b64_tr_b16 v[60:61], v12 offset:8192
  ds_read_b64_tr_b16 v[62:63], v12 offset:8704
  ds_read_b64_tr_b16 v[64:65], v13 offset:8192
  ds_read_b64_tr_b16 v[66:67], v13 offset:8704
  ds_read_b64_tr_b16 v[68:69], v12 offset:16384
  ds_read_b64_tr_b16 v[70:71], v12 offset:16896
  ds_read_b64_tr_b16 v[72:73], v13 offset:16384
  ds_read_b64_tr_b16 v[74:75], v13 offset:16896
  s_waitcnt lgkmcnt(0)
  v_mfma_f32_16x16x32_bf16 v[128:131], v[52:55], v[32:35], 0
  ds_read_b128 v[76:79], v11 offset:0
  v_mfma_f32_16x16x32_bf16 v[132:135], v[52:55], v[36:39], 0
  ds_read_b128 v[80:83], v11 offset:2048
  v_mfma_f32_16x16x32_bf16 v[136:139], v[52:55], v[40:43], 0
  ds_read_b128 v[84:87], v11 offset:4096
  v_mfma_f32_16x16x32_bf16 v[140:143], v[52:55], v[44:47], 0
  ds_read_b128 v[88:91], v11 offset:6144
  v_mfma_f32_16x16x32_bf16 v[156:159], v[56:59], v[44:47], 0
  ds_read_b64_tr_b16 v[96:97], v12 offset:4096
  v_mfma_f32_16x16x32_bf16 v[152:155], v[56:59], v[40:43], 0
  ds_read_b64_tr_b16 v[98:99], v12 offset:4608
  v_mfma_f32_16x16x32_bf16 v[148:151], v[56:59], v[36:39], 0
  ds_read_b64_tr_b16 v[100:101], v13 offset:4096
  v_mfma_f32_16x16x32_bf16 v[144:147], v[56:59], v[32:35], 0
  ds_read_b64_tr_b16 v[102:103], v13 offset:4608
  v_mfma_f32_16x16x32_bf16 v[160:163], v[60:63], v[32:35], 0
  ds_read_b64_tr_b16 v[104:105], v12 offset:12288
  v_mfma_f32_16x16x32_bf16 v[164:167], v[60:63], v[36:39], 0
  ds_read_b64_tr_b16 v[106:107], v12 offset:12800
  v_mfma_f32_16x16x32_bf16 v[168:171], v[60:63], v[40:43], 0
  ds_read_b64_tr_b16 v[108:109], v13 offset:12288
  v_mfma_f32_16x16x32_bf16 v[172:175], v[60:63], v[44:47], 0
  ds_read_b64_tr_b16 v[110:111], v13 offset:12800
  v_mfma_f32_16x16x32_bf16 v[188:191], v[64:67], v[44:47], 0
  ds_read_b64_tr_b16 v[112:113], v12 offset:20480
  v_mfma_f32_16x16x32_bf16 v[184:187], v[64:67], v[40:43], 0
  ds_read_b64_tr_b16 v[114:115], v12 offset:20992
  v_mfma_f32_16x16x32_bf16 v[180:183], v[64:67], v[36:39], 0
  ds_read_b64_tr_b16 v[116:117], v13 offset:20480
  v_mfma_f32_16x16x32_bf16 v[176:179], v[64:67], v[32:35], 0
  ds_read_b64_tr_b16 v[118:119], v13 offset:20992
  v_mfma_f32_16x16x32_bf16 v[192:195], v[32:35], v[68:71], 0
  v_add_u32_e64 v10, s75, v4
  v_mfma_f32_16x16x32_bf16 v[196:199], v[36:39], v[68:71], 0
  v_add_u32_e64 v11, s75, v5
  v_mfma_f32_16x16x32_bf16 v[200:203], v[40:43], v[68:71], 0
  v_add_u32_e64 v12, s75, v6
  v_mfma_f32_16x16x32_bf16 v[204:207], v[44:47], v[68:71], 0
  v_add_u32_e64 v13, s75, v7
  v_mfma_f32_16x16x32_bf16 v[220:223], v[44:47], v[72:75], 0
  v_add_u32_e64 v14, s75, v8
  v_mfma_f32_16x16x32_bf16 v[216:219], v[40:43], v[72:75], 0
  v_add_u32_e64 v15, s75, v9
  v_mfma_f32_16x16x32_bf16 v[212:215], v[36:39], v[72:75], 0
  s_add_u32 s75, s75, 43008
  v_mfma_f32_16x16x32_bf16 v[208:211], v[32:35], v[72:75], 0
  s_cmp_eq_u32 s75, 129024
  s_cselect_b32 s75, 0, s75
  s_waitcnt lgkmcnt(0)
  v_mfma_f32_16x16x32_bf16 v[128:131], v[96:99], v[76:79], v[128:131]
  v_mfma_f32_16x16x32_bf16 v[132:135], v[96:99], v[80:83], v[132:135]
  v_mfma_f32_16x16x32_bf16 v[136:139], v[96:99], v[84:87], v[136:139]
  v_mfma_f32_16x16x32_bf16 v[140:143], v[96:99], v[88:91], v[140:143]
  v_mfma_f32_16x16x32_bf16 v[156:159], v[100:103], v[88:91], v[156:159]
  v_mfma_f32_16x16x32_bf16 v[152:155], v[100:103], v[84:87], v[152:155]
  v_mfma_f32_16x16x32_bf16 v[148:151], v[100:103], v[80:83], v[148:151]
  v_mfma_f32_16x16x32_bf16 v[144:147], v[100:103], v[76:79], v[144:147]
  v_mfma_f32_16x16x32_bf16 v[160:163], v[104:107], v[76:79], v[160:163]
  v_mfma_f32_16x16x32_bf16 v[164:167], v[104:107], v[80:83], v[164:167]
  v_mfma_f32_16x16x32_bf16 v[168:171], v[104:107], v[84:87], v[168:171]
  v_mfma_f32_16x16x32_bf16 v[172:175], v[104:107], v[88:91], v[172:175]
  v_mfma_f32_16x16x32_bf16 v[188:191], v[108:111], v[88:91], v[188:191]
  v_mfma_f32_16x16x32_bf16 v[184:187], v[108:111], v[84:87], v[184:187]
  v_mfma_f32_16x16x32_bf16 v[180:183], v[108:111], v[80:83], v[180:183]
  v_mfma_f32_16x16x32_bf16 v[176:179], v[108:111], v[76:79], v[176:179]
  v_mfma_f32_16x16x32_bf16 v[192:195], v[76:79], v[112:115], v[192:195]
  v_mfma_f32_16x16x32_bf16 v[196:199], v[80:83], v[112:115], v[196:199]
  v_mfma_f32_16x16x32_bf16 v[200:203], v[84:87], v[112:115], v[200:203]
  v_mfma_f32_16x16x32_bf16 v[204:207], v[88:91], v[112:115], v[204:207]
  v_mfma_f32_16x16x32_bf16 v[220:223], v[88:91], v[116:119], v[220:223]
  v_mfma_f32_16x16x32_bf16 v[216:219], v[84:87], v[116:119], v[216:219]
  v_mfma_f32_16x16x32_bf16 v[212:215], v[80:83], v[116:119], v[212:215]
  v_mfma_f32_16x16x32_bf16 v[208:211], v[76:79], v[116:119], v[208:211]
  s_barrier
  v_mov_b32 v80, v60
  v_mov_b32 v81, v61
  v_mov_b32 v82, v62
  v_mov_b32 v83, v63
  v_mov_b32 v84, v68
  v_mov_b32 v85, v69
  v_mov_b32 v86, v70
  v_mov_b32 v87, v71
  ds_read_b64_tr_b16 v[52:53], v12 offset:0
  ds_read_b64_tr_b16 v[54:55], v12 offset:512
  ds_read_b64_tr_b16 v[56:57], v13 offset:0
  ds_read_b64_tr_b16 v[58:59], v13 offset:512
  ds_read_b64_tr_b16 v[60:61], v12 offset:8192
  ds_read_b64_tr_b16 v[62:63], v12 offset:8704
  ds_read_b64_tr_b16 v[64:65], v13 offset:8192
  ds_read_b64_tr_b16 v[66:67], v13 offset:8704
  ds_read_b64_tr_b16 v[68:69], v12 offset:16384
  ds_read_b64_tr_b16 v[70:71], v12 offset:16896
  ds_read_b64_tr_b16 v[72:73], v13 offset:16384
  ds_read_b64_tr_b16 v[74:75], v13 offset:16896
L_attn_nog:
  v_and_b32 v35, 1, v2
  v_xor_b32 v35, s71, v35
  s_lshl_b32 s8, s68, 7
  s_lshl_b32 s9, s71, 6
  s_add_u32 s8, s8, s9
  s_mul_i32 s10, s8, 7
  s_lshl2_add_u32 s11, s69, s72
  s_add_u32 s10, s10, s11
  s_lshl_b32 s10, s10, 10
  v_lshl_add_u32 v31, v1, 4, s10
  s_mul_i32 s10, s72, 14336
  s_add_u32 s10, s10, 87040
  s_lshl_b32 s11, s71, 10
  s_add_u32 s4, s10, s11
  s_sub_u32 s5, s10, s11
  s_mul_i32 s6, s71, 6144
  v_lshl_add_u32 v16, v1, 4, s4
  v_add_u32 v17, s6, v16
  v_lshl_add_u32 v18, v1, 4, s5
  v_add_u32 v18, s6, v18
  v_lshl_add_u32 v19, v2, 8, s4
  v_lshl_add_u32 v20, v2, 8, s5
  v_lshl_add_u32 v21, v3, 4, s4
  v_lshl_add_u32 v22, v3, 4, s5
  s_lshl_b32 s10, s71, 8
  s_add_u32 s10, s10, 129024
  v_lshl_add_u32 v23, v3, 2, s10
  v_lshl_add_u32 v24, v2, 4, s10
  v_and_b32 v33, 1, v3
  v_cmp_eq_u32 s[48:49], 1, v33
  v_lshl_add_u32 v34, v2, 2, v33
  v_add_u32 v35, 2, v34
  v_cmp_gt_u32 s[50:51], v34, v3
  v_cmp_gt_u32 s[52:53], v35, v3
  v_mov_b32 v36, 0xffff
  v_mov_b32 v37, 0xffff0000
  v_cndmask_b32 v36, v36, v37, s[48:49]
  s_add_u32 s10, s10, 704
  v_lshl_add_u32 v34, v34, 2, s10
  v_lshl_add_u32 v35, v35, 2, s10
  v_subrev_u32 v38, 64, v34
  v_subrev_u32 v39, 64, v35
  v_cndmask_b32 v25, v34, v38, s[50:51]
  v_cndmask_b32 v26, v35, v39, s[52:53]
  v_cndmask_b32 v27, 0, v36, s[50:51]
  v_cndmask_b32 v29, 0, v36, s[52:53]
  v_xor_b32 v28, v27, v36
  v_xor_b32 v30, v29, v36
  s_cmp_eq_u32 s8, 0
  s_cselect_b64 s[54:55], s[50:51], 0
  s_cselect_b64 s[14:15], s[52:53], 0
  s_waitcnt lgkmcnt(0)
  s_add_u32 s56, s22, 23592960
  s_addc_u32 s57, s23, 0
  s_and_b32 s57, s57, 0xffff
  s_mov_b32 s58, 327680
  s_mov_b32 s59, 0x00020000
  s_cmp_lg_u32 s96, 0
  s_cbranch_scc1 L_attn_nozero
  v_mov_b32 v122, 0
  v_mov_b32 v123, 0
  v_mov_b32 v124, 0
  v_mov_b32 v125, 0
  v_mov_b32 v126, 0
  v_mov_b32 v127, 0
  v_mov_b32 v128, 0
  v_mov_b32 v129, 0
  v_mov_b32 v130, 0
  v_mov_b32 v131, 0
  v_mov_b32 v132, 0
  v_mov_b32 v133, 0
  v_mov_b32 v134, 0
  v_mov_b32 v135, 0
  v_mov_b32 v136, 0
  v_mov_b32 v137, 0
  v_mov_b32 v138, 0
  v_mov_b32 v139, 0
  v_mov_b32 v140, 0
  v_mov_b32 v141, 0
  v_mov_b32 v142, 0
  v_mov_b32 v143, 0
  v_mov_b32 v144, 0
  v_mov_b32 v145, 0
  v_mov_b32 v146, 0
  v_mov_b32 v147, 0
  v_mov_b32 v148, 0
  v_mov_b32 v149, 0
  v_mov_b32 v150, 0
  v_mov_b32 v151, 0
  v_mov_b32 v152, 0
  v_mov_b32 v153, 0
  v_mov_b32 v154, 0
  v_mov_b32 v155, 0
  v_mov_b32 v156, 0
  v_mov_b32 v157, 0
  v_mov_b32 v158, 0
  v_mov_b32 v159, 0
  v_mov_b32 v160, 0
  v_mov_b32 v161, 0
  v_mov_b32 v162, 0
  v_mov_b32 v163, 0
  v_mov_b32 v164, 0
  v_mov_b32 v165, 0
  v_mov_b32 v166, 0
  v_mov_b32 v167, 0
  v_mov_b32 v168, 0
  v_mov_b32 v169, 0
  v_mov_b32 v170, 0
  v_mov_b32 v171, 0
  v_mov_b32 v172, 0
  v_mov_b32 v173, 0
  v_mov_b32 v174, 0
  v_mov_b32 v175, 0
  v_mov_b32 v176, 0
  v_mov_b32 v177, 0
  v_mov_b32 v178, 0
  v_mov_b32 v179, 0
  v_mov_b32 v180, 0
  v_mov_b32 v181, 0
  v_mov_b32 v182, 0
  v_mov_b32 v183, 0
  v_mov_b32 v184, 0
  v_mov_b32 v185, 0
  v_mov_b32 v186, 0
  v_mov_b32 v187, 0
  v_mov_b32 v188, 0
  v_mov_b32 v189, 0
  v_mov_b32 v190, 0
  v_mov_b32 v191, 0
  v_mov_b32 v192, 0
  v_mov_b32 v193, 0
  v_mov_b32 v194, 0
  v_mov_b32 v195, 0
  v_mov_b32 v196, 0
  v_mov_b32 v197, 0
  v_mov_b32 v198, 0
  v_mov_b32 v199, 0
  v_mov_b32 v200, 0
  v_mov_b32 v201, 0
  v_mov_b32 v202, 0
  v_mov_b32 v203, 0
  v_mov_b32 v204, 0
  v_mov_b32 v205, 0
  v_mov_b32 v206, 0
  v_mov_b32 v207, 0
  v_mov_b32 v208, 0
  v_mov_b32 v209, 0
  v_mov_b32 v210, 0
  v_mov_b32 v211, 0
  v_mov_b32 v212, 0
  v_mov_b32 v213, 0
  v_mov_b32 v214, 0
  v_mov_b32 v215, 0
  v_mov_b32 v216, 0
  v_mov_b32 v217, 0
  v_mov_b32 v218, 0
  v_mov_b32 v219, 0
  v_mov_b32 v220, 0
  v_mov_b32 v221, 0
  v_mov_b32 v222, 0
  v_mov_b32 v223, 0
  v_mov_b32 v224, 0
  v_mov_b32 v225, 0
  v_mov_b32 v226, 0
  v_mov_b32 v227, 0
  v_mov_b32 v228, 0
  v_mov_b32 v229, 0
  v_mov_b32 v230, 0
  v_mov_b32 v231, 0
  v_mov_b32 v232, 0
  v_mov_b32 v233, 0
  v_mov_b32 v234, 0
  v_mov_b32 v235, 0
  s_waitcnt lgkmcnt(0)
  s_lshl_b32 s3, s72, 5
  s_add_u32 s3, s3, s8
  s_lshl_b32 s4, s69, 14
  s_lshl3_add_u32 s3, s3, s4
  v_lshrrev_b32 v121, 1, v2
  v_lshl_add_u32 v121, v121, 4, v3
  v_and_b32 v120, 1, v2
  v_lshl_add_u32 v121, v121, 1, v120
  v_lshl_add_u32 v120, v121, 2, s3
  s_add_u32 s60, s22, 41943040
  s_addc_u32 s61, s23, 0
  s_and_b32 s61, s61, 0xffff
  s_mov_b32 s62, 524288
  s_mov_b32 s63, 0x00020000
  s_lshl_b32 s3, s2, 11
  s_cmp_lg_u32 s70, 0
  s_cbranch_scc1 L_attn_noclr
  s_lshl_b32 s5, s68, 10
  s_add_u32 s4, s4, s5
  v_lshlrev_b32 v121, 4, v1
  v_mov_b32 v40, -1
  v_mov_b32 v41, -1
  v_mov_b32 v42, -1
  v_mov_b32 v43, -1
  buffer_store_dwordx4 v[40:43], v121, s[56:59], s4 offen sc1
  buffer_store_dwordx4 v[128:131], v121, s[60:63], s3 offen offset:0 sc1
  buffer_store_dwordx4 v[128:131], v121, s[60:63], s3 offen offset:1024 sc1
  v_mov_b32 v126, 1
L_attn_noclr:
  s_and_b32 s65, s65, 0xffff
  s_mov_b32 s66, 256
  s_mov_b32 s67, 0x00020000
  s_mov_b32 s7, 0x3f803f80
L_attn_nozero:
  s_waitcnt lgkmcnt(0)
  s_lshl4_add_u32 s3, s68, s69
  s_lshl2_add_u32 s3, s3, s70
  s_lshl2_add_u32 s3, s3, 0x4000
  v_lshl_add_u32 v121, v3, 16, v2
  v_add_lshl_u32 v121, v121, s3, 4
  s_mov_b32 s36, s16
  s_and_b32 s37, s17, 0xffff
  s_mov_b32 s38, 4194304
  s_mov_b32 s39, 0x00020000
  s_and_b32 s3, s2, 3
  s_and_b32 s4, s99, 3
  s_lshl2_add_u32 s3, s3, s4
  s_lshl2_add_u32 s3, s3, s70
  s_lshl_b32 s3, s3, 16
  s_bfe_u32 s4, s2, 0x10002
  s_lshr_b32 s5, s99, 2
  s_lshl1_add_u32 s4, s5, s4
  s_lshl_b32 s4, s4, 7
  s_add_u32 s42, s3, s4
  s_add_u32 s43, s42, 32768
  v_and_b32 v127, 15, v1
  v_lshlrev_b32 v33, 1, v1
  v_and_b32 v33, 32, v33
  v_lshl_add_u32 v127, v127, 11, v33
  v_lshrrev_b32 v33, 1, v1
  v_and_b32 v33, 16, v33
  v_add_u32 v127, v127, v33
  s_add_u32 s44, s34, 8439808
  s_addc_u32 s45, s35, 0
  s_and_b32 s45, s45, 0xffff
  s_mov_b32 s46, 14628864
  s_mov_b32 s47, 0x00020000
  s_cmp_eq_u32 s96, 0
  s_barrier
  s_cbranch_scc1 L_attn_first
  ds_read_b128 v[88:91], v14 offset:46336
  ds_read_b128 v[92:95], v15 offset:46336
  buffer_load_dwordx4 v[122:125], v121, s[56:59], 0 offen sc1
  ds_read_b128 v[32:35], v10 offset:0
  ds_read_b128 v[36:39], v10 offset:2048
  ds_read_b128 v[40:43], v10 offset:4096
  ds_read_b128 v[44:47], v10 offset:6144
  ds_read_b128 v[48:51], v14
  s_waitcnt lgkmcnt(5)
  v_mfma_f32_16x16x32_bf16 v[228:231], v[80:83], v[88:91], 0
  v_mfma_f32_16x16x32_bf16 v[232:235], v[88:91], v[84:87], 0
  v_mfma_f32_16x16x32_bf16 v[228:231], v[104:107], v[92:95], v[228:231]
  v_mfma_f32_16x16x32_bf16 v[232:235], v[92:95], v[112:115], v[232:235]
  s_waitcnt lgkmcnt(0)
  s_branch L_attn_loop1
L_attn_first:
  ds_read_b128 v[32:35], v10 offset:0
  ds_read_b128 v[36:39], v10 offset:2048
  ds_read_b128 v[40:43], v10 offset:4096
  ds_read_b128 v[44:47], v10 offset:6144
  ds_read_b128 v[48:51], v14
  ds_read_b64_tr_b16 v[52:53], v12 offset:0
  ds_read_b64_tr_b16 v[54:55], v12 offset:512
  ds_read_b64_tr_b16 v[56:57], v13 offset:0
  ds_read_b64_tr_b16 v[58:59], v13 offset:512
  ds_read_b64_tr_b16 v[60:61], v12 offset:8192
  ds_read_b64_tr_b16 v[62:63], v12 offset:8704
  ds_read_b64_tr_b16 v[64:65], v13 offset:8192
  ds_read_b64_tr_b16 v[66:67], v13 offset:8704
  ds_read_b64_tr_b16 v[68:69], v12 offset:16384
  ds_read_b64_tr_b16 v[70:71], v12 offset:16896
  ds_read_b64_tr_b16 v[72:73], v13 offset:16384
  ds_read_b64_tr_b16 v[74:75], v13 offset:16896
.p2align 5
  s_nop 0
  s_nop 0
  s_nop 0
  s_waitcnt lgkmcnt(0)
L_attn_loop:
  v_mfma_f32_16x16x32_bf16 v[224:227], v[52:55], v[48:51], v[224:227]
L_attn_loop1:
  ds_read_b128 v[76:79], v11 offset:0
  v_mfma_f32_16x16x32_bf16 v[128:131], v[52:55], v[32:35], v[128:131]
  ds_read_b128 v[80:83], v11 offset:2048
  v_mfma_f32_16x16x32_bf16 v[132:135], v[52:55], v[36:39], v[132:135]
  ds_read_b128 v[84:87], v11 offset:4096
  v_mfma_f32_16x16x32_bf16 v[136:139], v[52:55], v[40:43], v[136:139]
  ds_read_b128 v[88:91], v11 offset:6144
  v_mfma_f32_16x16x32_bf16 v[140:143], v[52:55], v[44:47], v[140:143]
  ds_read_b128 v[92:95], v15
  v_mfma_f32_16x16x32_bf16 v[156:159], v[56:59], v[44:47], v[156:159]
  ds_read_b64_tr_b16 v[96:97], v12 offset:4096
  v_mfma_f32_16x16x32_bf16 v[152:155], v[56:59], v[40:43], v[152:155]
  ds_read_b64_tr_b16 v[98:99], v12 offset:4608
  v_mfma_f32_16x16x32_bf16 v[148:151], v[56:59], v[36:39], v[148:151]
  ds_read_b64_tr_b16 v[100:101], v13 offset:4096
  v_mfma_f32_16x16x32_bf16 v[144:147], v[56:59], v[32:35], v[144:147]
  ds_read_b64_tr_b16 v[102:103], v13 offset:4608
  v_mfma_f32_16x16x32_bf16 v[160:163], v[60:63], v[32:35], v[160:163]
  ds_read_b64_tr_b16 v[104:105], v12 offset:12288
  v_mfma_f32_16x16x32_bf16 v[228:231], v[60:63], v[48:51], v[228:231]
  ds_read_b64_tr_b16 v[106:107], v12 offset:12800
  v_mfma_f32_16x16x32_bf16 v[164:167], v[60:63], v[36:39], v[164:167]
  ds_read_b64_tr_b16 v[108:109], v13 offset:12288
  v_mfma_f32_16x16x32_bf16 v[168:171], v[60:63], v[40:43], v[168:171]
  ds_read_b64_tr_b16 v[110:111], v13 offset:12800
  v_mfma_f32_16x16x32_bf16 v[172:175], v[60:63], v[44:47], v[172:175]
  ds_read_b64_tr_b16 v[112:113], v12 offset:20480
  v_mfma_f32_16x16x32_bf16 v[188:191], v[64:67], v[44:47], v[188:191]
  ds_read_b64_tr_b16 v[114:115], v12 offset:20992
  v_mfma_f32_16x16x32_bf16 v[184:187], v[64:67], v[40:43], v[184:187]
  ds_read_b64_tr_b16 v[116:117], v13 offset:20480
  v_mfma_f32_16x16x32_bf16 v[180:183], v[64:67], v[36:39], v[180:183]
  ds_read_b64_tr_b16 v[118:119], v13 offset:20992
  v_mfma_f32_16x16x32_bf16 v[176:179], v[64:67], v[32:35], v[176:179]
  v_add_u32_e64 v10, s75, v4
  v_mfma_f32_16x16x32_bf16 v[192:195], v[32:35], v[68:71], v[192:195]
  v_add_u32_e64 v11, s75, v5
  v_mfma_f32_16x16x32_bf16 v[232:235], v[48:51], v[68:71], v[232:235]
  v_add_u32_e64 v12, s75, v6
  v_mfma_f32_16x16x32_bf16 v[196:199], v[36:39], v[68:71], v[196:199]
  v_add_u32_e64 v13, s75, v7
  v_mfma_f32_16x16x32_bf16 v[200:203], v[40:43], v[68:71], v[200:203]
  v_add_u32_e64 v14, s75, v8
  v_mfma_f32_16x16x32_bf16 v[204:207], v[44:47], v[68:71], v[204:207]
  v_add_u32_e64 v15, s75, v9
  v_mfma_f32_16x16x32_bf16 v[220:223], v[44:47], v[72:75], v[220:223]
  s_add_u32 s75, s75, 43008
  v_mfma_f32_16x16x32_bf16 v[216:219], v[40:43], v[72:75], v[216:219]
  s_cmp_eq_u32 s75, 129024
  v_mfma_f32_16x16x32_bf16 v[212:215], v[36:39], v[72:75], v[212:215]
  s_cselect_b32 s75, 0, s75
  s_sub_u32 s79, s79, 1
  v_mfma_f32_16x16x32_bf16 v[208:211], v[32:35], v[72:75], v[208:211]
  s_waitcnt lgkmcnt(0)
  s_barrier
  v_mfma_f32_16x16x32_bf16 v[128:131], v[96:99], v[76:79], v[128:131]
  ds_read_b128 v[32:35], v10 offset:0
  v_mfma_f32_16x16x32_bf16 v[132:135], v[96:99], v[80:83], v[132:135]
  ds_read_b128 v[36:39], v10 offset:2048
  v_mfma_f32_16x16x32_bf16 v[136:139], v[96:99], v[84:87], v[136:139]
  ds_read_b128 v[40:43], v10 offset:4096
  v_mfma_f32_16x16x32_bf16 v[140:143], v[96:99], v[88:91], v[140:143]
  ds_read_b128 v[44:47], v10 offset:6144
  v_mfma_f32_16x16x32_bf16 v[156:159], v[100:103], v[88:91], v[156:159]
  ds_read_b128 v[48:51], v14
  v_mfma_f32_16x16x32_bf16 v[152:155], v[100:103], v[84:87], v[152:155]
  ds_read_b64_tr_b16 v[52:53], v12 offset:0
  v_mfma_f32_16x16x32_bf16 v[148:151], v[100:103], v[80:83], v[148:151]
  ds_read_b64_tr_b16 v[54:55], v12 offset:512
  v_mfma_f32_16x16x32_bf16 v[144:147], v[100:103], v[76:79], v[144:147]
  ds_read_b64_tr_b16 v[56:57], v13 offset:0
  v_mfma_f32_16x16x32_bf16 v[160:163], v[104:107], v[76:79], v[160:163]
  ds_read_b64_tr_b16 v[58:59], v13 offset:512
  v_mfma_f32_16x16x32_bf16 v[228:231], v[104:107], v[92:95], v[228:231]
  ds_read_b64_tr_b16 v[60:61], v12 offset:8192
  v_mfma_f32_16x16x32_bf16 v[164:167], v[104:107], v[80:83], v[164:167]
  ds_read_b64_tr_b16 v[62:63], v12 offset:8704
  v_mfma_f32_16x16x32_bf16 v[168:171], v[104:107], v[84:87], v[168:171]
  ds_read_b64_tr_b16 v[64:65], v13 offset:8192
  v_mfma_f32_16x16x32_bf16 v[172:175], v[104:107], v[88:91], v[172:175]
  ds_read_b64_tr_b16 v[66:67], v13 offset:8704
  v_mfma_f32_16x16x32_bf16 v[188:191], v[108:111], v[88:91], v[188:191]
  ds_read_b64_tr_b16 v[68:69], v12 offset:16384
  v_mfma_f32_16x16x32_bf16 v[184:187], v[108:111], v[84:87], v[184:187]
  ds_read_b64_tr_b16 v[70:71], v12 offset:16896
  v_mfma_f32_16x16x32_bf16 v[180:183], v[108:111], v[80:83], v[180:183]
  ds_read_b64_tr_b16 v[72:73], v13 offset:16384
  v_mfma_f32_16x16x32_bf16 v[176:179], v[108:111], v[76:79], v[176:179]
  ds_read_b64_tr_b16 v[74:75], v13 offset:16896
  v_mfma_f32_16x16x32_bf16 v[192:195], v[76:79], v[112:115], v[192:195]
  s_cmp_lg_u32 s79, 0
  s_cselect_b32 vcc_lo, s96, 0
  v_mfma_f32_16x16x32_bf16 v[232:235], v[92:95], v[112:115], v[232:235]
  v_mfma_f32_16x16x32_bf16 v[196:199], v[80:83], v[112:115], v[196:199]
  v_mfma_f32_16x16x32_bf16 v[200:203], v[84:87], v[112:115], v[200:203]
  v_mfma_f32_16x16x32_bf16 v[204:207], v[88:91], v[112:115], v[204:207]
  v_mfma_f32_16x16x32_bf16 v[220:223], v[88:91], v[116:119], v[220:223]
  v_mfma_f32_16x16x32_bf16 v[216:219], v[84:87], v[116:119], v[216:219]
  v_mfma_f32_16x16x32_bf16 v[212:215], v[80:83], v[116:119], v[212:215]
  v_mfma_f32_16x16x32_bf16 v[208:211], v[76:79], v[116:119], v[208:211]
  s_waitcnt lgkmcnt(0)
  s_cbranch_vccnz L_attn_loop1
  v_mfma_f32_16x16x32_bf16 v[224:227], v[96:99], v[92:95], v[224:227]
  s_cbranch_scc1 L_attn_loop
L_attn_lend:
  s_add_u32 s98, s98, 1
  s_cmp_gt_u32 s98, 2
  s_cbranch_scc1 L_attn_exit
  s_cmp_lg_u32 s98, 1
  s_cbranch_scc1 L_attn_hook0
  s_mov_b32 s79, 1
  s_cmp_lg_u32 s72, 0
  s_cbranch_scc1 L_attn_dot0
  v_dot2_f32_bf16 v122, v32, s7, v122
  v_dot2_f32_bf16 v124, v32, v32, v124
  v_dot2_f32_bf16 v123, v36, s7, v123
  v_dot2_f32_bf16 v125, v36, v36, v125
  v_dot2_f32_bf16 v122, v33, s7, v122
  v_dot2_f32_bf16 v124, v33, v33, v124
  v_dot2_f32_bf16 v123, v37, s7, v123
  v_dot2_f32_bf16 v125, v37, v37, v125
  v_dot2_f32_bf16 v122, v34, s7, v122
  v_dot2_f32_bf16 v124, v34, v34, v124
  v_dot2_f32_bf16 v123, v38, s7, v123
  v_dot2_f32_bf16 v125, v38, v38, v125
  v_dot2_f32_bf16 v122, v35, s7, v122
  v_dot2_f32_bf16 v124, v35, v35, v124
  v_dot2_f32_bf16 v123, v39, s7, v123
  v_dot2_f32_bf16 v125, v39, v39, v125
  s_branch L_attn_dote0
  L_attn_dot0:
  v_dot2_f32_bf16 v122, v40, s7, v122
  v_dot2_f32_bf16 v124, v40, v40, v124
  v_dot2_f32_bf16 v123, v44, s7, v123
  v_dot2_f32_bf16 v125, v44, v44, v125
  v_dot2_f32_bf16 v122, v41, s7, v122
  v_dot2_f32_bf16 v124, v41, v41, v124
  v_dot2_f32_bf16 v123, v45, s7, v123
  v_dot2_f32_bf16 v125, v45, v45, v125
  v_dot2_f32_bf16 v122, v42, s7, v122
  v_dot2_f32_bf16 v124, v42, v42, v124
  v_dot2_f32_bf16 v123, v46, s7, v123
  v_dot2_f32_bf16 v125, v46, v46, v125
  v_dot2_f32_bf16 v122, v43, s7, v122
  v_dot2_f32_bf16 v124, v43, v43, v124
  v_dot2_f32_bf16 v123, v47, s7, v123
  v_dot2_f32_bf16 v125, v47, v47, v125
  L_attn_dote0:
  s_cmp_lg_u32 s70, 0
  s_cbranch_scc1 L_attn_loop
  s_waitcnt vmcnt(0)
  s_lshl4_add_u32 s3, s68, s69
  s_mov_b64 exec, 1
  buffer_store_byte v126, off, s[64:67], s3 sc1
  s_mov_b64 exec, -1
  s_branch L_attn_loop
L_attn_hook0:
  s_and_b32 s79, s69, 3
  s_add_u32 s79, s79, 1
  s_sub_u32 s79, 14, s79
  s_cmp_lg_u32 s72, 0
  s_cbranch_scc1 L_attn_dot1
  v_dot2_f32_bf16 v122, v76, s7, v122
  v_dot2_f32_bf16 v124, v76, v76, v124
  v_dot2_f32_bf16 v123, v80, s7, v123
  v_dot2_f32_bf16 v125, v80, v80, v125
  v_dot2_f32_bf16 v122, v77, s7, v122
  v_dot2_f32_bf16 v124, v77, v77, v124
  v_dot2_f32_bf16 v123, v81, s7, v123
  v_dot2_f32_bf16 v125, v81, v81, v125
  v_dot2_f32_bf16 v122, v78, s7, v122
  v_dot2_f32_bf16 v124, v78, v78, v124
  v_dot2_f32_bf16 v123, v82, s7, v123
  v_dot2_f32_bf16 v125, v82, v82, v125
  v_dot2_f32_bf16 v122, v79, s7, v122
  v_dot2_f32_bf16 v124, v79, v79, v124
  v_dot2_f32_bf16 v123, v83, s7, v123
  v_dot2_f32_bf16 v125, v83, v83, v125
  s_branch L_attn_dote1
  L_attn_dot1:
  v_dot2_f32_bf16 v122, v84, s7, v122
  v_dot2_f32_bf16 v124, v84, v84, v124
  v_dot2_f32_bf16 v123, v88, s7, v123
  v_dot2_f32_bf16 v125, v88, v88, v125
  v_dot2_f32_bf16 v122, v85, s7, v122
  v_dot2_f32_bf16 v124, v85, v85, v124
  v_dot2_f32_bf16 v123, v89, s7, v123
  v_dot2_f32_bf16 v125, v89, v89, v125
  v_dot2_f32_bf16 v122, v86, s7, v122
  v_dot2_f32_bf16 v124, v86, v86, v124
  v_dot2_f32_bf16 v123, v90, s7, v123
  v_dot2_f32_bf16 v125, v90, v90, v125
  v_dot2_f32_bf16 v122, v87, s7, v122
  v_dot2_f32_bf16 v124, v87, v87, v124
  v_dot2_f32_bf16 v123, v91, s7, v123
  v_dot2_f32_bf16 v125, v91, v91, v125
  L_attn_dote1:
  s_nop 2
  v_permlane32_swap_b32 v122, v123
  v_permlane32_swap_b32 v124, v125
  v_add_f32 v122, v122, v123
  v_add_f32 v124, v124, v125
  s_nop 0
  s_nop 0
  v_permlane16_swap_b32 v122, v124
  v_add_f32 v122, v122, v124
  buffer_store_dword v122, v120, s[56:59], 0 offen sc1
  s_branch L_attn_loop
L_attn_exit:
  v_mfma_f32_16x16x32_bf16 v[224:227], v[52:55], v[48:51], v[224:227]
  ds_read_b128 v[92:95], v15
  s_mul_i32 s3, s71, -32768
  v_mfma_f32_16x16x32_bf16 v[228:231], v[60:63], v[48:51], v[228:231]
  ds_read_b64_tr_b16 v[96:97], v12 offset:4096
  v_add_u32 v10, s3, v16
  v_mfma_f32_16x16x32_bf16 v[172:175], v[60:63], v[44:47], v[172:175]
  ds_read_b64_tr_b16 v[98:99], v12 offset:4608
  v_mfma_f32_16x16x32_bf16 v[188:191], v[64:67], v[44:47], v[188:191]
  ds_read_b64_tr_b16 v[104:105], v12 offset:12288
  v_mfma_f32_16x16x32_bf16 v[232:235], v[48:51], v[68:71], v[232:235]
  ds_read_b64_tr_b16 v[106:107], v12 offset:12800
  v_mfma_f32_16x16x32_bf16 v[204:207], v[44:47], v[68:71], v[204:207]
  ds_read_b128 v[88:91], v11 offset:6144
  v_mfma_f32_16x16x32_bf16 v[220:223], v[44:47], v[72:75], v[220:223]
  ds_read_b64_tr_b16 v[108:109], v13 offset:12288
  v_mfma_f32_16x16x32_bf16 v[128:131], v[52:55], v[32:35], v[128:131]
  ds_read_b64_tr_b16 v[110:111], v13 offset:12800
  v_mfma_f32_16x16x32_bf16 v[132:135], v[52:55], v[36:39], v[132:135]
  ds_read_b64_tr_b16 v[112:113], v12 offset:20480
  v_mfma_f32_16x16x32_bf16 v[136:139], v[52:55], v[40:43], v[136:139]
  ds_read_b64_tr_b16 v[114:115], v12 offset:20992
  v_mfma_f32_16x16x32_bf16 v[140:143], v[52:55], v[44:47], v[140:143]
  ds_read_b64_tr_b16 v[116:117], v13 offset:20480
  v_mfma_f32_16x16x32_bf16 v[156:159], v[56:59], v[44:47], v[156:159]
  ds_read_b64_tr_b16 v[118:119], v13 offset:20992
  v_mfma_f32_16x16x32_bf16 v[152:155], v[56:59], v[40:43], v[152:155]
  ds_read_b128 v[76:79], v11 offset:0
  v_mfma_f32_16x16x32_bf16 v[148:151], v[56:59], v[36:39], v[148:151]
  ds_read_b128 v[80:83], v11 offset:2048
  s_waitcnt lgkmcnt(2)
  v_mfma_f32_16x16x32_bf16 v[224:227], v[96:99], v[92:95], v[224:227]
  ds_read_b128 v[84:87], v11 offset:4096
  v_mfma_f32_16x16x32_bf16 v[228:231], v[104:107], v[92:95], v[228:231]
  ds_read_b64_tr_b16 v[100:101], v13 offset:4096
  v_mfma_f32_16x16x32_bf16 v[172:175], v[104:107], v[88:91], v[172:175]
  ds_read_b64_tr_b16 v[102:103], v13 offset:4608
  v_mfma_f32_16x16x32_bf16 v[188:191], v[108:111], v[88:91], v[188:191]
  s_cmp_lg_u32 s96, 0
  s_waitcnt vmcnt(0)
  v_mfma_f32_16x16x32_bf16 v[232:235], v[92:95], v[112:115], v[232:235]
  s_cbranch_scc1 L_attn_nores
  buffer_load_dwordx4 v[240:243], v127, s[36:39], s42 offen offset:0
  buffer_load_dwordx4 v[244:247], v127, s[36:39], s42 offen offset:64
  buffer_load_dwordx4 v[248:251], v127, s[36:39], s43 offen offset:0
  buffer_load_dwordx4 v[252:255], v127, s[36:39], s43 offen offset:64
  buffer_store_dwordx4 v[224:227], v121, s[56:59], 0 offen sc1
  v_mov_b32 v122, v224
  v_mov_b32 v123, v225
  v_mov_b32 v124, v226
  v_mov_b32 v125, v227
  L_attn_nores:
  v_mfma_f32_16x16x32_bf16 v[204:207], v[88:91], v[112:115], v[204:207]
  v_mfma_f32_16x16x32_bf16 v[220:223], v[88:91], v[116:119], v[220:223]
  v_mfma_f32_16x16x32_bf16 v[144:147], v[56:59], v[32:35], v[144:147]
  ds_write_b128 v16, v[122:125]
  v_mfma_f32_16x16x32_bf16 v[160:163], v[60:63], v[32:35], v[160:163]
  v_mfma_f32_16x16x32_bf16 v[164:167], v[60:63], v[36:39], v[164:167]
  v_mfma_f32_16x16x32_bf16 v[168:171], v[60:63], v[40:43], v[168:171]
  ds_write_b128 v16, v[228:231] offset:2048
  v_mfma_f32_16x16x32_bf16 v[184:187], v[64:67], v[40:43], v[184:187]
  v_mfma_f32_16x16x32_bf16 v[180:183], v[64:67], v[36:39], v[180:183]
  v_mfma_f32_16x16x32_bf16 v[176:179], v[64:67], v[32:35], v[176:179]
  ds_write_b128 v10, v[172:175] offset:8192
  v_mfma_f32_16x16x32_bf16 v[192:195], v[32:35], v[68:71], v[192:195]
  v_mfma_f32_16x16x32_bf16 v[196:199], v[36:39], v[68:71], v[196:199]
  v_mfma_f32_16x16x32_bf16 v[200:203], v[40:43], v[68:71], v[200:203]
  ds_write_b128 v10, v[188:191] offset:9216
  v_mfma_f32_16x16x32_bf16 v[216:219], v[40:43], v[72:75], v[216:219]
  v_mfma_f32_16x16x32_bf16 v[212:215], v[36:39], v[72:75], v[212:215]
  v_mfma_f32_16x16x32_bf16 v[208:211], v[32:35], v[72:75], v[208:211]
  ds_write_b128 v16, v[232:235] offset:4096
  s_waitcnt lgkmcnt(5)
  v_mfma_f32_16x16x32_bf16 v[128:131], v[96:99], v[76:79], v[128:131]
  v_mfma_f32_16x16x32_bf16 v[132:135], v[96:99], v[80:83], v[132:135]
  v_mfma_f32_16x16x32_bf16 v[136:139], v[96:99], v[84:87], v[136:139]
  ds_write_b128 v10, v[204:207] offset:10240
  v_mfma_f32_16x16x32_bf16 v[140:143], v[96:99], v[88:91], v[140:143]
  v_mfma_f32_16x16x32_bf16 v[156:159], v[100:103], v[88:91], v[156:159]
  v_mfma_f32_16x16x32_bf16 v[152:155], v[100:103], v[84:87], v[152:155]
  ds_write_b128 v10, v[220:223] offset:11264
  v_mfma_f32_16x16x32_bf16 v[148:151], v[100:103], v[80:83], v[148:151]
  v_mfma_f32_16x16x32_bf16 v[144:147], v[100:103], v[76:79], v[144:147]
  v_mfma_f32_16x16x32_bf16 v[160:163], v[104:107], v[76:79], v[160:163]
  v_mfma_f32_16x16x32_bf16 v[164:167], v[104:107], v[80:83], v[164:167]
  v_mfma_f32_16x16x32_bf16 v[168:171], v[104:107], v[84:87], v[168:171]
  v_mfma_f32_16x16x32_bf16 v[184:187], v[108:111], v[84:87], v[184:187]
  s_waitcnt lgkmcnt(0)
  s_barrier
  v_mfma_f32_16x16x32_bf16 v[180:183], v[108:111], v[80:83], v[180:183]
  ds_read_b128 v[48:51], v19 offset:0
  ds_read_b128 v[52:55], v20 offset:1024
  v_mfma_f32_16x16x32_bf16 v[176:179], v[108:111], v[76:79], v[176:179]
  ds_read2_b32 v[68:69], v23 offset0:16 offset1:176
  ds_read_b128 v[56:59], v19 offset:2048
  v_mfma_f32_16x16x32_bf16 v[192:195], v[76:79], v[112:115], v[192:195]
  ds_read_b128 v[60:63], v20 offset:3072
  ds_read2_b32 v[70:71], v23 offset0:32 offset1:192
  v_mfma_f32_16x16x32_bf16 v[196:199], v[80:83], v[112:115], v[196:199]
  ds_read2_b32 v[72:73], v23 offset0:48 offset1:208
  ds_read2_b32 v[74:75], v23 offset0:64 offset1:224
  v_mfma_f32_16x16x32_bf16 v[200:203], v[84:87], v[112:115], v[200:203]
  ds_read2_b32 v[66:67], v23 offset0:0 offset1:160
  ds_read_b128 v[32:35], v17 offset:2048
  v_mfma_f32_16x16x32_bf16 v[216:219], v[84:87], v[116:119], v[216:219]
  ds_read_b128 v[36:39], v18 offset:3072
  ds_read_b128 v[40:43], v17 offset:4096
  v_mfma_f32_16x16x32_bf16 v[212:215], v[80:83], v[116:119], v[212:215]
  ds_read_b128 v[44:47], v18 offset:5120
  ds_read_b32 v64, v21 offset:4096
  v_mfma_f32_16x16x32_bf16 v[208:211], v[76:79], v[116:119], v[208:211]
  ds_read_b32 v65, v22 offset:5120
  ds_read2_b32 v[120:121], v25 offset0:0 offset1:16
  s_waitcnt lgkmcnt(11)
  v_pk_fma_f32 v[128:129], v[48:49], v[68:69], v[128:129] op_sel:[0,0,0] op_sel_hi:[1,0,1] neg_lo:[0,1,0] neg_hi:[0,1,0]
  v_pk_fma_f32 v[130:131], v[50:51], v[68:69], v[130:131] op_sel:[0,0,0] op_sel_hi:[1,0,1] neg_lo:[0,1,0] neg_hi:[0,1,0]
  v_pk_fma_f32 v[144:145], v[52:53], v[68:69], v[144:145] op_sel:[0,0,0] op_sel_hi:[1,0,1] neg_lo:[0,1,0] neg_hi:[0,1,0]
  v_pk_fma_f32 v[146:147], v[54:55], v[68:69], v[146:147] op_sel:[0,0,0] op_sel_hi:[1,0,1] neg_lo:[0,1,0] neg_hi:[0,1,0]
  v_cvt_pk_bf16_f32 v128, v128, v129
  v_cvt_pk_bf16_f32 v129, v130, v131
  v_cvt_pk_bf16_f32 v130, v144, v145
  v_cvt_pk_bf16_f32 v131, v146, v147
  ds_read2_b32 v[124:125], v26 offset0:0 offset1:16
  ds_read2_b32 v[122:123], v25 offset0:32 offset1:48
  ds_read2_b32 v[126:127], v26 offset0:32 offset1:48
  v_pk_fma_f32 v[160:161], v[56:57], v[68:69], v[160:161] op_sel:[0,0,0] op_sel_hi:[1,0,1] neg_lo:[0,1,0] neg_hi:[0,1,0]
  v_pk_fma_f32 v[162:163], v[58:59], v[68:69], v[162:163] op_sel:[0,0,0] op_sel_hi:[1,0,1] neg_lo:[0,1,0] neg_hi:[0,1,0]
  v_pk_fma_f32 v[176:177], v[60:61], v[68:69], v[176:177] op_sel:[0,0,0] op_sel_hi:[1,0,1] neg_lo:[0,1,0] neg_hi:[0,1,0]
  v_pk_fma_f32 v[178:179], v[62:63], v[68:69], v[178:179] op_sel:[0,0,0] op_sel_hi:[1,0,1] neg_lo:[0,1,0] neg_hi:[0,1,0]
  v_cvt_pk_bf16_f32 v160, v160, v161
  v_cvt_pk_bf16_f32 v161, v162, v163
  v_cvt_pk_bf16_f32 v162, v176, v177
  v_cvt_pk_bf16_f32 v163, v178, v179
  s_waitcnt lgkmcnt(11)
  ds_read_b128 v[76:79], v24 offset:0
  ds_read_b128 v[96:99], v24 offset:640
  ds_read_b128 v[80:83], v24 offset:64
  v_pk_fma_f32 v[132:133], v[48:49], v[70:71], v[132:133] op_sel:[0,0,0] op_sel_hi:[1,0,1] neg_lo:[0,1,0] neg_hi:[0,1,0]
  v_pk_fma_f32 v[134:135], v[50:51], v[70:71], v[134:135] op_sel:[0,0,0] op_sel_hi:[1,0,1] neg_lo:[0,1,0] neg_hi:[0,1,0]
  v_pk_fma_f32 v[148:149], v[52:53], v[70:71], v[148:149] op_sel:[0,0,0] op_sel_hi:[1,0,1] neg_lo:[0,1,0] neg_hi:[0,1,0]
  v_pk_fma_f32 v[150:151], v[54:55], v[70:71], v[150:151] op_sel:[0,0,0] op_sel_hi:[1,0,1] neg_lo:[0,1,0] neg_hi:[0,1,0]
  v_mfma_f32_16x16x32_bf16 v[144:147], v[160:163], v[128:131], 0
  v_cvt_pk_bf16_f32 v132, v132, v133
  v_cvt_pk_bf16_f32 v133, v134, v135
  v_cvt_pk_bf16_f32 v134, v148, v149
  v_cvt_pk_bf16_f32 v135, v150, v151
  ds_read_b128 v[100:103], v24 offset:704
  ds_read_b128 v[84:87], v24 offset:128
  ds_read_b128 v[104:107], v24 offset:768
  v_pk_fma_f32 v[164:165], v[56:57], v[70:71], v[164:165] op_sel:[0,0,0] op_sel_hi:[1,0,1] neg_lo:[0,1,0] neg_hi:[0,1,0]
  v_pk_fma_f32 v[166:167], v[58:59], v[70:71], v[166:167] op_sel:[0,0,0] op_sel_hi:[1,0,1] neg_lo:[0,1,0] neg_hi:[0,1,0]
  v_pk_fma_f32 v[180:181], v[60:61], v[70:71], v[180:181] op_sel:[0,0,0] op_sel_hi:[1,0,1] neg_lo:[0,1,0] neg_hi:[0,1,0]
  v_pk_fma_f32 v[182:183], v[62:63], v[70:71], v[182:183] op_sel:[0,0,0] op_sel_hi:[1,0,1] neg_lo:[0,1,0] neg_hi:[0,1,0]
  v_mfma_f32_16x16x32_bf16 v[176:179], v[160:163], v[132:135], 0
  v_cvt_pk_bf16_f32 v164, v164, v165
  v_cvt_pk_bf16_f32 v165, v166, v167
  v_cvt_pk_bf16_f32 v166, v180, v181
  v_cvt_pk_bf16_f32 v167, v182, v183
  ds_read_b128 v[88:91], v24 offset:192
  ds_read_b128 v[108:111], v24 offset:832
  ds_read_b128 v[92:95], v24 offset:256
  v_pk_fma_f32 v[136:137], v[48:49], v[72:73], v[136:137] op_sel:[0,0,0] op_sel_hi:[1,0,1] neg_lo:[0,1,0] neg_hi:[0,1,0]
  v_pk_fma_f32 v[138:139], v[50:51], v[72:73], v[138:139] op_sel:[0,0,0] op_sel_hi:[1,0,1] neg_lo:[0,1,0] neg_hi:[0,1,0]
  v_pk_fma_f32 v[152:153], v[52:53], v[72:73], v[152:153] op_sel:[0,0,0] op_sel_hi:[1,0,1] neg_lo:[0,1,0] neg_hi:[0,1,0]
  v_pk_fma_f32 v[154:155], v[54:55], v[72:73], v[154:155] op_sel:[0,0,0] op_sel_hi:[1,0,1] neg_lo:[0,1,0] neg_hi:[0,1,0]
  v_mfma_f32_16x16x32_bf16 v[148:151], v[164:167], v[132:135], 0
  v_cvt_pk_bf16_f32 v136, v136, v137
  v_cvt_pk_bf16_f32 v137, v138, v139
  v_cvt_pk_bf16_f32 v138, v152, v153
  v_cvt_pk_bf16_f32 v139, v154, v155
  ds_read_b128 v[112:115], v24 offset:896
  v_pk_fma_f32 v[168:169], v[56:57], v[72:73], v[168:169] op_sel:[0,0,0] op_sel_hi:[1,0,1] neg_lo:[0,1,0] neg_hi:[0,1,0]
  v_pk_fma_f32 v[170:171], v[58:59], v[72:73], v[170:171] op_sel:[0,0,0] op_sel_hi:[1,0,1] neg_lo:[0,1,0] neg_hi:[0,1,0]
  v_pk_fma_f32 v[184:185], v[60:61], v[72:73], v[184:185] op_sel:[0,0,0] op_sel_hi:[1,0,1] neg_lo:[0,1,0] neg_hi:[0,1,0]
  v_pk_fma_f32 v[186:187], v[62:63], v[72:73], v[186:187] op_sel:[0,0,0] op_sel_hi:[1,0,1] neg_lo:[0,1,0] neg_hi:[0,1,0]
  v_mfma_f32_16x16x32_bf16 v[180:183], v[164:167], v[136:139], 0
  v_cvt_pk_bf16_f32 v168, v168, v169
  v_cvt_pk_bf16_f32 v169, v170, v171
  v_cvt_pk_bf16_f32 v170, v184, v185
  v_cvt_pk_bf16_f32 v171, v186, v187
  v_pk_fma_f32 v[140:141], v[48:49], v[74:75], v[140:141] op_sel:[0,0,0] op_sel_hi:[1,0,1] neg_lo:[0,1,0] neg_hi:[0,1,0]
  v_pk_fma_f32 v[142:143], v[50:51], v[74:75], v[142:143] op_sel:[0,0,0] op_sel_hi:[1,0,1] neg_lo:[0,1,0] neg_hi:[0,1,0]
  v_pk_fma_f32 v[156:157], v[52:53], v[74:75], v[156:157] op_sel:[0,0,0] op_sel_hi:[1,0,1] neg_lo:[0,1,0] neg_hi:[0,1,0]
  v_pk_fma_f32 v[158:159], v[54:55], v[74:75], v[158:159] op_sel:[0,0,0] op_sel_hi:[1,0,1] neg_lo:[0,1,0] neg_hi:[0,1,0]
  v_mfma_f32_16x16x32_bf16 v[152:155], v[168:171], v[136:139], 0
  v_cvt_pk_bf16_f32 v140, v140, v141
  v_cvt_pk_bf16_f32 v141, v142, v143
  v_cvt_pk_bf16_f32 v142, v156, v157
  v_cvt_pk_bf16_f32 v143, v158, v159
  v_pk_fma_f32 v[172:173], v[56:57], v[74:75], v[172:173] op_sel:[0,0,0] op_sel_hi:[1,0,1] neg_lo:[0,1,0] neg_hi:[0,1,0]
  v_pk_fma_f32 v[174:175], v[58:59], v[74:75], v[174:175] op_sel:[0,0,0] op_sel_hi:[1,0,1] neg_lo:[0,1,0] neg_hi:[0,1,0]
  v_pk_fma_f32 v[188:189], v[60:61], v[74:75], v[188:189] op_sel:[0,0,0] op_sel_hi:[1,0,1] neg_lo:[0,1,0] neg_hi:[0,1,0]
  v_pk_fma_f32 v[190:191], v[62:63], v[74:75], v[190:191] op_sel:[0,0,0] op_sel_hi:[1,0,1] neg_lo:[0,1,0] neg_hi:[0,1,0]
  v_mfma_f32_16x16x32_bf16 v[184:187], v[168:171], v[140:143], 0
  v_cvt_pk_bf16_f32 v172, v172, v173
  v_cvt_pk_bf16_f32 v173, v174, v175
  v_cvt_pk_bf16_f32 v174, v188, v189
  v_cvt_pk_bf16_f32 v175, v190, v191
  s_waitcnt lgkmcnt(0)
  v_pk_fma_f32 v[32:33], v[56:57], v[66:67], v[32:33] op_sel:[0,0,0] op_sel_hi:[1,0,1] neg_lo:[0,1,0] neg_hi:[0,1,0]
  v_pk_fma_f32 v[34:35], v[58:59], v[66:67], v[34:35] op_sel:[0,0,0] op_sel_hi:[1,0,1] neg_lo:[0,1,0] neg_hi:[0,1,0]
  v_pk_fma_f32 v[36:37], v[60:61], v[66:67], v[36:37] op_sel:[0,0,0] op_sel_hi:[1,0,1] neg_lo:[0,1,0] neg_hi:[0,1,0]
  v_pk_fma_f32 v[38:39], v[62:63], v[66:67], v[38:39] op_sel:[0,0,0] op_sel_hi:[1,0,1] neg_lo:[0,1,0] neg_hi:[0,1,0]
  v_mfma_f32_16x16x32_bf16 v[156:159], v[172:175], v[140:143], 0
  v_cvt_pk_bf16_f32 v32, v32, v33
  v_cvt_pk_bf16_f32 v33, v34, v35
  v_cvt_pk_bf16_f32 v34, v36, v37
  v_cvt_pk_bf16_f32 v35, v38, v39
  v_mul_f32 v69, 0x3e8293ee, v69
  v_mul_f32 v71, 0x3e8293ee, v71
  v_mfma_f32_16x16x32_bf16 v[188:191], v[32:35], v[128:131], 0
  v_mul_f32 v73, 0x3e8293ee, v73
  v_mul_f32 v75, 0x3e8293ee, v75
  v_mul_f32 v120, v120, v69
  v_mul_f32 v124, v124, v69
  v_mul_f32 v121, v121, v71
  v_mul_f32 v125, v125, v71
  v_mul_f32 v122, v122, v73
  v_mul_f32 v126, v126, v73
  v_mul_f32 v123, v123, v75
  v_mul_f32 v127, v127, v75
  v_pk_fma_f32 v[40:41], v[76:77], v[64:65], v[40:41] op_sel:[0,0,0] op_sel_hi:[1,0,1] neg_lo:[1,0,0] neg_hi:[1,0,0]
  v_pk_fma_f32 v[42:43], v[78:79], v[64:65], v[42:43] op_sel:[0,0,0] op_sel_hi:[1,0,1] neg_lo:[1,0,0] neg_hi:[1,0,0]
  v_pk_mul_f32 v[40:41], v[40:41], v[96:97]
  v_pk_mul_f32 v[42:43], v[42:43], v[98:99]
  v_cvt_pk_bf16_f32 v4, v40, v41
  v_cvt_pk_bf16_f32 v5, v42, v43
  v_pk_fma_f32 v[192:193], v[80:81], v[64:65], v[192:193] op_sel:[0,0,0] op_sel_hi:[1,0,1] neg_lo:[1,0,0] neg_hi:[1,0,0]
  v_pk_fma_f32 v[194:195], v[82:83], v[64:65], v[194:195] op_sel:[0,0,0] op_sel_hi:[1,0,1] neg_lo:[1,0,0] neg_hi:[1,0,0]
  v_pk_mul_f32 v[192:193], v[192:193], v[100:101]
  v_pk_mul_f32 v[194:195], v[194:195], v[102:103]
  v_cvt_pk_bf16_f32 v6, v192, v193
  v_cvt_pk_bf16_f32 v7, v194, v195
  v_pk_fma_f32 v[196:197], v[84:85], v[64:65], v[196:197] op_sel:[0,0,0] op_sel_hi:[1,0,1] neg_lo:[1,0,0] neg_hi:[1,0,0]
  v_pk_fma_f32 v[198:199], v[86:87], v[64:65], v[198:199] op_sel:[0,0,0] op_sel_hi:[1,0,1] neg_lo:[1,0,0] neg_hi:[1,0,0]
  v_pk_mul_f32 v[196:197], v[196:197], v[104:105]
  v_pk_mul_f32 v[198:199], v[198:199], v[106:107]
  v_cvt_pk_bf16_f32 v8, v196, v197
  v_cvt_pk_bf16_f32 v9, v198, v199
  v_pk_fma_f32 v[200:201], v[88:89], v[64:65], v[200:201] op_sel:[0,0,0] op_sel_hi:[1,0,1] neg_lo:[1,0,0] neg_hi:[1,0,0]
  v_pk_fma_f32 v[202:203], v[90:91], v[64:65], v[202:203] op_sel:[0,0,0] op_sel_hi:[1,0,1] neg_lo:[1,0,0] neg_hi:[1,0,0]
  v_pk_mul_f32 v[200:201], v[200:201], v[108:109]
  v_pk_mul_f32 v[202:203], v[202:203], v[110:111]
  v_cvt_pk_bf16_f32 v10, v200, v201
  v_cvt_pk_bf16_f32 v11, v202, v203
  v_pk_fma_f32 v[204:205], v[92:93], v[64:65], v[204:205] op_sel:[0,0,0] op_sel_hi:[1,0,1] neg_lo:[1,0,0] neg_hi:[1,0,0]
  v_pk_fma_f32 v[206:207], v[94:95], v[64:65], v[206:207] op_sel:[0,0,0] op_sel_hi:[1,0,1] neg_lo:[1,0,0] neg_hi:[1,0,0]
  v_pk_mul_f32 v[204:205], v[204:205], v[112:113]
  v_pk_mul_f32 v[206:207], v[206:207], v[114:115]
  v_cvt_pk_bf16_f32 v12, v204, v205
  v_cvt_pk_bf16_f32 v13, v206, v207
  v_pk_fma_f32 v[44:45], v[76:77], v[64:65], v[44:45] op_sel:[0,1,0] op_sel_hi:[1,1,1] neg_lo:[1,0,0] neg_hi:[1,0,0]
  v_pk_fma_f32 v[46:47], v[78:79], v[64:65], v[46:47] op_sel:[0,1,0] op_sel_hi:[1,1,1] neg_lo:[1,0,0] neg_hi:[1,0,0]
  v_pk_mul_f32 v[44:45], v[44:45], v[96:97]
  v_pk_mul_f32 v[46:47], v[46:47], v[98:99]
  v_cvt_pk_bf16_f32 v224, v44, v45
  v_cvt_pk_bf16_f32 v225, v46, v47
  v_pk_fma_f32 v[208:209], v[80:81], v[64:65], v[208:209] op_sel:[0,1,0] op_sel_hi:[1,1,1] neg_lo:[1,0,0] neg_hi:[1,0,0]
  v_pk_fma_f32 v[210:211], v[82:83], v[64:65], v[210:211] op_sel:[0,1,0] op_sel_hi:[1,1,1] neg_lo:[1,0,0] neg_hi:[1,0,0]
  v_pk_mul_f32 v[208:209], v[208:209], v[100:101]
  v_pk_mul_f32 v[210:211], v[210:211], v[102:103]
  v_cvt_pk_bf16_f32 v226, v208, v209
  v_cvt_pk_bf16_f32 v227, v210, v211
  v_pk_fma_f32 v[212:213], v[84:85], v[64:65], v[212:213] op_sel:[0,1,0] op_sel_hi:[1,1,1] neg_lo:[1,0,0] neg_hi:[1,0,0]
  v_pk_fma_f32 v[214:215], v[86:87], v[64:65], v[214:215] op_sel:[0,1,0] op_sel_hi:[1,1,1] neg_lo:[1,0,0] neg_hi:[1,0,0]
  v_pk_mul_f32 v[212:213], v[212:213], v[104:105]
  v_pk_mul_f32 v[214:215], v[214:215], v[106:107]
  v_cvt_pk_bf16_f32 v228, v212, v213
  v_cvt_pk_bf16_f32 v229, v214, v215
  v_cndmask_b32 v148, v148, v149, s[48:49]
  v_cndmask_b32 v176, v176, v177, s[48:49]
  v_cndmask_b32 v150, v150, v151, s[48:49]
  v_cndmask_b32 v178, v178, v179, s[48:49]
  v_cndmask_b32 v36, v148, v176, s[50:51]
  v_cndmask_b32 v37, v150, v178, s[52:53]
  v_mul_f32 v36, v36, v121
  v_mul_f32 v37, v37, v125
  v_cndmask_b32 v152, v152, v153, s[48:49]
  v_cndmask_b32 v180, v180, v181, s[48:49]
  v_cndmask_b32 v154, v154, v155, s[48:49]
  v_cndmask_b32 v182, v182, v183, s[48:49]
  v_cndmask_b32 v40, v152, v180, s[50:51]
  v_cndmask_b32 v41, v154, v182, s[52:53]
  v_mul_f32 v40, v40, v122
  v_mul_f32 v41, v41, v126
  v_cndmask_b32 v156, v156, v157, s[48:49]
  v_cndmask_b32 v184, v184, v185, s[48:49]
  v_cndmask_b32 v158, v158, v159, s[48:49]
  v_cndmask_b32 v186, v186, v187, s[48:49]
  v_cndmask_b32 v44, v156, v184, s[50:51]
  v_cndmask_b32 v45, v158, v186, s[52:53]
  v_mul_f32 v44, v44, v123
  v_mul_f32 v45, v45, v127
  v_cndmask_b32 v144, v144, v145, s[48:49]
  v_cndmask_b32 v188, v188, v189, s[48:49]
  v_cndmask_b32 v146, v146, v147, s[48:49]
  v_cndmask_b32 v190, v190, v191, s[48:49]
  v_cndmask_b32 v32, v144, v188, s[50:51]
  v_cndmask_b32 v33, v146, v190, s[52:53]
  v_mul_f32 v32, v32, v120
  v_mul_f32 v33, v33, v124
  v_mov_b32 v48, 0xceabfb8f
  v_cndmask_b32 v32, v32, v48, s[54:55]
  v_cndmask_b32 v33, v33, v48, s[14:15]
  v_max_f32 v42, v40, v41
  v_max_f32 v46, v44, v45
  v_max_f32 v38, v36, v37
  v_max_f32 v34, v32, v33
  v_permlane32_swap_b32 v42, v46
  v_pk_fma_f32 v[216:217], v[88:89], v[64:65], v[216:217] op_sel:[0,1,0] op_sel_hi:[1,1,1] neg_lo:[1,0,0] neg_hi:[1,0,0]
  v_permlane32_swap_b32 v34, v38
  v_max_f32 v42, v42, v46
  v_max_f32 v34, v34, v38
  v_pk_fma_f32 v[218:219], v[90:91], v[64:65], v[218:219] op_sel:[0,1,0] op_sel_hi:[1,1,1] neg_lo:[1,0,0] neg_hi:[1,0,0]
  v_pk_mul_f32 v[216:217], v[216:217], v[108:109]
  v_permlane16_swap_b32 v34, v42
  v_pk_mul_f32 v[218:219], v[218:219], v[110:111]
  v_max_f32 v38, v34, v42
  v_max_f32 v46, v34, v42
  v_cvt_pk_bf16_f32 v230, v216, v217
  v_cvt_pk_bf16_f32 v231, v218, v219
  v_permlane16_swap_b32 v38, v46
  v_pk_fma_f32 v[220:221], v[92:93], v[64:65], v[220:221] op_sel:[0,1,0] op_sel_hi:[1,1,1] neg_lo:[1,0,0] neg_hi:[1,0,0]
  v_mov_b32 v34, v38
  v_mov_b32 v42, v46
  v_pk_fma_f32 v[222:223], v[94:95], v[64:65], v[222:223] op_sel:[0,1,0] op_sel_hi:[1,1,1] neg_lo:[1,0,0] neg_hi:[1,0,0]
  v_permlane32_swap_b32 v34, v38
  v_permlane32_swap_b32 v42, v46
  v_pk_mul_f32 v[220:221], v[220:221], v[112:113]
  v_pk_mul_f32 v[222:223], v[222:223], v[114:115]
  v_cvt_pk_bf16_f32 v232, v220, v221
  v_cvt_pk_bf16_f32 v233, v222, v223
  v_sub_f32 v32, v32, v34
  v_sub_f32 v33, v33, v34
  v_exp_f32 v32, v32
  v_exp_f32 v33, v33
  s_nop 0
  v_cvt_pk_bf16_f32 v32, v32, v32
  v_cvt_pk_bf16_f32 v33, v33, v33
  v_and_b32 v128, v32, v27
  v_and_b32 v129, v33, v29
  v_and_b32 v130, v32, v28
  v_and_b32 v131, v33, v30
  v_sub_f32 v36, v36, v38
  v_sub_f32 v37, v37, v38
  v_mfma_f32_16x16x32_bf16 v[144:147], v[236:239], v[128:131], 0
  v_exp_f32 v36, v36
  v_exp_f32 v37, v37
  v_mfma_f32_16x16x32_bf16 v[192:195], v[4:7], v[128:131], 0
  v_cvt_pk_bf16_f32 v36, v36, v36
  v_cvt_pk_bf16_f32 v37, v37, v37
  v_and_b32 v132, v36, v27
  v_mfma_f32_16x16x32_bf16 v[208:211], v[224:227], v[128:131], 0
  v_and_b32 v133, v37, v29
  v_and_b32 v134, v36, v28
  v_and_b32 v135, v37, v30
  v_sub_f32 v40, v40, v42
  v_sub_f32 v41, v41, v42
  v_mfma_f32_16x16x32_bf16 v[148:151], v[236:239], v[132:135], 0
  v_exp_f32 v40, v40
  v_exp_f32 v41, v41
  v_mfma_f32_16x16x32_bf16 v[196:199], v[6:9], v[132:135], 0
  v_cvt_pk_bf16_f32 v40, v40, v40
  v_cvt_pk_bf16_f32 v41, v41, v41
  v_and_b32 v136, v40, v27
  v_mfma_f32_16x16x32_bf16 v[212:215], v[226:229], v[132:135], 0
  v_and_b32 v137, v41, v29
  v_and_b32 v138, v40, v28
  v_and_b32 v139, v41, v30
  v_sub_f32 v44, v44, v46
  v_sub_f32 v45, v45, v46
  v_mfma_f32_16x16x32_bf16 v[152:155], v[236:239], v[136:139], 0
  v_exp_f32 v44, v44
  v_exp_f32 v45, v45
  v_mfma_f32_16x16x32_bf16 v[200:203], v[8:11], v[136:139], 0
  v_cvt_pk_bf16_f32 v44, v44, v44
  v_cvt_pk_bf16_f32 v45, v45, v45
  v_and_b32 v140, v44, v27
  v_mfma_f32_16x16x32_bf16 v[216:219], v[228:231], v[136:139], 0
  v_and_b32 v141, v45, v29
  v_and_b32 v142, v44, v28
  v_and_b32 v143, v45, v30
  v_rcp_f32 v144, v144
  s_cmp_eq_u32 s71, 1
  v_mfma_f32_16x16x32_bf16 v[156:159], v[236:239], v[140:143], 0
  v_rcp_f32 v148, v148
  v_mfma_f32_16x16x32_bf16 v[204:207], v[10:13], v[140:143], 0
  v_rcp_f32 v152, v152
  v_mfma_f32_16x16x32_bf16 v[220:223], v[230:233], v[140:143], 0
  s_cbranch_scc1 L_attn_out1
  s_mov_b32 s3, 0
  v_pk_mul_f32 v[192:193], v[192:193], v[144:145] op_sel_hi:[1,0]
  v_pk_mul_f32 v[194:195], v[194:195], v[144:145] op_sel_hi:[1,0]
  v_pk_mul_f32 v[208:209], v[208:209], v[144:145] op_sel_hi:[1,0]
  v_pk_mul_f32 v[210:211], v[210:211], v[144:145] op_sel_hi:[1,0]
  v_cvt_pk_bf16_f32 v48, v192, v193
  v_cvt_pk_bf16_f32 v49, v194, v195
  v_cvt_pk_bf16_f32 v50, v208, v209
  v_cvt_pk_bf16_f32 v51, v210, v211
  buffer_store_dwordx4 v[48:51], v31, s[44:47], s3 offen sc1
  v_rcp_f32 v156, v156
  s_mov_b32 s3, 114688
  v_pk_mul_f32 v[196:197], v[196:197], v[148:149] op_sel_hi:[1,0]
  v_pk_mul_f32 v[198:199], v[198:199], v[148:149] op_sel_hi:[1,0]
  v_pk_mul_f32 v[212:213], v[212:213], v[148:149] op_sel_hi:[1,0]
  v_pk_mul_f32 v[214:215], v[214:215], v[148:149] op_sel_hi:[1,0]
  v_cvt_pk_bf16_f32 v52, v196, v197
  v_cvt_pk_bf16_f32 v53, v198, v199
  v_cvt_pk_bf16_f32 v54, v212, v213
  v_cvt_pk_bf16_f32 v55, v214, v215
  buffer_store_dwordx4 v[52:55], v31, s[44:47], s3 offen sc1
  s_mov_b32 s3, 229376
  v_pk_mul_f32 v[200:201], v[200:201], v[152:153] op_sel_hi:[1,0]
  v_pk_mul_f32 v[202:203], v[202:203], v[152:153] op_sel_hi:[1,0]
  v_pk_mul_f32 v[216:217], v[216:217], v[152:153] op_sel_hi:[1,0]
  v_pk_mul_f32 v[218:219], v[218:219], v[152:153] op_sel_hi:[1,0]
  v_cvt_pk_bf16_f32 v56, v200, v201
  v_cvt_pk_bf16_f32 v57, v202, v203
  v_cvt_pk_bf16_f32 v58, v216, v217
  v_cvt_pk_bf16_f32 v59, v218, v219
  buffer_store_dwordx4 v[56:59], v31, s[44:47], s3 offen sc1
  s_mov_b32 s3, 344064
  v_pk_mul_f32 v[204:205], v[204:205], v[156:157] op_sel_hi:[1,0]
  v_pk_mul_f32 v[206:207], v[206:207], v[156:157] op_sel_hi:[1,0]
  v_pk_mul_f32 v[220:221], v[220:221], v[156:157] op_sel_hi:[1,0]
  v_pk_mul_f32 v[222:223], v[222:223], v[156:157] op_sel_hi:[1,0]
  v_cvt_pk_bf16_f32 v60, v204, v205
  v_cvt_pk_bf16_f32 v61, v206, v207
  v_cvt_pk_bf16_f32 v62, v220, v221
  v_cvt_pk_bf16_f32 v63, v222, v223
  buffer_store_dwordx4 v[60:63], v31, s[44:47], s3 offen sc1
  s_branch L_attn_out2
L_attn_out1:
  s_mov_b32 s3, 0
  v_pk_mul_f32 v[192:193], v[192:193], v[144:145] op_sel_hi:[1,0]
  v_pk_mul_f32 v[194:195], v[194:195], v[144:145] op_sel_hi:[1,0]
  v_pk_mul_f32 v[208:209], v[208:209], v[144:145] op_sel_hi:[1,0]
  v_pk_mul_f32 v[210:211], v[210:211], v[144:145] op_sel_hi:[1,0]
  v_cvt_pk_bf16_f32 v50, v192, v193
  v_cvt_pk_bf16_f32 v51, v194, v195
  v_cvt_pk_bf16_f32 v48, v208, v209
  v_cvt_pk_bf16_f32 v49, v210, v211
  buffer_store_dwordx4 v[48:51], v31, s[44:47], s3 offen sc1
  v_rcp_f32 v156, v156
  s_mov_b32 s3, 114688
  v_pk_mul_f32 v[196:197], v[196:197], v[148:149] op_sel_hi:[1,0]
  v_pk_mul_f32 v[198:199], v[198:199], v[148:149] op_sel_hi:[1,0]
  v_pk_mul_f32 v[212:213], v[212:213], v[148:149] op_sel_hi:[1,0]
  v_pk_mul_f32 v[214:215], v[214:215], v[148:149] op_sel_hi:[1,0]
  v_cvt_pk_bf16_f32 v54, v196, v197
  v_cvt_pk_bf16_f32 v55, v198, v199
  v_cvt_pk_bf16_f32 v52, v212, v213
  v_cvt_pk_bf16_f32 v53, v214, v215
  buffer_store_dwordx4 v[52:55], v31, s[44:47], s3 offen sc1
  s_mov_b32 s3, 229376
  v_pk_mul_f32 v[200:201], v[200:201], v[152:153] op_sel_hi:[1,0]
  v_pk_mul_f32 v[202:203], v[202:203], v[152:153] op_sel_hi:[1,0]
  v_pk_mul_f32 v[216:217], v[216:217], v[152:153] op_sel_hi:[1,0]
  v_pk_mul_f32 v[218:219], v[218:219], v[152:153] op_sel_hi:[1,0]
  v_cvt_pk_bf16_f32 v58, v200, v201
  v_cvt_pk_bf16_f32 v59, v202, v203
  v_cvt_pk_bf16_f32 v56, v216, v217
  v_cvt_pk_bf16_f32 v57, v218, v219
  buffer_store_dwordx4 v[56:59], v31, s[44:47], s3 offen sc1
  s_mov_b32 s3, 344064
  v_pk_mul_f32 v[204:205], v[204:205], v[156:157] op_sel_hi:[1,0]
  v_pk_mul_f32 v[206:207], v[206:207], v[156:157] op_sel_hi:[1,0]
  v_pk_mul_f32 v[220:221], v[220:221], v[156:157] op_sel_hi:[1,0]
  v_pk_mul_f32 v[222:223], v[222:223], v[156:157] op_sel_hi:[1,0]
  v_cvt_pk_bf16_f32 v62, v204, v205
  v_cvt_pk_bf16_f32 v63, v206, v207
  v_cvt_pk_bf16_f32 v60, v220, v221
  v_cvt_pk_bf16_f32 v61, v222, v223
  buffer_store_dwordx4 v[60:63], v31, s[44:47], s3 offen sc1
L_attn_out2:
  s_waitcnt vmcnt(0) lgkmcnt(0)
  s_barrier
  s_add_u32 s97, s97, 1
  s_branch L_wo_body
.section .rodata,"a"
.p2align 6
.amdhsa_kernel interleave_layers__sliding_local_dilated__dense_activation_gelu__prompt_kernel
  .amdhsa_next_free_vgpr 256
  .amdhsa_next_free_sgpr 102
  .amdhsa_accum_offset 256
  .amdhsa_group_segment_fixed_size 0
  .amdhsa_kernarg_size 88
  .amdhsa_user_sgpr_count 2
  .amdhsa_user_sgpr_kernarg_segment_ptr 1
  .amdhsa_system_sgpr_workgroup_id_x 1
  .amdhsa_float_denorm_mode_32 3
  .amdhsa_float_denorm_mode_16_64 3
.end_amdhsa_kernel
.text
L_attn_c1:
L_wo_c0:
L_wo_body:
  s_cmp_ge_u32 s2, 256
  s_cbranch_scc1 L_wo_end
  v_lshrrev_b32 v2, 6, v0
  v_and_b32 v1, 63, v0
  v_readfirstlane_b32 s70, v2
  s_and_b32 s3, s2, 7
  s_lshr_b32 s99, s2, 3
  s_and_b32 s5, s3, 3
  s_lshl_b32 s5, s5, 2
  s_and_b32 s6, s99, 3
  s_add_u32 s68, s5, s6
  s_lshr_b32 s5, s3, 2
  s_lshr_b32 s78, s99, 2
  s_lshl1_add_u32 s69, s78, s5
  s_add_u32 s3, s68, s78
  s_lshl_b32 s3, s3, 3
  s_lshl_b32 s85, 0xffff02, s3
  s_sub_u32 s3, 0, s3
  s_lshr_b32 s3, 0xffff02, s3
  s_or_b32 s85, s85, s3
  s_cmp_lt_u32 s70, 4
  s_cbranch_scc1 L_wo_compute
L_wo_loader:
  s_add_u32 s3, s96, s70
  s_cmp_lg_u32 s3, 4
  s_cbranch_scc1 L_wo_chk0
  s_load_dwordx2 s[64:65], s[0:1], 72
  s_waitcnt lgkmcnt(0)
  s_and_b32 s65, s65, 0xffff
  s_mov_b32 s66, 256
  s_mov_b32 s67, 0x00020000
  v_lshlrev_b32 v17, 2, v1
  buffer_load_dword v12, v17, s[64:67], 0 offen sc1
L_wo_chk0:
  v_and_b32 v2, 3, v1
  v_lshlrev_b32 v2, 3, v2
  v_bfe_i32 v16, s85, v2, 8
  s_and_b32 s3, s68, 3
  s_mul_i32 s4, s3, 4
  v_add3_u32 v3, v16, v1, s4
  v_and_b32 v3, 15, v3
  v_lshlrev_b32 v16, 17, v3
  s_add_u32 s9, s70, s68
  s_and_b32 s9, s9, 3
  s_lshl_b32 s77, s9, 11
  v_and_b32 v10, 7, v1
  v_lshrrev_b32 v3, 3, v1
  s_lshl_b32 s10, s9, 4
  v_add_u32 v3, s10, v3
  v_mul_u32_u24 v3, 2048, v3
  v_lshrrev_b32 v2, 3, v1
  v_and_b32 v2, 6, v2
  v_xor_b32 v2, v2, v10
  s_lshl_b32 s10, s69, 7
  v_add_u32 v3, s10, v3
  v_lshl_add_u32 v8, v2, 4, v3
  v_add_u32 v3, 16384, v3
  v_lshl_add_u32 v9, v2, 4, v3
  s_mov_b32 s40, s20
  s_and_b32 s41, s21, 0xffff
  s_mov_b32 s42, 2097152
  s_mov_b32 s43, 0x00020000
  v_readlane_b32 s74, v16, 0
  s_add_u32 m0, s77, 28672
  s_add_u32 s4, s74, 0
  buffer_load_dwordx4 v8, s[40:43], s4 offen lds
  s_add_u32 m0, s77, 29696
  s_nop 0
  buffer_load_dwordx4 v9, s[40:43], s4 offen lds
  v_readlane_b32 s74, v16, 1
  s_add_u32 m0, s77, 36864
  s_add_u32 s4, s74, 0
  buffer_load_dwordx4 v8, s[40:43], s4 offen lds
  s_add_u32 m0, s77, 37888
  s_nop 0
  buffer_load_dwordx4 v9, s[40:43], s4 offen lds
  v_readlane_b32 s74, v16, 2
  s_add_u32 m0, s77, 45056
  s_add_u32 s4, s74, 0
  buffer_load_dwordx4 v8, s[40:43], s4 offen lds
  s_add_u32 m0, s77, 46080
  s_nop 0
  buffer_load_dwordx4 v9, s[40:43], s4 offen lds
  v_readlane_b32 s74, v16, 3
  s_add_u32 m0, s77, 53248
  s_add_u32 s4, s74, 0
  buffer_load_dwordx4 v8, s[40:43], s4 offen lds
  s_add_u32 m0, s77, 54272
  s_nop 0
  buffer_load_dwordx4 v9, s[40:43], s4 offen lds
  v_readlane_b32 s74, v16, 4
  s_add_u32 m0, s77, 61440
  s_add_u32 s4, s74, 0
  buffer_load_dwordx4 v8, s[40:43], s4 offen lds
  s_add_u32 m0, s77, 62464
  s_nop 0
  buffer_load_dwordx4 v9, s[40:43], s4 offen lds
  v_readlane_b32 s74, v16, 5
  s_add_u32 m0, s77, 69632
  s_add_u32 s4, s74, 0
  buffer_load_dwordx4 v8, s[40:43], s4 offen lds
  s_add_u32 m0, s77, 70656
  s_nop 0
  buffer_load_dwordx4 v9, s[40:43], s4 offen lds
  s_waitcnt vmcnt(12)
  s_add_u32 s3, s96, s70
  s_cmp_lg_u32 s3, 4
  s_cbranch_scc1 L_wo_chk1
  v_cmp_ne_u32 vcc, 0x01010101, v12
  s_cbranch_vccz L_wo_chk1
  s_load_dwordx2 s[64:65], s[0:1], 72
  s_waitcnt lgkmcnt(0)
  s_and_b32 s65, s65, 0xffff
  s_mov_b32 s66, 256
  s_mov_b32 s67, 0x00020000
  v_lshlrev_b32 v17, 2, v1
  s_mov_b32 s79, 0x100000
L_wo_chkl:
  buffer_load_dword v12, v17, s[64:67], 0 offen sc1
  s_sub_u32 s79, s79, 1
  s_cbranch_scc1 L_wo_chk1
  s_waitcnt vmcnt(0)
  v_cmp_ne_u32 vcc, 0x01010101, v12
  s_cbranch_vccnz L_wo_chkl
L_wo_chk1:
  s_waitcnt vmcnt(12)
  s_add_u32 s44, s22, 41943040
  s_addc_u32 s45, s23, 0
  s_and_b32 s45, s45, 0xffff
  s_mov_b32 s46, 524288
  s_mov_b32 s47, 0x00020000
  s_lshl4_add_u32 s3, s97, s68
  s_and_b32 s4, s69, 15
  s_lshl4_add_u32 s3, s3, s4
  s_lshl_b32 s3, s3, 7
  s_sub_u32 s3, s3, 32768
  v_lshlrev_b32 v11, 7, v1
  v_and_b32 v2, 15, v1
  v_lshlrev_b32 v2, 2, v2
  v_mov_b32 v3, 1
  s_mov_b32 s79, 0x100000
  s_cmp_lg_u32 s70, 4
  s_barrier
  s_cbranch_scc1 L_wo_nofl
  s_mov_b32 exec_lo, 0xffff
  s_mov_b32 exec_hi, 0
  buffer_store_dword v3, v11, s[44:47], s87 offen sc1
  s_mov_b64 exec, -1
L_wo_nofl:
  s_mov_b32 s5, s3
  v_readlane_b32 s74, v16, 6
  s_add_u32 m0, s77, 77824
  s_add_u32 s4, s74, 0
  buffer_load_dwordx4 v8, s[40:43], s4 offen lds
  s_add_u32 m0, s77, 78848
  s_nop 0
  buffer_load_dwordx4 v9, s[40:43], s4 offen lds
  v_readlane_b32 s74, v16, 7
  s_add_u32 m0, s77, 86016
  s_add_u32 s4, s74, 0
  buffer_load_dwordx4 v8, s[40:43], s4 offen lds
  s_add_u32 m0, s77, 87040
  s_nop 0
  buffer_load_dwordx4 v9, s[40:43], s4 offen lds
  v_readlane_b32 s74, v16, 8
  s_add_u32 m0, s77, 94208
  s_add_u32 s4, s74, 0
  buffer_load_dwordx4 v8, s[40:43], s4 offen lds
  s_add_u32 m0, s77, 95232
  s_nop 0
  buffer_load_dwordx4 v9, s[40:43], s4 offen lds
  v_readlane_b32 s74, v16, 9
  s_add_u32 m0, s77, 102400
  s_add_u32 s4, s74, 0
  buffer_load_dwordx4 v8, s[40:43], s4 offen lds
  s_add_u32 m0, s77, 103424
  s_nop 0
  buffer_load_dwordx4 v9, s[40:43], s4 offen lds
  v_readlane_b32 s74, v16, 10
  s_add_u32 m0, s77, 110592
  s_add_u32 s4, s74, 0
  buffer_load_dwordx4 v8, s[40:43], s4 offen lds
  s_add_u32 m0, s77, 111616
  s_nop 0
  buffer_load_dwordx4 v9, s[40:43], s4 offen lds
  v_readlane_b32 s74, v16, 11
  s_add_u32 m0, s77, 118784
  s_add_u32 s4, s74, 0
  buffer_load_dwordx4 v8, s[40:43], s4 offen lds
  s_add_u32 m0, s77, 119808
  s_nop 0
  buffer_load_dwordx4 v9, s[40:43], s4 offen lds
  v_readlane_b32 s74, v16, 12
  s_add_u32 m0, s77, 131072
  s_add_u32 s4, s74, 0
  buffer_load_dwordx4 v8, s[40:43], s4 offen lds
  s_add_u32 m0, s77, 132096
  s_nop 0
  buffer_load_dwordx4 v9, s[40:43], s4 offen lds
  v_readlane_b32 s74, v16, 13
  s_add_u32 m0, s77, 139264
  s_add_u32 s4, s74, 0
  buffer_load_dwordx4 v8, s[40:43], s4 offen lds
  s_add_u32 m0, s77, 140288
  s_nop 0
  buffer_load_dwordx4 v9, s[40:43], s4 offen lds
  v_readlane_b32 s74, v16, 14
  s_add_u32 m0, s77, 147456
  s_add_u32 s4, s74, 0
  buffer_load_dwordx4 v8, s[40:43], s4 offen lds
  s_add_u32 m0, s77, 148480
  s_nop 0
  buffer_load_dwordx4 v9, s[40:43], s4 offen lds
  v_readlane_b32 s74, v16, 15
  s_add_u32 m0, s77, 155648
  s_add_u32 s4, s74, 0
  buffer_load_dwordx4 v8, s[40:43], s4 offen lds
  s_add_u32 m0, s77, 156672
  s_nop 0
  buffer_load_dwordx4 v9, s[40:43], s4 offen lds
  s_mov_b32 s3, s5
  s_cmp_lg_u32 s70, 4
  s_cbranch_scc1 L_wo_dep
L_wo_poll:
  buffer_load_dword v3, v2, s[44:47], s3 offen sc1
  s_sub_u32 s79, s79, 1
  s_cbranch_scc1 L_wo_dep
  s_waitcnt vmcnt(0)
  v_cmp_ne_u32 vcc, 1, v3
  s_cbranch_vccnz L_wo_poll
L_wo_dep:
  s_waitcnt vmcnt(20) lgkmcnt(0)
  s_barrier
  s_waitcnt vmcnt(2)
  s_barrier
  s_lshl_b32 s87, s97, 15
  s_lshl_b32 s4, s68, 11
  s_add_u32 s87, s87, s4
  s_lshl_b32 s4, s69, 2
  s_add_u32 s87, s87, s4
  s_add_u32 s97, s97, 1
  s_branch L_w1_body
L_wo_end:
  s_endpgm
L_wo_compute:
  v_and_b32 v2, 3, v1
  v_lshlrev_b32 v2, 3, v2
  v_bfe_i32 v15, s85, v2, 8
  s_and_b32 s3, s68, 3
  s_mul_i32 s4, s3, 4
  v_add3_u32 v3, v15, v1, s4
  v_and_b32 v3, 15, v3
  v_lshlrev_b32 v15, 12, v3
  v_and_b32 v3, 15, v1
  v_lshrrev_b32 v2, 4, v1
  s_lshl_b32 s8, s68, 7
  s_lshl_b32 s9, s70, 5
  s_add_u32 s8, s8, s9
  s_mul_i32 s9, s8, 7168
  v_add_u32 v13, s8, v3
  s_lshl_b32 s10, s69, 7
  v_lshl_add_u32 v14, v2, 3, s10
  v_and_b32 v16, 1, v2
  v_lshrrev_b32 v17, 1, v2
  v_lshlrev_b32 v16, 4, v1
  s_add_u32 s9, s8, s69
  s_lshl_b32 s9, s9, 11
  v_add_u32 v12, s9, v16
  s_lshl_b32 s9, s70, 12
  v_add_u32 v19, s9, v16
  v_bfe_u32 v16, v1, 2, 2
  v_xor_b32 v16, v16, v2
  v_lshl_add_u32 v18, v16, 17, v13
  s_lshl_b32 s10, s69, 14
  v_lshl_add_u32 v18, v18, 3, s10
  v_lshrrev_b32 v6, 2, v1
  v_lshlrev_b32 v6, 7, v6
  v_and_b32 v17, 3, v1
  v_lshl_add_u32 v6, v17, 3, v6
  v_bfe_u32 v17, v1, 3, 2
  v_lshl_add_u32 v6, v17, 5, v6
  v_xor_b32 v7, 32, v6
  v_xor_b32 v8, 64, v6
  v_xor_b32 v9, 96, v6
  s_mov_b32 s11, 0xffff0000
  s_add_u32 s36, s34, 8439808
  s_addc_u32 s37, s35, 0
  s_and_b32 s37, s37, 0xffff
  s_mov_b32 s38, 4194304
  s_mov_b32 s39, 0x00020000
  s_add_u32 s44, s34, 4194304
  s_addc_u32 s45, s35, 0
  s_and_b32 s45, s45, 0xffff
  s_mov_b32 s46, 4194304
  s_mov_b32 s47, 0x00020000
  s_add_u32 s56, s34, 24117248
  s_addc_u32 s57, s35, 0
  s_and_b32 s57, s57, 0xffff
  s_mov_b32 s58, 262144
  s_mov_b32 s59, 0x00020000
  s_mul_i32 s9, s8, 7168
  s_add_u32 s36, s36, s9
  s_addc_u32 s37, s37, 0x100000
  s_add_u32 s64, s36, 114688
  s_addc_u32 s65, s37, 0
  s_mov_b32 s38, 63488
  s_mov_b32 s39, 0x00800000
  s_mov_b32 s66, 63488
  s_mov_b32 s67, 0x00800000
  s_cmp_lg_u32 s96, 0
  s_cbranch_scc1 L_pfc2_skip
  s_getpc_b64 s[4:5]
L_pfc2:
  s_lshl_b32 s3, s99, 2
  s_add_u32 s3, s3, s70
  s_mul_i32 s3, s3, 128
  s_min_u32 s3, s3, L_w1_c1-L_w1_c0-128
  s_add_i32 s3, s3, L_w1_c0-L_pfc2
  s_ashr_i32 s6, s3, 31
  s_add_u32 s4, s4, s3
  s_addc_u32 s5, s5, s6
  s_load_dword s40, s[4:5], 0
  s_load_dword s40, s[4:5], 64
L_pfc2_skip:
  v_add_u32 v26, 155648, v6
  v_add_u32 v27, 155648, v7
  v_add_u32 v28, 155648, v8
  v_add_u32 v29, 155648, v9
  v_add_u32 v20, 94208, v6
  v_add_u32 v21, 94208, v7
  v_add_u32 v22, 94208, v8
  v_add_u32 v23, 94208, v9
  v_add_u32 v6, 28672, v6
  v_add_u32 v7, 28672, v7
  v_add_u32 v8, 28672, v8
  v_add_u32 v9, 28672, v9
  v_readlane_b32 s48, v15, 0
  v_readlane_b32 s49, v15, 1
  v_readlane_b32 s50, v15, 2
  s_cmp_lg_u32 s96, 0
  s_cbranch_scc1 L_wo_nosw
  v_permlane16_swap_b32 v240, v242
  v_permlane16_swap_b32 v241, v243
  v_permlane16_swap_b32 v244, v246
  v_permlane16_swap_b32 v245, v247
  v_permlane16_swap_b32 v248, v250
  v_permlane16_swap_b32 v249, v251
  v_permlane16_swap_b32 v252, v254
  v_permlane16_swap_b32 v253, v255
L_wo_nosw:
  s_waitcnt lgkmcnt(0)
  s_barrier
  buffer_load_dwordx4 v[32:35], off, s[36:39], s48 offset:0
  buffer_load_dwordx4 v[36:39], off, s[64:67], s48 offset:0
  buffer_load_dwordx4 v[40:43], off, s[36:39], s48 offset:1024
  buffer_load_dwordx4 v[44:47], off, s[64:67], s48 offset:1024
  buffer_load_dwordx4 v[48:51], off, s[36:39], s49 offset:0
  buffer_load_dwordx4 v[52:55], off, s[64:67], s49 offset:0
  buffer_load_dwordx4 v[56:59], off, s[36:39], s49 offset:1024
  buffer_load_dwordx4 v[60:63], off, s[64:67], s49 offset:1024
  buffer_load_dwordx4 v[64:67], off, s[36:39], s50 offset:0
  buffer_load_dwordx4 v[68:71], off, s[64:67], s50 offset:0
  buffer_load_dwordx4 v[72:75], off, s[36:39], s50 offset:1024
  buffer_load_dwordx4 v[76:79], off, s[64:67], s50 offset:1024
  ds_read_b64_tr_b16 v[160:161], v6 offset:0
  ds_read_b64_tr_b16 v[162:163], v6 offset:2048
  ds_read_b64_tr_b16 v[164:165], v7 offset:0
  ds_read_b64_tr_b16 v[166:167], v7 offset:2048
  ds_read_b64_tr_b16 v[168:169], v8 offset:0
  ds_read_b64_tr_b16 v[170:171], v8 offset:2048
  ds_read_b64_tr_b16 v[172:173], v9 offset:0
  ds_read_b64_tr_b16 v[174:175], v9 offset:2048
  ds_read_b64_tr_b16 v[176:177], v6 offset:4096
  ds_read_b64_tr_b16 v[178:179], v6 offset:6144
  ds_read_b64_tr_b16 v[180:181], v7 offset:4096
  ds_read_b64_tr_b16 v[182:183], v7 offset:6144
  ds_read_b64_tr_b16 v[184:185], v8 offset:4096
  ds_read_b64_tr_b16 v[186:187], v8 offset:6144
  ds_read_b64_tr_b16 v[188:189], v9 offset:4096
  ds_read_b64_tr_b16 v[190:191], v9 offset:6144
  v_lshlrev_b32 v96, 16, v240
  v_and_b32 v97, s11, v240
  v_lshlrev_b32 v98, 16, v241
  v_and_b32 v99, s11, v241
  v_lshlrev_b32 v100, 16, v248
  v_and_b32 v101, s11, v248
  v_lshlrev_b32 v102, 16, v249
  v_and_b32 v103, s11, v249
  v_lshlrev_b32 v104, 16, v242
  v_and_b32 v105, s11, v242
  v_lshlrev_b32 v106, 16, v243
  v_and_b32 v107, s11, v243
  v_lshlrev_b32 v108, 16, v250
  v_and_b32 v109, s11, v250
  v_lshlrev_b32 v110, 16, v251
  v_and_b32 v111, s11, v251
  v_lshlrev_b32 v112, 16, v244
  v_and_b32 v113, s11, v244
  v_lshlrev_b32 v114, 16, v245
  v_and_b32 v115, s11, v245
  v_lshlrev_b32 v116, 16, v252
  v_and_b32 v117, s11, v252
  v_lshlrev_b32 v118, 16, v253
  v_and_b32 v119, s11, v253
  v_lshlrev_b32 v120, 16, v246
  v_and_b32 v121, s11, v246
  v_lshlrev_b32 v122, 16, v247
  v_and_b32 v123, s11, v247
  v_lshlrev_b32 v124, 16, v254
  v_and_b32 v125, s11, v254
  v_lshlrev_b32 v126, 16, v255
  v_and_b32 v127, s11, v255
  s_waitcnt vmcnt(10) lgkmcnt(8)
  v_mfma_f32_16x16x32_bf16 v[96:99], v[160:163], v[32:35], v[96:99]
  ds_read_b64_tr_b16 v[192:193], v6 offset:8192
  v_readlane_b32 s51, v15, 3
  v_mfma_f32_16x16x32_bf16 v[100:103], v[160:163], v[36:39], v[100:103]
  ds_read_b64_tr_b16 v[194:195], v6 offset:10240
  v_mfma_f32_16x16x32_bf16 v[108:111], v[164:167], v[36:39], v[108:111]
  ds_read_b64_tr_b16 v[196:197], v7 offset:8192
  v_mfma_f32_16x16x32_bf16 v[104:107], v[164:167], v[32:35], v[104:107]
  buffer_load_dwordx4 v[80:83], off, s[36:39], s51 offset:0
  v_mfma_f32_16x16x32_bf16 v[112:115], v[168:171], v[32:35], v[112:115]
  ds_read_b64_tr_b16 v[198:199], v7 offset:10240
  ds_read_b64_tr_b16 v[200:201], v8 offset:8192
  v_mfma_f32_16x16x32_bf16 v[116:119], v[168:171], v[36:39], v[116:119]
  ds_read_b64_tr_b16 v[202:203], v8 offset:10240
  ds_read_b64_tr_b16 v[204:205], v9 offset:8192
  v_mfma_f32_16x16x32_bf16 v[124:127], v[172:175], v[36:39], v[124:127]
  buffer_load_dwordx4 v[84:87], off, s[64:67], s51 offset:0
  v_mfma_f32_16x16x32_bf16 v[120:123], v[172:175], v[32:35], v[120:123]
  ds_read_b64_tr_b16 v[206:207], v9 offset:10240
  s_waitcnt vmcnt(10) lgkmcnt(8)
  v_mfma_f32_16x16x32_bf16 v[96:99], v[176:179], v[40:43], v[96:99]
  ds_read_b64_tr_b16 v[208:209], v6 offset:12288
  v_mfma_f32_16x16x32_bf16 v[100:103], v[176:179], v[44:47], v[100:103]
  buffer_load_dwordx4 v[88:91], off, s[36:39], s51 offset:1024
  v_mfma_f32_16x16x32_bf16 v[108:111], v[180:183], v[44:47], v[108:111]
  ds_read_b64_tr_b16 v[210:211], v6 offset:14336
  ds_read_b64_tr_b16 v[212:213], v7 offset:12288
  v_mfma_f32_16x16x32_bf16 v[104:107], v[180:183], v[40:43], v[104:107]
  ds_read_b64_tr_b16 v[214:215], v7 offset:14336
  ds_read_b64_tr_b16 v[216:217], v8 offset:12288
  v_mfma_f32_16x16x32_bf16 v[112:115], v[184:187], v[40:43], v[112:115]
  buffer_load_dwordx4 v[92:95], off, s[64:67], s51 offset:1024
  v_mfma_f32_16x16x32_bf16 v[116:119], v[184:187], v[44:47], v[116:119]
  ds_read_b64_tr_b16 v[218:219], v8 offset:14336
  v_readlane_b32 s48, v15, 4
  v_mfma_f32_16x16x32_bf16 v[124:127], v[188:191], v[44:47], v[124:127]
  ds_read_b64_tr_b16 v[220:221], v9 offset:12288
  v_mfma_f32_16x16x32_bf16 v[120:123], v[188:191], v[40:43], v[120:123]
  ds_read_b64_tr_b16 v[222:223], v9 offset:14336
  s_waitcnt vmcnt(10) lgkmcnt(8)
  v_mfma_f32_16x16x32_bf16 v[96:99], v[192:195], v[48:51], v[96:99]
  buffer_load_dwordx4 v[32:35], off, s[36:39], s48 offset:0
  v_mfma_f32_16x16x32_bf16 v[100:103], v[192:195], v[52:55], v[100:103]
  ds_read_b64_tr_b16 v[160:161], v6 offset:16384
  ds_read_b64_tr_b16 v[162:163], v6 offset:18432
  v_mfma_f32_16x16x32_bf16 v[108:111], v[196:199], v[52:55], v[108:111]
  ds_read_b64_tr_b16 v[164:165], v7 offset:16384
  v_mfma_f32_16x16x32_bf16 v[104:107], v[196:199], v[48:51], v[104:107]
  buffer_load_dwordx4 v[36:39], off, s[64:67], s48 offset:0
  v_mfma_f32_16x16x32_bf16 v[112:115], v[200:203], v[48:51], v[112:115]
  ds_read_b64_tr_b16 v[166:167], v7 offset:18432
  ds_read_b64_tr_b16 v[168:169], v8 offset:16384
  v_mfma_f32_16x16x32_bf16 v[116:119], v[200:203], v[52:55], v[116:119]
  ds_read_b64_tr_b16 v[170:171], v8 offset:18432
  ds_read_b64_tr_b16 v[172:173], v9 offset:16384
  v_mfma_f32_16x16x32_bf16 v[124:127], v[204:207], v[52:55], v[124:127]
  buffer_load_dwordx4 v[40:43], off, s[36:39], s48 offset:1024
  v_mfma_f32_16x16x32_bf16 v[120:123], v[204:207], v[48:51], v[120:123]
  ds_read_b64_tr_b16 v[174:175], v9 offset:18432
  s_waitcnt vmcnt(11) lgkmcnt(8)
  v_mfma_f32_16x16x32_bf16 v[96:99], v[208:211], v[56:59], v[96:99]
  ds_read_b64_tr_b16 v[176:177], v6 offset:20480
  v_mfma_f32_16x16x32_bf16 v[100:103], v[208:211], v[60:63], v[100:103]
  buffer_load_dwordx4 v[44:47], off, s[64:67], s48 offset:1024
  v_mfma_f32_16x16x32_bf16 v[108:111], v[212:215], v[60:63], v[108:111]
  ds_read_b64_tr_b16 v[178:179], v6 offset:22528
  ds_read_b64_tr_b16 v[180:181], v7 offset:20480
  v_mfma_f32_16x16x32_bf16 v[104:107], v[212:215], v[56:59], v[104:107]
  ds_read_b64_tr_b16 v[182:183], v7 offset:22528
  v_mfma_f32_16x16x32_bf16 v[112:115], v[216:219], v[56:59], v[112:115]
  ds_read_b64_tr_b16 v[184:185], v8 offset:20480
  v_mfma_f32_16x16x32_bf16 v[116:119], v[216:219], v[60:63], v[116:119]
  ds_read_b64_tr_b16 v[186:187], v8 offset:22528
  v_readlane_b32 s49, v15, 5
  v_mfma_f32_16x16x32_bf16 v[124:127], v[220:223], v[60:63], v[124:127]
  ds_read_b64_tr_b16 v[188:189], v9 offset:20480
  v_mfma_f32_16x16x32_bf16 v[120:123], v[220:223], v[56:59], v[120:123]
  ds_read_b64_tr_b16 v[190:191], v9 offset:22528
  s_waitcnt vmcnt(10) lgkmcnt(8)
  v_mfma_f32_16x16x32_bf16 v[96:99], v[160:163], v[64:67], v[96:99]
  buffer_load_dwordx4 v[48:51], off, s[36:39], s49 offset:0
  v_mfma_f32_16x16x32_bf16 v[100:103], v[160:163], v[68:71], v[100:103]
  ds_read_b64_tr_b16 v[192:193], v6 offset:24576
  ds_read_b64_tr_b16 v[194:195], v6 offset:26624
  v_mfma_f32_16x16x32_bf16 v[108:111], v[164:167], v[68:71], v[108:111]
  ds_read_b64_tr_b16 v[196:197], v7 offset:24576
  v_mfma_f32_16x16x32_bf16 v[104:107], v[164:167], v[64:67], v[104:107]
  buffer_load_dwordx4 v[52:55], off, s[64:67], s49 offset:0
  v_mfma_f32_16x16x32_bf16 v[112:115], v[168:171], v[64:67], v[112:115]
  ds_read_b64_tr_b16 v[198:199], v7 offset:26624
  ds_read_b64_tr_b16 v[200:201], v8 offset:24576
  v_mfma_f32_16x16x32_bf16 v[116:119], v[168:171], v[68:71], v[116:119]
  ds_read_b64_tr_b16 v[202:203], v8 offset:26624
  ds_read_b64_tr_b16 v[204:205], v9 offset:24576
  v_mfma_f32_16x16x32_bf16 v[124:127], v[172:175], v[68:71], v[124:127]
  buffer_load_dwordx4 v[56:59], off, s[36:39], s49 offset:1024
  v_mfma_f32_16x16x32_bf16 v[120:123], v[172:175], v[64:67], v[120:123]
  ds_read_b64_tr_b16 v[206:207], v9 offset:26624
  s_waitcnt vmcnt(11) lgkmcnt(8)
  v_mfma_f32_16x16x32_bf16 v[96:99], v[176:179], v[72:75], v[96:99]
  ds_read_b64_tr_b16 v[208:209], v6 offset:28672
  v_mfma_f32_16x16x32_bf16 v[100:103], v[176:179], v[76:79], v[100:103]
  buffer_load_dwordx4 v[60:63], off, s[64:67], s49 offset:1024
  v_mfma_f32_16x16x32_bf16 v[108:111], v[180:183], v[76:79], v[108:111]
  ds_read_b64_tr_b16 v[210:211], v6 offset:30720
  ds_read_b64_tr_b16 v[212:213], v7 offset:28672
  v_mfma_f32_16x16x32_bf16 v[104:107], v[180:183], v[72:75], v[104:107]
  ds_read_b64_tr_b16 v[214:215], v7 offset:30720
  v_mfma_f32_16x16x32_bf16 v[112:115], v[184:187], v[72:75], v[112:115]
  ds_read_b64_tr_b16 v[216:217], v8 offset:28672
  v_mfma_f32_16x16x32_bf16 v[116:119], v[184:187], v[76:79], v[116:119]
  ds_read_b64_tr_b16 v[218:219], v8 offset:30720
  v_readlane_b32 s50, v15, 6
  v_mfma_f32_16x16x32_bf16 v[124:127], v[188:191], v[76:79], v[124:127]
  ds_read_b64_tr_b16 v[220:221], v9 offset:28672
  v_mfma_f32_16x16x32_bf16 v[120:123], v[188:191], v[72:75], v[120:123]
  ds_read_b64_tr_b16 v[222:223], v9 offset:30720
  s_waitcnt vmcnt(10) lgkmcnt(8)
  v_mfma_f32_16x16x32_bf16 v[96:99], v[192:195], v[80:83], v[96:99]
  buffer_load_dwordx4 v[64:67], off, s[36:39], s50 offset:0
  v_mfma_f32_16x16x32_bf16 v[100:103], v[192:195], v[84:87], v[100:103]
  ds_read_b64_tr_b16 v[160:161], v6 offset:32768
  ds_read_b64_tr_b16 v[162:163], v6 offset:34816
  v_mfma_f32_16x16x32_bf16 v[108:111], v[196:199], v[84:87], v[108:111]
  ds_read_b64_tr_b16 v[164:165], v7 offset:32768
  v_mfma_f32_16x16x32_bf16 v[104:107], v[196:199], v[80:83], v[104:107]
  buffer_load_dwordx4 v[68:71], off, s[64:67], s50 offset:0
  v_mfma_f32_16x16x32_bf16 v[112:115], v[200:203], v[80:83], v[112:115]
  ds_read_b64_tr_b16 v[166:167], v7 offset:34816
  ds_read_b64_tr_b16 v[168:169], v8 offset:32768
  v_mfma_f32_16x16x32_bf16 v[116:119], v[200:203], v[84:87], v[116:119]
  ds_read_b64_tr_b16 v[170:171], v8 offset:34816
  ds_read_b64_tr_b16 v[172:173], v9 offset:32768
  v_mfma_f32_16x16x32_bf16 v[124:127], v[204:207], v[84:87], v[124:127]
  buffer_load_dwordx4 v[72:75], off, s[36:39], s50 offset:1024
  v_mfma_f32_16x16x32_bf16 v[120:123], v[204:207], v[80:83], v[120:123]
  ds_read_b64_tr_b16 v[174:175], v9 offset:34816
  s_waitcnt vmcnt(11) lgkmcnt(8)
  v_mfma_f32_16x16x32_bf16 v[96:99], v[208:211], v[88:91], v[96:99]
  ds_read_b64_tr_b16 v[176:177], v6 offset:36864
  v_mfma_f32_16x16x32_bf16 v[100:103], v[208:211], v[92:95], v[100:103]
  buffer_load_dwordx4 v[76:79], off, s[64:67], s50 offset:1024
  v_mfma_f32_16x16x32_bf16 v[108:111], v[212:215], v[92:95], v[108:111]
  ds_read_b64_tr_b16 v[178:179], v6 offset:38912
  ds_read_b64_tr_b16 v[180:181], v7 offset:36864
  v_mfma_f32_16x16x32_bf16 v[104:107], v[212:215], v[88:91], v[104:107]
  ds_read_b64_tr_b16 v[182:183], v7 offset:38912
  v_mfma_f32_16x16x32_bf16 v[112:115], v[216:219], v[88:91], v[112:115]
  ds_read_b64_tr_b16 v[184:185], v8 offset:36864
  v_mfma_f32_16x16x32_bf16 v[116:119], v[216:219], v[92:95], v[116:119]
  ds_read_b64_tr_b16 v[186:187], v8 offset:38912
  v_readlane_b32 s51, v15, 7
  v_mfma_f32_16x16x32_bf16 v[124:127], v[220:223], v[92:95], v[124:127]
  ds_read_b64_tr_b16 v[188:189], v9 offset:36864
  v_mfma_f32_16x16x32_bf16 v[120:123], v[220:223], v[88:91], v[120:123]
  ds_read_b64_tr_b16 v[190:191], v9 offset:38912
  s_waitcnt vmcnt(10) lgkmcnt(8)
  v_mfma_f32_16x16x32_bf16 v[96:99], v[160:163], v[32:35], v[96:99]
  buffer_load_dwordx4 v[80:83], off, s[36:39], s51 offset:0
  v_mfma_f32_16x16x32_bf16 v[100:103], v[160:163], v[36:39], v[100:103]
  ds_read_b64_tr_b16 v[192:193], v6 offset:40960
  ds_read_b64_tr_b16 v[194:195], v6 offset:43008
  v_mfma_f32_16x16x32_bf16 v[108:111], v[164:167], v[36:39], v[108:111]
  ds_read_b64_tr_b16 v[196:197], v7 offset:40960
  v_mfma_f32_16x16x32_bf16 v[104:107], v[164:167], v[32:35], v[104:107]
  buffer_load_dwordx4 v[84:87], off, s[64:67], s51 offset:0
  v_mfma_f32_16x16x32_bf16 v[112:115], v[168:171], v[32:35], v[112:115]
  ds_read_b64_tr_b16 v[198:199], v7 offset:43008
  ds_read_b64_tr_b16 v[200:201], v8 offset:40960
  v_mfma_f32_16x16x32_bf16 v[116:119], v[168:171], v[36:39], v[116:119]
  ds_read_b64_tr_b16 v[202:203], v8 offset:43008
  ds_read_b64_tr_b16 v[204:205], v9 offset:40960
  v_mfma_f32_16x16x32_bf16 v[124:127], v[172:175], v[36:39], v[124:127]
  buffer_load_dwordx4 v[88:91], off, s[36:39], s51 offset:1024
  v_mfma_f32_16x16x32_bf16 v[120:123], v[172:175], v[32:35], v[120:123]
  ds_read_b64_tr_b16 v[206:207], v9 offset:43008
  s_waitcnt vmcnt(11) lgkmcnt(8)
  s_barrier
  v_mfma_f32_16x16x32_bf16 v[96:99], v[176:179], v[40:43], v[96:99]
  ds_read_b64_tr_b16 v[208:209], v6 offset:45056
  v_mfma_f32_16x16x32_bf16 v[100:103], v[176:179], v[44:47], v[100:103]
  buffer_load_dwordx4 v[92:95], off, s[64:67], s51 offset:1024
  v_mfma_f32_16x16x32_bf16 v[108:111], v[180:183], v[44:47], v[108:111]
  ds_read_b64_tr_b16 v[210:211], v6 offset:47104
  ds_read_b64_tr_b16 v[212:213], v7 offset:45056
  v_mfma_f32_16x16x32_bf16 v[104:107], v[180:183], v[40:43], v[104:107]
  ds_read_b64_tr_b16 v[214:215], v7 offset:47104
  v_mfma_f32_16x16x32_bf16 v[112:115], v[184:187], v[40:43], v[112:115]
  ds_read_b64_tr_b16 v[216:217], v8 offset:45056
  v_mfma_f32_16x16x32_bf16 v[116:119], v[184:187], v[44:47], v[116:119]
  ds_read_b64_tr_b16 v[218:219], v8 offset:47104
  v_readlane_b32 s48, v15, 8
  v_mfma_f32_16x16x32_bf16 v[124:127], v[188:191], v[44:47], v[124:127]
  ds_read_b64_tr_b16 v[220:221], v9 offset:45056
  v_mfma_f32_16x16x32_bf16 v[120:123], v[188:191], v[40:43], v[120:123]
  ds_read_b64_tr_b16 v[222:223], v9 offset:47104
  s_waitcnt vmcnt(10) lgkmcnt(8)
  v_mfma_f32_16x16x32_bf16 v[96:99], v[192:195], v[48:51], v[96:99]
  buffer_load_dwordx4 v[32:35], off, s[36:39], s48 offset:0
  v_mfma_f32_16x16x32_bf16 v[100:103], v[192:195], v[52:55], v[100:103]
  ds_read_b64_tr_b16 v[160:161], v6 offset:49152
  ds_read_b64_tr_b16 v[162:163], v6 offset:51200
  v_mfma_f32_16x16x32_bf16 v[108:111], v[196:199], v[52:55], v[108:111]
  ds_read_b64_tr_b16 v[164:165], v7 offset:49152
  v_mfma_f32_16x16x32_bf16 v[104:107], v[196:199], v[48:51], v[104:107]
  buffer_load_dwordx4 v[36:39], off, s[64:67], s48 offset:0
  v_mfma_f32_16x16x32_bf16 v[112:115], v[200:203], v[48:51], v[112:115]
  ds_read_b64_tr_b16 v[166:167], v7 offset:51200
  ds_read_b64_tr_b16 v[168:169], v8 offset:49152
  v_mfma_f32_16x16x32_bf16 v[116:119], v[200:203], v[52:55], v[116:119]
  ds_read_b64_tr_b16 v[170:171], v8 offset:51200
  ds_read_b64_tr_b16 v[172:173], v9 offset:49152
  v_mfma_f32_16x16x32_bf16 v[124:127], v[204:207], v[52:55], v[124:127]
  buffer_load_dwordx4 v[40:43], off, s[36:39], s48 offset:1024
  v_mfma_f32_16x16x32_bf16 v[120:123], v[204:207], v[48:51], v[120:123]
  ds_read_b64_tr_b16 v[174:175], v9 offset:51200
  s_waitcnt vmcnt(11) lgkmcnt(8)
  v_mfma_f32_16x16x32_bf16 v[96:99], v[208:211], v[56:59], v[96:99]
  ds_read_b64_tr_b16 v[176:177], v6 offset:53248
  v_mfma_f32_16x16x32_bf16 v[100:103], v[208:211], v[60:63], v[100:103]
  buffer_load_dwordx4 v[44:47], off, s[64:67], s48 offset:1024
  v_mfma_f32_16x16x32_bf16 v[108:111], v[212:215], v[60:63], v[108:111]
  ds_read_b64_tr_b16 v[178:179], v6 offset:55296
  ds_read_b64_tr_b16 v[180:181], v7 offset:53248
  v_mfma_f32_16x16x32_bf16 v[104:107], v[212:215], v[56:59], v[104:107]
  ds_read_b64_tr_b16 v[182:183], v7 offset:55296
  v_mfma_f32_16x16x32_bf16 v[112:115], v[216:219], v[56:59], v[112:115]
  ds_read_b64_tr_b16 v[184:185], v8 offset:53248
  v_mfma_f32_16x16x32_bf16 v[116:119], v[216:219], v[60:63], v[116:119]
  ds_read_b64_tr_b16 v[186:187], v8 offset:55296
  v_readlane_b32 s49, v15, 9
  v_mfma_f32_16x16x32_bf16 v[124:127], v[220:223], v[60:63], v[124:127]
  ds_read_b64_tr_b16 v[188:189], v9 offset:53248
  v_mfma_f32_16x16x32_bf16 v[120:123], v[220:223], v[56:59], v[120:123]
  ds_read_b64_tr_b16 v[190:191], v9 offset:55296
  s_waitcnt vmcnt(10) lgkmcnt(8)
  v_mfma_f32_16x16x32_bf16 v[96:99], v[160:163], v[64:67], v[96:99]
  buffer_load_dwordx4 v[48:51], off, s[36:39], s49 offset:0
  v_mfma_f32_16x16x32_bf16 v[100:103], v[160:163], v[68:71], v[100:103]
  ds_read_b64_tr_b16 v[192:193], v6 offset:57344
  ds_read_b64_tr_b16 v[194:195], v6 offset:59392
  v_mfma_f32_16x16x32_bf16 v[108:111], v[164:167], v[68:71], v[108:111]
  ds_read_b64_tr_b16 v[196:197], v7 offset:57344
  v_mfma_f32_16x16x32_bf16 v[104:107], v[164:167], v[64:67], v[104:107]
  buffer_load_dwordx4 v[52:55], off, s[64:67], s49 offset:0
  v_mfma_f32_16x16x32_bf16 v[112:115], v[168:171], v[64:67], v[112:115]
  ds_read_b64_tr_b16 v[198:199], v7 offset:59392
  ds_read_b64_tr_b16 v[200:201], v8 offset:57344
  v_mfma_f32_16x16x32_bf16 v[116:119], v[168:171], v[68:71], v[116:119]
  ds_read_b64_tr_b16 v[202:203], v8 offset:59392
  ds_read_b64_tr_b16 v[204:205], v9 offset:57344
  v_mfma_f32_16x16x32_bf16 v[124:127], v[172:175], v[68:71], v[124:127]
  buffer_load_dwordx4 v[56:59], off, s[36:39], s49 offset:1024
  v_mfma_f32_16x16x32_bf16 v[120:123], v[172:175], v[64:67], v[120:123]
  ds_read_b64_tr_b16 v[206:207], v9 offset:59392
  s_waitcnt vmcnt(11) lgkmcnt(8)
  v_mfma_f32_16x16x32_bf16 v[96:99], v[176:179], v[72:75], v[96:99]
  ds_read_b64_tr_b16 v[208:209], v6 offset:61440
  v_mfma_f32_16x16x32_bf16 v[100:103], v[176:179], v[76:79], v[100:103]
  buffer_load_dwordx4 v[60:63], off, s[64:67], s49 offset:1024
  v_mfma_f32_16x16x32_bf16 v[108:111], v[180:183], v[76:79], v[108:111]
  ds_read_b64_tr_b16 v[210:211], v6 offset:63488
  ds_read_b64_tr_b16 v[212:213], v7 offset:61440
  v_mfma_f32_16x16x32_bf16 v[104:107], v[180:183], v[72:75], v[104:107]
  ds_read_b64_tr_b16 v[214:215], v7 offset:63488
  v_mfma_f32_16x16x32_bf16 v[112:115], v[184:187], v[72:75], v[112:115]
  ds_read_b64_tr_b16 v[216:217], v8 offset:61440
  v_mfma_f32_16x16x32_bf16 v[116:119], v[184:187], v[76:79], v[116:119]
  ds_read_b64_tr_b16 v[218:219], v8 offset:63488
  v_readlane_b32 s50, v15, 10
  v_mfma_f32_16x16x32_bf16 v[124:127], v[188:191], v[76:79], v[124:127]
  ds_read_b64_tr_b16 v[220:221], v9 offset:61440
  v_mfma_f32_16x16x32_bf16 v[120:123], v[188:191], v[72:75], v[120:123]
  ds_read_b64_tr_b16 v[222:223], v9 offset:63488
  s_waitcnt vmcnt(10) lgkmcnt(8)
  v_mfma_f32_16x16x32_bf16 v[96:99], v[192:195], v[80:83], v[96:99]
  buffer_load_dwordx4 v[64:67], off, s[36:39], s50 offset:0
  v_mfma_f32_16x16x32_bf16 v[100:103], v[192:195], v[84:87], v[100:103]
  ds_read_b64_tr_b16 v[160:161], v20 offset:0
  ds_read_b64_tr_b16 v[162:163], v20 offset:2048
  v_mfma_f32_16x16x32_bf16 v[108:111], v[196:199], v[84:87], v[108:111]
  ds_read_b64_tr_b16 v[164:165], v21 offset:0
  v_mfma_f32_16x16x32_bf16 v[104:107], v[196:199], v[80:83], v[104:107]
  buffer_load_dwordx4 v[68:71], off, s[64:67], s50 offset:0
  v_mfma_f32_16x16x32_bf16 v[112:115], v[200:203], v[80:83], v[112:115]
  ds_read_b64_tr_b16 v[166:167], v21 offset:2048
  ds_read_b64_tr_b16 v[168:169], v22 offset:0
  v_mfma_f32_16x16x32_bf16 v[116:119], v[200:203], v[84:87], v[116:119]
  ds_read_b64_tr_b16 v[170:171], v22 offset:2048
  ds_read_b64_tr_b16 v[172:173], v23 offset:0
  v_mfma_f32_16x16x32_bf16 v[124:127], v[204:207], v[84:87], v[124:127]
  buffer_load_dwordx4 v[72:75], off, s[36:39], s50 offset:1024
  v_mfma_f32_16x16x32_bf16 v[120:123], v[204:207], v[80:83], v[120:123]
  ds_read_b64_tr_b16 v[174:175], v23 offset:2048
  s_waitcnt vmcnt(11) lgkmcnt(8)
  v_mfma_f32_16x16x32_bf16 v[96:99], v[208:211], v[88:91], v[96:99]
  ds_read_b64_tr_b16 v[176:177], v20 offset:4096
  v_mfma_f32_16x16x32_bf16 v[100:103], v[208:211], v[92:95], v[100:103]
  buffer_load_dwordx4 v[76:79], off, s[64:67], s50 offset:1024
  v_mfma_f32_16x16x32_bf16 v[108:111], v[212:215], v[92:95], v[108:111]
  ds_read_b64_tr_b16 v[178:179], v20 offset:6144
  ds_read_b64_tr_b16 v[180:181], v21 offset:4096
  v_mfma_f32_16x16x32_bf16 v[104:107], v[212:215], v[88:91], v[104:107]
  ds_read_b64_tr_b16 v[182:183], v21 offset:6144
  v_mfma_f32_16x16x32_bf16 v[112:115], v[216:219], v[88:91], v[112:115]
  ds_read_b64_tr_b16 v[184:185], v22 offset:4096
  v_mfma_f32_16x16x32_bf16 v[116:119], v[216:219], v[92:95], v[116:119]
  ds_read_b64_tr_b16 v[186:187], v22 offset:6144
  v_readlane_b32 s51, v15, 11
  v_mfma_f32_16x16x32_bf16 v[124:127], v[220:223], v[92:95], v[124:127]
  ds_read_b64_tr_b16 v[188:189], v23 offset:4096
  v_mfma_f32_16x16x32_bf16 v[120:123], v[220:223], v[88:91], v[120:123]
  ds_read_b64_tr_b16 v[190:191], v23 offset:6144
  s_waitcnt vmcnt(10) lgkmcnt(8)
  v_mfma_f32_16x16x32_bf16 v[96:99], v[160:163], v[32:35], v[96:99]
  buffer_load_dwordx4 v[80:83], off, s[36:39], s51 offset:0
  v_mfma_f32_16x16x32_bf16 v[100:103], v[160:163], v[36:39], v[100:103]
  ds_read_b64_tr_b16 v[192:193], v20 offset:8192
  ds_read_b64_tr_b16 v[194:195], v20 offset:10240
  v_mfma_f32_16x16x32_bf16 v[108:111], v[164:167], v[36:39], v[108:111]
  ds_read_b64_tr_b16 v[196:197], v21 offset:8192
  v_mfma_f32_16x16x32_bf16 v[104:107], v[164:167], v[32:35], v[104:107]
  buffer_load_dwordx4 v[84:87], off, s[64:67], s51 offset:0
  v_mfma_f32_16x16x32_bf16 v[112:115], v[168:171], v[32:35], v[112:115]
  ds_read_b64_tr_b16 v[198:199], v21 offset:10240
  ds_read_b64_tr_b16 v[200:201], v22 offset:8192
  v_mfma_f32_16x16x32_bf16 v[116:119], v[168:171], v[36:39], v[116:119]
  ds_read_b64_tr_b16 v[202:203], v22 offset:10240
  ds_read_b64_tr_b16 v[204:205], v23 offset:8192
  v_mfma_f32_16x16x32_bf16 v[124:127], v[172:175], v[36:39], v[124:127]
  buffer_load_dwordx4 v[88:91], off, s[36:39], s51 offset:1024
  v_mfma_f32_16x16x32_bf16 v[120:123], v[172:175], v[32:35], v[120:123]
  ds_read_b64_tr_b16 v[206:207], v23 offset:10240
  s_waitcnt vmcnt(11) lgkmcnt(8)
  v_mfma_f32_16x16x32_bf16 v[96:99], v[176:179], v[40:43], v[96:99]
  ds_read_b64_tr_b16 v[208:209], v20 offset:12288
  v_mfma_f32_16x16x32_bf16 v[100:103], v[176:179], v[44:47], v[100:103]
  buffer_load_dwordx4 v[92:95], off, s[64:67], s51 offset:1024
  v_mfma_f32_16x16x32_bf16 v[108:111], v[180:183], v[44:47], v[108:111]
  ds_read_b64_tr_b16 v[210:211], v20 offset:14336
  ds_read_b64_tr_b16 v[212:213], v21 offset:12288
  v_mfma_f32_16x16x32_bf16 v[104:107], v[180:183], v[40:43], v[104:107]
  ds_read_b64_tr_b16 v[214:215], v21 offset:14336
  v_mfma_f32_16x16x32_bf16 v[112:115], v[184:187], v[40:43], v[112:115]
  ds_read_b64_tr_b16 v[216:217], v22 offset:12288
  v_mfma_f32_16x16x32_bf16 v[116:119], v[184:187], v[44:47], v[116:119]
  ds_read_b64_tr_b16 v[218:219], v22 offset:14336
  v_readlane_b32 s48, v15, 12
  v_mfma_f32_16x16x32_bf16 v[124:127], v[188:191], v[44:47], v[124:127]
  ds_read_b64_tr_b16 v[220:221], v23 offset:12288
  v_mfma_f32_16x16x32_bf16 v[120:123], v[188:191], v[40:43], v[120:123]
  ds_read_b64_tr_b16 v[222:223], v23 offset:14336
  s_waitcnt vmcnt(10) lgkmcnt(8)
  v_mfma_f32_16x16x32_bf16 v[96:99], v[192:195], v[48:51], v[96:99]
  buffer_load_dwordx4 v[32:35], off, s[36:39], s48 offset:0
  v_mfma_f32_16x16x32_bf16 v[100:103], v[192:195], v[52:55], v[100:103]
  ds_read_b64_tr_b16 v[160:161], v20 offset:16384
  ds_read_b64_tr_b16 v[162:163], v20 offset:18432
  v_mfma_f32_16x16x32_bf16 v[108:111], v[196:199], v[52:55], v[108:111]
  ds_read_b64_tr_b16 v[164:165], v21 offset:16384
  v_mfma_f32_16x16x32_bf16 v[104:107], v[196:199], v[48:51], v[104:107]
  buffer_load_dwordx4 v[36:39], off, s[64:67], s48 offset:0
  v_mfma_f32_16x16x32_bf16 v[112:115], v[200:203], v[48:51], v[112:115]
  ds_read_b64_tr_b16 v[166:167], v21 offset:18432
  ds_read_b64_tr_b16 v[168:169], v22 offset:16384
  v_mfma_f32_16x16x32_bf16 v[116:119], v[200:203], v[52:55], v[116:119]
  ds_read_b64_tr_b16 v[170:171], v22 offset:18432
  ds_read_b64_tr_b16 v[172:173], v23 offset:16384
  v_mfma_f32_16x16x32_bf16 v[124:127], v[204:207], v[52:55], v[124:127]
  buffer_load_dwordx4 v[40:43], off, s[36:39], s48 offset:1024
  v_mfma_f32_16x16x32_bf16 v[120:123], v[204:207], v[48:51], v[120:123]
  ds_read_b64_tr_b16 v[174:175], v23 offset:18432
  s_waitcnt vmcnt(11) lgkmcnt(8)
  v_mfma_f32_16x16x32_bf16 v[96:99], v[208:211], v[56:59], v[96:99]
  ds_read_b64_tr_b16 v[176:177], v20 offset:20480
  v_mfma_f32_16x16x32_bf16 v[100:103], v[208:211], v[60:63], v[100:103]
  buffer_load_dwordx4 v[44:47], off, s[64:67], s48 offset:1024
  v_mfma_f32_16x16x32_bf16 v[108:111], v[212:215], v[60:63], v[108:111]
  ds_read_b64_tr_b16 v[178:179], v20 offset:22528
  ds_read_b64_tr_b16 v[180:181], v21 offset:20480
  v_mfma_f32_16x16x32_bf16 v[104:107], v[212:215], v[56:59], v[104:107]
  ds_read_b64_tr_b16 v[182:183], v21 offset:22528
  v_mfma_f32_16x16x32_bf16 v[112:115], v[216:219], v[56:59], v[112:115]
  ds_read_b64_tr_b16 v[184:185], v22 offset:20480
  v_mfma_f32_16x16x32_bf16 v[116:119], v[216:219], v[60:63], v[116:119]
  ds_read_b64_tr_b16 v[186:187], v22 offset:22528
  v_readlane_b32 s49, v15, 13
  v_mfma_f32_16x16x32_bf16 v[124:127], v[220:223], v[60:63], v[124:127]
  ds_read_b64_tr_b16 v[188:189], v23 offset:20480
  v_mfma_f32_16x16x32_bf16 v[120:123], v[220:223], v[56:59], v[120:123]
  ds_read_b64_tr_b16 v[190:191], v23 offset:22528
  s_waitcnt vmcnt(10) lgkmcnt(8)
  v_mfma_f32_16x16x32_bf16 v[96:99], v[160:163], v[64:67], v[96:99]
  buffer_load_dwordx4 v[48:51], off, s[36:39], s49 offset:0
  v_mfma_f32_16x16x32_bf16 v[100:103], v[160:163], v[68:71], v[100:103]
  ds_read_b64_tr_b16 v[192:193], v20 offset:24576
  ds_read_b64_tr_b16 v[194:195], v20 offset:26624
  v_mfma_f32_16x16x32_bf16 v[108:111], v[164:167], v[68:71], v[108:111]
  ds_read_b64_tr_b16 v[196:197], v21 offset:24576
  v_mfma_f32_16x16x32_bf16 v[104:107], v[164:167], v[64:67], v[104:107]
  buffer_load_dwordx4 v[52:55], off, s[64:67], s49 offset:0
  v_mfma_f32_16x16x32_bf16 v[112:115], v[168:171], v[64:67], v[112:115]
  ds_read_b64_tr_b16 v[198:199], v21 offset:26624
  ds_read_b64_tr_b16 v[200:201], v22 offset:24576
  v_mfma_f32_16x16x32_bf16 v[116:119], v[168:171], v[68:71], v[116:119]
  ds_read_b64_tr_b16 v[202:203], v22 offset:26624
  ds_read_b64_tr_b16 v[204:205], v23 offset:24576
  v_mfma_f32_16x16x32_bf16 v[124:127], v[172:175], v[68:71], v[124:127]
  buffer_load_dwordx4 v[56:59], off, s[36:39], s49 offset:1024
  v_mfma_f32_16x16x32_bf16 v[120:123], v[172:175], v[64:67], v[120:123]
  ds_read_b64_tr_b16 v[206:207], v23 offset:26624
  s_waitcnt vmcnt(11) lgkmcnt(8)
  v_mfma_f32_16x16x32_bf16 v[96:99], v[176:179], v[72:75], v[96:99]
  ds_read_b64_tr_b16 v[208:209], v20 offset:28672
  v_mfma_f32_16x16x32_bf16 v[100:103], v[176:179], v[76:79], v[100:103]
  buffer_load_dwordx4 v[60:63], off, s[64:67], s49 offset:1024
  v_mfma_f32_16x16x32_bf16 v[108:111], v[180:183], v[76:79], v[108:111]
  ds_read_b64_tr_b16 v[210:211], v20 offset:30720
  ds_read_b64_tr_b16 v[212:213], v21 offset:28672
  v_mfma_f32_16x16x32_bf16 v[104:107], v[180:183], v[72:75], v[104:107]
  ds_read_b64_tr_b16 v[214:215], v21 offset:30720
  v_mfma_f32_16x16x32_bf16 v[112:115], v[184:187], v[72:75], v[112:115]
  ds_read_b64_tr_b16 v[216:217], v22 offset:28672
  v_mfma_f32_16x16x32_bf16 v[116:119], v[184:187], v[76:79], v[116:119]
  ds_read_b64_tr_b16 v[218:219], v22 offset:30720
  v_readlane_b32 s50, v15, 14
  v_mfma_f32_16x16x32_bf16 v[124:127], v[188:191], v[76:79], v[124:127]
  ds_read_b64_tr_b16 v[220:221], v23 offset:28672
  v_mfma_f32_16x16x32_bf16 v[120:123], v[188:191], v[72:75], v[120:123]
  ds_read_b64_tr_b16 v[222:223], v23 offset:30720
  s_waitcnt vmcnt(10) lgkmcnt(8)
  v_mfma_f32_16x16x32_bf16 v[96:99], v[192:195], v[80:83], v[96:99]
  buffer_load_dwordx4 v[64:67], off, s[36:39], s50 offset:0
  v_mfma_f32_16x16x32_bf16 v[100:103], v[192:195], v[84:87], v[100:103]
  ds_read_b64_tr_b16 v[160:161], v20 offset:36864
  ds_read_b64_tr_b16 v[162:163], v20 offset:38912
  v_mfma_f32_16x16x32_bf16 v[108:111], v[196:199], v[84:87], v[108:111]
  ds_read_b64_tr_b16 v[164:165], v21 offset:36864
  v_mfma_f32_16x16x32_bf16 v[104:107], v[196:199], v[80:83], v[104:107]
  buffer_load_dwordx4 v[68:71], off, s[64:67], s50 offset:0
  v_mfma_f32_16x16x32_bf16 v[112:115], v[200:203], v[80:83], v[112:115]
  ds_read_b64_tr_b16 v[166:167], v21 offset:38912
  ds_read_b64_tr_b16 v[168:169], v22 offset:36864
  v_mfma_f32_16x16x32_bf16 v[116:119], v[200:203], v[84:87], v[116:119]
  ds_read_b64_tr_b16 v[170:171], v22 offset:38912
  ds_read_b64_tr_b16 v[172:173], v23 offset:36864
  v_mfma_f32_16x16x32_bf16 v[124:127], v[204:207], v[84:87], v[124:127]
  buffer_load_dwordx4 v[72:75], off, s[36:39], s50 offset:1024
  v_mfma_f32_16x16x32_bf16 v[120:123], v[204:207], v[80:83], v[120:123]
  ds_read_b64_tr_b16 v[174:175], v23 offset:38912
  s_waitcnt vmcnt(11) lgkmcnt(8)
  v_mfma_f32_16x16x32_bf16 v[96:99], v[208:211], v[88:91], v[96:99]
  ds_read_b64_tr_b16 v[176:177], v20 offset:40960
  v_mfma_f32_16x16x32_bf16 v[100:103], v[208:211], v[92:95], v[100:103]
  buffer_load_dwordx4 v[76:79], off, s[64:67], s50 offset:1024
  v_mfma_f32_16x16x32_bf16 v[108:111], v[212:215], v[92:95], v[108:111]
  ds_read_b64_tr_b16 v[178:179], v20 offset:43008
  ds_read_b64_tr_b16 v[180:181], v21 offset:40960
  v_mfma_f32_16x16x32_bf16 v[104:107], v[212:215], v[88:91], v[104:107]
  ds_read_b64_tr_b16 v[182:183], v21 offset:43008
  v_mfma_f32_16x16x32_bf16 v[112:115], v[216:219], v[88:91], v[112:115]
  ds_read_b64_tr_b16 v[184:185], v22 offset:40960
  v_mfma_f32_16x16x32_bf16 v[116:119], v[216:219], v[92:95], v[116:119]
  ds_read_b64_tr_b16 v[186:187], v22 offset:43008
  v_readlane_b32 s51, v15, 15
  v_mfma_f32_16x16x32_bf16 v[124:127], v[220:223], v[92:95], v[124:127]
  ds_read_b64_tr_b16 v[188:189], v23 offset:40960
  v_mfma_f32_16x16x32_bf16 v[120:123], v[220:223], v[88:91], v[120:123]
  ds_read_b64_tr_b16 v[190:191], v23 offset:43008
  s_waitcnt vmcnt(10) lgkmcnt(8)
  v_mfma_f32_16x16x32_bf16 v[96:99], v[160:163], v[32:35], v[96:99]
  buffer_load_dwordx4 v[80:83], off, s[36:39], s51 offset:0
  v_mfma_f32_16x16x32_bf16 v[100:103], v[160:163], v[36:39], v[100:103]
  ds_read_b64_tr_b16 v[192:193], v20 offset:45056
  ds_read_b64_tr_b16 v[194:195], v20 offset:47104
  v_mfma_f32_16x16x32_bf16 v[108:111], v[164:167], v[36:39], v[108:111]
  ds_read_b64_tr_b16 v[196:197], v21 offset:45056
  v_mfma_f32_16x16x32_bf16 v[104:107], v[164:167], v[32:35], v[104:107]
  buffer_load_dwordx4 v[84:87], off, s[64:67], s51 offset:0
  v_mfma_f32_16x16x32_bf16 v[112:115], v[168:171], v[32:35], v[112:115]
  ds_read_b64_tr_b16 v[198:199], v21 offset:47104
  ds_read_b64_tr_b16 v[200:201], v22 offset:45056
  v_mfma_f32_16x16x32_bf16 v[116:119], v[168:171], v[36:39], v[116:119]
  ds_read_b64_tr_b16 v[202:203], v22 offset:47104
  ds_read_b64_tr_b16 v[204:205], v23 offset:45056
  v_mfma_f32_16x16x32_bf16 v[124:127], v[172:175], v[36:39], v[124:127]
  buffer_load_dwordx4 v[88:91], off, s[36:39], s51 offset:1024
  v_mfma_f32_16x16x32_bf16 v[120:123], v[172:175], v[32:35], v[120:123]
  ds_read_b64_tr_b16 v[206:207], v23 offset:47104
  s_waitcnt vmcnt(11) lgkmcnt(8)
  v_mfma_f32_16x16x32_bf16 v[96:99], v[176:179], v[40:43], v[96:99]
  ds_read_b64_tr_b16 v[208:209], v20 offset:49152
  v_mfma_f32_16x16x32_bf16 v[100:103], v[176:179], v[44:47], v[100:103]
  buffer_load_dwordx4 v[92:95], off, s[64:67], s51 offset:1024
  v_mfma_f32_16x16x32_bf16 v[108:111], v[180:183], v[44:47], v[108:111]
  ds_read_b64_tr_b16 v[210:211], v20 offset:51200
  ds_read_b64_tr_b16 v[212:213], v21 offset:49152
  v_mfma_f32_16x16x32_bf16 v[104:107], v[180:183], v[40:43], v[104:107]
  ds_read_b64_tr_b16 v[214:215], v21 offset:51200
  v_mfma_f32_16x16x32_bf16 v[112:115], v[184:187], v[40:43], v[112:115]
  ds_read_b64_tr_b16 v[216:217], v22 offset:49152
  v_mfma_f32_16x16x32_bf16 v[116:119], v[184:187], v[44:47], v[116:119]
  ds_read_b64_tr_b16 v[218:219], v22 offset:51200
  v_mfma_f32_16x16x32_bf16 v[124:127], v[188:191], v[44:47], v[124:127]
  ds_read_b64_tr_b16 v[220:221], v23 offset:49152
  v_mfma_f32_16x16x32_bf16 v[120:123], v[188:191], v[40:43], v[120:123]
  ds_read_b64_tr_b16 v[222:223], v23 offset:51200
  s_waitcnt vmcnt(10) lgkmcnt(8)
  v_mfma_f32_16x16x32_bf16 v[96:99], v[192:195], v[48:51], v[96:99]
  ds_read_b64_tr_b16 v[160:161], v20 offset:53248
  v_mfma_f32_16x16x32_bf16 v[100:103], v[192:195], v[52:55], v[100:103]
  ds_read_b64_tr_b16 v[162:163], v20 offset:55296
  v_mfma_f32_16x16x32_bf16 v[108:111], v[196:199], v[52:55], v[108:111]
  ds_read_b64_tr_b16 v[164:165], v21 offset:53248
  v_mfma_f32_16x16x32_bf16 v[104:107], v[196:199], v[48:51], v[104:107]
  ds_read_b64_tr_b16 v[166:167], v21 offset:55296
  v_mfma_f32_16x16x32_bf16 v[112:115], v[200:203], v[48:51], v[112:115]
  ds_read_b64_tr_b16 v[168:169], v22 offset:53248
  v_mfma_f32_16x16x32_bf16 v[116:119], v[200:203], v[52:55], v[116:119]
  ds_read_b64_tr_b16 v[170:171], v22 offset:55296
  v_mfma_f32_16x16x32_bf16 v[124:127], v[204:207], v[52:55], v[124:127]
  ds_read_b64_tr_b16 v[172:173], v23 offset:53248
  v_mfma_f32_16x16x32_bf16 v[120:123], v[204:207], v[48:51], v[120:123]
  ds_read_b64_tr_b16 v[174:175], v23 offset:55296
  s_waitcnt vmcnt(8) lgkmcnt(8)
  s_barrier
  v_mfma_f32_16x16x32_bf16 v[96:99], v[208:211], v[56:59], v[96:99]
  ds_read_b64_tr_b16 v[176:177], v20 offset:57344
  v_mfma_f32_16x16x32_bf16 v[100:103], v[208:211], v[60:63], v[100:103]
  ds_read_b64_tr_b16 v[178:179], v20 offset:59392
  v_mfma_f32_16x16x32_bf16 v[108:111], v[212:215], v[60:63], v[108:111]
  ds_read_b64_tr_b16 v[180:181], v21 offset:57344
  v_mfma_f32_16x16x32_bf16 v[104:107], v[212:215], v[56:59], v[104:107]
  ds_read_b64_tr_b16 v[182:183], v21 offset:59392
  v_mfma_f32_16x16x32_bf16 v[112:115], v[216:219], v[56:59], v[112:115]
  ds_read_b64_tr_b16 v[184:185], v22 offset:57344
  v_mfma_f32_16x16x32_bf16 v[116:119], v[216:219], v[60:63], v[116:119]
  ds_read_b64_tr_b16 v[186:187], v22 offset:59392
  v_mfma_f32_16x16x32_bf16 v[124:127], v[220:223], v[60:63], v[124:127]
  ds_read_b64_tr_b16 v[188:189], v23 offset:57344
  v_mfma_f32_16x16x32_bf16 v[120:123], v[220:223], v[56:59], v[120:123]
  ds_read_b64_tr_b16 v[190:191], v23 offset:59392
  s_waitcnt vmcnt(6) lgkmcnt(8)
  v_mfma_f32_16x16x32_bf16 v[96:99], v[160:163], v[64:67], v[96:99]
  ds_read_b64_tr_b16 v[192:193], v26 offset:0
  v_mfma_f32_16x16x32_bf16 v[100:103], v[160:163], v[68:71], v[100:103]
  ds_read_b64_tr_b16 v[194:195], v26 offset:2048
  v_mfma_f32_16x16x32_bf16 v[108:111], v[164:167], v[68:71], v[108:111]
  ds_read_b64_tr_b16 v[196:197], v27 offset:0
  v_mfma_f32_16x16x32_bf16 v[104:107], v[164:167], v[64:67], v[104:107]
  ds_read_b64_tr_b16 v[198:199], v27 offset:2048
  v_mfma_f32_16x16x32_bf16 v[112:115], v[168:171], v[64:67], v[112:115]
  ds_read_b64_tr_b16 v[200:201], v28 offset:0
  v_mfma_f32_16x16x32_bf16 v[116:119], v[168:171], v[68:71], v[116:119]
  ds_read_b64_tr_b16 v[202:203], v28 offset:2048
  v_mfma_f32_16x16x32_bf16 v[124:127], v[172:175], v[68:71], v[124:127]
  ds_read_b64_tr_b16 v[204:205], v29 offset:0
  v_mfma_f32_16x16x32_bf16 v[120:123], v[172:175], v[64:67], v[120:123]
  ds_read_b64_tr_b16 v[206:207], v29 offset:2048
  s_waitcnt vmcnt(4) lgkmcnt(8)
  v_mfma_f32_16x16x32_bf16 v[96:99], v[176:179], v[72:75], v[96:99]
  ds_read_b64_tr_b16 v[208:209], v26 offset:4096
  v_mfma_f32_16x16x32_bf16 v[100:103], v[176:179], v[76:79], v[100:103]
  ds_read_b64_tr_b16 v[210:211], v26 offset:6144
  v_mfma_f32_16x16x32_bf16 v[108:111], v[180:183], v[76:79], v[108:111]
  ds_read_b64_tr_b16 v[212:213], v27 offset:4096
  v_mfma_f32_16x16x32_bf16 v[104:107], v[180:183], v[72:75], v[104:107]
  ds_read_b64_tr_b16 v[214:215], v27 offset:6144
  v_mfma_f32_16x16x32_bf16 v[112:115], v[184:187], v[72:75], v[112:115]
  ds_read_b64_tr_b16 v[216:217], v28 offset:4096
  v_mfma_f32_16x16x32_bf16 v[116:119], v[184:187], v[76:79], v[116:119]
  ds_read_b64_tr_b16 v[218:219], v28 offset:6144
  v_mfma_f32_16x16x32_bf16 v[124:127], v[188:191], v[76:79], v[124:127]
  ds_read_b64_tr_b16 v[220:221], v29 offset:4096
  v_mfma_f32_16x16x32_bf16 v[120:123], v[188:191], v[72:75], v[120:123]
  ds_read_b64_tr_b16 v[222:223], v29 offset:6144
  s_waitcnt vmcnt(2) lgkmcnt(8)
  v_mfma_f32_16x16x32_bf16 v[96:99], v[192:195], v[80:83], v[96:99]
  v_mov_b32 v20, 0x3f803f80
  v_mov_b32 v21, 0x3f803f80
  v_mfma_f32_16x16x32_bf16 v[100:103], v[192:195], v[84:87], v[100:103]
  v_mov_b32 v22, 0x3f803f80
  v_mov_b32 v23, 0x3f803f80
  v_mfma_f32_16x16x32_bf16 v[108:111], v[196:199], v[84:87], v[108:111]
  v_mfma_f32_16x16x32_bf16 v[104:107], v[196:199], v[80:83], v[104:107]
  v_mfma_f32_16x16x32_bf16 v[112:115], v[200:203], v[80:83], v[112:115]
  v_mfma_f32_16x16x32_bf16 v[116:119], v[200:203], v[84:87], v[116:119]
  v_mfma_f32_16x16x32_bf16 v[124:127], v[204:207], v[84:87], v[124:127]
  v_mfma_f32_16x16x32_bf16 v[120:123], v[204:207], v[80:83], v[120:123]
  s_waitcnt vmcnt(0) lgkmcnt(0)
  v_mfma_f32_16x16x32_bf16 v[96:99], v[208:211], v[88:91], v[96:99]
  s_mov_b32 vcc_lo, 0xaaaaaaaa
  s_mov_b32 vcc_hi, vcc_lo
  v_mfma_f32_16x16x32_bf16 v[104:107], v[212:215], v[88:91], v[104:107]
  s_mov_b32 s8, 0xcccccccc
  s_mov_b32 s9, s8
  v_mfma_f32_16x16x32_bf16 v[112:115], v[216:219], v[88:91], v[112:115]
  s_mov_b32 s3, 32768
  v_mfma_f32_16x16x32_bf16 v[120:123], v[220:223], v[88:91], v[120:123]
  v_cvt_pk_bf16_f32 v240, v96, v97
  v_cvt_pk_bf16_f32 v241, v98, v99
  v_mfma_f32_16x16x32_bf16 v[100:103], v[208:211], v[92:95], v[100:103]
  v_cvt_pk_bf16_f32 v242, v104, v105
  v_cvt_pk_bf16_f32 v243, v106, v107
  v_mfma_f32_16x16x32_bf16 v[108:111], v[212:215], v[92:95], v[108:111]
  buffer_store_dwordx4 v[240:243], v12, s[44:47], 0 offen offset:0 sc1
  ds_write_b128 v19, v[240:243] offset:0
  v_mfma_f32_16x16x32_bf16 v[116:119], v[216:219], v[92:95], v[116:119]
  v_cvt_pk_bf16_f32 v244, v112, v113
  v_cvt_pk_bf16_f32 v245, v114, v115
  v_mfma_f32_16x16x32_bf16 v[124:127], v[220:223], v[92:95], v[124:127]
  v_cvt_pk_bf16_f32 v246, v120, v121
  v_cvt_pk_bf16_f32 v247, v122, v123
  buffer_store_dwordx4 v[244:247], v12, s[44:47], 0 offen offset:1024 sc1
  ds_write_b128 v19, v[244:247] offset:1024
  v_mfma_f32_16x16x32_bf16 v[132:135], v[240:243], v[240:243], 0
  v_cvt_pk_bf16_f32 v248, v100, v101
  v_cvt_pk_bf16_f32 v249, v102, v103
  v_mfma_f32_16x16x32_bf16 v[128:131], v[20:23], v[240:243], 0
  v_cvt_pk_bf16_f32 v250, v108, v109
  v_cvt_pk_bf16_f32 v251, v110, v111
  v_mfma_f32_16x16x32_bf16 v[132:135], v[244:247], v[244:247], v[132:135]
  buffer_store_dwordx4 v[248:251], v12, s[44:47], s3 offen offset:0 sc1
  ds_write_b128 v19, v[248:251] offset:2048
  v_mfma_f32_16x16x32_bf16 v[128:131], v[20:23], v[244:247], v[128:131]
  v_cvt_pk_bf16_f32 v252, v116, v117
  v_cvt_pk_bf16_f32 v253, v118, v119
  v_mfma_f32_16x16x32_bf16 v[140:143], v[248:251], v[248:251], 0
  v_cvt_pk_bf16_f32 v254, v124, v125
  v_cvt_pk_bf16_f32 v255, v126, v127
  v_mfma_f32_16x16x32_bf16 v[136:139], v[20:23], v[248:251], 0
  buffer_store_dwordx4 v[252:255], v12, s[44:47], s3 offen offset:1024 sc1
  ds_write_b128 v19, v[252:255] offset:3072
  v_mfma_f32_16x16x32_bf16 v[140:143], v[252:255], v[252:255], v[140:143]
  v_mfma_f32_16x16x32_bf16 v[136:139], v[20:23], v[252:255], v[136:139]
  v_cndmask_b32 v132, v132, v133, vcc
  v_cndmask_b32 v134, v134, v135, vcc
  v_cndmask_b32 v129, v132, v134, s[8:9]
  buffer_store_dwordx2 v[128:129], v18, s[56:59], 0 offen offset:0 sc1
  s_nop 2
  v_cndmask_b32 v140, v140, v141, vcc
  v_cndmask_b32 v142, v142, v143, vcc
  v_cndmask_b32 v137, v140, v142, s[8:9]
  buffer_store_dwordx2 v[136:137], v18, s[56:59], 0 offen offset:128 sc1
  s_waitcnt vmcnt(0) lgkmcnt(0)
  s_barrier
  s_add_u32 s97, s97, 1
  s_branch L_w1_body
L_wo_c1:
L_w1_c0:
L_w1_body:
  s_cmp_ge_u32 s2, 256
  s_cbranch_scc1 L_w1_end
  v_lshrrev_b32 v2, 6, v0
  v_and_b32 v1, 63, v0
  v_readfirstlane_b32 s70, v2
  s_and_b32 s3, s2, 7
  s_lshr_b32 s99, s2, 3
  s_and_b32 s5, s3, 3
  s_lshl_b32 s5, s5, 2
  s_and_b32 s6, s99, 3
  s_add_u32 s68, s5, s6
  s_lshr_b32 s5, s3, 2
  s_lshl_b32 s5, s5, 3
  s_lshr_b32 s6, s99, 2
  s_add_u32 s69, s5, s6
  s_cmp_lt_u32 s70, 4
  s_cbranch_scc1 L_w1_compute
L_w1_loader:
  s_add_u32 s8, s70, s69
  s_and_b32 s8, s8, 3
  s_add_u32 s9, s70, s68
  s_and_b32 s9, s9, 3
  s_lshl_b32 s76, s8, 12
  s_lshl_b32 s77, s9, 11
  s_add_u32 s77, s77, 16384
  s_lshl_b32 s11, s68, 7
  v_and_b32 v10, 7, v1
  s_lshr_b32 s10, s76, 11
  s_lshl_b32 s3, s68, 3
  s_add_u32 s10, s10, s3
  s_mul_i32 s10, s10, 32768
  v_lshl_add_u32 v4, v1, 4, s10
  v_add_u32 v5, 32768, v4
  v_lshrrev_b32 v3, 3, v1
  s_lshl_b32 s10, s9, 4
  v_add_u32 v3, s10, v3
  v_mul_u32_u24 v3, 7168, v3
  v_lshrrev_b32 v2, 3, v1
  v_and_b32 v2, 6, v2
  v_xor_b32 v2, v2, v10
  s_mul_i32 s10, s69, 128
  v_add_u32 v3, s10, v3
  v_lshl_add_u32 v8, v2, 4, v3
  v_add_u32 v3, 57344, v3
  v_lshl_add_u32 v9, v2, 4, v3
  v_lshrrev_b32 v3, 2, v1
  s_lshl_b32 s10, s9, 4
  v_add_u32 v3, s10, v3
  v_mul_u32_u24 v3, 7168, v3
  v_bfe_u32 v2, v1, 4, 1
  v_xor_b32 v2, v2, v1
  v_and_b32 v2, 3, v2
  s_lshl_b32 s10, s69, 6
  s_add_u32 s10, s10, 2048
  v_add_u32 v3, s10, v3
  v_lshl_add_u32 v28, v2, 4, v3
  s_lshl_b32 s78, s69, 7
  s_add_u32 s78, s78, 3072
  s_mov_b32 s75, 0
  s_add_u32 s100, s68, s69
  s_mov_b32 s101, -1
  s_add_u32 s3, s68, s69
  s_and_b32 s3, s3, 3
  s_mov_b32 s100, 0x68532410
  s_mov_b32 s101, 0xfedbac97
  s_cmp_eq_u32 s3, 1
  s_cselect_b32 s100, 0x96435210, s100
  s_cselect_b32 s101, 0xfecbda87, s101
  s_cmp_eq_u32 s3, 2
  s_cselect_b32 s100, 0x75463210, s100
  s_cselect_b32 s101, 0xfdceb98a, s101
  s_cmp_eq_u32 s3, 3
  s_cselect_b32 s100, 0x65743210, s100
  s_cselect_b32 s101, 0xedfca9b8, s101
  s_waitcnt lgkmcnt(0)
  s_mov_b32 s40, s24
  s_and_b32 s41, s25, 0xffff
  s_mov_b32 s42, 7340032
  s_mov_b32 s43, 0x00020000
  s_cmp_lg_u32 s96, 0
  s_cbranch_scc1 L_pfc3_skip
  s_getpc_b64 s[4:5]
L_pfc3:
  s_lshl_b32 s3, s99, 2
  s_add_u32 s3, s3, s70
  s_sub_u32 s3, s3, 4
  s_mul_i32 s3, s3, 192
  s_min_u32 s3, s3, L_w2_c1-L_w2_c0-192
  s_add_i32 s3, s3, L_w2_c0-L_pfc3
  s_ashr_i32 s6, s3, 31
  s_add_u32 s4, s4, s3
  s_addc_u32 s5, s5, s6
  s_load_dword s84, s[4:5], 0
  s_load_dword s84, s[4:5], 64
  s_load_dword s84, s[4:5], 128
L_pfc3_skip:
  s_add_u32 s36, s34, 4194304
  s_addc_u32 s37, s35, 0
  s_and_b32 s37, s37, 0xffff
  s_mov_b32 s38, 4194304
  s_mov_b32 s39, 0x00020000
  s_add_u32 s56, s34, 24117248
  s_addc_u32 s57, s35, 0
  s_and_b32 s57, s57, 0xffff
  s_mov_b32 s58, 262144
  s_mov_b32 s59, 0x00020000
  s_add_u32 s64, s22, 24641536
  s_addc_u32 s65, s23, 0
  s_and_b32 s65, s65, 0xffff
  s_mov_b32 s66, 262144
  s_mov_b32 s67, 0x00020000
  s_mov_b32 s52, s26
  s_and_b32 s53, s27, 0xffff
  s_mov_b32 s54, 7168
  s_mov_b32 s55, 0x00020000
  s_and_b32 s3, s70, 3
  s_lshl2_add_u32 s4, s68, s3
  s_lshl_b32 s4, s4, 8
  v_lshrrev_b32 v2, 4, v1
  v_and_b32 v3, 15, v1
  v_lshl_add_u32 v3, v3, 4, s4
  v_lshl_add_u32 v18, v2, 14, v3
  s_lshl_b32 s4, s69, 7
  s_lshl_b32 s5, s70, 6
  s_add_u32 s4, s4, s5
  s_add_u32 s4, s4, 1216
  s_lshl_b32 s5, s69, 6
  s_cmp_eq_u32 s70, 4
  s_cselect_b32 s4, s5, s4
  s_lshr_b32 s5, s5, 1
  s_add_u32 s5, s5, 1024
  s_cmp_eq_u32 s70, 7
  s_cselect_b32 s4, s5, s4
  v_and_b32 v3, 15, v1
  v_lshl_add_u32 v3, v3, 2, s4
  v_lshrrev_b32 v2, 4, v1
  v_add_lshl_u32 v23, v3, v2, 1
  v_lshlrev_b32 v3, 2, v3
  v_lshl_add_u32 v22, v2, 14, v3
  s_mov_b32 s60, s28
  s_and_b32 s61, s29, 0xffff
  s_mov_b32 s62, 7340032
  s_mov_b32 s63, 0x00020000
  s_cmp_eq_u32 s96, 0
  s_cselect_b32 s62, s62, 0
  s_and_b32 s3, s70, 3
  s_lshl_b32 s4, s2, 2
  s_add_u32 s3, s3, s4
  s_mul_i32 s98, s3, 3584
  s_add_u32 s98, s98, 3670016
  s_buffer_load_dword s84, s[60:63], s98 offset:0
  s_buffer_load_dword s84, s[60:63], s98 offset:64
  s_buffer_load_dword s84, s[60:63], s98 offset:128
  s_buffer_load_dword s84, s[60:63], s98 offset:192
  s_waitcnt vmcnt(0)
  s_barrier
  s_lshr_b32 s3, s69, 3
  s_and_b32 s73, s69, 7
  s_lshl1_add_u32 s91, s73, s3
  s_mul_i32 s74, s91, 458752
  s_lshl_b32 s73, s91, 11
  s_mov_b32 s88, s73
  s_add_u32 m0, s77, 0
  s_add_u32 s4, s74, 0
  buffer_load_dwordx4 v8, s[40:43], s4 offen lds
  s_add_u32 m0, s77, 1024
  s_nop 0
  buffer_load_dwordx4 v9, s[40:43], s4 offen lds
  s_add_u32 m0, s77, 8192
  s_add_u32 s4, s74, s78
  buffer_load_dwordx4 v8, s[40:43], s4 offen lds
  s_add_u32 m0, s77, 9216
  s_nop 0
  buffer_load_dwordx4 v9, s[40:43], s4 offen lds
  s_add_u32 m0, s77, 16384
  s_add_u32 s4, s4, 128
  buffer_load_dwordx4 v8, s[40:43], s4 offen lds
  s_add_u32 m0, s77, 17408
  s_nop 0
  buffer_load_dwordx4 v9, s[40:43], s4 offen lds
  s_add_u32 m0, s77, 24576
  s_nop 0
  buffer_load_dwordx4 v28, s[40:43], s74 offen lds
  s_and_b32 s73, s100, 15
  s_cmp_eq_u32 s73, s91
  s_cselect_b32 s74, 4, 0
  s_lshr_b64 s[100:101], s[100:101], s74
  s_and_b32 s73, s100, 15
  s_lshr_b64 s[100:101], s[100:101], 4
  s_mul_i32 s74, s73, 458752
  s_lshl_b32 s73, s73, 11
  s_add_u32 s3, s96, s70
  s_cmp_lg_u32 s3, 4
  s_cbranch_scc1 L_w1_chkNone
  s_add_u32 s44, s22, 41943040
  s_addc_u32 s45, s23, 0
  s_and_b32 s45, s45, 0xffff
  s_mov_b32 s46, 524288
  s_mov_b32 s47, 0x00020000
  v_lshrrev_b32 v2, 2, v1
  v_and_b32 v3, 3, v1
  v_lshlrev_b32 v2, 11, v2
  v_lshl_add_u32 v17, v3, 4, v2
  s_and_b32 s3, s69, 15
  s_lshl_b32 s3, s3, 7
  s_mov_b32 s79, 0x100000
L_w1_chkl:
  buffer_load_dwordx4 v[12:15], v17, s[44:47], s3 offen sc1
  s_sub_u32 s79, s79, 1
  s_cbranch_scc1 L_w1_chkNone
  s_waitcnt vmcnt(0)
  v_and_b32 v12, v12, v13
  v_and_b32 v14, v14, v15
  v_and_b32 v12, v12, v14
  v_cmp_ne_u32 vcc, 1, v12
  s_cbranch_vccnz L_w1_chkl
L_w1_chkNone:
  s_mov_b32 s75, 0
  s_add_u32 s44, s22, 41943040
  s_addc_u32 s45, s23, 0
  s_and_b32 s45, s45, 0xffff
  s_mov_b32 s46, 524288
  s_mov_b32 s47, 0x00020000
  s_lshl4_add_u32 s3, s97, s68
  s_and_b32 s4, s69, 15
  s_lshl4_add_u32 s3, s3, s4
  s_lshl_b32 s3, s3, 7
  s_sub_u32 s3, s3, 32768
  v_lshlrev_b32 v11, 7, v1
  v_and_b32 v2, 15, v1
  v_lshlrev_b32 v2, 2, v2
  s_getreg_b32 s4, hwreg(HW_REG_XCC_ID, 0, 4)
  v_add_u32 v3, 1, s4
  s_mov_b32 s79, 0x100000
  s_waitcnt vmcnt(0)
  s_cmp_lg_u32 s70, 4
  s_barrier
  s_cbranch_scc1 L_w1_nofl
  s_mov_b32 exec_lo, 0xffff
  s_mov_b32 exec_hi, 0
  buffer_store_dword v3, v11, s[44:47], s87 offen sc1
  s_mov_b64 exec, -1
L_w1_nofl:
  s_mov_b32 s5, s3
  s_mov_b32 s89, s73
  s_add_u32 m0, s77, 49152
  s_add_u32 s4, s74, 0
  buffer_load_dwordx4 v8, s[40:43], s4 offen lds
  s_add_u32 m0, s77, 50176
  s_nop 0
  buffer_load_dwordx4 v9, s[40:43], s4 offen lds
  s_add_u32 m0, s77, 57344
  s_add_u32 s4, s74, s78
  buffer_load_dwordx4 v8, s[40:43], s4 offen lds
  s_add_u32 m0, s77, 58368
  s_nop 0
  buffer_load_dwordx4 v9, s[40:43], s4 offen lds
  s_add_u32 m0, s77, 65536
  s_add_u32 s4, s4, 128
  buffer_load_dwordx4 v8, s[40:43], s4 offen lds
  s_add_u32 m0, s77, 66560
  s_nop 0
  buffer_load_dwordx4 v9, s[40:43], s4 offen lds
  s_add_u32 m0, s77, 73728
  s_nop 0
  buffer_load_dwordx4 v28, s[40:43], s74 offen lds
  s_and_b32 s73, s100, 15
  s_cmp_eq_u32 s73, s91
  s_cselect_b32 s74, 4, 0
  s_lshr_b64 s[100:101], s[100:101], s74
  s_and_b32 s73, s100, 15
  s_lshr_b64 s[100:101], s[100:101], 4
  s_mul_i32 s74, s73, 458752
  s_lshl_b32 s73, s73, 11
  s_mov_b32 s90, s73
  s_add_u32 m0, s77, 98304
  s_add_u32 s4, s74, 0
  buffer_load_dwordx4 v8, s[40:43], s4 offen lds
  s_add_u32 m0, s77, 99328
  s_nop 0
  buffer_load_dwordx4 v9, s[40:43], s4 offen lds
  s_add_u32 m0, s77, 106496
  s_add_u32 s4, s74, s78
  buffer_load_dwordx4 v8, s[40:43], s4 offen lds
  s_add_u32 m0, s77, 107520
  s_nop 0
  buffer_load_dwordx4 v9, s[40:43], s4 offen lds
  s_add_u32 m0, s77, 114688
  s_add_u32 s4, s4, 128
  buffer_load_dwordx4 v8, s[40:43], s4 offen lds
  s_add_u32 m0, s77, 115712
  s_nop 0
  buffer_load_dwordx4 v9, s[40:43], s4 offen lds
  s_add_u32 m0, s77, 122880
  s_nop 0
  buffer_load_dwordx4 v28, s[40:43], s74 offen lds
  s_and_b32 s73, s100, 15
  s_cmp_eq_u32 s73, s91
  s_cselect_b32 s74, 4, 0
  s_lshr_b64 s[100:101], s[100:101], s74
  s_and_b32 s73, s100, 15
  s_lshr_b64 s[100:101], s[100:101], 4
  s_mul_i32 s74, s73, 458752
  s_lshl_b32 s73, s73, 11
  s_mov_b32 s3, s5
  s_cmp_lg_u32 s70, 4
  s_cbranch_scc1 L_w1_dep
L_w1_poll:
  buffer_load_dword v27, v2, s[44:47], s3 offen sc1
  s_sub_u32 s79, s79, 1
  s_cbranch_scc1 L_w1_dep
  s_waitcnt vmcnt(0)
  v_cmp_eq_u32 vcc, 0, v27
  s_cbranch_vccnz L_w1_poll
L_w1_dep:
  s_waitcnt vmcnt(7)
  s_barrier
  s_add_u32 m0, s76, 49152
  s_nop 0
  buffer_load_dwordx4 v4, s[36:39], s89 offen offset:0 lds
  buffer_load_dwordx4 v4, s[36:39], s89 offen offset:1024 lds
  s_add_u32 m0, s76, 51200
  s_nop 0
  buffer_load_dwordx4 v5, s[36:39], s89 offen offset:0 lds
  buffer_load_dwordx4 v5, s[36:39], s89 offen offset:1024 lds
  s_add_u32 m0, s76, 98304
  s_nop 0
  buffer_load_dwordx4 v4, s[36:39], s90 offen offset:0 lds
  buffer_load_dwordx4 v4, s[36:39], s90 offen offset:1024 lds
  s_add_u32 m0, s76, 100352
  s_nop 0
  buffer_load_dwordx4 v5, s[36:39], s90 offen offset:0 lds
  buffer_load_dwordx4 v5, s[36:39], s90 offen offset:1024 lds
  s_waitcnt vmcnt(4)
  s_barrier
  s_mov_b32 s79, 13
L_w1_ld1:
  s_add_u32 s3, s75, s76
  s_add_u32 m0, s3, 0
  s_nop 0
  buffer_load_dwordx4 v4, s[36:39], s73 offen offset:0 lds
  buffer_load_dwordx4 v4, s[36:39], s73 offen offset:1024 lds
  s_add_u32 m0, s3, 2048
  s_nop 0
  buffer_load_dwordx4 v5, s[36:39], s73 offen offset:0 lds
  buffer_load_dwordx4 v5, s[36:39], s73 offen offset:1024 lds
  s_add_u32 s3, s75, s77
  s_add_u32 m0, s3, 0
  s_add_u32 s4, s74, 0
  buffer_load_dwordx4 v8, s[40:43], s4 offen lds
  s_add_u32 m0, s3, 1024
  s_nop 0
  buffer_load_dwordx4 v9, s[40:43], s4 offen lds
  s_add_u32 m0, s3, 8192
  s_add_u32 s4, s74, s78
  buffer_load_dwordx4 v8, s[40:43], s4 offen lds
  s_add_u32 m0, s3, 9216
  s_nop 0
  buffer_load_dwordx4 v9, s[40:43], s4 offen lds
  s_add_u32 m0, s3, 16384
  s_add_u32 s4, s4, 128
  buffer_load_dwordx4 v8, s[40:43], s4 offen lds
  s_add_u32 m0, s3, 17408
  s_nop 0
  buffer_load_dwordx4 v9, s[40:43], s4 offen lds
  s_add_u32 m0, s3, 24576
  s_nop 0
  buffer_load_dwordx4 v28, s[40:43], s74 offen lds
  s_and_b32 s73, s100, 15
  s_cmp_eq_u32 s73, s91
  s_cselect_b32 s74, 4, 0
  s_lshr_b64 s[100:101], s[100:101], s74
  s_and_b32 s73, s100, 15
  s_lshr_b64 s[100:101], s[100:101], 4
  s_mul_i32 s74, s73, 458752
  s_lshl_b32 s73, s73, 11
  s_add_u32 s75, s75, 49152
  s_cmp_eq_u32 s75, 147456
  s_cselect_b32 s75, 0, s75
  s_buffer_load_dword s84, s[60:63], s98 offset:256
  s_buffer_load_dword s84, s[60:63], s98 offset:320
  s_buffer_load_dword s84, s[60:63], s98 offset:384
  s_buffer_load_dword s84, s[60:63], s98 offset:448
  s_add_u32 s98, s98, 256
  s_waitcnt vmcnt(11)
  s_barrier
  s_sub_u32 s79, s79, 1
  s_cmp_lg_u32 s79, 0
  s_cbranch_scc1 L_w1_ld1
  buffer_load_dwordx4 v[32:35], v18, s[56:59], 0 offen
  s_mov_b32 s3, 65536
  buffer_load_dwordx4 v[36:39], v18, s[56:59], s3 offen
  s_mov_b32 s3, 131072
  buffer_load_dwordx4 v[40:43], v18, s[56:59], s3 offen
  s_mov_b32 s3, 196608
  buffer_load_dwordx4 v[44:47], v18, s[56:59], s3 offen
  s_cmp_lg_u32 s96, 0
  s_cbranch_scc1 L_w1_cl
  buffer_load_dwordx4 v[64:67], v22, s[64:67], 0 offen
  s_mov_b32 s3, 65536
  buffer_load_dwordx4 v[68:71], v22, s[64:67], s3 offen
  s_mov_b32 s3, 131072
  buffer_load_dwordx4 v[72:75], v22, s[64:67], s3 offen
  s_mov_b32 s3, 196608
  buffer_load_dwordx4 v[76:79], v22, s[64:67], s3 offen
  buffer_load_ushort v80, v23, s[52:55], 0 offen
  s_branch L_w1_cle
  L_w1_cl:
  s_waitcnt vmcnt(4)
  L_w1_cle:
  s_waitcnt vmcnt(9)
  s_barrier
  s_waitcnt vmcnt(0)
  s_cmp_lg_u32 s96, 0
  s_cbranch_scc1 L_w1_cp
  s_and_b32 s3, s70, 3
  s_lshl_b32 s5, s3, 9
  s_add_u32 s5, s5, 106496
  v_lshrrev_b32 v2, 5, v1
  v_and_b32 v3, 15, v1
  v_lshl_add_u32 v2, v3, 1, v2
  v_lshl_add_u32 v205, v2, 4, s5
  v_add_f32 v64, v64, v68
  v_add_f32 v65, v65, v69
  v_add_f32 v66, v66, v70
  v_add_f32 v67, v67, v71
  v_add_f32 v72, v72, v76
  v_add_f32 v73, v73, v77
  v_add_f32 v74, v74, v78
  v_add_f32 v75, v75, v79
  v_add_f32 v64, v64, v72
  v_add_f32 v65, v65, v73
  v_add_f32 v66, v66, v74
  v_add_f32 v67, v67, v75
  s_nop 1
  v_permlane32_swap_b32 v64, v66
  v_permlane32_swap_b32 v65, v67
  v_add_f32 v64, v64, v66
  v_add_f32 v65, v65, v67
  v_lshl_or_b32 v203, v80, 16, v80
  s_lshl_b32 s5, s3, 10
  s_add_u32 s5, s5, 110592
  v_permlane16_swap_b32 v64, v65
  v_lshrrev_b32 v2, 4, v1
  v_lshl_add_u32 v2, v3, 2, v2
  v_lshl_add_u32 v204, v2, 4, s5
  v_add_f32 v64, v64, v65
  v_cvt_pk_bf16_f32 v200, v64, v64
  v_and_b32 v65, 0xffff0000, v200
  v_sub_f32 v65, v64, v65
  v_cvt_pk_bf16_f32 v201, v64, v65
  v_and_b32 v202, 0xffff0000, v201
  v_sub_f32 v65, v65, v202
  v_cvt_pk_bf16_f32 v202, v65, v64
  v_mov_b32 v200, v201
  L_w1_cp:
  ds_write_b128 v204, v[200:203]
  v_add_f32 v32, v32, v36
  v_add_f32 v33, v33, v37
  v_add_f32 v34, v34, v38
  v_add_f32 v35, v35, v39
  v_add_f32 v40, v40, v44
  v_add_f32 v41, v41, v45
  v_add_f32 v42, v42, v46
  v_add_f32 v43, v43, v47
  v_add_f32 v32, v32, v40
  v_add_f32 v33, v33, v41
  v_add_f32 v34, v34, v42
  v_add_f32 v35, v35, v43
  s_nop 1
  v_permlane32_swap_b32 v32, v34
  v_permlane32_swap_b32 v33, v35
  v_add_f32 v32, v32, v34
  v_add_f32 v33, v33, v35
  v_mov_b32 v34, v32
  v_mov_b32 v35, v33
  s_nop 0
  v_permlane16_swap_b32 v32, v34
  v_permlane16_swap_b32 v33, v35
  v_add_f32 v32, v32, v34
  v_add_f32 v33, v33, v35
  v_mul_f32 v32, 0x3a800000, v32
  v_mul_f32 v33, 0x3a800000, v33
  v_fma_f32 v33, -v32, v32, v33
  v_max_f32 v33, 0, v33
  v_add_f32 v33, 0x3727c5ac, v33
  v_rsq_f32 v34, v33
  v_mul_f32 v32, -0.5, v32
  v_cvt_pk_bf16_f32 v36, v32, v32
  v_and_b32 v35, 0xffff0000, v36
  v_sub_f32 v35, v32, v35
  v_cvt_pk_bf16_f32 v37, v35, v35
  v_and_b32 v38, 0xffff0000, v37
  v_sub_f32 v35, v35, v38
  v_cvt_pk_bf16_f32 v38, v32, v35
  v_mul_f32 v42, v33, v34
  v_mul_f32 v40, 0xc0135761, v34
  v_mul_f32 v34, v34, v34
  v_mul_f32 v33, 0.5, v42
  v_mul_f32 v34, 0x3d372713, v34
  v_cvt_pk_bf16_f32 v35, v33, v33
  v_mul_f32 v41, v40, v34
  v_and_b32 v35, 0xffff0000, v35
  v_xor_b32_dpp v43, v27, v27 row_ror:2 row_mask:0xf bank_mask:0xf
  v_sub_f32 v35, v33, v35
  v_cmp_ne_u32 vcc, 0, v43
  v_cvt_pk_bf16_f32 v39, v33, v35
  s_or_b32 s92, vcc_lo, vcc_hi
  v_mov_b32 v43, s92
  ds_write_b128 v205, v[36:39]
  ds_write_b128 v205, v[40:43] offset:2048
  s_waitcnt lgkmcnt(0)
  s_barrier
  s_lshl_b32 s87, s97, 15
  s_lshl_b32 s4, s68, 11
  s_add_u32 s87, s87, s4
  s_lshl_b32 s4, s69, 2
  s_add_u32 s87, s87, s4
  s_add_u32 s97, s97, 1
  s_branch L_w2_body
L_w1_end:
  s_endpgm
L_w1_compute:
  s_and_b32 s71, s70, 1
  s_lshr_b32 s72, s70, 1
  v_and_b32 v3, 15, v1
  v_lshrrev_b32 v2, 4, v1
  s_lshl_b32 s8, s71, 13
  v_lshl_add_u32 v4, v1, 4, s8
  v_lshrrev_b32 v13, 2, v1
  v_lshlrev_b32 v13, 7, v13
  v_and_b32 v17, 3, v1
  v_lshl_add_u32 v13, v17, 3, v13
  v_bfe_u32 v17, v1, 3, 2
  v_lshl_add_u32 v13, v17, 5, v13
  s_lshl_b32 s9, s72, 6
  v_xor_b32 v13, s9, v13
  v_add_u32 v5, 16384, v13
  v_xor_b32 v6, 32, v5
  v_and_b32 v16, 1, v2
  v_lshrrev_b32 v17, 1, v2
  v_lshrrev_b32 v13, 2, v1
  v_and_b32 v14, 1, v1
  v_lshl_add_u32 v13, v13, 1, v14
  v_xor_b32 v14, s72, v16
  v_lshl_add_u32 v13, v13, 1, v14
  v_bfe_u32 v14, v1, 1, 1
  v_lshl_add_u32 v13, v13, 1, v14
  v_lshlrev_b32 v13, 3, v13
  v_add_u32 v7, 40960, v13
  s_mov_b32 s75, 0
  v_add_u32_e64 v20, s75, v4
  v_add_u32_e64 v21, s75, v5
  v_add_u32_e64 v22, s75, v6
  v_add_u32_e64 v23, s75, v7
  s_add_u32 s75, s75, 49152
  s_cmp_eq_u32 s75, 147456
  s_cselect_b32 s75, 0, s75
  s_mov_b32 s79, 14
  ds_read_b128 v[32:35], v20 offset:0
  ds_read_b128 v[36:39], v20 offset:2048
  ds_read_b128 v[40:43], v20 offset:4096
  ds_read_b128 v[44:47], v20 offset:6144
  ds_read_b64_tr_b16 v[48:49], v21 offset:0
  ds_read_b64_tr_b16 v[50:51], v21 offset:2048
  ds_read_b64_tr_b16 v[52:53], v22 offset:0
  ds_read_b64_tr_b16 v[54:55], v22 offset:2048
  ds_read_b64_tr_b16 v[56:57], v21 offset:8192
  ds_read_b64_tr_b16 v[58:59], v21 offset:10240
  ds_read_b64_tr_b16 v[60:61], v22 offset:8192
  ds_read_b64_tr_b16 v[62:63], v22 offset:10240
  ds_read_b64_tr_b16 v[64:65], v21 offset:16384
  ds_read_b64_tr_b16 v[66:67], v21 offset:18432
  ds_read_b64_tr_b16 v[68:69], v22 offset:16384
  ds_read_b64_tr_b16 v[70:71], v22 offset:18432
  ds_read_b64_tr_b16 v[72:73], v23 offset:0
  ds_read_b64_tr_b16 v[74:75], v23 offset:2048
  s_waitcnt lgkmcnt(0)
  v_mfma_f32_16x16x32_bf16 v[128:131], v[48:51], v[32:35], 0
  ds_read_b128 v[80:83], v20 offset:1024
  v_mfma_f32_16x16x32_bf16 v[132:135], v[48:51], v[36:39], 0
  ds_read_b128 v[84:87], v20 offset:3072
  v_mfma_f32_16x16x32_bf16 v[136:139], v[48:51], v[40:43], 0
  ds_read_b128 v[88:91], v20 offset:5120
  v_mfma_f32_16x16x32_bf16 v[140:143], v[48:51], v[44:47], 0
  ds_read_b128 v[92:95], v20 offset:7168
  v_mfma_f32_16x16x32_bf16 v[156:159], v[52:55], v[44:47], 0
  ds_read_b64_tr_b16 v[96:97], v21 offset:4096
  v_mfma_f32_16x16x32_bf16 v[152:155], v[52:55], v[40:43], 0
  ds_read_b64_tr_b16 v[98:99], v21 offset:6144
  v_mfma_f32_16x16x32_bf16 v[148:151], v[52:55], v[36:39], 0
  ds_read_b64_tr_b16 v[100:101], v22 offset:4096
  v_mfma_f32_16x16x32_bf16 v[144:147], v[52:55], v[32:35], 0
  ds_read_b64_tr_b16 v[102:103], v22 offset:6144
  v_mfma_f32_16x16x32_bf16 v[160:163], v[56:59], v[32:35], 0
  ds_read_b64_tr_b16 v[104:105], v21 offset:12288
  v_mfma_f32_16x16x32_bf16 v[164:167], v[56:59], v[36:39], 0
  ds_read_b64_tr_b16 v[106:107], v21 offset:14336
  v_mfma_f32_16x16x32_bf16 v[168:171], v[56:59], v[40:43], 0
  ds_read_b64_tr_b16 v[108:109], v22 offset:12288
  v_mfma_f32_16x16x32_bf16 v[172:175], v[56:59], v[44:47], 0
  ds_read_b64_tr_b16 v[110:111], v22 offset:14336
  v_mfma_f32_16x16x32_bf16 v[188:191], v[60:63], v[44:47], 0
  ds_read_b64_tr_b16 v[112:113], v21 offset:20480
  v_mfma_f32_16x16x32_bf16 v[184:187], v[60:63], v[40:43], 0
  ds_read_b64_tr_b16 v[114:115], v21 offset:22528
  v_mfma_f32_16x16x32_bf16 v[180:183], v[60:63], v[36:39], 0
  ds_read_b64_tr_b16 v[116:117], v22 offset:20480
  v_mfma_f32_16x16x32_bf16 v[176:179], v[60:63], v[32:35], 0
  ds_read_b64_tr_b16 v[118:119], v22 offset:22528
  v_mfma_f32_16x16x32_bf16 v[192:195], v[64:67], v[32:35], 0
  ds_read_b64_tr_b16 v[120:121], v23 offset:4096
  v_mfma_f32_16x16x32_bf16 v[196:199], v[64:67], v[36:39], 0
  ds_read_b64_tr_b16 v[122:123], v23 offset:6144
  v_mfma_f32_16x16x32_bf16 v[200:203], v[64:67], v[40:43], 0
  v_add_u32_e64 v20, s75, v4
  v_mfma_f32_16x16x32_bf16 v[204:207], v[64:67], v[44:47], 0
  v_add_u32_e64 v21, s75, v5
  v_mfma_f32_16x16x32_bf16 v[220:223], v[68:71], v[44:47], 0
  v_add_u32_e64 v22, s75, v6
  v_mfma_f32_16x16x32_bf16 v[216:219], v[68:71], v[40:43], 0
  v_add_u32_e64 v23, s75, v7
  v_mfma_f32_16x16x32_bf16 v[212:215], v[68:71], v[36:39], 0
  s_add_u32 s75, s75, 49152
  v_mfma_f32_16x16x32_bf16 v[208:211], v[68:71], v[32:35], 0
  s_cmp_eq_u32 s75, 147456
  v_mfma_f32_16x16x32_bf16 v[224:227], v[72:75], v[32:35], 0
  s_cselect_b32 s75, 0, s75
  v_mfma_f32_16x16x32_bf16 v[228:231], v[72:75], v[36:39], 0
  v_mfma_f32_16x16x32_bf16 v[232:235], v[72:75], v[40:43], 0
  v_mfma_f32_16x16x32_bf16 v[236:239], v[72:75], v[44:47], 0
  s_waitcnt lgkmcnt(0)
  v_mfma_f32_16x16x32_bf16 v[128:131], v[96:99], v[80:83], v[128:131]
  v_mfma_f32_16x16x32_bf16 v[132:135], v[96:99], v[84:87], v[132:135]
  v_mfma_f32_16x16x32_bf16 v[136:139], v[96:99], v[88:91], v[136:139]
  v_mfma_f32_16x16x32_bf16 v[140:143], v[96:99], v[92:95], v[140:143]
  v_mfma_f32_16x16x32_bf16 v[156:159], v[100:103], v[92:95], v[156:159]
  v_mfma_f32_16x16x32_bf16 v[152:155], v[100:103], v[88:91], v[152:155]
  v_mfma_f32_16x16x32_bf16 v[148:151], v[100:103], v[84:87], v[148:151]
  v_mfma_f32_16x16x32_bf16 v[144:147], v[100:103], v[80:83], v[144:147]
  v_mfma_f32_16x16x32_bf16 v[160:163], v[104:107], v[80:83], v[160:163]
  v_mfma_f32_16x16x32_bf16 v[164:167], v[104:107], v[84:87], v[164:167]
  v_mfma_f32_16x16x32_bf16 v[168:171], v[104:107], v[88:91], v[168:171]
  v_mfma_f32_16x16x32_bf16 v[172:175], v[104:107], v[92:95], v[172:175]
  v_mfma_f32_16x16x32_bf16 v[188:191], v[108:111], v[92:95], v[188:191]
  v_mfma_f32_16x16x32_bf16 v[184:187], v[108:111], v[88:91], v[184:187]
  v_mfma_f32_16x16x32_bf16 v[180:183], v[108:111], v[84:87], v[180:183]
  v_mfma_f32_16x16x32_bf16 v[176:179], v[108:111], v[80:83], v[176:179]
  v_mfma_f32_16x16x32_bf16 v[192:195], v[112:115], v[80:83], v[192:195]
  v_mfma_f32_16x16x32_bf16 v[196:199], v[112:115], v[84:87], v[196:199]
  v_mfma_f32_16x16x32_bf16 v[200:203], v[112:115], v[88:91], v[200:203]
  v_mfma_f32_16x16x32_bf16 v[204:207], v[112:115], v[92:95], v[204:207]
  v_mfma_f32_16x16x32_bf16 v[220:223], v[116:119], v[92:95], v[220:223]
  v_mfma_f32_16x16x32_bf16 v[216:219], v[116:119], v[88:91], v[216:219]
  v_mfma_f32_16x16x32_bf16 v[212:215], v[116:119], v[84:87], v[212:215]
  v_mfma_f32_16x16x32_bf16 v[208:211], v[116:119], v[80:83], v[208:211]
  v_mfma_f32_16x16x32_bf16 v[224:227], v[120:123], v[80:83], v[224:227]
  v_mfma_f32_16x16x32_bf16 v[228:231], v[120:123], v[84:87], v[228:231]
  v_mfma_f32_16x16x32_bf16 v[232:235], v[120:123], v[88:91], v[232:235]
  v_mfma_f32_16x16x32_bf16 v[236:239], v[120:123], v[92:95], v[236:239]
  s_lshl_b32 s8, s68, 7
  s_lshl_b32 s9, s71, 6
  s_add_u32 s8, s8, s9
  s_mul_i32 s8, s8, 7168
  v_lshlrev_b32 v14, 8, v17
  v_lshl_add_u32 v14, v3, 4, v14
  s_lshl3_add_u32 s9, s71, s72
  s_lshl_b32 s9, s9, 10
  s_add_u32 s9, s9, 114688
  v_lshl_add_u32 v18, v1, 4, s9
  s_mov_b32 s52, s30
  s_and_b32 s53, s31, 0xffff
  s_mov_b32 s54, 2048
  s_mov_b32 s55, 0x00020000
  s_lshr_b32 s9, s69, 3
  s_and_b32 s10, s69, 7
  s_lshl1_add_u32 s9, s10, s9
  s_lshl_b32 s9, s9, 7
  v_lshl_add_u32 v19, v2, 3, s9
  v_add_u32 v14, s8, v14
  s_lshl_b32 s10, s69, 11
  s_lshl_b32 s9, s72, 10
  s_add_u32 s9, s9, s10
  v_lshl_add_u32 v12, v1, 4, s8
  v_add_u32 v12, s9, v12
  v_mul_u32_u24 v16, 114688, v16
  s_lshr_b32 s9, s9, 1
  v_add3_u32 v13, v16, v14, s9
  s_lshl_b32 s9, s71, 10
  s_add_u32 s9, s9, 106496
  v_lshl_add_u32 v14, v3, 4, s9
  s_lshl_b32 s9, s72, 9
  s_add_u32 s9, s9, 110592
  v_lshl_add_u32 v15, v3, 4, s9
  v_bfe_u32 v16, v1, 2, 1
  v_bfe_u32 v17, v1, 3, 1
  v_lshl_add_u32 v17, v16, 2, v17
  v_and_b32 v16, 3, v1
  v_lshl_add_u32 v17, v17, 2, v16
  s_lshl_b32 s9, s72, 7
  s_add_u32 s9, s9, 110592
  v_lshl_add_u32 v16, v17, 4, s9
  v_bfe_u32 v17, v1, 4, 1
  v_lshl_add_u32 v14, v17, 3, v14
  v_lshl_add_u32 v15, v17, 3, v15
  v_lshl_add_u32 v16, v17, 3, v16
  v_mov_b32 v17, 108556
  s_add_u32 s44, s34, 8388608
  s_addc_u32 s45, s35, 0
  s_and_b32 s45, s45, 0xffff
  s_mov_b32 s46, 14680064
  s_mov_b32 s47, 0x00020000
  s_lshr_b32 s3, s69, 3
  s_and_b32 s78, s69, 7
  s_lshl1_add_u32 s69, s78, s3
  s_add_u32 s3, s68, s78
  s_and_b32 s3, s3, 3
  s_mov_b32 s4, 0x1616160
  s_cmp_eq_u32 s3, 1
  s_cselect_b32 s4, 0x5858580, s4
  s_cmp_eq_u32 s3, 2
  s_cselect_b32 s4, 0x16161600, s4
  s_cmp_eq_u32 s3, 3
  s_cselect_b32 s4, 0x58585800, s4
  v_subrev_u32 v2, 3, v1
  v_min_u32 v2, 16, v2
  v_lshlrev_b32 v3, 1, v2
  v_bfe_i32 v30, s4, v3, 2
  v_sub_u32 v30, v1, v30
  v_subrev_u32 v30, 7, v30
  v_ashrrev_i32 v3, 1, v30
  v_cmp_eq_u32 vcc, s78, v3
  s_and_b32 s3, s69, 1
  v_or_b32 v2, 14, v30
  v_cndmask_b32 v2, v30, v2, vcc
  v_cmp_gt_i32 vcc, 0, v30
  s_lshl2_add_u32 s4, s3, 20
  v_add_u32 v30, s4, v30
  s_lshl4_add_u32 s4, s3, 24
  v_add_u32 v2, s4, v2
  v_cndmask_b32 v30, v2, v30, vcc
  s_and_b32 s5, s68, 3
  s_mul_i32 s5, s5, 3
  s_sub_u32 s5, s5, 23
  v_add_u32 v3, s5, v1
  v_subrev_u32 v2, 10, v3
  v_min_u32 v3, v3, v2
  v_subrev_u32 v2, 10, v3
  v_min_u32 v3, v3, v2
  v_cmp_gt_u32 vcc, 23, v1
  s_sub_u32 s5, s3, 46
  v_lshl_add_u32 v2, v1, 1, s5
  v_cndmask_b32 v3, v3, v2, vcc
  s_add_u32 s5, s78, 3
  v_ashrrev_i32 v2, 1, v3
  v_add_u32 v2, s5, v2
  v_and_b32 v2, 7, v2
  v_cmp_gt_u32 vcc, 21, v1
  v_and_b32 v3, 1, v3
  v_lshl_add_u32 v3, v3, 3, v2
  v_cndmask_b32 v3, v3, v30, vcc
  v_lshlrev_b32 v30, 11, v3
  s_barrier
  ds_read_b64_tr_b16 v[48:49], v21 offset:0
  ds_read_b64_tr_b16 v[50:51], v21 offset:2048
  ds_read_b64_tr_b16 v[52:53], v22 offset:0
  ds_read_b64_tr_b16 v[54:55], v22 offset:2048
  ds_read_b64_tr_b16 v[56:57], v21 offset:8192
  ds_read_b64_tr_b16 v[58:59], v21 offset:10240
  ds_read_b64_tr_b16 v[60:61], v22 offset:8192
  ds_read_b64_tr_b16 v[62:63], v22 offset:10240
  ds_read_b64_tr_b16 v[64:65], v21 offset:16384
  ds_read_b64_tr_b16 v[66:67], v21 offset:18432
  ds_read_b64_tr_b16 v[68:69], v22 offset:16384
  ds_read_b64_tr_b16 v[70:71], v22 offset:18432
  ds_read_b64_tr_b16 v[72:73], v23 offset:0
  ds_read_b64_tr_b16 v[74:75], v23 offset:2048
  v_and_b32 v3, 15, v1
  v_lshrrev_b32 v2, 4, v1
  s_lshl_b32 s8, s68, 7
  s_lshl_b32 s9, s70, 5
  s_add_u32 s8, s8, s9
  v_add_u32 v76, s8, v3
  s_lshl_b32 s14, s69, 7
  v_lshrrev_b32 v79, 1, v2
  v_lshlrev_b32 v26, 3, v3
  v_and_b32 v26, 0x70, v26
  v_lshlrev_b32 v78, 3, v2
  v_xor_b32 v26, v26, v78
  v_lshl_add_u32 v26, v3, 7, v26
  s_lshl_b32 s3, s70, 12
  v_add_u32 v26, s3, v26
  v_lshl_add_u32 v27, v1, 4, s3
  s_cmp_eq_u32 s96, 0
  s_cselect_b32 s7, 128, 0
  s_add_u32 s7, s7, 2048
  v_xor_b32 v78, v1, v2
  v_and_b32 v78, 7, v78
  v_lshl_add_u32 v78, v78, 4, s14
  v_lshrrev_b32 v77, 3, v1
  v_add_u32 v77, s8, v77
  v_mad_u32_u24 v28, v77, s7, v78
  v_bfe_u32 v78, v1, 2, 2
  v_xor_b32 v78, v78, v2
  v_lshl_add_u32 v29, v78, 17, v76
  s_lshl_b32 s14, s69, 14
  v_lshl_add_u32 v29, v29, 3, s14
  v_lshrrev_b32 v8, 2, v1
  v_lshlrev_b32 v8, 7, v8
  v_and_b32 v79, 3, v1
  v_lshl_add_u32 v8, v79, 3, v8
  v_bfe_u32 v79, v1, 3, 2
  v_lshl_add_u32 v8, v79, 5, v8
  s_mov_b32 s11, 0xffff0000
  s_add_u32 s36, s34, 8388608
  s_addc_u32 s37, s35, 0
  s_and_b32 s37, s37, 0xffff
  s_mov_b32 s40, s32
  s_and_b32 s41, s33, 0xffff
  s_mov_b32 s43, 0x00020000
  s_add_u32 s48, s22, 33554432
  s_addc_u32 s49, s23, 0
  s_and_b32 s49, s49, 0xffff
  s_cmp_eq_u32 s96, 0
  s_cselect_b64 s[40:41], s[48:49], s[40:41]
  s_lshl_b32 s42, s7, 11
  s_add_u32 s56, s34, 24379392
  s_addc_u32 s57, s35, 0
  s_and_b32 s57, s57, 0xffff
  s_mov_b32 s58, 262144
  s_mov_b32 s59, 0x00020000
  s_mul_i32 s9, s8, 7168
  s_add_u32 s36, s36, s9
  s_addc_u32 s37, s37, 0x100000
  s_add_u32 s64, s36, 114688
  s_addc_u32 s65, s37, 0
  s_mov_b32 s38, 114688
  s_mov_b32 s39, 0x00800000
  s_mov_b32 s66, 114688
  s_mov_b32 s67, 0x00800000
  s_add_u32 s60, s34, 25165824
  s_addc_u32 s61, s35, 0
  s_and_b32 s61, s61, 0xffff
  s_mov_b32 s62, 4194304
  s_or_b32 s61, s61, 0x100000
  s_mov_b32 s63, 0x00800000
  s_lshl4_add_u32 s4, s68, s69
  s_lshl2_add_u32 s4, s4, s70
  s_add_u32 s6, s96, 4
  s_lshl_b32 s6, s6, 10
  s_add_u32 s6, s6, s4
  s_lshl_b32 s6, s6, 6
  s_lshl_b32 s4, s4, 12
  s_xor_b32 s5, s4, 16384
  v_readlane_b32 s51, v30, 3
  v_readlane_b32 s48, v30, 4
  v_readlane_b32 s49, v30, 5
  s_barrier
  ds_read_b128 v[32:35], v20 offset:0
  ds_read_b128 v[36:39], v20 offset:2048
  ds_read_b128 v[40:43], v20 offset:4096
  ds_read_b128 v[44:47], v20 offset:6144
.p2align 5
  s_nop 0
  s_nop 0
  s_nop 0
  s_waitcnt lgkmcnt(0)
L_w1_loop:
  v_mfma_f32_16x16x32_bf16 v[128:131], v[48:51], v[32:35], v[128:131]
  ds_read_b128 v[80:83], v20 offset:1024
  v_mfma_f32_16x16x32_bf16 v[132:135], v[48:51], v[36:39], v[132:135]
  ds_read_b128 v[84:87], v20 offset:3072
  v_mfma_f32_16x16x32_bf16 v[136:139], v[48:51], v[40:43], v[136:139]
  ds_read_b128 v[88:91], v20 offset:5120
  v_mfma_f32_16x16x32_bf16 v[140:143], v[48:51], v[44:47], v[140:143]
  ds_read_b128 v[92:95], v20 offset:7168
  v_mfma_f32_16x16x32_bf16 v[156:159], v[52:55], v[44:47], v[156:159]
  ds_read_b64_tr_b16 v[96:97], v21 offset:4096
  v_mfma_f32_16x16x32_bf16 v[152:155], v[52:55], v[40:43], v[152:155]
  ds_read_b64_tr_b16 v[98:99], v21 offset:6144
  v_mfma_f32_16x16x32_bf16 v[148:151], v[52:55], v[36:39], v[148:151]
  ds_read_b64_tr_b16 v[100:101], v22 offset:4096
  v_mfma_f32_16x16x32_bf16 v[144:147], v[52:55], v[32:35], v[144:147]
  ds_read_b64_tr_b16 v[102:103], v22 offset:6144
  v_mfma_f32_16x16x32_bf16 v[160:163], v[56:59], v[32:35], v[160:163]
  ds_read_b64_tr_b16 v[104:105], v21 offset:12288
  v_mfma_f32_16x16x32_bf16 v[164:167], v[56:59], v[36:39], v[164:167]
  ds_read_b64_tr_b16 v[106:107], v21 offset:14336
  v_mfma_f32_16x16x32_bf16 v[168:171], v[56:59], v[40:43], v[168:171]
  ds_read_b64_tr_b16 v[108:109], v22 offset:12288
  v_mfma_f32_16x16x32_bf16 v[172:175], v[56:59], v[44:47], v[172:175]
  ds_read_b64_tr_b16 v[110:111], v22 offset:14336
  v_mfma_f32_16x16x32_bf16 v[188:191], v[60:63], v[44:47], v[188:191]
  ds_read_b64_tr_b16 v[112:113], v21 offset:20480
  v_mfma_f32_16x16x32_bf16 v[184:187], v[60:63], v[40:43], v[184:187]
  ds_read_b64_tr_b16 v[114:115], v21 offset:22528
  v_mfma_f32_16x16x32_bf16 v[180:183], v[60:63], v[36:39], v[180:183]
  ds_read_b64_tr_b16 v[116:117], v22 offset:20480
  v_mfma_f32_16x16x32_bf16 v[176:179], v[60:63], v[32:35], v[176:179]
  ds_read_b64_tr_b16 v[118:119], v22 offset:22528
  v_mfma_f32_16x16x32_bf16 v[192:195], v[64:67], v[32:35], v[192:195]
  ds_read_b64_tr_b16 v[120:121], v23 offset:4096
  v_mfma_f32_16x16x32_bf16 v[196:199], v[64:67], v[36:39], v[196:199]
  ds_read_b64_tr_b16 v[122:123], v23 offset:6144
  v_mfma_f32_16x16x32_bf16 v[200:203], v[64:67], v[40:43], v[200:203]
  v_add_u32_e64 v20, s75, v4
  v_mfma_f32_16x16x32_bf16 v[204:207], v[64:67], v[44:47], v[204:207]
  v_add_u32_e64 v21, s75, v5
  v_mfma_f32_16x16x32_bf16 v[220:223], v[68:71], v[44:47], v[220:223]
  v_add_u32_e64 v22, s75, v6
  v_mfma_f32_16x16x32_bf16 v[216:219], v[68:71], v[40:43], v[216:219]
  v_add_u32_e64 v23, s75, v7
  v_mfma_f32_16x16x32_bf16 v[212:215], v[68:71], v[36:39], v[212:215]
  s_add_u32 s75, s75, 49152
  v_mfma_f32_16x16x32_bf16 v[208:211], v[68:71], v[32:35], v[208:211]
  s_cmp_eq_u32 s75, 147456
  v_mfma_f32_16x16x32_bf16 v[224:227], v[72:75], v[32:35], v[224:227]
  s_cselect_b32 s75, 0, s75
  s_sub_u32 s79, s79, 1
  v_mfma_f32_16x16x32_bf16 v[228:231], v[72:75], v[36:39], v[228:231]
  v_mfma_f32_16x16x32_bf16 v[232:235], v[72:75], v[40:43], v[232:235]
  v_mfma_f32_16x16x32_bf16 v[236:239], v[72:75], v[44:47], v[236:239]
  s_waitcnt lgkmcnt(0)
  s_barrier
  v_mfma_f32_16x16x32_bf16 v[128:131], v[96:99], v[80:83], v[128:131]
  ds_read_b128 v[32:35], v20 offset:0
  v_mfma_f32_16x16x32_bf16 v[132:135], v[96:99], v[84:87], v[132:135]
  ds_read_b128 v[36:39], v20 offset:2048
  v_mfma_f32_16x16x32_bf16 v[136:139], v[96:99], v[88:91], v[136:139]
  ds_read_b128 v[40:43], v20 offset:4096
  v_mfma_f32_16x16x32_bf16 v[140:143], v[96:99], v[92:95], v[140:143]
  ds_read_b128 v[44:47], v20 offset:6144
  v_mfma_f32_16x16x32_bf16 v[156:159], v[100:103], v[92:95], v[156:159]
  ds_read_b64_tr_b16 v[48:49], v21 offset:0
  v_mfma_f32_16x16x32_bf16 v[152:155], v[100:103], v[88:91], v[152:155]
  ds_read_b64_tr_b16 v[50:51], v21 offset:2048
  v_mfma_f32_16x16x32_bf16 v[148:151], v[100:103], v[84:87], v[148:151]
  ds_read_b64_tr_b16 v[52:53], v22 offset:0
  v_mfma_f32_16x16x32_bf16 v[144:147], v[100:103], v[80:83], v[144:147]
  ds_read_b64_tr_b16 v[54:55], v22 offset:2048
  v_mfma_f32_16x16x32_bf16 v[160:163], v[104:107], v[80:83], v[160:163]
  ds_read_b64_tr_b16 v[56:57], v21 offset:8192
  v_mfma_f32_16x16x32_bf16 v[164:167], v[104:107], v[84:87], v[164:167]
  ds_read_b64_tr_b16 v[58:59], v21 offset:10240
  v_mfma_f32_16x16x32_bf16 v[168:171], v[104:107], v[88:91], v[168:171]
  ds_read_b64_tr_b16 v[60:61], v22 offset:8192
  v_mfma_f32_16x16x32_bf16 v[172:175], v[104:107], v[92:95], v[172:175]
  ds_read_b64_tr_b16 v[62:63], v22 offset:10240
  v_mfma_f32_16x16x32_bf16 v[188:191], v[108:111], v[92:95], v[188:191]
  ds_read_b64_tr_b16 v[64:65], v21 offset:16384
  v_mfma_f32_16x16x32_bf16 v[184:187], v[108:111], v[88:91], v[184:187]
  ds_read_b64_tr_b16 v[66:67], v21 offset:18432
  v_mfma_f32_16x16x32_bf16 v[180:183], v[108:111], v[84:87], v[180:183]
  ds_read_b64_tr_b16 v[68:69], v22 offset:16384
  v_mfma_f32_16x16x32_bf16 v[176:179], v[108:111], v[80:83], v[176:179]
  ds_read_b64_tr_b16 v[70:71], v22 offset:18432
  v_mfma_f32_16x16x32_bf16 v[192:195], v[112:115], v[80:83], v[192:195]
  ds_read_b64_tr_b16 v[72:73], v23 offset:0
  v_mfma_f32_16x16x32_bf16 v[196:199], v[112:115], v[84:87], v[196:199]
  ds_read_b64_tr_b16 v[74:75], v23 offset:2048
  v_mfma_f32_16x16x32_bf16 v[200:203], v[112:115], v[88:91], v[200:203]
  s_cmp_lg_u32 s79, 0
  s_nop 0
  v_mfma_f32_16x16x32_bf16 v[204:207], v[112:115], v[92:95], v[204:207]
  v_mfma_f32_16x16x32_bf16 v[220:223], v[116:119], v[92:95], v[220:223]
  v_mfma_f32_16x16x32_bf16 v[216:219], v[116:119], v[88:91], v[216:219]
  v_mfma_f32_16x16x32_bf16 v[212:215], v[116:119], v[84:87], v[212:215]
  v_mfma_f32_16x16x32_bf16 v[208:211], v[116:119], v[80:83], v[208:211]
  v_mfma_f32_16x16x32_bf16 v[224:227], v[120:123], v[80:83], v[224:227]
  v_mfma_f32_16x16x32_bf16 v[228:231], v[120:123], v[84:87], v[228:231]
  v_mfma_f32_16x16x32_bf16 v[232:235], v[120:123], v[88:91], v[232:235]
  v_mfma_f32_16x16x32_bf16 v[236:239], v[120:123], v[92:95], v[236:239]
  s_waitcnt lgkmcnt(0)
  s_cbranch_scc1 L_w1_loop
L_w1_lend:
L_w1_exit:
  v_mfma_f32_16x16x32_bf16 v[128:131], v[48:51], v[32:35], v[128:131]
  ds_read_b128 v[80:83], v20 offset:1024
  v_mfma_f32_16x16x32_bf16 v[132:135], v[48:51], v[36:39], v[132:135]
  ds_read_b128 v[84:87], v20 offset:3072
  v_mfma_f32_16x16x32_bf16 v[136:139], v[48:51], v[40:43], v[136:139]
  ds_read_b128 v[88:91], v20 offset:5120
  v_mfma_f32_16x16x32_bf16 v[140:143], v[48:51], v[44:47], v[140:143]
  ds_read_b128 v[92:95], v20 offset:7168
  v_mfma_f32_16x16x32_bf16 v[156:159], v[52:55], v[44:47], v[156:159]
  ds_read_b64_tr_b16 v[96:97], v21 offset:4096
  v_mfma_f32_16x16x32_bf16 v[152:155], v[52:55], v[40:43], v[152:155]
  ds_read_b64_tr_b16 v[98:99], v21 offset:6144
  v_mfma_f32_16x16x32_bf16 v[148:151], v[52:55], v[36:39], v[148:151]
  ds_read_b64_tr_b16 v[100:101], v22 offset:4096
  v_mfma_f32_16x16x32_bf16 v[144:147], v[52:55], v[32:35], v[144:147]
  ds_read_b64_tr_b16 v[102:103], v22 offset:6144
  v_mfma_f32_16x16x32_bf16 v[160:163], v[56:59], v[32:35], v[160:163]
  ds_read_b64_tr_b16 v[104:105], v21 offset:12288
  v_mfma_f32_16x16x32_bf16 v[164:167], v[56:59], v[36:39], v[164:167]
  ds_read_b64_tr_b16 v[106:107], v21 offset:14336
  v_mfma_f32_16x16x32_bf16 v[168:171], v[56:59], v[40:43], v[168:171]
  ds_read_b64_tr_b16 v[108:109], v22 offset:12288
  v_mfma_f32_16x16x32_bf16 v[172:175], v[56:59], v[44:47], v[172:175]
  ds_read_b64_tr_b16 v[110:111], v22 offset:14336
  v_mfma_f32_16x16x32_bf16 v[188:191], v[60:63], v[44:47], v[188:191]
  ds_read_b64_tr_b16 v[112:113], v21 offset:20480
  v_mfma_f32_16x16x32_bf16 v[184:187], v[60:63], v[40:43], v[184:187]
  ds_read_b64_tr_b16 v[114:115], v21 offset:22528
  v_mfma_f32_16x16x32_bf16 v[180:183], v[60:63], v[36:39], v[180:183]
  ds_read_b64_tr_b16 v[116:117], v22 offset:20480
  v_mfma_f32_16x16x32_bf16 v[176:179], v[60:63], v[32:35], v[176:179]
  ds_read_b64_tr_b16 v[118:119], v22 offset:22528
  v_mfma_f32_16x16x32_bf16 v[192:195], v[64:67], v[32:35], v[192:195]
  ds_read_b64_tr_b16 v[120:121], v23 offset:4096
  v_mfma_f32_16x16x32_bf16 v[196:199], v[64:67], v[36:39], v[196:199]
  ds_read_b64_tr_b16 v[122:123], v23 offset:6144
  v_mfma_f32_16x16x32_bf16 v[200:203], v[64:67], v[40:43], v[200:203]
  v_and_b32 v76, -9, v14
  v_mfma_f32_16x16x32_bf16 v[204:207], v[64:67], v[44:47], v[204:207]
  v_mfma_f32_16x16x32_bf16 v[220:223], v[68:71], v[44:47], v[220:223]
  v_mfma_f32_16x16x32_bf16 v[216:219], v[68:71], v[40:43], v[216:219]
  v_mfma_f32_16x16x32_bf16 v[212:215], v[68:71], v[36:39], v[212:215]
  v_mfma_f32_16x16x32_bf16 v[208:211], v[68:71], v[32:35], v[208:211]
  v_mfma_f32_16x16x32_bf16 v[224:227], v[72:75], v[32:35], v[224:227]
  v_mfma_f32_16x16x32_bf16 v[228:231], v[72:75], v[36:39], v[228:231]
  v_mfma_f32_16x16x32_bf16 v[232:235], v[72:75], v[40:43], v[232:235]
  v_mfma_f32_16x16x32_bf16 v[236:239], v[72:75], v[44:47], v[236:239]
  s_waitcnt lgkmcnt(0)
  s_barrier
  v_mfma_f32_16x16x32_bf16 v[128:131], v[96:99], v[80:83], v[128:131]
  ds_read_b64 v[46:47], v14 offset:0
  ds_read_b64 v[32:33], v15 offset:0
  v_mfma_f32_16x16x32_bf16 v[132:135], v[96:99], v[84:87], v[132:135]
  ds_read_b64 v[34:35], v15 offset:256
  ds_read_b128 v[56:59], v76 offset:2048
  v_mfma_f32_16x16x32_bf16 v[136:139], v[96:99], v[88:91], v[136:139]
  ds_read_b32 v17, v17
  ds_read_b64 v[48:49], v14 offset:256
  v_mfma_f32_16x16x32_bf16 v[140:143], v[96:99], v[92:95], v[140:143]
  ds_read_b128 v[60:63], v76 offset:2304
  ds_read_b64 v[50:51], v14 offset:512
  v_mfma_f32_16x16x32_bf16 v[156:159], v[100:103], v[92:95], v[156:159]
  ds_read_b128 v[64:67], v76 offset:2560
  ds_read_b64 v[52:53], v14 offset:768
  v_mfma_f32_16x16x32_bf16 v[152:155], v[100:103], v[88:91], v[152:155]
  ds_read_b128 v[68:71], v76 offset:2816
  ds_read_b64 v[44:45], v16 offset:3072
  v_mfma_f32_16x16x32_bf16 v[148:151], v[100:103], v[84:87], v[148:151]
  ds_read_b64 v[36:37], v15 offset:1024
  ds_read_b64 v[38:39], v15 offset:1280
  v_mfma_f32_16x16x32_bf16 v[144:147], v[100:103], v[80:83], v[144:147]
  ds_read_b64 v[40:41], v15 offset:2048
  ds_read_b64 v[42:43], v15 offset:2304
  v_mfma_f32_16x16x32_bf16 v[160:163], v[104:107], v[80:83], v[160:163]
  v_mfma_f32_16x16x32_bf16 v[164:167], v[104:107], v[84:87], v[164:167]
  buffer_load_dwordx2 v[10:11], v19, s[52:55], 0 offen offset:0
  v_mfma_f32_16x16x32_bf16 v[168:171], v[104:107], v[88:91], v[168:171]
  buffer_load_dwordx2 v[24:25], v19, s[52:55], 0 offen offset:32
  v_mfma_f32_16x16x32_bf16 v[172:175], v[104:107], v[92:95], v[172:175]
  buffer_load_dwordx2 v[124:125], v19, s[52:55], 0 offen offset:64
  v_mfma_f32_16x16x32_bf16 v[188:191], v[108:111], v[92:95], v[188:191]
  buffer_load_dwordx2 v[126:127], v19, s[52:55], 0 offen offset:96
  v_mfma_f32_16x16x32_bf16 v[184:187], v[108:111], v[88:91], v[184:187]
  v_mfma_f32_16x16x32_bf16 v[180:183], v[108:111], v[84:87], v[180:183]
  s_waitcnt lgkmcnt(0)
  v_mfma_f32_16x16x16_bf16 v[128:131], v[32:33], v[46:47], v[128:131]
  v_readfirstlane_b32 s98, v17
  v_mfma_f32_16x16x32_bf16 v[176:179], v[108:111], v[80:83], v[176:179]
  v_mfma_f32_16x16x32_bf16 v[192:195], v[112:115], v[80:83], v[192:195]
  s_cmp_lg_u32 s98, 0
  s_cselect_b32 s98, 34603008, 0
  v_mfma_f32_16x16x32_bf16 v[196:199], v[112:115], v[84:87], v[196:199]
  s_add_u32 s44, s44, s98
  s_addc_u32 s45, s45, 0
  v_mfma_f32_16x16x32_bf16 v[200:203], v[112:115], v[88:91], v[200:203]
  s_add_u32 s36, s36, s98
  s_addc_u32 s37, s37, 0
  v_mfma_f32_16x16x32_bf16 v[204:207], v[112:115], v[92:95], v[204:207]
  s_add_u32 s64, s64, s98
  s_addc_u32 s65, s65, 0
  v_mfma_f32_16x16x32_bf16 v[220:223], v[116:119], v[92:95], v[220:223]
  v_mfma_f32_16x16x32_bf16 v[216:219], v[116:119], v[88:91], v[216:219]
  v_mfma_f32_16x16x32_bf16 v[212:215], v[116:119], v[84:87], v[212:215]
  v_mfma_f32_16x16x32_bf16 v[208:211], v[116:119], v[80:83], v[208:211]
  v_mfma_f32_16x16x32_bf16 v[224:227], v[120:123], v[80:83], v[224:227]
  v_mfma_f32_16x16x32_bf16 v[228:231], v[120:123], v[84:87], v[228:231]
  v_mfma_f32_16x16x32_bf16 v[232:235], v[120:123], v[88:91], v[232:235]
  v_mfma_f32_16x16x32_bf16 v[236:239], v[120:123], v[92:95], v[236:239]
  v_pk_mul_f32 v[100:101], v[128:129], v[128:129]
  v_pk_mul_f32 v[102:103], v[130:131], v[130:131]
  v_pk_fma_f32 v[100:101], v[100:101], v[56:57], v[56:57] op_sel:[0,1,0] op_sel_hi:[1,1,0]
  v_pk_fma_f32 v[102:103], v[102:103], v[56:57], v[56:57] op_sel:[0,1,0] op_sel_hi:[1,1,0]
  v_pk_mul_f32 v[100:101], v[100:101], v[128:129]
  v_pk_mul_f32 v[102:103], v[102:103], v[130:131]
  v_mfma_f32_16x16x16_bf16 v[144:147], v[34:35], v[46:47], v[144:147]
  v_exp_f32 v100, v100
  v_exp_f32 v101, v101
  v_exp_f32 v102, v102
  v_exp_f32 v103, v103
  v_pk_fma_f32 v[100:101], v[100:101], v[58:59], v[58:59] op_sel_hi:[1,0,0]
  v_pk_fma_f32 v[102:103], v[102:103], v[58:59], v[58:59] op_sel_hi:[1,0,0]
  v_rcp_f32 v100, v100
  v_rcp_f32 v101, v101
  v_rcp_f32 v102, v102
  v_rcp_f32 v103, v103
  v_pk_mul_f32 v[128:129], v[128:129], v[100:101]
  v_pk_mul_f32 v[130:131], v[130:131], v[102:103]
  v_cvt_pk_bf16_f32 v108, v128, v129
  v_cvt_pk_bf16_f32 v109, v130, v131
  v_pk_mul_f32 v[104:105], v[144:145], v[144:145]
  v_pk_mul_f32 v[106:107], v[146:147], v[146:147]
  v_pk_fma_f32 v[104:105], v[104:105], v[56:57], v[56:57] op_sel:[0,1,0] op_sel_hi:[1,1,0]
  v_pk_fma_f32 v[106:107], v[106:107], v[56:57], v[56:57] op_sel:[0,1,0] op_sel_hi:[1,1,0]
  v_pk_mul_f32 v[104:105], v[104:105], v[144:145]
  v_pk_mul_f32 v[106:107], v[106:107], v[146:147]
  v_mfma_f32_16x16x16_bf16 v[132:135], v[32:33], v[48:49], v[132:135]
  v_exp_f32 v104, v104
  v_exp_f32 v105, v105
  v_exp_f32 v106, v106
  v_exp_f32 v107, v107
  v_pk_fma_f32 v[104:105], v[104:105], v[58:59], v[58:59] op_sel_hi:[1,0,0]
  v_pk_fma_f32 v[106:107], v[106:107], v[58:59], v[58:59] op_sel_hi:[1,0,0]
  v_rcp_f32 v104, v104
  v_rcp_f32 v105, v105
  v_rcp_f32 v106, v106
  v_rcp_f32 v107, v107
  v_pk_mul_f32 v[144:145], v[144:145], v[104:105]
  v_pk_mul_f32 v[146:147], v[146:147], v[106:107]
  v_cvt_pk_bf16_f32 v110, v144, v145
  v_cvt_pk_bf16_f32 v111, v146, v147
  s_mov_b32 s3, 0
  buffer_store_dwordx4 v[108:111], v12, s[44:47], s3 offen sc1
  ds_write_b128 v18, v[108:111] offset:32768
  v_pk_mul_f32 v[100:101], v[132:133], v[132:133]
  v_pk_mul_f32 v[102:103], v[134:135], v[134:135]
  v_pk_fma_f32 v[100:101], v[100:101], v[60:61], v[60:61] op_sel:[0,1,0] op_sel_hi:[1,1,0]
  v_pk_fma_f32 v[102:103], v[102:103], v[60:61], v[60:61] op_sel:[0,1,0] op_sel_hi:[1,1,0]
  v_pk_mul_f32 v[100:101], v[100:101], v[132:133]
  v_pk_mul_f32 v[102:103], v[102:103], v[134:135]
  v_mfma_f32_16x16x16_bf16 v[148:151], v[34:35], v[48:49], v[148:151]
  v_exp_f32 v100, v100
  v_exp_f32 v101, v101
  v_exp_f32 v102, v102
  v_exp_f32 v103, v103
  v_pk_fma_f32 v[100:101], v[100:101], v[62:63], v[62:63] op_sel_hi:[1,0,0]
  v_pk_fma_f32 v[102:103], v[102:103], v[62:63], v[62:63] op_sel_hi:[1,0,0]
  v_rcp_f32 v100, v100
  v_rcp_f32 v101, v101
  v_rcp_f32 v102, v102
  v_rcp_f32 v103, v103
  v_pk_mul_f32 v[132:133], v[132:133], v[100:101]
  v_pk_mul_f32 v[134:135], v[134:135], v[102:103]
  v_cvt_pk_bf16_f32 v112, v132, v133
  v_cvt_pk_bf16_f32 v113, v134, v135
  v_pk_mul_f32 v[104:105], v[148:149], v[148:149]
  v_pk_mul_f32 v[106:107], v[150:151], v[150:151]
  v_pk_fma_f32 v[104:105], v[104:105], v[60:61], v[60:61] op_sel:[0,1,0] op_sel_hi:[1,1,0]
  v_pk_fma_f32 v[106:107], v[106:107], v[60:61], v[60:61] op_sel:[0,1,0] op_sel_hi:[1,1,0]
  v_pk_mul_f32 v[104:105], v[104:105], v[148:149]
  v_pk_mul_f32 v[106:107], v[106:107], v[150:151]
  v_mfma_f32_16x16x16_bf16 v[136:139], v[32:33], v[50:51], v[136:139]
  v_exp_f32 v104, v104
  v_exp_f32 v105, v105
  v_exp_f32 v106, v106
  v_exp_f32 v107, v107
  v_pk_fma_f32 v[104:105], v[104:105], v[62:63], v[62:63] op_sel_hi:[1,0,0]
  v_pk_fma_f32 v[106:107], v[106:107], v[62:63], v[62:63] op_sel_hi:[1,0,0]
  v_rcp_f32 v104, v104
  v_rcp_f32 v105, v105
  v_rcp_f32 v106, v106
  v_rcp_f32 v107, v107
  v_pk_mul_f32 v[148:149], v[148:149], v[104:105]
  v_pk_mul_f32 v[150:151], v[150:151], v[106:107]
  v_cvt_pk_bf16_f32 v114, v148, v149
  v_cvt_pk_bf16_f32 v115, v150, v151
  s_mov_b32 s3, 114688
  buffer_store_dwordx4 v[112:115], v12, s[44:47], s3 offen sc1
  ds_write_b128 v18, v[112:115] offset:34816
  v_pk_mul_f32 v[100:101], v[136:137], v[136:137]
  v_pk_mul_f32 v[102:103], v[138:139], v[138:139]
  v_pk_fma_f32 v[100:101], v[100:101], v[64:65], v[64:65] op_sel:[0,1,0] op_sel_hi:[1,1,0]
  v_pk_fma_f32 v[102:103], v[102:103], v[64:65], v[64:65] op_sel:[0,1,0] op_sel_hi:[1,1,0]
  v_pk_mul_f32 v[100:101], v[100:101], v[136:137]
  v_pk_mul_f32 v[102:103], v[102:103], v[138:139]
  v_mfma_f32_16x16x16_bf16 v[152:155], v[34:35], v[50:51], v[152:155]
  v_exp_f32 v100, v100
  v_exp_f32 v101, v101
  v_exp_f32 v102, v102
  v_exp_f32 v103, v103
  v_pk_fma_f32 v[100:101], v[100:101], v[66:67], v[66:67] op_sel_hi:[1,0,0]
  v_pk_fma_f32 v[102:103], v[102:103], v[66:67], v[66:67] op_sel_hi:[1,0,0]
  v_rcp_f32 v100, v100
  v_rcp_f32 v101, v101
  v_rcp_f32 v102, v102
  v_rcp_f32 v103, v103
  v_pk_mul_f32 v[136:137], v[136:137], v[100:101]
  v_pk_mul_f32 v[138:139], v[138:139], v[102:103]
  v_cvt_pk_bf16_f32 v116, v136, v137
  v_cvt_pk_bf16_f32 v117, v138, v139
  v_pk_mul_f32 v[104:105], v[152:153], v[152:153]
  v_pk_mul_f32 v[106:107], v[154:155], v[154:155]
  v_pk_fma_f32 v[104:105], v[104:105], v[64:65], v[64:65] op_sel:[0,1,0] op_sel_hi:[1,1,0]
  v_pk_fma_f32 v[106:107], v[106:107], v[64:65], v[64:65] op_sel:[0,1,0] op_sel_hi:[1,1,0]
  v_pk_mul_f32 v[104:105], v[104:105], v[152:153]
  v_pk_mul_f32 v[106:107], v[106:107], v[154:155]
  v_mfma_f32_16x16x16_bf16 v[140:143], v[32:33], v[52:53], v[140:143]
  v_exp_f32 v104, v104
  v_exp_f32 v105, v105
  v_exp_f32 v106, v106
  v_exp_f32 v107, v107
  v_pk_fma_f32 v[104:105], v[104:105], v[66:67], v[66:67] op_sel_hi:[1,0,0]
  v_pk_fma_f32 v[106:107], v[106:107], v[66:67], v[66:67] op_sel_hi:[1,0,0]
  v_rcp_f32 v104, v104
  v_rcp_f32 v105, v105
  v_rcp_f32 v106, v106
  v_rcp_f32 v107, v107
  v_pk_mul_f32 v[152:153], v[152:153], v[104:105]
  v_pk_mul_f32 v[154:155], v[154:155], v[106:107]
  v_cvt_pk_bf16_f32 v118, v152, v153
  v_cvt_pk_bf16_f32 v119, v154, v155
  s_mov_b32 s3, 229376
  buffer_store_dwordx4 v[116:119], v12, s[44:47], s3 offen sc1
  ds_write_b128 v18, v[116:119] offset:36864
  v_pk_mul_f32 v[100:101], v[140:141], v[140:141]
  v_pk_mul_f32 v[102:103], v[142:143], v[142:143]
  v_pk_fma_f32 v[100:101], v[100:101], v[68:69], v[68:69] op_sel:[0,1,0] op_sel_hi:[1,1,0]
  v_pk_fma_f32 v[102:103], v[102:103], v[68:69], v[68:69] op_sel:[0,1,0] op_sel_hi:[1,1,0]
  v_pk_mul_f32 v[100:101], v[100:101], v[140:141]
  v_pk_mul_f32 v[102:103], v[102:103], v[142:143]
  v_mfma_f32_16x16x16_bf16 v[156:159], v[34:35], v[52:53], v[156:159]
  v_exp_f32 v100, v100
  v_exp_f32 v101, v101
  v_exp_f32 v102, v102
  v_exp_f32 v103, v103
  v_pk_fma_f32 v[100:101], v[100:101], v[70:71], v[70:71] op_sel_hi:[1,0,0]
  v_pk_fma_f32 v[102:103], v[102:103], v[70:71], v[70:71] op_sel_hi:[1,0,0]
  v_rcp_f32 v100, v100
  v_rcp_f32 v101, v101
  v_rcp_f32 v102, v102
  v_rcp_f32 v103, v103
  v_pk_mul_f32 v[140:141], v[140:141], v[100:101]
  v_pk_mul_f32 v[142:143], v[142:143], v[102:103]
  v_cvt_pk_bf16_f32 v120, v140, v141
  v_cvt_pk_bf16_f32 v121, v142, v143
  v_pk_mul_f32 v[104:105], v[156:157], v[156:157]
  v_pk_mul_f32 v[106:107], v[158:159], v[158:159]
  v_pk_fma_f32 v[104:105], v[104:105], v[68:69], v[68:69] op_sel:[0,1,0] op_sel_hi:[1,1,0]
  v_pk_fma_f32 v[106:107], v[106:107], v[68:69], v[68:69] op_sel:[0,1,0] op_sel_hi:[1,1,0]
  v_pk_mul_f32 v[104:105], v[104:105], v[156:157]
  v_pk_mul_f32 v[106:107], v[106:107], v[158:159]
  v_mfma_f32_16x16x16_bf16 v[224:227], v[44:45], v[46:47], v[224:227]
  v_exp_f32 v104, v104
  v_exp_f32 v105, v105
  v_exp_f32 v106, v106
  v_exp_f32 v107, v107
  v_pk_fma_f32 v[104:105], v[104:105], v[70:71], v[70:71] op_sel_hi:[1,0,0]
  v_pk_fma_f32 v[106:107], v[106:107], v[70:71], v[70:71] op_sel_hi:[1,0,0]
  v_rcp_f32 v104, v104
  v_rcp_f32 v105, v105
  v_rcp_f32 v106, v106
  v_rcp_f32 v107, v107
  v_pk_mul_f32 v[156:157], v[156:157], v[104:105]
  v_pk_mul_f32 v[158:159], v[158:159], v[106:107]
  v_cvt_pk_bf16_f32 v122, v156, v157
  v_cvt_pk_bf16_f32 v123, v158, v159
  s_mov_b32 s3, 344064
  buffer_store_dwordx4 v[120:123], v12, s[44:47], s3 offen sc1
  ds_write_b128 v18, v[120:123] offset:38912
  v_pk_mul_f32 v[100:101], v[224:225], v[224:225]
  v_pk_mul_f32 v[102:103], v[226:227], v[226:227]
  v_pk_fma_f32 v[100:101], v[100:101], v[56:57], v[56:57] op_sel:[0,1,0] op_sel_hi:[1,1,0]
  v_pk_fma_f32 v[102:103], v[102:103], v[56:57], v[56:57] op_sel:[0,1,0] op_sel_hi:[1,1,0]
  v_pk_mul_f32 v[100:101], v[100:101], v[224:225]
  v_pk_mul_f32 v[102:103], v[102:103], v[226:227]
  v_mfma_f32_16x16x16_bf16 v[228:231], v[44:45], v[48:49], v[228:231]
  v_exp_f32 v100, v100
  v_exp_f32 v101, v101
  v_exp_f32 v102, v102
  v_exp_f32 v103, v103
  v_pk_fma_f32 v[100:101], v[100:101], v[58:59], v[58:59] op_sel_hi:[1,0,0]
  v_pk_fma_f32 v[102:103], v[102:103], v[58:59], v[58:59] op_sel_hi:[1,0,0]
  v_rcp_f32 v100, v100
  v_rcp_f32 v101, v101
  v_rcp_f32 v102, v102
  v_rcp_f32 v103, v103
  v_pk_mul_f32 v[224:225], v[224:225], v[100:101]
  v_pk_mul_f32 v[226:227], v[226:227], v[102:103]
  v_cvt_pk_bf16_f32 v108, v224, v225
  v_cvt_pk_bf16_f32 v109, v226, v227
  v_pk_mul_f32 v[100:101], v[228:229], v[228:229]
  v_pk_mul_f32 v[102:103], v[230:231], v[230:231]
  v_pk_fma_f32 v[100:101], v[100:101], v[60:61], v[60:61] op_sel:[0,1,0] op_sel_hi:[1,1,0]
  v_pk_fma_f32 v[102:103], v[102:103], v[60:61], v[60:61] op_sel:[0,1,0] op_sel_hi:[1,1,0]
  v_pk_mul_f32 v[100:101], v[100:101], v[228:229]
  v_pk_mul_f32 v[102:103], v[102:103], v[230:231]
  v_mfma_f32_16x16x16_bf16 v[232:235], v[44:45], v[50:51], v[232:235]
  v_exp_f32 v100, v100
  v_exp_f32 v101, v101
  v_exp_f32 v102, v102
  v_exp_f32 v103, v103
  v_pk_fma_f32 v[100:101], v[100:101], v[62:63], v[62:63] op_sel_hi:[1,0,0]
  v_pk_fma_f32 v[102:103], v[102:103], v[62:63], v[62:63] op_sel_hi:[1,0,0]
  v_rcp_f32 v100, v100
  v_rcp_f32 v101, v101
  v_rcp_f32 v102, v102
  v_rcp_f32 v103, v103
  v_pk_mul_f32 v[228:229], v[228:229], v[100:101]
  v_pk_mul_f32 v[230:231], v[230:231], v[102:103]
  v_cvt_pk_bf16_f32 v110, v228, v229
  v_cvt_pk_bf16_f32 v111, v230, v231
  s_mov_b32 s3, 32768
  s_nop 0
  v_permlane16_swap_b32 v108, v110
  v_permlane16_swap_b32 v109, v111
  buffer_store_dwordx4 v[108:111], v13, s[44:47], s3 offen sc1
  v_pk_mul_f32 v[100:101], v[232:233], v[232:233]
  v_pk_mul_f32 v[102:103], v[234:235], v[234:235]
  v_pk_fma_f32 v[100:101], v[100:101], v[64:65], v[64:65] op_sel:[0,1,0] op_sel_hi:[1,1,0]
  v_pk_fma_f32 v[102:103], v[102:103], v[64:65], v[64:65] op_sel:[0,1,0] op_sel_hi:[1,1,0]
  v_pk_mul_f32 v[100:101], v[100:101], v[232:233]
  v_pk_mul_f32 v[102:103], v[102:103], v[234:235]
  v_mfma_f32_16x16x16_bf16 v[236:239], v[44:45], v[52:53], v[236:239]
  v_exp_f32 v100, v100
  v_exp_f32 v101, v101
  v_exp_f32 v102, v102
  v_exp_f32 v103, v103
  v_pk_fma_f32 v[100:101], v[100:101], v[66:67], v[66:67] op_sel_hi:[1,0,0]
  v_pk_fma_f32 v[102:103], v[102:103], v[66:67], v[66:67] op_sel_hi:[1,0,0]
  v_rcp_f32 v100, v100
  v_rcp_f32 v101, v101
  v_rcp_f32 v102, v102
  v_rcp_f32 v103, v103
  v_pk_mul_f32 v[232:233], v[232:233], v[100:101]
  v_pk_mul_f32 v[234:235], v[234:235], v[102:103]
  v_cvt_pk_bf16_f32 v112, v232, v233
  v_cvt_pk_bf16_f32 v113, v234, v235
  v_pk_mul_f32 v[100:101], v[236:237], v[236:237]
  v_pk_mul_f32 v[102:103], v[238:239], v[238:239]
  v_pk_fma_f32 v[100:101], v[100:101], v[68:69], v[68:69] op_sel:[0,1,0] op_sel_hi:[1,1,0]
  v_pk_fma_f32 v[102:103], v[102:103], v[68:69], v[68:69] op_sel:[0,1,0] op_sel_hi:[1,1,0]
  v_pk_mul_f32 v[100:101], v[100:101], v[236:237]
  v_pk_mul_f32 v[102:103], v[102:103], v[238:239]
  v_mfma_f32_16x16x16_bf16 v[160:163], v[36:37], v[46:47], v[160:163]
  v_exp_f32 v100, v100
  v_exp_f32 v101, v101
  v_exp_f32 v102, v102
  v_exp_f32 v103, v103
  v_pk_fma_f32 v[100:101], v[100:101], v[70:71], v[70:71] op_sel_hi:[1,0,0]
  v_pk_fma_f32 v[102:103], v[102:103], v[70:71], v[70:71] op_sel_hi:[1,0,0]
  v_rcp_f32 v100, v100
  v_rcp_f32 v101, v101
  v_rcp_f32 v102, v102
  v_rcp_f32 v103, v103
  v_pk_mul_f32 v[236:237], v[236:237], v[100:101]
  v_pk_mul_f32 v[238:239], v[238:239], v[102:103]
  v_cvt_pk_bf16_f32 v114, v236, v237
  v_cvt_pk_bf16_f32 v115, v238, v239
  s_mov_b32 s3, 262144
  s_nop 0
  v_permlane16_swap_b32 v112, v114
  v_permlane16_swap_b32 v113, v115
  buffer_store_dwordx4 v[112:115], v13, s[44:47], s3 offen sc1
  v_pk_mul_f32 v[100:101], v[160:161], v[160:161]
  v_pk_mul_f32 v[102:103], v[162:163], v[162:163]
  v_pk_fma_f32 v[100:101], v[100:101], v[56:57], v[56:57] op_sel:[0,1,0] op_sel_hi:[1,1,0]
  v_pk_fma_f32 v[102:103], v[102:103], v[56:57], v[56:57] op_sel:[0,1,0] op_sel_hi:[1,1,0]
  v_pk_mul_f32 v[100:101], v[100:101], v[160:161]
  v_pk_mul_f32 v[102:103], v[102:103], v[162:163]
  v_mfma_f32_16x16x16_bf16 v[176:179], v[38:39], v[46:47], v[176:179]
  v_exp_f32 v100, v100
  v_exp_f32 v101, v101
  v_exp_f32 v102, v102
  v_exp_f32 v103, v103
  v_pk_fma_f32 v[100:101], v[100:101], v[58:59], v[58:59] op_sel_hi:[1,0,0]
  v_pk_fma_f32 v[102:103], v[102:103], v[58:59], v[58:59] op_sel_hi:[1,0,0]
  v_rcp_f32 v100, v100
  v_rcp_f32 v101, v101
  v_rcp_f32 v102, v102
  v_rcp_f32 v103, v103
  v_pk_mul_f32 v[160:161], v[160:161], v[100:101]
  v_pk_mul_f32 v[162:163], v[162:163], v[102:103]
  v_cvt_pk_bf16_f32 v116, v160, v161
  v_cvt_pk_bf16_f32 v117, v162, v163
  v_pk_mul_f32 v[104:105], v[176:177], v[176:177]
  v_pk_mul_f32 v[106:107], v[178:179], v[178:179]
  v_pk_fma_f32 v[104:105], v[104:105], v[56:57], v[56:57] op_sel:[0,1,0] op_sel_hi:[1,1,0]
  v_pk_fma_f32 v[106:107], v[106:107], v[56:57], v[56:57] op_sel:[0,1,0] op_sel_hi:[1,1,0]
  v_pk_mul_f32 v[104:105], v[104:105], v[176:177]
  v_pk_mul_f32 v[106:107], v[106:107], v[178:179]
  v_mfma_f32_16x16x16_bf16 v[164:167], v[36:37], v[48:49], v[164:167]
  v_exp_f32 v104, v104
  v_exp_f32 v105, v105
  v_exp_f32 v106, v106
  v_exp_f32 v107, v107
  v_pk_fma_f32 v[104:105], v[104:105], v[58:59], v[58:59] op_sel_hi:[1,0,0]
  v_pk_fma_f32 v[106:107], v[106:107], v[58:59], v[58:59] op_sel_hi:[1,0,0]
  v_rcp_f32 v104, v104
  v_rcp_f32 v105, v105
  v_rcp_f32 v106, v106
  v_rcp_f32 v107, v107
  v_pk_mul_f32 v[176:177], v[176:177], v[104:105]
  v_pk_mul_f32 v[178:179], v[178:179], v[106:107]
  v_cvt_pk_bf16_f32 v118, v176, v177
  v_cvt_pk_bf16_f32 v119, v178, v179
  s_add_u32 s3, s10, 49152
  buffer_store_dwordx4 v[116:119], v12, s[44:47], s3 offen sc1
  ds_write_b128 v18, v[116:119] offset:0
  v_pk_mul_f32 v[100:101], v[164:165], v[164:165]
  v_pk_mul_f32 v[102:103], v[166:167], v[166:167]
  v_pk_fma_f32 v[100:101], v[100:101], v[60:61], v[60:61] op_sel:[0,1,0] op_sel_hi:[1,1,0]
  v_pk_fma_f32 v[102:103], v[102:103], v[60:61], v[60:61] op_sel:[0,1,0] op_sel_hi:[1,1,0]
  v_pk_mul_f32 v[100:101], v[100:101], v[164:165]
  v_pk_mul_f32 v[102:103], v[102:103], v[166:167]
  v_mfma_f32_16x16x16_bf16 v[180:183], v[38:39], v[48:49], v[180:183]
  v_exp_f32 v100, v100
  v_exp_f32 v101, v101
  v_exp_f32 v102, v102
  v_exp_f32 v103, v103
  v_pk_fma_f32 v[100:101], v[100:101], v[62:63], v[62:63] op_sel_hi:[1,0,0]
  v_pk_fma_f32 v[102:103], v[102:103], v[62:63], v[62:63] op_sel_hi:[1,0,0]
  v_rcp_f32 v100, v100
  v_rcp_f32 v101, v101
  v_rcp_f32 v102, v102
  v_rcp_f32 v103, v103
  v_pk_mul_f32 v[164:165], v[164:165], v[100:101]
  v_pk_mul_f32 v[166:167], v[166:167], v[102:103]
  v_cvt_pk_bf16_f32 v120, v164, v165
  v_cvt_pk_bf16_f32 v121, v166, v167
  v_pk_mul_f32 v[104:105], v[180:181], v[180:181]
  v_pk_mul_f32 v[106:107], v[182:183], v[182:183]
  v_pk_fma_f32 v[104:105], v[104:105], v[60:61], v[60:61] op_sel:[0,1,0] op_sel_hi:[1,1,0]
  v_pk_fma_f32 v[106:107], v[106:107], v[60:61], v[60:61] op_sel:[0,1,0] op_sel_hi:[1,1,0]
  v_pk_mul_f32 v[104:105], v[104:105], v[180:181]
  v_pk_mul_f32 v[106:107], v[106:107], v[182:183]
  v_mfma_f32_16x16x16_bf16 v[168:171], v[36:37], v[50:51], v[168:171]
  v_exp_f32 v104, v104
  v_exp_f32 v105, v105
  v_exp_f32 v106, v106
  v_exp_f32 v107, v107
  v_pk_fma_f32 v[104:105], v[104:105], v[62:63], v[62:63] op_sel_hi:[1,0,0]
  v_pk_fma_f32 v[106:107], v[106:107], v[62:63], v[62:63] op_sel_hi:[1,0,0]
  v_rcp_f32 v104, v104
  v_rcp_f32 v105, v105
  v_rcp_f32 v106, v106
  v_rcp_f32 v107, v107
  v_pk_mul_f32 v[180:181], v[180:181], v[104:105]
  v_pk_mul_f32 v[182:183], v[182:183], v[106:107]
  v_cvt_pk_bf16_f32 v122, v180, v181
  v_cvt_pk_bf16_f32 v123, v182, v183
  s_add_u32 s3, s10, 163840
  buffer_store_dwordx4 v[120:123], v12, s[44:47], s3 offen sc1
  ds_write_b128 v18, v[120:123] offset:2048
  v_pk_mul_f32 v[100:101], v[168:169], v[168:169]
  v_pk_mul_f32 v[102:103], v[170:171], v[170:171]
  v_pk_fma_f32 v[100:101], v[100:101], v[64:65], v[64:65] op_sel:[0,1,0] op_sel_hi:[1,1,0]
  v_pk_fma_f32 v[102:103], v[102:103], v[64:65], v[64:65] op_sel:[0,1,0] op_sel_hi:[1,1,0]
  v_pk_mul_f32 v[100:101], v[100:101], v[168:169]
  v_pk_mul_f32 v[102:103], v[102:103], v[170:171]
  v_mfma_f32_16x16x16_bf16 v[184:187], v[38:39], v[50:51], v[184:187]
  v_exp_f32 v100, v100
  v_exp_f32 v101, v101
  v_exp_f32 v102, v102
  v_exp_f32 v103, v103
  v_pk_fma_f32 v[100:101], v[100:101], v[66:67], v[66:67] op_sel_hi:[1,0,0]
  v_pk_fma_f32 v[102:103], v[102:103], v[66:67], v[66:67] op_sel_hi:[1,0,0]
  v_rcp_f32 v100, v100
  v_rcp_f32 v101, v101
  v_rcp_f32 v102, v102
  v_rcp_f32 v103, v103
  v_pk_mul_f32 v[168:169], v[168:169], v[100:101]
  v_pk_mul_f32 v[170:171], v[170:171], v[102:103]
  v_cvt_pk_bf16_f32 v108, v168, v169
  v_cvt_pk_bf16_f32 v109, v170, v171
  v_pk_mul_f32 v[104:105], v[184:185], v[184:185]
  v_pk_mul_f32 v[106:107], v[186:187], v[186:187]
  v_pk_fma_f32 v[104:105], v[104:105], v[64:65], v[64:65] op_sel:[0,1,0] op_sel_hi:[1,1,0]
  v_pk_fma_f32 v[106:107], v[106:107], v[64:65], v[64:65] op_sel:[0,1,0] op_sel_hi:[1,1,0]
  v_pk_mul_f32 v[104:105], v[104:105], v[184:185]
  v_pk_mul_f32 v[106:107], v[106:107], v[186:187]
  v_mfma_f32_16x16x16_bf16 v[172:175], v[36:37], v[52:53], v[172:175]
  v_exp_f32 v104, v104
  v_exp_f32 v105, v105
  v_exp_f32 v106, v106
  v_exp_f32 v107, v107
  v_pk_fma_f32 v[104:105], v[104:105], v[66:67], v[66:67] op_sel_hi:[1,0,0]
  v_pk_fma_f32 v[106:107], v[106:107], v[66:67], v[66:67] op_sel_hi:[1,0,0]
  v_rcp_f32 v104, v104
  v_rcp_f32 v105, v105
  v_rcp_f32 v106, v106
  v_rcp_f32 v107, v107
  v_pk_mul_f32 v[184:185], v[184:185], v[104:105]
  v_pk_mul_f32 v[186:187], v[186:187], v[106:107]
  v_cvt_pk_bf16_f32 v110, v184, v185
  v_cvt_pk_bf16_f32 v111, v186, v187
  s_add_u32 s3, s10, 278528
  buffer_store_dwordx4 v[108:111], v12, s[44:47], s3 offen sc1
  ds_write_b128 v18, v[108:111] offset:4096
  v_pk_mul_f32 v[100:101], v[172:173], v[172:173]
  v_pk_mul_f32 v[102:103], v[174:175], v[174:175]
  v_pk_fma_f32 v[100:101], v[100:101], v[68:69], v[68:69] op_sel:[0,1,0] op_sel_hi:[1,1,0]
  v_pk_fma_f32 v[102:103], v[102:103], v[68:69], v[68:69] op_sel:[0,1,0] op_sel_hi:[1,1,0]
  v_pk_mul_f32 v[100:101], v[100:101], v[172:173]
  v_pk_mul_f32 v[102:103], v[102:103], v[174:175]
  v_mfma_f32_16x16x16_bf16 v[188:191], v[38:39], v[52:53], v[188:191]
  v_exp_f32 v100, v100
  v_exp_f32 v101, v101
  v_exp_f32 v102, v102
  v_exp_f32 v103, v103
  v_pk_fma_f32 v[100:101], v[100:101], v[70:71], v[70:71] op_sel_hi:[1,0,0]
  v_pk_fma_f32 v[102:103], v[102:103], v[70:71], v[70:71] op_sel_hi:[1,0,0]
  v_rcp_f32 v100, v100
  v_rcp_f32 v101, v101
  v_rcp_f32 v102, v102
  v_rcp_f32 v103, v103
  v_pk_mul_f32 v[172:173], v[172:173], v[100:101]
  v_pk_mul_f32 v[174:175], v[174:175], v[102:103]
  v_cvt_pk_bf16_f32 v112, v172, v173
  v_cvt_pk_bf16_f32 v113, v174, v175
  v_pk_mul_f32 v[104:105], v[188:189], v[188:189]
  v_pk_mul_f32 v[106:107], v[190:191], v[190:191]
  v_pk_fma_f32 v[104:105], v[104:105], v[68:69], v[68:69] op_sel:[0,1,0] op_sel_hi:[1,1,0]
  v_pk_fma_f32 v[106:107], v[106:107], v[68:69], v[68:69] op_sel:[0,1,0] op_sel_hi:[1,1,0]
  v_pk_mul_f32 v[104:105], v[104:105], v[188:189]
  v_pk_mul_f32 v[106:107], v[106:107], v[190:191]
  v_mfma_f32_16x16x16_bf16 v[192:195], v[40:41], v[46:47], v[192:195]
  v_exp_f32 v104, v104
  v_exp_f32 v105, v105
  v_exp_f32 v106, v106
  v_exp_f32 v107, v107
  v_pk_fma_f32 v[104:105], v[104:105], v[70:71], v[70:71] op_sel_hi:[1,0,0]
  v_pk_fma_f32 v[106:107], v[106:107], v[70:71], v[70:71] op_sel_hi:[1,0,0]
  v_rcp_f32 v104, v104
  v_rcp_f32 v105, v105
  v_rcp_f32 v106, v106
  v_rcp_f32 v107, v107
  v_pk_mul_f32 v[188:189], v[188:189], v[104:105]
  v_pk_mul_f32 v[190:191], v[190:191], v[106:107]
  v_cvt_pk_bf16_f32 v114, v188, v189
  v_cvt_pk_bf16_f32 v115, v190, v191
  s_add_u32 s3, s10, 393216
  buffer_store_dwordx4 v[112:115], v12, s[44:47], s3 offen sc1
  ds_write_b128 v18, v[112:115] offset:6144
  v_pk_mul_f32 v[100:101], v[192:193], v[192:193]
  v_pk_mul_f32 v[102:103], v[194:195], v[194:195]
  v_pk_fma_f32 v[100:101], v[100:101], v[56:57], v[56:57] op_sel:[0,1,0] op_sel_hi:[1,1,0]
  v_pk_fma_f32 v[102:103], v[102:103], v[56:57], v[56:57] op_sel:[0,1,0] op_sel_hi:[1,1,0]
  v_pk_mul_f32 v[100:101], v[100:101], v[192:193]
  v_pk_mul_f32 v[102:103], v[102:103], v[194:195]
  v_mfma_f32_16x16x16_bf16 v[208:211], v[42:43], v[46:47], v[208:211]
  v_exp_f32 v100, v100
  v_exp_f32 v101, v101
  v_exp_f32 v102, v102
  v_exp_f32 v103, v103
  v_pk_fma_f32 v[100:101], v[100:101], v[58:59], v[58:59] op_sel_hi:[1,0,0]
  v_pk_fma_f32 v[102:103], v[102:103], v[58:59], v[58:59] op_sel_hi:[1,0,0]
  v_rcp_f32 v100, v100
  v_rcp_f32 v101, v101
  v_rcp_f32 v102, v102
  v_rcp_f32 v103, v103
  v_pk_mul_f32 v[192:193], v[192:193], v[100:101]
  v_pk_mul_f32 v[194:195], v[194:195], v[102:103]
  v_cvt_pk_bf16_f32 v116, v192, v193
  v_cvt_pk_bf16_f32 v117, v194, v195
  v_pk_mul_f32 v[104:105], v[208:209], v[208:209]
  v_pk_mul_f32 v[106:107], v[210:211], v[210:211]
  v_pk_fma_f32 v[104:105], v[104:105], v[56:57], v[56:57] op_sel:[0,1,0] op_sel_hi:[1,1,0]
  v_pk_fma_f32 v[106:107], v[106:107], v[56:57], v[56:57] op_sel:[0,1,0] op_sel_hi:[1,1,0]
  v_pk_mul_f32 v[104:105], v[104:105], v[208:209]
  v_pk_mul_f32 v[106:107], v[106:107], v[210:211]
  v_mfma_f32_16x16x16_bf16 v[196:199], v[40:41], v[48:49], v[196:199]
  v_exp_f32 v104, v104
  v_exp_f32 v105, v105
  v_exp_f32 v106, v106
  v_exp_f32 v107, v107
  v_pk_fma_f32 v[104:105], v[104:105], v[58:59], v[58:59] op_sel_hi:[1,0,0]
  v_pk_fma_f32 v[106:107], v[106:107], v[58:59], v[58:59] op_sel_hi:[1,0,0]
  v_rcp_f32 v104, v104
  v_rcp_f32 v105, v105
  v_rcp_f32 v106, v106
  v_rcp_f32 v107, v107
  v_pk_mul_f32 v[208:209], v[208:209], v[104:105]
  v_pk_mul_f32 v[210:211], v[210:211], v[106:107]
  v_cvt_pk_bf16_f32 v118, v208, v209
  v_cvt_pk_bf16_f32 v119, v210, v211
  s_add_u32 s3, s10, 51200
  buffer_store_dwordx4 v[116:119], v12, s[44:47], s3 offen
  ds_write_b128 v18, v[116:119] offset:16384
  v_pk_mul_f32 v[100:101], v[196:197], v[196:197]
  v_pk_mul_f32 v[102:103], v[198:199], v[198:199]
  v_pk_fma_f32 v[100:101], v[100:101], v[60:61], v[60:61] op_sel:[0,1,0] op_sel_hi:[1,1,0]
  v_pk_fma_f32 v[102:103], v[102:103], v[60:61], v[60:61] op_sel:[0,1,0] op_sel_hi:[1,1,0]
  v_pk_mul_f32 v[100:101], v[100:101], v[196:197]
  v_pk_mul_f32 v[102:103], v[102:103], v[198:199]
  v_mfma_f32_16x16x16_bf16 v[212:215], v[42:43], v[48:49], v[212:215]
  v_exp_f32 v100, v100
  v_exp_f32 v101, v101
  v_exp_f32 v102, v102
  v_exp_f32 v103, v103
  v_pk_fma_f32 v[100:101], v[100:101], v[62:63], v[62:63] op_sel_hi:[1,0,0]
  v_pk_fma_f32 v[102:103], v[102:103], v[62:63], v[62:63] op_sel_hi:[1,0,0]
  v_rcp_f32 v100, v100
  v_rcp_f32 v101, v101
  v_rcp_f32 v102, v102
  v_rcp_f32 v103, v103
  v_pk_mul_f32 v[196:197], v[196:197], v[100:101]
  v_pk_mul_f32 v[198:199], v[198:199], v[102:103]
  v_cvt_pk_bf16_f32 v120, v196, v197
  v_cvt_pk_bf16_f32 v121, v198, v199
  v_pk_mul_f32 v[104:105], v[212:213], v[212:213]
  v_pk_mul_f32 v[106:107], v[214:215], v[214:215]
  v_pk_fma_f32 v[104:105], v[104:105], v[60:61], v[60:61] op_sel:[0,1,0] op_sel_hi:[1,1,0]
  v_pk_fma_f32 v[106:107], v[106:107], v[60:61], v[60:61] op_sel:[0,1,0] op_sel_hi:[1,1,0]
  v_pk_mul_f32 v[104:105], v[104:105], v[212:213]
  v_pk_mul_f32 v[106:107], v[106:107], v[214:215]
  v_mfma_f32_16x16x16_bf16 v[200:203], v[40:41], v[50:51], v[200:203]
  v_exp_f32 v104, v104
  v_exp_f32 v105, v105
  v_exp_f32 v106, v106
  v_exp_f32 v107, v107
  v_pk_fma_f32 v[104:105], v[104:105], v[62:63], v[62:63] op_sel_hi:[1,0,0]
  v_pk_fma_f32 v[106:107], v[106:107], v[62:63], v[62:63] op_sel_hi:[1,0,0]
  v_rcp_f32 v104, v104
  v_rcp_f32 v105, v105
  v_rcp_f32 v106, v106
  v_rcp_f32 v107, v107
  v_pk_mul_f32 v[212:213], v[212:213], v[104:105]
  v_pk_mul_f32 v[214:215], v[214:215], v[106:107]
  v_cvt_pk_bf16_f32 v122, v212, v213
  v_cvt_pk_bf16_f32 v123, v214, v215
  s_add_u32 s3, s10, 165888
  buffer_store_dwordx4 v[120:123], v12, s[44:47], s3 offen
  ds_write_b128 v18, v[120:123] offset:18432
  v_pk_mul_f32 v[100:101], v[200:201], v[200:201]
  v_pk_mul_f32 v[102:103], v[202:203], v[202:203]
  v_pk_fma_f32 v[100:101], v[100:101], v[64:65], v[64:65] op_sel:[0,1,0] op_sel_hi:[1,1,0]
  v_pk_fma_f32 v[102:103], v[102:103], v[64:65], v[64:65] op_sel:[0,1,0] op_sel_hi:[1,1,0]
  v_pk_mul_f32 v[100:101], v[100:101], v[200:201]
  v_pk_mul_f32 v[102:103], v[102:103], v[202:203]
  v_mfma_f32_16x16x16_bf16 v[216:219], v[42:43], v[50:51], v[216:219]
  v_exp_f32 v100, v100
  v_exp_f32 v101, v101
  v_exp_f32 v102, v102
  v_exp_f32 v103, v103
  v_pk_fma_f32 v[100:101], v[100:101], v[66:67], v[66:67] op_sel_hi:[1,0,0]
  v_pk_fma_f32 v[102:103], v[102:103], v[66:67], v[66:67] op_sel_hi:[1,0,0]
  v_rcp_f32 v100, v100
  v_rcp_f32 v101, v101
  v_rcp_f32 v102, v102
  v_rcp_f32 v103, v103
  v_pk_mul_f32 v[200:201], v[200:201], v[100:101]
  v_pk_mul_f32 v[202:203], v[202:203], v[102:103]
  v_cvt_pk_bf16_f32 v108, v200, v201
  v_cvt_pk_bf16_f32 v109, v202, v203
  v_pk_mul_f32 v[104:105], v[216:217], v[216:217]
  v_pk_mul_f32 v[106:107], v[218:219], v[218:219]
  v_pk_fma_f32 v[104:105], v[104:105], v[64:65], v[64:65] op_sel:[0,1,0] op_sel_hi:[1,1,0]
  v_pk_fma_f32 v[106:107], v[106:107], v[64:65], v[64:65] op_sel:[0,1,0] op_sel_hi:[1,1,0]
  v_pk_mul_f32 v[104:105], v[104:105], v[216:217]
  v_pk_mul_f32 v[106:107], v[106:107], v[218:219]
  v_mfma_f32_16x16x16_bf16 v[204:207], v[40:41], v[52:53], v[204:207]
  v_exp_f32 v104, v104
  v_exp_f32 v105, v105
  v_exp_f32 v106, v106
  v_exp_f32 v107, v107
  v_pk_fma_f32 v[104:105], v[104:105], v[66:67], v[66:67] op_sel_hi:[1,0,0]
  v_pk_fma_f32 v[106:107], v[106:107], v[66:67], v[66:67] op_sel_hi:[1,0,0]
  v_rcp_f32 v104, v104
  v_rcp_f32 v105, v105
  v_rcp_f32 v106, v106
  v_rcp_f32 v107, v107
  v_pk_mul_f32 v[216:217], v[216:217], v[104:105]
  v_pk_mul_f32 v[218:219], v[218:219], v[106:107]
  v_cvt_pk_bf16_f32 v110, v216, v217
  v_cvt_pk_bf16_f32 v111, v218, v219
  s_add_u32 s3, s10, 280576
  buffer_store_dwordx4 v[108:111], v12, s[44:47], s3 offen
  ds_write_b128 v18, v[108:111] offset:20480
  v_pk_mul_f32 v[100:101], v[204:205], v[204:205]
  v_pk_mul_f32 v[102:103], v[206:207], v[206:207]
  v_pk_fma_f32 v[100:101], v[100:101], v[68:69], v[68:69] op_sel:[0,1,0] op_sel_hi:[1,1,0]
  v_pk_fma_f32 v[102:103], v[102:103], v[68:69], v[68:69] op_sel:[0,1,0] op_sel_hi:[1,1,0]
  v_pk_mul_f32 v[100:101], v[100:101], v[204:205]
  v_pk_mul_f32 v[102:103], v[102:103], v[206:207]
  v_mfma_f32_16x16x16_bf16 v[220:223], v[42:43], v[52:53], v[220:223]
  v_exp_f32 v100, v100
  v_exp_f32 v101, v101
  v_exp_f32 v102, v102
  v_exp_f32 v103, v103
  v_pk_fma_f32 v[100:101], v[100:101], v[70:71], v[70:71] op_sel_hi:[1,0,0]
  v_pk_fma_f32 v[102:103], v[102:103], v[70:71], v[70:71] op_sel_hi:[1,0,0]
  v_rcp_f32 v100, v100
  v_rcp_f32 v101, v101
  v_rcp_f32 v102, v102
  v_rcp_f32 v103, v103
  v_pk_mul_f32 v[204:205], v[204:205], v[100:101]
  v_pk_mul_f32 v[206:207], v[206:207], v[102:103]
  v_cvt_pk_bf16_f32 v112, v204, v205
  v_cvt_pk_bf16_f32 v113, v206, v207
  v_pk_mul_f32 v[104:105], v[220:221], v[220:221]
  v_pk_mul_f32 v[106:107], v[222:223], v[222:223]
  v_pk_fma_f32 v[104:105], v[104:105], v[68:69], v[68:69] op_sel:[0,1,0] op_sel_hi:[1,1,0]
  v_pk_fma_f32 v[106:107], v[106:107], v[68:69], v[68:69] op_sel:[0,1,0] op_sel_hi:[1,1,0]
  v_pk_mul_f32 v[104:105], v[104:105], v[220:221]
  v_pk_mul_f32 v[106:107], v[106:107], v[222:223]
  v_exp_f32 v104, v104
  v_exp_f32 v105, v105
  v_exp_f32 v106, v106
  v_exp_f32 v107, v107
  v_pk_fma_f32 v[104:105], v[104:105], v[70:71], v[70:71] op_sel_hi:[1,0,0]
  v_pk_fma_f32 v[106:107], v[106:107], v[70:71], v[70:71] op_sel_hi:[1,0,0]
  v_rcp_f32 v104, v104
  v_rcp_f32 v105, v105
  v_rcp_f32 v106, v106
  v_rcp_f32 v107, v107
  v_pk_mul_f32 v[220:221], v[220:221], v[104:105]
  v_pk_mul_f32 v[222:223], v[222:223], v[106:107]
  v_cvt_pk_bf16_f32 v114, v220, v221
  v_cvt_pk_bf16_f32 v115, v222, v223
  s_add_u32 s3, s10, 395264
  buffer_store_dwordx4 v[112:115], v12, s[44:47], s3 offen
  ds_write_b128 v18, v[112:115] offset:22528
  v_add_u32 v2, 114688, v27
  v_mov_b32 v6, v8
  v_xor_b32 v7, 32, v8
  v_xor_b32 v9, 96, v8
  v_xor_b32 v8, 64, v8
  s_waitcnt vmcnt(14)
  v_lshlrev_b32 v216, 16, v10
  v_and_b32 v217, s11, v10
  v_lshlrev_b32 v218, 16, v11
  v_and_b32 v219, s11, v11
  v_lshlrev_b32 v96, 16, v240
  v_and_b32 v97, s11, v240
  v_pk_add_f32 v[96:97], v[96:97], v[216:217]
  v_lshlrev_b32 v98, 16, v241
  v_and_b32 v99, s11, v241
  v_pk_add_f32 v[98:99], v[98:99], v[218:219]
  v_lshlrev_b32 v100, 16, v248
  v_and_b32 v101, s11, v248
  v_pk_add_f32 v[100:101], v[100:101], v[216:217]
  v_lshlrev_b32 v102, 16, v249
  v_and_b32 v103, s11, v249
  v_pk_add_f32 v[102:103], v[102:103], v[218:219]
  v_lshlrev_b32 v216, 16, v24
  v_and_b32 v217, s11, v24
  v_lshlrev_b32 v218, 16, v25
  v_and_b32 v219, s11, v25
  v_lshlrev_b32 v104, 16, v242
  v_and_b32 v105, s11, v242
  v_pk_add_f32 v[104:105], v[104:105], v[216:217]
  v_lshlrev_b32 v106, 16, v243
  v_and_b32 v107, s11, v243
  v_pk_add_f32 v[106:107], v[106:107], v[218:219]
  v_lshlrev_b32 v108, 16, v250
  v_and_b32 v109, s11, v250
  v_pk_add_f32 v[108:109], v[108:109], v[216:217]
  v_lshlrev_b32 v110, 16, v251
  v_and_b32 v111, s11, v251
  v_pk_add_f32 v[110:111], v[110:111], v[218:219]
  v_lshlrev_b32 v216, 16, v124
  v_and_b32 v217, s11, v124
  v_lshlrev_b32 v218, 16, v125
  v_and_b32 v219, s11, v125
  v_lshlrev_b32 v112, 16, v244
  v_and_b32 v113, s11, v244
  v_pk_add_f32 v[112:113], v[112:113], v[216:217]
  v_lshlrev_b32 v114, 16, v245
  v_and_b32 v115, s11, v245
  v_pk_add_f32 v[114:115], v[114:115], v[218:219]
  v_lshlrev_b32 v116, 16, v252
  v_and_b32 v117, s11, v252
  v_pk_add_f32 v[116:117], v[116:117], v[216:217]
  v_lshlrev_b32 v118, 16, v253
  v_and_b32 v119, s11, v253
  v_pk_add_f32 v[118:119], v[118:119], v[218:219]
  v_lshlrev_b32 v216, 16, v126
  v_and_b32 v217, s11, v126
  v_lshlrev_b32 v218, 16, v127
  v_and_b32 v219, s11, v127
  v_lshlrev_b32 v120, 16, v246
  v_and_b32 v121, s11, v246
  v_pk_add_f32 v[120:121], v[120:121], v[216:217]
  v_lshlrev_b32 v122, 16, v247
  v_and_b32 v123, s11, v247
  v_pk_add_f32 v[122:123], v[122:123], v[218:219]
  v_lshlrev_b32 v124, 16, v254
  v_and_b32 v125, s11, v254
  v_pk_add_f32 v[124:125], v[124:125], v[216:217]
  v_lshlrev_b32 v126, 16, v255
  v_and_b32 v127, s11, v255
  v_pk_add_f32 v[126:127], v[126:127], v[218:219]
  s_waitcnt vmcnt(0) lgkmcnt(0)
  s_barrier
  s_add_u32 s97, s97, 1
  s_branch L_w2_compute
L_w1_c1:
L_w2_c0:
L_w2_body:
  s_cmp_ge_u32 s2, 256
  s_cbranch_scc1 L_w2_end
  v_lshrrev_b32 v2, 6, v0
  v_and_b32 v1, 63, v0
  v_readfirstlane_b32 s70, v2
  s_and_b32 s3, s2, 7
  s_lshr_b32 s99, s2, 3
  s_and_b32 s5, s3, 3
  s_lshl_b32 s5, s5, 2
  s_and_b32 s6, s99, 3
  s_add_u32 s68, s5, s6
  s_lshr_b32 s5, s3, 2
  s_lshr_b32 s78, s99, 2
  s_lshl1_add_u32 s69, s78, s5
  s_add_u32 s3, s68, s78
  s_lshl_b32 s3, s3, 3
  s_lshl_b32 s85, 0xffff02, s3
  s_sub_u32 s3, 0, s3
  s_lshr_b32 s3, 0xffff02, s3
  s_or_b32 s85, s85, s3
L_w2_loader:
  s_add_u32 s3, s68, s78
  s_and_b32 s3, s3, 3
  s_mov_b32 s4, 0x1616160
  s_cmp_eq_u32 s3, 1
  s_cselect_b32 s4, 0x5858580, s4
  s_cmp_eq_u32 s3, 2
  s_cselect_b32 s4, 0x16161600, s4
  s_cmp_eq_u32 s3, 3
  s_cselect_b32 s4, 0x58585800, s4
  v_subrev_u32 v2, 3, v1
  v_min_u32 v2, 16, v2
  v_lshlrev_b32 v3, 1, v2
  v_bfe_i32 v16, s4, v3, 2
  v_sub_u32 v16, v1, v16
  v_subrev_u32 v16, 7, v16
  v_ashrrev_i32 v3, 1, v16
  v_cmp_eq_u32 vcc, s78, v3
  s_and_b32 s3, s69, 1
  v_or_b32 v2, 14, v16
  v_cndmask_b32 v2, v16, v2, vcc
  v_cmp_gt_i32 vcc, 0, v16
  s_lshl2_add_u32 s4, s3, 20
  v_add_u32 v16, s4, v16
  s_lshl4_add_u32 s4, s3, 24
  v_add_u32 v2, s4, v2
  v_cndmask_b32 v16, v2, v16, vcc
  s_and_b32 s5, s68, 3
  s_mul_i32 s5, s5, 3
  s_sub_u32 s5, s5, 23
  v_add_u32 v3, s5, v1
  v_subrev_u32 v2, 10, v3
  v_min_u32 v3, v3, v2
  v_subrev_u32 v2, 10, v3
  v_min_u32 v3, v3, v2
  v_cmp_gt_u32 vcc, 23, v1
  s_sub_u32 s5, s3, 46
  v_lshl_add_u32 v2, v1, 1, s5
  v_cndmask_b32 v3, v3, v2, vcc
  s_add_u32 s5, s78, 3
  v_ashrrev_i32 v2, 1, v3
  v_add_u32 v2, s5, v2
  v_and_b32 v2, 7, v2
  v_and_b32 v3, 1, v3
  v_cmp_gt_u32 vcc, 21, v1
  v_lshl_add_u32 v3, v3, 3, v2
  s_lshl1_add_u32 s4, s78, s4
  s_lshl3_add_u32 s3, s3, s78
  v_cndmask_b32 v3, v3, v16, vcc
  v_writelane_b32 v3, s4, 0
  s_add_u32 s4, s4, 1
  v_writelane_b32 v3, s3, 2
  v_writelane_b32 v3, s4, 1
  v_lshlrev_b32 v16, 17, v3
  s_add_u32 s9, s70, s68
  s_and_b32 s9, s9, 3
  s_lshl_b32 s77, s9, 11
  v_and_b32 v10, 7, v1
  v_lshrrev_b32 v3, 3, v1
  s_lshl_b32 s10, s9, 4
  v_add_u32 v3, s10, v3
  v_mul_u32_u24 v3, 2048, v3
  v_lshrrev_b32 v2, 3, v1
  v_and_b32 v2, 6, v2
  v_xor_b32 v2, v2, v10
  s_lshl_b32 s10, s69, 7
  v_add_u32 v3, s10, v3
  v_lshl_add_u32 v8, v2, 4, v3
  v_add_u32 v3, 16384, v3
  v_lshl_add_u32 v9, v2, 4, v3
  s_mov_b32 s40, s28
  s_and_b32 s41, s29, 0xffff
  s_mov_b32 s42, 7340032
  s_mov_b32 s43, 0x00020000
  s_bitcmp1_b32 s69, 0
  s_mov_b32 s76, 128
  s_cselect_b32 s76, -128, s76
  v_readlane_b32 s74, v16, 0
  s_add_u32 m0, s77, 0
  s_add_u32 s4, s74, s76
  buffer_load_dwordx4 v8, s[40:43], s4 offen lds
  s_add_u32 m0, s77, 1024
  s_nop 0
  buffer_load_dwordx4 v9, s[40:43], s4 offen lds
  s_add_u32 m0, s77, 8192
  s_add_u32 s4, s74, 0
  buffer_load_dwordx4 v8, s[40:43], s4 offen lds
  s_add_u32 m0, s77, 9216
  s_nop 0
  buffer_load_dwordx4 v9, s[40:43], s4 offen lds
  v_readlane_b32 s74, v16, 1
  s_add_u32 m0, s77, 16384
  s_add_u32 s4, s74, s76
  buffer_load_dwordx4 v8, s[40:43], s4 offen lds
  s_add_u32 m0, s77, 17408
  s_nop 0
  buffer_load_dwordx4 v9, s[40:43], s4 offen lds
  s_add_u32 m0, s77, 24576
  s_add_u32 s4, s74, 0
  buffer_load_dwordx4 v8, s[40:43], s4 offen lds
  s_add_u32 m0, s77, 25600
  s_nop 0
  buffer_load_dwordx4 v9, s[40:43], s4 offen lds
  v_readlane_b32 s74, v16, 2
  s_add_u32 m0, s77, 32768
  s_add_u32 s4, s74, s76
  buffer_load_dwordx4 v8, s[40:43], s4 offen lds
  s_add_u32 m0, s77, 33792
  s_nop 0
  buffer_load_dwordx4 v9, s[40:43], s4 offen lds
  s_add_u32 m0, s77, 40960
  s_add_u32 s4, s74, 0
  buffer_load_dwordx4 v8, s[40:43], s4 offen lds
  s_add_u32 m0, s77, 41984
  s_nop 0
  buffer_load_dwordx4 v9, s[40:43], s4 offen lds
  v_readlane_b32 s74, v16, 3
  s_add_u32 m0, s77, 49152
  s_add_u32 s4, s74, s76
  buffer_load_dwordx4 v8, s[40:43], s4 offen lds
  s_add_u32 m0, s77, 50176
  s_nop 0
  buffer_load_dwordx4 v9, s[40:43], s4 offen lds
  s_add_u32 m0, s77, 57344
  s_add_u32 s4, s74, 0
  buffer_load_dwordx4 v8, s[40:43], s4 offen lds
  s_add_u32 m0, s77, 58368
  s_nop 0
  buffer_load_dwordx4 v9, s[40:43], s4 offen lds
  v_readlane_b32 s74, v16, 4
  s_add_u32 m0, s77, 65536
  s_add_u32 s4, s74, s76
  buffer_load_dwordx4 v8, s[40:43], s4 offen lds
  s_add_u32 m0, s77, 66560
  s_nop 0
  buffer_load_dwordx4 v9, s[40:43], s4 offen lds
  s_add_u32 m0, s77, 73728
  s_add_u32 s4, s74, 0
  buffer_load_dwordx4 v8, s[40:43], s4 offen lds
  s_add_u32 m0, s77, 74752
  s_nop 0
  buffer_load_dwordx4 v9, s[40:43], s4 offen lds
  s_add_u32 s44, s22, 41943040
  s_addc_u32 s45, s23, 0
  s_and_b32 s45, s45, 0xffff
  s_mov_b32 s46, 524288
  s_mov_b32 s47, 0x00020000
  s_lshl4_add_u32 s3, s97, s68
  s_and_b32 s4, s69, 15
  s_lshl4_add_u32 s3, s3, s4
  s_lshl_b32 s3, s3, 7
  s_sub_u32 s86, s3, 32768
  v_lshlrev_b32 v11, 7, v1
  v_and_b32 v2, 15, v1
  v_lshlrev_b32 v2, 2, v2
  s_cmp_lg_u32 s70, 4
  s_waitcnt vmcnt(14)
  s_cbranch_scc1 L_w2_nofl
  v_readlane_b32 s74, v16, 5
  s_add_u32 m0, s77, 81920
  s_add_u32 s4, s74, s76
  buffer_load_dwordx4 v8, s[40:43], s4 offen lds
  s_add_u32 m0, s77, 82944
  s_nop 0
  buffer_load_dwordx4 v9, s[40:43], s4 offen lds
  s_add_u32 m0, s77, 90112
  s_add_u32 s4, s74, 0
  buffer_load_dwordx4 v8, s[40:43], s4 offen lds
  s_add_u32 m0, s77, 91136
  s_nop 0
  buffer_load_dwordx4 v9, s[40:43], s4 offen lds
  v_readlane_b32 s74, v16, 6
  s_add_u32 m0, s77, 98304
  s_add_u32 s4, s74, s76
  buffer_load_dwordx4 v8, s[40:43], s4 offen lds
  s_add_u32 m0, s77, 99328
  s_nop 0
  buffer_load_dwordx4 v9, s[40:43], s4 offen lds
  v_mov_b32 v3, 1
  s_mov_b32 s79, 0x100000
  s_or_b32 s4, s2, 0xe0
  s_lshl4_add_u32 s4, s4, s97
  s_lshl_b32 s4, s4, 7
  s_lshl2_add_u32 s5, s78, s4
  s_cmp_eq_u32 s92, 0
  s_cselect_b32 s3, s4, s86
  s_cselect_b32 s4, 28, 60
  v_and_b32 v13, s4, v2
  buffer_load_dword v12, v13, s[44:47], s3 offen sc1
  s_setprio 3
  s_barrier
  s_cbranch_scc0 L_w2_wb
L_w2_wbd:
  s_mov_b64 exec, 1
  buffer_store_dword v3, off, s[44:47], s5
  s_mov_b64 exec, -1
L_w2_poll:
  buffer_load_dword v12, v13, s[44:47], s3 offen sc1
  s_sub_u32 s79, s79, 1
  s_cbranch_scc1 L_w2_dep
  s_waitcnt vmcnt(0)
  v_cmp_ne_u32 vcc, 1, v12
  s_cbranch_vccnz L_w2_poll
L_w2_dep:
  s_barrier
  s_setprio 0
  s_mov_b64 exec, 0xffff
  buffer_store_dword v3, v11, s[44:47], s87 offen sc1
  s_mov_b64 exec, -1
  s_branch L_w2_go
L_w2_nofl:
  s_barrier
  v_readlane_b32 s74, v16, 5
  s_add_u32 m0, s77, 81920
  s_add_u32 s4, s74, s76
  buffer_load_dwordx4 v8, s[40:43], s4 offen lds
  s_add_u32 m0, s77, 82944
  s_nop 0
  buffer_load_dwordx4 v9, s[40:43], s4 offen lds
  s_add_u32 m0, s77, 90112
  s_add_u32 s4, s74, 0
  buffer_load_dwordx4 v8, s[40:43], s4 offen lds
  s_add_u32 m0, s77, 91136
  s_nop 0
  buffer_load_dwordx4 v9, s[40:43], s4 offen lds
  v_readlane_b32 s74, v16, 6
  s_add_u32 m0, s77, 98304
  s_add_u32 s4, s74, s76
  buffer_load_dwordx4 v8, s[40:43], s4 offen lds
  s_add_u32 m0, s77, 99328
  s_nop 0
  buffer_load_dwordx4 v9, s[40:43], s4 offen lds
  s_waitcnt vmcnt(8)
  s_barrier
L_w2_go:
  s_add_u32 m0, s77, 106496
  s_add_u32 s4, s74, 0
  buffer_load_dwordx4 v8, s[40:43], s4 offen lds
  s_add_u32 m0, s77, 107520
  s_nop 0
  buffer_load_dwordx4 v9, s[40:43], s4 offen lds
  s_waitcnt vmcnt(4)
  v_readlane_b32 s74, v16, 7
  s_add_u32 m0, s77, 114688
  s_add_u32 s4, s74, s76
  buffer_load_dwordx4 v8, s[40:43], s4 offen lds
  s_add_u32 m0, s77, 115712
  s_nop 0
  buffer_load_dwordx4 v9, s[40:43], s4 offen lds
  s_waitcnt vmcnt(4)
  s_add_u32 m0, s77, 122880
  s_add_u32 s4, s74, 0
  buffer_load_dwordx4 v8, s[40:43], s4 offen lds
  s_add_u32 m0, s77, 123904
  s_nop 0
  buffer_load_dwordx4 v9, s[40:43], s4 offen lds
  s_waitcnt vmcnt(4)
  v_readlane_b32 s74, v16, 8
  s_add_u32 m0, s77, 131072
  s_add_u32 s4, s74, s76
  buffer_load_dwordx4 v8, s[40:43], s4 offen lds
  s_add_u32 m0, s77, 132096
  s_nop 0
  buffer_load_dwordx4 v9, s[40:43], s4 offen lds
  s_waitcnt vmcnt(4)
  s_add_u32 m0, s77, 139264
  s_add_u32 s4, s74, 0
  buffer_load_dwordx4 v8, s[40:43], s4 offen lds
  s_add_u32 m0, s77, 140288
  s_nop 0
  buffer_load_dwordx4 v9, s[40:43], s4 offen lds
  s_waitcnt vmcnt(4)
  v_readlane_b32 s74, v16, 9
  s_add_u32 m0, s77, 147456
  s_add_u32 s4, s74, s76
  buffer_load_dwordx4 v8, s[40:43], s4 offen lds
  s_add_u32 m0, s77, 148480
  s_nop 0
  buffer_load_dwordx4 v9, s[40:43], s4 offen lds
  s_waitcnt vmcnt(12)
  s_barrier
  s_add_u32 m0, s77, 155648
  s_add_u32 s4, s74, 0
  buffer_load_dwordx4 v8, s[40:43], s4 offen lds
  s_add_u32 m0, s77, 156672
  s_nop 0
  buffer_load_dwordx4 v9, s[40:43], s4 offen lds
  s_waitcnt vmcnt(4)
  v_readlane_b32 s74, v16, 10
  s_add_u32 m0, s77, 0
  s_add_u32 s4, s74, s76
  buffer_load_dwordx4 v8, s[40:43], s4 offen lds
  s_add_u32 m0, s77, 1024
  s_nop 0
  buffer_load_dwordx4 v9, s[40:43], s4 offen lds
  s_waitcnt vmcnt(4)
  s_add_u32 m0, s77, 8192
  s_add_u32 s4, s74, 0
  buffer_load_dwordx4 v8, s[40:43], s4 offen lds
  s_add_u32 m0, s77, 9216
  s_nop 0
  buffer_load_dwordx4 v9, s[40:43], s4 offen lds
  s_waitcnt vmcnt(4)
  v_readlane_b32 s74, v16, 11
  s_add_u32 m0, s77, 16384
  s_add_u32 s4, s74, s76
  buffer_load_dwordx4 v8, s[40:43], s4 offen lds
  s_add_u32 m0, s77, 17408
  s_nop 0
  buffer_load_dwordx4 v9, s[40:43], s4 offen lds
  s_waitcnt vmcnt(12)
  s_barrier
  s_add_u32 m0, s77, 24576
  s_add_u32 s4, s74, 0
  buffer_load_dwordx4 v8, s[40:43], s4 offen lds
  s_add_u32 m0, s77, 25600
  s_nop 0
  buffer_load_dwordx4 v9, s[40:43], s4 offen lds
  s_waitcnt vmcnt(4)
  v_readlane_b32 s74, v16, 12
  s_add_u32 m0, s77, 32768
  s_add_u32 s4, s74, s76
  buffer_load_dwordx4 v8, s[40:43], s4 offen lds
  s_add_u32 m0, s77, 33792
  s_nop 0
  buffer_load_dwordx4 v9, s[40:43], s4 offen lds
  s_waitcnt vmcnt(4)
  s_add_u32 m0, s77, 40960
  s_add_u32 s4, s74, 0
  buffer_load_dwordx4 v8, s[40:43], s4 offen lds
  s_add_u32 m0, s77, 41984
  s_nop 0
  buffer_load_dwordx4 v9, s[40:43], s4 offen lds
  s_waitcnt vmcnt(4)
  v_readlane_b32 s74, v16, 13
  s_add_u32 m0, s77, 49152
  s_add_u32 s4, s74, s76
  buffer_load_dwordx4 v8, s[40:43], s4 offen lds
  s_add_u32 m0, s77, 50176
  s_nop 0
  buffer_load_dwordx4 v9, s[40:43], s4 offen lds
  s_waitcnt vmcnt(12)
  s_barrier
  s_add_u32 m0, s77, 57344
  s_add_u32 s4, s74, 0
  buffer_load_dwordx4 v8, s[40:43], s4 offen lds
  s_add_u32 m0, s77, 58368
  s_nop 0
  buffer_load_dwordx4 v9, s[40:43], s4 offen lds
  s_waitcnt vmcnt(4)
  v_readlane_b32 s74, v16, 14
  s_add_u32 m0, s77, 65536
  s_add_u32 s4, s74, s76
  buffer_load_dwordx4 v8, s[40:43], s4 offen lds
  s_add_u32 m0, s77, 66560
  s_nop 0
  buffer_load_dwordx4 v9, s[40:43], s4 offen lds
  s_waitcnt vmcnt(4)
  s_add_u32 m0, s77, 73728
  s_add_u32 s4, s74, 0
  buffer_load_dwordx4 v8, s[40:43], s4 offen lds
  s_add_u32 m0, s77, 74752
  s_nop 0
  buffer_load_dwordx4 v9, s[40:43], s4 offen lds
  s_waitcnt vmcnt(4)
  v_readlane_b32 s74, v16, 15
  s_add_u32 m0, s77, 81920
  s_add_u32 s4, s74, s76
  buffer_load_dwordx4 v8, s[40:43], s4 offen lds
  s_add_u32 m0, s77, 82944
  s_nop 0
  buffer_load_dwordx4 v9, s[40:43], s4 offen lds
  s_waitcnt vmcnt(12)
  s_barrier
  s_add_u32 m0, s77, 90112
  s_add_u32 s4, s74, 0
  buffer_load_dwordx4 v8, s[40:43], s4 offen lds
  s_add_u32 m0, s77, 91136
  s_nop 0
  buffer_load_dwordx4 v9, s[40:43], s4 offen lds
  s_waitcnt vmcnt(4)
  v_readlane_b32 s74, v16, 16
  s_add_u32 m0, s77, 98304
  s_add_u32 s4, s74, s76
  buffer_load_dwordx4 v8, s[40:43], s4 offen lds
  s_add_u32 m0, s77, 99328
  s_nop 0
  buffer_load_dwordx4 v9, s[40:43], s4 offen lds
  s_waitcnt vmcnt(4)
  s_add_u32 m0, s77, 106496
  s_add_u32 s4, s74, 0
  buffer_load_dwordx4 v8, s[40:43], s4 offen lds
  s_add_u32 m0, s77, 107520
  s_nop 0
  buffer_load_dwordx4 v9, s[40:43], s4 offen lds
  s_waitcnt vmcnt(4)
  v_readlane_b32 s74, v16, 17
  s_add_u32 m0, s77, 114688
  s_add_u32 s4, s74, s76
  buffer_load_dwordx4 v8, s[40:43], s4 offen lds
  s_add_u32 m0, s77, 115712
  s_nop 0
  buffer_load_dwordx4 v9, s[40:43], s4 offen lds
  s_waitcnt vmcnt(12)
  s_barrier
  v_readlane_b32 s74, v16, 18
  s_add_u32 m0, s77, 122880
  s_add_u32 s4, s74, s76
  buffer_load_dwordx4 v8, s[40:43], s4 offen lds
  s_add_u32 m0, s77, 123904
  s_nop 0
  buffer_load_dwordx4 v9, s[40:43], s4 offen lds
  s_waitcnt vmcnt(4)
  v_readlane_b32 s74, v16, 19
  s_add_u32 m0, s77, 131072
  s_add_u32 s4, s74, s76
  buffer_load_dwordx4 v8, s[40:43], s4 offen lds
  s_add_u32 m0, s77, 132096
  s_nop 0
  buffer_load_dwordx4 v9, s[40:43], s4 offen lds
  s_waitcnt vmcnt(4)
  s_cmp_eq_u32 s70, 4
  s_cselect_b32 s46, s46, 0
  buffer_load_dword v3, v2, s[44:47], s86 offen sc1
  v_readlane_b32 s74, v16, 20
  s_add_u32 m0, s77, 139264
  s_add_u32 s4, s74, s76
  buffer_load_dwordx4 v8, s[40:43], s4 offen lds
  s_add_u32 m0, s77, 140288
  s_nop 0
  buffer_load_dwordx4 v9, s[40:43], s4 offen lds
  s_waitcnt vmcnt(4)
  v_readlane_b32 s74, v16, 21
  s_add_u32 m0, s77, 147456
  s_add_u32 s4, s74, s76
  buffer_load_dwordx4 v8, s[40:43], s4 offen lds
  s_add_u32 m0, s77, 148480
  s_nop 0
  buffer_load_dwordx4 v9, s[40:43], s4 offen lds
  s_mov_b32 s79, 0x100000
  s_cmp_lg_u32 s70, 4
  s_cbranch_scc1 L_w2l_dep
  s_waitcnt vmcnt(4)
  v_cmp_ne_u32 vcc, 1, v3
  s_cbranch_vccz L_w2l_dep
L_w2l_poll:
  buffer_load_dword v3, v2, s[44:47], s86 offen sc1
  s_sub_u32 s79, s79, 1
  s_cbranch_scc1 L_w2l_dep
  s_waitcnt vmcnt(0)
  v_cmp_ne_u32 vcc, 1, v3
  s_cbranch_vccnz L_w2l_poll
L_w2l_dep:
  s_waitcnt vmcnt(13)
  s_barrier
  v_readlane_b32 s74, v16, 22
  s_add_u32 m0, s77, 155648
  s_add_u32 s4, s74, s76
  buffer_load_dwordx4 v8, s[40:43], s4 offen lds
  s_add_u32 m0, s77, 156672
  s_nop 0
  buffer_load_dwordx4 v9, s[40:43], s4 offen lds
  s_waitcnt vmcnt(4)
  v_readlane_b32 s74, v16, 17
  s_add_u32 m0, s77, 0
  s_add_u32 s4, s74, 0
  buffer_load_dwordx4 v8, s[40:43], s4 offen lds
  s_add_u32 m0, s77, 1024
  s_nop 0
  buffer_load_dwordx4 v9, s[40:43], s4 offen lds
  s_waitcnt vmcnt(4)
  v_readlane_b32 s74, v16, 18
  s_add_u32 m0, s77, 8192
  s_add_u32 s4, s74, 0
  buffer_load_dwordx4 v8, s[40:43], s4 offen lds
  s_add_u32 m0, s77, 9216
  s_nop 0
  buffer_load_dwordx4 v9, s[40:43], s4 offen lds
  s_waitcnt vmcnt(4)
  v_readlane_b32 s74, v16, 19
  s_add_u32 m0, s77, 16384
  s_add_u32 s4, s74, 0
  buffer_load_dwordx4 v8, s[40:43], s4 offen lds
  s_add_u32 m0, s77, 17408
  s_nop 0
  buffer_load_dwordx4 v9, s[40:43], s4 offen lds
  s_waitcnt vmcnt(13)
  s_barrier
  v_readlane_b32 s74, v16, 20
  s_add_u32 m0, s77, 24576
  s_add_u32 s4, s74, 0
  buffer_load_dwordx4 v8, s[40:43], s4 offen lds
  s_add_u32 m0, s77, 25600
  s_nop 0
  buffer_load_dwordx4 v9, s[40:43], s4 offen lds
  s_waitcnt vmcnt(30)
  v_readlane_b32 s74, v16, 21
  s_add_u32 m0, s77, 32768
  s_add_u32 s4, s74, 0
  buffer_load_dwordx4 v8, s[40:43], s4 offen lds
  s_add_u32 m0, s77, 33792
  s_nop 0
  buffer_load_dwordx4 v9, s[40:43], s4 offen lds
  s_waitcnt vmcnt(30)
  v_readlane_b32 s74, v16, 22
  s_add_u32 m0, s77, 40960
  s_add_u32 s4, s74, 0
  buffer_load_dwordx4 v8, s[40:43], s4 offen lds
  s_add_u32 m0, s77, 41984
  s_nop 0
  buffer_load_dwordx4 v9, s[40:43], s4 offen lds
  s_waitcnt vmcnt(30)
  v_readlane_b32 s74, v16, 23
  s_add_u32 m0, s77, 49152
  s_add_u32 s4, s74, 0
  buffer_load_dwordx4 v8, s[40:43], s4 offen lds
  s_add_u32 m0, s77, 50176
  s_nop 0
  buffer_load_dwordx4 v9, s[40:43], s4 offen lds
  s_waitcnt vmcnt(30)
  v_readlane_b32 s74, v16, 24
  s_add_u32 m0, s77, 57344
  s_add_u32 s4, s74, 0
  buffer_load_dwordx4 v8, s[40:43], s4 offen lds
  s_add_u32 m0, s77, 58368
  s_nop 0
  buffer_load_dwordx4 v9, s[40:43], s4 offen lds
  s_waitcnt vmcnt(30)
  v_readlane_b32 s74, v16, 25
  s_add_u32 m0, s77, 65536
  s_add_u32 s4, s74, 0
  buffer_load_dwordx4 v8, s[40:43], s4 offen lds
  s_add_u32 m0, s77, 66560
  s_nop 0
  buffer_load_dwordx4 v9, s[40:43], s4 offen lds
  s_waitcnt vmcnt(30)
  v_readlane_b32 s74, v16, 26
  s_add_u32 m0, s77, 73728
  s_add_u32 s4, s74, 0
  buffer_load_dwordx4 v8, s[40:43], s4 offen lds
  s_add_u32 m0, s77, 74752
  s_nop 0
  buffer_load_dwordx4 v9, s[40:43], s4 offen lds
  s_waitcnt vmcnt(30)
  v_readlane_b32 s74, v16, 27
  s_add_u32 m0, s77, 81920
  s_add_u32 s4, s74, 0
  buffer_load_dwordx4 v8, s[40:43], s4 offen lds
  s_add_u32 m0, s77, 82944
  s_nop 0
  buffer_load_dwordx4 v9, s[40:43], s4 offen lds
  s_waitcnt vmcnt(30)
  v_readlane_b32 s74, v16, 28
  s_add_u32 m0, s77, 90112
  s_add_u32 s4, s74, 0
  buffer_load_dwordx4 v8, s[40:43], s4 offen lds
  s_add_u32 m0, s77, 91136
  s_nop 0
  buffer_load_dwordx4 v9, s[40:43], s4 offen lds
  s_waitcnt vmcnt(22)
  s_barrier
  v_readlane_b32 s74, v16, 29
  s_add_u32 m0, s77, 98304
  s_add_u32 s4, s74, 0
  buffer_load_dwordx4 v8, s[40:43], s4 offen lds
  s_add_u32 m0, s77, 99328
  s_nop 0
  buffer_load_dwordx4 v9, s[40:43], s4 offen lds
  s_waitcnt vmcnt(30)
  v_readlane_b32 s74, v16, 30
  s_add_u32 m0, s77, 106496
  s_add_u32 s4, s74, 0
  buffer_load_dwordx4 v8, s[40:43], s4 offen lds
  s_add_u32 m0, s77, 107520
  s_nop 0
  buffer_load_dwordx4 v9, s[40:43], s4 offen lds
  s_waitcnt vmcnt(30)
  v_readlane_b32 s74, v16, 31
  s_add_u32 m0, s77, 114688
  s_add_u32 s4, s74, 0
  buffer_load_dwordx4 v8, s[40:43], s4 offen lds
  s_add_u32 m0, s77, 115712
  s_nop 0
  buffer_load_dwordx4 v9, s[40:43], s4 offen lds
  s_waitcnt vmcnt(30)
  v_readlane_b32 s74, v16, 32
  s_add_u32 m0, s77, 122880
  s_add_u32 s4, s74, 0
  buffer_load_dwordx4 v8, s[40:43], s4 offen lds
  s_add_u32 m0, s77, 123904
  s_nop 0
  buffer_load_dwordx4 v9, s[40:43], s4 offen lds
  s_waitcnt vmcnt(22)
  s_barrier
  s_add_u32 s64, s22, 41943040
  s_addc_u32 s65, s23, 0
  s_and_b32 s65, s65, 0xffff
  s_mov_b32 s66, 524288
  s_mov_b32 s67, 0x00020000
  s_lshl4_add_u32 s6, s68, s69
  s_xor_b32 s6, s6, 1
  s_add_u32 s7, s96, 4
  s_lshl_b32 s7, s7, 8
  s_add_u32 s6, s6, s7
  s_lshl_b32 s86, s6, 8
  v_and_b32 v2, 3, v1
  v_lshlrev_b32 v30, 6, v2
  s_mov_b32 s79, 0x100000
  s_waitcnt vmcnt(0)
  s_barrier
  s_cmp_eq_u32 s96, 0
  s_cbranch_scc1 L_w2_zskip
  s_cmp_lg_u32 s70, 4
  s_cbranch_scc1 L_w2_xgo
  s_setprio 3
L_w2_xpoll:
  buffer_load_dword v5, v30, s[64:67], s86 offen sc1
  s_sub_u32 s79, s79, 1
  s_cbranch_scc1 L_w2_xgo
  s_waitcnt vmcnt(0)
  v_cmp_ne_u32 vcc, 1, v5
  s_cbranch_vccnz L_w2_xpoll
L_w2_xgo:
  s_setprio 0
  s_waitcnt vmcnt(0)
  s_barrier
L_w2_zskip:
  s_cmp_eq_u32 s96, 1
  s_cbranch_scc1 L_w2_end
  s_lshl_b32 s87, s97, 15
  s_lshl_b32 s4, s68, 11
  s_add_u32 s87, s87, s4
  s_lshl_b32 s4, s69, 2
  s_add_u32 s87, s87, s4
  s_mov_b32 s96, 1
  s_add_u32 s12, s22, 33554432
  s_addc_u32 s13, s23, 0
  s_add_u32 s34, s22, 67108864
  s_addc_u32 s35, s23, 0
  s_add_u32 s97, s97, 1
  s_branch L_attn_body
L_w2_wb:
  buffer_wbl2 sc1
  s_waitcnt vmcnt(0)
  s_mov_b64 exec, 0xffff
  buffer_store_dword v3, v11, s[44:47], s87 offen sc1
  s_branch L_w2_wbd
L_w2_end:
  s_endpgm
L_w2_compute:
  ds_read_b128 v[32:35], v2 offset:0
  ds_read_b128 v[36:39], v2 offset:2048
  ds_read_b64_tr_b16 v[160:161], v6 offset:0
  ds_read_b64_tr_b16 v[162:163], v6 offset:2048
  ds_read_b64_tr_b16 v[164:165], v7 offset:0
  ds_read_b64_tr_b16 v[166:167], v7 offset:2048
  ds_read_b64_tr_b16 v[168:169], v8 offset:0
  ds_read_b64_tr_b16 v[170:171], v8 offset:2048
  ds_read_b64_tr_b16 v[172:173], v9 offset:0
  ds_read_b64_tr_b16 v[174:175], v9 offset:2048
  ds_read_b128 v[40:43], v2 offset:1024
  ds_read_b128 v[44:47], v2 offset:3072
  ds_read_b64_tr_b16 v[176:177], v6 offset:4096
  ds_read_b64_tr_b16 v[178:179], v6 offset:6144
  ds_read_b64_tr_b16 v[180:181], v7 offset:4096
  ds_read_b64_tr_b16 v[182:183], v7 offset:6144
  ds_read_b64_tr_b16 v[184:185], v8 offset:4096
  ds_read_b64_tr_b16 v[186:187], v8 offset:6144
  ds_read_b64_tr_b16 v[188:189], v9 offset:4096
  ds_read_b64_tr_b16 v[190:191], v9 offset:6144
  ds_read_b128 v[48:51], v2 offset:16384
  ds_read_b128 v[52:55], v2 offset:18432
  ds_read_b128 v[56:59], v2 offset:17408
  ds_read_b128 v[60:63], v2 offset:19456
  ds_read_b128 v[64:67], v2 offset:32768
  ds_read_b128 v[68:71], v2 offset:34816
  ds_read_b128 v[72:75], v2 offset:33792
  ds_read_b128 v[76:79], v2 offset:35840
  s_waitcnt lgkmcnt(15)
  v_mfma_f32_16x16x32_bf16 v[128:131], v[160:163], v[32:35], 0
  ds_read_b64_tr_b16 v[192:193], v6 offset:8192
  v_mov_b32 v4, v26
  v_mfma_f32_16x16x32_bf16 v[132:135], v[160:163], v[36:39], 0
  ds_read_b64_tr_b16 v[194:195], v6 offset:10240
  v_mov_b32 v5, v27
  v_mfma_f32_16x16x32_bf16 v[140:143], v[164:167], v[36:39], 0
  ds_read_b64_tr_b16 v[196:197], v7 offset:8192
  v_mov_b32 v12, v28
  v_mfma_f32_16x16x32_bf16 v[136:139], v[164:167], v[32:35], 0
  ds_read_b64_tr_b16 v[198:199], v7 offset:10240
  v_mov_b32 v18, v29
  v_mfma_f32_16x16x32_bf16 v[144:147], v[168:171], v[32:35], 0
  ds_read_b64_tr_b16 v[200:201], v8 offset:8192
  v_mov_b32 v19, 1
  v_mfma_f32_16x16x32_bf16 v[148:151], v[168:171], v[36:39], 0
  ds_read_b64_tr_b16 v[202:203], v8 offset:10240
  v_add_u32 v20, 65536, v6
  v_mfma_f32_16x16x32_bf16 v[156:159], v[172:175], v[36:39], 0
  ds_read_b64_tr_b16 v[204:205], v9 offset:8192
  v_add_u32 v21, 65536, v7
  v_mfma_f32_16x16x32_bf16 v[152:155], v[172:175], v[32:35], 0
  ds_read_b64_tr_b16 v[206:207], v9 offset:10240
  s_waitcnt lgkmcnt(15)
  v_mfma_f32_16x16x32_bf16 v[128:131], v[176:179], v[40:43], v[128:131]
  ds_read_b64_tr_b16 v[208:209], v6 offset:12288
  v_add_u32 v22, 65536, v8
  v_mfma_f32_16x16x32_bf16 v[132:135], v[176:179], v[44:47], v[132:135]
  ds_read_b64_tr_b16 v[210:211], v6 offset:14336
  v_add_u32 v23, 65536, v9
  v_mfma_f32_16x16x32_bf16 v[140:143], v[180:183], v[44:47], v[140:143]
  ds_read_b64_tr_b16 v[212:213], v7 offset:12288
  v_add_u32 v26, 131072, v6
  v_mfma_f32_16x16x32_bf16 v[136:139], v[180:183], v[40:43], v[136:139]
  ds_read_b64_tr_b16 v[214:215], v7 offset:14336
  v_add_u32 v27, 131072, v7
  v_mfma_f32_16x16x32_bf16 v[144:147], v[184:187], v[40:43], v[144:147]
  ds_read_b64_tr_b16 v[216:217], v8 offset:12288
  v_add_u32 v28, 131072, v8
  v_mfma_f32_16x16x32_bf16 v[148:151], v[184:187], v[44:47], v[148:151]
  ds_read_b64_tr_b16 v[218:219], v8 offset:14336
  v_add_u32 v29, 131072, v9
  v_mfma_f32_16x16x32_bf16 v[156:159], v[188:191], v[44:47], v[156:159]
  ds_read_b64_tr_b16 v[220:221], v9 offset:12288
  s_add_u32 s52, s22, 41943040
  v_mfma_f32_16x16x32_bf16 v[152:155], v[188:191], v[40:43], v[152:155]
  ds_read_b64_tr_b16 v[222:223], v9 offset:14336
  s_waitcnt lgkmcnt(8)
  v_mfma_f32_16x16x32_bf16 v[96:99], v[192:195], v[32:35], v[96:99]
  ds_read_b64_tr_b16 v[160:161], v6 offset:16384
  s_addc_u32 s53, s23, 0
  v_mfma_f32_16x16x32_bf16 v[100:103], v[192:195], v[36:39], v[100:103]
  ds_read_b64_tr_b16 v[162:163], v6 offset:18432
  s_and_b32 s53, s53, 0xffff
  v_mfma_f32_16x16x32_bf16 v[108:111], v[196:199], v[36:39], v[108:111]
  ds_read_b64_tr_b16 v[164:165], v7 offset:16384
  s_mov_b32 s54, 524288
  v_mfma_f32_16x16x32_bf16 v[104:107], v[196:199], v[32:35], v[104:107]
  ds_read_b64_tr_b16 v[166:167], v7 offset:18432
  s_mov_b32 s55, 0x00020000
  v_mfma_f32_16x16x32_bf16 v[112:115], v[200:203], v[32:35], v[112:115]
  ds_read_b64_tr_b16 v[168:169], v8 offset:16384
  v_mfma_f32_16x16x32_bf16 v[116:119], v[200:203], v[36:39], v[116:119]
  ds_read_b64_tr_b16 v[170:171], v8 offset:18432
  v_mfma_f32_16x16x32_bf16 v[124:127], v[204:207], v[36:39], v[124:127]
  ds_read_b64_tr_b16 v[172:173], v9 offset:16384
  v_mfma_f32_16x16x32_bf16 v[120:123], v[204:207], v[32:35], v[120:123]
  ds_read_b64_tr_b16 v[174:175], v9 offset:18432
  s_waitcnt lgkmcnt(8)
  s_barrier
  buffer_load_dwordx4 v[80:83], off, s[36:39], s51 offset:0 sc1
  buffer_load_dwordx4 v[84:87], off, s[64:67], s51 offset:0 sc1
  buffer_load_dwordx4 v[88:91], off, s[36:39], s51 offset:1024 sc1
  buffer_load_dwordx4 v[92:95], off, s[64:67], s51 offset:1024 sc1
  buffer_load_dwordx4 v[224:227], off, s[36:39], s48 offset:0 sc1
  buffer_load_dwordx4 v[228:231], off, s[64:67], s48 offset:0 sc1
  buffer_load_dwordx4 v[232:235], off, s[36:39], s48 offset:1024 sc1
  buffer_load_dwordx4 v[236:239], off, s[64:67], s48 offset:1024 sc1
  buffer_load_dwordx4 v[240:243], off, s[36:39], s49 offset:0 sc1
  buffer_load_dwordx4 v[244:247], off, s[64:67], s49 offset:0 sc1
  buffer_load_dwordx4 v[248:251], off, s[36:39], s49 offset:1024 sc1
  buffer_load_dwordx4 v[252:255], off, s[64:67], s49 offset:1024 sc1
  v_mfma_f32_16x16x32_bf16 v[96:99], v[208:211], v[40:43], v[96:99]
  ds_read_b64_tr_b16 v[176:177], v6 offset:20480
  v_mfma_f32_16x16x32_bf16 v[100:103], v[208:211], v[44:47], v[100:103]
  ds_read_b64_tr_b16 v[178:179], v6 offset:22528
  v_mfma_f32_16x16x32_bf16 v[108:111], v[212:215], v[44:47], v[108:111]
  ds_read_b64_tr_b16 v[180:181], v7 offset:20480
  v_mfma_f32_16x16x32_bf16 v[104:107], v[212:215], v[40:43], v[104:107]
  ds_read_b64_tr_b16 v[182:183], v7 offset:22528
  v_mfma_f32_16x16x32_bf16 v[112:115], v[216:219], v[40:43], v[112:115]
  ds_read_b64_tr_b16 v[184:185], v8 offset:20480
  v_mfma_f32_16x16x32_bf16 v[116:119], v[216:219], v[44:47], v[116:119]
  ds_read_b64_tr_b16 v[186:187], v8 offset:22528
  v_readlane_b32 s50, v30, 6
  v_mfma_f32_16x16x32_bf16 v[124:127], v[220:223], v[44:47], v[124:127]
  ds_read_b64_tr_b16 v[188:189], v9 offset:20480
  v_mfma_f32_16x16x32_bf16 v[120:123], v[220:223], v[40:43], v[120:123]
  ds_read_b64_tr_b16 v[190:191], v9 offset:22528
  s_waitcnt lgkmcnt(8)
  v_mfma_f32_16x16x32_bf16 v[128:131], v[160:163], v[48:51], v[128:131]
  buffer_load_dwordx4 v[32:35], off, s[36:39], s50 offset:0 sc1
  v_mfma_f32_16x16x32_bf16 v[132:135], v[160:163], v[52:55], v[132:135]
  ds_read_b64_tr_b16 v[192:193], v6 offset:24576
  ds_read_b64_tr_b16 v[194:195], v6 offset:26624
  v_mfma_f32_16x16x32_bf16 v[140:143], v[164:167], v[52:55], v[140:143]
  ds_read_b64_tr_b16 v[196:197], v7 offset:24576
  v_mfma_f32_16x16x32_bf16 v[136:139], v[164:167], v[48:51], v[136:139]
  buffer_load_dwordx4 v[36:39], off, s[64:67], s50 offset:0 sc1
  v_mfma_f32_16x16x32_bf16 v[144:147], v[168:171], v[48:51], v[144:147]
  ds_read_b64_tr_b16 v[198:199], v7 offset:26624
  ds_read_b64_tr_b16 v[200:201], v8 offset:24576
  v_mfma_f32_16x16x32_bf16 v[148:151], v[168:171], v[52:55], v[148:151]
  ds_read_b64_tr_b16 v[202:203], v8 offset:26624
  ds_read_b64_tr_b16 v[204:205], v9 offset:24576
  v_mfma_f32_16x16x32_bf16 v[156:159], v[172:175], v[52:55], v[156:159]
  buffer_load_dwordx4 v[40:43], off, s[36:39], s50 offset:1024 sc1
  v_mfma_f32_16x16x32_bf16 v[152:155], v[172:175], v[48:51], v[152:155]
  ds_read_b64_tr_b16 v[206:207], v9 offset:26624
  s_waitcnt lgkmcnt(8)
  v_mfma_f32_16x16x32_bf16 v[128:131], v[176:179], v[56:59], v[128:131]
  ds_read_b64_tr_b16 v[208:209], v6 offset:28672
  v_mfma_f32_16x16x32_bf16 v[132:135], v[176:179], v[60:63], v[132:135]
  buffer_load_dwordx4 v[44:47], off, s[64:67], s50 offset:1024 sc1
  v_mfma_f32_16x16x32_bf16 v[140:143], v[180:183], v[60:63], v[140:143]
  ds_read_b64_tr_b16 v[210:211], v6 offset:30720
  ds_read_b64_tr_b16 v[212:213], v7 offset:28672
  v_mfma_f32_16x16x32_bf16 v[136:139], v[180:183], v[56:59], v[136:139]
  ds_read_b64_tr_b16 v[214:215], v7 offset:30720
  v_mfma_f32_16x16x32_bf16 v[144:147], v[184:187], v[56:59], v[144:147]
  ds_read_b64_tr_b16 v[216:217], v8 offset:28672
  v_mfma_f32_16x16x32_bf16 v[148:151], v[184:187], v[60:63], v[148:151]
  ds_read_b64_tr_b16 v[218:219], v8 offset:30720
  v_mfma_f32_16x16x32_bf16 v[156:159], v[188:191], v[60:63], v[156:159]
  ds_read_b64_tr_b16 v[220:221], v9 offset:28672
  v_mfma_f32_16x16x32_bf16 v[152:155], v[188:191], v[56:59], v[152:155]
  ds_read_b64_tr_b16 v[222:223], v9 offset:30720
  s_waitcnt lgkmcnt(8)
  v_mfma_f32_16x16x32_bf16 v[96:99], v[192:195], v[48:51], v[96:99]
  ds_read_b64_tr_b16 v[160:161], v6 offset:32768
  v_mfma_f32_16x16x32_bf16 v[100:103], v[192:195], v[52:55], v[100:103]
  ds_read_b64_tr_b16 v[162:163], v6 offset:34816
  v_mfma_f32_16x16x32_bf16 v[108:111], v[196:199], v[52:55], v[108:111]
  ds_read_b64_tr_b16 v[164:165], v7 offset:32768
  v_mfma_f32_16x16x32_bf16 v[104:107], v[196:199], v[48:51], v[104:107]
  ds_read_b64_tr_b16 v[166:167], v7 offset:34816
  v_mfma_f32_16x16x32_bf16 v[112:115], v[200:203], v[48:51], v[112:115]
  ds_read_b64_tr_b16 v[168:169], v8 offset:32768
  v_mfma_f32_16x16x32_bf16 v[116:119], v[200:203], v[52:55], v[116:119]
  ds_read_b64_tr_b16 v[170:171], v8 offset:34816
  v_mfma_f32_16x16x32_bf16 v[124:127], v[204:207], v[52:55], v[124:127]
  ds_read_b64_tr_b16 v[172:173], v9 offset:32768
  v_mfma_f32_16x16x32_bf16 v[120:123], v[204:207], v[48:51], v[120:123]
  ds_read_b64_tr_b16 v[174:175], v9 offset:34816
  s_waitcnt lgkmcnt(8)
  v_mfma_f32_16x16x32_bf16 v[96:99], v[208:211], v[56:59], v[96:99]
  ds_read_b64_tr_b16 v[176:177], v6 offset:36864
  v_mfma_f32_16x16x32_bf16 v[100:103], v[208:211], v[60:63], v[100:103]
  ds_read_b64_tr_b16 v[178:179], v6 offset:38912
  v_mfma_f32_16x16x32_bf16 v[108:111], v[212:215], v[60:63], v[108:111]
  ds_read_b64_tr_b16 v[180:181], v7 offset:36864
  v_mfma_f32_16x16x32_bf16 v[104:107], v[212:215], v[56:59], v[104:107]
  ds_read_b64_tr_b16 v[182:183], v7 offset:38912
  v_mfma_f32_16x16x32_bf16 v[112:115], v[216:219], v[56:59], v[112:115]
  ds_read_b64_tr_b16 v[184:185], v8 offset:36864
  v_mfma_f32_16x16x32_bf16 v[116:119], v[216:219], v[60:63], v[116:119]
  ds_read_b64_tr_b16 v[186:187], v8 offset:38912
  v_readlane_b32 s51, v30, 7
  v_mfma_f32_16x16x32_bf16 v[124:127], v[220:223], v[60:63], v[124:127]
  ds_read_b64_tr_b16 v[188:189], v9 offset:36864
  v_mfma_f32_16x16x32_bf16 v[120:123], v[220:223], v[56:59], v[120:123]
  ds_read_b64_tr_b16 v[190:191], v9 offset:38912
  s_waitcnt lgkmcnt(8)
  v_mfma_f32_16x16x32_bf16 v[128:131], v[160:163], v[64:67], v[128:131]
  buffer_load_dwordx4 v[48:51], off, s[36:39], s51 offset:0 sc1
  v_mfma_f32_16x16x32_bf16 v[132:135], v[160:163], v[68:71], v[132:135]
  ds_read_b64_tr_b16 v[192:193], v6 offset:40960
  ds_read_b64_tr_b16 v[194:195], v6 offset:43008
  v_mfma_f32_16x16x32_bf16 v[140:143], v[164:167], v[68:71], v[140:143]
  ds_read_b64_tr_b16 v[196:197], v7 offset:40960
  v_mfma_f32_16x16x32_bf16 v[136:139], v[164:167], v[64:67], v[136:139]
  buffer_load_dwordx4 v[52:55], off, s[64:67], s51 offset:0 sc1
  v_mfma_f32_16x16x32_bf16 v[144:147], v[168:171], v[64:67], v[144:147]
  ds_read_b64_tr_b16 v[198:199], v7 offset:43008
  ds_read_b64_tr_b16 v[200:201], v8 offset:40960
  v_mfma_f32_16x16x32_bf16 v[148:151], v[168:171], v[68:71], v[148:151]
  ds_read_b64_tr_b16 v[202:203], v8 offset:43008
  ds_read_b64_tr_b16 v[204:205], v9 offset:40960
  v_mfma_f32_16x16x32_bf16 v[156:159], v[172:175], v[68:71], v[156:159]
  buffer_load_dwordx4 v[56:59], off, s[36:39], s51 offset:1024 sc1
  v_mfma_f32_16x16x32_bf16 v[152:155], v[172:175], v[64:67], v[152:155]
  ds_read_b64_tr_b16 v[206:207], v9 offset:43008
  s_waitcnt lgkmcnt(8)
  v_mfma_f32_16x16x32_bf16 v[128:131], v[176:179], v[72:75], v[128:131]
  ds_read_b64_tr_b16 v[208:209], v6 offset:45056
  v_mfma_f32_16x16x32_bf16 v[132:135], v[176:179], v[76:79], v[132:135]
  buffer_load_dwordx4 v[60:63], off, s[64:67], s51 offset:1024 sc1
  v_mfma_f32_16x16x32_bf16 v[140:143], v[180:183], v[76:79], v[140:143]
  ds_read_b64_tr_b16 v[210:211], v6 offset:47104
  ds_read_b64_tr_b16 v[212:213], v7 offset:45056
  v_mfma_f32_16x16x32_bf16 v[136:139], v[180:183], v[72:75], v[136:139]
  ds_read_b64_tr_b16 v[214:215], v7 offset:47104
  v_mfma_f32_16x16x32_bf16 v[144:147], v[184:187], v[72:75], v[144:147]
  ds_read_b64_tr_b16 v[216:217], v8 offset:45056
  v_mfma_f32_16x16x32_bf16 v[148:151], v[184:187], v[76:79], v[148:151]
  ds_read_b64_tr_b16 v[218:219], v8 offset:47104
  v_mfma_f32_16x16x32_bf16 v[156:159], v[188:191], v[76:79], v[156:159]
  ds_read_b64_tr_b16 v[220:221], v9 offset:45056
  v_mfma_f32_16x16x32_bf16 v[152:155], v[188:191], v[72:75], v[152:155]
  ds_read_b64_tr_b16 v[222:223], v9 offset:47104
  s_waitcnt lgkmcnt(8)
  v_mfma_f32_16x16x32_bf16 v[96:99], v[192:195], v[64:67], v[96:99]
  ds_read_b64_tr_b16 v[160:161], v6 offset:49152
  v_mfma_f32_16x16x32_bf16 v[100:103], v[192:195], v[68:71], v[100:103]
  ds_read_b64_tr_b16 v[162:163], v6 offset:51200
  v_mfma_f32_16x16x32_bf16 v[108:111], v[196:199], v[68:71], v[108:111]
  ds_read_b64_tr_b16 v[164:165], v7 offset:49152
  v_mfma_f32_16x16x32_bf16 v[104:107], v[196:199], v[64:67], v[104:107]
  ds_read_b64_tr_b16 v[166:167], v7 offset:51200
  v_mfma_f32_16x16x32_bf16 v[112:115], v[200:203], v[64:67], v[112:115]
  ds_read_b64_tr_b16 v[168:169], v8 offset:49152
  v_mfma_f32_16x16x32_bf16 v[116:119], v[200:203], v[68:71], v[116:119]
  ds_read_b64_tr_b16 v[170:171], v8 offset:51200
  v_mfma_f32_16x16x32_bf16 v[124:127], v[204:207], v[68:71], v[124:127]
  ds_read_b64_tr_b16 v[172:173], v9 offset:49152
  v_mfma_f32_16x16x32_bf16 v[120:123], v[204:207], v[64:67], v[120:123]
  ds_read_b64_tr_b16 v[174:175], v9 offset:51200
  s_waitcnt lgkmcnt(8)
  v_mfma_f32_16x16x32_bf16 v[96:99], v[208:211], v[72:75], v[96:99]
  ds_read_b64_tr_b16 v[176:177], v6 offset:53248
  v_mfma_f32_16x16x32_bf16 v[100:103], v[208:211], v[76:79], v[100:103]
  ds_read_b64_tr_b16 v[178:179], v6 offset:55296
  v_mfma_f32_16x16x32_bf16 v[108:111], v[212:215], v[76:79], v[108:111]
  ds_read_b64_tr_b16 v[180:181], v7 offset:53248
  v_mfma_f32_16x16x32_bf16 v[104:107], v[212:215], v[72:75], v[104:107]
  ds_read_b64_tr_b16 v[182:183], v7 offset:55296
  v_mfma_f32_16x16x32_bf16 v[112:115], v[216:219], v[72:75], v[112:115]
  ds_read_b64_tr_b16 v[184:185], v8 offset:53248
  v_mfma_f32_16x16x32_bf16 v[116:119], v[216:219], v[76:79], v[116:119]
  ds_read_b64_tr_b16 v[186:187], v8 offset:55296
  v_readlane_b32 s48, v30, 8
  v_mfma_f32_16x16x32_bf16 v[124:127], v[220:223], v[76:79], v[124:127]
  ds_read_b64_tr_b16 v[188:189], v9 offset:53248
  v_mfma_f32_16x16x32_bf16 v[120:123], v[220:223], v[72:75], v[120:123]
  ds_read_b64_tr_b16 v[190:191], v9 offset:55296
  s_waitcnt vmcnt(18) lgkmcnt(8)
  v_mfma_f32_16x16x32_bf16 v[128:131], v[160:163], v[80:83], v[128:131]
  buffer_load_dwordx4 v[64:67], off, s[36:39], s48 offset:0 sc1
  v_mfma_f32_16x16x32_bf16 v[132:135], v[160:163], v[84:87], v[132:135]
  ds_read_b64_tr_b16 v[192:193], v6 offset:57344
  ds_read_b64_tr_b16 v[194:195], v6 offset:59392
  v_mfma_f32_16x16x32_bf16 v[140:143], v[164:167], v[84:87], v[140:143]
  ds_read_b64_tr_b16 v[196:197], v7 offset:57344
  v_mfma_f32_16x16x32_bf16 v[136:139], v[164:167], v[80:83], v[136:139]
  ds_read_b64_tr_b16 v[198:199], v7 offset:59392
  v_mfma_f32_16x16x32_bf16 v[144:147], v[168:171], v[80:83], v[144:147]
  ds_read_b64_tr_b16 v[200:201], v8 offset:57344
  v_mfma_f32_16x16x32_bf16 v[148:151], v[168:171], v[84:87], v[148:151]
  ds_read_b64_tr_b16 v[202:203], v8 offset:59392
  ds_read_b64_tr_b16 v[204:205], v9 offset:57344
  v_mfma_f32_16x16x32_bf16 v[156:159], v[172:175], v[84:87], v[156:159]
  buffer_load_dwordx4 v[68:71], off, s[64:67], s48 offset:0 sc1
  v_mfma_f32_16x16x32_bf16 v[152:155], v[172:175], v[80:83], v[152:155]
  ds_read_b64_tr_b16 v[206:207], v9 offset:59392
  s_waitcnt vmcnt(18) lgkmcnt(8)
  v_mfma_f32_16x16x32_bf16 v[128:131], v[176:179], v[88:91], v[128:131]
  ds_read_b64_tr_b16 v[208:209], v6 offset:61440
  v_mfma_f32_16x16x32_bf16 v[132:135], v[176:179], v[92:95], v[132:135]
  ds_read_b64_tr_b16 v[210:211], v6 offset:63488
  v_mfma_f32_16x16x32_bf16 v[140:143], v[180:183], v[92:95], v[140:143]
  ds_read_b64_tr_b16 v[212:213], v7 offset:61440
  v_mfma_f32_16x16x32_bf16 v[136:139], v[180:183], v[88:91], v[136:139]
  ds_read_b64_tr_b16 v[214:215], v7 offset:63488
  v_mfma_f32_16x16x32_bf16 v[144:147], v[184:187], v[88:91], v[144:147]
  buffer_load_dwordx4 v[72:75], off, s[36:39], s48 offset:1024 sc1
  v_mfma_f32_16x16x32_bf16 v[148:151], v[184:187], v[92:95], v[148:151]
  ds_read_b64_tr_b16 v[216:217], v8 offset:61440
  ds_read_b64_tr_b16 v[218:219], v8 offset:63488
  v_mfma_f32_16x16x32_bf16 v[156:159], v[188:191], v[92:95], v[156:159]
  ds_read_b64_tr_b16 v[220:221], v9 offset:61440
  v_mfma_f32_16x16x32_bf16 v[152:155], v[188:191], v[88:91], v[152:155]
  ds_read_b64_tr_b16 v[222:223], v9 offset:63488
  s_waitcnt lgkmcnt(8)
  v_mfma_f32_16x16x32_bf16 v[96:99], v[192:195], v[80:83], v[96:99]
  ds_read_b64_tr_b16 v[160:161], v20 offset:0
  v_mfma_f32_16x16x32_bf16 v[100:103], v[192:195], v[84:87], v[100:103]
  ds_read_b64_tr_b16 v[162:163], v20 offset:2048
  v_mfma_f32_16x16x32_bf16 v[108:111], v[196:199], v[84:87], v[108:111]
  buffer_load_dwordx4 v[76:79], off, s[64:67], s48 offset:1024 sc1
  v_mfma_f32_16x16x32_bf16 v[104:107], v[196:199], v[80:83], v[104:107]
  ds_read_b64_tr_b16 v[164:165], v21 offset:0
  ds_read_b64_tr_b16 v[166:167], v21 offset:2048
  v_mfma_f32_16x16x32_bf16 v[112:115], v[200:203], v[80:83], v[112:115]
  ds_read_b64_tr_b16 v[168:169], v22 offset:0
  v_mfma_f32_16x16x32_bf16 v[116:119], v[200:203], v[84:87], v[116:119]
  ds_read_b64_tr_b16 v[170:171], v22 offset:2048
  v_mfma_f32_16x16x32_bf16 v[124:127], v[204:207], v[84:87], v[124:127]
  ds_read_b64_tr_b16 v[172:173], v23 offset:0
  v_mfma_f32_16x16x32_bf16 v[120:123], v[204:207], v[80:83], v[120:123]
  ds_read_b64_tr_b16 v[174:175], v23 offset:2048
  s_waitcnt lgkmcnt(8)
  s_barrier
  v_mfma_f32_16x16x32_bf16 v[96:99], v[208:211], v[88:91], v[96:99]
  ds_read_b64_tr_b16 v[176:177], v20 offset:4096
  v_mfma_f32_16x16x32_bf16 v[100:103], v[208:211], v[92:95], v[100:103]
  ds_read_b64_tr_b16 v[178:179], v20 offset:6144
  v_mfma_f32_16x16x32_bf16 v[108:111], v[212:215], v[92:95], v[108:111]
  ds_read_b64_tr_b16 v[180:181], v21 offset:4096
  v_mfma_f32_16x16x32_bf16 v[104:107], v[212:215], v[88:91], v[104:107]
  ds_read_b64_tr_b16 v[182:183], v21 offset:6144
  v_mfma_f32_16x16x32_bf16 v[112:115], v[216:219], v[88:91], v[112:115]
  ds_read_b64_tr_b16 v[184:185], v22 offset:4096
  v_mfma_f32_16x16x32_bf16 v[116:119], v[216:219], v[92:95], v[116:119]
  ds_read_b64_tr_b16 v[186:187], v22 offset:6144
  v_readlane_b32 s49, v30, 9
  v_mfma_f32_16x16x32_bf16 v[124:127], v[220:223], v[92:95], v[124:127]
  ds_read_b64_tr_b16 v[188:189], v23 offset:4096
  v_mfma_f32_16x16x32_bf16 v[120:123], v[220:223], v[88:91], v[120:123]
  ds_read_b64_tr_b16 v[190:191], v23 offset:6144
  s_waitcnt vmcnt(18) lgkmcnt(8)
  v_mfma_f32_16x16x32_bf16 v[128:131], v[160:163], v[224:227], v[128:131]
  buffer_load_dwordx4 v[80:83], off, s[36:39], s49 offset:0 sc1
  v_mfma_f32_16x16x32_bf16 v[132:135], v[160:163], v[228:231], v[132:135]
  ds_read_b64_tr_b16 v[192:193], v20 offset:8192
  ds_read_b64_tr_b16 v[194:195], v20 offset:10240
  v_mfma_f32_16x16x32_bf16 v[140:143], v[164:167], v[228:231], v[140:143]
  ds_read_b64_tr_b16 v[196:197], v21 offset:8192
  v_mfma_f32_16x16x32_bf16 v[136:139], v[164:167], v[224:227], v[136:139]
  ds_read_b64_tr_b16 v[198:199], v21 offset:10240
  v_mfma_f32_16x16x32_bf16 v[144:147], v[168:171], v[224:227], v[144:147]
  ds_read_b64_tr_b16 v[200:201], v22 offset:8192
  v_mfma_f32_16x16x32_bf16 v[148:151], v[168:171], v[228:231], v[148:151]
  ds_read_b64_tr_b16 v[202:203], v22 offset:10240
  ds_read_b64_tr_b16 v[204:205], v23 offset:8192
  v_mfma_f32_16x16x32_bf16 v[156:159], v[172:175], v[228:231], v[156:159]
  buffer_load_dwordx4 v[84:87], off, s[64:67], s49 offset:0 sc1
  v_mfma_f32_16x16x32_bf16 v[152:155], v[172:175], v[224:227], v[152:155]
  ds_read_b64_tr_b16 v[206:207], v23 offset:10240
  s_waitcnt vmcnt(18) lgkmcnt(8)
  v_mfma_f32_16x16x32_bf16 v[128:131], v[176:179], v[232:235], v[128:131]
  ds_read_b64_tr_b16 v[208:209], v20 offset:12288
  v_mfma_f32_16x16x32_bf16 v[132:135], v[176:179], v[236:239], v[132:135]
  ds_read_b64_tr_b16 v[210:211], v20 offset:14336
  v_mfma_f32_16x16x32_bf16 v[140:143], v[180:183], v[236:239], v[140:143]
  ds_read_b64_tr_b16 v[212:213], v21 offset:12288
  v_mfma_f32_16x16x32_bf16 v[136:139], v[180:183], v[232:235], v[136:139]
  ds_read_b64_tr_b16 v[214:215], v21 offset:14336
  v_mfma_f32_16x16x32_bf16 v[144:147], v[184:187], v[232:235], v[144:147]
  buffer_load_dwordx4 v[88:91], off, s[36:39], s49 offset:1024 sc1
  v_mfma_f32_16x16x32_bf16 v[148:151], v[184:187], v[236:239], v[148:151]
  ds_read_b64_tr_b16 v[216:217], v22 offset:12288
  ds_read_b64_tr_b16 v[218:219], v22 offset:14336
  v_mfma_f32_16x16x32_bf16 v[156:159], v[188:191], v[236:239], v[156:159]
  ds_read_b64_tr_b16 v[220:221], v23 offset:12288
  v_mfma_f32_16x16x32_bf16 v[152:155], v[188:191], v[232:235], v[152:155]
  ds_read_b64_tr_b16 v[222:223], v23 offset:14336
  s_waitcnt lgkmcnt(8)
  v_mfma_f32_16x16x32_bf16 v[96:99], v[192:195], v[224:227], v[96:99]
  ds_read_b64_tr_b16 v[160:161], v20 offset:16384
  v_mfma_f32_16x16x32_bf16 v[100:103], v[192:195], v[228:231], v[100:103]
  ds_read_b64_tr_b16 v[162:163], v20 offset:18432
  v_mfma_f32_16x16x32_bf16 v[108:111], v[196:199], v[228:231], v[108:111]
  buffer_load_dwordx4 v[92:95], off, s[64:67], s49 offset:1024 sc1
  v_mfma_f32_16x16x32_bf16 v[104:107], v[196:199], v[224:227], v[104:107]
  ds_read_b64_tr_b16 v[164:165], v21 offset:16384
  ds_read_b64_tr_b16 v[166:167], v21 offset:18432
  v_mfma_f32_16x16x32_bf16 v[112:115], v[200:203], v[224:227], v[112:115]
  ds_read_b64_tr_b16 v[168:169], v22 offset:16384
  v_mfma_f32_16x16x32_bf16 v[116:119], v[200:203], v[228:231], v[116:119]
  ds_read_b64_tr_b16 v[170:171], v22 offset:18432
  v_mfma_f32_16x16x32_bf16 v[124:127], v[204:207], v[228:231], v[124:127]
  ds_read_b64_tr_b16 v[172:173], v23 offset:16384
  v_mfma_f32_16x16x32_bf16 v[120:123], v[204:207], v[224:227], v[120:123]
  ds_read_b64_tr_b16 v[174:175], v23 offset:18432
  s_waitcnt lgkmcnt(8)
  v_mfma_f32_16x16x32_bf16 v[96:99], v[208:211], v[232:235], v[96:99]
  ds_read_b64_tr_b16 v[176:177], v20 offset:20480
  v_mfma_f32_16x16x32_bf16 v[100:103], v[208:211], v[236:239], v[100:103]
  ds_read_b64_tr_b16 v[178:179], v20 offset:22528
  v_mfma_f32_16x16x32_bf16 v[108:111], v[212:215], v[236:239], v[108:111]
  ds_read_b64_tr_b16 v[180:181], v21 offset:20480
  v_mfma_f32_16x16x32_bf16 v[104:107], v[212:215], v[232:235], v[104:107]
  ds_read_b64_tr_b16 v[182:183], v21 offset:22528
  v_mfma_f32_16x16x32_bf16 v[112:115], v[216:219], v[232:235], v[112:115]
  ds_read_b64_tr_b16 v[184:185], v22 offset:20480
  v_mfma_f32_16x16x32_bf16 v[116:119], v[216:219], v[236:239], v[116:119]
  ds_read_b64_tr_b16 v[186:187], v22 offset:22528
  v_readlane_b32 s50, v30, 10
  v_mfma_f32_16x16x32_bf16 v[124:127], v[220:223], v[236:239], v[124:127]
  ds_read_b64_tr_b16 v[188:189], v23 offset:20480
  v_mfma_f32_16x16x32_bf16 v[120:123], v[220:223], v[232:235], v[120:123]
  ds_read_b64_tr_b16 v[190:191], v23 offset:22528
  s_waitcnt vmcnt(18) lgkmcnt(8)
  v_mfma_f32_16x16x32_bf16 v[128:131], v[160:163], v[240:243], v[128:131]
  buffer_load_dwordx4 v[224:227], off, s[36:39], s50 offset:0 sc1
  v_mfma_f32_16x16x32_bf16 v[132:135], v[160:163], v[244:247], v[132:135]
  ds_read_b64_tr_b16 v[192:193], v20 offset:24576
  ds_read_b64_tr_b16 v[194:195], v20 offset:26624
  v_mfma_f32_16x16x32_bf16 v[140:143], v[164:167], v[244:247], v[140:143]
  ds_read_b64_tr_b16 v[196:197], v21 offset:24576
  v_mfma_f32_16x16x32_bf16 v[136:139], v[164:167], v[240:243], v[136:139]
  ds_read_b64_tr_b16 v[198:199], v21 offset:26624
  v_mfma_f32_16x16x32_bf16 v[144:147], v[168:171], v[240:243], v[144:147]
  ds_read_b64_tr_b16 v[200:201], v22 offset:24576
  v_mfma_f32_16x16x32_bf16 v[148:151], v[168:171], v[244:247], v[148:151]
  ds_read_b64_tr_b16 v[202:203], v22 offset:26624
  ds_read_b64_tr_b16 v[204:205], v23 offset:24576
  v_mfma_f32_16x16x32_bf16 v[156:159], v[172:175], v[244:247], v[156:159]
  buffer_load_dwordx4 v[228:231], off, s[64:67], s50 offset:0 sc1
  v_mfma_f32_16x16x32_bf16 v[152:155], v[172:175], v[240:243], v[152:155]
  ds_read_b64_tr_b16 v[206:207], v23 offset:26624
  s_waitcnt vmcnt(18) lgkmcnt(8)
  v_mfma_f32_16x16x32_bf16 v[128:131], v[176:179], v[248:251], v[128:131]
  ds_read_b64_tr_b16 v[208:209], v20 offset:28672
  v_mfma_f32_16x16x32_bf16 v[132:135], v[176:179], v[252:255], v[132:135]
  ds_read_b64_tr_b16 v[210:211], v20 offset:30720
  v_mfma_f32_16x16x32_bf16 v[140:143], v[180:183], v[252:255], v[140:143]
  ds_read_b64_tr_b16 v[212:213], v21 offset:28672
  v_mfma_f32_16x16x32_bf16 v[136:139], v[180:183], v[248:251], v[136:139]
  ds_read_b64_tr_b16 v[214:215], v21 offset:30720
  v_mfma_f32_16x16x32_bf16 v[144:147], v[184:187], v[248:251], v[144:147]
  buffer_load_dwordx4 v[232:235], off, s[36:39], s50 offset:1024 sc1
  v_mfma_f32_16x16x32_bf16 v[148:151], v[184:187], v[252:255], v[148:151]
  ds_read_b64_tr_b16 v[216:217], v22 offset:28672
  ds_read_b64_tr_b16 v[218:219], v22 offset:30720
  v_mfma_f32_16x16x32_bf16 v[156:159], v[188:191], v[252:255], v[156:159]
  ds_read_b64_tr_b16 v[220:221], v23 offset:28672
  v_mfma_f32_16x16x32_bf16 v[152:155], v[188:191], v[248:251], v[152:155]
  ds_read_b64_tr_b16 v[222:223], v23 offset:30720
  s_waitcnt lgkmcnt(8)
  v_mfma_f32_16x16x32_bf16 v[96:99], v[192:195], v[240:243], v[96:99]
  ds_read_b64_tr_b16 v[160:161], v20 offset:32768
  v_mfma_f32_16x16x32_bf16 v[100:103], v[192:195], v[244:247], v[100:103]
  ds_read_b64_tr_b16 v[162:163], v20 offset:34816
  v_mfma_f32_16x16x32_bf16 v[108:111], v[196:199], v[244:247], v[108:111]
  buffer_load_dwordx4 v[236:239], off, s[64:67], s50 offset:1024 sc1
  v_mfma_f32_16x16x32_bf16 v[104:107], v[196:199], v[240:243], v[104:107]
  ds_read_b64_tr_b16 v[164:165], v21 offset:32768
  ds_read_b64_tr_b16 v[166:167], v21 offset:34816
  v_mfma_f32_16x16x32_bf16 v[112:115], v[200:203], v[240:243], v[112:115]
  ds_read_b64_tr_b16 v[168:169], v22 offset:32768
  v_mfma_f32_16x16x32_bf16 v[116:119], v[200:203], v[244:247], v[116:119]
  ds_read_b64_tr_b16 v[170:171], v22 offset:34816
  v_mfma_f32_16x16x32_bf16 v[124:127], v[204:207], v[244:247], v[124:127]
  ds_read_b64_tr_b16 v[172:173], v23 offset:32768
  v_mfma_f32_16x16x32_bf16 v[120:123], v[204:207], v[240:243], v[120:123]
  ds_read_b64_tr_b16 v[174:175], v23 offset:34816
  s_waitcnt lgkmcnt(8)
  s_barrier
  v_mfma_f32_16x16x32_bf16 v[96:99], v[208:211], v[248:251], v[96:99]
  ds_read_b64_tr_b16 v[176:177], v20 offset:36864
  v_mfma_f32_16x16x32_bf16 v[100:103], v[208:211], v[252:255], v[100:103]
  ds_read_b64_tr_b16 v[178:179], v20 offset:38912
  v_mfma_f32_16x16x32_bf16 v[108:111], v[212:215], v[252:255], v[108:111]
  ds_read_b64_tr_b16 v[180:181], v21 offset:36864
  v_mfma_f32_16x16x32_bf16 v[104:107], v[212:215], v[248:251], v[104:107]
  ds_read_b64_tr_b16 v[182:183], v21 offset:38912
  v_mfma_f32_16x16x32_bf16 v[112:115], v[216:219], v[248:251], v[112:115]
  ds_read_b64_tr_b16 v[184:185], v22 offset:36864
  v_mfma_f32_16x16x32_bf16 v[116:119], v[216:219], v[252:255], v[116:119]
  ds_read_b64_tr_b16 v[186:187], v22 offset:38912
  v_readlane_b32 s51, v30, 11
  v_mfma_f32_16x16x32_bf16 v[124:127], v[220:223], v[252:255], v[124:127]
  ds_read_b64_tr_b16 v[188:189], v23 offset:36864
  v_mfma_f32_16x16x32_bf16 v[120:123], v[220:223], v[248:251], v[120:123]
  ds_read_b64_tr_b16 v[190:191], v23 offset:38912
  s_waitcnt vmcnt(18) lgkmcnt(8)
  v_mfma_f32_16x16x32_bf16 v[128:131], v[160:163], v[32:35], v[128:131]
  buffer_load_dwordx4 v[240:243], off, s[36:39], s51 offset:0 sc1
  v_mfma_f32_16x16x32_bf16 v[132:135], v[160:163], v[36:39], v[132:135]
  ds_read_b64_tr_b16 v[192:193], v20 offset:40960
  ds_read_b64_tr_b16 v[194:195], v20 offset:43008
  v_mfma_f32_16x16x32_bf16 v[140:143], v[164:167], v[36:39], v[140:143]
  ds_read_b64_tr_b16 v[196:197], v21 offset:40960
  v_mfma_f32_16x16x32_bf16 v[136:139], v[164:167], v[32:35], v[136:139]
  ds_read_b64_tr_b16 v[198:199], v21 offset:43008
  v_mfma_f32_16x16x32_bf16 v[144:147], v[168:171], v[32:35], v[144:147]
  ds_read_b64_tr_b16 v[200:201], v22 offset:40960
  v_mfma_f32_16x16x32_bf16 v[148:151], v[168:171], v[36:39], v[148:151]
  ds_read_b64_tr_b16 v[202:203], v22 offset:43008
  ds_read_b64_tr_b16 v[204:205], v23 offset:40960
  v_mfma_f32_16x16x32_bf16 v[156:159], v[172:175], v[36:39], v[156:159]
  buffer_load_dwordx4 v[244:247], off, s[64:67], s51 offset:0 sc1
  v_mfma_f32_16x16x32_bf16 v[152:155], v[172:175], v[32:35], v[152:155]
  ds_read_b64_tr_b16 v[206:207], v23 offset:43008
  s_waitcnt vmcnt(18) lgkmcnt(8)
  v_mfma_f32_16x16x32_bf16 v[128:131], v[176:179], v[40:43], v[128:131]
  ds_read_b64_tr_b16 v[208:209], v20 offset:45056
  v_mfma_f32_16x16x32_bf16 v[132:135], v[176:179], v[44:47], v[132:135]
  ds_read_b64_tr_b16 v[210:211], v20 offset:47104
  v_mfma_f32_16x16x32_bf16 v[140:143], v[180:183], v[44:47], v[140:143]
  ds_read_b64_tr_b16 v[212:213], v21 offset:45056
  v_mfma_f32_16x16x32_bf16 v[136:139], v[180:183], v[40:43], v[136:139]
  ds_read_b64_tr_b16 v[214:215], v21 offset:47104
  v_mfma_f32_16x16x32_bf16 v[144:147], v[184:187], v[40:43], v[144:147]
  buffer_load_dwordx4 v[248:251], off, s[36:39], s51 offset:1024 sc1
  v_mfma_f32_16x16x32_bf16 v[148:151], v[184:187], v[44:47], v[148:151]
  ds_read_b64_tr_b16 v[216:217], v22 offset:45056
  ds_read_b64_tr_b16 v[218:219], v22 offset:47104
  v_mfma_f32_16x16x32_bf16 v[156:159], v[188:191], v[44:47], v[156:159]
  ds_read_b64_tr_b16 v[220:221], v23 offset:45056
  v_mfma_f32_16x16x32_bf16 v[152:155], v[188:191], v[40:43], v[152:155]
  ds_read_b64_tr_b16 v[222:223], v23 offset:47104
  s_waitcnt lgkmcnt(8)
  v_mfma_f32_16x16x32_bf16 v[96:99], v[192:195], v[32:35], v[96:99]
  ds_read_b64_tr_b16 v[160:161], v20 offset:49152
  v_mfma_f32_16x16x32_bf16 v[100:103], v[192:195], v[36:39], v[100:103]
  ds_read_b64_tr_b16 v[162:163], v20 offset:51200
  v_mfma_f32_16x16x32_bf16 v[108:111], v[196:199], v[36:39], v[108:111]
  buffer_load_dwordx4 v[252:255], off, s[64:67], s51 offset:1024 sc1
  v_mfma_f32_16x16x32_bf16 v[104:107], v[196:199], v[32:35], v[104:107]
  ds_read_b64_tr_b16 v[164:165], v21 offset:49152
  ds_read_b64_tr_b16 v[166:167], v21 offset:51200
  v_mfma_f32_16x16x32_bf16 v[112:115], v[200:203], v[32:35], v[112:115]
  ds_read_b64_tr_b16 v[168:169], v22 offset:49152
  v_mfma_f32_16x16x32_bf16 v[116:119], v[200:203], v[36:39], v[116:119]
  ds_read_b64_tr_b16 v[170:171], v22 offset:51200
  v_mfma_f32_16x16x32_bf16 v[124:127], v[204:207], v[36:39], v[124:127]
  ds_read_b64_tr_b16 v[172:173], v23 offset:49152
  v_mfma_f32_16x16x32_bf16 v[120:123], v[204:207], v[32:35], v[120:123]
  ds_read_b64_tr_b16 v[174:175], v23 offset:51200
  s_waitcnt lgkmcnt(8)
  v_mfma_f32_16x16x32_bf16 v[96:99], v[208:211], v[40:43], v[96:99]
  ds_read_b64_tr_b16 v[176:177], v20 offset:53248
  v_mfma_f32_16x16x32_bf16 v[100:103], v[208:211], v[44:47], v[100:103]
  ds_read_b64_tr_b16 v[178:179], v20 offset:55296
  v_mfma_f32_16x16x32_bf16 v[108:111], v[212:215], v[44:47], v[108:111]
  ds_read_b64_tr_b16 v[180:181], v21 offset:53248
  v_mfma_f32_16x16x32_bf16 v[104:107], v[212:215], v[40:43], v[104:107]
  ds_read_b64_tr_b16 v[182:183], v21 offset:55296
  v_mfma_f32_16x16x32_bf16 v[112:115], v[216:219], v[40:43], v[112:115]
  ds_read_b64_tr_b16 v[184:185], v22 offset:53248
  v_mfma_f32_16x16x32_bf16 v[116:119], v[216:219], v[44:47], v[116:119]
  ds_read_b64_tr_b16 v[186:187], v22 offset:55296
  v_readlane_b32 s48, v30, 12
  v_mfma_f32_16x16x32_bf16 v[124:127], v[220:223], v[44:47], v[124:127]
  ds_read_b64_tr_b16 v[188:189], v23 offset:53248
  v_mfma_f32_16x16x32_bf16 v[120:123], v[220:223], v[40:43], v[120:123]
  ds_read_b64_tr_b16 v[190:191], v23 offset:55296
  s_waitcnt vmcnt(18) lgkmcnt(8)
  v_mfma_f32_16x16x32_bf16 v[128:131], v[160:163], v[48:51], v[128:131]
  buffer_load_dwordx4 v[32:35], off, s[36:39], s48 offset:0 sc1
  v_mfma_f32_16x16x32_bf16 v[132:135], v[160:163], v[52:55], v[132:135]
  ds_read_b64_tr_b16 v[192:193], v20 offset:57344
  ds_read_b64_tr_b16 v[194:195], v20 offset:59392
  v_mfma_f32_16x16x32_bf16 v[140:143], v[164:167], v[52:55], v[140:143]
  ds_read_b64_tr_b16 v[196:197], v21 offset:57344
  v_mfma_f32_16x16x32_bf16 v[136:139], v[164:167], v[48:51], v[136:139]
  ds_read_b64_tr_b16 v[198:199], v21 offset:59392
  v_mfma_f32_16x16x32_bf16 v[144:147], v[168:171], v[48:51], v[144:147]
  ds_read_b64_tr_b16 v[200:201], v22 offset:57344
  v_mfma_f32_16x16x32_bf16 v[148:151], v[168:171], v[52:55], v[148:151]
  ds_read_b64_tr_b16 v[202:203], v22 offset:59392
  ds_read_b64_tr_b16 v[204:205], v23 offset:57344
  v_mfma_f32_16x16x32_bf16 v[156:159], v[172:175], v[52:55], v[156:159]
  buffer_load_dwordx4 v[36:39], off, s[64:67], s48 offset:0 sc1
  v_mfma_f32_16x16x32_bf16 v[152:155], v[172:175], v[48:51], v[152:155]
  ds_read_b64_tr_b16 v[206:207], v23 offset:59392
  s_waitcnt vmcnt(18) lgkmcnt(8)
  v_mfma_f32_16x16x32_bf16 v[128:131], v[176:179], v[56:59], v[128:131]
  ds_read_b64_tr_b16 v[208:209], v20 offset:61440
  v_mfma_f32_16x16x32_bf16 v[132:135], v[176:179], v[60:63], v[132:135]
  ds_read_b64_tr_b16 v[210:211], v20 offset:63488
  v_mfma_f32_16x16x32_bf16 v[140:143], v[180:183], v[60:63], v[140:143]
  ds_read_b64_tr_b16 v[212:213], v21 offset:61440
  v_mfma_f32_16x16x32_bf16 v[136:139], v[180:183], v[56:59], v[136:139]
  ds_read_b64_tr_b16 v[214:215], v21 offset:63488
  v_mfma_f32_16x16x32_bf16 v[144:147], v[184:187], v[56:59], v[144:147]
  buffer_load_dwordx4 v[40:43], off, s[36:39], s48 offset:1024 sc1
  v_mfma_f32_16x16x32_bf16 v[148:151], v[184:187], v[60:63], v[148:151]
  ds_read_b64_tr_b16 v[216:217], v22 offset:61440
  ds_read_b64_tr_b16 v[218:219], v22 offset:63488
  v_mfma_f32_16x16x32_bf16 v[156:159], v[188:191], v[60:63], v[156:159]
  ds_read_b64_tr_b16 v[220:221], v23 offset:61440
  v_mfma_f32_16x16x32_bf16 v[152:155], v[188:191], v[56:59], v[152:155]
  ds_read_b64_tr_b16 v[222:223], v23 offset:63488
  s_waitcnt lgkmcnt(8)
  v_mfma_f32_16x16x32_bf16 v[96:99], v[192:195], v[48:51], v[96:99]
  ds_read_b64_tr_b16 v[160:161], v26 offset:0
  v_mfma_f32_16x16x32_bf16 v[100:103], v[192:195], v[52:55], v[100:103]
  ds_read_b64_tr_b16 v[162:163], v26 offset:2048
  v_mfma_f32_16x16x32_bf16 v[108:111], v[196:199], v[52:55], v[108:111]
  buffer_load_dwordx4 v[44:47], off, s[64:67], s48 offset:1024 sc1
  v_mfma_f32_16x16x32_bf16 v[104:107], v[196:199], v[48:51], v[104:107]
  ds_read_b64_tr_b16 v[164:165], v27 offset:0
  ds_read_b64_tr_b16 v[166:167], v27 offset:2048
  v_mfma_f32_16x16x32_bf16 v[112:115], v[200:203], v[48:51], v[112:115]
  ds_read_b64_tr_b16 v[168:169], v28 offset:0
  v_mfma_f32_16x16x32_bf16 v[116:119], v[200:203], v[52:55], v[116:119]
  ds_read_b64_tr_b16 v[170:171], v28 offset:2048
  v_mfma_f32_16x16x32_bf16 v[124:127], v[204:207], v[52:55], v[124:127]
  ds_read_b64_tr_b16 v[172:173], v29 offset:0
  v_mfma_f32_16x16x32_bf16 v[120:123], v[204:207], v[48:51], v[120:123]
  ds_read_b64_tr_b16 v[174:175], v29 offset:2048
  s_waitcnt lgkmcnt(8)
  s_barrier
  v_mfma_f32_16x16x32_bf16 v[96:99], v[208:211], v[56:59], v[96:99]
  ds_read_b64_tr_b16 v[176:177], v26 offset:4096
  v_mfma_f32_16x16x32_bf16 v[100:103], v[208:211], v[60:63], v[100:103]
  ds_read_b64_tr_b16 v[178:179], v26 offset:6144
  v_mfma_f32_16x16x32_bf16 v[108:111], v[212:215], v[60:63], v[108:111]
  ds_read_b64_tr_b16 v[180:181], v27 offset:4096
  v_mfma_f32_16x16x32_bf16 v[104:107], v[212:215], v[56:59], v[104:107]
  ds_read_b64_tr_b16 v[182:183], v27 offset:6144
  v_mfma_f32_16x16x32_bf16 v[112:115], v[216:219], v[56:59], v[112:115]
  ds_read_b64_tr_b16 v[184:185], v28 offset:4096
  v_mfma_f32_16x16x32_bf16 v[116:119], v[216:219], v[60:63], v[116:119]
  ds_read_b64_tr_b16 v[186:187], v28 offset:6144
  v_readlane_b32 s49, v30, 13
  v_mfma_f32_16x16x32_bf16 v[124:127], v[220:223], v[60:63], v[124:127]
  ds_read_b64_tr_b16 v[188:189], v29 offset:4096
  v_mfma_f32_16x16x32_bf16 v[120:123], v[220:223], v[56:59], v[120:123]
  ds_read_b64_tr_b16 v[190:191], v29 offset:6144
  s_waitcnt vmcnt(18) lgkmcnt(8)
  v_mfma_f32_16x16x32_bf16 v[128:131], v[160:163], v[64:67], v[128:131]
  buffer_load_dwordx4 v[48:51], off, s[36:39], s49 offset:0 sc1
  v_mfma_f32_16x16x32_bf16 v[132:135], v[160:163], v[68:71], v[132:135]
  ds_read_b64_tr_b16 v[192:193], v26 offset:8192
  ds_read_b64_tr_b16 v[194:195], v26 offset:10240
  v_mfma_f32_16x16x32_bf16 v[140:143], v[164:167], v[68:71], v[140:143]
  ds_read_b64_tr_b16 v[196:197], v27 offset:8192
  v_mfma_f32_16x16x32_bf16 v[136:139], v[164:167], v[64:67], v[136:139]
  ds_read_b64_tr_b16 v[198:199], v27 offset:10240
  v_mfma_f32_16x16x32_bf16 v[144:147], v[168:171], v[64:67], v[144:147]
  ds_read_b64_tr_b16 v[200:201], v28 offset:8192
  v_mfma_f32_16x16x32_bf16 v[148:151], v[168:171], v[68:71], v[148:151]
  ds_read_b64_tr_b16 v[202:203], v28 offset:10240
  ds_read_b64_tr_b16 v[204:205], v29 offset:8192
  v_mfma_f32_16x16x32_bf16 v[156:159], v[172:175], v[68:71], v[156:159]
  buffer_load_dwordx4 v[52:55], off, s[64:67], s49 offset:0 sc1
  v_mfma_f32_16x16x32_bf16 v[152:155], v[172:175], v[64:67], v[152:155]
  ds_read_b64_tr_b16 v[206:207], v29 offset:10240
  s_waitcnt vmcnt(18) lgkmcnt(8)
  v_mfma_f32_16x16x32_bf16 v[128:131], v[176:179], v[72:75], v[128:131]
  ds_read_b64_tr_b16 v[208:209], v26 offset:12288
  v_mfma_f32_16x16x32_bf16 v[132:135], v[176:179], v[76:79], v[132:135]
  ds_read_b64_tr_b16 v[210:211], v26 offset:14336
  v_mfma_f32_16x16x32_bf16 v[140:143], v[180:183], v[76:79], v[140:143]
  ds_read_b64_tr_b16 v[212:213], v27 offset:12288
  v_mfma_f32_16x16x32_bf16 v[136:139], v[180:183], v[72:75], v[136:139]
  ds_read_b64_tr_b16 v[214:215], v27 offset:14336
  v_mfma_f32_16x16x32_bf16 v[144:147], v[184:187], v[72:75], v[144:147]
  buffer_load_dwordx4 v[56:59], off, s[36:39], s49 offset:1024 sc1
  v_mfma_f32_16x16x32_bf16 v[148:151], v[184:187], v[76:79], v[148:151]
  ds_read_b64_tr_b16 v[216:217], v28 offset:12288
  ds_read_b64_tr_b16 v[218:219], v28 offset:14336
  v_mfma_f32_16x16x32_bf16 v[156:159], v[188:191], v[76:79], v[156:159]
  ds_read_b64_tr_b16 v[220:221], v29 offset:12288
  v_mfma_f32_16x16x32_bf16 v[152:155], v[188:191], v[72:75], v[152:155]
  ds_read_b64_tr_b16 v[222:223], v29 offset:14336
  s_waitcnt lgkmcnt(8)
  v_mfma_f32_16x16x32_bf16 v[96:99], v[192:195], v[64:67], v[96:99]
  ds_read_b64_tr_b16 v[160:161], v26 offset:16384
  v_mfma_f32_16x16x32_bf16 v[100:103], v[192:195], v[68:71], v[100:103]
  ds_read_b64_tr_b16 v[162:163], v26 offset:18432
  v_mfma_f32_16x16x32_bf16 v[108:111], v[196:199], v[68:71], v[108:111]
  buffer_load_dwordx4 v[60:63], off, s[64:67], s49 offset:1024 sc1
  v_mfma_f32_16x16x32_bf16 v[104:107], v[196:199], v[64:67], v[104:107]
  ds_read_b64_tr_b16 v[164:165], v27 offset:16384
  ds_read_b64_tr_b16 v[166:167], v27 offset:18432
  v_mfma_f32_16x16x32_bf16 v[112:115], v[200:203], v[64:67], v[112:115]
  ds_read_b64_tr_b16 v[168:169], v28 offset:16384
  v_mfma_f32_16x16x32_bf16 v[116:119], v[200:203], v[68:71], v[116:119]
  ds_read_b64_tr_b16 v[170:171], v28 offset:18432
  v_mfma_f32_16x16x32_bf16 v[124:127], v[204:207], v[68:71], v[124:127]
  ds_read_b64_tr_b16 v[172:173], v29 offset:16384
  v_mfma_f32_16x16x32_bf16 v[120:123], v[204:207], v[64:67], v[120:123]
  ds_read_b64_tr_b16 v[174:175], v29 offset:18432
  s_waitcnt lgkmcnt(8)
  v_mfma_f32_16x16x32_bf16 v[96:99], v[208:211], v[72:75], v[96:99]
  ds_read_b64_tr_b16 v[176:177], v26 offset:20480
  v_mfma_f32_16x16x32_bf16 v[100:103], v[208:211], v[76:79], v[100:103]
  ds_read_b64_tr_b16 v[178:179], v26 offset:22528
  v_mfma_f32_16x16x32_bf16 v[108:111], v[212:215], v[76:79], v[108:111]
  ds_read_b64_tr_b16 v[180:181], v27 offset:20480
  v_mfma_f32_16x16x32_bf16 v[104:107], v[212:215], v[72:75], v[104:107]
  ds_read_b64_tr_b16 v[182:183], v27 offset:22528
  v_mfma_f32_16x16x32_bf16 v[112:115], v[216:219], v[72:75], v[112:115]
  ds_read_b64_tr_b16 v[184:185], v28 offset:20480
  v_mfma_f32_16x16x32_bf16 v[116:119], v[216:219], v[76:79], v[116:119]
  ds_read_b64_tr_b16 v[186:187], v28 offset:22528
  v_readlane_b32 s50, v30, 14
  v_mfma_f32_16x16x32_bf16 v[124:127], v[220:223], v[76:79], v[124:127]
  ds_read_b64_tr_b16 v[188:189], v29 offset:20480
  v_mfma_f32_16x16x32_bf16 v[120:123], v[220:223], v[72:75], v[120:123]
  ds_read_b64_tr_b16 v[190:191], v29 offset:22528
  s_waitcnt vmcnt(18) lgkmcnt(8)
  v_mfma_f32_16x16x32_bf16 v[128:131], v[160:163], v[80:83], v[128:131]
  buffer_load_dwordx4 v[64:67], off, s[36:39], s50 offset:0 sc1
  v_mfma_f32_16x16x32_bf16 v[132:135], v[160:163], v[84:87], v[132:135]
  ds_read_b64_tr_b16 v[192:193], v26 offset:24576
  ds_read_b64_tr_b16 v[194:195], v26 offset:26624
  v_mfma_f32_16x16x32_bf16 v[140:143], v[164:167], v[84:87], v[140:143]
  ds_read_b64_tr_b16 v[196:197], v27 offset:24576
  v_mfma_f32_16x16x32_bf16 v[136:139], v[164:167], v[80:83], v[136:139]
  ds_read_b64_tr_b16 v[198:199], v27 offset:26624
  v_mfma_f32_16x16x32_bf16 v[144:147], v[168:171], v[80:83], v[144:147]
  ds_read_b64_tr_b16 v[200:201], v28 offset:24576
  v_mfma_f32_16x16x32_bf16 v[148:151], v[168:171], v[84:87], v[148:151]
  ds_read_b64_tr_b16 v[202:203], v28 offset:26624
  ds_read_b64_tr_b16 v[204:205], v29 offset:24576
  v_mfma_f32_16x16x32_bf16 v[156:159], v[172:175], v[84:87], v[156:159]
  buffer_load_dwordx4 v[68:71], off, s[64:67], s50 offset:0 sc1
  v_mfma_f32_16x16x32_bf16 v[152:155], v[172:175], v[80:83], v[152:155]
  ds_read_b64_tr_b16 v[206:207], v29 offset:26624
  s_waitcnt vmcnt(18) lgkmcnt(8)
  v_mfma_f32_16x16x32_bf16 v[128:131], v[176:179], v[88:91], v[128:131]
  ds_read_b64_tr_b16 v[208:209], v26 offset:28672
  v_mfma_f32_16x16x32_bf16 v[132:135], v[176:179], v[92:95], v[132:135]
  ds_read_b64_tr_b16 v[210:211], v26 offset:30720
  v_mfma_f32_16x16x32_bf16 v[140:143], v[180:183], v[92:95], v[140:143]
  ds_read_b64_tr_b16 v[212:213], v27 offset:28672
  v_mfma_f32_16x16x32_bf16 v[136:139], v[180:183], v[88:91], v[136:139]
  ds_read_b64_tr_b16 v[214:215], v27 offset:30720
  v_mfma_f32_16x16x32_bf16 v[144:147], v[184:187], v[88:91], v[144:147]
  buffer_load_dwordx4 v[72:75], off, s[36:39], s50 offset:1024 sc1
  v_mfma_f32_16x16x32_bf16 v[148:151], v[184:187], v[92:95], v[148:151]
  ds_read_b64_tr_b16 v[216:217], v28 offset:28672
  ds_read_b64_tr_b16 v[218:219], v28 offset:30720
  v_mfma_f32_16x16x32_bf16 v[156:159], v[188:191], v[92:95], v[156:159]
  ds_read_b64_tr_b16 v[220:221], v29 offset:28672
  v_mfma_f32_16x16x32_bf16 v[152:155], v[188:191], v[88:91], v[152:155]
  ds_read_b64_tr_b16 v[222:223], v29 offset:30720
  s_waitcnt lgkmcnt(8)
  v_mfma_f32_16x16x32_bf16 v[96:99], v[192:195], v[80:83], v[96:99]
  ds_read_b64_tr_b16 v[160:161], v6 offset:0
  v_mfma_f32_16x16x32_bf16 v[100:103], v[192:195], v[84:87], v[100:103]
  ds_read_b64_tr_b16 v[162:163], v6 offset:2048
  v_mfma_f32_16x16x32_bf16 v[108:111], v[196:199], v[84:87], v[108:111]
  buffer_load_dwordx4 v[76:79], off, s[64:67], s50 offset:1024 sc1
  v_mfma_f32_16x16x32_bf16 v[104:107], v[196:199], v[80:83], v[104:107]
  ds_read_b64_tr_b16 v[164:165], v7 offset:0
  ds_read_b64_tr_b16 v[166:167], v7 offset:2048
  v_mfma_f32_16x16x32_bf16 v[112:115], v[200:203], v[80:83], v[112:115]
  ds_read_b64_tr_b16 v[168:169], v8 offset:0
  v_mfma_f32_16x16x32_bf16 v[116:119], v[200:203], v[84:87], v[116:119]
  ds_read_b64_tr_b16 v[170:171], v8 offset:2048
  v_mfma_f32_16x16x32_bf16 v[124:127], v[204:207], v[84:87], v[124:127]
  ds_read_b64_tr_b16 v[172:173], v9 offset:0
  v_mfma_f32_16x16x32_bf16 v[120:123], v[204:207], v[80:83], v[120:123]
  ds_read_b64_tr_b16 v[174:175], v9 offset:2048
  s_waitcnt lgkmcnt(8)
  s_barrier
  v_mfma_f32_16x16x32_bf16 v[96:99], v[208:211], v[88:91], v[96:99]
  ds_read_b64_tr_b16 v[176:177], v6 offset:4096
  v_mfma_f32_16x16x32_bf16 v[100:103], v[208:211], v[92:95], v[100:103]
  ds_read_b64_tr_b16 v[178:179], v6 offset:6144
  v_mfma_f32_16x16x32_bf16 v[108:111], v[212:215], v[92:95], v[108:111]
  ds_read_b64_tr_b16 v[180:181], v7 offset:4096
  v_mfma_f32_16x16x32_bf16 v[104:107], v[212:215], v[88:91], v[104:107]
  ds_read_b64_tr_b16 v[182:183], v7 offset:6144
  v_mfma_f32_16x16x32_bf16 v[112:115], v[216:219], v[88:91], v[112:115]
  ds_read_b64_tr_b16 v[184:185], v8 offset:4096
  v_mfma_f32_16x16x32_bf16 v[116:119], v[216:219], v[92:95], v[116:119]
  ds_read_b64_tr_b16 v[186:187], v8 offset:6144
  v_readlane_b32 s51, v30, 15
  v_mfma_f32_16x16x32_bf16 v[124:127], v[220:223], v[92:95], v[124:127]
  ds_read_b64_tr_b16 v[188:189], v9 offset:4096
  v_mfma_f32_16x16x32_bf16 v[120:123], v[220:223], v[88:91], v[120:123]
  ds_read_b64_tr_b16 v[190:191], v9 offset:6144
  s_waitcnt vmcnt(18) lgkmcnt(8)
  v_mfma_f32_16x16x32_bf16 v[128:131], v[160:163], v[224:227], v[128:131]
  buffer_load_dwordx4 v[80:83], off, s[36:39], s51 offset:0 sc1
  v_mfma_f32_16x16x32_bf16 v[132:135], v[160:163], v[228:231], v[132:135]
  ds_read_b64_tr_b16 v[192:193], v6 offset:8192
  ds_read_b64_tr_b16 v[194:195], v6 offset:10240
  v_mfma_f32_16x16x32_bf16 v[140:143], v[164:167], v[228:231], v[140:143]
  ds_read_b64_tr_b16 v[196:197], v7 offset:8192
  v_mfma_f32_16x16x32_bf16 v[136:139], v[164:167], v[224:227], v[136:139]
  ds_read_b64_tr_b16 v[198:199], v7 offset:10240
  v_mfma_f32_16x16x32_bf16 v[144:147], v[168:171], v[224:227], v[144:147]
  ds_read_b64_tr_b16 v[200:201], v8 offset:8192
  v_mfma_f32_16x16x32_bf16 v[148:151], v[168:171], v[228:231], v[148:151]
  ds_read_b64_tr_b16 v[202:203], v8 offset:10240
  ds_read_b64_tr_b16 v[204:205], v9 offset:8192
  v_mfma_f32_16x16x32_bf16 v[156:159], v[172:175], v[228:231], v[156:159]
  buffer_load_dwordx4 v[84:87], off, s[64:67], s51 offset:0 sc1
  v_mfma_f32_16x16x32_bf16 v[152:155], v[172:175], v[224:227], v[152:155]
  ds_read_b64_tr_b16 v[206:207], v9 offset:10240
  s_waitcnt vmcnt(18) lgkmcnt(8)
  v_mfma_f32_16x16x32_bf16 v[128:131], v[176:179], v[232:235], v[128:131]
  ds_read_b64_tr_b16 v[208:209], v6 offset:12288
  v_mfma_f32_16x16x32_bf16 v[132:135], v[176:179], v[236:239], v[132:135]
  ds_read_b64_tr_b16 v[210:211], v6 offset:14336
  v_mfma_f32_16x16x32_bf16 v[140:143], v[180:183], v[236:239], v[140:143]
  ds_read_b64_tr_b16 v[212:213], v7 offset:12288
  v_mfma_f32_16x16x32_bf16 v[136:139], v[180:183], v[232:235], v[136:139]
  ds_read_b64_tr_b16 v[214:215], v7 offset:14336
  v_mfma_f32_16x16x32_bf16 v[144:147], v[184:187], v[232:235], v[144:147]
  buffer_load_dwordx4 v[88:91], off, s[36:39], s51 offset:1024 sc1
  v_mfma_f32_16x16x32_bf16 v[148:151], v[184:187], v[236:239], v[148:151]
  ds_read_b64_tr_b16 v[216:217], v8 offset:12288
  ds_read_b64_tr_b16 v[218:219], v8 offset:14336
  v_mfma_f32_16x16x32_bf16 v[156:159], v[188:191], v[236:239], v[156:159]
  ds_read_b64_tr_b16 v[220:221], v9 offset:12288
  v_mfma_f32_16x16x32_bf16 v[152:155], v[188:191], v[232:235], v[152:155]
  ds_read_b64_tr_b16 v[222:223], v9 offset:14336
  s_waitcnt lgkmcnt(8)
  v_mfma_f32_16x16x32_bf16 v[96:99], v[192:195], v[224:227], v[96:99]
  ds_read_b64_tr_b16 v[160:161], v6 offset:16384
  v_mfma_f32_16x16x32_bf16 v[100:103], v[192:195], v[228:231], v[100:103]
  ds_read_b64_tr_b16 v[162:163], v6 offset:18432
  v_mfma_f32_16x16x32_bf16 v[108:111], v[196:199], v[228:231], v[108:111]
  buffer_load_dwordx4 v[92:95], off, s[64:67], s51 offset:1024 sc1
  v_mfma_f32_16x16x32_bf16 v[104:107], v[196:199], v[224:227], v[104:107]
  ds_read_b64_tr_b16 v[164:165], v7 offset:16384
  ds_read_b64_tr_b16 v[166:167], v7 offset:18432
  v_mfma_f32_16x16x32_bf16 v[112:115], v[200:203], v[224:227], v[112:115]
  ds_read_b64_tr_b16 v[168:169], v8 offset:16384
  v_mfma_f32_16x16x32_bf16 v[116:119], v[200:203], v[228:231], v[116:119]
  ds_read_b64_tr_b16 v[170:171], v8 offset:18432
  v_mfma_f32_16x16x32_bf16 v[124:127], v[204:207], v[228:231], v[124:127]
  ds_read_b64_tr_b16 v[172:173], v9 offset:16384
  v_mfma_f32_16x16x32_bf16 v[120:123], v[204:207], v[224:227], v[120:123]
  ds_read_b64_tr_b16 v[174:175], v9 offset:18432
  s_waitcnt lgkmcnt(8)
  v_mfma_f32_16x16x32_bf16 v[96:99], v[208:211], v[232:235], v[96:99]
  ds_read_b64_tr_b16 v[176:177], v6 offset:20480
  v_mfma_f32_16x16x32_bf16 v[100:103], v[208:211], v[236:239], v[100:103]
  ds_read_b64_tr_b16 v[178:179], v6 offset:22528
  v_mfma_f32_16x16x32_bf16 v[108:111], v[212:215], v[236:239], v[108:111]
  ds_read_b64_tr_b16 v[180:181], v7 offset:20480
  v_mfma_f32_16x16x32_bf16 v[104:107], v[212:215], v[232:235], v[104:107]
  ds_read_b64_tr_b16 v[182:183], v7 offset:22528
  v_mfma_f32_16x16x32_bf16 v[112:115], v[216:219], v[232:235], v[112:115]
  ds_read_b64_tr_b16 v[184:185], v8 offset:20480
  v_mfma_f32_16x16x32_bf16 v[116:119], v[216:219], v[236:239], v[116:119]
  ds_read_b64_tr_b16 v[186:187], v8 offset:22528
  v_readlane_b32 s48, v30, 16
  v_mfma_f32_16x16x32_bf16 v[124:127], v[220:223], v[236:239], v[124:127]
  ds_read_b64_tr_b16 v[188:189], v9 offset:20480
  v_mfma_f32_16x16x32_bf16 v[120:123], v[220:223], v[232:235], v[120:123]
  ds_read_b64_tr_b16 v[190:191], v9 offset:22528
  s_waitcnt vmcnt(18) lgkmcnt(8)
  v_mfma_f32_16x16x32_bf16 v[128:131], v[160:163], v[240:243], v[128:131]
  buffer_load_dwordx4 v[224:227], off, s[36:39], s48 offset:0 sc1
  v_mfma_f32_16x16x32_bf16 v[132:135], v[160:163], v[244:247], v[132:135]
  ds_read_b64_tr_b16 v[192:193], v6 offset:24576
  ds_read_b64_tr_b16 v[194:195], v6 offset:26624
  v_mfma_f32_16x16x32_bf16 v[140:143], v[164:167], v[244:247], v[140:143]
  ds_read_b64_tr_b16 v[196:197], v7 offset:24576
  v_mfma_f32_16x16x32_bf16 v[136:139], v[164:167], v[240:243], v[136:139]
  ds_read_b64_tr_b16 v[198:199], v7 offset:26624
  v_mfma_f32_16x16x32_bf16 v[144:147], v[168:171], v[240:243], v[144:147]
  ds_read_b64_tr_b16 v[200:201], v8 offset:24576
  v_mfma_f32_16x16x32_bf16 v[148:151], v[168:171], v[244:247], v[148:151]
  ds_read_b64_tr_b16 v[202:203], v8 offset:26624
  ds_read_b64_tr_b16 v[204:205], v9 offset:24576
  v_mfma_f32_16x16x32_bf16 v[156:159], v[172:175], v[244:247], v[156:159]
  buffer_load_dwordx4 v[228:231], off, s[64:67], s48 offset:0 sc1
  v_mfma_f32_16x16x32_bf16 v[152:155], v[172:175], v[240:243], v[152:155]
  ds_read_b64_tr_b16 v[206:207], v9 offset:26624
  s_waitcnt vmcnt(18) lgkmcnt(8)
  v_mfma_f32_16x16x32_bf16 v[128:131], v[176:179], v[248:251], v[128:131]
  ds_read_b64_tr_b16 v[208:209], v6 offset:28672
  v_mfma_f32_16x16x32_bf16 v[132:135], v[176:179], v[252:255], v[132:135]
  ds_read_b64_tr_b16 v[210:211], v6 offset:30720
  v_mfma_f32_16x16x32_bf16 v[140:143], v[180:183], v[252:255], v[140:143]
  ds_read_b64_tr_b16 v[212:213], v7 offset:28672
  v_mfma_f32_16x16x32_bf16 v[136:139], v[180:183], v[248:251], v[136:139]
  ds_read_b64_tr_b16 v[214:215], v7 offset:30720
  v_mfma_f32_16x16x32_bf16 v[144:147], v[184:187], v[248:251], v[144:147]
  buffer_load_dwordx4 v[232:235], off, s[36:39], s48 offset:1024 sc1
  v_mfma_f32_16x16x32_bf16 v[148:151], v[184:187], v[252:255], v[148:151]
  ds_read_b64_tr_b16 v[216:217], v8 offset:28672
  ds_read_b64_tr_b16 v[218:219], v8 offset:30720
  v_mfma_f32_16x16x32_bf16 v[156:159], v[188:191], v[252:255], v[156:159]
  ds_read_b64_tr_b16 v[220:221], v9 offset:28672
  v_mfma_f32_16x16x32_bf16 v[152:155], v[188:191], v[248:251], v[152:155]
  ds_read_b64_tr_b16 v[222:223], v9 offset:30720
  s_waitcnt lgkmcnt(8)
  v_mfma_f32_16x16x32_bf16 v[96:99], v[192:195], v[240:243], v[96:99]
  ds_read_b64_tr_b16 v[160:161], v6 offset:32768
  v_mfma_f32_16x16x32_bf16 v[100:103], v[192:195], v[244:247], v[100:103]
  ds_read_b64_tr_b16 v[162:163], v6 offset:34816
  v_mfma_f32_16x16x32_bf16 v[108:111], v[196:199], v[244:247], v[108:111]
  buffer_load_dwordx4 v[236:239], off, s[64:67], s48 offset:1024 sc1
  v_mfma_f32_16x16x32_bf16 v[104:107], v[196:199], v[240:243], v[104:107]
  ds_read_b64_tr_b16 v[164:165], v7 offset:32768
  ds_read_b64_tr_b16 v[166:167], v7 offset:34816
  v_mfma_f32_16x16x32_bf16 v[112:115], v[200:203], v[240:243], v[112:115]
  ds_read_b64_tr_b16 v[168:169], v8 offset:32768
  v_mfma_f32_16x16x32_bf16 v[116:119], v[200:203], v[244:247], v[116:119]
  ds_read_b64_tr_b16 v[170:171], v8 offset:34816
  v_mfma_f32_16x16x32_bf16 v[124:127], v[204:207], v[244:247], v[124:127]
  ds_read_b64_tr_b16 v[172:173], v9 offset:32768
  v_mfma_f32_16x16x32_bf16 v[120:123], v[204:207], v[240:243], v[120:123]
  ds_read_b64_tr_b16 v[174:175], v9 offset:34816
  s_waitcnt lgkmcnt(8)
  s_barrier
  v_mfma_f32_16x16x32_bf16 v[96:99], v[208:211], v[248:251], v[96:99]
  ds_read_b64_tr_b16 v[176:177], v6 offset:36864
  v_mfma_f32_16x16x32_bf16 v[100:103], v[208:211], v[252:255], v[100:103]
  ds_read_b64_tr_b16 v[178:179], v6 offset:38912
  v_mfma_f32_16x16x32_bf16 v[108:111], v[212:215], v[252:255], v[108:111]
  ds_read_b64_tr_b16 v[180:181], v7 offset:36864
  v_mfma_f32_16x16x32_bf16 v[104:107], v[212:215], v[248:251], v[104:107]
  ds_read_b64_tr_b16 v[182:183], v7 offset:38912
  v_mfma_f32_16x16x32_bf16 v[112:115], v[216:219], v[248:251], v[112:115]
  ds_read_b64_tr_b16 v[184:185], v8 offset:36864
  v_mfma_f32_16x16x32_bf16 v[116:119], v[216:219], v[252:255], v[116:119]
  ds_read_b64_tr_b16 v[186:187], v8 offset:38912
  v_readlane_b32 s49, v30, 17
  v_mfma_f32_16x16x32_bf16 v[124:127], v[220:223], v[252:255], v[124:127]
  ds_read_b64_tr_b16 v[188:189], v9 offset:36864
  v_mfma_f32_16x16x32_bf16 v[120:123], v[220:223], v[248:251], v[120:123]
  ds_read_b64_tr_b16 v[190:191], v9 offset:38912
  s_waitcnt vmcnt(18) lgkmcnt(8)
  v_mfma_f32_16x16x32_bf16 v[128:131], v[160:163], v[32:35], v[128:131]
  buffer_load_dwordx4 v[240:243], off, s[36:39], s49 offset:0 sc1
  v_mfma_f32_16x16x32_bf16 v[132:135], v[160:163], v[36:39], v[132:135]
  ds_read_b64_tr_b16 v[192:193], v6 offset:40960
  ds_read_b64_tr_b16 v[194:195], v6 offset:43008
  v_mfma_f32_16x16x32_bf16 v[140:143], v[164:167], v[36:39], v[140:143]
  ds_read_b64_tr_b16 v[196:197], v7 offset:40960
  v_mfma_f32_16x16x32_bf16 v[136:139], v[164:167], v[32:35], v[136:139]
  ds_read_b64_tr_b16 v[198:199], v7 offset:43008
  v_mfma_f32_16x16x32_bf16 v[144:147], v[168:171], v[32:35], v[144:147]
  ds_read_b64_tr_b16 v[200:201], v8 offset:40960
  v_mfma_f32_16x16x32_bf16 v[148:151], v[168:171], v[36:39], v[148:151]
  ds_read_b64_tr_b16 v[202:203], v8 offset:43008
  ds_read_b64_tr_b16 v[204:205], v9 offset:40960
  v_mfma_f32_16x16x32_bf16 v[156:159], v[172:175], v[36:39], v[156:159]
  buffer_load_dwordx4 v[244:247], off, s[64:67], s49 offset:0 sc1
  v_mfma_f32_16x16x32_bf16 v[152:155], v[172:175], v[32:35], v[152:155]
  ds_read_b64_tr_b16 v[206:207], v9 offset:43008
  s_waitcnt vmcnt(18) lgkmcnt(8)
  v_mfma_f32_16x16x32_bf16 v[128:131], v[176:179], v[40:43], v[128:131]
  ds_read_b64_tr_b16 v[208:209], v6 offset:45056
  v_mfma_f32_16x16x32_bf16 v[132:135], v[176:179], v[44:47], v[132:135]
  ds_read_b64_tr_b16 v[210:211], v6 offset:47104
  v_mfma_f32_16x16x32_bf16 v[140:143], v[180:183], v[44:47], v[140:143]
  ds_read_b64_tr_b16 v[212:213], v7 offset:45056
  v_mfma_f32_16x16x32_bf16 v[136:139], v[180:183], v[40:43], v[136:139]
  ds_read_b64_tr_b16 v[214:215], v7 offset:47104
  v_mfma_f32_16x16x32_bf16 v[144:147], v[184:187], v[40:43], v[144:147]
  buffer_load_dwordx4 v[248:251], off, s[36:39], s49 offset:1024 sc1
  v_mfma_f32_16x16x32_bf16 v[148:151], v[184:187], v[44:47], v[148:151]
  ds_read_b64_tr_b16 v[216:217], v8 offset:45056
  ds_read_b64_tr_b16 v[218:219], v8 offset:47104
  v_mfma_f32_16x16x32_bf16 v[156:159], v[188:191], v[44:47], v[156:159]
  ds_read_b64_tr_b16 v[220:221], v9 offset:45056
  v_mfma_f32_16x16x32_bf16 v[152:155], v[188:191], v[40:43], v[152:155]
  ds_read_b64_tr_b16 v[222:223], v9 offset:47104
  s_waitcnt lgkmcnt(8)
  v_mfma_f32_16x16x32_bf16 v[96:99], v[192:195], v[32:35], v[96:99]
  ds_read_b64_tr_b16 v[160:161], v6 offset:49152
  v_mfma_f32_16x16x32_bf16 v[100:103], v[192:195], v[36:39], v[100:103]
  ds_read_b64_tr_b16 v[162:163], v6 offset:51200
  v_mfma_f32_16x16x32_bf16 v[108:111], v[196:199], v[36:39], v[108:111]
  buffer_load_dwordx4 v[252:255], off, s[64:67], s49 offset:1024 sc1
  v_mfma_f32_16x16x32_bf16 v[104:107], v[196:199], v[32:35], v[104:107]
  ds_read_b64_tr_b16 v[164:165], v7 offset:49152
  ds_read_b64_tr_b16 v[166:167], v7 offset:51200
  v_mfma_f32_16x16x32_bf16 v[112:115], v[200:203], v[32:35], v[112:115]
  ds_read_b64_tr_b16 v[168:169], v8 offset:49152
  v_mfma_f32_16x16x32_bf16 v[116:119], v[200:203], v[36:39], v[116:119]
  ds_read_b64_tr_b16 v[170:171], v8 offset:51200
  v_mfma_f32_16x16x32_bf16 v[124:127], v[204:207], v[36:39], v[124:127]
  ds_read_b64_tr_b16 v[172:173], v9 offset:49152
  v_mfma_f32_16x16x32_bf16 v[120:123], v[204:207], v[32:35], v[120:123]
  ds_read_b64_tr_b16 v[174:175], v9 offset:51200
  s_waitcnt lgkmcnt(8)
  v_mfma_f32_16x16x32_bf16 v[96:99], v[208:211], v[40:43], v[96:99]
  ds_read_b64_tr_b16 v[176:177], v6 offset:53248
  v_mfma_f32_16x16x32_bf16 v[100:103], v[208:211], v[44:47], v[100:103]
  ds_read_b64_tr_b16 v[178:179], v6 offset:55296
  v_mfma_f32_16x16x32_bf16 v[108:111], v[212:215], v[44:47], v[108:111]
  ds_read_b64_tr_b16 v[180:181], v7 offset:53248
  v_mfma_f32_16x16x32_bf16 v[104:107], v[212:215], v[40:43], v[104:107]
  ds_read_b64_tr_b16 v[182:183], v7 offset:55296
  v_mfma_f32_16x16x32_bf16 v[112:115], v[216:219], v[40:43], v[112:115]
  ds_read_b64_tr_b16 v[184:185], v8 offset:53248
  v_mfma_f32_16x16x32_bf16 v[116:119], v[216:219], v[44:47], v[116:119]
  ds_read_b64_tr_b16 v[186:187], v8 offset:55296
  v_readlane_b32 s50, v30, 18
  v_mfma_f32_16x16x32_bf16 v[124:127], v[220:223], v[44:47], v[124:127]
  ds_read_b64_tr_b16 v[188:189], v9 offset:53248
  v_mfma_f32_16x16x32_bf16 v[120:123], v[220:223], v[40:43], v[120:123]
  ds_read_b64_tr_b16 v[190:191], v9 offset:55296
  s_waitcnt vmcnt(18) lgkmcnt(8)
  v_mfma_f32_16x16x32_bf16 v[128:131], v[160:163], v[48:51], v[128:131]
  buffer_load_dwordx4 v[32:35], off, s[36:39], s50 offset:0 sc1
  v_mfma_f32_16x16x32_bf16 v[132:135], v[160:163], v[52:55], v[132:135]
  ds_read_b64_tr_b16 v[192:193], v6 offset:57344
  ds_read_b64_tr_b16 v[194:195], v6 offset:59392
  v_mfma_f32_16x16x32_bf16 v[140:143], v[164:167], v[52:55], v[140:143]
  ds_read_b64_tr_b16 v[196:197], v7 offset:57344
  v_mfma_f32_16x16x32_bf16 v[136:139], v[164:167], v[48:51], v[136:139]
  ds_read_b64_tr_b16 v[198:199], v7 offset:59392
  v_mfma_f32_16x16x32_bf16 v[144:147], v[168:171], v[48:51], v[144:147]
  ds_read_b64_tr_b16 v[200:201], v8 offset:57344
  v_mfma_f32_16x16x32_bf16 v[148:151], v[168:171], v[52:55], v[148:151]
  ds_read_b64_tr_b16 v[202:203], v8 offset:59392
  ds_read_b64_tr_b16 v[204:205], v9 offset:57344
  v_mfma_f32_16x16x32_bf16 v[156:159], v[172:175], v[52:55], v[156:159]
  buffer_load_dwordx4 v[36:39], off, s[64:67], s50 offset:0 sc1
  v_mfma_f32_16x16x32_bf16 v[152:155], v[172:175], v[48:51], v[152:155]
  ds_read_b64_tr_b16 v[206:207], v9 offset:59392
  s_waitcnt vmcnt(18) lgkmcnt(8)
  v_mfma_f32_16x16x32_bf16 v[128:131], v[176:179], v[56:59], v[128:131]
  ds_read_b64_tr_b16 v[208:209], v6 offset:61440
  v_mfma_f32_16x16x32_bf16 v[132:135], v[176:179], v[60:63], v[132:135]
  ds_read_b64_tr_b16 v[210:211], v6 offset:63488
  v_mfma_f32_16x16x32_bf16 v[140:143], v[180:183], v[60:63], v[140:143]
  ds_read_b64_tr_b16 v[212:213], v7 offset:61440
  v_mfma_f32_16x16x32_bf16 v[136:139], v[180:183], v[56:59], v[136:139]
  ds_read_b64_tr_b16 v[214:215], v7 offset:63488
  v_mfma_f32_16x16x32_bf16 v[144:147], v[184:187], v[56:59], v[144:147]
  buffer_load_dwordx4 v[40:43], off, s[36:39], s50 offset:1024 sc1
  v_mfma_f32_16x16x32_bf16 v[148:151], v[184:187], v[60:63], v[148:151]
  ds_read_b64_tr_b16 v[216:217], v8 offset:61440
  ds_read_b64_tr_b16 v[218:219], v8 offset:63488
  v_mfma_f32_16x16x32_bf16 v[156:159], v[188:191], v[60:63], v[156:159]
  ds_read_b64_tr_b16 v[220:221], v9 offset:61440
  v_mfma_f32_16x16x32_bf16 v[152:155], v[188:191], v[56:59], v[152:155]
  ds_read_b64_tr_b16 v[222:223], v9 offset:63488
  s_waitcnt lgkmcnt(8)
  v_mfma_f32_16x16x32_bf16 v[96:99], v[192:195], v[48:51], v[96:99]
  ds_read_b64_tr_b16 v[160:161], v20 offset:0
  v_mfma_f32_16x16x32_bf16 v[100:103], v[192:195], v[52:55], v[100:103]
  ds_read_b64_tr_b16 v[162:163], v20 offset:2048
  v_mfma_f32_16x16x32_bf16 v[108:111], v[196:199], v[52:55], v[108:111]
  buffer_load_dwordx4 v[44:47], off, s[64:67], s50 offset:1024 sc1
  v_mfma_f32_16x16x32_bf16 v[104:107], v[196:199], v[48:51], v[104:107]
  ds_read_b64_tr_b16 v[164:165], v21 offset:0
  ds_read_b64_tr_b16 v[166:167], v21 offset:2048
  v_mfma_f32_16x16x32_bf16 v[112:115], v[200:203], v[48:51], v[112:115]
  ds_read_b64_tr_b16 v[168:169], v22 offset:0
  v_mfma_f32_16x16x32_bf16 v[116:119], v[200:203], v[52:55], v[116:119]
  ds_read_b64_tr_b16 v[170:171], v22 offset:2048
  v_mfma_f32_16x16x32_bf16 v[124:127], v[204:207], v[52:55], v[124:127]
  ds_read_b64_tr_b16 v[172:173], v23 offset:0
  v_mfma_f32_16x16x32_bf16 v[120:123], v[204:207], v[48:51], v[120:123]
  ds_read_b64_tr_b16 v[174:175], v23 offset:2048
  s_waitcnt lgkmcnt(8)
  s_barrier
  v_mfma_f32_16x16x32_bf16 v[96:99], v[208:211], v[56:59], v[96:99]
  ds_read_b64_tr_b16 v[176:177], v20 offset:4096
  v_mfma_f32_16x16x32_bf16 v[100:103], v[208:211], v[60:63], v[100:103]
  ds_read_b64_tr_b16 v[178:179], v20 offset:6144
  v_mfma_f32_16x16x32_bf16 v[108:111], v[212:215], v[60:63], v[108:111]
  ds_read_b64_tr_b16 v[180:181], v21 offset:4096
  v_mfma_f32_16x16x32_bf16 v[104:107], v[212:215], v[56:59], v[104:107]
  ds_read_b64_tr_b16 v[182:183], v21 offset:6144
  v_mfma_f32_16x16x32_bf16 v[112:115], v[216:219], v[56:59], v[112:115]
  ds_read_b64_tr_b16 v[184:185], v22 offset:4096
  v_mfma_f32_16x16x32_bf16 v[116:119], v[216:219], v[60:63], v[116:119]
  ds_read_b64_tr_b16 v[186:187], v22 offset:6144
  v_readlane_b32 s51, v30, 19
  v_mfma_f32_16x16x32_bf16 v[124:127], v[220:223], v[60:63], v[124:127]
  ds_read_b64_tr_b16 v[188:189], v23 offset:4096
  v_mfma_f32_16x16x32_bf16 v[120:123], v[220:223], v[56:59], v[120:123]
  ds_read_b64_tr_b16 v[190:191], v23 offset:6144
  s_waitcnt vmcnt(18) lgkmcnt(8)
  v_mfma_f32_16x16x32_bf16 v[128:131], v[160:163], v[64:67], v[128:131]
  buffer_load_dwordx4 v[48:51], off, s[36:39], s51 offset:0 sc1
  v_mfma_f32_16x16x32_bf16 v[132:135], v[160:163], v[68:71], v[132:135]
  ds_read_b64_tr_b16 v[192:193], v20 offset:8192
  ds_read_b64_tr_b16 v[194:195], v20 offset:10240
  v_mfma_f32_16x16x32_bf16 v[140:143], v[164:167], v[68:71], v[140:143]
  ds_read_b64_tr_b16 v[196:197], v21 offset:8192
  v_mfma_f32_16x16x32_bf16 v[136:139], v[164:167], v[64:67], v[136:139]
  ds_read_b64_tr_b16 v[198:199], v21 offset:10240
  v_mfma_f32_16x16x32_bf16 v[144:147], v[168:171], v[64:67], v[144:147]
  ds_read_b64_tr_b16 v[200:201], v22 offset:8192
  v_mfma_f32_16x16x32_bf16 v[148:151], v[168:171], v[68:71], v[148:151]
  ds_read_b64_tr_b16 v[202:203], v22 offset:10240
  ds_read_b64_tr_b16 v[204:205], v23 offset:8192
  v_mfma_f32_16x16x32_bf16 v[156:159], v[172:175], v[68:71], v[156:159]
  buffer_load_dwordx4 v[52:55], off, s[64:67], s51 offset:0 sc1
  v_mfma_f32_16x16x32_bf16 v[152:155], v[172:175], v[64:67], v[152:155]
  ds_read_b64_tr_b16 v[206:207], v23 offset:10240
  s_waitcnt vmcnt(18) lgkmcnt(8)
  v_mfma_f32_16x16x32_bf16 v[128:131], v[176:179], v[72:75], v[128:131]
  ds_read_b64_tr_b16 v[208:209], v20 offset:12288
  v_mfma_f32_16x16x32_bf16 v[132:135], v[176:179], v[76:79], v[132:135]
  ds_read_b64_tr_b16 v[210:211], v20 offset:14336
  v_mfma_f32_16x16x32_bf16 v[140:143], v[180:183], v[76:79], v[140:143]
  ds_read_b64_tr_b16 v[212:213], v21 offset:12288
  v_mfma_f32_16x16x32_bf16 v[136:139], v[180:183], v[72:75], v[136:139]
  ds_read_b64_tr_b16 v[214:215], v21 offset:14336
  v_mfma_f32_16x16x32_bf16 v[144:147], v[184:187], v[72:75], v[144:147]
  buffer_load_dwordx4 v[56:59], off, s[36:39], s51 offset:1024 sc1
  v_mfma_f32_16x16x32_bf16 v[148:151], v[184:187], v[76:79], v[148:151]
  ds_read_b64_tr_b16 v[216:217], v22 offset:12288
  ds_read_b64_tr_b16 v[218:219], v22 offset:14336
  v_mfma_f32_16x16x32_bf16 v[156:159], v[188:191], v[76:79], v[156:159]
  ds_read_b64_tr_b16 v[220:221], v23 offset:12288
  v_mfma_f32_16x16x32_bf16 v[152:155], v[188:191], v[72:75], v[152:155]
  ds_read_b64_tr_b16 v[222:223], v23 offset:14336
  s_waitcnt lgkmcnt(8)
  v_mfma_f32_16x16x32_bf16 v[96:99], v[192:195], v[64:67], v[96:99]
  ds_read_b64_tr_b16 v[160:161], v20 offset:16384
  v_mfma_f32_16x16x32_bf16 v[100:103], v[192:195], v[68:71], v[100:103]
  ds_read_b64_tr_b16 v[162:163], v20 offset:18432
  v_mfma_f32_16x16x32_bf16 v[108:111], v[196:199], v[68:71], v[108:111]
  buffer_load_dwordx4 v[60:63], off, s[64:67], s51 offset:1024 sc1
  v_mfma_f32_16x16x32_bf16 v[104:107], v[196:199], v[64:67], v[104:107]
  ds_read_b64_tr_b16 v[164:165], v21 offset:16384
  ds_read_b64_tr_b16 v[166:167], v21 offset:18432
  v_mfma_f32_16x16x32_bf16 v[112:115], v[200:203], v[64:67], v[112:115]
  ds_read_b64_tr_b16 v[168:169], v22 offset:16384
  v_mfma_f32_16x16x32_bf16 v[116:119], v[200:203], v[68:71], v[116:119]
  ds_read_b64_tr_b16 v[170:171], v22 offset:18432
  v_mfma_f32_16x16x32_bf16 v[124:127], v[204:207], v[68:71], v[124:127]
  ds_read_b64_tr_b16 v[172:173], v23 offset:16384
  v_mfma_f32_16x16x32_bf16 v[120:123], v[204:207], v[64:67], v[120:123]
  ds_read_b64_tr_b16 v[174:175], v23 offset:18432
  s_waitcnt lgkmcnt(8)
  v_mfma_f32_16x16x32_bf16 v[96:99], v[208:211], v[72:75], v[96:99]
  ds_read_b64_tr_b16 v[176:177], v20 offset:20480
  v_mfma_f32_16x16x32_bf16 v[100:103], v[208:211], v[76:79], v[100:103]
  ds_read_b64_tr_b16 v[178:179], v20 offset:22528
  v_mfma_f32_16x16x32_bf16 v[108:111], v[212:215], v[76:79], v[108:111]
  ds_read_b64_tr_b16 v[180:181], v21 offset:20480
  v_mfma_f32_16x16x32_bf16 v[104:107], v[212:215], v[72:75], v[104:107]
  ds_read_b64_tr_b16 v[182:183], v21 offset:22528
  v_mfma_f32_16x16x32_bf16 v[112:115], v[216:219], v[72:75], v[112:115]
  ds_read_b64_tr_b16 v[184:185], v22 offset:20480
  v_mfma_f32_16x16x32_bf16 v[116:119], v[216:219], v[76:79], v[116:119]
  ds_read_b64_tr_b16 v[186:187], v22 offset:22528
  v_readlane_b32 s48, v30, 20
  v_mfma_f32_16x16x32_bf16 v[124:127], v[220:223], v[76:79], v[124:127]
  ds_read_b64_tr_b16 v[188:189], v23 offset:20480
  v_mfma_f32_16x16x32_bf16 v[120:123], v[220:223], v[72:75], v[120:123]
  ds_read_b64_tr_b16 v[190:191], v23 offset:22528
  s_waitcnt vmcnt(18) lgkmcnt(8)
  v_mfma_f32_16x16x32_bf16 v[128:131], v[160:163], v[80:83], v[128:131]
  buffer_load_dwordx4 v[64:67], off, s[36:39], s48 offset:0 sc1
  v_mfma_f32_16x16x32_bf16 v[132:135], v[160:163], v[84:87], v[132:135]
  ds_read_b64_tr_b16 v[192:193], v20 offset:24576
  ds_read_b64_tr_b16 v[194:195], v20 offset:26624
  v_mfma_f32_16x16x32_bf16 v[140:143], v[164:167], v[84:87], v[140:143]
  ds_read_b64_tr_b16 v[196:197], v21 offset:24576
  v_mfma_f32_16x16x32_bf16 v[136:139], v[164:167], v[80:83], v[136:139]
  ds_read_b64_tr_b16 v[198:199], v21 offset:26624
  v_mfma_f32_16x16x32_bf16 v[144:147], v[168:171], v[80:83], v[144:147]
  ds_read_b64_tr_b16 v[200:201], v22 offset:24576
  v_mfma_f32_16x16x32_bf16 v[148:151], v[168:171], v[84:87], v[148:151]
  ds_read_b64_tr_b16 v[202:203], v22 offset:26624
  ds_read_b64_tr_b16 v[204:205], v23 offset:24576
  v_mfma_f32_16x16x32_bf16 v[156:159], v[172:175], v[84:87], v[156:159]
  buffer_load_dwordx4 v[68:71], off, s[64:67], s48 offset:0 sc1
  v_mfma_f32_16x16x32_bf16 v[152:155], v[172:175], v[80:83], v[152:155]
  ds_read_b64_tr_b16 v[206:207], v23 offset:26624
  s_waitcnt vmcnt(18) lgkmcnt(8)
  v_mfma_f32_16x16x32_bf16 v[128:131], v[176:179], v[88:91], v[128:131]
  ds_read_b64_tr_b16 v[208:209], v20 offset:28672
  v_mfma_f32_16x16x32_bf16 v[132:135], v[176:179], v[92:95], v[132:135]
  ds_read_b64_tr_b16 v[210:211], v20 offset:30720
  v_mfma_f32_16x16x32_bf16 v[140:143], v[180:183], v[92:95], v[140:143]
  ds_read_b64_tr_b16 v[212:213], v21 offset:28672
  v_mfma_f32_16x16x32_bf16 v[136:139], v[180:183], v[88:91], v[136:139]
  ds_read_b64_tr_b16 v[214:215], v21 offset:30720
  v_mfma_f32_16x16x32_bf16 v[144:147], v[184:187], v[88:91], v[144:147]
  buffer_load_dwordx4 v[72:75], off, s[36:39], s48 offset:1024 sc1
  v_mfma_f32_16x16x32_bf16 v[148:151], v[184:187], v[92:95], v[148:151]
  ds_read_b64_tr_b16 v[216:217], v22 offset:28672
  ds_read_b64_tr_b16 v[218:219], v22 offset:30720
  v_mfma_f32_16x16x32_bf16 v[156:159], v[188:191], v[92:95], v[156:159]
  ds_read_b64_tr_b16 v[220:221], v23 offset:28672
  v_mfma_f32_16x16x32_bf16 v[152:155], v[188:191], v[88:91], v[152:155]
  ds_read_b64_tr_b16 v[222:223], v23 offset:30720
  s_waitcnt lgkmcnt(8)
  v_mfma_f32_16x16x32_bf16 v[96:99], v[192:195], v[80:83], v[96:99]
  ds_read_b64_tr_b16 v[160:161], v20 offset:32768
  v_mfma_f32_16x16x32_bf16 v[100:103], v[192:195], v[84:87], v[100:103]
  ds_read_b64_tr_b16 v[162:163], v20 offset:34816
  v_mfma_f32_16x16x32_bf16 v[108:111], v[196:199], v[84:87], v[108:111]
  buffer_load_dwordx4 v[76:79], off, s[64:67], s48 offset:1024 sc1
  v_mfma_f32_16x16x32_bf16 v[104:107], v[196:199], v[80:83], v[104:107]
  ds_read_b64_tr_b16 v[164:165], v21 offset:32768
  ds_read_b64_tr_b16 v[166:167], v21 offset:34816
  v_mfma_f32_16x16x32_bf16 v[112:115], v[200:203], v[80:83], v[112:115]
  ds_read_b64_tr_b16 v[168:169], v22 offset:32768
  v_mfma_f32_16x16x32_bf16 v[116:119], v[200:203], v[84:87], v[116:119]
  ds_read_b64_tr_b16 v[170:171], v22 offset:34816
  v_mfma_f32_16x16x32_bf16 v[124:127], v[204:207], v[84:87], v[124:127]
  ds_read_b64_tr_b16 v[172:173], v23 offset:32768
  v_mfma_f32_16x16x32_bf16 v[120:123], v[204:207], v[80:83], v[120:123]
  ds_read_b64_tr_b16 v[174:175], v23 offset:34816
  s_waitcnt lgkmcnt(8)
  s_barrier
  v_mfma_f32_16x16x32_bf16 v[96:99], v[208:211], v[88:91], v[96:99]
  ds_read_b64_tr_b16 v[176:177], v20 offset:36864
  v_mfma_f32_16x16x32_bf16 v[100:103], v[208:211], v[92:95], v[100:103]
  ds_read_b64_tr_b16 v[178:179], v20 offset:38912
  v_mfma_f32_16x16x32_bf16 v[108:111], v[212:215], v[92:95], v[108:111]
  ds_read_b64_tr_b16 v[180:181], v21 offset:36864
  v_mfma_f32_16x16x32_bf16 v[104:107], v[212:215], v[88:91], v[104:107]
  ds_read_b64_tr_b16 v[182:183], v21 offset:38912
  v_mfma_f32_16x16x32_bf16 v[112:115], v[216:219], v[88:91], v[112:115]
  ds_read_b64_tr_b16 v[184:185], v22 offset:36864
  v_mfma_f32_16x16x32_bf16 v[116:119], v[216:219], v[92:95], v[116:119]
  ds_read_b64_tr_b16 v[186:187], v22 offset:38912
  v_readlane_b32 s49, v30, 21
  v_mfma_f32_16x16x32_bf16 v[124:127], v[220:223], v[92:95], v[124:127]
  ds_read_b64_tr_b16 v[188:189], v23 offset:36864
  v_mfma_f32_16x16x32_bf16 v[120:123], v[220:223], v[88:91], v[120:123]
  ds_read_b64_tr_b16 v[190:191], v23 offset:38912
  s_waitcnt vmcnt(18) lgkmcnt(8)
  v_mfma_f32_16x16x32_bf16 v[128:131], v[160:163], v[224:227], v[128:131]
  buffer_load_dwordx4 v[80:83], off, s[36:39], s49 offset:0 sc1
  v_mfma_f32_16x16x32_bf16 v[132:135], v[160:163], v[228:231], v[132:135]
  ds_read_b64_tr_b16 v[192:193], v20 offset:40960
  ds_read_b64_tr_b16 v[194:195], v20 offset:43008
  v_mfma_f32_16x16x32_bf16 v[140:143], v[164:167], v[228:231], v[140:143]
  ds_read_b64_tr_b16 v[196:197], v21 offset:40960
  v_mfma_f32_16x16x32_bf16 v[136:139], v[164:167], v[224:227], v[136:139]
  ds_read_b64_tr_b16 v[198:199], v21 offset:43008
  v_mfma_f32_16x16x32_bf16 v[144:147], v[168:171], v[224:227], v[144:147]
  ds_read_b64_tr_b16 v[200:201], v22 offset:40960
  v_mfma_f32_16x16x32_bf16 v[148:151], v[168:171], v[228:231], v[148:151]
  ds_read_b64_tr_b16 v[202:203], v22 offset:43008
  ds_read_b64_tr_b16 v[204:205], v23 offset:40960
  v_mfma_f32_16x16x32_bf16 v[156:159], v[172:175], v[228:231], v[156:159]
  buffer_load_dwordx4 v[84:87], off, s[64:67], s49 offset:0 sc1
  v_mfma_f32_16x16x32_bf16 v[152:155], v[172:175], v[224:227], v[152:155]
  ds_read_b64_tr_b16 v[206:207], v23 offset:43008
  s_waitcnt vmcnt(18) lgkmcnt(8)
  v_mfma_f32_16x16x32_bf16 v[128:131], v[176:179], v[232:235], v[128:131]
  ds_read_b64_tr_b16 v[208:209], v20 offset:45056
  v_mfma_f32_16x16x32_bf16 v[132:135], v[176:179], v[236:239], v[132:135]
  ds_read_b64_tr_b16 v[210:211], v20 offset:47104
  v_mfma_f32_16x16x32_bf16 v[140:143], v[180:183], v[236:239], v[140:143]
  ds_read_b64_tr_b16 v[212:213], v21 offset:45056
  v_mfma_f32_16x16x32_bf16 v[136:139], v[180:183], v[232:235], v[136:139]
  ds_read_b64_tr_b16 v[214:215], v21 offset:47104
  v_mfma_f32_16x16x32_bf16 v[144:147], v[184:187], v[232:235], v[144:147]
  buffer_load_dwordx4 v[88:91], off, s[36:39], s49 offset:1024 sc1
  v_mfma_f32_16x16x32_bf16 v[148:151], v[184:187], v[236:239], v[148:151]
  ds_read_b64_tr_b16 v[216:217], v22 offset:45056
  ds_read_b64_tr_b16 v[218:219], v22 offset:47104
  v_mfma_f32_16x16x32_bf16 v[156:159], v[188:191], v[236:239], v[156:159]
  ds_read_b64_tr_b16 v[220:221], v23 offset:45056
  v_mfma_f32_16x16x32_bf16 v[152:155], v[188:191], v[232:235], v[152:155]
  ds_read_b64_tr_b16 v[222:223], v23 offset:47104
  s_waitcnt lgkmcnt(8)
  v_mfma_f32_16x16x32_bf16 v[96:99], v[192:195], v[224:227], v[96:99]
  ds_read_b64_tr_b16 v[160:161], v20 offset:49152
  v_mfma_f32_16x16x32_bf16 v[100:103], v[192:195], v[228:231], v[100:103]
  ds_read_b64_tr_b16 v[162:163], v20 offset:51200
  v_mfma_f32_16x16x32_bf16 v[108:111], v[196:199], v[228:231], v[108:111]
  buffer_load_dwordx4 v[92:95], off, s[64:67], s49 offset:1024 sc1
  v_mfma_f32_16x16x32_bf16 v[104:107], v[196:199], v[224:227], v[104:107]
  ds_read_b64_tr_b16 v[164:165], v21 offset:49152
  ds_read_b64_tr_b16 v[166:167], v21 offset:51200
  v_mfma_f32_16x16x32_bf16 v[112:115], v[200:203], v[224:227], v[112:115]
  ds_read_b64_tr_b16 v[168:169], v22 offset:49152
  v_mfma_f32_16x16x32_bf16 v[116:119], v[200:203], v[228:231], v[116:119]
  ds_read_b64_tr_b16 v[170:171], v22 offset:51200
  v_mfma_f32_16x16x32_bf16 v[124:127], v[204:207], v[228:231], v[124:127]
  ds_read_b64_tr_b16 v[172:173], v23 offset:49152
  v_mfma_f32_16x16x32_bf16 v[120:123], v[204:207], v[224:227], v[120:123]
  ds_read_b64_tr_b16 v[174:175], v23 offset:51200
  s_waitcnt lgkmcnt(8)
  v_mfma_f32_16x16x32_bf16 v[96:99], v[208:211], v[232:235], v[96:99]
  ds_read_b64_tr_b16 v[176:177], v20 offset:53248
  v_mfma_f32_16x16x32_bf16 v[100:103], v[208:211], v[236:239], v[100:103]
  ds_read_b64_tr_b16 v[178:179], v20 offset:55296
  v_mfma_f32_16x16x32_bf16 v[108:111], v[212:215], v[236:239], v[108:111]
  ds_read_b64_tr_b16 v[180:181], v21 offset:53248
  v_mfma_f32_16x16x32_bf16 v[104:107], v[212:215], v[232:235], v[104:107]
  ds_read_b64_tr_b16 v[182:183], v21 offset:55296
  v_mfma_f32_16x16x32_bf16 v[112:115], v[216:219], v[232:235], v[112:115]
  ds_read_b64_tr_b16 v[184:185], v22 offset:53248
  v_mfma_f32_16x16x32_bf16 v[116:119], v[216:219], v[236:239], v[116:119]
  ds_read_b64_tr_b16 v[186:187], v22 offset:55296
  v_readlane_b32 s50, v30, 22
  v_mfma_f32_16x16x32_bf16 v[124:127], v[220:223], v[236:239], v[124:127]
  ds_read_b64_tr_b16 v[188:189], v23 offset:53248
  v_mfma_f32_16x16x32_bf16 v[120:123], v[220:223], v[232:235], v[120:123]
  ds_read_b64_tr_b16 v[190:191], v23 offset:55296
  s_waitcnt vmcnt(18) lgkmcnt(8)
  v_mfma_f32_16x16x32_bf16 v[128:131], v[160:163], v[240:243], v[128:131]
  buffer_load_dwordx4 v[224:227], off, s[36:39], s50 offset:0 sc1
  v_mfma_f32_16x16x32_bf16 v[132:135], v[160:163], v[244:247], v[132:135]
  ds_read_b64_tr_b16 v[192:193], v20 offset:57344
  ds_read_b64_tr_b16 v[194:195], v20 offset:59392
  v_mfma_f32_16x16x32_bf16 v[140:143], v[164:167], v[244:247], v[140:143]
  ds_read_b64_tr_b16 v[196:197], v21 offset:57344
  v_mfma_f32_16x16x32_bf16 v[136:139], v[164:167], v[240:243], v[136:139]
  ds_read_b64_tr_b16 v[198:199], v21 offset:59392
  v_mfma_f32_16x16x32_bf16 v[144:147], v[168:171], v[240:243], v[144:147]
  ds_read_b64_tr_b16 v[200:201], v22 offset:57344
  v_mfma_f32_16x16x32_bf16 v[148:151], v[168:171], v[244:247], v[148:151]
  ds_read_b64_tr_b16 v[202:203], v22 offset:59392
  ds_read_b64_tr_b16 v[204:205], v23 offset:57344
  v_mfma_f32_16x16x32_bf16 v[156:159], v[172:175], v[244:247], v[156:159]
  buffer_load_dwordx4 v[228:231], off, s[64:67], s50 offset:0 sc1
  v_mfma_f32_16x16x32_bf16 v[152:155], v[172:175], v[240:243], v[152:155]
  ds_read_b64_tr_b16 v[206:207], v23 offset:59392
  s_waitcnt vmcnt(18) lgkmcnt(8)
  v_mfma_f32_16x16x32_bf16 v[128:131], v[176:179], v[248:251], v[128:131]
  ds_read_b64_tr_b16 v[208:209], v20 offset:61440
  v_mfma_f32_16x16x32_bf16 v[132:135], v[176:179], v[252:255], v[132:135]
  ds_read_b64_tr_b16 v[210:211], v20 offset:63488
  v_mfma_f32_16x16x32_bf16 v[140:143], v[180:183], v[252:255], v[140:143]
  ds_read_b64_tr_b16 v[212:213], v21 offset:61440
  v_mfma_f32_16x16x32_bf16 v[136:139], v[180:183], v[248:251], v[136:139]
  ds_read_b64_tr_b16 v[214:215], v21 offset:63488
  v_mfma_f32_16x16x32_bf16 v[144:147], v[184:187], v[248:251], v[144:147]
  buffer_load_dwordx4 v[232:235], off, s[36:39], s50 offset:1024 sc1
  v_mfma_f32_16x16x32_bf16 v[148:151], v[184:187], v[252:255], v[148:151]
  ds_read_b64_tr_b16 v[216:217], v22 offset:61440
  ds_read_b64_tr_b16 v[218:219], v22 offset:63488
  v_mfma_f32_16x16x32_bf16 v[156:159], v[188:191], v[252:255], v[156:159]
  ds_read_b64_tr_b16 v[220:221], v23 offset:61440
  v_mfma_f32_16x16x32_bf16 v[152:155], v[188:191], v[248:251], v[152:155]
  ds_read_b64_tr_b16 v[222:223], v23 offset:63488
  s_waitcnt vmcnt(17) lgkmcnt(8)
  v_mfma_f32_16x16x32_bf16 v[128:131], v[192:195], v[32:35], v[128:131]
  ds_read_b64_tr_b16 v[160:161], v26 offset:0
  v_mfma_f32_16x16x32_bf16 v[132:135], v[192:195], v[36:39], v[132:135]
  ds_read_b64_tr_b16 v[162:163], v26 offset:2048
  v_mfma_f32_16x16x32_bf16 v[140:143], v[196:199], v[36:39], v[140:143]
  buffer_load_dwordx4 v[236:239], off, s[64:67], s50 offset:1024 sc1
  v_mfma_f32_16x16x32_bf16 v[136:139], v[196:199], v[32:35], v[136:139]
  ds_read_b64_tr_b16 v[164:165], v27 offset:0
  ds_read_b64_tr_b16 v[166:167], v27 offset:2048
  v_mfma_f32_16x16x32_bf16 v[144:147], v[200:203], v[32:35], v[144:147]
  ds_read_b64_tr_b16 v[168:169], v28 offset:0
  v_mfma_f32_16x16x32_bf16 v[148:151], v[200:203], v[36:39], v[148:151]
  ds_read_b64_tr_b16 v[170:171], v28 offset:2048
  v_mfma_f32_16x16x32_bf16 v[156:159], v[204:207], v[36:39], v[156:159]
  ds_read_b64_tr_b16 v[172:173], v29 offset:0
  v_mfma_f32_16x16x32_bf16 v[152:155], v[204:207], v[32:35], v[152:155]
  ds_read_b64_tr_b16 v[174:175], v29 offset:2048
  s_waitcnt vmcnt(16) lgkmcnt(8)
  s_barrier
  v_mfma_f32_16x16x32_bf16 v[128:131], v[208:211], v[40:43], v[128:131]
  ds_read_b64_tr_b16 v[176:177], v26 offset:4096
  v_mfma_f32_16x16x32_bf16 v[132:135], v[208:211], v[44:47], v[132:135]
  ds_read_b64_tr_b16 v[178:179], v26 offset:6144
  v_mfma_f32_16x16x32_bf16 v[140:143], v[212:215], v[44:47], v[140:143]
  ds_read_b64_tr_b16 v[180:181], v27 offset:4096
  v_mfma_f32_16x16x32_bf16 v[136:139], v[212:215], v[40:43], v[136:139]
  ds_read_b64_tr_b16 v[182:183], v27 offset:6144
  v_mfma_f32_16x16x32_bf16 v[144:147], v[216:219], v[40:43], v[144:147]
  ds_read_b64_tr_b16 v[184:185], v28 offset:4096
  v_mfma_f32_16x16x32_bf16 v[148:151], v[216:219], v[44:47], v[148:151]
  ds_read_b64_tr_b16 v[186:187], v28 offset:6144
  v_mfma_f32_16x16x32_bf16 v[156:159], v[220:223], v[44:47], v[156:159]
  ds_read_b64_tr_b16 v[188:189], v29 offset:4096
  v_mfma_f32_16x16x32_bf16 v[152:155], v[220:223], v[40:43], v[152:155]
  ds_read_b64_tr_b16 v[190:191], v29 offset:6144
  s_waitcnt vmcnt(14) lgkmcnt(8)
  v_mfma_f32_16x16x32_bf16 v[128:131], v[160:163], v[48:51], v[128:131]
  ds_read_b64_tr_b16 v[192:193], v26 offset:8192
  v_mfma_f32_16x16x32_bf16 v[132:135], v[160:163], v[52:55], v[132:135]
  ds_read_b64_tr_b16 v[194:195], v26 offset:10240
  v_mfma_f32_16x16x32_bf16 v[140:143], v[164:167], v[52:55], v[140:143]
  ds_read_b64_tr_b16 v[196:197], v27 offset:8192
  v_mfma_f32_16x16x32_bf16 v[136:139], v[164:167], v[48:51], v[136:139]
  ds_read_b64_tr_b16 v[198:199], v27 offset:10240
  v_mfma_f32_16x16x32_bf16 v[144:147], v[168:171], v[48:51], v[144:147]
  ds_read_b64_tr_b16 v[200:201], v28 offset:8192
  v_mfma_f32_16x16x32_bf16 v[148:151], v[168:171], v[52:55], v[148:151]
  ds_read_b64_tr_b16 v[202:203], v28 offset:10240
  v_mfma_f32_16x16x32_bf16 v[156:159], v[172:175], v[52:55], v[156:159]
  ds_read_b64_tr_b16 v[204:205], v29 offset:8192
  v_mfma_f32_16x16x32_bf16 v[152:155], v[172:175], v[48:51], v[152:155]
  ds_read_b64_tr_b16 v[206:207], v29 offset:10240
  s_waitcnt vmcnt(12) lgkmcnt(8)
  v_mfma_f32_16x16x32_bf16 v[128:131], v[176:179], v[56:59], v[128:131]
  ds_read_b64_tr_b16 v[208:209], v26 offset:12288
  v_mfma_f32_16x16x32_bf16 v[132:135], v[176:179], v[60:63], v[132:135]
  ds_read_b64_tr_b16 v[210:211], v26 offset:14336
  v_mfma_f32_16x16x32_bf16 v[140:143], v[180:183], v[60:63], v[140:143]
  ds_read_b64_tr_b16 v[212:213], v27 offset:12288
  v_mfma_f32_16x16x32_bf16 v[136:139], v[180:183], v[56:59], v[136:139]
  ds_read_b64_tr_b16 v[214:215], v27 offset:14336
  v_mfma_f32_16x16x32_bf16 v[144:147], v[184:187], v[56:59], v[144:147]
  ds_read_b64_tr_b16 v[216:217], v28 offset:12288
  v_mfma_f32_16x16x32_bf16 v[148:151], v[184:187], v[60:63], v[148:151]
  ds_read_b64_tr_b16 v[218:219], v28 offset:14336
  v_mfma_f32_16x16x32_bf16 v[156:159], v[188:191], v[60:63], v[156:159]
  ds_read_b64_tr_b16 v[220:221], v29 offset:12288
  v_mfma_f32_16x16x32_bf16 v[152:155], v[188:191], v[56:59], v[152:155]
  ds_read_b64_tr_b16 v[222:223], v29 offset:14336
  s_waitcnt vmcnt(10) lgkmcnt(8)
  v_mfma_f32_16x16x32_bf16 v[128:131], v[192:195], v[64:67], v[128:131]
  ds_read_b64_tr_b16 v[160:161], v26 offset:16384
  v_mfma_f32_16x16x32_bf16 v[132:135], v[192:195], v[68:71], v[132:135]
  ds_read_b64_tr_b16 v[162:163], v26 offset:18432
  v_mfma_f32_16x16x32_bf16 v[140:143], v[196:199], v[68:71], v[140:143]
  ds_read_b64_tr_b16 v[164:165], v27 offset:16384
  v_mfma_f32_16x16x32_bf16 v[136:139], v[196:199], v[64:67], v[136:139]
  ds_read_b64_tr_b16 v[166:167], v27 offset:18432
  v_mfma_f32_16x16x32_bf16 v[144:147], v[200:203], v[64:67], v[144:147]
  ds_read_b64_tr_b16 v[168:169], v28 offset:16384
  v_mfma_f32_16x16x32_bf16 v[148:151], v[200:203], v[68:71], v[148:151]
  ds_read_b64_tr_b16 v[170:171], v28 offset:18432
  v_mfma_f32_16x16x32_bf16 v[156:159], v[204:207], v[68:71], v[156:159]
  ds_read_b64_tr_b16 v[172:173], v29 offset:16384
  v_mfma_f32_16x16x32_bf16 v[152:155], v[204:207], v[64:67], v[152:155]
  ds_read_b64_tr_b16 v[174:175], v29 offset:18432
  s_waitcnt vmcnt(8) lgkmcnt(8)
  v_mfma_f32_16x16x32_bf16 v[128:131], v[208:211], v[72:75], v[128:131]
  ds_read_b64_tr_b16 v[176:177], v26 offset:20480
  v_mfma_f32_16x16x32_bf16 v[132:135], v[208:211], v[76:79], v[132:135]
  ds_read_b64_tr_b16 v[178:179], v26 offset:22528
  v_mfma_f32_16x16x32_bf16 v[140:143], v[212:215], v[76:79], v[140:143]
  ds_read_b64_tr_b16 v[180:181], v27 offset:20480
  v_mfma_f32_16x16x32_bf16 v[136:139], v[212:215], v[72:75], v[136:139]
  ds_read_b64_tr_b16 v[182:183], v27 offset:22528
  v_mfma_f32_16x16x32_bf16 v[144:147], v[216:219], v[72:75], v[144:147]
  ds_read_b64_tr_b16 v[184:185], v28 offset:20480
  v_mfma_f32_16x16x32_bf16 v[148:151], v[216:219], v[76:79], v[148:151]
  ds_read_b64_tr_b16 v[186:187], v28 offset:22528
  v_mfma_f32_16x16x32_bf16 v[156:159], v[220:223], v[76:79], v[156:159]
  ds_read_b64_tr_b16 v[188:189], v29 offset:20480
  v_mfma_f32_16x16x32_bf16 v[152:155], v[220:223], v[72:75], v[152:155]
  ds_read_b64_tr_b16 v[190:191], v29 offset:22528
  s_waitcnt vmcnt(6) lgkmcnt(8)
  v_mfma_f32_16x16x32_bf16 v[128:131], v[160:163], v[80:83], v[128:131]
  ds_read_b64_tr_b16 v[192:193], v26 offset:24576
  v_mfma_f32_16x16x32_bf16 v[132:135], v[160:163], v[84:87], v[132:135]
  ds_read_b64_tr_b16 v[194:195], v26 offset:26624
  v_mfma_f32_16x16x32_bf16 v[140:143], v[164:167], v[84:87], v[140:143]
  ds_read_b64_tr_b16 v[196:197], v27 offset:24576
  v_mfma_f32_16x16x32_bf16 v[136:139], v[164:167], v[80:83], v[136:139]
  ds_read_b64_tr_b16 v[198:199], v27 offset:26624
  v_mfma_f32_16x16x32_bf16 v[144:147], v[168:171], v[80:83], v[144:147]
  ds_read_b64_tr_b16 v[200:201], v28 offset:24576
  v_mfma_f32_16x16x32_bf16 v[148:151], v[168:171], v[84:87], v[148:151]
  ds_read_b64_tr_b16 v[202:203], v28 offset:26624
  v_mfma_f32_16x16x32_bf16 v[156:159], v[172:175], v[84:87], v[156:159]
  ds_read_b64_tr_b16 v[204:205], v29 offset:24576
  v_mfma_f32_16x16x32_bf16 v[152:155], v[172:175], v[80:83], v[152:155]
  ds_read_b64_tr_b16 v[206:207], v29 offset:26624
  s_waitcnt vmcnt(4) lgkmcnt(8)
  v_mfma_f32_16x16x32_bf16 v[128:131], v[176:179], v[88:91], v[128:131]
  ds_read_b64_tr_b16 v[208:209], v26 offset:28672
  v_mfma_f32_16x16x32_bf16 v[132:135], v[176:179], v[92:95], v[132:135]
  ds_read_b64_tr_b16 v[210:211], v26 offset:30720
  v_mfma_f32_16x16x32_bf16 v[140:143], v[180:183], v[92:95], v[140:143]
  ds_read_b64_tr_b16 v[212:213], v27 offset:28672
  v_mfma_f32_16x16x32_bf16 v[136:139], v[180:183], v[88:91], v[136:139]
  ds_read_b64_tr_b16 v[214:215], v27 offset:30720
  v_mfma_f32_16x16x32_bf16 v[144:147], v[184:187], v[88:91], v[144:147]
  ds_read_b64_tr_b16 v[216:217], v28 offset:28672
  v_mfma_f32_16x16x32_bf16 v[148:151], v[184:187], v[92:95], v[148:151]
  ds_read_b64_tr_b16 v[218:219], v28 offset:30720
  v_mfma_f32_16x16x32_bf16 v[156:159], v[188:191], v[92:95], v[156:159]
  ds_read_b64_tr_b16 v[220:221], v29 offset:28672
  v_mfma_f32_16x16x32_bf16 v[152:155], v[188:191], v[88:91], v[152:155]
  ds_read_b64_tr_b16 v[222:223], v29 offset:30720
  s_waitcnt vmcnt(2) lgkmcnt(8)
  v_mfma_f32_16x16x32_bf16 v[128:131], v[192:195], v[224:227], v[128:131]
  ds_read_b64_tr_b16 v[160:161], v6 offset:0
  v_mfma_f32_16x16x32_bf16 v[132:135], v[192:195], v[228:231], v[132:135]
  ds_read_b64_tr_b16 v[162:163], v6 offset:2048
  v_mfma_f32_16x16x32_bf16 v[140:143], v[196:199], v[228:231], v[140:143]
  ds_read_b64_tr_b16 v[164:165], v7 offset:0
  v_mfma_f32_16x16x32_bf16 v[136:139], v[196:199], v[224:227], v[136:139]
  ds_read_b64_tr_b16 v[166:167], v7 offset:2048
  v_mfma_f32_16x16x32_bf16 v[144:147], v[200:203], v[224:227], v[144:147]
  ds_read_b64_tr_b16 v[168:169], v8 offset:0
  v_mfma_f32_16x16x32_bf16 v[148:151], v[200:203], v[228:231], v[148:151]
  ds_read_b64_tr_b16 v[170:171], v8 offset:2048
  v_mfma_f32_16x16x32_bf16 v[156:159], v[204:207], v[228:231], v[156:159]
  ds_read_b64_tr_b16 v[172:173], v9 offset:0
  v_mfma_f32_16x16x32_bf16 v[152:155], v[204:207], v[224:227], v[152:155]
  ds_read_b64_tr_b16 v[174:175], v9 offset:2048
  s_waitcnt vmcnt(0) lgkmcnt(8)
  s_barrier
  v_mfma_f32_16x16x32_bf16 v[128:131], v[208:211], v[232:235], v[128:131]
  ds_read_b64_tr_b16 v[176:177], v6 offset:4096
  v_mfma_f32_16x16x32_bf16 v[132:135], v[208:211], v[236:239], v[132:135]
  ds_read_b64_tr_b16 v[178:179], v6 offset:6144
  v_mfma_f32_16x16x32_bf16 v[140:143], v[212:215], v[236:239], v[140:143]
  ds_read_b64_tr_b16 v[180:181], v7 offset:4096
  v_mfma_f32_16x16x32_bf16 v[136:139], v[212:215], v[232:235], v[136:139]
  ds_read_b64_tr_b16 v[182:183], v7 offset:6144
  v_mfma_f32_16x16x32_bf16 v[144:147], v[216:219], v[232:235], v[144:147]
  ds_read_b64_tr_b16 v[184:185], v8 offset:4096
  v_mfma_f32_16x16x32_bf16 v[148:151], v[216:219], v[236:239], v[148:151]
  ds_read_b64_tr_b16 v[186:187], v8 offset:6144
  v_mfma_f32_16x16x32_bf16 v[156:159], v[220:223], v[236:239], v[156:159]
  ds_read_b64_tr_b16 v[188:189], v9 offset:4096
  v_mfma_f32_16x16x32_bf16 v[152:155], v[220:223], v[232:235], v[152:155]
  ds_read_b64_tr_b16 v[190:191], v9 offset:6144
  s_waitcnt lgkmcnt(8)
  v_mfma_f32_16x16x32_bf16 v[96:99], v[160:163], v[240:243], v[96:99]
  ds_read_b64_tr_b16 v[192:193], v6 offset:8192
  v_mfma_f32_16x16x32_bf16 v[100:103], v[160:163], v[244:247], v[100:103]
  ds_read_b64_tr_b16 v[194:195], v6 offset:10240
  v_mfma_f32_16x16x32_bf16 v[108:111], v[164:167], v[244:247], v[108:111]
  ds_read_b64_tr_b16 v[196:197], v7 offset:8192
  v_cvt_pk_bf16_f32 v128, v128, v129
  v_mfma_f32_16x16x32_bf16 v[104:107], v[164:167], v[240:243], v[104:107]
  ds_read_b64_tr_b16 v[198:199], v7 offset:10240
  v_cvt_pk_bf16_f32 v129, v130, v131
  v_mfma_f32_16x16x32_bf16 v[112:115], v[168:171], v[240:243], v[112:115]
  ds_read_b64_tr_b16 v[200:201], v8 offset:8192
  v_cvt_pk_bf16_f32 v130, v132, v133
  v_mfma_f32_16x16x32_bf16 v[116:119], v[168:171], v[244:247], v[116:119]
  ds_read_b64_tr_b16 v[202:203], v8 offset:10240
  v_cvt_pk_bf16_f32 v131, v134, v135
  v_mfma_f32_16x16x32_bf16 v[124:127], v[172:175], v[244:247], v[124:127]
  ds_read_b64_tr_b16 v[204:205], v9 offset:8192
  buffer_store_dwordx4 v[128:131], off, s[60:63], s4 offset:0 sc1
  v_mfma_f32_16x16x32_bf16 v[120:123], v[172:175], v[240:243], v[120:123]
  ds_read_b64_tr_b16 v[206:207], v9 offset:10240
  s_waitcnt lgkmcnt(8)
  v_mfma_f32_16x16x32_bf16 v[96:99], v[176:179], v[248:251], v[96:99]
  ds_read_b64_tr_b16 v[208:209], v6 offset:12288
  v_cvt_pk_bf16_f32 v132, v136, v137
  v_mfma_f32_16x16x32_bf16 v[100:103], v[176:179], v[252:255], v[100:103]
  ds_read_b64_tr_b16 v[210:211], v6 offset:14336
  v_cvt_pk_bf16_f32 v133, v138, v139
  v_mfma_f32_16x16x32_bf16 v[108:111], v[180:183], v[252:255], v[108:111]
  ds_read_b64_tr_b16 v[212:213], v7 offset:12288
  v_cvt_pk_bf16_f32 v134, v140, v141
  v_mfma_f32_16x16x32_bf16 v[104:107], v[180:183], v[248:251], v[104:107]
  ds_read_b64_tr_b16 v[214:215], v7 offset:14336
  v_cvt_pk_bf16_f32 v135, v142, v143
  v_mfma_f32_16x16x32_bf16 v[112:115], v[184:187], v[248:251], v[112:115]
  ds_read_b64_tr_b16 v[216:217], v8 offset:12288
  buffer_store_dwordx4 v[132:135], off, s[60:63], s4 offset:1024 sc1
  v_mfma_f32_16x16x32_bf16 v[116:119], v[184:187], v[252:255], v[116:119]
  ds_read_b64_tr_b16 v[218:219], v8 offset:14336
  v_readlane_b32 s51, v30, 23
  v_mfma_f32_16x16x32_bf16 v[124:127], v[188:191], v[252:255], v[124:127]
  ds_read_b64_tr_b16 v[220:221], v9 offset:12288
  v_cvt_pk_bf16_f32 v136, v144, v145
  v_mfma_f32_16x16x32_bf16 v[120:123], v[188:191], v[248:251], v[120:123]
  ds_read_b64_tr_b16 v[222:223], v9 offset:14336
  s_waitcnt lgkmcnt(8)
  v_mfma_f32_16x16x32_bf16 v[96:99], v[192:195], v[32:35], v[96:99]
  ds_read_b64_tr_b16 v[160:161], v6 offset:16384
  buffer_load_dwordx4 v[240:243], off, s[36:39], s51 offset:0 sc1
  v_mfma_f32_16x16x32_bf16 v[100:103], v[192:195], v[36:39], v[100:103]
  ds_read_b64_tr_b16 v[162:163], v6 offset:18432
  v_cvt_pk_bf16_f32 v137, v146, v147
  v_mfma_f32_16x16x32_bf16 v[108:111], v[196:199], v[36:39], v[108:111]
  ds_read_b64_tr_b16 v[164:165], v7 offset:16384
  v_cvt_pk_bf16_f32 v138, v148, v149
  v_mfma_f32_16x16x32_bf16 v[104:107], v[196:199], v[32:35], v[104:107]
  ds_read_b64_tr_b16 v[166:167], v7 offset:18432
  v_cvt_pk_bf16_f32 v139, v150, v151
  v_mfma_f32_16x16x32_bf16 v[112:115], v[200:203], v[32:35], v[112:115]
  ds_read_b64_tr_b16 v[168:169], v8 offset:16384
  buffer_load_dwordx4 v[244:247], off, s[64:67], s51 offset:0 sc1
  v_mfma_f32_16x16x32_bf16 v[116:119], v[200:203], v[36:39], v[116:119]
  ds_read_b64_tr_b16 v[170:171], v8 offset:18432
  buffer_store_dwordx4 v[136:139], off, s[60:63], s4 offset:2048 sc1
  v_mfma_f32_16x16x32_bf16 v[124:127], v[204:207], v[36:39], v[124:127]
  ds_read_b64_tr_b16 v[172:173], v9 offset:16384
  v_cvt_pk_bf16_f32 v140, v152, v153
  v_mfma_f32_16x16x32_bf16 v[120:123], v[204:207], v[32:35], v[120:123]
  ds_read_b64_tr_b16 v[174:175], v9 offset:18432
  s_waitcnt lgkmcnt(8)
  v_mfma_f32_16x16x32_bf16 v[96:99], v[208:211], v[40:43], v[96:99]
  ds_read_b64_tr_b16 v[176:177], v6 offset:20480
  buffer_load_dwordx4 v[248:251], off, s[36:39], s51 offset:1024 sc1
  v_mfma_f32_16x16x32_bf16 v[100:103], v[208:211], v[44:47], v[100:103]
  ds_read_b64_tr_b16 v[178:179], v6 offset:22528
  v_cvt_pk_bf16_f32 v141, v154, v155
  v_mfma_f32_16x16x32_bf16 v[108:111], v[212:215], v[44:47], v[108:111]
  ds_read_b64_tr_b16 v[180:181], v7 offset:20480
  v_cvt_pk_bf16_f32 v142, v156, v157
  v_mfma_f32_16x16x32_bf16 v[104:107], v[212:215], v[40:43], v[104:107]
  ds_read_b64_tr_b16 v[182:183], v7 offset:22528
  v_cvt_pk_bf16_f32 v143, v158, v159
  v_mfma_f32_16x16x32_bf16 v[112:115], v[216:219], v[40:43], v[112:115]
  ds_read_b64_tr_b16 v[184:185], v8 offset:20480
  buffer_load_dwordx4 v[252:255], off, s[64:67], s51 offset:1024 sc1
  v_mfma_f32_16x16x32_bf16 v[116:119], v[216:219], v[44:47], v[116:119]
  ds_read_b64_tr_b16 v[186:187], v8 offset:22528
  buffer_store_dwordx4 v[140:143], off, s[60:63], s4 offset:3072 sc1
  v_mfma_f32_16x16x32_bf16 v[124:127], v[220:223], v[44:47], v[124:127]
  ds_read_b64_tr_b16 v[188:189], v9 offset:20480
  v_readlane_b32 s48, v30, 24
  v_mfma_f32_16x16x32_bf16 v[120:123], v[220:223], v[40:43], v[120:123]
  ds_read_b64_tr_b16 v[190:191], v9 offset:22528
  s_waitcnt lgkmcnt(8)
  v_mfma_f32_16x16x32_bf16 v[96:99], v[160:163], v[48:51], v[96:99]
  ds_read_b64_tr_b16 v[192:193], v6 offset:24576
  v_mfma_f32_16x16x32_bf16 v[100:103], v[160:163], v[52:55], v[100:103]
  buffer_load_dwordx4 v[32:35], off, s[36:39], s48 offset:0 sc1
  v_mfma_f32_16x16x32_bf16 v[108:111], v[164:167], v[52:55], v[108:111]
  ds_read_b64_tr_b16 v[194:195], v6 offset:26624
  ds_read_b64_tr_b16 v[196:197], v7 offset:24576
  v_mfma_f32_16x16x32_bf16 v[104:107], v[164:167], v[48:51], v[104:107]
  ds_read_b64_tr_b16 v[198:199], v7 offset:26624
  v_mfma_f32_16x16x32_bf16 v[112:115], v[168:171], v[48:51], v[112:115]
  ds_read_b64_tr_b16 v[200:201], v8 offset:24576
  v_mfma_f32_16x16x32_bf16 v[116:119], v[168:171], v[52:55], v[116:119]
  buffer_load_dwordx4 v[36:39], off, s[64:67], s48 offset:0 sc1
  v_mfma_f32_16x16x32_bf16 v[124:127], v[172:175], v[52:55], v[124:127]
  ds_read_b64_tr_b16 v[202:203], v8 offset:26624
  ds_read_b64_tr_b16 v[204:205], v9 offset:24576
  v_mfma_f32_16x16x32_bf16 v[120:123], v[172:175], v[48:51], v[120:123]
  ds_read_b64_tr_b16 v[206:207], v9 offset:26624
  s_waitcnt lgkmcnt(8)
  v_mfma_f32_16x16x32_bf16 v[96:99], v[176:179], v[56:59], v[96:99]
  ds_read_b64_tr_b16 v[208:209], v6 offset:28672
  v_mfma_f32_16x16x32_bf16 v[100:103], v[176:179], v[60:63], v[100:103]
  buffer_load_dwordx4 v[40:43], off, s[36:39], s48 offset:1024 sc1
  v_mfma_f32_16x16x32_bf16 v[108:111], v[180:183], v[60:63], v[108:111]
  ds_read_b64_tr_b16 v[210:211], v6 offset:30720
  ds_read_b64_tr_b16 v[212:213], v7 offset:28672
  v_mfma_f32_16x16x32_bf16 v[104:107], v[180:183], v[56:59], v[104:107]
  ds_read_b64_tr_b16 v[214:215], v7 offset:30720
  v_mfma_f32_16x16x32_bf16 v[112:115], v[184:187], v[56:59], v[112:115]
  ds_read_b64_tr_b16 v[216:217], v8 offset:28672
  v_mfma_f32_16x16x32_bf16 v[116:119], v[184:187], v[60:63], v[116:119]
  buffer_load_dwordx4 v[44:47], off, s[64:67], s48 offset:1024 sc1
  v_mfma_f32_16x16x32_bf16 v[124:127], v[188:191], v[60:63], v[124:127]
  ds_read_b64_tr_b16 v[218:219], v8 offset:30720
  ds_read_b64_tr_b16 v[220:221], v9 offset:28672
  v_mfma_f32_16x16x32_bf16 v[120:123], v[188:191], v[56:59], v[120:123]
  ds_read_b64_tr_b16 v[222:223], v9 offset:30720
  s_waitcnt lgkmcnt(8)
  v_mfma_f32_16x16x32_bf16 v[96:99], v[192:195], v[64:67], v[96:99]
  ds_read_b64_tr_b16 v[160:161], v6 offset:32768
  v_readlane_b32 s49, v30, 25
  v_mfma_f32_16x16x32_bf16 v[100:103], v[192:195], v[68:71], v[100:103]
  ds_read_b64_tr_b16 v[162:163], v6 offset:34816
  v_mfma_f32_16x16x32_bf16 v[108:111], v[196:199], v[68:71], v[108:111]
  ds_read_b64_tr_b16 v[164:165], v7 offset:32768
  v_mfma_f32_16x16x32_bf16 v[104:107], v[196:199], v[64:67], v[104:107]
  buffer_load_dwordx4 v[48:51], off, s[36:39], s49 offset:0 sc1
  v_mfma_f32_16x16x32_bf16 v[112:115], v[200:203], v[64:67], v[112:115]
  ds_read_b64_tr_b16 v[166:167], v7 offset:34816
  ds_read_b64_tr_b16 v[168:169], v8 offset:32768
  v_mfma_f32_16x16x32_bf16 v[116:119], v[200:203], v[68:71], v[116:119]
  ds_read_b64_tr_b16 v[170:171], v8 offset:34816
  v_mfma_f32_16x16x32_bf16 v[124:127], v[204:207], v[68:71], v[124:127]
  ds_read_b64_tr_b16 v[172:173], v9 offset:32768
  v_mfma_f32_16x16x32_bf16 v[120:123], v[204:207], v[64:67], v[120:123]
  ds_read_b64_tr_b16 v[174:175], v9 offset:34816
  s_waitcnt lgkmcnt(8)
  s_barrier
  v_mfma_f32_16x16x32_bf16 v[96:99], v[208:211], v[72:75], v[96:99]
  buffer_load_dwordx4 v[52:55], off, s[64:67], s49 offset:0 sc1
  v_mfma_f32_16x16x32_bf16 v[100:103], v[208:211], v[76:79], v[100:103]
  ds_read_b64_tr_b16 v[176:177], v6 offset:36864
  ds_read_b64_tr_b16 v[178:179], v6 offset:38912
  v_mfma_f32_16x16x32_bf16 v[108:111], v[212:215], v[76:79], v[108:111]
  ds_read_b64_tr_b16 v[180:181], v7 offset:36864
  v_mfma_f32_16x16x32_bf16 v[104:107], v[212:215], v[72:75], v[104:107]
  ds_read_b64_tr_b16 v[182:183], v7 offset:38912
  v_mfma_f32_16x16x32_bf16 v[112:115], v[216:219], v[72:75], v[112:115]
  buffer_load_dwordx4 v[56:59], off, s[36:39], s49 offset:1024 sc1
  v_mfma_f32_16x16x32_bf16 v[116:119], v[216:219], v[76:79], v[116:119]
  ds_read_b64_tr_b16 v[184:185], v8 offset:36864
  ds_read_b64_tr_b16 v[186:187], v8 offset:38912
  v_mfma_f32_16x16x32_bf16 v[124:127], v[220:223], v[76:79], v[124:127]
  ds_read_b64_tr_b16 v[188:189], v9 offset:36864
  v_mfma_f32_16x16x32_bf16 v[120:123], v[220:223], v[72:75], v[120:123]
  ds_read_b64_tr_b16 v[190:191], v9 offset:38912
  s_waitcnt lgkmcnt(8)
  v_mfma_f32_16x16x32_bf16 v[96:99], v[160:163], v[80:83], v[96:99]
  ds_read_b64_tr_b16 v[192:193], v6 offset:40960
  buffer_load_dwordx4 v[60:63], off, s[64:67], s49 offset:1024 sc1
  v_mfma_f32_16x16x32_bf16 v[100:103], v[160:163], v[84:87], v[100:103]
  ds_read_b64_tr_b16 v[194:195], v6 offset:43008
  s_waitcnt vmcnt(8)
  v_mfma_f32_16x16x32_bf16 v[108:111], v[164:167], v[84:87], v[108:111]
  ds_read_b64_tr_b16 v[196:197], v7 offset:40960
  v_readlane_b32 s50, v30, 26
  v_mfma_f32_16x16x32_bf16 v[104:107], v[164:167], v[80:83], v[104:107]
  buffer_store_dword v19, off, s[52:55], s6 sc1
  v_mfma_f32_16x16x32_bf16 v[112:115], v[168:171], v[80:83], v[112:115]
  ds_read_b64_tr_b16 v[198:199], v7 offset:43008
  ds_read_b64_tr_b16 v[200:201], v8 offset:40960
  v_mfma_f32_16x16x32_bf16 v[116:119], v[168:171], v[84:87], v[116:119]
  buffer_load_dwordx4 v[64:67], off, s[36:39], s50 offset:0 sc1
  v_mfma_f32_16x16x32_bf16 v[124:127], v[172:175], v[84:87], v[124:127]
  ds_read_b64_tr_b16 v[202:203], v8 offset:43008
  ds_read_b64_tr_b16 v[204:205], v9 offset:40960
  v_mfma_f32_16x16x32_bf16 v[120:123], v[172:175], v[80:83], v[120:123]
  ds_read_b64_tr_b16 v[206:207], v9 offset:43008
  s_waitcnt lgkmcnt(8)
  v_mfma_f32_16x16x32_bf16 v[96:99], v[176:179], v[88:91], v[96:99]
  ds_read_b64_tr_b16 v[208:209], v6 offset:45056
  v_mfma_f32_16x16x32_bf16 v[100:103], v[176:179], v[92:95], v[100:103]
  buffer_load_dwordx4 v[68:71], off, s[64:67], s50 offset:0 sc1
  v_mfma_f32_16x16x32_bf16 v[108:111], v[180:183], v[92:95], v[108:111]
  ds_read_b64_tr_b16 v[210:211], v6 offset:47104
  ds_read_b64_tr_b16 v[212:213], v7 offset:45056
  v_mfma_f32_16x16x32_bf16 v[104:107], v[180:183], v[88:91], v[104:107]
  ds_read_b64_tr_b16 v[214:215], v7 offset:47104
  v_mfma_f32_16x16x32_bf16 v[112:115], v[184:187], v[88:91], v[112:115]
  ds_read_b64_tr_b16 v[216:217], v8 offset:45056
  v_mfma_f32_16x16x32_bf16 v[116:119], v[184:187], v[92:95], v[116:119]
  buffer_load_dwordx4 v[72:75], off, s[36:39], s50 offset:1024 sc1
  v_mfma_f32_16x16x32_bf16 v[124:127], v[188:191], v[92:95], v[124:127]
  ds_read_b64_tr_b16 v[218:219], v8 offset:47104
  ds_read_b64_tr_b16 v[220:221], v9 offset:45056
  v_mfma_f32_16x16x32_bf16 v[120:123], v[188:191], v[88:91], v[120:123]
  ds_read_b64_tr_b16 v[222:223], v9 offset:47104
  s_waitcnt lgkmcnt(8)
  v_mfma_f32_16x16x32_bf16 v[96:99], v[192:195], v[224:227], v[96:99]
  ds_read_b64_tr_b16 v[160:161], v6 offset:49152
  v_mfma_f32_16x16x32_bf16 v[100:103], v[192:195], v[228:231], v[100:103]
  buffer_load_dwordx4 v[76:79], off, s[64:67], s50 offset:1024 sc1
  v_mfma_f32_16x16x32_bf16 v[108:111], v[196:199], v[228:231], v[108:111]
  ds_read_b64_tr_b16 v[162:163], v6 offset:51200
  ds_read_b64_tr_b16 v[164:165], v7 offset:49152
  v_mfma_f32_16x16x32_bf16 v[104:107], v[196:199], v[224:227], v[104:107]
  ds_read_b64_tr_b16 v[166:167], v7 offset:51200
  v_readlane_b32 s51, v30, 27
  v_mfma_f32_16x16x32_bf16 v[112:115], v[200:203], v[224:227], v[112:115]
  ds_read_b64_tr_b16 v[168:169], v8 offset:49152
  v_mfma_f32_16x16x32_bf16 v[116:119], v[200:203], v[228:231], v[116:119]
  ds_read_b64_tr_b16 v[170:171], v8 offset:51200
  ds_read_b64_tr_b16 v[172:173], v9 offset:49152
  v_mfma_f32_16x16x32_bf16 v[124:127], v[204:207], v[228:231], v[124:127]
  buffer_load_dwordx4 v[80:83], off, s[36:39], s51 offset:0 sc1
  v_mfma_f32_16x16x32_bf16 v[120:123], v[204:207], v[224:227], v[120:123]
  ds_read_b64_tr_b16 v[174:175], v9 offset:51200
  s_waitcnt lgkmcnt(8)
  v_mfma_f32_16x16x32_bf16 v[96:99], v[208:211], v[232:235], v[96:99]
  ds_read_b64_tr_b16 v[176:177], v6 offset:53248
  v_mfma_f32_16x16x32_bf16 v[100:103], v[208:211], v[236:239], v[100:103]
  ds_read_b64_tr_b16 v[178:179], v6 offset:55296
  v_mfma_f32_16x16x32_bf16 v[108:111], v[212:215], v[236:239], v[108:111]
  buffer_load_dwordx4 v[84:87], off, s[64:67], s51 offset:0 sc1
  v_mfma_f32_16x16x32_bf16 v[104:107], v[212:215], v[232:235], v[104:107]
  ds_read_b64_tr_b16 v[180:181], v7 offset:53248
  ds_read_b64_tr_b16 v[182:183], v7 offset:55296
  v_mfma_f32_16x16x32_bf16 v[112:115], v[216:219], v[232:235], v[112:115]
  ds_read_b64_tr_b16 v[184:185], v8 offset:53248
  v_mfma_f32_16x16x32_bf16 v[116:119], v[216:219], v[236:239], v[116:119]
  ds_read_b64_tr_b16 v[186:187], v8 offset:55296
  ds_read_b64_tr_b16 v[188:189], v9 offset:53248
  v_mfma_f32_16x16x32_bf16 v[124:127], v[220:223], v[236:239], v[124:127]
  buffer_load_dwordx4 v[88:91], off, s[36:39], s51 offset:1024 sc1
  v_mfma_f32_16x16x32_bf16 v[120:123], v[220:223], v[232:235], v[120:123]
  ds_read_b64_tr_b16 v[190:191], v9 offset:55296
  s_waitcnt lgkmcnt(8)
  v_mfma_f32_16x16x32_bf16 v[96:99], v[160:163], v[240:243], v[96:99]
  ds_read_b64_tr_b16 v[192:193], v6 offset:57344
  v_mfma_f32_16x16x32_bf16 v[100:103], v[160:163], v[244:247], v[100:103]
  ds_read_b64_tr_b16 v[194:195], v6 offset:59392
  v_mfma_f32_16x16x32_bf16 v[108:111], v[164:167], v[244:247], v[108:111]
  buffer_load_dwordx4 v[92:95], off, s[64:67], s51 offset:1024 sc1
  v_mfma_f32_16x16x32_bf16 v[104:107], v[164:167], v[240:243], v[104:107]
  ds_read_b64_tr_b16 v[196:197], v7 offset:57344
  ds_read_b64_tr_b16 v[198:199], v7 offset:59392
  v_mfma_f32_16x16x32_bf16 v[112:115], v[168:171], v[240:243], v[112:115]
  ds_read_b64_tr_b16 v[200:201], v8 offset:57344
  v_readlane_b32 s48, v30, 28
  v_mfma_f32_16x16x32_bf16 v[116:119], v[168:171], v[244:247], v[116:119]
  ds_read_b64_tr_b16 v[202:203], v8 offset:59392
  v_mfma_f32_16x16x32_bf16 v[124:127], v[172:175], v[244:247], v[124:127]
  ds_read_b64_tr_b16 v[204:205], v9 offset:57344
  v_mfma_f32_16x16x32_bf16 v[120:123], v[172:175], v[240:243], v[120:123]
  ds_read_b64_tr_b16 v[206:207], v9 offset:59392
  s_waitcnt lgkmcnt(8)
  v_mfma_f32_16x16x32_bf16 v[96:99], v[176:179], v[248:251], v[96:99]
  buffer_load_dwordx4 v[224:227], off, s[36:39], s48 offset:0 sc1
  v_mfma_f32_16x16x32_bf16 v[100:103], v[176:179], v[252:255], v[100:103]
  ds_read_b64_tr_b16 v[208:209], v6 offset:61440
  ds_read_b64_tr_b16 v[210:211], v6 offset:63488
  v_mfma_f32_16x16x32_bf16 v[108:111], v[180:183], v[252:255], v[108:111]
  ds_read_b64_tr_b16 v[212:213], v7 offset:61440
  v_mfma_f32_16x16x32_bf16 v[104:107], v[180:183], v[248:251], v[104:107]
  ds_read_b64_tr_b16 v[214:215], v7 offset:63488
  v_mfma_f32_16x16x32_bf16 v[112:115], v[184:187], v[248:251], v[112:115]
  buffer_load_dwordx4 v[228:231], off, s[64:67], s48 offset:0 sc1
  v_mfma_f32_16x16x32_bf16 v[116:119], v[184:187], v[252:255], v[116:119]
  ds_read_b64_tr_b16 v[216:217], v8 offset:61440
  ds_read_b64_tr_b16 v[218:219], v8 offset:63488
  v_mfma_f32_16x16x32_bf16 v[124:127], v[188:191], v[252:255], v[124:127]
  ds_read_b64_tr_b16 v[220:221], v9 offset:61440
  v_mfma_f32_16x16x32_bf16 v[120:123], v[188:191], v[248:251], v[120:123]
  ds_read_b64_tr_b16 v[222:223], v9 offset:63488
  s_waitcnt vmcnt(17) lgkmcnt(8)
  v_mfma_f32_16x16x32_bf16 v[96:99], v[192:195], v[32:35], v[96:99]
  buffer_load_dwordx4 v[232:235], off, s[36:39], s48 offset:1024 sc1
  v_mfma_f32_16x16x32_bf16 v[100:103], v[192:195], v[36:39], v[100:103]
  ds_read_b64_tr_b16 v[160:161], v20 offset:0
  ds_read_b64_tr_b16 v[162:163], v20 offset:2048
  v_mfma_f32_16x16x32_bf16 v[108:111], v[196:199], v[36:39], v[108:111]
  ds_read_b64_tr_b16 v[164:165], v21 offset:0
  v_mfma_f32_16x16x32_bf16 v[104:107], v[196:199], v[32:35], v[104:107]
  ds_read_b64_tr_b16 v[166:167], v21 offset:2048
  v_mfma_f32_16x16x32_bf16 v[112:115], v[200:203], v[32:35], v[112:115]
  buffer_load_dwordx4 v[236:239], off, s[64:67], s48 offset:1024 sc1
  v_mfma_f32_16x16x32_bf16 v[116:119], v[200:203], v[36:39], v[116:119]
  ds_read_b64_tr_b16 v[168:169], v22 offset:0
  ds_read_b64_tr_b16 v[170:171], v22 offset:2048
  v_mfma_f32_16x16x32_bf16 v[124:127], v[204:207], v[36:39], v[124:127]
  ds_read_b64_tr_b16 v[172:173], v23 offset:0
  v_readlane_b32 s49, v30, 29
  v_mfma_f32_16x16x32_bf16 v[120:123], v[204:207], v[32:35], v[120:123]
  ds_read_b64_tr_b16 v[174:175], v23 offset:2048
  s_waitcnt vmcnt(17) lgkmcnt(8)
  v_mfma_f32_16x16x32_bf16 v[96:99], v[208:211], v[40:43], v[96:99]
  ds_read_b64_tr_b16 v[176:177], v20 offset:4096
  v_mfma_f32_16x16x32_bf16 v[100:103], v[208:211], v[44:47], v[100:103]
  buffer_load_dwordx4 v[240:243], off, s[36:39], s49 offset:0 sc1
  v_mfma_f32_16x16x32_bf16 v[108:111], v[212:215], v[44:47], v[108:111]
  ds_read_b64_tr_b16 v[178:179], v20 offset:6144
  ds_read_b64_tr_b16 v[180:181], v21 offset:4096
  v_mfma_f32_16x16x32_bf16 v[104:107], v[212:215], v[40:43], v[104:107]
  ds_read_b64_tr_b16 v[182:183], v21 offset:6144
  v_mfma_f32_16x16x32_bf16 v[112:115], v[216:219], v[40:43], v[112:115]
  ds_read_b64_tr_b16 v[184:185], v22 offset:4096
  v_mfma_f32_16x16x32_bf16 v[116:119], v[216:219], v[44:47], v[116:119]
  buffer_load_dwordx4 v[244:247], off, s[64:67], s49 offset:0 sc1
  v_mfma_f32_16x16x32_bf16 v[124:127], v[220:223], v[44:47], v[124:127]
  ds_read_b64_tr_b16 v[186:187], v22 offset:6144
  ds_read_b64_tr_b16 v[188:189], v23 offset:4096
  v_mfma_f32_16x16x32_bf16 v[120:123], v[220:223], v[40:43], v[120:123]
  ds_read_b64_tr_b16 v[190:191], v23 offset:6144
  s_waitcnt vmcnt(17) lgkmcnt(8)
  v_mfma_f32_16x16x32_bf16 v[96:99], v[160:163], v[48:51], v[96:99]
  ds_read_b64_tr_b16 v[192:193], v20 offset:8192
  v_mfma_f32_16x16x32_bf16 v[100:103], v[160:163], v[52:55], v[100:103]
  buffer_load_dwordx4 v[248:251], off, s[36:39], s49 offset:1024 sc1
  v_mfma_f32_16x16x32_bf16 v[108:111], v[164:167], v[52:55], v[108:111]
  ds_read_b64_tr_b16 v[194:195], v20 offset:10240
  ds_read_b64_tr_b16 v[196:197], v21 offset:8192
  v_mfma_f32_16x16x32_bf16 v[104:107], v[164:167], v[48:51], v[104:107]
  ds_read_b64_tr_b16 v[198:199], v21 offset:10240
  v_mfma_f32_16x16x32_bf16 v[112:115], v[168:171], v[48:51], v[112:115]
  ds_read_b64_tr_b16 v[200:201], v22 offset:8192
  v_mfma_f32_16x16x32_bf16 v[116:119], v[168:171], v[52:55], v[116:119]
  buffer_load_dwordx4 v[252:255], off, s[64:67], s49 offset:1024 sc1
  v_mfma_f32_16x16x32_bf16 v[124:127], v[172:175], v[52:55], v[124:127]
  ds_read_b64_tr_b16 v[202:203], v22 offset:10240
  ds_read_b64_tr_b16 v[204:205], v23 offset:8192
  v_mfma_f32_16x16x32_bf16 v[120:123], v[172:175], v[48:51], v[120:123]
  ds_read_b64_tr_b16 v[206:207], v23 offset:10240
  s_waitcnt vmcnt(17) lgkmcnt(8)
  v_mfma_f32_16x16x32_bf16 v[96:99], v[176:179], v[56:59], v[96:99]
  ds_read_b64_tr_b16 v[208:209], v20 offset:12288
  v_readlane_b32 s50, v30, 30
  v_mfma_f32_16x16x32_bf16 v[100:103], v[176:179], v[60:63], v[100:103]
  ds_read_b64_tr_b16 v[210:211], v20 offset:14336
  v_mfma_f32_16x16x32_bf16 v[108:111], v[180:183], v[60:63], v[108:111]
  ds_read_b64_tr_b16 v[212:213], v21 offset:12288
  v_mfma_f32_16x16x32_bf16 v[104:107], v[180:183], v[56:59], v[104:107]
  buffer_load_dwordx4 v[32:35], off, s[36:39], s50 offset:0 sc1
  v_mfma_f32_16x16x32_bf16 v[112:115], v[184:187], v[56:59], v[112:115]
  ds_read_b64_tr_b16 v[214:215], v21 offset:14336
  ds_read_b64_tr_b16 v[216:217], v22 offset:12288
  v_mfma_f32_16x16x32_bf16 v[116:119], v[184:187], v[60:63], v[116:119]
  ds_read_b64_tr_b16 v[218:219], v22 offset:14336
  v_mfma_f32_16x16x32_bf16 v[124:127], v[188:191], v[60:63], v[124:127]
  ds_read_b64_tr_b16 v[220:221], v23 offset:12288
  v_mfma_f32_16x16x32_bf16 v[120:123], v[188:191], v[56:59], v[120:123]
  ds_read_b64_tr_b16 v[222:223], v23 offset:14336
  s_waitcnt vmcnt(15) lgkmcnt(8)
  v_mfma_f32_16x16x32_bf16 v[96:99], v[192:195], v[64:67], v[96:99]
  buffer_load_dwordx4 v[36:39], off, s[64:67], s50 offset:0 sc1
  v_mfma_f32_16x16x32_bf16 v[100:103], v[192:195], v[68:71], v[100:103]
  ds_read_b64_tr_b16 v[160:161], v20 offset:16384
  ds_read_b64_tr_b16 v[162:163], v20 offset:18432
  v_mfma_f32_16x16x32_bf16 v[108:111], v[196:199], v[68:71], v[108:111]
  ds_read_b64_tr_b16 v[164:165], v21 offset:16384
  v_mfma_f32_16x16x32_bf16 v[104:107], v[196:199], v[64:67], v[104:107]
  ds_read_b64_tr_b16 v[166:167], v21 offset:18432
  v_mfma_f32_16x16x32_bf16 v[112:115], v[200:203], v[64:67], v[112:115]
  buffer_load_dwordx4 v[40:43], off, s[36:39], s50 offset:1024 sc1
  v_mfma_f32_16x16x32_bf16 v[116:119], v[200:203], v[68:71], v[116:119]
  ds_read_b64_tr_b16 v[168:169], v22 offset:16384
  ds_read_b64_tr_b16 v[170:171], v22 offset:18432
  v_mfma_f32_16x16x32_bf16 v[124:127], v[204:207], v[68:71], v[124:127]
  ds_read_b64_tr_b16 v[172:173], v23 offset:16384
  v_mfma_f32_16x16x32_bf16 v[120:123], v[204:207], v[64:67], v[120:123]
  ds_read_b64_tr_b16 v[174:175], v23 offset:18432
  s_waitcnt vmcnt(15) lgkmcnt(8)
  v_mfma_f32_16x16x32_bf16 v[96:99], v[208:211], v[72:75], v[96:99]
  buffer_load_dwordx4 v[44:47], off, s[64:67], s50 offset:1024 sc1
  v_mfma_f32_16x16x32_bf16 v[100:103], v[208:211], v[76:79], v[100:103]
  ds_read_b64_tr_b16 v[176:177], v20 offset:20480
  ds_read_b64_tr_b16 v[178:179], v20 offset:22528
  v_mfma_f32_16x16x32_bf16 v[108:111], v[212:215], v[76:79], v[108:111]
  ds_read_b64_tr_b16 v[180:181], v21 offset:20480
  v_readlane_b32 s51, v30, 31
  v_mfma_f32_16x16x32_bf16 v[104:107], v[212:215], v[72:75], v[104:107]
  ds_read_b64_tr_b16 v[182:183], v21 offset:22528
  v_mfma_f32_16x16x32_bf16 v[112:115], v[216:219], v[72:75], v[112:115]
  ds_read_b64_tr_b16 v[184:185], v22 offset:20480
  v_mfma_f32_16x16x32_bf16 v[116:119], v[216:219], v[76:79], v[116:119]
  buffer_load_dwordx4 v[48:51], off, s[36:39], s51 offset:0 sc1
  v_mfma_f32_16x16x32_bf16 v[124:127], v[220:223], v[76:79], v[124:127]
  ds_read_b64_tr_b16 v[186:187], v22 offset:22528
  ds_read_b64_tr_b16 v[188:189], v23 offset:20480
  v_mfma_f32_16x16x32_bf16 v[120:123], v[220:223], v[72:75], v[120:123]
  ds_read_b64_tr_b16 v[190:191], v23 offset:22528
  s_waitcnt vmcnt(15) lgkmcnt(8)
  v_mfma_f32_16x16x32_bf16 v[96:99], v[160:163], v[80:83], v[96:99]
  ds_read_b64_tr_b16 v[192:193], v20 offset:24576
  v_mfma_f32_16x16x32_bf16 v[100:103], v[160:163], v[84:87], v[100:103]
  buffer_load_dwordx4 v[52:55], off, s[64:67], s51 offset:0 sc1
  v_mfma_f32_16x16x32_bf16 v[108:111], v[164:167], v[84:87], v[108:111]
  ds_read_b64_tr_b16 v[194:195], v20 offset:26624
  ds_read_b64_tr_b16 v[196:197], v21 offset:24576
  v_mfma_f32_16x16x32_bf16 v[104:107], v[164:167], v[80:83], v[104:107]
  ds_read_b64_tr_b16 v[198:199], v21 offset:26624
  v_mfma_f32_16x16x32_bf16 v[112:115], v[168:171], v[80:83], v[112:115]
  ds_read_b64_tr_b16 v[200:201], v22 offset:24576
  v_mfma_f32_16x16x32_bf16 v[116:119], v[168:171], v[84:87], v[116:119]
  buffer_load_dwordx4 v[56:59], off, s[36:39], s51 offset:1024 sc1
  v_mfma_f32_16x16x32_bf16 v[124:127], v[172:175], v[84:87], v[124:127]
  ds_read_b64_tr_b16 v[202:203], v22 offset:26624
  ds_read_b64_tr_b16 v[204:205], v23 offset:24576
  v_mfma_f32_16x16x32_bf16 v[120:123], v[172:175], v[80:83], v[120:123]
  ds_read_b64_tr_b16 v[206:207], v23 offset:26624
  s_waitcnt vmcnt(15) lgkmcnt(8)
  s_barrier
  v_mfma_f32_16x16x32_bf16 v[96:99], v[176:179], v[88:91], v[96:99]
  ds_read_b64_tr_b16 v[208:209], v20 offset:28672
  buffer_load_dwordx4 v[144:147], off, s[60:63], s5 offset:0 sc1
  v_mfma_f32_16x16x32_bf16 v[100:103], v[176:179], v[92:95], v[100:103]
  ds_read_b64_tr_b16 v[210:211], v20 offset:30720
  buffer_load_dwordx4 v[60:63], off, s[64:67], s51 offset:1024 sc1
  v_mfma_f32_16x16x32_bf16 v[108:111], v[180:183], v[92:95], v[108:111]
  ds_read_b64_tr_b16 v[212:213], v21 offset:28672
  buffer_load_dwordx4 v[148:151], off, s[60:63], s5 offset:1024 sc1
  v_mfma_f32_16x16x32_bf16 v[104:107], v[180:183], v[88:91], v[104:107]
  ds_read_b64_tr_b16 v[214:215], v21 offset:30720
  v_readlane_b32 s48, v30, 32
  v_mfma_f32_16x16x32_bf16 v[112:115], v[184:187], v[88:91], v[112:115]
  buffer_load_dwordx4 v[152:155], off, s[60:63], s5 offset:2048 sc1
  v_mfma_f32_16x16x32_bf16 v[116:119], v[184:187], v[92:95], v[116:119]
  ds_read_b64_tr_b16 v[216:217], v22 offset:28672
  ds_read_b64_tr_b16 v[218:219], v22 offset:30720
  v_mfma_f32_16x16x32_bf16 v[124:127], v[188:191], v[92:95], v[124:127]
  ds_read_b64_tr_b16 v[220:221], v23 offset:28672
  buffer_load_dwordx4 v[64:67], off, s[36:39], s48 offset:0 sc1
  v_mfma_f32_16x16x32_bf16 v[120:123], v[188:191], v[88:91], v[120:123]
  ds_read_b64_tr_b16 v[222:223], v23 offset:30720
  s_waitcnt vmcnt(18) lgkmcnt(8)
  v_mfma_f32_16x16x32_bf16 v[96:99], v[192:195], v[224:227], v[96:99]
  buffer_load_dwordx4 v[156:159], off, s[60:63], s5 offset:3072 sc1
  v_mfma_f32_16x16x32_bf16 v[100:103], v[192:195], v[228:231], v[100:103]
  ds_read_b64_tr_b16 v[160:161], v20 offset:32768
  ds_read_b64_tr_b16 v[162:163], v20 offset:34816
  v_mfma_f32_16x16x32_bf16 v[108:111], v[196:199], v[228:231], v[108:111]
  buffer_load_dwordx4 v[68:71], off, s[64:67], s48 offset:0 sc1
  v_mfma_f32_16x16x32_bf16 v[104:107], v[196:199], v[224:227], v[104:107]
  ds_read_b64_tr_b16 v[164:165], v21 offset:32768
  ds_read_b64_tr_b16 v[166:167], v21 offset:34816
  v_mfma_f32_16x16x32_bf16 v[112:115], v[200:203], v[224:227], v[112:115]
  ds_read_b64_tr_b16 v[168:169], v22 offset:32768
  v_mfma_f32_16x16x32_bf16 v[116:119], v[200:203], v[228:231], v[116:119]
  ds_read_b64_tr_b16 v[170:171], v22 offset:34816
  ds_read_b64_tr_b16 v[172:173], v23 offset:32768
  v_mfma_f32_16x16x32_bf16 v[124:127], v[204:207], v[228:231], v[124:127]
  buffer_load_dwordx4 v[72:75], off, s[36:39], s48 offset:1024 sc1
  v_mfma_f32_16x16x32_bf16 v[120:123], v[204:207], v[224:227], v[120:123]
  ds_read_b64_tr_b16 v[174:175], v23 offset:34816
  s_waitcnt vmcnt(19) lgkmcnt(8)
  v_mfma_f32_16x16x32_bf16 v[96:99], v[208:211], v[232:235], v[96:99]
  ds_read_b64_tr_b16 v[176:177], v20 offset:36864
  v_mfma_f32_16x16x32_bf16 v[100:103], v[208:211], v[236:239], v[100:103]
  ds_read_b64_tr_b16 v[178:179], v20 offset:38912
  v_mfma_f32_16x16x32_bf16 v[108:111], v[212:215], v[236:239], v[108:111]
  buffer_load_dwordx4 v[76:79], off, s[64:67], s48 offset:1024 sc1
  v_mfma_f32_16x16x32_bf16 v[104:107], v[212:215], v[232:235], v[104:107]
  ds_read_b64_tr_b16 v[180:181], v21 offset:36864
  ds_read_b64_tr_b16 v[182:183], v21 offset:38912
  v_mfma_f32_16x16x32_bf16 v[112:115], v[216:219], v[232:235], v[112:115]
  ds_read_b64_tr_b16 v[184:185], v22 offset:36864
  v_mfma_f32_16x16x32_bf16 v[116:119], v[216:219], v[236:239], v[116:119]
  ds_read_b64_tr_b16 v[186:187], v22 offset:38912
  v_mfma_f32_16x16x32_bf16 v[124:127], v[220:223], v[236:239], v[124:127]
  ds_read_b64_tr_b16 v[188:189], v23 offset:36864
  v_mfma_f32_16x16x32_bf16 v[120:123], v[220:223], v[232:235], v[120:123]
  ds_read_b64_tr_b16 v[190:191], v23 offset:38912
  s_waitcnt vmcnt(18) lgkmcnt(8)
  v_mfma_f32_16x16x32_bf16 v[96:99], v[160:163], v[240:243], v[96:99]
  ds_read_b64_tr_b16 v[192:193], v20 offset:40960
  v_mfma_f32_16x16x32_bf16 v[100:103], v[160:163], v[244:247], v[100:103]
  ds_read_b64_tr_b16 v[194:195], v20 offset:43008
  v_mfma_f32_16x16x32_bf16 v[108:111], v[164:167], v[244:247], v[108:111]
  ds_read_b64_tr_b16 v[196:197], v21 offset:40960
  v_mfma_f32_16x16x32_bf16 v[104:107], v[164:167], v[240:243], v[104:107]
  ds_read_b64_tr_b16 v[198:199], v21 offset:43008
  v_mfma_f32_16x16x32_bf16 v[112:115], v[168:171], v[240:243], v[112:115]
  ds_read_b64_tr_b16 v[200:201], v22 offset:40960
  v_mfma_f32_16x16x32_bf16 v[116:119], v[168:171], v[244:247], v[116:119]
  ds_read_b64_tr_b16 v[202:203], v22 offset:43008
  v_mfma_f32_16x16x32_bf16 v[124:127], v[172:175], v[244:247], v[124:127]
  ds_read_b64_tr_b16 v[204:205], v23 offset:40960
  v_mfma_f32_16x16x32_bf16 v[120:123], v[172:175], v[240:243], v[120:123]
  ds_read_b64_tr_b16 v[206:207], v23 offset:43008
  s_waitcnt vmcnt(16) lgkmcnt(8)
  v_mfma_f32_16x16x32_bf16 v[96:99], v[176:179], v[248:251], v[96:99]
  ds_read_b64_tr_b16 v[208:209], v20 offset:45056
  v_mfma_f32_16x16x32_bf16 v[100:103], v[176:179], v[252:255], v[100:103]
  ds_read_b64_tr_b16 v[210:211], v20 offset:47104
  v_mfma_f32_16x16x32_bf16 v[108:111], v[180:183], v[252:255], v[108:111]
  ds_read_b64_tr_b16 v[212:213], v21 offset:45056
  v_mfma_f32_16x16x32_bf16 v[104:107], v[180:183], v[248:251], v[104:107]
  ds_read_b64_tr_b16 v[214:215], v21 offset:47104
  v_mfma_f32_16x16x32_bf16 v[112:115], v[184:187], v[248:251], v[112:115]
  ds_read_b64_tr_b16 v[216:217], v22 offset:45056
  v_mfma_f32_16x16x32_bf16 v[116:119], v[184:187], v[252:255], v[116:119]
  ds_read_b64_tr_b16 v[218:219], v22 offset:47104
  v_mfma_f32_16x16x32_bf16 v[124:127], v[188:191], v[252:255], v[124:127]
  ds_read_b64_tr_b16 v[220:221], v23 offset:45056
  v_mfma_f32_16x16x32_bf16 v[120:123], v[188:191], v[248:251], v[120:123]
  ds_read_b64_tr_b16 v[222:223], v23 offset:47104
  s_waitcnt vmcnt(14) lgkmcnt(8)
  v_mfma_f32_16x16x32_bf16 v[96:99], v[192:195], v[32:35], v[96:99]
  ds_read_b64_tr_b16 v[160:161], v20 offset:49152
  v_mfma_f32_16x16x32_bf16 v[100:103], v[192:195], v[36:39], v[100:103]
  ds_read_b64_tr_b16 v[162:163], v20 offset:51200
  v_mfma_f32_16x16x32_bf16 v[108:111], v[196:199], v[36:39], v[108:111]
  ds_read_b64_tr_b16 v[164:165], v21 offset:49152
  v_mfma_f32_16x16x32_bf16 v[104:107], v[196:199], v[32:35], v[104:107]
  ds_read_b64_tr_b16 v[166:167], v21 offset:51200
  v_mfma_f32_16x16x32_bf16 v[112:115], v[200:203], v[32:35], v[112:115]
  ds_read_b64_tr_b16 v[168:169], v22 offset:49152
  v_mfma_f32_16x16x32_bf16 v[116:119], v[200:203], v[36:39], v[116:119]
  ds_read_b64_tr_b16 v[170:171], v22 offset:51200
  v_mfma_f32_16x16x32_bf16 v[124:127], v[204:207], v[36:39], v[124:127]
  ds_read_b64_tr_b16 v[172:173], v23 offset:49152
  v_mfma_f32_16x16x32_bf16 v[120:123], v[204:207], v[32:35], v[120:123]
  ds_read_b64_tr_b16 v[174:175], v23 offset:51200
  s_waitcnt vmcnt(12) lgkmcnt(8)
  v_mfma_f32_16x16x32_bf16 v[96:99], v[208:211], v[40:43], v[96:99]
  ds_read_b64_tr_b16 v[176:177], v20 offset:53248
  v_mfma_f32_16x16x32_bf16 v[100:103], v[208:211], v[44:47], v[100:103]
  ds_read_b64_tr_b16 v[178:179], v20 offset:55296
  v_mfma_f32_16x16x32_bf16 v[108:111], v[212:215], v[44:47], v[108:111]
  ds_read_b64_tr_b16 v[180:181], v21 offset:53248
  v_mfma_f32_16x16x32_bf16 v[104:107], v[212:215], v[40:43], v[104:107]
  ds_read_b64_tr_b16 v[182:183], v21 offset:55296
  v_mfma_f32_16x16x32_bf16 v[112:115], v[216:219], v[40:43], v[112:115]
  ds_read_b64_tr_b16 v[184:185], v22 offset:53248
  v_mfma_f32_16x16x32_bf16 v[116:119], v[216:219], v[44:47], v[116:119]
  ds_read_b64_tr_b16 v[186:187], v22 offset:55296
  v_mfma_f32_16x16x32_bf16 v[124:127], v[220:223], v[44:47], v[124:127]
  ds_read_b64_tr_b16 v[188:189], v23 offset:53248
  v_mfma_f32_16x16x32_bf16 v[120:123], v[220:223], v[40:43], v[120:123]
  ds_read_b64_tr_b16 v[190:191], v23 offset:55296
  s_waitcnt vmcnt(10) lgkmcnt(8)
  v_mfma_f32_16x16x32_bf16 v[96:99], v[160:163], v[48:51], v[96:99]
  ds_read_b64_tr_b16 v[192:193], v20 offset:57344
  s_waitcnt vmcnt(3)
  v_mfma_f32_16x16x32_bf16 v[100:103], v[160:163], v[52:55], v[100:103]
  ds_read_b64_tr_b16 v[194:195], v20 offset:59392
  v_lshlrev_b32 v128, 16, v144
  v_mfma_f32_16x16x32_bf16 v[108:111], v[164:167], v[52:55], v[108:111]
  ds_read_b64_tr_b16 v[196:197], v21 offset:57344
  v_and_b32 v129, s11, v144
  v_mfma_f32_16x16x32_bf16 v[104:107], v[164:167], v[48:51], v[104:107]
  ds_read_b64_tr_b16 v[198:199], v21 offset:59392
  v_lshlrev_b32 v130, 16, v145
  v_mfma_f32_16x16x32_bf16 v[112:115], v[168:171], v[48:51], v[112:115]
  ds_read_b64_tr_b16 v[200:201], v22 offset:57344
  v_and_b32 v131, s11, v145
  v_mfma_f32_16x16x32_bf16 v[116:119], v[168:171], v[52:55], v[116:119]
  ds_read_b64_tr_b16 v[202:203], v22 offset:59392
  v_lshlrev_b32 v132, 16, v146
  v_mfma_f32_16x16x32_bf16 v[124:127], v[172:175], v[52:55], v[124:127]
  ds_read_b64_tr_b16 v[204:205], v23 offset:57344
  v_and_b32 v133, s11, v146
  v_mfma_f32_16x16x32_bf16 v[120:123], v[172:175], v[48:51], v[120:123]
  ds_read_b64_tr_b16 v[206:207], v23 offset:59392
  s_waitcnt lgkmcnt(8)
  v_mfma_f32_16x16x32_bf16 v[96:99], v[176:179], v[56:59], v[96:99]
  ds_read_b64_tr_b16 v[208:209], v20 offset:61440
  v_lshlrev_b32 v134, 16, v147
  v_mfma_f32_16x16x32_bf16 v[100:103], v[176:179], v[60:63], v[100:103]
  ds_read_b64_tr_b16 v[210:211], v20 offset:63488
  v_and_b32 v135, s11, v147
  v_mfma_f32_16x16x32_bf16 v[108:111], v[180:183], v[60:63], v[108:111]
  ds_read_b64_tr_b16 v[212:213], v21 offset:61440
  v_lshlrev_b32 v136, 16, v148
  v_mfma_f32_16x16x32_bf16 v[104:107], v[180:183], v[56:59], v[104:107]
  ds_read_b64_tr_b16 v[214:215], v21 offset:63488
  v_and_b32 v137, s11, v148
  v_mfma_f32_16x16x32_bf16 v[112:115], v[184:187], v[56:59], v[112:115]
  ds_read_b64_tr_b16 v[216:217], v22 offset:61440
  v_lshlrev_b32 v138, 16, v149
  v_mfma_f32_16x16x32_bf16 v[116:119], v[184:187], v[60:63], v[116:119]
  ds_read_b64_tr_b16 v[218:219], v22 offset:63488
  v_and_b32 v139, s11, v149
  v_mfma_f32_16x16x32_bf16 v[124:127], v[188:191], v[60:63], v[124:127]
  ds_read_b64_tr_b16 v[220:221], v23 offset:61440
  v_lshlrev_b32 v140, 16, v150
  v_mfma_f32_16x16x32_bf16 v[120:123], v[188:191], v[56:59], v[120:123]
  ds_read_b64_tr_b16 v[222:223], v23 offset:63488
  s_waitcnt vmcnt(2) lgkmcnt(8)
  v_mfma_f32_16x16x32_bf16 v[96:99], v[192:195], v[64:67], v[96:99]
  v_mov_b32 v20, 0x3f803f80
  v_mov_b32 v21, 0x3f803f80
  v_mfma_f32_16x16x32_bf16 v[100:103], v[192:195], v[68:71], v[100:103]
  v_mov_b32 v22, 0x3f803f80
  v_mov_b32 v23, 0x3f803f80
  v_mfma_f32_16x16x32_bf16 v[108:111], v[196:199], v[68:71], v[108:111]
  v_and_b32 v141, s11, v150
  v_lshlrev_b32 v142, 16, v151
  v_and_b32 v143, s11, v151
  v_mfma_f32_16x16x32_bf16 v[104:107], v[196:199], v[64:67], v[104:107]
  v_lshlrev_b32 v144, 16, v152
  v_and_b32 v145, s11, v152
  v_lshlrev_b32 v146, 16, v153
  v_mfma_f32_16x16x32_bf16 v[112:115], v[200:203], v[64:67], v[112:115]
  v_and_b32 v147, s11, v153
  v_lshlrev_b32 v148, 16, v154
  v_and_b32 v149, s11, v154
  v_mfma_f32_16x16x32_bf16 v[116:119], v[200:203], v[68:71], v[116:119]
  v_lshlrev_b32 v150, 16, v155
  v_and_b32 v151, s11, v155
  v_lshlrev_b32 v152, 16, v156
  v_mfma_f32_16x16x32_bf16 v[124:127], v[204:207], v[68:71], v[124:127]
  v_and_b32 v153, s11, v156
  v_lshlrev_b32 v154, 16, v157
  v_and_b32 v155, s11, v157
  v_mfma_f32_16x16x32_bf16 v[120:123], v[204:207], v[64:67], v[120:123]
  s_waitcnt vmcnt(0) lgkmcnt(0)
  v_lshlrev_b32 v156, 16, v158
  v_and_b32 v157, s11, v158
  v_mfma_f32_16x16x32_bf16 v[96:99], v[208:211], v[72:75], v[96:99]
  v_lshlrev_b32 v158, 16, v159
  v_and_b32 v159, s11, v159
  v_mfma_f32_16x16x32_bf16 v[100:103], v[208:211], v[76:79], v[100:103]
  v_mfma_f32_16x16x32_bf16 v[108:111], v[212:215], v[76:79], v[108:111]
  v_mfma_f32_16x16x32_bf16 v[104:107], v[212:215], v[72:75], v[104:107]
  v_mfma_f32_16x16x32_bf16 v[112:115], v[216:219], v[72:75], v[112:115]
  v_mfma_f32_16x16x32_bf16 v[116:119], v[216:219], v[76:79], v[116:119]
  v_mfma_f32_16x16x32_bf16 v[124:127], v[220:223], v[76:79], v[124:127]
  v_mfma_f32_16x16x32_bf16 v[120:123], v[220:223], v[72:75], v[120:123]
  s_lshl_b32 s3, s7, 4
  s_mov_b32 vcc_lo, 0xaaaaaaaa
  s_lshl_b32 s4, s7, 3
  s_add_u32 s5, s3, s4
  v_xor_b32 v6, 32, v4
  v_xor_b32 v7, 64, v4
  v_xor_b32 v8, 96, v4
  v_xor_b32 v9, 64, v12
  v_pk_add_f32 v[96:97], v[96:97], v[128:129]
  v_pk_add_f32 v[98:99], v[98:99], v[130:131]
  v_cvt_pk_bf16_f32 v240, v96, v97
  v_cvt_pk_bf16_f32 v241, v98, v99
  v_pk_add_f32 v[104:105], v[104:105], v[136:137]
  v_pk_add_f32 v[106:107], v[106:107], v[138:139]
  v_cvt_pk_bf16_f32 v242, v104, v105
  v_cvt_pk_bf16_f32 v243, v106, v107
  ds_write_b64 v4, v[240:241] offset:0
  ds_write_b64 v6, v[242:243] offset:0
  v_pk_add_f32 v[112:113], v[112:113], v[144:145]
  v_pk_add_f32 v[114:115], v[114:115], v[146:147]
  v_cvt_pk_bf16_f32 v244, v112, v113
  v_cvt_pk_bf16_f32 v245, v114, v115
  v_pk_add_f32 v[120:121], v[120:121], v[152:153]
  v_pk_add_f32 v[122:123], v[122:123], v[154:155]
  v_cvt_pk_bf16_f32 v246, v120, v121
  v_cvt_pk_bf16_f32 v247, v122, v123
  ds_write_b64 v7, v[244:245] offset:0
  ds_write_b64 v8, v[246:247] offset:0
  ds_read_b128 v[32:35], v5 offset:0
  ds_read_b128 v[36:39], v5 offset:1024
  v_pk_add_f32 v[100:101], v[100:101], v[132:133]
  v_pk_add_f32 v[102:103], v[102:103], v[134:135]
  v_cvt_pk_bf16_f32 v248, v100, v101
  v_cvt_pk_bf16_f32 v249, v102, v103
  v_pk_add_f32 v[108:109], v[108:109], v[140:141]
  v_pk_add_f32 v[110:111], v[110:111], v[142:143]
  v_cvt_pk_bf16_f32 v250, v108, v109
  v_cvt_pk_bf16_f32 v251, v110, v111
  ds_write_b64 v4, v[248:249] offset:2048
  ds_write_b64 v6, v[250:251] offset:2048
  v_pk_add_f32 v[116:117], v[116:117], v[148:149]
  v_pk_add_f32 v[118:119], v[118:119], v[150:151]
  v_cvt_pk_bf16_f32 v252, v116, v117
  v_cvt_pk_bf16_f32 v253, v118, v119
  v_pk_add_f32 v[124:125], v[124:125], v[156:157]
  v_pk_add_f32 v[126:127], v[126:127], v[158:159]
  v_cvt_pk_bf16_f32 v254, v124, v125
  v_cvt_pk_bf16_f32 v255, v126, v127
  ds_write_b64 v7, v[252:253] offset:2048
  ds_write_b64 v8, v[254:255] offset:2048
  ds_read_b128 v[40:43], v5 offset:2048
  ds_read_b128 v[44:47], v5 offset:3072
  s_waitcnt lgkmcnt(7)
  buffer_store_dwordx4 v[32:35], v12, s[40:43], 0 offen sc1
  s_waitcnt lgkmcnt(6)
  buffer_store_dwordx4 v[36:39], v9, s[40:43], s4 offen sc1
  v_mfma_f32_16x16x32_bf16 v[52:55], v[240:243], v[240:243], 0
  s_mov_b32 vcc_hi, vcc_lo
  v_mfma_f32_16x16x32_bf16 v[48:51], v[20:23], v[240:243], 0
  s_mov_b32 s8, 0xcccccccc
  v_mfma_f32_16x16x32_bf16 v[52:55], v[244:247], v[244:247], v[52:55]
  s_mov_b32 s9, s8
  v_mfma_f32_16x16x32_bf16 v[48:51], v[20:23], v[244:247], v[48:51]
  s_waitcnt lgkmcnt(1)
  buffer_store_dwordx4 v[40:43], v12, s[40:43], s3 offen sc1
  s_waitcnt lgkmcnt(0)
  buffer_store_dwordx4 v[44:47], v9, s[40:43], s5 offen sc1
  s_cmp_eq_u32 s96, 1
  s_cbranch_scc1 L_w2_end
  v_mfma_f32_16x16x32_bf16 v[60:63], v[248:251], v[248:251], 0
  v_mfma_f32_16x16x32_bf16 v[56:59], v[20:23], v[248:251], 0
  v_mfma_f32_16x16x32_bf16 v[60:63], v[252:255], v[252:255], v[60:63]
  v_mfma_f32_16x16x32_bf16 v[56:59], v[20:23], v[252:255], v[56:59]
  v_cndmask_b32 v52, v52, v53, vcc
  v_cndmask_b32 v54, v54, v55, vcc
  v_cndmask_b32 v49, v52, v54, s[8:9]
  buffer_store_dwordx2 v[48:49], v18, s[56:59], 0 offen offset:0 sc1
  s_nop 2
  v_cndmask_b32 v60, v60, v61, vcc
  v_cndmask_b32 v62, v62, v63, vcc
  v_cndmask_b32 v57, v60, v62, s[8:9]
  buffer_store_dwordx2 v[56:57], v18, s[56:59], 0 offen offset:128 sc1
  s_waitcnt vmcnt(0) lgkmcnt(0)
  s_barrier
  s_mov_b32 s96, 1
  s_add_u32 s12, s22, 33554432
  s_addc_u32 s13, s23, 0
  s_add_u32 s34, s22, 67108864
  s_addc_u32 s35, s23, 0
  s_add_u32 s97, s97, 1
  s_branch L_attn_body
L_w2_c1:
```

```asm
; @launch grid=(256,1,1) block=(512,1,1) lds=163840
.amdgcn_target "amdgcn-amd-amdhsa--gfx950"
.text
.globl interleave_layers__sliding_local_dilated__dense_activation_gelu__prompt_kernel
.p2align 12
.fill 832, 4, 0xbf810000
.type interleave_layers__sliding_local_dilated__dense_activation_gelu__prompt_kernel,@function
interleave_layers__sliding_local_dilated__dense_activation_gelu__prompt_kernel:
L_attn_c0:
  s_load_dwordx4 s[16:19], s[0:1], 0
  s_load_dwordx2 s[20:21], s[0:1], 16
  s_load_dwordx2 s[22:23], s[0:1], 80
  s_load_dwordx8 s[24:31], s[0:1], 32
  s_load_dwordx2 s[32:33], s[0:1], 64
  s_load_dwordx2 s[34:35], s[0:1], 80
  s_load_dwordx2 s[12:13], s[0:1], 0
  s_load_dwordx2 s[64:65], s[0:1], 72
  s_mov_b32 s96, 0
  s_mov_b32 s97, 0
L_attn_body:
  s_cmp_ge_u32 s2, 256
  s_cbranch_scc1 L_attn_end
  v_lshrrev_b32 v2, 6, v0
  v_and_b32 v1, 63, v0
  v_readfirstlane_b32 s70, v2
  s_and_b32 s3, s2, 7
  s_lshr_b32 s99, s2, 3
  s_and_b32 s5, s3, 1
  s_lshl_b32 s5, s5, 3
  s_and_b32 s6, s99, 7
  s_add_u32 s68, s5, s6
  s_lshr_b32 s5, s3, 1
  s_lshl_b32 s5, s5, 2
  s_lshr_b32 s6, s99, 3
  s_add_u32 s69, s5, s6
  s_cmp_eq_u32 s96, 0
  s_cbranch_scc1 L_attn_map
  s_and_b32 s3, s2, 7
  s_and_b32 s5, s3, 3
  s_lshl_b32 s5, s5, 2
  s_and_b32 s6, s99, 3
  s_add_u32 s68, s5, s6
  s_lshr_b32 s5, s3, 2
  s_lshl_b32 s5, s5, 3
  s_lshr_b32 s6, s99, 2
  s_add_u32 s69, s5, s6
L_attn_map:
  s_cmp_lt_u32 s70, 4
  s_cbranch_scc1 L_attn_compute
L_attn_loader:
  s_add_u32 s8, s70, s69
  s_and_b32 s8, s8, 3
  s_add_u32 s9, s70, s68
  s_and_b32 s9, s9, 3
  s_lshl_b32 s76, s8, 12
  s_lshl_b32 s77, s9, 11
  s_add_u32 s77, s77, 16384
  s_lshl_b32 s11, s68, 7
  v_and_b32 v10, 7, v1
  v_lshrrev_b32 v3, 3, v1
  s_lshr_b32 s10, s76, 7
  s_lshl_b32 s3, s68, 7
  s_add_u32 s10, s10, s3
  v_add_u32 v3, s10, v3
  s_cmp_eq_u32 s96, 1
  s_cselect_b32 s5, 128, 0
  s_add_u32 s5, s5, 2048
  s_lshl_b32 s6, s5, 3
  v_mul_u32_u24 v3, s5, v3
  v_lshrrev_b32 v2, 4, v1
  v_xor_b32 v4, v2, v10
  v_lshl_add_u32 v4, v4, 4, v3
  v_add_u32 v3, s6, v3
  v_add_u32 v5, 4, v2
  v_xor_b32 v5, v5, v10
  v_lshl_add_u32 v5, v5, 4, v3
  v_add_u32 v3, s6, v3
  v_xor_b32 v6, v2, v10
  v_lshl_add_u32 v6, v6, 4, v3
  v_add_u32 v3, s6, v3
  v_add_u32 v7, 4, v2
  v_xor_b32 v7, v7, v10
  v_lshl_add_u32 v7, v7, 4, v3
  v_lshrrev_b32 v3, 3, v1
  s_lshl_b32 s10, s9, 4
  v_add_u32 v3, s10, v3
  v_mul_u32_u24 v3, 6144, v3
  v_lshrrev_b32 v2, 3, v1
  v_and_b32 v2, 2, v2
  v_xor_b32 v2, v2, v10
  s_mul_i32 s10, s69, 128
  v_add_u32 v3, s10, v3
  v_lshl_add_u32 v8, v2, 4, v3
  v_xor_b32 v2, 4, v2
  v_add_u32 v3, 49152, v3
  v_lshl_add_u32 v9, v2, 4, v3
  s_and_b32 s10, s70, 3
  s_lshl_b32 s78, s10, 9
  s_add_u32 s78, s78, 40960
  s_lshl_b32 s14, s10, 2
  s_add_u32 s14, s14, s11
  s_sub_u32 s14, s14, 16
  v_lshrrev_b32 v3, 3, v1
  v_add_u32 v3, s14, v3
  v_max_i32 v3, 0, v3
  v_mul_u32_u24 v3, s5, v3
  s_lshl_b32 s14, s10, 1
  v_lshrrev_b32 v2, 4, v1
  v_add_u32 v2, s14, v2
  v_and_b32 v2, 7, v2
  v_xor_b32 v2, v2, v10
  v_lshl_add_u32 v28, v2, 4, v3
  s_cmp_eq_u32 s10, 0
  s_cselect_b32 s14, 0xffffff00, -1
  s_mov_b32 s15, 0
  s_mov_b32 s75, 0
  s_add_u32 s100, s68, s69
  s_mov_b32 s101, -1
  s_add_u32 s3, s68, s69
  s_and_b32 s3, s3, 3
  s_mov_b32 s100, 0x75463102
  s_mov_b32 s101, 0xfdceb98a
  s_cmp_eq_u32 s3, 1
  s_cselect_b32 s100, 0x65742130, s100
  s_cselect_b32 s101, 0xedfca9b8, s101
  s_cmp_eq_u32 s3, 2
  s_cselect_b32 s100, 0x68532410, s100
  s_cselect_b32 s101, 0xfedbac97, s101
  s_cmp_eq_u32 s3, 3
  s_cselect_b32 s100, 0x96435210, s100
  s_cselect_b32 s101, 0xfecbda87, s101
  s_mov_b32 s91, s69
  s_and_b32 s92, s69, 3
  s_add_u32 s92, s92, 1
  s_and_b32 s73, s100, 15
  s_cmp_eq_u32 s73, s91
  s_cselect_b32 s74, 4, 0
  s_lshr_b64 s[100:101], s[100:101], s74
  s_and_b32 s73, s100, 15
  s_sub_u32 s92, s92, 1
  s_cselect_b32 s73, s91, s73
  s_cselect_b32 s74, 0, 4
  s_lshr_b64 s[100:101], s[100:101], s74
  s_mul_i32 s74, s73, 393216
  s_lshl_b32 s73, s73, 7
  s_waitcnt lgkmcnt(0)
  s_mov_b32 s36, s12
  s_and_b32 s37, s13, 0xffff
  s_mov_b32 s38, 4194304
  s_mov_b32 s39, 0x00020000
  s_cmp_eq_u32 s96, 1
  s_cselect_b32 s38, 128, 0
  s_add_u32 s38, s38, 2048
  s_lshl_b32 s38, s38, 11
  s_mov_b32 s40, s18
  s_and_b32 s41, s19, 0xffff
  s_mov_b32 s42, 6291456
  s_mov_b32 s43, 0x00020000
  s_cmp_lg_u32 s96, 0
  s_cbranch_scc1 L_attn_ld1
  s_mov_b32 s48, s28
  s_and_b32 s49, s29, 0xffff
  s_mov_b32 s50, 7340032
  s_mov_b32 s51, 0x00020000
  s_cmp_eq_u32 s96, 0
  s_cselect_b32 s50, s50, 0
  s_and_b32 s3, s70, 3
  s_lshl_b32 s4, s2, 2
  s_add_u32 s3, s3, s4
  s_mul_i32 s98, s3, 3584
  s_add_u32 s98, s98, 0
  s_add_u32 s3, s75, s76
  s_add_u32 m0, s3, 0
  s_nop 0
  buffer_load_dwordx4 v4, s[36:39], s73 offen lds
  s_add_u32 m0, s3, 1024
  s_nop 0
  buffer_load_dwordx4 v5, s[36:39], s73 offen lds
  s_add_u32 m0, s3, 2048
  s_nop 0
  buffer_load_dwordx4 v6, s[36:39], s73 offen lds
  s_add_u32 m0, s3, 3072
  s_nop 0
  buffer_load_dwordx4 v7, s[36:39], s73 offen lds
  s_add_u32 m0, s78, s75
  s_mov_b64 exec, s[14:15]
  buffer_load_dwordx4 v28, s[36:39], s73 offen lds
  s_mov_b64 exec, -1
  s_add_u32 s3, s75, s77
  s_add_u32 m0, s3, 0
  s_add_u32 s4, s74, 0
  buffer_load_dwordx4 v8, s[40:43], s4 offen lds
  s_add_u32 m0, s3, 1024
  s_nop 0
  buffer_load_dwordx4 v9, s[40:43], s4 offen lds
  s_add_u32 m0, s3, 8192
  s_add_u32 s4, s74, 2048
  buffer_load_dwordx4 v8, s[40:43], s4 offen lds
  s_add_u32 m0, s3, 9216
  s_nop 0
  buffer_load_dwordx4 v9, s[40:43], s4 offen lds
  s_add_u32 m0, s3, 16384
  s_add_u32 s4, s74, 4096
  buffer_load_dwordx4 v8, s[40:43], s4 offen lds
  s_add_u32 m0, s3, 17408
  s_nop 0
  buffer_load_dwordx4 v9, s[40:43], s4 offen lds
  s_and_b32 s73, s100, 15
  s_cmp_eq_u32 s73, s91
  s_cselect_b32 s74, 4, 0
  s_lshr_b64 s[100:101], s[100:101], s74
  s_and_b32 s73, s100, 15
  s_sub_u32 s92, s92, 1
  s_cselect_b32 s73, s91, s73
  s_cselect_b32 s74, 0, 4
  s_lshr_b64 s[100:101], s[100:101], s74
  s_mul_i32 s74, s73, 393216
  s_lshl_b32 s73, s73, 7
  s_add_u32 s75, s75, 43008
  s_cmp_eq_u32 s75, 129024
  s_cselect_b32 s75, 0, s75
  s_add_u32 s3, s75, s76
  s_add_u32 m0, s3, 0
  s_nop 0
  buffer_load_dwordx4 v4, s[36:39], s73 offen lds
  s_add_u32 m0, s3, 1024
  s_nop 0
  buffer_load_dwordx4 v5, s[36:39], s73 offen lds
  s_add_u32 m0, s3, 2048
  s_nop 0
  buffer_load_dwordx4 v6, s[36:39], s73 offen lds
  s_add_u32 m0, s3, 3072
  s_nop 0
  buffer_load_dwordx4 v7, s[36:39], s73 offen lds
  s_add_u32 m0, s78, s75
  s_mov_b64 exec, s[14:15]
  buffer_load_dwordx4 v28, s[36:39], s73 offen lds
  s_mov_b64 exec, -1
  s_add_u32 s3, s75, s77
  s_add_u32 m0, s3, 0
  s_add_u32 s4, s74, 0
  buffer_load_dwordx4 v8, s[40:43], s4 offen lds
  s_add_u32 m0, s3, 1024
  s_nop 0
  buffer_load_dwordx4 v9, s[40:43], s4 offen lds
  s_add_u32 m0, s3, 8192
  s_add_u32 s4, s74, 2048
  buffer_load_dwordx4 v8, s[40:43], s4 offen lds
  s_add_u32 m0, s3, 9216
  s_nop 0
  buffer_load_dwordx4 v9, s[40:43], s4 offen lds
  s_add_u32 m0, s3, 16384
  s_add_u32 s4, s74, 4096
  buffer_load_dwordx4 v8, s[40:43], s4 offen lds
  s_add_u32 m0, s3, 17408
  s_nop 0
  buffer_load_dwordx4 v9, s[40:43], s4 offen lds
  s_and_b32 s73, s100, 15
  s_cmp_eq_u32 s73, s91
  s_cselect_b32 s74, 4, 0
  s_lshr_b64 s[100:101], s[100:101], s74
  s_and_b32 s73, s100, 15
  s_sub_u32 s92, s92, 1
  s_cselect_b32 s73, s91, s73
  s_cselect_b32 s74, 0, 4
  s_lshr_b64 s[100:101], s[100:101], s74
  s_mul_i32 s74, s73, 393216
  s_lshl_b32 s73, s73, 7
  s_add_u32 s75, s75, 43008
  s_cmp_eq_u32 s75, 129024
  s_cselect_b32 s75, 0, s75
  s_mov_b32 s52, s24
  s_and_b32 s53, s25, 0xffff
  s_mov_b32 s54, 7340032
  s_mov_b32 s55, 0x00020000
  s_min_u32 s3, s2, 223
  s_mul_i32 s4, s3, 4682
  s_lshr_b32 s4, s4, 16
  s_mul_i32 s5, s4, 14
  s_sub_u32 s3, s3, s5
  s_lshl_b32 s3, s3, 2
  s_and_b32 s5, s70, 3
  s_add_u32 s3, s3, s5
  s_mul_i32 s5, s4, 458752
  s_lshl_b32 s8, s3, 7
  s_add_u32 s95, s5, s8
  s_lshl_b32 s9, s4, 14
  s_lshl_b32 s8, s3, 8
  s_add_u32 s94, s9, s8
  v_lshrrev_b32 v2, 3, v1
  v_mul_u32_u24 v2, 7168, v2
  v_and_b32 v3, 7, v1
  v_lshl_add_u32 v26, v3, 4, v2
  s_and_b32 s3, s70, 3
  s_lshl_b32 s4, s2, 2
  s_add_u32 s3, s3, s4
  s_sub_u32 s4, 384, s40
  s_and_b32 s4, s4, 0x380
  s_mul_i32 s5, s3, 6144
  s_add_u32 s5, s5, s4
  s_buffer_load_dword s84, s[40:43], s5 offset:0
  s_buffer_load_dword s84, s[40:43], s5 offset:64
  s_buffer_load_dword s84, s[40:43], s5 offset:1024
  s_buffer_load_dword s84, s[40:43], s5 offset:1088
  s_buffer_load_dword s84, s[40:43], s5 offset:2048
  s_buffer_load_dword s84, s[40:43], s5 offset:2112
  s_buffer_load_dword s84, s[40:43], s5 offset:3072
  s_buffer_load_dword s84, s[40:43], s5 offset:3136
  s_buffer_load_dword s84, s[40:43], s5 offset:4096
  s_buffer_load_dword s84, s[40:43], s5 offset:4160
  s_buffer_load_dword s84, s[40:43], s5 offset:5120
  s_buffer_load_dword s84, s[40:43], s5 offset:5184
  s_add_u32 s56, s22, 23592960
  s_addc_u32 s57, s23, 0
  s_and_b32 s57, s57, 0xffff
  s_mov_b32 s58, 262144
  s_mov_b32 s59, 0x00020000
  s_and_b32 s3, s70, 3
  s_lshl2_add_u32 s4, s68, s3
  s_lshl_b32 s4, s4, 8
  v_lshrrev_b32 v2, 4, v1
  v_and_b32 v3, 15, v1
  v_lshl_add_u32 v3, v3, 4, s4
  v_lshl_add_u32 v18, v2, 14, v3
  s_lshl_b32 s4, s68, 5
  s_add_u32 s4, s4, s3
  s_sub_u32 s4, s4, 4
  s_max_i32 s4, s4, 0
  s_lshl_b32 s4, s4, 5
  v_lshrrev_b32 v2, 2, v1
  v_and_b32 v3, 3, v1
  v_lshl_add_u32 v3, v3, 3, s4
  v_lshl_add_u32 v19, v2, 14, v3
  s_lshl_b32 s3, s68, 2
  s_sub_u32 s3, s3, 4
  v_and_b32 v20, 7, v1
  v_add_u32 v20, s3, v20
  v_max_i32 v20, 0, v20
  v_lshlrev_b32 v20, 2, v20
  s_and_b32 s65, s65, 0xffff
  s_mov_b32 s66, 256
  s_mov_b32 s67, 0x00020000
  s_waitcnt vmcnt(11)
  s_barrier
  s_add_u32 s3, s75, s76
  s_add_u32 m0, s3, 0
  s_nop 0
  buffer_load_dwordx4 v4, s[36:39], s73 offen lds
  s_add_u32 m0, s3, 1024
  s_nop 0
  buffer_load_dwordx4 v5, s[36:39], s73 offen lds
  s_add_u32 m0, s3, 2048
  s_nop 0
  buffer_load_dwordx4 v6, s[36:39], s73 offen lds
  s_add_u32 m0, s3, 3072
  s_nop 0
  buffer_load_dwordx4 v7, s[36:39], s73 offen lds
  s_add_u32 m0, s78, s75
  s_mov_b64 exec, s[14:15]
  buffer_load_dwordx4 v28, s[36:39], s73 offen lds
  s_mov_b64 exec, -1
  s_add_u32 s3, s75, s77
  s_add_u32 m0, s3, 0
  s_add_u32 s4, s74, 0
  buffer_load_dwordx4 v8, s[40:43], s4 offen lds
  s_add_u32 m0, s3, 1024
  s_nop 0
  buffer_load_dwordx4 v9, s[40:43], s4 offen lds
  s_add_u32 m0, s3, 8192
  s_add_u32 s4, s74, 2048
  buffer_load_dwordx4 v8, s[40:43], s4 offen lds
  s_add_u32 m0, s3, 9216
  s_nop 0
  buffer_load_dwordx4 v9, s[40:43], s4 offen lds
  s_add_u32 m0, s3, 16384
  s_add_u32 s4, s74, 4096
  buffer_load_dwordx4 v8, s[40:43], s4 offen lds
  s_add_u32 m0, s3, 17408
  s_nop 0
  buffer_load_dwordx4 v9, s[40:43], s4 offen lds
  s_and_b32 s73, s100, 15
  s_cmp_eq_u32 s73, s91
  s_cselect_b32 s74, 4, 0
  s_lshr_b64 s[100:101], s[100:101], s74
  s_and_b32 s73, s100, 15
  s_sub_u32 s92, s92, 1
  s_cselect_b32 s73, s91, s73
  s_cselect_b32 s74, 0, 4
  s_lshr_b64 s[100:101], s[100:101], s74
  s_mul_i32 s74, s73, 393216
  s_lshl_b32 s73, s73, 7
  s_add_u32 s75, s75, 43008
  s_cmp_eq_u32 s75, 129024
  s_cselect_b32 s75, 0, s75
  s_buffer_load_dword s84, s[48:51], s98 offset:0
  s_buffer_load_dword s84, s[48:51], s98 offset:64
  s_buffer_load_dword s84, s[48:51], s98 offset:128
  s_buffer_load_dword s84, s[48:51], s98 offset:192
  s_add_u32 s98, s98, 256
  buffer_load_dwordx4 v[64:67], v26, s[52:55], s95 offen
  s_add_u32 s95, s95, 57344
  buffer_load_dwordx4 v[68:71], v26, s[52:55], s95 offen
  s_add_u32 s95, s95, 57344
  s_waitcnt vmcnt(13)
  s_barrier
  s_add_u32 s3, s75, s76
  s_add_u32 m0, s3, 0
  s_nop 0
  buffer_load_dwordx4 v4, s[36:39], s73 offen lds
  s_add_u32 m0, s3, 1024
  s_nop 0
  buffer_load_dwordx4 v5, s[36:39], s73 offen lds
  s_add_u32 m0, s3, 2048
  s_nop 0
  buffer_load_dwordx4 v6, s[36:39], s73 offen lds
  s_add_u32 m0, s3, 3072
  s_nop 0
  buffer_load_dwordx4 v7, s[36:39], s73 offen lds
  s_add_u32 m0, s78, s75
  s_mov_b64 exec, s[14:15]
  buffer_load_dwordx4 v28, s[36:39], s73 offen lds
  s_mov_b64 exec, -1
  s_add_u32 s3, s75, s77
  s_add_u32 m0, s3, 0
  s_add_u32 s4, s74, 0
  buffer_load_dwordx4 v8, s[40:43], s4 offen lds
  s_add_u32 m0, s3, 1024
  s_nop 0
  buffer_load_dwordx4 v9, s[40:43], s4 offen lds
  s_add_u32 m0, s3, 8192
  s_add_u32 s4, s74, 2048
  buffer_load_dwordx4 v8, s[40:43], s4 offen lds
  s_add_u32 m0, s3, 9216
  s_nop 0
  buffer_load_dwordx4 v9, s[40:43], s4 offen lds
  s_add_u32 m0, s3, 16384
  s_add_u32 s4, s74, 4096
  buffer_load_dwordx4 v8, s[40:43], s4 offen lds
  s_add_u32 m0, s3, 17408
  s_nop 0
  buffer_load_dwordx4 v9, s[40:43], s4 offen lds
  s_and_b32 s73, s100, 15
  s_cmp_eq_u32 s73, s91
  s_cselect_b32 s74, 4, 0
  s_lshr_b64 s[100:101], s[100:101], s74
  s_and_b32 s73, s100, 15
  s_sub_u32 s92, s92, 1
  s_cselect_b32 s73, s91, s73
  s_cselect_b32 s74, 0, 4
  s_lshr_b64 s[100:101], s[100:101], s74
  s_mul_i32 s74, s73, 393216
  s_lshl_b32 s73, s73, 7
  s_add_u32 s75, s75, 43008
  s_cmp_eq_u32 s75, 129024
  s_cselect_b32 s75, 0, s75
  s_buffer_load_dword s84, s[48:51], s98 offset:0
  s_buffer_load_dword s84, s[48:51], s98 offset:64
  s_buffer_load_dword s84, s[48:51], s98 offset:128
  s_buffer_load_dword s84, s[48:51], s98 offset:192
  s_add_u32 s98, s98, 256
  buffer_load_dwordx4 v[72:75], v26, s[52:55], s95 offen
  s_add_u32 s95, s95, 57344
  buffer_load_dwordx4 v[76:79], v26, s[52:55], s95 offen
  s_add_u32 s95, s95, 57344
  s_branch L_padl
.fill 200, 4, 0xbf810000
L_padl:
  s_waitcnt vmcnt(15)
  s_barrier
  s_add_u32 s3, s75, s76
  s_add_u32 m0, s3, 0
  s_nop 0
  buffer_load_dwordx4 v4, s[36:39], s73 offen lds
  s_add_u32 m0, s3, 1024
  s_nop 0
  buffer_load_dwordx4 v5, s[36:39], s73 offen lds
  s_add_u32 m0, s3, 2048
  s_nop 0
  buffer_load_dwordx4 v6, s[36:39], s73 offen lds
  s_add_u32 m0, s3, 3072
  s_nop 0
  buffer_load_dwordx4 v7, s[36:39], s73 offen lds
  s_add_u32 m0, s78, s75
  s_mov_b64 exec, s[14:15]
  buffer_load_dwordx4 v28, s[36:39], s73 offen lds
  s_mov_b64 exec, -1
  s_add_u32 s3, s75, s77
  s_add_u32 m0, s3, 0
  s_add_u32 s4, s74, 0
  buffer_load_dwordx4 v8, s[40:43], s4 offen lds
  s_add_u32 m0, s3, 1024
  s_nop 0
  buffer_load_dwordx4 v9, s[40:43], s4 offen lds
  s_add_u32 m0, s3, 8192
  s_add_u32 s4, s74, 2048
  buffer_load_dwordx4 v8, s[40:43], s4 offen lds
  s_add_u32 m0, s3, 9216
  s_nop 0
  buffer_load_dwordx4 v9, s[40:43], s4 offen lds
  s_add_u32 m0, s3, 16384
  s_add_u32 s4, s74, 4096
  buffer_load_dwordx4 v8, s[40:43], s4 offen lds
  s_add_u32 m0, s3, 17408
  s_nop 0
  buffer_load_dwordx4 v9, s[40:43], s4 offen lds
  s_and_b32 s73, s100, 15
  s_cmp_eq_u32 s73, s91
  s_cselect_b32 s74, 4, 0
  s_lshr_b64 s[100:101], s[100:101], s74
  s_and_b32 s73, s100, 15
  s_sub_u32 s92, s92, 1
  s_cselect_b32 s73, s91, s73
  s_cselect_b32 s74, 0, 4
  s_lshr_b64 s[100:101], s[100:101], s74
  s_mul_i32 s74, s73, 393216
  s_lshl_b32 s73, s73, 7
  s_add_u32 s75, s75, 43008
  s_cmp_eq_u32 s75, 129024
  s_cselect_b32 s75, 0, s75
  s_buffer_load_dword s84, s[48:51], s98 offset:0
  s_buffer_load_dword s84, s[48:51], s98 offset:64
  s_buffer_load_dword s84, s[48:51], s98 offset:128
  s_buffer_load_dword s84, s[48:51], s98 offset:192
  s_add_u32 s98, s98, 256
  buffer_load_dwordx4 v[80:83], v26, s[52:55], s95 offen
  s_add_u32 s95, s95, 57344
  buffer_load_dwordx4 v[84:87], v26, s[52:55], s95 offen
  s_add_u32 s95, s95, 57344
  s_waitcnt vmcnt(15)
  s_barrier
  s_add_u32 s3, s75, s76
  s_add_u32 m0, s3, 0
  s_nop 0
  buffer_load_dwordx4 v4, s[36:39], s73 offen lds
  s_add_u32 m0, s3, 1024
  s_nop 0
  buffer_load_dwordx4 v5, s[36:39], s73 offen lds
  s_add_u32 m0, s3, 2048
  s_nop 0
  buffer_load_dwordx4 v6, s[36:39], s73 offen lds
  s_add_u32 m0, s3, 3072
  s_nop 0
  buffer_load_dwordx4 v7, s[36:39], s73 offen lds
  s_add_u32 m0, s78, s75
  s_mov_b64 exec, s[14:15]
  buffer_load_dwordx4 v28, s[36:39], s73 offen lds
  s_mov_b64 exec, -1
  s_add_u32 s3, s75, s77
  s_add_u32 m0, s3, 0
  s_add_u32 s4, s74, 0
  buffer_load_dwordx4 v8, s[40:43], s4 offen lds
  s_add_u32 m0, s3, 1024
  s_nop 0
  buffer_load_dwordx4 v9, s[40:43], s4 offen lds
  s_add_u32 m0, s3, 8192
  s_add_u32 s4, s74, 2048
  buffer_load_dwordx4 v8, s[40:43], s4 offen lds
  s_add_u32 m0, s3, 9216
  s_nop 0
  buffer_load_dwordx4 v9, s[40:43], s4 offen lds
  s_add_u32 m0, s3, 16384
  s_add_u32 s4, s74, 4096
  buffer_load_dwordx4 v8, s[40:43], s4 offen lds
  s_add_u32 m0, s3, 17408
  s_nop 0
  buffer_load_dwordx4 v9, s[40:43], s4 offen lds
  s_and_b32 s73, s100, 15
  s_cmp_eq_u32 s73, s91
  s_cselect_b32 s74, 4, 0
  s_lshr_b64 s[100:101], s[100:101], s74
  s_and_b32 s73, s100, 15
  s_sub_u32 s92, s92, 1
  s_cselect_b32 s73, s91, s73
  s_cselect_b32 s74, 0, 4
  s_lshr_b64 s[100:101], s[100:101], s74
  s_mul_i32 s74, s73, 393216
  s_lshl_b32 s73, s73, 7
  s_add_u32 s75, s75, 43008
  s_cmp_eq_u32 s75, 129024
  s_cselect_b32 s75, 0, s75
  s_buffer_load_dword s84, s[48:51], s98 offset:0
  s_buffer_load_dword s84, s[48:51], s98 offset:64
  s_buffer_load_dword s84, s[48:51], s98 offset:128
  s_buffer_load_dword s84, s[48:51], s98 offset:192
  s_add_u32 s98, s98, 256
  buffer_load_dwordx4 v[88:91], v26, s[52:55], s95 offen
  s_add_u32 s95, s95, 57344
  buffer_load_dwordx4 v[92:95], v26, s[52:55], s95 offen
  s_waitcnt vmcnt(15)
  s_barrier
  s_add_u32 s3, s75, s76
  s_add_u32 m0, s3, 0
  s_nop 0
  buffer_load_dwordx4 v4, s[36:39], s73 offen lds
  s_add_u32 m0, s3, 1024
  s_nop 0
  buffer_load_dwordx4 v5, s[36:39], s73 offen lds
  s_add_u32 m0, s3, 2048
  s_nop 0
  buffer_load_dwordx4 v6, s[36:39], s73 offen lds
  s_add_u32 m0, s3, 3072
  s_nop 0
  buffer_load_dwordx4 v7, s[36:39], s73 offen lds
  s_add_u32 m0, s78, s75
  s_mov_b64 exec, s[14:15]
  buffer_load_dwordx4 v28, s[36:39], s73 offen lds
  s_mov_b64 exec, -1
  s_add_u32 s3, s75, s77
  s_add_u32 m0, s3, 0
  s_add_u32 s4, s74, 0
  buffer_load_dwordx4 v8, s[40:43], s4 offen lds
  s_add_u32 m0, s3, 1024
  s_nop 0
  buffer_load_dwordx4 v9, s[40:43], s4 offen lds
  s_add_u32 m0, s3, 8192
  s_add_u32 s4, s74, 2048
  buffer_load_dwordx4 v8, s[40:43], s4 offen lds
  s_add_u32 m0, s3, 9216
  s_nop 0
  buffer_load_dwordx4 v9, s[40:43], s4 offen lds
  s_add_u32 m0, s3, 16384
  s_add_u32 s4, s74, 4096
  buffer_load_dwordx4 v8, s[40:43], s4 offen lds
  s_add_u32 m0, s3, 17408
  s_nop 0
  buffer_load_dwordx4 v9, s[40:43], s4 offen lds
  s_and_b32 s73, s100, 15
  s_cmp_eq_u32 s73, s91
  s_cselect_b32 s74, 4, 0
  s_lshr_b64 s[100:101], s[100:101], s74
  s_and_b32 s73, s100, 15
  s_sub_u32 s92, s92, 1
  s_cselect_b32 s73, s91, s73
  s_cselect_b32 s74, 0, 4
  s_lshr_b64 s[100:101], s[100:101], s74
  s_mul_i32 s74, s73, 393216
  s_lshl_b32 s73, s73, 7
  s_add_u32 s75, s75, 43008
  s_cmp_eq_u32 s75, 129024
  s_cselect_b32 s75, 0, s75
  s_buffer_load_dword s84, s[48:51], s98 offset:0
  s_buffer_load_dword s84, s[48:51], s98 offset:64
  s_buffer_load_dword s84, s[48:51], s98 offset:128
  s_buffer_load_dword s84, s[48:51], s98 offset:192
  s_add_u32 s98, s98, 256
  s_waitcnt vmcnt(13)
  s_barrier
  s_mov_b32 s79, 8
L_attn0_ld1:
  s_add_u32 s3, s75, s76
  s_add_u32 m0, s3, 0
  s_nop 0
  buffer_load_dwordx4 v4, s[36:39], s73 offen lds
  s_add_u32 m0, s3, 1024
  s_nop 0
  buffer_load_dwordx4 v5, s[36:39], s73 offen lds
  s_add_u32 m0, s3, 2048
  s_nop 0
  buffer_load_dwordx4 v6, s[36:39], s73 offen lds
  s_add_u32 m0, s3, 3072
  s_nop 0
  buffer_load_dwordx4 v7, s[36:39], s73 offen lds
  s_add_u32 m0, s78, s75
  s_mov_b64 exec, s[14:15]
  buffer_load_dwordx4 v28, s[36:39], s73 offen lds
  s_mov_b64 exec, -1
  s_add_u32 s3, s75, s77
  s_add_u32 m0, s3, 0
  s_add_u32 s4, s74, 0
  buffer_load_dwordx4 v8, s[40:43], s4 offen lds
  s_add_u32 m0, s3, 1024
  s_nop 0
  buffer_load_dwordx4 v9, s[40:43], s4 offen lds
  s_add_u32 m0, s3, 8192
  s_add_u32 s4, s74, 2048
  buffer_load_dwordx4 v8, s[40:43], s4 offen lds
  s_add_u32 m0, s3, 9216
  s_nop 0
  buffer_load_dwordx4 v9, s[40:43], s4 offen lds
  s_add_u32 m0, s3, 16384
  s_add_u32 s4, s74, 4096
  buffer_load_dwordx4 v8, s[40:43], s4 offen lds
  s_add_u32 m0, s3, 17408
  s_nop 0
  buffer_load_dwordx4 v9, s[40:43], s4 offen lds
  s_and_b32 s73, s100, 15
  s_cmp_eq_u32 s73, s91
  s_cselect_b32 s74, 4, 0
  s_lshr_b64 s[100:101], s[100:101], s74
  s_and_b32 s73, s100, 15
  s_sub_u32 s92, s92, 1
  s_cselect_b32 s73, s91, s73
  s_cselect_b32 s74, 0, 4
  s_lshr_b64 s[100:101], s[100:101], s74
  s_mul_i32 s74, s73, 393216
  s_lshl_b32 s73, s73, 7
  s_add_u32 s75, s75, 43008
  s_cmp_eq_u32 s75, 129024
  s_cselect_b32 s75, 0, s75
  s_buffer_load_dword s84, s[48:51], s98 offset:0
  s_buffer_load_dword s84, s[48:51], s98 offset:64
  s_buffer_load_dword s84, s[48:51], s98 offset:128
  s_buffer_load_dword s84, s[48:51], s98 offset:192
  s_add_u32 s98, s98, 256
  s_waitcnt vmcnt(11)
  s_barrier
  s_sub_u32 s79, s79, 1
  s_cmp_lg_u32 s79, 0
  s_cbranch_scc1 L_attn0_ld1
  buffer_load_dword v21, v20, s[64:67], 0 offen sc1
  s_add_u32 s3, s75, s76
  s_add_u32 m0, s3, 0
  s_nop 0
  buffer_load_dwordx4 v4, s[36:39], s73 offen lds
  s_add_u32 m0, s3, 1024
  s_nop 0
  buffer_load_dwordx4 v5, s[36:39], s73 offen lds
  s_add_u32 m0, s3, 2048
  s_nop 0
  buffer_load_dwordx4 v6, s[36:39], s73 offen lds
  s_add_u32 m0, s3, 3072
  s_nop 0
  buffer_load_dwordx4 v7, s[36:39], s73 offen lds
  s_add_u32 m0, s78, s75
  s_mov_b64 exec, s[14:15]
  buffer_load_dwordx4 v28, s[36:39], s73 offen lds
  s_mov_b64 exec, -1
  s_add_u32 s3, s75, s77
  s_add_u32 m0, s3, 0
  s_add_u32 s4, s74, 0
  buffer_load_dwordx4 v8, s[40:43], s4 offen lds
  s_add_u32 m0, s3, 1024
  s_nop 0
  buffer_load_dwordx4 v9, s[40:43], s4 offen lds
  s_add_u32 m0, s3, 8192
  s_add_u32 s4, s74, 2048
  buffer_load_dwordx4 v8, s[40:43], s4 offen lds
  s_add_u32 m0, s3, 9216
  s_nop 0
  buffer_load_dwordx4 v9, s[40:43], s4 offen lds
  s_add_u32 m0, s3, 16384
  s_add_u32 s4, s74, 4096
  buffer_load_dwordx4 v8, s[40:43], s4 offen lds
  s_add_u32 m0, s3, 17408
  s_nop 0
  buffer_load_dwordx4 v9, s[40:43], s4 offen lds
  s_and_b32 s73, s100, 15
  s_cmp_eq_u32 s73, s91
  s_cselect_b32 s74, 4, 0
  s_lshr_b64 s[100:101], s[100:101], s74
  s_and_b32 s73, s100, 15
  s_sub_u32 s92, s92, 1
  s_cselect_b32 s73, s91, s73
  s_cselect_b32 s74, 0, 4
  s_lshr_b64 s[100:101], s[100:101], s74
  s_mul_i32 s74, s73, 393216
  s_lshl_b32 s73, s73, 7
  s_add_u32 s75, s75, 43008
  s_cmp_eq_u32 s75, 129024
  s_cselect_b32 s75, 0, s75
  s_buffer_load_dword s84, s[48:51], s98 offset:0
  s_buffer_load_dword s84, s[48:51], s98 offset:64
  s_buffer_load_dword s84, s[48:51], s98 offset:128
  s_buffer_load_dword s84, s[48:51], s98 offset:192
  s_add_u32 s98, s98, 256
  s_waitcnt vmcnt(12)
  s_barrier
  s_waitcnt vmcnt(11)
  s_mov_b32 s5, 0x100000
  L_attn_dchk:
  v_or_b32 v13, 0xfefefefe, v21
  v_cmp_ne_u32 vcc, -1, v13
  s_cbranch_vccz L_attn_dok
  s_sub_u32 s5, s5, 1
  buffer_load_dword v21, v20, s[64:67], 0 offen sc1
  s_waitcnt vmcnt(0)
  s_cbranch_scc0 L_attn_dchk
  L_attn_dok:
  buffer_load_dwordx4 v[32:35], v18, s[56:59], 0 offen
  s_mov_b32 s3, 65536
  buffer_load_dwordx4 v[36:39], v18, s[56:59], s3 offen
  s_mov_b32 s3, 131072
  buffer_load_dwordx4 v[40:43], v18, s[56:59], s3 offen
  s_mov_b32 s3, 196608
  buffer_load_dwordx4 v[44:47], v18, s[56:59], s3 offen
  buffer_load_dwordx2 v[48:49], v19, s[56:59], 0 offen
  s_mov_b32 s5, 0xffff0000
  v_lshlrev_b32 v100, 16, v64
  v_and_b32 v101, s5, v64
  v_lshlrev_b32 v102, 16, v65
  v_and_b32 v103, s5, v65
  v_lshlrev_b32 v104, 16, v66
  v_and_b32 v105, s5, v66
  v_lshlrev_b32 v106, 16, v67
  v_and_b32 v107, s5, v67
  v_lshlrev_b32 v108, 16, v68
  v_and_b32 v68, s5, v68
  v_add_f32 v100, v100, v108
  v_add_f32 v101, v101, v68
  v_lshlrev_b32 v108, 16, v69
  v_and_b32 v69, s5, v69
  v_add_f32 v102, v102, v108
  v_add_f32 v103, v103, v69
  v_lshlrev_b32 v108, 16, v70
  v_and_b32 v70, s5, v70
  v_add_f32 v104, v104, v108
  v_add_f32 v105, v105, v70
  v_lshlrev_b32 v108, 16, v71
  v_and_b32 v71, s5, v71
  v_add_f32 v106, v106, v108
  v_add_f32 v107, v107, v71
  v_lshlrev_b32 v108, 16, v72
  v_and_b32 v72, s5, v72
  v_add_f32 v100, v100, v108
  v_add_f32 v101, v101, v72
  v_lshlrev_b32 v108, 16, v73
  v_and_b32 v73, s5, v73
  v_add_f32 v102, v102, v108
  v_add_f32 v103, v103, v73
  v_lshlrev_b32 v108, 16, v74
  v_and_b32 v74, s5, v74
  v_add_f32 v104, v104, v108
  v_add_f32 v105, v105, v74
  v_lshlrev_b32 v108, 16, v75
  v_and_b32 v75, s5, v75
  v_add_f32 v106, v106, v108
  v_add_f32 v107, v107, v75
  v_lshlrev_b32 v108, 16, v76
  v_and_b32 v76, s5, v76
  v_add_f32 v100, v100, v108
  v_add_f32 v101, v101, v76
  v_lshlrev_b32 v108, 16, v77
  v_and_b32 v77, s5, v77
  v_add_f32 v102, v102, v108
  v_add_f32 v103, v103, v77
  v_lshlrev_b32 v108, 16, v78
  v_and_b32 v78, s5, v78
  v_add_f32 v104, v104, v108
  v_add_f32 v105, v105, v78
  v_lshlrev_b32 v108, 16, v79
  v_and_b32 v79, s5, v79
  v_add_f32 v106, v106, v108
  v_add_f32 v107, v107, v79
  s_mov_b32 s60, s20
  s_and_b32 s61, s21, 0xffff
  s_mov_b32 s62, 2097152
  s_mov_b32 s63, 0x00020000
  s_and_b32 s3, s70, 3
  s_mul_i32 s3, s3, 8
  s_mul_i32 s4, s99, 32
  s_add_u32 s3, s3, s4
  v_lshrrev_b32 v2, 3, v1
  v_add_u32 v2, s3, v2
  v_mul_u32_u24 v2, 2048, v2
  v_and_b32 v3, 7, v1
  v_lshl_add_u32 v2, v3, 8, v2
  s_and_b32 s3, s2, 7
  s_lshr_b32 s3, s3, 2
  s_mul_i32 s3, s3, 128
  buffer_load_dword v96, v2, s[60:63], s3 offen
  s_waitcnt vmcnt(6)
  s_barrier
  s_mov_b32 s79, 0x4000
  s_waitcnt vmcnt(1)
L_attn_schk:
  v_add_f32 v32, v32, v36
  v_add_f32 v33, v33, v37
  v_add_f32 v34, v34, v38
  v_add_f32 v35, v35, v39
  v_add_f32 v40, v40, v44
  v_add_f32 v41, v41, v45
  v_add_f32 v42, v42, v46
  v_add_f32 v43, v43, v47
  v_add_f32 v32, v32, v40
  v_add_f32 v33, v33, v41
  v_add_f32 v34, v34, v42
  v_add_f32 v35, v35, v43
  s_nop 1
  v_permlane32_swap_b32 v32, v34
  v_permlane32_swap_b32 v33, v35
  v_add_f32 v32, v32, v34
  v_add_f32 v33, v33, v35
  v_cmp_u_f32 vcc, v32, v33
  v_cmp_u_f32 s[4:5], v48, v49
  s_or_b64 s[4:5], vcc, s[4:5]
  s_cbranch_scc0 L_attn_sok
  s_sub_u32 s79, s79, 1
  s_cbranch_scc1 L_attn_sok
  buffer_load_dwordx4 v[32:35], v18, s[56:59], 0 offen sc1
  s_mov_b32 s3, 65536
  buffer_load_dwordx4 v[36:39], v18, s[56:59], s3 offen sc1
  s_mov_b32 s3, 131072
  buffer_load_dwordx4 v[40:43], v18, s[56:59], s3 offen sc1
  s_mov_b32 s3, 196608
  buffer_load_dwordx4 v[44:47], v18, s[56:59], s3 offen sc1
  buffer_load_dwordx2 v[48:49], v19, s[56:59], 0 offen sc1
  s_waitcnt vmcnt(0)
  s_branch L_attn_schk
L_attn_sok:
  v_mov_b32 v34, v32
  v_mov_b32 v35, v33
  s_nop 0
  v_permlane16_swap_b32 v32, v34
  v_permlane16_swap_b32 v33, v35
  v_add_f32 v32, v32, v34
  v_add_f32 v33, v33, v35
  v_mul_f32 v32, 0x3a800000, v32
  v_mul_f32 v33, 0x3a800000, v33
  v_fma_f32 v33, -v32, v32, v33
  v_max_f32 v33, 0, v33
  v_add_f32 v33, 0x3727c5ac, v33
  v_rsq_f32 v33, v33
  s_nop 0
  s_and_b32 s3, s70, 3
  s_lshl_b32 s5, s3, 7
  s_add_u32 s5, s5, 129088
  v_and_b32 v3, 15, v1
  v_lshrrev_b32 v2, 5, v1
  v_lshl_add_u32 v2, v3, 1, v2
  v_lshl_add_u32 v2, v2, 2, s5
  ds_write2_b32 v2, v32, v33 offset0:0 offset1:160
  v_mov_b32 v50, v48
  v_mov_b32 v51, v49
  s_nop 0
  v_permlane32_swap_b32 v48, v50
  v_permlane32_swap_b32 v49, v51
  v_add_f32 v48, v48, v50
  v_add_f32 v49, v49, v51
  v_mov_b32 v50, v48
  v_mov_b32 v51, v49
  s_nop 0
  v_permlane16_swap_b32 v48, v50
  v_permlane16_swap_b32 v49, v51
  v_add_f32 v48, v48, v50
  v_add_f32 v49, v49, v51
  s_nop 1
  v_add_f32_dpp v48, v48, v48 row_ror:8 row_mask:0xf bank_mask:0xf
  v_add_f32_dpp v49, v49, v49 row_ror:8 row_mask:0xf bank_mask:0xf
  s_nop 1
  v_add_f32_dpp v48, v48, v48 row_ror:4 row_mask:0xf bank_mask:0xf
  v_add_f32_dpp v49, v49, v49 row_ror:4 row_mask:0xf bank_mask:0xf
  v_mul_f32 v48, 0x3a800000, v48
  v_mul_f32 v49, 0x3a800000, v49
  v_fma_f32 v49, -v48, v48, v49
  v_max_f32 v49, 0, v49
  v_add_f32 v49, 0x3727c5ac, v49
  v_rsq_f32 v49, v49
  s_nop 0
  s_lshl_b32 s5, s3, 4
  s_add_u32 s5, s5, 129024
  v_and_b32 v3, 3, v1
  v_lshl_add_u32 v2, v3, 2, s5
  ds_write2_b32 v2, v48, v49 offset0:0 offset1:160
  s_mov_b32 s5, 0xffff0000
  v_lshlrev_b32 v108, 16, v80
  v_and_b32 v80, s5, v80
  v_add_f32 v100, v100, v108
  v_add_f32 v101, v101, v80
  v_lshlrev_b32 v108, 16, v81
  v_and_b32 v81, s5, v81
  v_add_f32 v102, v102, v108
  v_add_f32 v103, v103, v81
  v_lshlrev_b32 v108, 16, v82
  v_and_b32 v82, s5, v82
  v_add_f32 v104, v104, v108
  v_add_f32 v105, v105, v82
  v_lshlrev_b32 v108, 16, v83
  v_and_b32 v83, s5, v83
  v_add_f32 v106, v106, v108
  v_add_f32 v107, v107, v83
  v_lshlrev_b32 v108, 16, v84
  v_and_b32 v84, s5, v84
  v_add_f32 v100, v100, v108
  v_add_f32 v101, v101, v84
  v_lshlrev_b32 v108, 16, v85
  v_and_b32 v85, s5, v85
  v_add_f32 v102, v102, v108
  v_add_f32 v103, v103, v85
  v_lshlrev_b32 v108, 16, v86
  v_and_b32 v86, s5, v86
  v_add_f32 v104, v104, v108
  v_add_f32 v105, v105, v86
  v_lshlrev_b32 v108, 16, v87
  v_and_b32 v87, s5, v87
  v_add_f32 v106, v106, v108
  v_add_f32 v107, v107, v87
  v_lshlrev_b32 v108, 16, v88
  v_and_b32 v88, s5, v88
  v_add_f32 v100, v100, v108
  v_add_f32 v101, v101, v88
  v_lshlrev_b32 v108, 16, v89
  v_and_b32 v89, s5, v89
  v_add_f32 v102, v102, v108
  v_add_f32 v103, v103, v89
  v_lshlrev_b32 v108, 16, v90
  v_and_b32 v90, s5, v90
  v_add_f32 v104, v104, v108
  v_add_f32 v105, v105, v90
  v_lshlrev_b32 v108, 16, v91
  v_and_b32 v91, s5, v91
  v_add_f32 v106, v106, v108
  v_add_f32 v107, v107, v91
  v_lshlrev_b32 v108, 16, v92
  v_and_b32 v92, s5, v92
  v_add_f32 v100, v100, v108
  v_add_f32 v101, v101, v92
  v_lshlrev_b32 v108, 16, v93
  v_and_b32 v93, s5, v93
  v_add_f32 v102, v102, v108
  v_add_f32 v103, v103, v93
  v_lshlrev_b32 v108, 16, v94
  v_and_b32 v94, s5, v94
  v_add_f32 v104, v104, v108
  v_add_f32 v105, v105, v94
  v_lshlrev_b32 v108, 16, v95
  v_and_b32 v95, s5, v95
  v_add_f32 v106, v106, v108
  v_add_f32 v107, v107, v95
  s_add_u32 s52, s22, 24641536
  s_addc_u32 s53, s23, 0
  s_and_b32 s53, s53, 0xffff
  s_mov_b32 s54, 262144
  s_mov_b32 s55, 0x00020000
  v_permlane32_swap_b32 v100, v104
  v_permlane32_swap_b32 v101, v105
  v_permlane32_swap_b32 v102, v106
  v_permlane32_swap_b32 v103, v107
  v_add_f32 v100, v100, v104
  v_add_f32 v101, v101, v105
  v_add_f32 v102, v102, v106
  v_add_f32 v103, v103, v107
  v_and_b32 v2, 7, v1
  v_lshlrev_b32 v2, 5, v2
  v_permlane16_swap_b32 v100, v102
  v_permlane16_swap_b32 v101, v103
  v_add_f32 v100, v100, v102
  v_add_f32 v101, v101, v103
  v_lshrrev_b32 v3, 4, v1
  v_lshl_add_u32 v102, v3, 3, v2
  v_add_f32_dpp v100, v100, v100 row_ror:8 row_mask:0xf bank_mask:0xf
  v_add_f32_dpp v101, v101, v101 row_ror:8 row_mask:0xf bank_mask:0xf
  buffer_store_dwordx2 v[100:101], v102, s[52:55], s94 offen sc1
  s_waitcnt lgkmcnt(0)
  s_barrier
  s_branch L_attn_ldend
L_attn_ld1:
  s_add_u32 s3, s68, s69
  s_and_b32 s3, s3, 3
  s_mov_b32 s100, 0x68532410
  s_mov_b32 s101, 0xfedbac97
  s_cmp_eq_u32 s3, 1
  s_cselect_b32 s100, 0x96435210, s100
  s_cselect_b32 s101, 0xfecbda87, s101
  s_cmp_eq_u32 s3, 2
  s_cselect_b32 s100, 0x75463210, s100
  s_cselect_b32 s101, 0xfdceb98a, s101
  s_cmp_eq_u32 s3, 3
  s_cselect_b32 s100, 0x65743210, s100
  s_cselect_b32 s101, 0xedfca9b8, s101
  s_add_u32 s56, s22, 24379392
  s_addc_u32 s57, s23, 0
  s_and_b32 s57, s57, 0xffff
  s_mov_b32 s58, 262144
  s_mov_b32 s59, 0x00020000
  s_and_b32 s3, s70, 3
  s_lshl2_add_u32 s4, s68, s3
  s_lshl_b32 s4, s4, 8
  v_lshrrev_b32 v2, 4, v1
  v_and_b32 v3, 15, v1
  v_lshl_add_u32 v3, v3, 4, s4
  v_lshl_add_u32 v18, v2, 14, v3
  s_lshl_b32 s4, s68, 5
  s_add_u32 s4, s4, s3
  s_sub_u32 s4, s4, 4
  s_max_i32 s4, s4, 0
  s_lshl_b32 s4, s4, 5
  v_lshrrev_b32 v2, 2, v1
  v_and_b32 v3, 3, v1
  v_lshl_add_u32 v3, v3, 3, s4
  v_lshl_add_u32 v19, v2, 14, v3
  s_add_u32 s64, s22, 41943040
  s_addc_u32 s65, s23, 0
  s_and_b32 s65, s65, 0xffff
  s_mov_b32 s66, 524288
  s_mov_b32 s67, 0x00020000
  v_and_b32 v30, 3, v1
  v_lshlrev_b32 v30, 6, v30
  s_mov_b32 s79, 0x100000
  s_cmp_lg_u32 s70, 4
  s_cbranch_scc1 L_attn_xgo
  s_setprio 3
L_attn_xpoll:
  buffer_load_dword v12, v30, s[64:67], s86 offen sc1
  s_sub_u32 s79, s79, 1
  s_cbranch_scc1 L_attn_xgo
  s_waitcnt vmcnt(0)
  v_cmp_ne_u32 vcc, 1, v12
  s_cbranch_vccnz L_attn_xpoll
L_attn_xgo:
  s_setprio 0
  s_barrier
  s_lshr_b32 s3, s69, 3
  s_and_b32 s73, s69, 7
  s_lshl1_add_u32 s91, s73, s3
  s_mul_i32 s74, s91, 393216
  s_lshl_b32 s73, s91, 7
  s_mov_b32 s88, s73
  s_add_u32 m0, s77, 0
  s_add_u32 s4, s74, 0
  buffer_load_dwordx4 v8, s[40:43], s4 offen lds
  s_add_u32 m0, s77, 1024
  s_nop 0
  buffer_load_dwordx4 v9, s[40:43], s4 offen lds
  s_add_u32 m0, s77, 8192
  s_add_u32 s4, s74, 2048
  buffer_load_dwordx4 v8, s[40:43], s4 offen lds
  s_add_u32 m0, s77, 9216
  s_nop 0
  buffer_load_dwordx4 v9, s[40:43], s4 offen lds
  s_add_u32 m0, s77, 16384
  s_add_u32 s4, s74, 4096
  buffer_load_dwordx4 v8, s[40:43], s4 offen lds
  s_add_u32 m0, s77, 17408
  s_nop 0
  buffer_load_dwordx4 v9, s[40:43], s4 offen lds
  s_and_b32 s73, s100, 15
  s_cmp_eq_u32 s73, s91
  s_cselect_b32 s74, 4, 0
  s_lshr_b64 s[100:101], s[100:101], s74
  s_and_b32 s73, s100, 15
  s_lshr_b64 s[100:101], s[100:101], 4
  s_mul_i32 s74, s73, 393216
  s_lshl_b32 s73, s73, 7
  s_mov_b32 s75, 0
  s_add_u32 s44, s22, 41943040
  s_addc_u32 s45, s23, 0
  s_and_b32 s45, s45, 0xffff
  s_mov_b32 s46, 524288
  s_mov_b32 s47, 0x00020000
  s_lshl4_add_u32 s3, s97, s68
  s_and_b32 s4, s69, 15
  s_lshl4_add_u32 s3, s3, s4
  s_lshl_b32 s3, s3, 7
  s_sub_u32 s3, s3, 32768
  v_lshlrev_b32 v11, 7, v1
  s_cmp_eq_u32 s68, 0
  s_cselect_b32 s4, 15, 31
  v_and_b32 v2, 16, v1
  v_lshl_add_u32 v11, v2, 2, v11
  v_and_b32 v2, s4, v1
  v_lshlrev_b32 v2, 2, v2
  v_mov_b32 v3, 1
  s_mov_b32 s79, 0x100000
  s_waitcnt vmcnt(0)
  s_cmp_lg_u32 s70, 4
  s_barrier
  s_cbranch_scc1 L_attn_nofl
  s_mov_b32 exec_lo, 0xffffffff
  s_mov_b32 exec_hi, 0
  buffer_store_dword v3, v11, s[44:47], s87 offen sc1
  s_mov_b64 exec, -1
L_attn_nofl:
  s_mov_b32 s5, s3
  s_mov_b32 s89, s73
  s_add_u32 m0, s77, 43008
  s_add_u32 s4, s74, 0
  buffer_load_dwordx4 v8, s[40:43], s4 offen lds
  s_add_u32 m0, s77, 44032
  s_nop 0
  buffer_load_dwordx4 v9, s[40:43], s4 offen lds
  s_add_u32 m0, s77, 51200
  s_add_u32 s4, s74, 2048
  buffer_load_dwordx4 v8, s[40:43], s4 offen lds
  s_add_u32 m0, s77, 52224
  s_nop 0
  buffer_load_dwordx4 v9, s[40:43], s4 offen lds
  s_add_u32 m0, s77, 59392
  s_add_u32 s4, s74, 4096
  buffer_load_dwordx4 v8, s[40:43], s4 offen lds
  s_add_u32 m0, s77, 60416
  s_nop 0
  buffer_load_dwordx4 v9, s[40:43], s4 offen lds
  s_and_b32 s73, s100, 15
  s_cmp_eq_u32 s73, s91
  s_cselect_b32 s74, 4, 0
  s_lshr_b64 s[100:101], s[100:101], s74
  s_and_b32 s73, s100, 15
  s_lshr_b64 s[100:101], s[100:101], 4
  s_mul_i32 s74, s73, 393216
  s_lshl_b32 s73, s73, 7
  s_mov_b32 s90, s73
  s_add_u32 m0, s77, 86016
  s_add_u32 s4, s74, 0
  buffer_load_dwordx4 v8, s[40:43], s4 offen lds
  s_add_u32 m0, s77, 87040
  s_nop 0
  buffer_load_dwordx4 v9, s[40:43], s4 offen lds
  s_add_u32 m0, s77, 94208
  s_add_u32 s4, s74, 2048
  buffer_load_dwordx4 v8, s[40:43], s4 offen lds
  s_add_u32 m0, s77, 95232
  s_nop 0
  buffer_load_dwordx4 v9, s[40:43], s4 offen lds
  s_add_u32 m0, s77, 102400
  s_add_u32 s4, s74, 4096
  buffer_load_dwordx4 v8, s[40:43], s4 offen lds
  s_add_u32 m0, s77, 103424
  s_nop 0
  buffer_load_dwordx4 v9, s[40:43], s4 offen lds
  s_and_b32 s73, s100, 15
  s_cmp_eq_u32 s73, s91
  s_cselect_b32 s74, 4, 0
  s_lshr_b64 s[100:101], s[100:101], s74
  s_and_b32 s73, s100, 15
  s_lshr_b64 s[100:101], s[100:101], 4
  s_mul_i32 s74, s73, 393216
  s_lshl_b32 s73, s73, 7
  s_mov_b32 s3, s5
  s_cmp_lg_u32 s70, 4
  s_cbranch_scc1 L_attn_dep
L_attn_poll:
  buffer_load_dword v3, v2, s[44:47], s3 offen sc1
  s_sub_u32 s79, s79, 1
  s_cbranch_scc1 L_attn_dep
  s_waitcnt vmcnt(0)
  v_cmp_ne_u32 vcc, 1, v3
  s_cbranch_vccnz L_attn_poll
L_attn_dep:
  s_waitcnt vmcnt(6)
  s_barrier
  s_add_u32 m0, s78, 89344
  s_mov_b64 exec, s[14:15]
  buffer_load_dwordx4 v28, s[36:39], s88 offen lds
  s_mov_b64 exec, -1
  s_add_u32 m0, s76, 43008
  s_nop 0
  buffer_load_dwordx4 v4, s[36:39], s89 offen lds
  s_add_u32 m0, s76, 44032
  s_nop 0
  buffer_load_dwordx4 v5, s[36:39], s89 offen lds
  s_add_u32 m0, s76, 45056
  s_nop 0
  buffer_load_dwordx4 v6, s[36:39], s89 offen lds
  s_add_u32 m0, s76, 46080
  s_nop 0
  buffer_load_dwordx4 v7, s[36:39], s89 offen lds
  s_add_u32 m0, s78, 43008
  s_mov_b64 exec, s[14:15]
  buffer_load_dwordx4 v28, s[36:39], s89 offen lds
  s_mov_b64 exec, -1
  s_add_u32 m0, s76, 86016
  s_nop 0
  buffer_load_dwordx4 v4, s[36:39], s90 offen lds
  s_add_u32 m0, s76, 87040
  s_nop 0
  buffer_load_dwordx4 v5, s[36:39], s90 offen lds
  s_add_u32 m0, s76, 88064
  s_nop 0
  buffer_load_dwordx4 v6, s[36:39], s90 offen lds
  s_add_u32 m0, s76, 89088
  s_nop 0
  buffer_load_dwordx4 v7, s[36:39], s90 offen lds
  s_add_u32 m0, s78, 86016
  s_mov_b64 exec, s[14:15]
  buffer_load_dwordx4 v28, s[36:39], s90 offen lds
  s_mov_b64 exec, -1
  s_waitcnt vmcnt(5)
  s_barrier
  s_mov_b32 s79, 12
L_attn1_ld1:
  s_add_u32 s3, s75, s76
  s_add_u32 m0, s3, 0
  s_nop 0
  buffer_load_dwordx4 v4, s[36:39], s73 offen lds
  s_add_u32 m0, s3, 1024
  s_nop 0
  buffer_load_dwordx4 v5, s[36:39], s73 offen lds
  s_add_u32 m0, s3, 2048
  s_nop 0
  buffer_load_dwordx4 v6, s[36:39], s73 offen lds
  s_add_u32 m0, s3, 3072
  s_nop 0
  buffer_load_dwordx4 v7, s[36:39], s73 offen lds
  s_add_u32 m0, s78, s75
  s_mov_b64 exec, s[14:15]
  buffer_load_dwordx4 v28, s[36:39], s73 offen lds
  s_mov_b64 exec, -1
  s_add_u32 s3, s75, s77
  s_add_u32 m0, s3, 0
  s_add_u32 s4, s74, 0
  buffer_load_dwordx4 v8, s[40:43], s4 offen lds
  s_add_u32 m0, s3, 1024
  s_nop 0
  buffer_load_dwordx4 v9, s[40:43], s4 offen lds
  s_add_u32 m0, s3, 8192
  s_add_u32 s4, s74, 2048
  buffer_load_dwordx4 v8, s[40:43], s4 offen lds
  s_add_u32 m0, s3, 9216
  s_nop 0
  buffer_load_dwordx4 v9, s[40:43], s4 offen lds
  s_add_u32 m0, s3, 16384
  s_add_u32 s4, s74, 4096
  buffer_load_dwordx4 v8, s[40:43], s4 offen lds
  s_add_u32 m0, s3, 17408
  s_nop 0
  buffer_load_dwordx4 v9, s[40:43], s4 offen lds
  s_and_b32 s73, s100, 15
  s_cmp_eq_u32 s73, s91
  s_cselect_b32 s74, 4, 0
  s_lshr_b64 s[100:101], s[100:101], s74
  s_and_b32 s73, s100, 15
  s_lshr_b64 s[100:101], s[100:101], 4
  s_mul_i32 s74, s73, 393216
  s_lshl_b32 s73, s73, 7
  s_add_u32 s75, s75, 43008
  s_cmp_eq_u32 s75, 129024
  s_cselect_b32 s75, 0, s75
  s_waitcnt vmcnt(11)
  s_barrier
  s_sub_u32 s79, s79, 1
  s_cmp_lg_u32 s79, 0
  s_cbranch_scc1 L_attn1_ld1
  s_add_u32 s3, s75, s76
  s_add_u32 m0, s3, 0
  s_nop 0
  buffer_load_dwordx4 v4, s[36:39], s73 offen lds
  s_add_u32 m0, s3, 1024
  s_nop 0
  buffer_load_dwordx4 v5, s[36:39], s73 offen lds
  s_add_u32 m0, s3, 2048
  s_nop 0
  buffer_load_dwordx4 v6, s[36:39], s73 offen lds
  s_add_u32 m0, s3, 3072
  s_nop 0
  buffer_load_dwordx4 v7, s[36:39], s73 offen lds
  s_add_u32 m0, s78, s75
  s_mov_b64 exec, s[14:15]
  buffer_load_dwordx4 v28, s[36:39], s73 offen lds
  s_mov_b64 exec, -1
  s_add_u32 s3, s75, s77
  s_add_u32 m0, s3, 0
  s_add_u32 s4, s74, 0
  buffer_load_dwordx4 v8, s[40:43], s4 offen lds
  s_add_u32 m0, s3, 1024
  s_nop 0
  buffer_load_dwordx4 v9, s[40:43], s4 offen lds
  s_add_u32 m0, s3, 8192
  s_add_u32 s4, s74, 2048
  buffer_load_dwordx4 v8, s[40:43], s4 offen lds
  s_add_u32 m0, s3, 9216
  s_nop 0
  buffer_load_dwordx4 v9, s[40:43], s4 offen lds
  s_add_u32 m0, s3, 16384
  s_add_u32 s4, s74, 4096
  buffer_load_dwordx4 v8, s[40:43], s4 offen lds
  s_add_u32 m0, s3, 17408
  s_nop 0
  buffer_load_dwordx4 v9, s[40:43], s4 offen lds
  s_and_b32 s73, s100, 15
  s_cmp_eq_u32 s73, s91
  s_cselect_b32 s74, 4, 0
  s_lshr_b64 s[100:101], s[100:101], s74
  s_and_b32 s73, s100, 15
  s_lshr_b64 s[100:101], s[100:101], 4
  s_mul_i32 s74, s73, 393216
  s_lshl_b32 s73, s73, 7
  s_add_u32 s75, s75, 43008
  s_cmp_eq_u32 s75, 129024
  s_cselect_b32 s75, 0, s75
  s_mov_b32 s60, s20
  s_and_b32 s61, s21, 0xffff
  s_mov_b32 s62, 2097152
  s_mov_b32 s63, 0x00020000
  s_and_b32 s3, s70, 3
  s_mul_i32 s3, s3, 8
  s_mul_i32 s4, s99, 32
  s_add_u32 s3, s3, s4
  v_lshrrev_b32 v2, 3, v1
  v_add_u32 v2, s3, v2
  v_mul_u32_u24 v2, 2048, v2
  v_and_b32 v3, 7, v1
  v_lshl_add_u32 v2, v3, 8, v2
  s_and_b32 s3, s2, 7
  s_lshr_b32 s3, s3, 2
  s_mul_i32 s3, s3, 128
  buffer_load_dword v96, v2, s[60:63], s3 offen
  s_waitcnt vmcnt(12)
  s_barrier
  buffer_load_dwordx4 v[32:35], v18, s[56:59], 0 offen
  s_mov_b32 s3, 65536
  buffer_load_dwordx4 v[36:39], v18, s[56:59], s3 offen
  s_mov_b32 s3, 131072
  buffer_load_dwordx4 v[40:43], v18, s[56:59], s3 offen
  s_mov_b32 s3, 196608
  buffer_load_dwordx4 v[44:47], v18, s[56:59], s3 offen
  buffer_load_dwordx2 v[48:49], v19, s[56:59], 0 offen
  s_waitcnt vmcnt(6)
  s_barrier
  s_waitcnt vmcnt(0)
  v_add_f32 v32, v32, v36
  v_add_f32 v33, v33, v37
  v_add_f32 v34, v34, v38
  v_add_f32 v35, v35, v39
  v_add_f32 v40, v40, v44
  v_add_f32 v41, v41, v45
  v_add_f32 v42, v42, v46
  v_add_f32 v43, v43, v47
  v_add_f32 v32, v32, v40
  v_add_f32 v33, v33, v41
  v_add_f32 v34, v34, v42
  v_add_f32 v35, v35, v43
  s_nop 1
  v_permlane32_swap_b32 v32, v34
  v_permlane32_swap_b32 v33, v35
  v_add_f32 v32, v32, v34
  v_add_f32 v33, v33, v35
  v_mov_b32 v34, v32
  v_mov_b32 v35, v33
  s_nop 0
  v_permlane16_swap_b32 v32, v34
  v_permlane16_swap_b32 v33, v35
  v_add_f32 v32, v32, v34
  v_add_f32 v33, v33, v35
  v_mul_f32 v32, 0x3a800000, v32
  v_mul_f32 v33, 0x3a800000, v33
  v_fma_f32 v33, -v32, v32, v33
  v_max_f32 v33, 0, v33
  v_add_f32 v33, 0x3727c5ac, v33
  v_rsq_f32 v33, v33
  s_nop 0
  s_and_b32 s3, s70, 3
  s_lshl_b32 s5, s3, 7
  s_add_u32 s5, s5, 129088
  v_and_b32 v3, 15, v1
  v_lshrrev_b32 v2, 5, v1
  v_lshl_add_u32 v2, v3, 1, v2
  v_lshl_add_u32 v2, v2, 2, s5
  ds_write2_b32 v2, v32, v33 offset0:0 offset1:160
  v_mov_b32 v50, v48
  v_mov_b32 v51, v49
  s_nop 0
  v_permlane32_swap_b32 v48, v50
  v_permlane32_swap_b32 v49, v51
  v_add_f32 v48, v48, v50
  v_add_f32 v49, v49, v51
  v_mov_b32 v50, v48
  v_mov_b32 v51, v49
  s_nop 0
  v_permlane16_swap_b32 v48, v50
  v_permlane16_swap_b32 v49, v51
  v_add_f32 v48, v48, v50
  v_add_f32 v49, v49, v51
  s_nop 1
  v_add_f32_dpp v48, v48, v48 row_ror:8 row_mask:0xf bank_mask:0xf
  v_add_f32_dpp v49, v49, v49 row_ror:8 row_mask:0xf bank_mask:0xf
  s_nop 1
  v_add_f32_dpp v48, v48, v48 row_ror:4 row_mask:0xf bank_mask:0xf
  v_add_f32_dpp v49, v49, v49 row_ror:4 row_mask:0xf bank_mask:0xf
  v_mul_f32 v48, 0x3a800000, v48
  v_mul_f32 v49, 0x3a800000, v49
  v_fma_f32 v49, -v48, v48, v49
  v_max_f32 v49, 0, v49
  v_add_f32 v49, 0x3727c5ac, v49
  v_rsq_f32 v49, v49
  s_nop 0
  s_lshl_b32 s5, s3, 4
  s_add_u32 s5, s5, 129024
  v_and_b32 v3, 3, v1
  v_lshl_add_u32 v2, v3, 2, s5
  ds_write2_b32 v2, v48, v49 offset0:0 offset1:160
  s_waitcnt lgkmcnt(0)
  s_barrier
L_attn_ldend:
  s_lshl_b32 s87, s97, 15
  s_lshl_b32 s4, s68, 11
  s_add_u32 s87, s87, s4
  s_lshl_b32 s4, s69, 2
  s_add_u32 s87, s87, s4
  s_add_u32 s97, s97, 1
  s_branch L_wo_body
L_attn_end:
  s_endpgm
.fill 835, 4, 0xbf810000
L_attn_compute:
  s_cmp_lg_u32 s96, 0
  s_cbranch_scc1 L_pfc1_skip
  s_getpc_b64 s[4:5]
L_pfc1:
  s_lshl_b32 s3, s99, 2
  s_add_u32 s3, s3, s70
  s_mul_i32 s3, s3, 320
  s_min_u32 s3, s3, L_w2_c1-L_attn_c0-320
  s_add_i32 s3, s3, L_attn_c0-L_pfc1
  s_ashr_i32 s6, s3, 31
  s_add_u32 s4, s4, s3
  s_addc_u32 s5, s5, s6
  s_load_dword s40, s[4:5], 0
  s_load_dword s40, s[4:5], 64
  s_load_dword s40, s[4:5], 128
  s_load_dword s40, s[4:5], 192
  s_load_dword s40, s[4:5], 256
L_pfc1_skip:
  s_and_b32 s71, s70, 1
  s_lshr_b32 s72, s70, 1
  v_and_b32 v3, 31, v1
  v_lshlrev_b32 v3, 2, v3
  v_add_u32 v3, 40960, v3
  v_mov_b32 v236, 0x3f803f80
  v_mov_b32 v237, 0x3f803f80
  v_mov_b32 v238, 0x3f803f80
  v_mov_b32 v239, 0x3f803f80
  ds_write_b32 v3, v236
  ds_write_b32 v3, v236 offset:43008
  v_add_u32 v3, 86016, v3
  ds_write_b32 v3, v236
  ds_write_b32 v3, v236 offset:3328
  v_and_b32 v3, 15, v1
  v_lshrrev_b32 v2, 4, v1
  v_lshrrev_b32 v33, 1, v3
  s_lshl_b32 s8, s71, 13
  v_xor_b32 v4, v2, v33
  v_lshlrev_b32 v4, 4, v4
  v_lshl_add_u32 v4, v3, 7, v4
  v_add_u32 v8, 40960, v4
  v_add_u32 v4, s8, v4
  v_add_u32 v5, 4, v2
  v_xor_b32 v5, v5, v33
  v_lshlrev_b32 v5, 4, v5
  v_lshl_add_u32 v5, v3, 7, v5
  v_add_u32 v9, 40960, v5
  v_add_u32 v5, s8, v5
  v_bfe_u32 v34, v1, 2, 2
  v_lshl_add_u32 v34, v2, 3, v34
  v_lshlrev_b32 v34, 7, v34
  v_and_b32 v33, 3, v1
  v_lshl_add_u32 v34, v33, 3, v34
  v_bfe_u32 v33, v1, 3, 2
  v_lshl_add_u32 v34, v33, 5, v34
  s_lshl_b32 s8, s70, 5
  v_xor_b32 v34, s8, v34
  v_add_u32 v6, 16384, v34
  v_xor_b32 v7, 32, v6
  s_mov_b32 s75, 0
  v_add_u32_e64 v10, s75, v4
  v_add_u32_e64 v11, s75, v5
  v_add_u32_e64 v12, s75, v6
  v_add_u32_e64 v13, s75, v7
  v_add_u32_e64 v14, s75, v8
  v_add_u32_e64 v15, s75, v9
  s_add_u32 s75, s75, 43008
  s_cmp_eq_u32 s75, 129024
  s_cselect_b32 s75, 0, s75
  s_mov_b32 vcc_hi, 0
  s_and_b32 s79, s69, 3
  s_add_u32 s79, s79, 1
  s_mul_i32 s98, s96, 2
  s_cmp_eq_u32 s96, 0
  s_cbranch_scc1 L_attn_nog
  s_mov_b32 s79, 14
  ds_read_b128 v[32:35], v10 offset:0
  ds_read_b128 v[36:39], v10 offset:2048
  ds_read_b128 v[40:43], v10 offset:4096
  ds_read_b128 v[44:47], v10 offset:6144
  ds_read_b64_tr_b16 v[52:53], v12 offset:0
  ds_read_b64_tr_b16 v[54:55], v12 offset:512
  ds_read_b64_tr_b16 v[56:57], v13 offset:0
  ds_read_b64_tr_b16 v[58:59], v13 offset:512
  ds_read_b64_tr_b16 v[60:61], v12 offset:8192
  ds_read_b64_tr_b16 v[62:63], v12 offset:8704
  ds_read_b64_tr_b16 v[64:65], v13 offset:8192
  ds_read_b64_tr_b16 v[66:67], v13 offset:8704
  ds_read_b64_tr_b16 v[68:69], v12 offset:16384
  ds_read_b64_tr_b16 v[70:71], v12 offset:16896
  ds_read_b64_tr_b16 v[72:73], v13 offset:16384
  ds_read_b64_tr_b16 v[74:75], v13 offset:16896
  s_waitcnt lgkmcnt(0)
  v_mfma_f32_16x16x32_bf16 v[128:131], v[52:55], v[32:35], 0
  ds_read_b128 v[76:79], v11 offset:0
  v_mfma_f32_16x16x32_bf16 v[132:135], v[52:55], v[36:39], 0
  ds_read_b128 v[80:83], v11 offset:2048
  v_mfma_f32_16x16x32_bf16 v[136:139], v[52:55], v[40:43], 0
  ds_read_b128 v[84:87], v11 offset:4096
  v_mfma_f32_16x16x32_bf16 v[140:143], v[52:55], v[44:47], 0
  ds_read_b128 v[88:91], v11 offset:6144
  v_mfma_f32_16x16x32_bf16 v[156:159], v[56:59], v[44:47], 0
  ds_read_b64_tr_b16 v[96:97], v12 offset:4096
  v_mfma_f32_16x16x32_bf16 v[152:155], v[56:59], v[40:43], 0
  ds_read_b64_tr_b16 v[98:99], v12 offset:4608
  v_mfma_f32_16x16x32_bf16 v[148:151], v[56:59], v[36:39], 0
  ds_read_b64_tr_b16 v[100:101], v13 offset:4096
  v_mfma_f32_16x16x32_bf16 v[144:147], v[56:59], v[32:35], 0
  ds_read_b64_tr_b16 v[102:103], v13 offset:4608
  v_mfma_f32_16x16x32_bf16 v[160:163], v[60:63], v[32:35], 0
  ds_read_b64_tr_b16 v[104:105], v12 offset:12288
  v_mfma_f32_16x16x32_bf16 v[164:167], v[60:63], v[36:39], 0
  ds_read_b64_tr_b16 v[106:107], v12 offset:12800
  v_mfma_f32_16x16x32_bf16 v[168:171], v[60:63], v[40:43], 0
  ds_read_b64_tr_b16 v[108:109], v13 offset:12288
  v_mfma_f32_16x16x32_bf16 v[172:175], v[60:63], v[44:47], 0
  ds_read_b64_tr_b16 v[110:111], v13 offset:12800
  v_mfma_f32_16x16x32_bf16 v[188:191], v[64:67], v[44:47], 0
  ds_read_b64_tr_b16 v[112:113], v12 offset:20480
  v_mfma_f32_16x16x32_bf16 v[184:187], v[64:67], v[40:43], 0
  ds_read_b64_tr_b16 v[114:115], v12 offset:20992
  v_mfma_f32_16x16x32_bf16 v[180:183], v[64:67], v[36:39], 0
  ds_read_b64_tr_b16 v[116:117], v13 offset:20480
  v_mfma_f32_16x16x32_bf16 v[176:179], v[64:67], v[32:35], 0
  ds_read_b64_tr_b16 v[118:119], v13 offset:20992
  v_mfma_f32_16x16x32_bf16 v[192:195], v[32:35], v[68:71], 0
  v_add_u32_e64 v10, s75, v4
  v_mfma_f32_16x16x32_bf16 v[196:199], v[36:39], v[68:71], 0
  v_add_u32_e64 v11, s75, v5
  v_mfma_f32_16x16x32_bf16 v[200:203], v[40:43], v[68:71], 0
  v_add_u32_e64 v12, s75, v6
  v_mfma_f32_16x16x32_bf16 v[204:207], v[44:47], v[68:71], 0
  v_add_u32_e64 v13, s75, v7
  v_mfma_f32_16x16x32_bf16 v[220:223], v[44:47], v[72:75], 0
  v_add_u32_e64 v14, s75, v8
  v_mfma_f32_16x16x32_bf16 v[216:219], v[40:43], v[72:75], 0
  v_add_u32_e64 v15, s75, v9
  v_mfma_f32_16x16x32_bf16 v[212:215], v[36:39], v[72:75], 0
  s_add_u32 s75, s75, 43008
  v_mfma_f32_16x16x32_bf16 v[208:211], v[32:35], v[72:75], 0
  s_cmp_eq_u32 s75, 129024
  s_cselect_b32 s75, 0, s75
  s_waitcnt lgkmcnt(0)
  v_mfma_f32_16x16x32_bf16 v[128:131], v[96:99], v[76:79], v[128:131]
  v_mfma_f32_16x16x32_bf16 v[132:135], v[96:99], v[80:83], v[132:135]
  v_mfma_f32_16x16x32_bf16 v[136:139], v[96:99], v[84:87], v[136:139]
  v_mfma_f32_16x16x32_bf16 v[140:143], v[96:99], v[88:91], v[140:143]
  v_mfma_f32_16x16x32_bf16 v[156:159], v[100:103], v[88:91], v[156:159]
  v_mfma_f32_16x16x32_bf16 v[152:155], v[100:103], v[84:87], v[152:155]
  v_mfma_f32_16x16x32_bf16 v[148:151], v[100:103], v[80:83], v[148:151]
  v_mfma_f32_16x16x32_bf16 v[144:147], v[100:103], v[76:79], v[144:147]
  v_mfma_f32_16x16x32_bf16 v[160:163], v[104:107], v[76:79], v[160:163]
  v_mfma_f32_16x16x32_bf16 v[164:167], v[104:107], v[80:83], v[164:167]
  v_mfma_f32_16x16x32_bf16 v[168:171], v[104:107], v[84:87], v[168:171]
  v_mfma_f32_16x16x32_bf16 v[172:175], v[104:107], v[88:91], v[172:175]
  v_mfma_f32_16x16x32_bf16 v[188:191], v[108:111], v[88:91], v[188:191]
  v_mfma_f32_16x16x32_bf16 v[184:187], v[108:111], v[84:87], v[184:187]
  v_mfma_f32_16x16x32_bf16 v[180:183], v[108:111], v[80:83], v[180:183]
  v_mfma_f32_16x16x32_bf16 v[176:179], v[108:111], v[76:79], v[176:179]
  v_mfma_f32_16x16x32_bf16 v[192:195], v[76:79], v[112:115], v[192:195]
  v_mfma_f32_16x16x32_bf16 v[196:199], v[80:83], v[112:115], v[196:199]
  v_mfma_f32_16x16x32_bf16 v[200:203], v[84:87], v[112:115], v[200:203]
  v_mfma_f32_16x16x32_bf16 v[204:207], v[88:91], v[112:115], v[204:207]
  v_mfma_f32_16x16x32_bf16 v[220:223], v[88:91], v[116:119], v[220:223]
  v_mfma_f32_16x16x32_bf16 v[216:219], v[84:87], v[116:119], v[216:219]
  v_mfma_f32_16x16x32_bf16 v[212:215], v[80:83], v[116:119], v[212:215]
  v_mfma_f32_16x16x32_bf16 v[208:211], v[76:79], v[116:119], v[208:211]
  s_barrier
  ds_read_b64_tr_b16 v[52:53], v12 offset:0
  ds_read_b64_tr_b16 v[54:55], v12 offset:512
  ds_read_b64_tr_b16 v[96:97], v12 offset:4096
  ds_read_b64_tr_b16 v[98:99], v12 offset:4608
  ds_read_b64_tr_b16 v[56:57], v13 offset:0
  ds_read_b64_tr_b16 v[58:59], v13 offset:512
  ds_read_b64_tr_b16 v[100:101], v13 offset:4096
  ds_read_b64_tr_b16 v[102:103], v13 offset:4608
  ds_read_b64_tr_b16 v[108:109], v13 offset:12288
  ds_read_b64_tr_b16 v[110:111], v13 offset:12800
  ds_read_b64_tr_b16 v[64:65], v13 offset:8192
  ds_read_b64_tr_b16 v[66:67], v13 offset:8704
L_attn_nog:
  v_and_b32 v35, 1, v2
  v_xor_b32 v35, s71, v35
  s_lshl_b32 s8, s68, 7
  s_lshl_b32 s9, s71, 6
  s_add_u32 s8, s8, s9
  s_mul_i32 s10, s8, 7
  s_lshl2_add_u32 s11, s69, s72
  s_add_u32 s10, s10, s11
  s_lshl_b32 s10, s10, 10
  v_lshl_add_u32 v31, v1, 4, s10
  s_mul_i32 s10, s72, 14336
  s_add_u32 s10, s10, 87040
  s_lshl_b32 s11, s71, 10
  s_add_u32 s4, s10, s11
  s_sub_u32 s5, s10, s11
  s_mul_i32 s6, s71, 6144
  v_lshl_add_u32 v16, v1, 4, s4
  v_add_u32 v17, s6, v16
  v_lshl_add_u32 v18, v1, 4, s5
  v_add_u32 v18, s6, v18
  v_lshl_add_u32 v19, v2, 8, s4
  v_lshl_add_u32 v20, v2, 8, s5
  v_lshl_add_u32 v21, v3, 4, s4
  v_lshl_add_u32 v22, v3, 4, s5
  s_lshl_b32 s10, s71, 8
  s_add_u32 s10, s10, 129024
  v_lshl_add_u32 v23, v3, 2, s10
  v_lshl_add_u32 v24, v2, 4, s10
  v_and_b32 v33, 1, v3
  v_cmp_eq_u32 s[48:49], 1, v33
  v_lshl_add_u32 v34, v2, 2, v33
  v_add_u32 v35, 2, v34
  v_cmp_gt_u32 s[50:51], v34, v3
  v_cmp_gt_u32 s[52:53], v35, v3
  v_mov_b32 v36, 0xffff
  v_mov_b32 v37, 0xffff0000
  v_cndmask_b32 v36, v36, v37, s[48:49]
  s_add_u32 s10, s10, 704
  v_lshl_add_u32 v34, v34, 2, s10
  v_lshl_add_u32 v35, v35, 2, s10
  v_subrev_u32 v38, 64, v34
  v_subrev_u32 v39, 64, v35
  v_cndmask_b32 v25, v34, v38, s[50:51]
  v_cndmask_b32 v26, v35, v39, s[52:53]
  v_cndmask_b32 v27, 0, v36, s[50:51]
  v_cndmask_b32 v29, 0, v36, s[52:53]
  v_xor_b32 v28, v27, v36
  v_xor_b32 v30, v29, v36
  s_cmp_eq_u32 s8, 0
  s_cselect_b64 s[54:55], s[50:51], 0
  s_cselect_b64 s[14:15], s[52:53], 0
  s_waitcnt lgkmcnt(0)
  s_add_u32 s56, s22, 23592960
  s_addc_u32 s57, s23, 0
  s_and_b32 s57, s57, 0xffff
  s_mov_b32 s58, 327680
  s_mov_b32 s59, 0x00020000
  s_cmp_lg_u32 s96, 0
  s_cbranch_scc1 L_attn_nozero
  v_mov_b32 v122, 0
  v_mov_b32 v123, 0
  v_mov_b32 v124, 0
  v_mov_b32 v125, 0
  v_mov_b32 v126, 0
  v_mov_b32 v127, 0
  v_mov_b32 v128, 0
  v_mov_b32 v129, 0
  v_mov_b32 v130, 0
  v_mov_b32 v131, 0
  v_mov_b32 v132, 0
  v_mov_b32 v133, 0
  v_mov_b32 v134, 0
  v_mov_b32 v135, 0
  v_mov_b32 v136, 0
  v_mov_b32 v137, 0
  v_mov_b32 v138, 0
  v_mov_b32 v139, 0
  v_mov_b32 v140, 0
  v_mov_b32 v141, 0
  v_mov_b32 v142, 0
  v_mov_b32 v143, 0
  v_mov_b32 v144, 0
  v_mov_b32 v145, 0
  v_mov_b32 v146, 0
  v_mov_b32 v147, 0
  v_mov_b32 v148, 0
  v_mov_b32 v149, 0
  v_mov_b32 v150, 0
  v_mov_b32 v151, 0
  v_mov_b32 v152, 0
  v_mov_b32 v153, 0
  v_mov_b32 v154, 0
  v_mov_b32 v155, 0
  v_mov_b32 v156, 0
  v_mov_b32 v157, 0
  v_mov_b32 v158, 0
  v_mov_b32 v159, 0
  v_mov_b32 v160, 0
  v_mov_b32 v161, 0
  v_mov_b32 v162, 0
  v_mov_b32 v163, 0
  v_mov_b32 v164, 0
  v_mov_b32 v165, 0
  v_mov_b32 v166, 0
  v_mov_b32 v167, 0
  v_mov_b32 v168, 0
  v_mov_b32 v169, 0
  v_mov_b32 v170, 0
  v_mov_b32 v171, 0
  v_mov_b32 v172, 0
  v_mov_b32 v173, 0
  v_mov_b32 v174, 0
  v_mov_b32 v175, 0
  v_mov_b32 v176, 0
  v_mov_b32 v177, 0
  v_mov_b32 v178, 0
  v_mov_b32 v179, 0
  v_mov_b32 v180, 0
  v_mov_b32 v181, 0
  v_mov_b32 v182, 0
  v_mov_b32 v183, 0
  v_mov_b32 v184, 0
  v_mov_b32 v185, 0
  v_mov_b32 v186, 0
  v_mov_b32 v187, 0
  v_mov_b32 v188, 0
  v_mov_b32 v189, 0
  v_mov_b32 v190, 0
  v_mov_b32 v191, 0
  v_mov_b32 v192, 0
  v_mov_b32 v193, 0
  v_mov_b32 v194, 0
  v_mov_b32 v195, 0
  v_mov_b32 v196, 0
  v_mov_b32 v197, 0
  v_mov_b32 v198, 0
  v_mov_b32 v199, 0
  v_mov_b32 v200, 0
  v_mov_b32 v201, 0
  v_mov_b32 v202, 0
  v_mov_b32 v203, 0
  v_mov_b32 v204, 0
  v_mov_b32 v205, 0
  v_mov_b32 v206, 0
  v_mov_b32 v207, 0
  v_mov_b32 v208, 0
  v_mov_b32 v209, 0
  v_mov_b32 v210, 0
  v_mov_b32 v211, 0
  v_mov_b32 v212, 0
  v_mov_b32 v213, 0
  v_mov_b32 v214, 0
  v_mov_b32 v215, 0
  v_mov_b32 v216, 0
  v_mov_b32 v217, 0
  v_mov_b32 v218, 0
  v_mov_b32 v219, 0
  v_mov_b32 v220, 0
  v_mov_b32 v221, 0
  v_mov_b32 v222, 0
  v_mov_b32 v223, 0
  v_mov_b32 v224, 0
  v_mov_b32 v225, 0
  v_mov_b32 v226, 0
  v_mov_b32 v227, 0
  v_mov_b32 v228, 0
  v_mov_b32 v229, 0
  v_mov_b32 v230, 0
  v_mov_b32 v231, 0
  v_mov_b32 v232, 0
  v_mov_b32 v233, 0
  v_mov_b32 v234, 0
  v_mov_b32 v235, 0
  s_waitcnt lgkmcnt(0)
  s_lshl_b32 s3, s72, 5
  s_add_u32 s3, s3, s8
  s_lshl_b32 s4, s69, 14
  s_lshl3_add_u32 s3, s3, s4
  v_lshrrev_b32 v121, 1, v2
  v_lshl_add_u32 v121, v121, 4, v3
  v_and_b32 v120, 1, v2
  v_lshl_add_u32 v121, v121, 1, v120
  v_lshl_add_u32 v120, v121, 2, s3
  s_add_u32 s60, s22, 41943040
  s_addc_u32 s61, s23, 0
  s_and_b32 s61, s61, 0xffff
  s_mov_b32 s62, 524288
  s_mov_b32 s63, 0x00020000
  s_lshl_b32 s3, s2, 11
  s_cmp_lg_u32 s70, 0
  s_cbranch_scc1 L_attn_noclr
  s_lshl_b32 s5, s68, 10
  s_add_u32 s4, s4, s5
  v_lshlrev_b32 v121, 4, v1
  v_mov_b32 v40, -1
  v_mov_b32 v41, -1
  v_mov_b32 v42, -1
  v_mov_b32 v43, -1
  buffer_store_dwordx4 v[40:43], v121, s[56:59], s4 offen sc1
  buffer_store_dwordx4 v[128:131], v121, s[60:63], s3 offen offset:0 sc1
  buffer_store_dwordx4 v[128:131], v121, s[60:63], s3 offen offset:1024 sc1
  v_mov_b32 v126, 1
L_attn_noclr:
  s_and_b32 s65, s65, 0xffff
  s_mov_b32 s66, 256
  s_mov_b32 s67, 0x00020000
  s_mov_b32 s7, 0x3f803f80
L_attn_nozero:
  s_waitcnt lgkmcnt(0)
  s_lshl4_add_u32 s3, s68, s69
  s_lshl2_add_u32 s3, s3, s70
  s_lshl2_add_u32 s3, s3, 0x4000
  v_lshl_add_u32 v121, v3, 16, v2
  v_add_lshl_u32 v121, v121, s3, 4
  s_mov_b32 s36, s16
  s_and_b32 s37, s17, 0xffff
  s_mov_b32 s38, 4194304
  s_mov_b32 s39, 0x00020000
  s_and_b32 s3, s2, 3
  s_and_b32 s4, s99, 3
  s_lshl2_add_u32 s3, s3, s4
  s_lshl2_add_u32 s3, s3, s70
  s_lshl_b32 s3, s3, 16
  s_bfe_u32 s4, s2, 0x10002
  s_lshr_b32 s5, s99, 2
  s_lshl1_add_u32 s4, s5, s4
  s_lshl_b32 s4, s4, 7
  s_add_u32 s42, s3, s4
  s_add_u32 s43, s42, 32768
  v_and_b32 v127, 15, v1
  v_lshlrev_b32 v33, 1, v1
  v_and_b32 v33, 32, v33
  v_lshl_add_u32 v127, v127, 11, v33
  v_lshrrev_b32 v33, 1, v1
  v_and_b32 v33, 16, v33
  v_add_u32 v127, v127, v33
  s_add_u32 s44, s34, 8439808
  s_addc_u32 s45, s35, 0
  s_and_b32 s45, s45, 0xffff
  s_mov_b32 s46, 14628864
  s_mov_b32 s47, 0x00020000
  s_cmp_eq_u32 s96, 0
  s_barrier
  s_cbranch_scc1 L_attn_first
  ds_read_b128 v[44:47], v14 offset:46336
  ds_read_b128 v[88:91], v15 offset:46336
  buffer_load_dwordx4 v[122:125], v121, s[56:59], 0 offen sc1
  ds_read_b128 v[48:51], v14
  ds_read_b128 v[92:95], v15
  ds_read_b128 v[76:79], v11 offset:0
  ds_read_b128 v[32:35], v10 offset:0
  ds_read_b128 v[80:83], v11 offset:2048
  ds_read_b128 v[36:39], v10 offset:2048
  ds_read_b128 v[84:87], v11 offset:4096
  ds_read_b128 v[40:43], v10 offset:4096
  s_waitcnt lgkmcnt(8)
  v_mfma_f32_16x16x32_bf16 v[228:231], v[60:63], v[44:47], 0
  v_mfma_f32_16x16x32_bf16 v[228:231], v[104:107], v[88:91], v[228:231]
  v_mfma_f32_16x16x32_bf16 v[232:235], v[44:47], v[68:71], 0
  v_mfma_f32_16x16x32_bf16 v[232:235], v[88:91], v[112:115], v[232:235]
  s_waitcnt lgkmcnt(0)
  s_branch L_attn_loop1
L_attn_first:
  ds_read_b64_tr_b16 v[52:53], v12 offset:0
  ds_read_b64_tr_b16 v[54:55], v12 offset:512
  ds_read_b64_tr_b16 v[96:97], v12 offset:4096
  ds_read_b64_tr_b16 v[98:99], v12 offset:4608
  ds_read_b64_tr_b16 v[56:57], v13 offset:0
  ds_read_b64_tr_b16 v[58:59], v13 offset:512
  ds_read_b64_tr_b16 v[100:101], v13 offset:4096
  ds_read_b64_tr_b16 v[102:103], v13 offset:4608
  ds_read_b64_tr_b16 v[108:109], v13 offset:12288
  ds_read_b64_tr_b16 v[110:111], v13 offset:12800
  ds_read_b64_tr_b16 v[64:65], v13 offset:8192
  ds_read_b64_tr_b16 v[66:67], v13 offset:8704
  ds_read_b128 v[48:51], v14
  ds_read_b128 v[92:95], v15
  ds_read_b128 v[76:79], v11 offset:0
  ds_read_b128 v[32:35], v10 offset:0
  ds_read_b128 v[80:83], v11 offset:2048
  ds_read_b128 v[36:39], v10 offset:2048
  ds_read_b128 v[84:87], v11 offset:4096
  ds_read_b128 v[40:43], v10 offset:4096
.p2align 5
  s_nop 0
  s_nop 0
  s_nop 0
  s_waitcnt lgkmcnt(0)
L_attn_loop:
  v_mfma_f32_16x16x32_bf16 v[224:227], v[52:55], v[48:51], v[224:227]
  v_mfma_f32_16x16x32_bf16 v[224:227], v[96:99], v[92:95], v[224:227]
L_attn_loop1:
  ds_read_b128 v[44:47], v10 offset:6144
  v_mfma_f32_16x16x32_bf16 v[128:131], v[96:99], v[76:79], v[128:131]
  ds_read_b128 v[88:91], v11 offset:6144
  v_mfma_f32_16x16x32_bf16 v[128:131], v[52:55], v[32:35], v[128:131]
  ds_read_b64_tr_b16 v[104:105], v12 offset:12288
  v_mfma_f32_16x16x32_bf16 v[144:147], v[56:59], v[32:35], v[144:147]
  ds_read_b64_tr_b16 v[106:107], v12 offset:12800
  v_mfma_f32_16x16x32_bf16 v[144:147], v[100:103], v[76:79], v[144:147]
  ds_read_b64_tr_b16 v[60:61], v12 offset:8192
  s_waitcnt lgkmcnt(7)
  s_nop 0
  v_mfma_f32_16x16x32_bf16 v[148:151], v[100:103], v[80:83], v[148:151]
  ds_read_b64_tr_b16 v[62:63], v12 offset:8704
  v_mfma_f32_16x16x32_bf16 v[148:151], v[56:59], v[36:39], v[148:151]
  ds_read_b64_tr_b16 v[68:69], v12 offset:16384
  v_mfma_f32_16x16x32_bf16 v[132:135], v[52:55], v[36:39], v[132:135]
  ds_read_b64_tr_b16 v[70:71], v12 offset:16896
  v_mfma_f32_16x16x32_bf16 v[132:135], v[96:99], v[80:83], v[132:135]
  ds_read_b64_tr_b16 v[112:113], v12 offset:20480
  s_waitcnt lgkmcnt(9)
  s_nop 0
  v_mfma_f32_16x16x32_bf16 v[136:139], v[96:99], v[84:87], v[136:139]
  ds_read_b64_tr_b16 v[114:115], v12 offset:20992
  v_mfma_f32_16x16x32_bf16 v[136:139], v[52:55], v[40:43], v[136:139]
  ds_read_b64_tr_b16 v[72:73], v13 offset:16384
  v_mfma_f32_16x16x32_bf16 v[152:155], v[56:59], v[40:43], v[152:155]
  ds_read_b64_tr_b16 v[74:75], v13 offset:16896
  v_mfma_f32_16x16x32_bf16 v[152:155], v[100:103], v[84:87], v[152:155]
  ds_read_b64_tr_b16 v[116:117], v13 offset:20480
  s_waitcnt lgkmcnt(11)
  s_nop 0
  v_mfma_f32_16x16x32_bf16 v[156:159], v[100:103], v[88:91], v[156:159]
  ds_read_b64_tr_b16 v[118:119], v13 offset:20992
  v_mfma_f32_16x16x32_bf16 v[156:159], v[56:59], v[44:47], v[156:159]
  v_add_u32_e64 v10, s75, v4
  v_mfma_f32_16x16x32_bf16 v[140:143], v[52:55], v[44:47], v[140:143]
  v_add_u32_e64 v11, s75, v5
  v_mfma_f32_16x16x32_bf16 v[140:143], v[96:99], v[88:91], v[140:143]
  v_add_u32_e64 v12, s75, v6
  v_mfma_f32_16x16x32_bf16 v[188:191], v[108:111], v[88:91], v[188:191]
  v_add_u32_e64 v13, s75, v7
  v_mfma_f32_16x16x32_bf16 v[188:191], v[64:67], v[44:47], v[188:191]
  v_add_u32_e64 v14, s75, v8
  v_mfma_f32_16x16x32_bf16 v[184:187], v[64:67], v[40:43], v[184:187]
  v_add_u32_e64 v15, s75, v9
  v_mfma_f32_16x16x32_bf16 v[184:187], v[108:111], v[84:87], v[184:187]
  s_add_u32 s75, s75, 43008
  v_mfma_f32_16x16x32_bf16 v[180:183], v[108:111], v[80:83], v[180:183]
  s_cmp_eq_u32 s75, 129024
  v_mfma_f32_16x16x32_bf16 v[180:183], v[64:67], v[36:39], v[180:183]
  s_cselect_b32 s75, 0, s75
  s_sub_u32 s79, s79, 1
  s_waitcnt lgkmcnt(0)
  s_barrier
  v_mfma_f32_16x16x32_bf16 v[176:179], v[64:67], v[32:35], v[176:179]
  ds_read_b64_tr_b16 v[52:53], v12 offset:0
  v_mfma_f32_16x16x32_bf16 v[176:179], v[108:111], v[76:79], v[176:179]
  ds_read_b64_tr_b16 v[54:55], v12 offset:512
  v_mfma_f32_16x16x32_bf16 v[160:163], v[104:107], v[76:79], v[160:163]
  ds_read_b64_tr_b16 v[96:97], v12 offset:4096
  v_mfma_f32_16x16x32_bf16 v[160:163], v[60:63], v[32:35], v[160:163]
  ds_read_b64_tr_b16 v[98:99], v12 offset:4608
  v_mfma_f32_16x16x32_bf16 v[164:167], v[60:63], v[36:39], v[164:167]
  ds_read_b64_tr_b16 v[56:57], v13 offset:0
  v_mfma_f32_16x16x32_bf16 v[164:167], v[104:107], v[80:83], v[164:167]
  ds_read_b64_tr_b16 v[58:59], v13 offset:512
  v_mfma_f32_16x16x32_bf16 v[168:171], v[104:107], v[84:87], v[168:171]
  ds_read_b64_tr_b16 v[100:101], v13 offset:4096
  v_mfma_f32_16x16x32_bf16 v[168:171], v[60:63], v[40:43], v[168:171]
  ds_read_b64_tr_b16 v[102:103], v13 offset:4608
  v_mfma_f32_16x16x32_bf16 v[172:175], v[60:63], v[44:47], v[172:175]
  ds_read_b64_tr_b16 v[108:109], v13 offset:12288
  v_mfma_f32_16x16x32_bf16 v[172:175], v[104:107], v[88:91], v[172:175]
  ds_read_b64_tr_b16 v[110:111], v13 offset:12800
  v_mfma_f32_16x16x32_bf16 v[228:231], v[104:107], v[92:95], v[228:231]
  ds_read_b64_tr_b16 v[64:65], v13 offset:8192
  v_mfma_f32_16x16x32_bf16 v[228:231], v[60:63], v[48:51], v[228:231]
  ds_read_b64_tr_b16 v[66:67], v13 offset:8704
  v_mfma_f32_16x16x32_bf16 v[232:235], v[48:51], v[68:71], v[232:235]
  ds_read_b128 v[48:51], v14
  v_mfma_f32_16x16x32_bf16 v[232:235], v[92:95], v[112:115], v[232:235]
  ds_read_b128 v[92:95], v15
  v_mfma_f32_16x16x32_bf16 v[192:195], v[76:79], v[112:115], v[192:195]
  s_cmp_lg_u32 s79, 0
  s_cselect_b32 vcc_lo, s96, 0
  v_mfma_f32_16x16x32_bf16 v[192:195], v[32:35], v[68:71], v[192:195]
  v_mfma_f32_16x16x32_bf16 v[208:211], v[32:35], v[72:75], v[208:211]
  ds_read_b128 v[32:35], v10 offset:0
  v_mfma_f32_16x16x32_bf16 v[208:211], v[76:79], v[116:119], v[208:211]
  ds_read_b128 v[76:79], v11 offset:0
  v_mfma_f32_16x16x32_bf16 v[212:215], v[80:83], v[116:119], v[212:215]
  v_mfma_f32_16x16x32_bf16 v[212:215], v[36:39], v[72:75], v[212:215]
  v_mfma_f32_16x16x32_bf16 v[196:199], v[36:39], v[68:71], v[196:199]
  ds_read_b128 v[36:39], v10 offset:2048
  v_mfma_f32_16x16x32_bf16 v[196:199], v[80:83], v[112:115], v[196:199]
  ds_read_b128 v[80:83], v11 offset:2048
  v_mfma_f32_16x16x32_bf16 v[200:203], v[84:87], v[112:115], v[200:203]
  v_mfma_f32_16x16x32_bf16 v[200:203], v[40:43], v[68:71], v[200:203]
  v_mfma_f32_16x16x32_bf16 v[216:219], v[40:43], v[72:75], v[216:219]
  ds_read_b128 v[40:43], v10 offset:4096
  v_mfma_f32_16x16x32_bf16 v[216:219], v[84:87], v[116:119], v[216:219]
  ds_read_b128 v[84:87], v11 offset:4096
  v_mfma_f32_16x16x32_bf16 v[220:223], v[88:91], v[116:119], v[220:223]
  v_mfma_f32_16x16x32_bf16 v[220:223], v[44:47], v[72:75], v[220:223]
  v_mfma_f32_16x16x32_bf16 v[204:207], v[44:47], v[68:71], v[204:207]
  v_mfma_f32_16x16x32_bf16 v[204:207], v[88:91], v[112:115], v[204:207]
  s_waitcnt lgkmcnt(4)
  s_cbranch_vccnz L_attn_loop1
  s_cbranch_scc1 L_attn_loop
L_attn_lend:
  s_add_u32 s98, s98, 1
  s_cmp_gt_u32 s98, 2
  s_cbranch_scc1 L_attn_exit
  s_cmp_lg_u32 s98, 1
  s_cbranch_scc1 L_attn_hook0
  s_mov_b32 s79, 1
  s_waitcnt lgkmcnt(0)
  s_cmp_lg_u32 s72, 0
  s_cbranch_scc1 L_attn_dot0
  v_dot2_f32_bf16 v122, v32, s7, v122
  v_dot2_f32_bf16 v123, v36, s7, v123
  v_dot2_f32_bf16 v124, v32, v32, v124
  v_dot2_f32_bf16 v125, v36, v36, v125
  v_dot2_f32_bf16 v122, v33, s7, v122
  v_dot2_f32_bf16 v123, v37, s7, v123
  v_dot2_f32_bf16 v124, v33, v33, v124
  v_dot2_f32_bf16 v125, v37, v37, v125
  v_dot2_f32_bf16 v122, v34, s7, v122
  v_dot2_f32_bf16 v123, v38, s7, v123
  v_dot2_f32_bf16 v124, v34, v34, v124
  v_dot2_f32_bf16 v125, v38, v38, v125
  v_dot2_f32_bf16 v122, v35, s7, v122
  v_dot2_f32_bf16 v123, v39, s7, v123
  v_dot2_f32_bf16 v124, v35, v35, v124
  v_dot2_f32_bf16 v125, v39, v39, v125
  v_dot2_f32_bf16 v122, v76, s7, v122
  v_dot2_f32_bf16 v123, v80, s7, v123
  v_dot2_f32_bf16 v124, v76, v76, v124
  v_dot2_f32_bf16 v125, v80, v80, v125
  v_dot2_f32_bf16 v122, v77, s7, v122
  v_dot2_f32_bf16 v123, v81, s7, v123
  v_dot2_f32_bf16 v124, v77, v77, v124
  v_dot2_f32_bf16 v125, v81, v81, v125
  v_dot2_f32_bf16 v122, v78, s7, v122
  v_dot2_f32_bf16 v123, v82, s7, v123
  v_dot2_f32_bf16 v124, v78, v78, v124
  v_dot2_f32_bf16 v125, v82, v82, v125
  v_dot2_f32_bf16 v122, v79, s7, v122
  v_dot2_f32_bf16 v123, v83, s7, v123
  v_dot2_f32_bf16 v124, v79, v79, v124
  v_dot2_f32_bf16 v125, v83, v83, v125
  s_branch L_attn_dote0
  L_attn_dot0:
  v_dot2_f32_bf16 v122, v40, s7, v122
  v_dot2_f32_bf16 v124, v40, v40, v124
  v_dot2_f32_bf16 v122, v41, s7, v122
  v_dot2_f32_bf16 v124, v41, v41, v124
  v_dot2_f32_bf16 v122, v42, s7, v122
  v_dot2_f32_bf16 v124, v42, v42, v124
  v_dot2_f32_bf16 v122, v43, s7, v122
  v_dot2_f32_bf16 v124, v43, v43, v124
  v_dot2_f32_bf16 v122, v84, s7, v122
  v_dot2_f32_bf16 v124, v84, v84, v124
  v_dot2_f32_bf16 v122, v85, s7, v122
  v_dot2_f32_bf16 v124, v85, v85, v124
  v_dot2_f32_bf16 v122, v86, s7, v122
  v_dot2_f32_bf16 v124, v86, v86, v124
  v_dot2_f32_bf16 v122, v87, s7, v122
  v_dot2_f32_bf16 v124, v87, v87, v124
  L_attn_dote0:
  s_cmp_lg_u32 s70, 0
  s_cbranch_scc1 L_attn_loop
  s_waitcnt vmcnt(0)
  s_lshl4_add_u32 s3, s68, s69
  s_mov_b64 exec, 1
  buffer_store_byte v126, off, s[64:67], s3 sc1
  s_mov_b64 exec, -1
  s_branch L_attn_loop
L_attn_hook0:
  s_and_b32 s79, s69, 3
  s_add_u32 s79, s79, 1
  s_sub_u32 s79, 14, s79
  s_cmp_eq_u32 s72, 0
  s_cbranch_scc1 L_attn_dot1
  v_dot2_f32_bf16 v123, v44, s7, v123
  v_dot2_f32_bf16 v125, v44, v44, v125
  v_dot2_f32_bf16 v123, v45, s7, v123
  v_dot2_f32_bf16 v125, v45, v45, v125
  v_dot2_f32_bf16 v123, v46, s7, v123
  v_dot2_f32_bf16 v125, v46, v46, v125
  v_dot2_f32_bf16 v123, v47, s7, v123
  v_dot2_f32_bf16 v125, v47, v47, v125
  v_dot2_f32_bf16 v123, v88, s7, v123
  v_dot2_f32_bf16 v125, v88, v88, v125
  v_dot2_f32_bf16 v123, v89, s7, v123
  v_dot2_f32_bf16 v125, v89, v89, v125
  v_dot2_f32_bf16 v123, v90, s7, v123
  v_dot2_f32_bf16 v125, v90, v90, v125
  v_dot2_f32_bf16 v123, v91, s7, v123
  v_dot2_f32_bf16 v125, v91, v91, v125
  L_attn_dot1:
  s_nop 2
  v_permlane32_swap_b32 v122, v123
  v_permlane32_swap_b32 v124, v125
  v_add_f32 v122, v122, v123
  v_add_f32 v124, v124, v125
  s_nop 0
  s_nop 0
  v_permlane16_swap_b32 v122, v124
  v_add_f32 v122, v122, v124
  buffer_store_dword v122, v120, s[56:59], 0 offen sc1
  s_branch L_attn_loop
L_attn_exit:
  v_mfma_f32_16x16x32_bf16 v[224:227], v[52:55], v[48:51], v[224:227]
  ds_read_b64_tr_b16 v[104:105], v12 offset:12288
  s_mul_i32 s3, s71, -32768
  v_mfma_f32_16x16x32_bf16 v[224:227], v[96:99], v[92:95], v[224:227]
  ds_read_b64_tr_b16 v[106:107], v12 offset:12800
  v_mfma_f32_16x16x32_bf16 v[128:131], v[96:99], v[76:79], v[128:131]
  ds_read_b64_tr_b16 v[60:61], v12 offset:8192
  v_mfma_f32_16x16x32_bf16 v[128:131], v[52:55], v[32:35], v[128:131]
  ds_read_b64_tr_b16 v[62:63], v12 offset:8704
  v_mfma_f32_16x16x32_bf16 v[144:147], v[56:59], v[32:35], v[144:147]
  ds_read_b128 v[44:47], v10 offset:6144
  v_mfma_f32_16x16x32_bf16 v[144:147], v[100:103], v[76:79], v[144:147]
  ds_read_b128 v[88:91], v11 offset:6144
  s_waitcnt lgkmcnt(8)
  v_mfma_f32_16x16x32_bf16 v[148:151], v[100:103], v[80:83], v[148:151]
  ds_read_b64_tr_b16 v[68:69], v12 offset:16384
  v_mfma_f32_16x16x32_bf16 v[148:151], v[56:59], v[36:39], v[148:151]
  ds_read_b64_tr_b16 v[70:71], v12 offset:16896
  v_add_u32 v10, s3, v16
  v_mfma_f32_16x16x32_bf16 v[132:135], v[52:55], v[36:39], v[132:135]
  ds_read_b64_tr_b16 v[112:113], v12 offset:20480
  v_mfma_f32_16x16x32_bf16 v[132:135], v[96:99], v[80:83], v[132:135]
  ds_read_b64_tr_b16 v[114:115], v12 offset:20992
  s_waitcnt lgkmcnt(10)
  v_mfma_f32_16x16x32_bf16 v[136:139], v[96:99], v[84:87], v[136:139]
  ds_read_b64_tr_b16 v[72:73], v13 offset:16384
  v_mfma_f32_16x16x32_bf16 v[136:139], v[52:55], v[40:43], v[136:139]
  ds_read_b64_tr_b16 v[74:75], v13 offset:16896
  v_mfma_f32_16x16x32_bf16 v[152:155], v[56:59], v[40:43], v[152:155]
  ds_read_b64_tr_b16 v[116:117], v13 offset:20480
  v_mfma_f32_16x16x32_bf16 v[152:155], v[100:103], v[84:87], v[152:155]
  ds_read_b64_tr_b16 v[118:119], v13 offset:20992
  s_waitcnt lgkmcnt(8)
  v_mfma_f32_16x16x32_bf16 v[228:231], v[104:107], v[92:95], v[228:231]
  v_mfma_f32_16x16x32_bf16 v[228:231], v[60:63], v[48:51], v[228:231]
  v_mfma_f32_16x16x32_bf16 v[172:175], v[60:63], v[44:47], v[172:175]
  v_mfma_f32_16x16x32_bf16 v[172:175], v[104:107], v[88:91], v[172:175]
  s_cmp_lg_u32 s96, 0
  s_waitcnt vmcnt(0)
  v_mfma_f32_16x16x32_bf16 v[188:191], v[108:111], v[88:91], v[188:191]
  s_cbranch_scc1 L_attn_nores
  buffer_load_dwordx4 v[240:243], v127, s[36:39], s42 offen offset:0
  buffer_load_dwordx4 v[244:247], v127, s[36:39], s42 offen offset:64
  buffer_load_dwordx4 v[248:251], v127, s[36:39], s43 offen offset:0
  buffer_load_dwordx4 v[252:255], v127, s[36:39], s43 offen offset:64
  buffer_store_dwordx4 v[224:227], v121, s[56:59], 0 offen sc1
  v_mov_b32 v122, v224
  v_mov_b32 v123, v225
  v_mov_b32 v124, v226
  v_mov_b32 v125, v227
  L_attn_nores:
  v_mfma_f32_16x16x32_bf16 v[188:191], v[64:67], v[44:47], v[188:191]
  s_waitcnt lgkmcnt(0)
  v_mfma_f32_16x16x32_bf16 v[232:235], v[48:51], v[68:71], v[232:235]
  ds_write_b128 v16, v[122:125]
  v_mfma_f32_16x16x32_bf16 v[232:235], v[92:95], v[112:115], v[232:235]
  v_mfma_f32_16x16x32_bf16 v[204:207], v[88:91], v[112:115], v[204:207]
  v_mfma_f32_16x16x32_bf16 v[204:207], v[44:47], v[68:71], v[204:207]
  v_mfma_f32_16x16x32_bf16 v[220:223], v[44:47], v[72:75], v[220:223]
  ds_write_b128 v16, v[228:231] offset:2048
  v_mfma_f32_16x16x32_bf16 v[220:223], v[88:91], v[116:119], v[220:223]
  v_mfma_f32_16x16x32_bf16 v[184:187], v[108:111], v[84:87], v[184:187]
  v_mfma_f32_16x16x32_bf16 v[184:187], v[64:67], v[40:43], v[184:187]
  v_mfma_f32_16x16x32_bf16 v[180:183], v[64:67], v[36:39], v[180:183]
  ds_write_b128 v10, v[172:175] offset:8192
  v_mfma_f32_16x16x32_bf16 v[180:183], v[108:111], v[80:83], v[180:183]
  v_mfma_f32_16x16x32_bf16 v[176:179], v[108:111], v[76:79], v[176:179]
  v_mfma_f32_16x16x32_bf16 v[176:179], v[64:67], v[32:35], v[176:179]
  v_mfma_f32_16x16x32_bf16 v[160:163], v[60:63], v[32:35], v[160:163]
  ds_write_b128 v10, v[188:191] offset:9216
  v_mfma_f32_16x16x32_bf16 v[160:163], v[104:107], v[76:79], v[160:163]
  v_mfma_f32_16x16x32_bf16 v[164:167], v[104:107], v[80:83], v[164:167]
  v_mfma_f32_16x16x32_bf16 v[164:167], v[60:63], v[36:39], v[164:167]
  v_mfma_f32_16x16x32_bf16 v[168:171], v[60:63], v[40:43], v[168:171]
  ds_write_b128 v16, v[232:235] offset:4096
  v_mfma_f32_16x16x32_bf16 v[168:171], v[104:107], v[84:87], v[168:171]
  v_mfma_f32_16x16x32_bf16 v[140:143], v[52:55], v[44:47], v[140:143]
  v_mfma_f32_16x16x32_bf16 v[156:159], v[56:59], v[44:47], v[156:159]
  v_mfma_f32_16x16x32_bf16 v[192:195], v[32:35], v[68:71], v[192:195]
  ds_write_b128 v10, v[204:207] offset:10240
  v_mfma_f32_16x16x32_bf16 v[208:211], v[32:35], v[72:75], v[208:211]
  v_mfma_f32_16x16x32_bf16 v[212:215], v[36:39], v[72:75], v[212:215]
  v_mfma_f32_16x16x32_bf16 v[196:199], v[36:39], v[68:71], v[196:199]
  v_mfma_f32_16x16x32_bf16 v[200:203], v[40:43], v[68:71], v[200:203]
  ds_write_b128 v10, v[220:223] offset:11264
  v_mfma_f32_16x16x32_bf16 v[216:219], v[40:43], v[72:75], v[216:219]
  s_waitcnt lgkmcnt(0)
  s_barrier
  v_mfma_f32_16x16x32_bf16 v[140:143], v[96:99], v[88:91], v[140:143]
  ds_read_b128 v[48:51], v19 offset:0
  ds_read_b128 v[52:55], v20 offset:1024
  v_mfma_f32_16x16x32_bf16 v[156:159], v[100:103], v[88:91], v[156:159]
  ds_read2_b32 v[68:69], v23 offset0:16 offset1:176
  ds_read_b128 v[56:59], v19 offset:2048
  v_mfma_f32_16x16x32_bf16 v[192:195], v[76:79], v[112:115], v[192:195]
  ds_read_b128 v[60:63], v20 offset:3072
  ds_read2_b32 v[70:71], v23 offset0:32 offset1:192
  v_mfma_f32_16x16x32_bf16 v[208:211], v[76:79], v[116:119], v[208:211]
  ds_read2_b32 v[72:73], v23 offset0:48 offset1:208
  ds_read2_b32 v[74:75], v23 offset0:64 offset1:224
  v_mfma_f32_16x16x32_bf16 v[212:215], v[80:83], v[116:119], v[212:215]
  ds_read2_b32 v[66:67], v23 offset0:0 offset1:160
  ds_read_b128 v[32:35], v17 offset:2048
  v_mfma_f32_16x16x32_bf16 v[196:199], v[80:83], v[112:115], v[196:199]
  ds_read_b128 v[36:39], v18 offset:3072
  ds_read_b128 v[40:43], v17 offset:4096
  v_mfma_f32_16x16x32_bf16 v[200:203], v[84:87], v[112:115], v[200:203]
  ds_read_b128 v[44:47], v18 offset:5120
  ds_read_b32 v64, v21 offset:4096
  v_mfma_f32_16x16x32_bf16 v[216:219], v[84:87], v[116:119], v[216:219]
  ds_read_b32 v65, v22 offset:5120
  ds_read2_b32 v[120:121], v25 offset0:0 offset1:16
  s_waitcnt lgkmcnt(11)
  v_pk_fma_f32 v[128:129], v[48:49], v[68:69], v[128:129] op_sel:[0,0,0] op_sel_hi:[1,0,1] neg_lo:[0,1,0] neg_hi:[0,1,0]
  v_pk_fma_f32 v[130:131], v[50:51], v[68:69], v[130:131] op_sel:[0,0,0] op_sel_hi:[1,0,1] neg_lo:[0,1,0] neg_hi:[0,1,0]
  v_pk_fma_f32 v[144:145], v[52:53], v[68:69], v[144:145] op_sel:[0,0,0] op_sel_hi:[1,0,1] neg_lo:[0,1,0] neg_hi:[0,1,0]
  v_pk_fma_f32 v[146:147], v[54:55], v[68:69], v[146:147] op_sel:[0,0,0] op_sel_hi:[1,0,1] neg_lo:[0,1,0] neg_hi:[0,1,0]
  v_cvt_pk_bf16_f32 v128, v128, v129
  v_cvt_pk_bf16_f32 v129, v130, v131
  v_cvt_pk_bf16_f32 v130, v144, v145
  v_cvt_pk_bf16_f32 v131, v146, v147
  ds_read2_b32 v[124:125], v26 offset0:0 offset1:16
  ds_read2_b32 v[122:123], v25 offset0:32 offset1:48
  ds_read2_b32 v[126:127], v26 offset0:32 offset1:48
  v_pk_fma_f32 v[160:161], v[56:57], v[68:69], v[160:161] op_sel:[0,0,0] op_sel_hi:[1,0,1] neg_lo:[0,1,0] neg_hi:[0,1,0]
  v_pk_fma_f32 v[162:163], v[58:59], v[68:69], v[162:163] op_sel:[0,0,0] op_sel_hi:[1,0,1] neg_lo:[0,1,0] neg_hi:[0,1,0]
  v_pk_fma_f32 v[176:177], v[60:61], v[68:69], v[176:177] op_sel:[0,0,0] op_sel_hi:[1,0,1] neg_lo:[0,1,0] neg_hi:[0,1,0]
  v_pk_fma_f32 v[178:179], v[62:63], v[68:69], v[178:179] op_sel:[0,0,0] op_sel_hi:[1,0,1] neg_lo:[0,1,0] neg_hi:[0,1,0]
  v_cvt_pk_bf16_f32 v160, v160, v161
  v_cvt_pk_bf16_f32 v161, v162, v163
  v_cvt_pk_bf16_f32 v162, v176, v177
  v_cvt_pk_bf16_f32 v163, v178, v179
  s_waitcnt lgkmcnt(11)
  ds_read_b128 v[76:79], v24 offset:0
  ds_read_b128 v[96:99], v24 offset:640
  ds_read_b128 v[80:83], v24 offset:64
  v_pk_fma_f32 v[132:133], v[48:49], v[70:71], v[132:133] op_sel:[0,0,0] op_sel_hi:[1,0,1] neg_lo:[0,1,0] neg_hi:[0,1,0]
  v_pk_fma_f32 v[134:135], v[50:51], v[70:71], v[134:135] op_sel:[0,0,0] op_sel_hi:[1,0,1] neg_lo:[0,1,0] neg_hi:[0,1,0]
  v_pk_fma_f32 v[148:149], v[52:53], v[70:71], v[148:149] op_sel:[0,0,0] op_sel_hi:[1,0,1] neg_lo:[0,1,0] neg_hi:[0,1,0]
  v_pk_fma_f32 v[150:151], v[54:55], v[70:71], v[150:151] op_sel:[0,0,0] op_sel_hi:[1,0,1] neg_lo:[0,1,0] neg_hi:[0,1,0]
  v_mfma_f32_16x16x32_bf16 v[144:147], v[160:163], v[128:131], 0
  v_cvt_pk_bf16_f32 v132, v132, v133
  v_cvt_pk_bf16_f32 v133, v134, v135
  v_cvt_pk_bf16_f32 v134, v148, v149
  v_cvt_pk_bf16_f32 v135, v150, v151
  ds_read_b128 v[100:103], v24 offset:704
  ds_read_b128 v[84:87], v24 offset:128
  ds_read_b128 v[104:107], v24 offset:768
  v_pk_fma_f32 v[164:165], v[56:57], v[70:71], v[164:165] op_sel:[0,0,0] op_sel_hi:[1,0,1] neg_lo:[0,1,0] neg_hi:[0,1,0]
  v_pk_fma_f32 v[166:167], v[58:59], v[70:71], v[166:167] op_sel:[0,0,0] op_sel_hi:[1,0,1] neg_lo:[0,1,0] neg_hi:[0,1,0]
  v_pk_fma_f32 v[180:181], v[60:61], v[70:71], v[180:181] op_sel:[0,0,0] op_sel_hi:[1,0,1] neg_lo:[0,1,0] neg_hi:[0,1,0]
  v_pk_fma_f32 v[182:183], v[62:63], v[70:71], v[182:183] op_sel:[0,0,0] op_sel_hi:[1,0,1] neg_lo:[0,1,0] neg_hi:[0,1,0]
  v_mfma_f32_16x16x32_bf16 v[176:179], v[160:163], v[132:135], 0
  v_cvt_pk_bf16_f32 v164, v164, v165
  v_cvt_pk_bf16_f32 v165, v166, v167
  v_cvt_pk_bf16_f32 v166, v180, v181
  v_cvt_pk_bf16_f32 v167, v182, v183
  ds_read_b128 v[88:91], v24 offset:192
  ds_read_b128 v[108:111], v24 offset:832
  ds_read_b128 v[92:95], v24 offset:256
  v_pk_fma_f32 v[136:137], v[48:49], v[72:73], v[136:137] op_sel:[0,0,0] op_sel_hi:[1,0,1] neg_lo:[0,1,0] neg_hi:[0,1,0]
  v_pk_fma_f32 v[138:139], v[50:51], v[72:73], v[138:139] op_sel:[0,0,0] op_sel_hi:[1,0,1] neg_lo:[0,1,0] neg_hi:[0,1,0]
  v_pk_fma_f32 v[152:153], v[52:53], v[72:73], v[152:153] op_sel:[0,0,0] op_sel_hi:[1,0,1] neg_lo:[0,1,0] neg_hi:[0,1,0]
  v_pk_fma_f32 v[154:155], v[54:55], v[72:73], v[154:155] op_sel:[0,0,0] op_sel_hi:[1,0,1] neg_lo:[0,1,0] neg_hi:[0,1,0]
  v_mfma_f32_16x16x32_bf16 v[148:151], v[164:167], v[132:135], 0
  v_cvt_pk_bf16_f32 v136, v136, v137
  v_cvt_pk_bf16_f32 v137, v138, v139
  v_cvt_pk_bf16_f32 v138, v152, v153
  v_cvt_pk_bf16_f32 v139, v154, v155
  ds_read_b128 v[112:115], v24 offset:896
  v_pk_fma_f32 v[168:169], v[56:57], v[72:73], v[168:169] op_sel:[0,0,0] op_sel_hi:[1,0,1] neg_lo:[0,1,0] neg_hi:[0,1,0]
  v_pk_fma_f32 v[170:171], v[58:59], v[72:73], v[170:171] op_sel:[0,0,0] op_sel_hi:[1,0,1] neg_lo:[0,1,0] neg_hi:[0,1,0]
  v_pk_fma_f32 v[184:185], v[60:61], v[72:73], v[184:185] op_sel:[0,0,0] op_sel_hi:[1,0,1] neg_lo:[0,1,0] neg_hi:[0,1,0]
  v_pk_fma_f32 v[186:187], v[62:63], v[72:73], v[186:187] op_sel:[0,0,0] op_sel_hi:[1,0,1] neg_lo:[0,1,0] neg_hi:[0,1,0]
  v_mfma_f32_16x16x32_bf16 v[180:183], v[164:167], v[136:139], 0
  v_cvt_pk_bf16_f32 v168, v168, v169
  v_cvt_pk_bf16_f32 v169, v170, v171
  v_cvt_pk_bf16_f32 v170, v184, v185
  v_cvt_pk_bf16_f32 v171, v186, v187
  v_pk_fma_f32 v[140:141], v[48:49], v[74:75], v[140:141] op_sel:[0,0,0] op_sel_hi:[1,0,1] neg_lo:[0,1,0] neg_hi:[0,1,0]
  v_pk_fma_f32 v[142:143], v[50:51], v[74:75], v[142:143] op_sel:[0,0,0] op_sel_hi:[1,0,1] neg_lo:[0,1,0] neg_hi:[0,1,0]
  v_pk_fma_f32 v[156:157], v[52:53], v[74:75], v[156:157] op_sel:[0,0,0] op_sel_hi:[1,0,1] neg_lo:[0,1,0] neg_hi:[0,1,0]
  v_pk_fma_f32 v[158:159], v[54:55], v[74:75], v[158:159] op_sel:[0,0,0] op_sel_hi:[1,0,1] neg_lo:[0,1,0] neg_hi:[0,1,0]
  v_mfma_f32_16x16x32_bf16 v[152:155], v[168:171], v[136:139], 0
  v_cvt_pk_bf16_f32 v140, v140, v141
  v_cvt_pk_bf16_f32 v141, v142, v143
  v_cvt_pk_bf16_f32 v142, v156, v157
  v_cvt_pk_bf16_f32 v143, v158, v159
  v_pk_fma_f32 v[172:173], v[56:57], v[74:75], v[172:173] op_sel:[0,0,0] op_sel_hi:[1,0,1] neg_lo:[0,1,0] neg_hi:[0,1,0]
  v_pk_fma_f32 v[174:175], v[58:59], v[74:75], v[174:175] op_sel:[0,0,0] op_sel_hi:[1,0,1] neg_lo:[0,1,0] neg_hi:[0,1,0]
  v_pk_fma_f32 v[188:189], v[60:61], v[74:75], v[188:189] op_sel:[0,0,0] op_sel_hi:[1,0,1] neg_lo:[0,1,0] neg_hi:[0,1,0]
  v_pk_fma_f32 v[190:191], v[62:63], v[74:75], v[190:191] op_sel:[0,0,0] op_sel_hi:[1,0,1] neg_lo:[0,1,0] neg_hi:[0,1,0]
  v_mfma_f32_16x16x32_bf16 v[184:187], v[168:171], v[140:143], 0
  v_cvt_pk_bf16_f32 v172, v172, v173
  v_cvt_pk_bf16_f32 v173, v174, v175
  v_cvt_pk_bf16_f32 v174, v188, v189
  v_cvt_pk_bf16_f32 v175, v190, v191
  s_waitcnt lgkmcnt(0)
  v_pk_fma_f32 v[32:33], v[56:57], v[66:67], v[32:33] op_sel:[0,0,0] op_sel_hi:[1,0,1] neg_lo:[0,1,0] neg_hi:[0,1,0]
  v_pk_fma_f32 v[34:35], v[58:59], v[66:67], v[34:35] op_sel:[0,0,0] op_sel_hi:[1,0,1] neg_lo:[0,1,0] neg_hi:[0,1,0]
  v_pk_fma_f32 v[36:37], v[60:61], v[66:67], v[36:37] op_sel:[0,0,0] op_sel_hi:[1,0,1] neg_lo:[0,1,0] neg_hi:[0,1,0]
  v_pk_fma_f32 v[38:39], v[62:63], v[66:67], v[38:39] op_sel:[0,0,0] op_sel_hi:[1,0,1] neg_lo:[0,1,0] neg_hi:[0,1,0]
  v_mfma_f32_16x16x32_bf16 v[156:159], v[172:175], v[140:143], 0
  v_cvt_pk_bf16_f32 v32, v32, v33
  v_cvt_pk_bf16_f32 v33, v34, v35
  v_cvt_pk_bf16_f32 v34, v36, v37
  v_cvt_pk_bf16_f32 v35, v38, v39
  v_mul_f32 v69, 0x3e8293ee, v69
  v_mul_f32 v71, 0x3e8293ee, v71
  v_mfma_f32_16x16x32_bf16 v[188:191], v[32:35], v[128:131], 0
  v_mul_f32 v73, 0x3e8293ee, v73
  v_mul_f32 v75, 0x3e8293ee, v75
  v_mul_f32 v120, v120, v69
  v_mul_f32 v124, v124, v69
  v_mul_f32 v121, v121, v71
  v_mul_f32 v125, v125, v71
  v_mul_f32 v122, v122, v73
  v_mul_f32 v126, v126, v73
  v_mul_f32 v123, v123, v75
  v_mul_f32 v127, v127, v75
  v_pk_fma_f32 v[40:41], v[76:77], v[64:65], v[40:41] op_sel:[0,0,0] op_sel_hi:[1,0,1] neg_lo:[1,0,0] neg_hi:[1,0,0]
  v_pk_fma_f32 v[42:43], v[78:79], v[64:65], v[42:43] op_sel:[0,0,0] op_sel_hi:[1,0,1] neg_lo:[1,0,0] neg_hi:[1,0,0]
  v_pk_mul_f32 v[40:41], v[40:41], v[96:97]
  v_pk_mul_f32 v[42:43], v[42:43], v[98:99]
  v_cvt_pk_bf16_f32 v4, v40, v41
  v_cvt_pk_bf16_f32 v5, v42, v43
  v_pk_fma_f32 v[192:193], v[80:81], v[64:65], v[192:193] op_sel:[0,0,0] op_sel_hi:[1,0,1] neg_lo:[1,0,0] neg_hi:[1,0,0]
  v_pk_fma_f32 v[194:195], v[82:83], v[64:65], v[194:195] op_sel:[0,0,0] op_sel_hi:[1,0,1] neg_lo:[1,0,0] neg_hi:[1,0,0]
  v_pk_mul_f32 v[192:193], v[192:193], v[100:101]
  v_pk_mul_f32 v[194:195], v[194:195], v[102:103]
  v_cvt_pk_bf16_f32 v6, v192, v193
  v_cvt_pk_bf16_f32 v7, v194, v195
  v_pk_fma_f32 v[196:197], v[84:85], v[64:65], v[196:197] op_sel:[0,0,0] op_sel_hi:[1,0,1] neg_lo:[1,0,0] neg_hi:[1,0,0]
  v_pk_fma_f32 v[198:199], v[86:87], v[64:65], v[198:199] op_sel:[0,0,0] op_sel_hi:[1,0,1] neg_lo:[1,0,0] neg_hi:[1,0,0]
  v_pk_mul_f32 v[196:197], v[196:197], v[104:105]
  v_pk_mul_f32 v[198:199], v[198:199], v[106:107]
  v_cvt_pk_bf16_f32 v8, v196, v197
  v_cvt_pk_bf16_f32 v9, v198, v199
  v_pk_fma_f32 v[200:201], v[88:89], v[64:65], v[200:201] op_sel:[0,0,0] op_sel_hi:[1,0,1] neg_lo:[1,0,0] neg_hi:[1,0,0]
  v_pk_fma_f32 v[202:203], v[90:91], v[64:65], v[202:203] op_sel:[0,0,0] op_sel_hi:[1,0,1] neg_lo:[1,0,0] neg_hi:[1,0,0]
  v_pk_mul_f32 v[200:201], v[200:201], v[108:109]
  v_pk_mul_f32 v[202:203], v[202:203], v[110:111]
  v_cvt_pk_bf16_f32 v10, v200, v201
  v_cvt_pk_bf16_f32 v11, v202, v203
  v_pk_fma_f32 v[204:205], v[92:93], v[64:65], v[204:205] op_sel:[0,0,0] op_sel_hi:[1,0,1] neg_lo:[1,0,0] neg_hi:[1,0,0]
  v_pk_fma_f32 v[206:207], v[94:95], v[64:65], v[206:207] op_sel:[0,0,0] op_sel_hi:[1,0,1] neg_lo:[1,0,0] neg_hi:[1,0,0]
  v_pk_mul_f32 v[204:205], v[204:205], v[112:113]
  v_pk_mul_f32 v[206:207], v[206:207], v[114:115]
  v_cvt_pk_bf16_f32 v12, v204, v205
  v_cvt_pk_bf16_f32 v13, v206, v207
  v_pk_fma_f32 v[44:45], v[76:77], v[64:65], v[44:45] op_sel:[0,1,0] op_sel_hi:[1,1,1] neg_lo:[1,0,0] neg_hi:[1,0,0]
  v_pk_fma_f32 v[46:47], v[78:79], v[64:65], v[46:47] op_sel:[0,1,0] op_sel_hi:[1,1,1] neg_lo:[1,0,0] neg_hi:[1,0,0]
  v_pk_mul_f32 v[44:45], v[44:45], v[96:97]
  v_pk_mul_f32 v[46:47], v[46:47], v[98:99]
  v_cvt_pk_bf16_f32 v224, v44, v45
  v_cvt_pk_bf16_f32 v225, v46, v47
  v_pk_fma_f32 v[208:209], v[80:81], v[64:65], v[208:209] op_sel:[0,1,0] op_sel_hi:[1,1,1] neg_lo:[1,0,0] neg_hi:[1,0,0]
  v_pk_fma_f32 v[210:211], v[82:83], v[64:65], v[210:211] op_sel:[0,1,0] op_sel_hi:[1,1,1] neg_lo:[1,0,0] neg_hi:[1,0,0]
  v_pk_mul_f32 v[208:209], v[208:209], v[100:101]
  v_pk_mul_f32 v[210:211], v[210:211], v[102:103]
  v_cvt_pk_bf16_f32 v226, v208, v209
  v_cvt_pk_bf16_f32 v227, v210, v211
  v_pk_fma_f32 v[212:213], v[84:85], v[64:65], v[212:213] op_sel:[0,1,0] op_sel_hi:[1,1,1] neg_lo:[1,0,0] neg_hi:[1,0,0]
  v_pk_fma_f32 v[214:215], v[86:87], v[64:65], v[214:215] op_sel:[0,1,0] op_sel_hi:[1,1,1] neg_lo:[1,0,0] neg_hi:[1,0,0]
  v_pk_mul_f32 v[212:213], v[212:213], v[104:105]
  v_pk_mul_f32 v[214:215], v[214:215], v[106:107]
  v_cvt_pk_bf16_f32 v228, v212, v213
  v_cvt_pk_bf16_f32 v229, v214, v215
  v_cndmask_b32 v148, v148, v149, s[48:49]
  v_cndmask_b32 v176, v176, v177, s[48:49]
  v_cndmask_b32 v150, v150, v151, s[48:49]
  v_cndmask_b32 v178, v178, v179, s[48:49]
  v_cndmask_b32 v36, v148, v176, s[50:51]
  v_cndmask_b32 v37, v150, v178, s[52:53]
  v_mul_f32 v36, v36, v121
  v_mul_f32 v37, v37, v125
  v_cndmask_b32 v152, v152, v153, s[48:49]
  v_cndmask_b32 v180, v180, v181, s[48:49]
  v_cndmask_b32 v154, v154, v155, s[48:49]
  v_cndmask_b32 v182, v182, v183, s[48:49]
  v_cndmask_b32 v40, v152, v180, s[50:51]
  v_cndmask_b32 v41, v154, v182, s[52:53]
  v_mul_f32 v40, v40, v122
  v_mul_f32 v41, v41, v126
  v_cndmask_b32 v156, v156, v157, s[48:49]
  v_cndmask_b32 v184, v184, v185, s[48:49]
  v_cndmask_b32 v158, v158, v159, s[48:49]
  v_cndmask_b32 v186, v186, v187, s[48:49]
  v_cndmask_b32 v44, v156, v184, s[50:51]
  v_cndmask_b32 v45, v158, v186, s[52:53]
  v_mul_f32 v44, v44, v123
  v_mul_f32 v45, v45, v127
  v_cndmask_b32 v144, v144, v145, s[48:49]
  v_cndmask_b32 v188, v188, v189, s[48:49]
  v_cndmask_b32 v146, v146, v147, s[48:49]
  v_cndmask_b32 v190, v190, v191, s[48:49]
  v_cndmask_b32 v32, v144, v188, s[50:51]
  v_cndmask_b32 v33, v146, v190, s[52:53]
  v_mul_f32 v32, v32, v120
  v_mul_f32 v33, v33, v124
  v_mov_b32 v48, 0xceabfb8f
  v_cndmask_b32 v32, v32, v48, s[54:55]
  v_cndmask_b32 v33, v33, v48, s[14:15]
  v_max_f32 v42, v40, v41
  v_max_f32 v46, v44, v45
  v_max_f32 v38, v36, v37
  v_max_f32 v34, v32, v33
  v_permlane32_swap_b32 v42, v46
  v_pk_fma_f32 v[216:217], v[88:89], v[64:65], v[216:217] op_sel:[0,1,0] op_sel_hi:[1,1,1] neg_lo:[1,0,0] neg_hi:[1,0,0]
  v_permlane32_swap_b32 v34, v38
  v_max_f32 v42, v42, v46
  v_max_f32 v34, v34, v38
  v_pk_fma_f32 v[218:219], v[90:91], v[64:65], v[218:219] op_sel:[0,1,0] op_sel_hi:[1,1,1] neg_lo:[1,0,0] neg_hi:[1,0,0]
  v_pk_mul_f32 v[216:217], v[216:217], v[108:109]
  v_permlane16_swap_b32 v34, v42
  v_pk_mul_f32 v[218:219], v[218:219], v[110:111]
  v_max_f32 v38, v34, v42
  v_max_f32 v46, v34, v42
  v_cvt_pk_bf16_f32 v230, v216, v217
  v_cvt_pk_bf16_f32 v231, v218, v219
  v_permlane16_swap_b32 v38, v46
  v_pk_fma_f32 v[220:221], v[92:93], v[64:65], v[220:221] op_sel:[0,1,0] op_sel_hi:[1,1,1] neg_lo:[1,0,0] neg_hi:[1,0,0]
  v_mov_b32 v34, v38
  v_mov_b32 v42, v46
  v_pk_fma_f32 v[222:223], v[94:95], v[64:65], v[222:223] op_sel:[0,1,0] op_sel_hi:[1,1,1] neg_lo:[1,0,0] neg_hi:[1,0,0]
  v_permlane32_swap_b32 v34, v38
  v_permlane32_swap_b32 v42, v46
  v_pk_mul_f32 v[220:221], v[220:221], v[112:113]
  v_pk_mul_f32 v[222:223], v[222:223], v[114:115]
  v_cvt_pk_bf16_f32 v232, v220, v221
  v_cvt_pk_bf16_f32 v233, v222, v223
  v_sub_f32 v32, v32, v34
  v_sub_f32 v33, v33, v34
  v_exp_f32 v32, v32
  v_exp_f32 v33, v33
  s_nop 0
  v_cvt_pk_bf16_f32 v32, v32, v32
  v_cvt_pk_bf16_f32 v33, v33, v33
  v_and_b32 v128, v32, v27
  v_and_b32 v129, v33, v29
  v_and_b32 v130, v32, v28
  v_and_b32 v131, v33, v30
  v_sub_f32 v36, v36, v38
  v_sub_f32 v37, v37, v38
  v_mfma_f32_16x16x32_bf16 v[144:147], v[236:239], v[128:131], 0
  v_exp_f32 v36, v36
  v_exp_f32 v37, v37
  v_mfma_f32_16x16x32_bf16 v[192:195], v[4:7], v[128:131], 0
  v_cvt_pk_bf16_f32 v36, v36, v36
  v_cvt_pk_bf16_f32 v37, v37, v37
  v_and_b32 v132, v36, v27
  v_mfma_f32_16x16x32_bf16 v[208:211], v[224:227], v[128:131], 0
  v_and_b32 v133, v37, v29
  v_and_b32 v134, v36, v28
  v_and_b32 v135, v37, v30
  v_sub_f32 v40, v40, v42
  v_sub_f32 v41, v41, v42
  v_mfma_f32_16x16x32_bf16 v[148:151], v[236:239], v[132:135], 0
  v_exp_f32 v40, v40
  v_exp_f32 v41, v41
  v_mfma_f32_16x16x32_bf16 v[196:199], v[6:9], v[132:135], 0
  v_cvt_pk_bf16_f32 v40, v40, v40
  v_cvt_pk_bf16_f32 v41, v41, v41
  v_and_b32 v136, v40, v27
  v_mfma_f32_16x16x32_bf16 v[212:215], v[226:229], v[132:135], 0
  v_and_b32 v137, v41, v29
  v_and_b32 v138, v40, v28
  v_and_b32 v139, v41, v30
  v_sub_f32 v44, v44, v46
  v_sub_f32 v45, v45, v46
  v_mfma_f32_16x16x32_bf16 v[152:155], v[236:239], v[136:139], 0
  v_exp_f32 v44, v44
  v_exp_f32 v45, v45
  v_mfma_f32_16x16x32_bf16 v[200:203], v[8:11], v[136:139], 0
  v_cvt_pk_bf16_f32 v44, v44, v44
  v_cvt_pk_bf16_f32 v45, v45, v45
  v_and_b32 v140, v44, v27
  v_mfma_f32_16x16x32_bf16 v[216:219], v[228:231], v[136:139], 0
  v_and_b32 v141, v45, v29
  v_and_b32 v142, v44, v28
  v_and_b32 v143, v45, v30
  v_rcp_f32 v144, v144
  s_cmp_eq_u32 s71, 1
  v_mfma_f32_16x16x32_bf16 v[156:159], v[236:239], v[140:143], 0
  v_rcp_f32 v148, v148
  v_mfma_f32_16x16x32_bf16 v[204:207], v[10:13], v[140:143], 0
  v_rcp_f32 v152, v152
  v_mfma_f32_16x16x32_bf16 v[220:223], v[230:233], v[140:143], 0
  s_cbranch_scc1 L_attn_out1
  s_mov_b32 s3, 0
  v_pk_mul_f32 v[192:193], v[192:193], v[144:145] op_sel_hi:[1,0]
  v_pk_mul_f32 v[194:195], v[194:195], v[144:145] op_sel_hi:[1,0]
  v_pk_mul_f32 v[208:209], v[208:209], v[144:145] op_sel_hi:[1,0]
  v_pk_mul_f32 v[210:211], v[210:211], v[144:145] op_sel_hi:[1,0]
  v_cvt_pk_bf16_f32 v48, v192, v193
  v_cvt_pk_bf16_f32 v49, v194, v195
  v_cvt_pk_bf16_f32 v50, v208, v209
  v_cvt_pk_bf16_f32 v51, v210, v211
  buffer_store_dwordx4 v[48:51], v31, s[44:47], s3 offen sc1
  v_rcp_f32 v156, v156
  s_mov_b32 s3, 114688
  v_pk_mul_f32 v[196:197], v[196:197], v[148:149] op_sel_hi:[1,0]
  v_pk_mul_f32 v[198:199], v[198:199], v[148:149] op_sel_hi:[1,0]
  v_pk_mul_f32 v[212:213], v[212:213], v[148:149] op_sel_hi:[1,0]
  v_pk_mul_f32 v[214:215], v[214:215], v[148:149] op_sel_hi:[1,0]
  v_cvt_pk_bf16_f32 v52, v196, v197
  v_cvt_pk_bf16_f32 v53, v198, v199
  v_cvt_pk_bf16_f32 v54, v212, v213
  v_cvt_pk_bf16_f32 v55, v214, v215
  buffer_store_dwordx4 v[52:55], v31, s[44:47], s3 offen sc1
  s_mov_b32 s3, 229376
  v_pk_mul_f32 v[200:201], v[200:201], v[152:153] op_sel_hi:[1,0]
  v_pk_mul_f32 v[202:203], v[202:203], v[152:153] op_sel_hi:[1,0]
  v_pk_mul_f32 v[216:217], v[216:217], v[152:153] op_sel_hi:[1,0]
  v_pk_mul_f32 v[218:219], v[218:219], v[152:153] op_sel_hi:[1,0]
  v_cvt_pk_bf16_f32 v56, v200, v201
  v_cvt_pk_bf16_f32 v57, v202, v203
  v_cvt_pk_bf16_f32 v58, v216, v217
  v_cvt_pk_bf16_f32 v59, v218, v219
  buffer_store_dwordx4 v[56:59], v31, s[44:47], s3 offen sc1
  s_mov_b32 s3, 344064
  v_pk_mul_f32 v[204:205], v[204:205], v[156:157] op_sel_hi:[1,0]
  v_pk_mul_f32 v[206:207], v[206:207], v[156:157] op_sel_hi:[1,0]
  v_pk_mul_f32 v[220:221], v[220:221], v[156:157] op_sel_hi:[1,0]
  v_pk_mul_f32 v[222:223], v[222:223], v[156:157] op_sel_hi:[1,0]
  v_cvt_pk_bf16_f32 v60, v204, v205
  v_cvt_pk_bf16_f32 v61, v206, v207
  v_cvt_pk_bf16_f32 v62, v220, v221
  v_cvt_pk_bf16_f32 v63, v222, v223
  buffer_store_dwordx4 v[60:63], v31, s[44:47], s3 offen sc1
  s_branch L_attn_out2
L_attn_out1:
  s_mov_b32 s3, 0
  v_pk_mul_f32 v[192:193], v[192:193], v[144:145] op_sel_hi:[1,0]
  v_pk_mul_f32 v[194:195], v[194:195], v[144:145] op_sel_hi:[1,0]
  v_pk_mul_f32 v[208:209], v[208:209], v[144:145] op_sel_hi:[1,0]
  v_pk_mul_f32 v[210:211], v[210:211], v[144:145] op_sel_hi:[1,0]
  v_cvt_pk_bf16_f32 v50, v192, v193
  v_cvt_pk_bf16_f32 v51, v194, v195
  v_cvt_pk_bf16_f32 v48, v208, v209
  v_cvt_pk_bf16_f32 v49, v210, v211
  buffer_store_dwordx4 v[48:51], v31, s[44:47], s3 offen sc1
  v_rcp_f32 v156, v156
  s_mov_b32 s3, 114688
  v_pk_mul_f32 v[196:197], v[196:197], v[148:149] op_sel_hi:[1,0]
  v_pk_mul_f32 v[198:199], v[198:199], v[148:149] op_sel_hi:[1,0]
  v_pk_mul_f32 v[212:213], v[212:213], v[148:149] op_sel_hi:[1,0]
  v_pk_mul_f32 v[214:215], v[214:215], v[148:149] op_sel_hi:[1,0]
  v_cvt_pk_bf16_f32 v54, v196, v197
  v_cvt_pk_bf16_f32 v55, v198, v199
  v_cvt_pk_bf16_f32 v52, v212, v213
  v_cvt_pk_bf16_f32 v53, v214, v215
  buffer_store_dwordx4 v[52:55], v31, s[44:47], s3 offen sc1
  s_mov_b32 s3, 229376
  v_pk_mul_f32 v[200:201], v[200:201], v[152:153] op_sel_hi:[1,0]
  v_pk_mul_f32 v[202:203], v[202:203], v[152:153] op_sel_hi:[1,0]
  v_pk_mul_f32 v[216:217], v[216:217], v[152:153] op_sel_hi:[1,0]
  v_pk_mul_f32 v[218:219], v[218:219], v[152:153] op_sel_hi:[1,0]
  v_cvt_pk_bf16_f32 v58, v200, v201
  v_cvt_pk_bf16_f32 v59, v202, v203
  v_cvt_pk_bf16_f32 v56, v216, v217
  v_cvt_pk_bf16_f32 v57, v218, v219
  buffer_store_dwordx4 v[56:59], v31, s[44:47], s3 offen sc1
  s_mov_b32 s3, 344064
  v_pk_mul_f32 v[204:205], v[204:205], v[156:157] op_sel_hi:[1,0]
  v_pk_mul_f32 v[206:207], v[206:207], v[156:157] op_sel_hi:[1,0]
  v_pk_mul_f32 v[220:221], v[220:221], v[156:157] op_sel_hi:[1,0]
  v_pk_mul_f32 v[222:223], v[222:223], v[156:157] op_sel_hi:[1,0]
  v_cvt_pk_bf16_f32 v62, v204, v205
  v_cvt_pk_bf16_f32 v63, v206, v207
  v_cvt_pk_bf16_f32 v60, v220, v221
  v_cvt_pk_bf16_f32 v61, v222, v223
  buffer_store_dwordx4 v[60:63], v31, s[44:47], s3 offen sc1
L_attn_out2:
  s_waitcnt vmcnt(0) lgkmcnt(0)
  s_barrier
  s_add_u32 s97, s97, 1
  s_branch L_wo_body
.section .rodata,"a"
.p2align 6
.amdhsa_kernel interleave_layers__sliding_local_dilated__dense_activation_gelu__prompt_kernel
  .amdhsa_next_free_vgpr 256
  .amdhsa_next_free_sgpr 102
  .amdhsa_accum_offset 256
  .amdhsa_group_segment_fixed_size 0
  .amdhsa_kernarg_size 88
  .amdhsa_user_sgpr_count 2
  .amdhsa_user_sgpr_kernarg_segment_ptr 1
  .amdhsa_system_sgpr_workgroup_id_x 1
  .amdhsa_float_denorm_mode_32 3
  .amdhsa_float_denorm_mode_16_64 3
.end_amdhsa_kernel
.text
L_attn_c1:
L_wo_c0:
L_wo_body:
  s_cmp_ge_u32 s2, 256
  s_cbranch_scc1 L_wo_end
  v_lshrrev_b32 v2, 6, v0
  v_and_b32 v1, 63, v0
  v_readfirstlane_b32 s70, v2
  s_and_b32 s3, s2, 7
  s_lshr_b32 s99, s2, 3
  s_and_b32 s5, s3, 3
  s_lshl_b32 s5, s5, 2
  s_and_b32 s6, s99, 3
  s_add_u32 s68, s5, s6
  s_lshr_b32 s5, s3, 2
  s_lshr_b32 s78, s99, 2
  s_lshl1_add_u32 s69, s78, s5
  s_add_u32 s3, s68, s78
  s_lshl_b32 s3, s3, 3
  s_lshl_b32 s85, 0xffff02, s3
  s_sub_u32 s3, 0, s3
  s_lshr_b32 s3, 0xffff02, s3
  s_or_b32 s85, s85, s3
  s_cmp_lt_u32 s70, 4
  s_cbranch_scc1 L_wo_compute
L_wo_loader:
  s_add_u32 s3, s96, s70
  s_cmp_lg_u32 s3, 4
  s_cbranch_scc1 L_wo_chk0
  s_load_dwordx2 s[64:65], s[0:1], 72
  s_waitcnt lgkmcnt(0)
  s_and_b32 s65, s65, 0xffff
  s_mov_b32 s66, 256
  s_mov_b32 s67, 0x00020000
  v_lshlrev_b32 v17, 2, v1
  buffer_load_dword v12, v17, s[64:67], 0 offen sc1
L_wo_chk0:
  v_and_b32 v2, 3, v1
  v_lshlrev_b32 v2, 3, v2
  v_bfe_i32 v16, s85, v2, 8
  s_and_b32 s3, s68, 3
  s_mul_i32 s4, s3, 4
  v_add3_u32 v3, v16, v1, s4
  v_and_b32 v3, 15, v3
  v_lshlrev_b32 v16, 17, v3
  s_add_u32 s9, s70, s68
  s_and_b32 s9, s9, 3
  s_lshl_b32 s77, s9, 11
  v_and_b32 v10, 7, v1
  v_lshrrev_b32 v3, 3, v1
  s_lshl_b32 s10, s9, 4
  v_add_u32 v3, s10, v3
  v_mul_u32_u24 v3, 2048, v3
  v_lshrrev_b32 v2, 3, v1
  v_and_b32 v2, 6, v2
  v_xor_b32 v2, v2, v10
  s_lshl_b32 s10, s69, 7
  v_add_u32 v3, s10, v3
  v_lshl_add_u32 v8, v2, 4, v3
  v_add_u32 v3, 16384, v3
  v_lshl_add_u32 v9, v2, 4, v3
  s_mov_b32 s40, s20
  s_and_b32 s41, s21, 0xffff
  s_mov_b32 s42, 2097152
  s_mov_b32 s43, 0x00020000
  v_readlane_b32 s74, v16, 0
  s_add_u32 m0, s77, 28672
  s_add_u32 s4, s74, 0
  buffer_load_dwordx4 v8, s[40:43], s4 offen lds
  s_add_u32 m0, s77, 29696
  s_nop 0
  buffer_load_dwordx4 v9, s[40:43], s4 offen lds
  v_readlane_b32 s74, v16, 1
  s_add_u32 m0, s77, 36864
  s_add_u32 s4, s74, 0
  buffer_load_dwordx4 v8, s[40:43], s4 offen lds
  s_add_u32 m0, s77, 37888
  s_nop 0
  buffer_load_dwordx4 v9, s[40:43], s4 offen lds
  v_readlane_b32 s74, v16, 2
  s_add_u32 m0, s77, 45056
  s_add_u32 s4, s74, 0
  buffer_load_dwordx4 v8, s[40:43], s4 offen lds
  s_add_u32 m0, s77, 46080
  s_nop 0
  buffer_load_dwordx4 v9, s[40:43], s4 offen lds
  v_readlane_b32 s74, v16, 3
  s_add_u32 m0, s77, 53248
  s_add_u32 s4, s74, 0
  buffer_load_dwordx4 v8, s[40:43], s4 offen lds
  s_add_u32 m0, s77, 54272
  s_nop 0
  buffer_load_dwordx4 v9, s[40:43], s4 offen lds
  v_readlane_b32 s74, v16, 4
  s_add_u32 m0, s77, 61440
  s_add_u32 s4, s74, 0
  buffer_load_dwordx4 v8, s[40:43], s4 offen lds
  s_add_u32 m0, s77, 62464
  s_nop 0
  buffer_load_dwordx4 v9, s[40:43], s4 offen lds
  v_readlane_b32 s74, v16, 5
  s_add_u32 m0, s77, 69632
  s_add_u32 s4, s74, 0
  buffer_load_dwordx4 v8, s[40:43], s4 offen lds
  s_add_u32 m0, s77, 70656
  s_nop 0
  buffer_load_dwordx4 v9, s[40:43], s4 offen lds
  s_waitcnt vmcnt(12)
  s_add_u32 s3, s96, s70
  s_cmp_lg_u32 s3, 4
  s_cbranch_scc1 L_wo_chk1
  v_cmp_ne_u32 vcc, 0x01010101, v12
  s_cbranch_vccz L_wo_chk1
  s_load_dwordx2 s[64:65], s[0:1], 72
  s_waitcnt lgkmcnt(0)
  s_and_b32 s65, s65, 0xffff
  s_mov_b32 s66, 256
  s_mov_b32 s67, 0x00020000
  v_lshlrev_b32 v17, 2, v1
  s_mov_b32 s79, 0x100000
L_wo_chkl:
  buffer_load_dword v12, v17, s[64:67], 0 offen sc1
  s_sub_u32 s79, s79, 1
  s_cbranch_scc1 L_wo_chk1
  s_waitcnt vmcnt(0)
  v_cmp_ne_u32 vcc, 0x01010101, v12
  s_cbranch_vccnz L_wo_chkl
L_wo_chk1:
  s_waitcnt vmcnt(12)
  s_add_u32 s44, s22, 41943040
  s_addc_u32 s45, s23, 0
  s_and_b32 s45, s45, 0xffff
  s_mov_b32 s46, 524288
  s_mov_b32 s47, 0x00020000
  s_lshl4_add_u32 s3, s97, s68
  s_and_b32 s4, s69, 15
  s_lshl4_add_u32 s3, s3, s4
  s_lshl_b32 s3, s3, 7
  s_sub_u32 s3, s3, 32768
  v_lshlrev_b32 v11, 7, v1
  v_and_b32 v2, 15, v1
  v_lshlrev_b32 v2, 2, v2
  v_mov_b32 v3, 1
  s_mov_b32 s79, 0x100000
  s_cmp_lg_u32 s70, 4
  s_barrier
  s_cbranch_scc1 L_wo_nofl
  s_mov_b32 exec_lo, 0xffff
  s_mov_b32 exec_hi, 0
  buffer_store_dword v3, v11, s[44:47], s87 offen sc1
  s_mov_b64 exec, -1
L_wo_nofl:
  s_mov_b32 s5, s3
  v_readlane_b32 s74, v16, 6
  s_add_u32 m0, s77, 77824
  s_add_u32 s4, s74, 0
  buffer_load_dwordx4 v8, s[40:43], s4 offen lds
  s_add_u32 m0, s77, 78848
  s_nop 0
  buffer_load_dwordx4 v9, s[40:43], s4 offen lds
  v_readlane_b32 s74, v16, 7
  s_add_u32 m0, s77, 86016
  s_add_u32 s4, s74, 0
  buffer_load_dwordx4 v8, s[40:43], s4 offen lds
  s_add_u32 m0, s77, 87040
  s_nop 0
  buffer_load_dwordx4 v9, s[40:43], s4 offen lds
  v_readlane_b32 s74, v16, 8
  s_add_u32 m0, s77, 94208
  s_add_u32 s4, s74, 0
  buffer_load_dwordx4 v8, s[40:43], s4 offen lds
  s_add_u32 m0, s77, 95232
  s_nop 0
  buffer_load_dwordx4 v9, s[40:43], s4 offen lds
  v_readlane_b32 s74, v16, 9
  s_add_u32 m0, s77, 102400
  s_add_u32 s4, s74, 0
  buffer_load_dwordx4 v8, s[40:43], s4 offen lds
  s_add_u32 m0, s77, 103424
  s_nop 0
  buffer_load_dwordx4 v9, s[40:43], s4 offen lds
  v_readlane_b32 s74, v16, 10
  s_add_u32 m0, s77, 110592
  s_add_u32 s4, s74, 0
  buffer_load_dwordx4 v8, s[40:43], s4 offen lds
  s_add_u32 m0, s77, 111616
  s_nop 0
  buffer_load_dwordx4 v9, s[40:43], s4 offen lds
  v_readlane_b32 s74, v16, 11
  s_add_u32 m0, s77, 118784
  s_add_u32 s4, s74, 0
  buffer_load_dwordx4 v8, s[40:43], s4 offen lds
  s_add_u32 m0, s77, 119808
  s_nop 0
  buffer_load_dwordx4 v9, s[40:43], s4 offen lds
  v_readlane_b32 s74, v16, 12
  s_add_u32 m0, s77, 131072
  s_add_u32 s4, s74, 0
  buffer_load_dwordx4 v8, s[40:43], s4 offen lds
  s_add_u32 m0, s77, 132096
  s_nop 0
  buffer_load_dwordx4 v9, s[40:43], s4 offen lds
  v_readlane_b32 s74, v16, 13
  s_add_u32 m0, s77, 139264
  s_add_u32 s4, s74, 0
  buffer_load_dwordx4 v8, s[40:43], s4 offen lds
  s_add_u32 m0, s77, 140288
  s_nop 0
  buffer_load_dwordx4 v9, s[40:43], s4 offen lds
  v_readlane_b32 s74, v16, 14
  s_add_u32 m0, s77, 147456
  s_add_u32 s4, s74, 0
  buffer_load_dwordx4 v8, s[40:43], s4 offen lds
  s_add_u32 m0, s77, 148480
  s_nop 0
  buffer_load_dwordx4 v9, s[40:43], s4 offen lds
  v_readlane_b32 s74, v16, 15
  s_add_u32 m0, s77, 155648
  s_add_u32 s4, s74, 0
  buffer_load_dwordx4 v8, s[40:43], s4 offen lds
  s_add_u32 m0, s77, 156672
  s_nop 0
  buffer_load_dwordx4 v9, s[40:43], s4 offen lds
  s_mov_b32 s3, s5
  s_cmp_lg_u32 s70, 4
  s_cbranch_scc1 L_wo_dep
L_wo_poll:
  buffer_load_dword v3, v2, s[44:47], s3 offen sc1
  s_sub_u32 s79, s79, 1
  s_cbranch_scc1 L_wo_dep
  s_waitcnt vmcnt(0)
  v_cmp_ne_u32 vcc, 1, v3
  s_cbranch_vccnz L_wo_poll
L_wo_dep:
  s_waitcnt vmcnt(20) lgkmcnt(0)
  s_barrier
  s_waitcnt vmcnt(2)
  s_barrier
  s_lshl_b32 s87, s97, 15
  s_lshl_b32 s4, s68, 11
  s_add_u32 s87, s87, s4
  s_lshl_b32 s4, s69, 2
  s_add_u32 s87, s87, s4
  s_add_u32 s97, s97, 1
  s_branch L_w1_body
L_wo_end:
  s_endpgm
L_wo_compute:
  v_and_b32 v2, 3, v1
  v_lshlrev_b32 v2, 3, v2
  v_bfe_i32 v15, s85, v2, 8
  s_and_b32 s3, s68, 3
  s_mul_i32 s4, s3, 4
  v_add3_u32 v3, v15, v1, s4
  v_and_b32 v3, 15, v3
  v_lshlrev_b32 v15, 12, v3
  v_and_b32 v3, 15, v1
  v_lshrrev_b32 v2, 4, v1
  s_lshl_b32 s8, s68, 7
  s_lshl_b32 s9, s70, 5
  s_add_u32 s8, s8, s9
  s_mul_i32 s9, s8, 7168
  v_add_u32 v13, s8, v3
  s_lshl_b32 s10, s69, 7
  v_lshl_add_u32 v14, v2, 3, s10
  v_and_b32 v16, 1, v2
  v_lshrrev_b32 v17, 1, v2
  v_lshlrev_b32 v16, 4, v1
  s_add_u32 s9, s8, s69
  s_lshl_b32 s9, s9, 11
  v_add_u32 v12, s9, v16
  s_lshl_b32 s9, s70, 12
  v_add_u32 v19, s9, v16
  v_bfe_u32 v16, v1, 2, 2
  v_xor_b32 v16, v16, v2
  v_lshl_add_u32 v18, v16, 17, v13
  s_lshl_b32 s10, s69, 14
  v_lshl_add_u32 v18, v18, 3, s10
  v_lshrrev_b32 v6, 2, v1
  v_lshlrev_b32 v6, 7, v6
  v_and_b32 v17, 3, v1
  v_lshl_add_u32 v6, v17, 3, v6
  v_bfe_u32 v17, v1, 3, 2
  v_lshl_add_u32 v6, v17, 5, v6
  v_xor_b32 v7, 32, v6
  v_xor_b32 v8, 64, v6
  v_xor_b32 v9, 96, v6
  s_mov_b32 s11, 0xffff0000
  s_add_u32 s36, s34, 8439808
  s_addc_u32 s37, s35, 0
  s_and_b32 s37, s37, 0xffff
  s_mov_b32 s38, 4194304
  s_mov_b32 s39, 0x00020000
  s_add_u32 s44, s34, 4194304
  s_addc_u32 s45, s35, 0
  s_and_b32 s45, s45, 0xffff
  s_mov_b32 s46, 4194304
  s_mov_b32 s47, 0x00020000
  s_add_u32 s56, s34, 24117248
  s_addc_u32 s57, s35, 0
  s_and_b32 s57, s57, 0xffff
  s_mov_b32 s58, 262144
  s_mov_b32 s59, 0x00020000
  s_mul_i32 s9, s8, 7168
  s_add_u32 s36, s36, s9
  s_addc_u32 s37, s37, 0x100000
  s_add_u32 s64, s36, 114688
  s_addc_u32 s65, s37, 0
  s_mov_b32 s38, 63488
  s_mov_b32 s39, 0x00800000
  s_mov_b32 s66, 63488
  s_mov_b32 s67, 0x00800000
  s_cmp_lg_u32 s96, 0
  s_cbranch_scc1 L_pfc2_skip
  s_getpc_b64 s[4:5]
L_pfc2:
  s_lshl_b32 s3, s99, 2
  s_add_u32 s3, s3, s70
  s_mul_i32 s3, s3, 128
  s_min_u32 s3, s3, L_w1_c1-L_w1_c0-128
  s_add_i32 s3, s3, L_w1_c0-L_pfc2
  s_ashr_i32 s6, s3, 31
  s_add_u32 s4, s4, s3
  s_addc_u32 s5, s5, s6
  s_load_dword s40, s[4:5], 0
  s_load_dword s40, s[4:5], 64
L_pfc2_skip:
  v_add_u32 v26, 155648, v6
  v_add_u32 v27, 155648, v7
  v_add_u32 v28, 155648, v8
  v_add_u32 v29, 155648, v9
  v_add_u32 v20, 94208, v6
  v_add_u32 v21, 94208, v7
  v_add_u32 v22, 94208, v8
  v_add_u32 v23, 94208, v9
  v_add_u32 v6, 28672, v6
  v_add_u32 v7, 28672, v7
  v_add_u32 v8, 28672, v8
  v_add_u32 v9, 28672, v9
  v_readlane_b32 s48, v15, 0
  v_readlane_b32 s49, v15, 1
  v_readlane_b32 s50, v15, 2
  s_cmp_lg_u32 s96, 0
  s_cbranch_scc1 L_wo_nosw
  v_permlane16_swap_b32 v240, v242
  v_permlane16_swap_b32 v241, v243
  v_permlane16_swap_b32 v244, v246
  v_permlane16_swap_b32 v245, v247
  v_permlane16_swap_b32 v248, v250
  v_permlane16_swap_b32 v249, v251
  v_permlane16_swap_b32 v252, v254
  v_permlane16_swap_b32 v253, v255
L_wo_nosw:
  s_waitcnt lgkmcnt(0)
  s_barrier
  buffer_load_dwordx4 v[32:35], off, s[36:39], s48 offset:0
  buffer_load_dwordx4 v[36:39], off, s[64:67], s48 offset:0
  buffer_load_dwordx4 v[40:43], off, s[36:39], s48 offset:1024
  buffer_load_dwordx4 v[44:47], off, s[64:67], s48 offset:1024
  buffer_load_dwordx4 v[48:51], off, s[36:39], s49 offset:0
  buffer_load_dwordx4 v[52:55], off, s[64:67], s49 offset:0
  buffer_load_dwordx4 v[56:59], off, s[36:39], s49 offset:1024
  buffer_load_dwordx4 v[60:63], off, s[64:67], s49 offset:1024
  buffer_load_dwordx4 v[64:67], off, s[36:39], s50 offset:0
  buffer_load_dwordx4 v[68:71], off, s[64:67], s50 offset:0
  buffer_load_dwordx4 v[72:75], off, s[36:39], s50 offset:1024
  buffer_load_dwordx4 v[76:79], off, s[64:67], s50 offset:1024
  ds_read_b64_tr_b16 v[160:161], v6 offset:0
  ds_read_b64_tr_b16 v[162:163], v6 offset:2048
  ds_read_b64_tr_b16 v[164:165], v7 offset:0
  ds_read_b64_tr_b16 v[166:167], v7 offset:2048
  ds_read_b64_tr_b16 v[176:177], v6 offset:4096
  ds_read_b64_tr_b16 v[178:179], v6 offset:6144
  ds_read_b64_tr_b16 v[180:181], v7 offset:4096
  ds_read_b64_tr_b16 v[182:183], v7 offset:6144
  ds_read_b64_tr_b16 v[168:169], v8 offset:0
  ds_read_b64_tr_b16 v[170:171], v8 offset:2048
  ds_read_b64_tr_b16 v[172:173], v9 offset:0
  ds_read_b64_tr_b16 v[174:175], v9 offset:2048
  ds_read_b64_tr_b16 v[184:185], v8 offset:4096
  ds_read_b64_tr_b16 v[186:187], v8 offset:6144
  ds_read_b64_tr_b16 v[188:189], v9 offset:4096
  ds_read_b64_tr_b16 v[190:191], v9 offset:6144
  v_lshlrev_b32 v96, 16, v240
  v_and_b32 v97, s11, v240
  v_lshlrev_b32 v98, 16, v241
  v_and_b32 v99, s11, v241
  v_lshlrev_b32 v100, 16, v248
  v_and_b32 v101, s11, v248
  v_lshlrev_b32 v102, 16, v249
  v_and_b32 v103, s11, v249
  v_lshlrev_b32 v104, 16, v242
  v_and_b32 v105, s11, v242
  v_lshlrev_b32 v106, 16, v243
  v_and_b32 v107, s11, v243
  v_lshlrev_b32 v108, 16, v250
  v_and_b32 v109, s11, v250
  v_lshlrev_b32 v110, 16, v251
  v_and_b32 v111, s11, v251
  v_lshlrev_b32 v112, 16, v244
  v_and_b32 v113, s11, v244
  v_lshlrev_b32 v114, 16, v245
  v_and_b32 v115, s11, v245
  v_lshlrev_b32 v116, 16, v252
  v_and_b32 v117, s11, v252
  v_lshlrev_b32 v118, 16, v253
  v_and_b32 v119, s11, v253
  v_lshlrev_b32 v120, 16, v246
  v_and_b32 v121, s11, v246
  v_lshlrev_b32 v122, 16, v247
  v_and_b32 v123, s11, v247
  v_lshlrev_b32 v124, 16, v254
  v_and_b32 v125, s11, v254
  v_lshlrev_b32 v126, 16, v255
  v_and_b32 v127, s11, v255
  s_waitcnt vmcnt(8) lgkmcnt(8)
  v_mfma_f32_16x16x32_bf16 v[96:99], v[160:163], v[32:35], v[96:99]
  ds_read_b64_tr_b16 v[192:193], v6 offset:8192
  v_readlane_b32 s51, v15, 3
  v_mfma_f32_16x16x32_bf16 v[96:99], v[176:179], v[40:43], v[96:99]
  ds_read_b64_tr_b16 v[194:195], v6 offset:10240
  v_mfma_f32_16x16x32_bf16 v[100:103], v[176:179], v[44:47], v[100:103]
  ds_read_b64_tr_b16 v[196:197], v7 offset:8192
  v_mfma_f32_16x16x32_bf16 v[100:103], v[160:163], v[36:39], v[100:103]
  buffer_load_dwordx4 v[80:83], off, s[36:39], s51 offset:0
  v_mfma_f32_16x16x32_bf16 v[108:111], v[164:167], v[36:39], v[108:111]
  ds_read_b64_tr_b16 v[198:199], v7 offset:10240
  ds_read_b64_tr_b16 v[208:209], v6 offset:12288
  v_mfma_f32_16x16x32_bf16 v[108:111], v[180:183], v[44:47], v[108:111]
  ds_read_b64_tr_b16 v[210:211], v6 offset:14336
  ds_read_b64_tr_b16 v[212:213], v7 offset:12288
  v_mfma_f32_16x16x32_bf16 v[104:107], v[180:183], v[40:43], v[104:107]
  buffer_load_dwordx4 v[84:87], off, s[64:67], s51 offset:0
  v_mfma_f32_16x16x32_bf16 v[104:107], v[164:167], v[32:35], v[104:107]
  ds_read_b64_tr_b16 v[214:215], v7 offset:14336
  s_waitcnt lgkmcnt(8)
  v_mfma_f32_16x16x32_bf16 v[112:115], v[168:171], v[32:35], v[112:115]
  ds_read_b64_tr_b16 v[200:201], v8 offset:8192
  v_mfma_f32_16x16x32_bf16 v[112:115], v[184:187], v[40:43], v[112:115]
  buffer_load_dwordx4 v[88:91], off, s[36:39], s51 offset:1024
  v_mfma_f32_16x16x32_bf16 v[116:119], v[184:187], v[44:47], v[116:119]
  ds_read_b64_tr_b16 v[202:203], v8 offset:10240
  ds_read_b64_tr_b16 v[204:205], v9 offset:8192
  v_mfma_f32_16x16x32_bf16 v[116:119], v[168:171], v[36:39], v[116:119]
  ds_read_b64_tr_b16 v[206:207], v9 offset:10240
  ds_read_b64_tr_b16 v[216:217], v8 offset:12288
  v_mfma_f32_16x16x32_bf16 v[124:127], v[172:175], v[36:39], v[124:127]
  buffer_load_dwordx4 v[92:95], off, s[64:67], s51 offset:1024
  v_mfma_f32_16x16x32_bf16 v[124:127], v[188:191], v[44:47], v[124:127]
  ds_read_b64_tr_b16 v[218:219], v8 offset:14336
  v_readlane_b32 s48, v15, 4
  v_mfma_f32_16x16x32_bf16 v[120:123], v[188:191], v[40:43], v[120:123]
  ds_read_b64_tr_b16 v[220:221], v9 offset:12288
  v_mfma_f32_16x16x32_bf16 v[120:123], v[172:175], v[32:35], v[120:123]
  ds_read_b64_tr_b16 v[222:223], v9 offset:14336
  s_waitcnt vmcnt(8) lgkmcnt(8)
  v_mfma_f32_16x16x32_bf16 v[96:99], v[192:195], v[48:51], v[96:99]
  buffer_load_dwordx4 v[32:35], off, s[36:39], s48 offset:0
  v_mfma_f32_16x16x32_bf16 v[96:99], v[208:211], v[56:59], v[96:99]
  ds_read_b64_tr_b16 v[160:161], v6 offset:16384
  ds_read_b64_tr_b16 v[162:163], v6 offset:18432
  v_mfma_f32_16x16x32_bf16 v[100:103], v[208:211], v[60:63], v[100:103]
  ds_read_b64_tr_b16 v[164:165], v7 offset:16384
  v_mfma_f32_16x16x32_bf16 v[100:103], v[192:195], v[52:55], v[100:103]
  buffer_load_dwordx4 v[36:39], off, s[64:67], s48 offset:0
  v_mfma_f32_16x16x32_bf16 v[108:111], v[196:199], v[52:55], v[108:111]
  ds_read_b64_tr_b16 v[166:167], v7 offset:18432
  ds_read_b64_tr_b16 v[176:177], v6 offset:20480
  v_mfma_f32_16x16x32_bf16 v[108:111], v[212:215], v[60:63], v[108:111]
  ds_read_b64_tr_b16 v[178:179], v6 offset:22528
  ds_read_b64_tr_b16 v[180:181], v7 offset:20480
  v_mfma_f32_16x16x32_bf16 v[104:107], v[212:215], v[56:59], v[104:107]
  buffer_load_dwordx4 v[40:43], off, s[36:39], s48 offset:1024
  v_mfma_f32_16x16x32_bf16 v[104:107], v[196:199], v[48:51], v[104:107]
  ds_read_b64_tr_b16 v[182:183], v7 offset:22528
  s_waitcnt lgkmcnt(8)
  v_mfma_f32_16x16x32_bf16 v[112:115], v[200:203], v[48:51], v[112:115]
  ds_read_b64_tr_b16 v[168:169], v8 offset:16384
  v_mfma_f32_16x16x32_bf16 v[112:115], v[216:219], v[56:59], v[112:115]
  buffer_load_dwordx4 v[44:47], off, s[64:67], s48 offset:1024
  v_mfma_f32_16x16x32_bf16 v[116:119], v[216:219], v[60:63], v[116:119]
  ds_read_b64_tr_b16 v[170:171], v8 offset:18432
  ds_read_b64_tr_b16 v[172:173], v9 offset:16384
  v_mfma_f32_16x16x32_bf16 v[116:119], v[200:203], v[52:55], v[116:119]
  ds_read_b64_tr_b16 v[174:175], v9 offset:18432
  v_mfma_f32_16x16x32_bf16 v[124:127], v[204:207], v[52:55], v[124:127]
  ds_read_b64_tr_b16 v[184:185], v8 offset:20480
  v_mfma_f32_16x16x32_bf16 v[124:127], v[220:223], v[60:63], v[124:127]
  ds_read_b64_tr_b16 v[186:187], v8 offset:22528
  v_readlane_b32 s49, v15, 5
  v_mfma_f32_16x16x32_bf16 v[120:123], v[220:223], v[56:59], v[120:123]
  ds_read_b64_tr_b16 v[188:189], v9 offset:20480
  v_mfma_f32_16x16x32_bf16 v[120:123], v[204:207], v[48:51], v[120:123]
  ds_read_b64_tr_b16 v[190:191], v9 offset:22528
  s_waitcnt vmcnt(8) lgkmcnt(8)
  v_mfma_f32_16x16x32_bf16 v[96:99], v[160:163], v[64:67], v[96:99]
  buffer_load_dwordx4 v[48:51], off, s[36:39], s49 offset:0
  v_mfma_f32_16x16x32_bf16 v[96:99], v[176:179], v[72:75], v[96:99]
  ds_read_b64_tr_b16 v[192:193], v6 offset:24576
  ds_read_b64_tr_b16 v[194:195], v6 offset:26624
  v_mfma_f32_16x16x32_bf16 v[100:103], v[176:179], v[76:79], v[100:103]
  ds_read_b64_tr_b16 v[196:197], v7 offset:24576
  v_mfma_f32_16x16x32_bf16 v[100:103], v[160:163], v[68:71], v[100:103]
  buffer_load_dwordx4 v[52:55], off, s[64:67], s49 offset:0
  v_mfma_f32_16x16x32_bf16 v[108:111], v[164:167], v[68:71], v[108:111]
  ds_read_b64_tr_b16 v[198:199], v7 offset:26624
  ds_read_b64_tr_b16 v[208:209], v6 offset:28672
  v_mfma_f32_16x16x32_bf16 v[108:111], v[180:183], v[76:79], v[108:111]
  ds_read_b64_tr_b16 v[210:211], v6 offset:30720
  ds_read_b64_tr_b16 v[212:213], v7 offset:28672
  v_mfma_f32_16x16x32_bf16 v[104:107], v[180:183], v[72:75], v[104:107]
  buffer_load_dwordx4 v[56:59], off, s[36:39], s49 offset:1024
  v_mfma_f32_16x16x32_bf16 v[104:107], v[164:167], v[64:67], v[104:107]
  ds_read_b64_tr_b16 v[214:215], v7 offset:30720
  s_waitcnt lgkmcnt(8)
  v_mfma_f32_16x16x32_bf16 v[112:115], v[168:171], v[64:67], v[112:115]
  ds_read_b64_tr_b16 v[200:201], v8 offset:24576
  v_mfma_f32_16x16x32_bf16 v[112:115], v[184:187], v[72:75], v[112:115]
  buffer_load_dwordx4 v[60:63], off, s[64:67], s49 offset:1024
  v_mfma_f32_16x16x32_bf16 v[116:119], v[184:187], v[76:79], v[116:119]
  ds_read_b64_tr_b16 v[202:203], v8 offset:26624
  ds_read_b64_tr_b16 v[204:205], v9 offset:24576
  v_mfma_f32_16x16x32_bf16 v[116:119], v[168:171], v[68:71], v[116:119]
  ds_read_b64_tr_b16 v[206:207], v9 offset:26624
  v_mfma_f32_16x16x32_bf16 v[124:127], v[172:175], v[68:71], v[124:127]
  ds_read_b64_tr_b16 v[216:217], v8 offset:28672
  v_mfma_f32_16x16x32_bf16 v[124:127], v[188:191], v[76:79], v[124:127]
  ds_read_b64_tr_b16 v[218:219], v8 offset:30720
  v_readlane_b32 s50, v15, 6
  v_mfma_f32_16x16x32_bf16 v[120:123], v[188:191], v[72:75], v[120:123]
  ds_read_b64_tr_b16 v[220:221], v9 offset:28672
  v_mfma_f32_16x16x32_bf16 v[120:123], v[172:175], v[64:67], v[120:123]
  ds_read_b64_tr_b16 v[222:223], v9 offset:30720
  s_waitcnt vmcnt(8) lgkmcnt(8)
  v_mfma_f32_16x16x32_bf16 v[96:99], v[192:195], v[80:83], v[96:99]
  buffer_load_dwordx4 v[64:67], off, s[36:39], s50 offset:0
  v_mfma_f32_16x16x32_bf16 v[96:99], v[208:211], v[88:91], v[96:99]
  ds_read_b64_tr_b16 v[160:161], v6 offset:32768
  ds_read_b64_tr_b16 v[162:163], v6 offset:34816
  v_mfma_f32_16x16x32_bf16 v[100:103], v[208:211], v[92:95], v[100:103]
  ds_read_b64_tr_b16 v[164:165], v7 offset:32768
  v_mfma_f32_16x16x32_bf16 v[100:103], v[192:195], v[84:87], v[100:103]
  buffer_load_dwordx4 v[68:71], off, s[64:67], s50 offset:0
  v_mfma_f32_16x16x32_bf16 v[108:111], v[196:199], v[84:87], v[108:111]
  ds_read_b64_tr_b16 v[166:167], v7 offset:34816
  ds_read_b64_tr_b16 v[176:177], v6 offset:36864
  v_mfma_f32_16x16x32_bf16 v[108:111], v[212:215], v[92:95], v[108:111]
  ds_read_b64_tr_b16 v[178:179], v6 offset:38912
  ds_read_b64_tr_b16 v[180:181], v7 offset:36864
  v_mfma_f32_16x16x32_bf16 v[104:107], v[212:215], v[88:91], v[104:107]
  buffer_load_dwordx4 v[72:75], off, s[36:39], s50 offset:1024
  v_mfma_f32_16x16x32_bf16 v[104:107], v[196:199], v[80:83], v[104:107]
  ds_read_b64_tr_b16 v[182:183], v7 offset:38912
  s_waitcnt lgkmcnt(8)
  v_mfma_f32_16x16x32_bf16 v[112:115], v[200:203], v[80:83], v[112:115]
  ds_read_b64_tr_b16 v[168:169], v8 offset:32768
  v_mfma_f32_16x16x32_bf16 v[112:115], v[216:219], v[88:91], v[112:115]
  buffer_load_dwordx4 v[76:79], off, s[64:67], s50 offset:1024
  v_mfma_f32_16x16x32_bf16 v[116:119], v[216:219], v[92:95], v[116:119]
  ds_read_b64_tr_b16 v[170:171], v8 offset:34816
  ds_read_b64_tr_b16 v[172:173], v9 offset:32768
  v_mfma_f32_16x16x32_bf16 v[116:119], v[200:203], v[84:87], v[116:119]
  ds_read_b64_tr_b16 v[174:175], v9 offset:34816
  v_mfma_f32_16x16x32_bf16 v[124:127], v[204:207], v[84:87], v[124:127]
  ds_read_b64_tr_b16 v[184:185], v8 offset:36864
  v_mfma_f32_16x16x32_bf16 v[124:127], v[220:223], v[92:95], v[124:127]
  ds_read_b64_tr_b16 v[186:187], v8 offset:38912
  v_readlane_b32 s51, v15, 7
  v_mfma_f32_16x16x32_bf16 v[120:123], v[220:223], v[88:91], v[120:123]
  ds_read_b64_tr_b16 v[188:189], v9 offset:36864
  v_mfma_f32_16x16x32_bf16 v[120:123], v[204:207], v[80:83], v[120:123]
  ds_read_b64_tr_b16 v[190:191], v9 offset:38912
  s_waitcnt vmcnt(8) lgkmcnt(8)
  v_mfma_f32_16x16x32_bf16 v[96:99], v[160:163], v[32:35], v[96:99]
  buffer_load_dwordx4 v[80:83], off, s[36:39], s51 offset:0
  v_mfma_f32_16x16x32_bf16 v[96:99], v[176:179], v[40:43], v[96:99]
  ds_read_b64_tr_b16 v[192:193], v6 offset:40960
  ds_read_b64_tr_b16 v[194:195], v6 offset:43008
  v_mfma_f32_16x16x32_bf16 v[100:103], v[176:179], v[44:47], v[100:103]
  ds_read_b64_tr_b16 v[196:197], v7 offset:40960
  v_mfma_f32_16x16x32_bf16 v[100:103], v[160:163], v[36:39], v[100:103]
  buffer_load_dwordx4 v[84:87], off, s[64:67], s51 offset:0
  v_mfma_f32_16x16x32_bf16 v[108:111], v[164:167], v[36:39], v[108:111]
  ds_read_b64_tr_b16 v[198:199], v7 offset:43008
  ds_read_b64_tr_b16 v[208:209], v6 offset:45056
  v_mfma_f32_16x16x32_bf16 v[108:111], v[180:183], v[44:47], v[108:111]
  ds_read_b64_tr_b16 v[210:211], v6 offset:47104
  ds_read_b64_tr_b16 v[212:213], v7 offset:45056
  v_mfma_f32_16x16x32_bf16 v[104:107], v[180:183], v[40:43], v[104:107]
  buffer_load_dwordx4 v[88:91], off, s[36:39], s51 offset:1024
  v_mfma_f32_16x16x32_bf16 v[104:107], v[164:167], v[32:35], v[104:107]
  ds_read_b64_tr_b16 v[214:215], v7 offset:47104
  s_waitcnt lgkmcnt(8)
  s_barrier
  v_mfma_f32_16x16x32_bf16 v[112:115], v[168:171], v[32:35], v[112:115]
  ds_read_b64_tr_b16 v[200:201], v8 offset:40960
  v_mfma_f32_16x16x32_bf16 v[112:115], v[184:187], v[40:43], v[112:115]
  buffer_load_dwordx4 v[92:95], off, s[64:67], s51 offset:1024
  v_mfma_f32_16x16x32_bf16 v[116:119], v[184:187], v[44:47], v[116:119]
  ds_read_b64_tr_b16 v[202:203], v8 offset:43008
  ds_read_b64_tr_b16 v[204:205], v9 offset:40960
  v_mfma_f32_16x16x32_bf16 v[116:119], v[168:171], v[36:39], v[116:119]
  ds_read_b64_tr_b16 v[206:207], v9 offset:43008
  v_mfma_f32_16x16x32_bf16 v[124:127], v[172:175], v[36:39], v[124:127]
  ds_read_b64_tr_b16 v[216:217], v8 offset:45056
  v_mfma_f32_16x16x32_bf16 v[124:127], v[188:191], v[44:47], v[124:127]
  ds_read_b64_tr_b16 v[218:219], v8 offset:47104
  v_readlane_b32 s48, v15, 8
  v_mfma_f32_16x16x32_bf16 v[120:123], v[188:191], v[40:43], v[120:123]
  ds_read_b64_tr_b16 v[220:221], v9 offset:45056
  v_mfma_f32_16x16x32_bf16 v[120:123], v[172:175], v[32:35], v[120:123]
  ds_read_b64_tr_b16 v[222:223], v9 offset:47104
  s_waitcnt vmcnt(8) lgkmcnt(8)
  v_mfma_f32_16x16x32_bf16 v[96:99], v[192:195], v[48:51], v[96:99]
  buffer_load_dwordx4 v[32:35], off, s[36:39], s48 offset:0
  v_mfma_f32_16x16x32_bf16 v[96:99], v[208:211], v[56:59], v[96:99]
  ds_read_b64_tr_b16 v[160:161], v6 offset:49152
  ds_read_b64_tr_b16 v[162:163], v6 offset:51200
  v_mfma_f32_16x16x32_bf16 v[100:103], v[208:211], v[60:63], v[100:103]
  ds_read_b64_tr_b16 v[164:165], v7 offset:49152
  v_mfma_f32_16x16x32_bf16 v[100:103], v[192:195], v[52:55], v[100:103]
  buffer_load_dwordx4 v[36:39], off, s[64:67], s48 offset:0
  v_mfma_f32_16x16x32_bf16 v[108:111], v[196:199], v[52:55], v[108:111]
  ds_read_b64_tr_b16 v[166:167], v7 offset:51200
  ds_read_b64_tr_b16 v[176:177], v6 offset:53248
  v_mfma_f32_16x16x32_bf16 v[108:111], v[212:215], v[60:63], v[108:111]
  ds_read_b64_tr_b16 v[178:179], v6 offset:55296
  ds_read_b64_tr_b16 v[180:181], v7 offset:53248
  v_mfma_f32_16x16x32_bf16 v[104:107], v[212:215], v[56:59], v[104:107]
  buffer_load_dwordx4 v[40:43], off, s[36:39], s48 offset:1024
  v_mfma_f32_16x16x32_bf16 v[104:107], v[196:199], v[48:51], v[104:107]
  ds_read_b64_tr_b16 v[182:183], v7 offset:55296
  s_waitcnt lgkmcnt(8)
  v_mfma_f32_16x16x32_bf16 v[112:115], v[200:203], v[48:51], v[112:115]
  ds_read_b64_tr_b16 v[168:169], v8 offset:49152
  v_mfma_f32_16x16x32_bf16 v[112:115], v[216:219], v[56:59], v[112:115]
  buffer_load_dwordx4 v[44:47], off, s[64:67], s48 offset:1024
  v_mfma_f32_16x16x32_bf16 v[116:119], v[216:219], v[60:63], v[116:119]
  ds_read_b64_tr_b16 v[170:171], v8 offset:51200
  ds_read_b64_tr_b16 v[172:173], v9 offset:49152
  v_mfma_f32_16x16x32_bf16 v[116:119], v[200:203], v[52:55], v[116:119]
  ds_read_b64_tr_b16 v[174:175], v9 offset:51200
  v_mfma_f32_16x16x32_bf16 v[124:127], v[204:207], v[52:55], v[124:127]
  ds_read_b64_tr_b16 v[184:185], v8 offset:53248
  v_mfma_f32_16x16x32_bf16 v[124:127], v[220:223], v[60:63], v[124:127]
  ds_read_b64_tr_b16 v[186:187], v8 offset:55296
  v_readlane_b32 s49, v15, 9
  v_mfma_f32_16x16x32_bf16 v[120:123], v[220:223], v[56:59], v[120:123]
  ds_read_b64_tr_b16 v[188:189], v9 offset:53248
  v_mfma_f32_16x16x32_bf16 v[120:123], v[204:207], v[48:51], v[120:123]
  ds_read_b64_tr_b16 v[190:191], v9 offset:55296
  s_waitcnt vmcnt(8) lgkmcnt(8)
  v_mfma_f32_16x16x32_bf16 v[96:99], v[160:163], v[64:67], v[96:99]
  buffer_load_dwordx4 v[48:51], off, s[36:39], s49 offset:0
  v_mfma_f32_16x16x32_bf16 v[96:99], v[176:179], v[72:75], v[96:99]
  ds_read_b64_tr_b16 v[192:193], v6 offset:57344
  ds_read_b64_tr_b16 v[194:195], v6 offset:59392
  v_mfma_f32_16x16x32_bf16 v[100:103], v[176:179], v[76:79], v[100:103]
  ds_read_b64_tr_b16 v[196:197], v7 offset:57344
  v_mfma_f32_16x16x32_bf16 v[100:103], v[160:163], v[68:71], v[100:103]
  buffer_load_dwordx4 v[52:55], off, s[64:67], s49 offset:0
  v_mfma_f32_16x16x32_bf16 v[108:111], v[164:167], v[68:71], v[108:111]
  ds_read_b64_tr_b16 v[198:199], v7 offset:59392
  ds_read_b64_tr_b16 v[208:209], v6 offset:61440
  v_mfma_f32_16x16x32_bf16 v[108:111], v[180:183], v[76:79], v[108:111]
  ds_read_b64_tr_b16 v[210:211], v6 offset:63488
  ds_read_b64_tr_b16 v[212:213], v7 offset:61440
  v_mfma_f32_16x16x32_bf16 v[104:107], v[180:183], v[72:75], v[104:107]
  buffer_load_dwordx4 v[56:59], off, s[36:39], s49 offset:1024
  v_mfma_f32_16x16x32_bf16 v[104:107], v[164:167], v[64:67], v[104:107]
  ds_read_b64_tr_b16 v[214:215], v7 offset:63488
  s_waitcnt lgkmcnt(8)
  v_mfma_f32_16x16x32_bf16 v[112:115], v[168:171], v[64:67], v[112:115]
  ds_read_b64_tr_b16 v[200:201], v8 offset:57344
  v_mfma_f32_16x16x32_bf16 v[112:115], v[184:187], v[72:75], v[112:115]
  buffer_load_dwordx4 v[60:63], off, s[64:67], s49 offset:1024
  v_mfma_f32_16x16x32_bf16 v[116:119], v[184:187], v[76:79], v[116:119]
  ds_read_b64_tr_b16 v[202:203], v8 offset:59392
  ds_read_b64_tr_b16 v[204:205], v9 offset:57344
  v_mfma_f32_16x16x32_bf16 v[116:119], v[168:171], v[68:71], v[116:119]
  ds_read_b64_tr_b16 v[206:207], v9 offset:59392
  v_mfma_f32_16x16x32_bf16 v[124:127], v[172:175], v[68:71], v[124:127]
  ds_read_b64_tr_b16 v[216:217], v8 offset:61440
  v_mfma_f32_16x16x32_bf16 v[124:127], v[188:191], v[76:79], v[124:127]
  ds_read_b64_tr_b16 v[218:219], v8 offset:63488
  v_readlane_b32 s50, v15, 10
  v_mfma_f32_16x16x32_bf16 v[120:123], v[188:191], v[72:75], v[120:123]
  ds_read_b64_tr_b16 v[220:221], v9 offset:61440
  v_mfma_f32_16x16x32_bf16 v[120:123], v[172:175], v[64:67], v[120:123]
  ds_read_b64_tr_b16 v[222:223], v9 offset:63488
  s_waitcnt vmcnt(8) lgkmcnt(8)
  v_mfma_f32_16x16x32_bf16 v[96:99], v[192:195], v[80:83], v[96:99]
  buffer_load_dwordx4 v[64:67], off, s[36:39], s50 offset:0
  v_mfma_f32_16x16x32_bf16 v[96:99], v[208:211], v[88:91], v[96:99]
  ds_read_b64_tr_b16 v[160:161], v20 offset:0
  ds_read_b64_tr_b16 v[162:163], v20 offset:2048
  v_mfma_f32_16x16x32_bf16 v[100:103], v[208:211], v[92:95], v[100:103]
  ds_read_b64_tr_b16 v[164:165], v21 offset:0
  v_mfma_f32_16x16x32_bf16 v[100:103], v[192:195], v[84:87], v[100:103]
  buffer_load_dwordx4 v[68:71], off, s[64:67], s50 offset:0
  v_mfma_f32_16x16x32_bf16 v[108:111], v[196:199], v[84:87], v[108:111]
  ds_read_b64_tr_b16 v[166:167], v21 offset:2048
  ds_read_b64_tr_b16 v[176:177], v20 offset:4096
  v_mfma_f32_16x16x32_bf16 v[108:111], v[212:215], v[92:95], v[108:111]
  ds_read_b64_tr_b16 v[178:179], v20 offset:6144
  ds_read_b64_tr_b16 v[180:181], v21 offset:4096
  v_mfma_f32_16x16x32_bf16 v[104:107], v[212:215], v[88:91], v[104:107]
  buffer_load_dwordx4 v[72:75], off, s[36:39], s50 offset:1024
  v_mfma_f32_16x16x32_bf16 v[104:107], v[196:199], v[80:83], v[104:107]
  ds_read_b64_tr_b16 v[182:183], v21 offset:6144
  s_waitcnt lgkmcnt(8)
  v_mfma_f32_16x16x32_bf16 v[112:115], v[200:203], v[80:83], v[112:115]
  ds_read_b64_tr_b16 v[168:169], v22 offset:0
  v_mfma_f32_16x16x32_bf16 v[112:115], v[216:219], v[88:91], v[112:115]
  buffer_load_dwordx4 v[76:79], off, s[64:67], s50 offset:1024
  v_mfma_f32_16x16x32_bf16 v[116:119], v[216:219], v[92:95], v[116:119]
  ds_read_b64_tr_b16 v[170:171], v22 offset:2048
  ds_read_b64_tr_b16 v[172:173], v23 offset:0
  v_mfma_f32_16x16x32_bf16 v[116:119], v[200:203], v[84:87], v[116:119]
  ds_read_b64_tr_b16 v[174:175], v23 offset:2048
  v_mfma_f32_16x16x32_bf16 v[124:127], v[204:207], v[84:87], v[124:127]
  ds_read_b64_tr_b16 v[184:185], v22 offset:4096
  v_mfma_f32_16x16x32_bf16 v[124:127], v[220:223], v[92:95], v[124:127]
  ds_read_b64_tr_b16 v[186:187], v22 offset:6144
  v_readlane_b32 s51, v15, 11
  v_mfma_f32_16x16x32_bf16 v[120:123], v[220:223], v[88:91], v[120:123]
  ds_read_b64_tr_b16 v[188:189], v23 offset:4096
  v_mfma_f32_16x16x32_bf16 v[120:123], v[204:207], v[80:83], v[120:123]
  ds_read_b64_tr_b16 v[190:191], v23 offset:6144
  s_waitcnt vmcnt(8) lgkmcnt(8)
  v_mfma_f32_16x16x32_bf16 v[96:99], v[160:163], v[32:35], v[96:99]
  buffer_load_dwordx4 v[80:83], off, s[36:39], s51 offset:0
  v_mfma_f32_16x16x32_bf16 v[96:99], v[176:179], v[40:43], v[96:99]
  ds_read_b64_tr_b16 v[192:193], v20 offset:8192
  ds_read_b64_tr_b16 v[194:195], v20 offset:10240
  v_mfma_f32_16x16x32_bf16 v[100:103], v[176:179], v[44:47], v[100:103]
  ds_read_b64_tr_b16 v[196:197], v21 offset:8192
  v_mfma_f32_16x16x32_bf16 v[100:103], v[160:163], v[36:39], v[100:103]
  buffer_load_dwordx4 v[84:87], off, s[64:67], s51 offset:0
  v_mfma_f32_16x16x32_bf16 v[108:111], v[164:167], v[36:39], v[108:111]
  ds_read_b64_tr_b16 v[198:199], v21 offset:10240
  ds_read_b64_tr_b16 v[208:209], v20 offset:12288
  v_mfma_f32_16x16x32_bf16 v[108:111], v[180:183], v[44:47], v[108:111]
  ds_read_b64_tr_b16 v[210:211], v20 offset:14336
  ds_read_b64_tr_b16 v[212:213], v21 offset:12288
  v_mfma_f32_16x16x32_bf16 v[104:107], v[180:183], v[40:43], v[104:107]
  buffer_load_dwordx4 v[88:91], off, s[36:39], s51 offset:1024
  v_mfma_f32_16x16x32_bf16 v[104:107], v[164:167], v[32:35], v[104:107]
  ds_read_b64_tr_b16 v[214:215], v21 offset:14336
  s_waitcnt lgkmcnt(8)
  v_mfma_f32_16x16x32_bf16 v[112:115], v[168:171], v[32:35], v[112:115]
  ds_read_b64_tr_b16 v[200:201], v22 offset:8192
  v_mfma_f32_16x16x32_bf16 v[112:115], v[184:187], v[40:43], v[112:115]
  buffer_load_dwordx4 v[92:95], off, s[64:67], s51 offset:1024
  v_mfma_f32_16x16x32_bf16 v[116:119], v[184:187], v[44:47], v[116:119]
  ds_read_b64_tr_b16 v[202:203], v22 offset:10240
  ds_read_b64_tr_b16 v[204:205], v23 offset:8192
  v_mfma_f32_16x16x32_bf16 v[116:119], v[168:171], v[36:39], v[116:119]
  ds_read_b64_tr_b16 v[206:207], v23 offset:10240
  v_mfma_f32_16x16x32_bf16 v[124:127], v[172:175], v[36:39], v[124:127]
  ds_read_b64_tr_b16 v[216:217], v22 offset:12288
  v_mfma_f32_16x16x32_bf16 v[124:127], v[188:191], v[44:47], v[124:127]
  ds_read_b64_tr_b16 v[218:219], v22 offset:14336
  v_readlane_b32 s48, v15, 12
  v_mfma_f32_16x16x32_bf16 v[120:123], v[188:191], v[40:43], v[120:123]
  ds_read_b64_tr_b16 v[220:221], v23 offset:12288
  v_mfma_f32_16x16x32_bf16 v[120:123], v[172:175], v[32:35], v[120:123]
  ds_read_b64_tr_b16 v[222:223], v23 offset:14336
  s_waitcnt vmcnt(8) lgkmcnt(8)
  v_mfma_f32_16x16x32_bf16 v[96:99], v[192:195], v[48:51], v[96:99]
  buffer_load_dwordx4 v[32:35], off, s[36:39], s48 offset:0
  v_mfma_f32_16x16x32_bf16 v[96:99], v[208:211], v[56:59], v[96:99]
  ds_read_b64_tr_b16 v[160:161], v20 offset:16384
  ds_read_b64_tr_b16 v[162:163], v20 offset:18432
  v_mfma_f32_16x16x32_bf16 v[100:103], v[208:211], v[60:63], v[100:103]
  ds_read_b64_tr_b16 v[164:165], v21 offset:16384
  v_mfma_f32_16x16x32_bf16 v[100:103], v[192:195], v[52:55], v[100:103]
  buffer_load_dwordx4 v[36:39], off, s[64:67], s48 offset:0
  v_mfma_f32_16x16x32_bf16 v[108:111], v[196:199], v[52:55], v[108:111]
  ds_read_b64_tr_b16 v[166:167], v21 offset:18432
  ds_read_b64_tr_b16 v[176:177], v20 offset:20480
  v_mfma_f32_16x16x32_bf16 v[108:111], v[212:215], v[60:63], v[108:111]
  ds_read_b64_tr_b16 v[178:179], v20 offset:22528
  ds_read_b64_tr_b16 v[180:181], v21 offset:20480
  v_mfma_f32_16x16x32_bf16 v[104:107], v[212:215], v[56:59], v[104:107]
  buffer_load_dwordx4 v[40:43], off, s[36:39], s48 offset:1024
  v_mfma_f32_16x16x32_bf16 v[104:107], v[196:199], v[48:51], v[104:107]
  ds_read_b64_tr_b16 v[182:183], v21 offset:22528
  s_waitcnt lgkmcnt(8)
  v_mfma_f32_16x16x32_bf16 v[112:115], v[200:203], v[48:51], v[112:115]
  ds_read_b64_tr_b16 v[168:169], v22 offset:16384
  v_mfma_f32_16x16x32_bf16 v[112:115], v[216:219], v[56:59], v[112:115]
  buffer_load_dwordx4 v[44:47], off, s[64:67], s48 offset:1024
  v_mfma_f32_16x16x32_bf16 v[116:119], v[216:219], v[60:63], v[116:119]
  ds_read_b64_tr_b16 v[170:171], v22 offset:18432
  ds_read_b64_tr_b16 v[172:173], v23 offset:16384
  v_mfma_f32_16x16x32_bf16 v[116:119], v[200:203], v[52:55], v[116:119]
  ds_read_b64_tr_b16 v[174:175], v23 offset:18432
  v_mfma_f32_16x16x32_bf16 v[124:127], v[204:207], v[52:55], v[124:127]
  ds_read_b64_tr_b16 v[184:185], v22 offset:20480
  v_mfma_f32_16x16x32_bf16 v[124:127], v[220:223], v[60:63], v[124:127]
  ds_read_b64_tr_b16 v[186:187], v22 offset:22528
  v_readlane_b32 s49, v15, 13
  v_mfma_f32_16x16x32_bf16 v[120:123], v[220:223], v[56:59], v[120:123]
  ds_read_b64_tr_b16 v[188:189], v23 offset:20480
  v_mfma_f32_16x16x32_bf16 v[120:123], v[204:207], v[48:51], v[120:123]
  ds_read_b64_tr_b16 v[190:191], v23 offset:22528
  s_waitcnt vmcnt(8) lgkmcnt(8)
  v_mfma_f32_16x16x32_bf16 v[96:99], v[160:163], v[64:67], v[96:99]
  buffer_load_dwordx4 v[48:51], off, s[36:39], s49 offset:0
  v_mfma_f32_16x16x32_bf16 v[96:99], v[176:179], v[72:75], v[96:99]
  ds_read_b64_tr_b16 v[192:193], v20 offset:24576
  ds_read_b64_tr_b16 v[194:195], v20 offset:26624
  v_mfma_f32_16x16x32_bf16 v[100:103], v[176:179], v[76:79], v[100:103]
  ds_read_b64_tr_b16 v[196:197], v21 offset:24576
  v_mfma_f32_16x16x32_bf16 v[100:103], v[160:163], v[68:71], v[100:103]
  buffer_load_dwordx4 v[52:55], off, s[64:67], s49 offset:0
  v_mfma_f32_16x16x32_bf16 v[108:111], v[164:167], v[68:71], v[108:111]
  ds_read_b64_tr_b16 v[198:199], v21 offset:26624
  ds_read_b64_tr_b16 v[208:209], v20 offset:28672
  v_mfma_f32_16x16x32_bf16 v[108:111], v[180:183], v[76:79], v[108:111]
  ds_read_b64_tr_b16 v[210:211], v20 offset:30720
  ds_read_b64_tr_b16 v[212:213], v21 offset:28672
  v_mfma_f32_16x16x32_bf16 v[104:107], v[180:183], v[72:75], v[104:107]
  buffer_load_dwordx4 v[56:59], off, s[36:39], s49 offset:1024
  v_mfma_f32_16x16x32_bf16 v[104:107], v[164:167], v[64:67], v[104:107]
  ds_read_b64_tr_b16 v[214:215], v21 offset:30720
  s_waitcnt lgkmcnt(8)
  v_mfma_f32_16x16x32_bf16 v[112:115], v[168:171], v[64:67], v[112:115]
  ds_read_b64_tr_b16 v[200:201], v22 offset:24576
  v_mfma_f32_16x16x32_bf16 v[112:115], v[184:187], v[72:75], v[112:115]
  buffer_load_dwordx4 v[60:63], off, s[64:67], s49 offset:1024
  v_mfma_f32_16x16x32_bf16 v[116:119], v[184:187], v[76:79], v[116:119]
  ds_read_b64_tr_b16 v[202:203], v22 offset:26624
  ds_read_b64_tr_b16 v[204:205], v23 offset:24576
  v_mfma_f32_16x16x32_bf16 v[116:119], v[168:171], v[68:71], v[116:119]
  ds_read_b64_tr_b16 v[206:207], v23 offset:26624
  v_mfma_f32_16x16x32_bf16 v[124:127], v[172:175], v[68:71], v[124:127]
  ds_read_b64_tr_b16 v[216:217], v22 offset:28672
  v_mfma_f32_16x16x32_bf16 v[124:127], v[188:191], v[76:79], v[124:127]
  ds_read_b64_tr_b16 v[218:219], v22 offset:30720
  v_readlane_b32 s50, v15, 14
  v_mfma_f32_16x16x32_bf16 v[120:123], v[188:191], v[72:75], v[120:123]
  ds_read_b64_tr_b16 v[220:221], v23 offset:28672
  v_mfma_f32_16x16x32_bf16 v[120:123], v[172:175], v[64:67], v[120:123]
  ds_read_b64_tr_b16 v[222:223], v23 offset:30720
  s_waitcnt vmcnt(8) lgkmcnt(8)
  v_mfma_f32_16x16x32_bf16 v[96:99], v[192:195], v[80:83], v[96:99]
  buffer_load_dwordx4 v[64:67], off, s[36:39], s50 offset:0
  v_mfma_f32_16x16x32_bf16 v[96:99], v[208:211], v[88:91], v[96:99]
  ds_read_b64_tr_b16 v[160:161], v20 offset:36864
  ds_read_b64_tr_b16 v[162:163], v20 offset:38912
  v_mfma_f32_16x16x32_bf16 v[100:103], v[208:211], v[92:95], v[100:103]
  ds_read_b64_tr_b16 v[164:165], v21 offset:36864
  v_mfma_f32_16x16x32_bf16 v[100:103], v[192:195], v[84:87], v[100:103]
  buffer_load_dwordx4 v[68:71], off, s[64:67], s50 offset:0
  v_mfma_f32_16x16x32_bf16 v[108:111], v[196:199], v[84:87], v[108:111]
  ds_read_b64_tr_b16 v[166:167], v21 offset:38912
  ds_read_b64_tr_b16 v[176:177], v20 offset:40960
  v_mfma_f32_16x16x32_bf16 v[108:111], v[212:215], v[92:95], v[108:111]
  ds_read_b64_tr_b16 v[178:179], v20 offset:43008
  ds_read_b64_tr_b16 v[180:181], v21 offset:40960
  v_mfma_f32_16x16x32_bf16 v[104:107], v[212:215], v[88:91], v[104:107]
  buffer_load_dwordx4 v[72:75], off, s[36:39], s50 offset:1024
  v_mfma_f32_16x16x32_bf16 v[104:107], v[196:199], v[80:83], v[104:107]
  ds_read_b64_tr_b16 v[182:183], v21 offset:43008
  s_waitcnt lgkmcnt(8)
  v_mfma_f32_16x16x32_bf16 v[112:115], v[200:203], v[80:83], v[112:115]
  ds_read_b64_tr_b16 v[168:169], v22 offset:36864
  v_mfma_f32_16x16x32_bf16 v[112:115], v[216:219], v[88:91], v[112:115]
  buffer_load_dwordx4 v[76:79], off, s[64:67], s50 offset:1024
  v_mfma_f32_16x16x32_bf16 v[116:119], v[216:219], v[92:95], v[116:119]
  ds_read_b64_tr_b16 v[170:171], v22 offset:38912
  ds_read_b64_tr_b16 v[172:173], v23 offset:36864
  v_mfma_f32_16x16x32_bf16 v[116:119], v[200:203], v[84:87], v[116:119]
  ds_read_b64_tr_b16 v[174:175], v23 offset:38912
  v_mfma_f32_16x16x32_bf16 v[124:127], v[204:207], v[84:87], v[124:127]
  ds_read_b64_tr_b16 v[184:185], v22 offset:40960
  v_mfma_f32_16x16x32_bf16 v[124:127], v[220:223], v[92:95], v[124:127]
  ds_read_b64_tr_b16 v[186:187], v22 offset:43008
  v_readlane_b32 s51, v15, 15
  v_mfma_f32_16x16x32_bf16 v[120:123], v[220:223], v[88:91], v[120:123]
  ds_read_b64_tr_b16 v[188:189], v23 offset:40960
  v_mfma_f32_16x16x32_bf16 v[120:123], v[204:207], v[80:83], v[120:123]
  ds_read_b64_tr_b16 v[190:191], v23 offset:43008
  s_waitcnt vmcnt(8) lgkmcnt(8)
  v_mfma_f32_16x16x32_bf16 v[96:99], v[160:163], v[32:35], v[96:99]
  buffer_load_dwordx4 v[80:83], off, s[36:39], s51 offset:0
  v_mfma_f32_16x16x32_bf16 v[96:99], v[176:179], v[40:43], v[96:99]
  ds_read_b64_tr_b16 v[192:193], v20 offset:45056
  ds_read_b64_tr_b16 v[194:195], v20 offset:47104
  v_mfma_f32_16x16x32_bf16 v[100:103], v[176:179], v[44:47], v[100:103]
  ds_read_b64_tr_b16 v[196:197], v21 offset:45056
  v_mfma_f32_16x16x32_bf16 v[100:103], v[160:163], v[36:39], v[100:103]
  buffer_load_dwordx4 v[84:87], off, s[64:67], s51 offset:0
  v_mfma_f32_16x16x32_bf16 v[108:111], v[164:167], v[36:39], v[108:111]
  ds_read_b64_tr_b16 v[198:199], v21 offset:47104
  ds_read_b64_tr_b16 v[208:209], v20 offset:49152
  v_mfma_f32_16x16x32_bf16 v[108:111], v[180:183], v[44:47], v[108:111]
  ds_read_b64_tr_b16 v[210:211], v20 offset:51200
  ds_read_b64_tr_b16 v[212:213], v21 offset:49152
  v_mfma_f32_16x16x32_bf16 v[104:107], v[180:183], v[40:43], v[104:107]
  buffer_load_dwordx4 v[88:91], off, s[36:39], s51 offset:1024
  v_mfma_f32_16x16x32_bf16 v[104:107], v[164:167], v[32:35], v[104:107]
  ds_read_b64_tr_b16 v[214:215], v21 offset:51200
  s_waitcnt lgkmcnt(8)
  v_mfma_f32_16x16x32_bf16 v[112:115], v[168:171], v[32:35], v[112:115]
  ds_read_b64_tr_b16 v[200:201], v22 offset:45056
  v_mfma_f32_16x16x32_bf16 v[112:115], v[184:187], v[40:43], v[112:115]
  buffer_load_dwordx4 v[92:95], off, s[64:67], s51 offset:1024
  v_mfma_f32_16x16x32_bf16 v[116:119], v[184:187], v[44:47], v[116:119]
  ds_read_b64_tr_b16 v[202:203], v22 offset:47104
  ds_read_b64_tr_b16 v[204:205], v23 offset:45056
  v_mfma_f32_16x16x32_bf16 v[116:119], v[168:171], v[36:39], v[116:119]
  ds_read_b64_tr_b16 v[206:207], v23 offset:47104
  v_mfma_f32_16x16x32_bf16 v[124:127], v[172:175], v[36:39], v[124:127]
  ds_read_b64_tr_b16 v[216:217], v22 offset:49152
  v_mfma_f32_16x16x32_bf16 v[124:127], v[188:191], v[44:47], v[124:127]
  ds_read_b64_tr_b16 v[218:219], v22 offset:51200
  v_mfma_f32_16x16x32_bf16 v[120:123], v[188:191], v[40:43], v[120:123]
  ds_read_b64_tr_b16 v[220:221], v23 offset:49152
  v_mfma_f32_16x16x32_bf16 v[120:123], v[172:175], v[32:35], v[120:123]
  ds_read_b64_tr_b16 v[222:223], v23 offset:51200
  s_waitcnt vmcnt(8) lgkmcnt(8)
  v_mfma_f32_16x16x32_bf16 v[96:99], v[192:195], v[48:51], v[96:99]
  ds_read_b64_tr_b16 v[160:161], v20 offset:53248
  v_mfma_f32_16x16x32_bf16 v[96:99], v[208:211], v[56:59], v[96:99]
  ds_read_b64_tr_b16 v[162:163], v20 offset:55296
  v_mfma_f32_16x16x32_bf16 v[100:103], v[208:211], v[60:63], v[100:103]
  ds_read_b64_tr_b16 v[164:165], v21 offset:53248
  v_mfma_f32_16x16x32_bf16 v[100:103], v[192:195], v[52:55], v[100:103]
  ds_read_b64_tr_b16 v[166:167], v21 offset:55296
  v_mfma_f32_16x16x32_bf16 v[108:111], v[196:199], v[52:55], v[108:111]
  ds_read_b64_tr_b16 v[176:177], v20 offset:57344
  v_mfma_f32_16x16x32_bf16 v[108:111], v[212:215], v[60:63], v[108:111]
  ds_read_b64_tr_b16 v[178:179], v20 offset:59392
  v_mfma_f32_16x16x32_bf16 v[104:107], v[212:215], v[56:59], v[104:107]
  ds_read_b64_tr_b16 v[180:181], v21 offset:57344
  v_mfma_f32_16x16x32_bf16 v[104:107], v[196:199], v[48:51], v[104:107]
  ds_read_b64_tr_b16 v[182:183], v21 offset:59392
  s_waitcnt lgkmcnt(8)
  s_barrier
  v_mfma_f32_16x16x32_bf16 v[112:115], v[200:203], v[48:51], v[112:115]
  ds_read_b64_tr_b16 v[168:169], v22 offset:53248
  v_mfma_f32_16x16x32_bf16 v[112:115], v[216:219], v[56:59], v[112:115]
  ds_read_b64_tr_b16 v[170:171], v22 offset:55296
  v_mfma_f32_16x16x32_bf16 v[116:119], v[216:219], v[60:63], v[116:119]
  ds_read_b64_tr_b16 v[172:173], v23 offset:53248
  v_mfma_f32_16x16x32_bf16 v[116:119], v[200:203], v[52:55], v[116:119]
  ds_read_b64_tr_b16 v[174:175], v23 offset:55296
  v_mfma_f32_16x16x32_bf16 v[124:127], v[204:207], v[52:55], v[124:127]
  ds_read_b64_tr_b16 v[184:185], v22 offset:57344
  v_mfma_f32_16x16x32_bf16 v[124:127], v[220:223], v[60:63], v[124:127]
  ds_read_b64_tr_b16 v[186:187], v22 offset:59392
  v_mfma_f32_16x16x32_bf16 v[120:123], v[220:223], v[56:59], v[120:123]
  ds_read_b64_tr_b16 v[188:189], v23 offset:57344
  v_mfma_f32_16x16x32_bf16 v[120:123], v[204:207], v[48:51], v[120:123]
  ds_read_b64_tr_b16 v[190:191], v23 offset:59392
  s_waitcnt vmcnt(4) lgkmcnt(8)
  v_mfma_f32_16x16x32_bf16 v[96:99], v[160:163], v[64:67], v[96:99]
  ds_read_b64_tr_b16 v[192:193], v26 offset:0
  v_mfma_f32_16x16x32_bf16 v[96:99], v[176:179], v[72:75], v[96:99]
  ds_read_b64_tr_b16 v[194:195], v26 offset:2048
  v_mfma_f32_16x16x32_bf16 v[100:103], v[176:179], v[76:79], v[100:103]
  ds_read_b64_tr_b16 v[196:197], v27 offset:0
  v_mfma_f32_16x16x32_bf16 v[100:103], v[160:163], v[68:71], v[100:103]
  ds_read_b64_tr_b16 v[198:199], v27 offset:2048
  v_mfma_f32_16x16x32_bf16 v[108:111], v[164:167], v[68:71], v[108:111]
  ds_read_b64_tr_b16 v[208:209], v26 offset:4096
  v_mfma_f32_16x16x32_bf16 v[108:111], v[180:183], v[76:79], v[108:111]
  ds_read_b64_tr_b16 v[210:211], v26 offset:6144
  v_mfma_f32_16x16x32_bf16 v[104:107], v[180:183], v[72:75], v[104:107]
  ds_read_b64_tr_b16 v[212:213], v27 offset:4096
  v_mfma_f32_16x16x32_bf16 v[104:107], v[164:167], v[64:67], v[104:107]
  ds_read_b64_tr_b16 v[214:215], v27 offset:6144
  s_waitcnt lgkmcnt(8)
  v_mfma_f32_16x16x32_bf16 v[112:115], v[168:171], v[64:67], v[112:115]
  ds_read_b64_tr_b16 v[200:201], v28 offset:0
  v_mfma_f32_16x16x32_bf16 v[112:115], v[184:187], v[72:75], v[112:115]
  ds_read_b64_tr_b16 v[202:203], v28 offset:2048
  v_mfma_f32_16x16x32_bf16 v[116:119], v[184:187], v[76:79], v[116:119]
  ds_read_b64_tr_b16 v[204:205], v29 offset:0
  v_mfma_f32_16x16x32_bf16 v[116:119], v[168:171], v[68:71], v[116:119]
  ds_read_b64_tr_b16 v[206:207], v29 offset:2048
  v_mfma_f32_16x16x32_bf16 v[124:127], v[172:175], v[68:71], v[124:127]
  ds_read_b64_tr_b16 v[216:217], v28 offset:4096
  v_mfma_f32_16x16x32_bf16 v[124:127], v[188:191], v[76:79], v[124:127]
  ds_read_b64_tr_b16 v[218:219], v28 offset:6144
  v_mfma_f32_16x16x32_bf16 v[120:123], v[188:191], v[72:75], v[120:123]
  ds_read_b64_tr_b16 v[220:221], v29 offset:4096
  v_mfma_f32_16x16x32_bf16 v[120:123], v[172:175], v[64:67], v[120:123]
  ds_read_b64_tr_b16 v[222:223], v29 offset:6144
  s_waitcnt vmcnt(0) lgkmcnt(8)
  v_mfma_f32_16x16x32_bf16 v[96:99], v[192:195], v[80:83], v[96:99]
  v_mov_b32 v20, 0x3f803f80
  v_mov_b32 v21, 0x3f803f80
  v_mfma_f32_16x16x32_bf16 v[96:99], v[208:211], v[88:91], v[96:99]
  v_mov_b32 v22, 0x3f803f80
  v_mov_b32 v23, 0x3f803f80
  v_mfma_f32_16x16x32_bf16 v[104:107], v[212:215], v[88:91], v[104:107]
  s_mov_b32 vcc_lo, 0xaaaaaaaa
  s_mov_b32 vcc_hi, vcc_lo
  v_mfma_f32_16x16x32_bf16 v[104:107], v[196:199], v[80:83], v[104:107]
  s_mov_b32 s8, 0xcccccccc
  s_mov_b32 s9, s8
  v_mfma_f32_16x16x32_bf16 v[108:111], v[196:199], v[84:87], v[108:111]
  s_mov_b32 s3, 32768
  v_mfma_f32_16x16x32_bf16 v[108:111], v[212:215], v[92:95], v[108:111]
  v_cvt_pk_bf16_f32 v240, v96, v97
  v_cvt_pk_bf16_f32 v241, v98, v99
  v_mfma_f32_16x16x32_bf16 v[100:103], v[208:211], v[92:95], v[100:103]
  v_cvt_pk_bf16_f32 v242, v104, v105
  v_cvt_pk_bf16_f32 v243, v106, v107
  v_mfma_f32_16x16x32_bf16 v[100:103], v[192:195], v[84:87], v[100:103]
  s_waitcnt lgkmcnt(0)
  buffer_store_dwordx4 v[240:243], v12, s[44:47], 0 offen offset:0 sc1
  v_mfma_f32_16x16x32_bf16 v[112:115], v[200:203], v[80:83], v[112:115]
  ds_write_b128 v19, v[240:243] offset:0
  v_mfma_f32_16x16x32_bf16 v[112:115], v[216:219], v[88:91], v[112:115]
  v_cvt_pk_bf16_f32 v250, v108, v109
  v_cvt_pk_bf16_f32 v251, v110, v111
  v_mfma_f32_16x16x32_bf16 v[120:123], v[220:223], v[88:91], v[120:123]
  v_cvt_pk_bf16_f32 v248, v100, v101
  v_cvt_pk_bf16_f32 v249, v102, v103
  v_mfma_f32_16x16x32_bf16 v[120:123], v[204:207], v[80:83], v[120:123]
  buffer_store_dwordx4 v[248:251], v12, s[44:47], s3 offen offset:0 sc1
  ds_write_b128 v19, v[248:251] offset:2048
  v_mfma_f32_16x16x32_bf16 v[124:127], v[204:207], v[84:87], v[124:127]
  s_nop 0
  v_mfma_f32_16x16x32_bf16 v[124:127], v[220:223], v[92:95], v[124:127]
  v_cvt_pk_bf16_f32 v244, v112, v113
  v_cvt_pk_bf16_f32 v245, v114, v115
  v_mfma_f32_16x16x32_bf16 v[116:119], v[216:219], v[92:95], v[116:119]
  v_cvt_pk_bf16_f32 v246, v120, v121
  v_cvt_pk_bf16_f32 v247, v122, v123
  v_mfma_f32_16x16x32_bf16 v[116:119], v[200:203], v[84:87], v[116:119]
  buffer_store_dwordx4 v[244:247], v12, s[44:47], 0 offen offset:1024 sc1
  ds_write_b128 v19, v[244:247] offset:1024
  v_mfma_f32_16x16x32_bf16 v[132:135], v[240:243], v[240:243], 0
  v_cvt_pk_bf16_f32 v254, v124, v125
  v_cvt_pk_bf16_f32 v255, v126, v127
  v_mfma_f32_16x16x32_bf16 v[128:131], v[20:23], v[240:243], 0
  v_mfma_f32_16x16x32_bf16 v[132:135], v[244:247], v[244:247], v[132:135]
  v_mfma_f32_16x16x32_bf16 v[128:131], v[20:23], v[244:247], v[128:131]
  v_cvt_pk_bf16_f32 v252, v116, v117
  v_cvt_pk_bf16_f32 v253, v118, v119
  v_mfma_f32_16x16x32_bf16 v[140:143], v[248:251], v[248:251], 0
  buffer_store_dwordx4 v[252:255], v12, s[44:47], s3 offen offset:1024 sc1
  ds_write_b128 v19, v[252:255] offset:3072
  v_mfma_f32_16x16x32_bf16 v[136:139], v[20:23], v[248:251], 0
  v_mfma_f32_16x16x32_bf16 v[140:143], v[252:255], v[252:255], v[140:143]
  v_mfma_f32_16x16x32_bf16 v[136:139], v[20:23], v[252:255], v[136:139]
  v_cndmask_b32 v132, v132, v133, vcc
  v_cndmask_b32 v134, v134, v135, vcc
  v_cndmask_b32 v129, v132, v134, s[8:9]
  buffer_store_dwordx2 v[128:129], v18, s[56:59], 0 offen offset:0 sc1
  s_nop 2
  v_cndmask_b32 v140, v140, v141, vcc
  v_cndmask_b32 v142, v142, v143, vcc
  v_cndmask_b32 v137, v140, v142, s[8:9]
  buffer_store_dwordx2 v[136:137], v18, s[56:59], 0 offen offset:128 sc1
  s_waitcnt vmcnt(0) lgkmcnt(0)
  s_barrier
  s_add_u32 s97, s97, 1
  s_branch L_w1_body
L_wo_c1:
L_w1_c0:
L_w1_body:
  s_cmp_ge_u32 s2, 256
  s_cbranch_scc1 L_w1_end
  v_lshrrev_b32 v2, 6, v0
  v_and_b32 v1, 63, v0
  v_readfirstlane_b32 s70, v2
  s_and_b32 s3, s2, 7
  s_lshr_b32 s99, s2, 3
  s_and_b32 s5, s3, 3
  s_lshl_b32 s5, s5, 2
  s_and_b32 s6, s99, 3
  s_add_u32 s68, s5, s6
  s_lshr_b32 s5, s3, 2
  s_lshl_b32 s5, s5, 3
  s_lshr_b32 s6, s99, 2
  s_add_u32 s69, s5, s6
  s_cmp_lt_u32 s70, 4
  s_cbranch_scc1 L_w1_compute
L_w1_loader:
  s_add_u32 s8, s70, s69
  s_and_b32 s8, s8, 3
  s_add_u32 s9, s70, s68
  s_and_b32 s9, s9, 3
  s_lshl_b32 s76, s8, 12
  s_lshl_b32 s77, s9, 11
  s_add_u32 s77, s77, 16384
  s_lshl_b32 s11, s68, 7
  v_and_b32 v10, 7, v1
  s_lshr_b32 s10, s76, 11
  s_lshl_b32 s3, s68, 3
  s_add_u32 s10, s10, s3
  s_mul_i32 s10, s10, 32768
  v_lshl_add_u32 v4, v1, 4, s10
  v_add_u32 v5, 32768, v4
  v_lshrrev_b32 v3, 3, v1
  s_lshl_b32 s10, s9, 4
  v_add_u32 v3, s10, v3
  v_mul_u32_u24 v3, 7168, v3
  v_lshrrev_b32 v2, 3, v1
  v_and_b32 v2, 6, v2
  v_xor_b32 v2, v2, v10
  s_mul_i32 s10, s69, 128
  v_add_u32 v3, s10, v3
  v_lshl_add_u32 v8, v2, 4, v3
  v_add_u32 v3, 57344, v3
  v_lshl_add_u32 v9, v2, 4, v3
  v_lshrrev_b32 v3, 2, v1
  s_lshl_b32 s10, s9, 4
  v_add_u32 v3, s10, v3
  v_mul_u32_u24 v3, 7168, v3
  v_bfe_u32 v2, v1, 4, 1
  v_xor_b32 v2, v2, v1
  v_and_b32 v2, 3, v2
  s_lshl_b32 s10, s69, 6
  s_add_u32 s10, s10, 2048
  v_add_u32 v3, s10, v3
  v_lshl_add_u32 v28, v2, 4, v3
  s_lshl_b32 s78, s69, 7
  s_add_u32 s78, s78, 3072
  s_mov_b32 s75, 0
  s_add_u32 s100, s68, s69
  s_mov_b32 s101, -1
  s_add_u32 s3, s68, s69
  s_and_b32 s3, s3, 3
  s_mov_b32 s100, 0x68532410
  s_mov_b32 s101, 0xfedbac97
  s_cmp_eq_u32 s3, 1
  s_cselect_b32 s100, 0x96435210, s100
  s_cselect_b32 s101, 0xfecbda87, s101
  s_cmp_eq_u32 s3, 2
  s_cselect_b32 s100, 0x75463210, s100
  s_cselect_b32 s101, 0xfdceb98a, s101
  s_cmp_eq_u32 s3, 3
  s_cselect_b32 s100, 0x65743210, s100
  s_cselect_b32 s101, 0xedfca9b8, s101
  s_waitcnt lgkmcnt(0)
  s_mov_b32 s40, s24
  s_and_b32 s41, s25, 0xffff
  s_mov_b32 s42, 7340032
  s_mov_b32 s43, 0x00020000
  s_cmp_lg_u32 s96, 0
  s_cbranch_scc1 L_pfc3_skip
  s_getpc_b64 s[4:5]
L_pfc3:
  s_lshl_b32 s3, s99, 2
  s_add_u32 s3, s3, s70
  s_sub_u32 s3, s3, 4
  s_mul_i32 s3, s3, 192
  s_min_u32 s3, s3, L_w2_c1-L_w2_c0-192
  s_add_i32 s3, s3, L_w2_c0-L_pfc3
  s_ashr_i32 s6, s3, 31
  s_add_u32 s4, s4, s3
  s_addc_u32 s5, s5, s6
  s_load_dword s84, s[4:5], 0
  s_load_dword s84, s[4:5], 64
  s_load_dword s84, s[4:5], 128
L_pfc3_skip:
  s_add_u32 s36, s34, 4194304
  s_addc_u32 s37, s35, 0
  s_and_b32 s37, s37, 0xffff
  s_mov_b32 s38, 4194304
  s_mov_b32 s39, 0x00020000
  s_add_u32 s56, s34, 24117248
  s_addc_u32 s57, s35, 0
  s_and_b32 s57, s57, 0xffff
  s_mov_b32 s58, 262144
  s_mov_b32 s59, 0x00020000
  s_add_u32 s64, s22, 24641536
  s_addc_u32 s65, s23, 0
  s_and_b32 s65, s65, 0xffff
  s_mov_b32 s66, 262144
  s_mov_b32 s67, 0x00020000
  s_mov_b32 s52, s26
  s_and_b32 s53, s27, 0xffff
  s_mov_b32 s54, 7168
  s_mov_b32 s55, 0x00020000
  s_and_b32 s3, s70, 3
  s_lshl2_add_u32 s4, s68, s3
  s_lshl_b32 s4, s4, 8
  v_lshrrev_b32 v2, 4, v1
  v_and_b32 v3, 15, v1
  v_lshl_add_u32 v3, v3, 4, s4
  v_lshl_add_u32 v18, v2, 14, v3
  s_lshl_b32 s4, s69, 7
  s_lshl_b32 s5, s70, 6
  s_add_u32 s4, s4, s5
  s_add_u32 s4, s4, 1216
  s_lshl_b32 s5, s69, 6
  s_cmp_eq_u32 s70, 4
  s_cselect_b32 s4, s5, s4
  s_lshr_b32 s5, s5, 1
  s_add_u32 s5, s5, 1024
  s_cmp_eq_u32 s70, 7
  s_cselect_b32 s4, s5, s4
  v_and_b32 v3, 15, v1
  v_lshl_add_u32 v3, v3, 2, s4
  v_lshrrev_b32 v2, 4, v1
  v_add_lshl_u32 v23, v3, v2, 1
  v_lshlrev_b32 v3, 2, v3
  v_lshl_add_u32 v22, v2, 14, v3
  s_mov_b32 s60, s28
  s_and_b32 s61, s29, 0xffff
  s_mov_b32 s62, 7340032
  s_mov_b32 s63, 0x00020000
  s_cmp_eq_u32 s96, 0
  s_cselect_b32 s62, s62, 0
  s_and_b32 s3, s70, 3
  s_lshl_b32 s4, s2, 2
  s_add_u32 s3, s3, s4
  s_mul_i32 s98, s3, 3584
  s_add_u32 s98, s98, 3670016
  s_buffer_load_dword s84, s[60:63], s98 offset:0
  s_buffer_load_dword s84, s[60:63], s98 offset:64
  s_buffer_load_dword s84, s[60:63], s98 offset:128
  s_buffer_load_dword s84, s[60:63], s98 offset:192
  s_waitcnt vmcnt(0)
  s_barrier
  s_lshr_b32 s3, s69, 3
  s_and_b32 s73, s69, 7
  s_lshl1_add_u32 s91, s73, s3
  s_mul_i32 s74, s91, 458752
  s_lshl_b32 s73, s91, 11
  s_mov_b32 s88, s73
  s_add_u32 m0, s77, 0
  s_add_u32 s4, s74, 0
  buffer_load_dwordx4 v8, s[40:43], s4 offen lds
  s_add_u32 m0, s77, 1024
  s_nop 0
  buffer_load_dwordx4 v9, s[40:43], s4 offen lds
  s_add_u32 m0, s77, 8192
  s_add_u32 s4, s74, s78
  buffer_load_dwordx4 v8, s[40:43], s4 offen lds
  s_add_u32 m0, s77, 9216
  s_nop 0
  buffer_load_dwordx4 v9, s[40:43], s4 offen lds
  s_add_u32 m0, s77, 16384
  s_add_u32 s4, s4, 128
  buffer_load_dwordx4 v8, s[40:43], s4 offen lds
  s_add_u32 m0, s77, 17408
  s_nop 0
  buffer_load_dwordx4 v9, s[40:43], s4 offen lds
  s_add_u32 m0, s77, 24576
  s_nop 0
  buffer_load_dwordx4 v28, s[40:43], s74 offen lds
  s_and_b32 s73, s100, 15
  s_cmp_eq_u32 s73, s91
  s_cselect_b32 s74, 4, 0
  s_lshr_b64 s[100:101], s[100:101], s74
  s_and_b32 s73, s100, 15
  s_lshr_b64 s[100:101], s[100:101], 4
  s_mul_i32 s74, s73, 458752
  s_lshl_b32 s73, s73, 11
  s_add_u32 s3, s96, s70
  s_cmp_lg_u32 s3, 4
  s_cbranch_scc1 L_w1_chkNone
  s_add_u32 s44, s22, 41943040
  s_addc_u32 s45, s23, 0
  s_and_b32 s45, s45, 0xffff
  s_mov_b32 s46, 524288
  s_mov_b32 s47, 0x00020000
  v_lshrrev_b32 v2, 2, v1
  v_and_b32 v3, 3, v1
  v_lshlrev_b32 v2, 11, v2
  v_lshl_add_u32 v17, v3, 4, v2
  s_and_b32 s3, s69, 15
  s_lshl_b32 s3, s3, 7
  s_mov_b32 s79, 0x100000
L_w1_chkl:
  buffer_load_dwordx4 v[12:15], v17, s[44:47], s3 offen sc1
  s_sub_u32 s79, s79, 1
  s_cbranch_scc1 L_w1_chkNone
  s_waitcnt vmcnt(0)
  v_and_b32 v12, v12, v13
  v_and_b32 v14, v14, v15
  v_and_b32 v12, v12, v14
  v_cmp_ne_u32 vcc, 1, v12
  s_cbranch_vccnz L_w1_chkl
L_w1_chkNone:
  s_mov_b32 s75, 0
  s_add_u32 s44, s22, 41943040
  s_addc_u32 s45, s23, 0
  s_and_b32 s45, s45, 0xffff
  s_mov_b32 s46, 524288
  s_mov_b32 s47, 0x00020000
  s_lshl4_add_u32 s3, s97, s68
  s_and_b32 s4, s69, 15
  s_lshl4_add_u32 s3, s3, s4
  s_lshl_b32 s3, s3, 7
  s_sub_u32 s3, s3, 32768
  v_lshlrev_b32 v11, 7, v1
  v_and_b32 v2, 15, v1
  v_lshlrev_b32 v2, 2, v2
  s_getreg_b32 s4, hwreg(HW_REG_XCC_ID, 0, 4)
  v_add_u32 v3, 1, s4
  s_mov_b32 s79, 0x100000
  s_waitcnt vmcnt(0)
  s_cmp_lg_u32 s70, 4
  s_barrier
  s_cbranch_scc1 L_w1_nofl
  s_mov_b32 exec_lo, 0xffff
  s_mov_b32 exec_hi, 0
  buffer_store_dword v3, v11, s[44:47], s87 offen sc1
  s_mov_b64 exec, -1
L_w1_nofl:
  s_mov_b32 s5, s3
  s_mov_b32 s89, s73
  s_add_u32 m0, s77, 49152
  s_add_u32 s4, s74, 0
  buffer_load_dwordx4 v8, s[40:43], s4 offen lds
  s_add_u32 m0, s77, 50176
  s_nop 0
  buffer_load_dwordx4 v9, s[40:43], s4 offen lds
  s_add_u32 m0, s77, 57344
  s_add_u32 s4, s74, s78
  buffer_load_dwordx4 v8, s[40:43], s4 offen lds
  s_add_u32 m0, s77, 58368
  s_nop 0
  buffer_load_dwordx4 v9, s[40:43], s4 offen lds
  s_add_u32 m0, s77, 65536
  s_add_u32 s4, s4, 128
  buffer_load_dwordx4 v8, s[40:43], s4 offen lds
  s_add_u32 m0, s77, 66560
  s_nop 0
  buffer_load_dwordx4 v9, s[40:43], s4 offen lds
  s_add_u32 m0, s77, 73728
  s_nop 0
  buffer_load_dwordx4 v28, s[40:43], s74 offen lds
  s_and_b32 s73, s100, 15
  s_cmp_eq_u32 s73, s91
  s_cselect_b32 s74, 4, 0
  s_lshr_b64 s[100:101], s[100:101], s74
  s_and_b32 s73, s100, 15
  s_lshr_b64 s[100:101], s[100:101], 4
  s_mul_i32 s74, s73, 458752
  s_lshl_b32 s73, s73, 11
  s_mov_b32 s90, s73
  s_add_u32 m0, s77, 98304
  s_add_u32 s4, s74, 0
  buffer_load_dwordx4 v8, s[40:43], s4 offen lds
  s_add_u32 m0, s77, 99328
  s_nop 0
  buffer_load_dwordx4 v9, s[40:43], s4 offen lds
  s_add_u32 m0, s77, 106496
  s_add_u32 s4, s74, s78
  buffer_load_dwordx4 v8, s[40:43], s4 offen lds
  s_add_u32 m0, s77, 107520
  s_nop 0
  buffer_load_dwordx4 v9, s[40:43], s4 offen lds
  s_add_u32 m0, s77, 114688
  s_add_u32 s4, s4, 128
  buffer_load_dwordx4 v8, s[40:43], s4 offen lds
  s_add_u32 m0, s77, 115712
  s_nop 0
  buffer_load_dwordx4 v9, s[40:43], s4 offen lds
  s_add_u32 m0, s77, 122880
  s_nop 0
  buffer_load_dwordx4 v28, s[40:43], s74 offen lds
  s_and_b32 s73, s100, 15
  s_cmp_eq_u32 s73, s91
  s_cselect_b32 s74, 4, 0
  s_lshr_b64 s[100:101], s[100:101], s74
  s_and_b32 s73, s100, 15
  s_lshr_b64 s[100:101], s[100:101], 4
  s_mul_i32 s74, s73, 458752
  s_lshl_b32 s73, s73, 11
  s_mov_b32 s3, s5
  s_cmp_lg_u32 s70, 4
  s_cbranch_scc1 L_w1_dep
L_w1_poll:
  buffer_load_dword v27, v2, s[44:47], s3 offen sc1
  s_sub_u32 s79, s79, 1
  s_cbranch_scc1 L_w1_dep
  s_waitcnt vmcnt(0)
  v_cmp_eq_u32 vcc, 0, v27
  s_cbranch_vccnz L_w1_poll
L_w1_dep:
  s_waitcnt vmcnt(7)
  s_barrier
  s_add_u32 m0, s76, 49152
  s_nop 0
  buffer_load_dwordx4 v4, s[36:39], s89 offen offset:0 lds
  buffer_load_dwordx4 v4, s[36:39], s89 offen offset:1024 lds
  s_add_u32 m0, s76, 51200
  s_nop 0
  buffer_load_dwordx4 v5, s[36:39], s89 offen offset:0 lds
  buffer_load_dwordx4 v5, s[36:39], s89 offen offset:1024 lds
  s_add_u32 m0, s76, 98304
  s_nop 0
  buffer_load_dwordx4 v4, s[36:39], s90 offen offset:0 lds
  buffer_load_dwordx4 v4, s[36:39], s90 offen offset:1024 lds
  s_add_u32 m0, s76, 100352
  s_nop 0
  buffer_load_dwordx4 v5, s[36:39], s90 offen offset:0 lds
  buffer_load_dwordx4 v5, s[36:39], s90 offen offset:1024 lds
  s_waitcnt vmcnt(4)
  s_barrier
  s_mov_b32 s79, 13
L_w1_ld1:
  s_add_u32 s3, s75, s76
  s_add_u32 m0, s3, 0
  s_nop 0
  buffer_load_dwordx4 v4, s[36:39], s73 offen offset:0 lds
  buffer_load_dwordx4 v4, s[36:39], s73 offen offset:1024 lds
  s_add_u32 m0, s3, 2048
  s_nop 0
  buffer_load_dwordx4 v5, s[36:39], s73 offen offset:0 lds
  buffer_load_dwordx4 v5, s[36:39], s73 offen offset:1024 lds
  s_add_u32 s3, s75, s77
  s_add_u32 m0, s3, 0
  s_add_u32 s4, s74, 0
  buffer_load_dwordx4 v8, s[40:43], s4 offen lds
  s_add_u32 m0, s3, 1024
  s_nop 0
  buffer_load_dwordx4 v9, s[40:43], s4 offen lds
  s_add_u32 m0, s3, 8192
  s_add_u32 s4, s74, s78
  buffer_load_dwordx4 v8, s[40:43], s4 offen lds
  s_add_u32 m0, s3, 9216
  s_nop 0
  buffer_load_dwordx4 v9, s[40:43], s4 offen lds
  s_add_u32 m0, s3, 16384
  s_add_u32 s4, s4, 128
  buffer_load_dwordx4 v8, s[40:43], s4 offen lds
  s_add_u32 m0, s3, 17408
  s_nop 0
  buffer_load_dwordx4 v9, s[40:43], s4 offen lds
  s_add_u32 m0, s3, 24576
  s_nop 0
  buffer_load_dwordx4 v28, s[40:43], s74 offen lds
  s_and_b32 s73, s100, 15
  s_cmp_eq_u32 s73, s91
  s_cselect_b32 s74, 4, 0
  s_lshr_b64 s[100:101], s[100:101], s74
  s_and_b32 s73, s100, 15
  s_lshr_b64 s[100:101], s[100:101], 4
  s_mul_i32 s74, s73, 458752
  s_lshl_b32 s73, s73, 11
  s_add_u32 s75, s75, 49152
  s_cmp_eq_u32 s75, 147456
  s_cselect_b32 s75, 0, s75
  s_buffer_load_dword s84, s[60:63], s98 offset:256
  s_buffer_load_dword s84, s[60:63], s98 offset:320
  s_buffer_load_dword s84, s[60:63], s98 offset:384
  s_buffer_load_dword s84, s[60:63], s98 offset:448
  s_add_u32 s98, s98, 256
  s_waitcnt vmcnt(11)
  s_barrier
  s_sub_u32 s79, s79, 1
  s_cmp_lg_u32 s79, 0
  s_cbranch_scc1 L_w1_ld1
  buffer_load_dwordx4 v[32:35], v18, s[56:59], 0 offen
  s_mov_b32 s3, 65536
  buffer_load_dwordx4 v[36:39], v18, s[56:59], s3 offen
  s_mov_b32 s3, 131072
  buffer_load_dwordx4 v[40:43], v18, s[56:59], s3 offen
  s_mov_b32 s3, 196608
  buffer_load_dwordx4 v[44:47], v18, s[56:59], s3 offen
  s_cmp_lg_u32 s96, 0
  s_cbranch_scc1 L_w1_cl
  buffer_load_dwordx4 v[64:67], v22, s[64:67], 0 offen
  s_mov_b32 s3, 65536
  buffer_load_dwordx4 v[68:71], v22, s[64:67], s3 offen
  s_mov_b32 s3, 131072
  buffer_load_dwordx4 v[72:75], v22, s[64:67], s3 offen
  s_mov_b32 s3, 196608
  buffer_load_dwordx4 v[76:79], v22, s[64:67], s3 offen
  buffer_load_ushort v80, v23, s[52:55], 0 offen
  s_branch L_w1_cle
  L_w1_cl:
  s_waitcnt vmcnt(4)
  L_w1_cle:
  s_waitcnt vmcnt(9)
  s_barrier
  s_waitcnt vmcnt(0)
  s_cmp_lg_u32 s96, 0
  s_cbranch_scc1 L_w1_cp
  s_and_b32 s3, s70, 3
  s_lshl_b32 s5, s3, 9
  s_add_u32 s5, s5, 106496
  v_lshrrev_b32 v2, 5, v1
  v_and_b32 v3, 15, v1
  v_lshl_add_u32 v2, v3, 1, v2
  v_lshl_add_u32 v205, v2, 4, s5
  v_add_f32 v64, v64, v68
  v_add_f32 v65, v65, v69
  v_add_f32 v66, v66, v70
  v_add_f32 v67, v67, v71
  v_add_f32 v72, v72, v76
  v_add_f32 v73, v73, v77
  v_add_f32 v74, v74, v78
  v_add_f32 v75, v75, v79
  v_add_f32 v64, v64, v72
  v_add_f32 v65, v65, v73
  v_add_f32 v66, v66, v74
  v_add_f32 v67, v67, v75
  s_nop 1
  v_permlane32_swap_b32 v64, v66
  v_permlane32_swap_b32 v65, v67
  v_add_f32 v64, v64, v66
  v_add_f32 v65, v65, v67
  v_lshl_or_b32 v203, v80, 16, v80
  s_lshl_b32 s5, s3, 10
  s_add_u32 s5, s5, 110592
  v_permlane16_swap_b32 v64, v65
  v_lshrrev_b32 v2, 4, v1
  v_lshl_add_u32 v2, v3, 2, v2
  v_lshl_add_u32 v204, v2, 4, s5
  v_add_f32 v64, v64, v65
  v_cvt_pk_bf16_f32 v200, v64, v64
  v_and_b32 v65, 0xffff0000, v200
  v_sub_f32 v65, v64, v65
  v_cvt_pk_bf16_f32 v201, v64, v65
  v_and_b32 v202, 0xffff0000, v201
  v_sub_f32 v65, v65, v202
  v_cvt_pk_bf16_f32 v202, v65, v64
  v_mov_b32 v200, v201
  L_w1_cp:
  ds_write_b128 v204, v[200:203]
  v_add_f32 v32, v32, v36
  v_add_f32 v33, v33, v37
  v_add_f32 v34, v34, v38
  v_add_f32 v35, v35, v39
  v_add_f32 v40, v40, v44
  v_add_f32 v41, v41, v45
  v_add_f32 v42, v42, v46
  v_add_f32 v43, v43, v47
  v_add_f32 v32, v32, v40
  v_add_f32 v33, v33, v41
  v_add_f32 v34, v34, v42
  v_add_f32 v35, v35, v43
  s_nop 1
  v_permlane32_swap_b32 v32, v34
  v_permlane32_swap_b32 v33, v35
  v_add_f32 v32, v32, v34
  v_add_f32 v33, v33, v35
  v_mov_b32 v34, v32
  v_mov_b32 v35, v33
  s_nop 0
  v_permlane16_swap_b32 v32, v34
  v_permlane16_swap_b32 v33, v35
  v_add_f32 v32, v32, v34
  v_add_f32 v33, v33, v35
  v_mul_f32 v32, 0x3a800000, v32
  v_mul_f32 v33, 0x3a800000, v33
  v_fma_f32 v33, -v32, v32, v33
  v_max_f32 v33, 0, v33
  v_add_f32 v33, 0x3727c5ac, v33
  v_rsq_f32 v34, v33
  v_mul_f32 v32, -0.5, v32
  v_cvt_pk_bf16_f32 v36, v32, v32
  v_and_b32 v35, 0xffff0000, v36
  v_sub_f32 v35, v32, v35
  v_cvt_pk_bf16_f32 v37, v35, v35
  v_and_b32 v38, 0xffff0000, v37
  v_sub_f32 v35, v35, v38
  v_cvt_pk_bf16_f32 v38, v32, v35
  v_mul_f32 v42, v33, v34
  v_mul_f32 v40, 0xc0135761, v34
  v_mul_f32 v34, v34, v34
  v_mul_f32 v33, 0.5, v42
  v_mul_f32 v34, 0x3d372713, v34
  v_cvt_pk_bf16_f32 v35, v33, v33
  v_mul_f32 v41, v40, v34
  v_and_b32 v35, 0xffff0000, v35
  v_xor_b32_dpp v43, v27, v27 row_ror:2 row_mask:0xf bank_mask:0xf
  v_sub_f32 v35, v33, v35
  v_cmp_ne_u32 vcc, 0, v43
  v_cvt_pk_bf16_f32 v39, v33, v35
  s_or_b32 s92, vcc_lo, vcc_hi
  v_mov_b32 v43, s92
  ds_write_b128 v205, v[36:39]
  ds_write_b128 v205, v[40:43] offset:2048
  s_waitcnt lgkmcnt(0)
  s_barrier
  s_lshl_b32 s87, s97, 15
  s_lshl_b32 s4, s68, 11
  s_add_u32 s87, s87, s4
  s_lshl_b32 s4, s69, 2
  s_add_u32 s87, s87, s4
  s_add_u32 s97, s97, 1
  s_branch L_w2_body
L_w1_end:
  s_endpgm
L_w1_compute:
  s_and_b32 s71, s70, 1
  s_lshr_b32 s72, s70, 1
  v_and_b32 v3, 15, v1
  v_lshrrev_b32 v2, 4, v1
  s_lshl_b32 s8, s71, 13
  v_lshl_add_u32 v4, v1, 4, s8
  v_lshrrev_b32 v13, 2, v1
  v_lshlrev_b32 v13, 7, v13
  v_and_b32 v17, 3, v1
  v_lshl_add_u32 v13, v17, 3, v13
  v_bfe_u32 v17, v1, 3, 2
  v_lshl_add_u32 v13, v17, 5, v13
  s_lshl_b32 s9, s72, 6
  v_xor_b32 v13, s9, v13
  v_add_u32 v5, 16384, v13
  v_xor_b32 v6, 32, v5
  v_and_b32 v16, 1, v2
  v_lshrrev_b32 v17, 1, v2
  v_lshrrev_b32 v13, 2, v1
  v_and_b32 v14, 1, v1
  v_lshl_add_u32 v13, v13, 1, v14
  v_xor_b32 v14, s72, v16
  v_lshl_add_u32 v13, v13, 1, v14
  v_bfe_u32 v14, v1, 1, 1
  v_lshl_add_u32 v13, v13, 1, v14
  v_lshlrev_b32 v13, 3, v13
  v_add_u32 v7, 40960, v13
  s_mov_b32 s75, 0
  v_add_u32_e64 v20, s75, v4
  v_add_u32_e64 v21, s75, v5
  v_add_u32_e64 v22, s75, v6
  v_add_u32_e64 v23, s75, v7
  s_add_u32 s75, s75, 49152
  s_cmp_eq_u32 s75, 147456
  s_cselect_b32 s75, 0, s75
  s_mov_b32 s79, 14
  ds_read_b128 v[32:35], v20 offset:0
  ds_read_b128 v[36:39], v20 offset:2048
  ds_read_b128 v[40:43], v20 offset:4096
  ds_read_b128 v[44:47], v20 offset:6144
  ds_read_b64_tr_b16 v[48:49], v21 offset:0
  ds_read_b64_tr_b16 v[50:51], v21 offset:2048
  ds_read_b64_tr_b16 v[52:53], v22 offset:0
  ds_read_b64_tr_b16 v[54:55], v22 offset:2048
  ds_read_b64_tr_b16 v[56:57], v21 offset:8192
  ds_read_b64_tr_b16 v[58:59], v21 offset:10240
  ds_read_b64_tr_b16 v[60:61], v22 offset:8192
  ds_read_b64_tr_b16 v[62:63], v22 offset:10240
  ds_read_b64_tr_b16 v[64:65], v21 offset:16384
  ds_read_b64_tr_b16 v[66:67], v21 offset:18432
  ds_read_b64_tr_b16 v[68:69], v22 offset:16384
  ds_read_b64_tr_b16 v[70:71], v22 offset:18432
  ds_read_b64_tr_b16 v[72:73], v23 offset:0
  ds_read_b64_tr_b16 v[74:75], v23 offset:2048
  s_waitcnt lgkmcnt(0)
  v_mfma_f32_16x16x32_bf16 v[128:131], v[48:51], v[32:35], 0
  ds_read_b128 v[80:83], v20 offset:1024
  v_mfma_f32_16x16x32_bf16 v[132:135], v[48:51], v[36:39], 0
  ds_read_b128 v[84:87], v20 offset:3072
  v_mfma_f32_16x16x32_bf16 v[136:139], v[48:51], v[40:43], 0
  ds_read_b128 v[88:91], v20 offset:5120
  v_mfma_f32_16x16x32_bf16 v[140:143], v[48:51], v[44:47], 0
  ds_read_b128 v[92:95], v20 offset:7168
  v_mfma_f32_16x16x32_bf16 v[156:159], v[52:55], v[44:47], 0
  ds_read_b64_tr_b16 v[96:97], v21 offset:4096
  v_mfma_f32_16x16x32_bf16 v[152:155], v[52:55], v[40:43], 0
  ds_read_b64_tr_b16 v[98:99], v21 offset:6144
  v_mfma_f32_16x16x32_bf16 v[148:151], v[52:55], v[36:39], 0
  ds_read_b64_tr_b16 v[100:101], v22 offset:4096
  v_mfma_f32_16x16x32_bf16 v[144:147], v[52:55], v[32:35], 0
  ds_read_b64_tr_b16 v[102:103], v22 offset:6144
  v_mfma_f32_16x16x32_bf16 v[160:163], v[56:59], v[32:35], 0
  ds_read_b64_tr_b16 v[104:105], v21 offset:12288
  v_mfma_f32_16x16x32_bf16 v[164:167], v[56:59], v[36:39], 0
  ds_read_b64_tr_b16 v[106:107], v21 offset:14336
  v_mfma_f32_16x16x32_bf16 v[168:171], v[56:59], v[40:43], 0
  ds_read_b64_tr_b16 v[108:109], v22 offset:12288
  v_mfma_f32_16x16x32_bf16 v[172:175], v[56:59], v[44:47], 0
  ds_read_b64_tr_b16 v[110:111], v22 offset:14336
  v_mfma_f32_16x16x32_bf16 v[188:191], v[60:63], v[44:47], 0
  ds_read_b64_tr_b16 v[112:113], v21 offset:20480
  v_mfma_f32_16x16x32_bf16 v[184:187], v[60:63], v[40:43], 0
  ds_read_b64_tr_b16 v[114:115], v21 offset:22528
  v_mfma_f32_16x16x32_bf16 v[180:183], v[60:63], v[36:39], 0
  ds_read_b64_tr_b16 v[116:117], v22 offset:20480
  v_mfma_f32_16x16x32_bf16 v[176:179], v[60:63], v[32:35], 0
  ds_read_b64_tr_b16 v[118:119], v22 offset:22528
  v_mfma_f32_16x16x32_bf16 v[192:195], v[64:67], v[32:35], 0
  ds_read_b64_tr_b16 v[120:121], v23 offset:4096
  v_mfma_f32_16x16x32_bf16 v[196:199], v[64:67], v[36:39], 0
  ds_read_b64_tr_b16 v[122:123], v23 offset:6144
  v_mfma_f32_16x16x32_bf16 v[200:203], v[64:67], v[40:43], 0
  v_add_u32_e64 v20, s75, v4
  v_mfma_f32_16x16x32_bf16 v[204:207], v[64:67], v[44:47], 0
  v_add_u32_e64 v21, s75, v5
  v_mfma_f32_16x16x32_bf16 v[220:223], v[68:71], v[44:47], 0
  v_add_u32_e64 v22, s75, v6
  v_mfma_f32_16x16x32_bf16 v[216:219], v[68:71], v[40:43], 0
  v_add_u32_e64 v23, s75, v7
  v_mfma_f32_16x16x32_bf16 v[212:215], v[68:71], v[36:39], 0
  s_add_u32 s75, s75, 49152
  v_mfma_f32_16x16x32_bf16 v[208:211], v[68:71], v[32:35], 0
  s_cmp_eq_u32 s75, 147456
  v_mfma_f32_16x16x32_bf16 v[224:227], v[72:75], v[32:35], 0
  s_cselect_b32 s75, 0, s75
  v_mfma_f32_16x16x32_bf16 v[228:231], v[72:75], v[36:39], 0
  v_mfma_f32_16x16x32_bf16 v[232:235], v[72:75], v[40:43], 0
  v_mfma_f32_16x16x32_bf16 v[236:239], v[72:75], v[44:47], 0
  s_waitcnt lgkmcnt(0)
  v_mfma_f32_16x16x32_bf16 v[128:131], v[96:99], v[80:83], v[128:131]
  v_mfma_f32_16x16x32_bf16 v[132:135], v[96:99], v[84:87], v[132:135]
  v_mfma_f32_16x16x32_bf16 v[136:139], v[96:99], v[88:91], v[136:139]
  v_mfma_f32_16x16x32_bf16 v[140:143], v[96:99], v[92:95], v[140:143]
  v_mfma_f32_16x16x32_bf16 v[156:159], v[100:103], v[92:95], v[156:159]
  v_mfma_f32_16x16x32_bf16 v[152:155], v[100:103], v[88:91], v[152:155]
  v_mfma_f32_16x16x32_bf16 v[148:151], v[100:103], v[84:87], v[148:151]
  v_mfma_f32_16x16x32_bf16 v[144:147], v[100:103], v[80:83], v[144:147]
  v_mfma_f32_16x16x32_bf16 v[160:163], v[104:107], v[80:83], v[160:163]
  v_mfma_f32_16x16x32_bf16 v[164:167], v[104:107], v[84:87], v[164:167]
  v_mfma_f32_16x16x32_bf16 v[168:171], v[104:107], v[88:91], v[168:171]
  v_mfma_f32_16x16x32_bf16 v[172:175], v[104:107], v[92:95], v[172:175]
  v_mfma_f32_16x16x32_bf16 v[188:191], v[108:111], v[92:95], v[188:191]
  v_mfma_f32_16x16x32_bf16 v[184:187], v[108:111], v[88:91], v[184:187]
  v_mfma_f32_16x16x32_bf16 v[180:183], v[108:111], v[84:87], v[180:183]
  v_mfma_f32_16x16x32_bf16 v[176:179], v[108:111], v[80:83], v[176:179]
  v_mfma_f32_16x16x32_bf16 v[192:195], v[112:115], v[80:83], v[192:195]
  v_mfma_f32_16x16x32_bf16 v[196:199], v[112:115], v[84:87], v[196:199]
  v_mfma_f32_16x16x32_bf16 v[200:203], v[112:115], v[88:91], v[200:203]
  v_mfma_f32_16x16x32_bf16 v[204:207], v[112:115], v[92:95], v[204:207]
  v_mfma_f32_16x16x32_bf16 v[220:223], v[116:119], v[92:95], v[220:223]
  v_mfma_f32_16x16x32_bf16 v[216:219], v[116:119], v[88:91], v[216:219]
  v_mfma_f32_16x16x32_bf16 v[212:215], v[116:119], v[84:87], v[212:215]
  v_mfma_f32_16x16x32_bf16 v[208:211], v[116:119], v[80:83], v[208:211]
  v_mfma_f32_16x16x32_bf16 v[224:227], v[120:123], v[80:83], v[224:227]
  v_mfma_f32_16x16x32_bf16 v[228:231], v[120:123], v[84:87], v[228:231]
  v_mfma_f32_16x16x32_bf16 v[232:235], v[120:123], v[88:91], v[232:235]
  v_mfma_f32_16x16x32_bf16 v[236:239], v[120:123], v[92:95], v[236:239]
  s_lshl_b32 s8, s68, 7
  s_lshl_b32 s9, s71, 6
  s_add_u32 s8, s8, s9
  s_mul_i32 s8, s8, 7168
  v_lshlrev_b32 v14, 8, v17
  v_lshl_add_u32 v14, v3, 4, v14
  s_lshl3_add_u32 s9, s71, s72
  s_lshl_b32 s9, s9, 10
  s_add_u32 s9, s9, 114688
  v_lshl_add_u32 v18, v1, 4, s9
  s_mov_b32 s52, s30
  s_and_b32 s53, s31, 0xffff
  s_mov_b32 s54, 2048
  s_mov_b32 s55, 0x00020000
  s_lshr_b32 s9, s69, 3
  s_and_b32 s10, s69, 7
  s_lshl1_add_u32 s9, s10, s9
  s_lshl_b32 s9, s9, 7
  v_lshl_add_u32 v19, v2, 3, s9
  v_add_u32 v14, s8, v14
  s_lshl_b32 s10, s69, 11
  s_lshl_b32 s9, s72, 10
  s_add_u32 s9, s9, s10
  v_lshl_add_u32 v12, v1, 4, s8
  v_add_u32 v12, s9, v12
  v_mul_u32_u24 v16, 114688, v16
  s_lshr_b32 s9, s9, 1
  v_add3_u32 v13, v16, v14, s9
  s_lshl_b32 s9, s71, 10
  s_add_u32 s9, s9, 106496
  v_lshl_add_u32 v14, v3, 4, s9
  s_lshl_b32 s9, s72, 9
  s_add_u32 s9, s9, 110592
  v_lshl_add_u32 v15, v3, 4, s9
  v_bfe_u32 v16, v1, 2, 1
  v_bfe_u32 v17, v1, 3, 1
  v_lshl_add_u32 v17, v16, 2, v17
  v_and_b32 v16, 3, v1
  v_lshl_add_u32 v17, v17, 2, v16
  s_lshl_b32 s9, s72, 7
  s_add_u32 s9, s9, 110592
  v_lshl_add_u32 v16, v17, 4, s9
  v_bfe_u32 v17, v1, 4, 1
  v_lshl_add_u32 v14, v17, 3, v14
  v_lshl_add_u32 v15, v17, 3, v15
  v_lshl_add_u32 v16, v17, 3, v16
  v_mov_b32 v17, 108556
  s_add_u32 s44, s34, 8388608
  s_addc_u32 s45, s35, 0
  s_and_b32 s45, s45, 0xffff
  s_mov_b32 s46, 14680064
  s_mov_b32 s47, 0x00020000
  s_lshr_b32 s3, s69, 3
  s_and_b32 s78, s69, 7
  s_lshl1_add_u32 s69, s78, s3
  s_add_u32 s3, s68, s78
  s_and_b32 s3, s3, 3
  s_mov_b32 s4, 0x1616160
  s_cmp_eq_u32 s3, 1
  s_cselect_b32 s4, 0x5858580, s4
  s_cmp_eq_u32 s3, 2
  s_cselect_b32 s4, 0x16161600, s4
  s_cmp_eq_u32 s3, 3
  s_cselect_b32 s4, 0x58585800, s4
  v_subrev_u32 v2, 3, v1
  v_min_u32 v2, 16, v2
  v_lshlrev_b32 v3, 1, v2
  v_bfe_i32 v30, s4, v3, 2
  v_sub_u32 v30, v1, v30
  v_subrev_u32 v30, 7, v30
  v_ashrrev_i32 v3, 1, v30
  v_cmp_eq_u32 vcc, s78, v3
  s_and_b32 s3, s69, 1
  v_or_b32 v2, 14, v30
  v_cndmask_b32 v2, v30, v2, vcc
  v_cmp_gt_i32 vcc, 0, v30
  s_lshl2_add_u32 s4, s3, 20
  v_add_u32 v30, s4, v30
  s_lshl4_add_u32 s4, s3, 24
  v_add_u32 v2, s4, v2
  v_cndmask_b32 v30, v2, v30, vcc
  s_and_b32 s5, s68, 3
  s_mul_i32 s5, s5, 3
  s_sub_u32 s5, s5, 23
  v_add_u32 v3, s5, v1
  v_subrev_u32 v2, 10, v3
  v_min_u32 v3, v3, v2
  v_subrev_u32 v2, 10, v3
  v_min_u32 v3, v3, v2
  v_cmp_gt_u32 vcc, 23, v1
  s_sub_u32 s5, s3, 46
  v_lshl_add_u32 v2, v1, 1, s5
  v_cndmask_b32 v3, v3, v2, vcc
  s_add_u32 s5, s78, 3
  v_ashrrev_i32 v2, 1, v3
  v_add_u32 v2, s5, v2
  v_and_b32 v2, 7, v2
  v_cmp_gt_u32 vcc, 21, v1
  v_and_b32 v3, 1, v3
  v_lshl_add_u32 v3, v3, 3, v2
  v_cndmask_b32 v3, v3, v30, vcc
  v_lshlrev_b32 v30, 11, v3
  s_barrier
  ds_read_b64_tr_b16 v[48:49], v21 offset:0
  ds_read_b64_tr_b16 v[50:51], v21 offset:2048
  ds_read_b64_tr_b16 v[96:97], v21 offset:4096
  ds_read_b64_tr_b16 v[98:99], v21 offset:6144
  ds_read_b64_tr_b16 v[100:101], v22 offset:4096
  ds_read_b64_tr_b16 v[102:103], v22 offset:6144
  ds_read_b64_tr_b16 v[52:53], v22 offset:0
  ds_read_b64_tr_b16 v[54:55], v22 offset:2048
  ds_read_b64_tr_b16 v[56:57], v21 offset:8192
  ds_read_b64_tr_b16 v[58:59], v21 offset:10240
  ds_read_b64_tr_b16 v[104:105], v21 offset:12288
  ds_read_b64_tr_b16 v[106:107], v21 offset:14336
  ds_read_b64_tr_b16 v[60:61], v22 offset:8192
  ds_read_b64_tr_b16 v[62:63], v22 offset:10240
  ds_read_b64_tr_b16 v[108:109], v22 offset:12288
  ds_read_b64_tr_b16 v[110:111], v22 offset:14336
  v_and_b32 v3, 15, v1
  v_lshrrev_b32 v2, 4, v1
  s_lshl_b32 s8, s68, 7
  s_lshl_b32 s9, s70, 5
  s_add_u32 s8, s8, s9
  v_add_u32 v76, s8, v3
  s_lshl_b32 s14, s69, 7
  v_lshrrev_b32 v79, 1, v2
  v_lshlrev_b32 v26, 3, v3
  v_and_b32 v26, 0x70, v26
  v_lshlrev_b32 v78, 3, v2
  v_xor_b32 v26, v26, v78
  v_lshl_add_u32 v26, v3, 7, v26
  s_lshl_b32 s3, s70, 12
  v_add_u32 v26, s3, v26
  v_lshl_add_u32 v27, v1, 4, s3
  s_cmp_eq_u32 s96, 0
  s_cselect_b32 s7, 128, 0
  s_add_u32 s7, s7, 2048
  v_xor_b32 v78, v1, v2
  v_and_b32 v78, 7, v78
  v_lshl_add_u32 v78, v78, 4, s14
  v_lshrrev_b32 v77, 3, v1
  v_add_u32 v77, s8, v77
  v_mad_u32_u24 v28, v77, s7, v78
  v_bfe_u32 v78, v1, 2, 2
  v_xor_b32 v78, v78, v2
  v_lshl_add_u32 v29, v78, 17, v76
  s_lshl_b32 s14, s69, 14
  v_lshl_add_u32 v29, v29, 3, s14
  v_lshrrev_b32 v8, 2, v1
  v_lshlrev_b32 v8, 7, v8
  v_and_b32 v79, 3, v1
  v_lshl_add_u32 v8, v79, 3, v8
  v_bfe_u32 v79, v1, 3, 2
  v_lshl_add_u32 v8, v79, 5, v8
  s_mov_b32 s11, 0xffff0000
  s_add_u32 s36, s34, 8388608
  s_addc_u32 s37, s35, 0
  s_and_b32 s37, s37, 0xffff
  s_mov_b32 s40, s32
  s_and_b32 s41, s33, 0xffff
  s_mov_b32 s43, 0x00020000
  s_add_u32 s48, s22, 33554432
  s_addc_u32 s49, s23, 0
  s_and_b32 s49, s49, 0xffff
  s_cmp_eq_u32 s96, 0
  s_cselect_b64 s[40:41], s[48:49], s[40:41]
  s_lshl_b32 s42, s7, 11
  s_add_u32 s56, s34, 24379392
  s_addc_u32 s57, s35, 0
  s_and_b32 s57, s57, 0xffff
  s_mov_b32 s58, 262144
  s_mov_b32 s59, 0x00020000
  s_mul_i32 s9, s8, 7168
  s_add_u32 s36, s36, s9
  s_addc_u32 s37, s37, 0x100000
  s_add_u32 s64, s36, 114688
  s_addc_u32 s65, s37, 0
  s_mov_b32 s38, 114688
  s_mov_b32 s39, 0x00800000
  s_mov_b32 s66, 114688
  s_mov_b32 s67, 0x00800000
  s_add_u32 s60, s34, 25165824
  s_addc_u32 s61, s35, 0
  s_and_b32 s61, s61, 0xffff
  s_mov_b32 s62, 4194304
  s_or_b32 s61, s61, 0x100000
  s_mov_b32 s63, 0x00800000
  s_lshl4_add_u32 s4, s68, s69
  s_lshl2_add_u32 s4, s4, s70
  s_add_u32 s6, s96, 4
  s_lshl_b32 s6, s6, 10
  s_add_u32 s6, s6, s4
  s_lshl_b32 s6, s6, 6
  s_lshl_b32 s4, s4, 12
  s_xor_b32 s5, s4, 16384
  v_readlane_b32 s51, v30, 3
  v_readlane_b32 s48, v30, 4
  v_readlane_b32 s49, v30, 5
  s_barrier
  ds_read_b128 v[32:35], v20 offset:0
  ds_read_b128 v[80:83], v20 offset:1024
  ds_read_b128 v[36:39], v20 offset:2048
  ds_read_b128 v[84:87], v20 offset:3072
  ds_read_b128 v[40:43], v20 offset:4096
  ds_read_b128 v[88:91], v20 offset:5120
.p2align 5
  s_nop 0
  s_nop 0
  s_nop 0
  s_waitcnt lgkmcnt(0)
L_w1_loop:
  v_mfma_f32_16x16x32_bf16 v[128:131], v[48:51], v[32:35], v[128:131]
  ds_read_b128 v[92:95], v20 offset:7168
  v_mfma_f32_16x16x32_bf16 v[128:131], v[96:99], v[80:83], v[128:131]
  ds_read_b128 v[44:47], v20 offset:6144
  v_mfma_f32_16x16x32_bf16 v[144:147], v[100:103], v[80:83], v[144:147]
  ds_read_b64_tr_b16 v[64:65], v21 offset:16384
  v_mfma_f32_16x16x32_bf16 v[144:147], v[52:55], v[32:35], v[144:147]
  ds_read_b64_tr_b16 v[66:67], v21 offset:18432
  s_waitcnt lgkmcnt(6)
  s_nop 0
  v_mfma_f32_16x16x32_bf16 v[148:151], v[52:55], v[36:39], v[148:151]
  ds_read_b64_tr_b16 v[112:113], v21 offset:20480
  v_mfma_f32_16x16x32_bf16 v[148:151], v[100:103], v[84:87], v[148:151]
  ds_read_b64_tr_b16 v[114:115], v21 offset:22528
  v_mfma_f32_16x16x32_bf16 v[132:135], v[96:99], v[84:87], v[132:135]
  ds_read_b64_tr_b16 v[68:69], v22 offset:16384
  v_mfma_f32_16x16x32_bf16 v[132:135], v[48:51], v[36:39], v[132:135]
  ds_read_b64_tr_b16 v[70:71], v22 offset:18432
  s_waitcnt lgkmcnt(8)
  s_nop 0
  v_mfma_f32_16x16x32_bf16 v[136:139], v[48:51], v[40:43], v[136:139]
  ds_read_b64_tr_b16 v[116:117], v22 offset:20480
  v_mfma_f32_16x16x32_bf16 v[136:139], v[96:99], v[88:91], v[136:139]
  ds_read_b64_tr_b16 v[118:119], v22 offset:22528
  v_mfma_f32_16x16x32_bf16 v[152:155], v[100:103], v[88:91], v[152:155]
  ds_read_b64_tr_b16 v[120:121], v23 offset:4096
  v_mfma_f32_16x16x32_bf16 v[152:155], v[52:55], v[40:43], v[152:155]
  ds_read_b64_tr_b16 v[122:123], v23 offset:6144
  s_waitcnt lgkmcnt(10)
  s_nop 0
  v_mfma_f32_16x16x32_bf16 v[156:159], v[52:55], v[44:47], v[156:159]
  ds_read_b64_tr_b16 v[72:73], v23 offset:0
  v_mfma_f32_16x16x32_bf16 v[156:159], v[100:103], v[92:95], v[156:159]
  ds_read_b64_tr_b16 v[74:75], v23 offset:2048
  v_mfma_f32_16x16x32_bf16 v[140:143], v[96:99], v[92:95], v[140:143]
  v_add_u32_e64 v20, s75, v4
  v_mfma_f32_16x16x32_bf16 v[140:143], v[48:51], v[44:47], v[140:143]
  v_add_u32_e64 v21, s75, v5
  v_mfma_f32_16x16x32_bf16 v[172:175], v[56:59], v[44:47], v[172:175]
  v_add_u32_e64 v22, s75, v6
  v_mfma_f32_16x16x32_bf16 v[172:175], v[104:107], v[92:95], v[172:175]
  v_add_u32_e64 v23, s75, v7
  v_mfma_f32_16x16x32_bf16 v[168:171], v[104:107], v[88:91], v[168:171]
  s_add_u32 s75, s75, 49152
  v_mfma_f32_16x16x32_bf16 v[168:171], v[56:59], v[40:43], v[168:171]
  s_cmp_eq_u32 s75, 147456
  v_mfma_f32_16x16x32_bf16 v[164:167], v[56:59], v[36:39], v[164:167]
  s_cselect_b32 s75, 0, s75
  s_sub_u32 s79, s79, 1
  v_mfma_f32_16x16x32_bf16 v[164:167], v[104:107], v[84:87], v[164:167]
  v_mfma_f32_16x16x32_bf16 v[160:163], v[104:107], v[80:83], v[160:163]
  v_mfma_f32_16x16x32_bf16 v[160:163], v[56:59], v[32:35], v[160:163]
  v_mfma_f32_16x16x32_bf16 v[176:179], v[60:63], v[32:35], v[176:179]
  v_mfma_f32_16x16x32_bf16 v[176:179], v[108:111], v[80:83], v[176:179]
  v_mfma_f32_16x16x32_bf16 v[180:183], v[108:111], v[84:87], v[180:183]
  v_mfma_f32_16x16x32_bf16 v[180:183], v[60:63], v[36:39], v[180:183]
  s_waitcnt lgkmcnt(0)
  s_barrier
  v_mfma_f32_16x16x32_bf16 v[184:187], v[60:63], v[40:43], v[184:187]
  ds_read_b64_tr_b16 v[48:49], v21 offset:0
  v_mfma_f32_16x16x32_bf16 v[184:187], v[108:111], v[88:91], v[184:187]
  ds_read_b64_tr_b16 v[50:51], v21 offset:2048
  v_mfma_f32_16x16x32_bf16 v[188:191], v[108:111], v[92:95], v[188:191]
  ds_read_b64_tr_b16 v[96:97], v21 offset:4096
  v_mfma_f32_16x16x32_bf16 v[188:191], v[60:63], v[44:47], v[188:191]
  ds_read_b64_tr_b16 v[98:99], v21 offset:6144
  v_mfma_f32_16x16x32_bf16 v[204:207], v[64:67], v[44:47], v[204:207]
  ds_read_b64_tr_b16 v[100:101], v22 offset:4096
  v_mfma_f32_16x16x32_bf16 v[204:207], v[112:115], v[92:95], v[204:207]
  ds_read_b64_tr_b16 v[102:103], v22 offset:6144
  v_mfma_f32_16x16x32_bf16 v[200:203], v[112:115], v[88:91], v[200:203]
  ds_read_b64_tr_b16 v[52:53], v22 offset:0
  v_mfma_f32_16x16x32_bf16 v[200:203], v[64:67], v[40:43], v[200:203]
  ds_read_b64_tr_b16 v[54:55], v22 offset:2048
  v_mfma_f32_16x16x32_bf16 v[196:199], v[64:67], v[36:39], v[196:199]
  ds_read_b64_tr_b16 v[56:57], v21 offset:8192
  v_mfma_f32_16x16x32_bf16 v[196:199], v[112:115], v[84:87], v[196:199]
  ds_read_b64_tr_b16 v[58:59], v21 offset:10240
  v_mfma_f32_16x16x32_bf16 v[192:195], v[112:115], v[80:83], v[192:195]
  ds_read_b64_tr_b16 v[104:105], v21 offset:12288
  v_mfma_f32_16x16x32_bf16 v[192:195], v[64:67], v[32:35], v[192:195]
  ds_read_b64_tr_b16 v[106:107], v21 offset:14336
  v_mfma_f32_16x16x32_bf16 v[208:211], v[68:71], v[32:35], v[208:211]
  ds_read_b64_tr_b16 v[60:61], v22 offset:8192
  v_mfma_f32_16x16x32_bf16 v[208:211], v[116:119], v[80:83], v[208:211]
  ds_read_b64_tr_b16 v[62:63], v22 offset:10240
  v_mfma_f32_16x16x32_bf16 v[224:227], v[120:123], v[80:83], v[224:227]
  ds_read_b128 v[80:83], v20 offset:1024
  v_mfma_f32_16x16x32_bf16 v[224:227], v[72:75], v[32:35], v[224:227]
  ds_read_b128 v[32:35], v20 offset:0
  v_mfma_f32_16x16x32_bf16 v[228:231], v[72:75], v[36:39], v[228:231]
  ds_read_b64_tr_b16 v[108:109], v22 offset:12288
  v_mfma_f32_16x16x32_bf16 v[228:231], v[120:123], v[84:87], v[228:231]
  ds_read_b64_tr_b16 v[110:111], v22 offset:14336
  v_mfma_f32_16x16x32_bf16 v[212:215], v[116:119], v[84:87], v[212:215]
  ds_read_b128 v[84:87], v20 offset:3072
  v_mfma_f32_16x16x32_bf16 v[212:215], v[68:71], v[36:39], v[212:215]
  ds_read_b128 v[36:39], v20 offset:2048
  v_mfma_f32_16x16x32_bf16 v[216:219], v[68:71], v[40:43], v[216:219]
  s_cmp_lg_u32 s79, 0
  s_nop 0
  v_mfma_f32_16x16x32_bf16 v[216:219], v[116:119], v[88:91], v[216:219]
  v_mfma_f32_16x16x32_bf16 v[232:235], v[120:123], v[88:91], v[232:235]
  ds_read_b128 v[88:91], v20 offset:5120
  v_mfma_f32_16x16x32_bf16 v[232:235], v[72:75], v[40:43], v[232:235]
  ds_read_b128 v[40:43], v20 offset:4096
  v_mfma_f32_16x16x32_bf16 v[236:239], v[72:75], v[44:47], v[236:239]
  v_mfma_f32_16x16x32_bf16 v[236:239], v[120:123], v[92:95], v[236:239]
  v_mfma_f32_16x16x32_bf16 v[220:223], v[116:119], v[92:95], v[220:223]
  v_mfma_f32_16x16x32_bf16 v[220:223], v[68:71], v[44:47], v[220:223]
  s_waitcnt lgkmcnt(6)
  s_cbranch_scc1 L_w1_loop
L_w1_lend:
L_w1_exit:
  v_mfma_f32_16x16x32_bf16 v[128:131], v[48:51], v[32:35], v[128:131]
  ds_read_b128 v[44:47], v20 offset:6144
  v_mfma_f32_16x16x32_bf16 v[144:147], v[52:55], v[32:35], v[144:147]
  ds_read_b64_tr_b16 v[64:65], v21 offset:16384
  v_mfma_f32_16x16x32_bf16 v[160:163], v[56:59], v[32:35], v[160:163]
  ds_read_b64_tr_b16 v[66:67], v21 offset:18432
  v_mfma_f32_16x16x32_bf16 v[176:179], v[60:63], v[32:35], v[176:179]
  ds_read_b64_tr_b16 v[68:69], v22 offset:16384
  s_waitcnt lgkmcnt(6)
  v_mfma_f32_16x16x32_bf16 v[132:135], v[48:51], v[36:39], v[132:135]
  ds_read_b64_tr_b16 v[70:71], v22 offset:18432
  v_mfma_f32_16x16x32_bf16 v[148:151], v[52:55], v[36:39], v[148:151]
  ds_read_b64_tr_b16 v[72:73], v23 offset:0
  v_mfma_f32_16x16x32_bf16 v[164:167], v[56:59], v[36:39], v[164:167]
  ds_read_b64_tr_b16 v[74:75], v23 offset:2048
  v_mfma_f32_16x16x32_bf16 v[180:183], v[60:63], v[36:39], v[180:183]
  ds_read_b128 v[92:95], v20 offset:7168
  s_waitcnt lgkmcnt(8)
  v_mfma_f32_16x16x32_bf16 v[136:139], v[48:51], v[40:43], v[136:139]
  ds_read_b64_tr_b16 v[112:113], v21 offset:20480
  v_mfma_f32_16x16x32_bf16 v[152:155], v[52:55], v[40:43], v[152:155]
  ds_read_b64_tr_b16 v[114:115], v21 offset:22528
  v_mfma_f32_16x16x32_bf16 v[168:171], v[56:59], v[40:43], v[168:171]
  ds_read_b64_tr_b16 v[116:117], v22 offset:20480
  v_mfma_f32_16x16x32_bf16 v[184:187], v[60:63], v[40:43], v[184:187]
  ds_read_b64_tr_b16 v[118:119], v22 offset:22528
  s_waitcnt lgkmcnt(11)
  v_mfma_f32_16x16x32_bf16 v[140:143], v[48:51], v[44:47], v[140:143]
  ds_read_b64_tr_b16 v[120:121], v23 offset:4096
  v_mfma_f32_16x16x32_bf16 v[156:159], v[52:55], v[44:47], v[156:159]
  ds_read_b64_tr_b16 v[122:123], v23 offset:6144
  v_mfma_f32_16x16x32_bf16 v[172:175], v[56:59], v[44:47], v[172:175]
  v_and_b32 v76, -9, v14
  v_mfma_f32_16x16x32_bf16 v[188:191], v[60:63], v[44:47], v[188:191]
  s_waitcnt lgkmcnt(11)
  v_mfma_f32_16x16x32_bf16 v[192:195], v[64:67], v[32:35], v[192:195]
  v_mfma_f32_16x16x32_bf16 v[196:199], v[64:67], v[36:39], v[196:199]
  v_mfma_f32_16x16x32_bf16 v[200:203], v[64:67], v[40:43], v[200:203]
  v_mfma_f32_16x16x32_bf16 v[204:207], v[64:67], v[44:47], v[204:207]
  s_waitcnt lgkmcnt(9)
  v_mfma_f32_16x16x32_bf16 v[220:223], v[68:71], v[44:47], v[220:223]
  v_mfma_f32_16x16x32_bf16 v[216:219], v[68:71], v[40:43], v[216:219]
  v_mfma_f32_16x16x32_bf16 v[212:215], v[68:71], v[36:39], v[212:215]
  v_mfma_f32_16x16x32_bf16 v[208:211], v[68:71], v[32:35], v[208:211]
  s_waitcnt lgkmcnt(7)
  v_mfma_f32_16x16x32_bf16 v[224:227], v[72:75], v[32:35], v[224:227]
  v_mfma_f32_16x16x32_bf16 v[228:231], v[72:75], v[36:39], v[228:231]
  v_mfma_f32_16x16x32_bf16 v[232:235], v[72:75], v[40:43], v[232:235]
  v_mfma_f32_16x16x32_bf16 v[236:239], v[72:75], v[44:47], v[236:239]
  s_waitcnt lgkmcnt(0)
  s_barrier
  v_mfma_f32_16x16x32_bf16 v[128:131], v[96:99], v[80:83], v[128:131]
  ds_read_b64 v[46:47], v14 offset:0
  ds_read_b64 v[32:33], v15 offset:0
  v_mfma_f32_16x16x32_bf16 v[132:135], v[96:99], v[84:87], v[132:135]
  ds_read_b64 v[34:35], v15 offset:256
  ds_read_b128 v[56:59], v76 offset:2048
  v_mfma_f32_16x16x32_bf16 v[136:139], v[96:99], v[88:91], v[136:139]
  ds_read_b32 v17, v17
  ds_read_b64 v[48:49], v14 offset:256
  v_mfma_f32_16x16x32_bf16 v[140:143], v[96:99], v[92:95], v[140:143]
  ds_read_b128 v[60:63], v76 offset:2304
  ds_read_b64 v[50:51], v14 offset:512
  v_mfma_f32_16x16x32_bf16 v[156:159], v[100:103], v[92:95], v[156:159]
  ds_read_b128 v[64:67], v76 offset:2560
  ds_read_b64 v[52:53], v14 offset:768
  v_mfma_f32_16x16x32_bf16 v[152:155], v[100:103], v[88:91], v[152:155]
  ds_read_b128 v[68:71], v76 offset:2816
  ds_read_b64 v[44:45], v16 offset:3072
  v_mfma_f32_16x16x32_bf16 v[148:151], v[100:103], v[84:87], v[148:151]
  ds_read_b64 v[36:37], v15 offset:1024
  ds_read_b64 v[38:39], v15 offset:1280
  v_mfma_f32_16x16x32_bf16 v[144:147], v[100:103], v[80:83], v[144:147]
  ds_read_b64 v[40:41], v15 offset:2048
  ds_read_b64 v[42:43], v15 offset:2304
  v_mfma_f32_16x16x32_bf16 v[160:163], v[104:107], v[80:83], v[160:163]
  v_mfma_f32_16x16x32_bf16 v[164:167], v[104:107], v[84:87], v[164:167]
  buffer_load_dwordx2 v[10:11], v19, s[52:55], 0 offen offset:0
  v_mfma_f32_16x16x32_bf16 v[168:171], v[104:107], v[88:91], v[168:171]
  buffer_load_dwordx2 v[24:25], v19, s[52:55], 0 offen offset:32
  v_mfma_f32_16x16x32_bf16 v[172:175], v[104:107], v[92:95], v[172:175]
  buffer_load_dwordx2 v[124:125], v19, s[52:55], 0 offen offset:64
  v_mfma_f32_16x16x32_bf16 v[188:191], v[108:111], v[92:95], v[188:191]
  buffer_load_dwordx2 v[126:127], v19, s[52:55], 0 offen offset:96
  v_mfma_f32_16x16x32_bf16 v[184:187], v[108:111], v[88:91], v[184:187]
  v_mfma_f32_16x16x32_bf16 v[180:183], v[108:111], v[84:87], v[180:183]
  s_waitcnt lgkmcnt(0)
  v_mfma_f32_16x16x16_bf16 v[128:131], v[32:33], v[46:47], v[128:131]
  v_readfirstlane_b32 s98, v17
  v_mfma_f32_16x16x32_bf16 v[176:179], v[108:111], v[80:83], v[176:179]
  v_mfma_f32_16x16x32_bf16 v[192:195], v[112:115], v[80:83], v[192:195]
  s_cmp_lg_u32 s98, 0
  s_cselect_b32 s98, 34603008, 0
  v_mfma_f32_16x16x32_bf16 v[196:199], v[112:115], v[84:87], v[196:199]
  s_add_u32 s44, s44, s98
  s_addc_u32 s45, s45, 0
  v_mfma_f32_16x16x32_bf16 v[200:203], v[112:115], v[88:91], v[200:203]
  s_add_u32 s36, s36, s98
  s_addc_u32 s37, s37, 0
  v_mfma_f32_16x16x32_bf16 v[204:207], v[112:115], v[92:95], v[204:207]
  s_add_u32 s64, s64, s98
  s_addc_u32 s65, s65, 0
  v_mfma_f32_16x16x32_bf16 v[220:223], v[116:119], v[92:95], v[220:223]
  s_mov_b32 s3, 114688
  s_mov_b32 s8, 229376
  v_mfma_f32_16x16x32_bf16 v[216:219], v[116:119], v[88:91], v[216:219]
  s_mov_b32 s9, 344064
  s_add_u32 s10, s10, 49152
  v_mfma_f32_16x16x32_bf16 v[212:215], v[116:119], v[84:87], v[212:215]
  v_add_u32 v17, s10, v12
  v_add_u32 v13, 0x8000, v13
  v_mfma_f32_16x16x32_bf16 v[208:211], v[116:119], v[80:83], v[208:211]
  v_mfma_f32_16x16x32_bf16 v[224:227], v[120:123], v[80:83], v[224:227]
  v_mfma_f32_16x16x32_bf16 v[228:231], v[120:123], v[84:87], v[228:231]
  v_mfma_f32_16x16x32_bf16 v[232:235], v[120:123], v[88:91], v[232:235]
  v_mfma_f32_16x16x32_bf16 v[236:239], v[120:123], v[92:95], v[236:239]
  v_pk_mul_f32 v[100:101], v[128:129], v[128:129]
  v_pk_mul_f32 v[102:103], v[130:131], v[130:131]
  v_pk_fma_f32 v[100:101], v[100:101], v[56:57], v[56:57] op_sel:[0,1,0] op_sel_hi:[1,1,0]
  v_pk_fma_f32 v[102:103], v[102:103], v[56:57], v[56:57] op_sel:[0,1,0] op_sel_hi:[1,1,0]
  v_pk_mul_f32 v[100:101], v[100:101], v[128:129]
  v_pk_mul_f32 v[102:103], v[102:103], v[130:131]
  v_mfma_f32_16x16x16_bf16 v[144:147], v[34:35], v[46:47], v[144:147]
  v_exp_f32 v100, v100
  v_exp_f32 v101, v101
  v_exp_f32 v102, v102
  v_exp_f32 v103, v103
  v_pk_fma_f32 v[100:101], v[100:101], v[58:59], v[58:59] op_sel_hi:[1,0,0]
  v_pk_fma_f32 v[102:103], v[102:103], v[58:59], v[58:59] op_sel_hi:[1,0,0]
  v_rcp_f32 v100, v100
  v_rcp_f32 v101, v101
  v_rcp_f32 v102, v102
  v_rcp_f32 v103, v103
  v_pk_mul_f32 v[128:129], v[128:129], v[100:101]
  v_pk_mul_f32 v[130:131], v[130:131], v[102:103]
  v_cvt_pk_bf16_f32 v108, v128, v129
  v_cvt_pk_bf16_f32 v109, v130, v131
  v_pk_mul_f32 v[104:105], v[144:145], v[144:145]
  v_pk_mul_f32 v[106:107], v[146:147], v[146:147]
  v_pk_fma_f32 v[104:105], v[104:105], v[56:57], v[56:57] op_sel:[0,1,0] op_sel_hi:[1,1,0]
  v_pk_fma_f32 v[106:107], v[106:107], v[56:57], v[56:57] op_sel:[0,1,0] op_sel_hi:[1,1,0]
  v_pk_mul_f32 v[104:105], v[104:105], v[144:145]
  v_pk_mul_f32 v[106:107], v[106:107], v[146:147]
  v_mfma_f32_16x16x16_bf16 v[132:135], v[32:33], v[48:49], v[132:135]
  v_exp_f32 v104, v104
  v_exp_f32 v105, v105
  v_exp_f32 v106, v106
  v_exp_f32 v107, v107
  v_pk_fma_f32 v[104:105], v[104:105], v[58:59], v[58:59] op_sel_hi:[1,0,0]
  v_pk_fma_f32 v[106:107], v[106:107], v[58:59], v[58:59] op_sel_hi:[1,0,0]
  v_rcp_f32 v104, v104
  v_rcp_f32 v105, v105
  v_rcp_f32 v106, v106
  v_rcp_f32 v107, v107
  v_pk_mul_f32 v[144:145], v[144:145], v[104:105]
  v_pk_mul_f32 v[146:147], v[146:147], v[106:107]
  v_cvt_pk_bf16_f32 v110, v144, v145
  v_cvt_pk_bf16_f32 v111, v146, v147
  buffer_store_dwordx4 v[108:111], v12, s[44:47], 0 offen sc1
  ds_write_b128 v18, v[108:111] offset:32768
  v_pk_mul_f32 v[100:101], v[132:133], v[132:133]
  v_pk_mul_f32 v[102:103], v[134:135], v[134:135]
  v_pk_fma_f32 v[100:101], v[100:101], v[60:61], v[60:61] op_sel:[0,1,0] op_sel_hi:[1,1,0]
  v_pk_fma_f32 v[102:103], v[102:103], v[60:61], v[60:61] op_sel:[0,1,0] op_sel_hi:[1,1,0]
  v_pk_mul_f32 v[100:101], v[100:101], v[132:133]
  v_pk_mul_f32 v[102:103], v[102:103], v[134:135]
  v_mfma_f32_16x16x16_bf16 v[148:151], v[34:35], v[48:49], v[148:151]
  v_exp_f32 v100, v100
  v_exp_f32 v101, v101
  v_exp_f32 v102, v102
  v_exp_f32 v103, v103
  v_pk_fma_f32 v[100:101], v[100:101], v[62:63], v[62:63] op_sel_hi:[1,0,0]
  v_pk_fma_f32 v[102:103], v[102:103], v[62:63], v[62:63] op_sel_hi:[1,0,0]
  v_rcp_f32 v100, v100
  v_rcp_f32 v101, v101
  v_rcp_f32 v102, v102
  v_rcp_f32 v103, v103
  v_pk_mul_f32 v[132:133], v[132:133], v[100:101]
  v_pk_mul_f32 v[134:135], v[134:135], v[102:103]
  v_cvt_pk_bf16_f32 v112, v132, v133
  v_cvt_pk_bf16_f32 v113, v134, v135
  v_pk_mul_f32 v[104:105], v[148:149], v[148:149]
  v_pk_mul_f32 v[106:107], v[150:151], v[150:151]
  v_pk_fma_f32 v[104:105], v[104:105], v[60:61], v[60:61] op_sel:[0,1,0] op_sel_hi:[1,1,0]
  v_pk_fma_f32 v[106:107], v[106:107], v[60:61], v[60:61] op_sel:[0,1,0] op_sel_hi:[1,1,0]
  v_pk_mul_f32 v[104:105], v[104:105], v[148:149]
  v_pk_mul_f32 v[106:107], v[106:107], v[150:151]
  v_mfma_f32_16x16x16_bf16 v[136:139], v[32:33], v[50:51], v[136:139]
  v_exp_f32 v104, v104
  v_exp_f32 v105, v105
  v_exp_f32 v106, v106
  v_exp_f32 v107, v107
  v_pk_fma_f32 v[104:105], v[104:105], v[62:63], v[62:63] op_sel_hi:[1,0,0]
  v_pk_fma_f32 v[106:107], v[106:107], v[62:63], v[62:63] op_sel_hi:[1,0,0]
  v_rcp_f32 v104, v104
  v_rcp_f32 v105, v105
  v_rcp_f32 v106, v106
  v_rcp_f32 v107, v107
  v_pk_mul_f32 v[148:149], v[148:149], v[104:105]
  v_pk_mul_f32 v[150:151], v[150:151], v[106:107]
  v_cvt_pk_bf16_f32 v114, v148, v149
  v_cvt_pk_bf16_f32 v115, v150, v151
  buffer_store_dwordx4 v[112:115], v12, s[44:47], s3 offen sc1
  ds_write_b128 v18, v[112:115] offset:34816
  v_pk_mul_f32 v[100:101], v[136:137], v[136:137]
  v_pk_mul_f32 v[102:103], v[138:139], v[138:139]
  v_pk_fma_f32 v[100:101], v[100:101], v[64:65], v[64:65] op_sel:[0,1,0] op_sel_hi:[1,1,0]
  v_pk_fma_f32 v[102:103], v[102:103], v[64:65], v[64:65] op_sel:[0,1,0] op_sel_hi:[1,1,0]
  v_pk_mul_f32 v[100:101], v[100:101], v[136:137]
  v_pk_mul_f32 v[102:103], v[102:103], v[138:139]
  v_mfma_f32_16x16x16_bf16 v[152:155], v[34:35], v[50:51], v[152:155]
  v_exp_f32 v100, v100
  v_exp_f32 v101, v101
  v_exp_f32 v102, v102
  v_exp_f32 v103, v103
  v_pk_fma_f32 v[100:101], v[100:101], v[66:67], v[66:67] op_sel_hi:[1,0,0]
  v_pk_fma_f32 v[102:103], v[102:103], v[66:67], v[66:67] op_sel_hi:[1,0,0]
  v_rcp_f32 v100, v100
  v_rcp_f32 v101, v101
  v_rcp_f32 v102, v102
  v_rcp_f32 v103, v103
  v_pk_mul_f32 v[136:137], v[136:137], v[100:101]
  v_pk_mul_f32 v[138:139], v[138:139], v[102:103]
  v_cvt_pk_bf16_f32 v116, v136, v137
  v_cvt_pk_bf16_f32 v117, v138, v139
  v_pk_mul_f32 v[104:105], v[152:153], v[152:153]
  v_pk_mul_f32 v[106:107], v[154:155], v[154:155]
  v_pk_fma_f32 v[104:105], v[104:105], v[64:65], v[64:65] op_sel:[0,1,0] op_sel_hi:[1,1,0]
  v_pk_fma_f32 v[106:107], v[106:107], v[64:65], v[64:65] op_sel:[0,1,0] op_sel_hi:[1,1,0]
  v_pk_mul_f32 v[104:105], v[104:105], v[152:153]
  v_pk_mul_f32 v[106:107], v[106:107], v[154:155]
  v_mfma_f32_16x16x16_bf16 v[140:143], v[32:33], v[52:53], v[140:143]
  v_exp_f32 v104, v104
  v_exp_f32 v105, v105
  v_exp_f32 v106, v106
  v_exp_f32 v107, v107
  v_pk_fma_f32 v[104:105], v[104:105], v[66:67], v[66:67] op_sel_hi:[1,0,0]
  v_pk_fma_f32 v[106:107], v[106:107], v[66:67], v[66:67] op_sel_hi:[1,0,0]
  v_rcp_f32 v104, v104
  v_rcp_f32 v105, v105
  v_rcp_f32 v106, v106
  v_rcp_f32 v107, v107
  v_pk_mul_f32 v[152:153], v[152:153], v[104:105]
  v_pk_mul_f32 v[154:155], v[154:155], v[106:107]
  v_cvt_pk_bf16_f32 v118, v152, v153
  v_cvt_pk_bf16_f32 v119, v154, v155
  buffer_store_dwordx4 v[116:119], v12, s[44:47], s8 offen sc1
  ds_write_b128 v18, v[116:119] offset:36864
  v_pk_mul_f32 v[100:101], v[140:141], v[140:141]
  v_pk_mul_f32 v[102:103], v[142:143], v[142:143]
  v_pk_fma_f32 v[100:101], v[100:101], v[68:69], v[68:69] op_sel:[0,1,0] op_sel_hi:[1,1,0]
  v_pk_fma_f32 v[102:103], v[102:103], v[68:69], v[68:69] op_sel:[0,1,0] op_sel_hi:[1,1,0]
  v_pk_mul_f32 v[100:101], v[100:101], v[140:141]
  v_pk_mul_f32 v[102:103], v[102:103], v[142:143]
  v_mfma_f32_16x16x16_bf16 v[156:159], v[34:35], v[52:53], v[156:159]
  v_exp_f32 v100, v100
  v_exp_f32 v101, v101
  v_exp_f32 v102, v102
  v_exp_f32 v103, v103
  v_pk_fma_f32 v[100:101], v[100:101], v[70:71], v[70:71] op_sel_hi:[1,0,0]
  v_pk_fma_f32 v[102:103], v[102:103], v[70:71], v[70:71] op_sel_hi:[1,0,0]
  v_rcp_f32 v100, v100
  v_rcp_f32 v101, v101
  v_rcp_f32 v102, v102
  v_rcp_f32 v103, v103
  v_pk_mul_f32 v[140:141], v[140:141], v[100:101]
  v_pk_mul_f32 v[142:143], v[142:143], v[102:103]
  v_cvt_pk_bf16_f32 v120, v140, v141
  v_cvt_pk_bf16_f32 v121, v142, v143
  v_pk_mul_f32 v[104:105], v[156:157], v[156:157]
  v_pk_mul_f32 v[106:107], v[158:159], v[158:159]
  v_pk_fma_f32 v[104:105], v[104:105], v[68:69], v[68:69] op_sel:[0,1,0] op_sel_hi:[1,1,0]
  v_pk_fma_f32 v[106:107], v[106:107], v[68:69], v[68:69] op_sel:[0,1,0] op_sel_hi:[1,1,0]
  v_pk_mul_f32 v[104:105], v[104:105], v[156:157]
  v_pk_mul_f32 v[106:107], v[106:107], v[158:159]
  v_mfma_f32_16x16x16_bf16 v[224:227], v[44:45], v[46:47], v[224:227]
  v_exp_f32 v104, v104
  v_exp_f32 v105, v105
  v_exp_f32 v106, v106
  v_exp_f32 v107, v107
  v_pk_fma_f32 v[104:105], v[104:105], v[70:71], v[70:71] op_sel_hi:[1,0,0]
  v_pk_fma_f32 v[106:107], v[106:107], v[70:71], v[70:71] op_sel_hi:[1,0,0]
  v_rcp_f32 v104, v104
  v_rcp_f32 v105, v105
  v_rcp_f32 v106, v106
  v_rcp_f32 v107, v107
  v_pk_mul_f32 v[156:157], v[156:157], v[104:105]
  v_pk_mul_f32 v[158:159], v[158:159], v[106:107]
  v_cvt_pk_bf16_f32 v122, v156, v157
  v_cvt_pk_bf16_f32 v123, v158, v159
  buffer_store_dwordx4 v[120:123], v12, s[44:47], s9 offen sc1
  ds_write_b128 v18, v[120:123] offset:38912
  v_pk_mul_f32 v[100:101], v[224:225], v[224:225]
  v_pk_mul_f32 v[102:103], v[226:227], v[226:227]
  v_pk_fma_f32 v[100:101], v[100:101], v[56:57], v[56:57] op_sel:[0,1,0] op_sel_hi:[1,1,0]
  v_pk_fma_f32 v[102:103], v[102:103], v[56:57], v[56:57] op_sel:[0,1,0] op_sel_hi:[1,1,0]
  v_pk_mul_f32 v[100:101], v[100:101], v[224:225]
  v_pk_mul_f32 v[102:103], v[102:103], v[226:227]
  v_mfma_f32_16x16x16_bf16 v[228:231], v[44:45], v[48:49], v[228:231]
  v_exp_f32 v100, v100
  v_exp_f32 v101, v101
  v_exp_f32 v102, v102
  v_exp_f32 v103, v103
  v_pk_fma_f32 v[100:101], v[100:101], v[58:59], v[58:59] op_sel_hi:[1,0,0]
  v_pk_fma_f32 v[102:103], v[102:103], v[58:59], v[58:59] op_sel_hi:[1,0,0]
  v_rcp_f32 v100, v100
  v_rcp_f32 v101, v101
  v_rcp_f32 v102, v102
  v_rcp_f32 v103, v103
  v_pk_mul_f32 v[224:225], v[224:225], v[100:101]
  v_pk_mul_f32 v[226:227], v[226:227], v[102:103]
  v_cvt_pk_bf16_f32 v108, v224, v225
  v_cvt_pk_bf16_f32 v109, v226, v227
  v_pk_mul_f32 v[100:101], v[228:229], v[228:229]
  v_pk_mul_f32 v[102:103], v[230:231], v[230:231]
  v_pk_fma_f32 v[100:101], v[100:101], v[60:61], v[60:61] op_sel:[0,1,0] op_sel_hi:[1,1,0]
  v_pk_fma_f32 v[102:103], v[102:103], v[60:61], v[60:61] op_sel:[0,1,0] op_sel_hi:[1,1,0]
  v_pk_mul_f32 v[100:101], v[100:101], v[228:229]
  v_pk_mul_f32 v[102:103], v[102:103], v[230:231]
  v_mfma_f32_16x16x16_bf16 v[232:235], v[44:45], v[50:51], v[232:235]
  v_exp_f32 v100, v100
  v_exp_f32 v101, v101
  v_exp_f32 v102, v102
  v_exp_f32 v103, v103
  v_pk_fma_f32 v[100:101], v[100:101], v[62:63], v[62:63] op_sel_hi:[1,0,0]
  v_pk_fma_f32 v[102:103], v[102:103], v[62:63], v[62:63] op_sel_hi:[1,0,0]
  v_rcp_f32 v100, v100
  v_rcp_f32 v101, v101
  v_rcp_f32 v102, v102
  v_rcp_f32 v103, v103
  v_pk_mul_f32 v[228:229], v[228:229], v[100:101]
  v_pk_mul_f32 v[230:231], v[230:231], v[102:103]
  v_cvt_pk_bf16_f32 v110, v228, v229
  v_cvt_pk_bf16_f32 v111, v230, v231
  s_nop 1
  v_permlane16_swap_b32 v108, v110
  v_permlane16_swap_b32 v109, v111
  buffer_store_dwordx4 v[108:111], v13, s[44:47], 0 offen sc1
  v_pk_mul_f32 v[100:101], v[232:233], v[232:233]
  v_pk_mul_f32 v[102:103], v[234:235], v[234:235]
  v_pk_fma_f32 v[100:101], v[100:101], v[64:65], v[64:65] op_sel:[0,1,0] op_sel_hi:[1,1,0]
  v_pk_fma_f32 v[102:103], v[102:103], v[64:65], v[64:65] op_sel:[0,1,0] op_sel_hi:[1,1,0]
  v_pk_mul_f32 v[100:101], v[100:101], v[232:233]
  v_pk_mul_f32 v[102:103], v[102:103], v[234:235]
  v_mfma_f32_16x16x16_bf16 v[236:239], v[44:45], v[52:53], v[236:239]
  v_exp_f32 v100, v100
  v_exp_f32 v101, v101
  v_exp_f32 v102, v102
  v_exp_f32 v103, v103
  v_pk_fma_f32 v[100:101], v[100:101], v[66:67], v[66:67] op_sel_hi:[1,0,0]
  v_pk_fma_f32 v[102:103], v[102:103], v[66:67], v[66:67] op_sel_hi:[1,0,0]
  v_rcp_f32 v100, v100
  v_rcp_f32 v101, v101
  v_rcp_f32 v102, v102
  v_rcp_f32 v103, v103
  v_pk_mul_f32 v[232:233], v[232:233], v[100:101]
  v_pk_mul_f32 v[234:235], v[234:235], v[102:103]
  v_cvt_pk_bf16_f32 v112, v232, v233
  v_cvt_pk_bf16_f32 v113, v234, v235
  v_pk_mul_f32 v[100:101], v[236:237], v[236:237]
  v_pk_mul_f32 v[102:103], v[238:239], v[238:239]
  v_pk_fma_f32 v[100:101], v[100:101], v[68:69], v[68:69] op_sel:[0,1,0] op_sel_hi:[1,1,0]
  v_pk_fma_f32 v[102:103], v[102:103], v[68:69], v[68:69] op_sel:[0,1,0] op_sel_hi:[1,1,0]
  v_pk_mul_f32 v[100:101], v[100:101], v[236:237]
  v_pk_mul_f32 v[102:103], v[102:103], v[238:239]
  v_mfma_f32_16x16x16_bf16 v[160:163], v[36:37], v[46:47], v[160:163]
  v_exp_f32 v100, v100
  v_exp_f32 v101, v101
  v_exp_f32 v102, v102
  v_exp_f32 v103, v103
  v_pk_fma_f32 v[100:101], v[100:101], v[70:71], v[70:71] op_sel_hi:[1,0,0]
  v_pk_fma_f32 v[102:103], v[102:103], v[70:71], v[70:71] op_sel_hi:[1,0,0]
  v_rcp_f32 v100, v100
  v_rcp_f32 v101, v101
  v_rcp_f32 v102, v102
  v_rcp_f32 v103, v103
  v_pk_mul_f32 v[236:237], v[236:237], v[100:101]
  v_pk_mul_f32 v[238:239], v[238:239], v[102:103]
  v_cvt_pk_bf16_f32 v114, v236, v237
  v_cvt_pk_bf16_f32 v115, v238, v239
  s_nop 1
  v_permlane16_swap_b32 v112, v114
  v_permlane16_swap_b32 v113, v115
  buffer_store_dwordx4 v[112:115], v13, s[44:47], s8 offen sc1
  v_pk_mul_f32 v[100:101], v[160:161], v[160:161]
  v_pk_mul_f32 v[102:103], v[162:163], v[162:163]
  v_pk_fma_f32 v[100:101], v[100:101], v[56:57], v[56:57] op_sel:[0,1,0] op_sel_hi:[1,1,0]
  v_pk_fma_f32 v[102:103], v[102:103], v[56:57], v[56:57] op_sel:[0,1,0] op_sel_hi:[1,1,0]
  v_pk_mul_f32 v[100:101], v[100:101], v[160:161]
  v_pk_mul_f32 v[102:103], v[102:103], v[162:163]
  v_mfma_f32_16x16x16_bf16 v[176:179], v[38:39], v[46:47], v[176:179]
  v_exp_f32 v100, v100
  v_exp_f32 v101, v101
  v_exp_f32 v102, v102
  v_exp_f32 v103, v103
  v_pk_fma_f32 v[100:101], v[100:101], v[58:59], v[58:59] op_sel_hi:[1,0,0]
  v_pk_fma_f32 v[102:103], v[102:103], v[58:59], v[58:59] op_sel_hi:[1,0,0]
  v_rcp_f32 v100, v100
  v_rcp_f32 v101, v101
  v_rcp_f32 v102, v102
  v_rcp_f32 v103, v103
  v_pk_mul_f32 v[160:161], v[160:161], v[100:101]
  v_pk_mul_f32 v[162:163], v[162:163], v[102:103]
  v_cvt_pk_bf16_f32 v116, v160, v161
  v_cvt_pk_bf16_f32 v117, v162, v163
  v_pk_mul_f32 v[104:105], v[176:177], v[176:177]
  v_pk_mul_f32 v[106:107], v[178:179], v[178:179]
  v_pk_fma_f32 v[104:105], v[104:105], v[56:57], v[56:57] op_sel:[0,1,0] op_sel_hi:[1,1,0]
  v_pk_fma_f32 v[106:107], v[106:107], v[56:57], v[56:57] op_sel:[0,1,0] op_sel_hi:[1,1,0]
  v_pk_mul_f32 v[104:105], v[104:105], v[176:177]
  v_pk_mul_f32 v[106:107], v[106:107], v[178:179]
  v_mfma_f32_16x16x16_bf16 v[164:167], v[36:37], v[48:49], v[164:167]
  v_exp_f32 v104, v104
  v_exp_f32 v105, v105
  v_exp_f32 v106, v106
  v_exp_f32 v107, v107
  v_pk_fma_f32 v[104:105], v[104:105], v[58:59], v[58:59] op_sel_hi:[1,0,0]
  v_pk_fma_f32 v[106:107], v[106:107], v[58:59], v[58:59] op_sel_hi:[1,0,0]
  v_rcp_f32 v104, v104
  v_rcp_f32 v105, v105
  v_rcp_f32 v106, v106
  v_rcp_f32 v107, v107
  v_pk_mul_f32 v[176:177], v[176:177], v[104:105]
  v_pk_mul_f32 v[178:179], v[178:179], v[106:107]
  v_cvt_pk_bf16_f32 v118, v176, v177
  v_cvt_pk_bf16_f32 v119, v178, v179
  buffer_store_dwordx4 v[116:119], v17, s[44:47], 0 offen sc1
  ds_write_b128 v18, v[116:119] offset:0
  v_pk_mul_f32 v[100:101], v[164:165], v[164:165]
  v_pk_mul_f32 v[102:103], v[166:167], v[166:167]
  v_pk_fma_f32 v[100:101], v[100:101], v[60:61], v[60:61] op_sel:[0,1,0] op_sel_hi:[1,1,0]
  v_pk_fma_f32 v[102:103], v[102:103], v[60:61], v[60:61] op_sel:[0,1,0] op_sel_hi:[1,1,0]
  v_pk_mul_f32 v[100:101], v[100:101], v[164:165]
  v_pk_mul_f32 v[102:103], v[102:103], v[166:167]
  v_mfma_f32_16x16x16_bf16 v[180:183], v[38:39], v[48:49], v[180:183]
  v_exp_f32 v100, v100
  v_exp_f32 v101, v101
  v_exp_f32 v102, v102
  v_exp_f32 v103, v103
  v_pk_fma_f32 v[100:101], v[100:101], v[62:63], v[62:63] op_sel_hi:[1,0,0]
  v_pk_fma_f32 v[102:103], v[102:103], v[62:63], v[62:63] op_sel_hi:[1,0,0]
  v_rcp_f32 v100, v100
  v_rcp_f32 v101, v101
  v_rcp_f32 v102, v102
  v_rcp_f32 v103, v103
  v_pk_mul_f32 v[164:165], v[164:165], v[100:101]
  v_pk_mul_f32 v[166:167], v[166:167], v[102:103]
  v_cvt_pk_bf16_f32 v120, v164, v165
  v_cvt_pk_bf16_f32 v121, v166, v167
  v_pk_mul_f32 v[104:105], v[180:181], v[180:181]
  v_pk_mul_f32 v[106:107], v[182:183], v[182:183]
  v_pk_fma_f32 v[104:105], v[104:105], v[60:61], v[60:61] op_sel:[0,1,0] op_sel_hi:[1,1,0]
  v_pk_fma_f32 v[106:107], v[106:107], v[60:61], v[60:61] op_sel:[0,1,0] op_sel_hi:[1,1,0]
  v_pk_mul_f32 v[104:105], v[104:105], v[180:181]
  v_pk_mul_f32 v[106:107], v[106:107], v[182:183]
  v_mfma_f32_16x16x16_bf16 v[168:171], v[36:37], v[50:51], v[168:171]
  v_exp_f32 v104, v104
  v_exp_f32 v105, v105
  v_exp_f32 v106, v106
  v_exp_f32 v107, v107
  v_pk_fma_f32 v[104:105], v[104:105], v[62:63], v[62:63] op_sel_hi:[1,0,0]
  v_pk_fma_f32 v[106:107], v[106:107], v[62:63], v[62:63] op_sel_hi:[1,0,0]
  v_rcp_f32 v104, v104
  v_rcp_f32 v105, v105
  v_rcp_f32 v106, v106
  v_rcp_f32 v107, v107
  v_pk_mul_f32 v[180:181], v[180:181], v[104:105]
  v_pk_mul_f32 v[182:183], v[182:183], v[106:107]
  v_cvt_pk_bf16_f32 v122, v180, v181
  v_cvt_pk_bf16_f32 v123, v182, v183
  buffer_store_dwordx4 v[120:123], v17, s[44:47], s3 offen sc1
  ds_write_b128 v18, v[120:123] offset:2048
  v_pk_mul_f32 v[100:101], v[168:169], v[168:169]
  v_pk_mul_f32 v[102:103], v[170:171], v[170:171]
  v_pk_fma_f32 v[100:101], v[100:101], v[64:65], v[64:65] op_sel:[0,1,0] op_sel_hi:[1,1,0]
  v_pk_fma_f32 v[102:103], v[102:103], v[64:65], v[64:65] op_sel:[0,1,0] op_sel_hi:[1,1,0]
  v_pk_mul_f32 v[100:101], v[100:101], v[168:169]
  v_pk_mul_f32 v[102:103], v[102:103], v[170:171]
  v_mfma_f32_16x16x16_bf16 v[184:187], v[38:39], v[50:51], v[184:187]
  v_exp_f32 v100, v100
  v_exp_f32 v101, v101
  v_exp_f32 v102, v102
  v_exp_f32 v103, v103
  v_pk_fma_f32 v[100:101], v[100:101], v[66:67], v[66:67] op_sel_hi:[1,0,0]
  v_pk_fma_f32 v[102:103], v[102:103], v[66:67], v[66:67] op_sel_hi:[1,0,0]
  v_rcp_f32 v100, v100
  v_rcp_f32 v101, v101
  v_rcp_f32 v102, v102
  v_rcp_f32 v103, v103
  v_pk_mul_f32 v[168:169], v[168:169], v[100:101]
  v_pk_mul_f32 v[170:171], v[170:171], v[102:103]
  v_cvt_pk_bf16_f32 v108, v168, v169
  v_cvt_pk_bf16_f32 v109, v170, v171
  v_pk_mul_f32 v[104:105], v[184:185], v[184:185]
  v_pk_mul_f32 v[106:107], v[186:187], v[186:187]
  v_pk_fma_f32 v[104:105], v[104:105], v[64:65], v[64:65] op_sel:[0,1,0] op_sel_hi:[1,1,0]
  v_pk_fma_f32 v[106:107], v[106:107], v[64:65], v[64:65] op_sel:[0,1,0] op_sel_hi:[1,1,0]
  v_pk_mul_f32 v[104:105], v[104:105], v[184:185]
  v_pk_mul_f32 v[106:107], v[106:107], v[186:187]
  v_mfma_f32_16x16x16_bf16 v[172:175], v[36:37], v[52:53], v[172:175]
  v_exp_f32 v104, v104
  v_exp_f32 v105, v105
  v_exp_f32 v106, v106
  v_exp_f32 v107, v107
  v_pk_fma_f32 v[104:105], v[104:105], v[66:67], v[66:67] op_sel_hi:[1,0,0]
  v_pk_fma_f32 v[106:107], v[106:107], v[66:67], v[66:67] op_sel_hi:[1,0,0]
  v_rcp_f32 v104, v104
  v_rcp_f32 v105, v105
  v_rcp_f32 v106, v106
  v_rcp_f32 v107, v107
  v_pk_mul_f32 v[184:185], v[184:185], v[104:105]
  v_pk_mul_f32 v[186:187], v[186:187], v[106:107]
  v_cvt_pk_bf16_f32 v110, v184, v185
  v_cvt_pk_bf16_f32 v111, v186, v187
  buffer_store_dwordx4 v[108:111], v17, s[44:47], s8 offen sc1
  ds_write_b128 v18, v[108:111] offset:4096
  v_pk_mul_f32 v[100:101], v[172:173], v[172:173]
  v_pk_mul_f32 v[102:103], v[174:175], v[174:175]
  v_pk_fma_f32 v[100:101], v[100:101], v[68:69], v[68:69] op_sel:[0,1,0] op_sel_hi:[1,1,0]
  v_pk_fma_f32 v[102:103], v[102:103], v[68:69], v[68:69] op_sel:[0,1,0] op_sel_hi:[1,1,0]
  v_pk_mul_f32 v[100:101], v[100:101], v[172:173]
  v_pk_mul_f32 v[102:103], v[102:103], v[174:175]
  v_mfma_f32_16x16x16_bf16 v[188:191], v[38:39], v[52:53], v[188:191]
  v_exp_f32 v100, v100
  v_exp_f32 v101, v101
  v_exp_f32 v102, v102
  v_exp_f32 v103, v103
  v_pk_fma_f32 v[100:101], v[100:101], v[70:71], v[70:71] op_sel_hi:[1,0,0]
  v_pk_fma_f32 v[102:103], v[102:103], v[70:71], v[70:71] op_sel_hi:[1,0,0]
  v_rcp_f32 v100, v100
  v_rcp_f32 v101, v101
  v_rcp_f32 v102, v102
  v_rcp_f32 v103, v103
  v_pk_mul_f32 v[172:173], v[172:173], v[100:101]
  v_pk_mul_f32 v[174:175], v[174:175], v[102:103]
  v_cvt_pk_bf16_f32 v112, v172, v173
  v_cvt_pk_bf16_f32 v113, v174, v175
  v_pk_mul_f32 v[104:105], v[188:189], v[188:189]
  v_pk_mul_f32 v[106:107], v[190:191], v[190:191]
  v_pk_fma_f32 v[104:105], v[104:105], v[68:69], v[68:69] op_sel:[0,1,0] op_sel_hi:[1,1,0]
  v_pk_fma_f32 v[106:107], v[106:107], v[68:69], v[68:69] op_sel:[0,1,0] op_sel_hi:[1,1,0]
  v_pk_mul_f32 v[104:105], v[104:105], v[188:189]
  v_pk_mul_f32 v[106:107], v[106:107], v[190:191]
  v_mfma_f32_16x16x16_bf16 v[192:195], v[40:41], v[46:47], v[192:195]
  v_exp_f32 v104, v104
  v_exp_f32 v105, v105
  v_exp_f32 v106, v106
  v_exp_f32 v107, v107
  v_pk_fma_f32 v[104:105], v[104:105], v[70:71], v[70:71] op_sel_hi:[1,0,0]
  v_pk_fma_f32 v[106:107], v[106:107], v[70:71], v[70:71] op_sel_hi:[1,0,0]
  v_rcp_f32 v104, v104
  v_rcp_f32 v105, v105
  v_rcp_f32 v106, v106
  v_rcp_f32 v107, v107
  v_pk_mul_f32 v[188:189], v[188:189], v[104:105]
  v_pk_mul_f32 v[190:191], v[190:191], v[106:107]
  v_cvt_pk_bf16_f32 v114, v188, v189
  v_cvt_pk_bf16_f32 v115, v190, v191
  buffer_store_dwordx4 v[112:115], v17, s[44:47], s9 offen sc1
  ds_write_b128 v18, v[112:115] offset:6144
  v_pk_mul_f32 v[100:101], v[192:193], v[192:193]
  v_pk_mul_f32 v[102:103], v[194:195], v[194:195]
  v_pk_fma_f32 v[100:101], v[100:101], v[56:57], v[56:57] op_sel:[0,1,0] op_sel_hi:[1,1,0]
  v_pk_fma_f32 v[102:103], v[102:103], v[56:57], v[56:57] op_sel:[0,1,0] op_sel_hi:[1,1,0]
  v_pk_mul_f32 v[100:101], v[100:101], v[192:193]
  v_pk_mul_f32 v[102:103], v[102:103], v[194:195]
  v_mfma_f32_16x16x16_bf16 v[208:211], v[42:43], v[46:47], v[208:211]
  v_exp_f32 v100, v100
  v_exp_f32 v101, v101
  v_exp_f32 v102, v102
  v_exp_f32 v103, v103
  v_pk_fma_f32 v[100:101], v[100:101], v[58:59], v[58:59] op_sel_hi:[1,0,0]
  v_pk_fma_f32 v[102:103], v[102:103], v[58:59], v[58:59] op_sel_hi:[1,0,0]
  v_rcp_f32 v100, v100
  v_rcp_f32 v101, v101
  v_rcp_f32 v102, v102
  v_rcp_f32 v103, v103
  v_pk_mul_f32 v[192:193], v[192:193], v[100:101]
  v_pk_mul_f32 v[194:195], v[194:195], v[102:103]
  v_cvt_pk_bf16_f32 v116, v192, v193
  v_cvt_pk_bf16_f32 v117, v194, v195
  v_pk_mul_f32 v[104:105], v[208:209], v[208:209]
  v_pk_mul_f32 v[106:107], v[210:211], v[210:211]
  v_pk_fma_f32 v[104:105], v[104:105], v[56:57], v[56:57] op_sel:[0,1,0] op_sel_hi:[1,1,0]
  v_pk_fma_f32 v[106:107], v[106:107], v[56:57], v[56:57] op_sel:[0,1,0] op_sel_hi:[1,1,0]
  v_pk_mul_f32 v[104:105], v[104:105], v[208:209]
  v_pk_mul_f32 v[106:107], v[106:107], v[210:211]
  v_mfma_f32_16x16x16_bf16 v[196:199], v[40:41], v[48:49], v[196:199]
  v_exp_f32 v104, v104
  v_exp_f32 v105, v105
  v_exp_f32 v106, v106
  v_exp_f32 v107, v107
  v_pk_fma_f32 v[104:105], v[104:105], v[58:59], v[58:59] op_sel_hi:[1,0,0]
  v_pk_fma_f32 v[106:107], v[106:107], v[58:59], v[58:59] op_sel_hi:[1,0,0]
  v_rcp_f32 v104, v104
  v_rcp_f32 v105, v105
  v_rcp_f32 v106, v106
  v_rcp_f32 v107, v107
  v_pk_mul_f32 v[208:209], v[208:209], v[104:105]
  v_pk_mul_f32 v[210:211], v[210:211], v[106:107]
  v_cvt_pk_bf16_f32 v118, v208, v209
  v_cvt_pk_bf16_f32 v119, v210, v211
  buffer_store_dwordx4 v[116:119], v17, s[44:47], 0 offen offset:2048
  ds_write_b128 v18, v[116:119] offset:16384
  v_pk_mul_f32 v[100:101], v[196:197], v[196:197]
  v_pk_mul_f32 v[102:103], v[198:199], v[198:199]
  v_pk_fma_f32 v[100:101], v[100:101], v[60:61], v[60:61] op_sel:[0,1,0] op_sel_hi:[1,1,0]
  v_pk_fma_f32 v[102:103], v[102:103], v[60:61], v[60:61] op_sel:[0,1,0] op_sel_hi:[1,1,0]
  v_pk_mul_f32 v[100:101], v[100:101], v[196:197]
  v_pk_mul_f32 v[102:103], v[102:103], v[198:199]
  v_mfma_f32_16x16x16_bf16 v[212:215], v[42:43], v[48:49], v[212:215]
  v_exp_f32 v100, v100
  v_exp_f32 v101, v101
  v_exp_f32 v102, v102
  v_exp_f32 v103, v103
  v_pk_fma_f32 v[100:101], v[100:101], v[62:63], v[62:63] op_sel_hi:[1,0,0]
  v_pk_fma_f32 v[102:103], v[102:103], v[62:63], v[62:63] op_sel_hi:[1,0,0]
  v_rcp_f32 v100, v100
  v_rcp_f32 v101, v101
  v_rcp_f32 v102, v102
  v_rcp_f32 v103, v103
  v_pk_mul_f32 v[196:197], v[196:197], v[100:101]
  v_pk_mul_f32 v[198:199], v[198:199], v[102:103]
  v_cvt_pk_bf16_f32 v120, v196, v197
  v_cvt_pk_bf16_f32 v121, v198, v199
  v_pk_mul_f32 v[104:105], v[212:213], v[212:213]
  v_pk_mul_f32 v[106:107], v[214:215], v[214:215]
  v_pk_fma_f32 v[104:105], v[104:105], v[60:61], v[60:61] op_sel:[0,1,0] op_sel_hi:[1,1,0]
  v_pk_fma_f32 v[106:107], v[106:107], v[60:61], v[60:61] op_sel:[0,1,0] op_sel_hi:[1,1,0]
  v_pk_mul_f32 v[104:105], v[104:105], v[212:213]
  v_pk_mul_f32 v[106:107], v[106:107], v[214:215]
  v_mfma_f32_16x16x16_bf16 v[200:203], v[40:41], v[50:51], v[200:203]
  v_exp_f32 v104, v104
  v_exp_f32 v105, v105
  v_exp_f32 v106, v106
  v_exp_f32 v107, v107
  v_pk_fma_f32 v[104:105], v[104:105], v[62:63], v[62:63] op_sel_hi:[1,0,0]
  v_pk_fma_f32 v[106:107], v[106:107], v[62:63], v[62:63] op_sel_hi:[1,0,0]
  v_rcp_f32 v104, v104
  v_rcp_f32 v105, v105
  v_rcp_f32 v106, v106
  v_rcp_f32 v107, v107
  v_pk_mul_f32 v[212:213], v[212:213], v[104:105]
  v_pk_mul_f32 v[214:215], v[214:215], v[106:107]
  v_cvt_pk_bf16_f32 v122, v212, v213
  v_cvt_pk_bf16_f32 v123, v214, v215
  buffer_store_dwordx4 v[120:123], v17, s[44:47], s3 offen offset:2048
  ds_write_b128 v18, v[120:123] offset:18432
  v_pk_mul_f32 v[100:101], v[200:201], v[200:201]
  v_pk_mul_f32 v[102:103], v[202:203], v[202:203]
  v_pk_fma_f32 v[100:101], v[100:101], v[64:65], v[64:65] op_sel:[0,1,0] op_sel_hi:[1,1,0]
  v_pk_fma_f32 v[102:103], v[102:103], v[64:65], v[64:65] op_sel:[0,1,0] op_sel_hi:[1,1,0]
  v_pk_mul_f32 v[100:101], v[100:101], v[200:201]
  v_pk_mul_f32 v[102:103], v[102:103], v[202:203]
  v_mfma_f32_16x16x16_bf16 v[216:219], v[42:43], v[50:51], v[216:219]
  v_exp_f32 v100, v100
  v_exp_f32 v101, v101
  v_exp_f32 v102, v102
  v_exp_f32 v103, v103
  v_pk_fma_f32 v[100:101], v[100:101], v[66:67], v[66:67] op_sel_hi:[1,0,0]
  v_pk_fma_f32 v[102:103], v[102:103], v[66:67], v[66:67] op_sel_hi:[1,0,0]
  v_rcp_f32 v100, v100
  v_rcp_f32 v101, v101
  v_rcp_f32 v102, v102
  v_rcp_f32 v103, v103
  v_pk_mul_f32 v[200:201], v[200:201], v[100:101]
  v_pk_mul_f32 v[202:203], v[202:203], v[102:103]
  v_cvt_pk_bf16_f32 v108, v200, v201
  v_cvt_pk_bf16_f32 v109, v202, v203
  v_pk_mul_f32 v[104:105], v[216:217], v[216:217]
  v_pk_mul_f32 v[106:107], v[218:219], v[218:219]
  v_pk_fma_f32 v[104:105], v[104:105], v[64:65], v[64:65] op_sel:[0,1,0] op_sel_hi:[1,1,0]
  v_pk_fma_f32 v[106:107], v[106:107], v[64:65], v[64:65] op_sel:[0,1,0] op_sel_hi:[1,1,0]
  v_pk_mul_f32 v[104:105], v[104:105], v[216:217]
  v_pk_mul_f32 v[106:107], v[106:107], v[218:219]
  v_mfma_f32_16x16x16_bf16 v[204:207], v[40:41], v[52:53], v[204:207]
  v_exp_f32 v104, v104
  v_exp_f32 v105, v105
  v_exp_f32 v106, v106
  v_exp_f32 v107, v107
  v_pk_fma_f32 v[104:105], v[104:105], v[66:67], v[66:67] op_sel_hi:[1,0,0]
  v_pk_fma_f32 v[106:107], v[106:107], v[66:67], v[66:67] op_sel_hi:[1,0,0]
  v_rcp_f32 v104, v104
  v_rcp_f32 v105, v105
  v_rcp_f32 v106, v106
  v_rcp_f32 v107, v107
  v_pk_mul_f32 v[216:217], v[216:217], v[104:105]
  v_pk_mul_f32 v[218:219], v[218:219], v[106:107]
  v_cvt_pk_bf16_f32 v110, v216, v217
  v_cvt_pk_bf16_f32 v111, v218, v219
  buffer_store_dwordx4 v[108:111], v17, s[44:47], s8 offen offset:2048
  ds_write_b128 v18, v[108:111] offset:20480
  v_pk_mul_f32 v[100:101], v[204:205], v[204:205]
  v_pk_mul_f32 v[102:103], v[206:207], v[206:207]
  v_pk_fma_f32 v[100:101], v[100:101], v[68:69], v[68:69] op_sel:[0,1,0] op_sel_hi:[1,1,0]
  v_pk_fma_f32 v[102:103], v[102:103], v[68:69], v[68:69] op_sel:[0,1,0] op_sel_hi:[1,1,0]
  v_pk_mul_f32 v[100:101], v[100:101], v[204:205]
  v_pk_mul_f32 v[102:103], v[102:103], v[206:207]
  v_mfma_f32_16x16x16_bf16 v[220:223], v[42:43], v[52:53], v[220:223]
  v_exp_f32 v100, v100
  v_exp_f32 v101, v101
  v_exp_f32 v102, v102
  v_exp_f32 v103, v103
  v_pk_fma_f32 v[100:101], v[100:101], v[70:71], v[70:71] op_sel_hi:[1,0,0]
  v_pk_fma_f32 v[102:103], v[102:103], v[70:71], v[70:71] op_sel_hi:[1,0,0]
  v_rcp_f32 v100, v100
  v_rcp_f32 v101, v101
  v_rcp_f32 v102, v102
  v_rcp_f32 v103, v103
  v_pk_mul_f32 v[204:205], v[204:205], v[100:101]
  v_pk_mul_f32 v[206:207], v[206:207], v[102:103]
  v_cvt_pk_bf16_f32 v112, v204, v205
  v_cvt_pk_bf16_f32 v113, v206, v207
  v_pk_mul_f32 v[104:105], v[220:221], v[220:221]
  v_pk_mul_f32 v[106:107], v[222:223], v[222:223]
  v_pk_fma_f32 v[104:105], v[104:105], v[68:69], v[68:69] op_sel:[0,1,0] op_sel_hi:[1,1,0]
  v_pk_fma_f32 v[106:107], v[106:107], v[68:69], v[68:69] op_sel:[0,1,0] op_sel_hi:[1,1,0]
  v_pk_mul_f32 v[104:105], v[104:105], v[220:221]
  v_pk_mul_f32 v[106:107], v[106:107], v[222:223]
  v_exp_f32 v104, v104
  v_exp_f32 v105, v105
  v_exp_f32 v106, v106
  v_exp_f32 v107, v107
  v_pk_fma_f32 v[104:105], v[104:105], v[70:71], v[70:71] op_sel_hi:[1,0,0]
  v_pk_fma_f32 v[106:107], v[106:107], v[70:71], v[70:71] op_sel_hi:[1,0,0]
  v_rcp_f32 v104, v104
  v_rcp_f32 v105, v105
  v_rcp_f32 v106, v106
  v_rcp_f32 v107, v107
  v_pk_mul_f32 v[220:221], v[220:221], v[104:105]
  v_pk_mul_f32 v[222:223], v[222:223], v[106:107]
  v_cvt_pk_bf16_f32 v114, v220, v221
  v_cvt_pk_bf16_f32 v115, v222, v223
  buffer_store_dwordx4 v[112:115], v17, s[44:47], s9 offen offset:2048
  ds_write_b128 v18, v[112:115] offset:22528
  v_add_u32 v2, 114688, v27
  v_mov_b32 v6, v8
  v_xor_b32 v7, 32, v8
  v_xor_b32 v9, 96, v8
  v_xor_b32 v8, 64, v8
  s_waitcnt vmcnt(14)
  v_lshlrev_b32 v216, 16, v10
  v_and_b32 v217, s11, v10
  v_lshlrev_b32 v218, 16, v11
  v_and_b32 v219, s11, v11
  v_lshlrev_b32 v96, 16, v240
  v_and_b32 v97, s11, v240
  v_pk_add_f32 v[96:97], v[96:97], v[216:217]
  v_lshlrev_b32 v98, 16, v241
  v_and_b32 v99, s11, v241
  v_pk_add_f32 v[98:99], v[98:99], v[218:219]
  v_lshlrev_b32 v100, 16, v248
  v_and_b32 v101, s11, v248
  v_pk_add_f32 v[100:101], v[100:101], v[216:217]
  v_lshlrev_b32 v102, 16, v249
  v_and_b32 v103, s11, v249
  v_pk_add_f32 v[102:103], v[102:103], v[218:219]
  v_lshlrev_b32 v216, 16, v24
  v_and_b32 v217, s11, v24
  v_lshlrev_b32 v218, 16, v25
  v_and_b32 v219, s11, v25
  v_lshlrev_b32 v104, 16, v242
  v_and_b32 v105, s11, v242
  v_pk_add_f32 v[104:105], v[104:105], v[216:217]
  v_lshlrev_b32 v106, 16, v243
  v_and_b32 v107, s11, v243
  v_pk_add_f32 v[106:107], v[106:107], v[218:219]
  v_lshlrev_b32 v108, 16, v250
  v_and_b32 v109, s11, v250
  v_pk_add_f32 v[108:109], v[108:109], v[216:217]
  v_lshlrev_b32 v110, 16, v251
  v_and_b32 v111, s11, v251
  v_pk_add_f32 v[110:111], v[110:111], v[218:219]
  v_lshlrev_b32 v216, 16, v124
  v_and_b32 v217, s11, v124
  v_lshlrev_b32 v218, 16, v125
  v_and_b32 v219, s11, v125
  v_lshlrev_b32 v112, 16, v244
  v_and_b32 v113, s11, v244
  v_pk_add_f32 v[112:113], v[112:113], v[216:217]
  v_lshlrev_b32 v114, 16, v245
  v_and_b32 v115, s11, v245
  v_pk_add_f32 v[114:115], v[114:115], v[218:219]
  v_lshlrev_b32 v116, 16, v252
  v_and_b32 v117, s11, v252
  v_pk_add_f32 v[116:117], v[116:117], v[216:217]
  v_lshlrev_b32 v118, 16, v253
  v_and_b32 v119, s11, v253
  v_pk_add_f32 v[118:119], v[118:119], v[218:219]
  v_lshlrev_b32 v216, 16, v126
  v_and_b32 v217, s11, v126
  v_lshlrev_b32 v218, 16, v127
  v_and_b32 v219, s11, v127
  v_lshlrev_b32 v120, 16, v246
  v_and_b32 v121, s11, v246
  v_pk_add_f32 v[120:121], v[120:121], v[216:217]
  v_lshlrev_b32 v122, 16, v247
  v_and_b32 v123, s11, v247
  v_pk_add_f32 v[122:123], v[122:123], v[218:219]
  v_lshlrev_b32 v124, 16, v254
  v_and_b32 v125, s11, v254
  v_pk_add_f32 v[124:125], v[124:125], v[216:217]
  v_lshlrev_b32 v126, 16, v255
  v_and_b32 v127, s11, v255
  v_pk_add_f32 v[126:127], v[126:127], v[218:219]
  s_waitcnt vmcnt(0) lgkmcnt(0)
  s_barrier
  s_add_u32 s97, s97, 1
  s_branch L_w2_compute
L_w1_c1:
L_w2_c0:
L_w2_body:
  s_cmp_ge_u32 s2, 256
  s_cbranch_scc1 L_w2_end
  v_lshrrev_b32 v2, 6, v0
  v_and_b32 v1, 63, v0
  v_readfirstlane_b32 s70, v2
  s_and_b32 s3, s2, 7
  s_lshr_b32 s99, s2, 3
  s_and_b32 s5, s3, 3
  s_lshl_b32 s5, s5, 2
  s_and_b32 s6, s99, 3
  s_add_u32 s68, s5, s6
  s_lshr_b32 s5, s3, 2
  s_lshr_b32 s78, s99, 2
  s_lshl1_add_u32 s69, s78, s5
  s_add_u32 s3, s68, s78
  s_lshl_b32 s3, s3, 3
  s_lshl_b32 s85, 0xffff02, s3
  s_sub_u32 s3, 0, s3
  s_lshr_b32 s3, 0xffff02, s3
  s_or_b32 s85, s85, s3
L_w2_loader:
  s_add_u32 s3, s68, s78
  s_and_b32 s3, s3, 3
  s_mov_b32 s4, 0x1616160
  s_cmp_eq_u32 s3, 1
  s_cselect_b32 s4, 0x5858580, s4
  s_cmp_eq_u32 s3, 2
  s_cselect_b32 s4, 0x16161600, s4
  s_cmp_eq_u32 s3, 3
  s_cselect_b32 s4, 0x58585800, s4
  v_subrev_u32 v2, 3, v1
  v_min_u32 v2, 16, v2
  v_lshlrev_b32 v3, 1, v2
  v_bfe_i32 v16, s4, v3, 2
  v_sub_u32 v16, v1, v16
  v_subrev_u32 v16, 7, v16
  v_ashrrev_i32 v3, 1, v16
  v_cmp_eq_u32 vcc, s78, v3
  s_and_b32 s3, s69, 1
  v_or_b32 v2, 14, v16
  v_cndmask_b32 v2, v16, v2, vcc
  v_cmp_gt_i32 vcc, 0, v16
  s_lshl2_add_u32 s4, s3, 20
  v_add_u32 v16, s4, v16
  s_lshl4_add_u32 s4, s3, 24
  v_add_u32 v2, s4, v2
  v_cndmask_b32 v16, v2, v16, vcc
  s_and_b32 s5, s68, 3
  s_mul_i32 s5, s5, 3
  s_sub_u32 s5, s5, 23
  v_add_u32 v3, s5, v1
  v_subrev_u32 v2, 10, v3
  v_min_u32 v3, v3, v2
  v_subrev_u32 v2, 10, v3
  v_min_u32 v3, v3, v2
  v_cmp_gt_u32 vcc, 23, v1
  s_sub_u32 s5, s3, 46
  v_lshl_add_u32 v2, v1, 1, s5
  v_cndmask_b32 v3, v3, v2, vcc
  s_add_u32 s5, s78, 3
  v_ashrrev_i32 v2, 1, v3
  v_add_u32 v2, s5, v2
  v_and_b32 v2, 7, v2
  v_and_b32 v3, 1, v3
  v_cmp_gt_u32 vcc, 21, v1
  v_lshl_add_u32 v3, v3, 3, v2
  s_lshl1_add_u32 s4, s78, s4
  s_lshl3_add_u32 s3, s3, s78
  v_cndmask_b32 v3, v3, v16, vcc
  v_writelane_b32 v3, s4, 0
  s_add_u32 s4, s4, 1
  v_writelane_b32 v3, s3, 2
  v_writelane_b32 v3, s4, 1
  v_lshlrev_b32 v16, 17, v3
  s_add_u32 s9, s70, s68
  s_and_b32 s9, s9, 3
  s_lshl_b32 s77, s9, 11
  v_and_b32 v10, 7, v1
  v_lshrrev_b32 v3, 3, v1
  s_lshl_b32 s10, s9, 4
  v_add_u32 v3, s10, v3
  v_mul_u32_u24 v3, 2048, v3
  v_lshrrev_b32 v2, 3, v1
  v_and_b32 v2, 6, v2
  v_xor_b32 v2, v2, v10
  s_lshl_b32 s10, s69, 7
  v_add_u32 v3, s10, v3
  v_lshl_add_u32 v8, v2, 4, v3
  v_add_u32 v3, 16384, v3
  v_lshl_add_u32 v9, v2, 4, v3
  s_mov_b32 s40, s28
  s_and_b32 s41, s29, 0xffff
  s_mov_b32 s42, 7340032
  s_mov_b32 s43, 0x00020000
  s_bitcmp1_b32 s69, 0
  s_mov_b32 s76, 128
  s_cselect_b32 s76, -128, s76
  v_readlane_b32 s74, v16, 0
  s_add_u32 m0, s77, 0
  s_add_u32 s4, s74, s76
  buffer_load_dwordx4 v8, s[40:43], s4 offen lds
  s_add_u32 m0, s77, 1024
  s_nop 0
  buffer_load_dwordx4 v9, s[40:43], s4 offen lds
  s_add_u32 m0, s77, 8192
  s_add_u32 s4, s74, 0
  buffer_load_dwordx4 v8, s[40:43], s4 offen lds
  s_add_u32 m0, s77, 9216
  s_nop 0
  buffer_load_dwordx4 v9, s[40:43], s4 offen lds
  v_readlane_b32 s74, v16, 1
  s_add_u32 m0, s77, 16384
  s_add_u32 s4, s74, s76
  buffer_load_dwordx4 v8, s[40:43], s4 offen lds
  s_add_u32 m0, s77, 17408
  s_nop 0
  buffer_load_dwordx4 v9, s[40:43], s4 offen lds
  s_add_u32 m0, s77, 24576
  s_add_u32 s4, s74, 0
  buffer_load_dwordx4 v8, s[40:43], s4 offen lds
  s_add_u32 m0, s77, 25600
  s_nop 0
  buffer_load_dwordx4 v9, s[40:43], s4 offen lds
  v_readlane_b32 s74, v16, 2
  s_add_u32 m0, s77, 32768
  s_add_u32 s4, s74, s76
  buffer_load_dwordx4 v8, s[40:43], s4 offen lds
  s_add_u32 m0, s77, 33792
  s_nop 0
  buffer_load_dwordx4 v9, s[40:43], s4 offen lds
  s_add_u32 m0, s77, 40960
  s_add_u32 s4, s74, 0
  buffer_load_dwordx4 v8, s[40:43], s4 offen lds
  s_add_u32 m0, s77, 41984
  s_nop 0
  buffer_load_dwordx4 v9, s[40:43], s4 offen lds
  v_readlane_b32 s74, v16, 3
  s_add_u32 m0, s77, 49152
  s_add_u32 s4, s74, s76
  buffer_load_dwordx4 v8, s[40:43], s4 offen lds
  s_add_u32 m0, s77, 50176
  s_nop 0
  buffer_load_dwordx4 v9, s[40:43], s4 offen lds
  s_add_u32 m0, s77, 57344
  s_add_u32 s4, s74, 0
  buffer_load_dwordx4 v8, s[40:43], s4 offen lds
  s_add_u32 m0, s77, 58368
  s_nop 0
  buffer_load_dwordx4 v9, s[40:43], s4 offen lds
  v_readlane_b32 s74, v16, 4
  s_add_u32 m0, s77, 65536
  s_add_u32 s4, s74, s76
  buffer_load_dwordx4 v8, s[40:43], s4 offen lds
  s_add_u32 m0, s77, 66560
  s_nop 0
  buffer_load_dwordx4 v9, s[40:43], s4 offen lds
  s_add_u32 m0, s77, 73728
  s_add_u32 s4, s74, 0
  buffer_load_dwordx4 v8, s[40:43], s4 offen lds
  s_add_u32 m0, s77, 74752
  s_nop 0
  buffer_load_dwordx4 v9, s[40:43], s4 offen lds
  s_add_u32 s44, s22, 41943040
  s_addc_u32 s45, s23, 0
  s_and_b32 s45, s45, 0xffff
  s_mov_b32 s46, 524288
  s_mov_b32 s47, 0x00020000
  s_lshl4_add_u32 s3, s97, s68
  s_and_b32 s4, s69, 15
  s_lshl4_add_u32 s3, s3, s4
  s_lshl_b32 s3, s3, 7
  s_sub_u32 s86, s3, 32768
  v_lshlrev_b32 v11, 7, v1
  v_and_b32 v2, 15, v1
  v_lshlrev_b32 v2, 2, v2
  s_cmp_lg_u32 s70, 4
  s_waitcnt vmcnt(14)
  s_cbranch_scc1 L_w2_nofl
  v_readlane_b32 s74, v16, 5
  s_add_u32 m0, s77, 81920
  s_add_u32 s4, s74, s76
  buffer_load_dwordx4 v8, s[40:43], s4 offen lds
  s_add_u32 m0, s77, 82944
  s_nop 0
  buffer_load_dwordx4 v9, s[40:43], s4 offen lds
  s_add_u32 m0, s77, 90112
  s_add_u32 s4, s74, 0
  buffer_load_dwordx4 v8, s[40:43], s4 offen lds
  s_add_u32 m0, s77, 91136
  s_nop 0
  buffer_load_dwordx4 v9, s[40:43], s4 offen lds
  v_readlane_b32 s74, v16, 6
  s_add_u32 m0, s77, 98304
  s_add_u32 s4, s74, s76
  buffer_load_dwordx4 v8, s[40:43], s4 offen lds
  s_add_u32 m0, s77, 99328
  s_nop 0
  buffer_load_dwordx4 v9, s[40:43], s4 offen lds
  v_mov_b32 v3, 1
  s_mov_b32 s79, 0x100000
  s_or_b32 s4, s2, 0xe0
  s_lshl4_add_u32 s4, s4, s97
  s_lshl_b32 s4, s4, 7
  s_lshl2_add_u32 s5, s78, s4
  s_cmp_eq_u32 s92, 0
  s_cselect_b32 s3, s4, s86
  s_cselect_b32 s4, 28, 60
  v_and_b32 v13, s4, v2
  buffer_load_dword v12, v13, s[44:47], s3 offen sc1
  s_setprio 3
  s_barrier
  s_cbranch_scc0 L_w2_wb
L_w2_wbd:
  s_mov_b64 exec, 1
  buffer_store_dword v3, off, s[44:47], s5
  s_mov_b64 exec, -1
L_w2_poll:
  buffer_load_dword v12, v13, s[44:47], s3 offen sc1
  s_sub_u32 s79, s79, 1
  s_cbranch_scc1 L_w2_dep
  s_waitcnt vmcnt(0)
  v_cmp_ne_u32 vcc, 1, v12
  s_cbranch_vccnz L_w2_poll
L_w2_dep:
  s_barrier
  s_setprio 0
  s_mov_b64 exec, 0xffff
  buffer_store_dword v3, v11, s[44:47], s87 offen sc1
  s_mov_b64 exec, -1
  s_branch L_w2_go
L_w2_nofl:
  s_barrier
  v_readlane_b32 s74, v16, 5
  s_add_u32 m0, s77, 81920
  s_add_u32 s4, s74, s76
  buffer_load_dwordx4 v8, s[40:43], s4 offen lds
  s_add_u32 m0, s77, 82944
  s_nop 0
  buffer_load_dwordx4 v9, s[40:43], s4 offen lds
  s_add_u32 m0, s77, 90112
  s_add_u32 s4, s74, 0
  buffer_load_dwordx4 v8, s[40:43], s4 offen lds
  s_add_u32 m0, s77, 91136
  s_nop 0
  buffer_load_dwordx4 v9, s[40:43], s4 offen lds
  v_readlane_b32 s74, v16, 6
  s_add_u32 m0, s77, 98304
  s_add_u32 s4, s74, s76
  buffer_load_dwordx4 v8, s[40:43], s4 offen lds
  s_add_u32 m0, s77, 99328
  s_nop 0
  buffer_load_dwordx4 v9, s[40:43], s4 offen lds
  s_waitcnt vmcnt(8)
  s_barrier
L_w2_go:
  s_add_u32 m0, s77, 106496
  s_add_u32 s4, s74, 0
  buffer_load_dwordx4 v8, s[40:43], s4 offen lds
  s_add_u32 m0, s77, 107520
  s_nop 0
  buffer_load_dwordx4 v9, s[40:43], s4 offen lds
  s_waitcnt vmcnt(4)
  v_readlane_b32 s74, v16, 7
  s_add_u32 m0, s77, 114688
  s_add_u32 s4, s74, s76
  buffer_load_dwordx4 v8, s[40:43], s4 offen lds
  s_add_u32 m0, s77, 115712
  s_nop 0
  buffer_load_dwordx4 v9, s[40:43], s4 offen lds
  s_waitcnt vmcnt(4)
  s_add_u32 m0, s77, 122880
  s_add_u32 s4, s74, 0
  buffer_load_dwordx4 v8, s[40:43], s4 offen lds
  s_add_u32 m0, s77, 123904
  s_nop 0
  buffer_load_dwordx4 v9, s[40:43], s4 offen lds
  s_waitcnt vmcnt(4)
  v_readlane_b32 s74, v16, 8
  s_add_u32 m0, s77, 131072
  s_add_u32 s4, s74, s76
  buffer_load_dwordx4 v8, s[40:43], s4 offen lds
  s_add_u32 m0, s77, 132096
  s_nop 0
  buffer_load_dwordx4 v9, s[40:43], s4 offen lds
  s_waitcnt vmcnt(4)
  s_add_u32 m0, s77, 139264
  s_add_u32 s4, s74, 0
  buffer_load_dwordx4 v8, s[40:43], s4 offen lds
  s_add_u32 m0, s77, 140288
  s_nop 0
  buffer_load_dwordx4 v9, s[40:43], s4 offen lds
  s_waitcnt vmcnt(4)
  v_readlane_b32 s74, v16, 9
  s_add_u32 m0, s77, 147456
  s_add_u32 s4, s74, s76
  buffer_load_dwordx4 v8, s[40:43], s4 offen lds
  s_add_u32 m0, s77, 148480
  s_nop 0
  buffer_load_dwordx4 v9, s[40:43], s4 offen lds
  s_waitcnt vmcnt(12)
  s_barrier
  s_add_u32 m0, s77, 155648
  s_add_u32 s4, s74, 0
  buffer_load_dwordx4 v8, s[40:43], s4 offen lds
  s_add_u32 m0, s77, 156672
  s_nop 0
  buffer_load_dwordx4 v9, s[40:43], s4 offen lds
  s_waitcnt vmcnt(4)
  v_readlane_b32 s74, v16, 10
  s_add_u32 m0, s77, 0
  s_add_u32 s4, s74, s76
  buffer_load_dwordx4 v8, s[40:43], s4 offen lds
  s_add_u32 m0, s77, 1024
  s_nop 0
  buffer_load_dwordx4 v9, s[40:43], s4 offen lds
  s_waitcnt vmcnt(4)
  s_add_u32 m0, s77, 8192
  s_add_u32 s4, s74, 0
  buffer_load_dwordx4 v8, s[40:43], s4 offen lds
  s_add_u32 m0, s77, 9216
  s_nop 0
  buffer_load_dwordx4 v9, s[40:43], s4 offen lds
  s_waitcnt vmcnt(4)
  v_readlane_b32 s74, v16, 11
  s_add_u32 m0, s77, 16384
  s_add_u32 s4, s74, s76
  buffer_load_dwordx4 v8, s[40:43], s4 offen lds
  s_add_u32 m0, s77, 17408
  s_nop 0
  buffer_load_dwordx4 v9, s[40:43], s4 offen lds
  s_waitcnt vmcnt(12)
  s_barrier
  s_add_u32 m0, s77, 24576
  s_add_u32 s4, s74, 0
  buffer_load_dwordx4 v8, s[40:43], s4 offen lds
  s_add_u32 m0, s77, 25600
  s_nop 0
  buffer_load_dwordx4 v9, s[40:43], s4 offen lds
  s_waitcnt vmcnt(4)
  v_readlane_b32 s74, v16, 12
  s_add_u32 m0, s77, 32768
  s_add_u32 s4, s74, s76
  buffer_load_dwordx4 v8, s[40:43], s4 offen lds
  s_add_u32 m0, s77, 33792
  s_nop 0
  buffer_load_dwordx4 v9, s[40:43], s4 offen lds
  s_waitcnt vmcnt(4)
  s_add_u32 m0, s77, 40960
  s_add_u32 s4, s74, 0
  buffer_load_dwordx4 v8, s[40:43], s4 offen lds
  s_add_u32 m0, s77, 41984
  s_nop 0
  buffer_load_dwordx4 v9, s[40:43], s4 offen lds
  s_waitcnt vmcnt(4)
  v_readlane_b32 s74, v16, 13
  s_add_u32 m0, s77, 49152
  s_add_u32 s4, s74, s76
  buffer_load_dwordx4 v8, s[40:43], s4 offen lds
  s_add_u32 m0, s77, 50176
  s_nop 0
  buffer_load_dwordx4 v9, s[40:43], s4 offen lds
  s_waitcnt vmcnt(12)
  s_barrier
  s_add_u32 m0, s77, 57344
  s_add_u32 s4, s74, 0
  buffer_load_dwordx4 v8, s[40:43], s4 offen lds
  s_add_u32 m0, s77, 58368
  s_nop 0
  buffer_load_dwordx4 v9, s[40:43], s4 offen lds
  s_waitcnt vmcnt(4)
  v_readlane_b32 s74, v16, 14
  s_add_u32 m0, s77, 65536
  s_add_u32 s4, s74, s76
  buffer_load_dwordx4 v8, s[40:43], s4 offen lds
  s_add_u32 m0, s77, 66560
  s_nop 0
  buffer_load_dwordx4 v9, s[40:43], s4 offen lds
  s_waitcnt vmcnt(4)
  s_add_u32 m0, s77, 73728
  s_add_u32 s4, s74, 0
  buffer_load_dwordx4 v8, s[40:43], s4 offen lds
  s_add_u32 m0, s77, 74752
  s_nop 0
  buffer_load_dwordx4 v9, s[40:43], s4 offen lds
  s_waitcnt vmcnt(4)
  v_readlane_b32 s74, v16, 15
  s_add_u32 m0, s77, 81920
  s_add_u32 s4, s74, s76
  buffer_load_dwordx4 v8, s[40:43], s4 offen lds
  s_add_u32 m0, s77, 82944
  s_nop 0
  buffer_load_dwordx4 v9, s[40:43], s4 offen lds
  s_waitcnt vmcnt(12)
  s_barrier
  s_add_u32 m0, s77, 90112
  s_add_u32 s4, s74, 0
  buffer_load_dwordx4 v8, s[40:43], s4 offen lds
  s_add_u32 m0, s77, 91136
  s_nop 0
  buffer_load_dwordx4 v9, s[40:43], s4 offen lds
  s_waitcnt vmcnt(4)
  v_readlane_b32 s74, v16, 16
  s_add_u32 m0, s77, 98304
  s_add_u32 s4, s74, s76
  buffer_load_dwordx4 v8, s[40:43], s4 offen lds
  s_add_u32 m0, s77, 99328
  s_nop 0
  buffer_load_dwordx4 v9, s[40:43], s4 offen lds
  s_waitcnt vmcnt(4)
  s_add_u32 m0, s77, 106496
  s_add_u32 s4, s74, 0
  buffer_load_dwordx4 v8, s[40:43], s4 offen lds
  s_add_u32 m0, s77, 107520
  s_nop 0
  buffer_load_dwordx4 v9, s[40:43], s4 offen lds
  s_waitcnt vmcnt(4)
  v_readlane_b32 s74, v16, 17
  s_add_u32 m0, s77, 114688
  s_add_u32 s4, s74, s76
  buffer_load_dwordx4 v8, s[40:43], s4 offen lds
  s_add_u32 m0, s77, 115712
  s_nop 0
  buffer_load_dwordx4 v9, s[40:43], s4 offen lds
  s_waitcnt vmcnt(12)
  s_barrier
  v_readlane_b32 s74, v16, 18
  s_add_u32 m0, s77, 122880
  s_add_u32 s4, s74, s76
  buffer_load_dwordx4 v8, s[40:43], s4 offen lds
  s_add_u32 m0, s77, 123904
  s_nop 0
  buffer_load_dwordx4 v9, s[40:43], s4 offen lds
  s_waitcnt vmcnt(4)
  v_readlane_b32 s74, v16, 19
  s_add_u32 m0, s77, 131072
  s_add_u32 s4, s74, s76
  buffer_load_dwordx4 v8, s[40:43], s4 offen lds
  s_add_u32 m0, s77, 132096
  s_nop 0
  buffer_load_dwordx4 v9, s[40:43], s4 offen lds
  s_waitcnt vmcnt(4)
  s_cmp_eq_u32 s70, 4
  s_cselect_b32 s46, s46, 0
  buffer_load_dword v3, v2, s[44:47], s86 offen sc1
  v_readlane_b32 s74, v16, 20
  s_add_u32 m0, s77, 139264
  s_add_u32 s4, s74, s76
  buffer_load_dwordx4 v8, s[40:43], s4 offen lds
  s_add_u32 m0, s77, 140288
  s_nop 0
  buffer_load_dwordx4 v9, s[40:43], s4 offen lds
  s_waitcnt vmcnt(4)
  v_readlane_b32 s74, v16, 21
  s_add_u32 m0, s77, 147456
  s_add_u32 s4, s74, s76
  buffer_load_dwordx4 v8, s[40:43], s4 offen lds
  s_add_u32 m0, s77, 148480
  s_nop 0
  buffer_load_dwordx4 v9, s[40:43], s4 offen lds
  s_mov_b32 s79, 0x100000
  s_cmp_lg_u32 s70, 4
  s_cbranch_scc1 L_w2l_dep
  s_waitcnt vmcnt(4)
  v_cmp_ne_u32 vcc, 1, v3
  s_cbranch_vccz L_w2l_dep
L_w2l_poll:
  buffer_load_dword v3, v2, s[44:47], s86 offen sc1
  s_sub_u32 s79, s79, 1
  s_cbranch_scc1 L_w2l_dep
  s_waitcnt vmcnt(0)
  v_cmp_ne_u32 vcc, 1, v3
  s_cbranch_vccnz L_w2l_poll
L_w2l_dep:
  s_waitcnt vmcnt(13)
  s_barrier
  v_readlane_b32 s74, v16, 22
  s_add_u32 m0, s77, 155648
  s_add_u32 s4, s74, s76
  buffer_load_dwordx4 v8, s[40:43], s4 offen lds
  s_add_u32 m0, s77, 156672
  s_nop 0
  buffer_load_dwordx4 v9, s[40:43], s4 offen lds
  s_waitcnt vmcnt(4)
  v_readlane_b32 s74, v16, 17
  s_add_u32 m0, s77, 0
  s_add_u32 s4, s74, 0
  buffer_load_dwordx4 v8, s[40:43], s4 offen lds
  s_add_u32 m0, s77, 1024
  s_nop 0
  buffer_load_dwordx4 v9, s[40:43], s4 offen lds
  s_waitcnt vmcnt(4)
  v_readlane_b32 s74, v16, 18
  s_add_u32 m0, s77, 8192
  s_add_u32 s4, s74, 0
  buffer_load_dwordx4 v8, s[40:43], s4 offen lds
  s_add_u32 m0, s77, 9216
  s_nop 0
  buffer_load_dwordx4 v9, s[40:43], s4 offen lds
  s_waitcnt vmcnt(4)
  v_readlane_b32 s74, v16, 19
  s_add_u32 m0, s77, 16384
  s_add_u32 s4, s74, 0
  buffer_load_dwordx4 v8, s[40:43], s4 offen lds
  s_add_u32 m0, s77, 17408
  s_nop 0
  buffer_load_dwordx4 v9, s[40:43], s4 offen lds
  s_waitcnt vmcnt(13)
  s_barrier
  v_readlane_b32 s74, v16, 20
  s_add_u32 m0, s77, 24576
  s_add_u32 s4, s74, 0
  buffer_load_dwordx4 v8, s[40:43], s4 offen lds
  s_add_u32 m0, s77, 25600
  s_nop 0
  buffer_load_dwordx4 v9, s[40:43], s4 offen lds
  s_waitcnt vmcnt(30)
  v_readlane_b32 s74, v16, 21
  s_add_u32 m0, s77, 32768
  s_add_u32 s4, s74, 0
  buffer_load_dwordx4 v8, s[40:43], s4 offen lds
  s_add_u32 m0, s77, 33792
  s_nop 0
  buffer_load_dwordx4 v9, s[40:43], s4 offen lds
  s_waitcnt vmcnt(30)
  v_readlane_b32 s74, v16, 22
  s_add_u32 m0, s77, 40960
  s_add_u32 s4, s74, 0
  buffer_load_dwordx4 v8, s[40:43], s4 offen lds
  s_add_u32 m0, s77, 41984
  s_nop 0
  buffer_load_dwordx4 v9, s[40:43], s4 offen lds
  s_waitcnt vmcnt(30)
  v_readlane_b32 s74, v16, 23
  s_add_u32 m0, s77, 49152
  s_add_u32 s4, s74, 0
  buffer_load_dwordx4 v8, s[40:43], s4 offen lds
  s_add_u32 m0, s77, 50176
  s_nop 0
  buffer_load_dwordx4 v9, s[40:43], s4 offen lds
  s_waitcnt vmcnt(30)
  v_readlane_b32 s74, v16, 24
  s_add_u32 m0, s77, 57344
  s_add_u32 s4, s74, 0
  buffer_load_dwordx4 v8, s[40:43], s4 offen lds
  s_add_u32 m0, s77, 58368
  s_nop 0
  buffer_load_dwordx4 v9, s[40:43], s4 offen lds
  s_waitcnt vmcnt(30)
  v_readlane_b32 s74, v16, 25
  s_add_u32 m0, s77, 65536
  s_add_u32 s4, s74, 0
  buffer_load_dwordx4 v8, s[40:43], s4 offen lds
  s_add_u32 m0, s77, 66560
  s_nop 0
  buffer_load_dwordx4 v9, s[40:43], s4 offen lds
  s_waitcnt vmcnt(30)
  v_readlane_b32 s74, v16, 26
  s_add_u32 m0, s77, 73728
  s_add_u32 s4, s74, 0
  buffer_load_dwordx4 v8, s[40:43], s4 offen lds
  s_add_u32 m0, s77, 74752
  s_nop 0
  buffer_load_dwordx4 v9, s[40:43], s4 offen lds
  s_waitcnt vmcnt(30)
  v_readlane_b32 s74, v16, 27
  s_add_u32 m0, s77, 81920
  s_add_u32 s4, s74, 0
  buffer_load_dwordx4 v8, s[40:43], s4 offen lds
  s_add_u32 m0, s77, 82944
  s_nop 0
  buffer_load_dwordx4 v9, s[40:43], s4 offen lds
  s_waitcnt vmcnt(30)
  v_readlane_b32 s74, v16, 28
  s_add_u32 m0, s77, 90112
  s_add_u32 s4, s74, 0
  buffer_load_dwordx4 v8, s[40:43], s4 offen lds
  s_add_u32 m0, s77, 91136
  s_nop 0
  buffer_load_dwordx4 v9, s[40:43], s4 offen lds
  s_waitcnt vmcnt(22)
  s_barrier
  v_readlane_b32 s74, v16, 29
  s_add_u32 m0, s77, 98304
  s_add_u32 s4, s74, 0
  buffer_load_dwordx4 v8, s[40:43], s4 offen lds
  s_add_u32 m0, s77, 99328
  s_nop 0
  buffer_load_dwordx4 v9, s[40:43], s4 offen lds
  s_waitcnt vmcnt(30)
  v_readlane_b32 s74, v16, 30
  s_add_u32 m0, s77, 106496
  s_add_u32 s4, s74, 0
  buffer_load_dwordx4 v8, s[40:43], s4 offen lds
  s_add_u32 m0, s77, 107520
  s_nop 0
  buffer_load_dwordx4 v9, s[40:43], s4 offen lds
  s_waitcnt vmcnt(30)
  v_readlane_b32 s74, v16, 31
  s_add_u32 m0, s77, 114688
  s_add_u32 s4, s74, 0
  buffer_load_dwordx4 v8, s[40:43], s4 offen lds
  s_add_u32 m0, s77, 115712
  s_nop 0
  buffer_load_dwordx4 v9, s[40:43], s4 offen lds
  s_waitcnt vmcnt(30)
  v_readlane_b32 s74, v16, 32
  s_add_u32 m0, s77, 122880
  s_add_u32 s4, s74, 0
  buffer_load_dwordx4 v8, s[40:43], s4 offen lds
  s_add_u32 m0, s77, 123904
  s_nop 0
  buffer_load_dwordx4 v9, s[40:43], s4 offen lds
  s_waitcnt vmcnt(22)
  s_barrier
  s_add_u32 s64, s22, 41943040
  s_addc_u32 s65, s23, 0
  s_and_b32 s65, s65, 0xffff
  s_mov_b32 s66, 524288
  s_mov_b32 s67, 0x00020000
  s_lshl4_add_u32 s6, s68, s69
  s_xor_b32 s6, s6, 1
  s_add_u32 s7, s96, 4
  s_lshl_b32 s7, s7, 8
  s_add_u32 s6, s6, s7
  s_lshl_b32 s86, s6, 8
  v_and_b32 v2, 3, v1
  v_lshlrev_b32 v30, 6, v2
  s_mov_b32 s79, 0x100000
  s_waitcnt vmcnt(0)
  s_barrier
  s_cmp_eq_u32 s96, 0
  s_cbranch_scc1 L_w2_zskip
  s_cmp_lg_u32 s70, 4
  s_cbranch_scc1 L_w2_xgo
  s_setprio 3
L_w2_xpoll:
  buffer_load_dword v5, v30, s[64:67], s86 offen sc1
  s_sub_u32 s79, s79, 1
  s_cbranch_scc1 L_w2_xgo
  s_waitcnt vmcnt(0)
  v_cmp_ne_u32 vcc, 1, v5
  s_cbranch_vccnz L_w2_xpoll
L_w2_xgo:
  s_setprio 0
  s_waitcnt vmcnt(0)
  s_barrier
L_w2_zskip:
  s_cmp_eq_u32 s96, 1
  s_cbranch_scc1 L_w2_end
  s_lshl_b32 s87, s97, 15
  s_lshl_b32 s4, s68, 11
  s_add_u32 s87, s87, s4
  s_lshl_b32 s4, s69, 2
  s_add_u32 s87, s87, s4
  s_mov_b32 s96, 1
  s_add_u32 s12, s22, 33554432
  s_addc_u32 s13, s23, 0
  s_add_u32 s34, s22, 67108864
  s_addc_u32 s35, s23, 0
  s_add_u32 s97, s97, 1
  s_branch L_attn_body
L_w2_wb:
  buffer_wbl2 sc1
  s_waitcnt vmcnt(0)
  s_mov_b64 exec, 0xffff
  buffer_store_dword v3, v11, s[44:47], s87 offen sc1
  s_branch L_w2_wbd
L_w2_end:
  s_endpgm
L_w2_compute:
  ds_read_b128 v[32:35], v2 offset:0
  ds_read_b128 v[36:39], v2 offset:2048
  ds_read_b64_tr_b16 v[160:161], v6 offset:0
  ds_read_b64_tr_b16 v[162:163], v6 offset:2048
  ds_read_b64_tr_b16 v[164:165], v7 offset:0
  ds_read_b64_tr_b16 v[166:167], v7 offset:2048
  ds_read_b64_tr_b16 v[176:177], v6 offset:4096
  ds_read_b64_tr_b16 v[178:179], v6 offset:6144
  ds_read_b64_tr_b16 v[180:181], v7 offset:4096
  ds_read_b64_tr_b16 v[182:183], v7 offset:6144
  ds_read_b128 v[40:43], v2 offset:1024
  ds_read_b128 v[44:47], v2 offset:3072
  ds_read_b64_tr_b16 v[168:169], v8 offset:0
  ds_read_b64_tr_b16 v[170:171], v8 offset:2048
  ds_read_b64_tr_b16 v[172:173], v9 offset:0
  ds_read_b64_tr_b16 v[174:175], v9 offset:2048
  ds_read_b64_tr_b16 v[184:185], v8 offset:4096
  ds_read_b64_tr_b16 v[186:187], v8 offset:6144
  ds_read_b64_tr_b16 v[188:189], v9 offset:4096
  ds_read_b64_tr_b16 v[190:191], v9 offset:6144
  ds_read_b128 v[48:51], v2 offset:16384
  ds_read_b128 v[52:55], v2 offset:18432
  ds_read_b128 v[56:59], v2 offset:17408
  ds_read_b128 v[60:63], v2 offset:19456
  ds_read_b128 v[64:67], v2 offset:32768
  ds_read_b128 v[68:71], v2 offset:34816
  ds_read_b128 v[72:75], v2 offset:33792
  ds_read_b128 v[76:79], v2 offset:35840
  s_waitcnt lgkmcnt(15)
  v_mfma_f32_16x16x32_bf16 v[128:131], v[160:163], v[32:35], 0
  ds_read_b64_tr_b16 v[192:193], v6 offset:8192
  v_mov_b32 v4, v26
  v_mfma_f32_16x16x32_bf16 v[128:131], v[176:179], v[40:43], v[128:131]
  ds_read_b64_tr_b16 v[194:195], v6 offset:10240
  v_mov_b32 v5, v27
  v_mfma_f32_16x16x32_bf16 v[132:135], v[176:179], v[44:47], 0
  ds_read_b64_tr_b16 v[196:197], v7 offset:8192
  v_mov_b32 v12, v28
  v_mfma_f32_16x16x32_bf16 v[132:135], v[160:163], v[36:39], v[132:135]
  ds_read_b64_tr_b16 v[198:199], v7 offset:10240
  v_mov_b32 v18, v29
  v_mfma_f32_16x16x32_bf16 v[140:143], v[164:167], v[36:39], 0
  ds_read_b64_tr_b16 v[208:209], v6 offset:12288
  v_mov_b32 v19, 1
  v_mfma_f32_16x16x32_bf16 v[140:143], v[180:183], v[44:47], v[140:143]
  ds_read_b64_tr_b16 v[210:211], v6 offset:14336
  v_add_u32 v20, 65536, v6
  v_mfma_f32_16x16x32_bf16 v[136:139], v[180:183], v[40:43], 0
  ds_read_b64_tr_b16 v[212:213], v7 offset:12288
  v_add_u32 v21, 65536, v7
  v_mfma_f32_16x16x32_bf16 v[136:139], v[164:167], v[32:35], v[136:139]
  ds_read_b64_tr_b16 v[214:215], v7 offset:14336
  s_waitcnt lgkmcnt(15)
  v_mfma_f32_16x16x32_bf16 v[144:147], v[168:171], v[32:35], 0
  ds_read_b64_tr_b16 v[200:201], v8 offset:8192
  v_add_u32 v22, 65536, v8
  v_mfma_f32_16x16x32_bf16 v[144:147], v[184:187], v[40:43], v[144:147]
  ds_read_b64_tr_b16 v[202:203], v8 offset:10240
  v_add_u32 v23, 65536, v9
  v_mfma_f32_16x16x32_bf16 v[148:151], v[184:187], v[44:47], 0
  ds_read_b64_tr_b16 v[204:205], v9 offset:8192
  v_add_u32 v26, 131072, v6
  v_mfma_f32_16x16x32_bf16 v[148:151], v[168:171], v[36:39], v[148:151]
  ds_read_b64_tr_b16 v[206:207], v9 offset:10240
  v_add_u32 v27, 131072, v7
  v_mfma_f32_16x16x32_bf16 v[156:159], v[172:175], v[36:39], 0
  ds_read_b64_tr_b16 v[216:217], v8 offset:12288
  v_add_u32 v28, 131072, v8
  v_mfma_f32_16x16x32_bf16 v[156:159], v[188:191], v[44:47], v[156:159]
  ds_read_b64_tr_b16 v[218:219], v8 offset:14336
  v_add_u32 v29, 131072, v9
  v_mfma_f32_16x16x32_bf16 v[152:155], v[188:191], v[40:43], 0
  ds_read_b64_tr_b16 v[220:221], v9 offset:12288
  s_add_u32 s52, s22, 41943040
  v_mfma_f32_16x16x32_bf16 v[152:155], v[172:175], v[32:35], v[152:155]
  ds_read_b64_tr_b16 v[222:223], v9 offset:14336
  s_waitcnt lgkmcnt(8)
  v_mfma_f32_16x16x32_bf16 v[96:99], v[192:195], v[32:35], v[96:99]
  ds_read_b64_tr_b16 v[160:161], v6 offset:16384
  s_addc_u32 s53, s23, 0
  v_mfma_f32_16x16x32_bf16 v[96:99], v[208:211], v[40:43], v[96:99]
  ds_read_b64_tr_b16 v[162:163], v6 offset:18432
  s_and_b32 s53, s53, 0xffff
  v_mfma_f32_16x16x32_bf16 v[100:103], v[208:211], v[44:47], v[100:103]
  ds_read_b64_tr_b16 v[164:165], v7 offset:16384
  s_mov_b32 s54, 524288
  v_mfma_f32_16x16x32_bf16 v[100:103], v[192:195], v[36:39], v[100:103]
  ds_read_b64_tr_b16 v[166:167], v7 offset:18432
  s_mov_b32 s55, 0x00020000
  v_mfma_f32_16x16x32_bf16 v[108:111], v[196:199], v[36:39], v[108:111]
  ds_read_b64_tr_b16 v[176:177], v6 offset:20480
  v_mfma_f32_16x16x32_bf16 v[108:111], v[212:215], v[44:47], v[108:111]
  ds_read_b64_tr_b16 v[178:179], v6 offset:22528
  v_mfma_f32_16x16x32_bf16 v[104:107], v[212:215], v[40:43], v[104:107]
  ds_read_b64_tr_b16 v[180:181], v7 offset:20480
  v_mfma_f32_16x16x32_bf16 v[104:107], v[196:199], v[32:35], v[104:107]
  ds_read_b64_tr_b16 v[182:183], v7 offset:22528
  s_waitcnt lgkmcnt(8)
  s_barrier
  buffer_load_dwordx4 v[80:83], off, s[36:39], s51 offset:0 sc1
  buffer_load_dwordx4 v[84:87], off, s[64:67], s51 offset:0 sc1
  buffer_load_dwordx4 v[88:91], off, s[36:39], s51 offset:1024 sc1
  buffer_load_dwordx4 v[92:95], off, s[64:67], s51 offset:1024 sc1
  buffer_load_dwordx4 v[224:227], off, s[36:39], s48 offset:0 sc1
  buffer_load_dwordx4 v[228:231], off, s[64:67], s48 offset:0 sc1
  buffer_load_dwordx4 v[232:235], off, s[36:39], s48 offset:1024 sc1
  buffer_load_dwordx4 v[236:239], off, s[64:67], s48 offset:1024 sc1
  buffer_load_dwordx4 v[240:243], off, s[36:39], s49 offset:0 sc1
  buffer_load_dwordx4 v[244:247], off, s[64:67], s49 offset:0 sc1
  buffer_load_dwordx4 v[248:251], off, s[36:39], s49 offset:1024 sc1
  buffer_load_dwordx4 v[252:255], off, s[64:67], s49 offset:1024 sc1
  v_mfma_f32_16x16x32_bf16 v[112:115], v[200:203], v[32:35], v[112:115]
  ds_read_b64_tr_b16 v[168:169], v8 offset:16384
  v_mfma_f32_16x16x32_bf16 v[112:115], v[216:219], v[40:43], v[112:115]
  ds_read_b64_tr_b16 v[170:171], v8 offset:18432
  v_mfma_f32_16x16x32_bf16 v[116:119], v[216:219], v[44:47], v[116:119]
  ds_read_b64_tr_b16 v[172:173], v9 offset:16384
  v_mfma_f32_16x16x32_bf16 v[116:119], v[200:203], v[36:39], v[116:119]
  ds_read_b64_tr_b16 v[174:175], v9 offset:18432
  v_mfma_f32_16x16x32_bf16 v[124:127], v[204:207], v[36:39], v[124:127]
  ds_read_b64_tr_b16 v[184:185], v8 offset:20480
  v_mfma_f32_16x16x32_bf16 v[124:127], v[220:223], v[44:47], v[124:127]
  ds_read_b64_tr_b16 v[186:187], v8 offset:22528
  v_readlane_b32 s50, v30, 6
  v_mfma_f32_16x16x32_bf16 v[120:123], v[220:223], v[40:43], v[120:123]
  ds_read_b64_tr_b16 v[188:189], v9 offset:20480
  v_mfma_f32_16x16x32_bf16 v[120:123], v[204:207], v[32:35], v[120:123]
  ds_read_b64_tr_b16 v[190:191], v9 offset:22528
  s_waitcnt lgkmcnt(8)
  v_mfma_f32_16x16x32_bf16 v[128:131], v[160:163], v[48:51], v[128:131]
  buffer_load_dwordx4 v[32:35], off, s[36:39], s50 offset:0 sc1
  v_mfma_f32_16x16x32_bf16 v[128:131], v[176:179], v[56:59], v[128:131]
  ds_read_b64_tr_b16 v[192:193], v6 offset:24576
  ds_read_b64_tr_b16 v[194:195], v6 offset:26624
  v_mfma_f32_16x16x32_bf16 v[132:135], v[176:179], v[60:63], v[132:135]
  ds_read_b64_tr_b16 v[196:197], v7 offset:24576
  v_mfma_f32_16x16x32_bf16 v[132:135], v[160:163], v[52:55], v[132:135]
  buffer_load_dwordx4 v[36:39], off, s[64:67], s50 offset:0 sc1
  v_mfma_f32_16x16x32_bf16 v[140:143], v[164:167], v[52:55], v[140:143]
  ds_read_b64_tr_b16 v[198:199], v7 offset:26624
  ds_read_b64_tr_b16 v[208:209], v6 offset:28672
  v_mfma_f32_16x16x32_bf16 v[140:143], v[180:183], v[60:63], v[140:143]
  ds_read_b64_tr_b16 v[210:211], v6 offset:30720
  ds_read_b64_tr_b16 v[212:213], v7 offset:28672
  v_mfma_f32_16x16x32_bf16 v[136:139], v[180:183], v[56:59], v[136:139]
  buffer_load_dwordx4 v[40:43], off, s[36:39], s50 offset:1024 sc1
  v_mfma_f32_16x16x32_bf16 v[136:139], v[164:167], v[48:51], v[136:139]
  ds_read_b64_tr_b16 v[214:215], v7 offset:30720
  s_waitcnt lgkmcnt(8)
  v_mfma_f32_16x16x32_bf16 v[144:147], v[168:171], v[48:51], v[144:147]
  ds_read_b64_tr_b16 v[200:201], v8 offset:24576
  v_mfma_f32_16x16x32_bf16 v[144:147], v[184:187], v[56:59], v[144:147]
  buffer_load_dwordx4 v[44:47], off, s[64:67], s50 offset:1024 sc1
  v_mfma_f32_16x16x32_bf16 v[148:151], v[184:187], v[60:63], v[148:151]
  ds_read_b64_tr_b16 v[202:203], v8 offset:26624
  ds_read_b64_tr_b16 v[204:205], v9 offset:24576
  v_mfma_f32_16x16x32_bf16 v[148:151], v[168:171], v[52:55], v[148:151]
  ds_read_b64_tr_b16 v[206:207], v9 offset:26624
  v_mfma_f32_16x16x32_bf16 v[156:159], v[172:175], v[52:55], v[156:159]
  ds_read_b64_tr_b16 v[216:217], v8 offset:28672
  v_mfma_f32_16x16x32_bf16 v[156:159], v[188:191], v[60:63], v[156:159]
  ds_read_b64_tr_b16 v[218:219], v8 offset:30720
  v_mfma_f32_16x16x32_bf16 v[152:155], v[188:191], v[56:59], v[152:155]
  ds_read_b64_tr_b16 v[220:221], v9 offset:28672
  v_mfma_f32_16x16x32_bf16 v[152:155], v[172:175], v[48:51], v[152:155]
  ds_read_b64_tr_b16 v[222:223], v9 offset:30720
  s_waitcnt lgkmcnt(8)
  v_mfma_f32_16x16x32_bf16 v[96:99], v[192:195], v[48:51], v[96:99]
  ds_read_b64_tr_b16 v[160:161], v6 offset:32768
  v_mfma_f32_16x16x32_bf16 v[96:99], v[208:211], v[56:59], v[96:99]
  ds_read_b64_tr_b16 v[162:163], v6 offset:34816
  v_mfma_f32_16x16x32_bf16 v[100:103], v[208:211], v[60:63], v[100:103]
  ds_read_b64_tr_b16 v[164:165], v7 offset:32768
  v_mfma_f32_16x16x32_bf16 v[100:103], v[192:195], v[52:55], v[100:103]
  ds_read_b64_tr_b16 v[166:167], v7 offset:34816
  v_mfma_f32_16x16x32_bf16 v[108:111], v[196:199], v[52:55], v[108:111]
  ds_read_b64_tr_b16 v[176:177], v6 offset:36864
  v_mfma_f32_16x16x32_bf16 v[108:111], v[212:215], v[60:63], v[108:111]
  ds_read_b64_tr_b16 v[178:179], v6 offset:38912
  v_mfma_f32_16x16x32_bf16 v[104:107], v[212:215], v[56:59], v[104:107]
  ds_read_b64_tr_b16 v[180:181], v7 offset:36864
  v_mfma_f32_16x16x32_bf16 v[104:107], v[196:199], v[48:51], v[104:107]
  ds_read_b64_tr_b16 v[182:183], v7 offset:38912
  s_waitcnt lgkmcnt(8)
  v_mfma_f32_16x16x32_bf16 v[112:115], v[200:203], v[48:51], v[112:115]
  ds_read_b64_tr_b16 v[168:169], v8 offset:32768
  v_mfma_f32_16x16x32_bf16 v[112:115], v[216:219], v[56:59], v[112:115]
  ds_read_b64_tr_b16 v[170:171], v8 offset:34816
  v_mfma_f32_16x16x32_bf16 v[116:119], v[216:219], v[60:63], v[116:119]
  ds_read_b64_tr_b16 v[172:173], v9 offset:32768
  v_mfma_f32_16x16x32_bf16 v[116:119], v[200:203], v[52:55], v[116:119]
  ds_read_b64_tr_b16 v[174:175], v9 offset:34816
  v_mfma_f32_16x16x32_bf16 v[124:127], v[204:207], v[52:55], v[124:127]
  ds_read_b64_tr_b16 v[184:185], v8 offset:36864
  v_mfma_f32_16x16x32_bf16 v[124:127], v[220:223], v[60:63], v[124:127]
  ds_read_b64_tr_b16 v[186:187], v8 offset:38912
  v_readlane_b32 s51, v30, 7
  v_mfma_f32_16x16x32_bf16 v[120:123], v[220:223], v[56:59], v[120:123]
  ds_read_b64_tr_b16 v[188:189], v9 offset:36864
  v_mfma_f32_16x16x32_bf16 v[120:123], v[204:207], v[48:51], v[120:123]
  ds_read_b64_tr_b16 v[190:191], v9 offset:38912
  s_waitcnt lgkmcnt(8)
  v_mfma_f32_16x16x32_bf16 v[128:131], v[160:163], v[64:67], v[128:131]
  buffer_load_dwordx4 v[48:51], off, s[36:39], s51 offset:0 sc1
  v_mfma_f32_16x16x32_bf16 v[128:131], v[176:179], v[72:75], v[128:131]
  ds_read_b64_tr_b16 v[192:193], v6 offset:40960
  ds_read_b64_tr_b16 v[194:195], v6 offset:43008
  v_mfma_f32_16x16x32_bf16 v[132:135], v[176:179], v[76:79], v[132:135]
  ds_read_b64_tr_b16 v[196:197], v7 offset:40960
  v_mfma_f32_16x16x32_bf16 v[132:135], v[160:163], v[68:71], v[132:135]
  buffer_load_dwordx4 v[52:55], off, s[64:67], s51 offset:0 sc1
  v_mfma_f32_16x16x32_bf16 v[140:143], v[164:167], v[68:71], v[140:143]
  ds_read_b64_tr_b16 v[198:199], v7 offset:43008
  ds_read_b64_tr_b16 v[208:209], v6 offset:45056
  v_mfma_f32_16x16x32_bf16 v[140:143], v[180:183], v[76:79], v[140:143]
  ds_read_b64_tr_b16 v[210:211], v6 offset:47104
  ds_read_b64_tr_b16 v[212:213], v7 offset:45056
  v_mfma_f32_16x16x32_bf16 v[136:139], v[180:183], v[72:75], v[136:139]
  buffer_load_dwordx4 v[56:59], off, s[36:39], s51 offset:1024 sc1
  v_mfma_f32_16x16x32_bf16 v[136:139], v[164:167], v[64:67], v[136:139]
  ds_read_b64_tr_b16 v[214:215], v7 offset:47104
  s_waitcnt lgkmcnt(8)
  v_mfma_f32_16x16x32_bf16 v[144:147], v[168:171], v[64:67], v[144:147]
  ds_read_b64_tr_b16 v[200:201], v8 offset:40960
  v_mfma_f32_16x16x32_bf16 v[144:147], v[184:187], v[72:75], v[144:147]
  buffer_load_dwordx4 v[60:63], off, s[64:67], s51 offset:1024 sc1
  v_mfma_f32_16x16x32_bf16 v[148:151], v[184:187], v[76:79], v[148:151]
  ds_read_b64_tr_b16 v[202:203], v8 offset:43008
  ds_read_b64_tr_b16 v[204:205], v9 offset:40960
  v_mfma_f32_16x16x32_bf16 v[148:151], v[168:171], v[68:71], v[148:151]
  ds_read_b64_tr_b16 v[206:207], v9 offset:43008
  v_mfma_f32_16x16x32_bf16 v[156:159], v[172:175], v[68:71], v[156:159]
  ds_read_b64_tr_b16 v[216:217], v8 offset:45056
  v_mfma_f32_16x16x32_bf16 v[156:159], v[188:191], v[76:79], v[156:159]
  ds_read_b64_tr_b16 v[218:219], v8 offset:47104
  v_mfma_f32_16x16x32_bf16 v[152:155], v[188:191], v[72:75], v[152:155]
  ds_read_b64_tr_b16 v[220:221], v9 offset:45056
  v_mfma_f32_16x16x32_bf16 v[152:155], v[172:175], v[64:67], v[152:155]
  ds_read_b64_tr_b16 v[222:223], v9 offset:47104
  s_waitcnt lgkmcnt(8)
  v_mfma_f32_16x16x32_bf16 v[96:99], v[192:195], v[64:67], v[96:99]
  ds_read_b64_tr_b16 v[160:161], v6 offset:49152
  v_mfma_f32_16x16x32_bf16 v[96:99], v[208:211], v[72:75], v[96:99]
  ds_read_b64_tr_b16 v[162:163], v6 offset:51200
  v_mfma_f32_16x16x32_bf16 v[100:103], v[208:211], v[76:79], v[100:103]
  ds_read_b64_tr_b16 v[164:165], v7 offset:49152
  v_mfma_f32_16x16x32_bf16 v[100:103], v[192:195], v[68:71], v[100:103]
  ds_read_b64_tr_b16 v[166:167], v7 offset:51200
  v_mfma_f32_16x16x32_bf16 v[108:111], v[196:199], v[68:71], v[108:111]
  ds_read_b64_tr_b16 v[176:177], v6 offset:53248
  v_mfma_f32_16x16x32_bf16 v[108:111], v[212:215], v[76:79], v[108:111]
  ds_read_b64_tr_b16 v[178:179], v6 offset:55296
  v_mfma_f32_16x16x32_bf16 v[104:107], v[212:215], v[72:75], v[104:107]
  ds_read_b64_tr_b16 v[180:181], v7 offset:53248
  v_mfma_f32_16x16x32_bf16 v[104:107], v[196:199], v[64:67], v[104:107]
  ds_read_b64_tr_b16 v[182:183], v7 offset:55296
  s_waitcnt lgkmcnt(8)
  v_mfma_f32_16x16x32_bf16 v[112:115], v[200:203], v[64:67], v[112:115]
  ds_read_b64_tr_b16 v[168:169], v8 offset:49152
  v_mfma_f32_16x16x32_bf16 v[112:115], v[216:219], v[72:75], v[112:115]
  ds_read_b64_tr_b16 v[170:171], v8 offset:51200
  v_mfma_f32_16x16x32_bf16 v[116:119], v[216:219], v[76:79], v[116:119]
  ds_read_b64_tr_b16 v[172:173], v9 offset:49152
  v_mfma_f32_16x16x32_bf16 v[116:119], v[200:203], v[68:71], v[116:119]
  ds_read_b64_tr_b16 v[174:175], v9 offset:51200
  v_mfma_f32_16x16x32_bf16 v[124:127], v[204:207], v[68:71], v[124:127]
  ds_read_b64_tr_b16 v[184:185], v8 offset:53248
  v_mfma_f32_16x16x32_bf16 v[124:127], v[220:223], v[76:79], v[124:127]
  ds_read_b64_tr_b16 v[186:187], v8 offset:55296
  v_readlane_b32 s48, v30, 8
  v_mfma_f32_16x16x32_bf16 v[120:123], v[220:223], v[72:75], v[120:123]
  ds_read_b64_tr_b16 v[188:189], v9 offset:53248
  v_mfma_f32_16x16x32_bf16 v[120:123], v[204:207], v[64:67], v[120:123]
  ds_read_b64_tr_b16 v[190:191], v9 offset:55296
  s_waitcnt vmcnt(16) lgkmcnt(8)
  v_mfma_f32_16x16x32_bf16 v[128:131], v[160:163], v[80:83], v[128:131]
  buffer_load_dwordx4 v[64:67], off, s[36:39], s48 offset:0 sc1
  v_mfma_f32_16x16x32_bf16 v[128:131], v[176:179], v[88:91], v[128:131]
  ds_read_b64_tr_b16 v[192:193], v6 offset:57344
  ds_read_b64_tr_b16 v[194:195], v6 offset:59392
  v_mfma_f32_16x16x32_bf16 v[132:135], v[176:179], v[92:95], v[132:135]
  ds_read_b64_tr_b16 v[196:197], v7 offset:57344
  v_mfma_f32_16x16x32_bf16 v[132:135], v[160:163], v[84:87], v[132:135]
  ds_read_b64_tr_b16 v[198:199], v7 offset:59392
  v_mfma_f32_16x16x32_bf16 v[140:143], v[164:167], v[84:87], v[140:143]
  ds_read_b64_tr_b16 v[208:209], v6 offset:61440
  v_mfma_f32_16x16x32_bf16 v[140:143], v[180:183], v[92:95], v[140:143]
  ds_read_b64_tr_b16 v[210:211], v6 offset:63488
  ds_read_b64_tr_b16 v[212:213], v7 offset:61440
  v_mfma_f32_16x16x32_bf16 v[136:139], v[180:183], v[88:91], v[136:139]
  buffer_load_dwordx4 v[68:71], off, s[64:67], s48 offset:0 sc1
  v_mfma_f32_16x16x32_bf16 v[136:139], v[164:167], v[80:83], v[136:139]
  ds_read_b64_tr_b16 v[214:215], v7 offset:63488
  s_waitcnt lgkmcnt(8)
  v_mfma_f32_16x16x32_bf16 v[144:147], v[168:171], v[80:83], v[144:147]
  ds_read_b64_tr_b16 v[200:201], v8 offset:57344
  v_mfma_f32_16x16x32_bf16 v[144:147], v[184:187], v[88:91], v[144:147]
  ds_read_b64_tr_b16 v[202:203], v8 offset:59392
  v_mfma_f32_16x16x32_bf16 v[148:151], v[184:187], v[92:95], v[148:151]
  ds_read_b64_tr_b16 v[204:205], v9 offset:57344
  v_mfma_f32_16x16x32_bf16 v[148:151], v[168:171], v[84:87], v[148:151]
  ds_read_b64_tr_b16 v[206:207], v9 offset:59392
  v_mfma_f32_16x16x32_bf16 v[156:159], v[172:175], v[84:87], v[156:159]
  buffer_load_dwordx4 v[72:75], off, s[36:39], s48 offset:1024 sc1
  v_mfma_f32_16x16x32_bf16 v[156:159], v[188:191], v[92:95], v[156:159]
  ds_read_b64_tr_b16 v[216:217], v8 offset:61440
  ds_read_b64_tr_b16 v[218:219], v8 offset:63488
  v_mfma_f32_16x16x32_bf16 v[152:155], v[188:191], v[88:91], v[152:155]
  ds_read_b64_tr_b16 v[220:221], v9 offset:61440
  v_mfma_f32_16x16x32_bf16 v[152:155], v[172:175], v[80:83], v[152:155]
  ds_read_b64_tr_b16 v[222:223], v9 offset:63488
  s_waitcnt lgkmcnt(8)
  v_mfma_f32_16x16x32_bf16 v[96:99], v[192:195], v[80:83], v[96:99]
  ds_read_b64_tr_b16 v[160:161], v20 offset:0
  v_mfma_f32_16x16x32_bf16 v[96:99], v[208:211], v[88:91], v[96:99]
  ds_read_b64_tr_b16 v[162:163], v20 offset:2048
  v_mfma_f32_16x16x32_bf16 v[100:103], v[208:211], v[92:95], v[100:103]
  buffer_load_dwordx4 v[76:79], off, s[64:67], s48 offset:1024 sc1
  v_mfma_f32_16x16x32_bf16 v[100:103], v[192:195], v[84:87], v[100:103]
  ds_read_b64_tr_b16 v[164:165], v21 offset:0
  ds_read_b64_tr_b16 v[166:167], v21 offset:2048
  v_mfma_f32_16x16x32_bf16 v[108:111], v[196:199], v[84:87], v[108:111]
  ds_read_b64_tr_b16 v[176:177], v20 offset:4096
  v_mfma_f32_16x16x32_bf16 v[108:111], v[212:215], v[92:95], v[108:111]
  ds_read_b64_tr_b16 v[178:179], v20 offset:6144
  v_mfma_f32_16x16x32_bf16 v[104:107], v[212:215], v[88:91], v[104:107]
  ds_read_b64_tr_b16 v[180:181], v21 offset:4096
  v_mfma_f32_16x16x32_bf16 v[104:107], v[196:199], v[80:83], v[104:107]
  ds_read_b64_tr_b16 v[182:183], v21 offset:6144
  s_waitcnt lgkmcnt(8)
  s_barrier
  v_mfma_f32_16x16x32_bf16 v[112:115], v[200:203], v[80:83], v[112:115]
  ds_read_b64_tr_b16 v[168:169], v22 offset:0
  v_mfma_f32_16x16x32_bf16 v[112:115], v[216:219], v[88:91], v[112:115]
  ds_read_b64_tr_b16 v[170:171], v22 offset:2048
  v_mfma_f32_16x16x32_bf16 v[116:119], v[216:219], v[92:95], v[116:119]
  ds_read_b64_tr_b16 v[172:173], v23 offset:0
  v_mfma_f32_16x16x32_bf16 v[116:119], v[200:203], v[84:87], v[116:119]
  ds_read_b64_tr_b16 v[174:175], v23 offset:2048
  v_mfma_f32_16x16x32_bf16 v[124:127], v[204:207], v[84:87], v[124:127]
  ds_read_b64_tr_b16 v[184:185], v22 offset:4096
  v_mfma_f32_16x16x32_bf16 v[124:127], v[220:223], v[92:95], v[124:127]
  ds_read_b64_tr_b16 v[186:187], v22 offset:6144
  v_readlane_b32 s49, v30, 9
  v_mfma_f32_16x16x32_bf16 v[120:123], v[220:223], v[88:91], v[120:123]
  ds_read_b64_tr_b16 v[188:189], v23 offset:4096
  v_mfma_f32_16x16x32_bf16 v[120:123], v[204:207], v[80:83], v[120:123]
  ds_read_b64_tr_b16 v[190:191], v23 offset:6144
  s_waitcnt vmcnt(16) lgkmcnt(8)
  v_mfma_f32_16x16x32_bf16 v[128:131], v[160:163], v[224:227], v[128:131]
  buffer_load_dwordx4 v[80:83], off, s[36:39], s49 offset:0 sc1
  v_mfma_f32_16x16x32_bf16 v[128:131], v[176:179], v[232:235], v[128:131]
  ds_read_b64_tr_b16 v[192:193], v20 offset:8192
  ds_read_b64_tr_b16 v[194:195], v20 offset:10240
  v_mfma_f32_16x16x32_bf16 v[132:135], v[176:179], v[236:239], v[132:135]
  ds_read_b64_tr_b16 v[196:197], v21 offset:8192
  v_mfma_f32_16x16x32_bf16 v[132:135], v[160:163], v[228:231], v[132:135]
  ds_read_b64_tr_b16 v[198:199], v21 offset:10240
  v_mfma_f32_16x16x32_bf16 v[140:143], v[164:167], v[228:231], v[140:143]
  ds_read_b64_tr_b16 v[208:209], v20 offset:12288
  v_mfma_f32_16x16x32_bf16 v[140:143], v[180:183], v[236:239], v[140:143]
  ds_read_b64_tr_b16 v[210:211], v20 offset:14336
  ds_read_b64_tr_b16 v[212:213], v21 offset:12288
  v_mfma_f32_16x16x32_bf16 v[136:139], v[180:183], v[232:235], v[136:139]
  buffer_load_dwordx4 v[84:87], off, s[64:67], s49 offset:0 sc1
  v_mfma_f32_16x16x32_bf16 v[136:139], v[164:167], v[224:227], v[136:139]
  ds_read_b64_tr_b16 v[214:215], v21 offset:14336
  s_waitcnt lgkmcnt(8)
  v_mfma_f32_16x16x32_bf16 v[144:147], v[168:171], v[224:227], v[144:147]
  ds_read_b64_tr_b16 v[200:201], v22 offset:8192
  v_mfma_f32_16x16x32_bf16 v[144:147], v[184:187], v[232:235], v[144:147]
  ds_read_b64_tr_b16 v[202:203], v22 offset:10240
  v_mfma_f32_16x16x32_bf16 v[148:151], v[184:187], v[236:239], v[148:151]
  ds_read_b64_tr_b16 v[204:205], v23 offset:8192
  v_mfma_f32_16x16x32_bf16 v[148:151], v[168:171], v[228:231], v[148:151]
  ds_read_b64_tr_b16 v[206:207], v23 offset:10240
  v_mfma_f32_16x16x32_bf16 v[156:159], v[172:175], v[228:231], v[156:159]
  buffer_load_dwordx4 v[88:91], off, s[36:39], s49 offset:1024 sc1
  v_mfma_f32_16x16x32_bf16 v[156:159], v[188:191], v[236:239], v[156:159]
  ds_read_b64_tr_b16 v[216:217], v22 offset:12288
  ds_read_b64_tr_b16 v[218:219], v22 offset:14336
  v_mfma_f32_16x16x32_bf16 v[152:155], v[188:191], v[232:235], v[152:155]
  ds_read_b64_tr_b16 v[220:221], v23 offset:12288
  v_mfma_f32_16x16x32_bf16 v[152:155], v[172:175], v[224:227], v[152:155]
  ds_read_b64_tr_b16 v[222:223], v23 offset:14336
  s_waitcnt lgkmcnt(8)
  v_mfma_f32_16x16x32_bf16 v[96:99], v[192:195], v[224:227], v[96:99]
  ds_read_b64_tr_b16 v[160:161], v20 offset:16384
  v_mfma_f32_16x16x32_bf16 v[96:99], v[208:211], v[232:235], v[96:99]
  ds_read_b64_tr_b16 v[162:163], v20 offset:18432
  v_mfma_f32_16x16x32_bf16 v[100:103], v[208:211], v[236:239], v[100:103]
  buffer_load_dwordx4 v[92:95], off, s[64:67], s49 offset:1024 sc1
  v_mfma_f32_16x16x32_bf16 v[100:103], v[192:195], v[228:231], v[100:103]
  ds_read_b64_tr_b16 v[164:165], v21 offset:16384
  ds_read_b64_tr_b16 v[166:167], v21 offset:18432
  v_mfma_f32_16x16x32_bf16 v[108:111], v[196:199], v[228:231], v[108:111]
  ds_read_b64_tr_b16 v[176:177], v20 offset:20480
  v_mfma_f32_16x16x32_bf16 v[108:111], v[212:215], v[236:239], v[108:111]
  ds_read_b64_tr_b16 v[178:179], v20 offset:22528
  v_mfma_f32_16x16x32_bf16 v[104:107], v[212:215], v[232:235], v[104:107]
  ds_read_b64_tr_b16 v[180:181], v21 offset:20480
  v_mfma_f32_16x16x32_bf16 v[104:107], v[196:199], v[224:227], v[104:107]
  ds_read_b64_tr_b16 v[182:183], v21 offset:22528
  s_waitcnt lgkmcnt(8)
  v_mfma_f32_16x16x32_bf16 v[112:115], v[200:203], v[224:227], v[112:115]
  ds_read_b64_tr_b16 v[168:169], v22 offset:16384
  v_mfma_f32_16x16x32_bf16 v[112:115], v[216:219], v[232:235], v[112:115]
  ds_read_b64_tr_b16 v[170:171], v22 offset:18432
  v_mfma_f32_16x16x32_bf16 v[116:119], v[216:219], v[236:239], v[116:119]
  ds_read_b64_tr_b16 v[172:173], v23 offset:16384
  v_mfma_f32_16x16x32_bf16 v[116:119], v[200:203], v[228:231], v[116:119]
  ds_read_b64_tr_b16 v[174:175], v23 offset:18432
  v_mfma_f32_16x16x32_bf16 v[124:127], v[204:207], v[228:231], v[124:127]
  ds_read_b64_tr_b16 v[184:185], v22 offset:20480
  v_mfma_f32_16x16x32_bf16 v[124:127], v[220:223], v[236:239], v[124:127]
  ds_read_b64_tr_b16 v[186:187], v22 offset:22528
  v_readlane_b32 s50, v30, 10
  v_mfma_f32_16x16x32_bf16 v[120:123], v[220:223], v[232:235], v[120:123]
  ds_read_b64_tr_b16 v[188:189], v23 offset:20480
  v_mfma_f32_16x16x32_bf16 v[120:123], v[204:207], v[224:227], v[120:123]
  ds_read_b64_tr_b16 v[190:191], v23 offset:22528
  s_waitcnt vmcnt(16) lgkmcnt(8)
  v_mfma_f32_16x16x32_bf16 v[128:131], v[160:163], v[240:243], v[128:131]
  buffer_load_dwordx4 v[224:227], off, s[36:39], s50 offset:0 sc1
  v_mfma_f32_16x16x32_bf16 v[128:131], v[176:179], v[248:251], v[128:131]
  ds_read_b64_tr_b16 v[192:193], v20 offset:24576
  ds_read_b64_tr_b16 v[194:195], v20 offset:26624
  v_mfma_f32_16x16x32_bf16 v[132:135], v[176:179], v[252:255], v[132:135]
  ds_read_b64_tr_b16 v[196:197], v21 offset:24576
  v_mfma_f32_16x16x32_bf16 v[132:135], v[160:163], v[244:247], v[132:135]
  ds_read_b64_tr_b16 v[198:199], v21 offset:26624
  v_mfma_f32_16x16x32_bf16 v[140:143], v[164:167], v[244:247], v[140:143]
  ds_read_b64_tr_b16 v[208:209], v20 offset:28672
  v_mfma_f32_16x16x32_bf16 v[140:143], v[180:183], v[252:255], v[140:143]
  ds_read_b64_tr_b16 v[210:211], v20 offset:30720
  ds_read_b64_tr_b16 v[212:213], v21 offset:28672
  v_mfma_f32_16x16x32_bf16 v[136:139], v[180:183], v[248:251], v[136:139]
  buffer_load_dwordx4 v[228:231], off, s[64:67], s50 offset:0 sc1
  v_mfma_f32_16x16x32_bf16 v[136:139], v[164:167], v[240:243], v[136:139]
  ds_read_b64_tr_b16 v[214:215], v21 offset:30720
  s_waitcnt lgkmcnt(8)
  v_mfma_f32_16x16x32_bf16 v[144:147], v[168:171], v[240:243], v[144:147]
  ds_read_b64_tr_b16 v[200:201], v22 offset:24576
  v_mfma_f32_16x16x32_bf16 v[144:147], v[184:187], v[248:251], v[144:147]
  ds_read_b64_tr_b16 v[202:203], v22 offset:26624
  v_mfma_f32_16x16x32_bf16 v[148:151], v[184:187], v[252:255], v[148:151]
  ds_read_b64_tr_b16 v[204:205], v23 offset:24576
  v_mfma_f32_16x16x32_bf16 v[148:151], v[168:171], v[244:247], v[148:151]
  ds_read_b64_tr_b16 v[206:207], v23 offset:26624
  v_mfma_f32_16x16x32_bf16 v[156:159], v[172:175], v[244:247], v[156:159]
  buffer_load_dwordx4 v[232:235], off, s[36:39], s50 offset:1024 sc1
  v_mfma_f32_16x16x32_bf16 v[156:159], v[188:191], v[252:255], v[156:159]
  ds_read_b64_tr_b16 v[216:217], v22 offset:28672
  ds_read_b64_tr_b16 v[218:219], v22 offset:30720
  v_mfma_f32_16x16x32_bf16 v[152:155], v[188:191], v[248:251], v[152:155]
  ds_read_b64_tr_b16 v[220:221], v23 offset:28672
  v_mfma_f32_16x16x32_bf16 v[152:155], v[172:175], v[240:243], v[152:155]
  ds_read_b64_tr_b16 v[222:223], v23 offset:30720
  s_waitcnt lgkmcnt(8)
  v_mfma_f32_16x16x32_bf16 v[96:99], v[192:195], v[240:243], v[96:99]
  ds_read_b64_tr_b16 v[160:161], v20 offset:32768
  v_mfma_f32_16x16x32_bf16 v[96:99], v[208:211], v[248:251], v[96:99]
  ds_read_b64_tr_b16 v[162:163], v20 offset:34816
  v_mfma_f32_16x16x32_bf16 v[100:103], v[208:211], v[252:255], v[100:103]
  buffer_load_dwordx4 v[236:239], off, s[64:67], s50 offset:1024 sc1
  v_mfma_f32_16x16x32_bf16 v[100:103], v[192:195], v[244:247], v[100:103]
  ds_read_b64_tr_b16 v[164:165], v21 offset:32768
  ds_read_b64_tr_b16 v[166:167], v21 offset:34816
  v_mfma_f32_16x16x32_bf16 v[108:111], v[196:199], v[244:247], v[108:111]
  ds_read_b64_tr_b16 v[176:177], v20 offset:36864
  v_mfma_f32_16x16x32_bf16 v[108:111], v[212:215], v[252:255], v[108:111]
  ds_read_b64_tr_b16 v[178:179], v20 offset:38912
  v_mfma_f32_16x16x32_bf16 v[104:107], v[212:215], v[248:251], v[104:107]
  ds_read_b64_tr_b16 v[180:181], v21 offset:36864
  v_mfma_f32_16x16x32_bf16 v[104:107], v[196:199], v[240:243], v[104:107]
  ds_read_b64_tr_b16 v[182:183], v21 offset:38912
  s_waitcnt lgkmcnt(8)
  s_barrier
  v_mfma_f32_16x16x32_bf16 v[112:115], v[200:203], v[240:243], v[112:115]
  ds_read_b64_tr_b16 v[168:169], v22 offset:32768
  v_mfma_f32_16x16x32_bf16 v[112:115], v[216:219], v[248:251], v[112:115]
  ds_read_b64_tr_b16 v[170:171], v22 offset:34816
  v_mfma_f32_16x16x32_bf16 v[116:119], v[216:219], v[252:255], v[116:119]
  ds_read_b64_tr_b16 v[172:173], v23 offset:32768
  v_mfma_f32_16x16x32_bf16 v[116:119], v[200:203], v[244:247], v[116:119]
  ds_read_b64_tr_b16 v[174:175], v23 offset:34816
  v_mfma_f32_16x16x32_bf16 v[124:127], v[204:207], v[244:247], v[124:127]
  ds_read_b64_tr_b16 v[184:185], v22 offset:36864
  v_mfma_f32_16x16x32_bf16 v[124:127], v[220:223], v[252:255], v[124:127]
  ds_read_b64_tr_b16 v[186:187], v22 offset:38912
  v_readlane_b32 s51, v30, 11
  v_mfma_f32_16x16x32_bf16 v[120:123], v[220:223], v[248:251], v[120:123]
  ds_read_b64_tr_b16 v[188:189], v23 offset:36864
  v_mfma_f32_16x16x32_bf16 v[120:123], v[204:207], v[240:243], v[120:123]
  ds_read_b64_tr_b16 v[190:191], v23 offset:38912
  s_waitcnt vmcnt(16) lgkmcnt(8)
  v_mfma_f32_16x16x32_bf16 v[128:131], v[160:163], v[32:35], v[128:131]
  buffer_load_dwordx4 v[240:243], off, s[36:39], s51 offset:0 sc1
  v_mfma_f32_16x16x32_bf16 v[128:131], v[176:179], v[40:43], v[128:131]
  ds_read_b64_tr_b16 v[192:193], v20 offset:40960
  ds_read_b64_tr_b16 v[194:195], v20 offset:43008
  v_mfma_f32_16x16x32_bf16 v[132:135], v[176:179], v[44:47], v[132:135]
  ds_read_b64_tr_b16 v[196:197], v21 offset:40960
  v_mfma_f32_16x16x32_bf16 v[132:135], v[160:163], v[36:39], v[132:135]
  ds_read_b64_tr_b16 v[198:199], v21 offset:43008
  v_mfma_f32_16x16x32_bf16 v[140:143], v[164:167], v[36:39], v[140:143]
  ds_read_b64_tr_b16 v[208:209], v20 offset:45056
  v_mfma_f32_16x16x32_bf16 v[140:143], v[180:183], v[44:47], v[140:143]
  ds_read_b64_tr_b16 v[210:211], v20 offset:47104
  ds_read_b64_tr_b16 v[212:213], v21 offset:45056
  v_mfma_f32_16x16x32_bf16 v[136:139], v[180:183], v[40:43], v[136:139]
  buffer_load_dwordx4 v[244:247], off, s[64:67], s51 offset:0 sc1
  v_mfma_f32_16x16x32_bf16 v[136:139], v[164:167], v[32:35], v[136:139]
  ds_read_b64_tr_b16 v[214:215], v21 offset:47104
  s_waitcnt lgkmcnt(8)
  v_mfma_f32_16x16x32_bf16 v[144:147], v[168:171], v[32:35], v[144:147]
  ds_read_b64_tr_b16 v[200:201], v22 offset:40960
  v_mfma_f32_16x16x32_bf16 v[144:147], v[184:187], v[40:43], v[144:147]
  ds_read_b64_tr_b16 v[202:203], v22 offset:43008
  v_mfma_f32_16x16x32_bf16 v[148:151], v[184:187], v[44:47], v[148:151]
  ds_read_b64_tr_b16 v[204:205], v23 offset:40960
  v_mfma_f32_16x16x32_bf16 v[148:151], v[168:171], v[36:39], v[148:151]
  ds_read_b64_tr_b16 v[206:207], v23 offset:43008
  v_mfma_f32_16x16x32_bf16 v[156:159], v[172:175], v[36:39], v[156:159]
  buffer_load_dwordx4 v[248:251], off, s[36:39], s51 offset:1024 sc1
  v_mfma_f32_16x16x32_bf16 v[156:159], v[188:191], v[44:47], v[156:159]
  ds_read_b64_tr_b16 v[216:217], v22 offset:45056
  ds_read_b64_tr_b16 v[218:219], v22 offset:47104
  v_mfma_f32_16x16x32_bf16 v[152:155], v[188:191], v[40:43], v[152:155]
  ds_read_b64_tr_b16 v[220:221], v23 offset:45056
  v_mfma_f32_16x16x32_bf16 v[152:155], v[172:175], v[32:35], v[152:155]
  ds_read_b64_tr_b16 v[222:223], v23 offset:47104
  s_waitcnt lgkmcnt(8)
  v_mfma_f32_16x16x32_bf16 v[96:99], v[192:195], v[32:35], v[96:99]
  ds_read_b64_tr_b16 v[160:161], v20 offset:49152
  v_mfma_f32_16x16x32_bf16 v[96:99], v[208:211], v[40:43], v[96:99]
  ds_read_b64_tr_b16 v[162:163], v20 offset:51200
  v_mfma_f32_16x16x32_bf16 v[100:103], v[208:211], v[44:47], v[100:103]
  buffer_load_dwordx4 v[252:255], off, s[64:67], s51 offset:1024 sc1
  v_mfma_f32_16x16x32_bf16 v[100:103], v[192:195], v[36:39], v[100:103]
  ds_read_b64_tr_b16 v[164:165], v21 offset:49152
  ds_read_b64_tr_b16 v[166:167], v21 offset:51200
  v_mfma_f32_16x16x32_bf16 v[108:111], v[196:199], v[36:39], v[108:111]
  ds_read_b64_tr_b16 v[176:177], v20 offset:53248
  v_mfma_f32_16x16x32_bf16 v[108:111], v[212:215], v[44:47], v[108:111]
  ds_read_b64_tr_b16 v[178:179], v20 offset:55296
  v_mfma_f32_16x16x32_bf16 v[104:107], v[212:215], v[40:43], v[104:107]
  ds_read_b64_tr_b16 v[180:181], v21 offset:53248
  v_mfma_f32_16x16x32_bf16 v[104:107], v[196:199], v[32:35], v[104:107]
  ds_read_b64_tr_b16 v[182:183], v21 offset:55296
  s_waitcnt lgkmcnt(8)
  v_mfma_f32_16x16x32_bf16 v[112:115], v[200:203], v[32:35], v[112:115]
  ds_read_b64_tr_b16 v[168:169], v22 offset:49152
  v_mfma_f32_16x16x32_bf16 v[112:115], v[216:219], v[40:43], v[112:115]
  ds_read_b64_tr_b16 v[170:171], v22 offset:51200
  v_mfma_f32_16x16x32_bf16 v[116:119], v[216:219], v[44:47], v[116:119]
  ds_read_b64_tr_b16 v[172:173], v23 offset:49152
  v_mfma_f32_16x16x32_bf16 v[116:119], v[200:203], v[36:39], v[116:119]
  ds_read_b64_tr_b16 v[174:175], v23 offset:51200
  v_mfma_f32_16x16x32_bf16 v[124:127], v[204:207], v[36:39], v[124:127]
  ds_read_b64_tr_b16 v[184:185], v22 offset:53248
  v_mfma_f32_16x16x32_bf16 v[124:127], v[220:223], v[44:47], v[124:127]
  ds_read_b64_tr_b16 v[186:187], v22 offset:55296
  v_readlane_b32 s48, v30, 12
  v_mfma_f32_16x16x32_bf16 v[120:123], v[220:223], v[40:43], v[120:123]
  ds_read_b64_tr_b16 v[188:189], v23 offset:53248
  v_mfma_f32_16x16x32_bf16 v[120:123], v[204:207], v[32:35], v[120:123]
  ds_read_b64_tr_b16 v[190:191], v23 offset:55296
  s_waitcnt vmcnt(16) lgkmcnt(8)
  v_mfma_f32_16x16x32_bf16 v[128:131], v[160:163], v[48:51], v[128:131]
  buffer_load_dwordx4 v[32:35], off, s[36:39], s48 offset:0 sc1
  v_mfma_f32_16x16x32_bf16 v[128:131], v[176:179], v[56:59], v[128:131]
  ds_read_b64_tr_b16 v[192:193], v20 offset:57344
  ds_read_b64_tr_b16 v[194:195], v20 offset:59392
  v_mfma_f32_16x16x32_bf16 v[132:135], v[176:179], v[60:63], v[132:135]
  ds_read_b64_tr_b16 v[196:197], v21 offset:57344
  v_mfma_f32_16x16x32_bf16 v[132:135], v[160:163], v[52:55], v[132:135]
  ds_read_b64_tr_b16 v[198:199], v21 offset:59392
  v_mfma_f32_16x16x32_bf16 v[140:143], v[164:167], v[52:55], v[140:143]
  ds_read_b64_tr_b16 v[208:209], v20 offset:61440
  v_mfma_f32_16x16x32_bf16 v[140:143], v[180:183], v[60:63], v[140:143]
  ds_read_b64_tr_b16 v[210:211], v20 offset:63488
  ds_read_b64_tr_b16 v[212:213], v21 offset:61440
  v_mfma_f32_16x16x32_bf16 v[136:139], v[180:183], v[56:59], v[136:139]
  buffer_load_dwordx4 v[36:39], off, s[64:67], s48 offset:0 sc1
  v_mfma_f32_16x16x32_bf16 v[136:139], v[164:167], v[48:51], v[136:139]
  ds_read_b64_tr_b16 v[214:215], v21 offset:63488
  s_waitcnt lgkmcnt(8)
  v_mfma_f32_16x16x32_bf16 v[144:147], v[168:171], v[48:51], v[144:147]
  ds_read_b64_tr_b16 v[200:201], v22 offset:57344
  v_mfma_f32_16x16x32_bf16 v[144:147], v[184:187], v[56:59], v[144:147]
  ds_read_b64_tr_b16 v[202:203], v22 offset:59392
  v_mfma_f32_16x16x32_bf16 v[148:151], v[184:187], v[60:63], v[148:151]
  ds_read_b64_tr_b16 v[204:205], v23 offset:57344
  v_mfma_f32_16x16x32_bf16 v[148:151], v[168:171], v[52:55], v[148:151]
  ds_read_b64_tr_b16 v[206:207], v23 offset:59392
  v_mfma_f32_16x16x32_bf16 v[156:159], v[172:175], v[52:55], v[156:159]
  buffer_load_dwordx4 v[40:43], off, s[36:39], s48 offset:1024 sc1
  v_mfma_f32_16x16x32_bf16 v[156:159], v[188:191], v[60:63], v[156:159]
  ds_read_b64_tr_b16 v[216:217], v22 offset:61440
  ds_read_b64_tr_b16 v[218:219], v22 offset:63488
  v_mfma_f32_16x16x32_bf16 v[152:155], v[188:191], v[56:59], v[152:155]
  ds_read_b64_tr_b16 v[220:221], v23 offset:61440
  v_mfma_f32_16x16x32_bf16 v[152:155], v[172:175], v[48:51], v[152:155]
  ds_read_b64_tr_b16 v[222:223], v23 offset:63488
  s_waitcnt lgkmcnt(8)
  v_mfma_f32_16x16x32_bf16 v[96:99], v[192:195], v[48:51], v[96:99]
  ds_read_b64_tr_b16 v[160:161], v26 offset:0
  v_mfma_f32_16x16x32_bf16 v[96:99], v[208:211], v[56:59], v[96:99]
  ds_read_b64_tr_b16 v[162:163], v26 offset:2048
  v_mfma_f32_16x16x32_bf16 v[100:103], v[208:211], v[60:63], v[100:103]
  buffer_load_dwordx4 v[44:47], off, s[64:67], s48 offset:1024 sc1
  v_mfma_f32_16x16x32_bf16 v[100:103], v[192:195], v[52:55], v[100:103]
  ds_read_b64_tr_b16 v[164:165], v27 offset:0
  ds_read_b64_tr_b16 v[166:167], v27 offset:2048
  v_mfma_f32_16x16x32_bf16 v[108:111], v[196:199], v[52:55], v[108:111]
  ds_read_b64_tr_b16 v[176:177], v26 offset:4096
  v_mfma_f32_16x16x32_bf16 v[108:111], v[212:215], v[60:63], v[108:111]
  ds_read_b64_tr_b16 v[178:179], v26 offset:6144
  v_mfma_f32_16x16x32_bf16 v[104:107], v[212:215], v[56:59], v[104:107]
  ds_read_b64_tr_b16 v[180:181], v27 offset:4096
  v_mfma_f32_16x16x32_bf16 v[104:107], v[196:199], v[48:51], v[104:107]
  ds_read_b64_tr_b16 v[182:183], v27 offset:6144
  s_waitcnt lgkmcnt(8)
  s_barrier
  v_mfma_f32_16x16x32_bf16 v[112:115], v[200:203], v[48:51], v[112:115]
  ds_read_b64_tr_b16 v[168:169], v28 offset:0
  v_mfma_f32_16x16x32_bf16 v[112:115], v[216:219], v[56:59], v[112:115]
  ds_read_b64_tr_b16 v[170:171], v28 offset:2048
  v_mfma_f32_16x16x32_bf16 v[116:119], v[216:219], v[60:63], v[116:119]
  ds_read_b64_tr_b16 v[172:173], v29 offset:0
  v_mfma_f32_16x16x32_bf16 v[116:119], v[200:203], v[52:55], v[116:119]
  ds_read_b64_tr_b16 v[174:175], v29 offset:2048
  v_mfma_f32_16x16x32_bf16 v[124:127], v[204:207], v[52:55], v[124:127]
  ds_read_b64_tr_b16 v[184:185], v28 offset:4096
  v_mfma_f32_16x16x32_bf16 v[124:127], v[220:223], v[60:63], v[124:127]
  ds_read_b64_tr_b16 v[186:187], v28 offset:6144
  v_readlane_b32 s49, v30, 13
  v_mfma_f32_16x16x32_bf16 v[120:123], v[220:223], v[56:59], v[120:123]
  ds_read_b64_tr_b16 v[188:189], v29 offset:4096
  v_mfma_f32_16x16x32_bf16 v[120:123], v[204:207], v[48:51], v[120:123]
  ds_read_b64_tr_b16 v[190:191], v29 offset:6144
  s_waitcnt vmcnt(16) lgkmcnt(8)
  v_mfma_f32_16x16x32_bf16 v[128:131], v[160:163], v[64:67], v[128:131]
  buffer_load_dwordx4 v[48:51], off, s[36:39], s49 offset:0 sc1
  v_mfma_f32_16x16x32_bf16 v[128:131], v[176:179], v[72:75], v[128:131]
  ds_read_b64_tr_b16 v[192:193], v26 offset:8192
  ds_read_b64_tr_b16 v[194:195], v26 offset:10240
  v_mfma_f32_16x16x32_bf16 v[132:135], v[176:179], v[76:79], v[132:135]
  ds_read_b64_tr_b16 v[196:197], v27 offset:8192
  v_mfma_f32_16x16x32_bf16 v[132:135], v[160:163], v[68:71], v[132:135]
  ds_read_b64_tr_b16 v[198:199], v27 offset:10240
  v_mfma_f32_16x16x32_bf16 v[140:143], v[164:167], v[68:71], v[140:143]
  ds_read_b64_tr_b16 v[208:209], v26 offset:12288
  v_mfma_f32_16x16x32_bf16 v[140:143], v[180:183], v[76:79], v[140:143]
  ds_read_b64_tr_b16 v[210:211], v26 offset:14336
  ds_read_b64_tr_b16 v[212:213], v27 offset:12288
  v_mfma_f32_16x16x32_bf16 v[136:139], v[180:183], v[72:75], v[136:139]
  buffer_load_dwordx4 v[52:55], off, s[64:67], s49 offset:0 sc1
  v_mfma_f32_16x16x32_bf16 v[136:139], v[164:167], v[64:67], v[136:139]
  ds_read_b64_tr_b16 v[214:215], v27 offset:14336
  s_waitcnt lgkmcnt(8)
  v_mfma_f32_16x16x32_bf16 v[144:147], v[168:171], v[64:67], v[144:147]
  ds_read_b64_tr_b16 v[200:201], v28 offset:8192
  v_mfma_f32_16x16x32_bf16 v[144:147], v[184:187], v[72:75], v[144:147]
  ds_read_b64_tr_b16 v[202:203], v28 offset:10240
  v_mfma_f32_16x16x32_bf16 v[148:151], v[184:187], v[76:79], v[148:151]
  ds_read_b64_tr_b16 v[204:205], v29 offset:8192
  v_mfma_f32_16x16x32_bf16 v[148:151], v[168:171], v[68:71], v[148:151]
  ds_read_b64_tr_b16 v[206:207], v29 offset:10240
  v_mfma_f32_16x16x32_bf16 v[156:159], v[172:175], v[68:71], v[156:159]
  buffer_load_dwordx4 v[56:59], off, s[36:39], s49 offset:1024 sc1
  v_mfma_f32_16x16x32_bf16 v[156:159], v[188:191], v[76:79], v[156:159]
  ds_read_b64_tr_b16 v[216:217], v28 offset:12288
  ds_read_b64_tr_b16 v[218:219], v28 offset:14336
  v_mfma_f32_16x16x32_bf16 v[152:155], v[188:191], v[72:75], v[152:155]
  ds_read_b64_tr_b16 v[220:221], v29 offset:12288
  v_mfma_f32_16x16x32_bf16 v[152:155], v[172:175], v[64:67], v[152:155]
  ds_read_b64_tr_b16 v[222:223], v29 offset:14336
  s_waitcnt lgkmcnt(8)
  v_mfma_f32_16x16x32_bf16 v[96:99], v[192:195], v[64:67], v[96:99]
  ds_read_b64_tr_b16 v[160:161], v26 offset:16384
  v_mfma_f32_16x16x32_bf16 v[96:99], v[208:211], v[72:75], v[96:99]
  ds_read_b64_tr_b16 v[162:163], v26 offset:18432
  v_mfma_f32_16x16x32_bf16 v[100:103], v[208:211], v[76:79], v[100:103]
  buffer_load_dwordx4 v[60:63], off, s[64:67], s49 offset:1024 sc1
  v_mfma_f32_16x16x32_bf16 v[100:103], v[192:195], v[68:71], v[100:103]
  ds_read_b64_tr_b16 v[164:165], v27 offset:16384
  ds_read_b64_tr_b16 v[166:167], v27 offset:18432
  v_mfma_f32_16x16x32_bf16 v[108:111], v[196:199], v[68:71], v[108:111]
  ds_read_b64_tr_b16 v[176:177], v26 offset:20480
  v_mfma_f32_16x16x32_bf16 v[108:111], v[212:215], v[76:79], v[108:111]
  ds_read_b64_tr_b16 v[178:179], v26 offset:22528
  v_mfma_f32_16x16x32_bf16 v[104:107], v[212:215], v[72:75], v[104:107]
  ds_read_b64_tr_b16 v[180:181], v27 offset:20480
  v_mfma_f32_16x16x32_bf16 v[104:107], v[196:199], v[64:67], v[104:107]
  ds_read_b64_tr_b16 v[182:183], v27 offset:22528
  s_waitcnt lgkmcnt(8)
  v_mfma_f32_16x16x32_bf16 v[112:115], v[200:203], v[64:67], v[112:115]
  ds_read_b64_tr_b16 v[168:169], v28 offset:16384
  v_mfma_f32_16x16x32_bf16 v[112:115], v[216:219], v[72:75], v[112:115]
  ds_read_b64_tr_b16 v[170:171], v28 offset:18432
  v_mfma_f32_16x16x32_bf16 v[116:119], v[216:219], v[76:79], v[116:119]
  ds_read_b64_tr_b16 v[172:173], v29 offset:16384
  v_mfma_f32_16x16x32_bf16 v[116:119], v[200:203], v[68:71], v[116:119]
  ds_read_b64_tr_b16 v[174:175], v29 offset:18432
  v_mfma_f32_16x16x32_bf16 v[124:127], v[204:207], v[68:71], v[124:127]
  ds_read_b64_tr_b16 v[184:185], v28 offset:20480
  v_mfma_f32_16x16x32_bf16 v[124:127], v[220:223], v[76:79], v[124:127]
  ds_read_b64_tr_b16 v[186:187], v28 offset:22528
  v_readlane_b32 s50, v30, 14
  v_mfma_f32_16x16x32_bf16 v[120:123], v[220:223], v[72:75], v[120:123]
  ds_read_b64_tr_b16 v[188:189], v29 offset:20480
  v_mfma_f32_16x16x32_bf16 v[120:123], v[204:207], v[64:67], v[120:123]
  ds_read_b64_tr_b16 v[190:191], v29 offset:22528
  s_waitcnt vmcnt(16) lgkmcnt(8)
  v_mfma_f32_16x16x32_bf16 v[128:131], v[160:163], v[80:83], v[128:131]
  buffer_load_dwordx4 v[64:67], off, s[36:39], s50 offset:0 sc1
  v_mfma_f32_16x16x32_bf16 v[128:131], v[176:179], v[88:91], v[128:131]
  ds_read_b64_tr_b16 v[192:193], v26 offset:24576
  ds_read_b64_tr_b16 v[194:195], v26 offset:26624
  v_mfma_f32_16x16x32_bf16 v[132:135], v[176:179], v[92:95], v[132:135]
  ds_read_b64_tr_b16 v[196:197], v27 offset:24576
  v_mfma_f32_16x16x32_bf16 v[132:135], v[160:163], v[84:87], v[132:135]
  ds_read_b64_tr_b16 v[198:199], v27 offset:26624
  v_mfma_f32_16x16x32_bf16 v[140:143], v[164:167], v[84:87], v[140:143]
  ds_read_b64_tr_b16 v[208:209], v26 offset:28672
  v_mfma_f32_16x16x32_bf16 v[140:143], v[180:183], v[92:95], v[140:143]
  ds_read_b64_tr_b16 v[210:211], v26 offset:30720
  ds_read_b64_tr_b16 v[212:213], v27 offset:28672
  v_mfma_f32_16x16x32_bf16 v[136:139], v[180:183], v[88:91], v[136:139]
  buffer_load_dwordx4 v[68:71], off, s[64:67], s50 offset:0 sc1
  v_mfma_f32_16x16x32_bf16 v[136:139], v[164:167], v[80:83], v[136:139]
  ds_read_b64_tr_b16 v[214:215], v27 offset:30720
  s_waitcnt lgkmcnt(8)
  v_mfma_f32_16x16x32_bf16 v[144:147], v[168:171], v[80:83], v[144:147]
  ds_read_b64_tr_b16 v[200:201], v28 offset:24576
  v_mfma_f32_16x16x32_bf16 v[144:147], v[184:187], v[88:91], v[144:147]
  ds_read_b64_tr_b16 v[202:203], v28 offset:26624
  v_mfma_f32_16x16x32_bf16 v[148:151], v[184:187], v[92:95], v[148:151]
  ds_read_b64_tr_b16 v[204:205], v29 offset:24576
  v_mfma_f32_16x16x32_bf16 v[148:151], v[168:171], v[84:87], v[148:151]
  ds_read_b64_tr_b16 v[206:207], v29 offset:26624
  v_mfma_f32_16x16x32_bf16 v[156:159], v[172:175], v[84:87], v[156:159]
  buffer_load_dwordx4 v[72:75], off, s[36:39], s50 offset:1024 sc1
  v_mfma_f32_16x16x32_bf16 v[156:159], v[188:191], v[92:95], v[156:159]
  ds_read_b64_tr_b16 v[216:217], v28 offset:28672
  ds_read_b64_tr_b16 v[218:219], v28 offset:30720
  v_mfma_f32_16x16x32_bf16 v[152:155], v[188:191], v[88:91], v[152:155]
  ds_read_b64_tr_b16 v[220:221], v29 offset:28672
  v_mfma_f32_16x16x32_bf16 v[152:155], v[172:175], v[80:83], v[152:155]
  ds_read_b64_tr_b16 v[222:223], v29 offset:30720
  s_waitcnt lgkmcnt(8)
  v_mfma_f32_16x16x32_bf16 v[96:99], v[192:195], v[80:83], v[96:99]
  ds_read_b64_tr_b16 v[160:161], v6 offset:0
  v_mfma_f32_16x16x32_bf16 v[96:99], v[208:211], v[88:91], v[96:99]
  ds_read_b64_tr_b16 v[162:163], v6 offset:2048
  v_mfma_f32_16x16x32_bf16 v[100:103], v[208:211], v[92:95], v[100:103]
  buffer_load_dwordx4 v[76:79], off, s[64:67], s50 offset:1024 sc1
  v_mfma_f32_16x16x32_bf16 v[100:103], v[192:195], v[84:87], v[100:103]
  ds_read_b64_tr_b16 v[164:165], v7 offset:0
  ds_read_b64_tr_b16 v[166:167], v7 offset:2048
  v_mfma_f32_16x16x32_bf16 v[108:111], v[196:199], v[84:87], v[108:111]
  ds_read_b64_tr_b16 v[176:177], v6 offset:4096
  v_mfma_f32_16x16x32_bf16 v[108:111], v[212:215], v[92:95], v[108:111]
  ds_read_b64_tr_b16 v[178:179], v6 offset:6144
  v_mfma_f32_16x16x32_bf16 v[104:107], v[212:215], v[88:91], v[104:107]
  ds_read_b64_tr_b16 v[180:181], v7 offset:4096
  v_mfma_f32_16x16x32_bf16 v[104:107], v[196:199], v[80:83], v[104:107]
  ds_read_b64_tr_b16 v[182:183], v7 offset:6144
  s_waitcnt lgkmcnt(8)
  s_barrier
  v_mfma_f32_16x16x32_bf16 v[112:115], v[200:203], v[80:83], v[112:115]
  ds_read_b64_tr_b16 v[168:169], v8 offset:0
  v_mfma_f32_16x16x32_bf16 v[112:115], v[216:219], v[88:91], v[112:115]
  ds_read_b64_tr_b16 v[170:171], v8 offset:2048
  v_mfma_f32_16x16x32_bf16 v[116:119], v[216:219], v[92:95], v[116:119]
  ds_read_b64_tr_b16 v[172:173], v9 offset:0
  v_mfma_f32_16x16x32_bf16 v[116:119], v[200:203], v[84:87], v[116:119]
  ds_read_b64_tr_b16 v[174:175], v9 offset:2048
  v_mfma_f32_16x16x32_bf16 v[124:127], v[204:207], v[84:87], v[124:127]
  ds_read_b64_tr_b16 v[184:185], v8 offset:4096
  v_mfma_f32_16x16x32_bf16 v[124:127], v[220:223], v[92:95], v[124:127]
  ds_read_b64_tr_b16 v[186:187], v8 offset:6144
  v_readlane_b32 s51, v30, 15
  v_mfma_f32_16x16x32_bf16 v[120:123], v[220:223], v[88:91], v[120:123]
  ds_read_b64_tr_b16 v[188:189], v9 offset:4096
  v_mfma_f32_16x16x32_bf16 v[120:123], v[204:207], v[80:83], v[120:123]
  ds_read_b64_tr_b16 v[190:191], v9 offset:6144
  s_waitcnt vmcnt(16) lgkmcnt(8)
  v_mfma_f32_16x16x32_bf16 v[128:131], v[160:163], v[224:227], v[128:131]
  buffer_load_dwordx4 v[80:83], off, s[36:39], s51 offset:0 sc1
  v_mfma_f32_16x16x32_bf16 v[128:131], v[176:179], v[232:235], v[128:131]
  ds_read_b64_tr_b16 v[192:193], v6 offset:8192
  ds_read_b64_tr_b16 v[194:195], v6 offset:10240
  v_mfma_f32_16x16x32_bf16 v[132:135], v[176:179], v[236:239], v[132:135]
  ds_read_b64_tr_b16 v[196:197], v7 offset:8192
  v_mfma_f32_16x16x32_bf16 v[132:135], v[160:163], v[228:231], v[132:135]
  ds_read_b64_tr_b16 v[198:199], v7 offset:10240
  v_mfma_f32_16x16x32_bf16 v[140:143], v[164:167], v[228:231], v[140:143]
  ds_read_b64_tr_b16 v[208:209], v6 offset:12288
  v_mfma_f32_16x16x32_bf16 v[140:143], v[180:183], v[236:239], v[140:143]
  ds_read_b64_tr_b16 v[210:211], v6 offset:14336
  ds_read_b64_tr_b16 v[212:213], v7 offset:12288
  v_mfma_f32_16x16x32_bf16 v[136:139], v[180:183], v[232:235], v[136:139]
  buffer_load_dwordx4 v[84:87], off, s[64:67], s51 offset:0 sc1
  v_mfma_f32_16x16x32_bf16 v[136:139], v[164:167], v[224:227], v[136:139]
  ds_read_b64_tr_b16 v[214:215], v7 offset:14336
  s_waitcnt lgkmcnt(8)
  v_mfma_f32_16x16x32_bf16 v[144:147], v[168:171], v[224:227], v[144:147]
  ds_read_b64_tr_b16 v[200:201], v8 offset:8192
  v_mfma_f32_16x16x32_bf16 v[144:147], v[184:187], v[232:235], v[144:147]
  ds_read_b64_tr_b16 v[202:203], v8 offset:10240
  v_mfma_f32_16x16x32_bf16 v[148:151], v[184:187], v[236:239], v[148:151]
  ds_read_b64_tr_b16 v[204:205], v9 offset:8192
  v_mfma_f32_16x16x32_bf16 v[148:151], v[168:171], v[228:231], v[148:151]
  ds_read_b64_tr_b16 v[206:207], v9 offset:10240
  v_mfma_f32_16x16x32_bf16 v[156:159], v[172:175], v[228:231], v[156:159]
  buffer_load_dwordx4 v[88:91], off, s[36:39], s51 offset:1024 sc1
  v_mfma_f32_16x16x32_bf16 v[156:159], v[188:191], v[236:239], v[156:159]
  ds_read_b64_tr_b16 v[216:217], v8 offset:12288
  ds_read_b64_tr_b16 v[218:219], v8 offset:14336
  v_mfma_f32_16x16x32_bf16 v[152:155], v[188:191], v[232:235], v[152:155]
  ds_read_b64_tr_b16 v[220:221], v9 offset:12288
  v_mfma_f32_16x16x32_bf16 v[152:155], v[172:175], v[224:227], v[152:155]
  ds_read_b64_tr_b16 v[222:223], v9 offset:14336
  s_waitcnt lgkmcnt(8)
  v_mfma_f32_16x16x32_bf16 v[96:99], v[192:195], v[224:227], v[96:99]
  ds_read_b64_tr_b16 v[160:161], v6 offset:16384
  v_mfma_f32_16x16x32_bf16 v[96:99], v[208:211], v[232:235], v[96:99]
  ds_read_b64_tr_b16 v[162:163], v6 offset:18432
  v_mfma_f32_16x16x32_bf16 v[100:103], v[208:211], v[236:239], v[100:103]
  buffer_load_dwordx4 v[92:95], off, s[64:67], s51 offset:1024 sc1
  v_mfma_f32_16x16x32_bf16 v[100:103], v[192:195], v[228:231], v[100:103]
  ds_read_b64_tr_b16 v[164:165], v7 offset:16384
  ds_read_b64_tr_b16 v[166:167], v7 offset:18432
  v_mfma_f32_16x16x32_bf16 v[108:111], v[196:199], v[228:231], v[108:111]
  ds_read_b64_tr_b16 v[176:177], v6 offset:20480
  v_mfma_f32_16x16x32_bf16 v[108:111], v[212:215], v[236:239], v[108:111]
  ds_read_b64_tr_b16 v[178:179], v6 offset:22528
  v_mfma_f32_16x16x32_bf16 v[104:107], v[212:215], v[232:235], v[104:107]
  ds_read_b64_tr_b16 v[180:181], v7 offset:20480
  v_mfma_f32_16x16x32_bf16 v[104:107], v[196:199], v[224:227], v[104:107]
  ds_read_b64_tr_b16 v[182:183], v7 offset:22528
  s_waitcnt lgkmcnt(8)
  v_mfma_f32_16x16x32_bf16 v[112:115], v[200:203], v[224:227], v[112:115]
  ds_read_b64_tr_b16 v[168:169], v8 offset:16384
  v_mfma_f32_16x16x32_bf16 v[112:115], v[216:219], v[232:235], v[112:115]
  ds_read_b64_tr_b16 v[170:171], v8 offset:18432
  v_mfma_f32_16x16x32_bf16 v[116:119], v[216:219], v[236:239], v[116:119]
  ds_read_b64_tr_b16 v[172:173], v9 offset:16384
  v_mfma_f32_16x16x32_bf16 v[116:119], v[200:203], v[228:231], v[116:119]
  ds_read_b64_tr_b16 v[174:175], v9 offset:18432
  v_mfma_f32_16x16x32_bf16 v[124:127], v[204:207], v[228:231], v[124:127]
  ds_read_b64_tr_b16 v[184:185], v8 offset:20480
  v_mfma_f32_16x16x32_bf16 v[124:127], v[220:223], v[236:239], v[124:127]
  ds_read_b64_tr_b16 v[186:187], v8 offset:22528
  v_readlane_b32 s48, v30, 16
  v_mfma_f32_16x16x32_bf16 v[120:123], v[220:223], v[232:235], v[120:123]
  ds_read_b64_tr_b16 v[188:189], v9 offset:20480
  v_mfma_f32_16x16x32_bf16 v[120:123], v[204:207], v[224:227], v[120:123]
  ds_read_b64_tr_b16 v[190:191], v9 offset:22528
  s_waitcnt vmcnt(16) lgkmcnt(8)
  v_mfma_f32_16x16x32_bf16 v[128:131], v[160:163], v[240:243], v[128:131]
  buffer_load_dwordx4 v[224:227], off, s[36:39], s48 offset:0 sc1
  v_mfma_f32_16x16x32_bf16 v[128:131], v[176:179], v[248:251], v[128:131]
  ds_read_b64_tr_b16 v[192:193], v6 offset:24576
  ds_read_b64_tr_b16 v[194:195], v6 offset:26624
  v_mfma_f32_16x16x32_bf16 v[132:135], v[176:179], v[252:255], v[132:135]
  ds_read_b64_tr_b16 v[196:197], v7 offset:24576
  v_mfma_f32_16x16x32_bf16 v[132:135], v[160:163], v[244:247], v[132:135]
  ds_read_b64_tr_b16 v[198:199], v7 offset:26624
  v_mfma_f32_16x16x32_bf16 v[140:143], v[164:167], v[244:247], v[140:143]
  ds_read_b64_tr_b16 v[208:209], v6 offset:28672
  v_mfma_f32_16x16x32_bf16 v[140:143], v[180:183], v[252:255], v[140:143]
  ds_read_b64_tr_b16 v[210:211], v6 offset:30720
  ds_read_b64_tr_b16 v[212:213], v7 offset:28672
  v_mfma_f32_16x16x32_bf16 v[136:139], v[180:183], v[248:251], v[136:139]
  buffer_load_dwordx4 v[228:231], off, s[64:67], s48 offset:0 sc1
  v_mfma_f32_16x16x32_bf16 v[136:139], v[164:167], v[240:243], v[136:139]
  ds_read_b64_tr_b16 v[214:215], v7 offset:30720
  s_waitcnt lgkmcnt(8)
  v_mfma_f32_16x16x32_bf16 v[144:147], v[168:171], v[240:243], v[144:147]
  ds_read_b64_tr_b16 v[200:201], v8 offset:24576
  v_mfma_f32_16x16x32_bf16 v[144:147], v[184:187], v[248:251], v[144:147]
  ds_read_b64_tr_b16 v[202:203], v8 offset:26624
  v_mfma_f32_16x16x32_bf16 v[148:151], v[184:187], v[252:255], v[148:151]
  ds_read_b64_tr_b16 v[204:205], v9 offset:24576
  v_mfma_f32_16x16x32_bf16 v[148:151], v[168:171], v[244:247], v[148:151]
  ds_read_b64_tr_b16 v[206:207], v9 offset:26624
  v_mfma_f32_16x16x32_bf16 v[156:159], v[172:175], v[244:247], v[156:159]
  buffer_load_dwordx4 v[232:235], off, s[36:39], s48 offset:1024 sc1
  v_mfma_f32_16x16x32_bf16 v[156:159], v[188:191], v[252:255], v[156:159]
  ds_read_b64_tr_b16 v[216:217], v8 offset:28672
  ds_read_b64_tr_b16 v[218:219], v8 offset:30720
  v_mfma_f32_16x16x32_bf16 v[152:155], v[188:191], v[248:251], v[152:155]
  ds_read_b64_tr_b16 v[220:221], v9 offset:28672
  v_mfma_f32_16x16x32_bf16 v[152:155], v[172:175], v[240:243], v[152:155]
  ds_read_b64_tr_b16 v[222:223], v9 offset:30720
  s_waitcnt lgkmcnt(8)
  v_mfma_f32_16x16x32_bf16 v[96:99], v[192:195], v[240:243], v[96:99]
  ds_read_b64_tr_b16 v[160:161], v6 offset:32768
  v_mfma_f32_16x16x32_bf16 v[96:99], v[208:211], v[248:251], v[96:99]
  ds_read_b64_tr_b16 v[162:163], v6 offset:34816
  v_mfma_f32_16x16x32_bf16 v[100:103], v[208:211], v[252:255], v[100:103]
  buffer_load_dwordx4 v[236:239], off, s[64:67], s48 offset:1024 sc1
  v_mfma_f32_16x16x32_bf16 v[100:103], v[192:195], v[244:247], v[100:103]
  ds_read_b64_tr_b16 v[164:165], v7 offset:32768
  ds_read_b64_tr_b16 v[166:167], v7 offset:34816
  v_mfma_f32_16x16x32_bf16 v[108:111], v[196:199], v[244:247], v[108:111]
  ds_read_b64_tr_b16 v[176:177], v6 offset:36864
  v_mfma_f32_16x16x32_bf16 v[108:111], v[212:215], v[252:255], v[108:111]
  ds_read_b64_tr_b16 v[178:179], v6 offset:38912
  v_mfma_f32_16x16x32_bf16 v[104:107], v[212:215], v[248:251], v[104:107]
  ds_read_b64_tr_b16 v[180:181], v7 offset:36864
  v_mfma_f32_16x16x32_bf16 v[104:107], v[196:199], v[240:243], v[104:107]
  ds_read_b64_tr_b16 v[182:183], v7 offset:38912
  s_waitcnt lgkmcnt(8)
  s_barrier
  v_mfma_f32_16x16x32_bf16 v[112:115], v[200:203], v[240:243], v[112:115]
  ds_read_b64_tr_b16 v[168:169], v8 offset:32768
  v_mfma_f32_16x16x32_bf16 v[112:115], v[216:219], v[248:251], v[112:115]
  ds_read_b64_tr_b16 v[170:171], v8 offset:34816
  v_mfma_f32_16x16x32_bf16 v[116:119], v[216:219], v[252:255], v[116:119]
  ds_read_b64_tr_b16 v[172:173], v9 offset:32768
  v_mfma_f32_16x16x32_bf16 v[116:119], v[200:203], v[244:247], v[116:119]
  ds_read_b64_tr_b16 v[174:175], v9 offset:34816
  v_mfma_f32_16x16x32_bf16 v[124:127], v[204:207], v[244:247], v[124:127]
  ds_read_b64_tr_b16 v[184:185], v8 offset:36864
  v_mfma_f32_16x16x32_bf16 v[124:127], v[220:223], v[252:255], v[124:127]
  ds_read_b64_tr_b16 v[186:187], v8 offset:38912
  v_readlane_b32 s49, v30, 17
  v_mfma_f32_16x16x32_bf16 v[120:123], v[220:223], v[248:251], v[120:123]
  ds_read_b64_tr_b16 v[188:189], v9 offset:36864
  v_mfma_f32_16x16x32_bf16 v[120:123], v[204:207], v[240:243], v[120:123]
  ds_read_b64_tr_b16 v[190:191], v9 offset:38912
  s_waitcnt vmcnt(16) lgkmcnt(8)
  v_mfma_f32_16x16x32_bf16 v[128:131], v[160:163], v[32:35], v[128:131]
  buffer_load_dwordx4 v[240:243], off, s[36:39], s49 offset:0 sc1
  v_mfma_f32_16x16x32_bf16 v[128:131], v[176:179], v[40:43], v[128:131]
  ds_read_b64_tr_b16 v[192:193], v6 offset:40960
  ds_read_b64_tr_b16 v[194:195], v6 offset:43008
  v_mfma_f32_16x16x32_bf16 v[132:135], v[176:179], v[44:47], v[132:135]
  ds_read_b64_tr_b16 v[196:197], v7 offset:40960
  v_mfma_f32_16x16x32_bf16 v[132:135], v[160:163], v[36:39], v[132:135]
  ds_read_b64_tr_b16 v[198:199], v7 offset:43008
  v_mfma_f32_16x16x32_bf16 v[140:143], v[164:167], v[36:39], v[140:143]
  ds_read_b64_tr_b16 v[208:209], v6 offset:45056
  v_mfma_f32_16x16x32_bf16 v[140:143], v[180:183], v[44:47], v[140:143]
  ds_read_b64_tr_b16 v[210:211], v6 offset:47104
  ds_read_b64_tr_b16 v[212:213], v7 offset:45056
  v_mfma_f32_16x16x32_bf16 v[136:139], v[180:183], v[40:43], v[136:139]
  buffer_load_dwordx4 v[244:247], off, s[64:67], s49 offset:0 sc1
  v_mfma_f32_16x16x32_bf16 v[136:139], v[164:167], v[32:35], v[136:139]
  ds_read_b64_tr_b16 v[214:215], v7 offset:47104
  s_waitcnt lgkmcnt(8)
  v_mfma_f32_16x16x32_bf16 v[144:147], v[168:171], v[32:35], v[144:147]
  ds_read_b64_tr_b16 v[200:201], v8 offset:40960
  v_mfma_f32_16x16x32_bf16 v[144:147], v[184:187], v[40:43], v[144:147]
  ds_read_b64_tr_b16 v[202:203], v8 offset:43008
  v_mfma_f32_16x16x32_bf16 v[148:151], v[184:187], v[44:47], v[148:151]
  ds_read_b64_tr_b16 v[204:205], v9 offset:40960
  v_mfma_f32_16x16x32_bf16 v[148:151], v[168:171], v[36:39], v[148:151]
  ds_read_b64_tr_b16 v[206:207], v9 offset:43008
  v_mfma_f32_16x16x32_bf16 v[156:159], v[172:175], v[36:39], v[156:159]
  buffer_load_dwordx4 v[248:251], off, s[36:39], s49 offset:1024 sc1
  v_mfma_f32_16x16x32_bf16 v[156:159], v[188:191], v[44:47], v[156:159]
  ds_read_b64_tr_b16 v[216:217], v8 offset:45056
  ds_read_b64_tr_b16 v[218:219], v8 offset:47104
  v_mfma_f32_16x16x32_bf16 v[152:155], v[188:191], v[40:43], v[152:155]
  ds_read_b64_tr_b16 v[220:221], v9 offset:45056
  v_mfma_f32_16x16x32_bf16 v[152:155], v[172:175], v[32:35], v[152:155]
  ds_read_b64_tr_b16 v[222:223], v9 offset:47104
  s_waitcnt lgkmcnt(8)
  v_mfma_f32_16x16x32_bf16 v[96:99], v[192:195], v[32:35], v[96:99]
  ds_read_b64_tr_b16 v[160:161], v6 offset:49152
  v_mfma_f32_16x16x32_bf16 v[96:99], v[208:211], v[40:43], v[96:99]
  ds_read_b64_tr_b16 v[162:163], v6 offset:51200
  v_mfma_f32_16x16x32_bf16 v[100:103], v[208:211], v[44:47], v[100:103]
  buffer_load_dwordx4 v[252:255], off, s[64:67], s49 offset:1024 sc1
  v_mfma_f32_16x16x32_bf16 v[100:103], v[192:195], v[36:39], v[100:103]
  ds_read_b64_tr_b16 v[164:165], v7 offset:49152
  ds_read_b64_tr_b16 v[166:167], v7 offset:51200
  v_mfma_f32_16x16x32_bf16 v[108:111], v[196:199], v[36:39], v[108:111]
  ds_read_b64_tr_b16 v[176:177], v6 offset:53248
  v_mfma_f32_16x16x32_bf16 v[108:111], v[212:215], v[44:47], v[108:111]
  ds_read_b64_tr_b16 v[178:179], v6 offset:55296
  v_mfma_f32_16x16x32_bf16 v[104:107], v[212:215], v[40:43], v[104:107]
  ds_read_b64_tr_b16 v[180:181], v7 offset:53248
  v_mfma_f32_16x16x32_bf16 v[104:107], v[196:199], v[32:35], v[104:107]
  ds_read_b64_tr_b16 v[182:183], v7 offset:55296
  s_waitcnt lgkmcnt(8)
  v_mfma_f32_16x16x32_bf16 v[112:115], v[200:203], v[32:35], v[112:115]
  ds_read_b64_tr_b16 v[168:169], v8 offset:49152
  v_mfma_f32_16x16x32_bf16 v[112:115], v[216:219], v[40:43], v[112:115]
  ds_read_b64_tr_b16 v[170:171], v8 offset:51200
  v_mfma_f32_16x16x32_bf16 v[116:119], v[216:219], v[44:47], v[116:119]
  ds_read_b64_tr_b16 v[172:173], v9 offset:49152
  v_mfma_f32_16x16x32_bf16 v[116:119], v[200:203], v[36:39], v[116:119]
  ds_read_b64_tr_b16 v[174:175], v9 offset:51200
  v_mfma_f32_16x16x32_bf16 v[124:127], v[204:207], v[36:39], v[124:127]
  ds_read_b64_tr_b16 v[184:185], v8 offset:53248
  v_mfma_f32_16x16x32_bf16 v[124:127], v[220:223], v[44:47], v[124:127]
  ds_read_b64_tr_b16 v[186:187], v8 offset:55296
  v_readlane_b32 s50, v30, 18
  v_mfma_f32_16x16x32_bf16 v[120:123], v[220:223], v[40:43], v[120:123]
  ds_read_b64_tr_b16 v[188:189], v9 offset:53248
  v_mfma_f32_16x16x32_bf16 v[120:123], v[204:207], v[32:35], v[120:123]
  ds_read_b64_tr_b16 v[190:191], v9 offset:55296
  s_waitcnt vmcnt(16) lgkmcnt(8)
  v_mfma_f32_16x16x32_bf16 v[128:131], v[160:163], v[48:51], v[128:131]
  buffer_load_dwordx4 v[32:35], off, s[36:39], s50 offset:0 sc1
  v_mfma_f32_16x16x32_bf16 v[128:131], v[176:179], v[56:59], v[128:131]
  ds_read_b64_tr_b16 v[192:193], v6 offset:57344
  ds_read_b64_tr_b16 v[194:195], v6 offset:59392
  v_mfma_f32_16x16x32_bf16 v[132:135], v[176:179], v[60:63], v[132:135]
  ds_read_b64_tr_b16 v[196:197], v7 offset:57344
  v_mfma_f32_16x16x32_bf16 v[132:135], v[160:163], v[52:55], v[132:135]
  ds_read_b64_tr_b16 v[198:199], v7 offset:59392
  v_mfma_f32_16x16x32_bf16 v[140:143], v[164:167], v[52:55], v[140:143]
  ds_read_b64_tr_b16 v[208:209], v6 offset:61440
  v_mfma_f32_16x16x32_bf16 v[140:143], v[180:183], v[60:63], v[140:143]
  ds_read_b64_tr_b16 v[210:211], v6 offset:63488
  ds_read_b64_tr_b16 v[212:213], v7 offset:61440
  v_mfma_f32_16x16x32_bf16 v[136:139], v[180:183], v[56:59], v[136:139]
  buffer_load_dwordx4 v[36:39], off, s[64:67], s50 offset:0 sc1
  v_mfma_f32_16x16x32_bf16 v[136:139], v[164:167], v[48:51], v[136:139]
  ds_read_b64_tr_b16 v[214:215], v7 offset:63488
  s_waitcnt lgkmcnt(8)
  v_mfma_f32_16x16x32_bf16 v[144:147], v[168:171], v[48:51], v[144:147]
  ds_read_b64_tr_b16 v[200:201], v8 offset:57344
  v_mfma_f32_16x16x32_bf16 v[144:147], v[184:187], v[56:59], v[144:147]
  ds_read_b64_tr_b16 v[202:203], v8 offset:59392
  v_mfma_f32_16x16x32_bf16 v[148:151], v[184:187], v[60:63], v[148:151]
  ds_read_b64_tr_b16 v[204:205], v9 offset:57344
  v_mfma_f32_16x16x32_bf16 v[148:151], v[168:171], v[52:55], v[148:151]
  ds_read_b64_tr_b16 v[206:207], v9 offset:59392
  v_mfma_f32_16x16x32_bf16 v[156:159], v[172:175], v[52:55], v[156:159]
  buffer_load_dwordx4 v[40:43], off, s[36:39], s50 offset:1024 sc1
  v_mfma_f32_16x16x32_bf16 v[156:159], v[188:191], v[60:63], v[156:159]
  ds_read_b64_tr_b16 v[216:217], v8 offset:61440
  ds_read_b64_tr_b16 v[218:219], v8 offset:63488
  v_mfma_f32_16x16x32_bf16 v[152:155], v[188:191], v[56:59], v[152:155]
  ds_read_b64_tr_b16 v[220:221], v9 offset:61440
  v_mfma_f32_16x16x32_bf16 v[152:155], v[172:175], v[48:51], v[152:155]
  ds_read_b64_tr_b16 v[222:223], v9 offset:63488
  s_waitcnt lgkmcnt(8)
  v_mfma_f32_16x16x32_bf16 v[96:99], v[192:195], v[48:51], v[96:99]
  ds_read_b64_tr_b16 v[160:161], v20 offset:0
  v_mfma_f32_16x16x32_bf16 v[96:99], v[208:211], v[56:59], v[96:99]
  ds_read_b64_tr_b16 v[162:163], v20 offset:2048
  v_mfma_f32_16x16x32_bf16 v[100:103], v[208:211], v[60:63], v[100:103]
  buffer_load_dwordx4 v[44:47], off, s[64:67], s50 offset:1024 sc1
  v_mfma_f32_16x16x32_bf16 v[100:103], v[192:195], v[52:55], v[100:103]
  ds_read_b64_tr_b16 v[164:165], v21 offset:0
  ds_read_b64_tr_b16 v[166:167], v21 offset:2048
  v_mfma_f32_16x16x32_bf16 v[108:111], v[196:199], v[52:55], v[108:111]
  ds_read_b64_tr_b16 v[176:177], v20 offset:4096
  v_mfma_f32_16x16x32_bf16 v[108:111], v[212:215], v[60:63], v[108:111]
  ds_read_b64_tr_b16 v[178:179], v20 offset:6144
  v_mfma_f32_16x16x32_bf16 v[104:107], v[212:215], v[56:59], v[104:107]
  ds_read_b64_tr_b16 v[180:181], v21 offset:4096
  v_mfma_f32_16x16x32_bf16 v[104:107], v[196:199], v[48:51], v[104:107]
  ds_read_b64_tr_b16 v[182:183], v21 offset:6144
  s_waitcnt lgkmcnt(8)
  s_barrier
  v_mfma_f32_16x16x32_bf16 v[112:115], v[200:203], v[48:51], v[112:115]
  ds_read_b64_tr_b16 v[168:169], v22 offset:0
  v_mfma_f32_16x16x32_bf16 v[112:115], v[216:219], v[56:59], v[112:115]
  ds_read_b64_tr_b16 v[170:171], v22 offset:2048
  v_mfma_f32_16x16x32_bf16 v[116:119], v[216:219], v[60:63], v[116:119]
  ds_read_b64_tr_b16 v[172:173], v23 offset:0
  v_mfma_f32_16x16x32_bf16 v[116:119], v[200:203], v[52:55], v[116:119]
  ds_read_b64_tr_b16 v[174:175], v23 offset:2048
  v_mfma_f32_16x16x32_bf16 v[124:127], v[204:207], v[52:55], v[124:127]
  ds_read_b64_tr_b16 v[184:185], v22 offset:4096
  v_mfma_f32_16x16x32_bf16 v[124:127], v[220:223], v[60:63], v[124:127]
  ds_read_b64_tr_b16 v[186:187], v22 offset:6144
  v_readlane_b32 s51, v30, 19
  v_mfma_f32_16x16x32_bf16 v[120:123], v[220:223], v[56:59], v[120:123]
  ds_read_b64_tr_b16 v[188:189], v23 offset:4096
  v_mfma_f32_16x16x32_bf16 v[120:123], v[204:207], v[48:51], v[120:123]
  ds_read_b64_tr_b16 v[190:191], v23 offset:6144
  s_waitcnt vmcnt(16) lgkmcnt(8)
  v_mfma_f32_16x16x32_bf16 v[128:131], v[160:163], v[64:67], v[128:131]
  buffer_load_dwordx4 v[48:51], off, s[36:39], s51 offset:0 sc1
  v_mfma_f32_16x16x32_bf16 v[128:131], v[176:179], v[72:75], v[128:131]
  ds_read_b64_tr_b16 v[192:193], v20 offset:8192
  ds_read_b64_tr_b16 v[194:195], v20 offset:10240
  v_mfma_f32_16x16x32_bf16 v[132:135], v[176:179], v[76:79], v[132:135]
  ds_read_b64_tr_b16 v[196:197], v21 offset:8192
  v_mfma_f32_16x16x32_bf16 v[132:135], v[160:163], v[68:71], v[132:135]
  ds_read_b64_tr_b16 v[198:199], v21 offset:10240
  v_mfma_f32_16x16x32_bf16 v[140:143], v[164:167], v[68:71], v[140:143]
  ds_read_b64_tr_b16 v[208:209], v20 offset:12288
  v_mfma_f32_16x16x32_bf16 v[140:143], v[180:183], v[76:79], v[140:143]
  ds_read_b64_tr_b16 v[210:211], v20 offset:14336
  ds_read_b64_tr_b16 v[212:213], v21 offset:12288
  v_mfma_f32_16x16x32_bf16 v[136:139], v[180:183], v[72:75], v[136:139]
  buffer_load_dwordx4 v[52:55], off, s[64:67], s51 offset:0 sc1
  v_mfma_f32_16x16x32_bf16 v[136:139], v[164:167], v[64:67], v[136:139]
  ds_read_b64_tr_b16 v[214:215], v21 offset:14336
  s_waitcnt lgkmcnt(8)
  v_mfma_f32_16x16x32_bf16 v[144:147], v[168:171], v[64:67], v[144:147]
  ds_read_b64_tr_b16 v[200:201], v22 offset:8192
  v_mfma_f32_16x16x32_bf16 v[144:147], v[184:187], v[72:75], v[144:147]
  ds_read_b64_tr_b16 v[202:203], v22 offset:10240
  v_mfma_f32_16x16x32_bf16 v[148:151], v[184:187], v[76:79], v[148:151]
  ds_read_b64_tr_b16 v[204:205], v23 offset:8192
  v_mfma_f32_16x16x32_bf16 v[148:151], v[168:171], v[68:71], v[148:151]
  ds_read_b64_tr_b16 v[206:207], v23 offset:10240
  v_mfma_f32_16x16x32_bf16 v[156:159], v[172:175], v[68:71], v[156:159]
  buffer_load_dwordx4 v[56:59], off, s[36:39], s51 offset:1024 sc1
  v_mfma_f32_16x16x32_bf16 v[156:159], v[188:191], v[76:79], v[156:159]
  ds_read_b64_tr_b16 v[216:217], v22 offset:12288
  ds_read_b64_tr_b16 v[218:219], v22 offset:14336
  v_mfma_f32_16x16x32_bf16 v[152:155], v[188:191], v[72:75], v[152:155]
  ds_read_b64_tr_b16 v[220:221], v23 offset:12288
  v_mfma_f32_16x16x32_bf16 v[152:155], v[172:175], v[64:67], v[152:155]
  ds_read_b64_tr_b16 v[222:223], v23 offset:14336
  s_waitcnt lgkmcnt(8)
  v_mfma_f32_16x16x32_bf16 v[96:99], v[192:195], v[64:67], v[96:99]
  ds_read_b64_tr_b16 v[160:161], v20 offset:16384
  v_mfma_f32_16x16x32_bf16 v[96:99], v[208:211], v[72:75], v[96:99]
  ds_read_b64_tr_b16 v[162:163], v20 offset:18432
  v_mfma_f32_16x16x32_bf16 v[100:103], v[208:211], v[76:79], v[100:103]
  buffer_load_dwordx4 v[60:63], off, s[64:67], s51 offset:1024 sc1
  v_mfma_f32_16x16x32_bf16 v[100:103], v[192:195], v[68:71], v[100:103]
  ds_read_b64_tr_b16 v[164:165], v21 offset:16384
  ds_read_b64_tr_b16 v[166:167], v21 offset:18432
  v_mfma_f32_16x16x32_bf16 v[108:111], v[196:199], v[68:71], v[108:111]
  ds_read_b64_tr_b16 v[176:177], v20 offset:20480
  v_mfma_f32_16x16x32_bf16 v[108:111], v[212:215], v[76:79], v[108:111]
  ds_read_b64_tr_b16 v[178:179], v20 offset:22528
  v_mfma_f32_16x16x32_bf16 v[104:107], v[212:215], v[72:75], v[104:107]
  ds_read_b64_tr_b16 v[180:181], v21 offset:20480
  v_mfma_f32_16x16x32_bf16 v[104:107], v[196:199], v[64:67], v[104:107]
  ds_read_b64_tr_b16 v[182:183], v21 offset:22528
  s_waitcnt lgkmcnt(8)
  v_mfma_f32_16x16x32_bf16 v[112:115], v[200:203], v[64:67], v[112:115]
  ds_read_b64_tr_b16 v[168:169], v22 offset:16384
  v_mfma_f32_16x16x32_bf16 v[112:115], v[216:219], v[72:75], v[112:115]
  ds_read_b64_tr_b16 v[170:171], v22 offset:18432
  v_mfma_f32_16x16x32_bf16 v[116:119], v[216:219], v[76:79], v[116:119]
  ds_read_b64_tr_b16 v[172:173], v23 offset:16384
  v_mfma_f32_16x16x32_bf16 v[116:119], v[200:203], v[68:71], v[116:119]
  ds_read_b64_tr_b16 v[174:175], v23 offset:18432
  v_mfma_f32_16x16x32_bf16 v[124:127], v[204:207], v[68:71], v[124:127]
  ds_read_b64_tr_b16 v[184:185], v22 offset:20480
  v_mfma_f32_16x16x32_bf16 v[124:127], v[220:223], v[76:79], v[124:127]
  ds_read_b64_tr_b16 v[186:187], v22 offset:22528
  v_readlane_b32 s48, v30, 20
  v_mfma_f32_16x16x32_bf16 v[120:123], v[220:223], v[72:75], v[120:123]
  ds_read_b64_tr_b16 v[188:189], v23 offset:20480
  v_mfma_f32_16x16x32_bf16 v[120:123], v[204:207], v[64:67], v[120:123]
  ds_read_b64_tr_b16 v[190:191], v23 offset:22528
  s_waitcnt vmcnt(16) lgkmcnt(8)
  v_mfma_f32_16x16x32_bf16 v[128:131], v[160:163], v[80:83], v[128:131]
  buffer_load_dwordx4 v[64:67], off, s[36:39], s48 offset:0 sc1
  v_mfma_f32_16x16x32_bf16 v[128:131], v[176:179], v[88:91], v[128:131]
  ds_read_b64_tr_b16 v[192:193], v20 offset:24576
  ds_read_b64_tr_b16 v[194:195], v20 offset:26624
  v_mfma_f32_16x16x32_bf16 v[132:135], v[176:179], v[92:95], v[132:135]
  ds_read_b64_tr_b16 v[196:197], v21 offset:24576
  v_mfma_f32_16x16x32_bf16 v[132:135], v[160:163], v[84:87], v[132:135]
  ds_read_b64_tr_b16 v[198:199], v21 offset:26624
  v_mfma_f32_16x16x32_bf16 v[140:143], v[164:167], v[84:87], v[140:143]
  ds_read_b64_tr_b16 v[208:209], v20 offset:28672
  v_mfma_f32_16x16x32_bf16 v[140:143], v[180:183], v[92:95], v[140:143]
  ds_read_b64_tr_b16 v[210:211], v20 offset:30720
  ds_read_b64_tr_b16 v[212:213], v21 offset:28672
  v_mfma_f32_16x16x32_bf16 v[136:139], v[180:183], v[88:91], v[136:139]
  buffer_load_dwordx4 v[68:71], off, s[64:67], s48 offset:0 sc1
  v_mfma_f32_16x16x32_bf16 v[136:139], v[164:167], v[80:83], v[136:139]
  ds_read_b64_tr_b16 v[214:215], v21 offset:30720
  s_waitcnt lgkmcnt(8)
  v_mfma_f32_16x16x32_bf16 v[144:147], v[168:171], v[80:83], v[144:147]
  ds_read_b64_tr_b16 v[200:201], v22 offset:24576
  v_mfma_f32_16x16x32_bf16 v[144:147], v[184:187], v[88:91], v[144:147]
  ds_read_b64_tr_b16 v[202:203], v22 offset:26624
  v_mfma_f32_16x16x32_bf16 v[148:151], v[184:187], v[92:95], v[148:151]
  ds_read_b64_tr_b16 v[204:205], v23 offset:24576
  v_mfma_f32_16x16x32_bf16 v[148:151], v[168:171], v[84:87], v[148:151]
  ds_read_b64_tr_b16 v[206:207], v23 offset:26624
  v_mfma_f32_16x16x32_bf16 v[156:159], v[172:175], v[84:87], v[156:159]
  buffer_load_dwordx4 v[72:75], off, s[36:39], s48 offset:1024 sc1
  v_mfma_f32_16x16x32_bf16 v[156:159], v[188:191], v[92:95], v[156:159]
  ds_read_b64_tr_b16 v[216:217], v22 offset:28672
  ds_read_b64_tr_b16 v[218:219], v22 offset:30720
  v_mfma_f32_16x16x32_bf16 v[152:155], v[188:191], v[88:91], v[152:155]
  ds_read_b64_tr_b16 v[220:221], v23 offset:28672
  v_mfma_f32_16x16x32_bf16 v[152:155], v[172:175], v[80:83], v[152:155]
  ds_read_b64_tr_b16 v[222:223], v23 offset:30720
  s_waitcnt lgkmcnt(8)
  v_mfma_f32_16x16x32_bf16 v[96:99], v[192:195], v[80:83], v[96:99]
  ds_read_b64_tr_b16 v[160:161], v20 offset:32768
  v_mfma_f32_16x16x32_bf16 v[96:99], v[208:211], v[88:91], v[96:99]
  ds_read_b64_tr_b16 v[162:163], v20 offset:34816
  v_mfma_f32_16x16x32_bf16 v[100:103], v[208:211], v[92:95], v[100:103]
  buffer_load_dwordx4 v[76:79], off, s[64:67], s48 offset:1024 sc1
  v_mfma_f32_16x16x32_bf16 v[100:103], v[192:195], v[84:87], v[100:103]
  ds_read_b64_tr_b16 v[164:165], v21 offset:32768
  ds_read_b64_tr_b16 v[166:167], v21 offset:34816
  v_mfma_f32_16x16x32_bf16 v[108:111], v[196:199], v[84:87], v[108:111]
  ds_read_b64_tr_b16 v[176:177], v20 offset:36864
  v_mfma_f32_16x16x32_bf16 v[108:111], v[212:215], v[92:95], v[108:111]
  ds_read_b64_tr_b16 v[178:179], v20 offset:38912
  v_mfma_f32_16x16x32_bf16 v[104:107], v[212:215], v[88:91], v[104:107]
  ds_read_b64_tr_b16 v[180:181], v21 offset:36864
  v_mfma_f32_16x16x32_bf16 v[104:107], v[196:199], v[80:83], v[104:107]
  ds_read_b64_tr_b16 v[182:183], v21 offset:38912
  s_waitcnt lgkmcnt(8)
  s_barrier
  v_mfma_f32_16x16x32_bf16 v[112:115], v[200:203], v[80:83], v[112:115]
  ds_read_b64_tr_b16 v[168:169], v22 offset:32768
  v_mfma_f32_16x16x32_bf16 v[112:115], v[216:219], v[88:91], v[112:115]
  ds_read_b64_tr_b16 v[170:171], v22 offset:34816
  v_mfma_f32_16x16x32_bf16 v[116:119], v[216:219], v[92:95], v[116:119]
  ds_read_b64_tr_b16 v[172:173], v23 offset:32768
  v_mfma_f32_16x16x32_bf16 v[116:119], v[200:203], v[84:87], v[116:119]
  ds_read_b64_tr_b16 v[174:175], v23 offset:34816
  v_mfma_f32_16x16x32_bf16 v[124:127], v[204:207], v[84:87], v[124:127]
  ds_read_b64_tr_b16 v[184:185], v22 offset:36864
  v_mfma_f32_16x16x32_bf16 v[124:127], v[220:223], v[92:95], v[124:127]
  ds_read_b64_tr_b16 v[186:187], v22 offset:38912
  v_readlane_b32 s49, v30, 21
  v_mfma_f32_16x16x32_bf16 v[120:123], v[220:223], v[88:91], v[120:123]
  ds_read_b64_tr_b16 v[188:189], v23 offset:36864
  v_mfma_f32_16x16x32_bf16 v[120:123], v[204:207], v[80:83], v[120:123]
  ds_read_b64_tr_b16 v[190:191], v23 offset:38912
  s_waitcnt vmcnt(16) lgkmcnt(8)
  v_mfma_f32_16x16x32_bf16 v[128:131], v[160:163], v[224:227], v[128:131]
  buffer_load_dwordx4 v[80:83], off, s[36:39], s49 offset:0 sc1
  v_mfma_f32_16x16x32_bf16 v[128:131], v[176:179], v[232:235], v[128:131]
  ds_read_b64_tr_b16 v[192:193], v20 offset:40960
  ds_read_b64_tr_b16 v[194:195], v20 offset:43008
  v_mfma_f32_16x16x32_bf16 v[132:135], v[176:179], v[236:239], v[132:135]
  ds_read_b64_tr_b16 v[196:197], v21 offset:40960
  v_mfma_f32_16x16x32_bf16 v[132:135], v[160:163], v[228:231], v[132:135]
  ds_read_b64_tr_b16 v[198:199], v21 offset:43008
  v_mfma_f32_16x16x32_bf16 v[140:143], v[164:167], v[228:231], v[140:143]
  ds_read_b64_tr_b16 v[208:209], v20 offset:45056
  v_mfma_f32_16x16x32_bf16 v[140:143], v[180:183], v[236:239], v[140:143]
  ds_read_b64_tr_b16 v[210:211], v20 offset:47104
  ds_read_b64_tr_b16 v[212:213], v21 offset:45056
  v_mfma_f32_16x16x32_bf16 v[136:139], v[180:183], v[232:235], v[136:139]
  buffer_load_dwordx4 v[84:87], off, s[64:67], s49 offset:0 sc1
  v_mfma_f32_16x16x32_bf16 v[136:139], v[164:167], v[224:227], v[136:139]
  ds_read_b64_tr_b16 v[214:215], v21 offset:47104
  s_waitcnt lgkmcnt(8)
  v_mfma_f32_16x16x32_bf16 v[144:147], v[168:171], v[224:227], v[144:147]
  ds_read_b64_tr_b16 v[200:201], v22 offset:40960
  v_mfma_f32_16x16x32_bf16 v[144:147], v[184:187], v[232:235], v[144:147]
  ds_read_b64_tr_b16 v[202:203], v22 offset:43008
  v_mfma_f32_16x16x32_bf16 v[148:151], v[184:187], v[236:239], v[148:151]
  ds_read_b64_tr_b16 v[204:205], v23 offset:40960
  v_mfma_f32_16x16x32_bf16 v[148:151], v[168:171], v[228:231], v[148:151]
  ds_read_b64_tr_b16 v[206:207], v23 offset:43008
  v_mfma_f32_16x16x32_bf16 v[156:159], v[172:175], v[228:231], v[156:159]
  buffer_load_dwordx4 v[88:91], off, s[36:39], s49 offset:1024 sc1
  v_mfma_f32_16x16x32_bf16 v[156:159], v[188:191], v[236:239], v[156:159]
  ds_read_b64_tr_b16 v[216:217], v22 offset:45056
  ds_read_b64_tr_b16 v[218:219], v22 offset:47104
  v_mfma_f32_16x16x32_bf16 v[152:155], v[188:191], v[232:235], v[152:155]
  ds_read_b64_tr_b16 v[220:221], v23 offset:45056
  v_mfma_f32_16x16x32_bf16 v[152:155], v[172:175], v[224:227], v[152:155]
  ds_read_b64_tr_b16 v[222:223], v23 offset:47104
  s_waitcnt lgkmcnt(8)
  v_mfma_f32_16x16x32_bf16 v[96:99], v[192:195], v[224:227], v[96:99]
  ds_read_b64_tr_b16 v[160:161], v20 offset:49152
  v_mfma_f32_16x16x32_bf16 v[96:99], v[208:211], v[232:235], v[96:99]
  ds_read_b64_tr_b16 v[162:163], v20 offset:51200
  v_mfma_f32_16x16x32_bf16 v[100:103], v[208:211], v[236:239], v[100:103]
  buffer_load_dwordx4 v[92:95], off, s[64:67], s49 offset:1024 sc1
  v_mfma_f32_16x16x32_bf16 v[100:103], v[192:195], v[228:231], v[100:103]
  ds_read_b64_tr_b16 v[164:165], v21 offset:49152
  ds_read_b64_tr_b16 v[166:167], v21 offset:51200
  v_mfma_f32_16x16x32_bf16 v[108:111], v[196:199], v[228:231], v[108:111]
  ds_read_b64_tr_b16 v[176:177], v20 offset:53248
  v_mfma_f32_16x16x32_bf16 v[108:111], v[212:215], v[236:239], v[108:111]
  ds_read_b64_tr_b16 v[178:179], v20 offset:55296
  v_mfma_f32_16x16x32_bf16 v[104:107], v[212:215], v[232:235], v[104:107]
  ds_read_b64_tr_b16 v[180:181], v21 offset:53248
  v_mfma_f32_16x16x32_bf16 v[104:107], v[196:199], v[224:227], v[104:107]
  ds_read_b64_tr_b16 v[182:183], v21 offset:55296
  s_waitcnt lgkmcnt(8)
  v_mfma_f32_16x16x32_bf16 v[112:115], v[200:203], v[224:227], v[112:115]
  ds_read_b64_tr_b16 v[168:169], v22 offset:49152
  v_mfma_f32_16x16x32_bf16 v[112:115], v[216:219], v[232:235], v[112:115]
  ds_read_b64_tr_b16 v[170:171], v22 offset:51200
  v_mfma_f32_16x16x32_bf16 v[116:119], v[216:219], v[236:239], v[116:119]
  ds_read_b64_tr_b16 v[172:173], v23 offset:49152
  v_mfma_f32_16x16x32_bf16 v[116:119], v[200:203], v[228:231], v[116:119]
  ds_read_b64_tr_b16 v[174:175], v23 offset:51200
  v_mfma_f32_16x16x32_bf16 v[124:127], v[204:207], v[228:231], v[124:127]
  ds_read_b64_tr_b16 v[184:185], v22 offset:53248
  v_mfma_f32_16x16x32_bf16 v[124:127], v[220:223], v[236:239], v[124:127]
  ds_read_b64_tr_b16 v[186:187], v22 offset:55296
  v_readlane_b32 s50, v30, 22
  v_mfma_f32_16x16x32_bf16 v[120:123], v[220:223], v[232:235], v[120:123]
  ds_read_b64_tr_b16 v[188:189], v23 offset:53248
  v_mfma_f32_16x16x32_bf16 v[120:123], v[204:207], v[224:227], v[120:123]
  ds_read_b64_tr_b16 v[190:191], v23 offset:55296
  s_waitcnt vmcnt(16) lgkmcnt(8)
  v_mfma_f32_16x16x32_bf16 v[128:131], v[160:163], v[240:243], v[128:131]
  buffer_load_dwordx4 v[224:227], off, s[36:39], s50 offset:0 sc1
  v_mfma_f32_16x16x32_bf16 v[128:131], v[176:179], v[248:251], v[128:131]
  ds_read_b64_tr_b16 v[192:193], v20 offset:57344
  ds_read_b64_tr_b16 v[194:195], v20 offset:59392
  v_mfma_f32_16x16x32_bf16 v[132:135], v[176:179], v[252:255], v[132:135]
  ds_read_b64_tr_b16 v[196:197], v21 offset:57344
  v_mfma_f32_16x16x32_bf16 v[132:135], v[160:163], v[244:247], v[132:135]
  ds_read_b64_tr_b16 v[198:199], v21 offset:59392
  v_mfma_f32_16x16x32_bf16 v[140:143], v[164:167], v[244:247], v[140:143]
  ds_read_b64_tr_b16 v[208:209], v20 offset:61440
  v_mfma_f32_16x16x32_bf16 v[140:143], v[180:183], v[252:255], v[140:143]
  ds_read_b64_tr_b16 v[210:211], v20 offset:63488
  ds_read_b64_tr_b16 v[212:213], v21 offset:61440
  v_mfma_f32_16x16x32_bf16 v[136:139], v[180:183], v[248:251], v[136:139]
  buffer_load_dwordx4 v[228:231], off, s[64:67], s50 offset:0 sc1
  v_mfma_f32_16x16x32_bf16 v[136:139], v[164:167], v[240:243], v[136:139]
  ds_read_b64_tr_b16 v[214:215], v21 offset:63488
  s_waitcnt lgkmcnt(8)
  v_mfma_f32_16x16x32_bf16 v[144:147], v[168:171], v[240:243], v[144:147]
  ds_read_b64_tr_b16 v[200:201], v22 offset:57344
  v_mfma_f32_16x16x32_bf16 v[144:147], v[184:187], v[248:251], v[144:147]
  ds_read_b64_tr_b16 v[202:203], v22 offset:59392
  v_mfma_f32_16x16x32_bf16 v[148:151], v[184:187], v[252:255], v[148:151]
  ds_read_b64_tr_b16 v[204:205], v23 offset:57344
  v_mfma_f32_16x16x32_bf16 v[148:151], v[168:171], v[244:247], v[148:151]
  ds_read_b64_tr_b16 v[206:207], v23 offset:59392
  v_mfma_f32_16x16x32_bf16 v[156:159], v[172:175], v[244:247], v[156:159]
  buffer_load_dwordx4 v[232:235], off, s[36:39], s50 offset:1024 sc1
  v_mfma_f32_16x16x32_bf16 v[156:159], v[188:191], v[252:255], v[156:159]
  ds_read_b64_tr_b16 v[216:217], v22 offset:61440
  ds_read_b64_tr_b16 v[218:219], v22 offset:63488
  v_mfma_f32_16x16x32_bf16 v[152:155], v[188:191], v[248:251], v[152:155]
  ds_read_b64_tr_b16 v[220:221], v23 offset:61440
  v_mfma_f32_16x16x32_bf16 v[152:155], v[172:175], v[240:243], v[152:155]
  ds_read_b64_tr_b16 v[222:223], v23 offset:63488
  s_waitcnt vmcnt(15) lgkmcnt(8)
  v_mfma_f32_16x16x32_bf16 v[128:131], v[192:195], v[32:35], v[128:131]
  ds_read_b64_tr_b16 v[160:161], v26 offset:0
  v_mfma_f32_16x16x32_bf16 v[128:131], v[208:211], v[40:43], v[128:131]
  ds_read_b64_tr_b16 v[162:163], v26 offset:2048
  v_mfma_f32_16x16x32_bf16 v[132:135], v[208:211], v[44:47], v[132:135]
  buffer_load_dwordx4 v[236:239], off, s[64:67], s50 offset:1024 sc1
  v_mfma_f32_16x16x32_bf16 v[132:135], v[192:195], v[36:39], v[132:135]
  ds_read_b64_tr_b16 v[164:165], v27 offset:0
  ds_read_b64_tr_b16 v[166:167], v27 offset:2048
  v_mfma_f32_16x16x32_bf16 v[140:143], v[196:199], v[36:39], v[140:143]
  ds_read_b64_tr_b16 v[176:177], v26 offset:4096
  v_mfma_f32_16x16x32_bf16 v[140:143], v[212:215], v[44:47], v[140:143]
  ds_read_b64_tr_b16 v[178:179], v26 offset:6144
  v_mfma_f32_16x16x32_bf16 v[136:139], v[212:215], v[40:43], v[136:139]
  ds_read_b64_tr_b16 v[180:181], v27 offset:4096
  v_mfma_f32_16x16x32_bf16 v[136:139], v[196:199], v[32:35], v[136:139]
  ds_read_b64_tr_b16 v[182:183], v27 offset:6144
  s_waitcnt lgkmcnt(8)
  s_barrier
  v_mfma_f32_16x16x32_bf16 v[144:147], v[200:203], v[32:35], v[144:147]
  ds_read_b64_tr_b16 v[168:169], v28 offset:0
  v_mfma_f32_16x16x32_bf16 v[144:147], v[216:219], v[40:43], v[144:147]
  ds_read_b64_tr_b16 v[170:171], v28 offset:2048
  v_mfma_f32_16x16x32_bf16 v[148:151], v[216:219], v[44:47], v[148:151]
  ds_read_b64_tr_b16 v[172:173], v29 offset:0
  v_mfma_f32_16x16x32_bf16 v[148:151], v[200:203], v[36:39], v[148:151]
  ds_read_b64_tr_b16 v[174:175], v29 offset:2048
  v_mfma_f32_16x16x32_bf16 v[156:159], v[204:207], v[36:39], v[156:159]
  ds_read_b64_tr_b16 v[184:185], v28 offset:4096
  v_mfma_f32_16x16x32_bf16 v[156:159], v[220:223], v[44:47], v[156:159]
  ds_read_b64_tr_b16 v[186:187], v28 offset:6144
  v_mfma_f32_16x16x32_bf16 v[152:155], v[220:223], v[40:43], v[152:155]
  ds_read_b64_tr_b16 v[188:189], v29 offset:4096
  v_mfma_f32_16x16x32_bf16 v[152:155], v[204:207], v[32:35], v[152:155]
  ds_read_b64_tr_b16 v[190:191], v29 offset:6144
  s_waitcnt vmcnt(12) lgkmcnt(8)
  v_mfma_f32_16x16x32_bf16 v[128:131], v[160:163], v[48:51], v[128:131]
  ds_read_b64_tr_b16 v[192:193], v26 offset:8192
  v_mfma_f32_16x16x32_bf16 v[128:131], v[176:179], v[56:59], v[128:131]
  ds_read_b64_tr_b16 v[194:195], v26 offset:10240
  v_mfma_f32_16x16x32_bf16 v[132:135], v[176:179], v[60:63], v[132:135]
  ds_read_b64_tr_b16 v[196:197], v27 offset:8192
  v_mfma_f32_16x16x32_bf16 v[132:135], v[160:163], v[52:55], v[132:135]
  ds_read_b64_tr_b16 v[198:199], v27 offset:10240
  v_mfma_f32_16x16x32_bf16 v[140:143], v[164:167], v[52:55], v[140:143]
  ds_read_b64_tr_b16 v[208:209], v26 offset:12288
  v_mfma_f32_16x16x32_bf16 v[140:143], v[180:183], v[60:63], v[140:143]
  ds_read_b64_tr_b16 v[210:211], v26 offset:14336
  v_mfma_f32_16x16x32_bf16 v[136:139], v[180:183], v[56:59], v[136:139]
  ds_read_b64_tr_b16 v[212:213], v27 offset:12288
  v_mfma_f32_16x16x32_bf16 v[136:139], v[164:167], v[48:51], v[136:139]
  ds_read_b64_tr_b16 v[214:215], v27 offset:14336
  s_waitcnt lgkmcnt(8)
  v_mfma_f32_16x16x32_bf16 v[144:147], v[168:171], v[48:51], v[144:147]
  ds_read_b64_tr_b16 v[200:201], v28 offset:8192
  v_mfma_f32_16x16x32_bf16 v[144:147], v[184:187], v[56:59], v[144:147]
  ds_read_b64_tr_b16 v[202:203], v28 offset:10240
  v_mfma_f32_16x16x32_bf16 v[148:151], v[184:187], v[60:63], v[148:151]
  ds_read_b64_tr_b16 v[204:205], v29 offset:8192
  v_mfma_f32_16x16x32_bf16 v[148:151], v[168:171], v[52:55], v[148:151]
  ds_read_b64_tr_b16 v[206:207], v29 offset:10240
  v_mfma_f32_16x16x32_bf16 v[156:159], v[172:175], v[52:55], v[156:159]
  ds_read_b64_tr_b16 v[216:217], v28 offset:12288
  v_mfma_f32_16x16x32_bf16 v[156:159], v[188:191], v[60:63], v[156:159]
  ds_read_b64_tr_b16 v[218:219], v28 offset:14336
  v_mfma_f32_16x16x32_bf16 v[152:155], v[188:191], v[56:59], v[152:155]
  ds_read_b64_tr_b16 v[220:221], v29 offset:12288
  v_mfma_f32_16x16x32_bf16 v[152:155], v[172:175], v[48:51], v[152:155]
  ds_read_b64_tr_b16 v[222:223], v29 offset:14336
  s_waitcnt vmcnt(8) lgkmcnt(8)
  v_mfma_f32_16x16x32_bf16 v[128:131], v[192:195], v[64:67], v[128:131]
  ds_read_b64_tr_b16 v[160:161], v26 offset:16384
  v_mfma_f32_16x16x32_bf16 v[128:131], v[208:211], v[72:75], v[128:131]
  ds_read_b64_tr_b16 v[162:163], v26 offset:18432
  v_mfma_f32_16x16x32_bf16 v[132:135], v[208:211], v[76:79], v[132:135]
  ds_read_b64_tr_b16 v[164:165], v27 offset:16384
  v_mfma_f32_16x16x32_bf16 v[132:135], v[192:195], v[68:71], v[132:135]
  ds_read_b64_tr_b16 v[166:167], v27 offset:18432
  v_mfma_f32_16x16x32_bf16 v[140:143], v[196:199], v[68:71], v[140:143]
  ds_read_b64_tr_b16 v[176:177], v26 offset:20480
  v_mfma_f32_16x16x32_bf16 v[140:143], v[212:215], v[76:79], v[140:143]
  ds_read_b64_tr_b16 v[178:179], v26 offset:22528
  v_mfma_f32_16x16x32_bf16 v[136:139], v[212:215], v[72:75], v[136:139]
  ds_read_b64_tr_b16 v[180:181], v27 offset:20480
  v_mfma_f32_16x16x32_bf16 v[136:139], v[196:199], v[64:67], v[136:139]
  ds_read_b64_tr_b16 v[182:183], v27 offset:22528
  s_waitcnt lgkmcnt(8)
  v_mfma_f32_16x16x32_bf16 v[144:147], v[200:203], v[64:67], v[144:147]
  ds_read_b64_tr_b16 v[168:169], v28 offset:16384
  v_mfma_f32_16x16x32_bf16 v[144:147], v[216:219], v[72:75], v[144:147]
  ds_read_b64_tr_b16 v[170:171], v28 offset:18432
  v_mfma_f32_16x16x32_bf16 v[148:151], v[216:219], v[76:79], v[148:151]
  ds_read_b64_tr_b16 v[172:173], v29 offset:16384
  v_mfma_f32_16x16x32_bf16 v[148:151], v[200:203], v[68:71], v[148:151]
  ds_read_b64_tr_b16 v[174:175], v29 offset:18432
  v_mfma_f32_16x16x32_bf16 v[156:159], v[204:207], v[68:71], v[156:159]
  ds_read_b64_tr_b16 v[184:185], v28 offset:20480
  v_mfma_f32_16x16x32_bf16 v[156:159], v[220:223], v[76:79], v[156:159]
  ds_read_b64_tr_b16 v[186:187], v28 offset:22528
  v_mfma_f32_16x16x32_bf16 v[152:155], v[220:223], v[72:75], v[152:155]
  ds_read_b64_tr_b16 v[188:189], v29 offset:20480
  v_mfma_f32_16x16x32_bf16 v[152:155], v[204:207], v[64:67], v[152:155]
  ds_read_b64_tr_b16 v[190:191], v29 offset:22528
  s_waitcnt vmcnt(4) lgkmcnt(8)
  v_mfma_f32_16x16x32_bf16 v[128:131], v[160:163], v[80:83], v[128:131]
  ds_read_b64_tr_b16 v[192:193], v26 offset:24576
  v_mfma_f32_16x16x32_bf16 v[128:131], v[176:179], v[88:91], v[128:131]
  ds_read_b64_tr_b16 v[194:195], v26 offset:26624
  v_mfma_f32_16x16x32_bf16 v[132:135], v[176:179], v[92:95], v[132:135]
  ds_read_b64_tr_b16 v[196:197], v27 offset:24576
  v_mfma_f32_16x16x32_bf16 v[132:135], v[160:163], v[84:87], v[132:135]
  ds_read_b64_tr_b16 v[198:199], v27 offset:26624
  v_mfma_f32_16x16x32_bf16 v[140:143], v[164:167], v[84:87], v[140:143]
  ds_read_b64_tr_b16 v[208:209], v26 offset:28672
  v_mfma_f32_16x16x32_bf16 v[140:143], v[180:183], v[92:95], v[140:143]
  ds_read_b64_tr_b16 v[210:211], v26 offset:30720
  v_mfma_f32_16x16x32_bf16 v[136:139], v[180:183], v[88:91], v[136:139]
  ds_read_b64_tr_b16 v[212:213], v27 offset:28672
  v_mfma_f32_16x16x32_bf16 v[136:139], v[164:167], v[80:83], v[136:139]
  ds_read_b64_tr_b16 v[214:215], v27 offset:30720
  s_waitcnt lgkmcnt(8)
  v_mfma_f32_16x16x32_bf16 v[144:147], v[168:171], v[80:83], v[144:147]
  ds_read_b64_tr_b16 v[200:201], v28 offset:24576
  v_mfma_f32_16x16x32_bf16 v[144:147], v[184:187], v[88:91], v[144:147]
  ds_read_b64_tr_b16 v[202:203], v28 offset:26624
  v_mfma_f32_16x16x32_bf16 v[148:151], v[184:187], v[92:95], v[148:151]
  ds_read_b64_tr_b16 v[204:205], v29 offset:24576
  v_mfma_f32_16x16x32_bf16 v[148:151], v[168:171], v[84:87], v[148:151]
  ds_read_b64_tr_b16 v[206:207], v29 offset:26624
  v_mfma_f32_16x16x32_bf16 v[156:159], v[172:175], v[84:87], v[156:159]
  ds_read_b64_tr_b16 v[216:217], v28 offset:28672
  v_mfma_f32_16x16x32_bf16 v[156:159], v[188:191], v[92:95], v[156:159]
  ds_read_b64_tr_b16 v[218:219], v28 offset:30720
  v_mfma_f32_16x16x32_bf16 v[152:155], v[188:191], v[88:91], v[152:155]
  ds_read_b64_tr_b16 v[220:221], v29 offset:28672
  v_mfma_f32_16x16x32_bf16 v[152:155], v[172:175], v[80:83], v[152:155]
  ds_read_b64_tr_b16 v[222:223], v29 offset:30720
  s_waitcnt vmcnt(0) lgkmcnt(8)
  v_mfma_f32_16x16x32_bf16 v[128:131], v[192:195], v[224:227], v[128:131]
  ds_read_b64_tr_b16 v[160:161], v6 offset:0
  v_mfma_f32_16x16x32_bf16 v[128:131], v[208:211], v[232:235], v[128:131]
  ds_read_b64_tr_b16 v[162:163], v6 offset:2048
  v_mfma_f32_16x16x32_bf16 v[132:135], v[208:211], v[236:239], v[132:135]
  ds_read_b64_tr_b16 v[164:165], v7 offset:0
  v_mfma_f32_16x16x32_bf16 v[132:135], v[192:195], v[228:231], v[132:135]
  ds_read_b64_tr_b16 v[166:167], v7 offset:2048
  v_mfma_f32_16x16x32_bf16 v[140:143], v[196:199], v[228:231], v[140:143]
  ds_read_b64_tr_b16 v[176:177], v6 offset:4096
  v_mfma_f32_16x16x32_bf16 v[140:143], v[212:215], v[236:239], v[140:143]
  ds_read_b64_tr_b16 v[178:179], v6 offset:6144
  v_mfma_f32_16x16x32_bf16 v[136:139], v[212:215], v[232:235], v[136:139]
  ds_read_b64_tr_b16 v[180:181], v7 offset:4096
  v_mfma_f32_16x16x32_bf16 v[136:139], v[196:199], v[224:227], v[136:139]
  ds_read_b64_tr_b16 v[182:183], v7 offset:6144
  s_waitcnt lgkmcnt(8)
  s_barrier
  v_mfma_f32_16x16x32_bf16 v[144:147], v[200:203], v[224:227], v[144:147]
  ds_read_b64_tr_b16 v[168:169], v8 offset:0
  v_mfma_f32_16x16x32_bf16 v[144:147], v[216:219], v[232:235], v[144:147]
  ds_read_b64_tr_b16 v[170:171], v8 offset:2048
  v_mfma_f32_16x16x32_bf16 v[148:151], v[216:219], v[236:239], v[148:151]
  ds_read_b64_tr_b16 v[172:173], v9 offset:0
  v_mfma_f32_16x16x32_bf16 v[148:151], v[200:203], v[228:231], v[148:151]
  ds_read_b64_tr_b16 v[174:175], v9 offset:2048
  v_mfma_f32_16x16x32_bf16 v[156:159], v[204:207], v[228:231], v[156:159]
  ds_read_b64_tr_b16 v[184:185], v8 offset:4096
  v_mfma_f32_16x16x32_bf16 v[156:159], v[220:223], v[236:239], v[156:159]
  ds_read_b64_tr_b16 v[186:187], v8 offset:6144
  v_mfma_f32_16x16x32_bf16 v[152:155], v[220:223], v[232:235], v[152:155]
  ds_read_b64_tr_b16 v[188:189], v9 offset:4096
  v_mfma_f32_16x16x32_bf16 v[152:155], v[204:207], v[224:227], v[152:155]
  ds_read_b64_tr_b16 v[190:191], v9 offset:6144
  s_waitcnt lgkmcnt(8)
  v_mfma_f32_16x16x32_bf16 v[96:99], v[160:163], v[240:243], v[96:99]
  ds_read_b64_tr_b16 v[192:193], v6 offset:8192
  v_mfma_f32_16x16x32_bf16 v[96:99], v[176:179], v[248:251], v[96:99]
  ds_read_b64_tr_b16 v[194:195], v6 offset:10240
  v_mfma_f32_16x16x32_bf16 v[100:103], v[176:179], v[252:255], v[100:103]
  ds_read_b64_tr_b16 v[196:197], v7 offset:8192
  v_cvt_pk_bf16_f32 v128, v128, v129
  v_mfma_f32_16x16x32_bf16 v[100:103], v[160:163], v[244:247], v[100:103]
  ds_read_b64_tr_b16 v[198:199], v7 offset:10240
  v_cvt_pk_bf16_f32 v129, v130, v131
  v_mfma_f32_16x16x32_bf16 v[108:111], v[164:167], v[244:247], v[108:111]
  ds_read_b64_tr_b16 v[208:209], v6 offset:12288
  v_cvt_pk_bf16_f32 v130, v132, v133
  v_mfma_f32_16x16x32_bf16 v[108:111], v[180:183], v[252:255], v[108:111]
  ds_read_b64_tr_b16 v[210:211], v6 offset:14336
  v_cvt_pk_bf16_f32 v131, v134, v135
  v_mfma_f32_16x16x32_bf16 v[104:107], v[180:183], v[248:251], v[104:107]
  ds_read_b64_tr_b16 v[212:213], v7 offset:12288
  buffer_store_dwordx4 v[128:131], off, s[60:63], s4 offset:0 sc1
  v_mfma_f32_16x16x32_bf16 v[104:107], v[164:167], v[240:243], v[104:107]
  ds_read_b64_tr_b16 v[214:215], v7 offset:14336
  s_waitcnt lgkmcnt(8)
  v_mfma_f32_16x16x32_bf16 v[112:115], v[168:171], v[240:243], v[112:115]
  ds_read_b64_tr_b16 v[200:201], v8 offset:8192
  v_cvt_pk_bf16_f32 v132, v136, v137
  v_mfma_f32_16x16x32_bf16 v[112:115], v[184:187], v[248:251], v[112:115]
  ds_read_b64_tr_b16 v[202:203], v8 offset:10240
  v_cvt_pk_bf16_f32 v133, v138, v139
  v_mfma_f32_16x16x32_bf16 v[116:119], v[184:187], v[252:255], v[116:119]
  ds_read_b64_tr_b16 v[204:205], v9 offset:8192
  v_cvt_pk_bf16_f32 v134, v140, v141
  v_mfma_f32_16x16x32_bf16 v[116:119], v[168:171], v[244:247], v[116:119]
  ds_read_b64_tr_b16 v[206:207], v9 offset:10240
  v_cvt_pk_bf16_f32 v135, v142, v143
  v_mfma_f32_16x16x32_bf16 v[124:127], v[172:175], v[244:247], v[124:127]
  ds_read_b64_tr_b16 v[216:217], v8 offset:12288
  buffer_store_dwordx4 v[132:135], off, s[60:63], s4 offset:1024 sc1
  v_mfma_f32_16x16x32_bf16 v[124:127], v[188:191], v[252:255], v[124:127]
  ds_read_b64_tr_b16 v[218:219], v8 offset:14336
  v_readlane_b32 s51, v30, 23
  v_mfma_f32_16x16x32_bf16 v[120:123], v[188:191], v[248:251], v[120:123]
  ds_read_b64_tr_b16 v[220:221], v9 offset:12288
  v_cvt_pk_bf16_f32 v136, v144, v145
  v_mfma_f32_16x16x32_bf16 v[120:123], v[172:175], v[240:243], v[120:123]
  ds_read_b64_tr_b16 v[222:223], v9 offset:14336
  s_waitcnt lgkmcnt(8)
  v_mfma_f32_16x16x32_bf16 v[96:99], v[192:195], v[32:35], v[96:99]
  ds_read_b64_tr_b16 v[160:161], v6 offset:16384
  buffer_load_dwordx4 v[240:243], off, s[36:39], s51 offset:0 sc1
  v_mfma_f32_16x16x32_bf16 v[96:99], v[208:211], v[40:43], v[96:99]
  ds_read_b64_tr_b16 v[162:163], v6 offset:18432
  v_cvt_pk_bf16_f32 v137, v146, v147
  v_mfma_f32_16x16x32_bf16 v[100:103], v[208:211], v[44:47], v[100:103]
  ds_read_b64_tr_b16 v[164:165], v7 offset:16384
  v_cvt_pk_bf16_f32 v138, v148, v149
  v_mfma_f32_16x16x32_bf16 v[100:103], v[192:195], v[36:39], v[100:103]
  ds_read_b64_tr_b16 v[166:167], v7 offset:18432
  v_cvt_pk_bf16_f32 v139, v150, v151
  v_mfma_f32_16x16x32_bf16 v[108:111], v[196:199], v[36:39], v[108:111]
  ds_read_b64_tr_b16 v[176:177], v6 offset:20480
  buffer_load_dwordx4 v[244:247], off, s[64:67], s51 offset:0 sc1
  v_mfma_f32_16x16x32_bf16 v[108:111], v[212:215], v[44:47], v[108:111]
  ds_read_b64_tr_b16 v[178:179], v6 offset:22528
  buffer_store_dwordx4 v[136:139], off, s[60:63], s4 offset:2048 sc1
  v_mfma_f32_16x16x32_bf16 v[104:107], v[212:215], v[40:43], v[104:107]
  ds_read_b64_tr_b16 v[180:181], v7 offset:20480
  v_cvt_pk_bf16_f32 v140, v152, v153
  v_mfma_f32_16x16x32_bf16 v[104:107], v[196:199], v[32:35], v[104:107]
  ds_read_b64_tr_b16 v[182:183], v7 offset:22528
  s_waitcnt lgkmcnt(8)
  v_mfma_f32_16x16x32_bf16 v[112:115], v[200:203], v[32:35], v[112:115]
  ds_read_b64_tr_b16 v[168:169], v8 offset:16384
  buffer_load_dwordx4 v[248:251], off, s[36:39], s51 offset:1024 sc1
  v_mfma_f32_16x16x32_bf16 v[112:115], v[216:219], v[40:43], v[112:115]
  ds_read_b64_tr_b16 v[170:171], v8 offset:18432
  v_cvt_pk_bf16_f32 v141, v154, v155
  v_mfma_f32_16x16x32_bf16 v[116:119], v[216:219], v[44:47], v[116:119]
  ds_read_b64_tr_b16 v[172:173], v9 offset:16384
  v_cvt_pk_bf16_f32 v142, v156, v157
  v_mfma_f32_16x16x32_bf16 v[116:119], v[200:203], v[36:39], v[116:119]
  ds_read_b64_tr_b16 v[174:175], v9 offset:18432
  v_cvt_pk_bf16_f32 v143, v158, v159
  v_mfma_f32_16x16x32_bf16 v[124:127], v[204:207], v[36:39], v[124:127]
  ds_read_b64_tr_b16 v[184:185], v8 offset:20480
  buffer_load_dwordx4 v[252:255], off, s[64:67], s51 offset:1024 sc1
  v_mfma_f32_16x16x32_bf16 v[124:127], v[220:223], v[44:47], v[124:127]
  ds_read_b64_tr_b16 v[186:187], v8 offset:22528
  buffer_store_dwordx4 v[140:143], off, s[60:63], s4 offset:3072 sc1
  v_mfma_f32_16x16x32_bf16 v[120:123], v[220:223], v[40:43], v[120:123]
  ds_read_b64_tr_b16 v[188:189], v9 offset:20480
  v_readlane_b32 s48, v30, 24
  v_mfma_f32_16x16x32_bf16 v[120:123], v[204:207], v[32:35], v[120:123]
  ds_read_b64_tr_b16 v[190:191], v9 offset:22528
  s_waitcnt lgkmcnt(8)
  v_mfma_f32_16x16x32_bf16 v[96:99], v[160:163], v[48:51], v[96:99]
  ds_read_b64_tr_b16 v[192:193], v6 offset:24576
  v_mfma_f32_16x16x32_bf16 v[96:99], v[176:179], v[56:59], v[96:99]
  buffer_load_dwordx4 v[32:35], off, s[36:39], s48 offset:0 sc1
  v_mfma_f32_16x16x32_bf16 v[100:103], v[176:179], v[60:63], v[100:103]
  ds_read_b64_tr_b16 v[194:195], v6 offset:26624
  ds_read_b64_tr_b16 v[196:197], v7 offset:24576
  v_mfma_f32_16x16x32_bf16 v[100:103], v[160:163], v[52:55], v[100:103]
  ds_read_b64_tr_b16 v[198:199], v7 offset:26624
  v_mfma_f32_16x16x32_bf16 v[108:111], v[164:167], v[52:55], v[108:111]
  ds_read_b64_tr_b16 v[208:209], v6 offset:28672
  v_mfma_f32_16x16x32_bf16 v[108:111], v[180:183], v[60:63], v[108:111]
  buffer_load_dwordx4 v[36:39], off, s[64:67], s48 offset:0 sc1
  v_mfma_f32_16x16x32_bf16 v[104:107], v[180:183], v[56:59], v[104:107]
  ds_read_b64_tr_b16 v[210:211], v6 offset:30720
  ds_read_b64_tr_b16 v[212:213], v7 offset:28672
  v_mfma_f32_16x16x32_bf16 v[104:107], v[164:167], v[48:51], v[104:107]
  ds_read_b64_tr_b16 v[214:215], v7 offset:30720
  s_waitcnt lgkmcnt(8)
  v_mfma_f32_16x16x32_bf16 v[112:115], v[168:171], v[48:51], v[112:115]
  ds_read_b64_tr_b16 v[200:201], v8 offset:24576
  v_mfma_f32_16x16x32_bf16 v[112:115], v[184:187], v[56:59], v[112:115]
  buffer_load_dwordx4 v[40:43], off, s[36:39], s48 offset:1024 sc1
  v_mfma_f32_16x16x32_bf16 v[116:119], v[184:187], v[60:63], v[116:119]
  ds_read_b64_tr_b16 v[202:203], v8 offset:26624
  ds_read_b64_tr_b16 v[204:205], v9 offset:24576
  v_mfma_f32_16x16x32_bf16 v[116:119], v[168:171], v[52:55], v[116:119]
  ds_read_b64_tr_b16 v[206:207], v9 offset:26624
  v_mfma_f32_16x16x32_bf16 v[124:127], v[172:175], v[52:55], v[124:127]
  ds_read_b64_tr_b16 v[216:217], v8 offset:28672
  v_mfma_f32_16x16x32_bf16 v[124:127], v[188:191], v[60:63], v[124:127]
  buffer_load_dwordx4 v[44:47], off, s[64:67], s48 offset:1024 sc1
  v_mfma_f32_16x16x32_bf16 v[120:123], v[188:191], v[56:59], v[120:123]
  ds_read_b64_tr_b16 v[218:219], v8 offset:30720
  ds_read_b64_tr_b16 v[220:221], v9 offset:28672
  v_mfma_f32_16x16x32_bf16 v[120:123], v[172:175], v[48:51], v[120:123]
  ds_read_b64_tr_b16 v[222:223], v9 offset:30720
  s_waitcnt lgkmcnt(8)
  v_mfma_f32_16x16x32_bf16 v[96:99], v[192:195], v[64:67], v[96:99]
  ds_read_b64_tr_b16 v[160:161], v6 offset:32768
  v_readlane_b32 s49, v30, 25
  v_mfma_f32_16x16x32_bf16 v[96:99], v[208:211], v[72:75], v[96:99]
  ds_read_b64_tr_b16 v[162:163], v6 offset:34816
  v_mfma_f32_16x16x32_bf16 v[100:103], v[208:211], v[76:79], v[100:103]
  ds_read_b64_tr_b16 v[164:165], v7 offset:32768
  v_mfma_f32_16x16x32_bf16 v[100:103], v[192:195], v[68:71], v[100:103]
  buffer_load_dwordx4 v[48:51], off, s[36:39], s49 offset:0 sc1
  v_mfma_f32_16x16x32_bf16 v[108:111], v[196:199], v[68:71], v[108:111]
  ds_read_b64_tr_b16 v[166:167], v7 offset:34816
  ds_read_b64_tr_b16 v[176:177], v6 offset:36864
  v_mfma_f32_16x16x32_bf16 v[108:111], v[212:215], v[76:79], v[108:111]
  ds_read_b64_tr_b16 v[178:179], v6 offset:38912
  v_mfma_f32_16x16x32_bf16 v[104:107], v[212:215], v[72:75], v[104:107]
  ds_read_b64_tr_b16 v[180:181], v7 offset:36864
  v_mfma_f32_16x16x32_bf16 v[104:107], v[196:199], v[64:67], v[104:107]
  ds_read_b64_tr_b16 v[182:183], v7 offset:38912
  s_waitcnt lgkmcnt(8)
  s_barrier
  v_mfma_f32_16x16x32_bf16 v[112:115], v[200:203], v[64:67], v[112:115]
  buffer_load_dwordx4 v[52:55], off, s[64:67], s49 offset:0 sc1
  v_mfma_f32_16x16x32_bf16 v[112:115], v[216:219], v[72:75], v[112:115]
  ds_read_b64_tr_b16 v[168:169], v8 offset:32768
  ds_read_b64_tr_b16 v[170:171], v8 offset:34816
  v_mfma_f32_16x16x32_bf16 v[116:119], v[216:219], v[76:79], v[116:119]
  ds_read_b64_tr_b16 v[172:173], v9 offset:32768
  v_mfma_f32_16x16x32_bf16 v[116:119], v[200:203], v[68:71], v[116:119]
  ds_read_b64_tr_b16 v[174:175], v9 offset:34816
  v_mfma_f32_16x16x32_bf16 v[124:127], v[204:207], v[68:71], v[124:127]
  buffer_load_dwordx4 v[56:59], off, s[36:39], s49 offset:1024 sc1
  v_mfma_f32_16x16x32_bf16 v[124:127], v[220:223], v[76:79], v[124:127]
  ds_read_b64_tr_b16 v[184:185], v8 offset:36864
  ds_read_b64_tr_b16 v[186:187], v8 offset:38912
  v_mfma_f32_16x16x32_bf16 v[120:123], v[220:223], v[72:75], v[120:123]
  ds_read_b64_tr_b16 v[188:189], v9 offset:36864
  v_mfma_f32_16x16x32_bf16 v[120:123], v[204:207], v[64:67], v[120:123]
  ds_read_b64_tr_b16 v[190:191], v9 offset:38912
  s_waitcnt lgkmcnt(8)
  v_mfma_f32_16x16x32_bf16 v[96:99], v[160:163], v[80:83], v[96:99]
  ds_read_b64_tr_b16 v[192:193], v6 offset:40960
  buffer_load_dwordx4 v[60:63], off, s[64:67], s49 offset:1024 sc1
  v_mfma_f32_16x16x32_bf16 v[96:99], v[176:179], v[88:91], v[96:99]
  ds_read_b64_tr_b16 v[194:195], v6 offset:43008
  s_waitcnt vmcnt(8)
  v_mfma_f32_16x16x32_bf16 v[100:103], v[176:179], v[92:95], v[100:103]
  ds_read_b64_tr_b16 v[196:197], v7 offset:40960
  v_readlane_b32 s50, v30, 26
  v_mfma_f32_16x16x32_bf16 v[100:103], v[160:163], v[84:87], v[100:103]
  buffer_store_dword v19, off, s[52:55], s6 sc1
  v_mfma_f32_16x16x32_bf16 v[108:111], v[164:167], v[84:87], v[108:111]
  ds_read_b64_tr_b16 v[198:199], v7 offset:43008
  ds_read_b64_tr_b16 v[208:209], v6 offset:45056
  v_mfma_f32_16x16x32_bf16 v[108:111], v[180:183], v[92:95], v[108:111]
  buffer_load_dwordx4 v[64:67], off, s[36:39], s50 offset:0 sc1
  v_mfma_f32_16x16x32_bf16 v[104:107], v[180:183], v[88:91], v[104:107]
  ds_read_b64_tr_b16 v[210:211], v6 offset:47104
  ds_read_b64_tr_b16 v[212:213], v7 offset:45056
  v_mfma_f32_16x16x32_bf16 v[104:107], v[164:167], v[80:83], v[104:107]
  ds_read_b64_tr_b16 v[214:215], v7 offset:47104
  s_waitcnt lgkmcnt(8)
  v_mfma_f32_16x16x32_bf16 v[112:115], v[168:171], v[80:83], v[112:115]
  ds_read_b64_tr_b16 v[200:201], v8 offset:40960
  v_mfma_f32_16x16x32_bf16 v[112:115], v[184:187], v[88:91], v[112:115]
  buffer_load_dwordx4 v[68:71], off, s[64:67], s50 offset:0 sc1
  v_mfma_f32_16x16x32_bf16 v[116:119], v[184:187], v[92:95], v[116:119]
  ds_read_b64_tr_b16 v[202:203], v8 offset:43008
  ds_read_b64_tr_b16 v[204:205], v9 offset:40960
  v_mfma_f32_16x16x32_bf16 v[116:119], v[168:171], v[84:87], v[116:119]
  ds_read_b64_tr_b16 v[206:207], v9 offset:43008
  v_mfma_f32_16x16x32_bf16 v[124:127], v[172:175], v[84:87], v[124:127]
  ds_read_b64_tr_b16 v[216:217], v8 offset:45056
  v_mfma_f32_16x16x32_bf16 v[124:127], v[188:191], v[92:95], v[124:127]
  buffer_load_dwordx4 v[72:75], off, s[36:39], s50 offset:1024 sc1
  v_mfma_f32_16x16x32_bf16 v[120:123], v[188:191], v[88:91], v[120:123]
  ds_read_b64_tr_b16 v[218:219], v8 offset:47104
  ds_read_b64_tr_b16 v[220:221], v9 offset:45056
  v_mfma_f32_16x16x32_bf16 v[120:123], v[172:175], v[80:83], v[120:123]
  ds_read_b64_tr_b16 v[222:223], v9 offset:47104
  s_waitcnt lgkmcnt(8)
  v_mfma_f32_16x16x32_bf16 v[96:99], v[192:195], v[224:227], v[96:99]
  ds_read_b64_tr_b16 v[160:161], v6 offset:49152
  v_mfma_f32_16x16x32_bf16 v[96:99], v[208:211], v[232:235], v[96:99]
  buffer_load_dwordx4 v[76:79], off, s[64:67], s50 offset:1024 sc1
  v_mfma_f32_16x16x32_bf16 v[100:103], v[208:211], v[236:239], v[100:103]
  ds_read_b64_tr_b16 v[162:163], v6 offset:51200
  ds_read_b64_tr_b16 v[164:165], v7 offset:49152
  v_mfma_f32_16x16x32_bf16 v[100:103], v[192:195], v[228:231], v[100:103]
  ds_read_b64_tr_b16 v[166:167], v7 offset:51200
  v_readlane_b32 s51, v30, 27
  v_mfma_f32_16x16x32_bf16 v[108:111], v[196:199], v[228:231], v[108:111]
  ds_read_b64_tr_b16 v[176:177], v6 offset:53248
  v_mfma_f32_16x16x32_bf16 v[108:111], v[212:215], v[236:239], v[108:111]
  ds_read_b64_tr_b16 v[178:179], v6 offset:55296
  ds_read_b64_tr_b16 v[180:181], v7 offset:53248
  v_mfma_f32_16x16x32_bf16 v[104:107], v[212:215], v[232:235], v[104:107]
  buffer_load_dwordx4 v[80:83], off, s[36:39], s51 offset:0 sc1
  v_mfma_f32_16x16x32_bf16 v[104:107], v[196:199], v[224:227], v[104:107]
  ds_read_b64_tr_b16 v[182:183], v7 offset:55296
  s_waitcnt lgkmcnt(8)
  v_mfma_f32_16x16x32_bf16 v[112:115], v[200:203], v[224:227], v[112:115]
  ds_read_b64_tr_b16 v[168:169], v8 offset:49152
  v_mfma_f32_16x16x32_bf16 v[112:115], v[216:219], v[232:235], v[112:115]
  ds_read_b64_tr_b16 v[170:171], v8 offset:51200
  v_mfma_f32_16x16x32_bf16 v[116:119], v[216:219], v[236:239], v[116:119]
  buffer_load_dwordx4 v[84:87], off, s[64:67], s51 offset:0 sc1
  v_mfma_f32_16x16x32_bf16 v[116:119], v[200:203], v[228:231], v[116:119]
  ds_read_b64_tr_b16 v[172:173], v9 offset:49152
  ds_read_b64_tr_b16 v[174:175], v9 offset:51200
  v_mfma_f32_16x16x32_bf16 v[124:127], v[204:207], v[228:231], v[124:127]
  ds_read_b64_tr_b16 v[184:185], v8 offset:53248
  v_mfma_f32_16x16x32_bf16 v[124:127], v[220:223], v[236:239], v[124:127]
  ds_read_b64_tr_b16 v[186:187], v8 offset:55296
  ds_read_b64_tr_b16 v[188:189], v9 offset:53248
  v_mfma_f32_16x16x32_bf16 v[120:123], v[220:223], v[232:235], v[120:123]
  buffer_load_dwordx4 v[88:91], off, s[36:39], s51 offset:1024 sc1
  v_mfma_f32_16x16x32_bf16 v[120:123], v[204:207], v[224:227], v[120:123]
  ds_read_b64_tr_b16 v[190:191], v9 offset:55296
  s_waitcnt lgkmcnt(8)
  v_mfma_f32_16x16x32_bf16 v[96:99], v[160:163], v[240:243], v[96:99]
  ds_read_b64_tr_b16 v[192:193], v6 offset:57344
  v_mfma_f32_16x16x32_bf16 v[96:99], v[176:179], v[248:251], v[96:99]
  ds_read_b64_tr_b16 v[194:195], v6 offset:59392
  v_mfma_f32_16x16x32_bf16 v[100:103], v[176:179], v[252:255], v[100:103]
  buffer_load_dwordx4 v[92:95], off, s[64:67], s51 offset:1024 sc1
  v_mfma_f32_16x16x32_bf16 v[100:103], v[160:163], v[244:247], v[100:103]
  ds_read_b64_tr_b16 v[196:197], v7 offset:57344
  ds_read_b64_tr_b16 v[198:199], v7 offset:59392
  v_mfma_f32_16x16x32_bf16 v[108:111], v[164:167], v[244:247], v[108:111]
  ds_read_b64_tr_b16 v[208:209], v6 offset:61440
  v_readlane_b32 s48, v30, 28
  v_mfma_f32_16x16x32_bf16 v[108:111], v[180:183], v[252:255], v[108:111]
  ds_read_b64_tr_b16 v[210:211], v6 offset:63488
  v_mfma_f32_16x16x32_bf16 v[104:107], v[180:183], v[248:251], v[104:107]
  ds_read_b64_tr_b16 v[212:213], v7 offset:61440
  v_mfma_f32_16x16x32_bf16 v[104:107], v[164:167], v[240:243], v[104:107]
  ds_read_b64_tr_b16 v[214:215], v7 offset:63488
  s_waitcnt lgkmcnt(8)
  v_mfma_f32_16x16x32_bf16 v[112:115], v[168:171], v[240:243], v[112:115]
  buffer_load_dwordx4 v[224:227], off, s[36:39], s48 offset:0 sc1
  v_mfma_f32_16x16x32_bf16 v[112:115], v[184:187], v[248:251], v[112:115]
  ds_read_b64_tr_b16 v[200:201], v8 offset:57344
  ds_read_b64_tr_b16 v[202:203], v8 offset:59392
  v_mfma_f32_16x16x32_bf16 v[116:119], v[184:187], v[252:255], v[116:119]
  ds_read_b64_tr_b16 v[204:205], v9 offset:57344
  v_mfma_f32_16x16x32_bf16 v[116:119], v[168:171], v[244:247], v[116:119]
  ds_read_b64_tr_b16 v[206:207], v9 offset:59392
  v_mfma_f32_16x16x32_bf16 v[124:127], v[172:175], v[244:247], v[124:127]
  buffer_load_dwordx4 v[228:231], off, s[64:67], s48 offset:0 sc1
  v_mfma_f32_16x16x32_bf16 v[124:127], v[188:191], v[252:255], v[124:127]
  ds_read_b64_tr_b16 v[216:217], v8 offset:61440
  ds_read_b64_tr_b16 v[218:219], v8 offset:63488
  v_mfma_f32_16x16x32_bf16 v[120:123], v[188:191], v[248:251], v[120:123]
  ds_read_b64_tr_b16 v[220:221], v9 offset:61440
  v_mfma_f32_16x16x32_bf16 v[120:123], v[172:175], v[240:243], v[120:123]
  ds_read_b64_tr_b16 v[222:223], v9 offset:63488
  s_waitcnt vmcnt(15) lgkmcnt(8)
  v_mfma_f32_16x16x32_bf16 v[96:99], v[192:195], v[32:35], v[96:99]
  buffer_load_dwordx4 v[232:235], off, s[36:39], s48 offset:1024 sc1
  v_mfma_f32_16x16x32_bf16 v[96:99], v[208:211], v[40:43], v[96:99]
  ds_read_b64_tr_b16 v[160:161], v20 offset:0
  ds_read_b64_tr_b16 v[162:163], v20 offset:2048
  v_mfma_f32_16x16x32_bf16 v[100:103], v[208:211], v[44:47], v[100:103]
  ds_read_b64_tr_b16 v[164:165], v21 offset:0
  v_mfma_f32_16x16x32_bf16 v[100:103], v[192:195], v[36:39], v[100:103]
  ds_read_b64_tr_b16 v[166:167], v21 offset:2048
  v_mfma_f32_16x16x32_bf16 v[108:111], v[196:199], v[36:39], v[108:111]
  buffer_load_dwordx4 v[236:239], off, s[64:67], s48 offset:1024 sc1
  v_mfma_f32_16x16x32_bf16 v[108:111], v[212:215], v[44:47], v[108:111]
  ds_read_b64_tr_b16 v[176:177], v20 offset:4096
  ds_read_b64_tr_b16 v[178:179], v20 offset:6144
  v_mfma_f32_16x16x32_bf16 v[104:107], v[212:215], v[40:43], v[104:107]
  ds_read_b64_tr_b16 v[180:181], v21 offset:4096
  v_readlane_b32 s49, v30, 29
  v_mfma_f32_16x16x32_bf16 v[104:107], v[196:199], v[32:35], v[104:107]
  ds_read_b64_tr_b16 v[182:183], v21 offset:6144
  s_waitcnt lgkmcnt(8)
  v_mfma_f32_16x16x32_bf16 v[112:115], v[200:203], v[32:35], v[112:115]
  ds_read_b64_tr_b16 v[168:169], v22 offset:0
  v_mfma_f32_16x16x32_bf16 v[112:115], v[216:219], v[40:43], v[112:115]
  buffer_load_dwordx4 v[240:243], off, s[36:39], s49 offset:0 sc1
  v_mfma_f32_16x16x32_bf16 v[116:119], v[216:219], v[44:47], v[116:119]
  ds_read_b64_tr_b16 v[170:171], v22 offset:2048
  ds_read_b64_tr_b16 v[172:173], v23 offset:0
  v_mfma_f32_16x16x32_bf16 v[116:119], v[200:203], v[36:39], v[116:119]
  ds_read_b64_tr_b16 v[174:175], v23 offset:2048
  v_mfma_f32_16x16x32_bf16 v[124:127], v[204:207], v[36:39], v[124:127]
  ds_read_b64_tr_b16 v[184:185], v22 offset:4096
  v_mfma_f32_16x16x32_bf16 v[124:127], v[220:223], v[44:47], v[124:127]
  buffer_load_dwordx4 v[244:247], off, s[64:67], s49 offset:0 sc1
  v_mfma_f32_16x16x32_bf16 v[120:123], v[220:223], v[40:43], v[120:123]
  ds_read_b64_tr_b16 v[186:187], v22 offset:6144
  ds_read_b64_tr_b16 v[188:189], v23 offset:4096
  v_mfma_f32_16x16x32_bf16 v[120:123], v[204:207], v[32:35], v[120:123]
  ds_read_b64_tr_b16 v[190:191], v23 offset:6144
  s_waitcnt vmcnt(15) lgkmcnt(8)
  v_mfma_f32_16x16x32_bf16 v[96:99], v[160:163], v[48:51], v[96:99]
  ds_read_b64_tr_b16 v[192:193], v20 offset:8192
  v_mfma_f32_16x16x32_bf16 v[96:99], v[176:179], v[56:59], v[96:99]
  buffer_load_dwordx4 v[248:251], off, s[36:39], s49 offset:1024 sc1
  v_mfma_f32_16x16x32_bf16 v[100:103], v[176:179], v[60:63], v[100:103]
  ds_read_b64_tr_b16 v[194:195], v20 offset:10240
  ds_read_b64_tr_b16 v[196:197], v21 offset:8192
  v_mfma_f32_16x16x32_bf16 v[100:103], v[160:163], v[52:55], v[100:103]
  ds_read_b64_tr_b16 v[198:199], v21 offset:10240
  v_mfma_f32_16x16x32_bf16 v[108:111], v[164:167], v[52:55], v[108:111]
  ds_read_b64_tr_b16 v[208:209], v20 offset:12288
  v_mfma_f32_16x16x32_bf16 v[108:111], v[180:183], v[60:63], v[108:111]
  buffer_load_dwordx4 v[252:255], off, s[64:67], s49 offset:1024 sc1
  v_mfma_f32_16x16x32_bf16 v[104:107], v[180:183], v[56:59], v[104:107]
  ds_read_b64_tr_b16 v[210:211], v20 offset:14336
  ds_read_b64_tr_b16 v[212:213], v21 offset:12288
  v_mfma_f32_16x16x32_bf16 v[104:107], v[164:167], v[48:51], v[104:107]
  ds_read_b64_tr_b16 v[214:215], v21 offset:14336
  s_waitcnt lgkmcnt(8)
  v_mfma_f32_16x16x32_bf16 v[112:115], v[168:171], v[48:51], v[112:115]
  ds_read_b64_tr_b16 v[200:201], v22 offset:8192
  v_readlane_b32 s50, v30, 30
  v_mfma_f32_16x16x32_bf16 v[112:115], v[184:187], v[56:59], v[112:115]
  ds_read_b64_tr_b16 v[202:203], v22 offset:10240
  v_mfma_f32_16x16x32_bf16 v[116:119], v[184:187], v[60:63], v[116:119]
  ds_read_b64_tr_b16 v[204:205], v23 offset:8192
  v_mfma_f32_16x16x32_bf16 v[116:119], v[168:171], v[52:55], v[116:119]
  buffer_load_dwordx4 v[32:35], off, s[36:39], s50 offset:0 sc1
  v_mfma_f32_16x16x32_bf16 v[124:127], v[172:175], v[52:55], v[124:127]
  ds_read_b64_tr_b16 v[206:207], v23 offset:10240
  ds_read_b64_tr_b16 v[216:217], v22 offset:12288
  v_mfma_f32_16x16x32_bf16 v[124:127], v[188:191], v[60:63], v[124:127]
  ds_read_b64_tr_b16 v[218:219], v22 offset:14336
  v_mfma_f32_16x16x32_bf16 v[120:123], v[188:191], v[56:59], v[120:123]
  ds_read_b64_tr_b16 v[220:221], v23 offset:12288
  v_mfma_f32_16x16x32_bf16 v[120:123], v[172:175], v[48:51], v[120:123]
  ds_read_b64_tr_b16 v[222:223], v23 offset:14336
  s_waitcnt vmcnt(13) lgkmcnt(8)
  v_mfma_f32_16x16x32_bf16 v[96:99], v[192:195], v[64:67], v[96:99]
  buffer_load_dwordx4 v[36:39], off, s[64:67], s50 offset:0 sc1
  v_mfma_f32_16x16x32_bf16 v[96:99], v[208:211], v[72:75], v[96:99]
  ds_read_b64_tr_b16 v[160:161], v20 offset:16384
  ds_read_b64_tr_b16 v[162:163], v20 offset:18432
  v_mfma_f32_16x16x32_bf16 v[100:103], v[208:211], v[76:79], v[100:103]
  ds_read_b64_tr_b16 v[164:165], v21 offset:16384
  v_mfma_f32_16x16x32_bf16 v[100:103], v[192:195], v[68:71], v[100:103]
  ds_read_b64_tr_b16 v[166:167], v21 offset:18432
  v_mfma_f32_16x16x32_bf16 v[108:111], v[196:199], v[68:71], v[108:111]
  buffer_load_dwordx4 v[40:43], off, s[36:39], s50 offset:1024 sc1
  v_mfma_f32_16x16x32_bf16 v[108:111], v[212:215], v[76:79], v[108:111]
  ds_read_b64_tr_b16 v[176:177], v20 offset:20480
  ds_read_b64_tr_b16 v[178:179], v20 offset:22528
  v_mfma_f32_16x16x32_bf16 v[104:107], v[212:215], v[72:75], v[104:107]
  ds_read_b64_tr_b16 v[180:181], v21 offset:20480
  v_mfma_f32_16x16x32_bf16 v[104:107], v[196:199], v[64:67], v[104:107]
  ds_read_b64_tr_b16 v[182:183], v21 offset:22528
  s_waitcnt lgkmcnt(8)
  v_mfma_f32_16x16x32_bf16 v[112:115], v[200:203], v[64:67], v[112:115]
  buffer_load_dwordx4 v[44:47], off, s[64:67], s50 offset:1024 sc1
  v_mfma_f32_16x16x32_bf16 v[112:115], v[216:219], v[72:75], v[112:115]
  ds_read_b64_tr_b16 v[168:169], v22 offset:16384
  ds_read_b64_tr_b16 v[170:171], v22 offset:18432
  v_mfma_f32_16x16x32_bf16 v[116:119], v[216:219], v[76:79], v[116:119]
  ds_read_b64_tr_b16 v[172:173], v23 offset:16384
  v_readlane_b32 s51, v30, 31
  v_mfma_f32_16x16x32_bf16 v[116:119], v[200:203], v[68:71], v[116:119]
  ds_read_b64_tr_b16 v[174:175], v23 offset:18432
  v_mfma_f32_16x16x32_bf16 v[124:127], v[204:207], v[68:71], v[124:127]
  ds_read_b64_tr_b16 v[184:185], v22 offset:20480
  v_mfma_f32_16x16x32_bf16 v[124:127], v[220:223], v[76:79], v[124:127]
  buffer_load_dwordx4 v[48:51], off, s[36:39], s51 offset:0 sc1
  v_mfma_f32_16x16x32_bf16 v[120:123], v[220:223], v[72:75], v[120:123]
  ds_read_b64_tr_b16 v[186:187], v22 offset:22528
  ds_read_b64_tr_b16 v[188:189], v23 offset:20480
  v_mfma_f32_16x16x32_bf16 v[120:123], v[204:207], v[64:67], v[120:123]
  ds_read_b64_tr_b16 v[190:191], v23 offset:22528
  s_waitcnt vmcnt(13) lgkmcnt(8)
  v_mfma_f32_16x16x32_bf16 v[96:99], v[160:163], v[80:83], v[96:99]
  ds_read_b64_tr_b16 v[192:193], v20 offset:24576
  v_mfma_f32_16x16x32_bf16 v[96:99], v[176:179], v[88:91], v[96:99]
  buffer_load_dwordx4 v[52:55], off, s[64:67], s51 offset:0 sc1
  v_mfma_f32_16x16x32_bf16 v[100:103], v[176:179], v[92:95], v[100:103]
  ds_read_b64_tr_b16 v[194:195], v20 offset:26624
  ds_read_b64_tr_b16 v[196:197], v21 offset:24576
  v_mfma_f32_16x16x32_bf16 v[100:103], v[160:163], v[84:87], v[100:103]
  ds_read_b64_tr_b16 v[198:199], v21 offset:26624
  v_mfma_f32_16x16x32_bf16 v[108:111], v[164:167], v[84:87], v[108:111]
  ds_read_b64_tr_b16 v[208:209], v20 offset:28672
  v_mfma_f32_16x16x32_bf16 v[108:111], v[180:183], v[92:95], v[108:111]
  buffer_load_dwordx4 v[56:59], off, s[36:39], s51 offset:1024 sc1
  v_mfma_f32_16x16x32_bf16 v[104:107], v[180:183], v[88:91], v[104:107]
  ds_read_b64_tr_b16 v[210:211], v20 offset:30720
  ds_read_b64_tr_b16 v[212:213], v21 offset:28672
  v_mfma_f32_16x16x32_bf16 v[104:107], v[164:167], v[80:83], v[104:107]
  ds_read_b64_tr_b16 v[214:215], v21 offset:30720
  s_waitcnt lgkmcnt(8)
  s_barrier
  v_mfma_f32_16x16x32_bf16 v[112:115], v[168:171], v[80:83], v[112:115]
  ds_read_b64_tr_b16 v[200:201], v22 offset:24576
  buffer_load_dwordx4 v[144:147], off, s[60:63], s5 offset:0 sc1
  v_mfma_f32_16x16x32_bf16 v[112:115], v[184:187], v[88:91], v[112:115]
  ds_read_b64_tr_b16 v[202:203], v22 offset:26624
  buffer_load_dwordx4 v[60:63], off, s[64:67], s51 offset:1024 sc1
  v_mfma_f32_16x16x32_bf16 v[116:119], v[184:187], v[92:95], v[116:119]
  ds_read_b64_tr_b16 v[204:205], v23 offset:24576
  buffer_load_dwordx4 v[148:151], off, s[60:63], s5 offset:1024 sc1
  v_mfma_f32_16x16x32_bf16 v[116:119], v[168:171], v[84:87], v[116:119]
  ds_read_b64_tr_b16 v[206:207], v23 offset:26624
  v_readlane_b32 s48, v30, 32
  v_mfma_f32_16x16x32_bf16 v[124:127], v[172:175], v[84:87], v[124:127]
  buffer_load_dwordx4 v[152:155], off, s[60:63], s5 offset:2048 sc1
  v_mfma_f32_16x16x32_bf16 v[124:127], v[188:191], v[92:95], v[124:127]
  ds_read_b64_tr_b16 v[216:217], v22 offset:28672
  ds_read_b64_tr_b16 v[218:219], v22 offset:30720
  v_mfma_f32_16x16x32_bf16 v[120:123], v[188:191], v[88:91], v[120:123]
  ds_read_b64_tr_b16 v[220:221], v23 offset:28672
  buffer_load_dwordx4 v[64:67], off, s[36:39], s48 offset:0 sc1
  v_mfma_f32_16x16x32_bf16 v[120:123], v[172:175], v[80:83], v[120:123]
  ds_read_b64_tr_b16 v[222:223], v23 offset:30720
  s_waitcnt vmcnt(16) lgkmcnt(8)
  v_mfma_f32_16x16x32_bf16 v[96:99], v[192:195], v[224:227], v[96:99]
  buffer_load_dwordx4 v[156:159], off, s[60:63], s5 offset:3072 sc1
  v_mfma_f32_16x16x32_bf16 v[96:99], v[208:211], v[232:235], v[96:99]
  ds_read_b64_tr_b16 v[160:161], v20 offset:32768
  ds_read_b64_tr_b16 v[162:163], v20 offset:34816
  v_mfma_f32_16x16x32_bf16 v[100:103], v[208:211], v[236:239], v[100:103]
  buffer_load_dwordx4 v[68:71], off, s[64:67], s48 offset:0 sc1
  v_mfma_f32_16x16x32_bf16 v[100:103], v[192:195], v[228:231], v[100:103]
  ds_read_b64_tr_b16 v[164:165], v21 offset:32768
  ds_read_b64_tr_b16 v[166:167], v21 offset:34816
  v_mfma_f32_16x16x32_bf16 v[108:111], v[196:199], v[228:231], v[108:111]
  ds_read_b64_tr_b16 v[176:177], v20 offset:36864
  v_mfma_f32_16x16x32_bf16 v[108:111], v[212:215], v[236:239], v[108:111]
  ds_read_b64_tr_b16 v[178:179], v20 offset:38912
  ds_read_b64_tr_b16 v[180:181], v21 offset:36864
  v_mfma_f32_16x16x32_bf16 v[104:107], v[212:215], v[232:235], v[104:107]
  buffer_load_dwordx4 v[72:75], off, s[36:39], s48 offset:1024 sc1
  v_mfma_f32_16x16x32_bf16 v[104:107], v[196:199], v[224:227], v[104:107]
  ds_read_b64_tr_b16 v[182:183], v21 offset:38912
  s_waitcnt lgkmcnt(8)
  v_mfma_f32_16x16x32_bf16 v[112:115], v[200:203], v[224:227], v[112:115]
  ds_read_b64_tr_b16 v[168:169], v22 offset:32768
  v_mfma_f32_16x16x32_bf16 v[112:115], v[216:219], v[232:235], v[112:115]
  ds_read_b64_tr_b16 v[170:171], v22 offset:34816
  v_mfma_f32_16x16x32_bf16 v[116:119], v[216:219], v[236:239], v[116:119]
  buffer_load_dwordx4 v[76:79], off, s[64:67], s48 offset:1024 sc1
  v_mfma_f32_16x16x32_bf16 v[116:119], v[200:203], v[228:231], v[116:119]
  ds_read_b64_tr_b16 v[172:173], v23 offset:32768
  ds_read_b64_tr_b16 v[174:175], v23 offset:34816
  v_mfma_f32_16x16x32_bf16 v[124:127], v[204:207], v[228:231], v[124:127]
  ds_read_b64_tr_b16 v[184:185], v22 offset:36864
  v_mfma_f32_16x16x32_bf16 v[124:127], v[220:223], v[236:239], v[124:127]
  ds_read_b64_tr_b16 v[186:187], v22 offset:38912
  v_mfma_f32_16x16x32_bf16 v[120:123], v[220:223], v[232:235], v[120:123]
  ds_read_b64_tr_b16 v[188:189], v23 offset:36864
  v_mfma_f32_16x16x32_bf16 v[120:123], v[204:207], v[224:227], v[120:123]
  ds_read_b64_tr_b16 v[190:191], v23 offset:38912
  s_waitcnt vmcnt(16) lgkmcnt(8)
  v_mfma_f32_16x16x32_bf16 v[96:99], v[160:163], v[240:243], v[96:99]
  ds_read_b64_tr_b16 v[192:193], v20 offset:40960
  v_mfma_f32_16x16x32_bf16 v[96:99], v[176:179], v[248:251], v[96:99]
  ds_read_b64_tr_b16 v[194:195], v20 offset:43008
  v_mfma_f32_16x16x32_bf16 v[100:103], v[176:179], v[252:255], v[100:103]
  ds_read_b64_tr_b16 v[196:197], v21 offset:40960
  v_mfma_f32_16x16x32_bf16 v[100:103], v[160:163], v[244:247], v[100:103]
  ds_read_b64_tr_b16 v[198:199], v21 offset:43008
  v_mfma_f32_16x16x32_bf16 v[108:111], v[164:167], v[244:247], v[108:111]
  ds_read_b64_tr_b16 v[208:209], v20 offset:45056
  v_mfma_f32_16x16x32_bf16 v[108:111], v[180:183], v[252:255], v[108:111]
  ds_read_b64_tr_b16 v[210:211], v20 offset:47104
  v_mfma_f32_16x16x32_bf16 v[104:107], v[180:183], v[248:251], v[104:107]
  ds_read_b64_tr_b16 v[212:213], v21 offset:45056
  v_mfma_f32_16x16x32_bf16 v[104:107], v[164:167], v[240:243], v[104:107]
  ds_read_b64_tr_b16 v[214:215], v21 offset:47104
  s_waitcnt lgkmcnt(8)
  v_mfma_f32_16x16x32_bf16 v[112:115], v[168:171], v[240:243], v[112:115]
  ds_read_b64_tr_b16 v[200:201], v22 offset:40960
  v_mfma_f32_16x16x32_bf16 v[112:115], v[184:187], v[248:251], v[112:115]
  ds_read_b64_tr_b16 v[202:203], v22 offset:43008
  v_mfma_f32_16x16x32_bf16 v[116:119], v[184:187], v[252:255], v[116:119]
  ds_read_b64_tr_b16 v[204:205], v23 offset:40960
  v_mfma_f32_16x16x32_bf16 v[116:119], v[168:171], v[244:247], v[116:119]
  ds_read_b64_tr_b16 v[206:207], v23 offset:43008
  v_mfma_f32_16x16x32_bf16 v[124:127], v[172:175], v[244:247], v[124:127]
  ds_read_b64_tr_b16 v[216:217], v22 offset:45056
  v_mfma_f32_16x16x32_bf16 v[124:127], v[188:191], v[252:255], v[124:127]
  ds_read_b64_tr_b16 v[218:219], v22 offset:47104
  v_mfma_f32_16x16x32_bf16 v[120:123], v[188:191], v[248:251], v[120:123]
  ds_read_b64_tr_b16 v[220:221], v23 offset:45056
  v_mfma_f32_16x16x32_bf16 v[120:123], v[172:175], v[240:243], v[120:123]
  ds_read_b64_tr_b16 v[222:223], v23 offset:47104
  s_waitcnt vmcnt(12) lgkmcnt(8)
  v_mfma_f32_16x16x32_bf16 v[96:99], v[192:195], v[32:35], v[96:99]
  ds_read_b64_tr_b16 v[160:161], v20 offset:49152
  v_mfma_f32_16x16x32_bf16 v[96:99], v[208:211], v[40:43], v[96:99]
  ds_read_b64_tr_b16 v[162:163], v20 offset:51200
  v_mfma_f32_16x16x32_bf16 v[100:103], v[208:211], v[44:47], v[100:103]
  ds_read_b64_tr_b16 v[164:165], v21 offset:49152
  v_mfma_f32_16x16x32_bf16 v[100:103], v[192:195], v[36:39], v[100:103]
  ds_read_b64_tr_b16 v[166:167], v21 offset:51200
  v_mfma_f32_16x16x32_bf16 v[108:111], v[196:199], v[36:39], v[108:111]
  ds_read_b64_tr_b16 v[176:177], v20 offset:53248
  v_mfma_f32_16x16x32_bf16 v[108:111], v[212:215], v[44:47], v[108:111]
  ds_read_b64_tr_b16 v[178:179], v20 offset:55296
  v_mfma_f32_16x16x32_bf16 v[104:107], v[212:215], v[40:43], v[104:107]
  ds_read_b64_tr_b16 v[180:181], v21 offset:53248
  v_mfma_f32_16x16x32_bf16 v[104:107], v[196:199], v[32:35], v[104:107]
  ds_read_b64_tr_b16 v[182:183], v21 offset:55296
  s_waitcnt lgkmcnt(8)
  v_mfma_f32_16x16x32_bf16 v[112:115], v[200:203], v[32:35], v[112:115]
  ds_read_b64_tr_b16 v[168:169], v22 offset:49152
  v_mfma_f32_16x16x32_bf16 v[112:115], v[216:219], v[40:43], v[112:115]
  ds_read_b64_tr_b16 v[170:171], v22 offset:51200
  v_mfma_f32_16x16x32_bf16 v[116:119], v[216:219], v[44:47], v[116:119]
  ds_read_b64_tr_b16 v[172:173], v23 offset:49152
  v_mfma_f32_16x16x32_bf16 v[116:119], v[200:203], v[36:39], v[116:119]
  ds_read_b64_tr_b16 v[174:175], v23 offset:51200
  v_mfma_f32_16x16x32_bf16 v[124:127], v[204:207], v[36:39], v[124:127]
  ds_read_b64_tr_b16 v[184:185], v22 offset:53248
  v_mfma_f32_16x16x32_bf16 v[124:127], v[220:223], v[44:47], v[124:127]
  ds_read_b64_tr_b16 v[186:187], v22 offset:55296
  v_mfma_f32_16x16x32_bf16 v[120:123], v[220:223], v[40:43], v[120:123]
  ds_read_b64_tr_b16 v[188:189], v23 offset:53248
  v_mfma_f32_16x16x32_bf16 v[120:123], v[204:207], v[32:35], v[120:123]
  ds_read_b64_tr_b16 v[190:191], v23 offset:55296
  s_waitcnt vmcnt(7) lgkmcnt(8)
  v_mfma_f32_16x16x32_bf16 v[96:99], v[160:163], v[48:51], v[96:99]
  ds_read_b64_tr_b16 v[192:193], v20 offset:57344
  s_waitcnt vmcnt(3)
  v_mfma_f32_16x16x32_bf16 v[96:99], v[176:179], v[56:59], v[96:99]
  ds_read_b64_tr_b16 v[194:195], v20 offset:59392
  v_lshlrev_b32 v128, 16, v144
  v_mfma_f32_16x16x32_bf16 v[100:103], v[176:179], v[60:63], v[100:103]
  ds_read_b64_tr_b16 v[196:197], v21 offset:57344
  v_and_b32 v129, s11, v144
  v_mfma_f32_16x16x32_bf16 v[100:103], v[160:163], v[52:55], v[100:103]
  ds_read_b64_tr_b16 v[198:199], v21 offset:59392
  v_lshlrev_b32 v130, 16, v145
  v_mfma_f32_16x16x32_bf16 v[108:111], v[164:167], v[52:55], v[108:111]
  ds_read_b64_tr_b16 v[208:209], v20 offset:61440
  v_and_b32 v131, s11, v145
  v_mfma_f32_16x16x32_bf16 v[108:111], v[180:183], v[60:63], v[108:111]
  ds_read_b64_tr_b16 v[210:211], v20 offset:63488
  v_lshlrev_b32 v132, 16, v146
  v_mfma_f32_16x16x32_bf16 v[104:107], v[180:183], v[56:59], v[104:107]
  ds_read_b64_tr_b16 v[212:213], v21 offset:61440
  v_and_b32 v133, s11, v146
  v_mfma_f32_16x16x32_bf16 v[104:107], v[164:167], v[48:51], v[104:107]
  ds_read_b64_tr_b16 v[214:215], v21 offset:63488
  s_waitcnt lgkmcnt(8)
  v_mfma_f32_16x16x32_bf16 v[112:115], v[168:171], v[48:51], v[112:115]
  ds_read_b64_tr_b16 v[200:201], v22 offset:57344
  v_lshlrev_b32 v134, 16, v147
  v_mfma_f32_16x16x32_bf16 v[112:115], v[184:187], v[56:59], v[112:115]
  ds_read_b64_tr_b16 v[202:203], v22 offset:59392
  v_and_b32 v135, s11, v147
  v_mfma_f32_16x16x32_bf16 v[116:119], v[184:187], v[60:63], v[116:119]
  ds_read_b64_tr_b16 v[204:205], v23 offset:57344
  v_lshlrev_b32 v136, 16, v148
  v_mfma_f32_16x16x32_bf16 v[116:119], v[168:171], v[52:55], v[116:119]
  ds_read_b64_tr_b16 v[206:207], v23 offset:59392
  v_and_b32 v137, s11, v148
  v_mfma_f32_16x16x32_bf16 v[124:127], v[172:175], v[52:55], v[124:127]
  ds_read_b64_tr_b16 v[216:217], v22 offset:61440
  v_lshlrev_b32 v138, 16, v149
  v_mfma_f32_16x16x32_bf16 v[124:127], v[188:191], v[60:63], v[124:127]
  ds_read_b64_tr_b16 v[218:219], v22 offset:63488
  v_and_b32 v139, s11, v149
  v_mfma_f32_16x16x32_bf16 v[120:123], v[188:191], v[56:59], v[120:123]
  ds_read_b64_tr_b16 v[220:221], v23 offset:61440
  v_lshlrev_b32 v140, 16, v150
  v_mfma_f32_16x16x32_bf16 v[120:123], v[172:175], v[48:51], v[120:123]
  ds_read_b64_tr_b16 v[222:223], v23 offset:63488
  s_waitcnt vmcnt(0) lgkmcnt(8)
  v_mfma_f32_16x16x32_bf16 v[96:99], v[192:195], v[64:67], v[96:99]
  v_mov_b32 v20, 0x3f803f80
  v_mov_b32 v21, 0x3f803f80
  v_mfma_f32_16x16x32_bf16 v[96:99], v[208:211], v[72:75], v[96:99]
  v_mov_b32 v22, 0x3f803f80
  v_mov_b32 v23, 0x3f803f80
  v_mfma_f32_16x16x32_bf16 v[100:103], v[208:211], v[76:79], v[100:103]
  v_and_b32 v141, s11, v150
  v_lshlrev_b32 v142, 16, v151
  v_and_b32 v143, s11, v151
  v_mfma_f32_16x16x32_bf16 v[100:103], v[192:195], v[68:71], v[100:103]
  v_lshlrev_b32 v144, 16, v152
  v_and_b32 v145, s11, v152
  v_lshlrev_b32 v146, 16, v153
  v_mfma_f32_16x16x32_bf16 v[108:111], v[196:199], v[68:71], v[108:111]
  v_and_b32 v147, s11, v153
  v_lshlrev_b32 v148, 16, v154
  v_and_b32 v149, s11, v154
  v_mfma_f32_16x16x32_bf16 v[108:111], v[212:215], v[76:79], v[108:111]
  v_lshlrev_b32 v150, 16, v155
  v_and_b32 v151, s11, v155
  v_lshlrev_b32 v152, 16, v156
  v_mfma_f32_16x16x32_bf16 v[104:107], v[212:215], v[72:75], v[104:107]
  v_and_b32 v153, s11, v156
  v_lshlrev_b32 v154, 16, v157
  v_and_b32 v155, s11, v157
  v_mfma_f32_16x16x32_bf16 v[104:107], v[196:199], v[64:67], v[104:107]
  s_waitcnt lgkmcnt(0)
  v_lshlrev_b32 v156, 16, v158
  v_and_b32 v157, s11, v158
  v_mfma_f32_16x16x32_bf16 v[112:115], v[200:203], v[64:67], v[112:115]
  v_lshlrev_b32 v158, 16, v159
  v_and_b32 v159, s11, v159
  v_mfma_f32_16x16x32_bf16 v[112:115], v[216:219], v[72:75], v[112:115]
  v_mfma_f32_16x16x32_bf16 v[116:119], v[216:219], v[76:79], v[116:119]
  v_mfma_f32_16x16x32_bf16 v[116:119], v[200:203], v[68:71], v[116:119]
  v_mfma_f32_16x16x32_bf16 v[124:127], v[204:207], v[68:71], v[124:127]
  v_mfma_f32_16x16x32_bf16 v[124:127], v[220:223], v[76:79], v[124:127]
  v_mfma_f32_16x16x32_bf16 v[120:123], v[220:223], v[72:75], v[120:123]
  v_mfma_f32_16x16x32_bf16 v[120:123], v[204:207], v[64:67], v[120:123]
  s_lshl_b32 s3, s7, 4
  s_mov_b32 vcc_lo, 0xaaaaaaaa
  s_lshl_b32 s4, s7, 3
  s_add_u32 s5, s3, s4
  v_xor_b32 v6, 32, v4
  v_xor_b32 v7, 64, v4
  v_xor_b32 v8, 96, v4
  v_xor_b32 v9, 64, v12
  v_pk_add_f32 v[96:97], v[96:97], v[128:129]
  v_pk_add_f32 v[98:99], v[98:99], v[130:131]
  v_cvt_pk_bf16_f32 v240, v96, v97
  v_cvt_pk_bf16_f32 v241, v98, v99
  v_pk_add_f32 v[104:105], v[104:105], v[136:137]
  v_pk_add_f32 v[106:107], v[106:107], v[138:139]
  v_cvt_pk_bf16_f32 v242, v104, v105
  v_cvt_pk_bf16_f32 v243, v106, v107
  ds_write_b64 v4, v[240:241] offset:0
  ds_write_b64 v6, v[242:243] offset:0
  v_pk_add_f32 v[112:113], v[112:113], v[144:145]
  v_pk_add_f32 v[114:115], v[114:115], v[146:147]
  v_cvt_pk_bf16_f32 v244, v112, v113
  v_cvt_pk_bf16_f32 v245, v114, v115
  v_pk_add_f32 v[120:121], v[120:121], v[152:153]
  v_pk_add_f32 v[122:123], v[122:123], v[154:155]
  v_cvt_pk_bf16_f32 v246, v120, v121
  v_cvt_pk_bf16_f32 v247, v122, v123
  ds_write_b64 v7, v[244:245] offset:0
  ds_write_b64 v8, v[246:247] offset:0
  ds_read_b128 v[32:35], v5 offset:0
  ds_read_b128 v[36:39], v5 offset:1024
  v_pk_add_f32 v[100:101], v[100:101], v[132:133]
  v_pk_add_f32 v[102:103], v[102:103], v[134:135]
  v_cvt_pk_bf16_f32 v248, v100, v101
  v_cvt_pk_bf16_f32 v249, v102, v103
  v_pk_add_f32 v[108:109], v[108:109], v[140:141]
  v_pk_add_f32 v[110:111], v[110:111], v[142:143]
  v_cvt_pk_bf16_f32 v250, v108, v109
  v_cvt_pk_bf16_f32 v251, v110, v111
  ds_write_b64 v4, v[248:249] offset:2048
  ds_write_b64 v6, v[250:251] offset:2048
  v_pk_add_f32 v[116:117], v[116:117], v[148:149]
  v_pk_add_f32 v[118:119], v[118:119], v[150:151]
  v_cvt_pk_bf16_f32 v252, v116, v117
  v_cvt_pk_bf16_f32 v253, v118, v119
  v_pk_add_f32 v[124:125], v[124:125], v[156:157]
  v_pk_add_f32 v[126:127], v[126:127], v[158:159]
  v_cvt_pk_bf16_f32 v254, v124, v125
  v_cvt_pk_bf16_f32 v255, v126, v127
  ds_write_b64 v7, v[252:253] offset:2048
  ds_write_b64 v8, v[254:255] offset:2048
  ds_read_b128 v[40:43], v5 offset:2048
  ds_read_b128 v[44:47], v5 offset:3072
  s_waitcnt lgkmcnt(7)
  buffer_store_dwordx4 v[32:35], v12, s[40:43], 0 offen sc1
  s_waitcnt lgkmcnt(6)
  buffer_store_dwordx4 v[36:39], v9, s[40:43], s4 offen sc1
  v_mfma_f32_16x16x32_bf16 v[52:55], v[240:243], v[240:243], 0
  s_mov_b32 vcc_hi, vcc_lo
  v_mfma_f32_16x16x32_bf16 v[48:51], v[20:23], v[240:243], 0
  s_mov_b32 s8, 0xcccccccc
  v_mfma_f32_16x16x32_bf16 v[52:55], v[244:247], v[244:247], v[52:55]
  s_mov_b32 s9, s8
  v_mfma_f32_16x16x32_bf16 v[48:51], v[20:23], v[244:247], v[48:51]
  s_waitcnt lgkmcnt(1)
  buffer_store_dwordx4 v[40:43], v12, s[40:43], s3 offen sc1
  s_waitcnt lgkmcnt(0)
  buffer_store_dwordx4 v[44:47], v9, s[40:43], s5 offen sc1
  s_cmp_eq_u32 s96, 1
  s_cbranch_scc1 L_w2_end
  v_mfma_f32_16x16x32_bf16 v[60:63], v[248:251], v[248:251], 0
  v_mfma_f32_16x16x32_bf16 v[56:59], v[20:23], v[248:251], 0
  v_mfma_f32_16x16x32_bf16 v[60:63], v[252:255], v[252:255], v[60:63]
  v_mfma_f32_16x16x32_bf16 v[56:59], v[20:23], v[252:255], v[56:59]
  v_cndmask_b32 v52, v52, v53, vcc
  v_cndmask_b32 v54, v54, v55, vcc
  v_cndmask_b32 v49, v52, v54, s[8:9]
  buffer_store_dwordx2 v[48:49], v18, s[56:59], 0 offen offset:0 sc1
  s_nop 2
  v_cndmask_b32 v60, v60, v61, vcc
  v_cndmask_b32 v62, v62, v63, vcc
  v_cndmask_b32 v57, v60, v62, s[8:9]
  buffer_store_dwordx2 v[56:57], v18, s[56:59], 0 offen offset:128 sc1
  s_waitcnt vmcnt(0) lgkmcnt(0)
  s_barrier
  s_mov_b32 s96, 1
  s_add_u32 s12, s22, 33554432
  s_addc_u32 s13, s23, 0
  s_add_u32 s34, s22, 67108864
  s_addc_u32 s35, s23, 0
  s_add_u32 s97, s97, 1
  s_branch L_attn_body
L_w2_c1:
```

```asm
; @launch grid=(256,1,1) block=(512,1,1) lds=163840
.amdgcn_target "amdgcn-amd-amdhsa--gfx950"
.text
.globl interleave_layers__sliding_local_dilated__dense_activation_gelu__prompt_kernel
.p2align 12
.fill 832, 4, 0xbf810000
.type interleave_layers__sliding_local_dilated__dense_activation_gelu__prompt_kernel,@function
interleave_layers__sliding_local_dilated__dense_activation_gelu__prompt_kernel:
L_attn_c0:
  s_load_dwordx4 s[16:19], s[0:1], 0
  s_load_dwordx2 s[20:21], s[0:1], 16
  s_load_dwordx2 s[22:23], s[0:1], 80
  s_load_dwordx8 s[24:31], s[0:1], 32
  s_load_dwordx2 s[32:33], s[0:1], 64
  s_load_dwordx2 s[34:35], s[0:1], 80
  s_load_dwordx2 s[12:13], s[0:1], 0
  s_load_dwordx2 s[64:65], s[0:1], 72
  s_mov_b32 s96, 0
  s_mov_b32 s97, 0
L_attn_body:
  s_cmp_ge_u32 s2, 256
  s_cbranch_scc1 L_attn_end
  v_lshrrev_b32 v2, 6, v0
  v_and_b32 v1, 63, v0
  v_readfirstlane_b32 s70, v2
  s_and_b32 s3, s2, 7
  s_lshr_b32 s99, s2, 3
  s_and_b32 s5, s3, 1
  s_lshl_b32 s5, s5, 3
  s_and_b32 s6, s99, 7
  s_add_u32 s68, s5, s6
  s_lshr_b32 s5, s3, 1
  s_lshl_b32 s5, s5, 2
  s_lshr_b32 s6, s99, 3
  s_add_u32 s69, s5, s6
  s_cmp_eq_u32 s96, 0
  s_cbranch_scc1 L_attn_map
  s_and_b32 s3, s2, 7
  s_and_b32 s5, s3, 3
  s_lshl_b32 s5, s5, 2
  s_and_b32 s6, s99, 3
  s_add_u32 s68, s5, s6
  s_lshr_b32 s5, s3, 2
  s_lshl_b32 s5, s5, 3
  s_lshr_b32 s6, s99, 2
  s_add_u32 s69, s5, s6
L_attn_map:
  s_cmp_lt_u32 s70, 4
  s_cbranch_scc1 L_attn_compute
L_attn_loader:
  s_add_u32 s8, s70, s69
  s_and_b32 s8, s8, 3
  s_add_u32 s9, s70, s68
  s_and_b32 s9, s9, 3
  s_lshl_b32 s76, s8, 12
  s_lshl_b32 s77, s9, 11
  s_add_u32 s77, s77, 16384
  s_lshl_b32 s11, s68, 7
  v_and_b32 v10, 7, v1
  v_lshrrev_b32 v3, 3, v1
  s_lshr_b32 s10, s76, 7
  s_lshl_b32 s3, s68, 7
  s_add_u32 s10, s10, s3
  v_add_u32 v3, s10, v3
  s_cmp_eq_u32 s96, 1
  s_cselect_b32 s5, 128, 0
  s_add_u32 s5, s5, 2048
  s_lshl_b32 s6, s5, 3
  v_mul_u32_u24 v3, s5, v3
  v_lshrrev_b32 v2, 4, v1
  v_xor_b32 v4, v2, v10
  v_lshl_add_u32 v4, v4, 4, v3
  v_add_u32 v3, s6, v3
  v_add_u32 v5, 4, v2
  v_xor_b32 v5, v5, v10
  v_lshl_add_u32 v5, v5, 4, v3
  v_add_u32 v3, s6, v3
  v_xor_b32 v6, v2, v10
  v_lshl_add_u32 v6, v6, 4, v3
  v_add_u32 v3, s6, v3
  v_add_u32 v7, 4, v2
  v_xor_b32 v7, v7, v10
  v_lshl_add_u32 v7, v7, 4, v3
  v_lshrrev_b32 v3, 3, v1
  s_lshl_b32 s10, s9, 4
  v_add_u32 v3, s10, v3
  v_mul_u32_u24 v3, 6144, v3
  v_lshrrev_b32 v2, 3, v1
  v_and_b32 v2, 2, v2
  v_xor_b32 v2, v2, v10
  s_mul_i32 s10, s69, 128
  v_add_u32 v3, s10, v3
  v_lshl_add_u32 v8, v2, 4, v3
  v_xor_b32 v2, 4, v2
  v_add_u32 v3, 49152, v3
  v_lshl_add_u32 v9, v2, 4, v3
  s_and_b32 s10, s70, 3
  s_lshl_b32 s78, s10, 9
  s_add_u32 s78, s78, 40960
  s_lshl_b32 s14, s10, 2
  s_add_u32 s14, s14, s11
  s_sub_u32 s14, s14, 16
  v_lshrrev_b32 v3, 3, v1
  v_add_u32 v3, s14, v3
  v_max_i32 v3, 0, v3
  v_mul_u32_u24 v3, s5, v3
  s_lshl_b32 s14, s10, 1
  v_lshrrev_b32 v2, 4, v1
  v_add_u32 v2, s14, v2
  v_and_b32 v2, 7, v2
  v_xor_b32 v2, v2, v10
  v_lshl_add_u32 v28, v2, 4, v3
  s_cmp_eq_u32 s10, 0
  s_cselect_b32 s14, 0xffffff00, -1
  s_mov_b32 s15, 0
  s_mov_b32 s75, 0
  s_add_u32 s100, s68, s69
  s_mov_b32 s101, -1
  s_add_u32 s3, s68, s69
  s_and_b32 s3, s3, 3
  s_mov_b32 s100, 0x75463102
  s_mov_b32 s101, 0xfdceb98a
  s_cmp_eq_u32 s3, 1
  s_cselect_b32 s100, 0x65742130, s100
  s_cselect_b32 s101, 0xedfca9b8, s101
  s_cmp_eq_u32 s3, 2
  s_cselect_b32 s100, 0x68532410, s100
  s_cselect_b32 s101, 0xfedbac97, s101
  s_cmp_eq_u32 s3, 3
  s_cselect_b32 s100, 0x96435210, s100
  s_cselect_b32 s101, 0xfecbda87, s101
  s_mov_b32 s91, s69
  s_and_b32 s92, s69, 3
  s_add_u32 s92, s92, 1
  s_and_b32 s73, s100, 15
  s_cmp_eq_u32 s73, s91
  s_cselect_b32 s74, 4, 0
  s_lshr_b64 s[100:101], s[100:101], s74
  s_and_b32 s73, s100, 15
  s_sub_u32 s92, s92, 1
  s_cselect_b32 s73, s91, s73
  s_cselect_b32 s74, 0, 4
  s_lshr_b64 s[100:101], s[100:101], s74
  s_mul_i32 s74, s73, 393216
  s_lshl_b32 s73, s73, 7
  s_waitcnt lgkmcnt(0)
  s_mov_b32 s36, s12
  s_and_b32 s37, s13, 0xffff
  s_mov_b32 s38, 4194304
  s_mov_b32 s39, 0x00020000
  s_cmp_eq_u32 s96, 1
  s_cselect_b32 s38, 128, 0
  s_add_u32 s38, s38, 2048
  s_lshl_b32 s38, s38, 11
  s_mov_b32 s40, s18
  s_and_b32 s41, s19, 0xffff
  s_mov_b32 s42, 6291456
  s_mov_b32 s43, 0x00020000
  s_cmp_lg_u32 s96, 0
  s_cbranch_scc1 L_attn_ld1
  s_mov_b32 s48, s28
  s_and_b32 s49, s29, 0xffff
  s_mov_b32 s50, 7340032
  s_mov_b32 s51, 0x00020000
  s_cmp_eq_u32 s96, 0
  s_cselect_b32 s50, s50, 0
  s_and_b32 s3, s70, 3
  s_lshl_b32 s4, s2, 2
  s_add_u32 s3, s3, s4
  s_mul_i32 s98, s3, 448
  s_add_u32 s98, s98, 0
  s_add_u32 s3, s75, s76
  s_add_u32 m0, s3, 0
  s_nop 0
  buffer_load_dwordx4 v4, s[36:39], s73 offen lds
  s_add_u32 m0, s3, 1024
  s_nop 0
  buffer_load_dwordx4 v5, s[36:39], s73 offen lds
  s_add_u32 m0, s3, 2048
  s_nop 0
  buffer_load_dwordx4 v6, s[36:39], s73 offen lds
  s_add_u32 m0, s3, 3072
  s_nop 0
  buffer_load_dwordx4 v7, s[36:39], s73 offen lds
  s_add_u32 m0, s78, s75
  s_mov_b64 exec, s[14:15]
  buffer_load_dwordx4 v28, s[36:39], s73 offen lds
  s_mov_b64 exec, -1
  s_add_u32 s3, s75, s77
  s_add_u32 m0, s3, 0
  s_add_u32 s4, s74, 0
  buffer_load_dwordx4 v8, s[40:43], s4 offen lds
  s_add_u32 m0, s3, 1024
  s_nop 0
  buffer_load_dwordx4 v9, s[40:43], s4 offen lds
  s_add_u32 m0, s3, 8192
  s_add_u32 s4, s74, 2048
  buffer_load_dwordx4 v8, s[40:43], s4 offen lds
  s_add_u32 m0, s3, 9216
  s_nop 0
  buffer_load_dwordx4 v9, s[40:43], s4 offen lds
  s_add_u32 m0, s3, 16384
  s_add_u32 s4, s74, 4096
  buffer_load_dwordx4 v8, s[40:43], s4 offen lds
  s_add_u32 m0, s3, 17408
  s_nop 0
  buffer_load_dwordx4 v9, s[40:43], s4 offen lds
  s_and_b32 s73, s100, 15
  s_cmp_eq_u32 s73, s91
  s_cselect_b32 s74, 4, 0
  s_lshr_b64 s[100:101], s[100:101], s74
  s_and_b32 s73, s100, 15
  s_sub_u32 s92, s92, 1
  s_cselect_b32 s73, s91, s73
  s_cselect_b32 s74, 0, 4
  s_lshr_b64 s[100:101], s[100:101], s74
  s_mul_i32 s74, s73, 393216
  s_lshl_b32 s73, s73, 7
  s_add_u32 s75, s75, 43008
  s_cmp_eq_u32 s75, 129024
  s_cselect_b32 s75, 0, s75
  s_add_u32 s3, s75, s76
  s_add_u32 m0, s3, 0
  s_nop 0
  buffer_load_dwordx4 v4, s[36:39], s73 offen lds
  s_add_u32 m0, s3, 1024
  s_nop 0
  buffer_load_dwordx4 v5, s[36:39], s73 offen lds
  s_add_u32 m0, s3, 2048
  s_nop 0
  buffer_load_dwordx4 v6, s[36:39], s73 offen lds
  s_add_u32 m0, s3, 3072
  s_nop 0
  buffer_load_dwordx4 v7, s[36:39], s73 offen lds
  s_add_u32 m0, s78, s75
  s_mov_b64 exec, s[14:15]
  buffer_load_dwordx4 v28, s[36:39], s73 offen lds
  s_mov_b64 exec, -1
  s_add_u32 s3, s75, s77
  s_add_u32 m0, s3, 0
  s_add_u32 s4, s74, 0
  buffer_load_dwordx4 v8, s[40:43], s4 offen lds
  s_add_u32 m0, s3, 1024
  s_nop 0
  buffer_load_dwordx4 v9, s[40:43], s4 offen lds
  s_add_u32 m0, s3, 8192
  s_add_u32 s4, s74, 2048
  buffer_load_dwordx4 v8, s[40:43], s4 offen lds
  s_add_u32 m0, s3, 9216
  s_nop 0
  buffer_load_dwordx4 v9, s[40:43], s4 offen lds
  s_add_u32 m0, s3, 16384
  s_add_u32 s4, s74, 4096
  buffer_load_dwordx4 v8, s[40:43], s4 offen lds
  s_add_u32 m0, s3, 17408
  s_nop 0
  buffer_load_dwordx4 v9, s[40:43], s4 offen lds
  s_and_b32 s73, s100, 15
  s_cmp_eq_u32 s73, s91
  s_cselect_b32 s74, 4, 0
  s_lshr_b64 s[100:101], s[100:101], s74
  s_and_b32 s73, s100, 15
  s_sub_u32 s92, s92, 1
  s_cselect_b32 s73, s91, s73
  s_cselect_b32 s74, 0, 4
  s_lshr_b64 s[100:101], s[100:101], s74
  s_mul_i32 s74, s73, 393216
  s_lshl_b32 s73, s73, 7
  s_add_u32 s75, s75, 43008
  s_cmp_eq_u32 s75, 129024
  s_cselect_b32 s75, 0, s75
  s_mov_b32 s52, s24
  s_and_b32 s53, s25, 0xffff
  s_mov_b32 s54, 7340032
  s_mov_b32 s55, 0x00020000
  s_min_u32 s3, s2, 223
  s_mul_i32 s4, s3, 4682
  s_lshr_b32 s4, s4, 16
  s_mul_i32 s5, s4, 14
  s_sub_u32 s3, s3, s5
  s_lshl_b32 s3, s3, 2
  s_and_b32 s5, s70, 3
  s_add_u32 s3, s3, s5
  s_mul_i32 s5, s4, 458752
  s_lshl_b32 s8, s3, 7
  s_add_u32 s95, s5, s8
  s_lshl_b32 s9, s4, 14
  s_lshl_b32 s8, s3, 8
  s_add_u32 s94, s9, s8
  v_lshrrev_b32 v2, 3, v1
  v_mul_u32_u24 v2, 7168, v2
  v_and_b32 v3, 7, v1
  v_lshl_add_u32 v26, v3, 4, v2
  s_and_b32 s3, s70, 3
  s_lshl_b32 s4, s2, 2
  s_add_u32 s3, s3, s4
  s_sub_u32 s4, 384, s40
  s_and_b32 s4, s4, 0x380
  s_mul_i32 s5, s3, 6144
  s_add_u32 s5, s5, s4
  s_buffer_load_dword s84, s[40:43], s5 offset:0
  s_buffer_load_dword s84, s[40:43], s5 offset:64
  s_buffer_load_dword s84, s[40:43], s5 offset:1024
  s_buffer_load_dword s84, s[40:43], s5 offset:1088
  s_buffer_load_dword s84, s[40:43], s5 offset:2048
  s_buffer_load_dword s84, s[40:43], s5 offset:2112
  s_buffer_load_dword s84, s[40:43], s5 offset:3072
  s_buffer_load_dword s84, s[40:43], s5 offset:3136
  s_buffer_load_dword s84, s[40:43], s5 offset:4096
  s_buffer_load_dword s84, s[40:43], s5 offset:4160
  s_buffer_load_dword s84, s[40:43], s5 offset:5120
  s_buffer_load_dword s84, s[40:43], s5 offset:5184
  s_add_u32 s56, s22, 23592960
  s_addc_u32 s57, s23, 0
  s_and_b32 s57, s57, 0xffff
  s_mov_b32 s58, 262144
  s_mov_b32 s59, 0x00020000
  s_and_b32 s3, s70, 3
  s_lshl2_add_u32 s4, s68, s3
  s_lshl_b32 s4, s4, 8
  v_lshrrev_b32 v2, 4, v1
  v_and_b32 v3, 15, v1
  v_lshl_add_u32 v3, v3, 4, s4
  v_lshl_add_u32 v18, v2, 14, v3
  s_lshl_b32 s4, s68, 5
  s_add_u32 s4, s4, s3
  s_sub_u32 s4, s4, 4
  s_max_i32 s4, s4, 0
  s_lshl_b32 s4, s4, 5
  v_lshrrev_b32 v2, 2, v1
  v_and_b32 v3, 3, v1
  v_lshl_add_u32 v3, v3, 3, s4
  v_lshl_add_u32 v19, v2, 14, v3
  s_lshl_b32 s3, s68, 2
  s_sub_u32 s3, s3, 4
  v_and_b32 v20, 7, v1
  v_add_u32 v20, s3, v20
  v_max_i32 v20, 0, v20
  v_lshlrev_b32 v20, 2, v20
  s_and_b32 s65, s65, 0xffff
  s_mov_b32 s66, 256
  s_mov_b32 s67, 0x00020000
  s_waitcnt vmcnt(11)
  s_barrier
  s_add_u32 s3, s75, s76
  s_add_u32 m0, s3, 0
  s_nop 0
  buffer_load_dwordx4 v4, s[36:39], s73 offen lds
  s_add_u32 m0, s3, 1024
  s_nop 0
  buffer_load_dwordx4 v5, s[36:39], s73 offen lds
  s_add_u32 m0, s3, 2048
  s_nop 0
  buffer_load_dwordx4 v6, s[36:39], s73 offen lds
  s_add_u32 m0, s3, 3072
  s_nop 0
  buffer_load_dwordx4 v7, s[36:39], s73 offen lds
  s_add_u32 m0, s78, s75
  s_mov_b64 exec, s[14:15]
  buffer_load_dwordx4 v28, s[36:39], s73 offen lds
  s_mov_b64 exec, -1
  s_add_u32 s3, s75, s77
  s_add_u32 m0, s3, 0
  s_add_u32 s4, s74, 0
  buffer_load_dwordx4 v8, s[40:43], s4 offen lds
  s_add_u32 m0, s3, 1024
  s_nop 0
  buffer_load_dwordx4 v9, s[40:43], s4 offen lds
  s_add_u32 m0, s3, 8192
  s_add_u32 s4, s74, 2048
  buffer_load_dwordx4 v8, s[40:43], s4 offen lds
  s_add_u32 m0, s3, 9216
  s_nop 0
  buffer_load_dwordx4 v9, s[40:43], s4 offen lds
  s_add_u32 m0, s3, 16384
  s_add_u32 s4, s74, 4096
  buffer_load_dwordx4 v8, s[40:43], s4 offen lds
  s_add_u32 m0, s3, 17408
  s_nop 0
  buffer_load_dwordx4 v9, s[40:43], s4 offen lds
  s_and_b32 s73, s100, 15
  s_cmp_eq_u32 s73, s91
  s_cselect_b32 s74, 4, 0
  s_lshr_b64 s[100:101], s[100:101], s74
  s_and_b32 s73, s100, 15
  s_sub_u32 s92, s92, 1
  s_cselect_b32 s73, s91, s73
  s_cselect_b32 s74, 0, 4
  s_lshr_b64 s[100:101], s[100:101], s74
  s_mul_i32 s74, s73, 393216
  s_lshl_b32 s73, s73, 7
  s_add_u32 s75, s75, 43008
  s_cmp_eq_u32 s75, 129024
  s_cselect_b32 s75, 0, s75
  buffer_load_dwordx4 v[64:67], v26, s[52:55], s95 offen
  s_add_u32 s95, s95, 57344
  buffer_load_dwordx4 v[68:71], v26, s[52:55], s95 offen
  s_add_u32 s95, s95, 57344
  s_waitcnt vmcnt(13)
  s_barrier
  s_add_u32 s3, s75, s76
  s_add_u32 m0, s3, 0
  s_nop 0
  buffer_load_dwordx4 v4, s[36:39], s73 offen lds
  s_add_u32 m0, s3, 1024
  s_nop 0
  buffer_load_dwordx4 v5, s[36:39], s73 offen lds
  s_add_u32 m0, s3, 2048
  s_nop 0
  buffer_load_dwordx4 v6, s[36:39], s73 offen lds
  s_add_u32 m0, s3, 3072
  s_nop 0
  buffer_load_dwordx4 v7, s[36:39], s73 offen lds
  s_add_u32 m0, s78, s75
  s_mov_b64 exec, s[14:15]
  buffer_load_dwordx4 v28, s[36:39], s73 offen lds
  s_mov_b64 exec, -1
  s_add_u32 s3, s75, s77
  s_add_u32 m0, s3, 0
  s_add_u32 s4, s74, 0
  buffer_load_dwordx4 v8, s[40:43], s4 offen lds
  s_add_u32 m0, s3, 1024
  s_nop 0
  buffer_load_dwordx4 v9, s[40:43], s4 offen lds
  s_add_u32 m0, s3, 8192
  s_add_u32 s4, s74, 2048
  buffer_load_dwordx4 v8, s[40:43], s4 offen lds
  s_add_u32 m0, s3, 9216
  s_nop 0
  buffer_load_dwordx4 v9, s[40:43], s4 offen lds
  s_add_u32 m0, s3, 16384
  s_add_u32 s4, s74, 4096
  buffer_load_dwordx4 v8, s[40:43], s4 offen lds
  s_add_u32 m0, s3, 17408
  s_nop 0
  buffer_load_dwordx4 v9, s[40:43], s4 offen lds
  s_and_b32 s73, s100, 15
  s_cmp_eq_u32 s73, s91
  s_cselect_b32 s74, 4, 0
  s_lshr_b64 s[100:101], s[100:101], s74
  s_and_b32 s73, s100, 15
  s_sub_u32 s92, s92, 1
  s_cselect_b32 s73, s91, s73
  s_cselect_b32 s74, 0, 4
  s_lshr_b64 s[100:101], s[100:101], s74
  s_mul_i32 s74, s73, 393216
  s_lshl_b32 s73, s73, 7
  s_add_u32 s75, s75, 43008
  s_cmp_eq_u32 s75, 129024
  s_cselect_b32 s75, 0, s75
  buffer_load_dwordx4 v[72:75], v26, s[52:55], s95 offen
  s_add_u32 s95, s95, 57344
  buffer_load_dwordx4 v[76:79], v26, s[52:55], s95 offen
  s_add_u32 s95, s95, 57344
  s_branch L_padl
.fill 220, 4, 0xbf810000
L_padl:
  s_waitcnt vmcnt(15)
  s_barrier
  s_add_u32 s3, s75, s76
  s_add_u32 m0, s3, 0
  s_nop 0
  buffer_load_dwordx4 v4, s[36:39], s73 offen lds
  s_add_u32 m0, s3, 1024
  s_nop 0
  buffer_load_dwordx4 v5, s[36:39], s73 offen lds
  s_add_u32 m0, s3, 2048
  s_nop 0
  buffer_load_dwordx4 v6, s[36:39], s73 offen lds
  s_add_u32 m0, s3, 3072
  s_nop 0
  buffer_load_dwordx4 v7, s[36:39], s73 offen lds
  s_add_u32 m0, s78, s75
  s_mov_b64 exec, s[14:15]
  buffer_load_dwordx4 v28, s[36:39], s73 offen lds
  s_mov_b64 exec, -1
  s_add_u32 s3, s75, s77
  s_add_u32 m0, s3, 0
  s_add_u32 s4, s74, 0
  buffer_load_dwordx4 v8, s[40:43], s4 offen lds
  s_add_u32 m0, s3, 1024
  s_nop 0
  buffer_load_dwordx4 v9, s[40:43], s4 offen lds
  s_add_u32 m0, s3, 8192
  s_add_u32 s4, s74, 2048
  buffer_load_dwordx4 v8, s[40:43], s4 offen lds
  s_add_u32 m0, s3, 9216
  s_nop 0
  buffer_load_dwordx4 v9, s[40:43], s4 offen lds
  s_add_u32 m0, s3, 16384
  s_add_u32 s4, s74, 4096
  buffer_load_dwordx4 v8, s[40:43], s4 offen lds
  s_add_u32 m0, s3, 17408
  s_nop 0
  buffer_load_dwordx4 v9, s[40:43], s4 offen lds
  s_and_b32 s73, s100, 15
  s_cmp_eq_u32 s73, s91
  s_cselect_b32 s74, 4, 0
  s_lshr_b64 s[100:101], s[100:101], s74
  s_and_b32 s73, s100, 15
  s_sub_u32 s92, s92, 1
  s_cselect_b32 s73, s91, s73
  s_cselect_b32 s74, 0, 4
  s_lshr_b64 s[100:101], s[100:101], s74
  s_mul_i32 s74, s73, 393216
  s_lshl_b32 s73, s73, 7
  s_add_u32 s75, s75, 43008
  s_cmp_eq_u32 s75, 129024
  s_cselect_b32 s75, 0, s75
  buffer_load_dwordx4 v[80:83], v26, s[52:55], s95 offen
  s_add_u32 s95, s95, 57344
  buffer_load_dwordx4 v[84:87], v26, s[52:55], s95 offen
  s_add_u32 s95, s95, 57344
  s_waitcnt vmcnt(15)
  s_barrier
  s_add_u32 s3, s75, s76
  s_add_u32 m0, s3, 0
  s_nop 0
  buffer_load_dwordx4 v4, s[36:39], s73 offen lds
  s_add_u32 m0, s3, 1024
  s_nop 0
  buffer_load_dwordx4 v5, s[36:39], s73 offen lds
  s_add_u32 m0, s3, 2048
  s_nop 0
  buffer_load_dwordx4 v6, s[36:39], s73 offen lds
  s_add_u32 m0, s3, 3072
  s_nop 0
  buffer_load_dwordx4 v7, s[36:39], s73 offen lds
  s_add_u32 m0, s78, s75
  s_mov_b64 exec, s[14:15]
  buffer_load_dwordx4 v28, s[36:39], s73 offen lds
  s_mov_b64 exec, -1
  s_add_u32 s3, s75, s77
  s_add_u32 m0, s3, 0
  s_add_u32 s4, s74, 0
  buffer_load_dwordx4 v8, s[40:43], s4 offen lds
  s_add_u32 m0, s3, 1024
  s_nop 0
  buffer_load_dwordx4 v9, s[40:43], s4 offen lds
  s_add_u32 m0, s3, 8192
  s_add_u32 s4, s74, 2048
  buffer_load_dwordx4 v8, s[40:43], s4 offen lds
  s_add_u32 m0, s3, 9216
  s_nop 0
  buffer_load_dwordx4 v9, s[40:43], s4 offen lds
  s_add_u32 m0, s3, 16384
  s_add_u32 s4, s74, 4096
  buffer_load_dwordx4 v8, s[40:43], s4 offen lds
  s_add_u32 m0, s3, 17408
  s_nop 0
  buffer_load_dwordx4 v9, s[40:43], s4 offen lds
  s_and_b32 s73, s100, 15
  s_cmp_eq_u32 s73, s91
  s_cselect_b32 s74, 4, 0
  s_lshr_b64 s[100:101], s[100:101], s74
  s_and_b32 s73, s100, 15
  s_sub_u32 s92, s92, 1
  s_cselect_b32 s73, s91, s73
  s_cselect_b32 s74, 0, 4
  s_lshr_b64 s[100:101], s[100:101], s74
  s_mul_i32 s74, s73, 393216
  s_lshl_b32 s73, s73, 7
  s_add_u32 s75, s75, 43008
  s_cmp_eq_u32 s75, 129024
  s_cselect_b32 s75, 0, s75
  buffer_load_dwordx4 v[88:91], v26, s[52:55], s95 offen
  s_add_u32 s95, s95, 57344
  buffer_load_dwordx4 v[92:95], v26, s[52:55], s95 offen
  s_waitcnt vmcnt(15)
  s_barrier
  s_add_u32 s3, s75, s76
  s_add_u32 m0, s3, 0
  s_nop 0
  buffer_load_dwordx4 v4, s[36:39], s73 offen lds
  s_add_u32 m0, s3, 1024
  s_nop 0
  buffer_load_dwordx4 v5, s[36:39], s73 offen lds
  s_add_u32 m0, s3, 2048
  s_nop 0
  buffer_load_dwordx4 v6, s[36:39], s73 offen lds
  s_add_u32 m0, s3, 3072
  s_nop 0
  buffer_load_dwordx4 v7, s[36:39], s73 offen lds
  s_add_u32 m0, s78, s75
  s_mov_b64 exec, s[14:15]
  buffer_load_dwordx4 v28, s[36:39], s73 offen lds
  s_mov_b64 exec, -1
  s_add_u32 s3, s75, s77
  s_add_u32 m0, s3, 0
  s_add_u32 s4, s74, 0
  buffer_load_dwordx4 v8, s[40:43], s4 offen lds
  s_add_u32 m0, s3, 1024
  s_nop 0
  buffer_load_dwordx4 v9, s[40:43], s4 offen lds
  s_add_u32 m0, s3, 8192
  s_add_u32 s4, s74, 2048
  buffer_load_dwordx4 v8, s[40:43], s4 offen lds
  s_add_u32 m0, s3, 9216
  s_nop 0
  buffer_load_dwordx4 v9, s[40:43], s4 offen lds
  s_add_u32 m0, s3, 16384
  s_add_u32 s4, s74, 4096
  buffer_load_dwordx4 v8, s[40:43], s4 offen lds
  s_add_u32 m0, s3, 17408
  s_nop 0
  buffer_load_dwordx4 v9, s[40:43], s4 offen lds
  s_and_b32 s73, s100, 15
  s_cmp_eq_u32 s73, s91
  s_cselect_b32 s74, 4, 0
  s_lshr_b64 s[100:101], s[100:101], s74
  s_and_b32 s73, s100, 15
  s_sub_u32 s92, s92, 1
  s_cselect_b32 s73, s91, s73
  s_cselect_b32 s74, 0, 4
  s_lshr_b64 s[100:101], s[100:101], s74
  s_mul_i32 s74, s73, 393216
  s_lshl_b32 s73, s73, 7
  s_add_u32 s75, s75, 43008
  s_cmp_eq_u32 s75, 129024
  s_cselect_b32 s75, 0, s75
  s_waitcnt vmcnt(13)
  s_barrier
  s_mov_b32 s79, 8
L_attn0_ld1:
  s_add_u32 s3, s75, s76
  s_add_u32 m0, s3, 0
  s_nop 0
  buffer_load_dwordx4 v4, s[36:39], s73 offen lds
  s_add_u32 m0, s3, 1024
  s_nop 0
  buffer_load_dwordx4 v5, s[36:39], s73 offen lds
  s_add_u32 m0, s3, 2048
  s_nop 0
  buffer_load_dwordx4 v6, s[36:39], s73 offen lds
  s_add_u32 m0, s3, 3072
  s_nop 0
  buffer_load_dwordx4 v7, s[36:39], s73 offen lds
  s_add_u32 m0, s78, s75
  s_mov_b64 exec, s[14:15]
  buffer_load_dwordx4 v28, s[36:39], s73 offen lds
  s_mov_b64 exec, -1
  s_add_u32 s3, s75, s77
  s_add_u32 m0, s3, 0
  s_add_u32 s4, s74, 0
  buffer_load_dwordx4 v8, s[40:43], s4 offen lds
  s_add_u32 m0, s3, 1024
  s_nop 0
  buffer_load_dwordx4 v9, s[40:43], s4 offen lds
  s_add_u32 m0, s3, 8192
  s_add_u32 s4, s74, 2048
  buffer_load_dwordx4 v8, s[40:43], s4 offen lds
  s_add_u32 m0, s3, 9216
  s_nop 0
  buffer_load_dwordx4 v9, s[40:43], s4 offen lds
  s_add_u32 m0, s3, 16384
  s_add_u32 s4, s74, 4096
  buffer_load_dwordx4 v8, s[40:43], s4 offen lds
  s_add_u32 m0, s3, 17408
  s_nop 0
  buffer_load_dwordx4 v9, s[40:43], s4 offen lds
  s_and_b32 s73, s100, 15
  s_cmp_eq_u32 s73, s91
  s_cselect_b32 s74, 4, 0
  s_lshr_b64 s[100:101], s[100:101], s74
  s_and_b32 s73, s100, 15
  s_sub_u32 s92, s92, 1
  s_cselect_b32 s73, s91, s73
  s_cselect_b32 s74, 0, 4
  s_lshr_b64 s[100:101], s[100:101], s74
  s_mul_i32 s74, s73, 393216
  s_lshl_b32 s73, s73, 7
  s_add_u32 s75, s75, 43008
  s_cmp_eq_u32 s75, 129024
  s_cselect_b32 s75, 0, s75
  s_buffer_load_dword s84, s[48:51], s98 offset:0
  s_buffer_load_dword s84, s[48:51], s98 offset:64
  s_buffer_load_dword s84, s[48:51], s98 offset:128
  s_buffer_load_dword s84, s[48:51], s98 offset:192
  s_buffer_load_dword s84, s[48:51], s98 offset:256
  s_buffer_load_dword s84, s[48:51], s98 offset:320
  s_buffer_load_dword s84, s[48:51], s98 offset:384
  s_add_u32 s98, s98, 458752
  s_waitcnt vmcnt(11)
  s_barrier
  s_sub_u32 s79, s79, 1
  s_cmp_lg_u32 s79, 0
  s_cbranch_scc1 L_attn0_ld1
  buffer_load_dword v21, v20, s[64:67], 0 offen sc1
  s_add_u32 s3, s75, s76
  s_add_u32 m0, s3, 0
  s_nop 0
  buffer_load_dwordx4 v4, s[36:39], s73 offen lds
  s_add_u32 m0, s3, 1024
  s_nop 0
  buffer_load_dwordx4 v5, s[36:39], s73 offen lds
  s_add_u32 m0, s3, 2048
  s_nop 0
  buffer_load_dwordx4 v6, s[36:39], s73 offen lds
  s_add_u32 m0, s3, 3072
  s_nop 0
  buffer_load_dwordx4 v7, s[36:39], s73 offen lds
  s_add_u32 m0, s78, s75
  s_mov_b64 exec, s[14:15]
  buffer_load_dwordx4 v28, s[36:39], s73 offen lds
  s_mov_b64 exec, -1
  s_add_u32 s3, s75, s77
  s_add_u32 m0, s3, 0
  s_add_u32 s4, s74, 0
  buffer_load_dwordx4 v8, s[40:43], s4 offen lds
  s_add_u32 m0, s3, 1024
  s_nop 0
  buffer_load_dwordx4 v9, s[40:43], s4 offen lds
  s_add_u32 m0, s3, 8192
  s_add_u32 s4, s74, 2048
  buffer_load_dwordx4 v8, s[40:43], s4 offen lds
  s_add_u32 m0, s3, 9216
  s_nop 0
  buffer_load_dwordx4 v9, s[40:43], s4 offen lds
  s_add_u32 m0, s3, 16384
  s_add_u32 s4, s74, 4096
  buffer_load_dwordx4 v8, s[40:43], s4 offen lds
  s_add_u32 m0, s3, 17408
  s_nop 0
  buffer_load_dwordx4 v9, s[40:43], s4 offen lds
  s_and_b32 s73, s100, 15
  s_cmp_eq_u32 s73, s91
  s_cselect_b32 s74, 4, 0
  s_lshr_b64 s[100:101], s[100:101], s74
  s_and_b32 s73, s100, 15
  s_sub_u32 s92, s92, 1
  s_cselect_b32 s73, s91, s73
  s_cselect_b32 s74, 0, 4
  s_lshr_b64 s[100:101], s[100:101], s74
  s_mul_i32 s74, s73, 393216
  s_lshl_b32 s73, s73, 7
  s_add_u32 s75, s75, 43008
  s_cmp_eq_u32 s75, 129024
  s_cselect_b32 s75, 0, s75
  s_buffer_load_dword s84, s[48:51], s98 offset:0
  s_buffer_load_dword s84, s[48:51], s98 offset:64
  s_buffer_load_dword s84, s[48:51], s98 offset:128
  s_buffer_load_dword s84, s[48:51], s98 offset:192
  s_buffer_load_dword s84, s[48:51], s98 offset:256
  s_buffer_load_dword s84, s[48:51], s98 offset:320
  s_buffer_load_dword s84, s[48:51], s98 offset:384
  s_add_u32 s98, s98, 458752
  s_waitcnt vmcnt(12)
  s_barrier
  s_waitcnt vmcnt(11)
  s_mov_b32 s5, 0x100000
  L_attn_dchk:
  v_or_b32 v13, 0xfefefefe, v21
  v_cmp_ne_u32 vcc, -1, v13
  s_cbranch_vccz L_attn_dok
  s_sub_u32 s5, s5, 1
  buffer_load_dword v21, v20, s[64:67], 0 offen sc1
  s_waitcnt vmcnt(0)
  s_cbranch_scc0 L_attn_dchk
  L_attn_dok:
  buffer_load_dwordx4 v[32:35], v18, s[56:59], 0 offen
  s_mov_b32 s3, 65536
  buffer_load_dwordx4 v[36:39], v18, s[56:59], s3 offen
  s_mov_b32 s3, 131072
  buffer_load_dwordx4 v[40:43], v18, s[56:59], s3 offen
  s_mov_b32 s3, 196608
  buffer_load_dwordx4 v[44:47], v18, s[56:59], s3 offen
  buffer_load_dwordx2 v[48:49], v19, s[56:59], 0 offen
  s_mov_b32 s5, 0xffff0000
  v_lshlrev_b32 v100, 16, v64
  v_and_b32 v101, s5, v64
  v_lshlrev_b32 v102, 16, v65
  v_and_b32 v103, s5, v65
  v_lshlrev_b32 v104, 16, v66
  v_and_b32 v105, s5, v66
  v_lshlrev_b32 v106, 16, v67
  v_and_b32 v107, s5, v67
  v_lshlrev_b32 v108, 16, v68
  v_and_b32 v68, s5, v68
  v_add_f32 v100, v100, v108
  v_add_f32 v101, v101, v68
  v_lshlrev_b32 v108, 16, v69
  v_and_b32 v69, s5, v69
  v_add_f32 v102, v102, v108
  v_add_f32 v103, v103, v69
  v_lshlrev_b32 v108, 16, v70
  v_and_b32 v70, s5, v70
  v_add_f32 v104, v104, v108
  v_add_f32 v105, v105, v70
  v_lshlrev_b32 v108, 16, v71
  v_and_b32 v71, s5, v71
  v_add_f32 v106, v106, v108
  v_add_f32 v107, v107, v71
  v_lshlrev_b32 v108, 16, v72
  v_and_b32 v72, s5, v72
  v_add_f32 v100, v100, v108
  v_add_f32 v101, v101, v72
  v_lshlrev_b32 v108, 16, v73
  v_and_b32 v73, s5, v73
  v_add_f32 v102, v102, v108
  v_add_f32 v103, v103, v73
  v_lshlrev_b32 v108, 16, v74
  v_and_b32 v74, s5, v74
  v_add_f32 v104, v104, v108
  v_add_f32 v105, v105, v74
  v_lshlrev_b32 v108, 16, v75
  v_and_b32 v75, s5, v75
  v_add_f32 v106, v106, v108
  v_add_f32 v107, v107, v75
  v_lshlrev_b32 v108, 16, v76
  v_and_b32 v76, s5, v76
  v_add_f32 v100, v100, v108
  v_add_f32 v101, v101, v76
  v_lshlrev_b32 v108, 16, v77
  v_and_b32 v77, s5, v77
  v_add_f32 v102, v102, v108
  v_add_f32 v103, v103, v77
  v_lshlrev_b32 v108, 16, v78
  v_and_b32 v78, s5, v78
  v_add_f32 v104, v104, v108
  v_add_f32 v105, v105, v78
  v_lshlrev_b32 v108, 16, v79
  v_and_b32 v79, s5, v79
  v_add_f32 v106, v106, v108
  v_add_f32 v107, v107, v79
  s_mov_b32 s60, s20
  s_and_b32 s61, s21, 0xffff
  s_mov_b32 s62, 2097152
  s_mov_b32 s63, 0x00020000
  s_and_b32 s3, s70, 3
  s_mul_i32 s3, s3, 8
  s_mul_i32 s4, s99, 32
  s_add_u32 s3, s3, s4
  v_lshrrev_b32 v2, 3, v1
  v_add_u32 v2, s3, v2
  v_mul_u32_u24 v2, 2048, v2
  v_and_b32 v3, 7, v1
  v_lshl_add_u32 v2, v3, 8, v2
  s_and_b32 s3, s2, 7
  s_lshr_b32 s3, s3, 2
  s_mul_i32 s3, s3, 128
  buffer_load_dword v96, v2, s[60:63], s3 offen
  s_waitcnt vmcnt(6)
  s_barrier
  s_mov_b32 s79, 0x4000
  s_waitcnt vmcnt(1)
L_attn_schk:
  v_add_f32 v32, v32, v36
  v_add_f32 v33, v33, v37
  v_add_f32 v34, v34, v38
  v_add_f32 v35, v35, v39
  v_add_f32 v40, v40, v44
  v_add_f32 v41, v41, v45
  v_add_f32 v42, v42, v46
  v_add_f32 v43, v43, v47
  v_add_f32 v32, v32, v40
  v_add_f32 v33, v33, v41
  v_add_f32 v34, v34, v42
  v_add_f32 v35, v35, v43
  s_nop 1
  v_permlane32_swap_b32 v32, v34
  v_permlane32_swap_b32 v33, v35
  v_add_f32 v32, v32, v34
  v_add_f32 v33, v33, v35
  v_cmp_u_f32 vcc, v32, v33
  v_cmp_u_f32 s[4:5], v48, v49
  s_or_b64 s[4:5], vcc, s[4:5]
  s_cbranch_scc0 L_attn_sok
  s_sub_u32 s79, s79, 1
  s_cbranch_scc1 L_attn_sok
  buffer_load_dwordx4 v[32:35], v18, s[56:59], 0 offen sc1
  s_mov_b32 s3, 65536
  buffer_load_dwordx4 v[36:39], v18, s[56:59], s3 offen sc1
  s_mov_b32 s3, 131072
  buffer_load_dwordx4 v[40:43], v18, s[56:59], s3 offen sc1
  s_mov_b32 s3, 196608
  buffer_load_dwordx4 v[44:47], v18, s[56:59], s3 offen sc1
  buffer_load_dwordx2 v[48:49], v19, s[56:59], 0 offen sc1
  s_waitcnt vmcnt(0)
  s_branch L_attn_schk
L_attn_sok:
  v_mov_b32 v34, v32
  v_mov_b32 v35, v33
  s_nop 0
  v_permlane16_swap_b32 v32, v34
  v_permlane16_swap_b32 v33, v35
  v_add_f32 v32, v32, v34
  v_add_f32 v33, v33, v35
  v_mul_f32 v32, 0x3a800000, v32
  v_mul_f32 v33, 0x3a800000, v33
  v_fma_f32 v33, -v32, v32, v33
  v_max_f32 v33, 0, v33
  v_add_f32 v33, 0x3727c5ac, v33
  v_rsq_f32 v33, v33
  s_nop 0
  s_and_b32 s3, s70, 3
  s_lshl_b32 s5, s3, 7
  s_add_u32 s5, s5, 129088
  v_and_b32 v3, 15, v1
  v_lshrrev_b32 v2, 5, v1
  v_lshl_add_u32 v2, v3, 1, v2
  v_lshl_add_u32 v2, v2, 2, s5
  ds_write2_b32 v2, v32, v33 offset0:0 offset1:160
  v_mov_b32 v50, v48
  v_mov_b32 v51, v49
  s_nop 0
  v_permlane32_swap_b32 v48, v50
  v_permlane32_swap_b32 v49, v51
  v_add_f32 v48, v48, v50
  v_add_f32 v49, v49, v51
  v_mov_b32 v50, v48
  v_mov_b32 v51, v49
  s_nop 0
  v_permlane16_swap_b32 v48, v50
  v_permlane16_swap_b32 v49, v51
  v_add_f32 v48, v48, v50
  v_add_f32 v49, v49, v51
  s_nop 1
  v_add_f32_dpp v48, v48, v48 row_ror:8 row_mask:0xf bank_mask:0xf
  v_add_f32_dpp v49, v49, v49 row_ror:8 row_mask:0xf bank_mask:0xf
  s_nop 1
  v_add_f32_dpp v48, v48, v48 row_ror:4 row_mask:0xf bank_mask:0xf
  v_add_f32_dpp v49, v49, v49 row_ror:4 row_mask:0xf bank_mask:0xf
  v_mul_f32 v48, 0x3a800000, v48
  v_mul_f32 v49, 0x3a800000, v49
  v_fma_f32 v49, -v48, v48, v49
  v_max_f32 v49, 0, v49
  v_add_f32 v49, 0x3727c5ac, v49
  v_rsq_f32 v49, v49
  s_nop 0
  s_lshl_b32 s5, s3, 4
  s_add_u32 s5, s5, 129024
  v_and_b32 v3, 3, v1
  v_lshl_add_u32 v2, v3, 2, s5
  ds_write2_b32 v2, v48, v49 offset0:0 offset1:160
  s_mov_b32 s5, 0xffff0000
  v_lshlrev_b32 v108, 16, v80
  v_and_b32 v80, s5, v80
  v_add_f32 v100, v100, v108
  v_add_f32 v101, v101, v80
  v_lshlrev_b32 v108, 16, v81
  v_and_b32 v81, s5, v81
  v_add_f32 v102, v102, v108
  v_add_f32 v103, v103, v81
  v_lshlrev_b32 v108, 16, v82
  v_and_b32 v82, s5, v82
  v_add_f32 v104, v104, v108
  v_add_f32 v105, v105, v82
  v_lshlrev_b32 v108, 16, v83
  v_and_b32 v83, s5, v83
  v_add_f32 v106, v106, v108
  v_add_f32 v107, v107, v83
  v_lshlrev_b32 v108, 16, v84
  v_and_b32 v84, s5, v84
  v_add_f32 v100, v100, v108
  v_add_f32 v101, v101, v84
  v_lshlrev_b32 v108, 16, v85
  v_and_b32 v85, s5, v85
  v_add_f32 v102, v102, v108
  v_add_f32 v103, v103, v85
  v_lshlrev_b32 v108, 16, v86
  v_and_b32 v86, s5, v86
  v_add_f32 v104, v104, v108
  v_add_f32 v105, v105, v86
  v_lshlrev_b32 v108, 16, v87
  v_and_b32 v87, s5, v87
  v_add_f32 v106, v106, v108
  v_add_f32 v107, v107, v87
  v_lshlrev_b32 v108, 16, v88
  v_and_b32 v88, s5, v88
  v_add_f32 v100, v100, v108
  v_add_f32 v101, v101, v88
  v_lshlrev_b32 v108, 16, v89
  v_and_b32 v89, s5, v89
  v_add_f32 v102, v102, v108
  v_add_f32 v103, v103, v89
  v_lshlrev_b32 v108, 16, v90
  v_and_b32 v90, s5, v90
  v_add_f32 v104, v104, v108
  v_add_f32 v105, v105, v90
  v_lshlrev_b32 v108, 16, v91
  v_and_b32 v91, s5, v91
  v_add_f32 v106, v106, v108
  v_add_f32 v107, v107, v91
  v_lshlrev_b32 v108, 16, v92
  v_and_b32 v92, s5, v92
  v_add_f32 v100, v100, v108
  v_add_f32 v101, v101, v92
  v_lshlrev_b32 v108, 16, v93
  v_and_b32 v93, s5, v93
  v_add_f32 v102, v102, v108
  v_add_f32 v103, v103, v93
  v_lshlrev_b32 v108, 16, v94
  v_and_b32 v94, s5, v94
  v_add_f32 v104, v104, v108
  v_add_f32 v105, v105, v94
  v_lshlrev_b32 v108, 16, v95
  v_and_b32 v95, s5, v95
  v_add_f32 v106, v106, v108
  v_add_f32 v107, v107, v95
  s_add_u32 s52, s22, 24641536
  s_addc_u32 s53, s23, 0
  s_and_b32 s53, s53, 0xffff
  s_mov_b32 s54, 262144
  s_mov_b32 s55, 0x00020000
  v_permlane32_swap_b32 v100, v104
  v_permlane32_swap_b32 v101, v105
  v_permlane32_swap_b32 v102, v106
  v_permlane32_swap_b32 v103, v107
  v_add_f32 v100, v100, v104
  v_add_f32 v101, v101, v105
  v_add_f32 v102, v102, v106
  v_add_f32 v103, v103, v107
  v_and_b32 v2, 7, v1
  v_lshlrev_b32 v2, 5, v2
  v_permlane16_swap_b32 v100, v102
  v_permlane16_swap_b32 v101, v103
  v_add_f32 v100, v100, v102
  v_add_f32 v101, v101, v103
  v_lshrrev_b32 v3, 4, v1
  v_lshl_add_u32 v102, v3, 3, v2
  v_add_f32_dpp v100, v100, v100 row_ror:8 row_mask:0xf bank_mask:0xf
  v_add_f32_dpp v101, v101, v101 row_ror:8 row_mask:0xf bank_mask:0xf
  buffer_store_dwordx2 v[100:101], v102, s[52:55], s94 offen sc1
  s_waitcnt lgkmcnt(0)
  s_barrier
  s_branch L_attn_ldend
L_attn_ld1:
  s_add_u32 s3, s68, s69
  s_and_b32 s3, s3, 3
  s_mov_b32 s100, 0x68532410
  s_mov_b32 s101, 0xfedbac97
  s_cmp_eq_u32 s3, 1
  s_cselect_b32 s100, 0x96435210, s100
  s_cselect_b32 s101, 0xfecbda87, s101
  s_cmp_eq_u32 s3, 2
  s_cselect_b32 s100, 0x75463210, s100
  s_cselect_b32 s101, 0xfdceb98a, s101
  s_cmp_eq_u32 s3, 3
  s_cselect_b32 s100, 0x65743210, s100
  s_cselect_b32 s101, 0xedfca9b8, s101
  s_add_u32 s56, s22, 24379392
  s_addc_u32 s57, s23, 0
  s_and_b32 s57, s57, 0xffff
  s_mov_b32 s58, 262144
  s_mov_b32 s59, 0x00020000
  s_and_b32 s3, s70, 3
  s_lshl2_add_u32 s4, s68, s3
  s_lshl_b32 s4, s4, 8
  v_lshrrev_b32 v2, 4, v1
  v_and_b32 v3, 15, v1
  v_lshl_add_u32 v3, v3, 4, s4
  v_lshl_add_u32 v18, v2, 14, v3
  s_lshl_b32 s4, s68, 5
  s_add_u32 s4, s4, s3
  s_sub_u32 s4, s4, 4
  s_max_i32 s4, s4, 0
  s_lshl_b32 s4, s4, 5
  v_lshrrev_b32 v2, 2, v1
  v_and_b32 v3, 3, v1
  v_lshl_add_u32 v3, v3, 3, s4
  v_lshl_add_u32 v19, v2, 14, v3
  s_add_u32 s64, s22, 41943040
  s_addc_u32 s65, s23, 0
  s_and_b32 s65, s65, 0xffff
  s_mov_b32 s66, 524288
  s_mov_b32 s67, 0x00020000
  v_and_b32 v30, 3, v1
  v_lshlrev_b32 v30, 6, v30
  s_mov_b32 s79, 0x100000
  s_cmp_lg_u32 s70, 4
  s_cbranch_scc1 L_attn_xgo
  s_setprio 3
L_attn_xpoll:
  buffer_load_dword v12, v30, s[64:67], s86 offen sc1
  s_sub_u32 s79, s79, 1
  s_cbranch_scc1 L_attn_xgo
  s_waitcnt vmcnt(0)
  v_cmp_ne_u32 vcc, 1, v12
  s_cbranch_vccnz L_attn_xpoll
L_attn_xgo:
  s_setprio 0
  s_barrier
  s_lshr_b32 s3, s69, 3
  s_and_b32 s73, s69, 7
  s_lshl1_add_u32 s91, s73, s3
  s_mul_i32 s74, s91, 393216
  s_lshl_b32 s73, s91, 7
  s_mov_b32 s88, s73
  s_add_u32 m0, s77, 0
  s_add_u32 s4, s74, 0
  buffer_load_dwordx4 v8, s[40:43], s4 offen lds
  s_add_u32 m0, s77, 1024
  s_nop 0
  buffer_load_dwordx4 v9, s[40:43], s4 offen lds
  s_add_u32 m0, s77, 8192
  s_add_u32 s4, s74, 2048
  buffer_load_dwordx4 v8, s[40:43], s4 offen lds
  s_add_u32 m0, s77, 9216
  s_nop 0
  buffer_load_dwordx4 v9, s[40:43], s4 offen lds
  s_add_u32 m0, s77, 16384
  s_add_u32 s4, s74, 4096
  buffer_load_dwordx4 v8, s[40:43], s4 offen lds
  s_add_u32 m0, s77, 17408
  s_nop 0
  buffer_load_dwordx4 v9, s[40:43], s4 offen lds
  s_and_b32 s73, s100, 15
  s_cmp_eq_u32 s73, s91
  s_cselect_b32 s74, 4, 0
  s_lshr_b64 s[100:101], s[100:101], s74
  s_and_b32 s73, s100, 15
  s_lshr_b64 s[100:101], s[100:101], 4
  s_mul_i32 s74, s73, 393216
  s_lshl_b32 s73, s73, 7
  s_mov_b32 s75, 0
  s_add_u32 s44, s22, 41943040
  s_addc_u32 s45, s23, 0
  s_and_b32 s45, s45, 0xffff
  s_mov_b32 s46, 524288
  s_mov_b32 s47, 0x00020000
  s_lshl4_add_u32 s3, s97, s68
  s_and_b32 s4, s69, 15
  s_lshl4_add_u32 s3, s3, s4
  s_lshl_b32 s3, s3, 7
  s_sub_u32 s3, s3, 32768
  v_lshlrev_b32 v11, 7, v1
  s_cmp_eq_u32 s68, 0
  s_cselect_b32 s4, 15, 31
  v_and_b32 v2, 16, v1
  v_lshl_add_u32 v11, v2, 2, v11
  v_and_b32 v2, s4, v1
  v_lshlrev_b32 v2, 2, v2
  v_mov_b32 v3, 1
  s_mov_b32 s79, 0x100000
  s_waitcnt vmcnt(0)
  s_cmp_lg_u32 s70, 4
  s_barrier
  s_cbranch_scc1 L_attn_nofl
  s_mov_b32 exec_lo, 0xffffffff
  s_mov_b32 exec_hi, 0
  buffer_store_dword v3, v11, s[44:47], s87 offen sc1
  s_mov_b64 exec, -1
L_attn_nofl:
  s_mov_b32 s5, s3
  s_mov_b32 s89, s73
  s_add_u32 m0, s77, 43008
  s_add_u32 s4, s74, 0
  buffer_load_dwordx4 v8, s[40:43], s4 offen lds
  s_add_u32 m0, s77, 44032
  s_nop 0
  buffer_load_dwordx4 v9, s[40:43], s4 offen lds
  s_add_u32 m0, s77, 51200
  s_add_u32 s4, s74, 2048
  buffer_load_dwordx4 v8, s[40:43], s4 offen lds
  s_add_u32 m0, s77, 52224
  s_nop 0
  buffer_load_dwordx4 v9, s[40:43], s4 offen lds
  s_add_u32 m0, s77, 59392
  s_add_u32 s4, s74, 4096
  buffer_load_dwordx4 v8, s[40:43], s4 offen lds
  s_add_u32 m0, s77, 60416
  s_nop 0
  buffer_load_dwordx4 v9, s[40:43], s4 offen lds
  s_and_b32 s73, s100, 15
  s_cmp_eq_u32 s73, s91
  s_cselect_b32 s74, 4, 0
  s_lshr_b64 s[100:101], s[100:101], s74
  s_and_b32 s73, s100, 15
  s_lshr_b64 s[100:101], s[100:101], 4
  s_mul_i32 s74, s73, 393216
  s_lshl_b32 s73, s73, 7
  s_mov_b32 s90, s73
  s_add_u32 m0, s77, 86016
  s_add_u32 s4, s74, 0
  buffer_load_dwordx4 v8, s[40:43], s4 offen lds
  s_add_u32 m0, s77, 87040
  s_nop 0
  buffer_load_dwordx4 v9, s[40:43], s4 offen lds
  s_add_u32 m0, s77, 94208
  s_add_u32 s4, s74, 2048
  buffer_load_dwordx4 v8, s[40:43], s4 offen lds
  s_add_u32 m0, s77, 95232
  s_nop 0
  buffer_load_dwordx4 v9, s[40:43], s4 offen lds
  s_add_u32 m0, s77, 102400
  s_add_u32 s4, s74, 4096
  buffer_load_dwordx4 v8, s[40:43], s4 offen lds
  s_add_u32 m0, s77, 103424
  s_nop 0
  buffer_load_dwordx4 v9, s[40:43], s4 offen lds
  s_and_b32 s73, s100, 15
  s_cmp_eq_u32 s73, s91
  s_cselect_b32 s74, 4, 0
  s_lshr_b64 s[100:101], s[100:101], s74
  s_and_b32 s73, s100, 15
  s_lshr_b64 s[100:101], s[100:101], 4
  s_mul_i32 s74, s73, 393216
  s_lshl_b32 s73, s73, 7
  s_mov_b32 s3, s5
  s_cmp_lg_u32 s70, 4
  s_cbranch_scc1 L_attn_dep
L_attn_poll:
  buffer_load_dword v3, v2, s[44:47], s3 offen sc1
  s_sub_u32 s79, s79, 1
  s_cbranch_scc1 L_attn_dep
  s_waitcnt vmcnt(0)
  v_cmp_ne_u32 vcc, 1, v3
  s_cbranch_vccnz L_attn_poll
L_attn_dep:
  s_waitcnt vmcnt(6)
  s_barrier
  s_add_u32 m0, s78, 89344
  s_mov_b64 exec, s[14:15]
  buffer_load_dwordx4 v28, s[36:39], s88 offen lds
  s_mov_b64 exec, -1
  s_add_u32 m0, s76, 43008
  s_nop 0
  buffer_load_dwordx4 v4, s[36:39], s89 offen lds
  s_add_u32 m0, s76, 44032
  s_nop 0
  buffer_load_dwordx4 v5, s[36:39], s89 offen lds
  s_add_u32 m0, s76, 45056
  s_nop 0
  buffer_load_dwordx4 v6, s[36:39], s89 offen lds
  s_add_u32 m0, s76, 46080
  s_nop 0
  buffer_load_dwordx4 v7, s[36:39], s89 offen lds
  s_add_u32 m0, s78, 43008
  s_mov_b64 exec, s[14:15]
  buffer_load_dwordx4 v28, s[36:39], s89 offen lds
  s_mov_b64 exec, -1
  s_add_u32 m0, s76, 86016
  s_nop 0
  buffer_load_dwordx4 v4, s[36:39], s90 offen lds
  s_add_u32 m0, s76, 87040
  s_nop 0
  buffer_load_dwordx4 v5, s[36:39], s90 offen lds
  s_add_u32 m0, s76, 88064
  s_nop 0
  buffer_load_dwordx4 v6, s[36:39], s90 offen lds
  s_add_u32 m0, s76, 89088
  s_nop 0
  buffer_load_dwordx4 v7, s[36:39], s90 offen lds
  s_add_u32 m0, s78, 86016
  s_mov_b64 exec, s[14:15]
  buffer_load_dwordx4 v28, s[36:39], s90 offen lds
  s_mov_b64 exec, -1
  s_waitcnt vmcnt(5)
  s_barrier
  s_mov_b32 s79, 12
L_attn1_ld1:
  s_add_u32 s3, s75, s76
  s_add_u32 m0, s3, 0
  s_nop 0
  buffer_load_dwordx4 v4, s[36:39], s73 offen lds
  s_add_u32 m0, s3, 1024
  s_nop 0
  buffer_load_dwordx4 v5, s[36:39], s73 offen lds
  s_add_u32 m0, s3, 2048
  s_nop 0
  buffer_load_dwordx4 v6, s[36:39], s73 offen lds
  s_add_u32 m0, s3, 3072
  s_nop 0
  buffer_load_dwordx4 v7, s[36:39], s73 offen lds
  s_add_u32 m0, s78, s75
  s_mov_b64 exec, s[14:15]
  buffer_load_dwordx4 v28, s[36:39], s73 offen lds
  s_mov_b64 exec, -1
  s_add_u32 s3, s75, s77
  s_add_u32 m0, s3, 0
  s_add_u32 s4, s74, 0
  buffer_load_dwordx4 v8, s[40:43], s4 offen lds
  s_add_u32 m0, s3, 1024
  s_nop 0
  buffer_load_dwordx4 v9, s[40:43], s4 offen lds
  s_add_u32 m0, s3, 8192
  s_add_u32 s4, s74, 2048
  buffer_load_dwordx4 v8, s[40:43], s4 offen lds
  s_add_u32 m0, s3, 9216
  s_nop 0
  buffer_load_dwordx4 v9, s[40:43], s4 offen lds
  s_add_u32 m0, s3, 16384
  s_add_u32 s4, s74, 4096
  buffer_load_dwordx4 v8, s[40:43], s4 offen lds
  s_add_u32 m0, s3, 17408
  s_nop 0
  buffer_load_dwordx4 v9, s[40:43], s4 offen lds
  s_and_b32 s73, s100, 15
  s_cmp_eq_u32 s73, s91
  s_cselect_b32 s74, 4, 0
  s_lshr_b64 s[100:101], s[100:101], s74
  s_and_b32 s73, s100, 15
  s_lshr_b64 s[100:101], s[100:101], 4
  s_mul_i32 s74, s73, 393216
  s_lshl_b32 s73, s73, 7
  s_add_u32 s75, s75, 43008
  s_cmp_eq_u32 s75, 129024
  s_cselect_b32 s75, 0, s75
  s_waitcnt vmcnt(11)
  s_barrier
  s_sub_u32 s79, s79, 1
  s_cmp_lg_u32 s79, 0
  s_cbranch_scc1 L_attn1_ld1
  s_add_u32 s3, s75, s76
  s_add_u32 m0, s3, 0
  s_nop 0
  buffer_load_dwordx4 v4, s[36:39], s73 offen lds
  s_add_u32 m0, s3, 1024
  s_nop 0
  buffer_load_dwordx4 v5, s[36:39], s73 offen lds
  s_add_u32 m0, s3, 2048
  s_nop 0
  buffer_load_dwordx4 v6, s[36:39], s73 offen lds
  s_add_u32 m0, s3, 3072
  s_nop 0
  buffer_load_dwordx4 v7, s[36:39], s73 offen lds
  s_add_u32 m0, s78, s75
  s_mov_b64 exec, s[14:15]
  buffer_load_dwordx4 v28, s[36:39], s73 offen lds
  s_mov_b64 exec, -1
  s_add_u32 s3, s75, s77
  s_add_u32 m0, s3, 0
  s_add_u32 s4, s74, 0
  buffer_load_dwordx4 v8, s[40:43], s4 offen lds
  s_add_u32 m0, s3, 1024
  s_nop 0
  buffer_load_dwordx4 v9, s[40:43], s4 offen lds
  s_add_u32 m0, s3, 8192
  s_add_u32 s4, s74, 2048
  buffer_load_dwordx4 v8, s[40:43], s4 offen lds
  s_add_u32 m0, s3, 9216
  s_nop 0
  buffer_load_dwordx4 v9, s[40:43], s4 offen lds
  s_add_u32 m0, s3, 16384
  s_add_u32 s4, s74, 4096
  buffer_load_dwordx4 v8, s[40:43], s4 offen lds
  s_add_u32 m0, s3, 17408
  s_nop 0
  buffer_load_dwordx4 v9, s[40:43], s4 offen lds
  s_and_b32 s73, s100, 15
  s_cmp_eq_u32 s73, s91
  s_cselect_b32 s74, 4, 0
  s_lshr_b64 s[100:101], s[100:101], s74
  s_and_b32 s73, s100, 15
  s_lshr_b64 s[100:101], s[100:101], 4
  s_mul_i32 s74, s73, 393216
  s_lshl_b32 s73, s73, 7
  s_add_u32 s75, s75, 43008
  s_cmp_eq_u32 s75, 129024
  s_cselect_b32 s75, 0, s75
  s_mov_b32 s60, s20
  s_and_b32 s61, s21, 0xffff
  s_mov_b32 s62, 2097152
  s_mov_b32 s63, 0x00020000
  s_and_b32 s3, s70, 3
  s_mul_i32 s3, s3, 8
  s_mul_i32 s4, s99, 32
  s_add_u32 s3, s3, s4
  v_lshrrev_b32 v2, 3, v1
  v_add_u32 v2, s3, v2
  v_mul_u32_u24 v2, 2048, v2
  v_and_b32 v3, 7, v1
  v_lshl_add_u32 v2, v3, 8, v2
  s_and_b32 s3, s2, 7
  s_lshr_b32 s3, s3, 2
  s_mul_i32 s3, s3, 128
  buffer_load_dword v96, v2, s[60:63], s3 offen
  s_waitcnt vmcnt(12)
  s_barrier
  buffer_load_dwordx4 v[32:35], v18, s[56:59], 0 offen
  s_mov_b32 s3, 65536
  buffer_load_dwordx4 v[36:39], v18, s[56:59], s3 offen
  s_mov_b32 s3, 131072
  buffer_load_dwordx4 v[40:43], v18, s[56:59], s3 offen
  s_mov_b32 s3, 196608
  buffer_load_dwordx4 v[44:47], v18, s[56:59], s3 offen
  buffer_load_dwordx2 v[48:49], v19, s[56:59], 0 offen
  s_waitcnt vmcnt(6)
  s_barrier
  s_waitcnt vmcnt(0)
  v_add_f32 v32, v32, v36
  v_add_f32 v33, v33, v37
  v_add_f32 v34, v34, v38
  v_add_f32 v35, v35, v39
  v_add_f32 v40, v40, v44
  v_add_f32 v41, v41, v45
  v_add_f32 v42, v42, v46
  v_add_f32 v43, v43, v47
  v_add_f32 v32, v32, v40
  v_add_f32 v33, v33, v41
  v_add_f32 v34, v34, v42
  v_add_f32 v35, v35, v43
  s_nop 1
  v_permlane32_swap_b32 v32, v34
  v_permlane32_swap_b32 v33, v35
  v_add_f32 v32, v32, v34
  v_add_f32 v33, v33, v35
  v_mov_b32 v34, v32
  v_mov_b32 v35, v33
  s_nop 0
  v_permlane16_swap_b32 v32, v34
  v_permlane16_swap_b32 v33, v35
  v_add_f32 v32, v32, v34
  v_add_f32 v33, v33, v35
  v_mul_f32 v32, 0x3a800000, v32
  v_mul_f32 v33, 0x3a800000, v33
  v_fma_f32 v33, -v32, v32, v33
  v_max_f32 v33, 0, v33
  v_add_f32 v33, 0x3727c5ac, v33
  v_rsq_f32 v33, v33
  s_nop 0
  s_and_b32 s3, s70, 3
  s_lshl_b32 s5, s3, 7
  s_add_u32 s5, s5, 129088
  v_and_b32 v3, 15, v1
  v_lshrrev_b32 v2, 5, v1
  v_lshl_add_u32 v2, v3, 1, v2
  v_lshl_add_u32 v2, v2, 2, s5
  ds_write2_b32 v2, v32, v33 offset0:0 offset1:160
  v_mov_b32 v50, v48
  v_mov_b32 v51, v49
  s_nop 0
  v_permlane32_swap_b32 v48, v50
  v_permlane32_swap_b32 v49, v51
  v_add_f32 v48, v48, v50
  v_add_f32 v49, v49, v51
  v_mov_b32 v50, v48
  v_mov_b32 v51, v49
  s_nop 0
  v_permlane16_swap_b32 v48, v50
  v_permlane16_swap_b32 v49, v51
  v_add_f32 v48, v48, v50
  v_add_f32 v49, v49, v51
  s_nop 1
  v_add_f32_dpp v48, v48, v48 row_ror:8 row_mask:0xf bank_mask:0xf
  v_add_f32_dpp v49, v49, v49 row_ror:8 row_mask:0xf bank_mask:0xf
  s_nop 1
  v_add_f32_dpp v48, v48, v48 row_ror:4 row_mask:0xf bank_mask:0xf
  v_add_f32_dpp v49, v49, v49 row_ror:4 row_mask:0xf bank_mask:0xf
  v_mul_f32 v48, 0x3a800000, v48
  v_mul_f32 v49, 0x3a800000, v49
  v_fma_f32 v49, -v48, v48, v49
  v_max_f32 v49, 0, v49
  v_add_f32 v49, 0x3727c5ac, v49
  v_rsq_f32 v49, v49
  s_nop 0
  s_lshl_b32 s5, s3, 4
  s_add_u32 s5, s5, 129024
  v_and_b32 v3, 3, v1
  v_lshl_add_u32 v2, v3, 2, s5
  ds_write2_b32 v2, v48, v49 offset0:0 offset1:160
  s_waitcnt lgkmcnt(0)
  s_barrier
L_attn_ldend:
  s_lshl_b32 s87, s97, 15
  s_lshl_b32 s4, s68, 11
  s_add_u32 s87, s87, s4
  s_lshl_b32 s4, s69, 2
  s_add_u32 s87, s87, s4
  s_add_u32 s97, s97, 1
  s_branch L_wo_body
L_attn_end:
  s_endpgm
.fill 853, 4, 0xbf810000
L_attn_compute:
  s_cmp_lg_u32 s96, 0
  s_cbranch_scc1 L_pfc1_skip
  s_getpc_b64 s[4:5]
L_pfc1:
  s_lshl_b32 s3, s99, 2
  s_add_u32 s3, s3, s70
  s_mul_i32 s3, s3, 320
  s_min_u32 s3, s3, L_w2_c1-L_attn_c0-320
  s_add_i32 s3, s3, L_attn_c0-L_pfc1
  s_ashr_i32 s6, s3, 31
  s_add_u32 s4, s4, s3
  s_addc_u32 s5, s5, s6
  s_load_dword s40, s[4:5], 0
  s_load_dword s40, s[4:5], 64
  s_load_dword s40, s[4:5], 128
  s_load_dword s40, s[4:5], 192
  s_load_dword s40, s[4:5], 256
L_pfc1_skip:
  s_and_b32 s71, s70, 1
  s_lshr_b32 s72, s70, 1
  v_and_b32 v3, 31, v1
  v_lshlrev_b32 v3, 2, v3
  v_add_u32 v3, 40960, v3
  v_mov_b32 v236, 0x3f803f80
  v_mov_b32 v237, 0x3f803f80
  v_mov_b32 v238, 0x3f803f80
  v_mov_b32 v239, 0x3f803f80
  ds_write_b32 v3, v236
  ds_write_b32 v3, v236 offset:43008
  v_add_u32 v3, 86016, v3
  ds_write_b32 v3, v236
  ds_write_b32 v3, v236 offset:3328
  v_and_b32 v3, 15, v1
  v_lshrrev_b32 v2, 4, v1
  v_lshrrev_b32 v33, 1, v3
  s_lshl_b32 s8, s71, 13
  v_xor_b32 v4, v2, v33
  v_lshlrev_b32 v4, 4, v4
  v_lshl_add_u32 v4, v3, 7, v4
  v_add_u32 v8, 40960, v4
  v_add_u32 v4, s8, v4
  v_add_u32 v5, 4, v2
  v_xor_b32 v5, v5, v33
  v_lshlrev_b32 v5, 4, v5
  v_lshl_add_u32 v5, v3, 7, v5
  v_add_u32 v9, 40960, v5
  v_add_u32 v5, s8, v5
  v_bfe_u32 v34, v1, 2, 2
  v_lshl_add_u32 v34, v2, 3, v34
  v_lshlrev_b32 v34, 7, v34
  v_and_b32 v33, 3, v1
  v_lshl_add_u32 v34, v33, 3, v34
  v_bfe_u32 v33, v1, 3, 2
  v_lshl_add_u32 v34, v33, 5, v34
  s_lshl_b32 s8, s70, 5
  v_xor_b32 v34, s8, v34
  v_add_u32 v6, 16384, v34
  v_xor_b32 v7, 32, v6
  s_mov_b32 s75, 0
  v_add_u32_e64 v10, s75, v4
  v_add_u32_e64 v11, s75, v5
  v_add_u32_e64 v12, s75, v6
  v_add_u32_e64 v13, s75, v7
  v_add_u32_e64 v14, s75, v8
  v_add_u32_e64 v15, s75, v9
  s_add_u32 s75, s75, 43008
  s_cmp_eq_u32 s75, 129024
  s_cselect_b32 s75, 0, s75
  s_mov_b32 vcc_hi, 0
  s_and_b32 s79, s69, 3
  s_add_u32 s79, s79, 1
  s_mul_i32 s98, s96, 2
  s_cmp_eq_u32 s96, 0
  s_cbranch_scc1 L_attn_nog
  s_mov_b32 s79, 14
  ds_read_b128 v[32:35], v10 offset:0
  ds_read_b128 v[36:39], v10 offset:2048
  ds_read_b128 v[40:43], v10 offset:4096
  ds_read_b128 v[44:47], v10 offset:6144
  ds_read_b64_tr_b16 v[52:53], v12 offset:0
  ds_read_b64_tr_b16 v[54:55], v12 offset:512
  ds_read_b64_tr_b16 v[56:57], v13 offset:0
  ds_read_b64_tr_b16 v[58:59], v13 offset:512
  ds_read_b64_tr_b16 v[60:61], v12 offset:8192
  ds_read_b64_tr_b16 v[62:63], v12 offset:8704
  ds_read_b64_tr_b16 v[64:65], v13 offset:8192
  ds_read_b64_tr_b16 v[66:67], v13 offset:8704
  ds_read_b64_tr_b16 v[68:69], v12 offset:16384
  ds_read_b64_tr_b16 v[70:71], v12 offset:16896
  ds_read_b64_tr_b16 v[72:73], v13 offset:16384
  ds_read_b64_tr_b16 v[74:75], v13 offset:16896
  s_waitcnt lgkmcnt(0)
  v_mfma_f32_16x16x32_bf16 v[128:131], v[52:55], v[32:35], 0
  ds_read_b128 v[76:79], v11 offset:0
  v_mfma_f32_16x16x32_bf16 v[132:135], v[52:55], v[36:39], 0
  ds_read_b128 v[80:83], v11 offset:2048
  v_mfma_f32_16x16x32_bf16 v[136:139], v[52:55], v[40:43], 0
  ds_read_b128 v[84:87], v11 offset:4096
  v_mfma_f32_16x16x32_bf16 v[140:143], v[52:55], v[44:47], 0
  ds_read_b128 v[88:91], v11 offset:6144
  v_mfma_f32_16x16x32_bf16 v[156:159], v[56:59], v[44:47], 0
  ds_read_b64_tr_b16 v[96:97], v12 offset:4096
  v_mfma_f32_16x16x32_bf16 v[152:155], v[56:59], v[40:43], 0
  ds_read_b64_tr_b16 v[98:99], v12 offset:4608
  v_mfma_f32_16x16x32_bf16 v[148:151], v[56:59], v[36:39], 0
  ds_read_b64_tr_b16 v[100:101], v13 offset:4096
  v_mfma_f32_16x16x32_bf16 v[144:147], v[56:59], v[32:35], 0
  ds_read_b64_tr_b16 v[102:103], v13 offset:4608
  v_mfma_f32_16x16x32_bf16 v[160:163], v[60:63], v[32:35], 0
  ds_read_b64_tr_b16 v[104:105], v12 offset:12288
  v_mfma_f32_16x16x32_bf16 v[164:167], v[60:63], v[36:39], 0
  ds_read_b64_tr_b16 v[106:107], v12 offset:12800
  v_mfma_f32_16x16x32_bf16 v[168:171], v[60:63], v[40:43], 0
  ds_read_b64_tr_b16 v[108:109], v13 offset:12288
  v_mfma_f32_16x16x32_bf16 v[172:175], v[60:63], v[44:47], 0
  ds_read_b64_tr_b16 v[110:111], v13 offset:12800
  v_mfma_f32_16x16x32_bf16 v[188:191], v[64:67], v[44:47], 0
  ds_read_b64_tr_b16 v[112:113], v12 offset:20480
  v_mfma_f32_16x16x32_bf16 v[184:187], v[64:67], v[40:43], 0
  ds_read_b64_tr_b16 v[114:115], v12 offset:20992
  v_mfma_f32_16x16x32_bf16 v[180:183], v[64:67], v[36:39], 0
  ds_read_b64_tr_b16 v[116:117], v13 offset:20480
  v_mfma_f32_16x16x32_bf16 v[176:179], v[64:67], v[32:35], 0
  ds_read_b64_tr_b16 v[118:119], v13 offset:20992
  v_mfma_f32_16x16x32_bf16 v[192:195], v[32:35], v[68:71], 0
  v_add_u32_e64 v10, s75, v4
  v_mfma_f32_16x16x32_bf16 v[196:199], v[36:39], v[68:71], 0
  v_add_u32_e64 v11, s75, v5
  v_mfma_f32_16x16x32_bf16 v[200:203], v[40:43], v[68:71], 0
  v_add_u32_e64 v12, s75, v6
  v_mfma_f32_16x16x32_bf16 v[204:207], v[44:47], v[68:71], 0
  v_add_u32_e64 v13, s75, v7
  v_mfma_f32_16x16x32_bf16 v[220:223], v[44:47], v[72:75], 0
  v_add_u32_e64 v14, s75, v8
  v_mfma_f32_16x16x32_bf16 v[216:219], v[40:43], v[72:75], 0
  v_add_u32_e64 v15, s75, v9
  v_mfma_f32_16x16x32_bf16 v[212:215], v[36:39], v[72:75], 0
  s_add_u32 s75, s75, 43008
  v_mfma_f32_16x16x32_bf16 v[208:211], v[32:35], v[72:75], 0
  s_cmp_eq_u32 s75, 129024
  s_cselect_b32 s75, 0, s75
  s_waitcnt lgkmcnt(0)
  v_mfma_f32_16x16x32_bf16 v[128:131], v[96:99], v[76:79], v[128:131]
  v_mfma_f32_16x16x32_bf16 v[132:135], v[96:99], v[80:83], v[132:135]
  v_mfma_f32_16x16x32_bf16 v[136:139], v[96:99], v[84:87], v[136:139]
  v_mfma_f32_16x16x32_bf16 v[140:143], v[96:99], v[88:91], v[140:143]
  v_mfma_f32_16x16x32_bf16 v[156:159], v[100:103], v[88:91], v[156:159]
  v_mfma_f32_16x16x32_bf16 v[152:155], v[100:103], v[84:87], v[152:155]
  v_mfma_f32_16x16x32_bf16 v[148:151], v[100:103], v[80:83], v[148:151]
  v_mfma_f32_16x16x32_bf16 v[144:147], v[100:103], v[76:79], v[144:147]
  v_mfma_f32_16x16x32_bf16 v[160:163], v[104:107], v[76:79], v[160:163]
  v_mfma_f32_16x16x32_bf16 v[164:167], v[104:107], v[80:83], v[164:167]
  v_mfma_f32_16x16x32_bf16 v[168:171], v[104:107], v[84:87], v[168:171]
  v_mfma_f32_16x16x32_bf16 v[172:175], v[104:107], v[88:91], v[172:175]
  v_mfma_f32_16x16x32_bf16 v[188:191], v[108:111], v[88:91], v[188:191]
  v_mfma_f32_16x16x32_bf16 v[184:187], v[108:111], v[84:87], v[184:187]
  v_mfma_f32_16x16x32_bf16 v[180:183], v[108:111], v[80:83], v[180:183]
  v_mfma_f32_16x16x32_bf16 v[176:179], v[108:111], v[76:79], v[176:179]
  v_mfma_f32_16x16x32_bf16 v[192:195], v[76:79], v[112:115], v[192:195]
  v_mfma_f32_16x16x32_bf16 v[196:199], v[80:83], v[112:115], v[196:199]
  v_mfma_f32_16x16x32_bf16 v[200:203], v[84:87], v[112:115], v[200:203]
  v_mfma_f32_16x16x32_bf16 v[204:207], v[88:91], v[112:115], v[204:207]
  v_mfma_f32_16x16x32_bf16 v[220:223], v[88:91], v[116:119], v[220:223]
  v_mfma_f32_16x16x32_bf16 v[216:219], v[84:87], v[116:119], v[216:219]
  v_mfma_f32_16x16x32_bf16 v[212:215], v[80:83], v[116:119], v[212:215]
  v_mfma_f32_16x16x32_bf16 v[208:211], v[76:79], v[116:119], v[208:211]
  s_barrier
  ds_read_b64_tr_b16 v[52:53], v12 offset:0
  ds_read_b64_tr_b16 v[54:55], v12 offset:512
  ds_read_b64_tr_b16 v[96:97], v12 offset:4096
  ds_read_b64_tr_b16 v[98:99], v12 offset:4608
  ds_read_b64_tr_b16 v[56:57], v13 offset:0
  ds_read_b64_tr_b16 v[58:59], v13 offset:512
  ds_read_b64_tr_b16 v[100:101], v13 offset:4096
  ds_read_b64_tr_b16 v[102:103], v13 offset:4608
  ds_read_b64_tr_b16 v[108:109], v13 offset:12288
  ds_read_b64_tr_b16 v[110:111], v13 offset:12800
  ds_read_b64_tr_b16 v[64:65], v13 offset:8192
  ds_read_b64_tr_b16 v[66:67], v13 offset:8704
L_attn_nog:
  v_and_b32 v35, 1, v2
  v_xor_b32 v35, s71, v35
  s_lshl_b32 s8, s68, 7
  s_lshl_b32 s9, s71, 6
  s_add_u32 s8, s8, s9
  s_mul_i32 s10, s8, 7
  s_lshl2_add_u32 s11, s69, s72
  s_add_u32 s10, s10, s11
  s_lshl_b32 s10, s10, 10
  v_lshl_add_u32 v31, v1, 4, s10
  s_mul_i32 s10, s72, 14336
  s_add_u32 s10, s10, 87040
  s_lshl_b32 s11, s71, 10
  s_add_u32 s4, s10, s11
  s_sub_u32 s5, s10, s11
  s_mul_i32 s6, s71, 6144
  v_lshl_add_u32 v16, v1, 4, s4
  v_add_u32 v17, s6, v16
  v_lshl_add_u32 v18, v1, 4, s5
  v_add_u32 v18, s6, v18
  v_lshl_add_u32 v19, v2, 8, s4
  v_lshl_add_u32 v20, v2, 8, s5
  v_lshl_add_u32 v21, v3, 4, s4
  v_lshl_add_u32 v22, v3, 4, s5
  s_lshl_b32 s10, s71, 8
  s_add_u32 s10, s10, 129024
  v_lshl_add_u32 v23, v3, 2, s10
  v_lshl_add_u32 v24, v2, 4, s10
  v_and_b32 v33, 1, v3
  v_cmp_eq_u32 s[48:49], 1, v33
  v_lshl_add_u32 v34, v2, 2, v33
  v_add_u32 v35, 2, v34
  v_cmp_gt_u32 s[50:51], v34, v3
  v_cmp_gt_u32 s[52:53], v35, v3
  v_mov_b32 v36, 0xffff
  v_mov_b32 v37, 0xffff0000
  v_cndmask_b32 v36, v36, v37, s[48:49]
  s_add_u32 s10, s10, 704
  v_lshl_add_u32 v34, v34, 2, s10
  v_lshl_add_u32 v35, v35, 2, s10
  v_subrev_u32 v38, 64, v34
  v_subrev_u32 v39, 64, v35
  v_cndmask_b32 v25, v34, v38, s[50:51]
  v_cndmask_b32 v26, v35, v39, s[52:53]
  v_cndmask_b32 v27, 0, v36, s[50:51]
  v_cndmask_b32 v29, 0, v36, s[52:53]
  v_xor_b32 v28, v27, v36
  v_xor_b32 v30, v29, v36
  s_cmp_eq_u32 s8, 0
  s_cselect_b64 s[54:55], s[50:51], 0
  s_cselect_b64 s[14:15], s[52:53], 0
  s_waitcnt lgkmcnt(0)
  s_add_u32 s56, s22, 23592960
  s_addc_u32 s57, s23, 0
  s_and_b32 s57, s57, 0xffff
  s_mov_b32 s58, 327680
  s_mov_b32 s59, 0x00020000
  s_cmp_lg_u32 s96, 0
  s_cbranch_scc1 L_attn_nozero
  v_mov_b32 v122, 0
  v_mov_b32 v123, 0
  v_mov_b32 v124, 0
  v_mov_b32 v125, 0
  v_mov_b32 v126, 0
  v_mov_b32 v127, 0
  v_mov_b32 v128, 0
  v_mov_b32 v129, 0
  v_mov_b32 v130, 0
  v_mov_b32 v131, 0
  v_mov_b32 v132, 0
  v_mov_b32 v133, 0
  v_mov_b32 v134, 0
  v_mov_b32 v135, 0
  v_mov_b32 v136, 0
  v_mov_b32 v137, 0
  v_mov_b32 v138, 0
  v_mov_b32 v139, 0
  v_mov_b32 v140, 0
  v_mov_b32 v141, 0
  v_mov_b32 v142, 0
  v_mov_b32 v143, 0
  v_mov_b32 v144, 0
  v_mov_b32 v145, 0
  v_mov_b32 v146, 0
  v_mov_b32 v147, 0
  v_mov_b32 v148, 0
  v_mov_b32 v149, 0
  v_mov_b32 v150, 0
  v_mov_b32 v151, 0
  v_mov_b32 v152, 0
  v_mov_b32 v153, 0
  v_mov_b32 v154, 0
  v_mov_b32 v155, 0
  v_mov_b32 v156, 0
  v_mov_b32 v157, 0
  v_mov_b32 v158, 0
  v_mov_b32 v159, 0
  v_mov_b32 v160, 0
  v_mov_b32 v161, 0
  v_mov_b32 v162, 0
  v_mov_b32 v163, 0
  v_mov_b32 v164, 0
  v_mov_b32 v165, 0
  v_mov_b32 v166, 0
  v_mov_b32 v167, 0
  v_mov_b32 v168, 0
  v_mov_b32 v169, 0
  v_mov_b32 v170, 0
  v_mov_b32 v171, 0
  v_mov_b32 v172, 0
  v_mov_b32 v173, 0
  v_mov_b32 v174, 0
  v_mov_b32 v175, 0
  v_mov_b32 v176, 0
  v_mov_b32 v177, 0
  v_mov_b32 v178, 0
  v_mov_b32 v179, 0
  v_mov_b32 v180, 0
  v_mov_b32 v181, 0
  v_mov_b32 v182, 0
  v_mov_b32 v183, 0
  v_mov_b32 v184, 0
  v_mov_b32 v185, 0
  v_mov_b32 v186, 0
  v_mov_b32 v187, 0
  v_mov_b32 v188, 0
  v_mov_b32 v189, 0
  v_mov_b32 v190, 0
  v_mov_b32 v191, 0
  v_mov_b32 v192, 0
  v_mov_b32 v193, 0
  v_mov_b32 v194, 0
  v_mov_b32 v195, 0
  v_mov_b32 v196, 0
  v_mov_b32 v197, 0
  v_mov_b32 v198, 0
  v_mov_b32 v199, 0
  v_mov_b32 v200, 0
  v_mov_b32 v201, 0
  v_mov_b32 v202, 0
  v_mov_b32 v203, 0
  v_mov_b32 v204, 0
  v_mov_b32 v205, 0
  v_mov_b32 v206, 0
  v_mov_b32 v207, 0
  v_mov_b32 v208, 0
  v_mov_b32 v209, 0
  v_mov_b32 v210, 0
  v_mov_b32 v211, 0
  v_mov_b32 v212, 0
  v_mov_b32 v213, 0
  v_mov_b32 v214, 0
  v_mov_b32 v215, 0
  v_mov_b32 v216, 0
  v_mov_b32 v217, 0
  v_mov_b32 v218, 0
  v_mov_b32 v219, 0
  v_mov_b32 v220, 0
  v_mov_b32 v221, 0
  v_mov_b32 v222, 0
  v_mov_b32 v223, 0
  v_mov_b32 v224, 0
  v_mov_b32 v225, 0
  v_mov_b32 v226, 0
  v_mov_b32 v227, 0
  v_mov_b32 v228, 0
  v_mov_b32 v229, 0
  v_mov_b32 v230, 0
  v_mov_b32 v231, 0
  v_mov_b32 v232, 0
  v_mov_b32 v233, 0
  v_mov_b32 v234, 0
  v_mov_b32 v235, 0
  s_waitcnt lgkmcnt(0)
  s_lshl_b32 s3, s72, 5
  s_add_u32 s3, s3, s8
  s_lshl_b32 s4, s69, 14
  s_lshl3_add_u32 s3, s3, s4
  v_lshrrev_b32 v121, 1, v2
  v_lshl_add_u32 v121, v121, 4, v3
  v_and_b32 v120, 1, v2
  v_lshl_add_u32 v121, v121, 1, v120
  v_lshl_add_u32 v120, v121, 2, s3
  s_add_u32 s60, s22, 41943040
  s_addc_u32 s61, s23, 0
  s_and_b32 s61, s61, 0xffff
  s_mov_b32 s62, 524288
  s_mov_b32 s63, 0x00020000
  s_lshl_b32 s3, s2, 11
  s_cmp_lg_u32 s70, 0
  s_cbranch_scc1 L_attn_noclr
  s_lshl_b32 s5, s68, 10
  s_add_u32 s4, s4, s5
  v_lshlrev_b32 v121, 4, v1
  v_mov_b32 v40, -1
  v_mov_b32 v41, -1
  v_mov_b32 v42, -1
  v_mov_b32 v43, -1
  buffer_store_dwordx4 v[40:43], v121, s[56:59], s4 offen sc1
  buffer_store_dwordx4 v[128:131], v121, s[60:63], s3 offen offset:0 sc1
  buffer_store_dwordx4 v[128:131], v121, s[60:63], s3 offen offset:1024 sc1
  v_mov_b32 v126, 1
L_attn_noclr:
  s_and_b32 s65, s65, 0xffff
  s_mov_b32 s66, 256
  s_mov_b32 s67, 0x00020000
  s_mov_b32 s7, 0x3f803f80
L_attn_nozero:
  s_waitcnt lgkmcnt(0)
  s_lshl4_add_u32 s3, s68, s69
  s_lshl2_add_u32 s3, s3, s70
  s_lshl2_add_u32 s3, s3, 0x4000
  v_lshl_add_u32 v121, v3, 16, v2
  v_add_lshl_u32 v121, v121, s3, 4
  s_mov_b32 s36, s16
  s_and_b32 s37, s17, 0xffff
  s_mov_b32 s38, 4194304
  s_mov_b32 s39, 0x00020000
  s_and_b32 s3, s2, 3
  s_and_b32 s4, s99, 3
  s_lshl2_add_u32 s3, s3, s4
  s_lshl2_add_u32 s3, s3, s70
  s_lshl_b32 s3, s3, 16
  s_bfe_u32 s4, s2, 0x10002
  s_lshr_b32 s5, s99, 2
  s_lshl1_add_u32 s4, s5, s4
  s_lshl_b32 s4, s4, 7
  s_add_u32 s42, s3, s4
  s_add_u32 s43, s42, 32768
  v_and_b32 v127, 15, v1
  v_lshlrev_b32 v33, 1, v1
  v_and_b32 v33, 32, v33
  v_lshl_add_u32 v127, v127, 11, v33
  v_lshrrev_b32 v33, 1, v1
  v_and_b32 v33, 16, v33
  v_add_u32 v127, v127, v33
  s_add_u32 s44, s34, 8439808
  s_addc_u32 s45, s35, 0
  s_and_b32 s45, s45, 0xffff
  s_mov_b32 s46, 14628864
  s_mov_b32 s47, 0x00020000
  s_cmp_eq_u32 s96, 0
  s_barrier
  s_cbranch_scc1 L_attn_first
  ds_read_b128 v[44:47], v14 offset:46336
  ds_read_b128 v[88:91], v15 offset:46336
  buffer_load_dwordx4 v[122:125], v121, s[56:59], 0 offen sc1
  ds_read_b128 v[48:51], v14
  ds_read_b128 v[92:95], v15
  ds_read_b128 v[76:79], v11 offset:0
  ds_read_b128 v[32:35], v10 offset:0
  ds_read_b128 v[80:83], v11 offset:2048
  ds_read_b128 v[36:39], v10 offset:2048
  ds_read_b128 v[84:87], v11 offset:4096
  ds_read_b128 v[40:43], v10 offset:4096
  s_waitcnt lgkmcnt(8)
  v_mfma_f32_16x16x32_bf16 v[228:231], v[60:63], v[44:47], 0
  v_mfma_f32_16x16x32_bf16 v[228:231], v[104:107], v[88:91], v[228:231]
  v_mfma_f32_16x16x32_bf16 v[232:235], v[44:47], v[68:71], 0
  v_mfma_f32_16x16x32_bf16 v[232:235], v[88:91], v[112:115], v[232:235]
  s_waitcnt lgkmcnt(0)
  s_branch L_attn_loop1
L_attn_first:
  ds_read_b64_tr_b16 v[52:53], v12 offset:0
  ds_read_b64_tr_b16 v[54:55], v12 offset:512
  ds_read_b64_tr_b16 v[96:97], v12 offset:4096
  ds_read_b64_tr_b16 v[98:99], v12 offset:4608
  ds_read_b64_tr_b16 v[56:57], v13 offset:0
  ds_read_b64_tr_b16 v[58:59], v13 offset:512
  ds_read_b64_tr_b16 v[100:101], v13 offset:4096
  ds_read_b64_tr_b16 v[102:103], v13 offset:4608
  ds_read_b64_tr_b16 v[108:109], v13 offset:12288
  ds_read_b64_tr_b16 v[110:111], v13 offset:12800
  ds_read_b64_tr_b16 v[64:65], v13 offset:8192
  ds_read_b64_tr_b16 v[66:67], v13 offset:8704
  ds_read_b128 v[48:51], v14
  ds_read_b128 v[92:95], v15
  ds_read_b128 v[76:79], v11 offset:0
  ds_read_b128 v[32:35], v10 offset:0
  ds_read_b128 v[80:83], v11 offset:2048
  ds_read_b128 v[36:39], v10 offset:2048
  ds_read_b128 v[84:87], v11 offset:4096
  ds_read_b128 v[40:43], v10 offset:4096
.p2align 5
  s_nop 0
  s_nop 0
  s_nop 0
  s_waitcnt lgkmcnt(0)
L_attn_loop:
  v_mfma_f32_16x16x32_bf16 v[224:227], v[52:55], v[48:51], v[224:227]
  v_mfma_f32_16x16x32_bf16 v[224:227], v[96:99], v[92:95], v[224:227]
L_attn_loop1:
  ds_read_b128 v[44:47], v10 offset:6144
  v_mfma_f32_16x16x32_bf16 v[128:131], v[96:99], v[76:79], v[128:131]
  ds_read_b128 v[88:91], v11 offset:6144
  v_mfma_f32_16x16x32_bf16 v[128:131], v[52:55], v[32:35], v[128:131]
  ds_read_b64_tr_b16 v[104:105], v12 offset:12288
  v_mfma_f32_16x16x32_bf16 v[144:147], v[56:59], v[32:35], v[144:147]
  ds_read_b64_tr_b16 v[106:107], v12 offset:12800
  v_mfma_f32_16x16x32_bf16 v[144:147], v[100:103], v[76:79], v[144:147]
  ds_read_b64_tr_b16 v[60:61], v12 offset:8192
  s_waitcnt lgkmcnt(7)
  s_nop 0
  v_mfma_f32_16x16x32_bf16 v[148:151], v[100:103], v[80:83], v[148:151]
  ds_read_b64_tr_b16 v[62:63], v12 offset:8704
  v_mfma_f32_16x16x32_bf16 v[148:151], v[56:59], v[36:39], v[148:151]
  ds_read_b64_tr_b16 v[68:69], v12 offset:16384
  v_mfma_f32_16x16x32_bf16 v[132:135], v[52:55], v[36:39], v[132:135]
  ds_read_b64_tr_b16 v[70:71], v12 offset:16896
  v_mfma_f32_16x16x32_bf16 v[132:135], v[96:99], v[80:83], v[132:135]
  ds_read_b64_tr_b16 v[112:113], v12 offset:20480
  s_waitcnt lgkmcnt(9)
  s_nop 0
  v_mfma_f32_16x16x32_bf16 v[136:139], v[96:99], v[84:87], v[136:139]
  ds_read_b64_tr_b16 v[114:115], v12 offset:20992
  v_mfma_f32_16x16x32_bf16 v[136:139], v[52:55], v[40:43], v[136:139]
  ds_read_b64_tr_b16 v[72:73], v13 offset:16384
  v_mfma_f32_16x16x32_bf16 v[152:155], v[56:59], v[40:43], v[152:155]
  ds_read_b64_tr_b16 v[74:75], v13 offset:16896
  v_mfma_f32_16x16x32_bf16 v[152:155], v[100:103], v[84:87], v[152:155]
  ds_read_b64_tr_b16 v[116:117], v13 offset:20480
  s_waitcnt lgkmcnt(11)
  s_nop 0
  v_mfma_f32_16x16x32_bf16 v[156:159], v[100:103], v[88:91], v[156:159]
  ds_read_b64_tr_b16 v[118:119], v13 offset:20992
  v_mfma_f32_16x16x32_bf16 v[156:159], v[56:59], v[44:47], v[156:159]
  v_add_u32_e64 v10, s75, v4
  v_mfma_f32_16x16x32_bf16 v[140:143], v[52:55], v[44:47], v[140:143]
  v_add_u32_e64 v11, s75, v5
  v_mfma_f32_16x16x32_bf16 v[140:143], v[96:99], v[88:91], v[140:143]
  v_add_u32_e64 v12, s75, v6
  v_mfma_f32_16x16x32_bf16 v[188:191], v[108:111], v[88:91], v[188:191]
  v_add_u32_e64 v13, s75, v7
  v_mfma_f32_16x16x32_bf16 v[188:191], v[64:67], v[44:47], v[188:191]
  v_add_u32_e64 v14, s75, v8
  v_mfma_f32_16x16x32_bf16 v[184:187], v[64:67], v[40:43], v[184:187]
  v_add_u32_e64 v15, s75, v9
  v_mfma_f32_16x16x32_bf16 v[184:187], v[108:111], v[84:87], v[184:187]
  s_add_u32 s75, s75, 43008
  v_mfma_f32_16x16x32_bf16 v[180:183], v[108:111], v[80:83], v[180:183]
  s_cmp_eq_u32 s75, 129024
  v_mfma_f32_16x16x32_bf16 v[180:183], v[64:67], v[36:39], v[180:183]
  s_cselect_b32 s75, 0, s75
  s_sub_u32 s79, s79, 1
  s_waitcnt lgkmcnt(0)
  s_barrier
  v_mfma_f32_16x16x32_bf16 v[176:179], v[64:67], v[32:35], v[176:179]
  ds_read_b64_tr_b16 v[52:53], v12 offset:0
  v_mfma_f32_16x16x32_bf16 v[176:179], v[108:111], v[76:79], v[176:179]
  ds_read_b64_tr_b16 v[54:55], v12 offset:512
  v_mfma_f32_16x16x32_bf16 v[160:163], v[104:107], v[76:79], v[160:163]
  ds_read_b64_tr_b16 v[96:97], v12 offset:4096
  v_mfma_f32_16x16x32_bf16 v[160:163], v[60:63], v[32:35], v[160:163]
  ds_read_b64_tr_b16 v[98:99], v12 offset:4608
  v_mfma_f32_16x16x32_bf16 v[164:167], v[60:63], v[36:39], v[164:167]
  ds_read_b64_tr_b16 v[56:57], v13 offset:0
  v_mfma_f32_16x16x32_bf16 v[164:167], v[104:107], v[80:83], v[164:167]
  ds_read_b64_tr_b16 v[58:59], v13 offset:512
  v_mfma_f32_16x16x32_bf16 v[168:171], v[104:107], v[84:87], v[168:171]
  ds_read_b64_tr_b16 v[100:101], v13 offset:4096
  v_mfma_f32_16x16x32_bf16 v[168:171], v[60:63], v[40:43], v[168:171]
  ds_read_b64_tr_b16 v[102:103], v13 offset:4608
  v_mfma_f32_16x16x32_bf16 v[172:175], v[60:63], v[44:47], v[172:175]
  ds_read_b64_tr_b16 v[108:109], v13 offset:12288
  v_mfma_f32_16x16x32_bf16 v[172:175], v[104:107], v[88:91], v[172:175]
  ds_read_b64_tr_b16 v[110:111], v13 offset:12800
  v_mfma_f32_16x16x32_bf16 v[228:231], v[104:107], v[92:95], v[228:231]
  ds_read_b64_tr_b16 v[64:65], v13 offset:8192
  v_mfma_f32_16x16x32_bf16 v[228:231], v[60:63], v[48:51], v[228:231]
  ds_read_b64_tr_b16 v[66:67], v13 offset:8704
  v_mfma_f32_16x16x32_bf16 v[232:235], v[48:51], v[68:71], v[232:235]
  ds_read_b128 v[48:51], v14
  v_mfma_f32_16x16x32_bf16 v[232:235], v[92:95], v[112:115], v[232:235]
  ds_read_b128 v[92:95], v15
  v_mfma_f32_16x16x32_bf16 v[192:195], v[76:79], v[112:115], v[192:195]
  s_cmp_lg_u32 s79, 0
  s_cselect_b32 vcc_lo, s96, 0
  v_mfma_f32_16x16x32_bf16 v[192:195], v[32:35], v[68:71], v[192:195]
  v_mfma_f32_16x16x32_bf16 v[208:211], v[32:35], v[72:75], v[208:211]
  ds_read_b128 v[32:35], v10 offset:0
  v_mfma_f32_16x16x32_bf16 v[208:211], v[76:79], v[116:119], v[208:211]
  ds_read_b128 v[76:79], v11 offset:0
  v_mfma_f32_16x16x32_bf16 v[212:215], v[80:83], v[116:119], v[212:215]
  v_mfma_f32_16x16x32_bf16 v[212:215], v[36:39], v[72:75], v[212:215]
  v_mfma_f32_16x16x32_bf16 v[196:199], v[36:39], v[68:71], v[196:199]
  ds_read_b128 v[36:39], v10 offset:2048
  v_mfma_f32_16x16x32_bf16 v[196:199], v[80:83], v[112:115], v[196:199]
  ds_read_b128 v[80:83], v11 offset:2048
  v_mfma_f32_16x16x32_bf16 v[200:203], v[84:87], v[112:115], v[200:203]
  v_mfma_f32_16x16x32_bf16 v[200:203], v[40:43], v[68:71], v[200:203]
  v_mfma_f32_16x16x32_bf16 v[216:219], v[40:43], v[72:75], v[216:219]
  ds_read_b128 v[40:43], v10 offset:4096
  v_mfma_f32_16x16x32_bf16 v[216:219], v[84:87], v[116:119], v[216:219]
  ds_read_b128 v[84:87], v11 offset:4096
  v_mfma_f32_16x16x32_bf16 v[220:223], v[88:91], v[116:119], v[220:223]
  v_mfma_f32_16x16x32_bf16 v[220:223], v[44:47], v[72:75], v[220:223]
  v_mfma_f32_16x16x32_bf16 v[204:207], v[44:47], v[68:71], v[204:207]
  v_mfma_f32_16x16x32_bf16 v[204:207], v[88:91], v[112:115], v[204:207]
  s_waitcnt lgkmcnt(4)
  s_cbranch_vccnz L_attn_loop1
  s_cbranch_scc1 L_attn_loop
L_attn_lend:
  s_add_u32 s98, s98, 1
  s_cmp_gt_u32 s98, 2
  s_cbranch_scc1 L_attn_exit
  s_cmp_lg_u32 s98, 1
  s_cbranch_scc1 L_attn_hook0
  s_mov_b32 s79, 1
  s_waitcnt lgkmcnt(0)
  s_cmp_lg_u32 s72, 0
  s_cbranch_scc1 L_attn_dot0
  v_dot2_f32_bf16 v122, v32, s7, v122
  v_dot2_f32_bf16 v123, v36, s7, v123
  v_dot2_f32_bf16 v124, v32, v32, v124
  v_dot2_f32_bf16 v125, v36, v36, v125
  v_dot2_f32_bf16 v122, v33, s7, v122
  v_dot2_f32_bf16 v123, v37, s7, v123
  v_dot2_f32_bf16 v124, v33, v33, v124
  v_dot2_f32_bf16 v125, v37, v37, v125
  v_dot2_f32_bf16 v122, v34, s7, v122
  v_dot2_f32_bf16 v123, v38, s7, v123
  v_dot2_f32_bf16 v124, v34, v34, v124
  v_dot2_f32_bf16 v125, v38, v38, v125
  v_dot2_f32_bf16 v122, v35, s7, v122
  v_dot2_f32_bf16 v123, v39, s7, v123
  v_dot2_f32_bf16 v124, v35, v35, v124
  v_dot2_f32_bf16 v125, v39, v39, v125
  v_dot2_f32_bf16 v122, v76, s7, v122
  v_dot2_f32_bf16 v123, v80, s7, v123
  v_dot2_f32_bf16 v124, v76, v76, v124
  v_dot2_f32_bf16 v125, v80, v80, v125
  v_dot2_f32_bf16 v122, v77, s7, v122
  v_dot2_f32_bf16 v123, v81, s7, v123
  v_dot2_f32_bf16 v124, v77, v77, v124
  v_dot2_f32_bf16 v125, v81, v81, v125
  v_dot2_f32_bf16 v122, v78, s7, v122
  v_dot2_f32_bf16 v123, v82, s7, v123
  v_dot2_f32_bf16 v124, v78, v78, v124
  v_dot2_f32_bf16 v125, v82, v82, v125
  v_dot2_f32_bf16 v122, v79, s7, v122
  v_dot2_f32_bf16 v123, v83, s7, v123
  v_dot2_f32_bf16 v124, v79, v79, v124
  v_dot2_f32_bf16 v125, v83, v83, v125
  s_branch L_attn_dote0
  L_attn_dot0:
  v_dot2_f32_bf16 v122, v40, s7, v122
  v_dot2_f32_bf16 v124, v40, v40, v124
  v_dot2_f32_bf16 v122, v41, s7, v122
  v_dot2_f32_bf16 v124, v41, v41, v124
  v_dot2_f32_bf16 v122, v42, s7, v122
  v_dot2_f32_bf16 v124, v42, v42, v124
  v_dot2_f32_bf16 v122, v43, s7, v122
  v_dot2_f32_bf16 v124, v43, v43, v124
  v_dot2_f32_bf16 v122, v84, s7, v122
  v_dot2_f32_bf16 v124, v84, v84, v124
  v_dot2_f32_bf16 v122, v85, s7, v122
  v_dot2_f32_bf16 v124, v85, v85, v124
  v_dot2_f32_bf16 v122, v86, s7, v122
  v_dot2_f32_bf16 v124, v86, v86, v124
  v_dot2_f32_bf16 v122, v87, s7, v122
  v_dot2_f32_bf16 v124, v87, v87, v124
  L_attn_dote0:
  s_cmp_lg_u32 s70, 0
  s_cbranch_scc1 L_attn_loop
  s_waitcnt vmcnt(0)
  s_lshl4_add_u32 s3, s68, s69
  s_mov_b64 exec, 1
  buffer_store_byte v126, off, s[64:67], s3 sc1
  s_mov_b64 exec, -1
  s_branch L_attn_loop
L_attn_hook0:
  s_and_b32 s79, s69, 3
  s_add_u32 s79, s79, 1
  s_sub_u32 s79, 14, s79
  s_cmp_eq_u32 s72, 0
  s_cbranch_scc1 L_attn_dot1
  v_dot2_f32_bf16 v123, v44, s7, v123
  v_dot2_f32_bf16 v125, v44, v44, v125
  v_dot2_f32_bf16 v123, v45, s7, v123
  v_dot2_f32_bf16 v125, v45, v45, v125
  v_dot2_f32_bf16 v123, v46, s7, v123
  v_dot2_f32_bf16 v125, v46, v46, v125
  v_dot2_f32_bf16 v123, v47, s7, v123
  v_dot2_f32_bf16 v125, v47, v47, v125
  v_dot2_f32_bf16 v123, v88, s7, v123
  v_dot2_f32_bf16 v125, v88, v88, v125
  v_dot2_f32_bf16 v123, v89, s7, v123
  v_dot2_f32_bf16 v125, v89, v89, v125
  v_dot2_f32_bf16 v123, v90, s7, v123
  v_dot2_f32_bf16 v125, v90, v90, v125
  v_dot2_f32_bf16 v123, v91, s7, v123
  v_dot2_f32_bf16 v125, v91, v91, v125
  L_attn_dot1:
  s_nop 2
  v_permlane32_swap_b32 v122, v123
  v_permlane32_swap_b32 v124, v125
  v_add_f32 v122, v122, v123
  v_add_f32 v124, v124, v125
  s_nop 0
  s_nop 0
  v_permlane16_swap_b32 v122, v124
  v_add_f32 v122, v122, v124
  buffer_store_dword v122, v120, s[56:59], 0 offen sc1
  s_branch L_attn_loop
L_attn_exit:
  v_mfma_f32_16x16x32_bf16 v[224:227], v[52:55], v[48:51], v[224:227]
  ds_read_b64_tr_b16 v[104:105], v12 offset:12288
  s_mul_i32 s3, s71, -32768
  v_mfma_f32_16x16x32_bf16 v[224:227], v[96:99], v[92:95], v[224:227]
  ds_read_b64_tr_b16 v[106:107], v12 offset:12800
  v_mfma_f32_16x16x32_bf16 v[128:131], v[96:99], v[76:79], v[128:131]
  ds_read_b64_tr_b16 v[60:61], v12 offset:8192
  v_mfma_f32_16x16x32_bf16 v[128:131], v[52:55], v[32:35], v[128:131]
  ds_read_b64_tr_b16 v[62:63], v12 offset:8704
  v_mfma_f32_16x16x32_bf16 v[144:147], v[56:59], v[32:35], v[144:147]
  ds_read_b128 v[44:47], v10 offset:6144
  v_mfma_f32_16x16x32_bf16 v[144:147], v[100:103], v[76:79], v[144:147]
  ds_read_b128 v[88:91], v11 offset:6144
  s_waitcnt lgkmcnt(8)
  v_mfma_f32_16x16x32_bf16 v[148:151], v[100:103], v[80:83], v[148:151]
  ds_read_b64_tr_b16 v[68:69], v12 offset:16384
  v_mfma_f32_16x16x32_bf16 v[148:151], v[56:59], v[36:39], v[148:151]
  ds_read_b64_tr_b16 v[70:71], v12 offset:16896
  v_add_u32 v10, s3, v16
  v_mfma_f32_16x16x32_bf16 v[132:135], v[52:55], v[36:39], v[132:135]
  ds_read_b64_tr_b16 v[112:113], v12 offset:20480
  v_mfma_f32_16x16x32_bf16 v[132:135], v[96:99], v[80:83], v[132:135]
  ds_read_b64_tr_b16 v[114:115], v12 offset:20992
  s_waitcnt lgkmcnt(10)
  v_mfma_f32_16x16x32_bf16 v[136:139], v[96:99], v[84:87], v[136:139]
  ds_read_b64_tr_b16 v[72:73], v13 offset:16384
  v_mfma_f32_16x16x32_bf16 v[136:139], v[52:55], v[40:43], v[136:139]
  ds_read_b64_tr_b16 v[74:75], v13 offset:16896
  v_mfma_f32_16x16x32_bf16 v[152:155], v[56:59], v[40:43], v[152:155]
  ds_read_b64_tr_b16 v[116:117], v13 offset:20480
  v_mfma_f32_16x16x32_bf16 v[152:155], v[100:103], v[84:87], v[152:155]
  ds_read_b64_tr_b16 v[118:119], v13 offset:20992
  s_waitcnt lgkmcnt(8)
  v_mfma_f32_16x16x32_bf16 v[228:231], v[104:107], v[92:95], v[228:231]
  v_mfma_f32_16x16x32_bf16 v[228:231], v[60:63], v[48:51], v[228:231]
  v_mfma_f32_16x16x32_bf16 v[172:175], v[60:63], v[44:47], v[172:175]
  v_mfma_f32_16x16x32_bf16 v[172:175], v[104:107], v[88:91], v[172:175]
  s_cmp_lg_u32 s96, 0
  s_waitcnt vmcnt(0)
  v_mfma_f32_16x16x32_bf16 v[188:191], v[108:111], v[88:91], v[188:191]
  s_cbranch_scc1 L_attn_nores
  buffer_load_dwordx4 v[240:243], v127, s[36:39], s42 offen offset:0
  buffer_load_dwordx4 v[244:247], v127, s[36:39], s42 offen offset:64
  buffer_load_dwordx4 v[248:251], v127, s[36:39], s43 offen offset:0
  buffer_load_dwordx4 v[252:255], v127, s[36:39], s43 offen offset:64
  buffer_store_dwordx4 v[224:227], v121, s[56:59], 0 offen sc1
  v_mov_b32 v122, v224
  v_mov_b32 v123, v225
  v_mov_b32 v124, v226
  v_mov_b32 v125, v227
  L_attn_nores:
  v_mfma_f32_16x16x32_bf16 v[188:191], v[64:67], v[44:47], v[188:191]
  s_waitcnt lgkmcnt(0)
  v_mfma_f32_16x16x32_bf16 v[232:235], v[48:51], v[68:71], v[232:235]
  ds_write_b128 v16, v[122:125]
  v_mfma_f32_16x16x32_bf16 v[232:235], v[92:95], v[112:115], v[232:235]
  v_mfma_f32_16x16x32_bf16 v[204:207], v[88:91], v[112:115], v[204:207]
  v_mfma_f32_16x16x32_bf16 v[204:207], v[44:47], v[68:71], v[204:207]
  v_mfma_f32_16x16x32_bf16 v[220:223], v[44:47], v[72:75], v[220:223]
  ds_write_b128 v16, v[228:231] offset:2048
  v_mfma_f32_16x16x32_bf16 v[220:223], v[88:91], v[116:119], v[220:223]
  v_mfma_f32_16x16x32_bf16 v[184:187], v[108:111], v[84:87], v[184:187]
  v_mfma_f32_16x16x32_bf16 v[184:187], v[64:67], v[40:43], v[184:187]
  v_mfma_f32_16x16x32_bf16 v[180:183], v[64:67], v[36:39], v[180:183]
  ds_write_b128 v10, v[172:175] offset:8192
  v_mfma_f32_16x16x32_bf16 v[180:183], v[108:111], v[80:83], v[180:183]
  v_mfma_f32_16x16x32_bf16 v[176:179], v[108:111], v[76:79], v[176:179]
  v_mfma_f32_16x16x32_bf16 v[176:179], v[64:67], v[32:35], v[176:179]
  v_mfma_f32_16x16x32_bf16 v[160:163], v[60:63], v[32:35], v[160:163]
  ds_write_b128 v10, v[188:191] offset:9216
  v_mfma_f32_16x16x32_bf16 v[160:163], v[104:107], v[76:79], v[160:163]
  v_mfma_f32_16x16x32_bf16 v[164:167], v[104:107], v[80:83], v[164:167]
  v_mfma_f32_16x16x32_bf16 v[164:167], v[60:63], v[36:39], v[164:167]
  v_mfma_f32_16x16x32_bf16 v[168:171], v[60:63], v[40:43], v[168:171]
  ds_write_b128 v16, v[232:235] offset:4096
  v_mfma_f32_16x16x32_bf16 v[168:171], v[104:107], v[84:87], v[168:171]
  v_mfma_f32_16x16x32_bf16 v[140:143], v[52:55], v[44:47], v[140:143]
  v_mfma_f32_16x16x32_bf16 v[156:159], v[56:59], v[44:47], v[156:159]
  v_mfma_f32_16x16x32_bf16 v[192:195], v[32:35], v[68:71], v[192:195]
  ds_write_b128 v10, v[204:207] offset:10240
  v_mfma_f32_16x16x32_bf16 v[208:211], v[32:35], v[72:75], v[208:211]
  v_mfma_f32_16x16x32_bf16 v[212:215], v[36:39], v[72:75], v[212:215]
  v_mfma_f32_16x16x32_bf16 v[196:199], v[36:39], v[68:71], v[196:199]
  v_mfma_f32_16x16x32_bf16 v[200:203], v[40:43], v[68:71], v[200:203]
  ds_write_b128 v10, v[220:223] offset:11264
  v_mfma_f32_16x16x32_bf16 v[216:219], v[40:43], v[72:75], v[216:219]
  s_waitcnt lgkmcnt(0)
  s_barrier
  v_mfma_f32_16x16x32_bf16 v[140:143], v[96:99], v[88:91], v[140:143]
  ds_read_b128 v[48:51], v19 offset:0
  ds_read_b128 v[52:55], v20 offset:1024
  v_mfma_f32_16x16x32_bf16 v[156:159], v[100:103], v[88:91], v[156:159]
  ds_read2_b32 v[68:69], v23 offset0:16 offset1:176
  ds_read_b128 v[56:59], v19 offset:2048
  v_mfma_f32_16x16x32_bf16 v[192:195], v[76:79], v[112:115], v[192:195]
  ds_read_b128 v[60:63], v20 offset:3072
  ds_read2_b32 v[70:71], v23 offset0:32 offset1:192
  v_mfma_f32_16x16x32_bf16 v[208:211], v[76:79], v[116:119], v[208:211]
  ds_read2_b32 v[72:73], v23 offset0:48 offset1:208
  ds_read2_b32 v[74:75], v23 offset0:64 offset1:224
  v_mfma_f32_16x16x32_bf16 v[212:215], v[80:83], v[116:119], v[212:215]
  ds_read2_b32 v[66:67], v23 offset0:0 offset1:160
  ds_read_b128 v[32:35], v17 offset:2048
  v_mfma_f32_16x16x32_bf16 v[196:199], v[80:83], v[112:115], v[196:199]
  ds_read_b128 v[36:39], v18 offset:3072
  ds_read_b128 v[40:43], v17 offset:4096
  v_mfma_f32_16x16x32_bf16 v[200:203], v[84:87], v[112:115], v[200:203]
  ds_read_b128 v[44:47], v18 offset:5120
  ds_read_b32 v64, v21 offset:4096
  v_mfma_f32_16x16x32_bf16 v[216:219], v[84:87], v[116:119], v[216:219]
  ds_read_b32 v65, v22 offset:5120
  ds_read2_b32 v[120:121], v25 offset0:0 offset1:16
  s_waitcnt lgkmcnt(11)
  v_pk_fma_f32 v[128:129], v[48:49], v[68:69], v[128:129] op_sel:[0,0,0] op_sel_hi:[1,0,1] neg_lo:[0,1,0] neg_hi:[0,1,0]
  v_pk_fma_f32 v[130:131], v[50:51], v[68:69], v[130:131] op_sel:[0,0,0] op_sel_hi:[1,0,1] neg_lo:[0,1,0] neg_hi:[0,1,0]
  v_pk_fma_f32 v[144:145], v[52:53], v[68:69], v[144:145] op_sel:[0,0,0] op_sel_hi:[1,0,1] neg_lo:[0,1,0] neg_hi:[0,1,0]
  v_pk_fma_f32 v[146:147], v[54:55], v[68:69], v[146:147] op_sel:[0,0,0] op_sel_hi:[1,0,1] neg_lo:[0,1,0] neg_hi:[0,1,0]
  v_cvt_pk_bf16_f32 v128, v128, v129
  v_cvt_pk_bf16_f32 v129, v130, v131
  v_cvt_pk_bf16_f32 v130, v144, v145
  v_cvt_pk_bf16_f32 v131, v146, v147
  ds_read2_b32 v[124:125], v26 offset0:0 offset1:16
  ds_read2_b32 v[122:123], v25 offset0:32 offset1:48
  ds_read2_b32 v[126:127], v26 offset0:32 offset1:48
  v_pk_fma_f32 v[160:161], v[56:57], v[68:69], v[160:161] op_sel:[0,0,0] op_sel_hi:[1,0,1] neg_lo:[0,1,0] neg_hi:[0,1,0]
  v_pk_fma_f32 v[162:163], v[58:59], v[68:69], v[162:163] op_sel:[0,0,0] op_sel_hi:[1,0,1] neg_lo:[0,1,0] neg_hi:[0,1,0]
  v_pk_fma_f32 v[176:177], v[60:61], v[68:69], v[176:177] op_sel:[0,0,0] op_sel_hi:[1,0,1] neg_lo:[0,1,0] neg_hi:[0,1,0]
  v_pk_fma_f32 v[178:179], v[62:63], v[68:69], v[178:179] op_sel:[0,0,0] op_sel_hi:[1,0,1] neg_lo:[0,1,0] neg_hi:[0,1,0]
  v_cvt_pk_bf16_f32 v160, v160, v161
  v_cvt_pk_bf16_f32 v161, v162, v163
  v_cvt_pk_bf16_f32 v162, v176, v177
  v_cvt_pk_bf16_f32 v163, v178, v179
  s_waitcnt lgkmcnt(11)
  ds_read_b128 v[76:79], v24 offset:0
  ds_read_b128 v[96:99], v24 offset:640
  ds_read_b128 v[80:83], v24 offset:64
  v_pk_fma_f32 v[132:133], v[48:49], v[70:71], v[132:133] op_sel:[0,0,0] op_sel_hi:[1,0,1] neg_lo:[0,1,0] neg_hi:[0,1,0]
  v_pk_fma_f32 v[134:135], v[50:51], v[70:71], v[134:135] op_sel:[0,0,0] op_sel_hi:[1,0,1] neg_lo:[0,1,0] neg_hi:[0,1,0]
  v_pk_fma_f32 v[148:149], v[52:53], v[70:71], v[148:149] op_sel:[0,0,0] op_sel_hi:[1,0,1] neg_lo:[0,1,0] neg_hi:[0,1,0]
  v_pk_fma_f32 v[150:151], v[54:55], v[70:71], v[150:151] op_sel:[0,0,0] op_sel_hi:[1,0,1] neg_lo:[0,1,0] neg_hi:[0,1,0]
  v_mfma_f32_16x16x32_bf16 v[144:147], v[160:163], v[128:131], 0
  v_cvt_pk_bf16_f32 v132, v132, v133
  v_cvt_pk_bf16_f32 v133, v134, v135
  v_cvt_pk_bf16_f32 v134, v148, v149
  v_cvt_pk_bf16_f32 v135, v150, v151
  ds_read_b128 v[100:103], v24 offset:704
  ds_read_b128 v[84:87], v24 offset:128
  ds_read_b128 v[104:107], v24 offset:768
  v_pk_fma_f32 v[164:165], v[56:57], v[70:71], v[164:165] op_sel:[0,0,0] op_sel_hi:[1,0,1] neg_lo:[0,1,0] neg_hi:[0,1,0]
  v_pk_fma_f32 v[166:167], v[58:59], v[70:71], v[166:167] op_sel:[0,0,0] op_sel_hi:[1,0,1] neg_lo:[0,1,0] neg_hi:[0,1,0]
  v_pk_fma_f32 v[180:181], v[60:61], v[70:71], v[180:181] op_sel:[0,0,0] op_sel_hi:[1,0,1] neg_lo:[0,1,0] neg_hi:[0,1,0]
  v_pk_fma_f32 v[182:183], v[62:63], v[70:71], v[182:183] op_sel:[0,0,0] op_sel_hi:[1,0,1] neg_lo:[0,1,0] neg_hi:[0,1,0]
  v_mfma_f32_16x16x32_bf16 v[176:179], v[160:163], v[132:135], 0
  v_cvt_pk_bf16_f32 v164, v164, v165
  v_cvt_pk_bf16_f32 v165, v166, v167
  v_cvt_pk_bf16_f32 v166, v180, v181
  v_cvt_pk_bf16_f32 v167, v182, v183
  ds_read_b128 v[88:91], v24 offset:192
  ds_read_b128 v[108:111], v24 offset:832
  ds_read_b128 v[92:95], v24 offset:256
  v_pk_fma_f32 v[136:137], v[48:49], v[72:73], v[136:137] op_sel:[0,0,0] op_sel_hi:[1,0,1] neg_lo:[0,1,0] neg_hi:[0,1,0]
  v_pk_fma_f32 v[138:139], v[50:51], v[72:73], v[138:139] op_sel:[0,0,0] op_sel_hi:[1,0,1] neg_lo:[0,1,0] neg_hi:[0,1,0]
  v_pk_fma_f32 v[152:153], v[52:53], v[72:73], v[152:153] op_sel:[0,0,0] op_sel_hi:[1,0,1] neg_lo:[0,1,0] neg_hi:[0,1,0]
  v_pk_fma_f32 v[154:155], v[54:55], v[72:73], v[154:155] op_sel:[0,0,0] op_sel_hi:[1,0,1] neg_lo:[0,1,0] neg_hi:[0,1,0]
  v_mfma_f32_16x16x32_bf16 v[148:151], v[164:167], v[132:135], 0
  v_cvt_pk_bf16_f32 v136, v136, v137
  v_cvt_pk_bf16_f32 v137, v138, v139
  v_cvt_pk_bf16_f32 v138, v152, v153
  v_cvt_pk_bf16_f32 v139, v154, v155
  ds_read_b128 v[112:115], v24 offset:896
  v_pk_fma_f32 v[168:169], v[56:57], v[72:73], v[168:169] op_sel:[0,0,0] op_sel_hi:[1,0,1] neg_lo:[0,1,0] neg_hi:[0,1,0]
  v_pk_fma_f32 v[170:171], v[58:59], v[72:73], v[170:171] op_sel:[0,0,0] op_sel_hi:[1,0,1] neg_lo:[0,1,0] neg_hi:[0,1,0]
  v_pk_fma_f32 v[184:185], v[60:61], v[72:73], v[184:185] op_sel:[0,0,0] op_sel_hi:[1,0,1] neg_lo:[0,1,0] neg_hi:[0,1,0]
  v_pk_fma_f32 v[186:187], v[62:63], v[72:73], v[186:187] op_sel:[0,0,0] op_sel_hi:[1,0,1] neg_lo:[0,1,0] neg_hi:[0,1,0]
  v_mfma_f32_16x16x32_bf16 v[180:183], v[164:167], v[136:139], 0
  v_cvt_pk_bf16_f32 v168, v168, v169
  v_cvt_pk_bf16_f32 v169, v170, v171
  v_cvt_pk_bf16_f32 v170, v184, v185
  v_cvt_pk_bf16_f32 v171, v186, v187
  v_pk_fma_f32 v[140:141], v[48:49], v[74:75], v[140:141] op_sel:[0,0,0] op_sel_hi:[1,0,1] neg_lo:[0,1,0] neg_hi:[0,1,0]
  v_pk_fma_f32 v[142:143], v[50:51], v[74:75], v[142:143] op_sel:[0,0,0] op_sel_hi:[1,0,1] neg_lo:[0,1,0] neg_hi:[0,1,0]
  v_pk_fma_f32 v[156:157], v[52:53], v[74:75], v[156:157] op_sel:[0,0,0] op_sel_hi:[1,0,1] neg_lo:[0,1,0] neg_hi:[0,1,0]
  v_pk_fma_f32 v[158:159], v[54:55], v[74:75], v[158:159] op_sel:[0,0,0] op_sel_hi:[1,0,1] neg_lo:[0,1,0] neg_hi:[0,1,0]
  v_mfma_f32_16x16x32_bf16 v[152:155], v[168:171], v[136:139], 0
  v_cvt_pk_bf16_f32 v140, v140, v141
  v_cvt_pk_bf16_f32 v141, v142, v143
  v_cvt_pk_bf16_f32 v142, v156, v157
  v_cvt_pk_bf16_f32 v143, v158, v159
  v_pk_fma_f32 v[172:173], v[56:57], v[74:75], v[172:173] op_sel:[0,0,0] op_sel_hi:[1,0,1] neg_lo:[0,1,0] neg_hi:[0,1,0]
  v_pk_fma_f32 v[174:175], v[58:59], v[74:75], v[174:175] op_sel:[0,0,0] op_sel_hi:[1,0,1] neg_lo:[0,1,0] neg_hi:[0,1,0]
  v_pk_fma_f32 v[188:189], v[60:61], v[74:75], v[188:189] op_sel:[0,0,0] op_sel_hi:[1,0,1] neg_lo:[0,1,0] neg_hi:[0,1,0]
  v_pk_fma_f32 v[190:191], v[62:63], v[74:75], v[190:191] op_sel:[0,0,0] op_sel_hi:[1,0,1] neg_lo:[0,1,0] neg_hi:[0,1,0]
  v_mfma_f32_16x16x32_bf16 v[184:187], v[168:171], v[140:143], 0
  v_cvt_pk_bf16_f32 v172, v172, v173
  v_cvt_pk_bf16_f32 v173, v174, v175
  v_cvt_pk_bf16_f32 v174, v188, v189
  v_cvt_pk_bf16_f32 v175, v190, v191
  s_waitcnt lgkmcnt(0)
  v_pk_fma_f32 v[32:33], v[56:57], v[66:67], v[32:33] op_sel:[0,0,0] op_sel_hi:[1,0,1] neg_lo:[0,1,0] neg_hi:[0,1,0]
  v_pk_fma_f32 v[34:35], v[58:59], v[66:67], v[34:35] op_sel:[0,0,0] op_sel_hi:[1,0,1] neg_lo:[0,1,0] neg_hi:[0,1,0]
  v_pk_fma_f32 v[36:37], v[60:61], v[66:67], v[36:37] op_sel:[0,0,0] op_sel_hi:[1,0,1] neg_lo:[0,1,0] neg_hi:[0,1,0]
  v_pk_fma_f32 v[38:39], v[62:63], v[66:67], v[38:39] op_sel:[0,0,0] op_sel_hi:[1,0,1] neg_lo:[0,1,0] neg_hi:[0,1,0]
  v_mfma_f32_16x16x32_bf16 v[156:159], v[172:175], v[140:143], 0
  v_cvt_pk_bf16_f32 v32, v32, v33
  v_cvt_pk_bf16_f32 v33, v34, v35
  v_cvt_pk_bf16_f32 v34, v36, v37
  v_cvt_pk_bf16_f32 v35, v38, v39
  v_mul_f32 v69, 0x3e8293ee, v69
  v_mul_f32 v71, 0x3e8293ee, v71
  v_mfma_f32_16x16x32_bf16 v[188:191], v[32:35], v[128:131], 0
  v_mul_f32 v73, 0x3e8293ee, v73
  v_mul_f32 v75, 0x3e8293ee, v75
  v_mul_f32 v120, v120, v69
  v_mul_f32 v124, v124, v69
  v_mul_f32 v121, v121, v71
  v_mul_f32 v125, v125, v71
  v_mul_f32 v122, v122, v73
  v_mul_f32 v126, v126, v73
  v_mul_f32 v123, v123, v75
  v_mul_f32 v127, v127, v75
  v_pk_fma_f32 v[40:41], v[76:77], v[64:65], v[40:41] op_sel:[0,0,0] op_sel_hi:[1,0,1] neg_lo:[1,0,0] neg_hi:[1,0,0]
  v_pk_fma_f32 v[42:43], v[78:79], v[64:65], v[42:43] op_sel:[0,0,0] op_sel_hi:[1,0,1] neg_lo:[1,0,0] neg_hi:[1,0,0]
  v_pk_mul_f32 v[40:41], v[40:41], v[96:97]
  v_pk_mul_f32 v[42:43], v[42:43], v[98:99]
  v_cvt_pk_bf16_f32 v4, v40, v41
  v_cvt_pk_bf16_f32 v5, v42, v43
  v_pk_fma_f32 v[192:193], v[80:81], v[64:65], v[192:193] op_sel:[0,0,0] op_sel_hi:[1,0,1] neg_lo:[1,0,0] neg_hi:[1,0,0]
  v_pk_fma_f32 v[194:195], v[82:83], v[64:65], v[194:195] op_sel:[0,0,0] op_sel_hi:[1,0,1] neg_lo:[1,0,0] neg_hi:[1,0,0]
  v_pk_mul_f32 v[192:193], v[192:193], v[100:101]
  v_pk_mul_f32 v[194:195], v[194:195], v[102:103]
  v_cvt_pk_bf16_f32 v6, v192, v193
  v_cvt_pk_bf16_f32 v7, v194, v195
  v_pk_fma_f32 v[196:197], v[84:85], v[64:65], v[196:197] op_sel:[0,0,0] op_sel_hi:[1,0,1] neg_lo:[1,0,0] neg_hi:[1,0,0]
  v_pk_fma_f32 v[198:199], v[86:87], v[64:65], v[198:199] op_sel:[0,0,0] op_sel_hi:[1,0,1] neg_lo:[1,0,0] neg_hi:[1,0,0]
  v_pk_mul_f32 v[196:197], v[196:197], v[104:105]
  v_pk_mul_f32 v[198:199], v[198:199], v[106:107]
  v_cvt_pk_bf16_f32 v8, v196, v197
  v_cvt_pk_bf16_f32 v9, v198, v199
  v_pk_fma_f32 v[200:201], v[88:89], v[64:65], v[200:201] op_sel:[0,0,0] op_sel_hi:[1,0,1] neg_lo:[1,0,0] neg_hi:[1,0,0]
  v_pk_fma_f32 v[202:203], v[90:91], v[64:65], v[202:203] op_sel:[0,0,0] op_sel_hi:[1,0,1] neg_lo:[1,0,0] neg_hi:[1,0,0]
  v_pk_mul_f32 v[200:201], v[200:201], v[108:109]
  v_pk_mul_f32 v[202:203], v[202:203], v[110:111]
  v_cvt_pk_bf16_f32 v10, v200, v201
  v_cvt_pk_bf16_f32 v11, v202, v203
  v_pk_fma_f32 v[204:205], v[92:93], v[64:65], v[204:205] op_sel:[0,0,0] op_sel_hi:[1,0,1] neg_lo:[1,0,0] neg_hi:[1,0,0]
  v_pk_fma_f32 v[206:207], v[94:95], v[64:65], v[206:207] op_sel:[0,0,0] op_sel_hi:[1,0,1] neg_lo:[1,0,0] neg_hi:[1,0,0]
  v_pk_mul_f32 v[204:205], v[204:205], v[112:113]
  v_pk_mul_f32 v[206:207], v[206:207], v[114:115]
  v_cvt_pk_bf16_f32 v12, v204, v205
  v_cvt_pk_bf16_f32 v13, v206, v207
  v_pk_fma_f32 v[44:45], v[76:77], v[64:65], v[44:45] op_sel:[0,1,0] op_sel_hi:[1,1,1] neg_lo:[1,0,0] neg_hi:[1,0,0]
  v_pk_fma_f32 v[46:47], v[78:79], v[64:65], v[46:47] op_sel:[0,1,0] op_sel_hi:[1,1,1] neg_lo:[1,0,0] neg_hi:[1,0,0]
  v_pk_mul_f32 v[44:45], v[44:45], v[96:97]
  v_pk_mul_f32 v[46:47], v[46:47], v[98:99]
  v_cvt_pk_bf16_f32 v224, v44, v45
  v_cvt_pk_bf16_f32 v225, v46, v47
  v_pk_fma_f32 v[208:209], v[80:81], v[64:65], v[208:209] op_sel:[0,1,0] op_sel_hi:[1,1,1] neg_lo:[1,0,0] neg_hi:[1,0,0]
  v_pk_fma_f32 v[210:211], v[82:83], v[64:65], v[210:211] op_sel:[0,1,0] op_sel_hi:[1,1,1] neg_lo:[1,0,0] neg_hi:[1,0,0]
  v_pk_mul_f32 v[208:209], v[208:209], v[100:101]
  v_pk_mul_f32 v[210:211], v[210:211], v[102:103]
  v_cvt_pk_bf16_f32 v226, v208, v209
  v_cvt_pk_bf16_f32 v227, v210, v211
  v_pk_fma_f32 v[212:213], v[84:85], v[64:65], v[212:213] op_sel:[0,1,0] op_sel_hi:[1,1,1] neg_lo:[1,0,0] neg_hi:[1,0,0]
  v_pk_fma_f32 v[214:215], v[86:87], v[64:65], v[214:215] op_sel:[0,1,0] op_sel_hi:[1,1,1] neg_lo:[1,0,0] neg_hi:[1,0,0]
  v_pk_mul_f32 v[212:213], v[212:213], v[104:105]
  v_pk_mul_f32 v[214:215], v[214:215], v[106:107]
  v_cvt_pk_bf16_f32 v228, v212, v213
  v_cvt_pk_bf16_f32 v229, v214, v215
  v_cndmask_b32 v148, v148, v149, s[48:49]
  v_cndmask_b32 v176, v176, v177, s[48:49]
  v_cndmask_b32 v150, v150, v151, s[48:49]
  v_cndmask_b32 v178, v178, v179, s[48:49]
  v_cndmask_b32 v36, v148, v176, s[50:51]
  v_cndmask_b32 v37, v150, v178, s[52:53]
  v_mul_f32 v36, v36, v121
  v_mul_f32 v37, v37, v125
  v_cndmask_b32 v152, v152, v153, s[48:49]
  v_cndmask_b32 v180, v180, v181, s[48:49]
  v_cndmask_b32 v154, v154, v155, s[48:49]
  v_cndmask_b32 v182, v182, v183, s[48:49]
  v_cndmask_b32 v40, v152, v180, s[50:51]
  v_cndmask_b32 v41, v154, v182, s[52:53]
  v_mul_f32 v40, v40, v122
  v_mul_f32 v41, v41, v126
  v_cndmask_b32 v156, v156, v157, s[48:49]
  v_cndmask_b32 v184, v184, v185, s[48:49]
  v_cndmask_b32 v158, v158, v159, s[48:49]
  v_cndmask_b32 v186, v186, v187, s[48:49]
  v_cndmask_b32 v44, v156, v184, s[50:51]
  v_cndmask_b32 v45, v158, v186, s[52:53]
  v_mul_f32 v44, v44, v123
  v_mul_f32 v45, v45, v127
  v_cndmask_b32 v144, v144, v145, s[48:49]
  v_cndmask_b32 v188, v188, v189, s[48:49]
  v_cndmask_b32 v146, v146, v147, s[48:49]
  v_cndmask_b32 v190, v190, v191, s[48:49]
  v_cndmask_b32 v32, v144, v188, s[50:51]
  v_cndmask_b32 v33, v146, v190, s[52:53]
  v_mul_f32 v32, v32, v120
  v_mul_f32 v33, v33, v124
  v_mov_b32 v48, 0xceabfb8f
  v_cndmask_b32 v32, v32, v48, s[54:55]
  v_cndmask_b32 v33, v33, v48, s[14:15]
  v_max_f32 v42, v40, v41
  v_max_f32 v46, v44, v45
  v_max_f32 v38, v36, v37
  v_max_f32 v34, v32, v33
  v_permlane32_swap_b32 v42, v46
  v_pk_fma_f32 v[216:217], v[88:89], v[64:65], v[216:217] op_sel:[0,1,0] op_sel_hi:[1,1,1] neg_lo:[1,0,0] neg_hi:[1,0,0]
  v_permlane32_swap_b32 v34, v38
  v_max_f32 v42, v42, v46
  v_max_f32 v34, v34, v38
  v_pk_fma_f32 v[218:219], v[90:91], v[64:65], v[218:219] op_sel:[0,1,0] op_sel_hi:[1,1,1] neg_lo:[1,0,0] neg_hi:[1,0,0]
  v_pk_mul_f32 v[216:217], v[216:217], v[108:109]
  v_permlane16_swap_b32 v34, v42
  v_pk_mul_f32 v[218:219], v[218:219], v[110:111]
  v_max_f32 v38, v34, v42
  v_max_f32 v46, v34, v42
  v_cvt_pk_bf16_f32 v230, v216, v217
  v_cvt_pk_bf16_f32 v231, v218, v219
  v_permlane16_swap_b32 v38, v46
  v_pk_fma_f32 v[220:221], v[92:93], v[64:65], v[220:221] op_sel:[0,1,0] op_sel_hi:[1,1,1] neg_lo:[1,0,0] neg_hi:[1,0,0]
  v_mov_b32 v34, v38
  v_mov_b32 v42, v46
  v_pk_fma_f32 v[222:223], v[94:95], v[64:65], v[222:223] op_sel:[0,1,0] op_sel_hi:[1,1,1] neg_lo:[1,0,0] neg_hi:[1,0,0]
  v_permlane32_swap_b32 v34, v38
  v_permlane32_swap_b32 v42, v46
  v_pk_mul_f32 v[220:221], v[220:221], v[112:113]
  v_pk_mul_f32 v[222:223], v[222:223], v[114:115]
  v_cvt_pk_bf16_f32 v232, v220, v221
  v_cvt_pk_bf16_f32 v233, v222, v223
  v_sub_f32 v32, v32, v34
  v_sub_f32 v33, v33, v34
  v_exp_f32 v32, v32
  v_exp_f32 v33, v33
  s_nop 0
  v_cvt_pk_bf16_f32 v32, v32, v32
  v_cvt_pk_bf16_f32 v33, v33, v33
  v_and_b32 v128, v32, v27
  v_and_b32 v129, v33, v29
  v_and_b32 v130, v32, v28
  v_and_b32 v131, v33, v30
  v_sub_f32 v36, v36, v38
  v_sub_f32 v37, v37, v38
  v_mfma_f32_16x16x32_bf16 v[144:147], v[236:239], v[128:131], 0
  v_exp_f32 v36, v36
  v_exp_f32 v37, v37
  v_mfma_f32_16x16x32_bf16 v[192:195], v[4:7], v[128:131], 0
  v_cvt_pk_bf16_f32 v36, v36, v36
  v_cvt_pk_bf16_f32 v37, v37, v37
  v_and_b32 v132, v36, v27
  v_mfma_f32_16x16x32_bf16 v[208:211], v[224:227], v[128:131], 0
  v_and_b32 v133, v37, v29
  v_and_b32 v134, v36, v28
  v_and_b32 v135, v37, v30
  v_sub_f32 v40, v40, v42
  v_sub_f32 v41, v41, v42
  v_mfma_f32_16x16x32_bf16 v[148:151], v[236:239], v[132:135], 0
  v_exp_f32 v40, v40
  v_exp_f32 v41, v41
  v_mfma_f32_16x16x32_bf16 v[196:199], v[6:9], v[132:135], 0
  v_cvt_pk_bf16_f32 v40, v40, v40
  v_cvt_pk_bf16_f32 v41, v41, v41
  v_and_b32 v136, v40, v27
  v_mfma_f32_16x16x32_bf16 v[212:215], v[226:229], v[132:135], 0
  v_and_b32 v137, v41, v29
  v_and_b32 v138, v40, v28
  v_and_b32 v139, v41, v30
  v_sub_f32 v44, v44, v46
  v_sub_f32 v45, v45, v46
  v_mfma_f32_16x16x32_bf16 v[152:155], v[236:239], v[136:139], 0
  v_exp_f32 v44, v44
  v_exp_f32 v45, v45
  v_mfma_f32_16x16x32_bf16 v[200:203], v[8:11], v[136:139], 0
  v_cvt_pk_bf16_f32 v44, v44, v44
  v_cvt_pk_bf16_f32 v45, v45, v45
  v_and_b32 v140, v44, v27
  v_mfma_f32_16x16x32_bf16 v[216:219], v[228:231], v[136:139], 0
  v_and_b32 v141, v45, v29
  v_and_b32 v142, v44, v28
  v_and_b32 v143, v45, v30
  v_rcp_f32 v144, v144
  s_cmp_eq_u32 s71, 1
  v_mfma_f32_16x16x32_bf16 v[156:159], v[236:239], v[140:143], 0
  v_rcp_f32 v148, v148
  v_mfma_f32_16x16x32_bf16 v[204:207], v[10:13], v[140:143], 0
  v_rcp_f32 v152, v152
  v_mfma_f32_16x16x32_bf16 v[220:223], v[230:233], v[140:143], 0
  s_cbranch_scc1 L_attn_out1
  s_mov_b32 s3, 0
  v_pk_mul_f32 v[192:193], v[192:193], v[144:145] op_sel_hi:[1,0]
  v_pk_mul_f32 v[194:195], v[194:195], v[144:145] op_sel_hi:[1,0]
  v_pk_mul_f32 v[208:209], v[208:209], v[144:145] op_sel_hi:[1,0]
  v_pk_mul_f32 v[210:211], v[210:211], v[144:145] op_sel_hi:[1,0]
  v_cvt_pk_bf16_f32 v48, v192, v193
  v_cvt_pk_bf16_f32 v49, v194, v195
  v_cvt_pk_bf16_f32 v50, v208, v209
  v_cvt_pk_bf16_f32 v51, v210, v211
  buffer_store_dwordx4 v[48:51], v31, s[44:47], s3 offen sc1
  v_rcp_f32 v156, v156
  s_mov_b32 s3, 114688
  v_pk_mul_f32 v[196:197], v[196:197], v[148:149] op_sel_hi:[1,0]
  v_pk_mul_f32 v[198:199], v[198:199], v[148:149] op_sel_hi:[1,0]
  v_pk_mul_f32 v[212:213], v[212:213], v[148:149] op_sel_hi:[1,0]
  v_pk_mul_f32 v[214:215], v[214:215], v[148:149] op_sel_hi:[1,0]
  v_cvt_pk_bf16_f32 v52, v196, v197
  v_cvt_pk_bf16_f32 v53, v198, v199
  v_cvt_pk_bf16_f32 v54, v212, v213
  v_cvt_pk_bf16_f32 v55, v214, v215
  buffer_store_dwordx4 v[52:55], v31, s[44:47], s3 offen sc1
  s_mov_b32 s3, 229376
  v_pk_mul_f32 v[200:201], v[200:201], v[152:153] op_sel_hi:[1,0]
  v_pk_mul_f32 v[202:203], v[202:203], v[152:153] op_sel_hi:[1,0]
  v_pk_mul_f32 v[216:217], v[216:217], v[152:153] op_sel_hi:[1,0]
  v_pk_mul_f32 v[218:219], v[218:219], v[152:153] op_sel_hi:[1,0]
  v_cvt_pk_bf16_f32 v56, v200, v201
  v_cvt_pk_bf16_f32 v57, v202, v203
  v_cvt_pk_bf16_f32 v58, v216, v217
  v_cvt_pk_bf16_f32 v59, v218, v219
  buffer_store_dwordx4 v[56:59], v31, s[44:47], s3 offen sc1
  s_mov_b32 s3, 344064
  v_pk_mul_f32 v[204:205], v[204:205], v[156:157] op_sel_hi:[1,0]
  v_pk_mul_f32 v[206:207], v[206:207], v[156:157] op_sel_hi:[1,0]
  v_pk_mul_f32 v[220:221], v[220:221], v[156:157] op_sel_hi:[1,0]
  v_pk_mul_f32 v[222:223], v[222:223], v[156:157] op_sel_hi:[1,0]
  v_cvt_pk_bf16_f32 v60, v204, v205
  v_cvt_pk_bf16_f32 v61, v206, v207
  v_cvt_pk_bf16_f32 v62, v220, v221
  v_cvt_pk_bf16_f32 v63, v222, v223
  buffer_store_dwordx4 v[60:63], v31, s[44:47], s3 offen sc1
  s_branch L_attn_out2
L_attn_out1:
  s_mov_b32 s3, 0
  v_pk_mul_f32 v[192:193], v[192:193], v[144:145] op_sel_hi:[1,0]
  v_pk_mul_f32 v[194:195], v[194:195], v[144:145] op_sel_hi:[1,0]
  v_pk_mul_f32 v[208:209], v[208:209], v[144:145] op_sel_hi:[1,0]
  v_pk_mul_f32 v[210:211], v[210:211], v[144:145] op_sel_hi:[1,0]
  v_cvt_pk_bf16_f32 v50, v192, v193
  v_cvt_pk_bf16_f32 v51, v194, v195
  v_cvt_pk_bf16_f32 v48, v208, v209
  v_cvt_pk_bf16_f32 v49, v210, v211
  buffer_store_dwordx4 v[48:51], v31, s[44:47], s3 offen sc1
  v_rcp_f32 v156, v156
  s_mov_b32 s3, 114688
  v_pk_mul_f32 v[196:197], v[196:197], v[148:149] op_sel_hi:[1,0]
  v_pk_mul_f32 v[198:199], v[198:199], v[148:149] op_sel_hi:[1,0]
  v_pk_mul_f32 v[212:213], v[212:213], v[148:149] op_sel_hi:[1,0]
  v_pk_mul_f32 v[214:215], v[214:215], v[148:149] op_sel_hi:[1,0]
  v_cvt_pk_bf16_f32 v54, v196, v197
  v_cvt_pk_bf16_f32 v55, v198, v199
  v_cvt_pk_bf16_f32 v52, v212, v213
  v_cvt_pk_bf16_f32 v53, v214, v215
  buffer_store_dwordx4 v[52:55], v31, s[44:47], s3 offen sc1
  s_mov_b32 s3, 229376
  v_pk_mul_f32 v[200:201], v[200:201], v[152:153] op_sel_hi:[1,0]
  v_pk_mul_f32 v[202:203], v[202:203], v[152:153] op_sel_hi:[1,0]
  v_pk_mul_f32 v[216:217], v[216:217], v[152:153] op_sel_hi:[1,0]
  v_pk_mul_f32 v[218:219], v[218:219], v[152:153] op_sel_hi:[1,0]
  v_cvt_pk_bf16_f32 v58, v200, v201
  v_cvt_pk_bf16_f32 v59, v202, v203
  v_cvt_pk_bf16_f32 v56, v216, v217
  v_cvt_pk_bf16_f32 v57, v218, v219
  buffer_store_dwordx4 v[56:59], v31, s[44:47], s3 offen sc1
  s_mov_b32 s3, 344064
  v_pk_mul_f32 v[204:205], v[204:205], v[156:157] op_sel_hi:[1,0]
  v_pk_mul_f32 v[206:207], v[206:207], v[156:157] op_sel_hi:[1,0]
  v_pk_mul_f32 v[220:221], v[220:221], v[156:157] op_sel_hi:[1,0]
  v_pk_mul_f32 v[222:223], v[222:223], v[156:157] op_sel_hi:[1,0]
  v_cvt_pk_bf16_f32 v62, v204, v205
  v_cvt_pk_bf16_f32 v63, v206, v207
  v_cvt_pk_bf16_f32 v60, v220, v221
  v_cvt_pk_bf16_f32 v61, v222, v223
  buffer_store_dwordx4 v[60:63], v31, s[44:47], s3 offen sc1
L_attn_out2:
  s_waitcnt vmcnt(0) lgkmcnt(0)
  s_barrier
  s_add_u32 s97, s97, 1
  s_branch L_wo_body
.section .rodata,"a"
.p2align 6
.amdhsa_kernel interleave_layers__sliding_local_dilated__dense_activation_gelu__prompt_kernel
  .amdhsa_next_free_vgpr 256
  .amdhsa_next_free_sgpr 102
  .amdhsa_accum_offset 256
  .amdhsa_group_segment_fixed_size 0
  .amdhsa_kernarg_size 88
  .amdhsa_user_sgpr_count 2
  .amdhsa_user_sgpr_kernarg_segment_ptr 1
  .amdhsa_system_sgpr_workgroup_id_x 1
  .amdhsa_float_denorm_mode_32 3
  .amdhsa_float_denorm_mode_16_64 3
.end_amdhsa_kernel
.text
L_attn_c1:
L_wo_c0:
L_wo_body:
  s_cmp_ge_u32 s2, 256
  s_cbranch_scc1 L_wo_end
  v_lshrrev_b32 v2, 6, v0
  v_and_b32 v1, 63, v0
  v_readfirstlane_b32 s70, v2
  s_and_b32 s3, s2, 7
  s_lshr_b32 s99, s2, 3
  s_and_b32 s5, s3, 3
  s_lshl_b32 s5, s5, 2
  s_and_b32 s6, s99, 3
  s_add_u32 s68, s5, s6
  s_lshr_b32 s5, s3, 2
  s_lshr_b32 s78, s99, 2
  s_lshl1_add_u32 s69, s78, s5
  s_add_u32 s3, s68, s78
  s_lshl_b32 s3, s3, 3
  s_lshl_b32 s85, 0xffff02, s3
  s_sub_u32 s3, 0, s3
  s_lshr_b32 s3, 0xffff02, s3
  s_or_b32 s85, s85, s3
  s_cmp_lt_u32 s70, 4
  s_cbranch_scc1 L_wo_compute
L_wo_loader:
  s_add_u32 s3, s96, s70
  s_cmp_lg_u32 s3, 4
  s_cbranch_scc1 L_wo_chk0
  s_load_dwordx2 s[64:65], s[0:1], 72
  s_waitcnt lgkmcnt(0)
  s_and_b32 s65, s65, 0xffff
  s_mov_b32 s66, 256
  s_mov_b32 s67, 0x00020000
  v_lshlrev_b32 v17, 2, v1
  buffer_load_dword v12, v17, s[64:67], 0 offen sc1
L_wo_chk0:
  v_and_b32 v2, 3, v1
  v_lshlrev_b32 v2, 3, v2
  v_bfe_i32 v16, s85, v2, 8
  s_and_b32 s3, s68, 3
  s_mul_i32 s4, s3, 4
  v_add3_u32 v3, v16, v1, s4
  v_and_b32 v3, 15, v3
  v_lshlrev_b32 v16, 17, v3
  s_add_u32 s9, s70, s68
  s_and_b32 s9, s9, 3
  s_lshl_b32 s77, s9, 11
  v_and_b32 v10, 7, v1
  v_lshrrev_b32 v3, 3, v1
  s_lshl_b32 s10, s9, 4
  v_add_u32 v3, s10, v3
  v_mul_u32_u24 v3, 2048, v3
  v_lshrrev_b32 v2, 3, v1
  v_and_b32 v2, 6, v2
  v_xor_b32 v2, v2, v10
  s_lshl_b32 s10, s69, 7
  v_add_u32 v3, s10, v3
  v_lshl_add_u32 v8, v2, 4, v3
  v_add_u32 v3, 16384, v3
  v_lshl_add_u32 v9, v2, 4, v3
  s_mov_b32 s40, s20
  s_and_b32 s41, s21, 0xffff
  s_mov_b32 s42, 2097152
  s_mov_b32 s43, 0x00020000
  v_readlane_b32 s74, v16, 0
  s_add_u32 m0, s77, 28672
  s_add_u32 s4, s74, 0
  buffer_load_dwordx4 v8, s[40:43], s4 offen lds
  s_add_u32 m0, s77, 29696
  s_nop 0
  buffer_load_dwordx4 v9, s[40:43], s4 offen lds
  v_readlane_b32 s74, v16, 1
  s_add_u32 m0, s77, 36864
  s_add_u32 s4, s74, 0
  buffer_load_dwordx4 v8, s[40:43], s4 offen lds
  s_add_u32 m0, s77, 37888
  s_nop 0
  buffer_load_dwordx4 v9, s[40:43], s4 offen lds
  v_readlane_b32 s74, v16, 2
  s_add_u32 m0, s77, 45056
  s_add_u32 s4, s74, 0
  buffer_load_dwordx4 v8, s[40:43], s4 offen lds
  s_add_u32 m0, s77, 46080
  s_nop 0
  buffer_load_dwordx4 v9, s[40:43], s4 offen lds
  v_readlane_b32 s74, v16, 3
  s_add_u32 m0, s77, 53248
  s_add_u32 s4, s74, 0
  buffer_load_dwordx4 v8, s[40:43], s4 offen lds
  s_add_u32 m0, s77, 54272
  s_nop 0
  buffer_load_dwordx4 v9, s[40:43], s4 offen lds
  v_readlane_b32 s74, v16, 4
  s_add_u32 m0, s77, 61440
  s_add_u32 s4, s74, 0
  buffer_load_dwordx4 v8, s[40:43], s4 offen lds
  s_add_u32 m0, s77, 62464
  s_nop 0
  buffer_load_dwordx4 v9, s[40:43], s4 offen lds
  v_readlane_b32 s74, v16, 5
  s_add_u32 m0, s77, 69632
  s_add_u32 s4, s74, 0
  buffer_load_dwordx4 v8, s[40:43], s4 offen lds
  s_add_u32 m0, s77, 70656
  s_nop 0
  buffer_load_dwordx4 v9, s[40:43], s4 offen lds
  s_waitcnt vmcnt(12)
  s_add_u32 s3, s96, s70
  s_cmp_lg_u32 s3, 4
  s_cbranch_scc1 L_wo_chk1
  v_cmp_ne_u32 vcc, 0x01010101, v12
  s_cbranch_vccz L_wo_chk1
  s_load_dwordx2 s[64:65], s[0:1], 72
  s_waitcnt lgkmcnt(0)
  s_and_b32 s65, s65, 0xffff
  s_mov_b32 s66, 256
  s_mov_b32 s67, 0x00020000
  v_lshlrev_b32 v17, 2, v1
  s_mov_b32 s79, 0x100000
L_wo_chkl:
  buffer_load_dword v12, v17, s[64:67], 0 offen sc1
  s_sub_u32 s79, s79, 1
  s_cbranch_scc1 L_wo_chk1
  s_waitcnt vmcnt(0)
  v_cmp_ne_u32 vcc, 0x01010101, v12
  s_cbranch_vccnz L_wo_chkl
L_wo_chk1:
  s_waitcnt vmcnt(12)
  s_add_u32 s44, s22, 41943040
  s_addc_u32 s45, s23, 0
  s_and_b32 s45, s45, 0xffff
  s_mov_b32 s46, 524288
  s_mov_b32 s47, 0x00020000
  s_lshl4_add_u32 s3, s97, s68
  s_and_b32 s4, s69, 15
  s_lshl4_add_u32 s3, s3, s4
  s_lshl_b32 s3, s3, 7
  s_sub_u32 s3, s3, 32768
  v_lshlrev_b32 v11, 7, v1
  v_and_b32 v2, 15, v1
  v_lshlrev_b32 v2, 2, v2
  v_mov_b32 v3, 1
  s_mov_b32 s79, 0x100000
  s_cmp_lg_u32 s70, 4
  s_barrier
  s_cbranch_scc1 L_wo_nofl
  s_mov_b32 exec_lo, 0xffff
  s_mov_b32 exec_hi, 0
  buffer_store_dword v3, v11, s[44:47], s87 offen sc1
  s_mov_b64 exec, -1
L_wo_nofl:
  s_mov_b32 s5, s3
  v_readlane_b32 s74, v16, 6
  s_add_u32 m0, s77, 77824
  s_add_u32 s4, s74, 0
  buffer_load_dwordx4 v8, s[40:43], s4 offen lds
  s_add_u32 m0, s77, 78848
  s_nop 0
  buffer_load_dwordx4 v9, s[40:43], s4 offen lds
  v_readlane_b32 s74, v16, 7
  s_add_u32 m0, s77, 86016
  s_add_u32 s4, s74, 0
  buffer_load_dwordx4 v8, s[40:43], s4 offen lds
  s_add_u32 m0, s77, 87040
  s_nop 0
  buffer_load_dwordx4 v9, s[40:43], s4 offen lds
  v_readlane_b32 s74, v16, 8
  s_add_u32 m0, s77, 94208
  s_add_u32 s4, s74, 0
  buffer_load_dwordx4 v8, s[40:43], s4 offen lds
  s_add_u32 m0, s77, 95232
  s_nop 0
  buffer_load_dwordx4 v9, s[40:43], s4 offen lds
  v_readlane_b32 s74, v16, 9
  s_add_u32 m0, s77, 102400
  s_add_u32 s4, s74, 0
  buffer_load_dwordx4 v8, s[40:43], s4 offen lds
  s_add_u32 m0, s77, 103424
  s_nop 0
  buffer_load_dwordx4 v9, s[40:43], s4 offen lds
  v_readlane_b32 s74, v16, 10
  s_add_u32 m0, s77, 110592
  s_add_u32 s4, s74, 0
  buffer_load_dwordx4 v8, s[40:43], s4 offen lds
  s_add_u32 m0, s77, 111616
  s_nop 0
  buffer_load_dwordx4 v9, s[40:43], s4 offen lds
  v_readlane_b32 s74, v16, 11
  s_add_u32 m0, s77, 118784
  s_add_u32 s4, s74, 0
  buffer_load_dwordx4 v8, s[40:43], s4 offen lds
  s_add_u32 m0, s77, 119808
  s_nop 0
  buffer_load_dwordx4 v9, s[40:43], s4 offen lds
  v_readlane_b32 s74, v16, 12
  s_add_u32 m0, s77, 131072
  s_add_u32 s4, s74, 0
  buffer_load_dwordx4 v8, s[40:43], s4 offen lds
  s_add_u32 m0, s77, 132096
  s_nop 0
  buffer_load_dwordx4 v9, s[40:43], s4 offen lds
  v_readlane_b32 s74, v16, 13
  s_add_u32 m0, s77, 139264
  s_add_u32 s4, s74, 0
  buffer_load_dwordx4 v8, s[40:43], s4 offen lds
  s_add_u32 m0, s77, 140288
  s_nop 0
  buffer_load_dwordx4 v9, s[40:43], s4 offen lds
  v_readlane_b32 s74, v16, 14
  s_add_u32 m0, s77, 147456
  s_add_u32 s4, s74, 0
  buffer_load_dwordx4 v8, s[40:43], s4 offen lds
  s_add_u32 m0, s77, 148480
  s_nop 0
  buffer_load_dwordx4 v9, s[40:43], s4 offen lds
  v_readlane_b32 s74, v16, 15
  s_add_u32 m0, s77, 155648
  s_add_u32 s4, s74, 0
  buffer_load_dwordx4 v8, s[40:43], s4 offen lds
  s_add_u32 m0, s77, 156672
  s_nop 0
  buffer_load_dwordx4 v9, s[40:43], s4 offen lds
  s_mov_b32 s3, s5
  s_cmp_lg_u32 s70, 4
  s_cbranch_scc1 L_wo_dep
L_wo_poll:
  buffer_load_dword v3, v2, s[44:47], s3 offen sc1
  s_sub_u32 s79, s79, 1
  s_cbranch_scc1 L_wo_dep
  s_waitcnt vmcnt(0)
  v_cmp_ne_u32 vcc, 1, v3
  s_cbranch_vccnz L_wo_poll
L_wo_dep:
  s_waitcnt vmcnt(20) lgkmcnt(0)
  s_barrier
  s_waitcnt vmcnt(2)
  s_barrier
  s_lshl_b32 s87, s97, 15
  s_lshl_b32 s4, s68, 11
  s_add_u32 s87, s87, s4
  s_lshl_b32 s4, s69, 2
  s_add_u32 s87, s87, s4
  s_add_u32 s97, s97, 1
  s_branch L_w1_body
L_wo_end:
  s_endpgm
L_wo_compute:
  v_and_b32 v2, 3, v1
  v_lshlrev_b32 v2, 3, v2
  v_bfe_i32 v15, s85, v2, 8
  s_and_b32 s3, s68, 3
  s_mul_i32 s4, s3, 4
  v_add3_u32 v3, v15, v1, s4
  v_and_b32 v3, 15, v3
  v_lshlrev_b32 v15, 12, v3
  v_and_b32 v3, 15, v1
  v_lshrrev_b32 v2, 4, v1
  s_lshl_b32 s8, s68, 7
  s_lshl_b32 s9, s70, 5
  s_add_u32 s8, s8, s9
  s_mul_i32 s9, s8, 7168
  v_add_u32 v13, s8, v3
  s_lshl_b32 s10, s69, 7
  v_lshl_add_u32 v14, v2, 3, s10
  v_and_b32 v16, 1, v2
  v_lshrrev_b32 v17, 1, v2
  v_lshlrev_b32 v16, 4, v1
  s_add_u32 s9, s8, s69
  s_lshl_b32 s9, s9, 11
  v_add_u32 v12, s9, v16
  s_lshl_b32 s9, s70, 12
  v_add_u32 v19, s9, v16
  v_bfe_u32 v16, v1, 2, 2
  v_xor_b32 v16, v16, v2
  v_lshl_add_u32 v18, v16, 17, v13
  s_lshl_b32 s10, s69, 14
  v_lshl_add_u32 v18, v18, 3, s10
  v_lshrrev_b32 v6, 2, v1
  v_lshlrev_b32 v6, 7, v6
  v_and_b32 v17, 3, v1
  v_lshl_add_u32 v6, v17, 3, v6
  v_bfe_u32 v17, v1, 3, 2
  v_lshl_add_u32 v6, v17, 5, v6
  v_xor_b32 v7, 32, v6
  v_xor_b32 v8, 64, v6
  v_xor_b32 v9, 96, v6
  s_mov_b32 s11, 0xffff0000
  s_add_u32 s36, s34, 8439808
  s_addc_u32 s37, s35, 0
  s_and_b32 s37, s37, 0xffff
  s_mov_b32 s38, 4194304
  s_mov_b32 s39, 0x00020000
  s_add_u32 s44, s34, 4194304
  s_addc_u32 s45, s35, 0
  s_and_b32 s45, s45, 0xffff
  s_mov_b32 s46, 4194304
  s_mov_b32 s47, 0x00020000
  s_add_u32 s56, s34, 24117248
  s_addc_u32 s57, s35, 0
  s_and_b32 s57, s57, 0xffff
  s_mov_b32 s58, 262144
  s_mov_b32 s59, 0x00020000
  s_mul_i32 s9, s8, 7168
  s_add_u32 s36, s36, s9
  s_addc_u32 s37, s37, 0x100000
  s_add_u32 s64, s36, 114688
  s_addc_u32 s65, s37, 0
  s_mov_b32 s38, 63488
  s_mov_b32 s39, 0x00800000
  s_mov_b32 s66, 63488
  s_mov_b32 s67, 0x00800000
  s_cmp_lg_u32 s96, 0
  s_cbranch_scc1 L_pfc2_skip
  s_getpc_b64 s[4:5]
L_pfc2:
  s_lshl_b32 s3, s99, 2
  s_add_u32 s3, s3, s70
  s_mul_i32 s3, s3, 128
  s_min_u32 s3, s3, L_w1_c1-L_w1_c0-128
  s_add_i32 s3, s3, L_w1_c0-L_pfc2
  s_ashr_i32 s6, s3, 31
  s_add_u32 s4, s4, s3
  s_addc_u32 s5, s5, s6
  s_load_dword s40, s[4:5], 0
  s_load_dword s40, s[4:5], 64
L_pfc2_skip:
  v_add_u32 v26, 155648, v6
  v_add_u32 v27, 155648, v7
  v_add_u32 v28, 155648, v8
  v_add_u32 v29, 155648, v9
  v_add_u32 v20, 94208, v6
  v_add_u32 v21, 94208, v7
  v_add_u32 v22, 94208, v8
  v_add_u32 v23, 94208, v9
  v_add_u32 v6, 28672, v6
  v_add_u32 v7, 28672, v7
  v_add_u32 v8, 28672, v8
  v_add_u32 v9, 28672, v9
  v_readlane_b32 s48, v15, 0
  v_readlane_b32 s49, v15, 1
  v_readlane_b32 s50, v15, 2
  s_cmp_lg_u32 s96, 0
  s_cbranch_scc1 L_wo_nosw
  v_permlane16_swap_b32 v240, v242
  v_permlane16_swap_b32 v241, v243
  v_permlane16_swap_b32 v244, v246
  v_permlane16_swap_b32 v245, v247
  v_permlane16_swap_b32 v248, v250
  v_permlane16_swap_b32 v249, v251
  v_permlane16_swap_b32 v252, v254
  v_permlane16_swap_b32 v253, v255
L_wo_nosw:
  s_waitcnt lgkmcnt(0)
  s_barrier
  buffer_load_dwordx4 v[32:35], off, s[36:39], s48 offset:0
  buffer_load_dwordx4 v[36:39], off, s[64:67], s48 offset:0
  buffer_load_dwordx4 v[40:43], off, s[36:39], s48 offset:1024
  buffer_load_dwordx4 v[44:47], off, s[64:67], s48 offset:1024
  buffer_load_dwordx4 v[48:51], off, s[36:39], s49 offset:0
  buffer_load_dwordx4 v[52:55], off, s[64:67], s49 offset:0
  buffer_load_dwordx4 v[56:59], off, s[36:39], s49 offset:1024
  buffer_load_dwordx4 v[60:63], off, s[64:67], s49 offset:1024
  buffer_load_dwordx4 v[64:67], off, s[36:39], s50 offset:0
  buffer_load_dwordx4 v[68:71], off, s[64:67], s50 offset:0
  buffer_load_dwordx4 v[72:75], off, s[36:39], s50 offset:1024
  buffer_load_dwordx4 v[76:79], off, s[64:67], s50 offset:1024
  ds_read_b64_tr_b16 v[160:161], v6 offset:0
  ds_read_b64_tr_b16 v[162:163], v6 offset:2048
  ds_read_b64_tr_b16 v[164:165], v7 offset:0
  ds_read_b64_tr_b16 v[166:167], v7 offset:2048
  ds_read_b64_tr_b16 v[176:177], v6 offset:4096
  ds_read_b64_tr_b16 v[178:179], v6 offset:6144
  ds_read_b64_tr_b16 v[180:181], v7 offset:4096
  ds_read_b64_tr_b16 v[182:183], v7 offset:6144
  ds_read_b64_tr_b16 v[168:169], v8 offset:0
  ds_read_b64_tr_b16 v[170:171], v8 offset:2048
  ds_read_b64_tr_b16 v[172:173], v9 offset:0
  ds_read_b64_tr_b16 v[174:175], v9 offset:2048
  ds_read_b64_tr_b16 v[184:185], v8 offset:4096
  ds_read_b64_tr_b16 v[186:187], v8 offset:6144
  ds_read_b64_tr_b16 v[188:189], v9 offset:4096
  ds_read_b64_tr_b16 v[190:191], v9 offset:6144
  v_lshlrev_b32 v96, 16, v240
  v_and_b32 v97, s11, v240
  v_lshlrev_b32 v98, 16, v241
  v_and_b32 v99, s11, v241
  v_lshlrev_b32 v100, 16, v248
  v_and_b32 v101, s11, v248
  v_lshlrev_b32 v102, 16, v249
  v_and_b32 v103, s11, v249
  v_lshlrev_b32 v104, 16, v242
  v_and_b32 v105, s11, v242
  v_lshlrev_b32 v106, 16, v243
  v_and_b32 v107, s11, v243
  v_lshlrev_b32 v108, 16, v250
  v_and_b32 v109, s11, v250
  v_lshlrev_b32 v110, 16, v251
  v_and_b32 v111, s11, v251
  v_lshlrev_b32 v112, 16, v244
  v_and_b32 v113, s11, v244
  v_lshlrev_b32 v114, 16, v245
  v_and_b32 v115, s11, v245
  v_lshlrev_b32 v116, 16, v252
  v_and_b32 v117, s11, v252
  v_lshlrev_b32 v118, 16, v253
  v_and_b32 v119, s11, v253
  v_lshlrev_b32 v120, 16, v246
  v_and_b32 v121, s11, v246
  v_lshlrev_b32 v122, 16, v247
  v_and_b32 v123, s11, v247
  v_lshlrev_b32 v124, 16, v254
  v_and_b32 v125, s11, v254
  v_lshlrev_b32 v126, 16, v255
  v_and_b32 v127, s11, v255
  s_waitcnt vmcnt(8) lgkmcnt(8)
  v_mfma_f32_16x16x32_bf16 v[96:99], v[160:163], v[32:35], v[96:99]
  ds_read_b64_tr_b16 v[192:193], v6 offset:8192
  v_readlane_b32 s51, v15, 3
  v_mfma_f32_16x16x32_bf16 v[96:99], v[176:179], v[40:43], v[96:99]
  ds_read_b64_tr_b16 v[194:195], v6 offset:10240
  v_mfma_f32_16x16x32_bf16 v[100:103], v[176:179], v[44:47], v[100:103]
  ds_read_b64_tr_b16 v[196:197], v7 offset:8192
  v_mfma_f32_16x16x32_bf16 v[100:103], v[160:163], v[36:39], v[100:103]
  buffer_load_dwordx4 v[80:83], off, s[36:39], s51 offset:0
  v_mfma_f32_16x16x32_bf16 v[108:111], v[164:167], v[36:39], v[108:111]
  ds_read_b64_tr_b16 v[198:199], v7 offset:10240
  ds_read_b64_tr_b16 v[208:209], v6 offset:12288
  v_mfma_f32_16x16x32_bf16 v[108:111], v[180:183], v[44:47], v[108:111]
  ds_read_b64_tr_b16 v[210:211], v6 offset:14336
  ds_read_b64_tr_b16 v[212:213], v7 offset:12288
  v_mfma_f32_16x16x32_bf16 v[104:107], v[180:183], v[40:43], v[104:107]
  buffer_load_dwordx4 v[84:87], off, s[64:67], s51 offset:0
  v_mfma_f32_16x16x32_bf16 v[104:107], v[164:167], v[32:35], v[104:107]
  ds_read_b64_tr_b16 v[214:215], v7 offset:14336
  s_waitcnt lgkmcnt(8)
  v_mfma_f32_16x16x32_bf16 v[112:115], v[168:171], v[32:35], v[112:115]
  ds_read_b64_tr_b16 v[200:201], v8 offset:8192
  v_mfma_f32_16x16x32_bf16 v[112:115], v[184:187], v[40:43], v[112:115]
  buffer_load_dwordx4 v[88:91], off, s[36:39], s51 offset:1024
  v_mfma_f32_16x16x32_bf16 v[116:119], v[184:187], v[44:47], v[116:119]
  ds_read_b64_tr_b16 v[202:203], v8 offset:10240
  ds_read_b64_tr_b16 v[204:205], v9 offset:8192
  v_mfma_f32_16x16x32_bf16 v[116:119], v[168:171], v[36:39], v[116:119]
  ds_read_b64_tr_b16 v[206:207], v9 offset:10240
  ds_read_b64_tr_b16 v[216:217], v8 offset:12288
  v_mfma_f32_16x16x32_bf16 v[124:127], v[172:175], v[36:39], v[124:127]
  buffer_load_dwordx4 v[92:95], off, s[64:67], s51 offset:1024
  v_mfma_f32_16x16x32_bf16 v[124:127], v[188:191], v[44:47], v[124:127]
  ds_read_b64_tr_b16 v[218:219], v8 offset:14336
  v_readlane_b32 s48, v15, 4
  v_mfma_f32_16x16x32_bf16 v[120:123], v[188:191], v[40:43], v[120:123]
  ds_read_b64_tr_b16 v[220:221], v9 offset:12288
  v_mfma_f32_16x16x32_bf16 v[120:123], v[172:175], v[32:35], v[120:123]
  ds_read_b64_tr_b16 v[222:223], v9 offset:14336
  s_waitcnt vmcnt(8) lgkmcnt(8)
  v_mfma_f32_16x16x32_bf16 v[96:99], v[192:195], v[48:51], v[96:99]
  buffer_load_dwordx4 v[32:35], off, s[36:39], s48 offset:0
  v_mfma_f32_16x16x32_bf16 v[96:99], v[208:211], v[56:59], v[96:99]
  ds_read_b64_tr_b16 v[160:161], v6 offset:16384
  ds_read_b64_tr_b16 v[162:163], v6 offset:18432
  v_mfma_f32_16x16x32_bf16 v[100:103], v[208:211], v[60:63], v[100:103]
  ds_read_b64_tr_b16 v[164:165], v7 offset:16384
  v_mfma_f32_16x16x32_bf16 v[100:103], v[192:195], v[52:55], v[100:103]
  buffer_load_dwordx4 v[36:39], off, s[64:67], s48 offset:0
  v_mfma_f32_16x16x32_bf16 v[108:111], v[196:199], v[52:55], v[108:111]
  ds_read_b64_tr_b16 v[166:167], v7 offset:18432
  ds_read_b64_tr_b16 v[176:177], v6 offset:20480
  v_mfma_f32_16x16x32_bf16 v[108:111], v[212:215], v[60:63], v[108:111]
  ds_read_b64_tr_b16 v[178:179], v6 offset:22528
  ds_read_b64_tr_b16 v[180:181], v7 offset:20480
  v_mfma_f32_16x16x32_bf16 v[104:107], v[212:215], v[56:59], v[104:107]
  buffer_load_dwordx4 v[40:43], off, s[36:39], s48 offset:1024
  v_mfma_f32_16x16x32_bf16 v[104:107], v[196:199], v[48:51], v[104:107]
  ds_read_b64_tr_b16 v[182:183], v7 offset:22528
  s_waitcnt lgkmcnt(8)
  v_mfma_f32_16x16x32_bf16 v[112:115], v[200:203], v[48:51], v[112:115]
  ds_read_b64_tr_b16 v[168:169], v8 offset:16384
  v_mfma_f32_16x16x32_bf16 v[112:115], v[216:219], v[56:59], v[112:115]
  buffer_load_dwordx4 v[44:47], off, s[64:67], s48 offset:1024
  v_mfma_f32_16x16x32_bf16 v[116:119], v[216:219], v[60:63], v[116:119]
  ds_read_b64_tr_b16 v[170:171], v8 offset:18432
  ds_read_b64_tr_b16 v[172:173], v9 offset:16384
  v_mfma_f32_16x16x32_bf16 v[116:119], v[200:203], v[52:55], v[116:119]
  ds_read_b64_tr_b16 v[174:175], v9 offset:18432
  v_mfma_f32_16x16x32_bf16 v[124:127], v[204:207], v[52:55], v[124:127]
  ds_read_b64_tr_b16 v[184:185], v8 offset:20480
  v_mfma_f32_16x16x32_bf16 v[124:127], v[220:223], v[60:63], v[124:127]
  ds_read_b64_tr_b16 v[186:187], v8 offset:22528
  v_readlane_b32 s49, v15, 5
  v_mfma_f32_16x16x32_bf16 v[120:123], v[220:223], v[56:59], v[120:123]
  ds_read_b64_tr_b16 v[188:189], v9 offset:20480
  v_mfma_f32_16x16x32_bf16 v[120:123], v[204:207], v[48:51], v[120:123]
  ds_read_b64_tr_b16 v[190:191], v9 offset:22528
  s_waitcnt vmcnt(8) lgkmcnt(8)
  v_mfma_f32_16x16x32_bf16 v[96:99], v[160:163], v[64:67], v[96:99]
  buffer_load_dwordx4 v[48:51], off, s[36:39], s49 offset:0
  v_mfma_f32_16x16x32_bf16 v[96:99], v[176:179], v[72:75], v[96:99]
  ds_read_b64_tr_b16 v[192:193], v6 offset:24576
  ds_read_b64_tr_b16 v[194:195], v6 offset:26624
  v_mfma_f32_16x16x32_bf16 v[100:103], v[176:179], v[76:79], v[100:103]
  ds_read_b64_tr_b16 v[196:197], v7 offset:24576
  v_mfma_f32_16x16x32_bf16 v[100:103], v[160:163], v[68:71], v[100:103]
  buffer_load_dwordx4 v[52:55], off, s[64:67], s49 offset:0
  v_mfma_f32_16x16x32_bf16 v[108:111], v[164:167], v[68:71], v[108:111]
  ds_read_b64_tr_b16 v[198:199], v7 offset:26624
  ds_read_b64_tr_b16 v[208:209], v6 offset:28672
  v_mfma_f32_16x16x32_bf16 v[108:111], v[180:183], v[76:79], v[108:111]
  ds_read_b64_tr_b16 v[210:211], v6 offset:30720
  ds_read_b64_tr_b16 v[212:213], v7 offset:28672
  v_mfma_f32_16x16x32_bf16 v[104:107], v[180:183], v[72:75], v[104:107]
  buffer_load_dwordx4 v[56:59], off, s[36:39], s49 offset:1024
  v_mfma_f32_16x16x32_bf16 v[104:107], v[164:167], v[64:67], v[104:107]
  ds_read_b64_tr_b16 v[214:215], v7 offset:30720
  s_waitcnt lgkmcnt(8)
  v_mfma_f32_16x16x32_bf16 v[112:115], v[168:171], v[64:67], v[112:115]
  ds_read_b64_tr_b16 v[200:201], v8 offset:24576
  v_mfma_f32_16x16x32_bf16 v[112:115], v[184:187], v[72:75], v[112:115]
  buffer_load_dwordx4 v[60:63], off, s[64:67], s49 offset:1024
  v_mfma_f32_16x16x32_bf16 v[116:119], v[184:187], v[76:79], v[116:119]
  ds_read_b64_tr_b16 v[202:203], v8 offset:26624
  ds_read_b64_tr_b16 v[204:205], v9 offset:24576
  v_mfma_f32_16x16x32_bf16 v[116:119], v[168:171], v[68:71], v[116:119]
  ds_read_b64_tr_b16 v[206:207], v9 offset:26624
  v_mfma_f32_16x16x32_bf16 v[124:127], v[172:175], v[68:71], v[124:127]
  ds_read_b64_tr_b16 v[216:217], v8 offset:28672
  v_mfma_f32_16x16x32_bf16 v[124:127], v[188:191], v[76:79], v[124:127]
  ds_read_b64_tr_b16 v[218:219], v8 offset:30720
  v_readlane_b32 s50, v15, 6
  v_mfma_f32_16x16x32_bf16 v[120:123], v[188:191], v[72:75], v[120:123]
  ds_read_b64_tr_b16 v[220:221], v9 offset:28672
  v_mfma_f32_16x16x32_bf16 v[120:123], v[172:175], v[64:67], v[120:123]
  ds_read_b64_tr_b16 v[222:223], v9 offset:30720
  s_waitcnt vmcnt(8) lgkmcnt(8)
  v_mfma_f32_16x16x32_bf16 v[96:99], v[192:195], v[80:83], v[96:99]
  buffer_load_dwordx4 v[64:67], off, s[36:39], s50 offset:0
  v_mfma_f32_16x16x32_bf16 v[96:99], v[208:211], v[88:91], v[96:99]
  ds_read_b64_tr_b16 v[160:161], v6 offset:32768
  ds_read_b64_tr_b16 v[162:163], v6 offset:34816
  v_mfma_f32_16x16x32_bf16 v[100:103], v[208:211], v[92:95], v[100:103]
  ds_read_b64_tr_b16 v[164:165], v7 offset:32768
  v_mfma_f32_16x16x32_bf16 v[100:103], v[192:195], v[84:87], v[100:103]
  buffer_load_dwordx4 v[68:71], off, s[64:67], s50 offset:0
  v_mfma_f32_16x16x32_bf16 v[108:111], v[196:199], v[84:87], v[108:111]
  ds_read_b64_tr_b16 v[166:167], v7 offset:34816
  ds_read_b64_tr_b16 v[176:177], v6 offset:36864
  v_mfma_f32_16x16x32_bf16 v[108:111], v[212:215], v[92:95], v[108:111]
  ds_read_b64_tr_b16 v[178:179], v6 offset:38912
  ds_read_b64_tr_b16 v[180:181], v7 offset:36864
  v_mfma_f32_16x16x32_bf16 v[104:107], v[212:215], v[88:91], v[104:107]
  buffer_load_dwordx4 v[72:75], off, s[36:39], s50 offset:1024
  v_mfma_f32_16x16x32_bf16 v[104:107], v[196:199], v[80:83], v[104:107]
  ds_read_b64_tr_b16 v[182:183], v7 offset:38912
  s_waitcnt lgkmcnt(8)
  v_mfma_f32_16x16x32_bf16 v[112:115], v[200:203], v[80:83], v[112:115]
  ds_read_b64_tr_b16 v[168:169], v8 offset:32768
  v_mfma_f32_16x16x32_bf16 v[112:115], v[216:219], v[88:91], v[112:115]
  buffer_load_dwordx4 v[76:79], off, s[64:67], s50 offset:1024
  v_mfma_f32_16x16x32_bf16 v[116:119], v[216:219], v[92:95], v[116:119]
  ds_read_b64_tr_b16 v[170:171], v8 offset:34816
  ds_read_b64_tr_b16 v[172:173], v9 offset:32768
  v_mfma_f32_16x16x32_bf16 v[116:119], v[200:203], v[84:87], v[116:119]
  ds_read_b64_tr_b16 v[174:175], v9 offset:34816
  v_mfma_f32_16x16x32_bf16 v[124:127], v[204:207], v[84:87], v[124:127]
  ds_read_b64_tr_b16 v[184:185], v8 offset:36864
  v_mfma_f32_16x16x32_bf16 v[124:127], v[220:223], v[92:95], v[124:127]
  ds_read_b64_tr_b16 v[186:187], v8 offset:38912
  v_readlane_b32 s51, v15, 7
  v_mfma_f32_16x16x32_bf16 v[120:123], v[220:223], v[88:91], v[120:123]
  ds_read_b64_tr_b16 v[188:189], v9 offset:36864
  v_mfma_f32_16x16x32_bf16 v[120:123], v[204:207], v[80:83], v[120:123]
  ds_read_b64_tr_b16 v[190:191], v9 offset:38912
  s_waitcnt vmcnt(8) lgkmcnt(8)
  v_mfma_f32_16x16x32_bf16 v[96:99], v[160:163], v[32:35], v[96:99]
  buffer_load_dwordx4 v[80:83], off, s[36:39], s51 offset:0
  v_mfma_f32_16x16x32_bf16 v[96:99], v[176:179], v[40:43], v[96:99]
  ds_read_b64_tr_b16 v[192:193], v6 offset:40960
  ds_read_b64_tr_b16 v[194:195], v6 offset:43008
  v_mfma_f32_16x16x32_bf16 v[100:103], v[176:179], v[44:47], v[100:103]
  ds_read_b64_tr_b16 v[196:197], v7 offset:40960
  v_mfma_f32_16x16x32_bf16 v[100:103], v[160:163], v[36:39], v[100:103]
  buffer_load_dwordx4 v[84:87], off, s[64:67], s51 offset:0
  v_mfma_f32_16x16x32_bf16 v[108:111], v[164:167], v[36:39], v[108:111]
  ds_read_b64_tr_b16 v[198:199], v7 offset:43008
  ds_read_b64_tr_b16 v[208:209], v6 offset:45056
  v_mfma_f32_16x16x32_bf16 v[108:111], v[180:183], v[44:47], v[108:111]
  ds_read_b64_tr_b16 v[210:211], v6 offset:47104
  ds_read_b64_tr_b16 v[212:213], v7 offset:45056
  v_mfma_f32_16x16x32_bf16 v[104:107], v[180:183], v[40:43], v[104:107]
  buffer_load_dwordx4 v[88:91], off, s[36:39], s51 offset:1024
  v_mfma_f32_16x16x32_bf16 v[104:107], v[164:167], v[32:35], v[104:107]
  ds_read_b64_tr_b16 v[214:215], v7 offset:47104
  s_waitcnt lgkmcnt(8)
  s_barrier
  v_mfma_f32_16x16x32_bf16 v[112:115], v[168:171], v[32:35], v[112:115]
  ds_read_b64_tr_b16 v[200:201], v8 offset:40960
  v_mfma_f32_16x16x32_bf16 v[112:115], v[184:187], v[40:43], v[112:115]
  buffer_load_dwordx4 v[92:95], off, s[64:67], s51 offset:1024
  v_mfma_f32_16x16x32_bf16 v[116:119], v[184:187], v[44:47], v[116:119]
  ds_read_b64_tr_b16 v[202:203], v8 offset:43008
  ds_read_b64_tr_b16 v[204:205], v9 offset:40960
  v_mfma_f32_16x16x32_bf16 v[116:119], v[168:171], v[36:39], v[116:119]
  ds_read_b64_tr_b16 v[206:207], v9 offset:43008
  v_mfma_f32_16x16x32_bf16 v[124:127], v[172:175], v[36:39], v[124:127]
  ds_read_b64_tr_b16 v[216:217], v8 offset:45056
  v_mfma_f32_16x16x32_bf16 v[124:127], v[188:191], v[44:47], v[124:127]
  ds_read_b64_tr_b16 v[218:219], v8 offset:47104
  v_readlane_b32 s48, v15, 8
  v_mfma_f32_16x16x32_bf16 v[120:123], v[188:191], v[40:43], v[120:123]
  ds_read_b64_tr_b16 v[220:221], v9 offset:45056
  v_mfma_f32_16x16x32_bf16 v[120:123], v[172:175], v[32:35], v[120:123]
  ds_read_b64_tr_b16 v[222:223], v9 offset:47104
  s_waitcnt vmcnt(8) lgkmcnt(8)
  v_mfma_f32_16x16x32_bf16 v[96:99], v[192:195], v[48:51], v[96:99]
  buffer_load_dwordx4 v[32:35], off, s[36:39], s48 offset:0
  v_mfma_f32_16x16x32_bf16 v[96:99], v[208:211], v[56:59], v[96:99]
  ds_read_b64_tr_b16 v[160:161], v6 offset:49152
  ds_read_b64_tr_b16 v[162:163], v6 offset:51200
  v_mfma_f32_16x16x32_bf16 v[100:103], v[208:211], v[60:63], v[100:103]
  ds_read_b64_tr_b16 v[164:165], v7 offset:49152
  v_mfma_f32_16x16x32_bf16 v[100:103], v[192:195], v[52:55], v[100:103]
  buffer_load_dwordx4 v[36:39], off, s[64:67], s48 offset:0
  v_mfma_f32_16x16x32_bf16 v[108:111], v[196:199], v[52:55], v[108:111]
  ds_read_b64_tr_b16 v[166:167], v7 offset:51200
  ds_read_b64_tr_b16 v[176:177], v6 offset:53248
  v_mfma_f32_16x16x32_bf16 v[108:111], v[212:215], v[60:63], v[108:111]
  ds_read_b64_tr_b16 v[178:179], v6 offset:55296
  ds_read_b64_tr_b16 v[180:181], v7 offset:53248
  v_mfma_f32_16x16x32_bf16 v[104:107], v[212:215], v[56:59], v[104:107]
  buffer_load_dwordx4 v[40:43], off, s[36:39], s48 offset:1024
  v_mfma_f32_16x16x32_bf16 v[104:107], v[196:199], v[48:51], v[104:107]
  ds_read_b64_tr_b16 v[182:183], v7 offset:55296
  s_waitcnt lgkmcnt(8)
  v_mfma_f32_16x16x32_bf16 v[112:115], v[200:203], v[48:51], v[112:115]
  ds_read_b64_tr_b16 v[168:169], v8 offset:49152
  v_mfma_f32_16x16x32_bf16 v[112:115], v[216:219], v[56:59], v[112:115]
  buffer_load_dwordx4 v[44:47], off, s[64:67], s48 offset:1024
  v_mfma_f32_16x16x32_bf16 v[116:119], v[216:219], v[60:63], v[116:119]
  ds_read_b64_tr_b16 v[170:171], v8 offset:51200
  ds_read_b64_tr_b16 v[172:173], v9 offset:49152
  v_mfma_f32_16x16x32_bf16 v[116:119], v[200:203], v[52:55], v[116:119]
  ds_read_b64_tr_b16 v[174:175], v9 offset:51200
  v_mfma_f32_16x16x32_bf16 v[124:127], v[204:207], v[52:55], v[124:127]
  ds_read_b64_tr_b16 v[184:185], v8 offset:53248
  v_mfma_f32_16x16x32_bf16 v[124:127], v[220:223], v[60:63], v[124:127]
  ds_read_b64_tr_b16 v[186:187], v8 offset:55296
  v_readlane_b32 s49, v15, 9
  v_mfma_f32_16x16x32_bf16 v[120:123], v[220:223], v[56:59], v[120:123]
  ds_read_b64_tr_b16 v[188:189], v9 offset:53248
  v_mfma_f32_16x16x32_bf16 v[120:123], v[204:207], v[48:51], v[120:123]
  ds_read_b64_tr_b16 v[190:191], v9 offset:55296
  s_waitcnt vmcnt(8) lgkmcnt(8)
  v_mfma_f32_16x16x32_bf16 v[96:99], v[160:163], v[64:67], v[96:99]
  buffer_load_dwordx4 v[48:51], off, s[36:39], s49 offset:0
  v_mfma_f32_16x16x32_bf16 v[96:99], v[176:179], v[72:75], v[96:99]
  ds_read_b64_tr_b16 v[192:193], v6 offset:57344
  ds_read_b64_tr_b16 v[194:195], v6 offset:59392
  v_mfma_f32_16x16x32_bf16 v[100:103], v[176:179], v[76:79], v[100:103]
  ds_read_b64_tr_b16 v[196:197], v7 offset:57344
  v_mfma_f32_16x16x32_bf16 v[100:103], v[160:163], v[68:71], v[100:103]
  buffer_load_dwordx4 v[52:55], off, s[64:67], s49 offset:0
  v_mfma_f32_16x16x32_bf16 v[108:111], v[164:167], v[68:71], v[108:111]
  ds_read_b64_tr_b16 v[198:199], v7 offset:59392
  ds_read_b64_tr_b16 v[208:209], v6 offset:61440
  v_mfma_f32_16x16x32_bf16 v[108:111], v[180:183], v[76:79], v[108:111]
  ds_read_b64_tr_b16 v[210:211], v6 offset:63488
  ds_read_b64_tr_b16 v[212:213], v7 offset:61440
  v_mfma_f32_16x16x32_bf16 v[104:107], v[180:183], v[72:75], v[104:107]
  buffer_load_dwordx4 v[56:59], off, s[36:39], s49 offset:1024
  v_mfma_f32_16x16x32_bf16 v[104:107], v[164:167], v[64:67], v[104:107]
  ds_read_b64_tr_b16 v[214:215], v7 offset:63488
  s_waitcnt lgkmcnt(8)
  v_mfma_f32_16x16x32_bf16 v[112:115], v[168:171], v[64:67], v[112:115]
  ds_read_b64_tr_b16 v[200:201], v8 offset:57344
  v_mfma_f32_16x16x32_bf16 v[112:115], v[184:187], v[72:75], v[112:115]
  buffer_load_dwordx4 v[60:63], off, s[64:67], s49 offset:1024
  v_mfma_f32_16x16x32_bf16 v[116:119], v[184:187], v[76:79], v[116:119]
  ds_read_b64_tr_b16 v[202:203], v8 offset:59392
  ds_read_b64_tr_b16 v[204:205], v9 offset:57344
  v_mfma_f32_16x16x32_bf16 v[116:119], v[168:171], v[68:71], v[116:119]
  ds_read_b64_tr_b16 v[206:207], v9 offset:59392
  v_mfma_f32_16x16x32_bf16 v[124:127], v[172:175], v[68:71], v[124:127]
  ds_read_b64_tr_b16 v[216:217], v8 offset:61440
  v_mfma_f32_16x16x32_bf16 v[124:127], v[188:191], v[76:79], v[124:127]
  ds_read_b64_tr_b16 v[218:219], v8 offset:63488
  v_readlane_b32 s50, v15, 10
  v_mfma_f32_16x16x32_bf16 v[120:123], v[188:191], v[72:75], v[120:123]
  ds_read_b64_tr_b16 v[220:221], v9 offset:61440
  v_mfma_f32_16x16x32_bf16 v[120:123], v[172:175], v[64:67], v[120:123]
  ds_read_b64_tr_b16 v[222:223], v9 offset:63488
  s_waitcnt vmcnt(8) lgkmcnt(8)
  v_mfma_f32_16x16x32_bf16 v[96:99], v[192:195], v[80:83], v[96:99]
  buffer_load_dwordx4 v[64:67], off, s[36:39], s50 offset:0
  v_mfma_f32_16x16x32_bf16 v[96:99], v[208:211], v[88:91], v[96:99]
  ds_read_b64_tr_b16 v[160:161], v20 offset:0
  ds_read_b64_tr_b16 v[162:163], v20 offset:2048
  v_mfma_f32_16x16x32_bf16 v[100:103], v[208:211], v[92:95], v[100:103]
  ds_read_b64_tr_b16 v[164:165], v21 offset:0
  v_mfma_f32_16x16x32_bf16 v[100:103], v[192:195], v[84:87], v[100:103]
  buffer_load_dwordx4 v[68:71], off, s[64:67], s50 offset:0
  v_mfma_f32_16x16x32_bf16 v[108:111], v[196:199], v[84:87], v[108:111]
  ds_read_b64_tr_b16 v[166:167], v21 offset:2048
  ds_read_b64_tr_b16 v[176:177], v20 offset:4096
  v_mfma_f32_16x16x32_bf16 v[108:111], v[212:215], v[92:95], v[108:111]
  ds_read_b64_tr_b16 v[178:179], v20 offset:6144
  ds_read_b64_tr_b16 v[180:181], v21 offset:4096
  v_mfma_f32_16x16x32_bf16 v[104:107], v[212:215], v[88:91], v[104:107]
  buffer_load_dwordx4 v[72:75], off, s[36:39], s50 offset:1024
  v_mfma_f32_16x16x32_bf16 v[104:107], v[196:199], v[80:83], v[104:107]
  ds_read_b64_tr_b16 v[182:183], v21 offset:6144
  s_waitcnt lgkmcnt(8)
  v_mfma_f32_16x16x32_bf16 v[112:115], v[200:203], v[80:83], v[112:115]
  ds_read_b64_tr_b16 v[168:169], v22 offset:0
  v_mfma_f32_16x16x32_bf16 v[112:115], v[216:219], v[88:91], v[112:115]
  buffer_load_dwordx4 v[76:79], off, s[64:67], s50 offset:1024
  v_mfma_f32_16x16x32_bf16 v[116:119], v[216:219], v[92:95], v[116:119]
  ds_read_b64_tr_b16 v[170:171], v22 offset:2048
  ds_read_b64_tr_b16 v[172:173], v23 offset:0
  v_mfma_f32_16x16x32_bf16 v[116:119], v[200:203], v[84:87], v[116:119]
  ds_read_b64_tr_b16 v[174:175], v23 offset:2048
  v_mfma_f32_16x16x32_bf16 v[124:127], v[204:207], v[84:87], v[124:127]
  ds_read_b64_tr_b16 v[184:185], v22 offset:4096
  v_mfma_f32_16x16x32_bf16 v[124:127], v[220:223], v[92:95], v[124:127]
  ds_read_b64_tr_b16 v[186:187], v22 offset:6144
  v_readlane_b32 s51, v15, 11
  v_mfma_f32_16x16x32_bf16 v[120:123], v[220:223], v[88:91], v[120:123]
  ds_read_b64_tr_b16 v[188:189], v23 offset:4096
  v_mfma_f32_16x16x32_bf16 v[120:123], v[204:207], v[80:83], v[120:123]
  ds_read_b64_tr_b16 v[190:191], v23 offset:6144
  s_waitcnt vmcnt(8) lgkmcnt(8)
  v_mfma_f32_16x16x32_bf16 v[96:99], v[160:163], v[32:35], v[96:99]
  buffer_load_dwordx4 v[80:83], off, s[36:39], s51 offset:0
  v_mfma_f32_16x16x32_bf16 v[96:99], v[176:179], v[40:43], v[96:99]
  ds_read_b64_tr_b16 v[192:193], v20 offset:8192
  ds_read_b64_tr_b16 v[194:195], v20 offset:10240
  v_mfma_f32_16x16x32_bf16 v[100:103], v[176:179], v[44:47], v[100:103]
  ds_read_b64_tr_b16 v[196:197], v21 offset:8192
  v_mfma_f32_16x16x32_bf16 v[100:103], v[160:163], v[36:39], v[100:103]
  buffer_load_dwordx4 v[84:87], off, s[64:67], s51 offset:0
  v_mfma_f32_16x16x32_bf16 v[108:111], v[164:167], v[36:39], v[108:111]
  ds_read_b64_tr_b16 v[198:199], v21 offset:10240
  ds_read_b64_tr_b16 v[208:209], v20 offset:12288
  v_mfma_f32_16x16x32_bf16 v[108:111], v[180:183], v[44:47], v[108:111]
  ds_read_b64_tr_b16 v[210:211], v20 offset:14336
  ds_read_b64_tr_b16 v[212:213], v21 offset:12288
  v_mfma_f32_16x16x32_bf16 v[104:107], v[180:183], v[40:43], v[104:107]
  buffer_load_dwordx4 v[88:91], off, s[36:39], s51 offset:1024
  v_mfma_f32_16x16x32_bf16 v[104:107], v[164:167], v[32:35], v[104:107]
  ds_read_b64_tr_b16 v[214:215], v21 offset:14336
  s_waitcnt lgkmcnt(8)
  v_mfma_f32_16x16x32_bf16 v[112:115], v[168:171], v[32:35], v[112:115]
  ds_read_b64_tr_b16 v[200:201], v22 offset:8192
  v_mfma_f32_16x16x32_bf16 v[112:115], v[184:187], v[40:43], v[112:115]
  buffer_load_dwordx4 v[92:95], off, s[64:67], s51 offset:1024
  v_mfma_f32_16x16x32_bf16 v[116:119], v[184:187], v[44:47], v[116:119]
  ds_read_b64_tr_b16 v[202:203], v22 offset:10240
  ds_read_b64_tr_b16 v[204:205], v23 offset:8192
  v_mfma_f32_16x16x32_bf16 v[116:119], v[168:171], v[36:39], v[116:119]
  ds_read_b64_tr_b16 v[206:207], v23 offset:10240
  v_mfma_f32_16x16x32_bf16 v[124:127], v[172:175], v[36:39], v[124:127]
  ds_read_b64_tr_b16 v[216:217], v22 offset:12288
  v_mfma_f32_16x16x32_bf16 v[124:127], v[188:191], v[44:47], v[124:127]
  ds_read_b64_tr_b16 v[218:219], v22 offset:14336
  v_readlane_b32 s48, v15, 12
  v_mfma_f32_16x16x32_bf16 v[120:123], v[188:191], v[40:43], v[120:123]
  ds_read_b64_tr_b16 v[220:221], v23 offset:12288
  v_mfma_f32_16x16x32_bf16 v[120:123], v[172:175], v[32:35], v[120:123]
  ds_read_b64_tr_b16 v[222:223], v23 offset:14336
  s_waitcnt vmcnt(8) lgkmcnt(8)
  v_mfma_f32_16x16x32_bf16 v[96:99], v[192:195], v[48:51], v[96:99]
  buffer_load_dwordx4 v[32:35], off, s[36:39], s48 offset:0
  v_mfma_f32_16x16x32_bf16 v[96:99], v[208:211], v[56:59], v[96:99]
  ds_read_b64_tr_b16 v[160:161], v20 offset:16384
  ds_read_b64_tr_b16 v[162:163], v20 offset:18432
  v_mfma_f32_16x16x32_bf16 v[100:103], v[208:211], v[60:63], v[100:103]
  ds_read_b64_tr_b16 v[164:165], v21 offset:16384
  v_mfma_f32_16x16x32_bf16 v[100:103], v[192:195], v[52:55], v[100:103]
  buffer_load_dwordx4 v[36:39], off, s[64:67], s48 offset:0
  v_mfma_f32_16x16x32_bf16 v[108:111], v[196:199], v[52:55], v[108:111]
  ds_read_b64_tr_b16 v[166:167], v21 offset:18432
  ds_read_b64_tr_b16 v[176:177], v20 offset:20480
  v_mfma_f32_16x16x32_bf16 v[108:111], v[212:215], v[60:63], v[108:111]
  ds_read_b64_tr_b16 v[178:179], v20 offset:22528
  ds_read_b64_tr_b16 v[180:181], v21 offset:20480
  v_mfma_f32_16x16x32_bf16 v[104:107], v[212:215], v[56:59], v[104:107]
  buffer_load_dwordx4 v[40:43], off, s[36:39], s48 offset:1024
  v_mfma_f32_16x16x32_bf16 v[104:107], v[196:199], v[48:51], v[104:107]
  ds_read_b64_tr_b16 v[182:183], v21 offset:22528
  s_waitcnt lgkmcnt(8)
  v_mfma_f32_16x16x32_bf16 v[112:115], v[200:203], v[48:51], v[112:115]
  ds_read_b64_tr_b16 v[168:169], v22 offset:16384
  v_mfma_f32_16x16x32_bf16 v[112:115], v[216:219], v[56:59], v[112:115]
  buffer_load_dwordx4 v[44:47], off, s[64:67], s48 offset:1024
  v_mfma_f32_16x16x32_bf16 v[116:119], v[216:219], v[60:63], v[116:119]
  ds_read_b64_tr_b16 v[170:171], v22 offset:18432
  ds_read_b64_tr_b16 v[172:173], v23 offset:16384
  v_mfma_f32_16x16x32_bf16 v[116:119], v[200:203], v[52:55], v[116:119]
  ds_read_b64_tr_b16 v[174:175], v23 offset:18432
  v_mfma_f32_16x16x32_bf16 v[124:127], v[204:207], v[52:55], v[124:127]
  ds_read_b64_tr_b16 v[184:185], v22 offset:20480
  v_mfma_f32_16x16x32_bf16 v[124:127], v[220:223], v[60:63], v[124:127]
  ds_read_b64_tr_b16 v[186:187], v22 offset:22528
  v_readlane_b32 s49, v15, 13
  v_mfma_f32_16x16x32_bf16 v[120:123], v[220:223], v[56:59], v[120:123]
  ds_read_b64_tr_b16 v[188:189], v23 offset:20480
  v_mfma_f32_16x16x32_bf16 v[120:123], v[204:207], v[48:51], v[120:123]
  ds_read_b64_tr_b16 v[190:191], v23 offset:22528
  s_waitcnt vmcnt(8) lgkmcnt(8)
  v_mfma_f32_16x16x32_bf16 v[96:99], v[160:163], v[64:67], v[96:99]
  buffer_load_dwordx4 v[48:51], off, s[36:39], s49 offset:0
  v_mfma_f32_16x16x32_bf16 v[96:99], v[176:179], v[72:75], v[96:99]
  ds_read_b64_tr_b16 v[192:193], v20 offset:24576
  ds_read_b64_tr_b16 v[194:195], v20 offset:26624
  v_mfma_f32_16x16x32_bf16 v[100:103], v[176:179], v[76:79], v[100:103]
  ds_read_b64_tr_b16 v[196:197], v21 offset:24576
  v_mfma_f32_16x16x32_bf16 v[100:103], v[160:163], v[68:71], v[100:103]
  buffer_load_dwordx4 v[52:55], off, s[64:67], s49 offset:0
  v_mfma_f32_16x16x32_bf16 v[108:111], v[164:167], v[68:71], v[108:111]
  ds_read_b64_tr_b16 v[198:199], v21 offset:26624
  ds_read_b64_tr_b16 v[208:209], v20 offset:28672
  v_mfma_f32_16x16x32_bf16 v[108:111], v[180:183], v[76:79], v[108:111]
  ds_read_b64_tr_b16 v[210:211], v20 offset:30720
  ds_read_b64_tr_b16 v[212:213], v21 offset:28672
  v_mfma_f32_16x16x32_bf16 v[104:107], v[180:183], v[72:75], v[104:107]
  buffer_load_dwordx4 v[56:59], off, s[36:39], s49 offset:1024
  v_mfma_f32_16x16x32_bf16 v[104:107], v[164:167], v[64:67], v[104:107]
  ds_read_b64_tr_b16 v[214:215], v21 offset:30720
  s_waitcnt lgkmcnt(8)
  v_mfma_f32_16x16x32_bf16 v[112:115], v[168:171], v[64:67], v[112:115]
  ds_read_b64_tr_b16 v[200:201], v22 offset:24576
  v_mfma_f32_16x16x32_bf16 v[112:115], v[184:187], v[72:75], v[112:115]
  buffer_load_dwordx4 v[60:63], off, s[64:67], s49 offset:1024
  v_mfma_f32_16x16x32_bf16 v[116:119], v[184:187], v[76:79], v[116:119]
  ds_read_b64_tr_b16 v[202:203], v22 offset:26624
  ds_read_b64_tr_b16 v[204:205], v23 offset:24576
  v_mfma_f32_16x16x32_bf16 v[116:119], v[168:171], v[68:71], v[116:119]
  ds_read_b64_tr_b16 v[206:207], v23 offset:26624
  v_mfma_f32_16x16x32_bf16 v[124:127], v[172:175], v[68:71], v[124:127]
  ds_read_b64_tr_b16 v[216:217], v22 offset:28672
  v_mfma_f32_16x16x32_bf16 v[124:127], v[188:191], v[76:79], v[124:127]
  ds_read_b64_tr_b16 v[218:219], v22 offset:30720
  v_readlane_b32 s50, v15, 14
  v_mfma_f32_16x16x32_bf16 v[120:123], v[188:191], v[72:75], v[120:123]
  ds_read_b64_tr_b16 v[220:221], v23 offset:28672
  v_mfma_f32_16x16x32_bf16 v[120:123], v[172:175], v[64:67], v[120:123]
  ds_read_b64_tr_b16 v[222:223], v23 offset:30720
  s_waitcnt vmcnt(8) lgkmcnt(8)
  v_mfma_f32_16x16x32_bf16 v[96:99], v[192:195], v[80:83], v[96:99]
  buffer_load_dwordx4 v[64:67], off, s[36:39], s50 offset:0
  v_mfma_f32_16x16x32_bf16 v[96:99], v[208:211], v[88:91], v[96:99]
  ds_read_b64_tr_b16 v[160:161], v20 offset:36864
  ds_read_b64_tr_b16 v[162:163], v20 offset:38912
  v_mfma_f32_16x16x32_bf16 v[100:103], v[208:211], v[92:95], v[100:103]
  ds_read_b64_tr_b16 v[164:165], v21 offset:36864
  v_mfma_f32_16x16x32_bf16 v[100:103], v[192:195], v[84:87], v[100:103]
  buffer_load_dwordx4 v[68:71], off, s[64:67], s50 offset:0
  v_mfma_f32_16x16x32_bf16 v[108:111], v[196:199], v[84:87], v[108:111]
  ds_read_b64_tr_b16 v[166:167], v21 offset:38912
  ds_read_b64_tr_b16 v[176:177], v20 offset:40960
  v_mfma_f32_16x16x32_bf16 v[108:111], v[212:215], v[92:95], v[108:111]
  ds_read_b64_tr_b16 v[178:179], v20 offset:43008
  ds_read_b64_tr_b16 v[180:181], v21 offset:40960
  v_mfma_f32_16x16x32_bf16 v[104:107], v[212:215], v[88:91], v[104:107]
  buffer_load_dwordx4 v[72:75], off, s[36:39], s50 offset:1024
  v_mfma_f32_16x16x32_bf16 v[104:107], v[196:199], v[80:83], v[104:107]
  ds_read_b64_tr_b16 v[182:183], v21 offset:43008
  s_waitcnt lgkmcnt(8)
  v_mfma_f32_16x16x32_bf16 v[112:115], v[200:203], v[80:83], v[112:115]
  ds_read_b64_tr_b16 v[168:169], v22 offset:36864
  v_mfma_f32_16x16x32_bf16 v[112:115], v[216:219], v[88:91], v[112:115]
  buffer_load_dwordx4 v[76:79], off, s[64:67], s50 offset:1024
  v_mfma_f32_16x16x32_bf16 v[116:119], v[216:219], v[92:95], v[116:119]
  ds_read_b64_tr_b16 v[170:171], v22 offset:38912
  ds_read_b64_tr_b16 v[172:173], v23 offset:36864
  v_mfma_f32_16x16x32_bf16 v[116:119], v[200:203], v[84:87], v[116:119]
  ds_read_b64_tr_b16 v[174:175], v23 offset:38912
  v_mfma_f32_16x16x32_bf16 v[124:127], v[204:207], v[84:87], v[124:127]
  ds_read_b64_tr_b16 v[184:185], v22 offset:40960
  v_mfma_f32_16x16x32_bf16 v[124:127], v[220:223], v[92:95], v[124:127]
  ds_read_b64_tr_b16 v[186:187], v22 offset:43008
  v_readlane_b32 s51, v15, 15
  v_mfma_f32_16x16x32_bf16 v[120:123], v[220:223], v[88:91], v[120:123]
  ds_read_b64_tr_b16 v[188:189], v23 offset:40960
  v_mfma_f32_16x16x32_bf16 v[120:123], v[204:207], v[80:83], v[120:123]
  ds_read_b64_tr_b16 v[190:191], v23 offset:43008
  s_waitcnt vmcnt(8) lgkmcnt(8)
  v_mfma_f32_16x16x32_bf16 v[96:99], v[160:163], v[32:35], v[96:99]
  buffer_load_dwordx4 v[80:83], off, s[36:39], s51 offset:0
  v_mfma_f32_16x16x32_bf16 v[96:99], v[176:179], v[40:43], v[96:99]
  ds_read_b64_tr_b16 v[192:193], v20 offset:45056
  ds_read_b64_tr_b16 v[194:195], v20 offset:47104
  v_mfma_f32_16x16x32_bf16 v[100:103], v[176:179], v[44:47], v[100:103]
  ds_read_b64_tr_b16 v[196:197], v21 offset:45056
  v_mfma_f32_16x16x32_bf16 v[100:103], v[160:163], v[36:39], v[100:103]
  buffer_load_dwordx4 v[84:87], off, s[64:67], s51 offset:0
  v_mfma_f32_16x16x32_bf16 v[108:111], v[164:167], v[36:39], v[108:111]
  ds_read_b64_tr_b16 v[198:199], v21 offset:47104
  ds_read_b64_tr_b16 v[208:209], v20 offset:49152
  v_mfma_f32_16x16x32_bf16 v[108:111], v[180:183], v[44:47], v[108:111]
  ds_read_b64_tr_b16 v[210:211], v20 offset:51200
  ds_read_b64_tr_b16 v[212:213], v21 offset:49152
  v_mfma_f32_16x16x32_bf16 v[104:107], v[180:183], v[40:43], v[104:107]
  buffer_load_dwordx4 v[88:91], off, s[36:39], s51 offset:1024
  v_mfma_f32_16x16x32_bf16 v[104:107], v[164:167], v[32:35], v[104:107]
  ds_read_b64_tr_b16 v[214:215], v21 offset:51200
  s_waitcnt lgkmcnt(8)
  v_mfma_f32_16x16x32_bf16 v[112:115], v[168:171], v[32:35], v[112:115]
  ds_read_b64_tr_b16 v[200:201], v22 offset:45056
  v_mfma_f32_16x16x32_bf16 v[112:115], v[184:187], v[40:43], v[112:115]
  buffer_load_dwordx4 v[92:95], off, s[64:67], s51 offset:1024
  v_mfma_f32_16x16x32_bf16 v[116:119], v[184:187], v[44:47], v[116:119]
  ds_read_b64_tr_b16 v[202:203], v22 offset:47104
  ds_read_b64_tr_b16 v[204:205], v23 offset:45056
  v_mfma_f32_16x16x32_bf16 v[116:119], v[168:171], v[36:39], v[116:119]
  ds_read_b64_tr_b16 v[206:207], v23 offset:47104
  v_mfma_f32_16x16x32_bf16 v[124:127], v[172:175], v[36:39], v[124:127]
  ds_read_b64_tr_b16 v[216:217], v22 offset:49152
  v_mfma_f32_16x16x32_bf16 v[124:127], v[188:191], v[44:47], v[124:127]
  ds_read_b64_tr_b16 v[218:219], v22 offset:51200
  v_mfma_f32_16x16x32_bf16 v[120:123], v[188:191], v[40:43], v[120:123]
  ds_read_b64_tr_b16 v[220:221], v23 offset:49152
  v_mfma_f32_16x16x32_bf16 v[120:123], v[172:175], v[32:35], v[120:123]
  ds_read_b64_tr_b16 v[222:223], v23 offset:51200
  s_waitcnt vmcnt(8) lgkmcnt(8)
  v_mfma_f32_16x16x32_bf16 v[96:99], v[192:195], v[48:51], v[96:99]
  ds_read_b64_tr_b16 v[160:161], v20 offset:53248
  v_mfma_f32_16x16x32_bf16 v[96:99], v[208:211], v[56:59], v[96:99]
  ds_read_b64_tr_b16 v[162:163], v20 offset:55296
  v_mfma_f32_16x16x32_bf16 v[100:103], v[208:211], v[60:63], v[100:103]
  ds_read_b64_tr_b16 v[164:165], v21 offset:53248
  v_mfma_f32_16x16x32_bf16 v[100:103], v[192:195], v[52:55], v[100:103]
  ds_read_b64_tr_b16 v[166:167], v21 offset:55296
  v_mfma_f32_16x16x32_bf16 v[108:111], v[196:199], v[52:55], v[108:111]
  ds_read_b64_tr_b16 v[176:177], v20 offset:57344
  v_mfma_f32_16x16x32_bf16 v[108:111], v[212:215], v[60:63], v[108:111]
  ds_read_b64_tr_b16 v[178:179], v20 offset:59392
  v_mfma_f32_16x16x32_bf16 v[104:107], v[212:215], v[56:59], v[104:107]
  ds_read_b64_tr_b16 v[180:181], v21 offset:57344
  v_mfma_f32_16x16x32_bf16 v[104:107], v[196:199], v[48:51], v[104:107]
  ds_read_b64_tr_b16 v[182:183], v21 offset:59392
  s_waitcnt lgkmcnt(8)
  s_barrier
  v_mfma_f32_16x16x32_bf16 v[112:115], v[200:203], v[48:51], v[112:115]
  ds_read_b64_tr_b16 v[168:169], v22 offset:53248
  v_mfma_f32_16x16x32_bf16 v[112:115], v[216:219], v[56:59], v[112:115]
  ds_read_b64_tr_b16 v[170:171], v22 offset:55296
  v_mfma_f32_16x16x32_bf16 v[116:119], v[216:219], v[60:63], v[116:119]
  ds_read_b64_tr_b16 v[172:173], v23 offset:53248
  v_mfma_f32_16x16x32_bf16 v[116:119], v[200:203], v[52:55], v[116:119]
  ds_read_b64_tr_b16 v[174:175], v23 offset:55296
  v_mfma_f32_16x16x32_bf16 v[124:127], v[204:207], v[52:55], v[124:127]
  ds_read_b64_tr_b16 v[184:185], v22 offset:57344
  v_mfma_f32_16x16x32_bf16 v[124:127], v[220:223], v[60:63], v[124:127]
  ds_read_b64_tr_b16 v[186:187], v22 offset:59392
  v_mfma_f32_16x16x32_bf16 v[120:123], v[220:223], v[56:59], v[120:123]
  ds_read_b64_tr_b16 v[188:189], v23 offset:57344
  v_mfma_f32_16x16x32_bf16 v[120:123], v[204:207], v[48:51], v[120:123]
  ds_read_b64_tr_b16 v[190:191], v23 offset:59392
  s_waitcnt vmcnt(4) lgkmcnt(8)
  v_mfma_f32_16x16x32_bf16 v[96:99], v[160:163], v[64:67], v[96:99]
  ds_read_b64_tr_b16 v[192:193], v26 offset:0
  v_mfma_f32_16x16x32_bf16 v[96:99], v[176:179], v[72:75], v[96:99]
  ds_read_b64_tr_b16 v[194:195], v26 offset:2048
  v_mfma_f32_16x16x32_bf16 v[100:103], v[176:179], v[76:79], v[100:103]
  ds_read_b64_tr_b16 v[196:197], v27 offset:0
  v_mfma_f32_16x16x32_bf16 v[100:103], v[160:163], v[68:71], v[100:103]
  ds_read_b64_tr_b16 v[198:199], v27 offset:2048
  v_mfma_f32_16x16x32_bf16 v[108:111], v[164:167], v[68:71], v[108:111]
  ds_read_b64_tr_b16 v[208:209], v26 offset:4096
  v_mfma_f32_16x16x32_bf16 v[108:111], v[180:183], v[76:79], v[108:111]
  ds_read_b64_tr_b16 v[210:211], v26 offset:6144
  v_mfma_f32_16x16x32_bf16 v[104:107], v[180:183], v[72:75], v[104:107]
  ds_read_b64_tr_b16 v[212:213], v27 offset:4096
  v_mfma_f32_16x16x32_bf16 v[104:107], v[164:167], v[64:67], v[104:107]
  ds_read_b64_tr_b16 v[214:215], v27 offset:6144
  s_waitcnt lgkmcnt(8)
  v_mfma_f32_16x16x32_bf16 v[112:115], v[168:171], v[64:67], v[112:115]
  ds_read_b64_tr_b16 v[200:201], v28 offset:0
  v_mfma_f32_16x16x32_bf16 v[112:115], v[184:187], v[72:75], v[112:115]
  ds_read_b64_tr_b16 v[202:203], v28 offset:2048
  v_mfma_f32_16x16x32_bf16 v[116:119], v[184:187], v[76:79], v[116:119]
  ds_read_b64_tr_b16 v[204:205], v29 offset:0
  v_mfma_f32_16x16x32_bf16 v[116:119], v[168:171], v[68:71], v[116:119]
  ds_read_b64_tr_b16 v[206:207], v29 offset:2048
  v_mfma_f32_16x16x32_bf16 v[124:127], v[172:175], v[68:71], v[124:127]
  ds_read_b64_tr_b16 v[216:217], v28 offset:4096
  v_mfma_f32_16x16x32_bf16 v[124:127], v[188:191], v[76:79], v[124:127]
  ds_read_b64_tr_b16 v[218:219], v28 offset:6144
  v_mfma_f32_16x16x32_bf16 v[120:123], v[188:191], v[72:75], v[120:123]
  ds_read_b64_tr_b16 v[220:221], v29 offset:4096
  v_mfma_f32_16x16x32_bf16 v[120:123], v[172:175], v[64:67], v[120:123]
  ds_read_b64_tr_b16 v[222:223], v29 offset:6144
  s_waitcnt vmcnt(0) lgkmcnt(8)
  v_mfma_f32_16x16x32_bf16 v[96:99], v[192:195], v[80:83], v[96:99]
  v_mov_b32 v20, 0x3f803f80
  v_mov_b32 v21, 0x3f803f80
  v_mfma_f32_16x16x32_bf16 v[96:99], v[208:211], v[88:91], v[96:99]
  v_mov_b32 v22, 0x3f803f80
  v_mov_b32 v23, 0x3f803f80
  v_mfma_f32_16x16x32_bf16 v[104:107], v[212:215], v[88:91], v[104:107]
  s_mov_b32 vcc_lo, 0xaaaaaaaa
  s_mov_b32 vcc_hi, vcc_lo
  v_mfma_f32_16x16x32_bf16 v[104:107], v[196:199], v[80:83], v[104:107]
  s_mov_b32 s8, 0xcccccccc
  s_mov_b32 s9, s8
  v_mfma_f32_16x16x32_bf16 v[108:111], v[196:199], v[84:87], v[108:111]
  s_mov_b32 s3, 32768
  v_mfma_f32_16x16x32_bf16 v[108:111], v[212:215], v[92:95], v[108:111]
  v_cvt_pk_bf16_f32 v240, v96, v97
  v_cvt_pk_bf16_f32 v241, v98, v99
  v_mfma_f32_16x16x32_bf16 v[100:103], v[208:211], v[92:95], v[100:103]
  v_cvt_pk_bf16_f32 v242, v104, v105
  v_cvt_pk_bf16_f32 v243, v106, v107
  v_mfma_f32_16x16x32_bf16 v[100:103], v[192:195], v[84:87], v[100:103]
  s_waitcnt lgkmcnt(0)
  buffer_store_dwordx4 v[240:243], v12, s[44:47], 0 offen offset:0 sc1
  v_mfma_f32_16x16x32_bf16 v[112:115], v[200:203], v[80:83], v[112:115]
  ds_write_b128 v19, v[240:243] offset:0
  v_mfma_f32_16x16x32_bf16 v[112:115], v[216:219], v[88:91], v[112:115]
  v_cvt_pk_bf16_f32 v250, v108, v109
  v_cvt_pk_bf16_f32 v251, v110, v111
  v_mfma_f32_16x16x32_bf16 v[120:123], v[220:223], v[88:91], v[120:123]
  v_cvt_pk_bf16_f32 v248, v100, v101
  v_cvt_pk_bf16_f32 v249, v102, v103
  v_mfma_f32_16x16x32_bf16 v[120:123], v[204:207], v[80:83], v[120:123]
  buffer_store_dwordx4 v[248:251], v12, s[44:47], s3 offen offset:0 sc1
  ds_write_b128 v19, v[248:251] offset:2048
  v_mfma_f32_16x16x32_bf16 v[124:127], v[204:207], v[84:87], v[124:127]
  s_nop 0
  v_mfma_f32_16x16x32_bf16 v[124:127], v[220:223], v[92:95], v[124:127]
  v_cvt_pk_bf16_f32 v244, v112, v113
  v_cvt_pk_bf16_f32 v245, v114, v115
  v_mfma_f32_16x16x32_bf16 v[116:119], v[216:219], v[92:95], v[116:119]
  v_cvt_pk_bf16_f32 v246, v120, v121
  v_cvt_pk_bf16_f32 v247, v122, v123
  v_mfma_f32_16x16x32_bf16 v[116:119], v[200:203], v[84:87], v[116:119]
  buffer_store_dwordx4 v[244:247], v12, s[44:47], 0 offen offset:1024 sc1
  ds_write_b128 v19, v[244:247] offset:1024
  v_mfma_f32_16x16x32_bf16 v[132:135], v[240:243], v[240:243], 0
  v_cvt_pk_bf16_f32 v254, v124, v125
  v_cvt_pk_bf16_f32 v255, v126, v127
  v_mfma_f32_16x16x32_bf16 v[128:131], v[20:23], v[240:243], 0
  v_mfma_f32_16x16x32_bf16 v[132:135], v[244:247], v[244:247], v[132:135]
  v_mfma_f32_16x16x32_bf16 v[128:131], v[20:23], v[244:247], v[128:131]
  v_cvt_pk_bf16_f32 v252, v116, v117
  v_cvt_pk_bf16_f32 v253, v118, v119
  v_mfma_f32_16x16x32_bf16 v[140:143], v[248:251], v[248:251], 0
  buffer_store_dwordx4 v[252:255], v12, s[44:47], s3 offen offset:1024 sc1
  ds_write_b128 v19, v[252:255] offset:3072
  v_mfma_f32_16x16x32_bf16 v[136:139], v[20:23], v[248:251], 0
  v_mfma_f32_16x16x32_bf16 v[140:143], v[252:255], v[252:255], v[140:143]
  v_mfma_f32_16x16x32_bf16 v[136:139], v[20:23], v[252:255], v[136:139]
  v_cndmask_b32 v132, v132, v133, vcc
  v_cndmask_b32 v134, v134, v135, vcc
  v_cndmask_b32 v129, v132, v134, s[8:9]
  buffer_store_dwordx2 v[128:129], v18, s[56:59], 0 offen offset:0 sc1
  s_nop 2
  v_cndmask_b32 v140, v140, v141, vcc
  v_cndmask_b32 v142, v142, v143, vcc
  v_cndmask_b32 v137, v140, v142, s[8:9]
  buffer_store_dwordx2 v[136:137], v18, s[56:59], 0 offen offset:128 sc1
  s_waitcnt vmcnt(0) lgkmcnt(0)
  s_barrier
  s_add_u32 s97, s97, 1
  s_branch L_w1_body
L_wo_c1:
L_w1_c0:
L_w1_body:
  s_cmp_ge_u32 s2, 256
  s_cbranch_scc1 L_w1_end
  v_lshrrev_b32 v2, 6, v0
  v_and_b32 v1, 63, v0
  v_readfirstlane_b32 s70, v2
  s_and_b32 s3, s2, 7
  s_lshr_b32 s99, s2, 3
  s_and_b32 s5, s3, 3
  s_lshl_b32 s5, s5, 2
  s_and_b32 s6, s99, 3
  s_add_u32 s68, s5, s6
  s_lshr_b32 s5, s3, 2
  s_lshl_b32 s5, s5, 3
  s_lshr_b32 s6, s99, 2
  s_add_u32 s69, s5, s6
  s_cmp_lt_u32 s70, 4
  s_cbranch_scc1 L_w1_compute
L_w1_loader:
  s_add_u32 s8, s70, s69
  s_and_b32 s8, s8, 3
  s_add_u32 s9, s70, s68
  s_and_b32 s9, s9, 3
  s_lshl_b32 s76, s8, 12
  s_lshl_b32 s77, s9, 11
  s_add_u32 s77, s77, 16384
  s_lshl_b32 s11, s68, 7
  v_and_b32 v10, 7, v1
  s_lshr_b32 s10, s76, 11
  s_lshl_b32 s3, s68, 3
  s_add_u32 s10, s10, s3
  s_mul_i32 s10, s10, 32768
  v_lshl_add_u32 v4, v1, 4, s10
  v_add_u32 v5, 32768, v4
  v_lshrrev_b32 v3, 3, v1
  s_lshl_b32 s10, s9, 4
  v_add_u32 v3, s10, v3
  v_mul_u32_u24 v3, 7168, v3
  v_lshrrev_b32 v2, 3, v1
  v_and_b32 v2, 6, v2
  v_xor_b32 v2, v2, v10
  s_mul_i32 s10, s69, 128
  v_add_u32 v3, s10, v3
  v_lshl_add_u32 v8, v2, 4, v3
  v_add_u32 v3, 57344, v3
  v_lshl_add_u32 v9, v2, 4, v3
  v_lshrrev_b32 v3, 2, v1
  s_lshl_b32 s10, s9, 4
  v_add_u32 v3, s10, v3
  v_mul_u32_u24 v3, 7168, v3
  v_bfe_u32 v2, v1, 4, 1
  v_xor_b32 v2, v2, v1
  v_and_b32 v2, 3, v2
  s_lshl_b32 s10, s69, 6
  s_add_u32 s10, s10, 2048
  v_add_u32 v3, s10, v3
  v_lshl_add_u32 v28, v2, 4, v3
  s_lshl_b32 s78, s69, 7
  s_add_u32 s78, s78, 3072
  s_mov_b32 s75, 0
  s_add_u32 s100, s68, s69
  s_mov_b32 s101, -1
  s_add_u32 s3, s68, s69
  s_and_b32 s3, s3, 3
  s_mov_b32 s100, 0x68532410
  s_mov_b32 s101, 0xfedbac97
  s_cmp_eq_u32 s3, 1
  s_cselect_b32 s100, 0x96435210, s100
  s_cselect_b32 s101, 0xfecbda87, s101
  s_cmp_eq_u32 s3, 2
  s_cselect_b32 s100, 0x75463210, s100
  s_cselect_b32 s101, 0xfdceb98a, s101
  s_cmp_eq_u32 s3, 3
  s_cselect_b32 s100, 0x65743210, s100
  s_cselect_b32 s101, 0xedfca9b8, s101
  s_waitcnt lgkmcnt(0)
  s_mov_b32 s40, s24
  s_and_b32 s41, s25, 0xffff
  s_mov_b32 s42, 7340032
  s_mov_b32 s43, 0x00020000
  s_cmp_lg_u32 s96, 0
  s_cbranch_scc1 L_pfc3_skip
  s_getpc_b64 s[4:5]
L_pfc3:
  s_lshl_b32 s3, s99, 2
  s_add_u32 s3, s3, s70
  s_sub_u32 s3, s3, 4
  s_mul_i32 s3, s3, 192
  s_min_u32 s3, s3, L_w2_c1-L_w2_c0-192
  s_add_i32 s3, s3, L_w2_c0-L_pfc3
  s_ashr_i32 s6, s3, 31
  s_add_u32 s4, s4, s3
  s_addc_u32 s5, s5, s6
  s_load_dword s84, s[4:5], 0
  s_load_dword s84, s[4:5], 64
  s_load_dword s84, s[4:5], 128
L_pfc3_skip:
  s_add_u32 s36, s34, 4194304
  s_addc_u32 s37, s35, 0
  s_and_b32 s37, s37, 0xffff
  s_mov_b32 s38, 4194304
  s_mov_b32 s39, 0x00020000
  s_add_u32 s56, s34, 24117248
  s_addc_u32 s57, s35, 0
  s_and_b32 s57, s57, 0xffff
  s_mov_b32 s58, 262144
  s_mov_b32 s59, 0x00020000
  s_add_u32 s64, s22, 24641536
  s_addc_u32 s65, s23, 0
  s_and_b32 s65, s65, 0xffff
  s_mov_b32 s66, 262144
  s_mov_b32 s67, 0x00020000
  s_mov_b32 s52, s26
  s_and_b32 s53, s27, 0xffff
  s_mov_b32 s54, 7168
  s_mov_b32 s55, 0x00020000
  s_and_b32 s3, s70, 3
  s_lshl2_add_u32 s4, s68, s3
  s_lshl_b32 s4, s4, 8
  v_lshrrev_b32 v2, 4, v1
  v_and_b32 v3, 15, v1
  v_lshl_add_u32 v3, v3, 4, s4
  v_lshl_add_u32 v18, v2, 14, v3
  s_lshl_b32 s4, s69, 7
  s_lshl_b32 s5, s70, 6
  s_add_u32 s4, s4, s5
  s_add_u32 s4, s4, 1216
  s_lshl_b32 s5, s69, 6
  s_cmp_eq_u32 s70, 4
  s_cselect_b32 s4, s5, s4
  s_lshr_b32 s5, s5, 1
  s_add_u32 s5, s5, 1024
  s_cmp_eq_u32 s70, 7
  s_cselect_b32 s4, s5, s4
  v_and_b32 v3, 15, v1
  v_lshl_add_u32 v3, v3, 2, s4
  v_lshrrev_b32 v2, 4, v1
  v_add_lshl_u32 v23, v3, v2, 1
  v_lshlrev_b32 v3, 2, v3
  v_lshl_add_u32 v22, v2, 14, v3
  s_mov_b32 s60, s28
  s_and_b32 s61, s29, 0xffff
  s_mov_b32 s62, 7340032
  s_mov_b32 s63, 0x00020000
  s_cmp_eq_u32 s96, 0
  s_cselect_b32 s62, s62, 0
  s_and_b32 s3, s70, 3
  s_lshl_b32 s4, s2, 2
  s_add_u32 s3, s3, s4
  s_mul_i32 s98, s3, 256
  s_add_u32 s98, s98, 4128768
  s_buffer_load_dword s84, s[60:63], s98 offset:0
  s_buffer_load_dword s84, s[60:63], s98 offset:64
  s_buffer_load_dword s84, s[60:63], s98 offset:128
  s_buffer_load_dword s84, s[60:63], s98 offset:192
  s_add_u32 s98, s98, 262144
  s_waitcnt vmcnt(0)
  s_barrier
  s_lshr_b32 s3, s69, 3
  s_and_b32 s73, s69, 7
  s_lshl1_add_u32 s91, s73, s3
  s_mul_i32 s74, s91, 458752
  s_lshl_b32 s73, s91, 11
  s_mov_b32 s88, s73
  s_add_u32 m0, s77, 0
  s_add_u32 s4, s74, 0
  buffer_load_dwordx4 v8, s[40:43], s4 offen lds
  s_add_u32 m0, s77, 1024
  s_nop 0
  buffer_load_dwordx4 v9, s[40:43], s4 offen lds
  s_add_u32 m0, s77, 8192
  s_add_u32 s4, s74, s78
  buffer_load_dwordx4 v8, s[40:43], s4 offen lds
  s_add_u32 m0, s77, 9216
  s_nop 0
  buffer_load_dwordx4 v9, s[40:43], s4 offen lds
  s_add_u32 m0, s77, 16384
  s_add_u32 s4, s4, 128
  buffer_load_dwordx4 v8, s[40:43], s4 offen lds
  s_add_u32 m0, s77, 17408
  s_nop 0
  buffer_load_dwordx4 v9, s[40:43], s4 offen lds
  s_add_u32 m0, s77, 24576
  s_nop 0
  buffer_load_dwordx4 v28, s[40:43], s74 offen lds
  s_and_b32 s73, s100, 15
  s_cmp_eq_u32 s73, s91
  s_cselect_b32 s74, 4, 0
  s_lshr_b64 s[100:101], s[100:101], s74
  s_and_b32 s73, s100, 15
  s_lshr_b64 s[100:101], s[100:101], 4
  s_mul_i32 s74, s73, 458752
  s_lshl_b32 s73, s73, 11
  s_add_u32 s3, s96, s70
  s_cmp_lg_u32 s3, 4
  s_cbranch_scc1 L_w1_chkNone
  s_add_u32 s44, s22, 41943040
  s_addc_u32 s45, s23, 0
  s_and_b32 s45, s45, 0xffff
  s_mov_b32 s46, 524288
  s_mov_b32 s47, 0x00020000
  v_lshrrev_b32 v2, 2, v1
  v_and_b32 v3, 3, v1
  v_lshlrev_b32 v2, 11, v2
  v_lshl_add_u32 v17, v3, 4, v2
  s_and_b32 s3, s69, 15
  s_lshl_b32 s3, s3, 7
  s_mov_b32 s79, 0x100000
L_w1_chkl:
  buffer_load_dwordx4 v[12:15], v17, s[44:47], s3 offen sc1
  s_sub_u32 s79, s79, 1
  s_cbranch_scc1 L_w1_chkNone
  s_waitcnt vmcnt(0)
  v_and_b32 v12, v12, v13
  v_and_b32 v14, v14, v15
  v_and_b32 v12, v12, v14
  v_cmp_ne_u32 vcc, 1, v12
  s_cbranch_vccnz L_w1_chkl
L_w1_chkNone:
  s_mov_b32 s75, 0
  s_add_u32 s44, s22, 41943040
  s_addc_u32 s45, s23, 0
  s_and_b32 s45, s45, 0xffff
  s_mov_b32 s46, 524288
  s_mov_b32 s47, 0x00020000
  s_lshl4_add_u32 s3, s97, s68
  s_and_b32 s4, s69, 15
  s_lshl4_add_u32 s3, s3, s4
  s_lshl_b32 s3, s3, 7
  s_sub_u32 s3, s3, 32768
  v_lshlrev_b32 v11, 7, v1
  v_and_b32 v2, 15, v1
  v_lshlrev_b32 v2, 2, v2
  s_getreg_b32 s4, hwreg(HW_REG_XCC_ID, 0, 4)
  v_add_u32 v3, 1, s4
  s_mov_b32 s79, 0x100000
  s_waitcnt vmcnt(0)
  s_cmp_lg_u32 s70, 4
  s_barrier
  s_cbranch_scc1 L_w1_nofl
  s_mov_b32 exec_lo, 0xffff
  s_mov_b32 exec_hi, 0
  buffer_store_dword v3, v11, s[44:47], s87 offen sc1
  s_mov_b64 exec, -1
L_w1_nofl:
  s_mov_b32 s5, s3
  s_mov_b32 s89, s73
  s_add_u32 m0, s77, 49152
  s_add_u32 s4, s74, 0
  buffer_load_dwordx4 v8, s[40:43], s4 offen lds
  s_add_u32 m0, s77, 50176
  s_nop 0
  buffer_load_dwordx4 v9, s[40:43], s4 offen lds
  s_add_u32 m0, s77, 57344
  s_add_u32 s4, s74, s78
  buffer_load_dwordx4 v8, s[40:43], s4 offen lds
  s_add_u32 m0, s77, 58368
  s_nop 0
  buffer_load_dwordx4 v9, s[40:43], s4 offen lds
  s_add_u32 m0, s77, 65536
  s_add_u32 s4, s4, 128
  buffer_load_dwordx4 v8, s[40:43], s4 offen lds
  s_add_u32 m0, s77, 66560
  s_nop 0
  buffer_load_dwordx4 v9, s[40:43], s4 offen lds
  s_add_u32 m0, s77, 73728
  s_nop 0
  buffer_load_dwordx4 v28, s[40:43], s74 offen lds
  s_and_b32 s73, s100, 15
  s_cmp_eq_u32 s73, s91
  s_cselect_b32 s74, 4, 0
  s_lshr_b64 s[100:101], s[100:101], s74
  s_and_b32 s73, s100, 15
  s_lshr_b64 s[100:101], s[100:101], 4
  s_mul_i32 s74, s73, 458752
  s_lshl_b32 s73, s73, 11
  s_mov_b32 s90, s73
  s_add_u32 m0, s77, 98304
  s_add_u32 s4, s74, 0
  buffer_load_dwordx4 v8, s[40:43], s4 offen lds
  s_add_u32 m0, s77, 99328
  s_nop 0
  buffer_load_dwordx4 v9, s[40:43], s4 offen lds
  s_add_u32 m0, s77, 106496
  s_add_u32 s4, s74, s78
  buffer_load_dwordx4 v8, s[40:43], s4 offen lds
  s_add_u32 m0, s77, 107520
  s_nop 0
  buffer_load_dwordx4 v9, s[40:43], s4 offen lds
  s_add_u32 m0, s77, 114688
  s_add_u32 s4, s4, 128
  buffer_load_dwordx4 v8, s[40:43], s4 offen lds
  s_add_u32 m0, s77, 115712
  s_nop 0
  buffer_load_dwordx4 v9, s[40:43], s4 offen lds
  s_add_u32 m0, s77, 122880
  s_nop 0
  buffer_load_dwordx4 v28, s[40:43], s74 offen lds
  s_and_b32 s73, s100, 15
  s_cmp_eq_u32 s73, s91
  s_cselect_b32 s74, 4, 0
  s_lshr_b64 s[100:101], s[100:101], s74
  s_and_b32 s73, s100, 15
  s_lshr_b64 s[100:101], s[100:101], 4
  s_mul_i32 s74, s73, 458752
  s_lshl_b32 s73, s73, 11
  s_mov_b32 s3, s5
  s_cmp_lg_u32 s70, 4
  s_cbranch_scc1 L_w1_dep
L_w1_poll:
  buffer_load_dword v27, v2, s[44:47], s3 offen sc1
  s_sub_u32 s79, s79, 1
  s_cbranch_scc1 L_w1_dep
  s_waitcnt vmcnt(0)
  v_cmp_eq_u32 vcc, 0, v27
  s_cbranch_vccnz L_w1_poll
L_w1_dep:
  s_waitcnt vmcnt(7)
  s_barrier
  s_add_u32 m0, s76, 49152
  s_nop 0
  buffer_load_dwordx4 v4, s[36:39], s89 offen offset:0 lds
  buffer_load_dwordx4 v4, s[36:39], s89 offen offset:1024 lds
  s_add_u32 m0, s76, 51200
  s_nop 0
  buffer_load_dwordx4 v5, s[36:39], s89 offen offset:0 lds
  buffer_load_dwordx4 v5, s[36:39], s89 offen offset:1024 lds
  s_add_u32 m0, s76, 98304
  s_nop 0
  buffer_load_dwordx4 v4, s[36:39], s90 offen offset:0 lds
  buffer_load_dwordx4 v4, s[36:39], s90 offen offset:1024 lds
  s_add_u32 m0, s76, 100352
  s_nop 0
  buffer_load_dwordx4 v5, s[36:39], s90 offen offset:0 lds
  buffer_load_dwordx4 v5, s[36:39], s90 offen offset:1024 lds
  s_waitcnt vmcnt(4)
  s_barrier
  s_mov_b32 s79, 13
L_w1_ld1:
  s_add_u32 s3, s75, s76
  s_add_u32 m0, s3, 0
  s_nop 0
  buffer_load_dwordx4 v4, s[36:39], s73 offen offset:0 lds
  buffer_load_dwordx4 v4, s[36:39], s73 offen offset:1024 lds
  s_add_u32 m0, s3, 2048
  s_nop 0
  buffer_load_dwordx4 v5, s[36:39], s73 offen offset:0 lds
  buffer_load_dwordx4 v5, s[36:39], s73 offen offset:1024 lds
  s_add_u32 s3, s75, s77
  s_add_u32 m0, s3, 0
  s_add_u32 s4, s74, 0
  buffer_load_dwordx4 v8, s[40:43], s4 offen lds
  s_add_u32 m0, s3, 1024
  s_nop 0
  buffer_load_dwordx4 v9, s[40:43], s4 offen lds
  s_add_u32 m0, s3, 8192
  s_add_u32 s4, s74, s78
  buffer_load_dwordx4 v8, s[40:43], s4 offen lds
  s_add_u32 m0, s3, 9216
  s_nop 0
  buffer_load_dwordx4 v9, s[40:43], s4 offen lds
  s_add_u32 m0, s3, 16384
  s_add_u32 s4, s4, 128
  buffer_load_dwordx4 v8, s[40:43], s4 offen lds
  s_add_u32 m0, s3, 17408
  s_nop 0
  buffer_load_dwordx4 v9, s[40:43], s4 offen lds
  s_add_u32 m0, s3, 24576
  s_nop 0
  buffer_load_dwordx4 v28, s[40:43], s74 offen lds
  s_and_b32 s73, s100, 15
  s_cmp_eq_u32 s73, s91
  s_cselect_b32 s74, 4, 0
  s_lshr_b64 s[100:101], s[100:101], s74
  s_and_b32 s73, s100, 15
  s_lshr_b64 s[100:101], s[100:101], 4
  s_mul_i32 s74, s73, 458752
  s_lshl_b32 s73, s73, 11
  s_add_u32 s75, s75, 49152
  s_cmp_eq_u32 s75, 147456
  s_cselect_b32 s75, 0, s75
  s_buffer_load_dword s84, s[60:63], s98 offset:0
  s_buffer_load_dword s84, s[60:63], s98 offset:64
  s_buffer_load_dword s84, s[60:63], s98 offset:128
  s_buffer_load_dword s84, s[60:63], s98 offset:192
  s_add_u32 s98, s98, 262144
  s_waitcnt vmcnt(11)
  s_barrier
  s_sub_u32 s79, s79, 1
  s_cmp_lg_u32 s79, 0
  s_cbranch_scc1 L_w1_ld1
  buffer_load_dwordx4 v[32:35], v18, s[56:59], 0 offen
  s_mov_b32 s3, 65536
  buffer_load_dwordx4 v[36:39], v18, s[56:59], s3 offen
  s_mov_b32 s3, 131072
  buffer_load_dwordx4 v[40:43], v18, s[56:59], s3 offen
  s_mov_b32 s3, 196608
  buffer_load_dwordx4 v[44:47], v18, s[56:59], s3 offen
  s_cmp_lg_u32 s96, 0
  s_cbranch_scc1 L_w1_cl
  buffer_load_dwordx4 v[64:67], v22, s[64:67], 0 offen
  s_mov_b32 s3, 65536
  buffer_load_dwordx4 v[68:71], v22, s[64:67], s3 offen
  s_mov_b32 s3, 131072
  buffer_load_dwordx4 v[72:75], v22, s[64:67], s3 offen
  s_mov_b32 s3, 196608
  buffer_load_dwordx4 v[76:79], v22, s[64:67], s3 offen
  buffer_load_ushort v80, v23, s[52:55], 0 offen
  s_branch L_w1_cle
  L_w1_cl:
  s_waitcnt vmcnt(4)
  L_w1_cle:
  s_waitcnt vmcnt(9)
  s_barrier
  s_waitcnt vmcnt(0)
  s_cmp_lg_u32 s96, 0
  s_cbranch_scc1 L_w1_cp
  s_and_b32 s3, s70, 3
  s_lshl_b32 s5, s3, 9
  s_add_u32 s5, s5, 106496
  v_lshrrev_b32 v2, 5, v1
  v_and_b32 v3, 15, v1
  v_lshl_add_u32 v2, v3, 1, v2
  v_lshl_add_u32 v205, v2, 4, s5
  v_add_f32 v64, v64, v68
  v_add_f32 v65, v65, v69
  v_add_f32 v66, v66, v70
  v_add_f32 v67, v67, v71
  v_add_f32 v72, v72, v76
  v_add_f32 v73, v73, v77
  v_add_f32 v74, v74, v78
  v_add_f32 v75, v75, v79
  v_add_f32 v64, v64, v72
  v_add_f32 v65, v65, v73
  v_add_f32 v66, v66, v74
  v_add_f32 v67, v67, v75
  s_nop 1
  v_permlane32_swap_b32 v64, v66
  v_permlane32_swap_b32 v65, v67
  v_add_f32 v64, v64, v66
  v_add_f32 v65, v65, v67
  v_lshl_or_b32 v203, v80, 16, v80
  s_lshl_b32 s5, s3, 10
  s_add_u32 s5, s5, 110592
  v_permlane16_swap_b32 v64, v65
  v_lshrrev_b32 v2, 4, v1
  v_lshl_add_u32 v2, v3, 2, v2
  v_lshl_add_u32 v204, v2, 4, s5
  v_add_f32 v64, v64, v65
  v_cvt_pk_bf16_f32 v200, v64, v64
  v_and_b32 v65, 0xffff0000, v200
  v_sub_f32 v65, v64, v65
  v_cvt_pk_bf16_f32 v201, v64, v65
  v_and_b32 v202, 0xffff0000, v201
  v_sub_f32 v65, v65, v202
  v_cvt_pk_bf16_f32 v202, v65, v64
  v_mov_b32 v200, v201
  L_w1_cp:
  ds_write_b128 v204, v[200:203]
  v_add_f32 v32, v32, v36
  v_add_f32 v33, v33, v37
  v_add_f32 v34, v34, v38
  v_add_f32 v35, v35, v39
  v_add_f32 v40, v40, v44
  v_add_f32 v41, v41, v45
  v_add_f32 v42, v42, v46
  v_add_f32 v43, v43, v47
  v_add_f32 v32, v32, v40
  v_add_f32 v33, v33, v41
  v_add_f32 v34, v34, v42
  v_add_f32 v35, v35, v43
  s_nop 1
  v_permlane32_swap_b32 v32, v34
  v_permlane32_swap_b32 v33, v35
  v_add_f32 v32, v32, v34
  v_add_f32 v33, v33, v35
  v_mov_b32 v34, v32
  v_mov_b32 v35, v33
  s_nop 0
  v_permlane16_swap_b32 v32, v34
  v_permlane16_swap_b32 v33, v35
  v_add_f32 v32, v32, v34
  v_add_f32 v33, v33, v35
  v_mul_f32 v32, 0x3a800000, v32
  v_mul_f32 v33, 0x3a800000, v33
  v_fma_f32 v33, -v32, v32, v33
  v_max_f32 v33, 0, v33
  v_add_f32 v33, 0x3727c5ac, v33
  v_rsq_f32 v34, v33
  v_mul_f32 v32, -0.5, v32
  v_cvt_pk_bf16_f32 v36, v32, v32
  v_and_b32 v35, 0xffff0000, v36
  v_sub_f32 v35, v32, v35
  v_cvt_pk_bf16_f32 v37, v35, v35
  v_and_b32 v38, 0xffff0000, v37
  v_sub_f32 v35, v35, v38
  v_cvt_pk_bf16_f32 v38, v32, v35
  v_mul_f32 v42, v33, v34
  v_mul_f32 v40, 0xc0135761, v34
  v_mul_f32 v34, v34, v34
  v_mul_f32 v33, 0.5, v42
  v_mul_f32 v34, 0x3d372713, v34
  v_cvt_pk_bf16_f32 v35, v33, v33
  v_mul_f32 v41, v40, v34
  v_and_b32 v35, 0xffff0000, v35
  v_xor_b32_dpp v43, v27, v27 row_ror:2 row_mask:0xf bank_mask:0xf
  v_sub_f32 v35, v33, v35
  v_cmp_ne_u32 vcc, 0, v43
  v_cvt_pk_bf16_f32 v39, v33, v35
  s_or_b32 s92, vcc_lo, vcc_hi
  v_mov_b32 v43, s92
  ds_write_b128 v205, v[36:39]
  ds_write_b128 v205, v[40:43] offset:2048
  s_waitcnt lgkmcnt(0)
  s_barrier
  s_lshl_b32 s87, s97, 15
  s_lshl_b32 s4, s68, 11
  s_add_u32 s87, s87, s4
  s_lshl_b32 s4, s69, 2
  s_add_u32 s87, s87, s4
  s_add_u32 s97, s97, 1
  s_branch L_w2_body
L_w1_end:
  s_endpgm
L_w1_compute:
  s_and_b32 s71, s70, 1
  s_lshr_b32 s72, s70, 1
  v_and_b32 v3, 15, v1
  v_lshrrev_b32 v2, 4, v1
  s_lshl_b32 s8, s71, 13
  v_lshl_add_u32 v4, v1, 4, s8
  v_lshrrev_b32 v13, 2, v1
  v_lshlrev_b32 v13, 7, v13
  v_and_b32 v17, 3, v1
  v_lshl_add_u32 v13, v17, 3, v13
  v_bfe_u32 v17, v1, 3, 2
  v_lshl_add_u32 v13, v17, 5, v13
  s_lshl_b32 s9, s72, 6
  v_xor_b32 v13, s9, v13
  v_add_u32 v5, 16384, v13
  v_xor_b32 v6, 32, v5
  v_and_b32 v16, 1, v2
  v_lshrrev_b32 v17, 1, v2
  v_lshrrev_b32 v13, 2, v1
  v_and_b32 v14, 1, v1
  v_lshl_add_u32 v13, v13, 1, v14
  v_xor_b32 v14, s72, v16
  v_lshl_add_u32 v13, v13, 1, v14
  v_bfe_u32 v14, v1, 1, 1
  v_lshl_add_u32 v13, v13, 1, v14
  v_lshlrev_b32 v13, 3, v13
  v_add_u32 v7, 40960, v13
  s_mov_b32 s75, 0
  v_add_u32_e64 v20, s75, v4
  v_add_u32_e64 v21, s75, v5
  v_add_u32_e64 v22, s75, v6
  v_add_u32_e64 v23, s75, v7
  s_add_u32 s75, s75, 49152
  s_cmp_eq_u32 s75, 147456
  s_cselect_b32 s75, 0, s75
  s_mov_b32 s79, 14
  ds_read_b128 v[32:35], v20 offset:0
  ds_read_b128 v[36:39], v20 offset:2048
  ds_read_b128 v[40:43], v20 offset:4096
  ds_read_b128 v[44:47], v20 offset:6144
  ds_read_b64_tr_b16 v[48:49], v21 offset:0
  ds_read_b64_tr_b16 v[50:51], v21 offset:2048
  ds_read_b64_tr_b16 v[52:53], v22 offset:0
  ds_read_b64_tr_b16 v[54:55], v22 offset:2048
  ds_read_b64_tr_b16 v[56:57], v21 offset:8192
  ds_read_b64_tr_b16 v[58:59], v21 offset:10240
  ds_read_b64_tr_b16 v[60:61], v22 offset:8192
  ds_read_b64_tr_b16 v[62:63], v22 offset:10240
  ds_read_b64_tr_b16 v[64:65], v21 offset:16384
  ds_read_b64_tr_b16 v[66:67], v21 offset:18432
  ds_read_b64_tr_b16 v[68:69], v22 offset:16384
  ds_read_b64_tr_b16 v[70:71], v22 offset:18432
  ds_read_b64_tr_b16 v[72:73], v23 offset:0
  ds_read_b64_tr_b16 v[74:75], v23 offset:2048
  s_waitcnt lgkmcnt(0)
  v_mfma_f32_16x16x32_bf16 v[128:131], v[48:51], v[32:35], 0
  ds_read_b128 v[80:83], v20 offset:1024
  v_mfma_f32_16x16x32_bf16 v[132:135], v[48:51], v[36:39], 0
  ds_read_b128 v[84:87], v20 offset:3072
  v_mfma_f32_16x16x32_bf16 v[136:139], v[48:51], v[40:43], 0
  ds_read_b128 v[88:91], v20 offset:5120
  v_mfma_f32_16x16x32_bf16 v[140:143], v[48:51], v[44:47], 0
  ds_read_b128 v[92:95], v20 offset:7168
  v_mfma_f32_16x16x32_bf16 v[156:159], v[52:55], v[44:47], 0
  ds_read_b64_tr_b16 v[96:97], v21 offset:4096
  v_mfma_f32_16x16x32_bf16 v[152:155], v[52:55], v[40:43], 0
  ds_read_b64_tr_b16 v[98:99], v21 offset:6144
  v_mfma_f32_16x16x32_bf16 v[148:151], v[52:55], v[36:39], 0
  ds_read_b64_tr_b16 v[100:101], v22 offset:4096
  v_mfma_f32_16x16x32_bf16 v[144:147], v[52:55], v[32:35], 0
  ds_read_b64_tr_b16 v[102:103], v22 offset:6144
  v_mfma_f32_16x16x32_bf16 v[160:163], v[56:59], v[32:35], 0
  ds_read_b64_tr_b16 v[104:105], v21 offset:12288
  v_mfma_f32_16x16x32_bf16 v[164:167], v[56:59], v[36:39], 0
  ds_read_b64_tr_b16 v[106:107], v21 offset:14336
  v_mfma_f32_16x16x32_bf16 v[168:171], v[56:59], v[40:43], 0
  ds_read_b64_tr_b16 v[108:109], v22 offset:12288
  v_mfma_f32_16x16x32_bf16 v[172:175], v[56:59], v[44:47], 0
  ds_read_b64_tr_b16 v[110:111], v22 offset:14336
  v_mfma_f32_16x16x32_bf16 v[188:191], v[60:63], v[44:47], 0
  ds_read_b64_tr_b16 v[112:113], v21 offset:20480
  v_mfma_f32_16x16x32_bf16 v[184:187], v[60:63], v[40:43], 0
  ds_read_b64_tr_b16 v[114:115], v21 offset:22528
  v_mfma_f32_16x16x32_bf16 v[180:183], v[60:63], v[36:39], 0
  ds_read_b64_tr_b16 v[116:117], v22 offset:20480
  v_mfma_f32_16x16x32_bf16 v[176:179], v[60:63], v[32:35], 0
  ds_read_b64_tr_b16 v[118:119], v22 offset:22528
  v_mfma_f32_16x16x32_bf16 v[192:195], v[64:67], v[32:35], 0
  ds_read_b64_tr_b16 v[120:121], v23 offset:4096
  v_mfma_f32_16x16x32_bf16 v[196:199], v[64:67], v[36:39], 0
  ds_read_b64_tr_b16 v[122:123], v23 offset:6144
  v_mfma_f32_16x16x32_bf16 v[200:203], v[64:67], v[40:43], 0
  v_add_u32_e64 v20, s75, v4
  v_mfma_f32_16x16x32_bf16 v[204:207], v[64:67], v[44:47], 0
  v_add_u32_e64 v21, s75, v5
  v_mfma_f32_16x16x32_bf16 v[220:223], v[68:71], v[44:47], 0
  v_add_u32_e64 v22, s75, v6
  v_mfma_f32_16x16x32_bf16 v[216:219], v[68:71], v[40:43], 0
  v_add_u32_e64 v23, s75, v7
  v_mfma_f32_16x16x32_bf16 v[212:215], v[68:71], v[36:39], 0
  s_add_u32 s75, s75, 49152
  v_mfma_f32_16x16x32_bf16 v[208:211], v[68:71], v[32:35], 0
  s_cmp_eq_u32 s75, 147456
  v_mfma_f32_16x16x32_bf16 v[224:227], v[72:75], v[32:35], 0
  s_cselect_b32 s75, 0, s75
  v_mfma_f32_16x16x32_bf16 v[228:231], v[72:75], v[36:39], 0
  v_mfma_f32_16x16x32_bf16 v[232:235], v[72:75], v[40:43], 0
  v_mfma_f32_16x16x32_bf16 v[236:239], v[72:75], v[44:47], 0
  s_waitcnt lgkmcnt(0)
  v_mfma_f32_16x16x32_bf16 v[128:131], v[96:99], v[80:83], v[128:131]
  v_mfma_f32_16x16x32_bf16 v[132:135], v[96:99], v[84:87], v[132:135]
  v_mfma_f32_16x16x32_bf16 v[136:139], v[96:99], v[88:91], v[136:139]
  v_mfma_f32_16x16x32_bf16 v[140:143], v[96:99], v[92:95], v[140:143]
  v_mfma_f32_16x16x32_bf16 v[156:159], v[100:103], v[92:95], v[156:159]
  v_mfma_f32_16x16x32_bf16 v[152:155], v[100:103], v[88:91], v[152:155]
  v_mfma_f32_16x16x32_bf16 v[148:151], v[100:103], v[84:87], v[148:151]
  v_mfma_f32_16x16x32_bf16 v[144:147], v[100:103], v[80:83], v[144:147]
  v_mfma_f32_16x16x32_bf16 v[160:163], v[104:107], v[80:83], v[160:163]
  v_mfma_f32_16x16x32_bf16 v[164:167], v[104:107], v[84:87], v[164:167]
  v_mfma_f32_16x16x32_bf16 v[168:171], v[104:107], v[88:91], v[168:171]
  v_mfma_f32_16x16x32_bf16 v[172:175], v[104:107], v[92:95], v[172:175]
  v_mfma_f32_16x16x32_bf16 v[188:191], v[108:111], v[92:95], v[188:191]
  v_mfma_f32_16x16x32_bf16 v[184:187], v[108:111], v[88:91], v[184:187]
  v_mfma_f32_16x16x32_bf16 v[180:183], v[108:111], v[84:87], v[180:183]
  v_mfma_f32_16x16x32_bf16 v[176:179], v[108:111], v[80:83], v[176:179]
  v_mfma_f32_16x16x32_bf16 v[192:195], v[112:115], v[80:83], v[192:195]
  v_mfma_f32_16x16x32_bf16 v[196:199], v[112:115], v[84:87], v[196:199]
  v_mfma_f32_16x16x32_bf16 v[200:203], v[112:115], v[88:91], v[200:203]
  v_mfma_f32_16x16x32_bf16 v[204:207], v[112:115], v[92:95], v[204:207]
  v_mfma_f32_16x16x32_bf16 v[220:223], v[116:119], v[92:95], v[220:223]
  v_mfma_f32_16x16x32_bf16 v[216:219], v[116:119], v[88:91], v[216:219]
  v_mfma_f32_16x16x32_bf16 v[212:215], v[116:119], v[84:87], v[212:215]
  v_mfma_f32_16x16x32_bf16 v[208:211], v[116:119], v[80:83], v[208:211]
  v_mfma_f32_16x16x32_bf16 v[224:227], v[120:123], v[80:83], v[224:227]
  v_mfma_f32_16x16x32_bf16 v[228:231], v[120:123], v[84:87], v[228:231]
  v_mfma_f32_16x16x32_bf16 v[232:235], v[120:123], v[88:91], v[232:235]
  v_mfma_f32_16x16x32_bf16 v[236:239], v[120:123], v[92:95], v[236:239]
  s_lshl_b32 s8, s68, 7
  s_lshl_b32 s9, s71, 6
  s_add_u32 s8, s8, s9
  s_mul_i32 s8, s8, 7168
  v_lshlrev_b32 v14, 8, v17
  v_lshl_add_u32 v14, v3, 4, v14
  s_lshl3_add_u32 s9, s71, s72
  s_lshl_b32 s9, s9, 10
  s_add_u32 s9, s9, 114688
  v_lshl_add_u32 v18, v1, 4, s9
  s_mov_b32 s52, s30
  s_and_b32 s53, s31, 0xffff
  s_mov_b32 s54, 2048
  s_mov_b32 s55, 0x00020000
  s_lshr_b32 s9, s69, 3
  s_and_b32 s10, s69, 7
  s_lshl1_add_u32 s9, s10, s9
  s_lshl_b32 s9, s9, 7
  v_lshl_add_u32 v19, v2, 3, s9
  v_add_u32 v14, s8, v14
  s_lshl_b32 s10, s69, 11
  s_lshl_b32 s9, s72, 10
  s_add_u32 s9, s9, s10
  v_lshl_add_u32 v12, v1, 4, s8
  v_add_u32 v12, s9, v12
  v_mul_u32_u24 v16, 114688, v16
  s_lshr_b32 s9, s9, 1
  v_add3_u32 v13, v16, v14, s9
  s_lshl_b32 s9, s71, 10
  s_add_u32 s9, s9, 106496
  v_lshl_add_u32 v14, v3, 4, s9
  s_lshl_b32 s9, s72, 9
  s_add_u32 s9, s9, 110592
  v_lshl_add_u32 v15, v3, 4, s9
  v_bfe_u32 v16, v1, 2, 1
  v_bfe_u32 v17, v1, 3, 1
  v_lshl_add_u32 v17, v16, 2, v17
  v_and_b32 v16, 3, v1
  v_lshl_add_u32 v17, v17, 2, v16
  s_lshl_b32 s9, s72, 7
  s_add_u32 s9, s9, 110592
  v_lshl_add_u32 v16, v17, 4, s9
  v_bfe_u32 v17, v1, 4, 1
  v_lshl_add_u32 v14, v17, 3, v14
  v_lshl_add_u32 v15, v17, 3, v15
  v_lshl_add_u32 v16, v17, 3, v16
  v_mov_b32 v17, 108556
  s_add_u32 s44, s34, 8388608
  s_addc_u32 s45, s35, 0
  s_and_b32 s45, s45, 0xffff
  s_mov_b32 s46, 14680064
  s_mov_b32 s47, 0x00020000
  s_lshr_b32 s3, s69, 3
  s_and_b32 s78, s69, 7
  s_lshl1_add_u32 s69, s78, s3
  s_add_u32 s3, s68, s78
  s_and_b32 s3, s3, 3
  s_mov_b32 s4, 0x1616160
  s_cmp_eq_u32 s3, 1
  s_cselect_b32 s4, 0x5858580, s4
  s_cmp_eq_u32 s3, 2
  s_cselect_b32 s4, 0x16161600, s4
  s_cmp_eq_u32 s3, 3
  s_cselect_b32 s4, 0x58585800, s4
  v_subrev_u32 v2, 3, v1
  v_min_u32 v2, 16, v2
  v_lshlrev_b32 v3, 1, v2
  v_bfe_i32 v30, s4, v3, 2
  v_sub_u32 v30, v1, v30
  v_subrev_u32 v30, 7, v30
  v_ashrrev_i32 v3, 1, v30
  v_cmp_eq_u32 vcc, s78, v3
  s_and_b32 s3, s69, 1
  v_or_b32 v2, 14, v30
  v_cndmask_b32 v2, v30, v2, vcc
  v_cmp_gt_i32 vcc, 0, v30
  s_lshl2_add_u32 s4, s3, 20
  v_add_u32 v30, s4, v30
  s_lshl4_add_u32 s4, s3, 24
  v_add_u32 v2, s4, v2
  v_cndmask_b32 v30, v2, v30, vcc
  s_and_b32 s5, s68, 3
  s_mul_i32 s5, s5, 3
  s_sub_u32 s5, s5, 23
  v_add_u32 v3, s5, v1
  v_subrev_u32 v2, 10, v3
  v_min_u32 v3, v3, v2
  v_subrev_u32 v2, 10, v3
  v_min_u32 v3, v3, v2
  v_cmp_gt_u32 vcc, 23, v1
  s_sub_u32 s5, s3, 46
  v_lshl_add_u32 v2, v1, 1, s5
  v_cndmask_b32 v3, v3, v2, vcc
  s_add_u32 s5, s78, 3
  v_ashrrev_i32 v2, 1, v3
  v_add_u32 v2, s5, v2
  v_and_b32 v2, 7, v2
  v_cmp_gt_u32 vcc, 21, v1
  v_and_b32 v3, 1, v3
  v_lshl_add_u32 v3, v3, 3, v2
  v_cndmask_b32 v3, v3, v30, vcc
  v_lshlrev_b32 v30, 11, v3
  s_barrier
  ds_read_b64_tr_b16 v[48:49], v21 offset:0
  ds_read_b64_tr_b16 v[50:51], v21 offset:2048
  ds_read_b64_tr_b16 v[96:97], v21 offset:4096
  ds_read_b64_tr_b16 v[98:99], v21 offset:6144
  ds_read_b64_tr_b16 v[100:101], v22 offset:4096
  ds_read_b64_tr_b16 v[102:103], v22 offset:6144
  ds_read_b64_tr_b16 v[52:53], v22 offset:0
  ds_read_b64_tr_b16 v[54:55], v22 offset:2048
  ds_read_b64_tr_b16 v[56:57], v21 offset:8192
  ds_read_b64_tr_b16 v[58:59], v21 offset:10240
  ds_read_b64_tr_b16 v[104:105], v21 offset:12288
  ds_read_b64_tr_b16 v[106:107], v21 offset:14336
  ds_read_b64_tr_b16 v[60:61], v22 offset:8192
  ds_read_b64_tr_b16 v[62:63], v22 offset:10240
  ds_read_b64_tr_b16 v[108:109], v22 offset:12288
  ds_read_b64_tr_b16 v[110:111], v22 offset:14336
  v_and_b32 v3, 15, v1
  v_lshrrev_b32 v2, 4, v1
  s_lshl_b32 s8, s68, 7
  s_lshl_b32 s9, s70, 5
  s_add_u32 s8, s8, s9
  v_add_u32 v76, s8, v3
  s_lshl_b32 s14, s69, 7
  v_lshrrev_b32 v79, 1, v2
  v_lshlrev_b32 v26, 3, v3
  v_and_b32 v26, 0x70, v26
  v_lshlrev_b32 v78, 3, v2
  v_xor_b32 v26, v26, v78
  v_lshl_add_u32 v26, v3, 7, v26
  s_lshl_b32 s3, s70, 12
  v_add_u32 v26, s3, v26
  v_lshl_add_u32 v27, v1, 4, s3
  s_cmp_eq_u32 s96, 0
  s_cselect_b32 s7, 128, 0
  s_add_u32 s7, s7, 2048
  v_xor_b32 v78, v1, v2
  v_and_b32 v78, 7, v78
  v_lshl_add_u32 v78, v78, 4, s14
  v_lshrrev_b32 v77, 3, v1
  v_add_u32 v77, s8, v77
  v_mad_u32_u24 v28, v77, s7, v78
  v_bfe_u32 v78, v1, 2, 2
  v_xor_b32 v78, v78, v2
  v_lshl_add_u32 v29, v78, 17, v76
  s_lshl_b32 s14, s69, 14
  v_lshl_add_u32 v29, v29, 3, s14
  v_lshrrev_b32 v8, 2, v1
  v_lshlrev_b32 v8, 7, v8
  v_and_b32 v79, 3, v1
  v_lshl_add_u32 v8, v79, 3, v8
  v_bfe_u32 v79, v1, 3, 2
  v_lshl_add_u32 v8, v79, 5, v8
  s_mov_b32 s11, 0xffff0000
  s_add_u32 s36, s34, 8388608
  s_addc_u32 s37, s35, 0
  s_and_b32 s37, s37, 0xffff
  s_mov_b32 s40, s32
  s_and_b32 s41, s33, 0xffff
  s_mov_b32 s43, 0x00020000
  s_add_u32 s48, s22, 33554432
  s_addc_u32 s49, s23, 0
  s_and_b32 s49, s49, 0xffff
  s_cmp_eq_u32 s96, 0
  s_cselect_b64 s[40:41], s[48:49], s[40:41]
  s_lshl_b32 s42, s7, 11
  s_add_u32 s56, s34, 24379392
  s_addc_u32 s57, s35, 0
  s_and_b32 s57, s57, 0xffff
  s_mov_b32 s58, 262144
  s_mov_b32 s59, 0x00020000
  s_mul_i32 s9, s8, 7168
  s_add_u32 s36, s36, s9
  s_addc_u32 s37, s37, 0x100000
  s_add_u32 s64, s36, 114688
  s_addc_u32 s65, s37, 0
  s_mov_b32 s38, 114688
  s_mov_b32 s39, 0x00800000
  s_mov_b32 s66, 114688
  s_mov_b32 s67, 0x00800000
  s_add_u32 s60, s34, 25165824
  s_addc_u32 s61, s35, 0
  s_and_b32 s61, s61, 0xffff
  s_mov_b32 s62, 4194304
  s_or_b32 s61, s61, 0x100000
  s_mov_b32 s63, 0x00800000
  s_lshl4_add_u32 s4, s68, s69
  s_lshl2_add_u32 s4, s4, s70
  s_add_u32 s6, s96, 4
  s_lshl_b32 s6, s6, 10
  s_add_u32 s6, s6, s4
  s_lshl_b32 s6, s6, 6
  s_lshl_b32 s4, s4, 12
  s_xor_b32 s5, s4, 16384
  v_readlane_b32 s51, v30, 3
  v_readlane_b32 s48, v30, 4
  v_readlane_b32 s49, v30, 5
  s_barrier
  ds_read_b128 v[32:35], v20 offset:0
  ds_read_b128 v[80:83], v20 offset:1024
  ds_read_b128 v[36:39], v20 offset:2048
  ds_read_b128 v[84:87], v20 offset:3072
  ds_read_b128 v[40:43], v20 offset:4096
  ds_read_b128 v[88:91], v20 offset:5120
.p2align 5
  s_nop 0
  s_nop 0
  s_nop 0
  s_waitcnt lgkmcnt(0)
L_w1_loop:
  v_mfma_f32_16x16x32_bf16 v[128:131], v[48:51], v[32:35], v[128:131]
  ds_read_b128 v[92:95], v20 offset:7168
  v_mfma_f32_16x16x32_bf16 v[128:131], v[96:99], v[80:83], v[128:131]
  ds_read_b128 v[44:47], v20 offset:6144
  v_mfma_f32_16x16x32_bf16 v[144:147], v[100:103], v[80:83], v[144:147]
  ds_read_b64_tr_b16 v[64:65], v21 offset:16384
  v_mfma_f32_16x16x32_bf16 v[144:147], v[52:55], v[32:35], v[144:147]
  ds_read_b64_tr_b16 v[66:67], v21 offset:18432
  s_waitcnt lgkmcnt(6)
  s_nop 0
  v_mfma_f32_16x16x32_bf16 v[148:151], v[52:55], v[36:39], v[148:151]
  ds_read_b64_tr_b16 v[112:113], v21 offset:20480
  v_mfma_f32_16x16x32_bf16 v[148:151], v[100:103], v[84:87], v[148:151]
  ds_read_b64_tr_b16 v[114:115], v21 offset:22528
  v_mfma_f32_16x16x32_bf16 v[132:135], v[96:99], v[84:87], v[132:135]
  ds_read_b64_tr_b16 v[68:69], v22 offset:16384
  v_mfma_f32_16x16x32_bf16 v[132:135], v[48:51], v[36:39], v[132:135]
  ds_read_b64_tr_b16 v[70:71], v22 offset:18432
  s_waitcnt lgkmcnt(8)
  s_nop 0
  v_mfma_f32_16x16x32_bf16 v[136:139], v[48:51], v[40:43], v[136:139]
  ds_read_b64_tr_b16 v[116:117], v22 offset:20480
  v_mfma_f32_16x16x32_bf16 v[136:139], v[96:99], v[88:91], v[136:139]
  ds_read_b64_tr_b16 v[118:119], v22 offset:22528
  v_mfma_f32_16x16x32_bf16 v[152:155], v[100:103], v[88:91], v[152:155]
  ds_read_b64_tr_b16 v[120:121], v23 offset:4096
  v_mfma_f32_16x16x32_bf16 v[152:155], v[52:55], v[40:43], v[152:155]
  ds_read_b64_tr_b16 v[122:123], v23 offset:6144
  s_waitcnt lgkmcnt(10)
  s_nop 0
  v_mfma_f32_16x16x32_bf16 v[156:159], v[52:55], v[44:47], v[156:159]
  ds_read_b64_tr_b16 v[72:73], v23 offset:0
  v_mfma_f32_16x16x32_bf16 v[156:159], v[100:103], v[92:95], v[156:159]
  ds_read_b64_tr_b16 v[74:75], v23 offset:2048
  v_mfma_f32_16x16x32_bf16 v[140:143], v[96:99], v[92:95], v[140:143]
  v_add_u32_e64 v20, s75, v4
  v_mfma_f32_16x16x32_bf16 v[140:143], v[48:51], v[44:47], v[140:143]
  v_add_u32_e64 v21, s75, v5
  v_mfma_f32_16x16x32_bf16 v[172:175], v[56:59], v[44:47], v[172:175]
  v_add_u32_e64 v22, s75, v6
  v_mfma_f32_16x16x32_bf16 v[172:175], v[104:107], v[92:95], v[172:175]
  v_add_u32_e64 v23, s75, v7
  v_mfma_f32_16x16x32_bf16 v[168:171], v[104:107], v[88:91], v[168:171]
  s_add_u32 s75, s75, 49152
  v_mfma_f32_16x16x32_bf16 v[168:171], v[56:59], v[40:43], v[168:171]
  s_cmp_eq_u32 s75, 147456
  v_mfma_f32_16x16x32_bf16 v[164:167], v[56:59], v[36:39], v[164:167]
  s_cselect_b32 s75, 0, s75
  s_sub_u32 s79, s79, 1
  v_mfma_f32_16x16x32_bf16 v[164:167], v[104:107], v[84:87], v[164:167]
  v_mfma_f32_16x16x32_bf16 v[160:163], v[104:107], v[80:83], v[160:163]
  v_mfma_f32_16x16x32_bf16 v[160:163], v[56:59], v[32:35], v[160:163]
  v_mfma_f32_16x16x32_bf16 v[176:179], v[60:63], v[32:35], v[176:179]
  v_mfma_f32_16x16x32_bf16 v[176:179], v[108:111], v[80:83], v[176:179]
  v_mfma_f32_16x16x32_bf16 v[180:183], v[108:111], v[84:87], v[180:183]
  v_mfma_f32_16x16x32_bf16 v[180:183], v[60:63], v[36:39], v[180:183]
  s_waitcnt lgkmcnt(0)
  s_barrier
  v_mfma_f32_16x16x32_bf16 v[184:187], v[60:63], v[40:43], v[184:187]
  ds_read_b64_tr_b16 v[48:49], v21 offset:0
  v_mfma_f32_16x16x32_bf16 v[184:187], v[108:111], v[88:91], v[184:187]
  ds_read_b64_tr_b16 v[50:51], v21 offset:2048
  v_mfma_f32_16x16x32_bf16 v[188:191], v[108:111], v[92:95], v[188:191]
  ds_read_b64_tr_b16 v[96:97], v21 offset:4096
  v_mfma_f32_16x16x32_bf16 v[188:191], v[60:63], v[44:47], v[188:191]
  ds_read_b64_tr_b16 v[98:99], v21 offset:6144
  v_mfma_f32_16x16x32_bf16 v[204:207], v[64:67], v[44:47], v[204:207]
  ds_read_b64_tr_b16 v[100:101], v22 offset:4096
  v_mfma_f32_16x16x32_bf16 v[204:207], v[112:115], v[92:95], v[204:207]
  ds_read_b64_tr_b16 v[102:103], v22 offset:6144
  v_mfma_f32_16x16x32_bf16 v[200:203], v[112:115], v[88:91], v[200:203]
  ds_read_b64_tr_b16 v[52:53], v22 offset:0
  v_mfma_f32_16x16x32_bf16 v[200:203], v[64:67], v[40:43], v[200:203]
  ds_read_b64_tr_b16 v[54:55], v22 offset:2048
  v_mfma_f32_16x16x32_bf16 v[196:199], v[64:67], v[36:39], v[196:199]
  ds_read_b64_tr_b16 v[56:57], v21 offset:8192
  v_mfma_f32_16x16x32_bf16 v[196:199], v[112:115], v[84:87], v[196:199]
  ds_read_b64_tr_b16 v[58:59], v21 offset:10240
  v_mfma_f32_16x16x32_bf16 v[192:195], v[112:115], v[80:83], v[192:195]
  ds_read_b64_tr_b16 v[104:105], v21 offset:12288
  v_mfma_f32_16x16x32_bf16 v[192:195], v[64:67], v[32:35], v[192:195]
  ds_read_b64_tr_b16 v[106:107], v21 offset:14336
  v_mfma_f32_16x16x32_bf16 v[208:211], v[68:71], v[32:35], v[208:211]
  ds_read_b64_tr_b16 v[60:61], v22 offset:8192
  v_mfma_f32_16x16x32_bf16 v[208:211], v[116:119], v[80:83], v[208:211]
  ds_read_b64_tr_b16 v[62:63], v22 offset:10240
  v_mfma_f32_16x16x32_bf16 v[224:227], v[120:123], v[80:83], v[224:227]
  ds_read_b128 v[80:83], v20 offset:1024
  v_mfma_f32_16x16x32_bf16 v[224:227], v[72:75], v[32:35], v[224:227]
  ds_read_b128 v[32:35], v20 offset:0
  v_mfma_f32_16x16x32_bf16 v[228:231], v[72:75], v[36:39], v[228:231]
  ds_read_b64_tr_b16 v[108:109], v22 offset:12288
  v_mfma_f32_16x16x32_bf16 v[228:231], v[120:123], v[84:87], v[228:231]
  ds_read_b64_tr_b16 v[110:111], v22 offset:14336
  v_mfma_f32_16x16x32_bf16 v[212:215], v[116:119], v[84:87], v[212:215]
  ds_read_b128 v[84:87], v20 offset:3072
  v_mfma_f32_16x16x32_bf16 v[212:215], v[68:71], v[36:39], v[212:215]
  ds_read_b128 v[36:39], v20 offset:2048
  v_mfma_f32_16x16x32_bf16 v[216:219], v[68:71], v[40:43], v[216:219]
  s_cmp_lg_u32 s79, 0
  s_nop 0
  v_mfma_f32_16x16x32_bf16 v[216:219], v[116:119], v[88:91], v[216:219]
  v_mfma_f32_16x16x32_bf16 v[232:235], v[120:123], v[88:91], v[232:235]
  ds_read_b128 v[88:91], v20 offset:5120
  v_mfma_f32_16x16x32_bf16 v[232:235], v[72:75], v[40:43], v[232:235]
  ds_read_b128 v[40:43], v20 offset:4096
  v_mfma_f32_16x16x32_bf16 v[236:239], v[72:75], v[44:47], v[236:239]
  v_mfma_f32_16x16x32_bf16 v[236:239], v[120:123], v[92:95], v[236:239]
  v_mfma_f32_16x16x32_bf16 v[220:223], v[116:119], v[92:95], v[220:223]
  v_mfma_f32_16x16x32_bf16 v[220:223], v[68:71], v[44:47], v[220:223]
  s_waitcnt lgkmcnt(6)
  s_cbranch_scc1 L_w1_loop
L_w1_lend:
L_w1_exit:
  v_mfma_f32_16x16x32_bf16 v[128:131], v[48:51], v[32:35], v[128:131]
  ds_read_b128 v[44:47], v20 offset:6144
  v_mfma_f32_16x16x32_bf16 v[144:147], v[52:55], v[32:35], v[144:147]
  ds_read_b64_tr_b16 v[64:65], v21 offset:16384
  v_mfma_f32_16x16x32_bf16 v[160:163], v[56:59], v[32:35], v[160:163]
  ds_read_b64_tr_b16 v[66:67], v21 offset:18432
  v_mfma_f32_16x16x32_bf16 v[176:179], v[60:63], v[32:35], v[176:179]
  ds_read_b64_tr_b16 v[68:69], v22 offset:16384
  s_waitcnt lgkmcnt(6)
  v_mfma_f32_16x16x32_bf16 v[132:135], v[48:51], v[36:39], v[132:135]
  ds_read_b64_tr_b16 v[70:71], v22 offset:18432
  v_mfma_f32_16x16x32_bf16 v[148:151], v[52:55], v[36:39], v[148:151]
  ds_read_b64_tr_b16 v[72:73], v23 offset:0
  v_mfma_f32_16x16x32_bf16 v[164:167], v[56:59], v[36:39], v[164:167]
  ds_read_b64_tr_b16 v[74:75], v23 offset:2048
  v_mfma_f32_16x16x32_bf16 v[180:183], v[60:63], v[36:39], v[180:183]
  ds_read_b128 v[92:95], v20 offset:7168
  s_waitcnt lgkmcnt(8)
  v_mfma_f32_16x16x32_bf16 v[136:139], v[48:51], v[40:43], v[136:139]
  ds_read_b64_tr_b16 v[112:113], v21 offset:20480
  v_mfma_f32_16x16x32_bf16 v[152:155], v[52:55], v[40:43], v[152:155]
  ds_read_b64_tr_b16 v[114:115], v21 offset:22528
  v_mfma_f32_16x16x32_bf16 v[168:171], v[56:59], v[40:43], v[168:171]
  ds_read_b64_tr_b16 v[116:117], v22 offset:20480
  v_mfma_f32_16x16x32_bf16 v[184:187], v[60:63], v[40:43], v[184:187]
  ds_read_b64_tr_b16 v[118:119], v22 offset:22528
  s_waitcnt lgkmcnt(11)
  v_mfma_f32_16x16x32_bf16 v[140:143], v[48:51], v[44:47], v[140:143]
  ds_read_b64_tr_b16 v[120:121], v23 offset:4096
  v_mfma_f32_16x16x32_bf16 v[156:159], v[52:55], v[44:47], v[156:159]
  ds_read_b64_tr_b16 v[122:123], v23 offset:6144
  v_mfma_f32_16x16x32_bf16 v[172:175], v[56:59], v[44:47], v[172:175]
  v_and_b32 v76, -9, v14
  v_mfma_f32_16x16x32_bf16 v[188:191], v[60:63], v[44:47], v[188:191]
  s_waitcnt lgkmcnt(11)
  v_mfma_f32_16x16x32_bf16 v[192:195], v[64:67], v[32:35], v[192:195]
  v_mfma_f32_16x16x32_bf16 v[196:199], v[64:67], v[36:39], v[196:199]
  v_mfma_f32_16x16x32_bf16 v[200:203], v[64:67], v[40:43], v[200:203]
  v_mfma_f32_16x16x32_bf16 v[204:207], v[64:67], v[44:47], v[204:207]
  s_waitcnt lgkmcnt(9)
  v_mfma_f32_16x16x32_bf16 v[220:223], v[68:71], v[44:47], v[220:223]
  v_mfma_f32_16x16x32_bf16 v[216:219], v[68:71], v[40:43], v[216:219]
  v_mfma_f32_16x16x32_bf16 v[212:215], v[68:71], v[36:39], v[212:215]
  v_mfma_f32_16x16x32_bf16 v[208:211], v[68:71], v[32:35], v[208:211]
  s_waitcnt lgkmcnt(7)
  v_mfma_f32_16x16x32_bf16 v[224:227], v[72:75], v[32:35], v[224:227]
  v_mfma_f32_16x16x32_bf16 v[228:231], v[72:75], v[36:39], v[228:231]
  v_mfma_f32_16x16x32_bf16 v[232:235], v[72:75], v[40:43], v[232:235]
  v_mfma_f32_16x16x32_bf16 v[236:239], v[72:75], v[44:47], v[236:239]
  s_waitcnt lgkmcnt(0)
  s_barrier
  v_mfma_f32_16x16x32_bf16 v[128:131], v[96:99], v[80:83], v[128:131]
  ds_read_b64 v[46:47], v14 offset:0
  ds_read_b64 v[32:33], v15 offset:0
  v_mfma_f32_16x16x32_bf16 v[132:135], v[96:99], v[84:87], v[132:135]
  ds_read_b64 v[34:35], v15 offset:256
  ds_read_b128 v[56:59], v76 offset:2048
  v_mfma_f32_16x16x32_bf16 v[136:139], v[96:99], v[88:91], v[136:139]
  ds_read_b32 v17, v17
  ds_read_b64 v[48:49], v14 offset:256
  v_mfma_f32_16x16x32_bf16 v[140:143], v[96:99], v[92:95], v[140:143]
  ds_read_b128 v[60:63], v76 offset:2304
  ds_read_b64 v[50:51], v14 offset:512
  v_mfma_f32_16x16x32_bf16 v[156:159], v[100:103], v[92:95], v[156:159]
  ds_read_b128 v[64:67], v76 offset:2560
  ds_read_b64 v[52:53], v14 offset:768
  v_mfma_f32_16x16x32_bf16 v[152:155], v[100:103], v[88:91], v[152:155]
  ds_read_b128 v[68:71], v76 offset:2816
  ds_read_b64 v[44:45], v16 offset:3072
  v_mfma_f32_16x16x32_bf16 v[148:151], v[100:103], v[84:87], v[148:151]
  ds_read_b64 v[36:37], v15 offset:1024
  ds_read_b64 v[38:39], v15 offset:1280
  v_mfma_f32_16x16x32_bf16 v[144:147], v[100:103], v[80:83], v[144:147]
  ds_read_b64 v[40:41], v15 offset:2048
  ds_read_b64 v[42:43], v15 offset:2304
  v_mfma_f32_16x16x32_bf16 v[160:163], v[104:107], v[80:83], v[160:163]
  v_mfma_f32_16x16x32_bf16 v[164:167], v[104:107], v[84:87], v[164:167]
  buffer_load_dwordx2 v[10:11], v19, s[52:55], 0 offen offset:0
  v_mfma_f32_16x16x32_bf16 v[168:171], v[104:107], v[88:91], v[168:171]
  buffer_load_dwordx2 v[24:25], v19, s[52:55], 0 offen offset:32
  v_mfma_f32_16x16x32_bf16 v[172:175], v[104:107], v[92:95], v[172:175]
  buffer_load_dwordx2 v[124:125], v19, s[52:55], 0 offen offset:64
  v_mfma_f32_16x16x32_bf16 v[188:191], v[108:111], v[92:95], v[188:191]
  buffer_load_dwordx2 v[126:127], v19, s[52:55], 0 offen offset:96
  v_mfma_f32_16x16x32_bf16 v[184:187], v[108:111], v[88:91], v[184:187]
  v_mfma_f32_16x16x32_bf16 v[180:183], v[108:111], v[84:87], v[180:183]
  s_waitcnt lgkmcnt(0)
  v_mfma_f32_16x16x16_bf16 v[128:131], v[32:33], v[46:47], v[128:131]
  v_readfirstlane_b32 s98, v17
  v_mfma_f32_16x16x32_bf16 v[176:179], v[108:111], v[80:83], v[176:179]
  v_mfma_f32_16x16x32_bf16 v[192:195], v[112:115], v[80:83], v[192:195]
  s_cmp_lg_u32 s98, 0
  s_cselect_b32 s98, 34603008, 0
  v_mfma_f32_16x16x32_bf16 v[196:199], v[112:115], v[84:87], v[196:199]
  s_add_u32 s44, s44, s98
  s_addc_u32 s45, s45, 0
  v_mfma_f32_16x16x32_bf16 v[200:203], v[112:115], v[88:91], v[200:203]
  s_add_u32 s36, s36, s98
  s_addc_u32 s37, s37, 0
  v_mfma_f32_16x16x32_bf16 v[204:207], v[112:115], v[92:95], v[204:207]
  s_add_u32 s64, s64, s98
  s_addc_u32 s65, s65, 0
  v_mfma_f32_16x16x32_bf16 v[220:223], v[116:119], v[92:95], v[220:223]
  s_mov_b32 s3, 114688
  s_mov_b32 s8, 229376
  v_mfma_f32_16x16x32_bf16 v[216:219], v[116:119], v[88:91], v[216:219]
  s_mov_b32 s9, 344064
  s_add_u32 s10, s10, 49152
  v_mfma_f32_16x16x32_bf16 v[212:215], v[116:119], v[84:87], v[212:215]
  v_add_u32 v17, s10, v12
  v_add_u32 v13, 0x8000, v13
  v_mfma_f32_16x16x32_bf16 v[208:211], v[116:119], v[80:83], v[208:211]
  v_mfma_f32_16x16x32_bf16 v[224:227], v[120:123], v[80:83], v[224:227]
  v_mfma_f32_16x16x32_bf16 v[228:231], v[120:123], v[84:87], v[228:231]
  v_mfma_f32_16x16x32_bf16 v[232:235], v[120:123], v[88:91], v[232:235]
  v_mfma_f32_16x16x32_bf16 v[236:239], v[120:123], v[92:95], v[236:239]
  v_pk_mul_f32 v[100:101], v[128:129], v[128:129]
  v_pk_mul_f32 v[102:103], v[130:131], v[130:131]
  v_pk_fma_f32 v[100:101], v[100:101], v[56:57], v[56:57] op_sel:[0,1,0] op_sel_hi:[1,1,0]
  v_pk_fma_f32 v[102:103], v[102:103], v[56:57], v[56:57] op_sel:[0,1,0] op_sel_hi:[1,1,0]
  v_pk_mul_f32 v[100:101], v[100:101], v[128:129]
  v_pk_mul_f32 v[102:103], v[102:103], v[130:131]
  v_mfma_f32_16x16x16_bf16 v[144:147], v[34:35], v[46:47], v[144:147]
  v_exp_f32 v100, v100
  v_exp_f32 v101, v101
  v_exp_f32 v102, v102
  v_exp_f32 v103, v103
  v_pk_fma_f32 v[100:101], v[100:101], v[58:59], v[58:59] op_sel_hi:[1,0,0]
  v_pk_fma_f32 v[102:103], v[102:103], v[58:59], v[58:59] op_sel_hi:[1,0,0]
  v_rcp_f32 v100, v100
  v_rcp_f32 v101, v101
  v_rcp_f32 v102, v102
  v_rcp_f32 v103, v103
  v_pk_mul_f32 v[128:129], v[128:129], v[100:101]
  v_pk_mul_f32 v[130:131], v[130:131], v[102:103]
  v_cvt_pk_bf16_f32 v108, v128, v129
  v_cvt_pk_bf16_f32 v109, v130, v131
  v_pk_mul_f32 v[104:105], v[144:145], v[144:145]
  v_pk_mul_f32 v[106:107], v[146:147], v[146:147]
  v_pk_fma_f32 v[104:105], v[104:105], v[56:57], v[56:57] op_sel:[0,1,0] op_sel_hi:[1,1,0]
  v_pk_fma_f32 v[106:107], v[106:107], v[56:57], v[56:57] op_sel:[0,1,0] op_sel_hi:[1,1,0]
  v_pk_mul_f32 v[104:105], v[104:105], v[144:145]
  v_pk_mul_f32 v[106:107], v[106:107], v[146:147]
  v_mfma_f32_16x16x16_bf16 v[132:135], v[32:33], v[48:49], v[132:135]
  v_exp_f32 v104, v104
  v_exp_f32 v105, v105
  v_exp_f32 v106, v106
  v_exp_f32 v107, v107
  v_pk_fma_f32 v[104:105], v[104:105], v[58:59], v[58:59] op_sel_hi:[1,0,0]
  v_pk_fma_f32 v[106:107], v[106:107], v[58:59], v[58:59] op_sel_hi:[1,0,0]
  v_rcp_f32 v104, v104
  v_rcp_f32 v105, v105
  v_rcp_f32 v106, v106
  v_rcp_f32 v107, v107
  v_pk_mul_f32 v[144:145], v[144:145], v[104:105]
  v_pk_mul_f32 v[146:147], v[146:147], v[106:107]
  v_cvt_pk_bf16_f32 v110, v144, v145
  v_cvt_pk_bf16_f32 v111, v146, v147
  buffer_store_dwordx4 v[108:111], v12, s[44:47], 0 offen sc1
  ds_write_b128 v18, v[108:111] offset:32768
  v_pk_mul_f32 v[100:101], v[132:133], v[132:133]
  v_pk_mul_f32 v[102:103], v[134:135], v[134:135]
  v_pk_fma_f32 v[100:101], v[100:101], v[60:61], v[60:61] op_sel:[0,1,0] op_sel_hi:[1,1,0]
  v_pk_fma_f32 v[102:103], v[102:103], v[60:61], v[60:61] op_sel:[0,1,0] op_sel_hi:[1,1,0]
  v_pk_mul_f32 v[100:101], v[100:101], v[132:133]
  v_pk_mul_f32 v[102:103], v[102:103], v[134:135]
  v_mfma_f32_16x16x16_bf16 v[148:151], v[34:35], v[48:49], v[148:151]
  v_exp_f32 v100, v100
  v_exp_f32 v101, v101
  v_exp_f32 v102, v102
  v_exp_f32 v103, v103
  v_pk_fma_f32 v[100:101], v[100:101], v[62:63], v[62:63] op_sel_hi:[1,0,0]
  v_pk_fma_f32 v[102:103], v[102:103], v[62:63], v[62:63] op_sel_hi:[1,0,0]
  v_rcp_f32 v100, v100
  v_rcp_f32 v101, v101
  v_rcp_f32 v102, v102
  v_rcp_f32 v103, v103
  v_pk_mul_f32 v[132:133], v[132:133], v[100:101]
  v_pk_mul_f32 v[134:135], v[134:135], v[102:103]
  v_cvt_pk_bf16_f32 v112, v132, v133
  v_cvt_pk_bf16_f32 v113, v134, v135
  v_pk_mul_f32 v[104:105], v[148:149], v[148:149]
  v_pk_mul_f32 v[106:107], v[150:151], v[150:151]
  v_pk_fma_f32 v[104:105], v[104:105], v[60:61], v[60:61] op_sel:[0,1,0] op_sel_hi:[1,1,0]
  v_pk_fma_f32 v[106:107], v[106:107], v[60:61], v[60:61] op_sel:[0,1,0] op_sel_hi:[1,1,0]
  v_pk_mul_f32 v[104:105], v[104:105], v[148:149]
  v_pk_mul_f32 v[106:107], v[106:107], v[150:151]
  v_mfma_f32_16x16x16_bf16 v[136:139], v[32:33], v[50:51], v[136:139]
  v_exp_f32 v104, v104
  v_exp_f32 v105, v105
  v_exp_f32 v106, v106
  v_exp_f32 v107, v107
  v_pk_fma_f32 v[104:105], v[104:105], v[62:63], v[62:63] op_sel_hi:[1,0,0]
  v_pk_fma_f32 v[106:107], v[106:107], v[62:63], v[62:63] op_sel_hi:[1,0,0]
  v_rcp_f32 v104, v104
  v_rcp_f32 v105, v105
  v_rcp_f32 v106, v106
  v_rcp_f32 v107, v107
  v_pk_mul_f32 v[148:149], v[148:149], v[104:105]
  v_pk_mul_f32 v[150:151], v[150:151], v[106:107]
  v_cvt_pk_bf16_f32 v114, v148, v149
  v_cvt_pk_bf16_f32 v115, v150, v151
  buffer_store_dwordx4 v[112:115], v12, s[44:47], s3 offen sc1
  ds_write_b128 v18, v[112:115] offset:34816
  v_pk_mul_f32 v[100:101], v[136:137], v[136:137]
  v_pk_mul_f32 v[102:103], v[138:139], v[138:139]
  v_pk_fma_f32 v[100:101], v[100:101], v[64:65], v[64:65] op_sel:[0,1,0] op_sel_hi:[1,1,0]
  v_pk_fma_f32 v[102:103], v[102:103], v[64:65], v[64:65] op_sel:[0,1,0] op_sel_hi:[1,1,0]
  v_pk_mul_f32 v[100:101], v[100:101], v[136:137]
  v_pk_mul_f32 v[102:103], v[102:103], v[138:139]
  v_mfma_f32_16x16x16_bf16 v[152:155], v[34:35], v[50:51], v[152:155]
  v_exp_f32 v100, v100
  v_exp_f32 v101, v101
  v_exp_f32 v102, v102
  v_exp_f32 v103, v103
  v_pk_fma_f32 v[100:101], v[100:101], v[66:67], v[66:67] op_sel_hi:[1,0,0]
  v_pk_fma_f32 v[102:103], v[102:103], v[66:67], v[66:67] op_sel_hi:[1,0,0]
  v_rcp_f32 v100, v100
  v_rcp_f32 v101, v101
  v_rcp_f32 v102, v102
  v_rcp_f32 v103, v103
  v_pk_mul_f32 v[136:137], v[136:137], v[100:101]
  v_pk_mul_f32 v[138:139], v[138:139], v[102:103]
  v_cvt_pk_bf16_f32 v116, v136, v137
  v_cvt_pk_bf16_f32 v117, v138, v139
  v_pk_mul_f32 v[104:105], v[152:153], v[152:153]
  v_pk_mul_f32 v[106:107], v[154:155], v[154:155]
  v_pk_fma_f32 v[104:105], v[104:105], v[64:65], v[64:65] op_sel:[0,1,0] op_sel_hi:[1,1,0]
  v_pk_fma_f32 v[106:107], v[106:107], v[64:65], v[64:65] op_sel:[0,1,0] op_sel_hi:[1,1,0]
  v_pk_mul_f32 v[104:105], v[104:105], v[152:153]
  v_pk_mul_f32 v[106:107], v[106:107], v[154:155]
  v_mfma_f32_16x16x16_bf16 v[140:143], v[32:33], v[52:53], v[140:143]
  v_exp_f32 v104, v104
  v_exp_f32 v105, v105
  v_exp_f32 v106, v106
  v_exp_f32 v107, v107
  v_pk_fma_f32 v[104:105], v[104:105], v[66:67], v[66:67] op_sel_hi:[1,0,0]
  v_pk_fma_f32 v[106:107], v[106:107], v[66:67], v[66:67] op_sel_hi:[1,0,0]
  v_rcp_f32 v104, v104
  v_rcp_f32 v105, v105
  v_rcp_f32 v106, v106
  v_rcp_f32 v107, v107
  v_pk_mul_f32 v[152:153], v[152:153], v[104:105]
  v_pk_mul_f32 v[154:155], v[154:155], v[106:107]
  v_cvt_pk_bf16_f32 v118, v152, v153
  v_cvt_pk_bf16_f32 v119, v154, v155
  buffer_store_dwordx4 v[116:119], v12, s[44:47], s8 offen sc1
  ds_write_b128 v18, v[116:119] offset:36864
  v_pk_mul_f32 v[100:101], v[140:141], v[140:141]
  v_pk_mul_f32 v[102:103], v[142:143], v[142:143]
  v_pk_fma_f32 v[100:101], v[100:101], v[68:69], v[68:69] op_sel:[0,1,0] op_sel_hi:[1,1,0]
  v_pk_fma_f32 v[102:103], v[102:103], v[68:69], v[68:69] op_sel:[0,1,0] op_sel_hi:[1,1,0]
  v_pk_mul_f32 v[100:101], v[100:101], v[140:141]
  v_pk_mul_f32 v[102:103], v[102:103], v[142:143]
  v_mfma_f32_16x16x16_bf16 v[156:159], v[34:35], v[52:53], v[156:159]
  v_exp_f32 v100, v100
  v_exp_f32 v101, v101
  v_exp_f32 v102, v102
  v_exp_f32 v103, v103
  v_pk_fma_f32 v[100:101], v[100:101], v[70:71], v[70:71] op_sel_hi:[1,0,0]
  v_pk_fma_f32 v[102:103], v[102:103], v[70:71], v[70:71] op_sel_hi:[1,0,0]
  v_rcp_f32 v100, v100
  v_rcp_f32 v101, v101
  v_rcp_f32 v102, v102
  v_rcp_f32 v103, v103
  v_pk_mul_f32 v[140:141], v[140:141], v[100:101]
  v_pk_mul_f32 v[142:143], v[142:143], v[102:103]
  v_cvt_pk_bf16_f32 v120, v140, v141
  v_cvt_pk_bf16_f32 v121, v142, v143
  v_pk_mul_f32 v[104:105], v[156:157], v[156:157]
  v_pk_mul_f32 v[106:107], v[158:159], v[158:159]
  v_pk_fma_f32 v[104:105], v[104:105], v[68:69], v[68:69] op_sel:[0,1,0] op_sel_hi:[1,1,0]
  v_pk_fma_f32 v[106:107], v[106:107], v[68:69], v[68:69] op_sel:[0,1,0] op_sel_hi:[1,1,0]
  v_pk_mul_f32 v[104:105], v[104:105], v[156:157]
  v_pk_mul_f32 v[106:107], v[106:107], v[158:159]
  v_mfma_f32_16x16x16_bf16 v[224:227], v[44:45], v[46:47], v[224:227]
  v_exp_f32 v104, v104
  v_exp_f32 v105, v105
  v_exp_f32 v106, v106
  v_exp_f32 v107, v107
  v_pk_fma_f32 v[104:105], v[104:105], v[70:71], v[70:71] op_sel_hi:[1,0,0]
  v_pk_fma_f32 v[106:107], v[106:107], v[70:71], v[70:71] op_sel_hi:[1,0,0]
  v_rcp_f32 v104, v104
  v_rcp_f32 v105, v105
  v_rcp_f32 v106, v106
  v_rcp_f32 v107, v107
  v_pk_mul_f32 v[156:157], v[156:157], v[104:105]
  v_pk_mul_f32 v[158:159], v[158:159], v[106:107]
  v_cvt_pk_bf16_f32 v122, v156, v157
  v_cvt_pk_bf16_f32 v123, v158, v159
  buffer_store_dwordx4 v[120:123], v12, s[44:47], s9 offen sc1
  ds_write_b128 v18, v[120:123] offset:38912
  v_pk_mul_f32 v[100:101], v[224:225], v[224:225]
  v_pk_mul_f32 v[102:103], v[226:227], v[226:227]
  v_pk_fma_f32 v[100:101], v[100:101], v[56:57], v[56:57] op_sel:[0,1,0] op_sel_hi:[1,1,0]
  v_pk_fma_f32 v[102:103], v[102:103], v[56:57], v[56:57] op_sel:[0,1,0] op_sel_hi:[1,1,0]
  v_pk_mul_f32 v[100:101], v[100:101], v[224:225]
  v_pk_mul_f32 v[102:103], v[102:103], v[226:227]
  v_mfma_f32_16x16x16_bf16 v[228:231], v[44:45], v[48:49], v[228:231]
  v_exp_f32 v100, v100
  v_exp_f32 v101, v101
  v_exp_f32 v102, v102
  v_exp_f32 v103, v103
  v_pk_fma_f32 v[100:101], v[100:101], v[58:59], v[58:59] op_sel_hi:[1,0,0]
  v_pk_fma_f32 v[102:103], v[102:103], v[58:59], v[58:59] op_sel_hi:[1,0,0]
  v_rcp_f32 v100, v100
  v_rcp_f32 v101, v101
  v_rcp_f32 v102, v102
  v_rcp_f32 v103, v103
  v_pk_mul_f32 v[224:225], v[224:225], v[100:101]
  v_pk_mul_f32 v[226:227], v[226:227], v[102:103]
  v_cvt_pk_bf16_f32 v108, v224, v225
  v_cvt_pk_bf16_f32 v109, v226, v227
  v_pk_mul_f32 v[100:101], v[228:229], v[228:229]
  v_pk_mul_f32 v[102:103], v[230:231], v[230:231]
  v_pk_fma_f32 v[100:101], v[100:101], v[60:61], v[60:61] op_sel:[0,1,0] op_sel_hi:[1,1,0]
  v_pk_fma_f32 v[102:103], v[102:103], v[60:61], v[60:61] op_sel:[0,1,0] op_sel_hi:[1,1,0]
  v_pk_mul_f32 v[100:101], v[100:101], v[228:229]
  v_pk_mul_f32 v[102:103], v[102:103], v[230:231]
  v_mfma_f32_16x16x16_bf16 v[232:235], v[44:45], v[50:51], v[232:235]
  v_exp_f32 v100, v100
  v_exp_f32 v101, v101
  v_exp_f32 v102, v102
  v_exp_f32 v103, v103
  v_pk_fma_f32 v[100:101], v[100:101], v[62:63], v[62:63] op_sel_hi:[1,0,0]
  v_pk_fma_f32 v[102:103], v[102:103], v[62:63], v[62:63] op_sel_hi:[1,0,0]
  v_rcp_f32 v100, v100
  v_rcp_f32 v101, v101
  v_rcp_f32 v102, v102
  v_rcp_f32 v103, v103
  v_pk_mul_f32 v[228:229], v[228:229], v[100:101]
  v_pk_mul_f32 v[230:231], v[230:231], v[102:103]
  v_cvt_pk_bf16_f32 v110, v228, v229
  v_cvt_pk_bf16_f32 v111, v230, v231
  s_nop 1
  v_permlane16_swap_b32 v108, v110
  v_permlane16_swap_b32 v109, v111
  buffer_store_dwordx4 v[108:111], v13, s[44:47], 0 offen sc1
  v_pk_mul_f32 v[100:101], v[232:233], v[232:233]
  v_pk_mul_f32 v[102:103], v[234:235], v[234:235]
  v_pk_fma_f32 v[100:101], v[100:101], v[64:65], v[64:65] op_sel:[0,1,0] op_sel_hi:[1,1,0]
  v_pk_fma_f32 v[102:103], v[102:103], v[64:65], v[64:65] op_sel:[0,1,0] op_sel_hi:[1,1,0]
  v_pk_mul_f32 v[100:101], v[100:101], v[232:233]
  v_pk_mul_f32 v[102:103], v[102:103], v[234:235]
  v_mfma_f32_16x16x16_bf16 v[236:239], v[44:45], v[52:53], v[236:239]
  v_exp_f32 v100, v100
  v_exp_f32 v101, v101
  v_exp_f32 v102, v102
  v_exp_f32 v103, v103
  v_pk_fma_f32 v[100:101], v[100:101], v[66:67], v[66:67] op_sel_hi:[1,0,0]
  v_pk_fma_f32 v[102:103], v[102:103], v[66:67], v[66:67] op_sel_hi:[1,0,0]
  v_rcp_f32 v100, v100
  v_rcp_f32 v101, v101
  v_rcp_f32 v102, v102
  v_rcp_f32 v103, v103
  v_pk_mul_f32 v[232:233], v[232:233], v[100:101]
  v_pk_mul_f32 v[234:235], v[234:235], v[102:103]
  v_cvt_pk_bf16_f32 v112, v232, v233
  v_cvt_pk_bf16_f32 v113, v234, v235
  v_pk_mul_f32 v[100:101], v[236:237], v[236:237]
  v_pk_mul_f32 v[102:103], v[238:239], v[238:239]
  v_pk_fma_f32 v[100:101], v[100:101], v[68:69], v[68:69] op_sel:[0,1,0] op_sel_hi:[1,1,0]
  v_pk_fma_f32 v[102:103], v[102:103], v[68:69], v[68:69] op_sel:[0,1,0] op_sel_hi:[1,1,0]
  v_pk_mul_f32 v[100:101], v[100:101], v[236:237]
  v_pk_mul_f32 v[102:103], v[102:103], v[238:239]
  v_mfma_f32_16x16x16_bf16 v[160:163], v[36:37], v[46:47], v[160:163]
  v_exp_f32 v100, v100
  v_exp_f32 v101, v101
  v_exp_f32 v102, v102
  v_exp_f32 v103, v103
  v_pk_fma_f32 v[100:101], v[100:101], v[70:71], v[70:71] op_sel_hi:[1,0,0]
  v_pk_fma_f32 v[102:103], v[102:103], v[70:71], v[70:71] op_sel_hi:[1,0,0]
  v_rcp_f32 v100, v100
  v_rcp_f32 v101, v101
  v_rcp_f32 v102, v102
  v_rcp_f32 v103, v103
  v_pk_mul_f32 v[236:237], v[236:237], v[100:101]
  v_pk_mul_f32 v[238:239], v[238:239], v[102:103]
  v_cvt_pk_bf16_f32 v114, v236, v237
  v_cvt_pk_bf16_f32 v115, v238, v239
  s_nop 1
  v_permlane16_swap_b32 v112, v114
  v_permlane16_swap_b32 v113, v115
  buffer_store_dwordx4 v[112:115], v13, s[44:47], s8 offen sc1
  v_pk_mul_f32 v[100:101], v[160:161], v[160:161]
  v_pk_mul_f32 v[102:103], v[162:163], v[162:163]
  v_pk_fma_f32 v[100:101], v[100:101], v[56:57], v[56:57] op_sel:[0,1,0] op_sel_hi:[1,1,0]
  v_pk_fma_f32 v[102:103], v[102:103], v[56:57], v[56:57] op_sel:[0,1,0] op_sel_hi:[1,1,0]
  v_pk_mul_f32 v[100:101], v[100:101], v[160:161]
  v_pk_mul_f32 v[102:103], v[102:103], v[162:163]
  v_mfma_f32_16x16x16_bf16 v[176:179], v[38:39], v[46:47], v[176:179]
  v_exp_f32 v100, v100
  v_exp_f32 v101, v101
  v_exp_f32 v102, v102
  v_exp_f32 v103, v103
  v_pk_fma_f32 v[100:101], v[100:101], v[58:59], v[58:59] op_sel_hi:[1,0,0]
  v_pk_fma_f32 v[102:103], v[102:103], v[58:59], v[58:59] op_sel_hi:[1,0,0]
  v_rcp_f32 v100, v100
  v_rcp_f32 v101, v101
  v_rcp_f32 v102, v102
  v_rcp_f32 v103, v103
  v_pk_mul_f32 v[160:161], v[160:161], v[100:101]
  v_pk_mul_f32 v[162:163], v[162:163], v[102:103]
  v_cvt_pk_bf16_f32 v116, v160, v161
  v_cvt_pk_bf16_f32 v117, v162, v163
  v_pk_mul_f32 v[104:105], v[176:177], v[176:177]
  v_pk_mul_f32 v[106:107], v[178:179], v[178:179]
  v_pk_fma_f32 v[104:105], v[104:105], v[56:57], v[56:57] op_sel:[0,1,0] op_sel_hi:[1,1,0]
  v_pk_fma_f32 v[106:107], v[106:107], v[56:57], v[56:57] op_sel:[0,1,0] op_sel_hi:[1,1,0]
  v_pk_mul_f32 v[104:105], v[104:105], v[176:177]
  v_pk_mul_f32 v[106:107], v[106:107], v[178:179]
  v_mfma_f32_16x16x16_bf16 v[164:167], v[36:37], v[48:49], v[164:167]
  v_exp_f32 v104, v104
  v_exp_f32 v105, v105
  v_exp_f32 v106, v106
  v_exp_f32 v107, v107
  v_pk_fma_f32 v[104:105], v[104:105], v[58:59], v[58:59] op_sel_hi:[1,0,0]
  v_pk_fma_f32 v[106:107], v[106:107], v[58:59], v[58:59] op_sel_hi:[1,0,0]
  v_rcp_f32 v104, v104
  v_rcp_f32 v105, v105
  v_rcp_f32 v106, v106
  v_rcp_f32 v107, v107
  v_pk_mul_f32 v[176:177], v[176:177], v[104:105]
  v_pk_mul_f32 v[178:179], v[178:179], v[106:107]
  v_cvt_pk_bf16_f32 v118, v176, v177
  v_cvt_pk_bf16_f32 v119, v178, v179
  buffer_store_dwordx4 v[116:119], v17, s[44:47], 0 offen sc1
  ds_write_b128 v18, v[116:119] offset:0
  v_pk_mul_f32 v[100:101], v[164:165], v[164:165]
  v_pk_mul_f32 v[102:103], v[166:167], v[166:167]
  v_pk_fma_f32 v[100:101], v[100:101], v[60:61], v[60:61] op_sel:[0,1,0] op_sel_hi:[1,1,0]
  v_pk_fma_f32 v[102:103], v[102:103], v[60:61], v[60:61] op_sel:[0,1,0] op_sel_hi:[1,1,0]
  v_pk_mul_f32 v[100:101], v[100:101], v[164:165]
  v_pk_mul_f32 v[102:103], v[102:103], v[166:167]
  v_mfma_f32_16x16x16_bf16 v[180:183], v[38:39], v[48:49], v[180:183]
  v_exp_f32 v100, v100
  v_exp_f32 v101, v101
  v_exp_f32 v102, v102
  v_exp_f32 v103, v103
  v_pk_fma_f32 v[100:101], v[100:101], v[62:63], v[62:63] op_sel_hi:[1,0,0]
  v_pk_fma_f32 v[102:103], v[102:103], v[62:63], v[62:63] op_sel_hi:[1,0,0]
  v_rcp_f32 v100, v100
  v_rcp_f32 v101, v101
  v_rcp_f32 v102, v102
  v_rcp_f32 v103, v103
  v_pk_mul_f32 v[164:165], v[164:165], v[100:101]
  v_pk_mul_f32 v[166:167], v[166:167], v[102:103]
  v_cvt_pk_bf16_f32 v120, v164, v165
  v_cvt_pk_bf16_f32 v121, v166, v167
  v_pk_mul_f32 v[104:105], v[180:181], v[180:181]
  v_pk_mul_f32 v[106:107], v[182:183], v[182:183]
  v_pk_fma_f32 v[104:105], v[104:105], v[60:61], v[60:61] op_sel:[0,1,0] op_sel_hi:[1,1,0]
  v_pk_fma_f32 v[106:107], v[106:107], v[60:61], v[60:61] op_sel:[0,1,0] op_sel_hi:[1,1,0]
  v_pk_mul_f32 v[104:105], v[104:105], v[180:181]
  v_pk_mul_f32 v[106:107], v[106:107], v[182:183]
  v_mfma_f32_16x16x16_bf16 v[168:171], v[36:37], v[50:51], v[168:171]
  v_exp_f32 v104, v104
  v_exp_f32 v105, v105
  v_exp_f32 v106, v106
  v_exp_f32 v107, v107
  v_pk_fma_f32 v[104:105], v[104:105], v[62:63], v[62:63] op_sel_hi:[1,0,0]
  v_pk_fma_f32 v[106:107], v[106:107], v[62:63], v[62:63] op_sel_hi:[1,0,0]
  v_rcp_f32 v104, v104
  v_rcp_f32 v105, v105
  v_rcp_f32 v106, v106
  v_rcp_f32 v107, v107
  v_pk_mul_f32 v[180:181], v[180:181], v[104:105]
  v_pk_mul_f32 v[182:183], v[182:183], v[106:107]
  v_cvt_pk_bf16_f32 v122, v180, v181
  v_cvt_pk_bf16_f32 v123, v182, v183
  buffer_store_dwordx4 v[120:123], v17, s[44:47], s3 offen sc1
  ds_write_b128 v18, v[120:123] offset:2048
  v_pk_mul_f32 v[100:101], v[168:169], v[168:169]
  v_pk_mul_f32 v[102:103], v[170:171], v[170:171]
  v_pk_fma_f32 v[100:101], v[100:101], v[64:65], v[64:65] op_sel:[0,1,0] op_sel_hi:[1,1,0]
  v_pk_fma_f32 v[102:103], v[102:103], v[64:65], v[64:65] op_sel:[0,1,0] op_sel_hi:[1,1,0]
  v_pk_mul_f32 v[100:101], v[100:101], v[168:169]
  v_pk_mul_f32 v[102:103], v[102:103], v[170:171]
  v_mfma_f32_16x16x16_bf16 v[184:187], v[38:39], v[50:51], v[184:187]
  v_exp_f32 v100, v100
  v_exp_f32 v101, v101
  v_exp_f32 v102, v102
  v_exp_f32 v103, v103
  v_pk_fma_f32 v[100:101], v[100:101], v[66:67], v[66:67] op_sel_hi:[1,0,0]
  v_pk_fma_f32 v[102:103], v[102:103], v[66:67], v[66:67] op_sel_hi:[1,0,0]
  v_rcp_f32 v100, v100
  v_rcp_f32 v101, v101
  v_rcp_f32 v102, v102
  v_rcp_f32 v103, v103
  v_pk_mul_f32 v[168:169], v[168:169], v[100:101]
  v_pk_mul_f32 v[170:171], v[170:171], v[102:103]
  v_cvt_pk_bf16_f32 v108, v168, v169
  v_cvt_pk_bf16_f32 v109, v170, v171
  v_pk_mul_f32 v[104:105], v[184:185], v[184:185]
  v_pk_mul_f32 v[106:107], v[186:187], v[186:187]
  v_pk_fma_f32 v[104:105], v[104:105], v[64:65], v[64:65] op_sel:[0,1,0] op_sel_hi:[1,1,0]
  v_pk_fma_f32 v[106:107], v[106:107], v[64:65], v[64:65] op_sel:[0,1,0] op_sel_hi:[1,1,0]
  v_pk_mul_f32 v[104:105], v[104:105], v[184:185]
  v_pk_mul_f32 v[106:107], v[106:107], v[186:187]
  v_mfma_f32_16x16x16_bf16 v[172:175], v[36:37], v[52:53], v[172:175]
  v_exp_f32 v104, v104
  v_exp_f32 v105, v105
  v_exp_f32 v106, v106
  v_exp_f32 v107, v107
  v_pk_fma_f32 v[104:105], v[104:105], v[66:67], v[66:67] op_sel_hi:[1,0,0]
  v_pk_fma_f32 v[106:107], v[106:107], v[66:67], v[66:67] op_sel_hi:[1,0,0]
  v_rcp_f32 v104, v104
  v_rcp_f32 v105, v105
  v_rcp_f32 v106, v106
  v_rcp_f32 v107, v107
  v_pk_mul_f32 v[184:185], v[184:185], v[104:105]
  v_pk_mul_f32 v[186:187], v[186:187], v[106:107]
  v_cvt_pk_bf16_f32 v110, v184, v185
  v_cvt_pk_bf16_f32 v111, v186, v187
  buffer_store_dwordx4 v[108:111], v17, s[44:47], s8 offen sc1
  ds_write_b128 v18, v[108:111] offset:4096
  v_pk_mul_f32 v[100:101], v[172:173], v[172:173]
  v_pk_mul_f32 v[102:103], v[174:175], v[174:175]
  v_pk_fma_f32 v[100:101], v[100:101], v[68:69], v[68:69] op_sel:[0,1,0] op_sel_hi:[1,1,0]
  v_pk_fma_f32 v[102:103], v[102:103], v[68:69], v[68:69] op_sel:[0,1,0] op_sel_hi:[1,1,0]
  v_pk_mul_f32 v[100:101], v[100:101], v[172:173]
  v_pk_mul_f32 v[102:103], v[102:103], v[174:175]
  v_mfma_f32_16x16x16_bf16 v[188:191], v[38:39], v[52:53], v[188:191]
  v_exp_f32 v100, v100
  v_exp_f32 v101, v101
  v_exp_f32 v102, v102
  v_exp_f32 v103, v103
  v_pk_fma_f32 v[100:101], v[100:101], v[70:71], v[70:71] op_sel_hi:[1,0,0]
  v_pk_fma_f32 v[102:103], v[102:103], v[70:71], v[70:71] op_sel_hi:[1,0,0]
  v_rcp_f32 v100, v100
  v_rcp_f32 v101, v101
  v_rcp_f32 v102, v102
  v_rcp_f32 v103, v103
  v_pk_mul_f32 v[172:173], v[172:173], v[100:101]
  v_pk_mul_f32 v[174:175], v[174:175], v[102:103]
  v_cvt_pk_bf16_f32 v112, v172, v173
  v_cvt_pk_bf16_f32 v113, v174, v175
  v_pk_mul_f32 v[104:105], v[188:189], v[188:189]
  v_pk_mul_f32 v[106:107], v[190:191], v[190:191]
  v_pk_fma_f32 v[104:105], v[104:105], v[68:69], v[68:69] op_sel:[0,1,0] op_sel_hi:[1,1,0]
  v_pk_fma_f32 v[106:107], v[106:107], v[68:69], v[68:69] op_sel:[0,1,0] op_sel_hi:[1,1,0]
  v_pk_mul_f32 v[104:105], v[104:105], v[188:189]
  v_pk_mul_f32 v[106:107], v[106:107], v[190:191]
  v_mfma_f32_16x16x16_bf16 v[192:195], v[40:41], v[46:47], v[192:195]
  v_exp_f32 v104, v104
  v_exp_f32 v105, v105
  v_exp_f32 v106, v106
  v_exp_f32 v107, v107
  v_pk_fma_f32 v[104:105], v[104:105], v[70:71], v[70:71] op_sel_hi:[1,0,0]
  v_pk_fma_f32 v[106:107], v[106:107], v[70:71], v[70:71] op_sel_hi:[1,0,0]
  v_rcp_f32 v104, v104
  v_rcp_f32 v105, v105
  v_rcp_f32 v106, v106
  v_rcp_f32 v107, v107
  v_pk_mul_f32 v[188:189], v[188:189], v[104:105]
  v_pk_mul_f32 v[190:191], v[190:191], v[106:107]
  v_cvt_pk_bf16_f32 v114, v188, v189
  v_cvt_pk_bf16_f32 v115, v190, v191
  buffer_store_dwordx4 v[112:115], v17, s[44:47], s9 offen sc1
  ds_write_b128 v18, v[112:115] offset:6144
  v_pk_mul_f32 v[100:101], v[192:193], v[192:193]
  v_pk_mul_f32 v[102:103], v[194:195], v[194:195]
  v_pk_fma_f32 v[100:101], v[100:101], v[56:57], v[56:57] op_sel:[0,1,0] op_sel_hi:[1,1,0]
  v_pk_fma_f32 v[102:103], v[102:103], v[56:57], v[56:57] op_sel:[0,1,0] op_sel_hi:[1,1,0]
  v_pk_mul_f32 v[100:101], v[100:101], v[192:193]
  v_pk_mul_f32 v[102:103], v[102:103], v[194:195]
  v_mfma_f32_16x16x16_bf16 v[208:211], v[42:43], v[46:47], v[208:211]
  v_exp_f32 v100, v100
  v_exp_f32 v101, v101
  v_exp_f32 v102, v102
  v_exp_f32 v103, v103
  v_pk_fma_f32 v[100:101], v[100:101], v[58:59], v[58:59] op_sel_hi:[1,0,0]
  v_pk_fma_f32 v[102:103], v[102:103], v[58:59], v[58:59] op_sel_hi:[1,0,0]
  v_rcp_f32 v100, v100
  v_rcp_f32 v101, v101
  v_rcp_f32 v102, v102
  v_rcp_f32 v103, v103
  v_pk_mul_f32 v[192:193], v[192:193], v[100:101]
  v_pk_mul_f32 v[194:195], v[194:195], v[102:103]
  v_cvt_pk_bf16_f32 v116, v192, v193
  v_cvt_pk_bf16_f32 v117, v194, v195
  v_pk_mul_f32 v[104:105], v[208:209], v[208:209]
  v_pk_mul_f32 v[106:107], v[210:211], v[210:211]
  v_pk_fma_f32 v[104:105], v[104:105], v[56:57], v[56:57] op_sel:[0,1,0] op_sel_hi:[1,1,0]
  v_pk_fma_f32 v[106:107], v[106:107], v[56:57], v[56:57] op_sel:[0,1,0] op_sel_hi:[1,1,0]
  v_pk_mul_f32 v[104:105], v[104:105], v[208:209]
  v_pk_mul_f32 v[106:107], v[106:107], v[210:211]
  v_mfma_f32_16x16x16_bf16 v[196:199], v[40:41], v[48:49], v[196:199]
  v_exp_f32 v104, v104
  v_exp_f32 v105, v105
  v_exp_f32 v106, v106
  v_exp_f32 v107, v107
  v_pk_fma_f32 v[104:105], v[104:105], v[58:59], v[58:59] op_sel_hi:[1,0,0]
  v_pk_fma_f32 v[106:107], v[106:107], v[58:59], v[58:59] op_sel_hi:[1,0,0]
  v_rcp_f32 v104, v104
  v_rcp_f32 v105, v105
  v_rcp_f32 v106, v106
  v_rcp_f32 v107, v107
  v_pk_mul_f32 v[208:209], v[208:209], v[104:105]
  v_pk_mul_f32 v[210:211], v[210:211], v[106:107]
  v_cvt_pk_bf16_f32 v118, v208, v209
  v_cvt_pk_bf16_f32 v119, v210, v211
  buffer_store_dwordx4 v[116:119], v17, s[44:47], 0 offen offset:2048
  ds_write_b128 v18, v[116:119] offset:16384
  v_pk_mul_f32 v[100:101], v[196:197], v[196:197]
  v_pk_mul_f32 v[102:103], v[198:199], v[198:199]
  v_pk_fma_f32 v[100:101], v[100:101], v[60:61], v[60:61] op_sel:[0,1,0] op_sel_hi:[1,1,0]
  v_pk_fma_f32 v[102:103], v[102:103], v[60:61], v[60:61] op_sel:[0,1,0] op_sel_hi:[1,1,0]
  v_pk_mul_f32 v[100:101], v[100:101], v[196:197]
  v_pk_mul_f32 v[102:103], v[102:103], v[198:199]
  v_mfma_f32_16x16x16_bf16 v[212:215], v[42:43], v[48:49], v[212:215]
  v_exp_f32 v100, v100
  v_exp_f32 v101, v101
  v_exp_f32 v102, v102
  v_exp_f32 v103, v103
  v_pk_fma_f32 v[100:101], v[100:101], v[62:63], v[62:63] op_sel_hi:[1,0,0]
  v_pk_fma_f32 v[102:103], v[102:103], v[62:63], v[62:63] op_sel_hi:[1,0,0]
  v_rcp_f32 v100, v100
  v_rcp_f32 v101, v101
  v_rcp_f32 v102, v102
  v_rcp_f32 v103, v103
  v_pk_mul_f32 v[196:197], v[196:197], v[100:101]
  v_pk_mul_f32 v[198:199], v[198:199], v[102:103]
  v_cvt_pk_bf16_f32 v120, v196, v197
  v_cvt_pk_bf16_f32 v121, v198, v199
  v_pk_mul_f32 v[104:105], v[212:213], v[212:213]
  v_pk_mul_f32 v[106:107], v[214:215], v[214:215]
  v_pk_fma_f32 v[104:105], v[104:105], v[60:61], v[60:61] op_sel:[0,1,0] op_sel_hi:[1,1,0]
  v_pk_fma_f32 v[106:107], v[106:107], v[60:61], v[60:61] op_sel:[0,1,0] op_sel_hi:[1,1,0]
  v_pk_mul_f32 v[104:105], v[104:105], v[212:213]
  v_pk_mul_f32 v[106:107], v[106:107], v[214:215]
  v_mfma_f32_16x16x16_bf16 v[200:203], v[40:41], v[50:51], v[200:203]
  v_exp_f32 v104, v104
  v_exp_f32 v105, v105
  v_exp_f32 v106, v106
  v_exp_f32 v107, v107
  v_pk_fma_f32 v[104:105], v[104:105], v[62:63], v[62:63] op_sel_hi:[1,0,0]
  v_pk_fma_f32 v[106:107], v[106:107], v[62:63], v[62:63] op_sel_hi:[1,0,0]
  v_rcp_f32 v104, v104
  v_rcp_f32 v105, v105
  v_rcp_f32 v106, v106
  v_rcp_f32 v107, v107
  v_pk_mul_f32 v[212:213], v[212:213], v[104:105]
  v_pk_mul_f32 v[214:215], v[214:215], v[106:107]
  v_cvt_pk_bf16_f32 v122, v212, v213
  v_cvt_pk_bf16_f32 v123, v214, v215
  buffer_store_dwordx4 v[120:123], v17, s[44:47], s3 offen offset:2048
  ds_write_b128 v18, v[120:123] offset:18432
  v_pk_mul_f32 v[100:101], v[200:201], v[200:201]
  v_pk_mul_f32 v[102:103], v[202:203], v[202:203]
  v_pk_fma_f32 v[100:101], v[100:101], v[64:65], v[64:65] op_sel:[0,1,0] op_sel_hi:[1,1,0]
  v_pk_fma_f32 v[102:103], v[102:103], v[64:65], v[64:65] op_sel:[0,1,0] op_sel_hi:[1,1,0]
  v_pk_mul_f32 v[100:101], v[100:101], v[200:201]
  v_pk_mul_f32 v[102:103], v[102:103], v[202:203]
  v_mfma_f32_16x16x16_bf16 v[216:219], v[42:43], v[50:51], v[216:219]
  v_exp_f32 v100, v100
  v_exp_f32 v101, v101
  v_exp_f32 v102, v102
  v_exp_f32 v103, v103
  v_pk_fma_f32 v[100:101], v[100:101], v[66:67], v[66:67] op_sel_hi:[1,0,0]
  v_pk_fma_f32 v[102:103], v[102:103], v[66:67], v[66:67] op_sel_hi:[1,0,0]
  v_rcp_f32 v100, v100
  v_rcp_f32 v101, v101
  v_rcp_f32 v102, v102
  v_rcp_f32 v103, v103
  v_pk_mul_f32 v[200:201], v[200:201], v[100:101]
  v_pk_mul_f32 v[202:203], v[202:203], v[102:103]
  v_cvt_pk_bf16_f32 v108, v200, v201
  v_cvt_pk_bf16_f32 v109, v202, v203
  v_pk_mul_f32 v[104:105], v[216:217], v[216:217]
  v_pk_mul_f32 v[106:107], v[218:219], v[218:219]
  v_pk_fma_f32 v[104:105], v[104:105], v[64:65], v[64:65] op_sel:[0,1,0] op_sel_hi:[1,1,0]
  v_pk_fma_f32 v[106:107], v[106:107], v[64:65], v[64:65] op_sel:[0,1,0] op_sel_hi:[1,1,0]
  v_pk_mul_f32 v[104:105], v[104:105], v[216:217]
  v_pk_mul_f32 v[106:107], v[106:107], v[218:219]
  v_mfma_f32_16x16x16_bf16 v[204:207], v[40:41], v[52:53], v[204:207]
  v_exp_f32 v104, v104
  v_exp_f32 v105, v105
  v_exp_f32 v106, v106
  v_exp_f32 v107, v107
  v_pk_fma_f32 v[104:105], v[104:105], v[66:67], v[66:67] op_sel_hi:[1,0,0]
  v_pk_fma_f32 v[106:107], v[106:107], v[66:67], v[66:67] op_sel_hi:[1,0,0]
  v_rcp_f32 v104, v104
  v_rcp_f32 v105, v105
  v_rcp_f32 v106, v106
  v_rcp_f32 v107, v107
  v_pk_mul_f32 v[216:217], v[216:217], v[104:105]
  v_pk_mul_f32 v[218:219], v[218:219], v[106:107]
  v_cvt_pk_bf16_f32 v110, v216, v217
  v_cvt_pk_bf16_f32 v111, v218, v219
  buffer_store_dwordx4 v[108:111], v17, s[44:47], s8 offen offset:2048
  ds_write_b128 v18, v[108:111] offset:20480
  v_pk_mul_f32 v[100:101], v[204:205], v[204:205]
  v_pk_mul_f32 v[102:103], v[206:207], v[206:207]
  v_pk_fma_f32 v[100:101], v[100:101], v[68:69], v[68:69] op_sel:[0,1,0] op_sel_hi:[1,1,0]
  v_pk_fma_f32 v[102:103], v[102:103], v[68:69], v[68:69] op_sel:[0,1,0] op_sel_hi:[1,1,0]
  v_pk_mul_f32 v[100:101], v[100:101], v[204:205]
  v_pk_mul_f32 v[102:103], v[102:103], v[206:207]
  v_mfma_f32_16x16x16_bf16 v[220:223], v[42:43], v[52:53], v[220:223]
  v_exp_f32 v100, v100
  v_exp_f32 v101, v101
  v_exp_f32 v102, v102
  v_exp_f32 v103, v103
  v_pk_fma_f32 v[100:101], v[100:101], v[70:71], v[70:71] op_sel_hi:[1,0,0]
  v_pk_fma_f32 v[102:103], v[102:103], v[70:71], v[70:71] op_sel_hi:[1,0,0]
  v_rcp_f32 v100, v100
  v_rcp_f32 v101, v101
  v_rcp_f32 v102, v102
  v_rcp_f32 v103, v103
  v_pk_mul_f32 v[204:205], v[204:205], v[100:101]
  v_pk_mul_f32 v[206:207], v[206:207], v[102:103]
  v_cvt_pk_bf16_f32 v112, v204, v205
  v_cvt_pk_bf16_f32 v113, v206, v207
  v_pk_mul_f32 v[104:105], v[220:221], v[220:221]
  v_pk_mul_f32 v[106:107], v[222:223], v[222:223]
  v_pk_fma_f32 v[104:105], v[104:105], v[68:69], v[68:69] op_sel:[0,1,0] op_sel_hi:[1,1,0]
  v_pk_fma_f32 v[106:107], v[106:107], v[68:69], v[68:69] op_sel:[0,1,0] op_sel_hi:[1,1,0]
  v_pk_mul_f32 v[104:105], v[104:105], v[220:221]
  v_pk_mul_f32 v[106:107], v[106:107], v[222:223]
  v_exp_f32 v104, v104
  v_exp_f32 v105, v105
  v_exp_f32 v106, v106
  v_exp_f32 v107, v107
  v_pk_fma_f32 v[104:105], v[104:105], v[70:71], v[70:71] op_sel_hi:[1,0,0]
  v_pk_fma_f32 v[106:107], v[106:107], v[70:71], v[70:71] op_sel_hi:[1,0,0]
  v_rcp_f32 v104, v104
  v_rcp_f32 v105, v105
  v_rcp_f32 v106, v106
  v_rcp_f32 v107, v107
  v_pk_mul_f32 v[220:221], v[220:221], v[104:105]
  v_pk_mul_f32 v[222:223], v[222:223], v[106:107]
  v_cvt_pk_bf16_f32 v114, v220, v221
  v_cvt_pk_bf16_f32 v115, v222, v223
  buffer_store_dwordx4 v[112:115], v17, s[44:47], s9 offen offset:2048
  ds_write_b128 v18, v[112:115] offset:22528
  v_add_u32 v2, 114688, v27
  v_mov_b32 v6, v8
  v_xor_b32 v7, 32, v8
  v_xor_b32 v9, 96, v8
  v_xor_b32 v8, 64, v8
  s_waitcnt vmcnt(14)
  v_lshlrev_b32 v216, 16, v10
  v_and_b32 v217, s11, v10
  v_lshlrev_b32 v218, 16, v11
  v_and_b32 v219, s11, v11
  v_lshlrev_b32 v96, 16, v240
  v_and_b32 v97, s11, v240
  v_pk_add_f32 v[96:97], v[96:97], v[216:217]
  v_lshlrev_b32 v98, 16, v241
  v_and_b32 v99, s11, v241
  v_pk_add_f32 v[98:99], v[98:99], v[218:219]
  v_lshlrev_b32 v100, 16, v248
  v_and_b32 v101, s11, v248
  v_pk_add_f32 v[100:101], v[100:101], v[216:217]
  v_lshlrev_b32 v102, 16, v249
  v_and_b32 v103, s11, v249
  v_pk_add_f32 v[102:103], v[102:103], v[218:219]
  v_lshlrev_b32 v216, 16, v24
  v_and_b32 v217, s11, v24
  v_lshlrev_b32 v218, 16, v25
  v_and_b32 v219, s11, v25
  v_lshlrev_b32 v104, 16, v242
  v_and_b32 v105, s11, v242
  v_pk_add_f32 v[104:105], v[104:105], v[216:217]
  v_lshlrev_b32 v106, 16, v243
  v_and_b32 v107, s11, v243
  v_pk_add_f32 v[106:107], v[106:107], v[218:219]
  v_lshlrev_b32 v108, 16, v250
  v_and_b32 v109, s11, v250
  v_pk_add_f32 v[108:109], v[108:109], v[216:217]
  v_lshlrev_b32 v110, 16, v251
  v_and_b32 v111, s11, v251
  v_pk_add_f32 v[110:111], v[110:111], v[218:219]
  v_lshlrev_b32 v216, 16, v124
  v_and_b32 v217, s11, v124
  v_lshlrev_b32 v218, 16, v125
  v_and_b32 v219, s11, v125
  v_lshlrev_b32 v112, 16, v244
  v_and_b32 v113, s11, v244
  v_pk_add_f32 v[112:113], v[112:113], v[216:217]
  v_lshlrev_b32 v114, 16, v245
  v_and_b32 v115, s11, v245
  v_pk_add_f32 v[114:115], v[114:115], v[218:219]
  v_lshlrev_b32 v116, 16, v252
  v_and_b32 v117, s11, v252
  v_pk_add_f32 v[116:117], v[116:117], v[216:217]
  v_lshlrev_b32 v118, 16, v253
  v_and_b32 v119, s11, v253
  v_pk_add_f32 v[118:119], v[118:119], v[218:219]
  v_lshlrev_b32 v216, 16, v126
  v_and_b32 v217, s11, v126
  v_lshlrev_b32 v218, 16, v127
  v_and_b32 v219, s11, v127
  v_lshlrev_b32 v120, 16, v246
  v_and_b32 v121, s11, v246
  v_pk_add_f32 v[120:121], v[120:121], v[216:217]
  v_lshlrev_b32 v122, 16, v247
  v_and_b32 v123, s11, v247
  v_pk_add_f32 v[122:123], v[122:123], v[218:219]
  v_lshlrev_b32 v124, 16, v254
  v_and_b32 v125, s11, v254
  v_pk_add_f32 v[124:125], v[124:125], v[216:217]
  v_lshlrev_b32 v126, 16, v255
  v_and_b32 v127, s11, v255
  v_pk_add_f32 v[126:127], v[126:127], v[218:219]
  s_waitcnt vmcnt(0) lgkmcnt(0)
  s_barrier
  s_add_u32 s97, s97, 1
  s_branch L_w2_compute
L_w1_c1:
L_w2_c0:
L_w2_body:
  s_cmp_ge_u32 s2, 256
  s_cbranch_scc1 L_w2_end
  v_lshrrev_b32 v2, 6, v0
  v_and_b32 v1, 63, v0
  v_readfirstlane_b32 s70, v2
  s_and_b32 s3, s2, 7
  s_lshr_b32 s99, s2, 3
  s_and_b32 s5, s3, 3
  s_lshl_b32 s5, s5, 2
  s_and_b32 s6, s99, 3
  s_add_u32 s68, s5, s6
  s_lshr_b32 s5, s3, 2
  s_lshr_b32 s78, s99, 2
  s_lshl1_add_u32 s69, s78, s5
  s_add_u32 s3, s68, s78
  s_lshl_b32 s3, s3, 3
  s_lshl_b32 s85, 0xffff02, s3
  s_sub_u32 s3, 0, s3
  s_lshr_b32 s3, 0xffff02, s3
  s_or_b32 s85, s85, s3
L_w2_loader:
  s_add_u32 s3, s68, s78
  s_and_b32 s3, s3, 3
  s_mov_b32 s4, 0x1616160
  s_cmp_eq_u32 s3, 1
  s_cselect_b32 s4, 0x5858580, s4
  s_cmp_eq_u32 s3, 2
  s_cselect_b32 s4, 0x16161600, s4
  s_cmp_eq_u32 s3, 3
  s_cselect_b32 s4, 0x58585800, s4
  v_subrev_u32 v2, 3, v1
  v_min_u32 v2, 16, v2
  v_lshlrev_b32 v3, 1, v2
  v_bfe_i32 v16, s4, v3, 2
  v_sub_u32 v16, v1, v16
  v_subrev_u32 v16, 7, v16
  v_ashrrev_i32 v3, 1, v16
  v_cmp_eq_u32 vcc, s78, v3
  s_and_b32 s3, s69, 1
  v_or_b32 v2, 14, v16
  v_cndmask_b32 v2, v16, v2, vcc
  v_cmp_gt_i32 vcc, 0, v16
  s_lshl2_add_u32 s4, s3, 20
  v_add_u32 v16, s4, v16
  s_lshl4_add_u32 s4, s3, 24
  v_add_u32 v2, s4, v2
  v_cndmask_b32 v16, v2, v16, vcc
  s_and_b32 s5, s68, 3
  s_mul_i32 s5, s5, 3
  s_sub_u32 s5, s5, 23
  v_add_u32 v3, s5, v1
  v_subrev_u32 v2, 10, v3
  v_min_u32 v3, v3, v2
  v_subrev_u32 v2, 10, v3
  v_min_u32 v3, v3, v2
  v_cmp_gt_u32 vcc, 23, v1
  s_sub_u32 s5, s3, 46
  v_lshl_add_u32 v2, v1, 1, s5
  v_cndmask_b32 v3, v3, v2, vcc
  s_add_u32 s5, s78, 3
  v_ashrrev_i32 v2, 1, v3
  v_add_u32 v2, s5, v2
  v_and_b32 v2, 7, v2
  v_and_b32 v3, 1, v3
  v_cmp_gt_u32 vcc, 21, v1
  v_lshl_add_u32 v3, v3, 3, v2
  s_lshl1_add_u32 s4, s78, s4
  s_lshl3_add_u32 s3, s3, s78
  v_cndmask_b32 v3, v3, v16, vcc
  v_writelane_b32 v3, s4, 0
  s_add_u32 s4, s4, 1
  v_writelane_b32 v3, s3, 2
  v_writelane_b32 v3, s4, 1
  v_lshlrev_b32 v16, 17, v3
  s_add_u32 s9, s70, s68
  s_and_b32 s9, s9, 3
  s_lshl_b32 s77, s9, 11
  v_and_b32 v10, 7, v1
  v_lshrrev_b32 v3, 3, v1
  s_lshl_b32 s10, s9, 4
  v_add_u32 v3, s10, v3
  v_mul_u32_u24 v3, 2048, v3
  v_lshrrev_b32 v2, 3, v1
  v_and_b32 v2, 6, v2
  v_xor_b32 v2, v2, v10
  s_lshl_b32 s10, s69, 7
  v_add_u32 v3, s10, v3
  v_lshl_add_u32 v8, v2, 4, v3
  v_add_u32 v3, 16384, v3
  v_lshl_add_u32 v9, v2, 4, v3
  s_mov_b32 s40, s28
  s_and_b32 s41, s29, 0xffff
  s_mov_b32 s42, 7340032
  s_mov_b32 s43, 0x00020000
  s_bitcmp1_b32 s69, 0
  s_mov_b32 s76, 128
  s_cselect_b32 s76, -128, s76
  v_readlane_b32 s74, v16, 0
  s_add_u32 m0, s77, 0
  s_add_u32 s4, s74, s76
  buffer_load_dwordx4 v8, s[40:43], s4 offen lds
  s_add_u32 m0, s77, 1024
  s_nop 0
  buffer_load_dwordx4 v9, s[40:43], s4 offen lds
  s_add_u32 m0, s77, 8192
  s_add_u32 s4, s74, 0
  buffer_load_dwordx4 v8, s[40:43], s4 offen lds
  s_add_u32 m0, s77, 9216
  s_nop 0
  buffer_load_dwordx4 v9, s[40:43], s4 offen lds
  v_readlane_b32 s74, v16, 1
  s_add_u32 m0, s77, 16384
  s_add_u32 s4, s74, s76
  buffer_load_dwordx4 v8, s[40:43], s4 offen lds
  s_add_u32 m0, s77, 17408
  s_nop 0
  buffer_load_dwordx4 v9, s[40:43], s4 offen lds
  s_add_u32 m0, s77, 24576
  s_add_u32 s4, s74, 0
  buffer_load_dwordx4 v8, s[40:43], s4 offen lds
  s_add_u32 m0, s77, 25600
  s_nop 0
  buffer_load_dwordx4 v9, s[40:43], s4 offen lds
  v_readlane_b32 s74, v16, 2
  s_add_u32 m0, s77, 32768
  s_add_u32 s4, s74, s76
  buffer_load_dwordx4 v8, s[40:43], s4 offen lds
  s_add_u32 m0, s77, 33792
  s_nop 0
  buffer_load_dwordx4 v9, s[40:43], s4 offen lds
  s_add_u32 m0, s77, 40960
  s_add_u32 s4, s74, 0
  buffer_load_dwordx4 v8, s[40:43], s4 offen lds
  s_add_u32 m0, s77, 41984
  s_nop 0
  buffer_load_dwordx4 v9, s[40:43], s4 offen lds
  v_readlane_b32 s74, v16, 3
  s_add_u32 m0, s77, 49152
  s_add_u32 s4, s74, s76
  buffer_load_dwordx4 v8, s[40:43], s4 offen lds
  s_add_u32 m0, s77, 50176
  s_nop 0
  buffer_load_dwordx4 v9, s[40:43], s4 offen lds
  s_add_u32 m0, s77, 57344
  s_add_u32 s4, s74, 0
  buffer_load_dwordx4 v8, s[40:43], s4 offen lds
  s_add_u32 m0, s77, 58368
  s_nop 0
  buffer_load_dwordx4 v9, s[40:43], s4 offen lds
  v_readlane_b32 s74, v16, 4
  s_add_u32 m0, s77, 65536
  s_add_u32 s4, s74, s76
  buffer_load_dwordx4 v8, s[40:43], s4 offen lds
  s_add_u32 m0, s77, 66560
  s_nop 0
  buffer_load_dwordx4 v9, s[40:43], s4 offen lds
  s_add_u32 m0, s77, 73728
  s_add_u32 s4, s74, 0
  buffer_load_dwordx4 v8, s[40:43], s4 offen lds
  s_add_u32 m0, s77, 74752
  s_nop 0
  buffer_load_dwordx4 v9, s[40:43], s4 offen lds
  s_add_u32 s44, s22, 41943040
  s_addc_u32 s45, s23, 0
  s_and_b32 s45, s45, 0xffff
  s_mov_b32 s46, 524288
  s_mov_b32 s47, 0x00020000
  s_lshl4_add_u32 s3, s97, s68
  s_and_b32 s4, s69, 15
  s_lshl4_add_u32 s3, s3, s4
  s_lshl_b32 s3, s3, 7
  s_sub_u32 s86, s3, 32768
  v_lshlrev_b32 v11, 7, v1
  v_and_b32 v2, 15, v1
  v_lshlrev_b32 v2, 2, v2
  s_cmp_lg_u32 s70, 4
  s_waitcnt vmcnt(14)
  s_cbranch_scc1 L_w2_nofl
  v_readlane_b32 s74, v16, 5
  s_add_u32 m0, s77, 81920
  s_add_u32 s4, s74, s76
  buffer_load_dwordx4 v8, s[40:43], s4 offen lds
  s_add_u32 m0, s77, 82944
  s_nop 0
  buffer_load_dwordx4 v9, s[40:43], s4 offen lds
  s_add_u32 m0, s77, 90112
  s_add_u32 s4, s74, 0
  buffer_load_dwordx4 v8, s[40:43], s4 offen lds
  s_add_u32 m0, s77, 91136
  s_nop 0
  buffer_load_dwordx4 v9, s[40:43], s4 offen lds
  v_readlane_b32 s74, v16, 6
  s_add_u32 m0, s77, 98304
  s_add_u32 s4, s74, s76
  buffer_load_dwordx4 v8, s[40:43], s4 offen lds
  s_add_u32 m0, s77, 99328
  s_nop 0
  buffer_load_dwordx4 v9, s[40:43], s4 offen lds
  v_mov_b32 v3, 1
  s_mov_b32 s79, 0x100000
  s_or_b32 s4, s2, 0xe0
  s_lshl4_add_u32 s4, s4, s97
  s_lshl_b32 s4, s4, 7
  s_lshl2_add_u32 s5, s78, s4
  s_cmp_eq_u32 s92, 0
  s_cselect_b32 s3, s4, s86
  s_cselect_b32 s4, 28, 60
  v_and_b32 v13, s4, v2
  buffer_load_dword v12, v13, s[44:47], s3 offen sc1
  s_setprio 3
  s_barrier
  s_cbranch_scc0 L_w2_wb
L_w2_wbd:
  s_mov_b64 exec, 1
  buffer_store_dword v3, off, s[44:47], s5
  s_mov_b64 exec, -1
L_w2_poll:
  buffer_load_dword v12, v13, s[44:47], s3 offen sc1
  s_sub_u32 s79, s79, 1
  s_cbranch_scc1 L_w2_dep
  s_waitcnt vmcnt(0)
  v_cmp_ne_u32 vcc, 1, v12
  s_cbranch_vccnz L_w2_poll
L_w2_dep:
  s_barrier
  s_setprio 0
  s_mov_b64 exec, 0xffff
  buffer_store_dword v3, v11, s[44:47], s87 offen sc1
  s_mov_b64 exec, -1
  s_branch L_w2_go
L_w2_nofl:
  s_barrier
  v_readlane_b32 s74, v16, 5
  s_add_u32 m0, s77, 81920
  s_add_u32 s4, s74, s76
  buffer_load_dwordx4 v8, s[40:43], s4 offen lds
  s_add_u32 m0, s77, 82944
  s_nop 0
  buffer_load_dwordx4 v9, s[40:43], s4 offen lds
  s_add_u32 m0, s77, 90112
  s_add_u32 s4, s74, 0
  buffer_load_dwordx4 v8, s[40:43], s4 offen lds
  s_add_u32 m0, s77, 91136
  s_nop 0
  buffer_load_dwordx4 v9, s[40:43], s4 offen lds
  v_readlane_b32 s74, v16, 6
  s_add_u32 m0, s77, 98304
  s_add_u32 s4, s74, s76
  buffer_load_dwordx4 v8, s[40:43], s4 offen lds
  s_add_u32 m0, s77, 99328
  s_nop 0
  buffer_load_dwordx4 v9, s[40:43], s4 offen lds
  s_waitcnt vmcnt(8)
  s_barrier
L_w2_go:
  s_add_u32 m0, s77, 106496
  s_add_u32 s4, s74, 0
  buffer_load_dwordx4 v8, s[40:43], s4 offen lds
  s_add_u32 m0, s77, 107520
  s_nop 0
  buffer_load_dwordx4 v9, s[40:43], s4 offen lds
  s_waitcnt vmcnt(4)
  v_readlane_b32 s74, v16, 7
  s_add_u32 m0, s77, 114688
  s_add_u32 s4, s74, s76
  buffer_load_dwordx4 v8, s[40:43], s4 offen lds
  s_add_u32 m0, s77, 115712
  s_nop 0
  buffer_load_dwordx4 v9, s[40:43], s4 offen lds
  s_waitcnt vmcnt(4)
  s_add_u32 m0, s77, 122880
  s_add_u32 s4, s74, 0
  buffer_load_dwordx4 v8, s[40:43], s4 offen lds
  s_add_u32 m0, s77, 123904
  s_nop 0
  buffer_load_dwordx4 v9, s[40:43], s4 offen lds
  s_waitcnt vmcnt(4)
  v_readlane_b32 s74, v16, 8
  s_add_u32 m0, s77, 131072
  s_add_u32 s4, s74, s76
  buffer_load_dwordx4 v8, s[40:43], s4 offen lds
  s_add_u32 m0, s77, 132096
  s_nop 0
  buffer_load_dwordx4 v9, s[40:43], s4 offen lds
  s_waitcnt vmcnt(4)
  s_add_u32 m0, s77, 139264
  s_add_u32 s4, s74, 0
  buffer_load_dwordx4 v8, s[40:43], s4 offen lds
  s_add_u32 m0, s77, 140288
  s_nop 0
  buffer_load_dwordx4 v9, s[40:43], s4 offen lds
  s_waitcnt vmcnt(4)
  v_readlane_b32 s74, v16, 9
  s_add_u32 m0, s77, 147456
  s_add_u32 s4, s74, s76
  buffer_load_dwordx4 v8, s[40:43], s4 offen lds
  s_add_u32 m0, s77, 148480
  s_nop 0
  buffer_load_dwordx4 v9, s[40:43], s4 offen lds
  s_waitcnt vmcnt(12)
  s_barrier
  s_add_u32 m0, s77, 155648
  s_add_u32 s4, s74, 0
  buffer_load_dwordx4 v8, s[40:43], s4 offen lds
  s_add_u32 m0, s77, 156672
  s_nop 0
  buffer_load_dwordx4 v9, s[40:43], s4 offen lds
  s_waitcnt vmcnt(4)
  v_readlane_b32 s74, v16, 10
  s_add_u32 m0, s77, 0
  s_add_u32 s4, s74, s76
  buffer_load_dwordx4 v8, s[40:43], s4 offen lds
  s_add_u32 m0, s77, 1024
  s_nop 0
  buffer_load_dwordx4 v9, s[40:43], s4 offen lds
  s_waitcnt vmcnt(4)
  s_add_u32 m0, s77, 8192
  s_add_u32 s4, s74, 0
  buffer_load_dwordx4 v8, s[40:43], s4 offen lds
  s_add_u32 m0, s77, 9216
  s_nop 0
  buffer_load_dwordx4 v9, s[40:43], s4 offen lds
  s_waitcnt vmcnt(4)
  v_readlane_b32 s74, v16, 11
  s_add_u32 m0, s77, 16384
  s_add_u32 s4, s74, s76
  buffer_load_dwordx4 v8, s[40:43], s4 offen lds
  s_add_u32 m0, s77, 17408
  s_nop 0
  buffer_load_dwordx4 v9, s[40:43], s4 offen lds
  s_waitcnt vmcnt(12)
  s_barrier
  s_add_u32 m0, s77, 24576
  s_add_u32 s4, s74, 0
  buffer_load_dwordx4 v8, s[40:43], s4 offen lds
  s_add_u32 m0, s77, 25600
  s_nop 0
  buffer_load_dwordx4 v9, s[40:43], s4 offen lds
  s_waitcnt vmcnt(4)
  v_readlane_b32 s74, v16, 12
  s_add_u32 m0, s77, 32768
  s_add_u32 s4, s74, s76
  buffer_load_dwordx4 v8, s[40:43], s4 offen lds
  s_add_u32 m0, s77, 33792
  s_nop 0
  buffer_load_dwordx4 v9, s[40:43], s4 offen lds
  s_waitcnt vmcnt(4)
  s_add_u32 m0, s77, 40960
  s_add_u32 s4, s74, 0
  buffer_load_dwordx4 v8, s[40:43], s4 offen lds
  s_add_u32 m0, s77, 41984
  s_nop 0
  buffer_load_dwordx4 v9, s[40:43], s4 offen lds
  s_waitcnt vmcnt(4)
  v_readlane_b32 s74, v16, 13
  s_add_u32 m0, s77, 49152
  s_add_u32 s4, s74, s76
  buffer_load_dwordx4 v8, s[40:43], s4 offen lds
  s_add_u32 m0, s77, 50176
  s_nop 0
  buffer_load_dwordx4 v9, s[40:43], s4 offen lds
  s_waitcnt vmcnt(12)
  s_barrier
  s_add_u32 m0, s77, 57344
  s_add_u32 s4, s74, 0
  buffer_load_dwordx4 v8, s[40:43], s4 offen lds
  s_add_u32 m0, s77, 58368
  s_nop 0
  buffer_load_dwordx4 v9, s[40:43], s4 offen lds
  s_waitcnt vmcnt(4)
  v_readlane_b32 s74, v16, 14
  s_add_u32 m0, s77, 65536
  s_add_u32 s4, s74, s76
  buffer_load_dwordx4 v8, s[40:43], s4 offen lds
  s_add_u32 m0, s77, 66560
  s_nop 0
  buffer_load_dwordx4 v9, s[40:43], s4 offen lds
  s_waitcnt vmcnt(4)
  s_add_u32 m0, s77, 73728
  s_add_u32 s4, s74, 0
  buffer_load_dwordx4 v8, s[40:43], s4 offen lds
  s_add_u32 m0, s77, 74752
  s_nop 0
  buffer_load_dwordx4 v9, s[40:43], s4 offen lds
  s_waitcnt vmcnt(4)
  v_readlane_b32 s74, v16, 15
  s_add_u32 m0, s77, 81920
  s_add_u32 s4, s74, s76
  buffer_load_dwordx4 v8, s[40:43], s4 offen lds
  s_add_u32 m0, s77, 82944
  s_nop 0
  buffer_load_dwordx4 v9, s[40:43], s4 offen lds
  s_waitcnt vmcnt(12)
  s_barrier
  s_add_u32 m0, s77, 90112
  s_add_u32 s4, s74, 0
  buffer_load_dwordx4 v8, s[40:43], s4 offen lds
  s_add_u32 m0, s77, 91136
  s_nop 0
  buffer_load_dwordx4 v9, s[40:43], s4 offen lds
  s_waitcnt vmcnt(4)
  v_readlane_b32 s74, v16, 16
  s_add_u32 m0, s77, 98304
  s_add_u32 s4, s74, s76
  buffer_load_dwordx4 v8, s[40:43], s4 offen lds
  s_add_u32 m0, s77, 99328
  s_nop 0
  buffer_load_dwordx4 v9, s[40:43], s4 offen lds
  s_waitcnt vmcnt(4)
  s_add_u32 m0, s77, 106496
  s_add_u32 s4, s74, 0
  buffer_load_dwordx4 v8, s[40:43], s4 offen lds
  s_add_u32 m0, s77, 107520
  s_nop 0
  buffer_load_dwordx4 v9, s[40:43], s4 offen lds
  s_waitcnt vmcnt(4)
  v_readlane_b32 s74, v16, 17
  s_add_u32 m0, s77, 114688
  s_add_u32 s4, s74, s76
  buffer_load_dwordx4 v8, s[40:43], s4 offen lds
  s_add_u32 m0, s77, 115712
  s_nop 0
  buffer_load_dwordx4 v9, s[40:43], s4 offen lds
  s_waitcnt vmcnt(12)
  s_barrier
  v_readlane_b32 s74, v16, 18
  s_add_u32 m0, s77, 122880
  s_add_u32 s4, s74, s76
  buffer_load_dwordx4 v8, s[40:43], s4 offen lds
  s_add_u32 m0, s77, 123904
  s_nop 0
  buffer_load_dwordx4 v9, s[40:43], s4 offen lds
  s_waitcnt vmcnt(4)
  v_readlane_b32 s74, v16, 19
  s_add_u32 m0, s77, 131072
  s_add_u32 s4, s74, s76
  buffer_load_dwordx4 v8, s[40:43], s4 offen lds
  s_add_u32 m0, s77, 132096
  s_nop 0
  buffer_load_dwordx4 v9, s[40:43], s4 offen lds
  s_waitcnt vmcnt(4)
  s_cmp_eq_u32 s70, 4
  s_cselect_b32 s46, s46, 0
  buffer_load_dword v3, v2, s[44:47], s86 offen sc1
  v_readlane_b32 s74, v16, 20
  s_add_u32 m0, s77, 139264
  s_add_u32 s4, s74, s76
  buffer_load_dwordx4 v8, s[40:43], s4 offen lds
  s_add_u32 m0, s77, 140288
  s_nop 0
  buffer_load_dwordx4 v9, s[40:43], s4 offen lds
  s_waitcnt vmcnt(4)
  v_readlane_b32 s74, v16, 21
  s_add_u32 m0, s77, 147456
  s_add_u32 s4, s74, s76
  buffer_load_dwordx4 v8, s[40:43], s4 offen lds
  s_add_u32 m0, s77, 148480
  s_nop 0
  buffer_load_dwordx4 v9, s[40:43], s4 offen lds
  s_mov_b32 s79, 0x100000
  s_cmp_lg_u32 s70, 4
  s_cbranch_scc1 L_w2l_dep
  s_waitcnt vmcnt(4)
  v_cmp_ne_u32 vcc, 1, v3
  s_cbranch_vccz L_w2l_dep
L_w2l_poll:
  buffer_load_dword v3, v2, s[44:47], s86 offen sc1
  s_sub_u32 s79, s79, 1
  s_cbranch_scc1 L_w2l_dep
  s_waitcnt vmcnt(0)
  v_cmp_ne_u32 vcc, 1, v3
  s_cbranch_vccnz L_w2l_poll
L_w2l_dep:
  s_waitcnt vmcnt(13)
  s_barrier
  v_readlane_b32 s74, v16, 22
  s_add_u32 m0, s77, 155648
  s_add_u32 s4, s74, s76
  buffer_load_dwordx4 v8, s[40:43], s4 offen lds
  s_add_u32 m0, s77, 156672
  s_nop 0
  buffer_load_dwordx4 v9, s[40:43], s4 offen lds
  s_waitcnt vmcnt(4)
  v_readlane_b32 s74, v16, 17
  s_add_u32 m0, s77, 0
  s_add_u32 s4, s74, 0
  buffer_load_dwordx4 v8, s[40:43], s4 offen lds
  s_add_u32 m0, s77, 1024
  s_nop 0
  buffer_load_dwordx4 v9, s[40:43], s4 offen lds
  s_waitcnt vmcnt(4)
  v_readlane_b32 s74, v16, 18
  s_add_u32 m0, s77, 8192
  s_add_u32 s4, s74, 0
  buffer_load_dwordx4 v8, s[40:43], s4 offen lds
  s_add_u32 m0, s77, 9216
  s_nop 0
  buffer_load_dwordx4 v9, s[40:43], s4 offen lds
  s_waitcnt vmcnt(4)
  v_readlane_b32 s74, v16, 19
  s_add_u32 m0, s77, 16384
  s_add_u32 s4, s74, 0
  buffer_load_dwordx4 v8, s[40:43], s4 offen lds
  s_add_u32 m0, s77, 17408
  s_nop 0
  buffer_load_dwordx4 v9, s[40:43], s4 offen lds
  s_waitcnt vmcnt(13)
  s_barrier
  v_readlane_b32 s74, v16, 20
  s_add_u32 m0, s77, 24576
  s_add_u32 s4, s74, 0
  buffer_load_dwordx4 v8, s[40:43], s4 offen lds
  s_add_u32 m0, s77, 25600
  s_nop 0
  buffer_load_dwordx4 v9, s[40:43], s4 offen lds
  s_waitcnt vmcnt(30)
  v_readlane_b32 s74, v16, 21
  s_add_u32 m0, s77, 32768
  s_add_u32 s4, s74, 0
  buffer_load_dwordx4 v8, s[40:43], s4 offen lds
  s_add_u32 m0, s77, 33792
  s_nop 0
  buffer_load_dwordx4 v9, s[40:43], s4 offen lds
  s_waitcnt vmcnt(30)
  v_readlane_b32 s74, v16, 22
  s_add_u32 m0, s77, 40960
  s_add_u32 s4, s74, 0
  buffer_load_dwordx4 v8, s[40:43], s4 offen lds
  s_add_u32 m0, s77, 41984
  s_nop 0
  buffer_load_dwordx4 v9, s[40:43], s4 offen lds
  s_waitcnt vmcnt(30)
  v_readlane_b32 s74, v16, 23
  s_add_u32 m0, s77, 49152
  s_add_u32 s4, s74, 0
  buffer_load_dwordx4 v8, s[40:43], s4 offen lds
  s_add_u32 m0, s77, 50176
  s_nop 0
  buffer_load_dwordx4 v9, s[40:43], s4 offen lds
  s_waitcnt vmcnt(30)
  v_readlane_b32 s74, v16, 24
  s_add_u32 m0, s77, 57344
  s_add_u32 s4, s74, 0
  buffer_load_dwordx4 v8, s[40:43], s4 offen lds
  s_add_u32 m0, s77, 58368
  s_nop 0
  buffer_load_dwordx4 v9, s[40:43], s4 offen lds
  s_waitcnt vmcnt(30)
  v_readlane_b32 s74, v16, 25
  s_add_u32 m0, s77, 65536
  s_add_u32 s4, s74, 0
  buffer_load_dwordx4 v8, s[40:43], s4 offen lds
  s_add_u32 m0, s77, 66560
  s_nop 0
  buffer_load_dwordx4 v9, s[40:43], s4 offen lds
  s_waitcnt vmcnt(30)
  v_readlane_b32 s74, v16, 26
  s_add_u32 m0, s77, 73728
  s_add_u32 s4, s74, 0
  buffer_load_dwordx4 v8, s[40:43], s4 offen lds
  s_add_u32 m0, s77, 74752
  s_nop 0
  buffer_load_dwordx4 v9, s[40:43], s4 offen lds
  s_waitcnt vmcnt(30)
  v_readlane_b32 s74, v16, 27
  s_add_u32 m0, s77, 81920
  s_add_u32 s4, s74, 0
  buffer_load_dwordx4 v8, s[40:43], s4 offen lds
  s_add_u32 m0, s77, 82944
  s_nop 0
  buffer_load_dwordx4 v9, s[40:43], s4 offen lds
  s_waitcnt vmcnt(30)
  v_readlane_b32 s74, v16, 28
  s_add_u32 m0, s77, 90112
  s_add_u32 s4, s74, 0
  buffer_load_dwordx4 v8, s[40:43], s4 offen lds
  s_add_u32 m0, s77, 91136
  s_nop 0
  buffer_load_dwordx4 v9, s[40:43], s4 offen lds
  s_waitcnt vmcnt(22)
  s_barrier
  v_readlane_b32 s74, v16, 29
  s_add_u32 m0, s77, 98304
  s_add_u32 s4, s74, 0
  buffer_load_dwordx4 v8, s[40:43], s4 offen lds
  s_add_u32 m0, s77, 99328
  s_nop 0
  buffer_load_dwordx4 v9, s[40:43], s4 offen lds
  s_waitcnt vmcnt(30)
  v_readlane_b32 s74, v16, 30
  s_add_u32 m0, s77, 106496
  s_add_u32 s4, s74, 0
  buffer_load_dwordx4 v8, s[40:43], s4 offen lds
  s_add_u32 m0, s77, 107520
  s_nop 0
  buffer_load_dwordx4 v9, s[40:43], s4 offen lds
  s_waitcnt vmcnt(30)
  v_readlane_b32 s74, v16, 31
  s_add_u32 m0, s77, 114688
  s_add_u32 s4, s74, 0
  buffer_load_dwordx4 v8, s[40:43], s4 offen lds
  s_add_u32 m0, s77, 115712
  s_nop 0
  buffer_load_dwordx4 v9, s[40:43], s4 offen lds
  s_waitcnt vmcnt(30)
  v_readlane_b32 s74, v16, 32
  s_add_u32 m0, s77, 122880
  s_add_u32 s4, s74, 0
  buffer_load_dwordx4 v8, s[40:43], s4 offen lds
  s_add_u32 m0, s77, 123904
  s_nop 0
  buffer_load_dwordx4 v9, s[40:43], s4 offen lds
  s_waitcnt vmcnt(22)
  s_barrier
  s_add_u32 s64, s22, 41943040
  s_addc_u32 s65, s23, 0
  s_and_b32 s65, s65, 0xffff
  s_mov_b32 s66, 524288
  s_mov_b32 s67, 0x00020000
  s_lshl4_add_u32 s6, s68, s69
  s_xor_b32 s6, s6, 1
  s_add_u32 s7, s96, 4
  s_lshl_b32 s7, s7, 8
  s_add_u32 s6, s6, s7
  s_lshl_b32 s86, s6, 8
  v_and_b32 v2, 3, v1
  v_lshlrev_b32 v30, 6, v2
  s_mov_b32 s79, 0x100000
  s_waitcnt vmcnt(0)
  s_barrier
  s_cmp_eq_u32 s96, 0
  s_cbranch_scc1 L_w2_zskip
  s_cmp_lg_u32 s70, 4
  s_cbranch_scc1 L_w2_xgo
  s_setprio 3
L_w2_xpoll:
  buffer_load_dword v5, v30, s[64:67], s86 offen sc1
  s_sub_u32 s79, s79, 1
  s_cbranch_scc1 L_w2_xgo
  s_waitcnt vmcnt(0)
  v_cmp_ne_u32 vcc, 1, v5
  s_cbranch_vccnz L_w2_xpoll
L_w2_xgo:
  s_setprio 0
  s_waitcnt vmcnt(0)
  s_barrier
L_w2_zskip:
  s_cmp_eq_u32 s96, 1
  s_cbranch_scc1 L_w2_end
  s_lshl_b32 s87, s97, 15
  s_lshl_b32 s4, s68, 11
  s_add_u32 s87, s87, s4
  s_lshl_b32 s4, s69, 2
  s_add_u32 s87, s87, s4
  s_mov_b32 s96, 1
  s_add_u32 s12, s22, 33554432
  s_addc_u32 s13, s23, 0
  s_add_u32 s34, s22, 67108864
  s_addc_u32 s35, s23, 0
  s_add_u32 s97, s97, 1
  s_branch L_attn_body
L_w2_wb:
  buffer_wbl2 sc1
  s_waitcnt vmcnt(0)
  s_mov_b64 exec, 0xffff
  buffer_store_dword v3, v11, s[44:47], s87 offen sc1
  s_branch L_w2_wbd
L_w2_end:
  s_endpgm
L_w2_compute:
  ds_read_b128 v[32:35], v2 offset:0
  ds_read_b128 v[36:39], v2 offset:2048
  ds_read_b64_tr_b16 v[160:161], v6 offset:0
  ds_read_b64_tr_b16 v[162:163], v6 offset:2048
  ds_read_b64_tr_b16 v[164:165], v7 offset:0
  ds_read_b64_tr_b16 v[166:167], v7 offset:2048
  ds_read_b64_tr_b16 v[176:177], v6 offset:4096
  ds_read_b64_tr_b16 v[178:179], v6 offset:6144
  ds_read_b64_tr_b16 v[180:181], v7 offset:4096
  ds_read_b64_tr_b16 v[182:183], v7 offset:6144
  ds_read_b128 v[40:43], v2 offset:1024
  ds_read_b128 v[44:47], v2 offset:3072
  ds_read_b64_tr_b16 v[168:169], v8 offset:0
  ds_read_b64_tr_b16 v[170:171], v8 offset:2048
  ds_read_b64_tr_b16 v[172:173], v9 offset:0
  ds_read_b64_tr_b16 v[174:175], v9 offset:2048
  ds_read_b64_tr_b16 v[184:185], v8 offset:4096
  ds_read_b64_tr_b16 v[186:187], v8 offset:6144
  ds_read_b64_tr_b16 v[188:189], v9 offset:4096
  ds_read_b64_tr_b16 v[190:191], v9 offset:6144
  ds_read_b128 v[48:51], v2 offset:16384
  ds_read_b128 v[52:55], v2 offset:18432
  ds_read_b128 v[56:59], v2 offset:17408
  ds_read_b128 v[60:63], v2 offset:19456
  ds_read_b128 v[64:67], v2 offset:32768
  ds_read_b128 v[68:71], v2 offset:34816
  ds_read_b128 v[72:75], v2 offset:33792
  ds_read_b128 v[76:79], v2 offset:35840
  s_waitcnt lgkmcnt(15)
  v_mfma_f32_16x16x32_bf16 v[128:131], v[160:163], v[32:35], 0
  ds_read_b64_tr_b16 v[192:193], v6 offset:8192
  v_mov_b32 v4, v26
  v_mfma_f32_16x16x32_bf16 v[128:131], v[176:179], v[40:43], v[128:131]
  ds_read_b64_tr_b16 v[194:195], v6 offset:10240
  v_mov_b32 v5, v27
  v_mfma_f32_16x16x32_bf16 v[132:135], v[176:179], v[44:47], 0
  ds_read_b64_tr_b16 v[196:197], v7 offset:8192
  v_mov_b32 v12, v28
  v_mfma_f32_16x16x32_bf16 v[132:135], v[160:163], v[36:39], v[132:135]
  ds_read_b64_tr_b16 v[198:199], v7 offset:10240
  v_mov_b32 v18, v29
  v_mfma_f32_16x16x32_bf16 v[140:143], v[164:167], v[36:39], 0
  ds_read_b64_tr_b16 v[208:209], v6 offset:12288
  v_mov_b32 v19, 1
  v_mfma_f32_16x16x32_bf16 v[140:143], v[180:183], v[44:47], v[140:143]
  ds_read_b64_tr_b16 v[210:211], v6 offset:14336
  v_add_u32 v20, 65536, v6
  v_mfma_f32_16x16x32_bf16 v[136:139], v[180:183], v[40:43], 0
  ds_read_b64_tr_b16 v[212:213], v7 offset:12288
  v_add_u32 v21, 65536, v7
  v_mfma_f32_16x16x32_bf16 v[136:139], v[164:167], v[32:35], v[136:139]
  ds_read_b64_tr_b16 v[214:215], v7 offset:14336
  s_waitcnt lgkmcnt(15)
  v_mfma_f32_16x16x32_bf16 v[144:147], v[168:171], v[32:35], 0
  ds_read_b64_tr_b16 v[200:201], v8 offset:8192
  v_add_u32 v22, 65536, v8
  v_mfma_f32_16x16x32_bf16 v[144:147], v[184:187], v[40:43], v[144:147]
  ds_read_b64_tr_b16 v[202:203], v8 offset:10240
  v_add_u32 v23, 65536, v9
  v_mfma_f32_16x16x32_bf16 v[148:151], v[184:187], v[44:47], 0
  ds_read_b64_tr_b16 v[204:205], v9 offset:8192
  v_add_u32 v26, 131072, v6
  v_mfma_f32_16x16x32_bf16 v[148:151], v[168:171], v[36:39], v[148:151]
  ds_read_b64_tr_b16 v[206:207], v9 offset:10240
  v_add_u32 v27, 131072, v7
  v_mfma_f32_16x16x32_bf16 v[156:159], v[172:175], v[36:39], 0
  ds_read_b64_tr_b16 v[216:217], v8 offset:12288
  v_add_u32 v28, 131072, v8
  v_mfma_f32_16x16x32_bf16 v[156:159], v[188:191], v[44:47], v[156:159]
  ds_read_b64_tr_b16 v[218:219], v8 offset:14336
  v_add_u32 v29, 131072, v9
  v_mfma_f32_16x16x32_bf16 v[152:155], v[188:191], v[40:43], 0
  ds_read_b64_tr_b16 v[220:221], v9 offset:12288
  s_add_u32 s52, s22, 41943040
  v_mfma_f32_16x16x32_bf16 v[152:155], v[172:175], v[32:35], v[152:155]
  ds_read_b64_tr_b16 v[222:223], v9 offset:14336
  s_waitcnt lgkmcnt(8)
  v_mfma_f32_16x16x32_bf16 v[96:99], v[192:195], v[32:35], v[96:99]
  ds_read_b64_tr_b16 v[160:161], v6 offset:16384
  s_addc_u32 s53, s23, 0
  v_mfma_f32_16x16x32_bf16 v[96:99], v[208:211], v[40:43], v[96:99]
  ds_read_b64_tr_b16 v[162:163], v6 offset:18432
  s_and_b32 s53, s53, 0xffff
  v_mfma_f32_16x16x32_bf16 v[100:103], v[208:211], v[44:47], v[100:103]
  ds_read_b64_tr_b16 v[164:165], v7 offset:16384
  s_mov_b32 s54, 524288
  v_mfma_f32_16x16x32_bf16 v[100:103], v[192:195], v[36:39], v[100:103]
  ds_read_b64_tr_b16 v[166:167], v7 offset:18432
  s_mov_b32 s55, 0x00020000
  v_mfma_f32_16x16x32_bf16 v[108:111], v[196:199], v[36:39], v[108:111]
  ds_read_b64_tr_b16 v[176:177], v6 offset:20480
  v_mfma_f32_16x16x32_bf16 v[108:111], v[212:215], v[44:47], v[108:111]
  ds_read_b64_tr_b16 v[178:179], v6 offset:22528
  v_mfma_f32_16x16x32_bf16 v[104:107], v[212:215], v[40:43], v[104:107]
  ds_read_b64_tr_b16 v[180:181], v7 offset:20480
  v_mfma_f32_16x16x32_bf16 v[104:107], v[196:199], v[32:35], v[104:107]
  ds_read_b64_tr_b16 v[182:183], v7 offset:22528
  s_waitcnt lgkmcnt(8)
  s_barrier
  buffer_load_dwordx4 v[80:83], off, s[36:39], s51 offset:0 sc1
  buffer_load_dwordx4 v[84:87], off, s[64:67], s51 offset:0 sc1
  buffer_load_dwordx4 v[88:91], off, s[36:39], s51 offset:1024 sc1
  buffer_load_dwordx4 v[92:95], off, s[64:67], s51 offset:1024 sc1
  buffer_load_dwordx4 v[224:227], off, s[36:39], s48 offset:0 sc1
  buffer_load_dwordx4 v[228:231], off, s[64:67], s48 offset:0 sc1
  buffer_load_dwordx4 v[232:235], off, s[36:39], s48 offset:1024 sc1
  buffer_load_dwordx4 v[236:239], off, s[64:67], s48 offset:1024 sc1
  buffer_load_dwordx4 v[240:243], off, s[36:39], s49 offset:0 sc1
  buffer_load_dwordx4 v[244:247], off, s[64:67], s49 offset:0 sc1
  buffer_load_dwordx4 v[248:251], off, s[36:39], s49 offset:1024 sc1
  buffer_load_dwordx4 v[252:255], off, s[64:67], s49 offset:1024 sc1
  v_mfma_f32_16x16x32_bf16 v[112:115], v[200:203], v[32:35], v[112:115]
  ds_read_b64_tr_b16 v[168:169], v8 offset:16384
  v_mfma_f32_16x16x32_bf16 v[112:115], v[216:219], v[40:43], v[112:115]
  ds_read_b64_tr_b16 v[170:171], v8 offset:18432
  v_mfma_f32_16x16x32_bf16 v[116:119], v[216:219], v[44:47], v[116:119]
  ds_read_b64_tr_b16 v[172:173], v9 offset:16384
  v_mfma_f32_16x16x32_bf16 v[116:119], v[200:203], v[36:39], v[116:119]
  ds_read_b64_tr_b16 v[174:175], v9 offset:18432
  v_mfma_f32_16x16x32_bf16 v[124:127], v[204:207], v[36:39], v[124:127]
  ds_read_b64_tr_b16 v[184:185], v8 offset:20480
  v_mfma_f32_16x16x32_bf16 v[124:127], v[220:223], v[44:47], v[124:127]
  ds_read_b64_tr_b16 v[186:187], v8 offset:22528
  v_readlane_b32 s50, v30, 6
  v_mfma_f32_16x16x32_bf16 v[120:123], v[220:223], v[40:43], v[120:123]
  ds_read_b64_tr_b16 v[188:189], v9 offset:20480
  v_mfma_f32_16x16x32_bf16 v[120:123], v[204:207], v[32:35], v[120:123]
  ds_read_b64_tr_b16 v[190:191], v9 offset:22528
  s_waitcnt lgkmcnt(8)
  v_mfma_f32_16x16x32_bf16 v[128:131], v[160:163], v[48:51], v[128:131]
  buffer_load_dwordx4 v[32:35], off, s[36:39], s50 offset:0 sc1
  v_mfma_f32_16x16x32_bf16 v[128:131], v[176:179], v[56:59], v[128:131]
  ds_read_b64_tr_b16 v[192:193], v6 offset:24576
  ds_read_b64_tr_b16 v[194:195], v6 offset:26624
  v_mfma_f32_16x16x32_bf16 v[132:135], v[176:179], v[60:63], v[132:135]
  ds_read_b64_tr_b16 v[196:197], v7 offset:24576
  v_mfma_f32_16x16x32_bf16 v[132:135], v[160:163], v[52:55], v[132:135]
  buffer_load_dwordx4 v[36:39], off, s[64:67], s50 offset:0 sc1
  v_mfma_f32_16x16x32_bf16 v[140:143], v[164:167], v[52:55], v[140:143]
  ds_read_b64_tr_b16 v[198:199], v7 offset:26624
  ds_read_b64_tr_b16 v[208:209], v6 offset:28672
  v_mfma_f32_16x16x32_bf16 v[140:143], v[180:183], v[60:63], v[140:143]
  ds_read_b64_tr_b16 v[210:211], v6 offset:30720
  ds_read_b64_tr_b16 v[212:213], v7 offset:28672
  v_mfma_f32_16x16x32_bf16 v[136:139], v[180:183], v[56:59], v[136:139]
  buffer_load_dwordx4 v[40:43], off, s[36:39], s50 offset:1024 sc1
  v_mfma_f32_16x16x32_bf16 v[136:139], v[164:167], v[48:51], v[136:139]
  ds_read_b64_tr_b16 v[214:215], v7 offset:30720
  s_waitcnt lgkmcnt(8)
  v_mfma_f32_16x16x32_bf16 v[144:147], v[168:171], v[48:51], v[144:147]
  ds_read_b64_tr_b16 v[200:201], v8 offset:24576
  v_mfma_f32_16x16x32_bf16 v[144:147], v[184:187], v[56:59], v[144:147]
  buffer_load_dwordx4 v[44:47], off, s[64:67], s50 offset:1024 sc1
  v_mfma_f32_16x16x32_bf16 v[148:151], v[184:187], v[60:63], v[148:151]
  ds_read_b64_tr_b16 v[202:203], v8 offset:26624
  ds_read_b64_tr_b16 v[204:205], v9 offset:24576
  v_mfma_f32_16x16x32_bf16 v[148:151], v[168:171], v[52:55], v[148:151]
  ds_read_b64_tr_b16 v[206:207], v9 offset:26624
  v_mfma_f32_16x16x32_bf16 v[156:159], v[172:175], v[52:55], v[156:159]
  ds_read_b64_tr_b16 v[216:217], v8 offset:28672
  v_mfma_f32_16x16x32_bf16 v[156:159], v[188:191], v[60:63], v[156:159]
  ds_read_b64_tr_b16 v[218:219], v8 offset:30720
  v_mfma_f32_16x16x32_bf16 v[152:155], v[188:191], v[56:59], v[152:155]
  ds_read_b64_tr_b16 v[220:221], v9 offset:28672
  v_mfma_f32_16x16x32_bf16 v[152:155], v[172:175], v[48:51], v[152:155]
  ds_read_b64_tr_b16 v[222:223], v9 offset:30720
  s_waitcnt lgkmcnt(8)
  v_mfma_f32_16x16x32_bf16 v[96:99], v[192:195], v[48:51], v[96:99]
  ds_read_b64_tr_b16 v[160:161], v6 offset:32768
  v_mfma_f32_16x16x32_bf16 v[96:99], v[208:211], v[56:59], v[96:99]
  ds_read_b64_tr_b16 v[162:163], v6 offset:34816
  v_mfma_f32_16x16x32_bf16 v[100:103], v[208:211], v[60:63], v[100:103]
  ds_read_b64_tr_b16 v[164:165], v7 offset:32768
  v_mfma_f32_16x16x32_bf16 v[100:103], v[192:195], v[52:55], v[100:103]
  ds_read_b64_tr_b16 v[166:167], v7 offset:34816
  v_mfma_f32_16x16x32_bf16 v[108:111], v[196:199], v[52:55], v[108:111]
  ds_read_b64_tr_b16 v[176:177], v6 offset:36864
  v_mfma_f32_16x16x32_bf16 v[108:111], v[212:215], v[60:63], v[108:111]
  ds_read_b64_tr_b16 v[178:179], v6 offset:38912
  v_mfma_f32_16x16x32_bf16 v[104:107], v[212:215], v[56:59], v[104:107]
  ds_read_b64_tr_b16 v[180:181], v7 offset:36864
  v_mfma_f32_16x16x32_bf16 v[104:107], v[196:199], v[48:51], v[104:107]
  ds_read_b64_tr_b16 v[182:183], v7 offset:38912
  s_waitcnt lgkmcnt(8)
  v_mfma_f32_16x16x32_bf16 v[112:115], v[200:203], v[48:51], v[112:115]
  ds_read_b64_tr_b16 v[168:169], v8 offset:32768
  v_mfma_f32_16x16x32_bf16 v[112:115], v[216:219], v[56:59], v[112:115]
  ds_read_b64_tr_b16 v[170:171], v8 offset:34816
  v_mfma_f32_16x16x32_bf16 v[116:119], v[216:219], v[60:63], v[116:119]
  ds_read_b64_tr_b16 v[172:173], v9 offset:32768
  v_mfma_f32_16x16x32_bf16 v[116:119], v[200:203], v[52:55], v[116:119]
  ds_read_b64_tr_b16 v[174:175], v9 offset:34816
  v_mfma_f32_16x16x32_bf16 v[124:127], v[204:207], v[52:55], v[124:127]
  ds_read_b64_tr_b16 v[184:185], v8 offset:36864
  v_mfma_f32_16x16x32_bf16 v[124:127], v[220:223], v[60:63], v[124:127]
  ds_read_b64_tr_b16 v[186:187], v8 offset:38912
  v_readlane_b32 s51, v30, 7
  v_mfma_f32_16x16x32_bf16 v[120:123], v[220:223], v[56:59], v[120:123]
  ds_read_b64_tr_b16 v[188:189], v9 offset:36864
  v_mfma_f32_16x16x32_bf16 v[120:123], v[204:207], v[48:51], v[120:123]
  ds_read_b64_tr_b16 v[190:191], v9 offset:38912
  s_waitcnt lgkmcnt(8)
  v_mfma_f32_16x16x32_bf16 v[128:131], v[160:163], v[64:67], v[128:131]
  buffer_load_dwordx4 v[48:51], off, s[36:39], s51 offset:0 sc1
  v_mfma_f32_16x16x32_bf16 v[128:131], v[176:179], v[72:75], v[128:131]
  ds_read_b64_tr_b16 v[192:193], v6 offset:40960
  ds_read_b64_tr_b16 v[194:195], v6 offset:43008
  v_mfma_f32_16x16x32_bf16 v[132:135], v[176:179], v[76:79], v[132:135]
  ds_read_b64_tr_b16 v[196:197], v7 offset:40960
  v_mfma_f32_16x16x32_bf16 v[132:135], v[160:163], v[68:71], v[132:135]
  buffer_load_dwordx4 v[52:55], off, s[64:67], s51 offset:0 sc1
  v_mfma_f32_16x16x32_bf16 v[140:143], v[164:167], v[68:71], v[140:143]
  ds_read_b64_tr_b16 v[198:199], v7 offset:43008
  ds_read_b64_tr_b16 v[208:209], v6 offset:45056
  v_mfma_f32_16x16x32_bf16 v[140:143], v[180:183], v[76:79], v[140:143]
  ds_read_b64_tr_b16 v[210:211], v6 offset:47104
  ds_read_b64_tr_b16 v[212:213], v7 offset:45056
  v_mfma_f32_16x16x32_bf16 v[136:139], v[180:183], v[72:75], v[136:139]
  buffer_load_dwordx4 v[56:59], off, s[36:39], s51 offset:1024 sc1
  v_mfma_f32_16x16x32_bf16 v[136:139], v[164:167], v[64:67], v[136:139]
  ds_read_b64_tr_b16 v[214:215], v7 offset:47104
  s_waitcnt lgkmcnt(8)
  v_mfma_f32_16x16x32_bf16 v[144:147], v[168:171], v[64:67], v[144:147]
  ds_read_b64_tr_b16 v[200:201], v8 offset:40960
  v_mfma_f32_16x16x32_bf16 v[144:147], v[184:187], v[72:75], v[144:147]
  buffer_load_dwordx4 v[60:63], off, s[64:67], s51 offset:1024 sc1
  v_mfma_f32_16x16x32_bf16 v[148:151], v[184:187], v[76:79], v[148:151]
  ds_read_b64_tr_b16 v[202:203], v8 offset:43008
  ds_read_b64_tr_b16 v[204:205], v9 offset:40960
  v_mfma_f32_16x16x32_bf16 v[148:151], v[168:171], v[68:71], v[148:151]
  ds_read_b64_tr_b16 v[206:207], v9 offset:43008
  v_mfma_f32_16x16x32_bf16 v[156:159], v[172:175], v[68:71], v[156:159]
  ds_read_b64_tr_b16 v[216:217], v8 offset:45056
  v_mfma_f32_16x16x32_bf16 v[156:159], v[188:191], v[76:79], v[156:159]
  ds_read_b64_tr_b16 v[218:219], v8 offset:47104
  v_mfma_f32_16x16x32_bf16 v[152:155], v[188:191], v[72:75], v[152:155]
  ds_read_b64_tr_b16 v[220:221], v9 offset:45056
  v_mfma_f32_16x16x32_bf16 v[152:155], v[172:175], v[64:67], v[152:155]
  ds_read_b64_tr_b16 v[222:223], v9 offset:47104
  s_waitcnt lgkmcnt(8)
  v_mfma_f32_16x16x32_bf16 v[96:99], v[192:195], v[64:67], v[96:99]
  ds_read_b64_tr_b16 v[160:161], v6 offset:49152
  v_mfma_f32_16x16x32_bf16 v[96:99], v[208:211], v[72:75], v[96:99]
  ds_read_b64_tr_b16 v[162:163], v6 offset:51200
  v_mfma_f32_16x16x32_bf16 v[100:103], v[208:211], v[76:79], v[100:103]
  ds_read_b64_tr_b16 v[164:165], v7 offset:49152
  v_mfma_f32_16x16x32_bf16 v[100:103], v[192:195], v[68:71], v[100:103]
  ds_read_b64_tr_b16 v[166:167], v7 offset:51200
  v_mfma_f32_16x16x32_bf16 v[108:111], v[196:199], v[68:71], v[108:111]
  ds_read_b64_tr_b16 v[176:177], v6 offset:53248
  v_mfma_f32_16x16x32_bf16 v[108:111], v[212:215], v[76:79], v[108:111]
  ds_read_b64_tr_b16 v[178:179], v6 offset:55296
  v_mfma_f32_16x16x32_bf16 v[104:107], v[212:215], v[72:75], v[104:107]
  ds_read_b64_tr_b16 v[180:181], v7 offset:53248
  v_mfma_f32_16x16x32_bf16 v[104:107], v[196:199], v[64:67], v[104:107]
  ds_read_b64_tr_b16 v[182:183], v7 offset:55296
  s_waitcnt lgkmcnt(8)
  v_mfma_f32_16x16x32_bf16 v[112:115], v[200:203], v[64:67], v[112:115]
  ds_read_b64_tr_b16 v[168:169], v8 offset:49152
  v_mfma_f32_16x16x32_bf16 v[112:115], v[216:219], v[72:75], v[112:115]
  ds_read_b64_tr_b16 v[170:171], v8 offset:51200
  v_mfma_f32_16x16x32_bf16 v[116:119], v[216:219], v[76:79], v[116:119]
  ds_read_b64_tr_b16 v[172:173], v9 offset:49152
  v_mfma_f32_16x16x32_bf16 v[116:119], v[200:203], v[68:71], v[116:119]
  ds_read_b64_tr_b16 v[174:175], v9 offset:51200
  v_mfma_f32_16x16x32_bf16 v[124:127], v[204:207], v[68:71], v[124:127]
  ds_read_b64_tr_b16 v[184:185], v8 offset:53248
  v_mfma_f32_16x16x32_bf16 v[124:127], v[220:223], v[76:79], v[124:127]
  ds_read_b64_tr_b16 v[186:187], v8 offset:55296
  v_readlane_b32 s48, v30, 8
  v_mfma_f32_16x16x32_bf16 v[120:123], v[220:223], v[72:75], v[120:123]
  ds_read_b64_tr_b16 v[188:189], v9 offset:53248
  v_mfma_f32_16x16x32_bf16 v[120:123], v[204:207], v[64:67], v[120:123]
  ds_read_b64_tr_b16 v[190:191], v9 offset:55296
  s_waitcnt vmcnt(16) lgkmcnt(8)
  v_mfma_f32_16x16x32_bf16 v[128:131], v[160:163], v[80:83], v[128:131]
  buffer_load_dwordx4 v[64:67], off, s[36:39], s48 offset:0 sc1
  v_mfma_f32_16x16x32_bf16 v[128:131], v[176:179], v[88:91], v[128:131]
  ds_read_b64_tr_b16 v[192:193], v6 offset:57344
  ds_read_b64_tr_b16 v[194:195], v6 offset:59392
  v_mfma_f32_16x16x32_bf16 v[132:135], v[176:179], v[92:95], v[132:135]
  ds_read_b64_tr_b16 v[196:197], v7 offset:57344
  v_mfma_f32_16x16x32_bf16 v[132:135], v[160:163], v[84:87], v[132:135]
  ds_read_b64_tr_b16 v[198:199], v7 offset:59392
  v_mfma_f32_16x16x32_bf16 v[140:143], v[164:167], v[84:87], v[140:143]
  ds_read_b64_tr_b16 v[208:209], v6 offset:61440
  v_mfma_f32_16x16x32_bf16 v[140:143], v[180:183], v[92:95], v[140:143]
  ds_read_b64_tr_b16 v[210:211], v6 offset:63488
  ds_read_b64_tr_b16 v[212:213], v7 offset:61440
  v_mfma_f32_16x16x32_bf16 v[136:139], v[180:183], v[88:91], v[136:139]
  buffer_load_dwordx4 v[68:71], off, s[64:67], s48 offset:0 sc1
  v_mfma_f32_16x16x32_bf16 v[136:139], v[164:167], v[80:83], v[136:139]
  ds_read_b64_tr_b16 v[214:215], v7 offset:63488
  s_waitcnt lgkmcnt(8)
  v_mfma_f32_16x16x32_bf16 v[144:147], v[168:171], v[80:83], v[144:147]
  ds_read_b64_tr_b16 v[200:201], v8 offset:57344
  v_mfma_f32_16x16x32_bf16 v[144:147], v[184:187], v[88:91], v[144:147]
  ds_read_b64_tr_b16 v[202:203], v8 offset:59392
  v_mfma_f32_16x16x32_bf16 v[148:151], v[184:187], v[92:95], v[148:151]
  ds_read_b64_tr_b16 v[204:205], v9 offset:57344
  v_mfma_f32_16x16x32_bf16 v[148:151], v[168:171], v[84:87], v[148:151]
  ds_read_b64_tr_b16 v[206:207], v9 offset:59392
  v_mfma_f32_16x16x32_bf16 v[156:159], v[172:175], v[84:87], v[156:159]
  buffer_load_dwordx4 v[72:75], off, s[36:39], s48 offset:1024 sc1
  v_mfma_f32_16x16x32_bf16 v[156:159], v[188:191], v[92:95], v[156:159]
  ds_read_b64_tr_b16 v[216:217], v8 offset:61440
  ds_read_b64_tr_b16 v[218:219], v8 offset:63488
  v_mfma_f32_16x16x32_bf16 v[152:155], v[188:191], v[88:91], v[152:155]
  ds_read_b64_tr_b16 v[220:221], v9 offset:61440
  v_mfma_f32_16x16x32_bf16 v[152:155], v[172:175], v[80:83], v[152:155]
  ds_read_b64_tr_b16 v[222:223], v9 offset:63488
  s_waitcnt lgkmcnt(8)
  v_mfma_f32_16x16x32_bf16 v[96:99], v[192:195], v[80:83], v[96:99]
  ds_read_b64_tr_b16 v[160:161], v20 offset:0
  v_mfma_f32_16x16x32_bf16 v[96:99], v[208:211], v[88:91], v[96:99]
  ds_read_b64_tr_b16 v[162:163], v20 offset:2048
  v_mfma_f32_16x16x32_bf16 v[100:103], v[208:211], v[92:95], v[100:103]
  buffer_load_dwordx4 v[76:79], off, s[64:67], s48 offset:1024 sc1
  v_mfma_f32_16x16x32_bf16 v[100:103], v[192:195], v[84:87], v[100:103]
  ds_read_b64_tr_b16 v[164:165], v21 offset:0
  ds_read_b64_tr_b16 v[166:167], v21 offset:2048
  v_mfma_f32_16x16x32_bf16 v[108:111], v[196:199], v[84:87], v[108:111]
  ds_read_b64_tr_b16 v[176:177], v20 offset:4096
  v_mfma_f32_16x16x32_bf16 v[108:111], v[212:215], v[92:95], v[108:111]
  ds_read_b64_tr_b16 v[178:179], v20 offset:6144
  v_mfma_f32_16x16x32_bf16 v[104:107], v[212:215], v[88:91], v[104:107]
  ds_read_b64_tr_b16 v[180:181], v21 offset:4096
  v_mfma_f32_16x16x32_bf16 v[104:107], v[196:199], v[80:83], v[104:107]
  ds_read_b64_tr_b16 v[182:183], v21 offset:6144
  s_waitcnt lgkmcnt(8)
  s_barrier
  v_mfma_f32_16x16x32_bf16 v[112:115], v[200:203], v[80:83], v[112:115]
  ds_read_b64_tr_b16 v[168:169], v22 offset:0
  v_mfma_f32_16x16x32_bf16 v[112:115], v[216:219], v[88:91], v[112:115]
  ds_read_b64_tr_b16 v[170:171], v22 offset:2048
  v_mfma_f32_16x16x32_bf16 v[116:119], v[216:219], v[92:95], v[116:119]
  ds_read_b64_tr_b16 v[172:173], v23 offset:0
  v_mfma_f32_16x16x32_bf16 v[116:119], v[200:203], v[84:87], v[116:119]
  ds_read_b64_tr_b16 v[174:175], v23 offset:2048
  v_mfma_f32_16x16x32_bf16 v[124:127], v[204:207], v[84:87], v[124:127]
  ds_read_b64_tr_b16 v[184:185], v22 offset:4096
  v_mfma_f32_16x16x32_bf16 v[124:127], v[220:223], v[92:95], v[124:127]
  ds_read_b64_tr_b16 v[186:187], v22 offset:6144
  v_readlane_b32 s49, v30, 9
  v_mfma_f32_16x16x32_bf16 v[120:123], v[220:223], v[88:91], v[120:123]
  ds_read_b64_tr_b16 v[188:189], v23 offset:4096
  v_mfma_f32_16x16x32_bf16 v[120:123], v[204:207], v[80:83], v[120:123]
  ds_read_b64_tr_b16 v[190:191], v23 offset:6144
  s_waitcnt vmcnt(16) lgkmcnt(8)
  v_mfma_f32_16x16x32_bf16 v[128:131], v[160:163], v[224:227], v[128:131]
  buffer_load_dwordx4 v[80:83], off, s[36:39], s49 offset:0 sc1
  v_mfma_f32_16x16x32_bf16 v[128:131], v[176:179], v[232:235], v[128:131]
  ds_read_b64_tr_b16 v[192:193], v20 offset:8192
  ds_read_b64_tr_b16 v[194:195], v20 offset:10240
  v_mfma_f32_16x16x32_bf16 v[132:135], v[176:179], v[236:239], v[132:135]
  ds_read_b64_tr_b16 v[196:197], v21 offset:8192
  v_mfma_f32_16x16x32_bf16 v[132:135], v[160:163], v[228:231], v[132:135]
  ds_read_b64_tr_b16 v[198:199], v21 offset:10240
  v_mfma_f32_16x16x32_bf16 v[140:143], v[164:167], v[228:231], v[140:143]
  ds_read_b64_tr_b16 v[208:209], v20 offset:12288
  v_mfma_f32_16x16x32_bf16 v[140:143], v[180:183], v[236:239], v[140:143]
  ds_read_b64_tr_b16 v[210:211], v20 offset:14336
  ds_read_b64_tr_b16 v[212:213], v21 offset:12288
  v_mfma_f32_16x16x32_bf16 v[136:139], v[180:183], v[232:235], v[136:139]
  buffer_load_dwordx4 v[84:87], off, s[64:67], s49 offset:0 sc1
  v_mfma_f32_16x16x32_bf16 v[136:139], v[164:167], v[224:227], v[136:139]
  ds_read_b64_tr_b16 v[214:215], v21 offset:14336
  s_waitcnt lgkmcnt(8)
  v_mfma_f32_16x16x32_bf16 v[144:147], v[168:171], v[224:227], v[144:147]
  ds_read_b64_tr_b16 v[200:201], v22 offset:8192
  v_mfma_f32_16x16x32_bf16 v[144:147], v[184:187], v[232:235], v[144:147]
  ds_read_b64_tr_b16 v[202:203], v22 offset:10240
  v_mfma_f32_16x16x32_bf16 v[148:151], v[184:187], v[236:239], v[148:151]
  ds_read_b64_tr_b16 v[204:205], v23 offset:8192
  v_mfma_f32_16x16x32_bf16 v[148:151], v[168:171], v[228:231], v[148:151]
  ds_read_b64_tr_b16 v[206:207], v23 offset:10240
  v_mfma_f32_16x16x32_bf16 v[156:159], v[172:175], v[228:231], v[156:159]
  buffer_load_dwordx4 v[88:91], off, s[36:39], s49 offset:1024 sc1
  v_mfma_f32_16x16x32_bf16 v[156:159], v[188:191], v[236:239], v[156:159]
  ds_read_b64_tr_b16 v[216:217], v22 offset:12288
  ds_read_b64_tr_b16 v[218:219], v22 offset:14336
  v_mfma_f32_16x16x32_bf16 v[152:155], v[188:191], v[232:235], v[152:155]
  ds_read_b64_tr_b16 v[220:221], v23 offset:12288
  v_mfma_f32_16x16x32_bf16 v[152:155], v[172:175], v[224:227], v[152:155]
  ds_read_b64_tr_b16 v[222:223], v23 offset:14336
  s_waitcnt lgkmcnt(8)
  v_mfma_f32_16x16x32_bf16 v[96:99], v[192:195], v[224:227], v[96:99]
  ds_read_b64_tr_b16 v[160:161], v20 offset:16384
  v_mfma_f32_16x16x32_bf16 v[96:99], v[208:211], v[232:235], v[96:99]
  ds_read_b64_tr_b16 v[162:163], v20 offset:18432
  v_mfma_f32_16x16x32_bf16 v[100:103], v[208:211], v[236:239], v[100:103]
  buffer_load_dwordx4 v[92:95], off, s[64:67], s49 offset:1024 sc1
  v_mfma_f32_16x16x32_bf16 v[100:103], v[192:195], v[228:231], v[100:103]
  ds_read_b64_tr_b16 v[164:165], v21 offset:16384
  ds_read_b64_tr_b16 v[166:167], v21 offset:18432
  v_mfma_f32_16x16x32_bf16 v[108:111], v[196:199], v[228:231], v[108:111]
  ds_read_b64_tr_b16 v[176:177], v20 offset:20480
  v_mfma_f32_16x16x32_bf16 v[108:111], v[212:215], v[236:239], v[108:111]
  ds_read_b64_tr_b16 v[178:179], v20 offset:22528
  v_mfma_f32_16x16x32_bf16 v[104:107], v[212:215], v[232:235], v[104:107]
  ds_read_b64_tr_b16 v[180:181], v21 offset:20480
  v_mfma_f32_16x16x32_bf16 v[104:107], v[196:199], v[224:227], v[104:107]
  ds_read_b64_tr_b16 v[182:183], v21 offset:22528
  s_waitcnt lgkmcnt(8)
  v_mfma_f32_16x16x32_bf16 v[112:115], v[200:203], v[224:227], v[112:115]
  ds_read_b64_tr_b16 v[168:169], v22 offset:16384
  v_mfma_f32_16x16x32_bf16 v[112:115], v[216:219], v[232:235], v[112:115]
  ds_read_b64_tr_b16 v[170:171], v22 offset:18432
  v_mfma_f32_16x16x32_bf16 v[116:119], v[216:219], v[236:239], v[116:119]
  ds_read_b64_tr_b16 v[172:173], v23 offset:16384
  v_mfma_f32_16x16x32_bf16 v[116:119], v[200:203], v[228:231], v[116:119]
  ds_read_b64_tr_b16 v[174:175], v23 offset:18432
  v_mfma_f32_16x16x32_bf16 v[124:127], v[204:207], v[228:231], v[124:127]
  ds_read_b64_tr_b16 v[184:185], v22 offset:20480
  v_mfma_f32_16x16x32_bf16 v[124:127], v[220:223], v[236:239], v[124:127]
  ds_read_b64_tr_b16 v[186:187], v22 offset:22528
  v_readlane_b32 s50, v30, 10
  v_mfma_f32_16x16x32_bf16 v[120:123], v[220:223], v[232:235], v[120:123]
  ds_read_b64_tr_b16 v[188:189], v23 offset:20480
  v_mfma_f32_16x16x32_bf16 v[120:123], v[204:207], v[224:227], v[120:123]
  ds_read_b64_tr_b16 v[190:191], v23 offset:22528
  s_waitcnt vmcnt(16) lgkmcnt(8)
  v_mfma_f32_16x16x32_bf16 v[128:131], v[160:163], v[240:243], v[128:131]
  buffer_load_dwordx4 v[224:227], off, s[36:39], s50 offset:0 sc1
  v_mfma_f32_16x16x32_bf16 v[128:131], v[176:179], v[248:251], v[128:131]
  ds_read_b64_tr_b16 v[192:193], v20 offset:24576
  ds_read_b64_tr_b16 v[194:195], v20 offset:26624
  v_mfma_f32_16x16x32_bf16 v[132:135], v[176:179], v[252:255], v[132:135]
  ds_read_b64_tr_b16 v[196:197], v21 offset:24576
  v_mfma_f32_16x16x32_bf16 v[132:135], v[160:163], v[244:247], v[132:135]
  ds_read_b64_tr_b16 v[198:199], v21 offset:26624
  v_mfma_f32_16x16x32_bf16 v[140:143], v[164:167], v[244:247], v[140:143]
  ds_read_b64_tr_b16 v[208:209], v20 offset:28672
  v_mfma_f32_16x16x32_bf16 v[140:143], v[180:183], v[252:255], v[140:143]
  ds_read_b64_tr_b16 v[210:211], v20 offset:30720
  ds_read_b64_tr_b16 v[212:213], v21 offset:28672
  v_mfma_f32_16x16x32_bf16 v[136:139], v[180:183], v[248:251], v[136:139]
  buffer_load_dwordx4 v[228:231], off, s[64:67], s50 offset:0 sc1
  v_mfma_f32_16x16x32_bf16 v[136:139], v[164:167], v[240:243], v[136:139]
  ds_read_b64_tr_b16 v[214:215], v21 offset:30720
  s_waitcnt lgkmcnt(8)
  v_mfma_f32_16x16x32_bf16 v[144:147], v[168:171], v[240:243], v[144:147]
  ds_read_b64_tr_b16 v[200:201], v22 offset:24576
  v_mfma_f32_16x16x32_bf16 v[144:147], v[184:187], v[248:251], v[144:147]
  ds_read_b64_tr_b16 v[202:203], v22 offset:26624
  v_mfma_f32_16x16x32_bf16 v[148:151], v[184:187], v[252:255], v[148:151]
  ds_read_b64_tr_b16 v[204:205], v23 offset:24576
  v_mfma_f32_16x16x32_bf16 v[148:151], v[168:171], v[244:247], v[148:151]
  ds_read_b64_tr_b16 v[206:207], v23 offset:26624
  v_mfma_f32_16x16x32_bf16 v[156:159], v[172:175], v[244:247], v[156:159]
  buffer_load_dwordx4 v[232:235], off, s[36:39], s50 offset:1024 sc1
  v_mfma_f32_16x16x32_bf16 v[156:159], v[188:191], v[252:255], v[156:159]
  ds_read_b64_tr_b16 v[216:217], v22 offset:28672
  ds_read_b64_tr_b16 v[218:219], v22 offset:30720
  v_mfma_f32_16x16x32_bf16 v[152:155], v[188:191], v[248:251], v[152:155]
  ds_read_b64_tr_b16 v[220:221], v23 offset:28672
  v_mfma_f32_16x16x32_bf16 v[152:155], v[172:175], v[240:243], v[152:155]
  ds_read_b64_tr_b16 v[222:223], v23 offset:30720
  s_waitcnt lgkmcnt(8)
  v_mfma_f32_16x16x32_bf16 v[96:99], v[192:195], v[240:243], v[96:99]
  ds_read_b64_tr_b16 v[160:161], v20 offset:32768
  v_mfma_f32_16x16x32_bf16 v[96:99], v[208:211], v[248:251], v[96:99]
  ds_read_b64_tr_b16 v[162:163], v20 offset:34816
  v_mfma_f32_16x16x32_bf16 v[100:103], v[208:211], v[252:255], v[100:103]
  buffer_load_dwordx4 v[236:239], off, s[64:67], s50 offset:1024 sc1
  v_mfma_f32_16x16x32_bf16 v[100:103], v[192:195], v[244:247], v[100:103]
  ds_read_b64_tr_b16 v[164:165], v21 offset:32768
  ds_read_b64_tr_b16 v[166:167], v21 offset:34816
  v_mfma_f32_16x16x32_bf16 v[108:111], v[196:199], v[244:247], v[108:111]
  ds_read_b64_tr_b16 v[176:177], v20 offset:36864
  v_mfma_f32_16x16x32_bf16 v[108:111], v[212:215], v[252:255], v[108:111]
  ds_read_b64_tr_b16 v[178:179], v20 offset:38912
  v_mfma_f32_16x16x32_bf16 v[104:107], v[212:215], v[248:251], v[104:107]
  ds_read_b64_tr_b16 v[180:181], v21 offset:36864
  v_mfma_f32_16x16x32_bf16 v[104:107], v[196:199], v[240:243], v[104:107]
  ds_read_b64_tr_b16 v[182:183], v21 offset:38912
  s_waitcnt lgkmcnt(8)
  s_barrier
  v_mfma_f32_16x16x32_bf16 v[112:115], v[200:203], v[240:243], v[112:115]
  ds_read_b64_tr_b16 v[168:169], v22 offset:32768
  v_mfma_f32_16x16x32_bf16 v[112:115], v[216:219], v[248:251], v[112:115]
  ds_read_b64_tr_b16 v[170:171], v22 offset:34816
  v_mfma_f32_16x16x32_bf16 v[116:119], v[216:219], v[252:255], v[116:119]
  ds_read_b64_tr_b16 v[172:173], v23 offset:32768
  v_mfma_f32_16x16x32_bf16 v[116:119], v[200:203], v[244:247], v[116:119]
  ds_read_b64_tr_b16 v[174:175], v23 offset:34816
  v_mfma_f32_16x16x32_bf16 v[124:127], v[204:207], v[244:247], v[124:127]
  ds_read_b64_tr_b16 v[184:185], v22 offset:36864
  v_mfma_f32_16x16x32_bf16 v[124:127], v[220:223], v[252:255], v[124:127]
  ds_read_b64_tr_b16 v[186:187], v22 offset:38912
  v_readlane_b32 s51, v30, 11
  v_mfma_f32_16x16x32_bf16 v[120:123], v[220:223], v[248:251], v[120:123]
  ds_read_b64_tr_b16 v[188:189], v23 offset:36864
  v_mfma_f32_16x16x32_bf16 v[120:123], v[204:207], v[240:243], v[120:123]
  ds_read_b64_tr_b16 v[190:191], v23 offset:38912
  s_waitcnt vmcnt(16) lgkmcnt(8)
  v_mfma_f32_16x16x32_bf16 v[128:131], v[160:163], v[32:35], v[128:131]
  buffer_load_dwordx4 v[240:243], off, s[36:39], s51 offset:0 sc1
  v_mfma_f32_16x16x32_bf16 v[128:131], v[176:179], v[40:43], v[128:131]
  ds_read_b64_tr_b16 v[192:193], v20 offset:40960
  ds_read_b64_tr_b16 v[194:195], v20 offset:43008
  v_mfma_f32_16x16x32_bf16 v[132:135], v[176:179], v[44:47], v[132:135]
  ds_read_b64_tr_b16 v[196:197], v21 offset:40960
  v_mfma_f32_16x16x32_bf16 v[132:135], v[160:163], v[36:39], v[132:135]
  ds_read_b64_tr_b16 v[198:199], v21 offset:43008
  v_mfma_f32_16x16x32_bf16 v[140:143], v[164:167], v[36:39], v[140:143]
  ds_read_b64_tr_b16 v[208:209], v20 offset:45056
  v_mfma_f32_16x16x32_bf16 v[140:143], v[180:183], v[44:47], v[140:143]
  ds_read_b64_tr_b16 v[210:211], v20 offset:47104
  ds_read_b64_tr_b16 v[212:213], v21 offset:45056
  v_mfma_f32_16x16x32_bf16 v[136:139], v[180:183], v[40:43], v[136:139]
  buffer_load_dwordx4 v[244:247], off, s[64:67], s51 offset:0 sc1
  v_mfma_f32_16x16x32_bf16 v[136:139], v[164:167], v[32:35], v[136:139]
  ds_read_b64_tr_b16 v[214:215], v21 offset:47104
  s_waitcnt lgkmcnt(8)
  v_mfma_f32_16x16x32_bf16 v[144:147], v[168:171], v[32:35], v[144:147]
  ds_read_b64_tr_b16 v[200:201], v22 offset:40960
  v_mfma_f32_16x16x32_bf16 v[144:147], v[184:187], v[40:43], v[144:147]
  ds_read_b64_tr_b16 v[202:203], v22 offset:43008
  v_mfma_f32_16x16x32_bf16 v[148:151], v[184:187], v[44:47], v[148:151]
  ds_read_b64_tr_b16 v[204:205], v23 offset:40960
  v_mfma_f32_16x16x32_bf16 v[148:151], v[168:171], v[36:39], v[148:151]
  ds_read_b64_tr_b16 v[206:207], v23 offset:43008
  v_mfma_f32_16x16x32_bf16 v[156:159], v[172:175], v[36:39], v[156:159]
  buffer_load_dwordx4 v[248:251], off, s[36:39], s51 offset:1024 sc1
  v_mfma_f32_16x16x32_bf16 v[156:159], v[188:191], v[44:47], v[156:159]
  ds_read_b64_tr_b16 v[216:217], v22 offset:45056
  ds_read_b64_tr_b16 v[218:219], v22 offset:47104
  v_mfma_f32_16x16x32_bf16 v[152:155], v[188:191], v[40:43], v[152:155]
  ds_read_b64_tr_b16 v[220:221], v23 offset:45056
  v_mfma_f32_16x16x32_bf16 v[152:155], v[172:175], v[32:35], v[152:155]
  ds_read_b64_tr_b16 v[222:223], v23 offset:47104
  s_waitcnt lgkmcnt(8)
  v_mfma_f32_16x16x32_bf16 v[96:99], v[192:195], v[32:35], v[96:99]
  ds_read_b64_tr_b16 v[160:161], v20 offset:49152
  v_mfma_f32_16x16x32_bf16 v[96:99], v[208:211], v[40:43], v[96:99]
  ds_read_b64_tr_b16 v[162:163], v20 offset:51200
  v_mfma_f32_16x16x32_bf16 v[100:103], v[208:211], v[44:47], v[100:103]
  buffer_load_dwordx4 v[252:255], off, s[64:67], s51 offset:1024 sc1
  v_mfma_f32_16x16x32_bf16 v[100:103], v[192:195], v[36:39], v[100:103]
  ds_read_b64_tr_b16 v[164:165], v21 offset:49152
  ds_read_b64_tr_b16 v[166:167], v21 offset:51200
  v_mfma_f32_16x16x32_bf16 v[108:111], v[196:199], v[36:39], v[108:111]
  ds_read_b64_tr_b16 v[176:177], v20 offset:53248
  v_mfma_f32_16x16x32_bf16 v[108:111], v[212:215], v[44:47], v[108:111]
  ds_read_b64_tr_b16 v[178:179], v20 offset:55296
  v_mfma_f32_16x16x32_bf16 v[104:107], v[212:215], v[40:43], v[104:107]
  ds_read_b64_tr_b16 v[180:181], v21 offset:53248
  v_mfma_f32_16x16x32_bf16 v[104:107], v[196:199], v[32:35], v[104:107]
  ds_read_b64_tr_b16 v[182:183], v21 offset:55296
  s_waitcnt lgkmcnt(8)
  v_mfma_f32_16x16x32_bf16 v[112:115], v[200:203], v[32:35], v[112:115]
  ds_read_b64_tr_b16 v[168:169], v22 offset:49152
  v_mfma_f32_16x16x32_bf16 v[112:115], v[216:219], v[40:43], v[112:115]
  ds_read_b64_tr_b16 v[170:171], v22 offset:51200
  v_mfma_f32_16x16x32_bf16 v[116:119], v[216:219], v[44:47], v[116:119]
  ds_read_b64_tr_b16 v[172:173], v23 offset:49152
  v_mfma_f32_16x16x32_bf16 v[116:119], v[200:203], v[36:39], v[116:119]
  ds_read_b64_tr_b16 v[174:175], v23 offset:51200
  v_mfma_f32_16x16x32_bf16 v[124:127], v[204:207], v[36:39], v[124:127]
  ds_read_b64_tr_b16 v[184:185], v22 offset:53248
  v_mfma_f32_16x16x32_bf16 v[124:127], v[220:223], v[44:47], v[124:127]
  ds_read_b64_tr_b16 v[186:187], v22 offset:55296
  v_readlane_b32 s48, v30, 12
  v_mfma_f32_16x16x32_bf16 v[120:123], v[220:223], v[40:43], v[120:123]
  ds_read_b64_tr_b16 v[188:189], v23 offset:53248
  v_mfma_f32_16x16x32_bf16 v[120:123], v[204:207], v[32:35], v[120:123]
  ds_read_b64_tr_b16 v[190:191], v23 offset:55296
  s_waitcnt vmcnt(16) lgkmcnt(8)
  v_mfma_f32_16x16x32_bf16 v[128:131], v[160:163], v[48:51], v[128:131]
  buffer_load_dwordx4 v[32:35], off, s[36:39], s48 offset:0 sc1
  v_mfma_f32_16x16x32_bf16 v[128:131], v[176:179], v[56:59], v[128:131]
  ds_read_b64_tr_b16 v[192:193], v20 offset:57344
  ds_read_b64_tr_b16 v[194:195], v20 offset:59392
  v_mfma_f32_16x16x32_bf16 v[132:135], v[176:179], v[60:63], v[132:135]
  ds_read_b64_tr_b16 v[196:197], v21 offset:57344
  v_mfma_f32_16x16x32_bf16 v[132:135], v[160:163], v[52:55], v[132:135]
  ds_read_b64_tr_b16 v[198:199], v21 offset:59392
  v_mfma_f32_16x16x32_bf16 v[140:143], v[164:167], v[52:55], v[140:143]
  ds_read_b64_tr_b16 v[208:209], v20 offset:61440
  v_mfma_f32_16x16x32_bf16 v[140:143], v[180:183], v[60:63], v[140:143]
  ds_read_b64_tr_b16 v[210:211], v20 offset:63488
  ds_read_b64_tr_b16 v[212:213], v21 offset:61440
  v_mfma_f32_16x16x32_bf16 v[136:139], v[180:183], v[56:59], v[136:139]
  buffer_load_dwordx4 v[36:39], off, s[64:67], s48 offset:0 sc1
  v_mfma_f32_16x16x32_bf16 v[136:139], v[164:167], v[48:51], v[136:139]
  ds_read_b64_tr_b16 v[214:215], v21 offset:63488
  s_waitcnt lgkmcnt(8)
  v_mfma_f32_16x16x32_bf16 v[144:147], v[168:171], v[48:51], v[144:147]
  ds_read_b64_tr_b16 v[200:201], v22 offset:57344
  v_mfma_f32_16x16x32_bf16 v[144:147], v[184:187], v[56:59], v[144:147]
  ds_read_b64_tr_b16 v[202:203], v22 offset:59392
  v_mfma_f32_16x16x32_bf16 v[148:151], v[184:187], v[60:63], v[148:151]
  ds_read_b64_tr_b16 v[204:205], v23 offset:57344
  v_mfma_f32_16x16x32_bf16 v[148:151], v[168:171], v[52:55], v[148:151]
  ds_read_b64_tr_b16 v[206:207], v23 offset:59392
  v_mfma_f32_16x16x32_bf16 v[156:159], v[172:175], v[52:55], v[156:159]
  buffer_load_dwordx4 v[40:43], off, s[36:39], s48 offset:1024 sc1
  v_mfma_f32_16x16x32_bf16 v[156:159], v[188:191], v[60:63], v[156:159]
  ds_read_b64_tr_b16 v[216:217], v22 offset:61440
  ds_read_b64_tr_b16 v[218:219], v22 offset:63488
  v_mfma_f32_16x16x32_bf16 v[152:155], v[188:191], v[56:59], v[152:155]
  ds_read_b64_tr_b16 v[220:221], v23 offset:61440
  v_mfma_f32_16x16x32_bf16 v[152:155], v[172:175], v[48:51], v[152:155]
  ds_read_b64_tr_b16 v[222:223], v23 offset:63488
  s_waitcnt lgkmcnt(8)
  v_mfma_f32_16x16x32_bf16 v[96:99], v[192:195], v[48:51], v[96:99]
  ds_read_b64_tr_b16 v[160:161], v26 offset:0
  v_mfma_f32_16x16x32_bf16 v[96:99], v[208:211], v[56:59], v[96:99]
  ds_read_b64_tr_b16 v[162:163], v26 offset:2048
  v_mfma_f32_16x16x32_bf16 v[100:103], v[208:211], v[60:63], v[100:103]
  buffer_load_dwordx4 v[44:47], off, s[64:67], s48 offset:1024 sc1
  v_mfma_f32_16x16x32_bf16 v[100:103], v[192:195], v[52:55], v[100:103]
  ds_read_b64_tr_b16 v[164:165], v27 offset:0
  ds_read_b64_tr_b16 v[166:167], v27 offset:2048
  v_mfma_f32_16x16x32_bf16 v[108:111], v[196:199], v[52:55], v[108:111]
  ds_read_b64_tr_b16 v[176:177], v26 offset:4096
  v_mfma_f32_16x16x32_bf16 v[108:111], v[212:215], v[60:63], v[108:111]
  ds_read_b64_tr_b16 v[178:179], v26 offset:6144
  v_mfma_f32_16x16x32_bf16 v[104:107], v[212:215], v[56:59], v[104:107]
  ds_read_b64_tr_b16 v[180:181], v27 offset:4096
  v_mfma_f32_16x16x32_bf16 v[104:107], v[196:199], v[48:51], v[104:107]
  ds_read_b64_tr_b16 v[182:183], v27 offset:6144
  s_waitcnt lgkmcnt(8)
  s_barrier
  v_mfma_f32_16x16x32_bf16 v[112:115], v[200:203], v[48:51], v[112:115]
  ds_read_b64_tr_b16 v[168:169], v28 offset:0
  v_mfma_f32_16x16x32_bf16 v[112:115], v[216:219], v[56:59], v[112:115]
  ds_read_b64_tr_b16 v[170:171], v28 offset:2048
  v_mfma_f32_16x16x32_bf16 v[116:119], v[216:219], v[60:63], v[116:119]
  ds_read_b64_tr_b16 v[172:173], v29 offset:0
  v_mfma_f32_16x16x32_bf16 v[116:119], v[200:203], v[52:55], v[116:119]
  ds_read_b64_tr_b16 v[174:175], v29 offset:2048
  v_mfma_f32_16x16x32_bf16 v[124:127], v[204:207], v[52:55], v[124:127]
  ds_read_b64_tr_b16 v[184:185], v28 offset:4096
  v_mfma_f32_16x16x32_bf16 v[124:127], v[220:223], v[60:63], v[124:127]
  ds_read_b64_tr_b16 v[186:187], v28 offset:6144
  v_readlane_b32 s49, v30, 13
  v_mfma_f32_16x16x32_bf16 v[120:123], v[220:223], v[56:59], v[120:123]
  ds_read_b64_tr_b16 v[188:189], v29 offset:4096
  v_mfma_f32_16x16x32_bf16 v[120:123], v[204:207], v[48:51], v[120:123]
  ds_read_b64_tr_b16 v[190:191], v29 offset:6144
  s_waitcnt vmcnt(16) lgkmcnt(8)
  v_mfma_f32_16x16x32_bf16 v[128:131], v[160:163], v[64:67], v[128:131]
  buffer_load_dwordx4 v[48:51], off, s[36:39], s49 offset:0 sc1
  v_mfma_f32_16x16x32_bf16 v[128:131], v[176:179], v[72:75], v[128:131]
  ds_read_b64_tr_b16 v[192:193], v26 offset:8192
  ds_read_b64_tr_b16 v[194:195], v26 offset:10240
  v_mfma_f32_16x16x32_bf16 v[132:135], v[176:179], v[76:79], v[132:135]
  ds_read_b64_tr_b16 v[196:197], v27 offset:8192
  v_mfma_f32_16x16x32_bf16 v[132:135], v[160:163], v[68:71], v[132:135]
  ds_read_b64_tr_b16 v[198:199], v27 offset:10240
  v_mfma_f32_16x16x32_bf16 v[140:143], v[164:167], v[68:71], v[140:143]
  ds_read_b64_tr_b16 v[208:209], v26 offset:12288
  v_mfma_f32_16x16x32_bf16 v[140:143], v[180:183], v[76:79], v[140:143]
  ds_read_b64_tr_b16 v[210:211], v26 offset:14336
  ds_read_b64_tr_b16 v[212:213], v27 offset:12288
  v_mfma_f32_16x16x32_bf16 v[136:139], v[180:183], v[72:75], v[136:139]
  buffer_load_dwordx4 v[52:55], off, s[64:67], s49 offset:0 sc1
  v_mfma_f32_16x16x32_bf16 v[136:139], v[164:167], v[64:67], v[136:139]
  ds_read_b64_tr_b16 v[214:215], v27 offset:14336
  s_waitcnt lgkmcnt(8)
  v_mfma_f32_16x16x32_bf16 v[144:147], v[168:171], v[64:67], v[144:147]
  ds_read_b64_tr_b16 v[200:201], v28 offset:8192
  v_mfma_f32_16x16x32_bf16 v[144:147], v[184:187], v[72:75], v[144:147]
  ds_read_b64_tr_b16 v[202:203], v28 offset:10240
  v_mfma_f32_16x16x32_bf16 v[148:151], v[184:187], v[76:79], v[148:151]
  ds_read_b64_tr_b16 v[204:205], v29 offset:8192
  v_mfma_f32_16x16x32_bf16 v[148:151], v[168:171], v[68:71], v[148:151]
  ds_read_b64_tr_b16 v[206:207], v29 offset:10240
  v_mfma_f32_16x16x32_bf16 v[156:159], v[172:175], v[68:71], v[156:159]
  buffer_load_dwordx4 v[56:59], off, s[36:39], s49 offset:1024 sc1
  v_mfma_f32_16x16x32_bf16 v[156:159], v[188:191], v[76:79], v[156:159]
  ds_read_b64_tr_b16 v[216:217], v28 offset:12288
  ds_read_b64_tr_b16 v[218:219], v28 offset:14336
  v_mfma_f32_16x16x32_bf16 v[152:155], v[188:191], v[72:75], v[152:155]
  ds_read_b64_tr_b16 v[220:221], v29 offset:12288
  v_mfma_f32_16x16x32_bf16 v[152:155], v[172:175], v[64:67], v[152:155]
  ds_read_b64_tr_b16 v[222:223], v29 offset:14336
  s_waitcnt lgkmcnt(8)
  v_mfma_f32_16x16x32_bf16 v[96:99], v[192:195], v[64:67], v[96:99]
  ds_read_b64_tr_b16 v[160:161], v26 offset:16384
  v_mfma_f32_16x16x32_bf16 v[96:99], v[208:211], v[72:75], v[96:99]
  ds_read_b64_tr_b16 v[162:163], v26 offset:18432
  v_mfma_f32_16x16x32_bf16 v[100:103], v[208:211], v[76:79], v[100:103]
  buffer_load_dwordx4 v[60:63], off, s[64:67], s49 offset:1024 sc1
  v_mfma_f32_16x16x32_bf16 v[100:103], v[192:195], v[68:71], v[100:103]
  ds_read_b64_tr_b16 v[164:165], v27 offset:16384
  ds_read_b64_tr_b16 v[166:167], v27 offset:18432
  v_mfma_f32_16x16x32_bf16 v[108:111], v[196:199], v[68:71], v[108:111]
  ds_read_b64_tr_b16 v[176:177], v26 offset:20480
  v_mfma_f32_16x16x32_bf16 v[108:111], v[212:215], v[76:79], v[108:111]
  ds_read_b64_tr_b16 v[178:179], v26 offset:22528
  v_mfma_f32_16x16x32_bf16 v[104:107], v[212:215], v[72:75], v[104:107]
  ds_read_b64_tr_b16 v[180:181], v27 offset:20480
  v_mfma_f32_16x16x32_bf16 v[104:107], v[196:199], v[64:67], v[104:107]
  ds_read_b64_tr_b16 v[182:183], v27 offset:22528
  s_waitcnt lgkmcnt(8)
  v_mfma_f32_16x16x32_bf16 v[112:115], v[200:203], v[64:67], v[112:115]
  ds_read_b64_tr_b16 v[168:169], v28 offset:16384
  v_mfma_f32_16x16x32_bf16 v[112:115], v[216:219], v[72:75], v[112:115]
  ds_read_b64_tr_b16 v[170:171], v28 offset:18432
  v_mfma_f32_16x16x32_bf16 v[116:119], v[216:219], v[76:79], v[116:119]
  ds_read_b64_tr_b16 v[172:173], v29 offset:16384
  v_mfma_f32_16x16x32_bf16 v[116:119], v[200:203], v[68:71], v[116:119]
  ds_read_b64_tr_b16 v[174:175], v29 offset:18432
  v_mfma_f32_16x16x32_bf16 v[124:127], v[204:207], v[68:71], v[124:127]
  ds_read_b64_tr_b16 v[184:185], v28 offset:20480
  v_mfma_f32_16x16x32_bf16 v[124:127], v[220:223], v[76:79], v[124:127]
  ds_read_b64_tr_b16 v[186:187], v28 offset:22528
  v_readlane_b32 s50, v30, 14
  v_mfma_f32_16x16x32_bf16 v[120:123], v[220:223], v[72:75], v[120:123]
  ds_read_b64_tr_b16 v[188:189], v29 offset:20480
  v_mfma_f32_16x16x32_bf16 v[120:123], v[204:207], v[64:67], v[120:123]
  ds_read_b64_tr_b16 v[190:191], v29 offset:22528
  s_waitcnt vmcnt(16) lgkmcnt(8)
  v_mfma_f32_16x16x32_bf16 v[128:131], v[160:163], v[80:83], v[128:131]
  buffer_load_dwordx4 v[64:67], off, s[36:39], s50 offset:0 sc1
  v_mfma_f32_16x16x32_bf16 v[128:131], v[176:179], v[88:91], v[128:131]
  ds_read_b64_tr_b16 v[192:193], v26 offset:24576
  ds_read_b64_tr_b16 v[194:195], v26 offset:26624
  v_mfma_f32_16x16x32_bf16 v[132:135], v[176:179], v[92:95], v[132:135]
  ds_read_b64_tr_b16 v[196:197], v27 offset:24576
  v_mfma_f32_16x16x32_bf16 v[132:135], v[160:163], v[84:87], v[132:135]
  ds_read_b64_tr_b16 v[198:199], v27 offset:26624
  v_mfma_f32_16x16x32_bf16 v[140:143], v[164:167], v[84:87], v[140:143]
  ds_read_b64_tr_b16 v[208:209], v26 offset:28672
  v_mfma_f32_16x16x32_bf16 v[140:143], v[180:183], v[92:95], v[140:143]
  ds_read_b64_tr_b16 v[210:211], v26 offset:30720
  ds_read_b64_tr_b16 v[212:213], v27 offset:28672
  v_mfma_f32_16x16x32_bf16 v[136:139], v[180:183], v[88:91], v[136:139]
  buffer_load_dwordx4 v[68:71], off, s[64:67], s50 offset:0 sc1
  v_mfma_f32_16x16x32_bf16 v[136:139], v[164:167], v[80:83], v[136:139]
  ds_read_b64_tr_b16 v[214:215], v27 offset:30720
  s_waitcnt lgkmcnt(8)
  v_mfma_f32_16x16x32_bf16 v[144:147], v[168:171], v[80:83], v[144:147]
  ds_read_b64_tr_b16 v[200:201], v28 offset:24576
  v_mfma_f32_16x16x32_bf16 v[144:147], v[184:187], v[88:91], v[144:147]
  ds_read_b64_tr_b16 v[202:203], v28 offset:26624
  v_mfma_f32_16x16x32_bf16 v[148:151], v[184:187], v[92:95], v[148:151]
  ds_read_b64_tr_b16 v[204:205], v29 offset:24576
  v_mfma_f32_16x16x32_bf16 v[148:151], v[168:171], v[84:87], v[148:151]
  ds_read_b64_tr_b16 v[206:207], v29 offset:26624
  v_mfma_f32_16x16x32_bf16 v[156:159], v[172:175], v[84:87], v[156:159]
  buffer_load_dwordx4 v[72:75], off, s[36:39], s50 offset:1024 sc1
  v_mfma_f32_16x16x32_bf16 v[156:159], v[188:191], v[92:95], v[156:159]
  ds_read_b64_tr_b16 v[216:217], v28 offset:28672
  ds_read_b64_tr_b16 v[218:219], v28 offset:30720
  v_mfma_f32_16x16x32_bf16 v[152:155], v[188:191], v[88:91], v[152:155]
  ds_read_b64_tr_b16 v[220:221], v29 offset:28672
  v_mfma_f32_16x16x32_bf16 v[152:155], v[172:175], v[80:83], v[152:155]
  ds_read_b64_tr_b16 v[222:223], v29 offset:30720
  s_waitcnt lgkmcnt(8)
  v_mfma_f32_16x16x32_bf16 v[96:99], v[192:195], v[80:83], v[96:99]
  ds_read_b64_tr_b16 v[160:161], v6 offset:0
  v_mfma_f32_16x16x32_bf16 v[96:99], v[208:211], v[88:91], v[96:99]
  ds_read_b64_tr_b16 v[162:163], v6 offset:2048
  v_mfma_f32_16x16x32_bf16 v[100:103], v[208:211], v[92:95], v[100:103]
  buffer_load_dwordx4 v[76:79], off, s[64:67], s50 offset:1024 sc1
  v_mfma_f32_16x16x32_bf16 v[100:103], v[192:195], v[84:87], v[100:103]
  ds_read_b64_tr_b16 v[164:165], v7 offset:0
  ds_read_b64_tr_b16 v[166:167], v7 offset:2048
  v_mfma_f32_16x16x32_bf16 v[108:111], v[196:199], v[84:87], v[108:111]
  ds_read_b64_tr_b16 v[176:177], v6 offset:4096
  v_mfma_f32_16x16x32_bf16 v[108:111], v[212:215], v[92:95], v[108:111]
  ds_read_b64_tr_b16 v[178:179], v6 offset:6144
  v_mfma_f32_16x16x32_bf16 v[104:107], v[212:215], v[88:91], v[104:107]
  ds_read_b64_tr_b16 v[180:181], v7 offset:4096
  v_mfma_f32_16x16x32_bf16 v[104:107], v[196:199], v[80:83], v[104:107]
  ds_read_b64_tr_b16 v[182:183], v7 offset:6144
  s_waitcnt lgkmcnt(8)
  s_barrier
  v_mfma_f32_16x16x32_bf16 v[112:115], v[200:203], v[80:83], v[112:115]
  ds_read_b64_tr_b16 v[168:169], v8 offset:0
  v_mfma_f32_16x16x32_bf16 v[112:115], v[216:219], v[88:91], v[112:115]
  ds_read_b64_tr_b16 v[170:171], v8 offset:2048
  v_mfma_f32_16x16x32_bf16 v[116:119], v[216:219], v[92:95], v[116:119]
  ds_read_b64_tr_b16 v[172:173], v9 offset:0
  v_mfma_f32_16x16x32_bf16 v[116:119], v[200:203], v[84:87], v[116:119]
  ds_read_b64_tr_b16 v[174:175], v9 offset:2048
  v_mfma_f32_16x16x32_bf16 v[124:127], v[204:207], v[84:87], v[124:127]
  ds_read_b64_tr_b16 v[184:185], v8 offset:4096
  v_mfma_f32_16x16x32_bf16 v[124:127], v[220:223], v[92:95], v[124:127]
  ds_read_b64_tr_b16 v[186:187], v8 offset:6144
  v_readlane_b32 s51, v30, 15
  v_mfma_f32_16x16x32_bf16 v[120:123], v[220:223], v[88:91], v[120:123]
  ds_read_b64_tr_b16 v[188:189], v9 offset:4096
  v_mfma_f32_16x16x32_bf16 v[120:123], v[204:207], v[80:83], v[120:123]
  ds_read_b64_tr_b16 v[190:191], v9 offset:6144
  s_waitcnt vmcnt(16) lgkmcnt(8)
  v_mfma_f32_16x16x32_bf16 v[128:131], v[160:163], v[224:227], v[128:131]
  buffer_load_dwordx4 v[80:83], off, s[36:39], s51 offset:0 sc1
  v_mfma_f32_16x16x32_bf16 v[128:131], v[176:179], v[232:235], v[128:131]
  ds_read_b64_tr_b16 v[192:193], v6 offset:8192
  ds_read_b64_tr_b16 v[194:195], v6 offset:10240
  v_mfma_f32_16x16x32_bf16 v[132:135], v[176:179], v[236:239], v[132:135]
  ds_read_b64_tr_b16 v[196:197], v7 offset:8192
  v_mfma_f32_16x16x32_bf16 v[132:135], v[160:163], v[228:231], v[132:135]
  ds_read_b64_tr_b16 v[198:199], v7 offset:10240
  v_mfma_f32_16x16x32_bf16 v[140:143], v[164:167], v[228:231], v[140:143]
  ds_read_b64_tr_b16 v[208:209], v6 offset:12288
  v_mfma_f32_16x16x32_bf16 v[140:143], v[180:183], v[236:239], v[140:143]
  ds_read_b64_tr_b16 v[210:211], v6 offset:14336
  ds_read_b64_tr_b16 v[212:213], v7 offset:12288
  v_mfma_f32_16x16x32_bf16 v[136:139], v[180:183], v[232:235], v[136:139]
  buffer_load_dwordx4 v[84:87], off, s[64:67], s51 offset:0 sc1
  v_mfma_f32_16x16x32_bf16 v[136:139], v[164:167], v[224:227], v[136:139]
  ds_read_b64_tr_b16 v[214:215], v7 offset:14336
  s_waitcnt lgkmcnt(8)
  v_mfma_f32_16x16x32_bf16 v[144:147], v[168:171], v[224:227], v[144:147]
  ds_read_b64_tr_b16 v[200:201], v8 offset:8192
  v_mfma_f32_16x16x32_bf16 v[144:147], v[184:187], v[232:235], v[144:147]
  ds_read_b64_tr_b16 v[202:203], v8 offset:10240
  v_mfma_f32_16x16x32_bf16 v[148:151], v[184:187], v[236:239], v[148:151]
  ds_read_b64_tr_b16 v[204:205], v9 offset:8192
  v_mfma_f32_16x16x32_bf16 v[148:151], v[168:171], v[228:231], v[148:151]
  ds_read_b64_tr_b16 v[206:207], v9 offset:10240
  v_mfma_f32_16x16x32_bf16 v[156:159], v[172:175], v[228:231], v[156:159]
  buffer_load_dwordx4 v[88:91], off, s[36:39], s51 offset:1024 sc1
  v_mfma_f32_16x16x32_bf16 v[156:159], v[188:191], v[236:239], v[156:159]
  ds_read_b64_tr_b16 v[216:217], v8 offset:12288
  ds_read_b64_tr_b16 v[218:219], v8 offset:14336
  v_mfma_f32_16x16x32_bf16 v[152:155], v[188:191], v[232:235], v[152:155]
  ds_read_b64_tr_b16 v[220:221], v9 offset:12288
  v_mfma_f32_16x16x32_bf16 v[152:155], v[172:175], v[224:227], v[152:155]
  ds_read_b64_tr_b16 v[222:223], v9 offset:14336
  s_waitcnt lgkmcnt(8)
  v_mfma_f32_16x16x32_bf16 v[96:99], v[192:195], v[224:227], v[96:99]
  ds_read_b64_tr_b16 v[160:161], v6 offset:16384
  v_mfma_f32_16x16x32_bf16 v[96:99], v[208:211], v[232:235], v[96:99]
  ds_read_b64_tr_b16 v[162:163], v6 offset:18432
  v_mfma_f32_16x16x32_bf16 v[100:103], v[208:211], v[236:239], v[100:103]
  buffer_load_dwordx4 v[92:95], off, s[64:67], s51 offset:1024 sc1
  v_mfma_f32_16x16x32_bf16 v[100:103], v[192:195], v[228:231], v[100:103]
  ds_read_b64_tr_b16 v[164:165], v7 offset:16384
  ds_read_b64_tr_b16 v[166:167], v7 offset:18432
  v_mfma_f32_16x16x32_bf16 v[108:111], v[196:199], v[228:231], v[108:111]
  ds_read_b64_tr_b16 v[176:177], v6 offset:20480
  v_mfma_f32_16x16x32_bf16 v[108:111], v[212:215], v[236:239], v[108:111]
  ds_read_b64_tr_b16 v[178:179], v6 offset:22528
  v_mfma_f32_16x16x32_bf16 v[104:107], v[212:215], v[232:235], v[104:107]
  ds_read_b64_tr_b16 v[180:181], v7 offset:20480
  v_mfma_f32_16x16x32_bf16 v[104:107], v[196:199], v[224:227], v[104:107]
  ds_read_b64_tr_b16 v[182:183], v7 offset:22528
  s_waitcnt lgkmcnt(8)
  v_mfma_f32_16x16x32_bf16 v[112:115], v[200:203], v[224:227], v[112:115]
  ds_read_b64_tr_b16 v[168:169], v8 offset:16384
  v_mfma_f32_16x16x32_bf16 v[112:115], v[216:219], v[232:235], v[112:115]
  ds_read_b64_tr_b16 v[170:171], v8 offset:18432
  v_mfma_f32_16x16x32_bf16 v[116:119], v[216:219], v[236:239], v[116:119]
  ds_read_b64_tr_b16 v[172:173], v9 offset:16384
  v_mfma_f32_16x16x32_bf16 v[116:119], v[200:203], v[228:231], v[116:119]
  ds_read_b64_tr_b16 v[174:175], v9 offset:18432
  v_mfma_f32_16x16x32_bf16 v[124:127], v[204:207], v[228:231], v[124:127]
  ds_read_b64_tr_b16 v[184:185], v8 offset:20480
  v_mfma_f32_16x16x32_bf16 v[124:127], v[220:223], v[236:239], v[124:127]
  ds_read_b64_tr_b16 v[186:187], v8 offset:22528
  v_readlane_b32 s48, v30, 16
  v_mfma_f32_16x16x32_bf16 v[120:123], v[220:223], v[232:235], v[120:123]
  ds_read_b64_tr_b16 v[188:189], v9 offset:20480
  v_mfma_f32_16x16x32_bf16 v[120:123], v[204:207], v[224:227], v[120:123]
  ds_read_b64_tr_b16 v[190:191], v9 offset:22528
  s_waitcnt vmcnt(16) lgkmcnt(8)
  v_mfma_f32_16x16x32_bf16 v[128:131], v[160:163], v[240:243], v[128:131]
  buffer_load_dwordx4 v[224:227], off, s[36:39], s48 offset:0 sc1
  v_mfma_f32_16x16x32_bf16 v[128:131], v[176:179], v[248:251], v[128:131]
  ds_read_b64_tr_b16 v[192:193], v6 offset:24576
  ds_read_b64_tr_b16 v[194:195], v6 offset:26624
  v_mfma_f32_16x16x32_bf16 v[132:135], v[176:179], v[252:255], v[132:135]
  ds_read_b64_tr_b16 v[196:197], v7 offset:24576
  v_mfma_f32_16x16x32_bf16 v[132:135], v[160:163], v[244:247], v[132:135]
  ds_read_b64_tr_b16 v[198:199], v7 offset:26624
  v_mfma_f32_16x16x32_bf16 v[140:143], v[164:167], v[244:247], v[140:143]
  ds_read_b64_tr_b16 v[208:209], v6 offset:28672
  v_mfma_f32_16x16x32_bf16 v[140:143], v[180:183], v[252:255], v[140:143]
  ds_read_b64_tr_b16 v[210:211], v6 offset:30720
  ds_read_b64_tr_b16 v[212:213], v7 offset:28672
  v_mfma_f32_16x16x32_bf16 v[136:139], v[180:183], v[248:251], v[136:139]
  buffer_load_dwordx4 v[228:231], off, s[64:67], s48 offset:0 sc1
  v_mfma_f32_16x16x32_bf16 v[136:139], v[164:167], v[240:243], v[136:139]
  ds_read_b64_tr_b16 v[214:215], v7 offset:30720
  s_waitcnt lgkmcnt(8)
  v_mfma_f32_16x16x32_bf16 v[144:147], v[168:171], v[240:243], v[144:147]
  ds_read_b64_tr_b16 v[200:201], v8 offset:24576
  v_mfma_f32_16x16x32_bf16 v[144:147], v[184:187], v[248:251], v[144:147]
  ds_read_b64_tr_b16 v[202:203], v8 offset:26624
  v_mfma_f32_16x16x32_bf16 v[148:151], v[184:187], v[252:255], v[148:151]
  ds_read_b64_tr_b16 v[204:205], v9 offset:24576
  v_mfma_f32_16x16x32_bf16 v[148:151], v[168:171], v[244:247], v[148:151]
  ds_read_b64_tr_b16 v[206:207], v9 offset:26624
  v_mfma_f32_16x16x32_bf16 v[156:159], v[172:175], v[244:247], v[156:159]
  buffer_load_dwordx4 v[232:235], off, s[36:39], s48 offset:1024 sc1
  v_mfma_f32_16x16x32_bf16 v[156:159], v[188:191], v[252:255], v[156:159]
  ds_read_b64_tr_b16 v[216:217], v8 offset:28672
  ds_read_b64_tr_b16 v[218:219], v8 offset:30720
  v_mfma_f32_16x16x32_bf16 v[152:155], v[188:191], v[248:251], v[152:155]
  ds_read_b64_tr_b16 v[220:221], v9 offset:28672
  v_mfma_f32_16x16x32_bf16 v[152:155], v[172:175], v[240:243], v[152:155]
  ds_read_b64_tr_b16 v[222:223], v9 offset:30720
  s_waitcnt lgkmcnt(8)
  v_mfma_f32_16x16x32_bf16 v[96:99], v[192:195], v[240:243], v[96:99]
  ds_read_b64_tr_b16 v[160:161], v6 offset:32768
  v_mfma_f32_16x16x32_bf16 v[96:99], v[208:211], v[248:251], v[96:99]
  ds_read_b64_tr_b16 v[162:163], v6 offset:34816
  v_mfma_f32_16x16x32_bf16 v[100:103], v[208:211], v[252:255], v[100:103]
  buffer_load_dwordx4 v[236:239], off, s[64:67], s48 offset:1024 sc1
  v_mfma_f32_16x16x32_bf16 v[100:103], v[192:195], v[244:247], v[100:103]
  ds_read_b64_tr_b16 v[164:165], v7 offset:32768
  ds_read_b64_tr_b16 v[166:167], v7 offset:34816
  v_mfma_f32_16x16x32_bf16 v[108:111], v[196:199], v[244:247], v[108:111]
  ds_read_b64_tr_b16 v[176:177], v6 offset:36864
  v_mfma_f32_16x16x32_bf16 v[108:111], v[212:215], v[252:255], v[108:111]
  ds_read_b64_tr_b16 v[178:179], v6 offset:38912
  v_mfma_f32_16x16x32_bf16 v[104:107], v[212:215], v[248:251], v[104:107]
  ds_read_b64_tr_b16 v[180:181], v7 offset:36864
  v_mfma_f32_16x16x32_bf16 v[104:107], v[196:199], v[240:243], v[104:107]
  ds_read_b64_tr_b16 v[182:183], v7 offset:38912
  s_waitcnt lgkmcnt(8)
  s_barrier
  v_mfma_f32_16x16x32_bf16 v[112:115], v[200:203], v[240:243], v[112:115]
  ds_read_b64_tr_b16 v[168:169], v8 offset:32768
  v_mfma_f32_16x16x32_bf16 v[112:115], v[216:219], v[248:251], v[112:115]
  ds_read_b64_tr_b16 v[170:171], v8 offset:34816
  v_mfma_f32_16x16x32_bf16 v[116:119], v[216:219], v[252:255], v[116:119]
  ds_read_b64_tr_b16 v[172:173], v9 offset:32768
  v_mfma_f32_16x16x32_bf16 v[116:119], v[200:203], v[244:247], v[116:119]
  ds_read_b64_tr_b16 v[174:175], v9 offset:34816
  v_mfma_f32_16x16x32_bf16 v[124:127], v[204:207], v[244:247], v[124:127]
  ds_read_b64_tr_b16 v[184:185], v8 offset:36864
  v_mfma_f32_16x16x32_bf16 v[124:127], v[220:223], v[252:255], v[124:127]
  ds_read_b64_tr_b16 v[186:187], v8 offset:38912
  v_readlane_b32 s49, v30, 17
  v_mfma_f32_16x16x32_bf16 v[120:123], v[220:223], v[248:251], v[120:123]
  ds_read_b64_tr_b16 v[188:189], v9 offset:36864
  v_mfma_f32_16x16x32_bf16 v[120:123], v[204:207], v[240:243], v[120:123]
  ds_read_b64_tr_b16 v[190:191], v9 offset:38912
  s_waitcnt vmcnt(16) lgkmcnt(8)
  v_mfma_f32_16x16x32_bf16 v[128:131], v[160:163], v[32:35], v[128:131]
  buffer_load_dwordx4 v[240:243], off, s[36:39], s49 offset:0 sc1
  v_mfma_f32_16x16x32_bf16 v[128:131], v[176:179], v[40:43], v[128:131]
  ds_read_b64_tr_b16 v[192:193], v6 offset:40960
  ds_read_b64_tr_b16 v[194:195], v6 offset:43008
  v_mfma_f32_16x16x32_bf16 v[132:135], v[176:179], v[44:47], v[132:135]
  ds_read_b64_tr_b16 v[196:197], v7 offset:40960
  v_mfma_f32_16x16x32_bf16 v[132:135], v[160:163], v[36:39], v[132:135]
  ds_read_b64_tr_b16 v[198:199], v7 offset:43008
  v_mfma_f32_16x16x32_bf16 v[140:143], v[164:167], v[36:39], v[140:143]
  ds_read_b64_tr_b16 v[208:209], v6 offset:45056
  v_mfma_f32_16x16x32_bf16 v[140:143], v[180:183], v[44:47], v[140:143]
  ds_read_b64_tr_b16 v[210:211], v6 offset:47104
  ds_read_b64_tr_b16 v[212:213], v7 offset:45056
  v_mfma_f32_16x16x32_bf16 v[136:139], v[180:183], v[40:43], v[136:139]
  buffer_load_dwordx4 v[244:247], off, s[64:67], s49 offset:0 sc1
  v_mfma_f32_16x16x32_bf16 v[136:139], v[164:167], v[32:35], v[136:139]
  ds_read_b64_tr_b16 v[214:215], v7 offset:47104
  s_waitcnt lgkmcnt(8)
  v_mfma_f32_16x16x32_bf16 v[144:147], v[168:171], v[32:35], v[144:147]
  ds_read_b64_tr_b16 v[200:201], v8 offset:40960
  v_mfma_f32_16x16x32_bf16 v[144:147], v[184:187], v[40:43], v[144:147]
  ds_read_b64_tr_b16 v[202:203], v8 offset:43008
  v_mfma_f32_16x16x32_bf16 v[148:151], v[184:187], v[44:47], v[148:151]
  ds_read_b64_tr_b16 v[204:205], v9 offset:40960
  v_mfma_f32_16x16x32_bf16 v[148:151], v[168:171], v[36:39], v[148:151]
  ds_read_b64_tr_b16 v[206:207], v9 offset:43008
  v_mfma_f32_16x16x32_bf16 v[156:159], v[172:175], v[36:39], v[156:159]
  buffer_load_dwordx4 v[248:251], off, s[36:39], s49 offset:1024 sc1
  v_mfma_f32_16x16x32_bf16 v[156:159], v[188:191], v[44:47], v[156:159]
  ds_read_b64_tr_b16 v[216:217], v8 offset:45056
  ds_read_b64_tr_b16 v[218:219], v8 offset:47104
  v_mfma_f32_16x16x32_bf16 v[152:155], v[188:191], v[40:43], v[152:155]
  ds_read_b64_tr_b16 v[220:221], v9 offset:45056
  v_mfma_f32_16x16x32_bf16 v[152:155], v[172:175], v[32:35], v[152:155]
  ds_read_b64_tr_b16 v[222:223], v9 offset:47104
  s_waitcnt lgkmcnt(8)
  v_mfma_f32_16x16x32_bf16 v[96:99], v[192:195], v[32:35], v[96:99]
  ds_read_b64_tr_b16 v[160:161], v6 offset:49152
  v_mfma_f32_16x16x32_bf16 v[96:99], v[208:211], v[40:43], v[96:99]
  ds_read_b64_tr_b16 v[162:163], v6 offset:51200
  v_mfma_f32_16x16x32_bf16 v[100:103], v[208:211], v[44:47], v[100:103]
  buffer_load_dwordx4 v[252:255], off, s[64:67], s49 offset:1024 sc1
  v_mfma_f32_16x16x32_bf16 v[100:103], v[192:195], v[36:39], v[100:103]
  ds_read_b64_tr_b16 v[164:165], v7 offset:49152
  ds_read_b64_tr_b16 v[166:167], v7 offset:51200
  v_mfma_f32_16x16x32_bf16 v[108:111], v[196:199], v[36:39], v[108:111]
  ds_read_b64_tr_b16 v[176:177], v6 offset:53248
  v_mfma_f32_16x16x32_bf16 v[108:111], v[212:215], v[44:47], v[108:111]
  ds_read_b64_tr_b16 v[178:179], v6 offset:55296
  v_mfma_f32_16x16x32_bf16 v[104:107], v[212:215], v[40:43], v[104:107]
  ds_read_b64_tr_b16 v[180:181], v7 offset:53248
  v_mfma_f32_16x16x32_bf16 v[104:107], v[196:199], v[32:35], v[104:107]
  ds_read_b64_tr_b16 v[182:183], v7 offset:55296
  s_waitcnt lgkmcnt(8)
  v_mfma_f32_16x16x32_bf16 v[112:115], v[200:203], v[32:35], v[112:115]
  ds_read_b64_tr_b16 v[168:169], v8 offset:49152
  v_mfma_f32_16x16x32_bf16 v[112:115], v[216:219], v[40:43], v[112:115]
  ds_read_b64_tr_b16 v[170:171], v8 offset:51200
  v_mfma_f32_16x16x32_bf16 v[116:119], v[216:219], v[44:47], v[116:119]
  ds_read_b64_tr_b16 v[172:173], v9 offset:49152
  v_mfma_f32_16x16x32_bf16 v[116:119], v[200:203], v[36:39], v[116:119]
  ds_read_b64_tr_b16 v[174:175], v9 offset:51200
  v_mfma_f32_16x16x32_bf16 v[124:127], v[204:207], v[36:39], v[124:127]
  ds_read_b64_tr_b16 v[184:185], v8 offset:53248
  v_mfma_f32_16x16x32_bf16 v[124:127], v[220:223], v[44:47], v[124:127]
  ds_read_b64_tr_b16 v[186:187], v8 offset:55296
  v_readlane_b32 s50, v30, 18
  v_mfma_f32_16x16x32_bf16 v[120:123], v[220:223], v[40:43], v[120:123]
  ds_read_b64_tr_b16 v[188:189], v9 offset:53248
  v_mfma_f32_16x16x32_bf16 v[120:123], v[204:207], v[32:35], v[120:123]
  ds_read_b64_tr_b16 v[190:191], v9 offset:55296
  s_waitcnt vmcnt(16) lgkmcnt(8)
  v_mfma_f32_16x16x32_bf16 v[128:131], v[160:163], v[48:51], v[128:131]
  buffer_load_dwordx4 v[32:35], off, s[36:39], s50 offset:0 sc1
  v_mfma_f32_16x16x32_bf16 v[128:131], v[176:179], v[56:59], v[128:131]
  ds_read_b64_tr_b16 v[192:193], v6 offset:57344
  ds_read_b64_tr_b16 v[194:195], v6 offset:59392
  v_mfma_f32_16x16x32_bf16 v[132:135], v[176:179], v[60:63], v[132:135]
  ds_read_b64_tr_b16 v[196:197], v7 offset:57344
  v_mfma_f32_16x16x32_bf16 v[132:135], v[160:163], v[52:55], v[132:135]
  ds_read_b64_tr_b16 v[198:199], v7 offset:59392
  v_mfma_f32_16x16x32_bf16 v[140:143], v[164:167], v[52:55], v[140:143]
  ds_read_b64_tr_b16 v[208:209], v6 offset:61440
  v_mfma_f32_16x16x32_bf16 v[140:143], v[180:183], v[60:63], v[140:143]
  ds_read_b64_tr_b16 v[210:211], v6 offset:63488
  ds_read_b64_tr_b16 v[212:213], v7 offset:61440
  v_mfma_f32_16x16x32_bf16 v[136:139], v[180:183], v[56:59], v[136:139]
  buffer_load_dwordx4 v[36:39], off, s[64:67], s50 offset:0 sc1
  v_mfma_f32_16x16x32_bf16 v[136:139], v[164:167], v[48:51], v[136:139]
  ds_read_b64_tr_b16 v[214:215], v7 offset:63488
  s_waitcnt lgkmcnt(8)
  v_mfma_f32_16x16x32_bf16 v[144:147], v[168:171], v[48:51], v[144:147]
  ds_read_b64_tr_b16 v[200:201], v8 offset:57344
  v_mfma_f32_16x16x32_bf16 v[144:147], v[184:187], v[56:59], v[144:147]
  ds_read_b64_tr_b16 v[202:203], v8 offset:59392
  v_mfma_f32_16x16x32_bf16 v[148:151], v[184:187], v[60:63], v[148:151]
  ds_read_b64_tr_b16 v[204:205], v9 offset:57344
  v_mfma_f32_16x16x32_bf16 v[148:151], v[168:171], v[52:55], v[148:151]
  ds_read_b64_tr_b16 v[206:207], v9 offset:59392
  v_mfma_f32_16x16x32_bf16 v[156:159], v[172:175], v[52:55], v[156:159]
  buffer_load_dwordx4 v[40:43], off, s[36:39], s50 offset:1024 sc1
  v_mfma_f32_16x16x32_bf16 v[156:159], v[188:191], v[60:63], v[156:159]
  ds_read_b64_tr_b16 v[216:217], v8 offset:61440
  ds_read_b64_tr_b16 v[218:219], v8 offset:63488
  v_mfma_f32_16x16x32_bf16 v[152:155], v[188:191], v[56:59], v[152:155]
  ds_read_b64_tr_b16 v[220:221], v9 offset:61440
  v_mfma_f32_16x16x32_bf16 v[152:155], v[172:175], v[48:51], v[152:155]
  ds_read_b64_tr_b16 v[222:223], v9 offset:63488
  s_waitcnt lgkmcnt(8)
  v_mfma_f32_16x16x32_bf16 v[96:99], v[192:195], v[48:51], v[96:99]
  ds_read_b64_tr_b16 v[160:161], v20 offset:0
  v_mfma_f32_16x16x32_bf16 v[96:99], v[208:211], v[56:59], v[96:99]
  ds_read_b64_tr_b16 v[162:163], v20 offset:2048
  v_mfma_f32_16x16x32_bf16 v[100:103], v[208:211], v[60:63], v[100:103]
  buffer_load_dwordx4 v[44:47], off, s[64:67], s50 offset:1024 sc1
  v_mfma_f32_16x16x32_bf16 v[100:103], v[192:195], v[52:55], v[100:103]
  ds_read_b64_tr_b16 v[164:165], v21 offset:0
  ds_read_b64_tr_b16 v[166:167], v21 offset:2048
  v_mfma_f32_16x16x32_bf16 v[108:111], v[196:199], v[52:55], v[108:111]
  ds_read_b64_tr_b16 v[176:177], v20 offset:4096
  v_mfma_f32_16x16x32_bf16 v[108:111], v[212:215], v[60:63], v[108:111]
  ds_read_b64_tr_b16 v[178:179], v20 offset:6144
  v_mfma_f32_16x16x32_bf16 v[104:107], v[212:215], v[56:59], v[104:107]
  ds_read_b64_tr_b16 v[180:181], v21 offset:4096
  v_mfma_f32_16x16x32_bf16 v[104:107], v[196:199], v[48:51], v[104:107]
  ds_read_b64_tr_b16 v[182:183], v21 offset:6144
  s_waitcnt lgkmcnt(8)
  s_barrier
  v_mfma_f32_16x16x32_bf16 v[112:115], v[200:203], v[48:51], v[112:115]
  ds_read_b64_tr_b16 v[168:169], v22 offset:0
  v_mfma_f32_16x16x32_bf16 v[112:115], v[216:219], v[56:59], v[112:115]
  ds_read_b64_tr_b16 v[170:171], v22 offset:2048
  v_mfma_f32_16x16x32_bf16 v[116:119], v[216:219], v[60:63], v[116:119]
  ds_read_b64_tr_b16 v[172:173], v23 offset:0
  v_mfma_f32_16x16x32_bf16 v[116:119], v[200:203], v[52:55], v[116:119]
  ds_read_b64_tr_b16 v[174:175], v23 offset:2048
  v_mfma_f32_16x16x32_bf16 v[124:127], v[204:207], v[52:55], v[124:127]
  ds_read_b64_tr_b16 v[184:185], v22 offset:4096
  v_mfma_f32_16x16x32_bf16 v[124:127], v[220:223], v[60:63], v[124:127]
  ds_read_b64_tr_b16 v[186:187], v22 offset:6144
  v_readlane_b32 s51, v30, 19
  v_mfma_f32_16x16x32_bf16 v[120:123], v[220:223], v[56:59], v[120:123]
  ds_read_b64_tr_b16 v[188:189], v23 offset:4096
  v_mfma_f32_16x16x32_bf16 v[120:123], v[204:207], v[48:51], v[120:123]
  ds_read_b64_tr_b16 v[190:191], v23 offset:6144
  s_waitcnt vmcnt(16) lgkmcnt(8)
  v_mfma_f32_16x16x32_bf16 v[128:131], v[160:163], v[64:67], v[128:131]
  buffer_load_dwordx4 v[48:51], off, s[36:39], s51 offset:0 sc1
  v_mfma_f32_16x16x32_bf16 v[128:131], v[176:179], v[72:75], v[128:131]
  ds_read_b64_tr_b16 v[192:193], v20 offset:8192
  ds_read_b64_tr_b16 v[194:195], v20 offset:10240
  v_mfma_f32_16x16x32_bf16 v[132:135], v[176:179], v[76:79], v[132:135]
  ds_read_b64_tr_b16 v[196:197], v21 offset:8192
  v_mfma_f32_16x16x32_bf16 v[132:135], v[160:163], v[68:71], v[132:135]
  ds_read_b64_tr_b16 v[198:199], v21 offset:10240
  v_mfma_f32_16x16x32_bf16 v[140:143], v[164:167], v[68:71], v[140:143]
  ds_read_b64_tr_b16 v[208:209], v20 offset:12288
  v_mfma_f32_16x16x32_bf16 v[140:143], v[180:183], v[76:79], v[140:143]
  ds_read_b64_tr_b16 v[210:211], v20 offset:14336
  ds_read_b64_tr_b16 v[212:213], v21 offset:12288
  v_mfma_f32_16x16x32_bf16 v[136:139], v[180:183], v[72:75], v[136:139]
  buffer_load_dwordx4 v[52:55], off, s[64:67], s51 offset:0 sc1
  v_mfma_f32_16x16x32_bf16 v[136:139], v[164:167], v[64:67], v[136:139]
  ds_read_b64_tr_b16 v[214:215], v21 offset:14336
  s_waitcnt lgkmcnt(8)
  v_mfma_f32_16x16x32_bf16 v[144:147], v[168:171], v[64:67], v[144:147]
  ds_read_b64_tr_b16 v[200:201], v22 offset:8192
  v_mfma_f32_16x16x32_bf16 v[144:147], v[184:187], v[72:75], v[144:147]
  ds_read_b64_tr_b16 v[202:203], v22 offset:10240
  v_mfma_f32_16x16x32_bf16 v[148:151], v[184:187], v[76:79], v[148:151]
  ds_read_b64_tr_b16 v[204:205], v23 offset:8192
  v_mfma_f32_16x16x32_bf16 v[148:151], v[168:171], v[68:71], v[148:151]
  ds_read_b64_tr_b16 v[206:207], v23 offset:10240
  v_mfma_f32_16x16x32_bf16 v[156:159], v[172:175], v[68:71], v[156:159]
  buffer_load_dwordx4 v[56:59], off, s[36:39], s51 offset:1024 sc1
  v_mfma_f32_16x16x32_bf16 v[156:159], v[188:191], v[76:79], v[156:159]
  ds_read_b64_tr_b16 v[216:217], v22 offset:12288
  ds_read_b64_tr_b16 v[218:219], v22 offset:14336
  v_mfma_f32_16x16x32_bf16 v[152:155], v[188:191], v[72:75], v[152:155]
  ds_read_b64_tr_b16 v[220:221], v23 offset:12288
  v_mfma_f32_16x16x32_bf16 v[152:155], v[172:175], v[64:67], v[152:155]
  ds_read_b64_tr_b16 v[222:223], v23 offset:14336
  s_waitcnt lgkmcnt(8)
  v_mfma_f32_16x16x32_bf16 v[96:99], v[192:195], v[64:67], v[96:99]
  ds_read_b64_tr_b16 v[160:161], v20 offset:16384
  v_mfma_f32_16x16x32_bf16 v[96:99], v[208:211], v[72:75], v[96:99]
  ds_read_b64_tr_b16 v[162:163], v20 offset:18432
  v_mfma_f32_16x16x32_bf16 v[100:103], v[208:211], v[76:79], v[100:103]
  buffer_load_dwordx4 v[60:63], off, s[64:67], s51 offset:1024 sc1
  v_mfma_f32_16x16x32_bf16 v[100:103], v[192:195], v[68:71], v[100:103]
  ds_read_b64_tr_b16 v[164:165], v21 offset:16384
  ds_read_b64_tr_b16 v[166:167], v21 offset:18432
  v_mfma_f32_16x16x32_bf16 v[108:111], v[196:199], v[68:71], v[108:111]
  ds_read_b64_tr_b16 v[176:177], v20 offset:20480
  v_mfma_f32_16x16x32_bf16 v[108:111], v[212:215], v[76:79], v[108:111]
  ds_read_b64_tr_b16 v[178:179], v20 offset:22528
  v_mfma_f32_16x16x32_bf16 v[104:107], v[212:215], v[72:75], v[104:107]
  ds_read_b64_tr_b16 v[180:181], v21 offset:20480
  v_mfma_f32_16x16x32_bf16 v[104:107], v[196:199], v[64:67], v[104:107]
  ds_read_b64_tr_b16 v[182:183], v21 offset:22528
  s_waitcnt lgkmcnt(8)
  v_mfma_f32_16x16x32_bf16 v[112:115], v[200:203], v[64:67], v[112:115]
  ds_read_b64_tr_b16 v[168:169], v22 offset:16384
  v_mfma_f32_16x16x32_bf16 v[112:115], v[216:219], v[72:75], v[112:115]
  ds_read_b64_tr_b16 v[170:171], v22 offset:18432
  v_mfma_f32_16x16x32_bf16 v[116:119], v[216:219], v[76:79], v[116:119]
  ds_read_b64_tr_b16 v[172:173], v23 offset:16384
  v_mfma_f32_16x16x32_bf16 v[116:119], v[200:203], v[68:71], v[116:119]
  ds_read_b64_tr_b16 v[174:175], v23 offset:18432
  v_mfma_f32_16x16x32_bf16 v[124:127], v[204:207], v[68:71], v[124:127]
  ds_read_b64_tr_b16 v[184:185], v22 offset:20480
  v_mfma_f32_16x16x32_bf16 v[124:127], v[220:223], v[76:79], v[124:127]
  ds_read_b64_tr_b16 v[186:187], v22 offset:22528
  v_readlane_b32 s48, v30, 20
  v_mfma_f32_16x16x32_bf16 v[120:123], v[220:223], v[72:75], v[120:123]
  ds_read_b64_tr_b16 v[188:189], v23 offset:20480
  v_mfma_f32_16x16x32_bf16 v[120:123], v[204:207], v[64:67], v[120:123]
  ds_read_b64_tr_b16 v[190:191], v23 offset:22528
  s_waitcnt vmcnt(16) lgkmcnt(8)
  v_mfma_f32_16x16x32_bf16 v[128:131], v[160:163], v[80:83], v[128:131]
  buffer_load_dwordx4 v[64:67], off, s[36:39], s48 offset:0 sc1
  v_mfma_f32_16x16x32_bf16 v[128:131], v[176:179], v[88:91], v[128:131]
  ds_read_b64_tr_b16 v[192:193], v20 offset:24576
  ds_read_b64_tr_b16 v[194:195], v20 offset:26624
  v_mfma_f32_16x16x32_bf16 v[132:135], v[176:179], v[92:95], v[132:135]
  ds_read_b64_tr_b16 v[196:197], v21 offset:24576
  v_mfma_f32_16x16x32_bf16 v[132:135], v[160:163], v[84:87], v[132:135]
  ds_read_b64_tr_b16 v[198:199], v21 offset:26624
  v_mfma_f32_16x16x32_bf16 v[140:143], v[164:167], v[84:87], v[140:143]
  ds_read_b64_tr_b16 v[208:209], v20 offset:28672
  v_mfma_f32_16x16x32_bf16 v[140:143], v[180:183], v[92:95], v[140:143]
  ds_read_b64_tr_b16 v[210:211], v20 offset:30720
  ds_read_b64_tr_b16 v[212:213], v21 offset:28672
  v_mfma_f32_16x16x32_bf16 v[136:139], v[180:183], v[88:91], v[136:139]
  buffer_load_dwordx4 v[68:71], off, s[64:67], s48 offset:0 sc1
  v_mfma_f32_16x16x32_bf16 v[136:139], v[164:167], v[80:83], v[136:139]
  ds_read_b64_tr_b16 v[214:215], v21 offset:30720
  s_waitcnt lgkmcnt(8)
  v_mfma_f32_16x16x32_bf16 v[144:147], v[168:171], v[80:83], v[144:147]
  ds_read_b64_tr_b16 v[200:201], v22 offset:24576
  v_mfma_f32_16x16x32_bf16 v[144:147], v[184:187], v[88:91], v[144:147]
  ds_read_b64_tr_b16 v[202:203], v22 offset:26624
  v_mfma_f32_16x16x32_bf16 v[148:151], v[184:187], v[92:95], v[148:151]
  ds_read_b64_tr_b16 v[204:205], v23 offset:24576
  v_mfma_f32_16x16x32_bf16 v[148:151], v[168:171], v[84:87], v[148:151]
  ds_read_b64_tr_b16 v[206:207], v23 offset:26624
  v_mfma_f32_16x16x32_bf16 v[156:159], v[172:175], v[84:87], v[156:159]
  buffer_load_dwordx4 v[72:75], off, s[36:39], s48 offset:1024 sc1
  v_mfma_f32_16x16x32_bf16 v[156:159], v[188:191], v[92:95], v[156:159]
  ds_read_b64_tr_b16 v[216:217], v22 offset:28672
  ds_read_b64_tr_b16 v[218:219], v22 offset:30720
  v_mfma_f32_16x16x32_bf16 v[152:155], v[188:191], v[88:91], v[152:155]
  ds_read_b64_tr_b16 v[220:221], v23 offset:28672
  v_mfma_f32_16x16x32_bf16 v[152:155], v[172:175], v[80:83], v[152:155]
  ds_read_b64_tr_b16 v[222:223], v23 offset:30720
  s_waitcnt lgkmcnt(8)
  v_mfma_f32_16x16x32_bf16 v[96:99], v[192:195], v[80:83], v[96:99]
  ds_read_b64_tr_b16 v[160:161], v20 offset:32768
  v_mfma_f32_16x16x32_bf16 v[96:99], v[208:211], v[88:91], v[96:99]
  ds_read_b64_tr_b16 v[162:163], v20 offset:34816
  v_mfma_f32_16x16x32_bf16 v[100:103], v[208:211], v[92:95], v[100:103]
  buffer_load_dwordx4 v[76:79], off, s[64:67], s48 offset:1024 sc1
  v_mfma_f32_16x16x32_bf16 v[100:103], v[192:195], v[84:87], v[100:103]
  ds_read_b64_tr_b16 v[164:165], v21 offset:32768
  ds_read_b64_tr_b16 v[166:167], v21 offset:34816
  v_mfma_f32_16x16x32_bf16 v[108:111], v[196:199], v[84:87], v[108:111]
  ds_read_b64_tr_b16 v[176:177], v20 offset:36864
  v_mfma_f32_16x16x32_bf16 v[108:111], v[212:215], v[92:95], v[108:111]
  ds_read_b64_tr_b16 v[178:179], v20 offset:38912
  v_mfma_f32_16x16x32_bf16 v[104:107], v[212:215], v[88:91], v[104:107]
  ds_read_b64_tr_b16 v[180:181], v21 offset:36864
  v_mfma_f32_16x16x32_bf16 v[104:107], v[196:199], v[80:83], v[104:107]
  ds_read_b64_tr_b16 v[182:183], v21 offset:38912
  s_waitcnt lgkmcnt(8)
  s_barrier
  v_mfma_f32_16x16x32_bf16 v[112:115], v[200:203], v[80:83], v[112:115]
  ds_read_b64_tr_b16 v[168:169], v22 offset:32768
  v_mfma_f32_16x16x32_bf16 v[112:115], v[216:219], v[88:91], v[112:115]
  ds_read_b64_tr_b16 v[170:171], v22 offset:34816
  v_mfma_f32_16x16x32_bf16 v[116:119], v[216:219], v[92:95], v[116:119]
  ds_read_b64_tr_b16 v[172:173], v23 offset:32768
  v_mfma_f32_16x16x32_bf16 v[116:119], v[200:203], v[84:87], v[116:119]
  ds_read_b64_tr_b16 v[174:175], v23 offset:34816
  v_mfma_f32_16x16x32_bf16 v[124:127], v[204:207], v[84:87], v[124:127]
  ds_read_b64_tr_b16 v[184:185], v22 offset:36864
  v_mfma_f32_16x16x32_bf16 v[124:127], v[220:223], v[92:95], v[124:127]
  ds_read_b64_tr_b16 v[186:187], v22 offset:38912
  v_readlane_b32 s49, v30, 21
  v_mfma_f32_16x16x32_bf16 v[120:123], v[220:223], v[88:91], v[120:123]
  ds_read_b64_tr_b16 v[188:189], v23 offset:36864
  v_mfma_f32_16x16x32_bf16 v[120:123], v[204:207], v[80:83], v[120:123]
  ds_read_b64_tr_b16 v[190:191], v23 offset:38912
  s_waitcnt vmcnt(16) lgkmcnt(8)
  v_mfma_f32_16x16x32_bf16 v[128:131], v[160:163], v[224:227], v[128:131]
  buffer_load_dwordx4 v[80:83], off, s[36:39], s49 offset:0 sc1
  v_mfma_f32_16x16x32_bf16 v[128:131], v[176:179], v[232:235], v[128:131]
  ds_read_b64_tr_b16 v[192:193], v20 offset:40960
  ds_read_b64_tr_b16 v[194:195], v20 offset:43008
  v_mfma_f32_16x16x32_bf16 v[132:135], v[176:179], v[236:239], v[132:135]
  ds_read_b64_tr_b16 v[196:197], v21 offset:40960
  v_mfma_f32_16x16x32_bf16 v[132:135], v[160:163], v[228:231], v[132:135]
  ds_read_b64_tr_b16 v[198:199], v21 offset:43008
  v_mfma_f32_16x16x32_bf16 v[140:143], v[164:167], v[228:231], v[140:143]
  ds_read_b64_tr_b16 v[208:209], v20 offset:45056
  v_mfma_f32_16x16x32_bf16 v[140:143], v[180:183], v[236:239], v[140:143]
  ds_read_b64_tr_b16 v[210:211], v20 offset:47104
  ds_read_b64_tr_b16 v[212:213], v21 offset:45056
  v_mfma_f32_16x16x32_bf16 v[136:139], v[180:183], v[232:235], v[136:139]
  buffer_load_dwordx4 v[84:87], off, s[64:67], s49 offset:0 sc1
  v_mfma_f32_16x16x32_bf16 v[136:139], v[164:167], v[224:227], v[136:139]
  ds_read_b64_tr_b16 v[214:215], v21 offset:47104
  s_waitcnt lgkmcnt(8)
  v_mfma_f32_16x16x32_bf16 v[144:147], v[168:171], v[224:227], v[144:147]
  ds_read_b64_tr_b16 v[200:201], v22 offset:40960
  v_mfma_f32_16x16x32_bf16 v[144:147], v[184:187], v[232:235], v[144:147]
  ds_read_b64_tr_b16 v[202:203], v22 offset:43008
  v_mfma_f32_16x16x32_bf16 v[148:151], v[184:187], v[236:239], v[148:151]
  ds_read_b64_tr_b16 v[204:205], v23 offset:40960
  v_mfma_f32_16x16x32_bf16 v[148:151], v[168:171], v[228:231], v[148:151]
  ds_read_b64_tr_b16 v[206:207], v23 offset:43008
  v_mfma_f32_16x16x32_bf16 v[156:159], v[172:175], v[228:231], v[156:159]
  buffer_load_dwordx4 v[88:91], off, s[36:39], s49 offset:1024 sc1
  v_mfma_f32_16x16x32_bf16 v[156:159], v[188:191], v[236:239], v[156:159]
  ds_read_b64_tr_b16 v[216:217], v22 offset:45056
  ds_read_b64_tr_b16 v[218:219], v22 offset:47104
  v_mfma_f32_16x16x32_bf16 v[152:155], v[188:191], v[232:235], v[152:155]
  ds_read_b64_tr_b16 v[220:221], v23 offset:45056
  v_mfma_f32_16x16x32_bf16 v[152:155], v[172:175], v[224:227], v[152:155]
  ds_read_b64_tr_b16 v[222:223], v23 offset:47104
  s_waitcnt lgkmcnt(8)
  v_mfma_f32_16x16x32_bf16 v[96:99], v[192:195], v[224:227], v[96:99]
  ds_read_b64_tr_b16 v[160:161], v20 offset:49152
  v_mfma_f32_16x16x32_bf16 v[96:99], v[208:211], v[232:235], v[96:99]
  ds_read_b64_tr_b16 v[162:163], v20 offset:51200
  v_mfma_f32_16x16x32_bf16 v[100:103], v[208:211], v[236:239], v[100:103]
  buffer_load_dwordx4 v[92:95], off, s[64:67], s49 offset:1024 sc1
  v_mfma_f32_16x16x32_bf16 v[100:103], v[192:195], v[228:231], v[100:103]
  ds_read_b64_tr_b16 v[164:165], v21 offset:49152
  ds_read_b64_tr_b16 v[166:167], v21 offset:51200
  v_mfma_f32_16x16x32_bf16 v[108:111], v[196:199], v[228:231], v[108:111]
  ds_read_b64_tr_b16 v[176:177], v20 offset:53248
  v_mfma_f32_16x16x32_bf16 v[108:111], v[212:215], v[236:239], v[108:111]
  ds_read_b64_tr_b16 v[178:179], v20 offset:55296
  v_mfma_f32_16x16x32_bf16 v[104:107], v[212:215], v[232:235], v[104:107]
  ds_read_b64_tr_b16 v[180:181], v21 offset:53248
  v_mfma_f32_16x16x32_bf16 v[104:107], v[196:199], v[224:227], v[104:107]
  ds_read_b64_tr_b16 v[182:183], v21 offset:55296
  s_waitcnt lgkmcnt(8)
  v_mfma_f32_16x16x32_bf16 v[112:115], v[200:203], v[224:227], v[112:115]
  ds_read_b64_tr_b16 v[168:169], v22 offset:49152
  v_mfma_f32_16x16x32_bf16 v[112:115], v[216:219], v[232:235], v[112:115]
  ds_read_b64_tr_b16 v[170:171], v22 offset:51200
  v_mfma_f32_16x16x32_bf16 v[116:119], v[216:219], v[236:239], v[116:119]
  ds_read_b64_tr_b16 v[172:173], v23 offset:49152
  v_mfma_f32_16x16x32_bf16 v[116:119], v[200:203], v[228:231], v[116:119]
  ds_read_b64_tr_b16 v[174:175], v23 offset:51200
  v_mfma_f32_16x16x32_bf16 v[124:127], v[204:207], v[228:231], v[124:127]
  ds_read_b64_tr_b16 v[184:185], v22 offset:53248
  v_mfma_f32_16x16x32_bf16 v[124:127], v[220:223], v[236:239], v[124:127]
  ds_read_b64_tr_b16 v[186:187], v22 offset:55296
  v_readlane_b32 s50, v30, 22
  v_mfma_f32_16x16x32_bf16 v[120:123], v[220:223], v[232:235], v[120:123]
  ds_read_b64_tr_b16 v[188:189], v23 offset:53248
  v_mfma_f32_16x16x32_bf16 v[120:123], v[204:207], v[224:227], v[120:123]
  ds_read_b64_tr_b16 v[190:191], v23 offset:55296
  s_waitcnt vmcnt(16) lgkmcnt(8)
  v_mfma_f32_16x16x32_bf16 v[128:131], v[160:163], v[240:243], v[128:131]
  buffer_load_dwordx4 v[224:227], off, s[36:39], s50 offset:0 sc1
  v_mfma_f32_16x16x32_bf16 v[128:131], v[176:179], v[248:251], v[128:131]
  ds_read_b64_tr_b16 v[192:193], v20 offset:57344
  ds_read_b64_tr_b16 v[194:195], v20 offset:59392
  v_mfma_f32_16x16x32_bf16 v[132:135], v[176:179], v[252:255], v[132:135]
  ds_read_b64_tr_b16 v[196:197], v21 offset:57344
  v_mfma_f32_16x16x32_bf16 v[132:135], v[160:163], v[244:247], v[132:135]
  ds_read_b64_tr_b16 v[198:199], v21 offset:59392
  v_mfma_f32_16x16x32_bf16 v[140:143], v[164:167], v[244:247], v[140:143]
  ds_read_b64_tr_b16 v[208:209], v20 offset:61440
  v_mfma_f32_16x16x32_bf16 v[140:143], v[180:183], v[252:255], v[140:143]
  ds_read_b64_tr_b16 v[210:211], v20 offset:63488
  ds_read_b64_tr_b16 v[212:213], v21 offset:61440
  v_mfma_f32_16x16x32_bf16 v[136:139], v[180:183], v[248:251], v[136:139]
  buffer_load_dwordx4 v[228:231], off, s[64:67], s50 offset:0 sc1
  v_mfma_f32_16x16x32_bf16 v[136:139], v[164:167], v[240:243], v[136:139]
  ds_read_b64_tr_b16 v[214:215], v21 offset:63488
  s_waitcnt lgkmcnt(8)
  v_mfma_f32_16x16x32_bf16 v[144:147], v[168:171], v[240:243], v[144:147]
  ds_read_b64_tr_b16 v[200:201], v22 offset:57344
  v_mfma_f32_16x16x32_bf16 v[144:147], v[184:187], v[248:251], v[144:147]
  ds_read_b64_tr_b16 v[202:203], v22 offset:59392
  v_mfma_f32_16x16x32_bf16 v[148:151], v[184:187], v[252:255], v[148:151]
  ds_read_b64_tr_b16 v[204:205], v23 offset:57344
  v_mfma_f32_16x16x32_bf16 v[148:151], v[168:171], v[244:247], v[148:151]
  ds_read_b64_tr_b16 v[206:207], v23 offset:59392
  v_mfma_f32_16x16x32_bf16 v[156:159], v[172:175], v[244:247], v[156:159]
  buffer_load_dwordx4 v[232:235], off, s[36:39], s50 offset:1024 sc1
  v_mfma_f32_16x16x32_bf16 v[156:159], v[188:191], v[252:255], v[156:159]
  ds_read_b64_tr_b16 v[216:217], v22 offset:61440
  ds_read_b64_tr_b16 v[218:219], v22 offset:63488
  v_mfma_f32_16x16x32_bf16 v[152:155], v[188:191], v[248:251], v[152:155]
  ds_read_b64_tr_b16 v[220:221], v23 offset:61440
  v_mfma_f32_16x16x32_bf16 v[152:155], v[172:175], v[240:243], v[152:155]
  ds_read_b64_tr_b16 v[222:223], v23 offset:63488
  s_waitcnt vmcnt(15) lgkmcnt(8)
  v_mfma_f32_16x16x32_bf16 v[128:131], v[192:195], v[32:35], v[128:131]
  ds_read_b64_tr_b16 v[160:161], v26 offset:0
  v_mfma_f32_16x16x32_bf16 v[128:131], v[208:211], v[40:43], v[128:131]
  ds_read_b64_tr_b16 v[162:163], v26 offset:2048
  v_mfma_f32_16x16x32_bf16 v[132:135], v[208:211], v[44:47], v[132:135]
  buffer_load_dwordx4 v[236:239], off, s[64:67], s50 offset:1024 sc1
  v_mfma_f32_16x16x32_bf16 v[132:135], v[192:195], v[36:39], v[132:135]
  ds_read_b64_tr_b16 v[164:165], v27 offset:0
  ds_read_b64_tr_b16 v[166:167], v27 offset:2048
  v_mfma_f32_16x16x32_bf16 v[140:143], v[196:199], v[36:39], v[140:143]
  ds_read_b64_tr_b16 v[176:177], v26 offset:4096
  v_mfma_f32_16x16x32_bf16 v[140:143], v[212:215], v[44:47], v[140:143]
  ds_read_b64_tr_b16 v[178:179], v26 offset:6144
  v_mfma_f32_16x16x32_bf16 v[136:139], v[212:215], v[40:43], v[136:139]
  ds_read_b64_tr_b16 v[180:181], v27 offset:4096
  v_mfma_f32_16x16x32_bf16 v[136:139], v[196:199], v[32:35], v[136:139]
  ds_read_b64_tr_b16 v[182:183], v27 offset:6144
  s_waitcnt lgkmcnt(8)
  s_barrier
  v_mfma_f32_16x16x32_bf16 v[144:147], v[200:203], v[32:35], v[144:147]
  ds_read_b64_tr_b16 v[168:169], v28 offset:0
  v_mfma_f32_16x16x32_bf16 v[144:147], v[216:219], v[40:43], v[144:147]
  ds_read_b64_tr_b16 v[170:171], v28 offset:2048
  v_mfma_f32_16x16x32_bf16 v[148:151], v[216:219], v[44:47], v[148:151]
  ds_read_b64_tr_b16 v[172:173], v29 offset:0
  v_mfma_f32_16x16x32_bf16 v[148:151], v[200:203], v[36:39], v[148:151]
  ds_read_b64_tr_b16 v[174:175], v29 offset:2048
  v_mfma_f32_16x16x32_bf16 v[156:159], v[204:207], v[36:39], v[156:159]
  ds_read_b64_tr_b16 v[184:185], v28 offset:4096
  v_mfma_f32_16x16x32_bf16 v[156:159], v[220:223], v[44:47], v[156:159]
  ds_read_b64_tr_b16 v[186:187], v28 offset:6144
  v_mfma_f32_16x16x32_bf16 v[152:155], v[220:223], v[40:43], v[152:155]
  ds_read_b64_tr_b16 v[188:189], v29 offset:4096
  v_mfma_f32_16x16x32_bf16 v[152:155], v[204:207], v[32:35], v[152:155]
  ds_read_b64_tr_b16 v[190:191], v29 offset:6144
  s_waitcnt vmcnt(12) lgkmcnt(8)
  v_mfma_f32_16x16x32_bf16 v[128:131], v[160:163], v[48:51], v[128:131]
  ds_read_b64_tr_b16 v[192:193], v26 offset:8192
  v_mfma_f32_16x16x32_bf16 v[128:131], v[176:179], v[56:59], v[128:131]
  ds_read_b64_tr_b16 v[194:195], v26 offset:10240
  v_mfma_f32_16x16x32_bf16 v[132:135], v[176:179], v[60:63], v[132:135]
  ds_read_b64_tr_b16 v[196:197], v27 offset:8192
  v_mfma_f32_16x16x32_bf16 v[132:135], v[160:163], v[52:55], v[132:135]
  ds_read_b64_tr_b16 v[198:199], v27 offset:10240
  v_mfma_f32_16x16x32_bf16 v[140:143], v[164:167], v[52:55], v[140:143]
  ds_read_b64_tr_b16 v[208:209], v26 offset:12288
  v_mfma_f32_16x16x32_bf16 v[140:143], v[180:183], v[60:63], v[140:143]
  ds_read_b64_tr_b16 v[210:211], v26 offset:14336
  v_mfma_f32_16x16x32_bf16 v[136:139], v[180:183], v[56:59], v[136:139]
  ds_read_b64_tr_b16 v[212:213], v27 offset:12288
  v_mfma_f32_16x16x32_bf16 v[136:139], v[164:167], v[48:51], v[136:139]
  ds_read_b64_tr_b16 v[214:215], v27 offset:14336
  s_waitcnt lgkmcnt(8)
  v_mfma_f32_16x16x32_bf16 v[144:147], v[168:171], v[48:51], v[144:147]
  ds_read_b64_tr_b16 v[200:201], v28 offset:8192
  v_mfma_f32_16x16x32_bf16 v[144:147], v[184:187], v[56:59], v[144:147]
  ds_read_b64_tr_b16 v[202:203], v28 offset:10240
  v_mfma_f32_16x16x32_bf16 v[148:151], v[184:187], v[60:63], v[148:151]
  ds_read_b64_tr_b16 v[204:205], v29 offset:8192
  v_mfma_f32_16x16x32_bf16 v[148:151], v[168:171], v[52:55], v[148:151]
  ds_read_b64_tr_b16 v[206:207], v29 offset:10240
  v_mfma_f32_16x16x32_bf16 v[156:159], v[172:175], v[52:55], v[156:159]
  ds_read_b64_tr_b16 v[216:217], v28 offset:12288
  v_mfma_f32_16x16x32_bf16 v[156:159], v[188:191], v[60:63], v[156:159]
  ds_read_b64_tr_b16 v[218:219], v28 offset:14336
  v_mfma_f32_16x16x32_bf16 v[152:155], v[188:191], v[56:59], v[152:155]
  ds_read_b64_tr_b16 v[220:221], v29 offset:12288
  v_mfma_f32_16x16x32_bf16 v[152:155], v[172:175], v[48:51], v[152:155]
  ds_read_b64_tr_b16 v[222:223], v29 offset:14336
  s_waitcnt vmcnt(8) lgkmcnt(8)
  v_mfma_f32_16x16x32_bf16 v[128:131], v[192:195], v[64:67], v[128:131]
  ds_read_b64_tr_b16 v[160:161], v26 offset:16384
  v_mfma_f32_16x16x32_bf16 v[128:131], v[208:211], v[72:75], v[128:131]
  ds_read_b64_tr_b16 v[162:163], v26 offset:18432
  v_mfma_f32_16x16x32_bf16 v[132:135], v[208:211], v[76:79], v[132:135]
  ds_read_b64_tr_b16 v[164:165], v27 offset:16384
  v_mfma_f32_16x16x32_bf16 v[132:135], v[192:195], v[68:71], v[132:135]
  ds_read_b64_tr_b16 v[166:167], v27 offset:18432
  v_mfma_f32_16x16x32_bf16 v[140:143], v[196:199], v[68:71], v[140:143]
  ds_read_b64_tr_b16 v[176:177], v26 offset:20480
  v_mfma_f32_16x16x32_bf16 v[140:143], v[212:215], v[76:79], v[140:143]
  ds_read_b64_tr_b16 v[178:179], v26 offset:22528
  v_mfma_f32_16x16x32_bf16 v[136:139], v[212:215], v[72:75], v[136:139]
  ds_read_b64_tr_b16 v[180:181], v27 offset:20480
  v_mfma_f32_16x16x32_bf16 v[136:139], v[196:199], v[64:67], v[136:139]
  ds_read_b64_tr_b16 v[182:183], v27 offset:22528
  s_waitcnt lgkmcnt(8)
  v_mfma_f32_16x16x32_bf16 v[144:147], v[200:203], v[64:67], v[144:147]
  ds_read_b64_tr_b16 v[168:169], v28 offset:16384
  v_mfma_f32_16x16x32_bf16 v[144:147], v[216:219], v[72:75], v[144:147]
  ds_read_b64_tr_b16 v[170:171], v28 offset:18432
  v_mfma_f32_16x16x32_bf16 v[148:151], v[216:219], v[76:79], v[148:151]
  ds_read_b64_tr_b16 v[172:173], v29 offset:16384
  v_mfma_f32_16x16x32_bf16 v[148:151], v[200:203], v[68:71], v[148:151]
  ds_read_b64_tr_b16 v[174:175], v29 offset:18432
  v_mfma_f32_16x16x32_bf16 v[156:159], v[204:207], v[68:71], v[156:159]
  ds_read_b64_tr_b16 v[184:185], v28 offset:20480
  v_mfma_f32_16x16x32_bf16 v[156:159], v[220:223], v[76:79], v[156:159]
  ds_read_b64_tr_b16 v[186:187], v28 offset:22528
  v_mfma_f32_16x16x32_bf16 v[152:155], v[220:223], v[72:75], v[152:155]
  ds_read_b64_tr_b16 v[188:189], v29 offset:20480
  v_mfma_f32_16x16x32_bf16 v[152:155], v[204:207], v[64:67], v[152:155]
  ds_read_b64_tr_b16 v[190:191], v29 offset:22528
  s_waitcnt vmcnt(4) lgkmcnt(8)
  v_mfma_f32_16x16x32_bf16 v[128:131], v[160:163], v[80:83], v[128:131]
  ds_read_b64_tr_b16 v[192:193], v26 offset:24576
  v_mfma_f32_16x16x32_bf16 v[128:131], v[176:179], v[88:91], v[128:131]
  ds_read_b64_tr_b16 v[194:195], v26 offset:26624
  v_mfma_f32_16x16x32_bf16 v[132:135], v[176:179], v[92:95], v[132:135]
  ds_read_b64_tr_b16 v[196:197], v27 offset:24576
  v_mfma_f32_16x16x32_bf16 v[132:135], v[160:163], v[84:87], v[132:135]
  ds_read_b64_tr_b16 v[198:199], v27 offset:26624
  v_mfma_f32_16x16x32_bf16 v[140:143], v[164:167], v[84:87], v[140:143]
  ds_read_b64_tr_b16 v[208:209], v26 offset:28672
  v_mfma_f32_16x16x32_bf16 v[140:143], v[180:183], v[92:95], v[140:143]
  ds_read_b64_tr_b16 v[210:211], v26 offset:30720
  v_mfma_f32_16x16x32_bf16 v[136:139], v[180:183], v[88:91], v[136:139]
  ds_read_b64_tr_b16 v[212:213], v27 offset:28672
  v_mfma_f32_16x16x32_bf16 v[136:139], v[164:167], v[80:83], v[136:139]
  ds_read_b64_tr_b16 v[214:215], v27 offset:30720
  s_waitcnt lgkmcnt(8)
  v_mfma_f32_16x16x32_bf16 v[144:147], v[168:171], v[80:83], v[144:147]
  ds_read_b64_tr_b16 v[200:201], v28 offset:24576
  v_mfma_f32_16x16x32_bf16 v[144:147], v[184:187], v[88:91], v[144:147]
  ds_read_b64_tr_b16 v[202:203], v28 offset:26624
  v_mfma_f32_16x16x32_bf16 v[148:151], v[184:187], v[92:95], v[148:151]
  ds_read_b64_tr_b16 v[204:205], v29 offset:24576
  v_mfma_f32_16x16x32_bf16 v[148:151], v[168:171], v[84:87], v[148:151]
  ds_read_b64_tr_b16 v[206:207], v29 offset:26624
  v_mfma_f32_16x16x32_bf16 v[156:159], v[172:175], v[84:87], v[156:159]
  ds_read_b64_tr_b16 v[216:217], v28 offset:28672
  v_mfma_f32_16x16x32_bf16 v[156:159], v[188:191], v[92:95], v[156:159]
  ds_read_b64_tr_b16 v[218:219], v28 offset:30720
  v_mfma_f32_16x16x32_bf16 v[152:155], v[188:191], v[88:91], v[152:155]
  ds_read_b64_tr_b16 v[220:221], v29 offset:28672
  v_mfma_f32_16x16x32_bf16 v[152:155], v[172:175], v[80:83], v[152:155]
  ds_read_b64_tr_b16 v[222:223], v29 offset:30720
  s_waitcnt vmcnt(0) lgkmcnt(8)
  v_mfma_f32_16x16x32_bf16 v[128:131], v[192:195], v[224:227], v[128:131]
  ds_read_b64_tr_b16 v[160:161], v6 offset:0
  v_mfma_f32_16x16x32_bf16 v[128:131], v[208:211], v[232:235], v[128:131]
  ds_read_b64_tr_b16 v[162:163], v6 offset:2048
  v_mfma_f32_16x16x32_bf16 v[132:135], v[208:211], v[236:239], v[132:135]
  ds_read_b64_tr_b16 v[164:165], v7 offset:0
  v_mfma_f32_16x16x32_bf16 v[132:135], v[192:195], v[228:231], v[132:135]
  ds_read_b64_tr_b16 v[166:167], v7 offset:2048
  v_mfma_f32_16x16x32_bf16 v[140:143], v[196:199], v[228:231], v[140:143]
  ds_read_b64_tr_b16 v[176:177], v6 offset:4096
  v_mfma_f32_16x16x32_bf16 v[140:143], v[212:215], v[236:239], v[140:143]
  ds_read_b64_tr_b16 v[178:179], v6 offset:6144
  v_mfma_f32_16x16x32_bf16 v[136:139], v[212:215], v[232:235], v[136:139]
  ds_read_b64_tr_b16 v[180:181], v7 offset:4096
  v_mfma_f32_16x16x32_bf16 v[136:139], v[196:199], v[224:227], v[136:139]
  ds_read_b64_tr_b16 v[182:183], v7 offset:6144
  s_waitcnt lgkmcnt(8)
  s_barrier
  v_mfma_f32_16x16x32_bf16 v[144:147], v[200:203], v[224:227], v[144:147]
  ds_read_b64_tr_b16 v[168:169], v8 offset:0
  v_mfma_f32_16x16x32_bf16 v[144:147], v[216:219], v[232:235], v[144:147]
  ds_read_b64_tr_b16 v[170:171], v8 offset:2048
  v_mfma_f32_16x16x32_bf16 v[148:151], v[216:219], v[236:239], v[148:151]
  ds_read_b64_tr_b16 v[172:173], v9 offset:0
  v_mfma_f32_16x16x32_bf16 v[148:151], v[200:203], v[228:231], v[148:151]
  ds_read_b64_tr_b16 v[174:175], v9 offset:2048
  v_mfma_f32_16x16x32_bf16 v[156:159], v[204:207], v[228:231], v[156:159]
  ds_read_b64_tr_b16 v[184:185], v8 offset:4096
  v_mfma_f32_16x16x32_bf16 v[156:159], v[220:223], v[236:239], v[156:159]
  ds_read_b64_tr_b16 v[186:187], v8 offset:6144
  v_mfma_f32_16x16x32_bf16 v[152:155], v[220:223], v[232:235], v[152:155]
  ds_read_b64_tr_b16 v[188:189], v9 offset:4096
  v_mfma_f32_16x16x32_bf16 v[152:155], v[204:207], v[224:227], v[152:155]
  ds_read_b64_tr_b16 v[190:191], v9 offset:6144
  s_waitcnt lgkmcnt(8)
  v_mfma_f32_16x16x32_bf16 v[96:99], v[160:163], v[240:243], v[96:99]
  ds_read_b64_tr_b16 v[192:193], v6 offset:8192
  v_mfma_f32_16x16x32_bf16 v[96:99], v[176:179], v[248:251], v[96:99]
  ds_read_b64_tr_b16 v[194:195], v6 offset:10240
  v_mfma_f32_16x16x32_bf16 v[100:103], v[176:179], v[252:255], v[100:103]
  ds_read_b64_tr_b16 v[196:197], v7 offset:8192
  v_cvt_pk_bf16_f32 v128, v128, v129
  v_mfma_f32_16x16x32_bf16 v[100:103], v[160:163], v[244:247], v[100:103]
  ds_read_b64_tr_b16 v[198:199], v7 offset:10240
  v_cvt_pk_bf16_f32 v129, v130, v131
  v_mfma_f32_16x16x32_bf16 v[108:111], v[164:167], v[244:247], v[108:111]
  ds_read_b64_tr_b16 v[208:209], v6 offset:12288
  v_cvt_pk_bf16_f32 v130, v132, v133
  v_mfma_f32_16x16x32_bf16 v[108:111], v[180:183], v[252:255], v[108:111]
  ds_read_b64_tr_b16 v[210:211], v6 offset:14336
  v_cvt_pk_bf16_f32 v131, v134, v135
  v_mfma_f32_16x16x32_bf16 v[104:107], v[180:183], v[248:251], v[104:107]
  ds_read_b64_tr_b16 v[212:213], v7 offset:12288
  buffer_store_dwordx4 v[128:131], off, s[60:63], s4 offset:0 sc1
  v_mfma_f32_16x16x32_bf16 v[104:107], v[164:167], v[240:243], v[104:107]
  ds_read_b64_tr_b16 v[214:215], v7 offset:14336
  s_waitcnt lgkmcnt(8)
  v_mfma_f32_16x16x32_bf16 v[112:115], v[168:171], v[240:243], v[112:115]
  ds_read_b64_tr_b16 v[200:201], v8 offset:8192
  v_cvt_pk_bf16_f32 v132, v136, v137
  v_mfma_f32_16x16x32_bf16 v[112:115], v[184:187], v[248:251], v[112:115]
  ds_read_b64_tr_b16 v[202:203], v8 offset:10240
  v_cvt_pk_bf16_f32 v133, v138, v139
  v_mfma_f32_16x16x32_bf16 v[116:119], v[184:187], v[252:255], v[116:119]
  ds_read_b64_tr_b16 v[204:205], v9 offset:8192
  v_cvt_pk_bf16_f32 v134, v140, v141
  v_mfma_f32_16x16x32_bf16 v[116:119], v[168:171], v[244:247], v[116:119]
  ds_read_b64_tr_b16 v[206:207], v9 offset:10240
  v_cvt_pk_bf16_f32 v135, v142, v143
  v_mfma_f32_16x16x32_bf16 v[124:127], v[172:175], v[244:247], v[124:127]
  ds_read_b64_tr_b16 v[216:217], v8 offset:12288
  buffer_store_dwordx4 v[132:135], off, s[60:63], s4 offset:1024 sc1
  v_mfma_f32_16x16x32_bf16 v[124:127], v[188:191], v[252:255], v[124:127]
  ds_read_b64_tr_b16 v[218:219], v8 offset:14336
  v_readlane_b32 s51, v30, 23
  v_mfma_f32_16x16x32_bf16 v[120:123], v[188:191], v[248:251], v[120:123]
  ds_read_b64_tr_b16 v[220:221], v9 offset:12288
  v_cvt_pk_bf16_f32 v136, v144, v145
  v_mfma_f32_16x16x32_bf16 v[120:123], v[172:175], v[240:243], v[120:123]
  ds_read_b64_tr_b16 v[222:223], v9 offset:14336
  s_waitcnt lgkmcnt(8)
  v_mfma_f32_16x16x32_bf16 v[96:99], v[192:195], v[32:35], v[96:99]
  ds_read_b64_tr_b16 v[160:161], v6 offset:16384
  buffer_load_dwordx4 v[240:243], off, s[36:39], s51 offset:0 sc1
  v_mfma_f32_16x16x32_bf16 v[96:99], v[208:211], v[40:43], v[96:99]
  ds_read_b64_tr_b16 v[162:163], v6 offset:18432
  v_cvt_pk_bf16_f32 v137, v146, v147
  v_mfma_f32_16x16x32_bf16 v[100:103], v[208:211], v[44:47], v[100:103]
  ds_read_b64_tr_b16 v[164:165], v7 offset:16384
  v_cvt_pk_bf16_f32 v138, v148, v149
  v_mfma_f32_16x16x32_bf16 v[100:103], v[192:195], v[36:39], v[100:103]
  ds_read_b64_tr_b16 v[166:167], v7 offset:18432
  v_cvt_pk_bf16_f32 v139, v150, v151
  v_mfma_f32_16x16x32_bf16 v[108:111], v[196:199], v[36:39], v[108:111]
  ds_read_b64_tr_b16 v[176:177], v6 offset:20480
  buffer_load_dwordx4 v[244:247], off, s[64:67], s51 offset:0 sc1
  v_mfma_f32_16x16x32_bf16 v[108:111], v[212:215], v[44:47], v[108:111]
  ds_read_b64_tr_b16 v[178:179], v6 offset:22528
  buffer_store_dwordx4 v[136:139], off, s[60:63], s4 offset:2048 sc1
  v_mfma_f32_16x16x32_bf16 v[104:107], v[212:215], v[40:43], v[104:107]
  ds_read_b64_tr_b16 v[180:181], v7 offset:20480
  v_cvt_pk_bf16_f32 v140, v152, v153
  v_mfma_f32_16x16x32_bf16 v[104:107], v[196:199], v[32:35], v[104:107]
  ds_read_b64_tr_b16 v[182:183], v7 offset:22528
  s_waitcnt lgkmcnt(8)
  v_mfma_f32_16x16x32_bf16 v[112:115], v[200:203], v[32:35], v[112:115]
  ds_read_b64_tr_b16 v[168:169], v8 offset:16384
  buffer_load_dwordx4 v[248:251], off, s[36:39], s51 offset:1024 sc1
  v_mfma_f32_16x16x32_bf16 v[112:115], v[216:219], v[40:43], v[112:115]
  ds_read_b64_tr_b16 v[170:171], v8 offset:18432
  v_cvt_pk_bf16_f32 v141, v154, v155
  v_mfma_f32_16x16x32_bf16 v[116:119], v[216:219], v[44:47], v[116:119]
  ds_read_b64_tr_b16 v[172:173], v9 offset:16384
  v_cvt_pk_bf16_f32 v142, v156, v157
  v_mfma_f32_16x16x32_bf16 v[116:119], v[200:203], v[36:39], v[116:119]
  ds_read_b64_tr_b16 v[174:175], v9 offset:18432
  v_cvt_pk_bf16_f32 v143, v158, v159
  v_mfma_f32_16x16x32_bf16 v[124:127], v[204:207], v[36:39], v[124:127]
  ds_read_b64_tr_b16 v[184:185], v8 offset:20480
  buffer_load_dwordx4 v[252:255], off, s[64:67], s51 offset:1024 sc1
  v_mfma_f32_16x16x32_bf16 v[124:127], v[220:223], v[44:47], v[124:127]
  ds_read_b64_tr_b16 v[186:187], v8 offset:22528
  buffer_store_dwordx4 v[140:143], off, s[60:63], s4 offset:3072 sc1
  v_mfma_f32_16x16x32_bf16 v[120:123], v[220:223], v[40:43], v[120:123]
  ds_read_b64_tr_b16 v[188:189], v9 offset:20480
  v_readlane_b32 s48, v30, 24
  v_mfma_f32_16x16x32_bf16 v[120:123], v[204:207], v[32:35], v[120:123]
  ds_read_b64_tr_b16 v[190:191], v9 offset:22528
  s_waitcnt lgkmcnt(8)
  v_mfma_f32_16x16x32_bf16 v[96:99], v[160:163], v[48:51], v[96:99]
  ds_read_b64_tr_b16 v[192:193], v6 offset:24576
  v_mfma_f32_16x16x32_bf16 v[96:99], v[176:179], v[56:59], v[96:99]
  buffer_load_dwordx4 v[32:35], off, s[36:39], s48 offset:0 sc1
  v_mfma_f32_16x16x32_bf16 v[100:103], v[176:179], v[60:63], v[100:103]
  ds_read_b64_tr_b16 v[194:195], v6 offset:26624
  ds_read_b64_tr_b16 v[196:197], v7 offset:24576
  v_mfma_f32_16x16x32_bf16 v[100:103], v[160:163], v[52:55], v[100:103]
  ds_read_b64_tr_b16 v[198:199], v7 offset:26624
  v_mfma_f32_16x16x32_bf16 v[108:111], v[164:167], v[52:55], v[108:111]
  ds_read_b64_tr_b16 v[208:209], v6 offset:28672
  v_mfma_f32_16x16x32_bf16 v[108:111], v[180:183], v[60:63], v[108:111]
  buffer_load_dwordx4 v[36:39], off, s[64:67], s48 offset:0 sc1
  v_mfma_f32_16x16x32_bf16 v[104:107], v[180:183], v[56:59], v[104:107]
  ds_read_b64_tr_b16 v[210:211], v6 offset:30720
  ds_read_b64_tr_b16 v[212:213], v7 offset:28672
  v_mfma_f32_16x16x32_bf16 v[104:107], v[164:167], v[48:51], v[104:107]
  ds_read_b64_tr_b16 v[214:215], v7 offset:30720
  s_waitcnt lgkmcnt(8)
  v_mfma_f32_16x16x32_bf16 v[112:115], v[168:171], v[48:51], v[112:115]
  ds_read_b64_tr_b16 v[200:201], v8 offset:24576
  v_mfma_f32_16x16x32_bf16 v[112:115], v[184:187], v[56:59], v[112:115]
  buffer_load_dwordx4 v[40:43], off, s[36:39], s48 offset:1024 sc1
  v_mfma_f32_16x16x32_bf16 v[116:119], v[184:187], v[60:63], v[116:119]
  ds_read_b64_tr_b16 v[202:203], v8 offset:26624
  ds_read_b64_tr_b16 v[204:205], v9 offset:24576
  v_mfma_f32_16x16x32_bf16 v[116:119], v[168:171], v[52:55], v[116:119]
  ds_read_b64_tr_b16 v[206:207], v9 offset:26624
  v_mfma_f32_16x16x32_bf16 v[124:127], v[172:175], v[52:55], v[124:127]
  ds_read_b64_tr_b16 v[216:217], v8 offset:28672
  v_mfma_f32_16x16x32_bf16 v[124:127], v[188:191], v[60:63], v[124:127]
  buffer_load_dwordx4 v[44:47], off, s[64:67], s48 offset:1024 sc1
  v_mfma_f32_16x16x32_bf16 v[120:123], v[188:191], v[56:59], v[120:123]
  ds_read_b64_tr_b16 v[218:219], v8 offset:30720
  ds_read_b64_tr_b16 v[220:221], v9 offset:28672
  v_mfma_f32_16x16x32_bf16 v[120:123], v[172:175], v[48:51], v[120:123]
  ds_read_b64_tr_b16 v[222:223], v9 offset:30720
  s_waitcnt lgkmcnt(8)
  v_mfma_f32_16x16x32_bf16 v[96:99], v[192:195], v[64:67], v[96:99]
  ds_read_b64_tr_b16 v[160:161], v6 offset:32768
  v_readlane_b32 s49, v30, 25
  v_mfma_f32_16x16x32_bf16 v[96:99], v[208:211], v[72:75], v[96:99]
  ds_read_b64_tr_b16 v[162:163], v6 offset:34816
  v_mfma_f32_16x16x32_bf16 v[100:103], v[208:211], v[76:79], v[100:103]
  ds_read_b64_tr_b16 v[164:165], v7 offset:32768
  v_mfma_f32_16x16x32_bf16 v[100:103], v[192:195], v[68:71], v[100:103]
  buffer_load_dwordx4 v[48:51], off, s[36:39], s49 offset:0 sc1
  v_mfma_f32_16x16x32_bf16 v[108:111], v[196:199], v[68:71], v[108:111]
  ds_read_b64_tr_b16 v[166:167], v7 offset:34816
  ds_read_b64_tr_b16 v[176:177], v6 offset:36864
  v_mfma_f32_16x16x32_bf16 v[108:111], v[212:215], v[76:79], v[108:111]
  ds_read_b64_tr_b16 v[178:179], v6 offset:38912
  v_mfma_f32_16x16x32_bf16 v[104:107], v[212:215], v[72:75], v[104:107]
  ds_read_b64_tr_b16 v[180:181], v7 offset:36864
  v_mfma_f32_16x16x32_bf16 v[104:107], v[196:199], v[64:67], v[104:107]
  ds_read_b64_tr_b16 v[182:183], v7 offset:38912
  s_waitcnt lgkmcnt(8)
  s_barrier
  v_mfma_f32_16x16x32_bf16 v[112:115], v[200:203], v[64:67], v[112:115]
  buffer_load_dwordx4 v[52:55], off, s[64:67], s49 offset:0 sc1
  v_mfma_f32_16x16x32_bf16 v[112:115], v[216:219], v[72:75], v[112:115]
  ds_read_b64_tr_b16 v[168:169], v8 offset:32768
  ds_read_b64_tr_b16 v[170:171], v8 offset:34816
  v_mfma_f32_16x16x32_bf16 v[116:119], v[216:219], v[76:79], v[116:119]
  ds_read_b64_tr_b16 v[172:173], v9 offset:32768
  v_mfma_f32_16x16x32_bf16 v[116:119], v[200:203], v[68:71], v[116:119]
  ds_read_b64_tr_b16 v[174:175], v9 offset:34816
  v_mfma_f32_16x16x32_bf16 v[124:127], v[204:207], v[68:71], v[124:127]
  buffer_load_dwordx4 v[56:59], off, s[36:39], s49 offset:1024 sc1
  v_mfma_f32_16x16x32_bf16 v[124:127], v[220:223], v[76:79], v[124:127]
  ds_read_b64_tr_b16 v[184:185], v8 offset:36864
  ds_read_b64_tr_b16 v[186:187], v8 offset:38912
  v_mfma_f32_16x16x32_bf16 v[120:123], v[220:223], v[72:75], v[120:123]
  ds_read_b64_tr_b16 v[188:189], v9 offset:36864
  v_mfma_f32_16x16x32_bf16 v[120:123], v[204:207], v[64:67], v[120:123]
  ds_read_b64_tr_b16 v[190:191], v9 offset:38912
  s_waitcnt lgkmcnt(8)
  v_mfma_f32_16x16x32_bf16 v[96:99], v[160:163], v[80:83], v[96:99]
  ds_read_b64_tr_b16 v[192:193], v6 offset:40960
  buffer_load_dwordx4 v[60:63], off, s[64:67], s49 offset:1024 sc1
  v_mfma_f32_16x16x32_bf16 v[96:99], v[176:179], v[88:91], v[96:99]
  ds_read_b64_tr_b16 v[194:195], v6 offset:43008
  s_waitcnt vmcnt(8)
  v_mfma_f32_16x16x32_bf16 v[100:103], v[176:179], v[92:95], v[100:103]
  ds_read_b64_tr_b16 v[196:197], v7 offset:40960
  v_readlane_b32 s50, v30, 26
  v_mfma_f32_16x16x32_bf16 v[100:103], v[160:163], v[84:87], v[100:103]
  buffer_store_dword v19, off, s[52:55], s6 sc1
  v_mfma_f32_16x16x32_bf16 v[108:111], v[164:167], v[84:87], v[108:111]
  ds_read_b64_tr_b16 v[198:199], v7 offset:43008
  ds_read_b64_tr_b16 v[208:209], v6 offset:45056
  v_mfma_f32_16x16x32_bf16 v[108:111], v[180:183], v[92:95], v[108:111]
  buffer_load_dwordx4 v[64:67], off, s[36:39], s50 offset:0 sc1
  v_mfma_f32_16x16x32_bf16 v[104:107], v[180:183], v[88:91], v[104:107]
  ds_read_b64_tr_b16 v[210:211], v6 offset:47104
  ds_read_b64_tr_b16 v[212:213], v7 offset:45056
  v_mfma_f32_16x16x32_bf16 v[104:107], v[164:167], v[80:83], v[104:107]
  ds_read_b64_tr_b16 v[214:215], v7 offset:47104
  s_waitcnt lgkmcnt(8)
  v_mfma_f32_16x16x32_bf16 v[112:115], v[168:171], v[80:83], v[112:115]
  ds_read_b64_tr_b16 v[200:201], v8 offset:40960
  v_mfma_f32_16x16x32_bf16 v[112:115], v[184:187], v[88:91], v[112:115]
  buffer_load_dwordx4 v[68:71], off, s[64:67], s50 offset:0 sc1
  v_mfma_f32_16x16x32_bf16 v[116:119], v[184:187], v[92:95], v[116:119]
  ds_read_b64_tr_b16 v[202:203], v8 offset:43008
  ds_read_b64_tr_b16 v[204:205], v9 offset:40960
  v_mfma_f32_16x16x32_bf16 v[116:119], v[168:171], v[84:87], v[116:119]
  ds_read_b64_tr_b16 v[206:207], v9 offset:43008
  v_mfma_f32_16x16x32_bf16 v[124:127], v[172:175], v[84:87], v[124:127]
  ds_read_b64_tr_b16 v[216:217], v8 offset:45056
  v_mfma_f32_16x16x32_bf16 v[124:127], v[188:191], v[92:95], v[124:127]
  buffer_load_dwordx4 v[72:75], off, s[36:39], s50 offset:1024 sc1
  v_mfma_f32_16x16x32_bf16 v[120:123], v[188:191], v[88:91], v[120:123]
  ds_read_b64_tr_b16 v[218:219], v8 offset:47104
  ds_read_b64_tr_b16 v[220:221], v9 offset:45056
  v_mfma_f32_16x16x32_bf16 v[120:123], v[172:175], v[80:83], v[120:123]
  ds_read_b64_tr_b16 v[222:223], v9 offset:47104
  s_waitcnt lgkmcnt(8)
  v_mfma_f32_16x16x32_bf16 v[96:99], v[192:195], v[224:227], v[96:99]
  ds_read_b64_tr_b16 v[160:161], v6 offset:49152
  v_mfma_f32_16x16x32_bf16 v[96:99], v[208:211], v[232:235], v[96:99]
  buffer_load_dwordx4 v[76:79], off, s[64:67], s50 offset:1024 sc1
  v_mfma_f32_16x16x32_bf16 v[100:103], v[208:211], v[236:239], v[100:103]
  ds_read_b64_tr_b16 v[162:163], v6 offset:51200
  ds_read_b64_tr_b16 v[164:165], v7 offset:49152
  v_mfma_f32_16x16x32_bf16 v[100:103], v[192:195], v[228:231], v[100:103]
  ds_read_b64_tr_b16 v[166:167], v7 offset:51200
  v_readlane_b32 s51, v30, 27
  v_mfma_f32_16x16x32_bf16 v[108:111], v[196:199], v[228:231], v[108:111]
  ds_read_b64_tr_b16 v[176:177], v6 offset:53248
  v_mfma_f32_16x16x32_bf16 v[108:111], v[212:215], v[236:239], v[108:111]
  ds_read_b64_tr_b16 v[178:179], v6 offset:55296
  ds_read_b64_tr_b16 v[180:181], v7 offset:53248
  v_mfma_f32_16x16x32_bf16 v[104:107], v[212:215], v[232:235], v[104:107]
  buffer_load_dwordx4 v[80:83], off, s[36:39], s51 offset:0 sc1
  v_mfma_f32_16x16x32_bf16 v[104:107], v[196:199], v[224:227], v[104:107]
  ds_read_b64_tr_b16 v[182:183], v7 offset:55296
  s_waitcnt lgkmcnt(8)
  v_mfma_f32_16x16x32_bf16 v[112:115], v[200:203], v[224:227], v[112:115]
  ds_read_b64_tr_b16 v[168:169], v8 offset:49152
  v_mfma_f32_16x16x32_bf16 v[112:115], v[216:219], v[232:235], v[112:115]
  ds_read_b64_tr_b16 v[170:171], v8 offset:51200
  v_mfma_f32_16x16x32_bf16 v[116:119], v[216:219], v[236:239], v[116:119]
  buffer_load_dwordx4 v[84:87], off, s[64:67], s51 offset:0 sc1
  v_mfma_f32_16x16x32_bf16 v[116:119], v[200:203], v[228:231], v[116:119]
  ds_read_b64_tr_b16 v[172:173], v9 offset:49152
  ds_read_b64_tr_b16 v[174:175], v9 offset:51200
  v_mfma_f32_16x16x32_bf16 v[124:127], v[204:207], v[228:231], v[124:127]
  ds_read_b64_tr_b16 v[184:185], v8 offset:53248
  v_mfma_f32_16x16x32_bf16 v[124:127], v[220:223], v[236:239], v[124:127]
  ds_read_b64_tr_b16 v[186:187], v8 offset:55296
  ds_read_b64_tr_b16 v[188:189], v9 offset:53248
  v_mfma_f32_16x16x32_bf16 v[120:123], v[220:223], v[232:235], v[120:123]
  buffer_load_dwordx4 v[88:91], off, s[36:39], s51 offset:1024 sc1
  v_mfma_f32_16x16x32_bf16 v[120:123], v[204:207], v[224:227], v[120:123]
  ds_read_b64_tr_b16 v[190:191], v9 offset:55296
  s_waitcnt lgkmcnt(8)
  v_mfma_f32_16x16x32_bf16 v[96:99], v[160:163], v[240:243], v[96:99]
  ds_read_b64_tr_b16 v[192:193], v6 offset:57344
  v_mfma_f32_16x16x32_bf16 v[96:99], v[176:179], v[248:251], v[96:99]
  ds_read_b64_tr_b16 v[194:195], v6 offset:59392
  v_mfma_f32_16x16x32_bf16 v[100:103], v[176:179], v[252:255], v[100:103]
  buffer_load_dwordx4 v[92:95], off, s[64:67], s51 offset:1024 sc1
  v_mfma_f32_16x16x32_bf16 v[100:103], v[160:163], v[244:247], v[100:103]
  ds_read_b64_tr_b16 v[196:197], v7 offset:57344
  ds_read_b64_tr_b16 v[198:199], v7 offset:59392
  v_mfma_f32_16x16x32_bf16 v[108:111], v[164:167], v[244:247], v[108:111]
  ds_read_b64_tr_b16 v[208:209], v6 offset:61440
  v_readlane_b32 s48, v30, 28
  v_mfma_f32_16x16x32_bf16 v[108:111], v[180:183], v[252:255], v[108:111]
  ds_read_b64_tr_b16 v[210:211], v6 offset:63488
  v_mfma_f32_16x16x32_bf16 v[104:107], v[180:183], v[248:251], v[104:107]
  ds_read_b64_tr_b16 v[212:213], v7 offset:61440
  v_mfma_f32_16x16x32_bf16 v[104:107], v[164:167], v[240:243], v[104:107]
  ds_read_b64_tr_b16 v[214:215], v7 offset:63488
  s_waitcnt lgkmcnt(8)
  v_mfma_f32_16x16x32_bf16 v[112:115], v[168:171], v[240:243], v[112:115]
  buffer_load_dwordx4 v[224:227], off, s[36:39], s48 offset:0 sc1
  v_mfma_f32_16x16x32_bf16 v[112:115], v[184:187], v[248:251], v[112:115]
  ds_read_b64_tr_b16 v[200:201], v8 offset:57344
  ds_read_b64_tr_b16 v[202:203], v8 offset:59392
  v_mfma_f32_16x16x32_bf16 v[116:119], v[184:187], v[252:255], v[116:119]
  ds_read_b64_tr_b16 v[204:205], v9 offset:57344
  v_mfma_f32_16x16x32_bf16 v[116:119], v[168:171], v[244:247], v[116:119]
  ds_read_b64_tr_b16 v[206:207], v9 offset:59392
  v_mfma_f32_16x16x32_bf16 v[124:127], v[172:175], v[244:247], v[124:127]
  buffer_load_dwordx4 v[228:231], off, s[64:67], s48 offset:0 sc1
  v_mfma_f32_16x16x32_bf16 v[124:127], v[188:191], v[252:255], v[124:127]
  ds_read_b64_tr_b16 v[216:217], v8 offset:61440
  ds_read_b64_tr_b16 v[218:219], v8 offset:63488
  v_mfma_f32_16x16x32_bf16 v[120:123], v[188:191], v[248:251], v[120:123]
  ds_read_b64_tr_b16 v[220:221], v9 offset:61440
  v_mfma_f32_16x16x32_bf16 v[120:123], v[172:175], v[240:243], v[120:123]
  ds_read_b64_tr_b16 v[222:223], v9 offset:63488
  s_waitcnt vmcnt(15) lgkmcnt(8)
  v_mfma_f32_16x16x32_bf16 v[96:99], v[192:195], v[32:35], v[96:99]
  buffer_load_dwordx4 v[232:235], off, s[36:39], s48 offset:1024 sc1
  v_mfma_f32_16x16x32_bf16 v[96:99], v[208:211], v[40:43], v[96:99]
  ds_read_b64_tr_b16 v[160:161], v20 offset:0
  ds_read_b64_tr_b16 v[162:163], v20 offset:2048
  v_mfma_f32_16x16x32_bf16 v[100:103], v[208:211], v[44:47], v[100:103]
  ds_read_b64_tr_b16 v[164:165], v21 offset:0
  v_mfma_f32_16x16x32_bf16 v[100:103], v[192:195], v[36:39], v[100:103]
  ds_read_b64_tr_b16 v[166:167], v21 offset:2048
  v_mfma_f32_16x16x32_bf16 v[108:111], v[196:199], v[36:39], v[108:111]
  buffer_load_dwordx4 v[236:239], off, s[64:67], s48 offset:1024 sc1
  v_mfma_f32_16x16x32_bf16 v[108:111], v[212:215], v[44:47], v[108:111]
  ds_read_b64_tr_b16 v[176:177], v20 offset:4096
  ds_read_b64_tr_b16 v[178:179], v20 offset:6144
  v_mfma_f32_16x16x32_bf16 v[104:107], v[212:215], v[40:43], v[104:107]
  ds_read_b64_tr_b16 v[180:181], v21 offset:4096
  v_readlane_b32 s49, v30, 29
  v_mfma_f32_16x16x32_bf16 v[104:107], v[196:199], v[32:35], v[104:107]
  ds_read_b64_tr_b16 v[182:183], v21 offset:6144
  s_waitcnt lgkmcnt(8)
  v_mfma_f32_16x16x32_bf16 v[112:115], v[200:203], v[32:35], v[112:115]
  ds_read_b64_tr_b16 v[168:169], v22 offset:0
  v_mfma_f32_16x16x32_bf16 v[112:115], v[216:219], v[40:43], v[112:115]
  buffer_load_dwordx4 v[240:243], off, s[36:39], s49 offset:0 sc1
  v_mfma_f32_16x16x32_bf16 v[116:119], v[216:219], v[44:47], v[116:119]
  ds_read_b64_tr_b16 v[170:171], v22 offset:2048
  ds_read_b64_tr_b16 v[172:173], v23 offset:0
  v_mfma_f32_16x16x32_bf16 v[116:119], v[200:203], v[36:39], v[116:119]
  ds_read_b64_tr_b16 v[174:175], v23 offset:2048
  v_mfma_f32_16x16x32_bf16 v[124:127], v[204:207], v[36:39], v[124:127]
  ds_read_b64_tr_b16 v[184:185], v22 offset:4096
  v_mfma_f32_16x16x32_bf16 v[124:127], v[220:223], v[44:47], v[124:127]
  buffer_load_dwordx4 v[244:247], off, s[64:67], s49 offset:0 sc1
  v_mfma_f32_16x16x32_bf16 v[120:123], v[220:223], v[40:43], v[120:123]
  ds_read_b64_tr_b16 v[186:187], v22 offset:6144
  ds_read_b64_tr_b16 v[188:189], v23 offset:4096
  v_mfma_f32_16x16x32_bf16 v[120:123], v[204:207], v[32:35], v[120:123]
  ds_read_b64_tr_b16 v[190:191], v23 offset:6144
  s_waitcnt vmcnt(15) lgkmcnt(8)
  v_mfma_f32_16x16x32_bf16 v[96:99], v[160:163], v[48:51], v[96:99]
  ds_read_b64_tr_b16 v[192:193], v20 offset:8192
  v_mfma_f32_16x16x32_bf16 v[96:99], v[176:179], v[56:59], v[96:99]
  buffer_load_dwordx4 v[248:251], off, s[36:39], s49 offset:1024 sc1
  v_mfma_f32_16x16x32_bf16 v[100:103], v[176:179], v[60:63], v[100:103]
  ds_read_b64_tr_b16 v[194:195], v20 offset:10240
  ds_read_b64_tr_b16 v[196:197], v21 offset:8192
  v_mfma_f32_16x16x32_bf16 v[100:103], v[160:163], v[52:55], v[100:103]
  ds_read_b64_tr_b16 v[198:199], v21 offset:10240
  v_mfma_f32_16x16x32_bf16 v[108:111], v[164:167], v[52:55], v[108:111]
  ds_read_b64_tr_b16 v[208:209], v20 offset:12288
  v_mfma_f32_16x16x32_bf16 v[108:111], v[180:183], v[60:63], v[108:111]
  buffer_load_dwordx4 v[252:255], off, s[64:67], s49 offset:1024 sc1
  v_mfma_f32_16x16x32_bf16 v[104:107], v[180:183], v[56:59], v[104:107]
  ds_read_b64_tr_b16 v[210:211], v20 offset:14336
  ds_read_b64_tr_b16 v[212:213], v21 offset:12288
  v_mfma_f32_16x16x32_bf16 v[104:107], v[164:167], v[48:51], v[104:107]
  ds_read_b64_tr_b16 v[214:215], v21 offset:14336
  s_waitcnt lgkmcnt(8)
  v_mfma_f32_16x16x32_bf16 v[112:115], v[168:171], v[48:51], v[112:115]
  ds_read_b64_tr_b16 v[200:201], v22 offset:8192
  v_readlane_b32 s50, v30, 30
  v_mfma_f32_16x16x32_bf16 v[112:115], v[184:187], v[56:59], v[112:115]
  ds_read_b64_tr_b16 v[202:203], v22 offset:10240
  v_mfma_f32_16x16x32_bf16 v[116:119], v[184:187], v[60:63], v[116:119]
  ds_read_b64_tr_b16 v[204:205], v23 offset:8192
  v_mfma_f32_16x16x32_bf16 v[116:119], v[168:171], v[52:55], v[116:119]
  buffer_load_dwordx4 v[32:35], off, s[36:39], s50 offset:0 sc1
  v_mfma_f32_16x16x32_bf16 v[124:127], v[172:175], v[52:55], v[124:127]
  ds_read_b64_tr_b16 v[206:207], v23 offset:10240
  ds_read_b64_tr_b16 v[216:217], v22 offset:12288
  v_mfma_f32_16x16x32_bf16 v[124:127], v[188:191], v[60:63], v[124:127]
  ds_read_b64_tr_b16 v[218:219], v22 offset:14336
  v_mfma_f32_16x16x32_bf16 v[120:123], v[188:191], v[56:59], v[120:123]
  ds_read_b64_tr_b16 v[220:221], v23 offset:12288
  v_mfma_f32_16x16x32_bf16 v[120:123], v[172:175], v[48:51], v[120:123]
  ds_read_b64_tr_b16 v[222:223], v23 offset:14336
  s_waitcnt vmcnt(13) lgkmcnt(8)
  v_mfma_f32_16x16x32_bf16 v[96:99], v[192:195], v[64:67], v[96:99]
  buffer_load_dwordx4 v[36:39], off, s[64:67], s50 offset:0 sc1
  v_mfma_f32_16x16x32_bf16 v[96:99], v[208:211], v[72:75], v[96:99]
  ds_read_b64_tr_b16 v[160:161], v20 offset:16384
  ds_read_b64_tr_b16 v[162:163], v20 offset:18432
  v_mfma_f32_16x16x32_bf16 v[100:103], v[208:211], v[76:79], v[100:103]
  ds_read_b64_tr_b16 v[164:165], v21 offset:16384
  v_mfma_f32_16x16x32_bf16 v[100:103], v[192:195], v[68:71], v[100:103]
  ds_read_b64_tr_b16 v[166:167], v21 offset:18432
  v_mfma_f32_16x16x32_bf16 v[108:111], v[196:199], v[68:71], v[108:111]
  buffer_load_dwordx4 v[40:43], off, s[36:39], s50 offset:1024 sc1
  v_mfma_f32_16x16x32_bf16 v[108:111], v[212:215], v[76:79], v[108:111]
  ds_read_b64_tr_b16 v[176:177], v20 offset:20480
  ds_read_b64_tr_b16 v[178:179], v20 offset:22528
  v_mfma_f32_16x16x32_bf16 v[104:107], v[212:215], v[72:75], v[104:107]
  ds_read_b64_tr_b16 v[180:181], v21 offset:20480
  v_mfma_f32_16x16x32_bf16 v[104:107], v[196:199], v[64:67], v[104:107]
  ds_read_b64_tr_b16 v[182:183], v21 offset:22528
  s_waitcnt lgkmcnt(8)
  v_mfma_f32_16x16x32_bf16 v[112:115], v[200:203], v[64:67], v[112:115]
  buffer_load_dwordx4 v[44:47], off, s[64:67], s50 offset:1024 sc1
  v_mfma_f32_16x16x32_bf16 v[112:115], v[216:219], v[72:75], v[112:115]
  ds_read_b64_tr_b16 v[168:169], v22 offset:16384
  ds_read_b64_tr_b16 v[170:171], v22 offset:18432
  v_mfma_f32_16x16x32_bf16 v[116:119], v[216:219], v[76:79], v[116:119]
  ds_read_b64_tr_b16 v[172:173], v23 offset:16384
  v_readlane_b32 s51, v30, 31
  v_mfma_f32_16x16x32_bf16 v[116:119], v[200:203], v[68:71], v[116:119]
  ds_read_b64_tr_b16 v[174:175], v23 offset:18432
  v_mfma_f32_16x16x32_bf16 v[124:127], v[204:207], v[68:71], v[124:127]
  ds_read_b64_tr_b16 v[184:185], v22 offset:20480
  v_mfma_f32_16x16x32_bf16 v[124:127], v[220:223], v[76:79], v[124:127]
  buffer_load_dwordx4 v[48:51], off, s[36:39], s51 offset:0 sc1
  v_mfma_f32_16x16x32_bf16 v[120:123], v[220:223], v[72:75], v[120:123]
  ds_read_b64_tr_b16 v[186:187], v22 offset:22528
  ds_read_b64_tr_b16 v[188:189], v23 offset:20480
  v_mfma_f32_16x16x32_bf16 v[120:123], v[204:207], v[64:67], v[120:123]
  ds_read_b64_tr_b16 v[190:191], v23 offset:22528
  s_waitcnt vmcnt(13) lgkmcnt(8)
  v_mfma_f32_16x16x32_bf16 v[96:99], v[160:163], v[80:83], v[96:99]
  ds_read_b64_tr_b16 v[192:193], v20 offset:24576
  v_mfma_f32_16x16x32_bf16 v[96:99], v[176:179], v[88:91], v[96:99]
  buffer_load_dwordx4 v[52:55], off, s[64:67], s51 offset:0 sc1
  v_mfma_f32_16x16x32_bf16 v[100:103], v[176:179], v[92:95], v[100:103]
  ds_read_b64_tr_b16 v[194:195], v20 offset:26624
  ds_read_b64_tr_b16 v[196:197], v21 offset:24576
  v_mfma_f32_16x16x32_bf16 v[100:103], v[160:163], v[84:87], v[100:103]
  ds_read_b64_tr_b16 v[198:199], v21 offset:26624
  v_mfma_f32_16x16x32_bf16 v[108:111], v[164:167], v[84:87], v[108:111]
  ds_read_b64_tr_b16 v[208:209], v20 offset:28672
  v_mfma_f32_16x16x32_bf16 v[108:111], v[180:183], v[92:95], v[108:111]
  buffer_load_dwordx4 v[56:59], off, s[36:39], s51 offset:1024 sc1
  v_mfma_f32_16x16x32_bf16 v[104:107], v[180:183], v[88:91], v[104:107]
  ds_read_b64_tr_b16 v[210:211], v20 offset:30720
  ds_read_b64_tr_b16 v[212:213], v21 offset:28672
  v_mfma_f32_16x16x32_bf16 v[104:107], v[164:167], v[80:83], v[104:107]
  ds_read_b64_tr_b16 v[214:215], v21 offset:30720
  s_waitcnt lgkmcnt(8)
  s_barrier
  v_mfma_f32_16x16x32_bf16 v[112:115], v[168:171], v[80:83], v[112:115]
  ds_read_b64_tr_b16 v[200:201], v22 offset:24576
  buffer_load_dwordx4 v[144:147], off, s[60:63], s5 offset:0 sc1
  v_mfma_f32_16x16x32_bf16 v[112:115], v[184:187], v[88:91], v[112:115]
  ds_read_b64_tr_b16 v[202:203], v22 offset:26624
  buffer_load_dwordx4 v[60:63], off, s[64:67], s51 offset:1024 sc1
  v_mfma_f32_16x16x32_bf16 v[116:119], v[184:187], v[92:95], v[116:119]
  ds_read_b64_tr_b16 v[204:205], v23 offset:24576
  buffer_load_dwordx4 v[148:151], off, s[60:63], s5 offset:1024 sc1
  v_mfma_f32_16x16x32_bf16 v[116:119], v[168:171], v[84:87], v[116:119]
  ds_read_b64_tr_b16 v[206:207], v23 offset:26624
  v_readlane_b32 s48, v30, 32
  v_mfma_f32_16x16x32_bf16 v[124:127], v[172:175], v[84:87], v[124:127]
  buffer_load_dwordx4 v[152:155], off, s[60:63], s5 offset:2048 sc1
  v_mfma_f32_16x16x32_bf16 v[124:127], v[188:191], v[92:95], v[124:127]
  ds_read_b64_tr_b16 v[216:217], v22 offset:28672
  ds_read_b64_tr_b16 v[218:219], v22 offset:30720
  v_mfma_f32_16x16x32_bf16 v[120:123], v[188:191], v[88:91], v[120:123]
  ds_read_b64_tr_b16 v[220:221], v23 offset:28672
  buffer_load_dwordx4 v[64:67], off, s[36:39], s48 offset:0 sc1
  v_mfma_f32_16x16x32_bf16 v[120:123], v[172:175], v[80:83], v[120:123]
  ds_read_b64_tr_b16 v[222:223], v23 offset:30720
  s_waitcnt vmcnt(16) lgkmcnt(8)
  v_mfma_f32_16x16x32_bf16 v[96:99], v[192:195], v[224:227], v[96:99]
  buffer_load_dwordx4 v[156:159], off, s[60:63], s5 offset:3072 sc1
  v_mfma_f32_16x16x32_bf16 v[96:99], v[208:211], v[232:235], v[96:99]
  ds_read_b64_tr_b16 v[160:161], v20 offset:32768
  ds_read_b64_tr_b16 v[162:163], v20 offset:34816
  v_mfma_f32_16x16x32_bf16 v[100:103], v[208:211], v[236:239], v[100:103]
  buffer_load_dwordx4 v[68:71], off, s[64:67], s48 offset:0 sc1
  v_mfma_f32_16x16x32_bf16 v[100:103], v[192:195], v[228:231], v[100:103]
  ds_read_b64_tr_b16 v[164:165], v21 offset:32768
  ds_read_b64_tr_b16 v[166:167], v21 offset:34816
  v_mfma_f32_16x16x32_bf16 v[108:111], v[196:199], v[228:231], v[108:111]
  ds_read_b64_tr_b16 v[176:177], v20 offset:36864
  v_mfma_f32_16x16x32_bf16 v[108:111], v[212:215], v[236:239], v[108:111]
  ds_read_b64_tr_b16 v[178:179], v20 offset:38912
  ds_read_b64_tr_b16 v[180:181], v21 offset:36864
  v_mfma_f32_16x16x32_bf16 v[104:107], v[212:215], v[232:235], v[104:107]
  buffer_load_dwordx4 v[72:75], off, s[36:39], s48 offset:1024 sc1
  v_mfma_f32_16x16x32_bf16 v[104:107], v[196:199], v[224:227], v[104:107]
  ds_read_b64_tr_b16 v[182:183], v21 offset:38912
  s_waitcnt lgkmcnt(8)
  v_mfma_f32_16x16x32_bf16 v[112:115], v[200:203], v[224:227], v[112:115]
  ds_read_b64_tr_b16 v[168:169], v22 offset:32768
  v_mfma_f32_16x16x32_bf16 v[112:115], v[216:219], v[232:235], v[112:115]
  ds_read_b64_tr_b16 v[170:171], v22 offset:34816
  v_mfma_f32_16x16x32_bf16 v[116:119], v[216:219], v[236:239], v[116:119]
  buffer_load_dwordx4 v[76:79], off, s[64:67], s48 offset:1024 sc1
  v_mfma_f32_16x16x32_bf16 v[116:119], v[200:203], v[228:231], v[116:119]
  ds_read_b64_tr_b16 v[172:173], v23 offset:32768
  ds_read_b64_tr_b16 v[174:175], v23 offset:34816
  v_mfma_f32_16x16x32_bf16 v[124:127], v[204:207], v[228:231], v[124:127]
  ds_read_b64_tr_b16 v[184:185], v22 offset:36864
  v_mfma_f32_16x16x32_bf16 v[124:127], v[220:223], v[236:239], v[124:127]
  ds_read_b64_tr_b16 v[186:187], v22 offset:38912
  v_mfma_f32_16x16x32_bf16 v[120:123], v[220:223], v[232:235], v[120:123]
  ds_read_b64_tr_b16 v[188:189], v23 offset:36864
  v_mfma_f32_16x16x32_bf16 v[120:123], v[204:207], v[224:227], v[120:123]
  ds_read_b64_tr_b16 v[190:191], v23 offset:38912
  s_waitcnt vmcnt(16) lgkmcnt(8)
  v_mfma_f32_16x16x32_bf16 v[96:99], v[160:163], v[240:243], v[96:99]
  ds_read_b64_tr_b16 v[192:193], v20 offset:40960
  v_mfma_f32_16x16x32_bf16 v[96:99], v[176:179], v[248:251], v[96:99]
  ds_read_b64_tr_b16 v[194:195], v20 offset:43008
  v_mfma_f32_16x16x32_bf16 v[100:103], v[176:179], v[252:255], v[100:103]
  ds_read_b64_tr_b16 v[196:197], v21 offset:40960
  v_mfma_f32_16x16x32_bf16 v[100:103], v[160:163], v[244:247], v[100:103]
  ds_read_b64_tr_b16 v[198:199], v21 offset:43008
  v_mfma_f32_16x16x32_bf16 v[108:111], v[164:167], v[244:247], v[108:111]
  ds_read_b64_tr_b16 v[208:209], v20 offset:45056
  v_mfma_f32_16x16x32_bf16 v[108:111], v[180:183], v[252:255], v[108:111]
  ds_read_b64_tr_b16 v[210:211], v20 offset:47104
  v_mfma_f32_16x16x32_bf16 v[104:107], v[180:183], v[248:251], v[104:107]
  ds_read_b64_tr_b16 v[212:213], v21 offset:45056
  v_mfma_f32_16x16x32_bf16 v[104:107], v[164:167], v[240:243], v[104:107]
  ds_read_b64_tr_b16 v[214:215], v21 offset:47104
  s_waitcnt lgkmcnt(8)
  v_mfma_f32_16x16x32_bf16 v[112:115], v[168:171], v[240:243], v[112:115]
  ds_read_b64_tr_b16 v[200:201], v22 offset:40960
  v_mfma_f32_16x16x32_bf16 v[112:115], v[184:187], v[248:251], v[112:115]
  ds_read_b64_tr_b16 v[202:203], v22 offset:43008
  v_mfma_f32_16x16x32_bf16 v[116:119], v[184:187], v[252:255], v[116:119]
  ds_read_b64_tr_b16 v[204:205], v23 offset:40960
  v_mfma_f32_16x16x32_bf16 v[116:119], v[168:171], v[244:247], v[116:119]
  ds_read_b64_tr_b16 v[206:207], v23 offset:43008
  v_mfma_f32_16x16x32_bf16 v[124:127], v[172:175], v[244:247], v[124:127]
  ds_read_b64_tr_b16 v[216:217], v22 offset:45056
  v_mfma_f32_16x16x32_bf16 v[124:127], v[188:191], v[252:255], v[124:127]
  ds_read_b64_tr_b16 v[218:219], v22 offset:47104
  v_mfma_f32_16x16x32_bf16 v[120:123], v[188:191], v[248:251], v[120:123]
  ds_read_b64_tr_b16 v[220:221], v23 offset:45056
  v_mfma_f32_16x16x32_bf16 v[120:123], v[172:175], v[240:243], v[120:123]
  ds_read_b64_tr_b16 v[222:223], v23 offset:47104
  s_waitcnt vmcnt(12) lgkmcnt(8)
  v_mfma_f32_16x16x32_bf16 v[96:99], v[192:195], v[32:35], v[96:99]
  ds_read_b64_tr_b16 v[160:161], v20 offset:49152
  v_mfma_f32_16x16x32_bf16 v[96:99], v[208:211], v[40:43], v[96:99]
  ds_read_b64_tr_b16 v[162:163], v20 offset:51200
  v_mfma_f32_16x16x32_bf16 v[100:103], v[208:211], v[44:47], v[100:103]
  ds_read_b64_tr_b16 v[164:165], v21 offset:49152
  v_mfma_f32_16x16x32_bf16 v[100:103], v[192:195], v[36:39], v[100:103]
  ds_read_b64_tr_b16 v[166:167], v21 offset:51200
  v_mfma_f32_16x16x32_bf16 v[108:111], v[196:199], v[36:39], v[108:111]
  ds_read_b64_tr_b16 v[176:177], v20 offset:53248
  v_mfma_f32_16x16x32_bf16 v[108:111], v[212:215], v[44:47], v[108:111]
  ds_read_b64_tr_b16 v[178:179], v20 offset:55296
  v_mfma_f32_16x16x32_bf16 v[104:107], v[212:215], v[40:43], v[104:107]
  ds_read_b64_tr_b16 v[180:181], v21 offset:53248
  v_mfma_f32_16x16x32_bf16 v[104:107], v[196:199], v[32:35], v[104:107]
  ds_read_b64_tr_b16 v[182:183], v21 offset:55296
  s_waitcnt lgkmcnt(8)
  v_mfma_f32_16x16x32_bf16 v[112:115], v[200:203], v[32:35], v[112:115]
  ds_read_b64_tr_b16 v[168:169], v22 offset:49152
  v_mfma_f32_16x16x32_bf16 v[112:115], v[216:219], v[40:43], v[112:115]
  ds_read_b64_tr_b16 v[170:171], v22 offset:51200
  v_mfma_f32_16x16x32_bf16 v[116:119], v[216:219], v[44:47], v[116:119]
  ds_read_b64_tr_b16 v[172:173], v23 offset:49152
  v_mfma_f32_16x16x32_bf16 v[116:119], v[200:203], v[36:39], v[116:119]
  ds_read_b64_tr_b16 v[174:175], v23 offset:51200
  v_mfma_f32_16x16x32_bf16 v[124:127], v[204:207], v[36:39], v[124:127]
  ds_read_b64_tr_b16 v[184:185], v22 offset:53248
  v_mfma_f32_16x16x32_bf16 v[124:127], v[220:223], v[44:47], v[124:127]
  ds_read_b64_tr_b16 v[186:187], v22 offset:55296
  v_mfma_f32_16x16x32_bf16 v[120:123], v[220:223], v[40:43], v[120:123]
  ds_read_b64_tr_b16 v[188:189], v23 offset:53248
  v_mfma_f32_16x16x32_bf16 v[120:123], v[204:207], v[32:35], v[120:123]
  ds_read_b64_tr_b16 v[190:191], v23 offset:55296
  s_waitcnt vmcnt(7) lgkmcnt(8)
  v_mfma_f32_16x16x32_bf16 v[96:99], v[160:163], v[48:51], v[96:99]
  ds_read_b64_tr_b16 v[192:193], v20 offset:57344
  s_waitcnt vmcnt(3)
  v_mfma_f32_16x16x32_bf16 v[96:99], v[176:179], v[56:59], v[96:99]
  ds_read_b64_tr_b16 v[194:195], v20 offset:59392
  v_lshlrev_b32 v128, 16, v144
  v_mfma_f32_16x16x32_bf16 v[100:103], v[176:179], v[60:63], v[100:103]
  ds_read_b64_tr_b16 v[196:197], v21 offset:57344
  v_and_b32 v129, s11, v144
  v_mfma_f32_16x16x32_bf16 v[100:103], v[160:163], v[52:55], v[100:103]
  ds_read_b64_tr_b16 v[198:199], v21 offset:59392
  v_lshlrev_b32 v130, 16, v145
  v_mfma_f32_16x16x32_bf16 v[108:111], v[164:167], v[52:55], v[108:111]
  ds_read_b64_tr_b16 v[208:209], v20 offset:61440
  v_and_b32 v131, s11, v145
  v_mfma_f32_16x16x32_bf16 v[108:111], v[180:183], v[60:63], v[108:111]
  ds_read_b64_tr_b16 v[210:211], v20 offset:63488
  v_lshlrev_b32 v132, 16, v146
  v_mfma_f32_16x16x32_bf16 v[104:107], v[180:183], v[56:59], v[104:107]
  ds_read_b64_tr_b16 v[212:213], v21 offset:61440
  v_and_b32 v133, s11, v146
  v_mfma_f32_16x16x32_bf16 v[104:107], v[164:167], v[48:51], v[104:107]
  ds_read_b64_tr_b16 v[214:215], v21 offset:63488
  s_waitcnt lgkmcnt(8)
  v_mfma_f32_16x16x32_bf16 v[112:115], v[168:171], v[48:51], v[112:115]
  ds_read_b64_tr_b16 v[200:201], v22 offset:57344
  v_lshlrev_b32 v134, 16, v147
  v_mfma_f32_16x16x32_bf16 v[112:115], v[184:187], v[56:59], v[112:115]
  ds_read_b64_tr_b16 v[202:203], v22 offset:59392
  v_and_b32 v135, s11, v147
  v_mfma_f32_16x16x32_bf16 v[116:119], v[184:187], v[60:63], v[116:119]
  ds_read_b64_tr_b16 v[204:205], v23 offset:57344
  v_lshlrev_b32 v136, 16, v148
  v_mfma_f32_16x16x32_bf16 v[116:119], v[168:171], v[52:55], v[116:119]
  ds_read_b64_tr_b16 v[206:207], v23 offset:59392
  v_and_b32 v137, s11, v148
  v_mfma_f32_16x16x32_bf16 v[124:127], v[172:175], v[52:55], v[124:127]
  ds_read_b64_tr_b16 v[216:217], v22 offset:61440
  v_lshlrev_b32 v138, 16, v149
  v_mfma_f32_16x16x32_bf16 v[124:127], v[188:191], v[60:63], v[124:127]
  ds_read_b64_tr_b16 v[218:219], v22 offset:63488
  v_and_b32 v139, s11, v149
  v_mfma_f32_16x16x32_bf16 v[120:123], v[188:191], v[56:59], v[120:123]
  ds_read_b64_tr_b16 v[220:221], v23 offset:61440
  v_lshlrev_b32 v140, 16, v150
  v_mfma_f32_16x16x32_bf16 v[120:123], v[172:175], v[48:51], v[120:123]
  ds_read_b64_tr_b16 v[222:223], v23 offset:63488
  s_waitcnt vmcnt(0) lgkmcnt(8)
  v_mfma_f32_16x16x32_bf16 v[96:99], v[192:195], v[64:67], v[96:99]
  v_mov_b32 v20, 0x3f803f80
  v_mov_b32 v21, 0x3f803f80
  v_mfma_f32_16x16x32_bf16 v[96:99], v[208:211], v[72:75], v[96:99]
  v_mov_b32 v22, 0x3f803f80
  v_mov_b32 v23, 0x3f803f80
  v_mfma_f32_16x16x32_bf16 v[100:103], v[208:211], v[76:79], v[100:103]
  v_and_b32 v141, s11, v150
  v_lshlrev_b32 v142, 16, v151
  v_and_b32 v143, s11, v151
  v_mfma_f32_16x16x32_bf16 v[100:103], v[192:195], v[68:71], v[100:103]
  v_lshlrev_b32 v144, 16, v152
  v_and_b32 v145, s11, v152
  v_lshlrev_b32 v146, 16, v153
  v_mfma_f32_16x16x32_bf16 v[108:111], v[196:199], v[68:71], v[108:111]
  v_and_b32 v147, s11, v153
  v_lshlrev_b32 v148, 16, v154
  v_and_b32 v149, s11, v154
  v_mfma_f32_16x16x32_bf16 v[108:111], v[212:215], v[76:79], v[108:111]
  v_lshlrev_b32 v150, 16, v155
  v_and_b32 v151, s11, v155
  v_lshlrev_b32 v152, 16, v156
  v_mfma_f32_16x16x32_bf16 v[104:107], v[212:215], v[72:75], v[104:107]
  v_and_b32 v153, s11, v156
  v_lshlrev_b32 v154, 16, v157
  v_and_b32 v155, s11, v157
  v_mfma_f32_16x16x32_bf16 v[104:107], v[196:199], v[64:67], v[104:107]
  s_waitcnt lgkmcnt(0)
  v_lshlrev_b32 v156, 16, v158
  v_and_b32 v157, s11, v158
  v_mfma_f32_16x16x32_bf16 v[112:115], v[200:203], v[64:67], v[112:115]
  v_lshlrev_b32 v158, 16, v159
  v_and_b32 v159, s11, v159
  v_mfma_f32_16x16x32_bf16 v[112:115], v[216:219], v[72:75], v[112:115]
  v_mfma_f32_16x16x32_bf16 v[116:119], v[216:219], v[76:79], v[116:119]
  v_mfma_f32_16x16x32_bf16 v[116:119], v[200:203], v[68:71], v[116:119]
  v_mfma_f32_16x16x32_bf16 v[124:127], v[204:207], v[68:71], v[124:127]
  v_mfma_f32_16x16x32_bf16 v[124:127], v[220:223], v[76:79], v[124:127]
  v_mfma_f32_16x16x32_bf16 v[120:123], v[220:223], v[72:75], v[120:123]
  v_mfma_f32_16x16x32_bf16 v[120:123], v[204:207], v[64:67], v[120:123]
  s_lshl_b32 s3, s7, 4
  s_mov_b32 vcc_lo, 0xaaaaaaaa
  s_lshl_b32 s4, s7, 3
  s_add_u32 s5, s3, s4
  v_xor_b32 v6, 32, v4
  v_xor_b32 v7, 64, v4
  v_xor_b32 v8, 96, v4
  v_xor_b32 v9, 64, v12
  v_pk_add_f32 v[96:97], v[96:97], v[128:129]
  v_pk_add_f32 v[98:99], v[98:99], v[130:131]
  v_cvt_pk_bf16_f32 v240, v96, v97
  v_cvt_pk_bf16_f32 v241, v98, v99
  v_pk_add_f32 v[104:105], v[104:105], v[136:137]
  v_pk_add_f32 v[106:107], v[106:107], v[138:139]
  v_cvt_pk_bf16_f32 v242, v104, v105
  v_cvt_pk_bf16_f32 v243, v106, v107
  ds_write_b64 v4, v[240:241] offset:0
  ds_write_b64 v6, v[242:243] offset:0
  v_pk_add_f32 v[112:113], v[112:113], v[144:145]
  v_pk_add_f32 v[114:115], v[114:115], v[146:147]
  v_cvt_pk_bf16_f32 v244, v112, v113
  v_cvt_pk_bf16_f32 v245, v114, v115
  v_pk_add_f32 v[120:121], v[120:121], v[152:153]
  v_pk_add_f32 v[122:123], v[122:123], v[154:155]
  v_cvt_pk_bf16_f32 v246, v120, v121
  v_cvt_pk_bf16_f32 v247, v122, v123
  ds_write_b64 v7, v[244:245] offset:0
  ds_write_b64 v8, v[246:247] offset:0
  ds_read_b128 v[32:35], v5 offset:0
  ds_read_b128 v[36:39], v5 offset:1024
  v_pk_add_f32 v[100:101], v[100:101], v[132:133]
  v_pk_add_f32 v[102:103], v[102:103], v[134:135]
  v_cvt_pk_bf16_f32 v248, v100, v101
  v_cvt_pk_bf16_f32 v249, v102, v103
  v_pk_add_f32 v[108:109], v[108:109], v[140:141]
  v_pk_add_f32 v[110:111], v[110:111], v[142:143]
  v_cvt_pk_bf16_f32 v250, v108, v109
  v_cvt_pk_bf16_f32 v251, v110, v111
  ds_write_b64 v4, v[248:249] offset:2048
  ds_write_b64 v6, v[250:251] offset:2048
  v_pk_add_f32 v[116:117], v[116:117], v[148:149]
  v_pk_add_f32 v[118:119], v[118:119], v[150:151]
  v_cvt_pk_bf16_f32 v252, v116, v117
  v_cvt_pk_bf16_f32 v253, v118, v119
  v_pk_add_f32 v[124:125], v[124:125], v[156:157]
  v_pk_add_f32 v[126:127], v[126:127], v[158:159]
  v_cvt_pk_bf16_f32 v254, v124, v125
  v_cvt_pk_bf16_f32 v255, v126, v127
  ds_write_b64 v7, v[252:253] offset:2048
  ds_write_b64 v8, v[254:255] offset:2048
  ds_read_b128 v[40:43], v5 offset:2048
  ds_read_b128 v[44:47], v5 offset:3072
  s_waitcnt lgkmcnt(7)
  buffer_store_dwordx4 v[32:35], v12, s[40:43], 0 offen sc1
  s_waitcnt lgkmcnt(6)
  buffer_store_dwordx4 v[36:39], v9, s[40:43], s4 offen sc1
  v_mfma_f32_16x16x32_bf16 v[52:55], v[240:243], v[240:243], 0
  s_mov_b32 vcc_hi, vcc_lo
  v_mfma_f32_16x16x32_bf16 v[48:51], v[20:23], v[240:243], 0
  s_mov_b32 s8, 0xcccccccc
  v_mfma_f32_16x16x32_bf16 v[52:55], v[244:247], v[244:247], v[52:55]
  s_mov_b32 s9, s8
  v_mfma_f32_16x16x32_bf16 v[48:51], v[20:23], v[244:247], v[48:51]
  s_waitcnt lgkmcnt(1)
  buffer_store_dwordx4 v[40:43], v12, s[40:43], s3 offen sc1
  s_waitcnt lgkmcnt(0)
  buffer_store_dwordx4 v[44:47], v9, s[40:43], s5 offen sc1
  s_cmp_eq_u32 s96, 1
  s_cbranch_scc1 L_w2_end
  v_mfma_f32_16x16x32_bf16 v[60:63], v[248:251], v[248:251], 0
  v_mfma_f32_16x16x32_bf16 v[56:59], v[20:23], v[248:251], 0
  v_mfma_f32_16x16x32_bf16 v[60:63], v[252:255], v[252:255], v[60:63]
  v_mfma_f32_16x16x32_bf16 v[56:59], v[20:23], v[252:255], v[56:59]
  v_cndmask_b32 v52, v52, v53, vcc
  v_cndmask_b32 v54, v54, v55, vcc
  v_cndmask_b32 v49, v52, v54, s[8:9]
  buffer_store_dwordx2 v[48:49], v18, s[56:59], 0 offen offset:0 sc1
  s_nop 2
  v_cndmask_b32 v60, v60, v61, vcc
  v_cndmask_b32 v62, v62, v63, vcc
  v_cndmask_b32 v57, v60, v62, s[8:9]
  buffer_store_dwordx2 v[56:57], v18, s[56:59], 0 offen offset:128 sc1
  s_waitcnt vmcnt(0) lgkmcnt(0)
  s_barrier
  s_mov_b32 s96, 1
  s_add_u32 s12, s22, 33554432
  s_addc_u32 s13, s23, 0
  s_add_u32 s34, s22, 67108864
  s_addc_u32 s35, s23, 0
  s_add_u32 s97, s97, 1
  s_branch L_attn_body
L_w2_c1:
```
